```python
import torch

def _softmax(x, axis=-1):
    return torch.softmax(x, dim=axis)

def _gelu(x):
    return torch.nn.functional.gelu(x, approximate='tanh')

def _silu(x):
    return torch.nn.functional.silu(x)

def _sigmoid(x):
    return torch.sigmoid(x)

def _layernorm(x, axis=-1, eps=1e-05):
    m = x.mean(dim=axis, keepdim=True)
    v = x.var(dim=axis, keepdim=True, unbiased=False)
    return (x - m) / torch.sqrt(v + eps)

def _scatter_add(tgt, idx, src, axis=0):
    return tgt.clone().index_add_(axis, idx, src)

def _segment_sum(src, seg, n):
    out = torch.zeros((n,) + src.shape[1:], dtype=src.dtype)
    return out.index_add_(0, seg, src)

def _pad(x, pw):
    flat = tuple((v for pair in reversed(pw) for v in pair))
    return torch.nn.functional.pad(x, flat)
kernel_name = 'adaLN_cond__gqa_block_cached__moe_arch_mod__prompt'

def setup_inputs():

    _w = lambda a: (lambda t: t.to(torch.bfloat16) if t.is_floating_point() else t)(torch.as_tensor(a))

    def _A_setup():
        B, Sq, D = (1, 2048, 576)
        Hq, Hkv, Sk, Dh = (32, 16, 2048, 128)
        assert Hq % Hkv == 0, (Hq, Hkv)
        return {'x': _w((lambda *s: torch.randn(*s, dtype=torch.bfloat16) * 0.1)(B, Sq, D)), 'k_cache': _w((lambda *s: torch.randn(*s, dtype=torch.bfloat16) * 0.8)(B, Hkv, Sk, Dh)), 'v_cache': _w((lambda *s: torch.randn(*s, dtype=torch.bfloat16) * 0.8)(B, Hkv, Sk, Dh)), 'wq': _w((lambda *s: torch.randn(*s, dtype=torch.bfloat16) * 0.8)(D, Hq * Dh) * D ** (-0.5)), 'wo': _w((lambda *s: torch.randn(*s, dtype=torch.bfloat16) * 0.8)(Hq * Dh, D) * (Hq * Dh) ** (-0.5))}
    _A_in = _A_setup()

    def _B_setup():
        B, S, D, F, C = (1, 2048, 576, 4608, 2)
        return {'x': _w((lambda *s: torch.randn(*s, dtype=torch.bfloat16) * 0.1)(B, S, D)), 'w_r': _w((lambda *s: torch.randn(*s, dtype=torch.bfloat16) * 3.2)(D)), 'w_gate': _w((lambda *s: torch.randn(*s, dtype=torch.bfloat16) * 0.2)(D, F)), 'w_up': _w((lambda *s: torch.randn(*s, dtype=torch.bfloat16) * 0.2)(D, F)), 'w_down': _w((lambda *s: torch.randn(*s, dtype=torch.bfloat16) * 0.2)(F, D))}
    _B_in = _B_setup()
    return {'A_x': _A_in['x'], 'A_k_cache': _A_in['k_cache'], 'A_v_cache': _A_in['v_cache'], 'A_wq': _A_in['wq'], 'A_wo': _A_in['wo'], 'B_x': _B_in['x'], 'B_w_r': _B_in['w_r'], 'B_w_gate': _B_in['w_gate'], 'B_w_up': _B_in['w_up'], 'B_w_down': _B_in['w_down'], 'c': _w((lambda *s: torch.randn(*s, dtype=torch.bfloat16) * 0.4)(1, 576) * 8.0), 'w_mod': _w((lambda *s: torch.randn(*s, dtype=torch.bfloat16) * 0.4)(576, 6 * 576) * 576 ** (-0.5) * 8.0)}

def reference(A_x, A_k_cache, A_v_cache, A_wq, A_wo, B_x, B_w_r, B_w_gate, B_w_up, B_w_down, c, w_mod):

    def _A_ref(x, k_cache, v_cache, wq, wo):
        B, Sq, D = x.shape
        Hq, Dh = (32, 128)
        Hkv = k_cache.shape[1]
        rep = Hq // Hkv
        q = (lambda x, *d: x.permute(*d))((x @ wq).reshape(B, Sq, Hq, Dh), 0, 2, 1, 3)
        k = (lambda x, n, axis: torch.repeat_interleave(x, n, dim=axis))(k_cache, rep, axis=1)
        v = (lambda x, n, axis: torch.repeat_interleave(x, n, dim=axis))(v_cache, rep, axis=1)
        scores = torch.einsum('bhqd,bhkd->bhqk', q, k) * Dh ** (-0.5)
        p = _softmax(scores, axis=-1)
        o = torch.einsum('bhqk,bhkd->bhqd', p, v)
        return (lambda x, *d: x.permute(*d))(o, 0, 2, 1, 3).reshape(B, Sq, Hq * Dh) @ wo

    def _B_ref(x, w_r, w_gate, w_up, w_down):
        B, S, D = x.shape
        C = 2
        r = x @ w_r
        idx = torch.argsort(-r, axis=-1)[:, :C]
        idx_e = (lambda x, n, axis: torch.repeat_interleave(x, n, dim=axis))(idx.reshape(B, C, 1), D, axis=2)
        x_sel = (lambda x, i, axis: torch.take_along_dim(x, i, dim=axis))(x, idx_e, axis=1)
        g = _silu(x_sel @ w_gate)
        u = x_sel @ w_up
        y = g * u @ w_down
        r_sel = _sigmoid((lambda x, i, axis: torch.take_along_dim(x, i, dim=axis))(r, idx, axis=1))
        y = y * r_sel.reshape(B, C, 1)
        b_off = (torch.arange(B) * S).reshape(B, 1)
        flat_idx = (idx + b_off).reshape(B * C)
        zero = (x * 0.0).reshape(B * S, D)
        upd = _scatter_add(zero, flat_idx, y.reshape(B * C, D), axis=0)
        return x + upd.reshape(B, S, D)
    x = A_x
    mod = (_silu(c) @ w_mod).reshape(c.shape[0], 6, 1, -1)
    sa, ca, ga, sb, cb, gb = (mod[:, 0].clone(), mod[:, 1].clone(), mod[:, 2].clone(), mod[:, 3].clone(), mod[:, 4].clone(), mod[:, 5].clone())
    h = _layernorm(x, axis=-1) * (1 + ca) + sa
    x = x + ga * _A_ref(h, A_k_cache, A_v_cache, A_wq, A_wo)
    h = _layernorm(x, axis=-1) * (1 + cb) + sb
    x = x + gb * _B_ref(h, B_w_r, B_w_gate, B_w_up, B_w_down)
    return x
```

```asm
; @launch kernel=front_kernel grid=(236,1,1) block=(384,1,1) lds=3072
; @launch kernel=attn_kernel grid=(256,1,1) block=(256,1,1) lds=143424
; @launch kernel=mid_kernel grid=(256,1,1) block=(576,1,1) lds=2048
; @launch kernel=ffn_kernel grid=(144,1,1) block=(256,1,1) lds=111104
; @launch kernel=fin_kernel grid=(36,1,1) block=(256,1,1) lds=1024
.amdgcn_target "amdgcn-amd-amdhsa--gfx950"
.text
.globl front_kernel
.p2align 8
.type front_kernel,@function
front_kernel:
    s_cmp_ge_u32 s2, 236
    s_cbranch_scc1 L1_end
    s_load_dwordx2 s[4:5], s[0:1], 0
    s_load_dwordx4 s[8:11], s[0:1], 80
    s_load_dwordx2 s[6:7], s[0:1], 112
    s_waitcnt lgkmcnt(0)
    s_mov_b32 s12, s4
    s_mov_b32 s13, s5
    s_mov_b32 s14, 2359296
    s_mov_b32 s15, 0x20000
    s_mov_b32 s16, s8
    s_mov_b32 s17, s9
    s_mov_b32 s18, 1152
    s_mov_b32 s19, 0x20000
    s_mov_b32 s20, s10
    s_mov_b32 s21, s11
    s_mov_b32 s22, 3981312
    s_mov_b32 s23, 0x20000
    s_mov_b32 s24, s6
    s_mov_b32 s25, s7
    s_mov_b32 s26, 3407872
    s_mov_b32 s27, 0x20000
    s_cmp_ge_u32 s2, 108
    s_cbranch_scc1 L1_ln
    v_and_b32 v1, 3, v0
    v_lshrrev_b32 v2, 2, v0
    v_mul_u32_u24 v3, 6912, v2
    v_lshl_add_u32 v3, v1, 4, v3
    v_lshlrev_b32 v4, 1, v2
    s_lshl_b32 s3, s2, 6
    buffer_load_ushort v8, v4, s[16:19], 0 offen offset:0
    buffer_load_ushort v9, v4, s[16:19], 0 offen offset:192
    buffer_load_ushort v10, v4, s[16:19], 0 offen offset:384
    buffer_load_ushort v11, v4, s[16:19], 0 offen offset:576
    buffer_load_ushort v12, v4, s[16:19], 0 offen offset:768
    buffer_load_ushort v13, v4, s[16:19], 0 offen offset:960
    buffer_load_dwordx4 v[16:19], v3, s[20:23], s3 offen
    s_add_u32 s3, s3, 663552
    buffer_load_dwordx4 v[20:23], v3, s[20:23], s3 offen
    s_add_u32 s3, s3, 663552
    buffer_load_dwordx4 v[24:27], v3, s[20:23], s3 offen
    s_add_u32 s3, s3, 663552
    buffer_load_dwordx4 v[28:31], v3, s[20:23], s3 offen
    s_add_u32 s3, s3, 663552
    buffer_load_dwordx4 v[32:35], v3, s[20:23], s3 offen
    s_add_u32 s3, s3, 663552
    buffer_load_dwordx4 v[36:39], v3, s[20:23], s3 offen
    s_mul_i32 s28, s2, 3641
    s_lshr_b32 s28, s28, 16
    s_mul_i32 s29, s28, 18
    s_sub_u32 s29, s2, s29
    s_mov_b32 s30, 1.0
    s_mov_b32 s31, 0
    s_cmp_lt_u32 s28, 2
    s_cselect_b32 s30, 0x3e0293ee, s30
    s_cmp_eq_u32 s28, 1
    s_cselect_b32 s31, 0x3e0293ee, s31
    s_cmp_eq_u32 s28, 4
    s_cselect_b32 s31, 1.0, s31
    s_waitcnt vmcnt(6)
    v_lshlrev_b32 v8, 16, v8
    v_lshlrev_b32 v9, 16, v9
    v_lshlrev_b32 v10, 16, v10
    v_lshlrev_b32 v11, 16, v11
    v_lshlrev_b32 v12, 16, v12
    v_lshlrev_b32 v13, 16, v13
    v_mul_f32 v40, 0xbfb8aa3b, v8
    v_mul_f32 v41, 0xbfb8aa3b, v9
    v_mul_f32 v42, 0xbfb8aa3b, v10
    v_mul_f32 v43, 0xbfb8aa3b, v11
    v_mul_f32 v44, 0xbfb8aa3b, v12
    v_mul_f32 v45, 0xbfb8aa3b, v13
    v_exp_f32 v40, v40
    v_exp_f32 v41, v41
    v_exp_f32 v42, v42
    v_exp_f32 v43, v43
    v_exp_f32 v44, v44
    v_exp_f32 v45, v45
    v_add_f32 v40, 1.0, v40
    v_add_f32 v41, 1.0, v41
    v_add_f32 v42, 1.0, v42
    v_add_f32 v43, 1.0, v43
    v_add_f32 v44, 1.0, v44
    v_add_f32 v45, 1.0, v45
    v_rcp_f32 v40, v40
    v_rcp_f32 v41, v41
    v_rcp_f32 v42, v42
    v_rcp_f32 v43, v43
    v_rcp_f32 v44, v44
    v_rcp_f32 v45, v45
    v_mul_f32 v8, v8, v40
    v_mul_f32 v9, v9, v41
    v_mul_f32 v10, v10, v42
    v_mul_f32 v11, v11, v43
    v_mul_f32 v12, v12, v44
    v_mul_f32 v13, v13, v45
    s_waitcnt vmcnt(5)
    v_lshlrev_b32 v40, 16, v16
    v_and_b32 v41, 0xffff0000, v16
    v_mul_f32 v48, v40, v8
    v_mul_f32 v49, v41, v8
    v_lshlrev_b32 v40, 16, v17
    v_and_b32 v41, 0xffff0000, v17
    v_mul_f32 v50, v40, v8
    v_mul_f32 v51, v41, v8
    v_lshlrev_b32 v40, 16, v18
    v_and_b32 v41, 0xffff0000, v18
    v_mul_f32 v52, v40, v8
    v_mul_f32 v53, v41, v8
    v_lshlrev_b32 v40, 16, v19
    v_and_b32 v41, 0xffff0000, v19
    v_mul_f32 v54, v40, v8
    v_mul_f32 v55, v41, v8
    s_waitcnt vmcnt(4)
    v_lshlrev_b32 v40, 16, v20
    v_and_b32 v41, 0xffff0000, v20
    v_fmac_f32 v48, v40, v9
    v_fmac_f32 v49, v41, v9
    v_lshlrev_b32 v40, 16, v21
    v_and_b32 v41, 0xffff0000, v21
    v_fmac_f32 v50, v40, v9
    v_fmac_f32 v51, v41, v9
    v_lshlrev_b32 v40, 16, v22
    v_and_b32 v41, 0xffff0000, v22
    v_fmac_f32 v52, v40, v9
    v_fmac_f32 v53, v41, v9
    v_lshlrev_b32 v40, 16, v23
    v_and_b32 v41, 0xffff0000, v23
    v_fmac_f32 v54, v40, v9
    v_fmac_f32 v55, v41, v9
    s_waitcnt vmcnt(3)
    v_lshlrev_b32 v40, 16, v24
    v_and_b32 v41, 0xffff0000, v24
    v_fmac_f32 v48, v40, v10
    v_fmac_f32 v49, v41, v10
    v_lshlrev_b32 v40, 16, v25
    v_and_b32 v41, 0xffff0000, v25
    v_fmac_f32 v50, v40, v10
    v_fmac_f32 v51, v41, v10
    v_lshlrev_b32 v40, 16, v26
    v_and_b32 v41, 0xffff0000, v26
    v_fmac_f32 v52, v40, v10
    v_fmac_f32 v53, v41, v10
    v_lshlrev_b32 v40, 16, v27
    v_and_b32 v41, 0xffff0000, v27
    v_fmac_f32 v54, v40, v10
    v_fmac_f32 v55, v41, v10
    s_waitcnt vmcnt(2)
    v_lshlrev_b32 v40, 16, v28
    v_and_b32 v41, 0xffff0000, v28
    v_fmac_f32 v48, v40, v11
    v_fmac_f32 v49, v41, v11
    v_lshlrev_b32 v40, 16, v29
    v_and_b32 v41, 0xffff0000, v29
    v_fmac_f32 v50, v40, v11
    v_fmac_f32 v51, v41, v11
    v_lshlrev_b32 v40, 16, v30
    v_and_b32 v41, 0xffff0000, v30
    v_fmac_f32 v52, v40, v11
    v_fmac_f32 v53, v41, v11
    v_lshlrev_b32 v40, 16, v31
    v_and_b32 v41, 0xffff0000, v31
    v_fmac_f32 v54, v40, v11
    v_fmac_f32 v55, v41, v11
    s_waitcnt vmcnt(1)
    v_lshlrev_b32 v40, 16, v32
    v_and_b32 v41, 0xffff0000, v32
    v_fmac_f32 v48, v40, v12
    v_fmac_f32 v49, v41, v12
    v_lshlrev_b32 v40, 16, v33
    v_and_b32 v41, 0xffff0000, v33
    v_fmac_f32 v50, v40, v12
    v_fmac_f32 v51, v41, v12
    v_lshlrev_b32 v40, 16, v34
    v_and_b32 v41, 0xffff0000, v34
    v_fmac_f32 v52, v40, v12
    v_fmac_f32 v53, v41, v12
    v_lshlrev_b32 v40, 16, v35
    v_and_b32 v41, 0xffff0000, v35
    v_fmac_f32 v54, v40, v12
    v_fmac_f32 v55, v41, v12
    s_waitcnt vmcnt(0)
    v_lshlrev_b32 v40, 16, v36
    v_and_b32 v41, 0xffff0000, v36
    v_fmac_f32 v48, v40, v13
    v_fmac_f32 v49, v41, v13
    v_lshlrev_b32 v40, 16, v37
    v_and_b32 v41, 0xffff0000, v37
    v_fmac_f32 v50, v40, v13
    v_fmac_f32 v51, v41, v13
    v_lshlrev_b32 v40, 16, v38
    v_and_b32 v41, 0xffff0000, v38
    v_fmac_f32 v52, v40, v13
    v_fmac_f32 v53, v41, v13
    v_lshlrev_b32 v40, 16, v39
    v_and_b32 v41, 0xffff0000, v39
    v_fmac_f32 v54, v40, v13
    v_fmac_f32 v55, v41, v13
    s_nop 1
    v_add_f32_dpp v48, v48, v48 row_ror:4 row_mask:0xf bank_mask:0xf
    v_add_f32_dpp v49, v49, v49 row_ror:4 row_mask:0xf bank_mask:0xf
    v_add_f32_dpp v50, v50, v50 row_ror:4 row_mask:0xf bank_mask:0xf
    v_add_f32_dpp v51, v51, v51 row_ror:4 row_mask:0xf bank_mask:0xf
    v_add_f32_dpp v52, v52, v52 row_ror:4 row_mask:0xf bank_mask:0xf
    v_add_f32_dpp v53, v53, v53 row_ror:4 row_mask:0xf bank_mask:0xf
    v_add_f32_dpp v54, v54, v54 row_ror:4 row_mask:0xf bank_mask:0xf
    v_add_f32_dpp v55, v55, v55 row_ror:4 row_mask:0xf bank_mask:0xf
    s_nop 1
    v_add_f32_dpp v48, v48, v48 row_ror:8 row_mask:0xf bank_mask:0xf
    v_add_f32_dpp v49, v49, v49 row_ror:8 row_mask:0xf bank_mask:0xf
    v_add_f32_dpp v50, v50, v50 row_ror:8 row_mask:0xf bank_mask:0xf
    v_add_f32_dpp v51, v51, v51 row_ror:8 row_mask:0xf bank_mask:0xf
    v_add_f32_dpp v52, v52, v52 row_ror:8 row_mask:0xf bank_mask:0xf
    v_add_f32_dpp v53, v53, v53 row_ror:8 row_mask:0xf bank_mask:0xf
    v_add_f32_dpp v54, v54, v54 row_ror:8 row_mask:0xf bank_mask:0xf
    v_add_f32_dpp v55, v55, v55 row_ror:8 row_mask:0xf bank_mask:0xf
    v_lshrrev_b32 v5, 4, v0
    v_lshlrev_b32 v5, 7, v5
    v_lshl_add_u32 v5, v1, 5, v5
    v_and_b32 v6, 15, v0
    v_cmp_gt_u32 vcc, 4, v6
    s_nop 0
    s_and_saveexec_b64 s[32:33], vcc
    ds_write_b128 v5, v[48:51]
    ds_write_b128 v5, v[52:55] offset:16
    s_mov_b64 exec, s[32:33]
    s_waitcnt lgkmcnt(0)
    s_barrier
    v_readfirstlane_b32 s34, v0
    s_nop 0
    s_cmp_ge_u32 s34, 64
    s_cbranch_scc1 L1_end
    v_and_b32 v6, 31, v0
    v_lshrrev_b32 v7, 5, v0
    v_mul_u32_u24 v7, 1536, v7
    v_lshl_add_u32 v7, v6, 2, v7
    ds_read_b32 v16, v7 offset:0
    ds_read_b32 v17, v7 offset:128
    ds_read_b32 v18, v7 offset:256
    ds_read_b32 v19, v7 offset:384
    ds_read_b32 v20, v7 offset:512
    ds_read_b32 v21, v7 offset:640
    ds_read_b32 v22, v7 offset:768
    ds_read_b32 v23, v7 offset:896
    ds_read_b32 v24, v7 offset:1024
    ds_read_b32 v25, v7 offset:1152
    ds_read_b32 v26, v7 offset:1280
    ds_read_b32 v27, v7 offset:1408
    s_lshl_b32 s29, s29, 5
    v_add_u32 v6, s29, v6
    v_lshrrev_b32 v8, 3, v6
    v_lshlrev_b32 v8, 6, v8
    v_and_b32 v9, 7, v6
    v_lshl_add_u32 v8, v9, 2, v8
    v_lshlrev_b32 v9, 2, v6
    s_mul_i32 s35, s28, 2304
    s_add_u32 s35, s35, 3584
    s_cmp_eq_u32 s28, 0
    s_cselect_b32 s35, 32, s35
    s_cmp_eq_u32 s28, 1
    s_cselect_b32 s35, 0, s35
    s_cmp_lt_u32 s28, 2
    s_cselect_b64 vcc, -1, 0
    v_cndmask_b32 v8, v9, v8, vcc
    s_waitcnt lgkmcnt(0)
    v_add_f32 v16, v16, v22
    v_add_f32 v17, v17, v23
    v_add_f32 v18, v18, v24
    v_add_f32 v19, v19, v25
    v_add_f32 v20, v20, v26
    v_add_f32 v21, v21, v27
    v_add_f32 v16, v16, v19
    v_add_f32 v17, v17, v20
    v_add_f32 v18, v18, v21
    v_add_f32 v16, v16, v17
    v_add_f32 v16, v16, v18
    v_mov_b32 v17, v16
    s_nop 1
    v_permlane32_swap_b32 v17, v16
    v_add_f32 v16, v16, v17
    v_mov_b32 v17, s31
    v_fma_f32 v16, v16, s30, v17
    s_mov_b64 exec, 0xffffffff
    buffer_store_dword v16, v8, s[24:27], s35 offen
    s_endpgm
L1_ln:
    s_sub_u32 s3, s2, 108
    v_lshrrev_b32 v1, 6, v0
    v_and_b32 v2, 15, v0
    v_bfe_u32 v3, v0, 4, 2
    v_mul_u32_u24 v4, 1152, v2
    v_lshl_add_u32 v4, v3, 4, v4
    v_mul_u32_u24 v5, 192, v1
    v_add_u32 v4, v4, v5
    s_mul_i32 s28, s3, 18432
    buffer_load_dwordx4 v[8:11], v4, s[12:15], s28 offen offset:0
    buffer_load_dwordx4 v[12:15], v4, s[12:15], s28 offen offset:64
    buffer_load_dwordx4 v[16:19], v4, s[12:15], s28 offen offset:128
    v_lshlrev_b32 v6, 5, v2
    v_lshl_add_u32 v7, v1, 2, v6
    v_and_b32 v5, 63, v0
    v_lshlrev_b32 v5, 4, v5
    v_mul_u32_u24 v1, 3072, v1
    v_add_u32 v5, v5, v1
    s_add_u32 s28, s28, 1048576
    s_waitcnt vmcnt(2)
    v_lshlrev_b32 v24, 16, v8
    v_and_b32 v25, 0xffff0000, v8
    v_lshlrev_b32 v26, 16, v9
    v_and_b32 v27, 0xffff0000, v9
    v_lshlrev_b32 v28, 16, v10
    v_and_b32 v29, 0xffff0000, v10
    v_lshlrev_b32 v30, 16, v11
    v_and_b32 v31, 0xffff0000, v11
    s_waitcnt vmcnt(1)
    v_lshlrev_b32 v32, 16, v12
    v_and_b32 v33, 0xffff0000, v12
    v_lshlrev_b32 v34, 16, v13
    v_and_b32 v35, 0xffff0000, v13
    v_lshlrev_b32 v36, 16, v14
    v_and_b32 v37, 0xffff0000, v14
    v_lshlrev_b32 v38, 16, v15
    v_and_b32 v39, 0xffff0000, v15
    s_waitcnt vmcnt(0)
    v_lshlrev_b32 v40, 16, v16
    v_and_b32 v41, 0xffff0000, v16
    v_lshlrev_b32 v42, 16, v17
    v_and_b32 v43, 0xffff0000, v17
    v_lshlrev_b32 v44, 16, v18
    v_and_b32 v45, 0xffff0000, v18
    v_lshlrev_b32 v46, 16, v19
    v_and_b32 v47, 0xffff0000, v19
    v_add_f32 v20, v24, v25
    v_add_f32 v22, v26, v27
    v_add_f32 v20, v20, v28
    v_add_f32 v22, v22, v29
    v_add_f32 v20, v20, v30
    v_add_f32 v22, v22, v31
    v_add_f32 v20, v20, v32
    v_add_f32 v22, v22, v33
    v_add_f32 v20, v20, v34
    v_add_f32 v22, v22, v35
    v_add_f32 v20, v20, v36
    v_add_f32 v22, v22, v37
    v_add_f32 v20, v20, v38
    v_add_f32 v22, v22, v39
    v_add_f32 v20, v20, v40
    v_add_f32 v22, v22, v41
    v_add_f32 v20, v20, v42
    v_add_f32 v22, v22, v43
    v_add_f32 v20, v20, v44
    v_add_f32 v22, v22, v45
    v_add_f32 v20, v20, v46
    v_add_f32 v22, v22, v47
    v_add_f32 v20, v20, v22
    v_mov_b32 v21, v20
    s_nop 1
    v_permlane16_swap_b32 v21, v20
    v_add_f32 v20, v20, v21
    v_mov_b32 v21, v20
    s_nop 1
    v_permlane32_swap_b32 v21, v20
    v_add_f32 v20, v20, v21
    ds_write_b32 v7, v20 offset:0
    s_waitcnt lgkmcnt(0)
    s_barrier
    ds_read_b128 v[8:11], v6 offset:0
    ds_read_b64 v[12:13], v6 offset:16
    s_waitcnt lgkmcnt(0)
    v_add_f32 v8, v8, v9
    v_add_f32 v10, v10, v11
    v_add_f32 v12, v12, v13
    v_add_f32 v8, v8, v10
    v_add_f32 v20, v8, v12
    v_mul_f32 v20, 0x3ae38e39, v20
    v_sub_f32 v24, v24, v20
    v_sub_f32 v25, v25, v20
    v_sub_f32 v26, v26, v20
    v_sub_f32 v27, v27, v20
    v_sub_f32 v28, v28, v20
    v_sub_f32 v29, v29, v20
    v_sub_f32 v30, v30, v20
    v_sub_f32 v31, v31, v20
    v_sub_f32 v32, v32, v20
    v_sub_f32 v33, v33, v20
    v_sub_f32 v34, v34, v20
    v_sub_f32 v35, v35, v20
    v_sub_f32 v36, v36, v20
    v_sub_f32 v37, v37, v20
    v_sub_f32 v38, v38, v20
    v_sub_f32 v39, v39, v20
    v_sub_f32 v40, v40, v20
    v_sub_f32 v41, v41, v20
    v_sub_f32 v42, v42, v20
    v_sub_f32 v43, v43, v20
    v_sub_f32 v44, v44, v20
    v_sub_f32 v45, v45, v20
    v_sub_f32 v46, v46, v20
    v_sub_f32 v47, v47, v20
    v_mul_f32 v20, v24, v24
    v_mul_f32 v22, v25, v25
    v_fmac_f32 v20, v26, v26
    v_fmac_f32 v22, v27, v27
    v_fmac_f32 v20, v28, v28
    v_fmac_f32 v22, v29, v29
    v_fmac_f32 v20, v30, v30
    v_fmac_f32 v22, v31, v31
    v_fmac_f32 v20, v32, v32
    v_fmac_f32 v22, v33, v33
    v_fmac_f32 v20, v34, v34
    v_fmac_f32 v22, v35, v35
    v_fmac_f32 v20, v36, v36
    v_fmac_f32 v22, v37, v37
    v_fmac_f32 v20, v38, v38
    v_fmac_f32 v22, v39, v39
    v_fmac_f32 v20, v40, v40
    v_fmac_f32 v22, v41, v41
    v_fmac_f32 v20, v42, v42
    v_fmac_f32 v22, v43, v43
    v_fmac_f32 v20, v44, v44
    v_fmac_f32 v22, v45, v45
    v_fmac_f32 v20, v46, v46
    v_fmac_f32 v22, v47, v47
    v_add_f32 v20, v20, v22
    v_mov_b32 v21, v20
    s_nop 1
    v_permlane16_swap_b32 v21, v20
    v_add_f32 v20, v20, v21
    v_mov_b32 v21, v20
    s_nop 1
    v_permlane32_swap_b32 v21, v20
    v_add_f32 v20, v20, v21
    ds_write_b32 v7, v20 offset:512
    s_waitcnt lgkmcnt(0)
    s_barrier
    ds_read_b128 v[8:11], v6 offset:512
    ds_read_b64 v[12:13], v6 offset:528
    s_waitcnt lgkmcnt(0)
    v_add_f32 v8, v8, v9
    v_add_f32 v10, v10, v11
    v_add_f32 v12, v12, v13
    v_add_f32 v8, v8, v10
    v_add_f32 v20, v8, v12
    v_mov_b32 v21, 0x3727c5ac
    v_fmac_f32 v21, 0x3ae38e39, v20
    v_rsq_f32 v21, v21
    s_nop 0
    v_mul_f32 v24, v24, v21
    v_mul_f32 v25, v25, v21
    v_mul_f32 v26, v26, v21
    v_mul_f32 v27, v27, v21
    v_mul_f32 v28, v28, v21
    v_mul_f32 v29, v29, v21
    v_mul_f32 v30, v30, v21
    v_mul_f32 v31, v31, v21
    v_mul_f32 v32, v32, v21
    v_mul_f32 v33, v33, v21
    v_mul_f32 v34, v34, v21
    v_mul_f32 v35, v35, v21
    v_mul_f32 v36, v36, v21
    v_mul_f32 v37, v37, v21
    v_mul_f32 v38, v38, v21
    v_mul_f32 v39, v39, v21
    v_mul_f32 v40, v40, v21
    v_mul_f32 v41, v41, v21
    v_mul_f32 v42, v42, v21
    v_mul_f32 v43, v43, v21
    v_mul_f32 v44, v44, v21
    v_mul_f32 v45, v45, v21
    v_mul_f32 v46, v46, v21
    v_mul_f32 v47, v47, v21
    v_cvt_pk_f16_f32 v8, v24, v25
    v_cvt_pk_f16_f32 v9, v26, v27
    v_cvt_pk_f16_f32 v10, v28, v29
    v_cvt_pk_f16_f32 v11, v30, v31
    buffer_store_dwordx4 v[8:11], v5, s[24:27], s28 offen offset:0
    v_cvt_pk_f16_f32 v12, v32, v33
    v_cvt_pk_f16_f32 v13, v34, v35
    v_cvt_pk_f16_f32 v14, v36, v37
    v_cvt_pk_f16_f32 v15, v38, v39
    buffer_store_dwordx4 v[12:15], v5, s[24:27], s28 offen offset:1024
    v_cvt_pk_f16_f32 v16, v40, v41
    v_cvt_pk_f16_f32 v17, v42, v43
    v_cvt_pk_f16_f32 v18, v44, v45
    v_cvt_pk_f16_f32 v19, v46, v47
    buffer_store_dwordx4 v[16:19], v5, s[24:27], s28 offen offset:2048
L1_end:
    s_endpgm

.globl attn_kernel
.p2align 8
.type attn_kernel,@function
attn_kernel:
    s_cmp_ge_u32 s2, 256
    s_cbranch_scc1 L2_end
    s_load_dwordx8 s[4:11], s[0:1], 8
    s_load_dwordx2 s[12:13], s[0:1], 112
    v_lshrrev_b32 v12, 6, v0
    v_and_b32 v0, 63, v0
    v_readfirstlane_b32 s51, v12
    s_and_b32 s3, s2, 7
    s_lshr_b32 s14, s2, 3
    s_and_b32 s52, s3, 3
    s_lshl_b32 s52, s52, 2
    s_and_b32 s15, s14, 3
    s_add_u32 s52, s52, s15
    s_lshr_b32 s53, s3, 2
    s_mul_i32 s53, s53, 8
    s_lshr_b32 s15, s14, 2
    s_add_u32 s53, s53, s15
    s_mul_i32 s44, s51, 4224
    s_add_u32 s44, s44, 8192
    v_lshlrev_b32 v8, 4, v0
    v_lshl_add_u32 v5, v12, 12, v8
    v_lshrrev_b32 v13, 5, v0
    v_lshl_add_u32 v13, v12, 1, v13
    v_lshlrev_b32 v13, 15, v13
    v_and_b32 v14, 31, v0
    v_lshl_add_u32 v6, v14, 4, v13
    s_waitcnt lgkmcnt(0)
    s_lshl_b32 s3, s52, 9
    s_add_u32 s24, s8, s3
    s_addc_u32 s25, s9, 0
    s_mov_b32 s26, 0
    s_mov_b32 s27, 0x20000
    s_sub_u32 s26, 4718592, s3
    s_mov_b32 s36, s12
    s_mov_b32 s37, s13
    s_mov_b32 s38, 8192
    s_mov_b32 s39, 0x20000
    s_lshl_b32 s3, s53, 2
    s_add_u32 s3, s3, s51
    s_mul_i32 s14, s3, 36864
    s_add_u32 s14, s14, 1048576
    s_add_u32 s32, s12, s14
    s_addc_u32 s33, s13, 0
    s_mov_b32 s34, 36864
    s_mov_b32 s35, 0x20000
    s_lshl_b32 m0, s51, 10
    s_lshl_b32 s45, s51, 10
    buffer_load_dwordx4 v8, s[36:39], s45 offen lds
    s_add_u32 m0, m0, 4096
    s_add_u32 s45, s45, 4096
    buffer_load_dwordx4 v8, s[36:39], s45 offen lds
    s_mov_b32 s54, 0
    buffer_load_dwordx4 v[80:83], v8, s[32:35], s54 offen
    s_mov_b32 s54, 1024
    buffer_load_dwordx4 v[84:87], v8, s[32:35], s54 offen
    s_mov_b32 s54, 18432
    buffer_load_dwordx4 v[88:91], v8, s[32:35], s54 offen
    s_mov_b32 s54, 19456
    buffer_load_dwordx4 v[92:95], v8, s[32:35], s54 offen
    s_add_u32 m0, s44, 33792
    s_mov_b32 s45, 0
    buffer_load_dwordx4 v6, s[24:27], s45 offen lds
    s_add_u32 m0, s44, 34848
    s_mov_b32 s45, 8192
    buffer_load_dwordx4 v6, s[24:27], s45 offen lds
    s_add_u32 m0, s44, 35904
    s_mov_b32 s45, 16384
    buffer_load_dwordx4 v6, s[24:27], s45 offen lds
    s_add_u32 m0, s44, 36960
    s_mov_b32 s45, 24576
    buffer_load_dwordx4 v6, s[24:27], s45 offen lds
    s_add_u32 m0, s44, 50688
    s_mov_b32 s45, 262144
    buffer_load_dwordx4 v6, s[24:27], s45 offen lds
    s_add_u32 m0, s44, 51744
    s_mov_b32 s45, 270336
    buffer_load_dwordx4 v6, s[24:27], s45 offen lds
    s_add_u32 m0, s44, 52800
    s_mov_b32 s45, 278528
    buffer_load_dwordx4 v6, s[24:27], s45 offen lds
    s_add_u32 m0, s44, 53856
    s_mov_b32 s45, 286720
    buffer_load_dwordx4 v6, s[24:27], s45 offen lds
    s_mov_b32 s54, 2048
    buffer_load_dwordx4 v[96:99], v8, s[32:35], s54 offen
    s_mov_b32 s54, 3072
    buffer_load_dwordx4 v[100:103], v8, s[32:35], s54 offen
    s_mov_b32 s54, 20480
    buffer_load_dwordx4 v[104:107], v8, s[32:35], s54 offen
    s_mov_b32 s54, 21504
    buffer_load_dwordx4 v[108:111], v8, s[32:35], s54 offen
    s_add_u32 m0, s44, 67584
    s_mov_b32 s45, 524288
    buffer_load_dwordx4 v6, s[24:27], s45 offen lds
    s_add_u32 m0, s44, 68640
    s_mov_b32 s45, 532480
    buffer_load_dwordx4 v6, s[24:27], s45 offen lds
    s_add_u32 m0, s44, 69696
    s_mov_b32 s45, 540672
    buffer_load_dwordx4 v6, s[24:27], s45 offen lds
    s_add_u32 m0, s44, 70752
    s_mov_b32 s45, 548864
    buffer_load_dwordx4 v6, s[24:27], s45 offen lds
    s_add_u32 m0, s44, 84480
    s_mov_b32 s45, 786432
    buffer_load_dwordx4 v6, s[24:27], s45 offen lds
    s_add_u32 m0, s44, 85536
    s_mov_b32 s45, 794624
    buffer_load_dwordx4 v6, s[24:27], s45 offen lds
    s_add_u32 m0, s44, 86592
    s_mov_b32 s45, 802816
    buffer_load_dwordx4 v6, s[24:27], s45 offen lds
    s_add_u32 m0, s44, 87648
    s_mov_b32 s45, 811008
    buffer_load_dwordx4 v6, s[24:27], s45 offen lds
    s_mov_b32 s54, 4096
    buffer_load_dwordx4 v[112:115], v8, s[32:35], s54 offen
    s_mov_b32 s54, 5120
    buffer_load_dwordx4 v[116:119], v8, s[32:35], s54 offen
    s_mov_b32 s54, 22528
    buffer_load_dwordx4 v[120:123], v8, s[32:35], s54 offen
    s_mov_b32 s54, 23552
    buffer_load_dwordx4 v[124:127], v8, s[32:35], s54 offen
    s_add_u32 m0, s44, 101376
    s_mov_b32 s45, 1048576
    buffer_load_dwordx4 v6, s[24:27], s45 offen lds
    s_add_u32 m0, s44, 102432
    s_mov_b32 s45, 1056768
    buffer_load_dwordx4 v6, s[24:27], s45 offen lds
    s_add_u32 m0, s44, 103488
    s_mov_b32 s45, 1064960
    buffer_load_dwordx4 v6, s[24:27], s45 offen lds
    s_add_u32 m0, s44, 104544
    s_mov_b32 s45, 1073152
    buffer_load_dwordx4 v6, s[24:27], s45 offen lds
    s_add_u32 m0, s44, 118272
    s_mov_b32 s45, 1310720
    buffer_load_dwordx4 v6, s[24:27], s45 offen lds
    s_add_u32 m0, s44, 119328
    s_mov_b32 s45, 1318912
    buffer_load_dwordx4 v6, s[24:27], s45 offen lds
    s_add_u32 m0, s44, 120384
    s_mov_b32 s45, 1327104
    buffer_load_dwordx4 v6, s[24:27], s45 offen lds
    s_add_u32 m0, s44, 121440
    s_mov_b32 s45, 1335296
    buffer_load_dwordx4 v6, s[24:27], s45 offen lds
    s_mov_b32 s54, 6144
    buffer_load_dwordx4 v[48:51], v8, s[32:35], s54 offen
    s_mov_b32 s54, 7168
    buffer_load_dwordx4 v[52:55], v8, s[32:35], s54 offen
    s_mov_b32 s54, 24576
    buffer_load_dwordx4 v[56:59], v8, s[32:35], s54 offen
    s_mov_b32 s54, 25600
    buffer_load_dwordx4 v[60:63], v8, s[32:35], s54 offen
    s_add_u32 m0, s44, 0
    s_mov_b32 s45, 1572864
    buffer_load_dwordx4 v6, s[24:27], s45 offen lds
    s_add_u32 m0, s44, 1056
    s_mov_b32 s45, 1581056
    buffer_load_dwordx4 v6, s[24:27], s45 offen lds
    s_add_u32 m0, s44, 2112
    s_mov_b32 s45, 1589248
    buffer_load_dwordx4 v6, s[24:27], s45 offen lds
    s_add_u32 m0, s44, 3168
    s_mov_b32 s45, 1597440
    buffer_load_dwordx4 v6, s[24:27], s45 offen lds
    s_add_u32 m0, s44, 16896
    s_mov_b32 s45, 1835008
    buffer_load_dwordx4 v6, s[24:27], s45 offen lds
    s_add_u32 m0, s44, 17952
    s_mov_b32 s45, 1843200
    buffer_load_dwordx4 v6, s[24:27], s45 offen lds
    s_add_u32 m0, s44, 19008
    s_mov_b32 s45, 1851392
    buffer_load_dwordx4 v6, s[24:27], s45 offen lds
    s_add_u32 m0, s44, 20064
    s_mov_b32 s45, 1859584
    buffer_load_dwordx4 v6, s[24:27], s45 offen lds
    s_mov_b32 s54, 8192
    buffer_load_dwordx4 v[64:67], v8, s[32:35], s54 offen
    s_mov_b32 s54, 9216
    buffer_load_dwordx4 v[68:71], v8, s[32:35], s54 offen
    s_mov_b32 s54, 26624
    buffer_load_dwordx4 v[72:75], v8, s[32:35], s54 offen
    s_mov_b32 s54, 27648
    buffer_load_dwordx4 v[76:79], v8, s[32:35], s54 offen
    s_mul_i32 s14, s3, 589824
    s_mul_i32 s15, s52, 9216
    s_add_u32 s14, s14, s15
    s_add_u32 s14, s14, 8388608
    s_add_u32 s40, s12, s14
    s_addc_u32 s41, s13, 0
    s_mov_b32 s42, 0
    s_mov_b32 s43, 0x20000
    s_sub_u32 s42, 589824, s15
    s_lshl_b32 s3, s52, 19
    s_add_u32 s16, s4, s3
    s_addc_u32 s17, s5, 0
    s_mov_b32 s18, 524288
    s_mov_b32 s19, 0x20000
    s_add_u32 s20, s6, s3
    s_addc_u32 s21, s7, 0
    s_mov_b32 s22, 524288
    s_mov_b32 s23, 0x20000
    s_mul_i32 s3, s52, 294912
    s_add_u32 s28, s10, s3
    s_addc_u32 s29, s11, 0
    s_mov_b32 s30, 294912
    s_mov_b32 s31, 0x20000
    s_mov_b32 s50, 0
    v_lshrrev_b32 v13, 4, v0
    v_lshlrev_b32 v9, 6, v13
    v_lshrrev_b32 v14, 2, v0
    v_mul_u32_u24 v14, 1056, v14
    v_add_u32 v14, 8192, v14
    v_and_b32 v15, 1, v0
    v_lshlrev_b32 v15, 4, v15
    v_add_u32 v3, v14, v15
    v_and_b32 v15, 2, v0
    v_lshl_add_u32 v3, v15, 2, v3
    v_add_u32 v4, 67584, v3
    v_lshrrev_b32 v14, 3, v0
    v_lshlrev_b32 v14, 2, v14
    v_add_u32 v14, v14, v12
    v_mul_u32_u24 v14, 4608, v14
    v_and_b32 v15, 7, v0
    v_lshl_add_u32 v7, v15, 4, v14
    v_lshlrev_b32 v10, 4, v15
    v_lshl_add_u32 v10, v13, 7, v10
    v_bfe_u32 v14, v0, 3, 1
    v_mul_u32_u24 v14, 147456, v14
    v_add_u32 v10, v10, v14
    v_lshrrev_b32 v14, 2, v0
    v_mul_u32_u24 v14, 1056, v14
    v_and_b32 v15, 3, v0
    v_lshl_add_u32 v14, v15, 3, v14
    v_add_u32 v2, 92672, v14
    v_and_b32 v14, 15, v0
    v_mul_u32_u24 v14, 1056, v14
    v_lshrrev_b32 v15, 4, v0
    v_lshl_add_u32 v14, v15, 4, v14
    v_add_u32 v1, 75776, v14
    v_and_b32 v14, 1, v0
    v_cmp_eq_u32 vcc, 0, v14
    v_mov_b32 v11, 0xeeeeeeee
    v_mov_b32 v15, 0x44444444
    v_cndmask_b32 v11, v11, v15, vcc
    v_and_b32 v14, 2, v0
    v_cmp_eq_u32 vcc, 0, v14
    v_mov_b32 v15, 0x3f803f80
    s_nop 0
    v_cndmask_b32 v15, 0, v15, vcc
    v_accvgpr_write_b32 a16, v15
    v_accvgpr_write_b32 a17, v15
    v_accvgpr_write_b32 a18, v15
    v_accvgpr_write_b32 a19, v15
    s_waitcnt vmcnt(48)
    s_barrier
    ds_read_b128 v[16:19], v9 offset:0
    ds_read_b128 v[20:23], v9 offset:32
    ds_read_b128 v[24:27], v9 offset:16
    ds_read_b128 v[28:31], v9 offset:48
    s_waitcnt lgkmcnt(2)
    v_fma_mix_f32 v32, v80, v16, v20 op_sel:[0,0,0] op_sel_hi:[1,0,0]
    v_fma_mix_f32 v33, v80, v17, v21 op_sel:[1,0,0] op_sel_hi:[1,0,0]
    v_fma_mix_f32 v34, v81, v18, v22 op_sel:[0,0,0] op_sel_hi:[1,0,0]
    v_fma_mix_f32 v35, v81, v19, v23 op_sel:[1,0,0] op_sel_hi:[1,0,0]
    v_cvt_pk_bf16_f32 v80, v32, v33
    v_cvt_pk_bf16_f32 v81, v34, v35
    v_fma_mix_f32 v36, v88, v16, v20 op_sel:[0,0,0] op_sel_hi:[1,0,0]
    v_fma_mix_f32 v37, v88, v17, v21 op_sel:[1,0,0] op_sel_hi:[1,0,0]
    v_fma_mix_f32 v38, v89, v18, v22 op_sel:[0,0,0] op_sel_hi:[1,0,0]
    v_fma_mix_f32 v39, v89, v19, v23 op_sel:[1,0,0] op_sel_hi:[1,0,0]
    v_cvt_pk_bf16_f32 v88, v36, v37
    v_cvt_pk_bf16_f32 v89, v38, v39
    ds_read_b128 v[16:19], v9 offset:256
    ds_read_b128 v[20:23], v9 offset:288
    s_waitcnt lgkmcnt(2)
    v_fma_mix_f32 v32, v82, v24, v28 op_sel:[0,0,0] op_sel_hi:[1,0,0]
    v_fma_mix_f32 v33, v82, v25, v29 op_sel:[1,0,0] op_sel_hi:[1,0,0]
    v_fma_mix_f32 v34, v83, v26, v30 op_sel:[0,0,0] op_sel_hi:[1,0,0]
    v_fma_mix_f32 v35, v83, v27, v31 op_sel:[1,0,0] op_sel_hi:[1,0,0]
    v_cvt_pk_bf16_f32 v82, v32, v33
    v_cvt_pk_bf16_f32 v83, v34, v35
    v_fma_mix_f32 v36, v90, v24, v28 op_sel:[0,0,0] op_sel_hi:[1,0,0]
    v_fma_mix_f32 v37, v90, v25, v29 op_sel:[1,0,0] op_sel_hi:[1,0,0]
    v_fma_mix_f32 v38, v91, v26, v30 op_sel:[0,0,0] op_sel_hi:[1,0,0]
    v_fma_mix_f32 v39, v91, v27, v31 op_sel:[1,0,0] op_sel_hi:[1,0,0]
    v_cvt_pk_bf16_f32 v90, v36, v37
    v_cvt_pk_bf16_f32 v91, v38, v39
    ds_read_b128 v[24:27], v9 offset:272
    ds_read_b128 v[28:31], v9 offset:304
    s_waitcnt lgkmcnt(2)
    v_fma_mix_f32 v32, v84, v16, v20 op_sel:[0,0,0] op_sel_hi:[1,0,0]
    v_fma_mix_f32 v33, v84, v17, v21 op_sel:[1,0,0] op_sel_hi:[1,0,0]
    v_fma_mix_f32 v34, v85, v18, v22 op_sel:[0,0,0] op_sel_hi:[1,0,0]
    v_fma_mix_f32 v35, v85, v19, v23 op_sel:[1,0,0] op_sel_hi:[1,0,0]
    v_cvt_pk_bf16_f32 v84, v32, v33
    v_cvt_pk_bf16_f32 v85, v34, v35
    v_fma_mix_f32 v36, v92, v16, v20 op_sel:[0,0,0] op_sel_hi:[1,0,0]
    v_fma_mix_f32 v37, v92, v17, v21 op_sel:[1,0,0] op_sel_hi:[1,0,0]
    v_fma_mix_f32 v38, v93, v18, v22 op_sel:[0,0,0] op_sel_hi:[1,0,0]
    v_fma_mix_f32 v39, v93, v19, v23 op_sel:[1,0,0] op_sel_hi:[1,0,0]
    v_cvt_pk_bf16_f32 v92, v36, v37
    v_cvt_pk_bf16_f32 v93, v38, v39
    ds_read_b128 v[16:19], v9 offset:512
    ds_read_b128 v[20:23], v9 offset:544
    s_waitcnt lgkmcnt(2)
    v_fma_mix_f32 v32, v86, v24, v28 op_sel:[0,0,0] op_sel_hi:[1,0,0]
    v_fma_mix_f32 v33, v86, v25, v29 op_sel:[1,0,0] op_sel_hi:[1,0,0]
    v_fma_mix_f32 v34, v87, v26, v30 op_sel:[0,0,0] op_sel_hi:[1,0,0]
    v_fma_mix_f32 v35, v87, v27, v31 op_sel:[1,0,0] op_sel_hi:[1,0,0]
    v_cvt_pk_bf16_f32 v86, v32, v33
    v_cvt_pk_bf16_f32 v87, v34, v35
    v_fma_mix_f32 v36, v94, v24, v28 op_sel:[0,0,0] op_sel_hi:[1,0,0]
    v_fma_mix_f32 v37, v94, v25, v29 op_sel:[1,0,0] op_sel_hi:[1,0,0]
    v_fma_mix_f32 v38, v95, v26, v30 op_sel:[0,0,0] op_sel_hi:[1,0,0]
    v_fma_mix_f32 v39, v95, v27, v31 op_sel:[1,0,0] op_sel_hi:[1,0,0]
    v_cvt_pk_bf16_f32 v94, v36, v37
    v_cvt_pk_bf16_f32 v95, v38, v39
    s_waitcnt vmcnt(40)
    s_barrier
    ds_read_b64_tr_b16 a[192:193], v3 offset:33792
    ds_read_b64_tr_b16 a[194:195], v3 offset:34304
    ds_read_b64_tr_b16 a[196:197], v3 offset:50688
    ds_read_b64_tr_b16 a[198:199], v3 offset:51200
    ds_read_b64_tr_b16 a[200:201], v3 offset:33824
    ds_read_b64_tr_b16 a[202:203], v3 offset:34336
    ds_read_b64_tr_b16 a[204:205], v3 offset:50720
    ds_read_b64_tr_b16 a[206:207], v3 offset:51232
    ds_read_b64_tr_b16 a[208:209], v3 offset:33856
    ds_read_b64_tr_b16 a[210:211], v3 offset:34368
    ds_read_b64_tr_b16 a[212:213], v3 offset:50752
    ds_read_b64_tr_b16 a[214:215], v3 offset:51264
    s_waitcnt lgkmcnt(8)
    v_mfma_f32_16x16x32_bf16 v[128:131], a[192:195], v[80:83], 0
    s_waitcnt vmcnt(36)
    ds_read_b64_tr_b16 a[216:217], v3 offset:33888
    ds_read_b128 v[24:27], v9 offset:528
    v_mfma_f32_16x16x32_bf16 v[128:131], a[196:199], v[84:87], v[128:131]
    ds_read_b64_tr_b16 a[218:219], v3 offset:34400
    ds_read_b128 v[28:31], v9 offset:560
    v_mfma_f32_16x16x32_bf16 v[160:163], a[192:195], v[88:91], 0
    ds_read_b64_tr_b16 a[220:221], v3 offset:50784
    v_fma_mix_f32 v32, v96, v16, v20 op_sel:[0,0,0] op_sel_hi:[1,0,0]
    v_mfma_f32_16x16x32_bf16 v[160:163], a[196:199], v[92:95], v[160:163]
    s_waitcnt lgkmcnt(9)
    ds_read_b64_tr_b16 a[222:223], v3 offset:51296
    v_fma_mix_f32 v33, v96, v17, v21 op_sel:[1,0,0] op_sel_hi:[1,0,0]
    v_mfma_f32_16x16x32_bf16 v[132:135], a[200:203], v[80:83], 0
    ds_read_b64_tr_b16 a[224:225], v3 offset:33920
    v_fma_mix_f32 v34, v97, v18, v22 op_sel:[0,0,0] op_sel_hi:[1,0,0]
    v_mfma_f32_16x16x32_bf16 v[132:135], a[204:207], v[84:87], v[132:135]
    ds_read_b64_tr_b16 a[226:227], v3 offset:34432
    v_fma_mix_f32 v35, v97, v19, v23 op_sel:[1,0,0] op_sel_hi:[1,0,0]
    v_mfma_f32_16x16x32_bf16 v[164:167], a[200:203], v[88:91], 0
    ds_read_b64_tr_b16 a[228:229], v3 offset:50816
    v_cvt_pk_bf16_f32 v96, v32, v33
    v_mfma_f32_16x16x32_bf16 v[164:167], a[204:207], v[92:95], v[164:167]
    s_waitcnt lgkmcnt(9)
    ds_read_b64_tr_b16 a[230:231], v3 offset:51328
    v_cvt_pk_bf16_f32 v97, v34, v35
    v_mfma_f32_16x16x32_bf16 v[136:139], a[208:211], v[80:83], 0
    ds_read_b64_tr_b16 a[232:233], v3 offset:33952
    v_fma_mix_f32 v36, v104, v16, v20 op_sel:[0,0,0] op_sel_hi:[1,0,0]
    v_mfma_f32_16x16x32_bf16 v[136:139], a[212:215], v[84:87], v[136:139]
    ds_read_b64_tr_b16 a[234:235], v3 offset:34464
    v_fma_mix_f32 v37, v104, v17, v21 op_sel:[1,0,0] op_sel_hi:[1,0,0]
    v_mfma_f32_16x16x32_bf16 v[168:171], a[208:211], v[88:91], 0
    ds_read_b64_tr_b16 a[236:237], v3 offset:50848
    v_fma_mix_f32 v38, v105, v18, v22 op_sel:[0,0,0] op_sel_hi:[1,0,0]
    v_mfma_f32_16x16x32_bf16 v[168:171], a[212:215], v[92:95], v[168:171]
    s_waitcnt lgkmcnt(7)
    ds_read_b64_tr_b16 a[238:239], v3 offset:51360
    v_fma_mix_f32 v39, v105, v19, v23 op_sel:[1,0,0] op_sel_hi:[1,0,0]
    v_mfma_f32_16x16x32_bf16 v[140:143], a[216:219], v[80:83], 0
    ds_read_b64_tr_b16 a[240:241], v3 offset:33984
    v_cvt_pk_bf16_f32 v104, v36, v37
    v_mfma_f32_16x16x32_bf16 v[140:143], a[220:223], v[84:87], v[140:143]
    ds_read_b64_tr_b16 a[242:243], v3 offset:34496
    v_cvt_pk_bf16_f32 v105, v38, v39
    v_mfma_f32_16x16x32_bf16 v[172:175], a[216:219], v[88:91], 0
    ds_read_b64_tr_b16 a[244:245], v3 offset:50880
    v_mfma_f32_16x16x32_bf16 v[172:175], a[220:223], v[92:95], v[172:175]
    s_waitcnt lgkmcnt(7)
    ds_read_b64_tr_b16 a[246:247], v3 offset:51392
    v_mfma_f32_16x16x32_bf16 v[144:147], a[224:227], v[80:83], 0
    ds_read_b64_tr_b16 a[248:249], v3 offset:34016
    ds_read_b128 v[16:19], v9 offset:768
    v_mfma_f32_16x16x32_bf16 v[144:147], a[228:231], v[84:87], v[144:147]
    ds_read_b64_tr_b16 a[250:251], v3 offset:34528
    ds_read_b128 v[20:23], v9 offset:800
    v_mfma_f32_16x16x32_bf16 v[176:179], a[224:227], v[88:91], 0
    ds_read_b64_tr_b16 a[252:253], v3 offset:50912
    v_fma_mix_f32 v32, v98, v24, v28 op_sel:[0,0,0] op_sel_hi:[1,0,0]
    v_mfma_f32_16x16x32_bf16 v[176:179], a[228:231], v[92:95], v[176:179]
    s_waitcnt lgkmcnt(9)
    ds_read_b64_tr_b16 a[254:255], v3 offset:51424
    v_fma_mix_f32 v33, v98, v25, v29 op_sel:[1,0,0] op_sel_hi:[1,0,0]
    v_mfma_f32_16x16x32_bf16 v[148:151], a[232:235], v[80:83], 0
    ds_read_b64_tr_b16 a[192:193], v3 offset:34048
    v_fma_mix_f32 v34, v99, v26, v30 op_sel:[0,0,0] op_sel_hi:[1,0,0]
    v_mfma_f32_16x16x32_bf16 v[148:151], a[236:239], v[84:87], v[148:151]
    ds_read_b64_tr_b16 a[194:195], v3 offset:34560
    v_fma_mix_f32 v35, v99, v27, v31 op_sel:[1,0,0] op_sel_hi:[1,0,0]
    v_mfma_f32_16x16x32_bf16 v[180:183], a[232:235], v[88:91], 0
    ds_read_b64_tr_b16 a[196:197], v3 offset:50944
    v_cvt_pk_bf16_f32 v98, v32, v33
    v_mfma_f32_16x16x32_bf16 v[180:183], a[236:239], v[92:95], v[180:183]
    s_waitcnt lgkmcnt(9)
    ds_read_b64_tr_b16 a[198:199], v3 offset:51456
    v_cvt_pk_bf16_f32 v99, v34, v35
    v_mfma_f32_16x16x32_bf16 v[152:155], a[240:243], v[80:83], 0
    ds_read_b64_tr_b16 a[200:201], v3 offset:34080
    v_fma_mix_f32 v36, v106, v24, v28 op_sel:[0,0,0] op_sel_hi:[1,0,0]
    v_mfma_f32_16x16x32_bf16 v[152:155], a[244:247], v[84:87], v[152:155]
    ds_read_b64_tr_b16 a[202:203], v3 offset:34592
    v_fma_mix_f32 v37, v106, v25, v29 op_sel:[1,0,0] op_sel_hi:[1,0,0]
    v_mfma_f32_16x16x32_bf16 v[184:187], a[240:243], v[88:91], 0
    ds_read_b64_tr_b16 a[204:205], v3 offset:50976
    v_fma_mix_f32 v38, v107, v26, v30 op_sel:[0,0,0] op_sel_hi:[1,0,0]
    v_mfma_f32_16x16x32_bf16 v[184:187], a[244:247], v[92:95], v[184:187]
    s_waitcnt lgkmcnt(7)
    ds_read_b64_tr_b16 a[206:207], v3 offset:51488
    v_fma_mix_f32 v39, v107, v27, v31 op_sel:[1,0,0] op_sel_hi:[1,0,0]
    v_mfma_f32_16x16x32_bf16 v[156:159], a[248:251], v[80:83], 0
    ds_read_b64_tr_b16 a[208:209], v3 offset:34112
    v_cvt_pk_bf16_f32 v106, v36, v37
    v_mfma_f32_16x16x32_bf16 v[156:159], a[252:255], v[84:87], v[156:159]
    ds_read_b64_tr_b16 a[210:211], v3 offset:34624
    v_cvt_pk_bf16_f32 v107, v38, v39
    v_mfma_f32_16x16x32_bf16 v[188:191], a[248:251], v[88:91], 0
    ds_read_b64_tr_b16 a[212:213], v3 offset:51008
    v_mfma_f32_16x16x32_bf16 v[188:191], a[252:255], v[92:95], v[188:191]
    s_waitcnt lgkmcnt(7)
    ds_read_b64_tr_b16 a[214:215], v3 offset:51520
    v_mfma_f32_16x16x32_bf16 v[192:195], a[192:195], v[80:83], 0
    ds_read_b64_tr_b16 a[216:217], v3 offset:34144
    ds_read_b128 v[24:27], v9 offset:784
    v_mfma_f32_16x16x32_bf16 v[192:195], a[196:199], v[84:87], v[192:195]
    ds_read_b64_tr_b16 a[218:219], v3 offset:34656
    ds_read_b128 v[28:31], v9 offset:816
    v_mfma_f32_16x16x32_bf16 v[224:227], a[192:195], v[88:91], 0
    ds_read_b64_tr_b16 a[220:221], v3 offset:51040
    v_fma_mix_f32 v32, v100, v16, v20 op_sel:[0,0,0] op_sel_hi:[1,0,0]
    v_mfma_f32_16x16x32_bf16 v[224:227], a[196:199], v[92:95], v[224:227]
    s_waitcnt lgkmcnt(9)
    ds_read_b64_tr_b16 a[222:223], v3 offset:51552
    v_fma_mix_f32 v33, v100, v17, v21 op_sel:[1,0,0] op_sel_hi:[1,0,0]
    v_mfma_f32_16x16x32_bf16 v[196:199], a[200:203], v[80:83], 0
    ds_read_b64_tr_b16 a[224:225], v3 offset:34176
    v_fma_mix_f32 v34, v101, v18, v22 op_sel:[0,0,0] op_sel_hi:[1,0,0]
    v_mfma_f32_16x16x32_bf16 v[196:199], a[204:207], v[84:87], v[196:199]
    ds_read_b64_tr_b16 a[226:227], v3 offset:34688
    v_fma_mix_f32 v35, v101, v19, v23 op_sel:[1,0,0] op_sel_hi:[1,0,0]
    v_mfma_f32_16x16x32_bf16 v[228:231], a[200:203], v[88:91], 0
    ds_read_b64_tr_b16 a[228:229], v3 offset:51072
    v_cvt_pk_bf16_f32 v100, v32, v33
    v_mfma_f32_16x16x32_bf16 v[228:231], a[204:207], v[92:95], v[228:231]
    s_waitcnt lgkmcnt(9)
    ds_read_b64_tr_b16 a[230:231], v3 offset:51584
    v_cvt_pk_bf16_f32 v101, v34, v35
    v_mfma_f32_16x16x32_bf16 v[200:203], a[208:211], v[80:83], 0
    ds_read_b64_tr_b16 a[232:233], v3 offset:34208
    v_fma_mix_f32 v36, v108, v16, v20 op_sel:[0,0,0] op_sel_hi:[1,0,0]
    v_mfma_f32_16x16x32_bf16 v[200:203], a[212:215], v[84:87], v[200:203]
    ds_read_b64_tr_b16 a[234:235], v3 offset:34720
    v_fma_mix_f32 v37, v108, v17, v21 op_sel:[1,0,0] op_sel_hi:[1,0,0]
    v_mfma_f32_16x16x32_bf16 v[232:235], a[208:211], v[88:91], 0
    ds_read_b64_tr_b16 a[236:237], v3 offset:51104
    v_fma_mix_f32 v38, v109, v18, v22 op_sel:[0,0,0] op_sel_hi:[1,0,0]
    v_mfma_f32_16x16x32_bf16 v[232:235], a[212:215], v[92:95], v[232:235]
    s_waitcnt lgkmcnt(7)
    ds_read_b64_tr_b16 a[238:239], v3 offset:51616
    v_fma_mix_f32 v39, v109, v19, v23 op_sel:[1,0,0] op_sel_hi:[1,0,0]
    v_mfma_f32_16x16x32_bf16 v[204:207], a[216:219], v[80:83], 0
    ds_read_b64_tr_b16 a[240:241], v3 offset:34240
    v_cvt_pk_bf16_f32 v108, v36, v37
    v_mfma_f32_16x16x32_bf16 v[204:207], a[220:223], v[84:87], v[204:207]
    ds_read_b64_tr_b16 a[242:243], v3 offset:34752
    v_cvt_pk_bf16_f32 v109, v38, v39
    v_mfma_f32_16x16x32_bf16 v[236:239], a[216:219], v[88:91], 0
    ds_read_b64_tr_b16 a[244:245], v3 offset:51136
    v_mfma_f32_16x16x32_bf16 v[236:239], a[220:223], v[92:95], v[236:239]
    s_waitcnt lgkmcnt(7)
    ds_read_b64_tr_b16 a[246:247], v3 offset:51648
    v_mfma_f32_16x16x32_bf16 v[208:211], a[224:227], v[80:83], 0
    ds_read_b64_tr_b16 a[248:249], v3 offset:34272
    ds_read_b128 v[16:19], v9 offset:1024
    v_mfma_f32_16x16x32_bf16 v[208:211], a[228:231], v[84:87], v[208:211]
    ds_read_b64_tr_b16 a[250:251], v3 offset:34784
    ds_read_b128 v[20:23], v9 offset:1056
    v_mfma_f32_16x16x32_bf16 v[240:243], a[224:227], v[88:91], 0
    ds_read_b64_tr_b16 a[252:253], v3 offset:51168
    v_fma_mix_f32 v32, v102, v24, v28 op_sel:[0,0,0] op_sel_hi:[1,0,0]
    v_mfma_f32_16x16x32_bf16 v[240:243], a[228:231], v[92:95], v[240:243]
    s_waitcnt vmcnt(28)
    s_barrier
    s_waitcnt lgkmcnt(9)
    ds_read_b64_tr_b16 a[254:255], v3 offset:51680
    v_fma_mix_f32 v33, v102, v25, v29 op_sel:[1,0,0] op_sel_hi:[1,0,0]
    v_mfma_f32_16x16x32_bf16 v[212:215], a[232:235], v[80:83], 0
    ds_read_b64_tr_b16 a[192:193], v4 offset:0
    v_fma_mix_f32 v34, v103, v26, v30 op_sel:[0,0,0] op_sel_hi:[1,0,0]
    v_mfma_f32_16x16x32_bf16 v[212:215], a[236:239], v[84:87], v[212:215]
    ds_read_b64_tr_b16 a[194:195], v4 offset:512
    v_fma_mix_f32 v35, v103, v27, v31 op_sel:[1,0,0] op_sel_hi:[1,0,0]
    v_mfma_f32_16x16x32_bf16 v[244:247], a[232:235], v[88:91], 0
    ds_read_b64_tr_b16 a[196:197], v4 offset:16896
    v_cvt_pk_bf16_f32 v102, v32, v33
    v_mfma_f32_16x16x32_bf16 v[244:247], a[236:239], v[92:95], v[244:247]
    s_waitcnt lgkmcnt(9)
    ds_read_b64_tr_b16 a[198:199], v4 offset:17408
    v_cvt_pk_bf16_f32 v103, v34, v35
    v_mfma_f32_16x16x32_bf16 v[216:219], a[240:243], v[80:83], 0
    ds_read_b64_tr_b16 a[200:201], v4 offset:32
    v_fma_mix_f32 v36, v110, v24, v28 op_sel:[0,0,0] op_sel_hi:[1,0,0]
    v_mfma_f32_16x16x32_bf16 v[216:219], a[244:247], v[84:87], v[216:219]
    ds_read_b64_tr_b16 a[202:203], v4 offset:544
    v_fma_mix_f32 v37, v110, v25, v29 op_sel:[1,0,0] op_sel_hi:[1,0,0]
    v_mfma_f32_16x16x32_bf16 v[248:251], a[240:243], v[88:91], 0
    ds_read_b64_tr_b16 a[204:205], v4 offset:16928
    v_fma_mix_f32 v38, v111, v26, v30 op_sel:[0,0,0] op_sel_hi:[1,0,0]
    v_mfma_f32_16x16x32_bf16 v[248:251], a[244:247], v[92:95], v[248:251]
    s_waitcnt lgkmcnt(7)
    ds_read_b64_tr_b16 a[206:207], v4 offset:17440
    v_fma_mix_f32 v39, v111, v27, v31 op_sel:[1,0,0] op_sel_hi:[1,0,0]
    v_mfma_f32_16x16x32_bf16 v[220:223], a[248:251], v[80:83], 0
    ds_read_b64_tr_b16 a[208:209], v4 offset:64
    v_cvt_pk_bf16_f32 v110, v36, v37
    v_mfma_f32_16x16x32_bf16 v[220:223], a[252:255], v[84:87], v[220:223]
    ds_read_b64_tr_b16 a[210:211], v4 offset:576
    v_cvt_pk_bf16_f32 v111, v38, v39
    v_mfma_f32_16x16x32_bf16 v[252:255], a[248:251], v[88:91], 0
    ds_read_b64_tr_b16 a[212:213], v4 offset:16960
    v_mfma_f32_16x16x32_bf16 v[252:255], a[252:255], v[92:95], v[252:255]
    s_waitcnt lgkmcnt(7)
    ds_read_b64_tr_b16 a[214:215], v4 offset:17472
    v_mfma_f32_16x16x32_bf16 v[128:131], a[192:195], v[96:99], v[128:131]
    s_waitcnt vmcnt(24)
    ds_read_b64_tr_b16 a[216:217], v4 offset:96
    ds_read_b128 v[24:27], v9 offset:1040
    v_mfma_f32_16x16x32_bf16 v[128:131], a[196:199], v[100:103], v[128:131]
    ds_read_b64_tr_b16 a[218:219], v4 offset:608
    ds_read_b64_tr_b16 a[220:221], v4 offset:16992
    v_mfma_f32_16x16x32_bf16 v[160:163], a[192:195], v[104:107], v[160:163]
    s_mov_b32 s54, 10240
    ds_read_b64_tr_b16 a[222:223], v4 offset:17504
    ds_read_b128 v[28:31], v9 offset:1072
    v_mfma_f32_16x16x32_bf16 v[160:163], a[196:199], v[108:111], v[160:163]
    s_waitcnt lgkmcnt(10)
    buffer_load_dwordx4 v[80:83], v8, s[32:35], s54 offen
    v_mfma_f32_16x16x32_bf16 v[132:135], a[200:203], v[96:99], v[132:135]
    ds_read_b64_tr_b16 a[224:225], v4 offset:128
    v_fma_mix_f32 v32, v112, v16, v20 op_sel:[0,0,0] op_sel_hi:[1,0,0]
    v_mfma_f32_16x16x32_bf16 v[132:135], a[204:207], v[100:103], v[132:135]
    ds_read_b64_tr_b16 a[226:227], v4 offset:640
    v_fma_mix_f32 v33, v112, v17, v21 op_sel:[1,0,0] op_sel_hi:[1,0,0]
    v_mfma_f32_16x16x32_bf16 v[164:167], a[200:203], v[104:107], v[164:167]
    ds_read_b64_tr_b16 a[228:229], v4 offset:17024
    v_fma_mix_f32 v34, v113, v18, v22 op_sel:[0,0,0] op_sel_hi:[1,0,0]
    v_mfma_f32_16x16x32_bf16 v[164:167], a[204:207], v[108:111], v[164:167]
    s_waitcnt lgkmcnt(9)
    ds_read_b64_tr_b16 a[230:231], v4 offset:17536
    v_fma_mix_f32 v35, v113, v19, v23 op_sel:[1,0,0] op_sel_hi:[1,0,0]
    v_mfma_f32_16x16x32_bf16 v[136:139], a[208:211], v[96:99], v[136:139]
    ds_read_b64_tr_b16 a[232:233], v4 offset:160
    v_cvt_pk_bf16_f32 v112, v32, v33
    v_mfma_f32_16x16x32_bf16 v[136:139], a[212:215], v[100:103], v[136:139]
    ds_read_b64_tr_b16 a[234:235], v4 offset:672
    v_cvt_pk_bf16_f32 v113, v34, v35
    v_mfma_f32_16x16x32_bf16 v[168:171], a[208:211], v[104:107], v[168:171]
    ds_read_b64_tr_b16 a[236:237], v4 offset:17056
    v_fma_mix_f32 v36, v120, v16, v20 op_sel:[0,0,0] op_sel_hi:[1,0,0]
    v_mfma_f32_16x16x32_bf16 v[168:171], a[212:215], v[108:111], v[168:171]
    s_waitcnt lgkmcnt(8)
    ds_read_b64_tr_b16 a[238:239], v4 offset:17568
    v_fma_mix_f32 v37, v120, v17, v21 op_sel:[1,0,0] op_sel_hi:[1,0,0]
    v_mfma_f32_16x16x32_bf16 v[140:143], a[216:219], v[96:99], v[140:143]
    ds_read_b64_tr_b16 a[240:241], v4 offset:192
    v_fma_mix_f32 v38, v121, v18, v22 op_sel:[0,0,0] op_sel_hi:[1,0,0]
    v_mfma_f32_16x16x32_bf16 v[140:143], a[220:223], v[100:103], v[140:143]
    ds_read_b64_tr_b16 a[242:243], v4 offset:704
    v_fma_mix_f32 v39, v121, v19, v23 op_sel:[1,0,0] op_sel_hi:[1,0,0]
    v_mfma_f32_16x16x32_bf16 v[172:175], a[216:219], v[104:107], v[172:175]
    ds_read_b64_tr_b16 a[244:245], v4 offset:17088
    v_cvt_pk_bf16_f32 v120, v36, v37
    v_mfma_f32_16x16x32_bf16 v[172:175], a[220:223], v[108:111], v[172:175]
    s_waitcnt lgkmcnt(7)
    ds_read_b64_tr_b16 a[246:247], v4 offset:17600
    v_cvt_pk_bf16_f32 v121, v38, v39
    v_mfma_f32_16x16x32_bf16 v[144:147], a[224:227], v[96:99], v[144:147]
    ds_read_b64_tr_b16 a[248:249], v4 offset:224
    ds_read_b128 v[16:19], v9 offset:1280
    v_mfma_f32_16x16x32_bf16 v[144:147], a[228:231], v[100:103], v[144:147]
    ds_read_b64_tr_b16 a[250:251], v4 offset:736
    ds_read_b64_tr_b16 a[252:253], v4 offset:17120
    v_mfma_f32_16x16x32_bf16 v[176:179], a[224:227], v[104:107], v[176:179]
    s_mov_b32 s54, 11264
    ds_read_b64_tr_b16 a[254:255], v4 offset:17632
    ds_read_b128 v[20:23], v9 offset:1312
    v_mfma_f32_16x16x32_bf16 v[176:179], a[228:231], v[108:111], v[176:179]
    s_waitcnt lgkmcnt(10)
    buffer_load_dwordx4 v[84:87], v8, s[32:35], s54 offen
    v_mfma_f32_16x16x32_bf16 v[148:151], a[232:235], v[96:99], v[148:151]
    ds_read_b64_tr_b16 a[192:193], v4 offset:256
    v_fma_mix_f32 v32, v114, v24, v28 op_sel:[0,0,0] op_sel_hi:[1,0,0]
    v_mfma_f32_16x16x32_bf16 v[148:151], a[236:239], v[100:103], v[148:151]
    ds_read_b64_tr_b16 a[194:195], v4 offset:768
    v_fma_mix_f32 v33, v114, v25, v29 op_sel:[1,0,0] op_sel_hi:[1,0,0]
    v_mfma_f32_16x16x32_bf16 v[180:183], a[232:235], v[104:107], v[180:183]
    ds_read_b64_tr_b16 a[196:197], v4 offset:17152
    v_fma_mix_f32 v34, v115, v26, v30 op_sel:[0,0,0] op_sel_hi:[1,0,0]
    v_mfma_f32_16x16x32_bf16 v[180:183], a[236:239], v[108:111], v[180:183]
    s_waitcnt lgkmcnt(9)
    ds_read_b64_tr_b16 a[198:199], v4 offset:17664
    v_fma_mix_f32 v35, v115, v27, v31 op_sel:[1,0,0] op_sel_hi:[1,0,0]
    v_mfma_f32_16x16x32_bf16 v[152:155], a[240:243], v[96:99], v[152:155]
    ds_read_b64_tr_b16 a[200:201], v4 offset:288
    v_cvt_pk_bf16_f32 v114, v32, v33
    v_mfma_f32_16x16x32_bf16 v[152:155], a[244:247], v[100:103], v[152:155]
    ds_read_b64_tr_b16 a[202:203], v4 offset:800
    v_cvt_pk_bf16_f32 v115, v34, v35
    v_mfma_f32_16x16x32_bf16 v[184:187], a[240:243], v[104:107], v[184:187]
    ds_read_b64_tr_b16 a[204:205], v4 offset:17184
    v_fma_mix_f32 v36, v122, v24, v28 op_sel:[0,0,0] op_sel_hi:[1,0,0]
    v_mfma_f32_16x16x32_bf16 v[184:187], a[244:247], v[108:111], v[184:187]
    s_waitcnt lgkmcnt(8)
    ds_read_b64_tr_b16 a[206:207], v4 offset:17696
    v_fma_mix_f32 v37, v122, v25, v29 op_sel:[1,0,0] op_sel_hi:[1,0,0]
    v_mfma_f32_16x16x32_bf16 v[156:159], a[248:251], v[96:99], v[156:159]
    ds_read_b64_tr_b16 a[208:209], v4 offset:320
    v_fma_mix_f32 v38, v123, v26, v30 op_sel:[0,0,0] op_sel_hi:[1,0,0]
    v_mfma_f32_16x16x32_bf16 v[156:159], a[252:255], v[100:103], v[156:159]
    ds_read_b64_tr_b16 a[210:211], v4 offset:832
    v_fma_mix_f32 v39, v123, v27, v31 op_sel:[1,0,0] op_sel_hi:[1,0,0]
    v_mfma_f32_16x16x32_bf16 v[188:191], a[248:251], v[104:107], v[188:191]
    ds_read_b64_tr_b16 a[212:213], v4 offset:17216
    v_cvt_pk_bf16_f32 v122, v36, v37
    v_mfma_f32_16x16x32_bf16 v[188:191], a[252:255], v[108:111], v[188:191]
    s_waitcnt lgkmcnt(7)
    ds_read_b64_tr_b16 a[214:215], v4 offset:17728
    v_cvt_pk_bf16_f32 v123, v38, v39
    v_mfma_f32_16x16x32_bf16 v[192:195], a[192:195], v[96:99], v[192:195]
    ds_read_b64_tr_b16 a[216:217], v4 offset:352
    ds_read_b128 v[24:27], v9 offset:1296
    v_mfma_f32_16x16x32_bf16 v[192:195], a[196:199], v[100:103], v[192:195]
    ds_read_b64_tr_b16 a[218:219], v4 offset:864
    ds_read_b64_tr_b16 a[220:221], v4 offset:17248
    v_mfma_f32_16x16x32_bf16 v[224:227], a[192:195], v[104:107], v[224:227]
    s_mov_b32 s54, 28672
    ds_read_b64_tr_b16 a[222:223], v4 offset:17760
    ds_read_b128 v[28:31], v9 offset:1328
    v_mfma_f32_16x16x32_bf16 v[224:227], a[196:199], v[108:111], v[224:227]
    s_waitcnt lgkmcnt(10)
    buffer_load_dwordx4 v[88:91], v8, s[32:35], s54 offen
    v_mfma_f32_16x16x32_bf16 v[196:199], a[200:203], v[96:99], v[196:199]
    ds_read_b64_tr_b16 a[224:225], v4 offset:384
    v_fma_mix_f32 v32, v116, v16, v20 op_sel:[0,0,0] op_sel_hi:[1,0,0]
    v_mfma_f32_16x16x32_bf16 v[196:199], a[204:207], v[100:103], v[196:199]
    ds_read_b64_tr_b16 a[226:227], v4 offset:896
    v_fma_mix_f32 v33, v116, v17, v21 op_sel:[1,0,0] op_sel_hi:[1,0,0]
    v_mfma_f32_16x16x32_bf16 v[228:231], a[200:203], v[104:107], v[228:231]
    ds_read_b64_tr_b16 a[228:229], v4 offset:17280
    v_fma_mix_f32 v34, v117, v18, v22 op_sel:[0,0,0] op_sel_hi:[1,0,0]
    v_mfma_f32_16x16x32_bf16 v[228:231], a[204:207], v[108:111], v[228:231]
    s_waitcnt lgkmcnt(9)
    ds_read_b64_tr_b16 a[230:231], v4 offset:17792
    v_fma_mix_f32 v35, v117, v19, v23 op_sel:[1,0,0] op_sel_hi:[1,0,0]
    v_mfma_f32_16x16x32_bf16 v[200:203], a[208:211], v[96:99], v[200:203]
    ds_read_b64_tr_b16 a[232:233], v4 offset:416
    v_cvt_pk_bf16_f32 v116, v32, v33
    v_mfma_f32_16x16x32_bf16 v[200:203], a[212:215], v[100:103], v[200:203]
    ds_read_b64_tr_b16 a[234:235], v4 offset:928
    v_cvt_pk_bf16_f32 v117, v34, v35
    v_mfma_f32_16x16x32_bf16 v[232:235], a[208:211], v[104:107], v[232:235]
    ds_read_b64_tr_b16 a[236:237], v4 offset:17312
    v_fma_mix_f32 v36, v124, v16, v20 op_sel:[0,0,0] op_sel_hi:[1,0,0]
    v_mfma_f32_16x16x32_bf16 v[232:235], a[212:215], v[108:111], v[232:235]
    s_waitcnt lgkmcnt(8)
    ds_read_b64_tr_b16 a[238:239], v4 offset:17824
    v_fma_mix_f32 v37, v124, v17, v21 op_sel:[1,0,0] op_sel_hi:[1,0,0]
    v_mfma_f32_16x16x32_bf16 v[204:207], a[216:219], v[96:99], v[204:207]
    ds_read_b64_tr_b16 a[240:241], v4 offset:448
    v_fma_mix_f32 v38, v125, v18, v22 op_sel:[0,0,0] op_sel_hi:[1,0,0]
    v_mfma_f32_16x16x32_bf16 v[204:207], a[220:223], v[100:103], v[204:207]
    ds_read_b64_tr_b16 a[242:243], v4 offset:960
    v_fma_mix_f32 v39, v125, v19, v23 op_sel:[1,0,0] op_sel_hi:[1,0,0]
    v_mfma_f32_16x16x32_bf16 v[236:239], a[216:219], v[104:107], v[236:239]
    ds_read_b64_tr_b16 a[244:245], v4 offset:17344
    v_cvt_pk_bf16_f32 v124, v36, v37
    v_mfma_f32_16x16x32_bf16 v[236:239], a[220:223], v[108:111], v[236:239]
    s_waitcnt lgkmcnt(7)
    ds_read_b64_tr_b16 a[246:247], v4 offset:17856
    v_cvt_pk_bf16_f32 v125, v38, v39
    v_mfma_f32_16x16x32_bf16 v[208:211], a[224:227], v[96:99], v[208:211]
    ds_read_b64_tr_b16 a[248:249], v4 offset:480
    ds_read_b128 v[16:19], v9 offset:1536
    v_mfma_f32_16x16x32_bf16 v[208:211], a[228:231], v[100:103], v[208:211]
    ds_read_b64_tr_b16 a[250:251], v4 offset:992
    ds_read_b64_tr_b16 a[252:253], v4 offset:17376
    v_mfma_f32_16x16x32_bf16 v[240:243], a[224:227], v[104:107], v[240:243]
    s_mov_b32 s54, 29696
    ds_read_b64_tr_b16 a[254:255], v4 offset:17888
    ds_read_b128 v[20:23], v9 offset:1568
    v_mfma_f32_16x16x32_bf16 v[240:243], a[228:231], v[108:111], v[240:243]
    s_waitcnt vmcnt(19)
    s_barrier
    s_waitcnt lgkmcnt(10)
    buffer_load_dwordx4 v[92:95], v8, s[32:35], s54 offen
    v_mfma_f32_16x16x32_bf16 v[212:215], a[232:235], v[96:99], v[212:215]
    ds_read_b64_tr_b16 a[192:193], v4 offset:33792
    v_fma_mix_f32 v32, v118, v24, v28 op_sel:[0,0,0] op_sel_hi:[1,0,0]
    v_mfma_f32_16x16x32_bf16 v[212:215], a[236:239], v[100:103], v[212:215]
    s_mov_b32 s45, 2097152
    ds_read_b64_tr_b16 a[194:195], v4 offset:34304
    ds_read_b64_tr_b16 a[196:197], v4 offset:50688
    v_fma_mix_f32 v33, v118, v25, v29 op_sel:[1,0,0] op_sel_hi:[1,0,0]
    v_mfma_f32_16x16x32_bf16 v[244:247], a[232:235], v[104:107], v[244:247]
    s_add_u32 m0, s44, 33792
    ds_read_b64_tr_b16 a[198:199], v4 offset:51200
    v_fma_mix_f32 v34, v119, v26, v30 op_sel:[0,0,0] op_sel_hi:[1,0,0]
    v_mfma_f32_16x16x32_bf16 v[244:247], a[236:239], v[108:111], v[244:247]
    s_waitcnt lgkmcnt(10)
    buffer_load_dwordx4 v6, s[24:27], s45 offen lds
    v_mfma_f32_16x16x32_bf16 v[216:219], a[240:243], v[96:99], v[216:219]
    ds_read_b64_tr_b16 a[200:201], v4 offset:33824
    v_fma_mix_f32 v35, v119, v27, v31 op_sel:[1,0,0] op_sel_hi:[1,0,0]
    v_mfma_f32_16x16x32_bf16 v[216:219], a[244:247], v[100:103], v[216:219]
    ds_read_b64_tr_b16 a[202:203], v4 offset:34336
    v_cvt_pk_bf16_f32 v118, v32, v33
    v_cvt_pk_bf16_f32 v119, v34, v35
    v_mfma_f32_16x16x32_bf16 v[248:251], a[240:243], v[104:107], v[248:251]
    ds_read_b64_tr_b16 a[204:205], v4 offset:50720
    v_fma_mix_f32 v36, v126, v24, v28 op_sel:[0,0,0] op_sel_hi:[1,0,0]
    v_mfma_f32_16x16x32_bf16 v[248:251], a[244:247], v[108:111], v[248:251]
    s_waitcnt lgkmcnt(8)
    ds_read_b64_tr_b16 a[206:207], v4 offset:51232
    v_fma_mix_f32 v37, v126, v25, v29 op_sel:[1,0,0] op_sel_hi:[1,0,0]
    v_fma_mix_f32 v38, v127, v26, v30 op_sel:[0,0,0] op_sel_hi:[1,0,0]
    v_mfma_f32_16x16x32_bf16 v[220:223], a[248:251], v[96:99], v[220:223]
    ds_read_b64_tr_b16 a[208:209], v4 offset:33856
    v_fma_mix_f32 v39, v127, v27, v31 op_sel:[1,0,0] op_sel_hi:[1,0,0]
    v_mfma_f32_16x16x32_bf16 v[220:223], a[252:255], v[100:103], v[220:223]
    s_mov_b32 s45, 2105344
    ds_read_b64_tr_b16 a[210:211], v4 offset:34368
    ds_read_b64_tr_b16 a[212:213], v4 offset:50752
    v_cvt_pk_bf16_f32 v126, v36, v37
    v_mfma_f32_16x16x32_bf16 v[252:255], a[248:251], v[104:107], v[252:255]
    s_add_u32 m0, s44, 34848
    ds_read_b64_tr_b16 a[214:215], v4 offset:51264
    v_cvt_pk_bf16_f32 v127, v38, v39
    v_mfma_f32_16x16x32_bf16 v[252:255], a[252:255], v[108:111], v[252:255]
    s_waitcnt lgkmcnt(8)
    buffer_load_dwordx4 v6, s[24:27], s45 offen lds
    v_mfma_f32_16x16x32_bf16 v[128:131], a[192:195], v[112:115], v[128:131]
    s_waitcnt vmcnt(18)
    ds_read_b64_tr_b16 a[216:217], v4 offset:33888
    ds_read_b128 v[24:27], v9 offset:1552
    v_mfma_f32_16x16x32_bf16 v[128:131], a[196:199], v[116:119], v[128:131]
    ds_read_b64_tr_b16 a[218:219], v4 offset:34400
    ds_read_b64_tr_b16 a[220:221], v4 offset:50784
    v_mfma_f32_16x16x32_bf16 v[160:163], a[192:195], v[120:123], v[160:163]
    s_mov_b32 s54, 12288
    ds_read_b64_tr_b16 a[222:223], v4 offset:51296
    ds_read_b128 v[28:31], v9 offset:1584
    v_mfma_f32_16x16x32_bf16 v[160:163], a[196:199], v[124:127], v[160:163]
    s_waitcnt lgkmcnt(10)
    buffer_load_dwordx4 v[96:99], v8, s[32:35], s54 offen
    v_mfma_f32_16x16x32_bf16 v[132:135], a[200:203], v[112:115], v[132:135]
    ds_read_b64_tr_b16 a[224:225], v4 offset:33920
    v_fma_mix_f32 v32, v48, v16, v20 op_sel:[0,0,0] op_sel_hi:[1,0,0]
    v_mfma_f32_16x16x32_bf16 v[132:135], a[204:207], v[116:119], v[132:135]
    s_mov_b32 s45, 2113536
    ds_read_b64_tr_b16 a[226:227], v4 offset:34432
    ds_read_b64_tr_b16 a[228:229], v4 offset:50816
    v_fma_mix_f32 v33, v48, v17, v21 op_sel:[1,0,0] op_sel_hi:[1,0,0]
    v_mfma_f32_16x16x32_bf16 v[164:167], a[200:203], v[120:123], v[164:167]
    s_add_u32 m0, s44, 35904
    ds_read_b64_tr_b16 a[230:231], v4 offset:51328
    v_fma_mix_f32 v34, v49, v18, v22 op_sel:[0,0,0] op_sel_hi:[1,0,0]
    v_mfma_f32_16x16x32_bf16 v[164:167], a[204:207], v[124:127], v[164:167]
    s_waitcnt lgkmcnt(10)
    buffer_load_dwordx4 v6, s[24:27], s45 offen lds
    v_mfma_f32_16x16x32_bf16 v[136:139], a[208:211], v[112:115], v[136:139]
    ds_read_b64_tr_b16 a[232:233], v4 offset:33952
    v_fma_mix_f32 v35, v49, v19, v23 op_sel:[1,0,0] op_sel_hi:[1,0,0]
    v_mfma_f32_16x16x32_bf16 v[136:139], a[212:215], v[116:119], v[136:139]
    ds_read_b64_tr_b16 a[234:235], v4 offset:34464
    v_cvt_pk_bf16_f32 v48, v32, v33
    v_cvt_pk_bf16_f32 v49, v34, v35
    v_mfma_f32_16x16x32_bf16 v[168:171], a[208:211], v[120:123], v[168:171]
    ds_read_b64_tr_b16 a[236:237], v4 offset:50848
    v_fma_mix_f32 v36, v56, v16, v20 op_sel:[0,0,0] op_sel_hi:[1,0,0]
    v_mfma_f32_16x16x32_bf16 v[168:171], a[212:215], v[124:127], v[168:171]
    s_waitcnt lgkmcnt(8)
    ds_read_b64_tr_b16 a[238:239], v4 offset:51360
    v_fma_mix_f32 v37, v56, v17, v21 op_sel:[1,0,0] op_sel_hi:[1,0,0]
    v_fma_mix_f32 v38, v57, v18, v22 op_sel:[0,0,0] op_sel_hi:[1,0,0]
    v_mfma_f32_16x16x32_bf16 v[140:143], a[216:219], v[112:115], v[140:143]
    ds_read_b64_tr_b16 a[240:241], v4 offset:33984
    v_fma_mix_f32 v39, v57, v19, v23 op_sel:[1,0,0] op_sel_hi:[1,0,0]
    v_mfma_f32_16x16x32_bf16 v[140:143], a[220:223], v[116:119], v[140:143]
    s_mov_b32 s45, 2121728
    ds_read_b64_tr_b16 a[242:243], v4 offset:34496
    ds_read_b64_tr_b16 a[244:245], v4 offset:50880
    v_cvt_pk_bf16_f32 v56, v36, v37
    v_mfma_f32_16x16x32_bf16 v[172:175], a[216:219], v[120:123], v[172:175]
    s_add_u32 m0, s44, 36960
    ds_read_b64_tr_b16 a[246:247], v4 offset:51392
    v_cvt_pk_bf16_f32 v57, v38, v39
    v_mfma_f32_16x16x32_bf16 v[172:175], a[220:223], v[124:127], v[172:175]
    s_waitcnt lgkmcnt(8)
    buffer_load_dwordx4 v6, s[24:27], s45 offen lds
    v_mfma_f32_16x16x32_bf16 v[144:147], a[224:227], v[112:115], v[144:147]
    ds_read_b64_tr_b16 a[248:249], v4 offset:34016
    ds_read_b128 v[16:19], v9 offset:1792
    v_mfma_f32_16x16x32_bf16 v[144:147], a[228:231], v[116:119], v[144:147]
    ds_read_b64_tr_b16 a[250:251], v4 offset:34528
    ds_read_b64_tr_b16 a[252:253], v4 offset:50912
    v_mfma_f32_16x16x32_bf16 v[176:179], a[224:227], v[120:123], v[176:179]
    s_mov_b32 s54, 13312
    ds_read_b64_tr_b16 a[254:255], v4 offset:51424
    ds_read_b128 v[20:23], v9 offset:1824
    v_mfma_f32_16x16x32_bf16 v[176:179], a[228:231], v[124:127], v[176:179]
    s_waitcnt lgkmcnt(10)
    buffer_load_dwordx4 v[100:103], v8, s[32:35], s54 offen
    v_mfma_f32_16x16x32_bf16 v[148:151], a[232:235], v[112:115], v[148:151]
    ds_read_b64_tr_b16 a[192:193], v4 offset:34048
    v_fma_mix_f32 v32, v50, v24, v28 op_sel:[0,0,0] op_sel_hi:[1,0,0]
    v_mfma_f32_16x16x32_bf16 v[148:151], a[236:239], v[116:119], v[148:151]
    s_mov_b32 s45, 2359296
    ds_read_b64_tr_b16 a[194:195], v4 offset:34560
    ds_read_b64_tr_b16 a[196:197], v4 offset:50944
    v_fma_mix_f32 v33, v50, v25, v29 op_sel:[1,0,0] op_sel_hi:[1,0,0]
    v_mfma_f32_16x16x32_bf16 v[180:183], a[232:235], v[120:123], v[180:183]
    s_add_u32 m0, s44, 50688
    ds_read_b64_tr_b16 a[198:199], v4 offset:51456
    v_fma_mix_f32 v34, v51, v26, v30 op_sel:[0,0,0] op_sel_hi:[1,0,0]
    v_mfma_f32_16x16x32_bf16 v[180:183], a[236:239], v[124:127], v[180:183]
    s_waitcnt lgkmcnt(10)
    buffer_load_dwordx4 v6, s[24:27], s45 offen lds
    v_mfma_f32_16x16x32_bf16 v[152:155], a[240:243], v[112:115], v[152:155]
    ds_read_b64_tr_b16 a[200:201], v4 offset:34080
    v_fma_mix_f32 v35, v51, v27, v31 op_sel:[1,0,0] op_sel_hi:[1,0,0]
    v_mfma_f32_16x16x32_bf16 v[152:155], a[244:247], v[116:119], v[152:155]
    ds_read_b64_tr_b16 a[202:203], v4 offset:34592
    v_cvt_pk_bf16_f32 v50, v32, v33
    v_cvt_pk_bf16_f32 v51, v34, v35
    v_mfma_f32_16x16x32_bf16 v[184:187], a[240:243], v[120:123], v[184:187]
    ds_read_b64_tr_b16 a[204:205], v4 offset:50976
    v_fma_mix_f32 v36, v58, v24, v28 op_sel:[0,0,0] op_sel_hi:[1,0,0]
    v_mfma_f32_16x16x32_bf16 v[184:187], a[244:247], v[124:127], v[184:187]
    s_waitcnt lgkmcnt(8)
    ds_read_b64_tr_b16 a[206:207], v4 offset:51488
    v_fma_mix_f32 v37, v58, v25, v29 op_sel:[1,0,0] op_sel_hi:[1,0,0]
    v_fma_mix_f32 v38, v59, v26, v30 op_sel:[0,0,0] op_sel_hi:[1,0,0]
    v_mfma_f32_16x16x32_bf16 v[156:159], a[248:251], v[112:115], v[156:159]
    ds_read_b64_tr_b16 a[208:209], v4 offset:34112
    v_fma_mix_f32 v39, v59, v27, v31 op_sel:[1,0,0] op_sel_hi:[1,0,0]
    v_mfma_f32_16x16x32_bf16 v[156:159], a[252:255], v[116:119], v[156:159]
    s_mov_b32 s45, 2367488
    ds_read_b64_tr_b16 a[210:211], v4 offset:34624
    ds_read_b64_tr_b16 a[212:213], v4 offset:51008
    v_cvt_pk_bf16_f32 v58, v36, v37
    v_mfma_f32_16x16x32_bf16 v[188:191], a[248:251], v[120:123], v[188:191]
    s_add_u32 m0, s44, 51744
    ds_read_b64_tr_b16 a[214:215], v4 offset:51520
    v_cvt_pk_bf16_f32 v59, v38, v39
    v_mfma_f32_16x16x32_bf16 v[188:191], a[252:255], v[124:127], v[188:191]
    s_waitcnt lgkmcnt(8)
    buffer_load_dwordx4 v6, s[24:27], s45 offen lds
    v_mfma_f32_16x16x32_bf16 v[192:195], a[192:195], v[112:115], v[192:195]
    ds_read_b64_tr_b16 a[216:217], v4 offset:34144
    ds_read_b128 v[24:27], v9 offset:1808
    v_mfma_f32_16x16x32_bf16 v[192:195], a[196:199], v[116:119], v[192:195]
    ds_read_b64_tr_b16 a[218:219], v4 offset:34656
    ds_read_b64_tr_b16 a[220:221], v4 offset:51040
    v_mfma_f32_16x16x32_bf16 v[224:227], a[192:195], v[120:123], v[224:227]
    s_mov_b32 s54, 30720
    ds_read_b64_tr_b16 a[222:223], v4 offset:51552
    ds_read_b128 v[28:31], v9 offset:1840
    v_mfma_f32_16x16x32_bf16 v[224:227], a[196:199], v[124:127], v[224:227]
    s_waitcnt lgkmcnt(10)
    buffer_load_dwordx4 v[104:107], v8, s[32:35], s54 offen
    v_mfma_f32_16x16x32_bf16 v[196:199], a[200:203], v[112:115], v[196:199]
    ds_read_b64_tr_b16 a[224:225], v4 offset:34176
    v_fma_mix_f32 v32, v52, v16, v20 op_sel:[0,0,0] op_sel_hi:[1,0,0]
    v_mfma_f32_16x16x32_bf16 v[196:199], a[204:207], v[116:119], v[196:199]
    s_mov_b32 s45, 2375680
    ds_read_b64_tr_b16 a[226:227], v4 offset:34688
    ds_read_b64_tr_b16 a[228:229], v4 offset:51072
    v_fma_mix_f32 v33, v52, v17, v21 op_sel:[1,0,0] op_sel_hi:[1,0,0]
    v_mfma_f32_16x16x32_bf16 v[228:231], a[200:203], v[120:123], v[228:231]
    s_add_u32 m0, s44, 52800
    ds_read_b64_tr_b16 a[230:231], v4 offset:51584
    v_fma_mix_f32 v34, v53, v18, v22 op_sel:[0,0,0] op_sel_hi:[1,0,0]
    v_mfma_f32_16x16x32_bf16 v[228:231], a[204:207], v[124:127], v[228:231]
    s_waitcnt lgkmcnt(10)
    buffer_load_dwordx4 v6, s[24:27], s45 offen lds
    v_mfma_f32_16x16x32_bf16 v[200:203], a[208:211], v[112:115], v[200:203]
    ds_read_b64_tr_b16 a[232:233], v4 offset:34208
    v_fma_mix_f32 v35, v53, v19, v23 op_sel:[1,0,0] op_sel_hi:[1,0,0]
    v_mfma_f32_16x16x32_bf16 v[200:203], a[212:215], v[116:119], v[200:203]
    ds_read_b64_tr_b16 a[234:235], v4 offset:34720
    v_cvt_pk_bf16_f32 v52, v32, v33
    v_cvt_pk_bf16_f32 v53, v34, v35
    v_mfma_f32_16x16x32_bf16 v[232:235], a[208:211], v[120:123], v[232:235]
    ds_read_b64_tr_b16 a[236:237], v4 offset:51104
    v_fma_mix_f32 v36, v60, v16, v20 op_sel:[0,0,0] op_sel_hi:[1,0,0]
    v_mfma_f32_16x16x32_bf16 v[232:235], a[212:215], v[124:127], v[232:235]
    s_waitcnt lgkmcnt(8)
    ds_read_b64_tr_b16 a[238:239], v4 offset:51616
    v_fma_mix_f32 v37, v60, v17, v21 op_sel:[1,0,0] op_sel_hi:[1,0,0]
    v_fma_mix_f32 v38, v61, v18, v22 op_sel:[0,0,0] op_sel_hi:[1,0,0]
    v_mfma_f32_16x16x32_bf16 v[204:207], a[216:219], v[112:115], v[204:207]
    ds_read_b64_tr_b16 a[240:241], v4 offset:34240
    v_fma_mix_f32 v39, v61, v19, v23 op_sel:[1,0,0] op_sel_hi:[1,0,0]
    v_mfma_f32_16x16x32_bf16 v[204:207], a[220:223], v[116:119], v[204:207]
    s_mov_b32 s45, 2383872
    ds_read_b64_tr_b16 a[242:243], v4 offset:34752
    ds_read_b64_tr_b16 a[244:245], v4 offset:51136
    v_cvt_pk_bf16_f32 v60, v36, v37
    v_mfma_f32_16x16x32_bf16 v[236:239], a[216:219], v[120:123], v[236:239]
    s_add_u32 m0, s44, 53856
    ds_read_b64_tr_b16 a[246:247], v4 offset:51648
    v_cvt_pk_bf16_f32 v61, v38, v39
    v_mfma_f32_16x16x32_bf16 v[236:239], a[220:223], v[124:127], v[236:239]
    s_waitcnt lgkmcnt(8)
    buffer_load_dwordx4 v6, s[24:27], s45 offen lds
    v_mfma_f32_16x16x32_bf16 v[208:211], a[224:227], v[112:115], v[208:211]
    ds_read_b64_tr_b16 a[248:249], v4 offset:34272
    ds_read_b128 v[16:19], v9 offset:2048
    v_mfma_f32_16x16x32_bf16 v[208:211], a[228:231], v[116:119], v[208:211]
    ds_read_b64_tr_b16 a[250:251], v4 offset:34784
    ds_read_b64_tr_b16 a[252:253], v4 offset:51168
    v_mfma_f32_16x16x32_bf16 v[240:243], a[224:227], v[120:123], v[240:243]
    s_mov_b32 s54, 31744
    ds_read_b64_tr_b16 a[254:255], v4 offset:51680
    ds_read_b128 v[20:23], v9 offset:2080
    v_mfma_f32_16x16x32_bf16 v[240:243], a[228:231], v[124:127], v[240:243]
    s_waitcnt vmcnt(19)
    s_barrier
    s_waitcnt lgkmcnt(10)
    buffer_load_dwordx4 v[108:111], v8, s[32:35], s54 offen
    v_mfma_f32_16x16x32_bf16 v[212:215], a[232:235], v[112:115], v[212:215]
    ds_read_b64_tr_b16 a[192:193], v3 offset:0
    v_fma_mix_f32 v32, v54, v24, v28 op_sel:[0,0,0] op_sel_hi:[1,0,0]
    v_mfma_f32_16x16x32_bf16 v[212:215], a[236:239], v[116:119], v[212:215]
    s_mov_b32 s45, 2621440
    ds_read_b64_tr_b16 a[194:195], v3 offset:512
    ds_read_b64_tr_b16 a[196:197], v3 offset:16896
    v_fma_mix_f32 v33, v54, v25, v29 op_sel:[1,0,0] op_sel_hi:[1,0,0]
    v_mfma_f32_16x16x32_bf16 v[244:247], a[232:235], v[120:123], v[244:247]
    s_add_u32 m0, s44, 67584
    ds_read_b64_tr_b16 a[198:199], v3 offset:17408
    v_fma_mix_f32 v34, v55, v26, v30 op_sel:[0,0,0] op_sel_hi:[1,0,0]
    v_mfma_f32_16x16x32_bf16 v[244:247], a[236:239], v[124:127], v[244:247]
    s_waitcnt lgkmcnt(10)
    buffer_load_dwordx4 v6, s[24:27], s45 offen lds
    v_mfma_f32_16x16x32_bf16 v[216:219], a[240:243], v[112:115], v[216:219]
    ds_read_b64_tr_b16 a[200:201], v3 offset:32
    v_fma_mix_f32 v35, v55, v27, v31 op_sel:[1,0,0] op_sel_hi:[1,0,0]
    v_mfma_f32_16x16x32_bf16 v[216:219], a[244:247], v[116:119], v[216:219]
    ds_read_b64_tr_b16 a[202:203], v3 offset:544
    v_cvt_pk_bf16_f32 v54, v32, v33
    v_cvt_pk_bf16_f32 v55, v34, v35
    v_mfma_f32_16x16x32_bf16 v[248:251], a[240:243], v[120:123], v[248:251]
    ds_read_b64_tr_b16 a[204:205], v3 offset:16928
    v_fma_mix_f32 v36, v62, v24, v28 op_sel:[0,0,0] op_sel_hi:[1,0,0]
    v_mfma_f32_16x16x32_bf16 v[248:251], a[244:247], v[124:127], v[248:251]
    s_waitcnt lgkmcnt(8)
    ds_read_b64_tr_b16 a[206:207], v3 offset:17440
    v_fma_mix_f32 v37, v62, v25, v29 op_sel:[1,0,0] op_sel_hi:[1,0,0]
    v_fma_mix_f32 v38, v63, v26, v30 op_sel:[0,0,0] op_sel_hi:[1,0,0]
    v_mfma_f32_16x16x32_bf16 v[220:223], a[248:251], v[112:115], v[220:223]
    ds_read_b64_tr_b16 a[208:209], v3 offset:64
    v_fma_mix_f32 v39, v63, v27, v31 op_sel:[1,0,0] op_sel_hi:[1,0,0]
    v_mfma_f32_16x16x32_bf16 v[220:223], a[252:255], v[116:119], v[220:223]
    s_mov_b32 s45, 2629632
    ds_read_b64_tr_b16 a[210:211], v3 offset:576
    ds_read_b64_tr_b16 a[212:213], v3 offset:16960
    v_cvt_pk_bf16_f32 v62, v36, v37
    v_mfma_f32_16x16x32_bf16 v[252:255], a[248:251], v[120:123], v[252:255]
    s_add_u32 m0, s44, 68640
    ds_read_b64_tr_b16 a[214:215], v3 offset:17472
    v_cvt_pk_bf16_f32 v63, v38, v39
    v_mfma_f32_16x16x32_bf16 v[252:255], a[252:255], v[124:127], v[252:255]
    s_waitcnt lgkmcnt(8)
    buffer_load_dwordx4 v6, s[24:27], s45 offen lds
    v_mfma_f32_16x16x32_bf16 v[128:131], a[192:195], v[48:51], v[128:131]
    s_waitcnt vmcnt(18)
    ds_read_b64_tr_b16 a[216:217], v3 offset:96
    ds_read_b128 v[24:27], v9 offset:2064
    v_mfma_f32_16x16x32_bf16 v[128:131], a[196:199], v[52:55], v[128:131]
    ds_read_b64_tr_b16 a[218:219], v3 offset:608
    ds_read_b64_tr_b16 a[220:221], v3 offset:16992
    v_mfma_f32_16x16x32_bf16 v[160:163], a[192:195], v[56:59], v[160:163]
    s_mov_b32 s54, 14336
    ds_read_b64_tr_b16 a[222:223], v3 offset:17504
    ds_read_b128 v[28:31], v9 offset:2096
    v_mfma_f32_16x16x32_bf16 v[160:163], a[196:199], v[60:63], v[160:163]
    s_waitcnt lgkmcnt(10)
    buffer_load_dwordx4 v[112:115], v8, s[32:35], s54 offen
    v_mfma_f32_16x16x32_bf16 v[132:135], a[200:203], v[48:51], v[132:135]
    ds_read_b64_tr_b16 a[224:225], v3 offset:128
    v_fma_mix_f32 v32, v64, v16, v20 op_sel:[0,0,0] op_sel_hi:[1,0,0]
    v_mfma_f32_16x16x32_bf16 v[132:135], a[204:207], v[52:55], v[132:135]
    s_mov_b32 s45, 2637824
    ds_read_b64_tr_b16 a[226:227], v3 offset:640
    ds_read_b64_tr_b16 a[228:229], v3 offset:17024
    v_fma_mix_f32 v33, v64, v17, v21 op_sel:[1,0,0] op_sel_hi:[1,0,0]
    v_mfma_f32_16x16x32_bf16 v[164:167], a[200:203], v[56:59], v[164:167]
    s_add_u32 m0, s44, 69696
    ds_read_b64_tr_b16 a[230:231], v3 offset:17536
    v_fma_mix_f32 v34, v65, v18, v22 op_sel:[0,0,0] op_sel_hi:[1,0,0]
    v_mfma_f32_16x16x32_bf16 v[164:167], a[204:207], v[60:63], v[164:167]
    s_waitcnt lgkmcnt(10)
    buffer_load_dwordx4 v6, s[24:27], s45 offen lds
    v_mfma_f32_16x16x32_bf16 v[136:139], a[208:211], v[48:51], v[136:139]
    ds_read_b64_tr_b16 a[232:233], v3 offset:160
    v_fma_mix_f32 v35, v65, v19, v23 op_sel:[1,0,0] op_sel_hi:[1,0,0]
    v_mfma_f32_16x16x32_bf16 v[136:139], a[212:215], v[52:55], v[136:139]
    ds_read_b64_tr_b16 a[234:235], v3 offset:672
    v_cvt_pk_bf16_f32 v64, v32, v33
    v_cvt_pk_bf16_f32 v65, v34, v35
    v_mfma_f32_16x16x32_bf16 v[168:171], a[208:211], v[56:59], v[168:171]
    ds_read_b64_tr_b16 a[236:237], v3 offset:17056
    v_fma_mix_f32 v36, v72, v16, v20 op_sel:[0,0,0] op_sel_hi:[1,0,0]
    v_mfma_f32_16x16x32_bf16 v[168:171], a[212:215], v[60:63], v[168:171]
    s_waitcnt lgkmcnt(8)
    ds_read_b64_tr_b16 a[238:239], v3 offset:17568
    v_fma_mix_f32 v37, v72, v17, v21 op_sel:[1,0,0] op_sel_hi:[1,0,0]
    v_fma_mix_f32 v38, v73, v18, v22 op_sel:[0,0,0] op_sel_hi:[1,0,0]
    v_mfma_f32_16x16x32_bf16 v[140:143], a[216:219], v[48:51], v[140:143]
    ds_read_b64_tr_b16 a[240:241], v3 offset:192
    v_fma_mix_f32 v39, v73, v19, v23 op_sel:[1,0,0] op_sel_hi:[1,0,0]
    v_mfma_f32_16x16x32_bf16 v[140:143], a[220:223], v[52:55], v[140:143]
    s_mov_b32 s45, 2646016
    ds_read_b64_tr_b16 a[242:243], v3 offset:704
    ds_read_b64_tr_b16 a[244:245], v3 offset:17088
    v_cvt_pk_bf16_f32 v72, v36, v37
    v_mfma_f32_16x16x32_bf16 v[172:175], a[216:219], v[56:59], v[172:175]
    s_add_u32 m0, s44, 70752
    ds_read_b64_tr_b16 a[246:247], v3 offset:17600
    v_cvt_pk_bf16_f32 v73, v38, v39
    v_mfma_f32_16x16x32_bf16 v[172:175], a[220:223], v[60:63], v[172:175]
    s_waitcnt lgkmcnt(8)
    buffer_load_dwordx4 v6, s[24:27], s45 offen lds
    v_mfma_f32_16x16x32_bf16 v[144:147], a[224:227], v[48:51], v[144:147]
    ds_read_b64_tr_b16 a[248:249], v3 offset:224
    ds_read_b128 v[16:19], v9 offset:2304
    v_mfma_f32_16x16x32_bf16 v[144:147], a[228:231], v[52:55], v[144:147]
    ds_read_b64_tr_b16 a[250:251], v3 offset:736
    ds_read_b64_tr_b16 a[252:253], v3 offset:17120
    v_mfma_f32_16x16x32_bf16 v[176:179], a[224:227], v[56:59], v[176:179]
    s_mov_b32 s54, 15360
    ds_read_b64_tr_b16 a[254:255], v3 offset:17632
    ds_read_b128 v[20:23], v9 offset:2336
    v_mfma_f32_16x16x32_bf16 v[176:179], a[228:231], v[60:63], v[176:179]
    s_waitcnt lgkmcnt(10)
    buffer_load_dwordx4 v[116:119], v8, s[32:35], s54 offen
    v_mfma_f32_16x16x32_bf16 v[148:151], a[232:235], v[48:51], v[148:151]
    ds_read_b64_tr_b16 a[192:193], v3 offset:256
    v_fma_mix_f32 v32, v66, v24, v28 op_sel:[0,0,0] op_sel_hi:[1,0,0]
    v_mfma_f32_16x16x32_bf16 v[148:151], a[236:239], v[52:55], v[148:151]
    s_mov_b32 s45, 2883584
    ds_read_b64_tr_b16 a[194:195], v3 offset:768
    ds_read_b64_tr_b16 a[196:197], v3 offset:17152
    v_fma_mix_f32 v33, v66, v25, v29 op_sel:[1,0,0] op_sel_hi:[1,0,0]
    v_mfma_f32_16x16x32_bf16 v[180:183], a[232:235], v[56:59], v[180:183]
    s_add_u32 m0, s44, 84480
    ds_read_b64_tr_b16 a[198:199], v3 offset:17664
    v_fma_mix_f32 v34, v67, v26, v30 op_sel:[0,0,0] op_sel_hi:[1,0,0]
    v_mfma_f32_16x16x32_bf16 v[180:183], a[236:239], v[60:63], v[180:183]
    s_waitcnt lgkmcnt(10)
    buffer_load_dwordx4 v6, s[24:27], s45 offen lds
    v_mfma_f32_16x16x32_bf16 v[152:155], a[240:243], v[48:51], v[152:155]
    ds_read_b64_tr_b16 a[200:201], v3 offset:288
    v_fma_mix_f32 v35, v67, v27, v31 op_sel:[1,0,0] op_sel_hi:[1,0,0]
    v_mfma_f32_16x16x32_bf16 v[152:155], a[244:247], v[52:55], v[152:155]
    ds_read_b64_tr_b16 a[202:203], v3 offset:800
    v_cvt_pk_bf16_f32 v66, v32, v33
    v_cvt_pk_bf16_f32 v67, v34, v35
    v_mfma_f32_16x16x32_bf16 v[184:187], a[240:243], v[56:59], v[184:187]
    ds_read_b64_tr_b16 a[204:205], v3 offset:17184
    v_fma_mix_f32 v36, v74, v24, v28 op_sel:[0,0,0] op_sel_hi:[1,0,0]
    v_mfma_f32_16x16x32_bf16 v[184:187], a[244:247], v[60:63], v[184:187]
    s_waitcnt lgkmcnt(8)
    ds_read_b64_tr_b16 a[206:207], v3 offset:17696
    v_fma_mix_f32 v37, v74, v25, v29 op_sel:[1,0,0] op_sel_hi:[1,0,0]
    v_fma_mix_f32 v38, v75, v26, v30 op_sel:[0,0,0] op_sel_hi:[1,0,0]
    v_mfma_f32_16x16x32_bf16 v[156:159], a[248:251], v[48:51], v[156:159]
    ds_read_b64_tr_b16 a[208:209], v3 offset:320
    v_fma_mix_f32 v39, v75, v27, v31 op_sel:[1,0,0] op_sel_hi:[1,0,0]
    v_mfma_f32_16x16x32_bf16 v[156:159], a[252:255], v[52:55], v[156:159]
    s_mov_b32 s45, 2891776
    ds_read_b64_tr_b16 a[210:211], v3 offset:832
    ds_read_b64_tr_b16 a[212:213], v3 offset:17216
    v_cvt_pk_bf16_f32 v74, v36, v37
    v_mfma_f32_16x16x32_bf16 v[188:191], a[248:251], v[56:59], v[188:191]
    s_add_u32 m0, s44, 85536
    ds_read_b64_tr_b16 a[214:215], v3 offset:17728
    v_cvt_pk_bf16_f32 v75, v38, v39
    v_mfma_f32_16x16x32_bf16 v[188:191], a[252:255], v[60:63], v[188:191]
    s_waitcnt lgkmcnt(8)
    buffer_load_dwordx4 v6, s[24:27], s45 offen lds
    v_mfma_f32_16x16x32_bf16 v[192:195], a[192:195], v[48:51], v[192:195]
    ds_read_b64_tr_b16 a[216:217], v3 offset:352
    ds_read_b128 v[24:27], v9 offset:2320
    v_mfma_f32_16x16x32_bf16 v[192:195], a[196:199], v[52:55], v[192:195]
    ds_read_b64_tr_b16 a[218:219], v3 offset:864
    ds_read_b64_tr_b16 a[220:221], v3 offset:17248
    v_mfma_f32_16x16x32_bf16 v[224:227], a[192:195], v[56:59], v[224:227]
    s_mov_b32 s54, 32768
    ds_read_b64_tr_b16 a[222:223], v3 offset:17760
    ds_read_b128 v[28:31], v9 offset:2352
    v_mfma_f32_16x16x32_bf16 v[224:227], a[196:199], v[60:63], v[224:227]
    s_waitcnt lgkmcnt(10)
    buffer_load_dwordx4 v[120:123], v8, s[32:35], s54 offen
    v_mfma_f32_16x16x32_bf16 v[196:199], a[200:203], v[48:51], v[196:199]
    ds_read_b64_tr_b16 a[224:225], v3 offset:384
    v_fma_mix_f32 v32, v68, v16, v20 op_sel:[0,0,0] op_sel_hi:[1,0,0]
    v_mfma_f32_16x16x32_bf16 v[196:199], a[204:207], v[52:55], v[196:199]
    s_mov_b32 s45, 2899968
    ds_read_b64_tr_b16 a[226:227], v3 offset:896
    ds_read_b64_tr_b16 a[228:229], v3 offset:17280
    v_fma_mix_f32 v33, v68, v17, v21 op_sel:[1,0,0] op_sel_hi:[1,0,0]
    v_mfma_f32_16x16x32_bf16 v[228:231], a[200:203], v[56:59], v[228:231]
    s_add_u32 m0, s44, 86592
    ds_read_b64_tr_b16 a[230:231], v3 offset:17792
    v_fma_mix_f32 v34, v69, v18, v22 op_sel:[0,0,0] op_sel_hi:[1,0,0]
    v_mfma_f32_16x16x32_bf16 v[228:231], a[204:207], v[60:63], v[228:231]
    s_waitcnt lgkmcnt(10)
    buffer_load_dwordx4 v6, s[24:27], s45 offen lds
    v_mfma_f32_16x16x32_bf16 v[200:203], a[208:211], v[48:51], v[200:203]
    ds_read_b64_tr_b16 a[232:233], v3 offset:416
    v_fma_mix_f32 v35, v69, v19, v23 op_sel:[1,0,0] op_sel_hi:[1,0,0]
    v_mfma_f32_16x16x32_bf16 v[200:203], a[212:215], v[52:55], v[200:203]
    ds_read_b64_tr_b16 a[234:235], v3 offset:928
    v_cvt_pk_bf16_f32 v68, v32, v33
    v_cvt_pk_bf16_f32 v69, v34, v35
    v_mfma_f32_16x16x32_bf16 v[232:235], a[208:211], v[56:59], v[232:235]
    ds_read_b64_tr_b16 a[236:237], v3 offset:17312
    v_fma_mix_f32 v36, v76, v16, v20 op_sel:[0,0,0] op_sel_hi:[1,0,0]
    v_mfma_f32_16x16x32_bf16 v[232:235], a[212:215], v[60:63], v[232:235]
    s_waitcnt lgkmcnt(8)
    ds_read_b64_tr_b16 a[238:239], v3 offset:17824
    v_fma_mix_f32 v37, v76, v17, v21 op_sel:[1,0,0] op_sel_hi:[1,0,0]
    v_fma_mix_f32 v38, v77, v18, v22 op_sel:[0,0,0] op_sel_hi:[1,0,0]
    v_mfma_f32_16x16x32_bf16 v[204:207], a[216:219], v[48:51], v[204:207]
    ds_read_b64_tr_b16 a[240:241], v3 offset:448
    v_fma_mix_f32 v39, v77, v19, v23 op_sel:[1,0,0] op_sel_hi:[1,0,0]
    v_mfma_f32_16x16x32_bf16 v[204:207], a[220:223], v[52:55], v[204:207]
    s_mov_b32 s45, 2908160
    ds_read_b64_tr_b16 a[242:243], v3 offset:960
    ds_read_b64_tr_b16 a[244:245], v3 offset:17344
    v_cvt_pk_bf16_f32 v76, v36, v37
    v_mfma_f32_16x16x32_bf16 v[236:239], a[216:219], v[56:59], v[236:239]
    s_add_u32 m0, s44, 87648
    ds_read_b64_tr_b16 a[246:247], v3 offset:17856
    v_cvt_pk_bf16_f32 v77, v38, v39
    v_mfma_f32_16x16x32_bf16 v[236:239], a[220:223], v[60:63], v[236:239]
    s_waitcnt lgkmcnt(8)
    buffer_load_dwordx4 v6, s[24:27], s45 offen lds
    v_mfma_f32_16x16x32_bf16 v[208:211], a[224:227], v[48:51], v[208:211]
    ds_read_b64_tr_b16 a[248:249], v3 offset:480
    ds_read_b128 v[16:19], v9 offset:2560
    v_mfma_f32_16x16x32_bf16 v[208:211], a[228:231], v[52:55], v[208:211]
    ds_read_b64_tr_b16 a[250:251], v3 offset:992
    ds_read_b64_tr_b16 a[252:253], v3 offset:17376
    v_mfma_f32_16x16x32_bf16 v[240:243], a[224:227], v[56:59], v[240:243]
    s_mov_b32 s54, 33792
    ds_read_b64_tr_b16 a[254:255], v3 offset:17888
    ds_read_b128 v[20:23], v9 offset:2592
    v_mfma_f32_16x16x32_bf16 v[240:243], a[228:231], v[60:63], v[240:243]
    s_waitcnt vmcnt(12)
    s_barrier
    s_waitcnt lgkmcnt(10)
    buffer_load_dwordx4 v[124:127], v8, s[32:35], s54 offen
    v_mfma_f32_16x16x32_bf16 v[212:215], a[232:235], v[48:51], v[212:215]
    ds_read_b64_tr_b16 a[192:193], v3 offset:33792
    v_fma_mix_f32 v32, v70, v24, v28 op_sel:[0,0,0] op_sel_hi:[1,0,0]
    v_mfma_f32_16x16x32_bf16 v[212:215], a[236:239], v[52:55], v[212:215]
    s_mov_b32 s45, 3145728
    ds_read_b64_tr_b16 a[194:195], v3 offset:34304
    ds_read_b64_tr_b16 a[196:197], v3 offset:50688
    v_fma_mix_f32 v33, v70, v25, v29 op_sel:[1,0,0] op_sel_hi:[1,0,0]
    v_mfma_f32_16x16x32_bf16 v[244:247], a[232:235], v[56:59], v[244:247]
    s_add_u32 m0, s44, 101376
    ds_read_b64_tr_b16 a[198:199], v3 offset:51200
    v_fma_mix_f32 v34, v71, v26, v30 op_sel:[0,0,0] op_sel_hi:[1,0,0]
    v_mfma_f32_16x16x32_bf16 v[244:247], a[236:239], v[60:63], v[244:247]
    s_waitcnt lgkmcnt(10)
    buffer_load_dwordx4 v6, s[24:27], s45 offen lds
    v_mfma_f32_16x16x32_bf16 v[216:219], a[240:243], v[48:51], v[216:219]
    ds_read_b64_tr_b16 a[200:201], v3 offset:33824
    v_fma_mix_f32 v35, v71, v27, v31 op_sel:[1,0,0] op_sel_hi:[1,0,0]
    v_mfma_f32_16x16x32_bf16 v[216:219], a[244:247], v[52:55], v[216:219]
    ds_read_b64_tr_b16 a[202:203], v3 offset:34336
    v_cvt_pk_bf16_f32 v70, v32, v33
    v_cvt_pk_bf16_f32 v71, v34, v35
    v_mfma_f32_16x16x32_bf16 v[248:251], a[240:243], v[56:59], v[248:251]
    ds_read_b64_tr_b16 a[204:205], v3 offset:50720
    v_fma_mix_f32 v36, v78, v24, v28 op_sel:[0,0,0] op_sel_hi:[1,0,0]
    v_mfma_f32_16x16x32_bf16 v[248:251], a[244:247], v[60:63], v[248:251]
    s_waitcnt lgkmcnt(8)
    ds_read_b64_tr_b16 a[206:207], v3 offset:51232
    v_fma_mix_f32 v37, v78, v25, v29 op_sel:[1,0,0] op_sel_hi:[1,0,0]
    v_fma_mix_f32 v38, v79, v26, v30 op_sel:[0,0,0] op_sel_hi:[1,0,0]
    v_mfma_f32_16x16x32_bf16 v[220:223], a[248:251], v[48:51], v[220:223]
    ds_read_b64_tr_b16 a[208:209], v3 offset:33856
    v_fma_mix_f32 v39, v79, v27, v31 op_sel:[1,0,0] op_sel_hi:[1,0,0]
    v_mfma_f32_16x16x32_bf16 v[220:223], a[252:255], v[52:55], v[220:223]
    s_mov_b32 s45, 3153920
    ds_read_b64_tr_b16 a[210:211], v3 offset:34368
    ds_read_b64_tr_b16 a[212:213], v3 offset:50752
    v_cvt_pk_bf16_f32 v78, v36, v37
    v_mfma_f32_16x16x32_bf16 v[252:255], a[248:251], v[56:59], v[252:255]
    s_add_u32 m0, s44, 102432
    ds_read_b64_tr_b16 a[214:215], v3 offset:51264
    v_cvt_pk_bf16_f32 v79, v38, v39
    v_mfma_f32_16x16x32_bf16 v[252:255], a[252:255], v[60:63], v[252:255]
    s_waitcnt lgkmcnt(8)
    buffer_load_dwordx4 v6, s[24:27], s45 offen lds
    v_mfma_f32_16x16x32_bf16 v[128:131], a[192:195], v[64:67], v[128:131]
    ds_read_b64_tr_b16 a[216:217], v3 offset:33888
    ds_read_b128 v[24:27], v9 offset:2576
    v_mfma_f32_16x16x32_bf16 v[128:131], a[196:199], v[68:71], v[128:131]
    ds_read_b64_tr_b16 a[218:219], v3 offset:34400
    ds_read_b64_tr_b16 a[220:221], v3 offset:50784
    v_mfma_f32_16x16x32_bf16 v[160:163], a[192:195], v[72:75], v[160:163]
    s_mov_b32 s54, 16384
    ds_read_b64_tr_b16 a[222:223], v3 offset:51296
    ds_read_b128 v[28:31], v9 offset:2608
    v_mfma_f32_16x16x32_bf16 v[160:163], a[196:199], v[76:79], v[160:163]
    s_waitcnt lgkmcnt(10)
    buffer_load_dwordx4 v[48:51], v8, s[32:35], s54 offen
    v_mfma_f32_16x16x32_bf16 v[132:135], a[200:203], v[64:67], v[132:135]
    ds_read_b64_tr_b16 a[224:225], v3 offset:33920
    v_fma_mix_f32 v32, v80, v16, v20 op_sel:[0,0,0] op_sel_hi:[1,0,0]
    v_mfma_f32_16x16x32_bf16 v[132:135], a[204:207], v[68:71], v[132:135]
    s_mov_b32 s45, 3162112
    ds_read_b64_tr_b16 a[226:227], v3 offset:34432
    ds_read_b64_tr_b16 a[228:229], v3 offset:50816
    v_fma_mix_f32 v33, v80, v17, v21 op_sel:[1,0,0] op_sel_hi:[1,0,0]
    v_mfma_f32_16x16x32_bf16 v[164:167], a[200:203], v[72:75], v[164:167]
    s_add_u32 m0, s44, 103488
    ds_read_b64_tr_b16 a[230:231], v3 offset:51328
    v_fma_mix_f32 v34, v81, v18, v22 op_sel:[0,0,0] op_sel_hi:[1,0,0]
    v_mfma_f32_16x16x32_bf16 v[164:167], a[204:207], v[76:79], v[164:167]
    s_waitcnt lgkmcnt(10)
    buffer_load_dwordx4 v6, s[24:27], s45 offen lds
    v_mfma_f32_16x16x32_bf16 v[136:139], a[208:211], v[64:67], v[136:139]
    ds_read_b64_tr_b16 a[232:233], v3 offset:33952
    v_fma_mix_f32 v35, v81, v19, v23 op_sel:[1,0,0] op_sel_hi:[1,0,0]
    v_mfma_f32_16x16x32_bf16 v[136:139], a[212:215], v[68:71], v[136:139]
    ds_read_b64_tr_b16 a[234:235], v3 offset:34464
    v_cvt_pk_bf16_f32 v80, v32, v33
    v_cvt_pk_bf16_f32 v81, v34, v35
    v_mfma_f32_16x16x32_bf16 v[168:171], a[208:211], v[72:75], v[168:171]
    ds_read_b64_tr_b16 a[236:237], v3 offset:50848
    v_fma_mix_f32 v36, v88, v16, v20 op_sel:[0,0,0] op_sel_hi:[1,0,0]
    v_mfma_f32_16x16x32_bf16 v[168:171], a[212:215], v[76:79], v[168:171]
    s_waitcnt lgkmcnt(8)
    ds_read_b64_tr_b16 a[238:239], v3 offset:51360
    v_fma_mix_f32 v37, v88, v17, v21 op_sel:[1,0,0] op_sel_hi:[1,0,0]
    v_fma_mix_f32 v38, v89, v18, v22 op_sel:[0,0,0] op_sel_hi:[1,0,0]
    v_mfma_f32_16x16x32_bf16 v[140:143], a[216:219], v[64:67], v[140:143]
    ds_read_b64_tr_b16 a[240:241], v3 offset:33984
    v_fma_mix_f32 v39, v89, v19, v23 op_sel:[1,0,0] op_sel_hi:[1,0,0]
    v_mfma_f32_16x16x32_bf16 v[140:143], a[220:223], v[68:71], v[140:143]
    s_mov_b32 s45, 3170304
    ds_read_b64_tr_b16 a[242:243], v3 offset:34496
    ds_read_b64_tr_b16 a[244:245], v3 offset:50880
    v_cvt_pk_bf16_f32 v88, v36, v37
    v_mfma_f32_16x16x32_bf16 v[172:175], a[216:219], v[72:75], v[172:175]
    s_add_u32 m0, s44, 104544
    ds_read_b64_tr_b16 a[246:247], v3 offset:51392
    v_cvt_pk_bf16_f32 v89, v38, v39
    v_mfma_f32_16x16x32_bf16 v[172:175], a[220:223], v[76:79], v[172:175]
    s_waitcnt lgkmcnt(8)
    buffer_load_dwordx4 v6, s[24:27], s45 offen lds
    v_mfma_f32_16x16x32_bf16 v[144:147], a[224:227], v[64:67], v[144:147]
    ds_read_b64_tr_b16 a[248:249], v3 offset:34016
    ds_read_b128 v[16:19], v9 offset:2816
    v_mfma_f32_16x16x32_bf16 v[144:147], a[228:231], v[68:71], v[144:147]
    ds_read_b64_tr_b16 a[250:251], v3 offset:34528
    ds_read_b64_tr_b16 a[252:253], v3 offset:50912
    v_mfma_f32_16x16x32_bf16 v[176:179], a[224:227], v[72:75], v[176:179]
    s_mov_b32 s54, 17408
    ds_read_b64_tr_b16 a[254:255], v3 offset:51424
    ds_read_b128 v[20:23], v9 offset:2848
    v_mfma_f32_16x16x32_bf16 v[176:179], a[228:231], v[76:79], v[176:179]
    s_waitcnt lgkmcnt(10)
    buffer_load_dwordx4 v[52:55], v8, s[32:35], s54 offen
    v_mfma_f32_16x16x32_bf16 v[148:151], a[232:235], v[64:67], v[148:151]
    ds_read_b64_tr_b16 a[192:193], v3 offset:34048
    v_fma_mix_f32 v32, v82, v24, v28 op_sel:[0,0,0] op_sel_hi:[1,0,0]
    v_mfma_f32_16x16x32_bf16 v[148:151], a[236:239], v[68:71], v[148:151]
    s_mov_b32 s45, 3407872
    ds_read_b64_tr_b16 a[194:195], v3 offset:34560
    ds_read_b64_tr_b16 a[196:197], v3 offset:50944
    v_fma_mix_f32 v33, v82, v25, v29 op_sel:[1,0,0] op_sel_hi:[1,0,0]
    v_mfma_f32_16x16x32_bf16 v[180:183], a[232:235], v[72:75], v[180:183]
    s_add_u32 m0, s44, 118272
    ds_read_b64_tr_b16 a[198:199], v3 offset:51456
    v_fma_mix_f32 v34, v83, v26, v30 op_sel:[0,0,0] op_sel_hi:[1,0,0]
    v_mfma_f32_16x16x32_bf16 v[180:183], a[236:239], v[76:79], v[180:183]
    s_waitcnt lgkmcnt(10)
    buffer_load_dwordx4 v6, s[24:27], s45 offen lds
    v_mfma_f32_16x16x32_bf16 v[152:155], a[240:243], v[64:67], v[152:155]
    ds_read_b64_tr_b16 a[200:201], v3 offset:34080
    v_fma_mix_f32 v35, v83, v27, v31 op_sel:[1,0,0] op_sel_hi:[1,0,0]
    v_mfma_f32_16x16x32_bf16 v[152:155], a[244:247], v[68:71], v[152:155]
    ds_read_b64_tr_b16 a[202:203], v3 offset:34592
    v_cvt_pk_bf16_f32 v82, v32, v33
    v_cvt_pk_bf16_f32 v83, v34, v35
    v_mfma_f32_16x16x32_bf16 v[184:187], a[240:243], v[72:75], v[184:187]
    ds_read_b64_tr_b16 a[204:205], v3 offset:50976
    v_fma_mix_f32 v36, v90, v24, v28 op_sel:[0,0,0] op_sel_hi:[1,0,0]
    v_mfma_f32_16x16x32_bf16 v[184:187], a[244:247], v[76:79], v[184:187]
    s_waitcnt lgkmcnt(8)
    ds_read_b64_tr_b16 a[206:207], v3 offset:51488
    v_fma_mix_f32 v37, v90, v25, v29 op_sel:[1,0,0] op_sel_hi:[1,0,0]
    v_fma_mix_f32 v38, v91, v26, v30 op_sel:[0,0,0] op_sel_hi:[1,0,0]
    v_mfma_f32_16x16x32_bf16 v[156:159], a[248:251], v[64:67], v[156:159]
    ds_read_b64_tr_b16 a[208:209], v3 offset:34112
    v_fma_mix_f32 v39, v91, v27, v31 op_sel:[1,0,0] op_sel_hi:[1,0,0]
    v_mfma_f32_16x16x32_bf16 v[156:159], a[252:255], v[68:71], v[156:159]
    s_mov_b32 s45, 3416064
    ds_read_b64_tr_b16 a[210:211], v3 offset:34624
    ds_read_b64_tr_b16 a[212:213], v3 offset:51008
    v_cvt_pk_bf16_f32 v90, v36, v37
    v_mfma_f32_16x16x32_bf16 v[188:191], a[248:251], v[72:75], v[188:191]
    s_add_u32 m0, s44, 119328
    ds_read_b64_tr_b16 a[214:215], v3 offset:51520
    v_cvt_pk_bf16_f32 v91, v38, v39
    v_mfma_f32_16x16x32_bf16 v[188:191], a[252:255], v[76:79], v[188:191]
    s_waitcnt lgkmcnt(8)
    buffer_load_dwordx4 v6, s[24:27], s45 offen lds
    v_mfma_f32_16x16x32_bf16 v[192:195], a[192:195], v[64:67], v[192:195]
    ds_read_b64_tr_b16 a[216:217], v3 offset:34144
    ds_read_b128 v[24:27], v9 offset:2832
    v_mfma_f32_16x16x32_bf16 v[192:195], a[196:199], v[68:71], v[192:195]
    ds_read_b64_tr_b16 a[218:219], v3 offset:34656
    ds_read_b64_tr_b16 a[220:221], v3 offset:51040
    v_mfma_f32_16x16x32_bf16 v[224:227], a[192:195], v[72:75], v[224:227]
    s_mov_b32 s54, 34816
    ds_read_b64_tr_b16 a[222:223], v3 offset:51552
    ds_read_b128 v[28:31], v9 offset:2864
    v_mfma_f32_16x16x32_bf16 v[224:227], a[196:199], v[76:79], v[224:227]
    s_waitcnt lgkmcnt(10)
    buffer_load_dwordx4 v[56:59], v8, s[32:35], s54 offen
    v_mfma_f32_16x16x32_bf16 v[196:199], a[200:203], v[64:67], v[196:199]
    ds_read_b64_tr_b16 a[224:225], v3 offset:34176
    v_fma_mix_f32 v32, v84, v16, v20 op_sel:[0,0,0] op_sel_hi:[1,0,0]
    v_mfma_f32_16x16x32_bf16 v[196:199], a[204:207], v[68:71], v[196:199]
    s_mov_b32 s45, 3424256
    ds_read_b64_tr_b16 a[226:227], v3 offset:34688
    ds_read_b64_tr_b16 a[228:229], v3 offset:51072
    v_fma_mix_f32 v33, v84, v17, v21 op_sel:[1,0,0] op_sel_hi:[1,0,0]
    v_mfma_f32_16x16x32_bf16 v[228:231], a[200:203], v[72:75], v[228:231]
    s_add_u32 m0, s44, 120384
    ds_read_b64_tr_b16 a[230:231], v3 offset:51584
    v_fma_mix_f32 v34, v85, v18, v22 op_sel:[0,0,0] op_sel_hi:[1,0,0]
    v_mfma_f32_16x16x32_bf16 v[228:231], a[204:207], v[76:79], v[228:231]
    s_waitcnt lgkmcnt(10)
    buffer_load_dwordx4 v6, s[24:27], s45 offen lds
    v_mfma_f32_16x16x32_bf16 v[200:203], a[208:211], v[64:67], v[200:203]
    ds_read_b64_tr_b16 a[232:233], v3 offset:34208
    v_fma_mix_f32 v35, v85, v19, v23 op_sel:[1,0,0] op_sel_hi:[1,0,0]
    v_mfma_f32_16x16x32_bf16 v[200:203], a[212:215], v[68:71], v[200:203]
    ds_read_b64_tr_b16 a[234:235], v3 offset:34720
    v_cvt_pk_bf16_f32 v84, v32, v33
    v_cvt_pk_bf16_f32 v85, v34, v35
    v_mfma_f32_16x16x32_bf16 v[232:235], a[208:211], v[72:75], v[232:235]
    ds_read_b64_tr_b16 a[236:237], v3 offset:51104
    v_fma_mix_f32 v36, v92, v16, v20 op_sel:[0,0,0] op_sel_hi:[1,0,0]
    v_mfma_f32_16x16x32_bf16 v[232:235], a[212:215], v[76:79], v[232:235]
    s_waitcnt lgkmcnt(8)
    ds_read_b64_tr_b16 a[238:239], v3 offset:51616
    v_fma_mix_f32 v37, v92, v17, v21 op_sel:[1,0,0] op_sel_hi:[1,0,0]
    v_fma_mix_f32 v38, v93, v18, v22 op_sel:[0,0,0] op_sel_hi:[1,0,0]
    v_mfma_f32_16x16x32_bf16 v[204:207], a[216:219], v[64:67], v[204:207]
    ds_read_b64_tr_b16 a[240:241], v3 offset:34240
    v_fma_mix_f32 v39, v93, v19, v23 op_sel:[1,0,0] op_sel_hi:[1,0,0]
    v_mfma_f32_16x16x32_bf16 v[204:207], a[220:223], v[68:71], v[204:207]
    s_mov_b32 s45, 3432448
    ds_read_b64_tr_b16 a[242:243], v3 offset:34752
    ds_read_b64_tr_b16 a[244:245], v3 offset:51136
    v_cvt_pk_bf16_f32 v92, v36, v37
    v_mfma_f32_16x16x32_bf16 v[236:239], a[216:219], v[72:75], v[236:239]
    s_add_u32 m0, s44, 121440
    ds_read_b64_tr_b16 a[246:247], v3 offset:51648
    v_cvt_pk_bf16_f32 v93, v38, v39
    v_mfma_f32_16x16x32_bf16 v[236:239], a[220:223], v[76:79], v[236:239]
    s_waitcnt lgkmcnt(8)
    buffer_load_dwordx4 v6, s[24:27], s45 offen lds
    v_mfma_f32_16x16x32_bf16 v[208:211], a[224:227], v[64:67], v[208:211]
    ds_read_b64_tr_b16 a[248:249], v3 offset:34272
    ds_read_b128 v[16:19], v9 offset:3072
    v_mfma_f32_16x16x32_bf16 v[208:211], a[228:231], v[68:71], v[208:211]
    ds_read_b64_tr_b16 a[250:251], v3 offset:34784
    ds_read_b64_tr_b16 a[252:253], v3 offset:51168
    v_mfma_f32_16x16x32_bf16 v[240:243], a[224:227], v[72:75], v[240:243]
    s_mov_b32 s54, 35840
    ds_read_b64_tr_b16 a[254:255], v3 offset:51680
    ds_read_b128 v[20:23], v9 offset:3104
    v_mfma_f32_16x16x32_bf16 v[240:243], a[228:231], v[76:79], v[240:243]
    s_waitcnt vmcnt(12)
    s_barrier
    s_waitcnt lgkmcnt(10)
    buffer_load_dwordx4 v[60:63], v8, s[32:35], s54 offen
    v_mfma_f32_16x16x32_bf16 v[212:215], a[232:235], v[64:67], v[212:215]
    ds_read_b64_tr_b16 a[192:193], v4 offset:0
    v_fma_mix_f32 v32, v86, v24, v28 op_sel:[0,0,0] op_sel_hi:[1,0,0]
    v_mfma_f32_16x16x32_bf16 v[212:215], a[236:239], v[68:71], v[212:215]
    s_mov_b32 s45, 3670016
    ds_read_b64_tr_b16 a[194:195], v4 offset:512
    ds_read_b64_tr_b16 a[196:197], v4 offset:16896
    v_fma_mix_f32 v33, v86, v25, v29 op_sel:[1,0,0] op_sel_hi:[1,0,0]
    v_mfma_f32_16x16x32_bf16 v[244:247], a[232:235], v[72:75], v[244:247]
    s_add_u32 m0, s44, 0
    ds_read_b64_tr_b16 a[198:199], v4 offset:17408
    v_fma_mix_f32 v34, v87, v26, v30 op_sel:[0,0,0] op_sel_hi:[1,0,0]
    v_mfma_f32_16x16x32_bf16 v[244:247], a[236:239], v[76:79], v[244:247]
    s_waitcnt lgkmcnt(10)
    buffer_load_dwordx4 v6, s[24:27], s45 offen lds
    v_mfma_f32_16x16x32_bf16 v[216:219], a[240:243], v[64:67], v[216:219]
    ds_read_b64_tr_b16 a[200:201], v4 offset:32
    v_fma_mix_f32 v35, v87, v27, v31 op_sel:[1,0,0] op_sel_hi:[1,0,0]
    v_mfma_f32_16x16x32_bf16 v[216:219], a[244:247], v[68:71], v[216:219]
    ds_read_b64_tr_b16 a[202:203], v4 offset:544
    v_cvt_pk_bf16_f32 v86, v32, v33
    v_cvt_pk_bf16_f32 v87, v34, v35
    v_mfma_f32_16x16x32_bf16 v[248:251], a[240:243], v[72:75], v[248:251]
    ds_read_b64_tr_b16 a[204:205], v4 offset:16928
    v_fma_mix_f32 v36, v94, v24, v28 op_sel:[0,0,0] op_sel_hi:[1,0,0]
    v_mfma_f32_16x16x32_bf16 v[248:251], a[244:247], v[76:79], v[248:251]
    s_waitcnt lgkmcnt(8)
    ds_read_b64_tr_b16 a[206:207], v4 offset:17440
    v_fma_mix_f32 v37, v94, v25, v29 op_sel:[1,0,0] op_sel_hi:[1,0,0]
    v_fma_mix_f32 v38, v95, v26, v30 op_sel:[0,0,0] op_sel_hi:[1,0,0]
    v_mfma_f32_16x16x32_bf16 v[220:223], a[248:251], v[64:67], v[220:223]
    ds_read_b64_tr_b16 a[208:209], v4 offset:64
    v_fma_mix_f32 v39, v95, v27, v31 op_sel:[1,0,0] op_sel_hi:[1,0,0]
    v_mfma_f32_16x16x32_bf16 v[220:223], a[252:255], v[68:71], v[220:223]
    s_mov_b32 s45, 3678208
    ds_read_b64_tr_b16 a[210:211], v4 offset:576
    ds_read_b64_tr_b16 a[212:213], v4 offset:16960
    v_cvt_pk_bf16_f32 v94, v36, v37
    v_mfma_f32_16x16x32_bf16 v[252:255], a[248:251], v[72:75], v[252:255]
    s_add_u32 m0, s44, 1056
    ds_read_b64_tr_b16 a[214:215], v4 offset:17472
    v_cvt_pk_bf16_f32 v95, v38, v39
    v_mfma_f32_16x16x32_bf16 v[252:255], a[252:255], v[76:79], v[252:255]
    s_waitcnt lgkmcnt(8)
    buffer_load_dwordx4 v6, s[24:27], s45 offen lds
    v_mfma_f32_16x16x32_bf16 v[128:131], a[192:195], v[80:83], v[128:131]
    ds_read_b64_tr_b16 a[216:217], v4 offset:96
    ds_read_b128 v[24:27], v9 offset:3088
    v_mfma_f32_16x16x32_bf16 v[128:131], a[196:199], v[84:87], v[128:131]
    ds_read_b64_tr_b16 a[218:219], v4 offset:608
    ds_read_b128 v[28:31], v9 offset:3120
    v_mfma_f32_16x16x32_bf16 v[160:163], a[192:195], v[88:91], v[160:163]
    ds_read_b64_tr_b16 a[220:221], v4 offset:16992
    v_fma_mix_f32 v32, v96, v16, v20 op_sel:[0,0,0] op_sel_hi:[1,0,0]
    v_mfma_f32_16x16x32_bf16 v[160:163], a[196:199], v[92:95], v[160:163]
    s_waitcnt lgkmcnt(9)
    ds_read_b64_tr_b16 a[222:223], v4 offset:17504
    v_fma_mix_f32 v33, v96, v17, v21 op_sel:[1,0,0] op_sel_hi:[1,0,0]
    v_mfma_f32_16x16x32_bf16 v[132:135], a[200:203], v[80:83], v[132:135]
    ds_read_b64_tr_b16 a[224:225], v4 offset:128
    v_fma_mix_f32 v34, v97, v18, v22 op_sel:[0,0,0] op_sel_hi:[1,0,0]
    v_mfma_f32_16x16x32_bf16 v[132:135], a[204:207], v[84:87], v[132:135]
    s_mov_b32 s45, 3686400
    ds_read_b64_tr_b16 a[226:227], v4 offset:640
    ds_read_b64_tr_b16 a[228:229], v4 offset:17024
    v_mfma_f32_16x16x32_bf16 v[164:167], a[200:203], v[88:91], v[164:167]
    s_add_u32 m0, s44, 2112
    ds_read_b64_tr_b16 a[230:231], v4 offset:17536
    v_fma_mix_f32 v35, v97, v19, v23 op_sel:[1,0,0] op_sel_hi:[1,0,0]
    v_mfma_f32_16x16x32_bf16 v[164:167], a[204:207], v[92:95], v[164:167]
    s_waitcnt lgkmcnt(10)
    buffer_load_dwordx4 v6, s[24:27], s45 offen lds
    v_mfma_f32_16x16x32_bf16 v[136:139], a[208:211], v[80:83], v[136:139]
    ds_read_b64_tr_b16 a[232:233], v4 offset:160
    v_cvt_pk_bf16_f32 v96, v32, v33
    v_mfma_f32_16x16x32_bf16 v[136:139], a[212:215], v[84:87], v[136:139]
    ds_read_b64_tr_b16 a[234:235], v4 offset:672
    v_cvt_pk_bf16_f32 v97, v34, v35
    v_mfma_f32_16x16x32_bf16 v[168:171], a[208:211], v[88:91], v[168:171]
    ds_read_b64_tr_b16 a[236:237], v4 offset:17056
    v_fma_mix_f32 v36, v104, v16, v20 op_sel:[0,0,0] op_sel_hi:[1,0,0]
    v_mfma_f32_16x16x32_bf16 v[168:171], a[212:215], v[92:95], v[168:171]
    s_waitcnt lgkmcnt(7)
    ds_read_b64_tr_b16 a[238:239], v4 offset:17568
    v_fma_mix_f32 v37, v104, v17, v21 op_sel:[1,0,0] op_sel_hi:[1,0,0]
    v_fma_mix_f32 v38, v105, v18, v22 op_sel:[0,0,0] op_sel_hi:[1,0,0]
    v_mfma_f32_16x16x32_bf16 v[140:143], a[216:219], v[80:83], v[140:143]
    ds_read_b64_tr_b16 a[240:241], v4 offset:192
    v_fma_mix_f32 v39, v105, v19, v23 op_sel:[1,0,0] op_sel_hi:[1,0,0]
    v_mfma_f32_16x16x32_bf16 v[140:143], a[220:223], v[84:87], v[140:143]
    s_mov_b32 s45, 3694592
    ds_read_b64_tr_b16 a[242:243], v4 offset:704
    ds_read_b64_tr_b16 a[244:245], v4 offset:17088
    v_cvt_pk_bf16_f32 v104, v36, v37
    v_mfma_f32_16x16x32_bf16 v[172:175], a[216:219], v[88:91], v[172:175]
    s_add_u32 m0, s44, 3168
    ds_read_b64_tr_b16 a[246:247], v4 offset:17600
    v_cvt_pk_bf16_f32 v105, v38, v39
    v_mfma_f32_16x16x32_bf16 v[172:175], a[220:223], v[92:95], v[172:175]
    s_waitcnt lgkmcnt(8)
    buffer_load_dwordx4 v6, s[24:27], s45 offen lds
    v_mfma_f32_16x16x32_bf16 v[144:147], a[224:227], v[80:83], v[144:147]
    ds_read_b64_tr_b16 a[248:249], v4 offset:224
    ds_read_b128 v[16:19], v9 offset:3328
    v_mfma_f32_16x16x32_bf16 v[144:147], a[228:231], v[84:87], v[144:147]
    ds_read_b64_tr_b16 a[250:251], v4 offset:736
    ds_read_b128 v[20:23], v9 offset:3360
    v_mfma_f32_16x16x32_bf16 v[176:179], a[224:227], v[88:91], v[176:179]
    ds_read_b64_tr_b16 a[252:253], v4 offset:17120
    v_fma_mix_f32 v32, v98, v24, v28 op_sel:[0,0,0] op_sel_hi:[1,0,0]
    v_mfma_f32_16x16x32_bf16 v[176:179], a[228:231], v[92:95], v[176:179]
    s_waitcnt lgkmcnt(9)
    ds_read_b64_tr_b16 a[254:255], v4 offset:17632
    v_fma_mix_f32 v33, v98, v25, v29 op_sel:[1,0,0] op_sel_hi:[1,0,0]
    v_mfma_f32_16x16x32_bf16 v[148:151], a[232:235], v[80:83], v[148:151]
    ds_read_b64_tr_b16 a[192:193], v4 offset:256
    v_fma_mix_f32 v34, v99, v26, v30 op_sel:[0,0,0] op_sel_hi:[1,0,0]
    v_mfma_f32_16x16x32_bf16 v[148:151], a[236:239], v[84:87], v[148:151]
    s_mov_b32 s45, 3932160
    ds_read_b64_tr_b16 a[194:195], v4 offset:768
    ds_read_b64_tr_b16 a[196:197], v4 offset:17152
    v_mfma_f32_16x16x32_bf16 v[180:183], a[232:235], v[88:91], v[180:183]
    s_add_u32 m0, s44, 16896
    ds_read_b64_tr_b16 a[198:199], v4 offset:17664
    v_fma_mix_f32 v35, v99, v27, v31 op_sel:[1,0,0] op_sel_hi:[1,0,0]
    v_mfma_f32_16x16x32_bf16 v[180:183], a[236:239], v[92:95], v[180:183]
    s_waitcnt lgkmcnt(10)
    buffer_load_dwordx4 v6, s[24:27], s45 offen lds
    v_mfma_f32_16x16x32_bf16 v[152:155], a[240:243], v[80:83], v[152:155]
    ds_read_b64_tr_b16 a[200:201], v4 offset:288
    v_cvt_pk_bf16_f32 v98, v32, v33
    v_mfma_f32_16x16x32_bf16 v[152:155], a[244:247], v[84:87], v[152:155]
    ds_read_b64_tr_b16 a[202:203], v4 offset:800
    v_cvt_pk_bf16_f32 v99, v34, v35
    v_mfma_f32_16x16x32_bf16 v[184:187], a[240:243], v[88:91], v[184:187]
    ds_read_b64_tr_b16 a[204:205], v4 offset:17184
    v_fma_mix_f32 v36, v106, v24, v28 op_sel:[0,0,0] op_sel_hi:[1,0,0]
    v_mfma_f32_16x16x32_bf16 v[184:187], a[244:247], v[92:95], v[184:187]
    s_waitcnt lgkmcnt(7)
    ds_read_b64_tr_b16 a[206:207], v4 offset:17696
    v_fma_mix_f32 v37, v106, v25, v29 op_sel:[1,0,0] op_sel_hi:[1,0,0]
    v_fma_mix_f32 v38, v107, v26, v30 op_sel:[0,0,0] op_sel_hi:[1,0,0]
    v_mfma_f32_16x16x32_bf16 v[156:159], a[248:251], v[80:83], v[156:159]
    ds_read_b64_tr_b16 a[208:209], v4 offset:320
    v_fma_mix_f32 v39, v107, v27, v31 op_sel:[1,0,0] op_sel_hi:[1,0,0]
    v_mfma_f32_16x16x32_bf16 v[156:159], a[252:255], v[84:87], v[156:159]
    s_mov_b32 s45, 3940352
    ds_read_b64_tr_b16 a[210:211], v4 offset:832
    ds_read_b64_tr_b16 a[212:213], v4 offset:17216
    v_cvt_pk_bf16_f32 v106, v36, v37
    v_mfma_f32_16x16x32_bf16 v[188:191], a[248:251], v[88:91], v[188:191]
    s_add_u32 m0, s44, 17952
    ds_read_b64_tr_b16 a[214:215], v4 offset:17728
    v_cvt_pk_bf16_f32 v107, v38, v39
    v_mfma_f32_16x16x32_bf16 v[188:191], a[252:255], v[92:95], v[188:191]
    s_waitcnt lgkmcnt(8)
    buffer_load_dwordx4 v6, s[24:27], s45 offen lds
    v_mfma_f32_16x16x32_bf16 v[192:195], a[192:195], v[80:83], v[192:195]
    ds_read_b64_tr_b16 a[216:217], v4 offset:352
    ds_read_b128 v[24:27], v9 offset:3344
    v_mfma_f32_16x16x32_bf16 v[192:195], a[196:199], v[84:87], v[192:195]
    ds_read_b64_tr_b16 a[218:219], v4 offset:864
    ds_read_b128 v[28:31], v9 offset:3376
    v_mfma_f32_16x16x32_bf16 v[224:227], a[192:195], v[88:91], v[224:227]
    ds_read_b64_tr_b16 a[220:221], v4 offset:17248
    v_fma_mix_f32 v32, v100, v16, v20 op_sel:[0,0,0] op_sel_hi:[1,0,0]
    v_mfma_f32_16x16x32_bf16 v[224:227], a[196:199], v[92:95], v[224:227]
    s_waitcnt lgkmcnt(9)
    ds_read_b64_tr_b16 a[222:223], v4 offset:17760
    v_fma_mix_f32 v33, v100, v17, v21 op_sel:[1,0,0] op_sel_hi:[1,0,0]
    v_mfma_f32_16x16x32_bf16 v[196:199], a[200:203], v[80:83], v[196:199]
    ds_read_b64_tr_b16 a[224:225], v4 offset:384
    v_fma_mix_f32 v34, v101, v18, v22 op_sel:[0,0,0] op_sel_hi:[1,0,0]
    v_mfma_f32_16x16x32_bf16 v[196:199], a[204:207], v[84:87], v[196:199]
    s_mov_b32 s45, 3948544
    ds_read_b64_tr_b16 a[226:227], v4 offset:896
    ds_read_b64_tr_b16 a[228:229], v4 offset:17280
    v_mfma_f32_16x16x32_bf16 v[228:231], a[200:203], v[88:91], v[228:231]
    s_add_u32 m0, s44, 19008
    ds_read_b64_tr_b16 a[230:231], v4 offset:17792
    v_fma_mix_f32 v35, v101, v19, v23 op_sel:[1,0,0] op_sel_hi:[1,0,0]
    v_mfma_f32_16x16x32_bf16 v[228:231], a[204:207], v[92:95], v[228:231]
    s_waitcnt lgkmcnt(10)
    buffer_load_dwordx4 v6, s[24:27], s45 offen lds
    v_mfma_f32_16x16x32_bf16 v[200:203], a[208:211], v[80:83], v[200:203]
    ds_read_b64_tr_b16 a[232:233], v4 offset:416
    v_cvt_pk_bf16_f32 v100, v32, v33
    v_mfma_f32_16x16x32_bf16 v[200:203], a[212:215], v[84:87], v[200:203]
    ds_read_b64_tr_b16 a[234:235], v4 offset:928
    v_cvt_pk_bf16_f32 v101, v34, v35
    v_mfma_f32_16x16x32_bf16 v[232:235], a[208:211], v[88:91], v[232:235]
    ds_read_b64_tr_b16 a[236:237], v4 offset:17312
    v_fma_mix_f32 v36, v108, v16, v20 op_sel:[0,0,0] op_sel_hi:[1,0,0]
    v_mfma_f32_16x16x32_bf16 v[232:235], a[212:215], v[92:95], v[232:235]
    s_waitcnt lgkmcnt(7)
    ds_read_b64_tr_b16 a[238:239], v4 offset:17824
    v_fma_mix_f32 v37, v108, v17, v21 op_sel:[1,0,0] op_sel_hi:[1,0,0]
    v_fma_mix_f32 v38, v109, v18, v22 op_sel:[0,0,0] op_sel_hi:[1,0,0]
    v_mfma_f32_16x16x32_bf16 v[204:207], a[216:219], v[80:83], v[204:207]
    ds_read_b64_tr_b16 a[240:241], v4 offset:448
    v_fma_mix_f32 v39, v109, v19, v23 op_sel:[1,0,0] op_sel_hi:[1,0,0]
    v_mfma_f32_16x16x32_bf16 v[204:207], a[220:223], v[84:87], v[204:207]
    s_mov_b32 s45, 3956736
    ds_read_b64_tr_b16 a[242:243], v4 offset:960
    ds_read_b64_tr_b16 a[244:245], v4 offset:17344
    v_cvt_pk_bf16_f32 v108, v36, v37
    v_mfma_f32_16x16x32_bf16 v[236:239], a[216:219], v[88:91], v[236:239]
    s_add_u32 m0, s44, 20064
    ds_read_b64_tr_b16 a[246:247], v4 offset:17856
    v_cvt_pk_bf16_f32 v109, v38, v39
    v_mfma_f32_16x16x32_bf16 v[236:239], a[220:223], v[92:95], v[236:239]
    s_waitcnt lgkmcnt(8)
    buffer_load_dwordx4 v6, s[24:27], s45 offen lds
    v_mfma_f32_16x16x32_bf16 v[208:211], a[224:227], v[80:83], v[208:211]
    ds_read_b64_tr_b16 a[248:249], v4 offset:480
    ds_read_b128 v[16:19], v9 offset:3584
    v_mfma_f32_16x16x32_bf16 v[208:211], a[228:231], v[84:87], v[208:211]
    ds_read_b64_tr_b16 a[250:251], v4 offset:992
    ds_read_b128 v[20:23], v9 offset:3616
    v_mfma_f32_16x16x32_bf16 v[240:243], a[224:227], v[88:91], v[240:243]
    ds_read_b64_tr_b16 a[252:253], v4 offset:17376
    v_fma_mix_f32 v32, v102, v24, v28 op_sel:[0,0,0] op_sel_hi:[1,0,0]
    v_mfma_f32_16x16x32_bf16 v[240:243], a[228:231], v[92:95], v[240:243]
    s_waitcnt vmcnt(9)
    s_barrier
    s_waitcnt lgkmcnt(9)
    ds_read_b64_tr_b16 a[254:255], v4 offset:17888
    v_fma_mix_f32 v33, v102, v25, v29 op_sel:[1,0,0] op_sel_hi:[1,0,0]
    v_mfma_f32_16x16x32_bf16 v[212:215], a[232:235], v[80:83], v[212:215]
    ds_read_b64_tr_b16 a[192:193], v4 offset:33792
    v_fma_mix_f32 v34, v103, v26, v30 op_sel:[0,0,0] op_sel_hi:[1,0,0]
    v_mfma_f32_16x16x32_bf16 v[212:215], a[236:239], v[84:87], v[212:215]
    s_mov_b32 s45, 4194304
    ds_read_b64_tr_b16 a[194:195], v4 offset:34304
    ds_read_b64_tr_b16 a[196:197], v4 offset:50688
    v_mfma_f32_16x16x32_bf16 v[244:247], a[232:235], v[88:91], v[244:247]
    s_add_u32 m0, s44, 33792
    ds_read_b64_tr_b16 a[198:199], v4 offset:51200
    v_fma_mix_f32 v35, v103, v27, v31 op_sel:[1,0,0] op_sel_hi:[1,0,0]
    v_mfma_f32_16x16x32_bf16 v[244:247], a[236:239], v[92:95], v[244:247]
    s_waitcnt lgkmcnt(10)
    buffer_load_dwordx4 v6, s[24:27], s45 offen lds
    v_mfma_f32_16x16x32_bf16 v[216:219], a[240:243], v[80:83], v[216:219]
    ds_read_b64_tr_b16 a[200:201], v4 offset:33824
    v_cvt_pk_bf16_f32 v102, v32, v33
    v_mfma_f32_16x16x32_bf16 v[216:219], a[244:247], v[84:87], v[216:219]
    ds_read_b64_tr_b16 a[202:203], v4 offset:34336
    v_cvt_pk_bf16_f32 v103, v34, v35
    v_mfma_f32_16x16x32_bf16 v[248:251], a[240:243], v[88:91], v[248:251]
    ds_read_b64_tr_b16 a[204:205], v4 offset:50720
    v_fma_mix_f32 v36, v110, v24, v28 op_sel:[0,0,0] op_sel_hi:[1,0,0]
    v_mfma_f32_16x16x32_bf16 v[248:251], a[244:247], v[92:95], v[248:251]
    s_waitcnt lgkmcnt(7)
    ds_read_b64_tr_b16 a[206:207], v4 offset:51232
    v_fma_mix_f32 v37, v110, v25, v29 op_sel:[1,0,0] op_sel_hi:[1,0,0]
    v_fma_mix_f32 v38, v111, v26, v30 op_sel:[0,0,0] op_sel_hi:[1,0,0]
    v_mfma_f32_16x16x32_bf16 v[220:223], a[248:251], v[80:83], v[220:223]
    ds_read_b64_tr_b16 a[208:209], v4 offset:33856
    v_fma_mix_f32 v39, v111, v27, v31 op_sel:[1,0,0] op_sel_hi:[1,0,0]
    v_mfma_f32_16x16x32_bf16 v[220:223], a[252:255], v[84:87], v[220:223]
    s_mov_b32 s45, 4202496
    ds_read_b64_tr_b16 a[210:211], v4 offset:34368
    ds_read_b64_tr_b16 a[212:213], v4 offset:50752
    v_cvt_pk_bf16_f32 v110, v36, v37
    v_mfma_f32_16x16x32_bf16 v[252:255], a[248:251], v[88:91], v[252:255]
    s_add_u32 m0, s44, 34848
    ds_read_b64_tr_b16 a[214:215], v4 offset:51264
    v_cvt_pk_bf16_f32 v111, v38, v39
    v_mfma_f32_16x16x32_bf16 v[252:255], a[252:255], v[92:95], v[252:255]
    s_waitcnt lgkmcnt(8)
    buffer_load_dwordx4 v6, s[24:27], s45 offen lds
    v_mfma_f32_16x16x32_bf16 v[128:131], a[192:195], v[96:99], v[128:131]
    ds_read_b64_tr_b16 a[216:217], v4 offset:33888
    ds_read_b128 v[24:27], v9 offset:3600
    v_mfma_f32_16x16x32_bf16 v[128:131], a[196:199], v[100:103], v[128:131]
    ds_read_b64_tr_b16 a[218:219], v4 offset:34400
    ds_read_b128 v[28:31], v9 offset:3632
    v_mfma_f32_16x16x32_bf16 v[160:163], a[192:195], v[104:107], v[160:163]
    ds_read_b64_tr_b16 a[220:221], v4 offset:50784
    v_fma_mix_f32 v32, v112, v16, v20 op_sel:[0,0,0] op_sel_hi:[1,0,0]
    v_mfma_f32_16x16x32_bf16 v[160:163], a[196:199], v[108:111], v[160:163]
    s_waitcnt lgkmcnt(9)
    ds_read_b64_tr_b16 a[222:223], v4 offset:51296
    v_fma_mix_f32 v33, v112, v17, v21 op_sel:[1,0,0] op_sel_hi:[1,0,0]
    v_mfma_f32_16x16x32_bf16 v[132:135], a[200:203], v[96:99], v[132:135]
    ds_read_b64_tr_b16 a[224:225], v4 offset:33920
    v_fma_mix_f32 v34, v113, v18, v22 op_sel:[0,0,0] op_sel_hi:[1,0,0]
    v_mfma_f32_16x16x32_bf16 v[132:135], a[204:207], v[100:103], v[132:135]
    s_mov_b32 s45, 4210688
    ds_read_b64_tr_b16 a[226:227], v4 offset:34432
    ds_read_b64_tr_b16 a[228:229], v4 offset:50816
    v_mfma_f32_16x16x32_bf16 v[164:167], a[200:203], v[104:107], v[164:167]
    s_add_u32 m0, s44, 35904
    ds_read_b64_tr_b16 a[230:231], v4 offset:51328
    v_fma_mix_f32 v35, v113, v19, v23 op_sel:[1,0,0] op_sel_hi:[1,0,0]
    v_mfma_f32_16x16x32_bf16 v[164:167], a[204:207], v[108:111], v[164:167]
    s_waitcnt lgkmcnt(10)
    buffer_load_dwordx4 v6, s[24:27], s45 offen lds
    v_mfma_f32_16x16x32_bf16 v[136:139], a[208:211], v[96:99], v[136:139]
    ds_read_b64_tr_b16 a[232:233], v4 offset:33952
    v_cvt_pk_bf16_f32 v112, v32, v33
    v_mfma_f32_16x16x32_bf16 v[136:139], a[212:215], v[100:103], v[136:139]
    ds_read_b64_tr_b16 a[234:235], v4 offset:34464
    v_cvt_pk_bf16_f32 v113, v34, v35
    v_mfma_f32_16x16x32_bf16 v[168:171], a[208:211], v[104:107], v[168:171]
    ds_read_b64_tr_b16 a[236:237], v4 offset:50848
    v_fma_mix_f32 v36, v120, v16, v20 op_sel:[0,0,0] op_sel_hi:[1,0,0]
    v_mfma_f32_16x16x32_bf16 v[168:171], a[212:215], v[108:111], v[168:171]
    s_waitcnt lgkmcnt(7)
    ds_read_b64_tr_b16 a[238:239], v4 offset:51360
    v_fma_mix_f32 v37, v120, v17, v21 op_sel:[1,0,0] op_sel_hi:[1,0,0]
    v_fma_mix_f32 v38, v121, v18, v22 op_sel:[0,0,0] op_sel_hi:[1,0,0]
    v_mfma_f32_16x16x32_bf16 v[140:143], a[216:219], v[96:99], v[140:143]
    ds_read_b64_tr_b16 a[240:241], v4 offset:33984
    v_fma_mix_f32 v39, v121, v19, v23 op_sel:[1,0,0] op_sel_hi:[1,0,0]
    v_mfma_f32_16x16x32_bf16 v[140:143], a[220:223], v[100:103], v[140:143]
    s_mov_b32 s45, 4218880
    ds_read_b64_tr_b16 a[242:243], v4 offset:34496
    ds_read_b64_tr_b16 a[244:245], v4 offset:50880
    v_cvt_pk_bf16_f32 v120, v36, v37
    v_mfma_f32_16x16x32_bf16 v[172:175], a[216:219], v[104:107], v[172:175]
    s_add_u32 m0, s44, 36960
    ds_read_b64_tr_b16 a[246:247], v4 offset:51392
    v_cvt_pk_bf16_f32 v121, v38, v39
    v_mfma_f32_16x16x32_bf16 v[172:175], a[220:223], v[108:111], v[172:175]
    s_waitcnt lgkmcnt(8)
    buffer_load_dwordx4 v6, s[24:27], s45 offen lds
    v_mfma_f32_16x16x32_bf16 v[144:147], a[224:227], v[96:99], v[144:147]
    ds_read_b64_tr_b16 a[248:249], v4 offset:34016
    ds_read_b128 v[16:19], v9 offset:3840
    v_mfma_f32_16x16x32_bf16 v[144:147], a[228:231], v[100:103], v[144:147]
    ds_read_b64_tr_b16 a[250:251], v4 offset:34528
    ds_read_b128 v[20:23], v9 offset:3872
    v_mfma_f32_16x16x32_bf16 v[176:179], a[224:227], v[104:107], v[176:179]
    ds_read_b64_tr_b16 a[252:253], v4 offset:50912
    v_fma_mix_f32 v32, v114, v24, v28 op_sel:[0,0,0] op_sel_hi:[1,0,0]
    v_mfma_f32_16x16x32_bf16 v[176:179], a[228:231], v[108:111], v[176:179]
    s_waitcnt lgkmcnt(9)
    ds_read_b64_tr_b16 a[254:255], v4 offset:51424
    v_fma_mix_f32 v33, v114, v25, v29 op_sel:[1,0,0] op_sel_hi:[1,0,0]
    v_mfma_f32_16x16x32_bf16 v[148:151], a[232:235], v[96:99], v[148:151]
    ds_read_b64_tr_b16 a[192:193], v4 offset:34048
    v_fma_mix_f32 v34, v115, v26, v30 op_sel:[0,0,0] op_sel_hi:[1,0,0]
    v_mfma_f32_16x16x32_bf16 v[148:151], a[236:239], v[100:103], v[148:151]
    s_mov_b32 s45, 4456448
    ds_read_b64_tr_b16 a[194:195], v4 offset:34560
    ds_read_b64_tr_b16 a[196:197], v4 offset:50944
    v_mfma_f32_16x16x32_bf16 v[180:183], a[232:235], v[104:107], v[180:183]
    s_add_u32 m0, s44, 50688
    ds_read_b64_tr_b16 a[198:199], v4 offset:51456
    v_fma_mix_f32 v35, v115, v27, v31 op_sel:[1,0,0] op_sel_hi:[1,0,0]
    v_mfma_f32_16x16x32_bf16 v[180:183], a[236:239], v[108:111], v[180:183]
    s_waitcnt lgkmcnt(10)
    buffer_load_dwordx4 v6, s[24:27], s45 offen lds
    v_mfma_f32_16x16x32_bf16 v[152:155], a[240:243], v[96:99], v[152:155]
    ds_read_b64_tr_b16 a[200:201], v4 offset:34080
    v_cvt_pk_bf16_f32 v114, v32, v33
    v_mfma_f32_16x16x32_bf16 v[152:155], a[244:247], v[100:103], v[152:155]
    ds_read_b64_tr_b16 a[202:203], v4 offset:34592
    v_cvt_pk_bf16_f32 v115, v34, v35
    v_mfma_f32_16x16x32_bf16 v[184:187], a[240:243], v[104:107], v[184:187]
    ds_read_b64_tr_b16 a[204:205], v4 offset:50976
    v_fma_mix_f32 v36, v122, v24, v28 op_sel:[0,0,0] op_sel_hi:[1,0,0]
    v_mfma_f32_16x16x32_bf16 v[184:187], a[244:247], v[108:111], v[184:187]
    s_waitcnt lgkmcnt(7)
    ds_read_b64_tr_b16 a[206:207], v4 offset:51488
    v_fma_mix_f32 v37, v122, v25, v29 op_sel:[1,0,0] op_sel_hi:[1,0,0]
    v_fma_mix_f32 v38, v123, v26, v30 op_sel:[0,0,0] op_sel_hi:[1,0,0]
    v_mfma_f32_16x16x32_bf16 v[156:159], a[248:251], v[96:99], v[156:159]
    ds_read_b64_tr_b16 a[208:209], v4 offset:34112
    v_fma_mix_f32 v39, v123, v27, v31 op_sel:[1,0,0] op_sel_hi:[1,0,0]
    v_mfma_f32_16x16x32_bf16 v[156:159], a[252:255], v[100:103], v[156:159]
    s_mov_b32 s45, 4464640
    ds_read_b64_tr_b16 a[210:211], v4 offset:34624
    ds_read_b64_tr_b16 a[212:213], v4 offset:51008
    v_cvt_pk_bf16_f32 v122, v36, v37
    v_mfma_f32_16x16x32_bf16 v[188:191], a[248:251], v[104:107], v[188:191]
    s_add_u32 m0, s44, 51744
    ds_read_b64_tr_b16 a[214:215], v4 offset:51520
    v_cvt_pk_bf16_f32 v123, v38, v39
    v_mfma_f32_16x16x32_bf16 v[188:191], a[252:255], v[108:111], v[188:191]
    s_waitcnt lgkmcnt(8)
    buffer_load_dwordx4 v6, s[24:27], s45 offen lds
    v_mfma_f32_16x16x32_bf16 v[192:195], a[192:195], v[96:99], v[192:195]
    ds_read_b64_tr_b16 a[216:217], v4 offset:34144
    ds_read_b128 v[24:27], v9 offset:3856
    v_mfma_f32_16x16x32_bf16 v[192:195], a[196:199], v[100:103], v[192:195]
    ds_read_b64_tr_b16 a[218:219], v4 offset:34656
    ds_read_b128 v[28:31], v9 offset:3888
    v_mfma_f32_16x16x32_bf16 v[224:227], a[192:195], v[104:107], v[224:227]
    ds_read_b64_tr_b16 a[220:221], v4 offset:51040
    v_fma_mix_f32 v32, v116, v16, v20 op_sel:[0,0,0] op_sel_hi:[1,0,0]
    v_mfma_f32_16x16x32_bf16 v[224:227], a[196:199], v[108:111], v[224:227]
    s_waitcnt lgkmcnt(9)
    ds_read_b64_tr_b16 a[222:223], v4 offset:51552
    v_fma_mix_f32 v33, v116, v17, v21 op_sel:[1,0,0] op_sel_hi:[1,0,0]
    v_mfma_f32_16x16x32_bf16 v[196:199], a[200:203], v[96:99], v[196:199]
    ds_read_b64_tr_b16 a[224:225], v4 offset:34176
    v_fma_mix_f32 v34, v117, v18, v22 op_sel:[0,0,0] op_sel_hi:[1,0,0]
    v_mfma_f32_16x16x32_bf16 v[196:199], a[204:207], v[100:103], v[196:199]
    s_mov_b32 s45, 4472832
    ds_read_b64_tr_b16 a[226:227], v4 offset:34688
    ds_read_b64_tr_b16 a[228:229], v4 offset:51072
    v_mfma_f32_16x16x32_bf16 v[228:231], a[200:203], v[104:107], v[228:231]
    s_add_u32 m0, s44, 52800
    ds_read_b64_tr_b16 a[230:231], v4 offset:51584
    v_fma_mix_f32 v35, v117, v19, v23 op_sel:[1,0,0] op_sel_hi:[1,0,0]
    v_mfma_f32_16x16x32_bf16 v[228:231], a[204:207], v[108:111], v[228:231]
    s_waitcnt lgkmcnt(10)
    buffer_load_dwordx4 v6, s[24:27], s45 offen lds
    v_mfma_f32_16x16x32_bf16 v[200:203], a[208:211], v[96:99], v[200:203]
    ds_read_b64_tr_b16 a[232:233], v4 offset:34208
    v_cvt_pk_bf16_f32 v116, v32, v33
    v_mfma_f32_16x16x32_bf16 v[200:203], a[212:215], v[100:103], v[200:203]
    ds_read_b64_tr_b16 a[234:235], v4 offset:34720
    v_cvt_pk_bf16_f32 v117, v34, v35
    v_mfma_f32_16x16x32_bf16 v[232:235], a[208:211], v[104:107], v[232:235]
    ds_read_b64_tr_b16 a[236:237], v4 offset:51104
    v_fma_mix_f32 v36, v124, v16, v20 op_sel:[0,0,0] op_sel_hi:[1,0,0]
    v_mfma_f32_16x16x32_bf16 v[232:235], a[212:215], v[108:111], v[232:235]
    s_waitcnt lgkmcnt(7)
    ds_read_b64_tr_b16 a[238:239], v4 offset:51616
    v_fma_mix_f32 v37, v124, v17, v21 op_sel:[1,0,0] op_sel_hi:[1,0,0]
    v_fma_mix_f32 v38, v125, v18, v22 op_sel:[0,0,0] op_sel_hi:[1,0,0]
    v_mfma_f32_16x16x32_bf16 v[204:207], a[216:219], v[96:99], v[204:207]
    ds_read_b64_tr_b16 a[240:241], v4 offset:34240
    v_fma_mix_f32 v39, v125, v19, v23 op_sel:[1,0,0] op_sel_hi:[1,0,0]
    v_mfma_f32_16x16x32_bf16 v[204:207], a[220:223], v[100:103], v[204:207]
    s_mov_b32 s45, 4481024
    ds_read_b64_tr_b16 a[242:243], v4 offset:34752
    ds_read_b64_tr_b16 a[244:245], v4 offset:51136
    v_cvt_pk_bf16_f32 v124, v36, v37
    v_mfma_f32_16x16x32_bf16 v[236:239], a[216:219], v[104:107], v[236:239]
    s_add_u32 m0, s44, 53856
    ds_read_b64_tr_b16 a[246:247], v4 offset:51648
    v_cvt_pk_bf16_f32 v125, v38, v39
    v_mfma_f32_16x16x32_bf16 v[236:239], a[220:223], v[108:111], v[236:239]
    s_waitcnt lgkmcnt(8)
    buffer_load_dwordx4 v6, s[24:27], s45 offen lds
    v_mfma_f32_16x16x32_bf16 v[208:211], a[224:227], v[96:99], v[208:211]
    ds_read_b64_tr_b16 a[248:249], v4 offset:34272
    ds_read_b128 v[16:19], v9 offset:4096
    v_mfma_f32_16x16x32_bf16 v[208:211], a[228:231], v[100:103], v[208:211]
    ds_read_b64_tr_b16 a[250:251], v4 offset:34784
    ds_read_b128 v[20:23], v9 offset:4128
    v_mfma_f32_16x16x32_bf16 v[240:243], a[224:227], v[104:107], v[240:243]
    ds_read_b64_tr_b16 a[252:253], v4 offset:51168
    v_fma_mix_f32 v32, v118, v24, v28 op_sel:[0,0,0] op_sel_hi:[1,0,0]
    v_mfma_f32_16x16x32_bf16 v[240:243], a[228:231], v[108:111], v[240:243]
    s_waitcnt vmcnt(8)
    s_barrier
    s_waitcnt lgkmcnt(9)
    ds_read_b64_tr_b16 a[254:255], v4 offset:51680
    v_fma_mix_f32 v33, v118, v25, v29 op_sel:[1,0,0] op_sel_hi:[1,0,0]
    v_mfma_f32_16x16x32_bf16 v[212:215], a[232:235], v[96:99], v[212:215]
    ds_read_b64_tr_b16 a[192:193], v3 offset:0
    v_fma_mix_f32 v34, v119, v26, v30 op_sel:[0,0,0] op_sel_hi:[1,0,0]
    v_mfma_f32_16x16x32_bf16 v[212:215], a[236:239], v[100:103], v[212:215]
    s_mov_b32 s46, 0
    ds_read_b64_tr_b16 a[194:195], v3 offset:512
    ds_read_b64_tr_b16 a[196:197], v3 offset:16896
    v_mfma_f32_16x16x32_bf16 v[244:247], a[232:235], v[104:107], v[244:247]
    s_add_u32 m0, s44, 67584
    ds_read_b64_tr_b16 a[198:199], v3 offset:17408
    v_fma_mix_f32 v35, v119, v27, v31 op_sel:[1,0,0] op_sel_hi:[1,0,0]
    v_mfma_f32_16x16x32_bf16 v[244:247], a[236:239], v[108:111], v[244:247]
    s_waitcnt lgkmcnt(10)
    buffer_load_dwordx4 v5, s[16:19], s46 offen offset:0 lds
    v_mfma_f32_16x16x32_bf16 v[216:219], a[240:243], v[96:99], v[216:219]
    ds_read_b64_tr_b16 a[200:201], v3 offset:32
    v_cvt_pk_bf16_f32 v118, v32, v33
    v_mfma_f32_16x16x32_bf16 v[216:219], a[244:247], v[100:103], v[216:219]
    ds_read_b64_tr_b16 a[202:203], v3 offset:544
    v_cvt_pk_bf16_f32 v119, v34, v35
    v_mfma_f32_16x16x32_bf16 v[248:251], a[240:243], v[104:107], v[248:251]
    ds_read_b64_tr_b16 a[204:205], v3 offset:16928
    v_fma_mix_f32 v36, v126, v24, v28 op_sel:[0,0,0] op_sel_hi:[1,0,0]
    v_mfma_f32_16x16x32_bf16 v[248:251], a[244:247], v[108:111], v[248:251]
    s_waitcnt lgkmcnt(7)
    ds_read_b64_tr_b16 a[206:207], v3 offset:17440
    v_fma_mix_f32 v37, v126, v25, v29 op_sel:[1,0,0] op_sel_hi:[1,0,0]
    v_fma_mix_f32 v38, v127, v26, v30 op_sel:[0,0,0] op_sel_hi:[1,0,0]
    v_mfma_f32_16x16x32_bf16 v[220:223], a[248:251], v[96:99], v[220:223]
    ds_read_b64_tr_b16 a[208:209], v3 offset:64
    v_fma_mix_f32 v39, v127, v27, v31 op_sel:[1,0,0] op_sel_hi:[1,0,0]
    v_mfma_f32_16x16x32_bf16 v[220:223], a[252:255], v[100:103], v[220:223]
    ds_read_b64_tr_b16 a[210:211], v3 offset:576
    ds_read_b64_tr_b16 a[212:213], v3 offset:16960
    v_cvt_pk_bf16_f32 v126, v36, v37
    v_mfma_f32_16x16x32_bf16 v[252:255], a[248:251], v[104:107], v[252:255]
    s_add_u32 m0, s44, 67616
    ds_read_b64_tr_b16 a[214:215], v3 offset:17472
    v_cvt_pk_bf16_f32 v127, v38, v39
    v_mfma_f32_16x16x32_bf16 v[252:255], a[252:255], v[108:111], v[252:255]
    s_waitcnt lgkmcnt(8)
    buffer_load_dwordx4 v5, s[16:19], s46 offen offset:1024 lds
    v_mfma_f32_16x16x32_bf16 v[128:131], a[192:195], v[112:115], v[128:131]
    ds_read_b64_tr_b16 a[216:217], v3 offset:96
    ds_read_b128 v[24:27], v9 offset:4112
    v_mfma_f32_16x16x32_bf16 v[128:131], a[196:199], v[116:119], v[128:131]
    ds_read_b64_tr_b16 a[218:219], v3 offset:608
    ds_read_b128 v[28:31], v9 offset:4144
    v_mfma_f32_16x16x32_bf16 v[160:163], a[192:195], v[120:123], v[160:163]
    ds_read_b64_tr_b16 a[220:221], v3 offset:16992
    v_fma_mix_f32 v32, v48, v16, v20 op_sel:[0,0,0] op_sel_hi:[1,0,0]
    v_mfma_f32_16x16x32_bf16 v[160:163], a[196:199], v[124:127], v[160:163]
    s_waitcnt lgkmcnt(9)
    ds_read_b64_tr_b16 a[222:223], v3 offset:17504
    v_fma_mix_f32 v33, v48, v17, v21 op_sel:[1,0,0] op_sel_hi:[1,0,0]
    v_mfma_f32_16x16x32_bf16 v[132:135], a[200:203], v[112:115], v[132:135]
    ds_read_b64_tr_b16 a[224:225], v3 offset:128
    v_fma_mix_f32 v34, v49, v18, v22 op_sel:[0,0,0] op_sel_hi:[1,0,0]
    v_mfma_f32_16x16x32_bf16 v[132:135], a[204:207], v[116:119], v[132:135]
    ds_read_b64_tr_b16 a[226:227], v3 offset:640
    ds_read_b64_tr_b16 a[228:229], v3 offset:17024
    v_mfma_f32_16x16x32_bf16 v[164:167], a[200:203], v[120:123], v[164:167]
    s_add_u32 m0, s44, 67648
    ds_read_b64_tr_b16 a[230:231], v3 offset:17536
    v_fma_mix_f32 v35, v49, v19, v23 op_sel:[1,0,0] op_sel_hi:[1,0,0]
    v_mfma_f32_16x16x32_bf16 v[164:167], a[204:207], v[124:127], v[164:167]
    s_waitcnt lgkmcnt(10)
    buffer_load_dwordx4 v5, s[16:19], s46 offen offset:2048 lds
    v_mfma_f32_16x16x32_bf16 v[136:139], a[208:211], v[112:115], v[136:139]
    ds_read_b64_tr_b16 a[232:233], v3 offset:160
    v_cvt_pk_bf16_f32 v48, v32, v33
    v_mfma_f32_16x16x32_bf16 v[136:139], a[212:215], v[116:119], v[136:139]
    ds_read_b64_tr_b16 a[234:235], v3 offset:672
    v_cvt_pk_bf16_f32 v49, v34, v35
    v_mfma_f32_16x16x32_bf16 v[168:171], a[208:211], v[120:123], v[168:171]
    ds_read_b64_tr_b16 a[236:237], v3 offset:17056
    v_fma_mix_f32 v36, v56, v16, v20 op_sel:[0,0,0] op_sel_hi:[1,0,0]
    v_mfma_f32_16x16x32_bf16 v[168:171], a[212:215], v[124:127], v[168:171]
    s_waitcnt lgkmcnt(7)
    ds_read_b64_tr_b16 a[238:239], v3 offset:17568
    v_fma_mix_f32 v37, v56, v17, v21 op_sel:[1,0,0] op_sel_hi:[1,0,0]
    v_fma_mix_f32 v38, v57, v18, v22 op_sel:[0,0,0] op_sel_hi:[1,0,0]
    v_mfma_f32_16x16x32_bf16 v[140:143], a[216:219], v[112:115], v[140:143]
    ds_read_b64_tr_b16 a[240:241], v3 offset:192
    v_fma_mix_f32 v39, v57, v19, v23 op_sel:[1,0,0] op_sel_hi:[1,0,0]
    v_mfma_f32_16x16x32_bf16 v[140:143], a[220:223], v[116:119], v[140:143]
    ds_read_b64_tr_b16 a[242:243], v3 offset:704
    ds_read_b64_tr_b16 a[244:245], v3 offset:17088
    v_cvt_pk_bf16_f32 v56, v36, v37
    v_mfma_f32_16x16x32_bf16 v[172:175], a[216:219], v[120:123], v[172:175]
    s_add_u32 m0, s44, 67680
    ds_read_b64_tr_b16 a[246:247], v3 offset:17600
    v_cvt_pk_bf16_f32 v57, v38, v39
    v_mfma_f32_16x16x32_bf16 v[172:175], a[220:223], v[124:127], v[172:175]
    s_waitcnt lgkmcnt(8)
    buffer_load_dwordx4 v5, s[16:19], s46 offen offset:3072 lds
    v_mfma_f32_16x16x32_bf16 v[144:147], a[224:227], v[112:115], v[144:147]
    ds_read_b64_tr_b16 a[248:249], v3 offset:224
    ds_read_b128 v[16:19], v9 offset:4352
    v_mfma_f32_16x16x32_bf16 v[144:147], a[228:231], v[116:119], v[144:147]
    ds_read_b64_tr_b16 a[250:251], v3 offset:736
    ds_read_b128 v[20:23], v9 offset:4384
    v_mfma_f32_16x16x32_bf16 v[176:179], a[224:227], v[120:123], v[176:179]
    ds_read_b64_tr_b16 a[252:253], v3 offset:17120
    v_fma_mix_f32 v32, v50, v24, v28 op_sel:[0,0,0] op_sel_hi:[1,0,0]
    v_mfma_f32_16x16x32_bf16 v[176:179], a[228:231], v[124:127], v[176:179]
    s_waitcnt lgkmcnt(9)
    ds_read_b64_tr_b16 a[254:255], v3 offset:17632
    v_fma_mix_f32 v33, v50, v25, v29 op_sel:[1,0,0] op_sel_hi:[1,0,0]
    v_mfma_f32_16x16x32_bf16 v[148:151], a[232:235], v[112:115], v[148:151]
    ds_read_b64_tr_b16 a[192:193], v3 offset:256
    v_fma_mix_f32 v34, v51, v26, v30 op_sel:[0,0,0] op_sel_hi:[1,0,0]
    v_mfma_f32_16x16x32_bf16 v[148:151], a[236:239], v[116:119], v[148:151]
    ds_read_b64_tr_b16 a[194:195], v3 offset:768
    ds_read_b64_tr_b16 a[196:197], v3 offset:17152
    v_mfma_f32_16x16x32_bf16 v[180:183], a[232:235], v[120:123], v[180:183]
    s_add_u32 m0, s44, 84480
    ds_read_b64_tr_b16 a[198:199], v3 offset:17664
    v_fma_mix_f32 v35, v51, v27, v31 op_sel:[1,0,0] op_sel_hi:[1,0,0]
    v_mfma_f32_16x16x32_bf16 v[180:183], a[236:239], v[124:127], v[180:183]
    s_waitcnt lgkmcnt(10)
    buffer_load_dwordx4 v5, s[20:23], s46 offen offset:0 lds
    v_mfma_f32_16x16x32_bf16 v[152:155], a[240:243], v[112:115], v[152:155]
    ds_read_b64_tr_b16 a[200:201], v3 offset:288
    v_cvt_pk_bf16_f32 v50, v32, v33
    v_mfma_f32_16x16x32_bf16 v[152:155], a[244:247], v[116:119], v[152:155]
    ds_read_b64_tr_b16 a[202:203], v3 offset:800
    v_cvt_pk_bf16_f32 v51, v34, v35
    v_mfma_f32_16x16x32_bf16 v[184:187], a[240:243], v[120:123], v[184:187]
    ds_read_b64_tr_b16 a[204:205], v3 offset:17184
    v_fma_mix_f32 v36, v58, v24, v28 op_sel:[0,0,0] op_sel_hi:[1,0,0]
    v_mfma_f32_16x16x32_bf16 v[184:187], a[244:247], v[124:127], v[184:187]
    s_waitcnt lgkmcnt(7)
    ds_read_b64_tr_b16 a[206:207], v3 offset:17696
    v_fma_mix_f32 v37, v58, v25, v29 op_sel:[1,0,0] op_sel_hi:[1,0,0]
    v_fma_mix_f32 v38, v59, v26, v30 op_sel:[0,0,0] op_sel_hi:[1,0,0]
    v_mfma_f32_16x16x32_bf16 v[156:159], a[248:251], v[112:115], v[156:159]
    ds_read_b64_tr_b16 a[208:209], v3 offset:320
    v_fma_mix_f32 v39, v59, v27, v31 op_sel:[1,0,0] op_sel_hi:[1,0,0]
    v_mfma_f32_16x16x32_bf16 v[156:159], a[252:255], v[116:119], v[156:159]
    ds_read_b64_tr_b16 a[210:211], v3 offset:832
    ds_read_b64_tr_b16 a[212:213], v3 offset:17216
    v_cvt_pk_bf16_f32 v58, v36, v37
    v_mfma_f32_16x16x32_bf16 v[188:191], a[248:251], v[120:123], v[188:191]
    s_add_u32 m0, s44, 84512
    ds_read_b64_tr_b16 a[214:215], v3 offset:17728
    v_cvt_pk_bf16_f32 v59, v38, v39
    v_mfma_f32_16x16x32_bf16 v[188:191], a[252:255], v[124:127], v[188:191]
    s_waitcnt lgkmcnt(8)
    buffer_load_dwordx4 v5, s[20:23], s46 offen offset:1024 lds
    v_mfma_f32_16x16x32_bf16 v[192:195], a[192:195], v[112:115], v[192:195]
    ds_read_b64_tr_b16 a[216:217], v3 offset:352
    ds_read_b128 v[24:27], v9 offset:4368
    v_mfma_f32_16x16x32_bf16 v[192:195], a[196:199], v[116:119], v[192:195]
    ds_read_b64_tr_b16 a[218:219], v3 offset:864
    ds_read_b128 v[28:31], v9 offset:4400
    v_mfma_f32_16x16x32_bf16 v[224:227], a[192:195], v[120:123], v[224:227]
    ds_read_b64_tr_b16 a[220:221], v3 offset:17248
    v_fma_mix_f32 v32, v52, v16, v20 op_sel:[0,0,0] op_sel_hi:[1,0,0]
    v_mfma_f32_16x16x32_bf16 v[224:227], a[196:199], v[124:127], v[224:227]
    s_waitcnt lgkmcnt(9)
    ds_read_b64_tr_b16 a[222:223], v3 offset:17760
    v_fma_mix_f32 v33, v52, v17, v21 op_sel:[1,0,0] op_sel_hi:[1,0,0]
    v_mfma_f32_16x16x32_bf16 v[196:199], a[200:203], v[112:115], v[196:199]
    ds_read_b64_tr_b16 a[224:225], v3 offset:384
    v_fma_mix_f32 v34, v53, v18, v22 op_sel:[0,0,0] op_sel_hi:[1,0,0]
    v_mfma_f32_16x16x32_bf16 v[196:199], a[204:207], v[116:119], v[196:199]
    ds_read_b64_tr_b16 a[226:227], v3 offset:896
    ds_read_b64_tr_b16 a[228:229], v3 offset:17280
    v_mfma_f32_16x16x32_bf16 v[228:231], a[200:203], v[120:123], v[228:231]
    s_add_u32 m0, s44, 84544
    ds_read_b64_tr_b16 a[230:231], v3 offset:17792
    v_fma_mix_f32 v35, v53, v19, v23 op_sel:[1,0,0] op_sel_hi:[1,0,0]
    v_mfma_f32_16x16x32_bf16 v[228:231], a[204:207], v[124:127], v[228:231]
    s_waitcnt lgkmcnt(10)
    buffer_load_dwordx4 v5, s[20:23], s46 offen offset:2048 lds
    v_mfma_f32_16x16x32_bf16 v[200:203], a[208:211], v[112:115], v[200:203]
    ds_read_b64_tr_b16 a[232:233], v3 offset:416
    v_cvt_pk_bf16_f32 v52, v32, v33
    v_mfma_f32_16x16x32_bf16 v[200:203], a[212:215], v[116:119], v[200:203]
    ds_read_b64_tr_b16 a[234:235], v3 offset:928
    v_cvt_pk_bf16_f32 v53, v34, v35
    v_mfma_f32_16x16x32_bf16 v[232:235], a[208:211], v[120:123], v[232:235]
    ds_read_b64_tr_b16 a[236:237], v3 offset:17312
    v_fma_mix_f32 v36, v60, v16, v20 op_sel:[0,0,0] op_sel_hi:[1,0,0]
    v_mfma_f32_16x16x32_bf16 v[232:235], a[212:215], v[124:127], v[232:235]
    s_waitcnt lgkmcnt(7)
    ds_read_b64_tr_b16 a[238:239], v3 offset:17824
    v_fma_mix_f32 v37, v60, v17, v21 op_sel:[1,0,0] op_sel_hi:[1,0,0]
    v_fma_mix_f32 v38, v61, v18, v22 op_sel:[0,0,0] op_sel_hi:[1,0,0]
    v_mfma_f32_16x16x32_bf16 v[204:207], a[216:219], v[112:115], v[204:207]
    ds_read_b64_tr_b16 a[240:241], v3 offset:448
    v_fma_mix_f32 v39, v61, v19, v23 op_sel:[1,0,0] op_sel_hi:[1,0,0]
    v_mfma_f32_16x16x32_bf16 v[204:207], a[220:223], v[116:119], v[204:207]
    ds_read_b64_tr_b16 a[242:243], v3 offset:960
    ds_read_b64_tr_b16 a[244:245], v3 offset:17344
    v_cvt_pk_bf16_f32 v60, v36, v37
    v_mfma_f32_16x16x32_bf16 v[236:239], a[216:219], v[120:123], v[236:239]
    s_add_u32 m0, s44, 84576
    ds_read_b64_tr_b16 a[246:247], v3 offset:17856
    v_cvt_pk_bf16_f32 v61, v38, v39
    v_mfma_f32_16x16x32_bf16 v[236:239], a[220:223], v[124:127], v[236:239]
    s_waitcnt lgkmcnt(8)
    buffer_load_dwordx4 v5, s[20:23], s46 offen offset:3072 lds
    v_mfma_f32_16x16x32_bf16 v[208:211], a[224:227], v[112:115], v[208:211]
    ds_read_b64_tr_b16 a[248:249], v3 offset:480
    v_fma_mix_f32 v32, v54, v24, v28 op_sel:[0,0,0] op_sel_hi:[1,0,0]
    v_mfma_f32_16x16x32_bf16 v[208:211], a[228:231], v[116:119], v[208:211]
    ds_read_b64_tr_b16 a[250:251], v3 offset:992
    v_fma_mix_f32 v33, v54, v25, v29 op_sel:[1,0,0] op_sel_hi:[1,0,0]
    v_mfma_f32_16x16x32_bf16 v[240:243], a[224:227], v[120:123], v[240:243]
    ds_read_b64_tr_b16 a[252:253], v3 offset:17376
    v_fma_mix_f32 v34, v55, v26, v30 op_sel:[0,0,0] op_sel_hi:[1,0,0]
    v_mfma_f32_16x16x32_bf16 v[240:243], a[228:231], v[124:127], v[240:243]
    s_waitcnt vmcnt(8)
    s_barrier
    s_waitcnt lgkmcnt(7)
    ds_read_b64_tr_b16 a[254:255], v3 offset:17888
    v_fma_mix_f32 v35, v55, v27, v31 op_sel:[1,0,0] op_sel_hi:[1,0,0]
    v_mfma_f32_16x16x32_bf16 v[212:215], a[232:235], v[112:115], v[212:215]
    ds_read_b64_tr_b16 a[192:193], v3 offset:33792
    v_cvt_pk_bf16_f32 v54, v32, v33
    v_mfma_f32_16x16x32_bf16 v[212:215], a[236:239], v[116:119], v[212:215]
    s_mov_b32 s46, 16384
    ds_read_b64_tr_b16 a[194:195], v3 offset:34304
    ds_read_b64_tr_b16 a[196:197], v3 offset:50688
    v_mfma_f32_16x16x32_bf16 v[244:247], a[232:235], v[120:123], v[244:247]
    s_add_u32 m0, s44, 101376
    ds_read_b64_tr_b16 a[198:199], v3 offset:51200
    v_cvt_pk_bf16_f32 v55, v34, v35
    v_mfma_f32_16x16x32_bf16 v[244:247], a[236:239], v[124:127], v[244:247]
    s_waitcnt lgkmcnt(8)
    buffer_load_dwordx4 v5, s[16:19], s46 offen offset:0 lds
    v_mfma_f32_16x16x32_bf16 v[216:219], a[240:243], v[112:115], v[216:219]
    ds_read_b64_tr_b16 a[200:201], v3 offset:33824
    v_fma_mix_f32 v36, v62, v24, v28 op_sel:[0,0,0] op_sel_hi:[1,0,0]
    v_mfma_f32_16x16x32_bf16 v[216:219], a[244:247], v[116:119], v[216:219]
    ds_read_b64_tr_b16 a[202:203], v3 offset:34336
    v_fma_mix_f32 v37, v62, v25, v29 op_sel:[1,0,0] op_sel_hi:[1,0,0]
    v_mfma_f32_16x16x32_bf16 v[248:251], a[240:243], v[120:123], v[248:251]
    ds_read_b64_tr_b16 a[204:205], v3 offset:50720
    v_fma_mix_f32 v38, v63, v26, v30 op_sel:[0,0,0] op_sel_hi:[1,0,0]
    v_mfma_f32_16x16x32_bf16 v[248:251], a[244:247], v[124:127], v[248:251]
    s_waitcnt lgkmcnt(7)
    ds_read_b64_tr_b16 a[206:207], v3 offset:51232
    v_fma_mix_f32 v39, v63, v27, v31 op_sel:[1,0,0] op_sel_hi:[1,0,0]
    v_mfma_f32_16x16x32_bf16 v[220:223], a[248:251], v[112:115], v[220:223]
    ds_read_b64_tr_b16 a[208:209], v3 offset:33856
    v_cvt_pk_bf16_f32 v62, v36, v37
    v_mfma_f32_16x16x32_bf16 v[220:223], a[252:255], v[116:119], v[220:223]
    ds_read_b64_tr_b16 a[210:211], v3 offset:34368
    ds_read_b64_tr_b16 a[212:213], v3 offset:50752
    v_mfma_f32_16x16x32_bf16 v[252:255], a[248:251], v[120:123], v[252:255]
    s_add_u32 m0, s44, 101408
    ds_read_b64_tr_b16 a[214:215], v3 offset:51264
    v_cvt_pk_bf16_f32 v63, v38, v39
    v_mfma_f32_16x16x32_bf16 v[252:255], a[252:255], v[124:127], v[252:255]
    s_waitcnt lgkmcnt(8)
    buffer_load_dwordx4 v5, s[16:19], s46 offen offset:1024 lds
    v_mfma_f32_16x16x32_bf16 v[128:131], a[192:195], v[48:51], v[128:131]
    ds_read_b64_tr_b16 a[216:217], v3 offset:33888
    v_mfma_f32_16x16x32_bf16 v[128:131], a[196:199], v[52:55], v[128:131]
    ds_read_b64_tr_b16 a[218:219], v3 offset:34400
    v_mfma_f32_16x16x32_bf16 v[160:163], a[192:195], v[56:59], v[160:163]
    ds_read_b64_tr_b16 a[220:221], v3 offset:50784
    v_mfma_f32_16x16x32_bf16 v[160:163], a[196:199], v[60:63], v[160:163]
    s_waitcnt lgkmcnt(7)
    ds_read_b64_tr_b16 a[222:223], v3 offset:51296
    v_mfma_f32_16x16x32_bf16 v[132:135], a[200:203], v[48:51], v[132:135]
    ds_read_b64_tr_b16 a[224:225], v3 offset:33920
    v_mfma_f32_16x16x32_bf16 v[132:135], a[204:207], v[52:55], v[132:135]
    ds_read_b64_tr_b16 a[226:227], v3 offset:34432
    ds_read_b64_tr_b16 a[228:229], v3 offset:50816
    v_mfma_f32_16x16x32_bf16 v[164:167], a[200:203], v[56:59], v[164:167]
    s_add_u32 m0, s44, 101440
    ds_read_b64_tr_b16 a[230:231], v3 offset:51328
    v_mfma_f32_16x16x32_bf16 v[164:167], a[204:207], v[60:63], v[164:167]
    s_waitcnt lgkmcnt(8)
    buffer_load_dwordx4 v5, s[16:19], s46 offen offset:2048 lds
    v_mfma_f32_16x16x32_bf16 v[136:139], a[208:211], v[48:51], v[136:139]
    ds_read_b64_tr_b16 a[232:233], v3 offset:33952
    v_mfma_f32_16x16x32_bf16 v[136:139], a[212:215], v[52:55], v[136:139]
    ds_read_b64_tr_b16 a[234:235], v3 offset:34464
    v_mfma_f32_16x16x32_bf16 v[168:171], a[208:211], v[56:59], v[168:171]
    ds_read_b64_tr_b16 a[236:237], v3 offset:50848
    v_mfma_f32_16x16x32_bf16 v[168:171], a[212:215], v[60:63], v[168:171]
    s_waitcnt lgkmcnt(7)
    ds_read_b64_tr_b16 a[238:239], v3 offset:51360
    v_mfma_f32_16x16x32_bf16 v[140:143], a[216:219], v[48:51], v[140:143]
    ds_read_b64_tr_b16 a[240:241], v3 offset:33984
    v_cvt_pk_bf16_f32 v64, v128, v129
    v_mfma_f32_16x16x32_bf16 v[140:143], a[220:223], v[52:55], v[140:143]
    ds_read_b64_tr_b16 a[242:243], v3 offset:34496
    ds_read_b64_tr_b16 a[244:245], v3 offset:50880
    v_mfma_f32_16x16x32_bf16 v[172:175], a[216:219], v[56:59], v[172:175]
    s_add_u32 m0, s44, 101472
    ds_read_b64_tr_b16 a[246:247], v3 offset:51392
    v_cvt_pk_bf16_f32 v65, v130, v131
    v_mfma_f32_16x16x32_bf16 v[172:175], a[220:223], v[60:63], v[172:175]
    s_waitcnt lgkmcnt(8)
    buffer_load_dwordx4 v5, s[16:19], s46 offen offset:3072 lds
    v_mfma_f32_16x16x32_bf16 v[144:147], a[224:227], v[48:51], v[144:147]
    ds_read_b64_tr_b16 a[248:249], v3 offset:34016
    v_cvt_pk_bf16_f32 v66, v132, v133
    v_mfma_f32_16x16x32_bf16 v[144:147], a[228:231], v[52:55], v[144:147]
    ds_read_b64_tr_b16 a[250:251], v3 offset:34528
    v_cvt_pk_bf16_f32 v67, v134, v135
    v_mfma_f32_16x16x32_bf16 v[176:179], a[224:227], v[56:59], v[176:179]
    ds_read_b64_tr_b16 a[252:253], v3 offset:50912
    v_cvt_pk_bf16_f32 v80, v160, v161
    v_mfma_f32_16x16x32_bf16 v[176:179], a[228:231], v[60:63], v[176:179]
    s_waitcnt lgkmcnt(7)
    ds_read_b64_tr_b16 a[254:255], v3 offset:51424
    v_cvt_pk_bf16_f32 v81, v162, v163
    v_mfma_f32_16x16x32_bf16 v[148:151], a[232:235], v[48:51], v[148:151]
    ds_read_b64_tr_b16 a[192:193], v3 offset:34048
    v_cvt_pk_bf16_f32 v82, v164, v165
    v_mfma_f32_16x16x32_bf16 v[148:151], a[236:239], v[52:55], v[148:151]
    ds_read_b64_tr_b16 a[194:195], v3 offset:34560
    ds_read_b64_tr_b16 a[196:197], v3 offset:50944
    v_mfma_f32_16x16x32_bf16 v[180:183], a[232:235], v[56:59], v[180:183]
    s_add_u32 m0, s44, 118272
    ds_read_b64_tr_b16 a[198:199], v3 offset:51456
    v_cvt_pk_bf16_f32 v83, v166, v167
    v_mfma_f32_16x16x32_bf16 v[180:183], a[236:239], v[60:63], v[180:183]
    s_waitcnt lgkmcnt(8)
    buffer_load_dwordx4 v5, s[20:23], s46 offen offset:0 lds
    v_mfma_f32_16x16x32_bf16 v[152:155], a[240:243], v[48:51], v[152:155]
    ds_read_b64_tr_b16 a[200:201], v3 offset:34080
    v_cvt_pk_bf16_f32 v68, v136, v137
    v_mfma_f32_16x16x32_bf16 v[152:155], a[244:247], v[52:55], v[152:155]
    ds_read_b64_tr_b16 a[202:203], v3 offset:34592
    v_cvt_pk_bf16_f32 v69, v138, v139
    v_mfma_f32_16x16x32_bf16 v[184:187], a[240:243], v[56:59], v[184:187]
    ds_read_b64_tr_b16 a[204:205], v3 offset:50976
    v_cvt_pk_bf16_f32 v70, v140, v141
    v_mfma_f32_16x16x32_bf16 v[184:187], a[244:247], v[60:63], v[184:187]
    s_waitcnt lgkmcnt(7)
    ds_read_b64_tr_b16 a[206:207], v3 offset:51488
    v_cvt_pk_bf16_f32 v71, v142, v143
    v_mfma_f32_16x16x32_bf16 v[156:159], a[248:251], v[48:51], v[156:159]
    ds_read_b64_tr_b16 a[208:209], v3 offset:34112
    v_cvt_pk_bf16_f32 v84, v168, v169
    v_mfma_f32_16x16x32_bf16 v[156:159], a[252:255], v[52:55], v[156:159]
    ds_read_b64_tr_b16 a[210:211], v3 offset:34624
    ds_read_b64_tr_b16 a[212:213], v3 offset:51008
    v_mfma_f32_16x16x32_bf16 v[188:191], a[248:251], v[56:59], v[188:191]
    s_add_u32 m0, s44, 118304
    ds_read_b64_tr_b16 a[214:215], v3 offset:51520
    v_cvt_pk_bf16_f32 v85, v170, v171
    v_mfma_f32_16x16x32_bf16 v[188:191], a[252:255], v[60:63], v[188:191]
    s_waitcnt lgkmcnt(8)
    buffer_load_dwordx4 v5, s[20:23], s46 offen offset:1024 lds
    v_mfma_f32_16x16x32_bf16 v[192:195], a[192:195], v[48:51], v[192:195]
    ds_read_b64_tr_b16 a[216:217], v3 offset:34144
    v_cvt_pk_bf16_f32 v86, v172, v173
    v_mfma_f32_16x16x32_bf16 v[192:195], a[196:199], v[52:55], v[192:195]
    ds_read_b64_tr_b16 a[218:219], v3 offset:34656
    v_cvt_pk_bf16_f32 v87, v174, v175
    v_mfma_f32_16x16x32_bf16 v[224:227], a[192:195], v[56:59], v[224:227]
    ds_read_b64_tr_b16 a[220:221], v3 offset:51040
    v_cvt_pk_bf16_f32 v72, v144, v145
    v_mfma_f32_16x16x32_bf16 v[224:227], a[196:199], v[60:63], v[224:227]
    s_waitcnt lgkmcnt(7)
    ds_read_b64_tr_b16 a[222:223], v3 offset:51552
    v_cvt_pk_bf16_f32 v73, v146, v147
    v_mfma_f32_16x16x32_bf16 v[196:199], a[200:203], v[48:51], v[196:199]
    ds_read_b64_tr_b16 a[224:225], v3 offset:34176
    v_cvt_pk_bf16_f32 v74, v148, v149
    v_mfma_f32_16x16x32_bf16 v[196:199], a[204:207], v[52:55], v[196:199]
    ds_read_b64_tr_b16 a[226:227], v3 offset:34688
    ds_read_b64_tr_b16 a[228:229], v3 offset:51072
    v_mfma_f32_16x16x32_bf16 v[228:231], a[200:203], v[56:59], v[228:231]
    s_add_u32 m0, s44, 118336
    ds_read_b64_tr_b16 a[230:231], v3 offset:51584
    v_cvt_pk_bf16_f32 v75, v150, v151
    v_mfma_f32_16x16x32_bf16 v[228:231], a[204:207], v[60:63], v[228:231]
    s_waitcnt lgkmcnt(8)
    buffer_load_dwordx4 v5, s[20:23], s46 offen offset:2048 lds
    v_mfma_f32_16x16x32_bf16 v[200:203], a[208:211], v[48:51], v[200:203]
    ds_read_b64_tr_b16 a[232:233], v3 offset:34208
    v_cvt_pk_bf16_f32 v88, v176, v177
    v_mfma_f32_16x16x32_bf16 v[200:203], a[212:215], v[52:55], v[200:203]
    ds_read_b64_tr_b16 a[234:235], v3 offset:34720
    v_cvt_pk_bf16_f32 v89, v178, v179
    v_mfma_f32_16x16x32_bf16 v[232:235], a[208:211], v[56:59], v[232:235]
    ds_read_b64_tr_b16 a[236:237], v3 offset:51104
    v_cvt_pk_bf16_f32 v90, v180, v181
    v_mfma_f32_16x16x32_bf16 v[232:235], a[212:215], v[60:63], v[232:235]
    s_waitcnt lgkmcnt(7)
    ds_read_b64_tr_b16 a[238:239], v3 offset:51616
    v_cvt_pk_bf16_f32 v91, v182, v183
    v_mfma_f32_16x16x32_bf16 v[204:207], a[216:219], v[48:51], v[204:207]
    ds_read_b64_tr_b16 a[240:241], v3 offset:34240
    v_cvt_pk_bf16_f32 v76, v152, v153
    v_mfma_f32_16x16x32_bf16 v[204:207], a[220:223], v[52:55], v[204:207]
    ds_read_b64_tr_b16 a[242:243], v3 offset:34752
    ds_read_b64_tr_b16 a[244:245], v3 offset:51136
    v_mfma_f32_16x16x32_bf16 v[236:239], a[216:219], v[56:59], v[236:239]
    s_add_u32 m0, s44, 118368
    ds_read_b64_tr_b16 a[246:247], v3 offset:51648
    v_cvt_pk_bf16_f32 v77, v154, v155
    v_mfma_f32_16x16x32_bf16 v[236:239], a[220:223], v[60:63], v[236:239]
    s_waitcnt lgkmcnt(8)
    buffer_load_dwordx4 v5, s[20:23], s46 offen offset:3072 lds
    v_mfma_f32_16x16x32_bf16 v[208:211], a[224:227], v[48:51], v[208:211]
    ds_read_b64_tr_b16 a[248:249], v3 offset:34272
    v_cvt_pk_bf16_f32 v78, v156, v157
    v_mfma_f32_16x16x32_bf16 v[208:211], a[228:231], v[52:55], v[208:211]
    ds_read_b64_tr_b16 a[250:251], v3 offset:34784
    v_cvt_pk_bf16_f32 v79, v158, v159
    v_mfma_f32_16x16x32_bf16 v[240:243], a[224:227], v[56:59], v[240:243]
    ds_read_b64_tr_b16 a[252:253], v3 offset:51168
    v_cvt_pk_bf16_f32 v92, v184, v185
    v_mfma_f32_16x16x32_bf16 v[240:243], a[228:231], v[60:63], v[240:243]
    s_waitcnt vmcnt(8)
    s_barrier
    s_waitcnt lgkmcnt(7)
    ds_read_b64_tr_b16 a[254:255], v3 offset:51680
    v_cvt_pk_bf16_f32 v93, v186, v187
    v_mfma_f32_16x16x32_bf16 v[212:215], a[232:235], v[48:51], v[212:215]
    ds_read_b128 a[64:67], v1 offset:0
    v_cvt_pk_bf16_f32 v94, v188, v189
    v_mfma_f32_16x16x32_bf16 v[212:215], a[236:239], v[52:55], v[212:215]
    s_mov_b32 s46, 32768
    ds_read_b128 a[68:71], v1 offset:64
    v_cvt_pk_bf16_f32 v95, v190, v191
    v_mfma_f32_16x16x32_bf16 v[244:247], a[232:235], v[56:59], v[244:247]
    s_add_u32 m0, s44, 0
    ds_read_b128 a[72:75], v1 offset:128
    v_cvt_pk_bf16_f32 v96, v192, v193
    v_mfma_f32_16x16x32_bf16 v[244:247], a[236:239], v[60:63], v[244:247]
    s_waitcnt lgkmcnt(7)
    buffer_load_dwordx4 v5, s[16:19], s46 offen offset:0 lds
    v_mfma_f32_16x16x32_bf16 v[216:219], a[240:243], v[48:51], v[216:219]
    ds_read_b128 a[76:79], v1 offset:192
    v_cvt_pk_bf16_f32 v97, v194, v195
    v_mfma_f32_16x16x32_bf16 v[216:219], a[244:247], v[52:55], v[216:219]
    ds_read_b128 a[80:83], v1 offset:256
    v_cvt_pk_bf16_f32 v98, v196, v197
    v_mfma_f32_16x16x32_bf16 v[248:251], a[240:243], v[56:59], v[248:251]
    ds_read_b128 a[84:87], v1 offset:320
    v_cvt_pk_bf16_f32 v99, v198, v199
    v_mfma_f32_16x16x32_bf16 v[248:251], a[244:247], v[60:63], v[248:251]
    s_waitcnt lgkmcnt(6)
    ds_read_b128 a[88:91], v1 offset:384
    v_cvt_pk_bf16_f32 v112, v224, v225
    v_mfma_f32_16x16x32_bf16 v[220:223], a[248:251], v[48:51], v[220:223]
    ds_read_b128 a[92:95], v1 offset:448
    v_cvt_pk_bf16_f32 v113, v226, v227
    v_mfma_f32_16x16x32_bf16 v[220:223], a[252:255], v[52:55], v[220:223]
    ds_read_b128 a[96:99], v1 offset:512
    v_cvt_pk_bf16_f32 v114, v228, v229
    v_mfma_f32_16x16x32_bf16 v[252:255], a[248:251], v[56:59], v[252:255]
    s_add_u32 m0, s44, 32
    ds_read_b128 a[100:103], v1 offset:576
    v_cvt_pk_bf16_f32 v115, v230, v231
    v_mfma_f32_16x16x32_bf16 v[252:255], a[252:255], v[60:63], v[252:255]
    buffer_load_dwordx4 v5, s[16:19], s46 offen offset:1024 lds
    s_add_u32 m0, s44, 64
    s_nop 0
    buffer_load_dwordx4 v5, s[16:19], s46 offen offset:2048 lds
    s_add_u32 m0, s44, 96
    s_nop 0
    buffer_load_dwordx4 v5, s[16:19], s46 offen offset:3072 lds
    s_add_u32 m0, s44, 16896
    s_nop 0
    buffer_load_dwordx4 v5, s[20:23], s46 offen offset:0 lds
    s_add_u32 m0, s44, 16928
    s_nop 0
    buffer_load_dwordx4 v5, s[20:23], s46 offen offset:1024 lds
    s_add_u32 m0, s44, 16960
    s_nop 0
    buffer_load_dwordx4 v5, s[20:23], s46 offen offset:2048 lds
    s_add_u32 m0, s44, 16992
    s_nop 0
    buffer_load_dwordx4 v5, s[20:23], s46 offen offset:3072 lds
    ds_read_b128 a[104:107], v1 offset:640
    ds_read_b128 a[108:111], v1 offset:704
    ds_read_b128 a[112:115], v1 offset:768
    ds_read_b128 a[116:119], v1 offset:832
    ds_read_b128 a[120:123], v1 offset:896
    ds_read_b128 a[124:127], v1 offset:960
    ds_read_b64_tr_b16 a[128:129], v2 offset:0
    ds_read_b64_tr_b16 a[130:131], v2 offset:256
    ds_read_b64_tr_b16 a[132:133], v2 offset:512
    ds_read_b64_tr_b16 a[134:135], v2 offset:768
    ds_read_b64_tr_b16 a[136:137], v2 offset:32
    ds_read_b64_tr_b16 a[138:139], v2 offset:288
    ds_read_b64_tr_b16 a[140:141], v2 offset:544
    ds_read_b64_tr_b16 a[142:143], v2 offset:800
    ds_read_b64_tr_b16 a[144:145], v2 offset:64
    ds_read_b64_tr_b16 a[146:147], v2 offset:320
    ds_read_b64_tr_b16 a[148:149], v2 offset:576
    ds_read_b64_tr_b16 a[150:151], v2 offset:832
    ds_read_b64_tr_b16 a[152:153], v2 offset:96
    ds_read_b64_tr_b16 a[154:155], v2 offset:352
    ds_read_b64_tr_b16 a[156:157], v2 offset:608
    ds_read_b64_tr_b16 a[158:159], v2 offset:864
    ds_read_b64_tr_b16 a[160:161], v2 offset:128
    ds_read_b64_tr_b16 a[162:163], v2 offset:384
    ds_read_b64_tr_b16 a[164:165], v2 offset:640
    ds_read_b64_tr_b16 a[166:167], v2 offset:896
    ds_read_b64_tr_b16 a[168:169], v2 offset:160
    ds_read_b64_tr_b16 a[170:171], v2 offset:416
    ds_read_b64_tr_b16 a[172:173], v2 offset:672
    ds_read_b64_tr_b16 a[174:175], v2 offset:928
    ds_read_b64_tr_b16 a[176:177], v2 offset:192
    ds_read_b64_tr_b16 a[178:179], v2 offset:448
    ds_read_b64_tr_b16 a[180:181], v2 offset:704
    ds_read_b64_tr_b16 a[182:183], v2 offset:960
    ds_read_b64_tr_b16 a[184:185], v2 offset:224
    ds_read_b64_tr_b16 a[186:187], v2 offset:480
    ds_read_b64_tr_b16 a[188:189], v2 offset:736
    ds_read_b64_tr_b16 a[190:191], v2 offset:992
    v_cvt_pk_bf16_f32 v100, v200, v201
    v_cvt_pk_bf16_f32 v101, v202, v203
    v_cvt_pk_bf16_f32 v102, v204, v205
    v_cvt_pk_bf16_f32 v103, v206, v207
    v_cvt_pk_bf16_f32 v116, v232, v233
    v_cvt_pk_bf16_f32 v117, v234, v235
    v_cvt_pk_bf16_f32 v118, v236, v237
    v_cvt_pk_bf16_f32 v119, v238, v239
    v_cvt_pk_bf16_f32 v104, v208, v209
    v_cvt_pk_bf16_f32 v105, v210, v211
    v_cvt_pk_bf16_f32 v106, v212, v213
    v_cvt_pk_bf16_f32 v107, v214, v215
    v_cvt_pk_bf16_f32 v120, v240, v241
    v_cvt_pk_bf16_f32 v121, v242, v243
    v_cvt_pk_bf16_f32 v122, v244, v245
    v_cvt_pk_bf16_f32 v123, v246, v247
    v_cvt_pk_bf16_f32 v108, v216, v217
    v_cvt_pk_bf16_f32 v109, v218, v219
    v_cvt_pk_bf16_f32 v110, v220, v221
    v_cvt_pk_bf16_f32 v111, v222, v223
    v_cvt_pk_bf16_f32 v124, v248, v249
    v_cvt_pk_bf16_f32 v125, v250, v251
    v_cvt_pk_bf16_f32 v126, v252, v253
    v_cvt_pk_bf16_f32 v127, v254, v255
    s_nop 0
    v_permlane32_swap_b32 v64, v66
    v_permlane32_swap_b32 v65, v67
    v_permlane32_swap_b32 v80, v82
    v_permlane32_swap_b32 v81, v83
    v_permlane32_swap_b32 v68, v70
    v_permlane32_swap_b32 v69, v71
    v_permlane32_swap_b32 v84, v86
    v_permlane32_swap_b32 v85, v87
    v_permlane32_swap_b32 v72, v74
    v_permlane32_swap_b32 v73, v75
    v_permlane32_swap_b32 v88, v90
    v_permlane32_swap_b32 v89, v91
    v_permlane32_swap_b32 v76, v78
    v_permlane32_swap_b32 v77, v79
    v_permlane32_swap_b32 v92, v94
    v_permlane32_swap_b32 v93, v95
    v_permlane32_swap_b32 v96, v98
    v_permlane32_swap_b32 v97, v99
    v_permlane32_swap_b32 v112, v114
    v_permlane32_swap_b32 v113, v115
    v_permlane32_swap_b32 v100, v102
    v_permlane32_swap_b32 v101, v103
    v_permlane32_swap_b32 v116, v118
    v_permlane32_swap_b32 v117, v119
    v_permlane32_swap_b32 v104, v106
    v_permlane32_swap_b32 v105, v107
    v_permlane32_swap_b32 v120, v122
    v_permlane32_swap_b32 v121, v123
    v_permlane32_swap_b32 v108, v110
    v_permlane32_swap_b32 v109, v111
    v_permlane32_swap_b32 v124, v126
    v_permlane32_swap_b32 v125, v127
    s_waitcnt lgkmcnt(15)
    v_mfma_f32_16x16x32_bf16 v[16:19], a[64:67], v[64:67], 0
    v_mfma_f32_16x16x32_bf16 v[16:19], a[68:71], v[68:71], v[16:19]
    v_mfma_f32_16x16x32_bf16 v[16:19], a[72:75], v[72:75], v[16:19]
    v_mfma_f32_16x16x32_bf16 v[16:19], a[76:79], v[76:79], v[16:19]
    v_mfma_f32_16x16x32_bf16 v[20:23], a[64:67], v[80:83], 0
    v_mfma_f32_16x16x32_bf16 v[20:23], a[68:71], v[84:87], v[20:23]
    v_mfma_f32_16x16x32_bf16 v[20:23], a[72:75], v[88:91], v[20:23]
    v_mfma_f32_16x16x32_bf16 v[20:23], a[76:79], v[92:95], v[20:23]
    v_mfma_f32_16x16x32_bf16 v[24:27], a[64:67], v[96:99], 0
    v_mfma_f32_16x16x32_bf16 v[24:27], a[68:71], v[100:103], v[24:27]
    v_mfma_f32_16x16x32_bf16 v[24:27], a[72:75], v[104:107], v[24:27]
    v_mfma_f32_16x16x32_bf16 v[24:27], a[76:79], v[108:111], v[24:27]
    v_mfma_f32_16x16x32_bf16 v[28:31], a[64:67], v[112:115], 0
    v_mfma_f32_16x16x32_bf16 v[28:31], a[68:71], v[116:119], v[28:31]
    v_mfma_f32_16x16x32_bf16 v[28:31], a[72:75], v[120:123], v[28:31]
    v_mfma_f32_16x16x32_bf16 v[28:31], a[76:79], v[124:127], v[28:31]
    s_nop 1
    v_max3_f32 v16, v16, v17, v18
    v_max_f32 v16, v16, v19
    v_max3_f32 v20, v20, v21, v22
    v_max_f32 v20, v20, v23
    v_max3_f32 v24, v24, v25, v26
    v_max_f32 v24, v24, v27
    v_max3_f32 v28, v28, v29, v30
    v_max_f32 v28, v28, v31
    v_mov_b32 v12, v16
    v_mov_b32 v13, v20
    v_mov_b32 v14, v24
    v_mov_b32 v15, v28
    v_permlane16_swap_b32 v12, v16
    v_permlane16_swap_b32 v13, v20
    v_permlane16_swap_b32 v14, v24
    v_permlane16_swap_b32 v15, v28
    v_max_f32 v16, v16, v12
    v_max_f32 v20, v20, v13
    v_max_f32 v24, v24, v14
    v_max_f32 v28, v28, v15
    v_mov_b32 v12, v16
    v_mov_b32 v13, v20
    v_mov_b32 v14, v24
    v_mov_b32 v15, v28
    v_permlane32_swap_b32 v12, v16
    v_permlane32_swap_b32 v13, v20
    v_permlane32_swap_b32 v14, v24
    v_permlane32_swap_b32 v15, v28
    v_max_f32 v16, v16, v12
    v_max_f32 v20, v20, v13
    v_max_f32 v24, v24, v14
    v_max_f32 v28, v28, v15
    v_sub_f32 v48, 0xc2000000, v16
    v_sub_f32 v49, 0xc2000000, v16
    v_sub_f32 v50, 0xc2000000, v16
    v_sub_f32 v51, 0xc2000000, v16
    v_sub_f32 v52, 0xc2000000, v20
    v_sub_f32 v53, 0xc2000000, v20
    v_sub_f32 v54, 0xc2000000, v20
    v_sub_f32 v55, 0xc2000000, v20
    v_sub_f32 v56, 0xc2000000, v24
    v_sub_f32 v57, 0xc2000000, v24
    v_sub_f32 v58, 0xc2000000, v24
    v_sub_f32 v59, 0xc2000000, v24
    v_sub_f32 v60, 0xc2000000, v28
    v_sub_f32 v61, 0xc2000000, v28
    v_sub_f32 v62, 0xc2000000, v28
    v_sub_f32 v63, 0xc2000000, v28
L2_entry:
    v_accvgpr_write_b32 a0, 0
    v_accvgpr_write_b32 a1, 0
    v_accvgpr_write_b32 a2, 0
    v_accvgpr_write_b32 a3, 0
    v_accvgpr_write_b32 a4, 0
    v_accvgpr_write_b32 a5, 0
    v_accvgpr_write_b32 a6, 0
    v_accvgpr_write_b32 a7, 0
    v_accvgpr_write_b32 a8, 0
    v_accvgpr_write_b32 a9, 0
    v_accvgpr_write_b32 a10, 0
    v_accvgpr_write_b32 a11, 0
    v_accvgpr_write_b32 a12, 0
    v_accvgpr_write_b32 a13, 0
    v_accvgpr_write_b32 a14, 0
    v_accvgpr_write_b32 a15, 0
    v_mov_b32 v224, 0
    v_mov_b32 v225, 0
    v_mov_b32 v226, 0
    v_mov_b32 v227, 0
    v_mov_b32 v228, 0
    v_mov_b32 v229, 0
    v_mov_b32 v230, 0
    v_mov_b32 v231, 0
    v_mov_b32 v232, 0
    v_mov_b32 v233, 0
    v_mov_b32 v234, 0
    v_mov_b32 v235, 0
    v_mov_b32 v236, 0
    v_mov_b32 v237, 0
    v_mov_b32 v238, 0
    v_mov_b32 v239, 0
    v_mov_b32 v240, 0
    v_mov_b32 v241, 0
    v_mov_b32 v242, 0
    v_mov_b32 v243, 0
    v_mov_b32 v244, 0
    v_mov_b32 v245, 0
    v_mov_b32 v246, 0
    v_mov_b32 v247, 0
    v_mov_b32 v248, 0
    v_mov_b32 v249, 0
    v_mov_b32 v250, 0
    v_mov_b32 v251, 0
    v_mov_b32 v252, 0
    v_mov_b32 v253, 0
    v_mov_b32 v254, 0
    v_mov_b32 v255, 0
    s_mov_b32 s47, s44
    s_mov_b32 s48, -67584
    s_mov_b32 s49, 15
    s_mov_b32 s46, 49152
    s_waitcnt vmcnt(8) lgkmcnt(0)
    s_barrier
    v_mfma_f32_16x16x32_bf16 v[16:19], a[64:67], v[64:67], v[48:51]
    v_mfma_f32_16x16x32_bf16 v[16:19], a[68:71], v[68:71], v[16:19]
    v_mfma_f32_16x16x32_bf16 v[16:19], a[72:75], v[72:75], v[16:19]
    s_add_u32 m0, s47, 33792
    v_mfma_f32_16x16x32_bf16 v[16:19], a[76:79], v[76:79], v[16:19]
    buffer_load_dwordx4 v5, s[16:19], s46 offen offset:0 lds
    v_mfma_f32_16x16x32_bf16 v[20:23], a[80:83], v[64:67], v[48:51]
    v_mfma_f32_16x16x32_bf16 v[20:23], a[84:87], v[68:71], v[20:23]
    v_mfma_f32_16x16x32_bf16 v[20:23], a[88:91], v[72:75], v[20:23]
    s_add_u32 m0, s47, 33824
    v_mfma_f32_16x16x32_bf16 v[20:23], a[92:95], v[76:79], v[20:23]
    buffer_load_dwordx4 v5, s[16:19], s46 offen offset:1024 lds
    v_mfma_f32_16x16x32_bf16 v[24:27], a[96:99], v[64:67], v[48:51]
    v_exp_f32 v16, v16
    v_mfma_f32_16x16x32_bf16 v[24:27], a[100:103], v[68:71], v[24:27]
    v_mfma_f32_16x16x32_bf16 v[24:27], a[104:107], v[72:75], v[24:27]
    s_add_u32 m0, s47, 33856
    v_exp_f32 v17, v17
    v_mfma_f32_16x16x32_bf16 v[24:27], a[108:111], v[76:79], v[24:27]
    buffer_load_dwordx4 v5, s[16:19], s46 offen offset:2048 lds
    v_mfma_f32_16x16x32_bf16 v[28:31], a[112:115], v[64:67], v[48:51]
    v_exp_f32 v18, v18
    v_mfma_f32_16x16x32_bf16 v[28:31], a[116:119], v[68:71], v[28:31]
    v_cvt_pk_bf16_f32 v32, v16, v17
    v_mfma_f32_16x16x32_bf16 v[28:31], a[120:123], v[72:75], v[28:31]
    s_add_u32 m0, s47, 33888
    v_exp_f32 v19, v19
    v_mfma_f32_16x16x32_bf16 v[28:31], a[124:127], v[76:79], v[28:31]
    buffer_load_dwordx4 v5, s[16:19], s46 offen offset:3072 lds
    s_nop 3
    v_exp_f32 v20, v20
    s_nop 0
    ds_read_b64_tr_b16 a[192:193], v2 offset:33792
    v_cvt_pk_bf16_f32 v33, v18, v19
    s_add_u32 m0, s47, 50688
    v_exp_f32 v21, v21
    s_nop 0
    buffer_load_dwordx4 v5, s[20:23], s46 offen offset:0 lds
    v_exp_f32 v22, v22
    s_nop 0
    ds_read_b64_tr_b16 a[194:195], v2 offset:34048
    v_cvt_pk_bf16_f32 v34, v20, v21
    s_add_u32 m0, s47, 50720
    v_exp_f32 v23, v23
    s_nop 0
    buffer_load_dwordx4 v5, s[20:23], s46 offen offset:1024 lds
    v_exp_f32 v24, v24
    s_nop 0
    ds_read_b64_tr_b16 a[196:197], v2 offset:34304
    v_cvt_pk_bf16_f32 v35, v22, v23
    s_add_u32 m0, s47, 50752
    v_exp_f32 v25, v25
    s_nop 0
    buffer_load_dwordx4 v5, s[20:23], s46 offen offset:2048 lds
    v_exp_f32 v26, v26
    s_nop 0
    ds_read_b64_tr_b16 a[198:199], v2 offset:34560
    v_cvt_pk_bf16_f32 v36, v24, v25
    s_add_u32 m0, s47, 50784
    v_exp_f32 v27, v27
    s_nop 0
    buffer_load_dwordx4 v5, s[20:23], s46 offen offset:3072 lds
    ds_read_b64_tr_b16 a[200:201], v2 offset:33824
    s_nop 0
    v_mfma_f32_16x16x32_bf16 v[16:19], a[64:67], v[80:83], v[52:55]
    v_exp_f32 v28, v28
    v_mfma_f32_16x16x32_bf16 v[16:19], a[68:71], v[84:87], v[16:19]
    ds_read_b64_tr_b16 a[202:203], v2 offset:34080
    v_cvt_pk_bf16_f32 v37, v26, v27
    v_mfma_f32_16x16x32_bf16 v[16:19], a[72:75], v[88:91], v[16:19]
    v_exp_f32 v29, v29
    v_mfma_f32_16x16x32_bf16 v[16:19], a[76:79], v[92:95], v[16:19]
    ds_read_b64_tr_b16 a[204:205], v2 offset:34336
    v_mfma_f32_16x16x32_bf16 v[20:23], a[80:83], v[80:83], v[52:55]
    v_exp_f32 v30, v30
    v_mfma_f32_16x16x32_bf16 v[20:23], a[84:87], v[84:87], v[20:23]
    ds_read_b64_tr_b16 a[206:207], v2 offset:34592
    v_cvt_pk_bf16_f32 v38, v28, v29
    v_mfma_f32_16x16x32_bf16 v[20:23], a[88:91], v[88:91], v[20:23]
    v_exp_f32 v31, v31
    v_mfma_f32_16x16x32_bf16 v[20:23], a[92:95], v[92:95], v[20:23]
    ds_read_b64_tr_b16 a[208:209], v2 offset:33856
    v_mfma_f32_16x16x32_bf16 v[24:27], a[96:99], v[80:83], v[52:55]
    v_exp_f32 v16, v16
    v_mfma_f32_16x16x32_bf16 v[24:27], a[100:103], v[84:87], v[24:27]
    ds_read_b64_tr_b16 a[210:211], v2 offset:34112
    v_cvt_pk_bf16_f32 v39, v30, v31
    v_mfma_f32_16x16x32_bf16 v[24:27], a[104:107], v[88:91], v[24:27]
    v_exp_f32 v17, v17
    v_mfma_f32_16x16x32_bf16 v[24:27], a[108:111], v[92:95], v[24:27]
    ds_read_b64_tr_b16 a[212:213], v2 offset:34368
    v_mfma_f32_16x16x32_bf16 v[28:31], a[112:115], v[80:83], v[52:55]
    v_exp_f32 v18, v18
    v_mfma_f32_16x16x32_bf16 v[28:31], a[116:119], v[84:87], v[28:31]
    ds_read_b64_tr_b16 a[214:215], v2 offset:34624
    v_cvt_pk_bf16_f32 v40, v16, v17
    v_mfma_f32_16x16x32_bf16 v[28:31], a[120:123], v[88:91], v[28:31]
    v_exp_f32 v19, v19
    v_mfma_f32_16x16x32_bf16 v[28:31], a[124:127], v[92:95], v[28:31]
    ds_read_b64_tr_b16 a[216:217], v2 offset:33888
    v_mfma_f32_16x16x32_bf16 v[128:131], a[128:131], v[32:35], 0
    v_exp_f32 v20, v20
    v_mfma_f32_16x16x32_bf16 v[128:131], a[132:135], v[36:39], v[128:131]
    ds_read_b64_tr_b16 a[218:219], v2 offset:34144
    v_cvt_pk_bf16_f32 v41, v18, v19
    v_mfma_f32_16x16x32_bf16 v[132:135], a[136:139], v[32:35], 0
    v_exp_f32 v21, v21
    v_mfma_f32_16x16x32_bf16 v[132:135], a[140:143], v[36:39], v[132:135]
    ds_read_b64_tr_b16 a[220:221], v2 offset:34400
    v_mfma_f32_16x16x32_bf16 v[136:139], a[144:147], v[32:35], 0
    v_exp_f32 v22, v22
    v_mfma_f32_16x16x32_bf16 v[136:139], a[148:151], v[36:39], v[136:139]
    ds_read_b64_tr_b16 a[222:223], v2 offset:34656
    v_cvt_pk_bf16_f32 v42, v20, v21
    v_mfma_f32_16x16x32_bf16 v[140:143], a[152:155], v[32:35], 0
    v_exp_f32 v23, v23
    v_mfma_f32_16x16x32_bf16 v[140:143], a[156:159], v[36:39], v[140:143]
    ds_read_b64_tr_b16 a[224:225], v2 offset:33920
    v_mfma_f32_16x16x32_bf16 v[144:147], a[160:163], v[32:35], 0
    v_exp_f32 v24, v24
    v_mfma_f32_16x16x32_bf16 v[144:147], a[164:167], v[36:39], v[144:147]
    ds_read_b64_tr_b16 a[226:227], v2 offset:34176
    v_cvt_pk_bf16_f32 v43, v22, v23
    v_mfma_f32_16x16x32_bf16 v[148:151], a[168:171], v[32:35], 0
    v_exp_f32 v25, v25
    v_mfma_f32_16x16x32_bf16 v[148:151], a[172:175], v[36:39], v[148:151]
    ds_read_b64_tr_b16 a[228:229], v2 offset:34432
    v_mfma_f32_16x16x32_bf16 v[152:155], a[176:179], v[32:35], 0
    v_exp_f32 v26, v26
    v_mfma_f32_16x16x32_bf16 v[152:155], a[180:183], v[36:39], v[152:155]
    ds_read_b64_tr_b16 a[230:231], v2 offset:34688
    v_cvt_pk_bf16_f32 v44, v24, v25
    v_mfma_f32_16x16x32_bf16 v[156:159], a[184:187], v[32:35], 0
    v_exp_f32 v27, v27
    v_mfma_f32_16x16x32_bf16 v[156:159], a[188:191], v[36:39], v[156:159]
    ds_read_b64_tr_b16 a[232:233], v2 offset:33952
    v_smfmac_f32_16x16x64_bf16 a[0:3], a[16:19], v[32:39], v11
    ds_read_b64_tr_b16 a[234:235], v2 offset:34208
    v_mfma_f32_16x16x32_bf16 v[16:19], a[64:67], v[96:99], v[56:59]
    v_exp_f32 v28, v28
    v_mfma_f32_16x16x32_bf16 v[16:19], a[68:71], v[100:103], v[16:19]
    ds_read_b64_tr_b16 a[236:237], v2 offset:34464
    v_cvt_pk_bf16_f32 v45, v26, v27
    v_mfma_f32_16x16x32_bf16 v[16:19], a[72:75], v[104:107], v[16:19]
    v_exp_f32 v29, v29
    v_mfma_f32_16x16x32_bf16 v[16:19], a[76:79], v[108:111], v[16:19]
    ds_read_b64_tr_b16 a[238:239], v2 offset:34720
    v_mfma_f32_16x16x32_bf16 v[20:23], a[80:83], v[96:99], v[56:59]
    v_exp_f32 v30, v30
    v_mfma_f32_16x16x32_bf16 v[20:23], a[84:87], v[100:103], v[20:23]
    ds_read_b64_tr_b16 a[240:241], v2 offset:33984
    v_cvt_pk_bf16_f32 v46, v28, v29
    v_mfma_f32_16x16x32_bf16 v[20:23], a[88:91], v[104:107], v[20:23]
    v_exp_f32 v31, v31
    v_mfma_f32_16x16x32_bf16 v[20:23], a[92:95], v[108:111], v[20:23]
    ds_read_b64_tr_b16 a[242:243], v2 offset:34240
    v_mfma_f32_16x16x32_bf16 v[24:27], a[96:99], v[96:99], v[56:59]
    v_exp_f32 v16, v16
    v_mfma_f32_16x16x32_bf16 v[24:27], a[100:103], v[100:103], v[24:27]
    ds_read_b64_tr_b16 a[244:245], v2 offset:34496
    v_cvt_pk_bf16_f32 v47, v30, v31
    v_mfma_f32_16x16x32_bf16 v[24:27], a[104:107], v[104:107], v[24:27]
    v_exp_f32 v17, v17
    v_mfma_f32_16x16x32_bf16 v[24:27], a[108:111], v[108:111], v[24:27]
    ds_read_b64_tr_b16 a[246:247], v2 offset:34752
    v_mfma_f32_16x16x32_bf16 v[28:31], a[112:115], v[96:99], v[56:59]
    v_exp_f32 v18, v18
    v_mfma_f32_16x16x32_bf16 v[28:31], a[116:119], v[100:103], v[28:31]
    ds_read_b64_tr_b16 a[248:249], v2 offset:34016
    v_cvt_pk_bf16_f32 v32, v16, v17
    v_mfma_f32_16x16x32_bf16 v[28:31], a[120:123], v[104:107], v[28:31]
    v_exp_f32 v19, v19
    v_mfma_f32_16x16x32_bf16 v[28:31], a[124:127], v[108:111], v[28:31]
    ds_read_b64_tr_b16 a[250:251], v2 offset:34272
    v_mfma_f32_16x16x32_bf16 v[160:163], a[128:131], v[40:43], 0
    v_exp_f32 v20, v20
    v_mfma_f32_16x16x32_bf16 v[160:163], a[132:135], v[44:47], v[160:163]
    ds_read_b64_tr_b16 a[252:253], v2 offset:34528
    v_cvt_pk_bf16_f32 v33, v18, v19
    v_mfma_f32_16x16x32_bf16 v[164:167], a[136:139], v[40:43], 0
    v_exp_f32 v21, v21
    v_mfma_f32_16x16x32_bf16 v[164:167], a[140:143], v[44:47], v[164:167]
    ds_read_b64_tr_b16 a[254:255], v2 offset:34784
    v_mfma_f32_16x16x32_bf16 v[168:171], a[144:147], v[40:43], 0
    v_exp_f32 v22, v22
    v_mfma_f32_16x16x32_bf16 v[168:171], a[148:151], v[44:47], v[168:171]
    v_cvt_pk_bf16_f32 v34, v20, v21
    v_mfma_f32_16x16x32_bf16 v[172:175], a[152:155], v[40:43], 0
    v_exp_f32 v23, v23
    v_mfma_f32_16x16x32_bf16 v[172:175], a[156:159], v[44:47], v[172:175]
    v_mfma_f32_16x16x32_bf16 v[176:179], a[160:163], v[40:43], 0
    v_exp_f32 v24, v24
    v_mfma_f32_16x16x32_bf16 v[176:179], a[164:167], v[44:47], v[176:179]
    v_cvt_pk_bf16_f32 v35, v22, v23
    v_mfma_f32_16x16x32_bf16 v[180:183], a[168:171], v[40:43], 0
    v_exp_f32 v25, v25
    v_mfma_f32_16x16x32_bf16 v[180:183], a[172:175], v[44:47], v[180:183]
    v_mfma_f32_16x16x32_bf16 v[184:187], a[176:179], v[40:43], 0
    v_exp_f32 v26, v26
    v_mfma_f32_16x16x32_bf16 v[184:187], a[180:183], v[44:47], v[184:187]
    v_cvt_pk_bf16_f32 v36, v24, v25
    v_mfma_f32_16x16x32_bf16 v[188:191], a[184:187], v[40:43], 0
    v_exp_f32 v27, v27
    v_mfma_f32_16x16x32_bf16 v[188:191], a[188:191], v[44:47], v[188:191]
    v_smfmac_f32_16x16x64_bf16 a[4:7], a[16:19], v[40:47], v11
    v_mfma_f32_16x16x32_bf16 v[16:19], a[64:67], v[112:115], v[60:63]
    v_exp_f32 v28, v28
    v_mfma_f32_16x16x32_bf16 v[16:19], a[68:71], v[116:119], v[16:19]
    s_add_u32 s46, s46, 16384
    ds_read_b128 a[64:67], v1 offset:33792
    v_cvt_pk_bf16_f32 v37, v26, v27
    v_mfma_f32_16x16x32_bf16 v[16:19], a[72:75], v[120:123], v[16:19]
    s_min_u32 s46, s46, 507904
    v_exp_f32 v29, v29
    v_mfma_f32_16x16x32_bf16 v[16:19], a[76:79], v[124:127], v[16:19]
    ds_read_b128 a[68:71], v1 offset:33856
    v_mfma_f32_16x16x32_bf16 v[20:23], a[80:83], v[112:115], v[60:63]
    v_exp_f32 v30, v30
    v_mfma_f32_16x16x32_bf16 v[20:23], a[84:87], v[116:119], v[20:23]
    ds_read_b128 a[72:75], v1 offset:33920
    v_cvt_pk_bf16_f32 v38, v28, v29
    v_mfma_f32_16x16x32_bf16 v[20:23], a[88:91], v[120:123], v[20:23]
    v_exp_f32 v31, v31
    v_mfma_f32_16x16x32_bf16 v[20:23], a[92:95], v[124:127], v[20:23]
    ds_read_b128 a[76:79], v1 offset:33984
    v_mfma_f32_16x16x32_bf16 v[24:27], a[96:99], v[112:115], v[60:63]
    v_exp_f32 v16, v16
    v_mfma_f32_16x16x32_bf16 v[24:27], a[100:103], v[116:119], v[24:27]
    ds_read_b128 a[80:83], v1 offset:34048
    v_cvt_pk_bf16_f32 v39, v30, v31
    v_mfma_f32_16x16x32_bf16 v[24:27], a[104:107], v[120:123], v[24:27]
    v_exp_f32 v17, v17
    v_mfma_f32_16x16x32_bf16 v[24:27], a[108:111], v[124:127], v[24:27]
    ds_read_b128 a[84:87], v1 offset:34112
    v_mfma_f32_16x16x32_bf16 v[28:31], a[112:115], v[112:115], v[60:63]
    v_exp_f32 v18, v18
    v_mfma_f32_16x16x32_bf16 v[28:31], a[116:119], v[116:119], v[28:31]
    ds_read_b128 a[88:91], v1 offset:34176
    v_cvt_pk_bf16_f32 v40, v16, v17
    v_mfma_f32_16x16x32_bf16 v[28:31], a[120:123], v[120:123], v[28:31]
    v_exp_f32 v19, v19
    v_mfma_f32_16x16x32_bf16 v[28:31], a[124:127], v[124:127], v[28:31]
    ds_read_b128 a[92:95], v1 offset:34240
    v_mfma_f32_16x16x32_bf16 v[192:195], a[128:131], v[32:35], 0
    v_exp_f32 v20, v20
    v_mfma_f32_16x16x32_bf16 v[192:195], a[132:135], v[36:39], v[192:195]
    ds_read_b128 a[96:99], v1 offset:34304
    v_cvt_pk_bf16_f32 v41, v18, v19
    v_mfma_f32_16x16x32_bf16 v[196:199], a[136:139], v[32:35], 0
    v_exp_f32 v21, v21
    v_mfma_f32_16x16x32_bf16 v[196:199], a[140:143], v[36:39], v[196:199]
    ds_read_b128 a[100:103], v1 offset:34368
    v_mfma_f32_16x16x32_bf16 v[200:203], a[144:147], v[32:35], 0
    v_exp_f32 v22, v22
    v_mfma_f32_16x16x32_bf16 v[200:203], a[148:151], v[36:39], v[200:203]
    ds_read_b128 a[104:107], v1 offset:34432
    v_cvt_pk_bf16_f32 v42, v20, v21
    v_mfma_f32_16x16x32_bf16 v[204:207], a[152:155], v[32:35], 0
    v_exp_f32 v23, v23
    v_mfma_f32_16x16x32_bf16 v[204:207], a[156:159], v[36:39], v[204:207]
    ds_read_b128 a[108:111], v1 offset:34496
    v_mfma_f32_16x16x32_bf16 v[208:211], a[160:163], v[32:35], 0
    v_exp_f32 v24, v24
    v_mfma_f32_16x16x32_bf16 v[208:211], a[164:167], v[36:39], v[208:211]
    ds_read_b128 a[112:115], v1 offset:34560
    v_cvt_pk_bf16_f32 v43, v22, v23
    v_mfma_f32_16x16x32_bf16 v[212:215], a[168:171], v[32:35], 0
    v_exp_f32 v25, v25
    v_mfma_f32_16x16x32_bf16 v[212:215], a[172:175], v[36:39], v[212:215]
    ds_read_b128 a[116:119], v1 offset:34624
    v_mfma_f32_16x16x32_bf16 v[216:219], a[176:179], v[32:35], 0
    v_exp_f32 v26, v26
    v_mfma_f32_16x16x32_bf16 v[216:219], a[180:183], v[36:39], v[216:219]
    ds_read_b128 a[120:123], v1 offset:34688
    v_cvt_pk_bf16_f32 v44, v24, v25
    v_mfma_f32_16x16x32_bf16 v[220:223], a[184:187], v[32:35], 0
    v_exp_f32 v27, v27
    v_mfma_f32_16x16x32_bf16 v[220:223], a[188:191], v[36:39], v[220:223]
    ds_read_b128 a[124:127], v1 offset:34752
    v_smfmac_f32_16x16x64_bf16 a[8:11], a[16:19], v[32:39], v11
    s_waitcnt vmcnt(8) lgkmcnt(12)
    s_barrier
.p2align 5
L2_loop:
    v_mfma_f32_16x16x32_bf16 v[16:19], a[64:67], v[64:67], v[48:51]
    s_sub_u32 s47, s47, s48
    v_exp_f32 v28, v28
    v_mfma_f32_16x16x32_bf16 v[16:19], a[68:71], v[68:71], v[16:19]
    v_cvt_pk_bf16_f32 v45, v26, v27
    v_add_u32 v1, s48, v1
    v_mfma_f32_16x16x32_bf16 v[16:19], a[72:75], v[72:75], v[16:19]
    s_add_u32 m0, s47, 0
    v_exp_f32 v29, v29
    v_mfma_f32_16x16x32_bf16 v[16:19], a[76:79], v[76:79], v[16:19]
    s_waitcnt lgkmcnt(8)
    buffer_load_dwordx4 v5, s[16:19], s46 offen offset:0 lds
    v_mfma_f32_16x16x32_bf16 v[20:23], a[80:83], v[64:67], v[48:51]
    v_exp_f32 v30, v30
    v_mfma_f32_16x16x32_bf16 v[20:23], a[84:87], v[68:71], v[20:23]
    v_cvt_pk_bf16_f32 v46, v28, v29
    v_add_u32 v2, s48, v2
    v_mfma_f32_16x16x32_bf16 v[20:23], a[88:91], v[72:75], v[20:23]
    s_add_u32 m0, s47, 32
    v_exp_f32 v31, v31
    v_mfma_f32_16x16x32_bf16 v[20:23], a[92:95], v[76:79], v[20:23]
    s_waitcnt lgkmcnt(4)
    buffer_load_dwordx4 v5, s[16:19], s46 offen offset:1024 lds
    v_mfma_f32_16x16x32_bf16 v[24:27], a[96:99], v[64:67], v[48:51]
    s_sub_u32 s48, 0, s48
    v_exp_f32 v16, v16
    v_mfma_f32_16x16x32_bf16 v[24:27], a[100:103], v[68:71], v[24:27]
    v_cvt_pk_bf16_f32 v47, v30, v31
    v_mfma_f32_16x16x32_bf16 v[24:27], a[104:107], v[72:75], v[24:27]
    s_add_u32 m0, s47, 64
    v_exp_f32 v17, v17
    v_mfma_f32_16x16x32_bf16 v[24:27], a[108:111], v[76:79], v[24:27]
    s_waitcnt lgkmcnt(0)
    buffer_load_dwordx4 v5, s[16:19], s46 offen offset:2048 lds
    v_mfma_f32_16x16x32_bf16 v[28:31], a[112:115], v[64:67], v[48:51]
    v_exp_f32 v18, v18
    v_mfma_f32_16x16x32_bf16 v[28:31], a[116:119], v[68:71], v[28:31]
    v_cvt_pk_bf16_f32 v32, v16, v17
    v_mfma_f32_16x16x32_bf16 v[28:31], a[120:123], v[72:75], v[28:31]
    s_add_u32 m0, s47, 96
    v_exp_f32 v19, v19
    v_mfma_f32_16x16x32_bf16 v[28:31], a[124:127], v[76:79], v[28:31]
    buffer_load_dwordx4 v5, s[16:19], s46 offen offset:3072 lds
    v_mfma_f32_16x16x32_bf16 v[224:227], a[128:131], v[40:43], v[224:227]
    v_exp_f32 v20, v20
    v_mfma_f32_16x16x32_bf16 v[224:227], a[132:135], v[44:47], v[224:227]
    ds_read_b64_tr_b16 a[128:129], v2 offset:0
    v_cvt_pk_bf16_f32 v33, v18, v19
    v_mfma_f32_16x16x32_bf16 v[228:231], a[136:139], v[40:43], v[228:231]
    s_add_u32 m0, s47, 16896
    v_exp_f32 v21, v21
    v_mfma_f32_16x16x32_bf16 v[228:231], a[140:143], v[44:47], v[228:231]
    buffer_load_dwordx4 v5, s[20:23], s46 offen offset:0 lds
    v_mfma_f32_16x16x32_bf16 v[232:235], a[144:147], v[40:43], v[232:235]
    v_exp_f32 v22, v22
    v_mfma_f32_16x16x32_bf16 v[232:235], a[148:151], v[44:47], v[232:235]
    ds_read_b64_tr_b16 a[130:131], v2 offset:256
    v_cvt_pk_bf16_f32 v34, v20, v21
    v_mfma_f32_16x16x32_bf16 v[236:239], a[152:155], v[40:43], v[236:239]
    s_add_u32 m0, s47, 16928
    v_exp_f32 v23, v23
    v_mfma_f32_16x16x32_bf16 v[236:239], a[156:159], v[44:47], v[236:239]
    buffer_load_dwordx4 v5, s[20:23], s46 offen offset:1024 lds
    v_mfma_f32_16x16x32_bf16 v[240:243], a[160:163], v[40:43], v[240:243]
    v_exp_f32 v24, v24
    v_mfma_f32_16x16x32_bf16 v[240:243], a[164:167], v[44:47], v[240:243]
    ds_read_b64_tr_b16 a[132:133], v2 offset:512
    v_cvt_pk_bf16_f32 v35, v22, v23
    v_mfma_f32_16x16x32_bf16 v[244:247], a[168:171], v[40:43], v[244:247]
    s_add_u32 m0, s47, 16960
    v_exp_f32 v25, v25
    v_mfma_f32_16x16x32_bf16 v[244:247], a[172:175], v[44:47], v[244:247]
    buffer_load_dwordx4 v5, s[20:23], s46 offen offset:2048 lds
    v_mfma_f32_16x16x32_bf16 v[248:251], a[176:179], v[40:43], v[248:251]
    v_exp_f32 v26, v26
    v_mfma_f32_16x16x32_bf16 v[248:251], a[180:183], v[44:47], v[248:251]
    ds_read_b64_tr_b16 a[134:135], v2 offset:768
    v_cvt_pk_bf16_f32 v36, v24, v25
    v_mfma_f32_16x16x32_bf16 v[252:255], a[184:187], v[40:43], v[252:255]
    s_add_u32 m0, s47, 16992
    v_exp_f32 v27, v27
    v_mfma_f32_16x16x32_bf16 v[252:255], a[188:191], v[44:47], v[252:255]
    buffer_load_dwordx4 v5, s[20:23], s46 offen offset:3072 lds
    v_smfmac_f32_16x16x64_bf16 a[12:15], a[16:19], v[40:47], v11
    ds_read_b64_tr_b16 a[136:137], v2 offset:32
    v_mfma_f32_16x16x32_bf16 v[16:19], a[64:67], v[80:83], v[52:55]
    v_exp_f32 v28, v28
    v_mfma_f32_16x16x32_bf16 v[16:19], a[68:71], v[84:87], v[16:19]
    ds_read_b64_tr_b16 a[138:139], v2 offset:288
    v_cvt_pk_bf16_f32 v37, v26, v27
    v_mfma_f32_16x16x32_bf16 v[16:19], a[72:75], v[88:91], v[16:19]
    v_exp_f32 v29, v29
    v_mfma_f32_16x16x32_bf16 v[16:19], a[76:79], v[92:95], v[16:19]
    ds_read_b64_tr_b16 a[140:141], v2 offset:544
    v_mfma_f32_16x16x32_bf16 v[20:23], a[80:83], v[80:83], v[52:55]
    v_exp_f32 v30, v30
    v_mfma_f32_16x16x32_bf16 v[20:23], a[84:87], v[84:87], v[20:23]
    ds_read_b64_tr_b16 a[142:143], v2 offset:800
    v_cvt_pk_bf16_f32 v38, v28, v29
    v_mfma_f32_16x16x32_bf16 v[20:23], a[88:91], v[88:91], v[20:23]
    v_exp_f32 v31, v31
    v_mfma_f32_16x16x32_bf16 v[20:23], a[92:95], v[92:95], v[20:23]
    ds_read_b64_tr_b16 a[144:145], v2 offset:64
    v_mfma_f32_16x16x32_bf16 v[24:27], a[96:99], v[80:83], v[52:55]
    v_exp_f32 v16, v16
    v_mfma_f32_16x16x32_bf16 v[24:27], a[100:103], v[84:87], v[24:27]
    ds_read_b64_tr_b16 a[146:147], v2 offset:320
    v_cvt_pk_bf16_f32 v39, v30, v31
    v_mfma_f32_16x16x32_bf16 v[24:27], a[104:107], v[88:91], v[24:27]
    v_exp_f32 v17, v17
    v_mfma_f32_16x16x32_bf16 v[24:27], a[108:111], v[92:95], v[24:27]
    ds_read_b64_tr_b16 a[148:149], v2 offset:576
    v_mfma_f32_16x16x32_bf16 v[28:31], a[112:115], v[80:83], v[52:55]
    v_exp_f32 v18, v18
    v_mfma_f32_16x16x32_bf16 v[28:31], a[116:119], v[84:87], v[28:31]
    ds_read_b64_tr_b16 a[150:151], v2 offset:832
    v_cvt_pk_bf16_f32 v40, v16, v17
    v_mfma_f32_16x16x32_bf16 v[28:31], a[120:123], v[88:91], v[28:31]
    v_exp_f32 v19, v19
    v_mfma_f32_16x16x32_bf16 v[28:31], a[124:127], v[92:95], v[28:31]
    ds_read_b64_tr_b16 a[152:153], v2 offset:96
    v_mfma_f32_16x16x32_bf16 v[128:131], a[192:195], v[32:35], v[128:131]
    v_exp_f32 v20, v20
    v_mfma_f32_16x16x32_bf16 v[128:131], a[196:199], v[36:39], v[128:131]
    ds_read_b64_tr_b16 a[154:155], v2 offset:352
    v_cvt_pk_bf16_f32 v41, v18, v19
    v_mfma_f32_16x16x32_bf16 v[132:135], a[200:203], v[32:35], v[132:135]
    v_exp_f32 v21, v21
    v_mfma_f32_16x16x32_bf16 v[132:135], a[204:207], v[36:39], v[132:135]
    ds_read_b64_tr_b16 a[156:157], v2 offset:608
    v_mfma_f32_16x16x32_bf16 v[136:139], a[208:211], v[32:35], v[136:139]
    v_exp_f32 v22, v22
    v_mfma_f32_16x16x32_bf16 v[136:139], a[212:215], v[36:39], v[136:139]
    ds_read_b64_tr_b16 a[158:159], v2 offset:864
    v_cvt_pk_bf16_f32 v42, v20, v21
    v_mfma_f32_16x16x32_bf16 v[140:143], a[216:219], v[32:35], v[140:143]
    v_exp_f32 v23, v23
    v_mfma_f32_16x16x32_bf16 v[140:143], a[220:223], v[36:39], v[140:143]
    ds_read_b64_tr_b16 a[160:161], v2 offset:128
    v_mfma_f32_16x16x32_bf16 v[144:147], a[224:227], v[32:35], v[144:147]
    v_exp_f32 v24, v24
    v_mfma_f32_16x16x32_bf16 v[144:147], a[228:231], v[36:39], v[144:147]
    ds_read_b64_tr_b16 a[162:163], v2 offset:384
    v_cvt_pk_bf16_f32 v43, v22, v23
    v_mfma_f32_16x16x32_bf16 v[148:151], a[232:235], v[32:35], v[148:151]
    v_exp_f32 v25, v25
    v_mfma_f32_16x16x32_bf16 v[148:151], a[236:239], v[36:39], v[148:151]
    ds_read_b64_tr_b16 a[164:165], v2 offset:640
    v_mfma_f32_16x16x32_bf16 v[152:155], a[240:243], v[32:35], v[152:155]
    v_exp_f32 v26, v26
    v_mfma_f32_16x16x32_bf16 v[152:155], a[244:247], v[36:39], v[152:155]
    ds_read_b64_tr_b16 a[166:167], v2 offset:896
    v_cvt_pk_bf16_f32 v44, v24, v25
    v_mfma_f32_16x16x32_bf16 v[156:159], a[248:251], v[32:35], v[156:159]
    v_exp_f32 v27, v27
    v_mfma_f32_16x16x32_bf16 v[156:159], a[252:255], v[36:39], v[156:159]
    ds_read_b64_tr_b16 a[168:169], v2 offset:160
    v_smfmac_f32_16x16x64_bf16 a[0:3], a[16:19], v[32:39], v11
    ds_read_b64_tr_b16 a[170:171], v2 offset:416
    v_mfma_f32_16x16x32_bf16 v[16:19], a[64:67], v[96:99], v[56:59]
    v_exp_f32 v28, v28
    v_mfma_f32_16x16x32_bf16 v[16:19], a[68:71], v[100:103], v[16:19]
    ds_read_b64_tr_b16 a[172:173], v2 offset:672
    v_cvt_pk_bf16_f32 v45, v26, v27
    v_mfma_f32_16x16x32_bf16 v[16:19], a[72:75], v[104:107], v[16:19]
    v_exp_f32 v29, v29
    v_mfma_f32_16x16x32_bf16 v[16:19], a[76:79], v[108:111], v[16:19]
    ds_read_b64_tr_b16 a[174:175], v2 offset:928
    v_mfma_f32_16x16x32_bf16 v[20:23], a[80:83], v[96:99], v[56:59]
    v_exp_f32 v30, v30
    v_mfma_f32_16x16x32_bf16 v[20:23], a[84:87], v[100:103], v[20:23]
    ds_read_b64_tr_b16 a[176:177], v2 offset:192
    v_cvt_pk_bf16_f32 v46, v28, v29
    v_mfma_f32_16x16x32_bf16 v[20:23], a[88:91], v[104:107], v[20:23]
    v_exp_f32 v31, v31
    v_mfma_f32_16x16x32_bf16 v[20:23], a[92:95], v[108:111], v[20:23]
    ds_read_b64_tr_b16 a[178:179], v2 offset:448
    v_mfma_f32_16x16x32_bf16 v[24:27], a[96:99], v[96:99], v[56:59]
    v_exp_f32 v16, v16
    v_mfma_f32_16x16x32_bf16 v[24:27], a[100:103], v[100:103], v[24:27]
    ds_read_b64_tr_b16 a[180:181], v2 offset:704
    v_cvt_pk_bf16_f32 v47, v30, v31
    v_mfma_f32_16x16x32_bf16 v[24:27], a[104:107], v[104:107], v[24:27]
    v_exp_f32 v17, v17
    v_mfma_f32_16x16x32_bf16 v[24:27], a[108:111], v[108:111], v[24:27]
    ds_read_b64_tr_b16 a[182:183], v2 offset:960
    v_mfma_f32_16x16x32_bf16 v[28:31], a[112:115], v[96:99], v[56:59]
    v_exp_f32 v18, v18
    v_mfma_f32_16x16x32_bf16 v[28:31], a[116:119], v[100:103], v[28:31]
    ds_read_b64_tr_b16 a[184:185], v2 offset:224
    v_cvt_pk_bf16_f32 v32, v16, v17
    v_mfma_f32_16x16x32_bf16 v[28:31], a[120:123], v[104:107], v[28:31]
    v_exp_f32 v19, v19
    v_mfma_f32_16x16x32_bf16 v[28:31], a[124:127], v[108:111], v[28:31]
    ds_read_b64_tr_b16 a[186:187], v2 offset:480
    v_mfma_f32_16x16x32_bf16 v[160:163], a[192:195], v[40:43], v[160:163]
    v_exp_f32 v20, v20
    v_mfma_f32_16x16x32_bf16 v[160:163], a[196:199], v[44:47], v[160:163]
    ds_read_b64_tr_b16 a[188:189], v2 offset:736
    v_cvt_pk_bf16_f32 v33, v18, v19
    v_mfma_f32_16x16x32_bf16 v[164:167], a[200:203], v[40:43], v[164:167]
    v_exp_f32 v21, v21
    v_mfma_f32_16x16x32_bf16 v[164:167], a[204:207], v[44:47], v[164:167]
    ds_read_b64_tr_b16 a[190:191], v2 offset:992
    v_mfma_f32_16x16x32_bf16 v[168:171], a[208:211], v[40:43], v[168:171]
    v_exp_f32 v22, v22
    v_mfma_f32_16x16x32_bf16 v[168:171], a[212:215], v[44:47], v[168:171]
    v_cvt_pk_bf16_f32 v34, v20, v21
    v_mfma_f32_16x16x32_bf16 v[172:175], a[216:219], v[40:43], v[172:175]
    v_exp_f32 v23, v23
    v_mfma_f32_16x16x32_bf16 v[172:175], a[220:223], v[44:47], v[172:175]
    v_mfma_f32_16x16x32_bf16 v[176:179], a[224:227], v[40:43], v[176:179]
    v_exp_f32 v24, v24
    v_mfma_f32_16x16x32_bf16 v[176:179], a[228:231], v[44:47], v[176:179]
    v_cvt_pk_bf16_f32 v35, v22, v23
    v_mfma_f32_16x16x32_bf16 v[180:183], a[232:235], v[40:43], v[180:183]
    v_exp_f32 v25, v25
    v_mfma_f32_16x16x32_bf16 v[180:183], a[236:239], v[44:47], v[180:183]
    v_mfma_f32_16x16x32_bf16 v[184:187], a[240:243], v[40:43], v[184:187]
    v_exp_f32 v26, v26
    v_mfma_f32_16x16x32_bf16 v[184:187], a[244:247], v[44:47], v[184:187]
    v_cvt_pk_bf16_f32 v36, v24, v25
    v_mfma_f32_16x16x32_bf16 v[188:191], a[248:251], v[40:43], v[188:191]
    v_exp_f32 v27, v27
    v_mfma_f32_16x16x32_bf16 v[188:191], a[252:255], v[44:47], v[188:191]
    v_smfmac_f32_16x16x64_bf16 a[4:7], a[16:19], v[40:47], v11
    v_mfma_f32_16x16x32_bf16 v[16:19], a[64:67], v[112:115], v[60:63]
    v_exp_f32 v28, v28
    v_mfma_f32_16x16x32_bf16 v[16:19], a[68:71], v[116:119], v[16:19]
    s_add_u32 s46, s46, 16384
    ds_read_b128 a[64:67], v1 offset:0
    v_cvt_pk_bf16_f32 v37, v26, v27
    v_mfma_f32_16x16x32_bf16 v[16:19], a[72:75], v[120:123], v[16:19]
    s_min_u32 s46, s46, 507904
    v_exp_f32 v29, v29
    v_mfma_f32_16x16x32_bf16 v[16:19], a[76:79], v[124:127], v[16:19]
    ds_read_b128 a[68:71], v1 offset:64
    v_mfma_f32_16x16x32_bf16 v[20:23], a[80:83], v[112:115], v[60:63]
    v_exp_f32 v30, v30
    v_mfma_f32_16x16x32_bf16 v[20:23], a[84:87], v[116:119], v[20:23]
    ds_read_b128 a[72:75], v1 offset:128
    v_cvt_pk_bf16_f32 v38, v28, v29
    v_mfma_f32_16x16x32_bf16 v[20:23], a[88:91], v[120:123], v[20:23]
    v_exp_f32 v31, v31
    v_mfma_f32_16x16x32_bf16 v[20:23], a[92:95], v[124:127], v[20:23]
    ds_read_b128 a[76:79], v1 offset:192
    v_mfma_f32_16x16x32_bf16 v[24:27], a[96:99], v[112:115], v[60:63]
    v_exp_f32 v16, v16
    v_mfma_f32_16x16x32_bf16 v[24:27], a[100:103], v[116:119], v[24:27]
    ds_read_b128 a[80:83], v1 offset:256
    v_cvt_pk_bf16_f32 v39, v30, v31
    v_mfma_f32_16x16x32_bf16 v[24:27], a[104:107], v[120:123], v[24:27]
    v_exp_f32 v17, v17
    v_mfma_f32_16x16x32_bf16 v[24:27], a[108:111], v[124:127], v[24:27]
    ds_read_b128 a[84:87], v1 offset:320
    v_mfma_f32_16x16x32_bf16 v[28:31], a[112:115], v[112:115], v[60:63]
    v_exp_f32 v18, v18
    v_mfma_f32_16x16x32_bf16 v[28:31], a[116:119], v[116:119], v[28:31]
    ds_read_b128 a[88:91], v1 offset:384
    v_cvt_pk_bf16_f32 v40, v16, v17
    v_mfma_f32_16x16x32_bf16 v[28:31], a[120:123], v[120:123], v[28:31]
    v_exp_f32 v19, v19
    v_mfma_f32_16x16x32_bf16 v[28:31], a[124:127], v[124:127], v[28:31]
    ds_read_b128 a[92:95], v1 offset:448
    v_mfma_f32_16x16x32_bf16 v[192:195], a[192:195], v[32:35], v[192:195]
    v_exp_f32 v20, v20
    v_mfma_f32_16x16x32_bf16 v[192:195], a[196:199], v[36:39], v[192:195]
    ds_read_b128 a[96:99], v1 offset:512
    v_cvt_pk_bf16_f32 v41, v18, v19
    v_mfma_f32_16x16x32_bf16 v[196:199], a[200:203], v[32:35], v[196:199]
    v_exp_f32 v21, v21
    v_mfma_f32_16x16x32_bf16 v[196:199], a[204:207], v[36:39], v[196:199]
    ds_read_b128 a[100:103], v1 offset:576
    v_mfma_f32_16x16x32_bf16 v[200:203], a[208:211], v[32:35], v[200:203]
    v_exp_f32 v22, v22
    v_mfma_f32_16x16x32_bf16 v[200:203], a[212:215], v[36:39], v[200:203]
    ds_read_b128 a[104:107], v1 offset:640
    v_cvt_pk_bf16_f32 v42, v20, v21
    v_mfma_f32_16x16x32_bf16 v[204:207], a[216:219], v[32:35], v[204:207]
    v_exp_f32 v23, v23
    v_mfma_f32_16x16x32_bf16 v[204:207], a[220:223], v[36:39], v[204:207]
    ds_read_b128 a[108:111], v1 offset:704
    v_mfma_f32_16x16x32_bf16 v[208:211], a[224:227], v[32:35], v[208:211]
    v_exp_f32 v24, v24
    v_mfma_f32_16x16x32_bf16 v[208:211], a[228:231], v[36:39], v[208:211]
    ds_read_b128 a[112:115], v1 offset:768
    v_cvt_pk_bf16_f32 v43, v22, v23
    v_mfma_f32_16x16x32_bf16 v[212:215], a[232:235], v[32:35], v[212:215]
    v_exp_f32 v25, v25
    v_mfma_f32_16x16x32_bf16 v[212:215], a[236:239], v[36:39], v[212:215]
    ds_read_b128 a[116:119], v1 offset:832
    v_mfma_f32_16x16x32_bf16 v[216:219], a[240:243], v[32:35], v[216:219]
    v_exp_f32 v26, v26
    v_mfma_f32_16x16x32_bf16 v[216:219], a[244:247], v[36:39], v[216:219]
    ds_read_b128 a[120:123], v1 offset:896
    v_cvt_pk_bf16_f32 v44, v24, v25
    v_mfma_f32_16x16x32_bf16 v[220:223], a[248:251], v[32:35], v[220:223]
    v_exp_f32 v27, v27
    v_mfma_f32_16x16x32_bf16 v[220:223], a[252:255], v[36:39], v[220:223]
    ds_read_b128 a[124:127], v1 offset:960
    v_smfmac_f32_16x16x64_bf16 a[8:11], a[16:19], v[32:39], v11
    s_waitcnt vmcnt(8) lgkmcnt(12)
    s_barrier
    v_mfma_f32_16x16x32_bf16 v[16:19], a[64:67], v[64:67], v[48:51]
    v_exp_f32 v28, v28
    v_mfma_f32_16x16x32_bf16 v[16:19], a[68:71], v[68:71], v[16:19]
    v_cvt_pk_bf16_f32 v45, v26, v27
    v_mfma_f32_16x16x32_bf16 v[16:19], a[72:75], v[72:75], v[16:19]
    s_add_u32 m0, s47, 33792
    v_exp_f32 v29, v29
    v_mfma_f32_16x16x32_bf16 v[16:19], a[76:79], v[76:79], v[16:19]
    s_waitcnt lgkmcnt(8)
    buffer_load_dwordx4 v5, s[16:19], s46 offen offset:0 lds
    v_mfma_f32_16x16x32_bf16 v[20:23], a[80:83], v[64:67], v[48:51]
    v_exp_f32 v30, v30
    v_mfma_f32_16x16x32_bf16 v[20:23], a[84:87], v[68:71], v[20:23]
    v_cvt_pk_bf16_f32 v46, v28, v29
    v_mfma_f32_16x16x32_bf16 v[20:23], a[88:91], v[72:75], v[20:23]
    s_add_u32 m0, s47, 33824
    v_exp_f32 v31, v31
    v_mfma_f32_16x16x32_bf16 v[20:23], a[92:95], v[76:79], v[20:23]
    s_waitcnt lgkmcnt(4)
    buffer_load_dwordx4 v5, s[16:19], s46 offen offset:1024 lds
    v_mfma_f32_16x16x32_bf16 v[24:27], a[96:99], v[64:67], v[48:51]
    v_exp_f32 v16, v16
    v_mfma_f32_16x16x32_bf16 v[24:27], a[100:103], v[68:71], v[24:27]
    v_cvt_pk_bf16_f32 v47, v30, v31
    v_mfma_f32_16x16x32_bf16 v[24:27], a[104:107], v[72:75], v[24:27]
    s_add_u32 m0, s47, 33856
    v_exp_f32 v17, v17
    v_mfma_f32_16x16x32_bf16 v[24:27], a[108:111], v[76:79], v[24:27]
    s_waitcnt lgkmcnt(0)
    buffer_load_dwordx4 v5, s[16:19], s46 offen offset:2048 lds
    v_mfma_f32_16x16x32_bf16 v[28:31], a[112:115], v[64:67], v[48:51]
    v_exp_f32 v18, v18
    v_mfma_f32_16x16x32_bf16 v[28:31], a[116:119], v[68:71], v[28:31]
    v_cvt_pk_bf16_f32 v32, v16, v17
    v_mfma_f32_16x16x32_bf16 v[28:31], a[120:123], v[72:75], v[28:31]
    s_add_u32 m0, s47, 33888
    v_exp_f32 v19, v19
    v_mfma_f32_16x16x32_bf16 v[28:31], a[124:127], v[76:79], v[28:31]
    buffer_load_dwordx4 v5, s[16:19], s46 offen offset:3072 lds
    v_mfma_f32_16x16x32_bf16 v[224:227], a[192:195], v[40:43], v[224:227]
    v_exp_f32 v20, v20
    v_mfma_f32_16x16x32_bf16 v[224:227], a[196:199], v[44:47], v[224:227]
    ds_read_b64_tr_b16 a[192:193], v2 offset:33792
    v_cvt_pk_bf16_f32 v33, v18, v19
    v_mfma_f32_16x16x32_bf16 v[228:231], a[200:203], v[40:43], v[228:231]
    s_add_u32 m0, s47, 50688
    v_exp_f32 v21, v21
    v_mfma_f32_16x16x32_bf16 v[228:231], a[204:207], v[44:47], v[228:231]
    buffer_load_dwordx4 v5, s[20:23], s46 offen offset:0 lds
    v_mfma_f32_16x16x32_bf16 v[232:235], a[208:211], v[40:43], v[232:235]
    v_exp_f32 v22, v22
    v_mfma_f32_16x16x32_bf16 v[232:235], a[212:215], v[44:47], v[232:235]
    ds_read_b64_tr_b16 a[194:195], v2 offset:34048
    v_cvt_pk_bf16_f32 v34, v20, v21
    v_mfma_f32_16x16x32_bf16 v[236:239], a[216:219], v[40:43], v[236:239]
    s_add_u32 m0, s47, 50720
    v_exp_f32 v23, v23
    v_mfma_f32_16x16x32_bf16 v[236:239], a[220:223], v[44:47], v[236:239]
    buffer_load_dwordx4 v5, s[20:23], s46 offen offset:1024 lds
    v_mfma_f32_16x16x32_bf16 v[240:243], a[224:227], v[40:43], v[240:243]
    v_exp_f32 v24, v24
    v_mfma_f32_16x16x32_bf16 v[240:243], a[228:231], v[44:47], v[240:243]
    ds_read_b64_tr_b16 a[196:197], v2 offset:34304
    v_cvt_pk_bf16_f32 v35, v22, v23
    v_mfma_f32_16x16x32_bf16 v[244:247], a[232:235], v[40:43], v[244:247]
    s_add_u32 m0, s47, 50752
    v_exp_f32 v25, v25
    v_mfma_f32_16x16x32_bf16 v[244:247], a[236:239], v[44:47], v[244:247]
    buffer_load_dwordx4 v5, s[20:23], s46 offen offset:2048 lds
    v_mfma_f32_16x16x32_bf16 v[248:251], a[240:243], v[40:43], v[248:251]
    v_exp_f32 v26, v26
    v_mfma_f32_16x16x32_bf16 v[248:251], a[244:247], v[44:47], v[248:251]
    ds_read_b64_tr_b16 a[198:199], v2 offset:34560
    v_cvt_pk_bf16_f32 v36, v24, v25
    v_mfma_f32_16x16x32_bf16 v[252:255], a[248:251], v[40:43], v[252:255]
    s_add_u32 m0, s47, 50784
    v_exp_f32 v27, v27
    v_mfma_f32_16x16x32_bf16 v[252:255], a[252:255], v[44:47], v[252:255]
    buffer_load_dwordx4 v5, s[20:23], s46 offen offset:3072 lds
    v_smfmac_f32_16x16x64_bf16 a[12:15], a[16:19], v[40:47], v11
    ds_read_b64_tr_b16 a[200:201], v2 offset:33824
    v_mfma_f32_16x16x32_bf16 v[16:19], a[64:67], v[80:83], v[52:55]
    v_exp_f32 v28, v28
    v_mfma_f32_16x16x32_bf16 v[16:19], a[68:71], v[84:87], v[16:19]
    ds_read_b64_tr_b16 a[202:203], v2 offset:34080
    v_cvt_pk_bf16_f32 v37, v26, v27
    v_mfma_f32_16x16x32_bf16 v[16:19], a[72:75], v[88:91], v[16:19]
    v_exp_f32 v29, v29
    v_mfma_f32_16x16x32_bf16 v[16:19], a[76:79], v[92:95], v[16:19]
    ds_read_b64_tr_b16 a[204:205], v2 offset:34336
    v_mfma_f32_16x16x32_bf16 v[20:23], a[80:83], v[80:83], v[52:55]
    v_exp_f32 v30, v30
    v_mfma_f32_16x16x32_bf16 v[20:23], a[84:87], v[84:87], v[20:23]
    ds_read_b64_tr_b16 a[206:207], v2 offset:34592
    v_cvt_pk_bf16_f32 v38, v28, v29
    v_mfma_f32_16x16x32_bf16 v[20:23], a[88:91], v[88:91], v[20:23]
    v_exp_f32 v31, v31
    v_mfma_f32_16x16x32_bf16 v[20:23], a[92:95], v[92:95], v[20:23]
    ds_read_b64_tr_b16 a[208:209], v2 offset:33856
    v_mfma_f32_16x16x32_bf16 v[24:27], a[96:99], v[80:83], v[52:55]
    v_exp_f32 v16, v16
    v_mfma_f32_16x16x32_bf16 v[24:27], a[100:103], v[84:87], v[24:27]
    ds_read_b64_tr_b16 a[210:211], v2 offset:34112
    v_cvt_pk_bf16_f32 v39, v30, v31
    v_mfma_f32_16x16x32_bf16 v[24:27], a[104:107], v[88:91], v[24:27]
    v_exp_f32 v17, v17
    v_mfma_f32_16x16x32_bf16 v[24:27], a[108:111], v[92:95], v[24:27]
    ds_read_b64_tr_b16 a[212:213], v2 offset:34368
    v_mfma_f32_16x16x32_bf16 v[28:31], a[112:115], v[80:83], v[52:55]
    v_exp_f32 v18, v18
    v_mfma_f32_16x16x32_bf16 v[28:31], a[116:119], v[84:87], v[28:31]
    ds_read_b64_tr_b16 a[214:215], v2 offset:34624
    v_cvt_pk_bf16_f32 v40, v16, v17
    v_mfma_f32_16x16x32_bf16 v[28:31], a[120:123], v[88:91], v[28:31]
    v_exp_f32 v19, v19
    v_mfma_f32_16x16x32_bf16 v[28:31], a[124:127], v[92:95], v[28:31]
    ds_read_b64_tr_b16 a[216:217], v2 offset:33888
    v_mfma_f32_16x16x32_bf16 v[128:131], a[128:131], v[32:35], v[128:131]
    v_exp_f32 v20, v20
    v_mfma_f32_16x16x32_bf16 v[128:131], a[132:135], v[36:39], v[128:131]
    ds_read_b64_tr_b16 a[218:219], v2 offset:34144
    v_cvt_pk_bf16_f32 v41, v18, v19
    v_mfma_f32_16x16x32_bf16 v[132:135], a[136:139], v[32:35], v[132:135]
    v_exp_f32 v21, v21
    v_mfma_f32_16x16x32_bf16 v[132:135], a[140:143], v[36:39], v[132:135]
    ds_read_b64_tr_b16 a[220:221], v2 offset:34400
    v_mfma_f32_16x16x32_bf16 v[136:139], a[144:147], v[32:35], v[136:139]
    v_exp_f32 v22, v22
    v_mfma_f32_16x16x32_bf16 v[136:139], a[148:151], v[36:39], v[136:139]
    ds_read_b64_tr_b16 a[222:223], v2 offset:34656
    v_cvt_pk_bf16_f32 v42, v20, v21
    v_mfma_f32_16x16x32_bf16 v[140:143], a[152:155], v[32:35], v[140:143]
    v_exp_f32 v23, v23
    v_mfma_f32_16x16x32_bf16 v[140:143], a[156:159], v[36:39], v[140:143]
    ds_read_b64_tr_b16 a[224:225], v2 offset:33920
    v_mfma_f32_16x16x32_bf16 v[144:147], a[160:163], v[32:35], v[144:147]
    v_exp_f32 v24, v24
    v_mfma_f32_16x16x32_bf16 v[144:147], a[164:167], v[36:39], v[144:147]
    ds_read_b64_tr_b16 a[226:227], v2 offset:34176
    v_cvt_pk_bf16_f32 v43, v22, v23
    v_mfma_f32_16x16x32_bf16 v[148:151], a[168:171], v[32:35], v[148:151]
    v_exp_f32 v25, v25
    v_mfma_f32_16x16x32_bf16 v[148:151], a[172:175], v[36:39], v[148:151]
    ds_read_b64_tr_b16 a[228:229], v2 offset:34432
    v_mfma_f32_16x16x32_bf16 v[152:155], a[176:179], v[32:35], v[152:155]
    v_exp_f32 v26, v26
    v_mfma_f32_16x16x32_bf16 v[152:155], a[180:183], v[36:39], v[152:155]
    ds_read_b64_tr_b16 a[230:231], v2 offset:34688
    v_cvt_pk_bf16_f32 v44, v24, v25
    v_mfma_f32_16x16x32_bf16 v[156:159], a[184:187], v[32:35], v[156:159]
    v_exp_f32 v27, v27
    v_mfma_f32_16x16x32_bf16 v[156:159], a[188:191], v[36:39], v[156:159]
    ds_read_b64_tr_b16 a[232:233], v2 offset:33952
    v_smfmac_f32_16x16x64_bf16 a[0:3], a[16:19], v[32:39], v11
    ds_read_b64_tr_b16 a[234:235], v2 offset:34208
    v_mfma_f32_16x16x32_bf16 v[16:19], a[64:67], v[96:99], v[56:59]
    v_exp_f32 v28, v28
    v_mfma_f32_16x16x32_bf16 v[16:19], a[68:71], v[100:103], v[16:19]
    ds_read_b64_tr_b16 a[236:237], v2 offset:34464
    v_cvt_pk_bf16_f32 v45, v26, v27
    v_mfma_f32_16x16x32_bf16 v[16:19], a[72:75], v[104:107], v[16:19]
    v_exp_f32 v29, v29
    v_mfma_f32_16x16x32_bf16 v[16:19], a[76:79], v[108:111], v[16:19]
    ds_read_b64_tr_b16 a[238:239], v2 offset:34720
    v_mfma_f32_16x16x32_bf16 v[20:23], a[80:83], v[96:99], v[56:59]
    v_exp_f32 v30, v30
    v_mfma_f32_16x16x32_bf16 v[20:23], a[84:87], v[100:103], v[20:23]
    ds_read_b64_tr_b16 a[240:241], v2 offset:33984
    v_cvt_pk_bf16_f32 v46, v28, v29
    v_mfma_f32_16x16x32_bf16 v[20:23], a[88:91], v[104:107], v[20:23]
    v_exp_f32 v31, v31
    v_mfma_f32_16x16x32_bf16 v[20:23], a[92:95], v[108:111], v[20:23]
    ds_read_b64_tr_b16 a[242:243], v2 offset:34240
    v_mfma_f32_16x16x32_bf16 v[24:27], a[96:99], v[96:99], v[56:59]
    v_exp_f32 v16, v16
    v_mfma_f32_16x16x32_bf16 v[24:27], a[100:103], v[100:103], v[24:27]
    ds_read_b64_tr_b16 a[244:245], v2 offset:34496
    v_cvt_pk_bf16_f32 v47, v30, v31
    v_mfma_f32_16x16x32_bf16 v[24:27], a[104:107], v[104:107], v[24:27]
    v_exp_f32 v17, v17
    v_mfma_f32_16x16x32_bf16 v[24:27], a[108:111], v[108:111], v[24:27]
    ds_read_b64_tr_b16 a[246:247], v2 offset:34752
    v_mfma_f32_16x16x32_bf16 v[28:31], a[112:115], v[96:99], v[56:59]
    v_exp_f32 v18, v18
    v_mfma_f32_16x16x32_bf16 v[28:31], a[116:119], v[100:103], v[28:31]
    ds_read_b64_tr_b16 a[248:249], v2 offset:34016
    v_cvt_pk_bf16_f32 v32, v16, v17
    v_mfma_f32_16x16x32_bf16 v[28:31], a[120:123], v[104:107], v[28:31]
    v_exp_f32 v19, v19
    v_mfma_f32_16x16x32_bf16 v[28:31], a[124:127], v[108:111], v[28:31]
    ds_read_b64_tr_b16 a[250:251], v2 offset:34272
    v_mfma_f32_16x16x32_bf16 v[160:163], a[128:131], v[40:43], v[160:163]
    v_exp_f32 v20, v20
    v_mfma_f32_16x16x32_bf16 v[160:163], a[132:135], v[44:47], v[160:163]
    ds_read_b64_tr_b16 a[252:253], v2 offset:34528
    v_cvt_pk_bf16_f32 v33, v18, v19
    v_mfma_f32_16x16x32_bf16 v[164:167], a[136:139], v[40:43], v[164:167]
    v_exp_f32 v21, v21
    v_mfma_f32_16x16x32_bf16 v[164:167], a[140:143], v[44:47], v[164:167]
    ds_read_b64_tr_b16 a[254:255], v2 offset:34784
    v_mfma_f32_16x16x32_bf16 v[168:171], a[144:147], v[40:43], v[168:171]
    v_exp_f32 v22, v22
    v_mfma_f32_16x16x32_bf16 v[168:171], a[148:151], v[44:47], v[168:171]
    v_cvt_pk_bf16_f32 v34, v20, v21
    v_mfma_f32_16x16x32_bf16 v[172:175], a[152:155], v[40:43], v[172:175]
    v_exp_f32 v23, v23
    v_mfma_f32_16x16x32_bf16 v[172:175], a[156:159], v[44:47], v[172:175]
    v_mfma_f32_16x16x32_bf16 v[176:179], a[160:163], v[40:43], v[176:179]
    v_exp_f32 v24, v24
    v_mfma_f32_16x16x32_bf16 v[176:179], a[164:167], v[44:47], v[176:179]
    v_cvt_pk_bf16_f32 v35, v22, v23
    v_mfma_f32_16x16x32_bf16 v[180:183], a[168:171], v[40:43], v[180:183]
    v_exp_f32 v25, v25
    v_mfma_f32_16x16x32_bf16 v[180:183], a[172:175], v[44:47], v[180:183]
    v_mfma_f32_16x16x32_bf16 v[184:187], a[176:179], v[40:43], v[184:187]
    v_exp_f32 v26, v26
    v_mfma_f32_16x16x32_bf16 v[184:187], a[180:183], v[44:47], v[184:187]
    v_cvt_pk_bf16_f32 v36, v24, v25
    v_mfma_f32_16x16x32_bf16 v[188:191], a[184:187], v[40:43], v[188:191]
    v_exp_f32 v27, v27
    v_mfma_f32_16x16x32_bf16 v[188:191], a[188:191], v[44:47], v[188:191]
    v_smfmac_f32_16x16x64_bf16 a[4:7], a[16:19], v[40:47], v11
    v_mfma_f32_16x16x32_bf16 v[16:19], a[64:67], v[112:115], v[60:63]
    v_exp_f32 v28, v28
    v_mfma_f32_16x16x32_bf16 v[16:19], a[68:71], v[116:119], v[16:19]
    s_add_u32 s46, s46, 16384
    ds_read_b128 a[64:67], v1 offset:33792
    v_cvt_pk_bf16_f32 v37, v26, v27
    v_mfma_f32_16x16x32_bf16 v[16:19], a[72:75], v[120:123], v[16:19]
    s_min_u32 s46, s46, 507904
    v_exp_f32 v29, v29
    v_mfma_f32_16x16x32_bf16 v[16:19], a[76:79], v[124:127], v[16:19]
    ds_read_b128 a[68:71], v1 offset:33856
    v_mfma_f32_16x16x32_bf16 v[20:23], a[80:83], v[112:115], v[60:63]
    v_exp_f32 v30, v30
    v_mfma_f32_16x16x32_bf16 v[20:23], a[84:87], v[116:119], v[20:23]
    ds_read_b128 a[72:75], v1 offset:33920
    v_cvt_pk_bf16_f32 v38, v28, v29
    v_mfma_f32_16x16x32_bf16 v[20:23], a[88:91], v[120:123], v[20:23]
    v_exp_f32 v31, v31
    v_mfma_f32_16x16x32_bf16 v[20:23], a[92:95], v[124:127], v[20:23]
    ds_read_b128 a[76:79], v1 offset:33984
    v_mfma_f32_16x16x32_bf16 v[24:27], a[96:99], v[112:115], v[60:63]
    v_exp_f32 v16, v16
    v_mfma_f32_16x16x32_bf16 v[24:27], a[100:103], v[116:119], v[24:27]
    ds_read_b128 a[80:83], v1 offset:34048
    v_cvt_pk_bf16_f32 v39, v30, v31
    v_mfma_f32_16x16x32_bf16 v[24:27], a[104:107], v[120:123], v[24:27]
    v_exp_f32 v17, v17
    v_mfma_f32_16x16x32_bf16 v[24:27], a[108:111], v[124:127], v[24:27]
    ds_read_b128 a[84:87], v1 offset:34112
    v_mfma_f32_16x16x32_bf16 v[28:31], a[112:115], v[112:115], v[60:63]
    v_exp_f32 v18, v18
    v_mfma_f32_16x16x32_bf16 v[28:31], a[116:119], v[116:119], v[28:31]
    ds_read_b128 a[88:91], v1 offset:34176
    v_cvt_pk_bf16_f32 v40, v16, v17
    v_mfma_f32_16x16x32_bf16 v[28:31], a[120:123], v[120:123], v[28:31]
    v_exp_f32 v19, v19
    v_mfma_f32_16x16x32_bf16 v[28:31], a[124:127], v[124:127], v[28:31]
    ds_read_b128 a[92:95], v1 offset:34240
    v_mfma_f32_16x16x32_bf16 v[192:195], a[128:131], v[32:35], v[192:195]
    v_exp_f32 v20, v20
    v_mfma_f32_16x16x32_bf16 v[192:195], a[132:135], v[36:39], v[192:195]
    ds_read_b128 a[96:99], v1 offset:34304
    v_cvt_pk_bf16_f32 v41, v18, v19
    v_mfma_f32_16x16x32_bf16 v[196:199], a[136:139], v[32:35], v[196:199]
    v_exp_f32 v21, v21
    v_mfma_f32_16x16x32_bf16 v[196:199], a[140:143], v[36:39], v[196:199]
    ds_read_b128 a[100:103], v1 offset:34368
    v_mfma_f32_16x16x32_bf16 v[200:203], a[144:147], v[32:35], v[200:203]
    v_exp_f32 v22, v22
    v_mfma_f32_16x16x32_bf16 v[200:203], a[148:151], v[36:39], v[200:203]
    ds_read_b128 a[104:107], v1 offset:34432
    v_cvt_pk_bf16_f32 v42, v20, v21
    v_mfma_f32_16x16x32_bf16 v[204:207], a[152:155], v[32:35], v[204:207]
    v_exp_f32 v23, v23
    v_mfma_f32_16x16x32_bf16 v[204:207], a[156:159], v[36:39], v[204:207]
    ds_read_b128 a[108:111], v1 offset:34496
    v_mfma_f32_16x16x32_bf16 v[208:211], a[160:163], v[32:35], v[208:211]
    v_exp_f32 v24, v24
    v_mfma_f32_16x16x32_bf16 v[208:211], a[164:167], v[36:39], v[208:211]
    ds_read_b128 a[112:115], v1 offset:34560
    v_cvt_pk_bf16_f32 v43, v22, v23
    v_mfma_f32_16x16x32_bf16 v[212:215], a[168:171], v[32:35], v[212:215]
    v_exp_f32 v25, v25
    v_mfma_f32_16x16x32_bf16 v[212:215], a[172:175], v[36:39], v[212:215]
    ds_read_b128 a[116:119], v1 offset:34624
    v_mfma_f32_16x16x32_bf16 v[216:219], a[176:179], v[32:35], v[216:219]
    v_exp_f32 v26, v26
    v_mfma_f32_16x16x32_bf16 v[216:219], a[180:183], v[36:39], v[216:219]
    s_sub_u32 s49, s49, 1
    ds_read_b128 a[120:123], v1 offset:34688
    v_cvt_pk_bf16_f32 v44, v24, v25
    v_mfma_f32_16x16x32_bf16 v[220:223], a[184:187], v[32:35], v[220:223]
    s_cmp_lg_u32 s49, 0
    v_exp_f32 v27, v27
    v_mfma_f32_16x16x32_bf16 v[220:223], a[188:191], v[36:39], v[220:223]
    ds_read_b128 a[124:127], v1 offset:34752
    v_smfmac_f32_16x16x64_bf16 a[8:11], a[16:19], v[32:39], v11
    s_waitcnt vmcnt(8) lgkmcnt(12)
    s_barrier
    s_cbranch_scc1 L2_loop
    v_mfma_f32_16x16x32_bf16 v[16:19], a[64:67], v[64:67], v[48:51]
    v_exp_f32 v28, v28
    v_mfma_f32_16x16x32_bf16 v[16:19], a[68:71], v[68:71], v[16:19]
    s_mov_b32 s45, 0
    v_cvt_pk_bf16_f32 v45, v26, v27
    v_mfma_f32_16x16x32_bf16 v[16:19], a[72:75], v[72:75], v[16:19]
    s_add_u32 m0, s44, 67584
    v_exp_f32 v29, v29
    v_mfma_f32_16x16x32_bf16 v[16:19], a[76:79], v[76:79], v[16:19]
    s_waitcnt lgkmcnt(8)
    buffer_load_dwordx4 v7, s[28:31], s45 offen offset:0 lds
    v_mfma_f32_16x16x32_bf16 v[20:23], a[80:83], v[64:67], v[48:51]
    v_exp_f32 v30, v30
    v_mfma_f32_16x16x32_bf16 v[20:23], a[84:87], v[68:71], v[20:23]
    v_cvt_pk_bf16_f32 v46, v28, v29
    v_mfma_f32_16x16x32_bf16 v[20:23], a[88:91], v[72:75], v[20:23]
    s_add_u32 m0, s44, 67488
    v_exp_f32 v31, v31
    v_mfma_f32_16x16x32_bf16 v[20:23], a[92:95], v[76:79], v[20:23]
    s_waitcnt lgkmcnt(4)
    buffer_load_dwordx4 v7, s[28:31], s45 offen offset:1152 lds
    v_mfma_f32_16x16x32_bf16 v[24:27], a[96:99], v[64:67], v[48:51]
    v_exp_f32 v16, v16
    v_mfma_f32_16x16x32_bf16 v[24:27], a[100:103], v[68:71], v[24:27]
    v_cvt_pk_bf16_f32 v47, v30, v31
    v_mfma_f32_16x16x32_bf16 v[24:27], a[104:107], v[72:75], v[24:27]
    s_add_u32 m0, s44, 67392
    v_exp_f32 v17, v17
    v_mfma_f32_16x16x32_bf16 v[24:27], a[108:111], v[76:79], v[24:27]
    s_waitcnt lgkmcnt(0)
    buffer_load_dwordx4 v7, s[28:31], s45 offen offset:2304 lds
    v_mfma_f32_16x16x32_bf16 v[28:31], a[112:115], v[64:67], v[48:51]
    v_exp_f32 v18, v18
    v_mfma_f32_16x16x32_bf16 v[28:31], a[116:119], v[68:71], v[28:31]
    v_cvt_pk_bf16_f32 v32, v16, v17
    v_mfma_f32_16x16x32_bf16 v[28:31], a[120:123], v[72:75], v[28:31]
    s_add_u32 m0, s44, 67296
    v_exp_f32 v19, v19
    v_mfma_f32_16x16x32_bf16 v[28:31], a[124:127], v[76:79], v[28:31]
    buffer_load_dwordx4 v7, s[28:31], s45 offen offset:3456 lds
    v_mfma_f32_16x16x32_bf16 v[224:227], a[128:131], v[40:43], v[224:227]
    v_exp_f32 v20, v20
    v_mfma_f32_16x16x32_bf16 v[224:227], a[132:135], v[44:47], v[224:227]
    s_mov_b32 s45, 147456
    v_cvt_pk_bf16_f32 v33, v18, v19
    v_mfma_f32_16x16x32_bf16 v[228:231], a[136:139], v[40:43], v[228:231]
    s_add_u32 m0, s44, 84480
    v_exp_f32 v21, v21
    v_mfma_f32_16x16x32_bf16 v[228:231], a[140:143], v[44:47], v[228:231]
    buffer_load_dwordx4 v7, s[28:31], s45 offen offset:0 lds
    v_mfma_f32_16x16x32_bf16 v[232:235], a[144:147], v[40:43], v[232:235]
    v_exp_f32 v22, v22
    v_mfma_f32_16x16x32_bf16 v[232:235], a[148:151], v[44:47], v[232:235]
    v_cvt_pk_bf16_f32 v34, v20, v21
    v_mfma_f32_16x16x32_bf16 v[236:239], a[152:155], v[40:43], v[236:239]
    s_add_u32 m0, s44, 84384
    v_exp_f32 v23, v23
    v_mfma_f32_16x16x32_bf16 v[236:239], a[156:159], v[44:47], v[236:239]
    buffer_load_dwordx4 v7, s[28:31], s45 offen offset:1152 lds
    v_mfma_f32_16x16x32_bf16 v[240:243], a[160:163], v[40:43], v[240:243]
    v_exp_f32 v24, v24
    v_mfma_f32_16x16x32_bf16 v[240:243], a[164:167], v[44:47], v[240:243]
    v_cvt_pk_bf16_f32 v35, v22, v23
    v_mfma_f32_16x16x32_bf16 v[244:247], a[168:171], v[40:43], v[244:247]
    s_add_u32 m0, s44, 84288
    v_exp_f32 v25, v25
    v_mfma_f32_16x16x32_bf16 v[244:247], a[172:175], v[44:47], v[244:247]
    buffer_load_dwordx4 v7, s[28:31], s45 offen offset:2304 lds
    v_mfma_f32_16x16x32_bf16 v[248:251], a[176:179], v[40:43], v[248:251]
    v_exp_f32 v26, v26
    v_mfma_f32_16x16x32_bf16 v[248:251], a[180:183], v[44:47], v[248:251]
    v_cvt_pk_bf16_f32 v36, v24, v25
    v_mfma_f32_16x16x32_bf16 v[252:255], a[184:187], v[40:43], v[252:255]
    s_add_u32 m0, s44, 84192
    v_exp_f32 v27, v27
    v_mfma_f32_16x16x32_bf16 v[252:255], a[188:191], v[44:47], v[252:255]
    buffer_load_dwordx4 v7, s[28:31], s45 offen offset:3456 lds
    v_smfmac_f32_16x16x64_bf16 a[12:15], a[16:19], v[40:47], v11
    v_mfma_f32_16x16x32_bf16 v[16:19], a[64:67], v[80:83], v[52:55]
    v_exp_f32 v28, v28
    v_mfma_f32_16x16x32_bf16 v[16:19], a[68:71], v[84:87], v[16:19]
    s_mov_b32 s45, 128
    v_cvt_pk_bf16_f32 v37, v26, v27
    v_mfma_f32_16x16x32_bf16 v[16:19], a[72:75], v[88:91], v[16:19]
    s_add_u32 m0, s44, 101376
    v_exp_f32 v29, v29
    v_mfma_f32_16x16x32_bf16 v[16:19], a[76:79], v[92:95], v[16:19]
    buffer_load_dwordx4 v7, s[28:31], s45 offen offset:0 lds
    v_mfma_f32_16x16x32_bf16 v[20:23], a[80:83], v[80:83], v[52:55]
    v_exp_f32 v30, v30
    v_mfma_f32_16x16x32_bf16 v[20:23], a[84:87], v[84:87], v[20:23]
    v_cvt_pk_bf16_f32 v38, v28, v29
    v_mfma_f32_16x16x32_bf16 v[20:23], a[88:91], v[88:91], v[20:23]
    s_add_u32 m0, s44, 101280
    v_exp_f32 v31, v31
    v_mfma_f32_16x16x32_bf16 v[20:23], a[92:95], v[92:95], v[20:23]
    buffer_load_dwordx4 v7, s[28:31], s45 offen offset:1152 lds
    v_mfma_f32_16x16x32_bf16 v[24:27], a[96:99], v[80:83], v[52:55]
    v_exp_f32 v16, v16
    v_mfma_f32_16x16x32_bf16 v[24:27], a[100:103], v[84:87], v[24:27]
    v_cvt_pk_bf16_f32 v39, v30, v31
    v_mfma_f32_16x16x32_bf16 v[24:27], a[104:107], v[88:91], v[24:27]
    s_add_u32 m0, s44, 101184
    v_exp_f32 v17, v17
    v_mfma_f32_16x16x32_bf16 v[24:27], a[108:111], v[92:95], v[24:27]
    buffer_load_dwordx4 v7, s[28:31], s45 offen offset:2304 lds
    v_mfma_f32_16x16x32_bf16 v[28:31], a[112:115], v[80:83], v[52:55]
    v_exp_f32 v18, v18
    v_mfma_f32_16x16x32_bf16 v[28:31], a[116:119], v[84:87], v[28:31]
    v_cvt_pk_bf16_f32 v40, v16, v17
    v_mfma_f32_16x16x32_bf16 v[28:31], a[120:123], v[88:91], v[28:31]
    s_add_u32 m0, s44, 101088
    v_exp_f32 v19, v19
    v_mfma_f32_16x16x32_bf16 v[28:31], a[124:127], v[92:95], v[28:31]
    buffer_load_dwordx4 v7, s[28:31], s45 offen offset:3456 lds
    v_mfma_f32_16x16x32_bf16 v[128:131], a[192:195], v[32:35], v[128:131]
    v_exp_f32 v20, v20
    v_mfma_f32_16x16x32_bf16 v[128:131], a[196:199], v[36:39], v[128:131]
    s_mov_b32 s45, 147584
    v_cvt_pk_bf16_f32 v41, v18, v19
    v_mfma_f32_16x16x32_bf16 v[132:135], a[200:203], v[32:35], v[132:135]
    s_add_u32 m0, s44, 118272
    v_exp_f32 v21, v21
    v_mfma_f32_16x16x32_bf16 v[132:135], a[204:207], v[36:39], v[132:135]
    buffer_load_dwordx4 v7, s[28:31], s45 offen offset:0 lds
    v_mfma_f32_16x16x32_bf16 v[136:139], a[208:211], v[32:35], v[136:139]
    v_exp_f32 v22, v22
    v_mfma_f32_16x16x32_bf16 v[136:139], a[212:215], v[36:39], v[136:139]
    v_cvt_pk_bf16_f32 v42, v20, v21
    v_mfma_f32_16x16x32_bf16 v[140:143], a[216:219], v[32:35], v[140:143]
    s_add_u32 m0, s44, 118176
    v_exp_f32 v23, v23
    v_mfma_f32_16x16x32_bf16 v[140:143], a[220:223], v[36:39], v[140:143]
    buffer_load_dwordx4 v7, s[28:31], s45 offen offset:1152 lds
    v_mfma_f32_16x16x32_bf16 v[144:147], a[224:227], v[32:35], v[144:147]
    v_exp_f32 v24, v24
    v_mfma_f32_16x16x32_bf16 v[144:147], a[228:231], v[36:39], v[144:147]
    v_cvt_pk_bf16_f32 v43, v22, v23
    v_mfma_f32_16x16x32_bf16 v[148:151], a[232:235], v[32:35], v[148:151]
    s_add_u32 m0, s44, 118080
    v_exp_f32 v25, v25
    v_mfma_f32_16x16x32_bf16 v[148:151], a[236:239], v[36:39], v[148:151]
    buffer_load_dwordx4 v7, s[28:31], s45 offen offset:2304 lds
    v_mfma_f32_16x16x32_bf16 v[152:155], a[240:243], v[32:35], v[152:155]
    v_exp_f32 v26, v26
    v_mfma_f32_16x16x32_bf16 v[152:155], a[244:247], v[36:39], v[152:155]
    v_cvt_pk_bf16_f32 v44, v24, v25
    v_mfma_f32_16x16x32_bf16 v[156:159], a[248:251], v[32:35], v[156:159]
    s_add_u32 m0, s44, 117984
    v_exp_f32 v27, v27
    v_mfma_f32_16x16x32_bf16 v[156:159], a[252:255], v[36:39], v[156:159]
    buffer_load_dwordx4 v7, s[28:31], s45 offen offset:3456 lds
    v_smfmac_f32_16x16x64_bf16 a[0:3], a[16:19], v[32:39], v11
    v_mfma_f32_16x16x32_bf16 v[16:19], a[64:67], v[96:99], v[56:59]
    v_exp_f32 v28, v28
    v_mfma_f32_16x16x32_bf16 v[16:19], a[68:71], v[100:103], v[16:19]
    s_mov_b32 s45, 256
    v_cvt_pk_bf16_f32 v45, v26, v27
    v_mfma_f32_16x16x32_bf16 v[16:19], a[72:75], v[104:107], v[16:19]
    s_add_u32 m0, s44, 0
    v_exp_f32 v29, v29
    v_mfma_f32_16x16x32_bf16 v[16:19], a[76:79], v[108:111], v[16:19]
    buffer_load_dwordx4 v7, s[28:31], s45 offen offset:0 lds
    v_mfma_f32_16x16x32_bf16 v[20:23], a[80:83], v[96:99], v[56:59]
    v_exp_f32 v30, v30
    v_mfma_f32_16x16x32_bf16 v[20:23], a[84:87], v[100:103], v[20:23]
    v_cvt_pk_bf16_f32 v46, v28, v29
    v_mfma_f32_16x16x32_bf16 v[20:23], a[88:91], v[104:107], v[20:23]
    s_add_u32 m0, s44, -96
    v_exp_f32 v31, v31
    v_mfma_f32_16x16x32_bf16 v[20:23], a[92:95], v[108:111], v[20:23]
    buffer_load_dwordx4 v7, s[28:31], s45 offen offset:1152 lds
    v_mfma_f32_16x16x32_bf16 v[24:27], a[96:99], v[96:99], v[56:59]
    v_exp_f32 v16, v16
    v_mfma_f32_16x16x32_bf16 v[24:27], a[100:103], v[100:103], v[24:27]
    v_cvt_pk_bf16_f32 v47, v30, v31
    v_mfma_f32_16x16x32_bf16 v[24:27], a[104:107], v[104:107], v[24:27]
    s_add_u32 m0, s44, -192
    v_exp_f32 v17, v17
    v_mfma_f32_16x16x32_bf16 v[24:27], a[108:111], v[108:111], v[24:27]
    buffer_load_dwordx4 v7, s[28:31], s45 offen offset:2304 lds
    v_mfma_f32_16x16x32_bf16 v[28:31], a[112:115], v[96:99], v[56:59]
    v_exp_f32 v18, v18
    v_mfma_f32_16x16x32_bf16 v[28:31], a[116:119], v[100:103], v[28:31]
    v_cvt_pk_bf16_f32 v32, v16, v17
    v_mfma_f32_16x16x32_bf16 v[28:31], a[120:123], v[104:107], v[28:31]
    s_add_u32 m0, s44, -288
    v_exp_f32 v19, v19
    v_mfma_f32_16x16x32_bf16 v[28:31], a[124:127], v[108:111], v[28:31]
    buffer_load_dwordx4 v7, s[28:31], s45 offen offset:3456 lds
    v_mfma_f32_16x16x32_bf16 v[160:163], a[192:195], v[40:43], v[160:163]
    v_exp_f32 v20, v20
    v_mfma_f32_16x16x32_bf16 v[160:163], a[196:199], v[44:47], v[160:163]
    s_mov_b32 s45, 147712
    v_cvt_pk_bf16_f32 v33, v18, v19
    v_mfma_f32_16x16x32_bf16 v[164:167], a[200:203], v[40:43], v[164:167]
    s_add_u32 m0, s44, 16896
    v_exp_f32 v21, v21
    v_mfma_f32_16x16x32_bf16 v[164:167], a[204:207], v[44:47], v[164:167]
    buffer_load_dwordx4 v7, s[28:31], s45 offen offset:0 lds
    v_mfma_f32_16x16x32_bf16 v[168:171], a[208:211], v[40:43], v[168:171]
    v_exp_f32 v22, v22
    v_mfma_f32_16x16x32_bf16 v[168:171], a[212:215], v[44:47], v[168:171]
    v_cvt_pk_bf16_f32 v34, v20, v21
    v_mfma_f32_16x16x32_bf16 v[172:175], a[216:219], v[40:43], v[172:175]
    s_add_u32 m0, s44, 16800
    v_exp_f32 v23, v23
    v_mfma_f32_16x16x32_bf16 v[172:175], a[220:223], v[44:47], v[172:175]
    buffer_load_dwordx4 v7, s[28:31], s45 offen offset:1152 lds
    v_mfma_f32_16x16x32_bf16 v[176:179], a[224:227], v[40:43], v[176:179]
    v_exp_f32 v24, v24
    v_mfma_f32_16x16x32_bf16 v[176:179], a[228:231], v[44:47], v[176:179]
    v_cvt_pk_bf16_f32 v35, v22, v23
    v_mfma_f32_16x16x32_bf16 v[180:183], a[232:235], v[40:43], v[180:183]
    s_add_u32 m0, s44, 16704
    v_exp_f32 v25, v25
    v_mfma_f32_16x16x32_bf16 v[180:183], a[236:239], v[44:47], v[180:183]
    buffer_load_dwordx4 v7, s[28:31], s45 offen offset:2304 lds
    v_mfma_f32_16x16x32_bf16 v[184:187], a[240:243], v[40:43], v[184:187]
    v_exp_f32 v26, v26
    v_mfma_f32_16x16x32_bf16 v[184:187], a[244:247], v[44:47], v[184:187]
    v_cvt_pk_bf16_f32 v36, v24, v25
    v_mfma_f32_16x16x32_bf16 v[188:191], a[248:251], v[40:43], v[188:191]
    s_add_u32 m0, s44, 16608
    v_exp_f32 v27, v27
    v_mfma_f32_16x16x32_bf16 v[188:191], a[252:255], v[44:47], v[188:191]
    buffer_load_dwordx4 v7, s[28:31], s45 offen offset:3456 lds
    v_smfmac_f32_16x16x64_bf16 a[4:7], a[16:19], v[40:47], v11
    v_mfma_f32_16x16x32_bf16 v[16:19], a[64:67], v[112:115], v[60:63]
    v_exp_f32 v28, v28
    v_mfma_f32_16x16x32_bf16 v[16:19], a[68:71], v[116:119], v[16:19]
    v_cvt_pk_bf16_f32 v37, v26, v27
    v_mfma_f32_16x16x32_bf16 v[16:19], a[72:75], v[120:123], v[16:19]
    v_exp_f32 v29, v29
    v_mfma_f32_16x16x32_bf16 v[16:19], a[76:79], v[124:127], v[16:19]
    v_mfma_f32_16x16x32_bf16 v[20:23], a[80:83], v[112:115], v[60:63]
    v_exp_f32 v30, v30
    v_mfma_f32_16x16x32_bf16 v[20:23], a[84:87], v[116:119], v[20:23]
    v_cvt_pk_bf16_f32 v38, v28, v29
    v_mfma_f32_16x16x32_bf16 v[20:23], a[88:91], v[120:123], v[20:23]
    v_exp_f32 v31, v31
    v_mfma_f32_16x16x32_bf16 v[20:23], a[92:95], v[124:127], v[20:23]
    v_mfma_f32_16x16x32_bf16 v[24:27], a[96:99], v[112:115], v[60:63]
    v_exp_f32 v16, v16
    v_mfma_f32_16x16x32_bf16 v[24:27], a[100:103], v[116:119], v[24:27]
    v_cvt_pk_bf16_f32 v39, v30, v31
    v_mfma_f32_16x16x32_bf16 v[24:27], a[104:107], v[120:123], v[24:27]
    v_exp_f32 v17, v17
    v_mfma_f32_16x16x32_bf16 v[24:27], a[108:111], v[124:127], v[24:27]
    v_mfma_f32_16x16x32_bf16 v[28:31], a[112:115], v[112:115], v[60:63]
    v_exp_f32 v18, v18
    v_mfma_f32_16x16x32_bf16 v[28:31], a[116:119], v[116:119], v[28:31]
    v_cvt_pk_bf16_f32 v40, v16, v17
    v_mfma_f32_16x16x32_bf16 v[28:31], a[120:123], v[120:123], v[28:31]
    v_exp_f32 v19, v19
    v_mfma_f32_16x16x32_bf16 v[28:31], a[124:127], v[124:127], v[28:31]
    v_mfma_f32_16x16x32_bf16 v[192:195], a[192:195], v[32:35], v[192:195]
    v_exp_f32 v20, v20
    v_mfma_f32_16x16x32_bf16 v[192:195], a[196:199], v[36:39], v[192:195]
    v_cvt_pk_bf16_f32 v41, v18, v19
    v_mfma_f32_16x16x32_bf16 v[196:199], a[200:203], v[32:35], v[196:199]
    v_exp_f32 v21, v21
    v_mfma_f32_16x16x32_bf16 v[196:199], a[204:207], v[36:39], v[196:199]
    v_mfma_f32_16x16x32_bf16 v[200:203], a[208:211], v[32:35], v[200:203]
    v_exp_f32 v22, v22
    v_mfma_f32_16x16x32_bf16 v[200:203], a[212:215], v[36:39], v[200:203]
    v_cvt_pk_bf16_f32 v42, v20, v21
    v_mfma_f32_16x16x32_bf16 v[204:207], a[216:219], v[32:35], v[204:207]
    v_exp_f32 v23, v23
    v_mfma_f32_16x16x32_bf16 v[204:207], a[220:223], v[36:39], v[204:207]
    v_mfma_f32_16x16x32_bf16 v[208:211], a[224:227], v[32:35], v[208:211]
    v_exp_f32 v24, v24
    v_mfma_f32_16x16x32_bf16 v[208:211], a[228:231], v[36:39], v[208:211]
    v_cvt_pk_bf16_f32 v43, v22, v23
    v_mfma_f32_16x16x32_bf16 v[212:215], a[232:235], v[32:35], v[212:215]
    v_exp_f32 v25, v25
    v_mfma_f32_16x16x32_bf16 v[212:215], a[236:239], v[36:39], v[212:215]
    v_mfma_f32_16x16x32_bf16 v[216:219], a[240:243], v[32:35], v[216:219]
    v_exp_f32 v26, v26
    v_mfma_f32_16x16x32_bf16 v[216:219], a[244:247], v[36:39], v[216:219]
    v_cvt_pk_bf16_f32 v44, v24, v25
    v_mfma_f32_16x16x32_bf16 v[220:223], a[248:251], v[32:35], v[220:223]
    v_exp_f32 v27, v27
    v_mfma_f32_16x16x32_bf16 v[220:223], a[252:255], v[36:39], v[220:223]
    v_smfmac_f32_16x16x64_bf16 a[8:11], a[16:19], v[32:39], v11
    v_exp_f32 v28, v28
    s_nop 0
    v_cvt_pk_bf16_f32 v45, v26, v27
    v_exp_f32 v29, v29
    s_nop 0
    v_exp_f32 v30, v30
    s_nop 0
    v_cvt_pk_bf16_f32 v46, v28, v29
    v_exp_f32 v31, v31
    s_nop 0
    v_cvt_pk_bf16_f32 v47, v30, v31
    s_nop 1
    v_mfma_f32_16x16x32_bf16 v[224:227], a[192:195], v[40:43], v[224:227]
    v_mfma_f32_16x16x32_bf16 v[224:227], a[196:199], v[44:47], v[224:227]
    v_mfma_f32_16x16x32_bf16 v[228:231], a[200:203], v[40:43], v[228:231]
    v_mfma_f32_16x16x32_bf16 v[228:231], a[204:207], v[44:47], v[228:231]
    v_mfma_f32_16x16x32_bf16 v[232:235], a[208:211], v[40:43], v[232:235]
    v_mfma_f32_16x16x32_bf16 v[232:235], a[212:215], v[44:47], v[232:235]
    v_mfma_f32_16x16x32_bf16 v[236:239], a[216:219], v[40:43], v[236:239]
    v_mfma_f32_16x16x32_bf16 v[236:239], a[220:223], v[44:47], v[236:239]
    v_mfma_f32_16x16x32_bf16 v[240:243], a[224:227], v[40:43], v[240:243]
    v_mfma_f32_16x16x32_bf16 v[240:243], a[228:231], v[44:47], v[240:243]
    v_mfma_f32_16x16x32_bf16 v[244:247], a[232:235], v[40:43], v[244:247]
    v_mfma_f32_16x16x32_bf16 v[244:247], a[236:239], v[44:47], v[244:247]
    v_mfma_f32_16x16x32_bf16 v[248:251], a[240:243], v[40:43], v[248:251]
    v_mfma_f32_16x16x32_bf16 v[248:251], a[244:247], v[44:47], v[248:251]
    v_mfma_f32_16x16x32_bf16 v[252:255], a[248:251], v[40:43], v[252:255]
    v_mfma_f32_16x16x32_bf16 v[252:255], a[252:255], v[44:47], v[252:255]
    v_smfmac_f32_16x16x64_bf16 a[12:15], a[16:19], v[40:47], v11
    s_nop 7
    v_accvgpr_read_b32 v12, a0
    v_accvgpr_read_b32 v16, a1
    v_accvgpr_read_b32 v13, a4
    v_accvgpr_read_b32 v17, a5
    v_accvgpr_read_b32 v14, a8
    v_accvgpr_read_b32 v18, a9
    v_accvgpr_read_b32 v15, a12
    v_accvgpr_read_b32 v19, a13
    v_add_f32 v12, v12, v16
    v_add_f32 v13, v13, v17
    v_add_f32 v14, v14, v18
    v_add_f32 v15, v15, v19
    s_mov_b32 s3, 0x5d800000
    v_cmp_nlt_f32 s[56:57], v12, s3
    v_cmp_nlt_f32 s[58:59], v13, s3
    v_cmp_nlt_f32 s[60:61], v14, s3
    v_cmp_nlt_f32 s[62:63], v15, s3
    s_or_b64 s[56:57], s[56:57], s[58:59]
    s_or_b64 s[60:61], s[60:61], s[62:63]
    s_or_b64 s[56:57], s[56:57], s[60:61]
    s_cselect_b32 s3, 1, 0
    s_lshl_b32 s14, s51, 2
    s_add_u32 s14, s14, 143360
    v_mov_b32 v16, s3
    v_mov_b32 v17, s14
    v_mov_b32 v18, 143360
    ds_write_b32 v17, v16
    v_rcp_f32 v12, v12
    v_rcp_f32 v13, v13
    v_rcp_f32 v14, v14
    v_rcp_f32 v15, v15
    s_waitcnt vmcnt(16) lgkmcnt(0)
    s_barrier
    ds_read_b128 v[20:23], v18
    ds_read_b64_tr_b16 a[64:65], v4 offset:0
    ds_read_b64_tr_b16 a[66:67], v4 offset:128
    ds_read_b64_tr_b16 a[68:69], v4 offset:256
    ds_read_b64_tr_b16 a[70:71], v4 offset:384
    ds_read_b64_tr_b16 a[72:73], v4 offset:512
    ds_read_b64_tr_b16 a[74:75], v4 offset:640
    ds_read_b64_tr_b16 a[76:77], v4 offset:768
    ds_read_b64_tr_b16 a[78:79], v4 offset:896
    ds_read_b64_tr_b16 a[80:81], v4 offset:16896
    ds_read_b64_tr_b16 a[82:83], v4 offset:17024
    ds_read_b64_tr_b16 a[84:85], v4 offset:17152
    ds_read_b64_tr_b16 a[86:87], v4 offset:17280
    ds_read_b64_tr_b16 a[88:89], v4 offset:17408
    ds_read_b64_tr_b16 a[90:91], v4 offset:17536
    ds_read_b64_tr_b16 a[92:93], v4 offset:17664
    ds_read_b64_tr_b16 a[94:95], v4 offset:17792
    v_mul_f32 v128, v128, v12
    v_mul_f32 v129, v129, v12
    v_mul_f32 v130, v130, v12
    v_mul_f32 v131, v131, v12
    v_mul_f32 v132, v132, v12
    v_mul_f32 v133, v133, v12
    v_mul_f32 v134, v134, v12
    v_mul_f32 v135, v135, v12
    v_cvt_pk_bf16_f32 v128, v128, v129
    v_cvt_pk_bf16_f32 v129, v130, v131
    v_cvt_pk_bf16_f32 v130, v132, v133
    v_cvt_pk_bf16_f32 v131, v134, v135
    v_mul_f32 v160, v160, v13
    v_mul_f32 v161, v161, v13
    v_mul_f32 v162, v162, v13
    v_mul_f32 v163, v163, v13
    v_mul_f32 v164, v164, v13
    v_mul_f32 v165, v165, v13
    v_mul_f32 v166, v166, v13
    v_mul_f32 v167, v167, v13
    v_cvt_pk_bf16_f32 v160, v160, v161
    v_cvt_pk_bf16_f32 v161, v162, v163
    v_cvt_pk_bf16_f32 v162, v164, v165
    v_cvt_pk_bf16_f32 v163, v166, v167
    v_mul_f32 v136, v136, v12
    v_mul_f32 v137, v137, v12
    v_mul_f32 v138, v138, v12
    v_mul_f32 v139, v139, v12
    v_mul_f32 v140, v140, v12
    v_mul_f32 v141, v141, v12
    v_mul_f32 v142, v142, v12
    v_mul_f32 v143, v143, v12
    v_cvt_pk_bf16_f32 v136, v136, v137
    v_cvt_pk_bf16_f32 v137, v138, v139
    v_cvt_pk_bf16_f32 v138, v140, v141
    v_cvt_pk_bf16_f32 v139, v142, v143
    v_mul_f32 v168, v168, v13
    v_mul_f32 v169, v169, v13
    v_mul_f32 v170, v170, v13
    v_mul_f32 v171, v171, v13
    v_mul_f32 v172, v172, v13
    v_mul_f32 v173, v173, v13
    v_mul_f32 v174, v174, v13
    v_mul_f32 v175, v175, v13
    v_cvt_pk_bf16_f32 v168, v168, v169
    v_cvt_pk_bf16_f32 v169, v170, v171
    v_cvt_pk_bf16_f32 v170, v172, v173
    v_cvt_pk_bf16_f32 v171, v174, v175
    v_mul_f32 v144, v144, v12
    v_mul_f32 v145, v145, v12
    v_mul_f32 v146, v146, v12
    v_mul_f32 v147, v147, v12
    v_mul_f32 v148, v148, v12
    v_mul_f32 v149, v149, v12
    v_mul_f32 v150, v150, v12
    v_mul_f32 v151, v151, v12
    v_cvt_pk_bf16_f32 v144, v144, v145
    v_cvt_pk_bf16_f32 v145, v146, v147
    v_cvt_pk_bf16_f32 v146, v148, v149
    v_cvt_pk_bf16_f32 v147, v150, v151
    v_mul_f32 v176, v176, v13
    v_mul_f32 v177, v177, v13
    v_mul_f32 v178, v178, v13
    v_mul_f32 v179, v179, v13
    v_mul_f32 v180, v180, v13
    v_mul_f32 v181, v181, v13
    v_mul_f32 v182, v182, v13
    v_mul_f32 v183, v183, v13
    v_cvt_pk_bf16_f32 v176, v176, v177
    v_cvt_pk_bf16_f32 v177, v178, v179
    v_cvt_pk_bf16_f32 v178, v180, v181
    v_cvt_pk_bf16_f32 v179, v182, v183
    v_mul_f32 v152, v152, v12
    v_mul_f32 v153, v153, v12
    v_mul_f32 v154, v154, v12
    v_mul_f32 v155, v155, v12
    v_mul_f32 v156, v156, v12
    v_mul_f32 v157, v157, v12
    v_mul_f32 v158, v158, v12
    v_mul_f32 v159, v159, v12
    v_cvt_pk_bf16_f32 v152, v152, v153
    v_cvt_pk_bf16_f32 v153, v154, v155
    v_cvt_pk_bf16_f32 v154, v156, v157
    v_cvt_pk_bf16_f32 v155, v158, v159
    v_mul_f32 v184, v184, v13
    v_mul_f32 v185, v185, v13
    v_mul_f32 v186, v186, v13
    v_mul_f32 v187, v187, v13
    v_mul_f32 v188, v188, v13
    v_mul_f32 v189, v189, v13
    v_mul_f32 v190, v190, v13
    v_mul_f32 v191, v191, v13
    v_cvt_pk_bf16_f32 v184, v184, v185
    v_cvt_pk_bf16_f32 v185, v186, v187
    v_cvt_pk_bf16_f32 v186, v188, v189
    v_cvt_pk_bf16_f32 v187, v190, v191
    v_mul_f32 v192, v192, v14
    v_mul_f32 v193, v193, v14
    v_mul_f32 v194, v194, v14
    v_mul_f32 v195, v195, v14
    v_mul_f32 v196, v196, v14
    v_mul_f32 v197, v197, v14
    v_mul_f32 v198, v198, v14
    v_mul_f32 v199, v199, v14
    v_cvt_pk_bf16_f32 v192, v192, v193
    v_cvt_pk_bf16_f32 v193, v194, v195
    v_cvt_pk_bf16_f32 v194, v196, v197
    v_cvt_pk_bf16_f32 v195, v198, v199
    v_mul_f32 v224, v224, v15
    v_mul_f32 v225, v225, v15
    v_mul_f32 v226, v226, v15
    v_mul_f32 v227, v227, v15
    v_mul_f32 v228, v228, v15
    v_mul_f32 v229, v229, v15
    v_mul_f32 v230, v230, v15
    v_mul_f32 v231, v231, v15
    v_cvt_pk_bf16_f32 v224, v224, v225
    v_cvt_pk_bf16_f32 v225, v226, v227
    v_cvt_pk_bf16_f32 v226, v228, v229
    v_cvt_pk_bf16_f32 v227, v230, v231
    v_mul_f32 v200, v200, v14
    v_mul_f32 v201, v201, v14
    v_mul_f32 v202, v202, v14
    v_mul_f32 v203, v203, v14
    v_mul_f32 v204, v204, v14
    v_mul_f32 v205, v205, v14
    v_mul_f32 v206, v206, v14
    v_mul_f32 v207, v207, v14
    v_cvt_pk_bf16_f32 v200, v200, v201
    v_cvt_pk_bf16_f32 v201, v202, v203
    v_cvt_pk_bf16_f32 v202, v204, v205
    v_cvt_pk_bf16_f32 v203, v206, v207
    v_mul_f32 v232, v232, v15
    v_mul_f32 v233, v233, v15
    v_mul_f32 v234, v234, v15
    v_mul_f32 v235, v235, v15
    v_mul_f32 v236, v236, v15
    v_mul_f32 v237, v237, v15
    v_mul_f32 v238, v238, v15
    v_mul_f32 v239, v239, v15
    v_cvt_pk_bf16_f32 v232, v232, v233
    v_cvt_pk_bf16_f32 v233, v234, v235
    v_cvt_pk_bf16_f32 v234, v236, v237
    v_cvt_pk_bf16_f32 v235, v238, v239
    v_mul_f32 v208, v208, v14
    v_mul_f32 v209, v209, v14
    v_mul_f32 v210, v210, v14
    v_mul_f32 v211, v211, v14
    v_mul_f32 v212, v212, v14
    v_mul_f32 v213, v213, v14
    v_mul_f32 v214, v214, v14
    v_mul_f32 v215, v215, v14
    v_cvt_pk_bf16_f32 v208, v208, v209
    v_cvt_pk_bf16_f32 v209, v210, v211
    v_cvt_pk_bf16_f32 v210, v212, v213
    v_cvt_pk_bf16_f32 v211, v214, v215
    v_mul_f32 v240, v240, v15
    v_mul_f32 v241, v241, v15
    v_mul_f32 v242, v242, v15
    v_mul_f32 v243, v243, v15
    v_mul_f32 v244, v244, v15
    v_mul_f32 v245, v245, v15
    v_mul_f32 v246, v246, v15
    v_mul_f32 v247, v247, v15
    v_cvt_pk_bf16_f32 v240, v240, v241
    v_cvt_pk_bf16_f32 v241, v242, v243
    v_cvt_pk_bf16_f32 v242, v244, v245
    v_cvt_pk_bf16_f32 v243, v246, v247
    v_mul_f32 v216, v216, v14
    v_mul_f32 v217, v217, v14
    v_mul_f32 v218, v218, v14
    v_mul_f32 v219, v219, v14
    v_mul_f32 v220, v220, v14
    v_mul_f32 v221, v221, v14
    v_mul_f32 v222, v222, v14
    v_mul_f32 v223, v223, v14
    v_cvt_pk_bf16_f32 v216, v216, v217
    v_cvt_pk_bf16_f32 v217, v218, v219
    v_cvt_pk_bf16_f32 v218, v220, v221
    v_cvt_pk_bf16_f32 v219, v222, v223
    v_mul_f32 v248, v248, v15
    v_mul_f32 v249, v249, v15
    v_mul_f32 v250, v250, v15
    v_mul_f32 v251, v251, v15
    v_mul_f32 v252, v252, v15
    v_mul_f32 v253, v253, v15
    v_mul_f32 v254, v254, v15
    v_mul_f32 v255, v255, v15
    v_cvt_pk_bf16_f32 v248, v248, v249
    v_cvt_pk_bf16_f32 v249, v250, v251
    v_cvt_pk_bf16_f32 v250, v252, v253
    v_cvt_pk_bf16_f32 v251, v254, v255
    s_waitcnt lgkmcnt(12)
    v_or3_b32 v20, v20, v21, v22
    v_or_b32 v20, v20, v23
    s_nop 0
    v_readfirstlane_b32 s3, v20
    s_nop 0
    s_andn2_b32 s3, s3, s50
    s_cbranch_scc1 L2_fallback
    v_mfma_f32_16x16x32_bf16 v[16:19], a[64:67], v[128:131], 0
    ds_read_b64_tr_b16 a[96:97], v4 offset:32
    ds_read_b64_tr_b16 a[98:99], v4 offset:160
    v_mfma_f32_16x16x32_bf16 v[16:19], a[68:71], v[136:139], v[16:19]
    s_waitcnt lgkmcnt(10)
    ds_read_b64_tr_b16 a[100:101], v4 offset:288
    ds_read_b64_tr_b16 a[102:103], v4 offset:416
    v_mfma_f32_16x16x32_bf16 v[16:19], a[72:75], v[144:147], v[16:19]
    ds_read_b64_tr_b16 a[104:105], v4 offset:544
    v_mfma_f32_16x16x32_bf16 v[16:19], a[76:79], v[152:155], v[16:19]
    s_waitcnt lgkmcnt(9)
    ds_read_b64_tr_b16 a[106:107], v4 offset:672
    v_mfma_f32_16x16x32_bf16 v[16:19], a[80:83], v[192:195], v[16:19]
    ds_read_b64_tr_b16 a[108:109], v4 offset:800
    v_mfma_f32_16x16x32_bf16 v[16:19], a[84:87], v[200:203], v[16:19]
    s_mov_b32 s45, 384
    s_waitcnt lgkmcnt(7)
    ds_read_b64_tr_b16 a[110:111], v4 offset:928
    v_mfma_f32_16x16x32_bf16 v[16:19], a[88:91], v[208:211], v[16:19]
    s_add_u32 m0, s44, 33792
    ds_read_b64_tr_b16 a[112:113], v4 offset:16928
    v_mfma_f32_16x16x32_bf16 v[16:19], a[92:95], v[216:219], v[16:19]
    buffer_load_dwordx4 v7, s[28:31], s45 offen offset:0 lds
    v_mfma_f32_16x16x32_bf16 v[20:23], a[64:67], v[160:163], 0
    ds_read_b64_tr_b16 a[114:115], v4 offset:17056
    v_mfma_f32_16x16x32_bf16 v[20:23], a[68:71], v[168:171], v[20:23]
    ds_read_b64_tr_b16 a[116:117], v4 offset:17184
    v_mfma_f32_16x16x32_bf16 v[20:23], a[72:75], v[176:179], v[20:23]
    ds_read_b64_tr_b16 a[118:119], v4 offset:17312
    v_mfma_f32_16x16x32_bf16 v[20:23], a[76:79], v[184:187], v[20:23]
    ds_read_b64_tr_b16 a[120:121], v4 offset:17440
    v_mfma_f32_16x16x32_bf16 v[20:23], a[80:83], v[224:227], v[20:23]
    ds_read_b64_tr_b16 a[122:123], v4 offset:17568
    v_mfma_f32_16x16x32_bf16 v[20:23], a[84:87], v[232:235], v[20:23]
    ds_read_b64_tr_b16 a[124:125], v4 offset:17696
    v_mfma_f32_16x16x32_bf16 v[20:23], a[88:91], v[240:243], v[20:23]
    s_add_u32 m0, s44, 33696
    ds_read_b64_tr_b16 a[126:127], v4 offset:17824
    v_mfma_f32_16x16x32_bf16 v[20:23], a[92:95], v[248:251], v[20:23]
    s_waitcnt lgkmcnt(12)
    buffer_load_dwordx4 v7, s[28:31], s45 offen offset:1152 lds
    v_mfma_f32_16x16x32_bf16 v[24:27], a[96:99], v[128:131], 0
    ds_read_b64_tr_b16 a[64:65], v4 offset:64
    ds_read_b64_tr_b16 a[66:67], v4 offset:192
    v_mfma_f32_16x16x32_bf16 v[24:27], a[100:103], v[136:139], v[24:27]
    s_waitcnt lgkmcnt(10)
    ds_read_b64_tr_b16 a[68:69], v4 offset:320
    ds_read_b64_tr_b16 a[70:71], v4 offset:448
    v_mfma_f32_16x16x32_bf16 v[24:27], a[104:107], v[144:147], v[24:27]
    ds_read_b64_tr_b16 a[72:73], v4 offset:576
    v_mfma_f32_16x16x32_bf16 v[24:27], a[108:111], v[152:155], v[24:27]
    s_waitcnt lgkmcnt(9)
    ds_read_b64_tr_b16 a[74:75], v4 offset:704
    v_mfma_f32_16x16x32_bf16 v[24:27], a[112:115], v[192:195], v[24:27]
    ds_read_b64_tr_b16 a[76:77], v4 offset:832
    v_mfma_f32_16x16x32_bf16 v[24:27], a[116:119], v[200:203], v[24:27]
    s_waitcnt lgkmcnt(7)
    ds_read_b64_tr_b16 a[78:79], v4 offset:960
    v_mfma_f32_16x16x32_bf16 v[24:27], a[120:123], v[208:211], v[24:27]
    s_add_u32 m0, s44, 33600
    ds_read_b64_tr_b16 a[80:81], v4 offset:16960
    v_mfma_f32_16x16x32_bf16 v[24:27], a[124:127], v[216:219], v[24:27]
    buffer_load_dwordx4 v7, s[28:31], s45 offen offset:2304 lds
    v_mfma_f32_16x16x32_bf16 v[28:31], a[96:99], v[160:163], 0
    ds_read_b64_tr_b16 a[82:83], v4 offset:17088
    v_mfma_f32_16x16x32_bf16 v[28:31], a[100:103], v[168:171], v[28:31]
    ds_read_b64_tr_b16 a[84:85], v4 offset:17216
    v_mfma_f32_16x16x32_bf16 v[28:31], a[104:107], v[176:179], v[28:31]
    ds_read_b64_tr_b16 a[86:87], v4 offset:17344
    v_mfma_f32_16x16x32_bf16 v[28:31], a[108:111], v[184:187], v[28:31]
    ds_read_b64_tr_b16 a[88:89], v4 offset:17472
    v_mfma_f32_16x16x32_bf16 v[28:31], a[112:115], v[224:227], v[28:31]
    ds_read_b64_tr_b16 a[90:91], v4 offset:17600
    v_mfma_f32_16x16x32_bf16 v[28:31], a[116:119], v[232:235], v[28:31]
    ds_read_b64_tr_b16 a[92:93], v4 offset:17728
    v_mfma_f32_16x16x32_bf16 v[28:31], a[120:123], v[240:243], v[28:31]
    s_add_u32 m0, s44, 33504
    ds_read_b64_tr_b16 a[94:95], v4 offset:17856
    v_mfma_f32_16x16x32_bf16 v[28:31], a[124:127], v[248:251], v[28:31]
    s_waitcnt lgkmcnt(12)
    buffer_load_dwordx4 v7, s[28:31], s45 offen offset:3456 lds
    v_mfma_f32_16x16x32_bf16 v[32:35], a[64:67], v[128:131], 0
    ds_read_b64_tr_b16 a[96:97], v4 offset:96
    v_cvt_pk_bf16_f32 v48, v16, v17
    v_mfma_f32_16x16x32_bf16 v[32:35], a[68:71], v[136:139], v[32:35]
    s_waitcnt lgkmcnt(9)
    ds_read_b64_tr_b16 a[98:99], v4 offset:224
    v_cvt_pk_bf16_f32 v49, v18, v19
    v_mfma_f32_16x16x32_bf16 v[32:35], a[72:75], v[144:147], v[32:35]
    ds_read_b64_tr_b16 a[100:101], v4 offset:352
    v_cvt_pk_bf16_f32 v50, v24, v25
    v_mfma_f32_16x16x32_bf16 v[32:35], a[76:79], v[152:155], v[32:35]
    s_waitcnt lgkmcnt(7)
    ds_read_b64_tr_b16 a[102:103], v4 offset:480
    v_cvt_pk_bf16_f32 v51, v26, v27
    v_mfma_f32_16x16x32_bf16 v[32:35], a[80:83], v[192:195], v[32:35]
    s_mov_b32 s54, 0
    ds_read_b64_tr_b16 a[104:105], v4 offset:608
    ds_read_b64_tr_b16 a[106:107], v4 offset:736
    v_mfma_f32_16x16x32_bf16 v[32:35], a[84:87], v[200:203], v[32:35]
    s_mov_b32 s45, 147840
    s_waitcnt lgkmcnt(6)
    v_permlane32_swap_b32 v48, v50
    v_mfma_f32_16x16x32_bf16 v[32:35], a[88:91], v[208:211], v[32:35]
    s_add_u32 m0, s44, 50688
    v_permlane32_swap_b32 v49, v51
    v_mfma_f32_16x16x32_bf16 v[32:35], a[92:95], v[216:219], v[32:35]
    buffer_load_dwordx4 v7, s[28:31], s45 offen offset:0 lds
    ds_read_b64_tr_b16 a[108:109], v4 offset:864
    ds_read_b64_tr_b16 a[110:111], v4 offset:992
    buffer_store_dwordx4 v[48:51], v10, s[40:43], s54 offen offset:0
    v_mfma_f32_16x16x32_bf16 v[36:39], a[64:67], v[160:163], 0
    ds_read_b64_tr_b16 a[112:113], v4 offset:16992
    v_cvt_pk_bf16_f32 v52, v20, v21
    v_mfma_f32_16x16x32_bf16 v[36:39], a[68:71], v[168:171], v[36:39]
    ds_read_b64_tr_b16 a[114:115], v4 offset:17120
    v_cvt_pk_bf16_f32 v53, v22, v23
    v_mfma_f32_16x16x32_bf16 v[36:39], a[72:75], v[176:179], v[36:39]
    ds_read_b64_tr_b16 a[116:117], v4 offset:17248
    v_cvt_pk_bf16_f32 v54, v28, v29
    v_mfma_f32_16x16x32_bf16 v[36:39], a[76:79], v[184:187], v[36:39]
    ds_read_b64_tr_b16 a[118:119], v4 offset:17376
    v_cvt_pk_bf16_f32 v55, v30, v31
    v_mfma_f32_16x16x32_bf16 v[36:39], a[80:83], v[224:227], v[36:39]
    s_mov_b32 s54, 294912
    ds_read_b64_tr_b16 a[120:121], v4 offset:17504
    ds_read_b64_tr_b16 a[122:123], v4 offset:17632
    v_mfma_f32_16x16x32_bf16 v[36:39], a[84:87], v[232:235], v[36:39]
    v_permlane32_swap_b32 v52, v54
    v_mfma_f32_16x16x32_bf16 v[36:39], a[88:91], v[240:243], v[36:39]
    s_add_u32 m0, s44, 50592
    v_permlane32_swap_b32 v53, v55
    v_mfma_f32_16x16x32_bf16 v[36:39], a[92:95], v[248:251], v[36:39]
    s_waitcnt vmcnt(14)
    s_barrier
    s_waitcnt lgkmcnt(10)
    buffer_load_dwordx4 v7, s[28:31], s45 offen offset:1152 lds
    ds_read_b64_tr_b16 a[124:125], v4 offset:17760
    ds_read_b64_tr_b16 a[126:127], v4 offset:17888
    buffer_store_dwordx4 v[52:55], v10, s[40:43], s54 offen offset:0
    v_mfma_f32_16x16x32_bf16 v[40:43], a[96:99], v[128:131], 0
    ds_read_b64_tr_b16 a[64:65], v4 offset:33792
    ds_read_b64_tr_b16 a[66:67], v4 offset:33920
    v_mfma_f32_16x16x32_bf16 v[40:43], a[100:103], v[136:139], v[40:43]
    s_waitcnt lgkmcnt(10)
    ds_read_b64_tr_b16 a[68:69], v4 offset:34048
    ds_read_b64_tr_b16 a[70:71], v4 offset:34176
    v_mfma_f32_16x16x32_bf16 v[40:43], a[104:107], v[144:147], v[40:43]
    ds_read_b64_tr_b16 a[72:73], v4 offset:34304
    v_mfma_f32_16x16x32_bf16 v[40:43], a[108:111], v[152:155], v[40:43]
    s_waitcnt lgkmcnt(9)
    ds_read_b64_tr_b16 a[74:75], v4 offset:34432
    v_mfma_f32_16x16x32_bf16 v[40:43], a[112:115], v[192:195], v[40:43]
    ds_read_b64_tr_b16 a[76:77], v4 offset:34560
    v_mfma_f32_16x16x32_bf16 v[40:43], a[116:119], v[200:203], v[40:43]
    s_waitcnt lgkmcnt(7)
    ds_read_b64_tr_b16 a[78:79], v4 offset:34688
    v_mfma_f32_16x16x32_bf16 v[40:43], a[120:123], v[208:211], v[40:43]
    s_add_u32 m0, s44, 50496
    ds_read_b64_tr_b16 a[80:81], v4 offset:50688
    v_mfma_f32_16x16x32_bf16 v[40:43], a[124:127], v[216:219], v[40:43]
    buffer_load_dwordx4 v7, s[28:31], s45 offen offset:2304 lds
    v_mfma_f32_16x16x32_bf16 v[44:47], a[96:99], v[160:163], 0
    ds_read_b64_tr_b16 a[82:83], v4 offset:50816
    v_mfma_f32_16x16x32_bf16 v[44:47], a[100:103], v[168:171], v[44:47]
    ds_read_b64_tr_b16 a[84:85], v4 offset:50944
    v_mfma_f32_16x16x32_bf16 v[44:47], a[104:107], v[176:179], v[44:47]
    ds_read_b64_tr_b16 a[86:87], v4 offset:51072
    v_mfma_f32_16x16x32_bf16 v[44:47], a[108:111], v[184:187], v[44:47]
    ds_read_b64_tr_b16 a[88:89], v4 offset:51200
    v_mfma_f32_16x16x32_bf16 v[44:47], a[112:115], v[224:227], v[44:47]
    ds_read_b64_tr_b16 a[90:91], v4 offset:51328
    v_mfma_f32_16x16x32_bf16 v[44:47], a[116:119], v[232:235], v[44:47]
    ds_read_b64_tr_b16 a[92:93], v4 offset:51456
    v_mfma_f32_16x16x32_bf16 v[44:47], a[120:123], v[240:243], v[44:47]
    s_add_u32 m0, s44, 50400
    ds_read_b64_tr_b16 a[94:95], v4 offset:51584
    v_mfma_f32_16x16x32_bf16 v[44:47], a[124:127], v[248:251], v[44:47]
    s_waitcnt lgkmcnt(12)
    buffer_load_dwordx4 v7, s[28:31], s45 offen offset:3456 lds
    v_mfma_f32_16x16x32_bf16 v[16:19], a[64:67], v[128:131], 0
    ds_read_b64_tr_b16 a[96:97], v4 offset:33824
    v_cvt_pk_bf16_f32 v48, v32, v33
    v_mfma_f32_16x16x32_bf16 v[16:19], a[68:71], v[136:139], v[16:19]
    s_waitcnt lgkmcnt(9)
    ds_read_b64_tr_b16 a[98:99], v4 offset:33952
    v_cvt_pk_bf16_f32 v49, v34, v35
    v_mfma_f32_16x16x32_bf16 v[16:19], a[72:75], v[144:147], v[16:19]
    ds_read_b64_tr_b16 a[100:101], v4 offset:34080
    v_cvt_pk_bf16_f32 v50, v40, v41
    v_mfma_f32_16x16x32_bf16 v[16:19], a[76:79], v[152:155], v[16:19]
    s_waitcnt lgkmcnt(7)
    ds_read_b64_tr_b16 a[102:103], v4 offset:34208
    v_cvt_pk_bf16_f32 v51, v42, v43
    v_mfma_f32_16x16x32_bf16 v[16:19], a[80:83], v[192:195], v[16:19]
    s_mov_b32 s54, 0
    ds_read_b64_tr_b16 a[104:105], v4 offset:34336
    ds_read_b64_tr_b16 a[106:107], v4 offset:34464
    v_mfma_f32_16x16x32_bf16 v[16:19], a[84:87], v[200:203], v[16:19]
    s_waitcnt lgkmcnt(6)
    v_permlane32_swap_b32 v48, v50
    v_mfma_f32_16x16x32_bf16 v[16:19], a[88:91], v[208:211], v[16:19]
    v_permlane32_swap_b32 v49, v51
    v_mfma_f32_16x16x32_bf16 v[16:19], a[92:95], v[216:219], v[16:19]
    ds_read_b64_tr_b16 a[108:109], v4 offset:34592
    ds_read_b64_tr_b16 a[110:111], v4 offset:34720
    buffer_store_dwordx4 v[48:51], v10, s[40:43], s54 offen offset:512
    v_mfma_f32_16x16x32_bf16 v[20:23], a[64:67], v[160:163], 0
    ds_read_b64_tr_b16 a[112:113], v4 offset:50720
    v_cvt_pk_bf16_f32 v52, v36, v37
    v_mfma_f32_16x16x32_bf16 v[20:23], a[68:71], v[168:171], v[20:23]
    ds_read_b64_tr_b16 a[114:115], v4 offset:50848
    v_cvt_pk_bf16_f32 v53, v38, v39
    v_mfma_f32_16x16x32_bf16 v[20:23], a[72:75], v[176:179], v[20:23]
    ds_read_b64_tr_b16 a[116:117], v4 offset:50976
    v_cvt_pk_bf16_f32 v54, v44, v45
    v_mfma_f32_16x16x32_bf16 v[20:23], a[76:79], v[184:187], v[20:23]
    ds_read_b64_tr_b16 a[118:119], v4 offset:51104
    v_cvt_pk_bf16_f32 v55, v46, v47
    v_mfma_f32_16x16x32_bf16 v[20:23], a[80:83], v[224:227], v[20:23]
    s_mov_b32 s54, 294912
    ds_read_b64_tr_b16 a[120:121], v4 offset:51232
    ds_read_b64_tr_b16 a[122:123], v4 offset:51360
    v_mfma_f32_16x16x32_bf16 v[20:23], a[84:87], v[232:235], v[20:23]
    v_permlane32_swap_b32 v52, v54
    v_mfma_f32_16x16x32_bf16 v[20:23], a[88:91], v[240:243], v[20:23]
    v_permlane32_swap_b32 v53, v55
    v_mfma_f32_16x16x32_bf16 v[20:23], a[92:95], v[248:251], v[20:23]
    s_waitcnt lgkmcnt(10)
    ds_read_b64_tr_b16 a[124:125], v4 offset:51488
    ds_read_b64_tr_b16 a[126:127], v4 offset:51616
    buffer_store_dwordx4 v[52:55], v10, s[40:43], s54 offen offset:512
    v_mfma_f32_16x16x32_bf16 v[24:27], a[96:99], v[128:131], 0
    ds_read_b64_tr_b16 a[64:65], v4 offset:33856
    v_mfma_f32_16x16x32_bf16 v[24:27], a[100:103], v[136:139], v[24:27]
    s_waitcnt lgkmcnt(9)
    ds_read_b64_tr_b16 a[66:67], v4 offset:33984
    v_mfma_f32_16x16x32_bf16 v[24:27], a[104:107], v[144:147], v[24:27]
    ds_read_b64_tr_b16 a[68:69], v4 offset:34112
    v_mfma_f32_16x16x32_bf16 v[24:27], a[108:111], v[152:155], v[24:27]
    s_waitcnt lgkmcnt(7)
    ds_read_b64_tr_b16 a[70:71], v4 offset:34240
    v_mfma_f32_16x16x32_bf16 v[24:27], a[112:115], v[192:195], v[24:27]
    ds_read_b64_tr_b16 a[72:73], v4 offset:34368
    v_mfma_f32_16x16x32_bf16 v[24:27], a[116:119], v[200:203], v[24:27]
    s_waitcnt lgkmcnt(5)
    ds_read_b64_tr_b16 a[74:75], v4 offset:34496
    v_mfma_f32_16x16x32_bf16 v[24:27], a[120:123], v[208:211], v[24:27]
    ds_read_b64_tr_b16 a[76:77], v4 offset:34624
    v_mfma_f32_16x16x32_bf16 v[24:27], a[124:127], v[216:219], v[24:27]
    ds_read_b64_tr_b16 a[78:79], v4 offset:34752
    v_mfma_f32_16x16x32_bf16 v[28:31], a[96:99], v[160:163], 0
    ds_read_b64_tr_b16 a[80:81], v4 offset:50752
    v_mfma_f32_16x16x32_bf16 v[28:31], a[100:103], v[168:171], v[28:31]
    ds_read_b64_tr_b16 a[82:83], v4 offset:50880
    v_mfma_f32_16x16x32_bf16 v[28:31], a[104:107], v[176:179], v[28:31]
    ds_read_b64_tr_b16 a[84:85], v4 offset:51008
    v_mfma_f32_16x16x32_bf16 v[28:31], a[108:111], v[184:187], v[28:31]
    ds_read_b64_tr_b16 a[86:87], v4 offset:51136
    v_mfma_f32_16x16x32_bf16 v[28:31], a[112:115], v[224:227], v[28:31]
    ds_read_b64_tr_b16 a[88:89], v4 offset:51264
    v_mfma_f32_16x16x32_bf16 v[28:31], a[116:119], v[232:235], v[28:31]
    ds_read_b64_tr_b16 a[90:91], v4 offset:51392
    v_mfma_f32_16x16x32_bf16 v[28:31], a[120:123], v[240:243], v[28:31]
    ds_read_b64_tr_b16 a[92:93], v4 offset:51520
    v_mfma_f32_16x16x32_bf16 v[28:31], a[124:127], v[248:251], v[28:31]
    s_waitcnt lgkmcnt(11)
    ds_read_b64_tr_b16 a[94:95], v4 offset:51648
    v_mfma_f32_16x16x32_bf16 v[32:35], a[64:67], v[128:131], 0
    ds_read_b64_tr_b16 a[96:97], v4 offset:33888
    v_cvt_pk_bf16_f32 v48, v16, v17
    v_mfma_f32_16x16x32_bf16 v[32:35], a[68:71], v[136:139], v[32:35]
    s_waitcnt lgkmcnt(9)
    ds_read_b64_tr_b16 a[98:99], v4 offset:34016
    v_cvt_pk_bf16_f32 v49, v18, v19
    v_mfma_f32_16x16x32_bf16 v[32:35], a[72:75], v[144:147], v[32:35]
    ds_read_b64_tr_b16 a[100:101], v4 offset:34144
    v_cvt_pk_bf16_f32 v50, v24, v25
    v_mfma_f32_16x16x32_bf16 v[32:35], a[76:79], v[152:155], v[32:35]
    s_waitcnt lgkmcnt(7)
    ds_read_b64_tr_b16 a[102:103], v4 offset:34272
    v_cvt_pk_bf16_f32 v51, v26, v27
    v_mfma_f32_16x16x32_bf16 v[32:35], a[80:83], v[192:195], v[32:35]
    s_mov_b32 s54, 1024
    ds_read_b64_tr_b16 a[104:105], v4 offset:34400
    ds_read_b64_tr_b16 a[106:107], v4 offset:34528
    v_mfma_f32_16x16x32_bf16 v[32:35], a[84:87], v[200:203], v[32:35]
    s_waitcnt lgkmcnt(6)
    v_permlane32_swap_b32 v48, v50
    v_mfma_f32_16x16x32_bf16 v[32:35], a[88:91], v[208:211], v[32:35]
    v_permlane32_swap_b32 v49, v51
    v_mfma_f32_16x16x32_bf16 v[32:35], a[92:95], v[216:219], v[32:35]
    ds_read_b64_tr_b16 a[108:109], v4 offset:34656
    ds_read_b64_tr_b16 a[110:111], v4 offset:34784
    buffer_store_dwordx4 v[48:51], v10, s[40:43], s54 offen offset:0
    v_mfma_f32_16x16x32_bf16 v[36:39], a[64:67], v[160:163], 0
    ds_read_b64_tr_b16 a[112:113], v4 offset:50784
    v_cvt_pk_bf16_f32 v52, v20, v21
    v_mfma_f32_16x16x32_bf16 v[36:39], a[68:71], v[168:171], v[36:39]
    ds_read_b64_tr_b16 a[114:115], v4 offset:50912
    v_cvt_pk_bf16_f32 v53, v22, v23
    v_mfma_f32_16x16x32_bf16 v[36:39], a[72:75], v[176:179], v[36:39]
    ds_read_b64_tr_b16 a[116:117], v4 offset:51040
    v_cvt_pk_bf16_f32 v54, v28, v29
    v_mfma_f32_16x16x32_bf16 v[36:39], a[76:79], v[184:187], v[36:39]
    ds_read_b64_tr_b16 a[118:119], v4 offset:51168
    v_cvt_pk_bf16_f32 v55, v30, v31
    v_mfma_f32_16x16x32_bf16 v[36:39], a[80:83], v[224:227], v[36:39]
    s_mov_b32 s54, 295936
    ds_read_b64_tr_b16 a[120:121], v4 offset:51296
    ds_read_b64_tr_b16 a[122:123], v4 offset:51424
    v_mfma_f32_16x16x32_bf16 v[36:39], a[84:87], v[232:235], v[36:39]
    v_permlane32_swap_b32 v52, v54
    v_mfma_f32_16x16x32_bf16 v[36:39], a[88:91], v[240:243], v[36:39]
    v_permlane32_swap_b32 v53, v55
    v_mfma_f32_16x16x32_bf16 v[36:39], a[92:95], v[248:251], v[36:39]
    s_waitcnt vmcnt(13)
    s_barrier
    s_waitcnt lgkmcnt(10)
    ds_read_b64_tr_b16 a[124:125], v4 offset:51552
    ds_read_b64_tr_b16 a[126:127], v4 offset:51680
    buffer_store_dwordx4 v[52:55], v10, s[40:43], s54 offen offset:0
    v_mfma_f32_16x16x32_bf16 v[40:43], a[96:99], v[128:131], 0
    ds_read_b64_tr_b16 a[64:65], v3 offset:0
    ds_read_b64_tr_b16 a[66:67], v3 offset:128
    v_mfma_f32_16x16x32_bf16 v[40:43], a[100:103], v[136:139], v[40:43]
    s_waitcnt lgkmcnt(10)
    ds_read_b64_tr_b16 a[68:69], v3 offset:256
    ds_read_b64_tr_b16 a[70:71], v3 offset:384
    v_mfma_f32_16x16x32_bf16 v[40:43], a[104:107], v[144:147], v[40:43]
    ds_read_b64_tr_b16 a[72:73], v3 offset:512
    v_mfma_f32_16x16x32_bf16 v[40:43], a[108:111], v[152:155], v[40:43]
    s_waitcnt lgkmcnt(9)
    ds_read_b64_tr_b16 a[74:75], v3 offset:640
    v_mfma_f32_16x16x32_bf16 v[40:43], a[112:115], v[192:195], v[40:43]
    ds_read_b64_tr_b16 a[76:77], v3 offset:768
    v_mfma_f32_16x16x32_bf16 v[40:43], a[116:119], v[200:203], v[40:43]
    s_mov_b32 s45, 512
    s_waitcnt lgkmcnt(7)
    ds_read_b64_tr_b16 a[78:79], v3 offset:896
    v_mfma_f32_16x16x32_bf16 v[40:43], a[120:123], v[208:211], v[40:43]
    s_add_u32 m0, s44, 67584
    ds_read_b64_tr_b16 a[80:81], v3 offset:16896
    v_mfma_f32_16x16x32_bf16 v[40:43], a[124:127], v[216:219], v[40:43]
    buffer_load_dwordx4 v7, s[28:31], s45 offen offset:0 lds
    v_mfma_f32_16x16x32_bf16 v[44:47], a[96:99], v[160:163], 0
    ds_read_b64_tr_b16 a[82:83], v3 offset:17024
    v_mfma_f32_16x16x32_bf16 v[44:47], a[100:103], v[168:171], v[44:47]
    ds_read_b64_tr_b16 a[84:85], v3 offset:17152
    v_mfma_f32_16x16x32_bf16 v[44:47], a[104:107], v[176:179], v[44:47]
    ds_read_b64_tr_b16 a[86:87], v3 offset:17280
    v_mfma_f32_16x16x32_bf16 v[44:47], a[108:111], v[184:187], v[44:47]
    ds_read_b64_tr_b16 a[88:89], v3 offset:17408
    v_mfma_f32_16x16x32_bf16 v[44:47], a[112:115], v[224:227], v[44:47]
    ds_read_b64_tr_b16 a[90:91], v3 offset:17536
    v_mfma_f32_16x16x32_bf16 v[44:47], a[116:119], v[232:235], v[44:47]
    ds_read_b64_tr_b16 a[92:93], v3 offset:17664
    v_mfma_f32_16x16x32_bf16 v[44:47], a[120:123], v[240:243], v[44:47]
    s_add_u32 m0, s44, 67488
    ds_read_b64_tr_b16 a[94:95], v3 offset:17792
    v_mfma_f32_16x16x32_bf16 v[44:47], a[124:127], v[248:251], v[44:47]
    s_waitcnt lgkmcnt(12)
    buffer_load_dwordx4 v7, s[28:31], s45 offen offset:1152 lds
    v_mfma_f32_16x16x32_bf16 v[16:19], a[64:67], v[128:131], 0
    ds_read_b64_tr_b16 a[96:97], v3 offset:32
    v_cvt_pk_bf16_f32 v48, v32, v33
    v_mfma_f32_16x16x32_bf16 v[16:19], a[68:71], v[136:139], v[16:19]
    s_waitcnt lgkmcnt(9)
    ds_read_b64_tr_b16 a[98:99], v3 offset:160
    v_cvt_pk_bf16_f32 v49, v34, v35
    v_mfma_f32_16x16x32_bf16 v[16:19], a[72:75], v[144:147], v[16:19]
    ds_read_b64_tr_b16 a[100:101], v3 offset:288
    v_cvt_pk_bf16_f32 v50, v40, v41
    v_mfma_f32_16x16x32_bf16 v[16:19], a[76:79], v[152:155], v[16:19]
    s_waitcnt lgkmcnt(7)
    ds_read_b64_tr_b16 a[102:103], v3 offset:416
    v_cvt_pk_bf16_f32 v51, v42, v43
    v_mfma_f32_16x16x32_bf16 v[16:19], a[80:83], v[192:195], v[16:19]
    s_mov_b32 s54, 1024
    ds_read_b64_tr_b16 a[104:105], v3 offset:544
    ds_read_b64_tr_b16 a[106:107], v3 offset:672
    v_mfma_f32_16x16x32_bf16 v[16:19], a[84:87], v[200:203], v[16:19]
    s_waitcnt lgkmcnt(6)
    v_permlane32_swap_b32 v48, v50
    v_mfma_f32_16x16x32_bf16 v[16:19], a[88:91], v[208:211], v[16:19]
    s_add_u32 m0, s44, 67392
    v_permlane32_swap_b32 v49, v51
    v_mfma_f32_16x16x32_bf16 v[16:19], a[92:95], v[216:219], v[16:19]
    buffer_load_dwordx4 v7, s[28:31], s45 offen offset:2304 lds
    ds_read_b64_tr_b16 a[108:109], v3 offset:800
    ds_read_b64_tr_b16 a[110:111], v3 offset:928
    buffer_store_dwordx4 v[48:51], v10, s[40:43], s54 offen offset:512
    v_mfma_f32_16x16x32_bf16 v[20:23], a[64:67], v[160:163], 0
    ds_read_b64_tr_b16 a[112:113], v3 offset:16928
    v_cvt_pk_bf16_f32 v52, v36, v37
    v_mfma_f32_16x16x32_bf16 v[20:23], a[68:71], v[168:171], v[20:23]
    ds_read_b64_tr_b16 a[114:115], v3 offset:17056
    v_cvt_pk_bf16_f32 v53, v38, v39
    v_mfma_f32_16x16x32_bf16 v[20:23], a[72:75], v[176:179], v[20:23]
    ds_read_b64_tr_b16 a[116:117], v3 offset:17184
    v_cvt_pk_bf16_f32 v54, v44, v45
    v_mfma_f32_16x16x32_bf16 v[20:23], a[76:79], v[184:187], v[20:23]
    ds_read_b64_tr_b16 a[118:119], v3 offset:17312
    v_cvt_pk_bf16_f32 v55, v46, v47
    v_mfma_f32_16x16x32_bf16 v[20:23], a[80:83], v[224:227], v[20:23]
    s_mov_b32 s54, 295936
    ds_read_b64_tr_b16 a[120:121], v3 offset:17440
    ds_read_b64_tr_b16 a[122:123], v3 offset:17568
    v_mfma_f32_16x16x32_bf16 v[20:23], a[84:87], v[232:235], v[20:23]
    v_permlane32_swap_b32 v52, v54
    v_mfma_f32_16x16x32_bf16 v[20:23], a[88:91], v[240:243], v[20:23]
    s_add_u32 m0, s44, 67296
    v_permlane32_swap_b32 v53, v55
    v_mfma_f32_16x16x32_bf16 v[20:23], a[92:95], v[248:251], v[20:23]
    s_waitcnt lgkmcnt(10)
    buffer_load_dwordx4 v7, s[28:31], s45 offen offset:3456 lds
    ds_read_b64_tr_b16 a[124:125], v3 offset:17696
    ds_read_b64_tr_b16 a[126:127], v3 offset:17824
    buffer_store_dwordx4 v[52:55], v10, s[40:43], s54 offen offset:512
    v_mfma_f32_16x16x32_bf16 v[24:27], a[96:99], v[128:131], 0
    ds_read_b64_tr_b16 a[64:65], v3 offset:64
    ds_read_b64_tr_b16 a[66:67], v3 offset:192
    v_mfma_f32_16x16x32_bf16 v[24:27], a[100:103], v[136:139], v[24:27]
    s_waitcnt lgkmcnt(10)
    ds_read_b64_tr_b16 a[68:69], v3 offset:320
    ds_read_b64_tr_b16 a[70:71], v3 offset:448
    v_mfma_f32_16x16x32_bf16 v[24:27], a[104:107], v[144:147], v[24:27]
    ds_read_b64_tr_b16 a[72:73], v3 offset:576
    v_mfma_f32_16x16x32_bf16 v[24:27], a[108:111], v[152:155], v[24:27]
    s_waitcnt lgkmcnt(9)
    ds_read_b64_tr_b16 a[74:75], v3 offset:704
    v_mfma_f32_16x16x32_bf16 v[24:27], a[112:115], v[192:195], v[24:27]
    ds_read_b64_tr_b16 a[76:77], v3 offset:832
    v_mfma_f32_16x16x32_bf16 v[24:27], a[116:119], v[200:203], v[24:27]
    s_mov_b32 s45, 147968
    s_waitcnt lgkmcnt(7)
    ds_read_b64_tr_b16 a[78:79], v3 offset:960
    v_mfma_f32_16x16x32_bf16 v[24:27], a[120:123], v[208:211], v[24:27]
    s_add_u32 m0, s44, 84480
    ds_read_b64_tr_b16 a[80:81], v3 offset:16960
    v_mfma_f32_16x16x32_bf16 v[24:27], a[124:127], v[216:219], v[24:27]
    buffer_load_dwordx4 v7, s[28:31], s45 offen offset:0 lds
    v_mfma_f32_16x16x32_bf16 v[28:31], a[96:99], v[160:163], 0
    ds_read_b64_tr_b16 a[82:83], v3 offset:17088
    v_mfma_f32_16x16x32_bf16 v[28:31], a[100:103], v[168:171], v[28:31]
    ds_read_b64_tr_b16 a[84:85], v3 offset:17216
    v_mfma_f32_16x16x32_bf16 v[28:31], a[104:107], v[176:179], v[28:31]
    ds_read_b64_tr_b16 a[86:87], v3 offset:17344
    v_mfma_f32_16x16x32_bf16 v[28:31], a[108:111], v[184:187], v[28:31]
    ds_read_b64_tr_b16 a[88:89], v3 offset:17472
    v_mfma_f32_16x16x32_bf16 v[28:31], a[112:115], v[224:227], v[28:31]
    ds_read_b64_tr_b16 a[90:91], v3 offset:17600
    v_mfma_f32_16x16x32_bf16 v[28:31], a[116:119], v[232:235], v[28:31]
    ds_read_b64_tr_b16 a[92:93], v3 offset:17728
    v_mfma_f32_16x16x32_bf16 v[28:31], a[120:123], v[240:243], v[28:31]
    s_add_u32 m0, s44, 84384
    ds_read_b64_tr_b16 a[94:95], v3 offset:17856
    v_mfma_f32_16x16x32_bf16 v[28:31], a[124:127], v[248:251], v[28:31]
    s_waitcnt lgkmcnt(12)
    buffer_load_dwordx4 v7, s[28:31], s45 offen offset:1152 lds
    v_mfma_f32_16x16x32_bf16 v[32:35], a[64:67], v[128:131], 0
    ds_read_b64_tr_b16 a[96:97], v3 offset:96
    v_cvt_pk_bf16_f32 v48, v16, v17
    v_mfma_f32_16x16x32_bf16 v[32:35], a[68:71], v[136:139], v[32:35]
    s_waitcnt lgkmcnt(9)
    ds_read_b64_tr_b16 a[98:99], v3 offset:224
    v_cvt_pk_bf16_f32 v49, v18, v19
    v_mfma_f32_16x16x32_bf16 v[32:35], a[72:75], v[144:147], v[32:35]
    ds_read_b64_tr_b16 a[100:101], v3 offset:352
    v_cvt_pk_bf16_f32 v50, v24, v25
    v_mfma_f32_16x16x32_bf16 v[32:35], a[76:79], v[152:155], v[32:35]
    s_waitcnt lgkmcnt(7)
    ds_read_b64_tr_b16 a[102:103], v3 offset:480
    v_cvt_pk_bf16_f32 v51, v26, v27
    v_mfma_f32_16x16x32_bf16 v[32:35], a[80:83], v[192:195], v[32:35]
    s_mov_b32 s54, 2048
    ds_read_b64_tr_b16 a[104:105], v3 offset:608
    ds_read_b64_tr_b16 a[106:107], v3 offset:736
    v_mfma_f32_16x16x32_bf16 v[32:35], a[84:87], v[200:203], v[32:35]
    s_waitcnt lgkmcnt(6)
    v_permlane32_swap_b32 v48, v50
    v_mfma_f32_16x16x32_bf16 v[32:35], a[88:91], v[208:211], v[32:35]
    s_add_u32 m0, s44, 84288
    v_permlane32_swap_b32 v49, v51
    v_mfma_f32_16x16x32_bf16 v[32:35], a[92:95], v[216:219], v[32:35]
    buffer_load_dwordx4 v7, s[28:31], s45 offen offset:2304 lds
    ds_read_b64_tr_b16 a[108:109], v3 offset:864
    ds_read_b64_tr_b16 a[110:111], v3 offset:992
    buffer_store_dwordx4 v[48:51], v10, s[40:43], s54 offen offset:0
    v_mfma_f32_16x16x32_bf16 v[36:39], a[64:67], v[160:163], 0
    ds_read_b64_tr_b16 a[112:113], v3 offset:16992
    v_cvt_pk_bf16_f32 v52, v20, v21
    v_mfma_f32_16x16x32_bf16 v[36:39], a[68:71], v[168:171], v[36:39]
    ds_read_b64_tr_b16 a[114:115], v3 offset:17120
    v_cvt_pk_bf16_f32 v53, v22, v23
    v_mfma_f32_16x16x32_bf16 v[36:39], a[72:75], v[176:179], v[36:39]
    ds_read_b64_tr_b16 a[116:117], v3 offset:17248
    v_cvt_pk_bf16_f32 v54, v28, v29
    v_mfma_f32_16x16x32_bf16 v[36:39], a[76:79], v[184:187], v[36:39]
    ds_read_b64_tr_b16 a[118:119], v3 offset:17376
    v_cvt_pk_bf16_f32 v55, v30, v31
    v_mfma_f32_16x16x32_bf16 v[36:39], a[80:83], v[224:227], v[36:39]
    s_mov_b32 s54, 296960
    ds_read_b64_tr_b16 a[120:121], v3 offset:17504
    ds_read_b64_tr_b16 a[122:123], v3 offset:17632
    v_mfma_f32_16x16x32_bf16 v[36:39], a[84:87], v[232:235], v[36:39]
    v_permlane32_swap_b32 v52, v54
    v_mfma_f32_16x16x32_bf16 v[36:39], a[88:91], v[240:243], v[36:39]
    s_add_u32 m0, s44, 84192
    v_permlane32_swap_b32 v53, v55
    v_mfma_f32_16x16x32_bf16 v[36:39], a[92:95], v[248:251], v[36:39]
    s_waitcnt vmcnt(14)
    s_barrier
    s_waitcnt lgkmcnt(10)
    buffer_load_dwordx4 v7, s[28:31], s45 offen offset:3456 lds
    ds_read_b64_tr_b16 a[124:125], v3 offset:17760
    ds_read_b64_tr_b16 a[126:127], v3 offset:17888
    buffer_store_dwordx4 v[52:55], v10, s[40:43], s54 offen offset:0
    v_mfma_f32_16x16x32_bf16 v[40:43], a[96:99], v[128:131], 0
    ds_read_b64_tr_b16 a[64:65], v3 offset:33792
    ds_read_b64_tr_b16 a[66:67], v3 offset:33920
    v_mfma_f32_16x16x32_bf16 v[40:43], a[100:103], v[136:139], v[40:43]
    s_waitcnt lgkmcnt(10)
    ds_read_b64_tr_b16 a[68:69], v3 offset:34048
    ds_read_b64_tr_b16 a[70:71], v3 offset:34176
    v_mfma_f32_16x16x32_bf16 v[40:43], a[104:107], v[144:147], v[40:43]
    ds_read_b64_tr_b16 a[72:73], v3 offset:34304
    v_mfma_f32_16x16x32_bf16 v[40:43], a[108:111], v[152:155], v[40:43]
    s_waitcnt lgkmcnt(9)
    ds_read_b64_tr_b16 a[74:75], v3 offset:34432
    v_mfma_f32_16x16x32_bf16 v[40:43], a[112:115], v[192:195], v[40:43]
    ds_read_b64_tr_b16 a[76:77], v3 offset:34560
    v_mfma_f32_16x16x32_bf16 v[40:43], a[116:119], v[200:203], v[40:43]
    s_mov_b32 s45, 640
    s_waitcnt lgkmcnt(7)
    ds_read_b64_tr_b16 a[78:79], v3 offset:34688
    v_mfma_f32_16x16x32_bf16 v[40:43], a[120:123], v[208:211], v[40:43]
    s_add_u32 m0, s44, 101376
    ds_read_b64_tr_b16 a[80:81], v3 offset:50688
    v_mfma_f32_16x16x32_bf16 v[40:43], a[124:127], v[216:219], v[40:43]
    buffer_load_dwordx4 v7, s[28:31], s45 offen offset:0 lds
    v_mfma_f32_16x16x32_bf16 v[44:47], a[96:99], v[160:163], 0
    ds_read_b64_tr_b16 a[82:83], v3 offset:50816
    v_mfma_f32_16x16x32_bf16 v[44:47], a[100:103], v[168:171], v[44:47]
    ds_read_b64_tr_b16 a[84:85], v3 offset:50944
    v_mfma_f32_16x16x32_bf16 v[44:47], a[104:107], v[176:179], v[44:47]
    ds_read_b64_tr_b16 a[86:87], v3 offset:51072
    v_mfma_f32_16x16x32_bf16 v[44:47], a[108:111], v[184:187], v[44:47]
    ds_read_b64_tr_b16 a[88:89], v3 offset:51200
    v_mfma_f32_16x16x32_bf16 v[44:47], a[112:115], v[224:227], v[44:47]
    ds_read_b64_tr_b16 a[90:91], v3 offset:51328
    v_mfma_f32_16x16x32_bf16 v[44:47], a[116:119], v[232:235], v[44:47]
    ds_read_b64_tr_b16 a[92:93], v3 offset:51456
    v_mfma_f32_16x16x32_bf16 v[44:47], a[120:123], v[240:243], v[44:47]
    s_add_u32 m0, s44, 101280
    ds_read_b64_tr_b16 a[94:95], v3 offset:51584
    v_mfma_f32_16x16x32_bf16 v[44:47], a[124:127], v[248:251], v[44:47]
    s_waitcnt lgkmcnt(12)
    buffer_load_dwordx4 v7, s[28:31], s45 offen offset:1152 lds
    v_mfma_f32_16x16x32_bf16 v[16:19], a[64:67], v[128:131], 0
    ds_read_b64_tr_b16 a[96:97], v3 offset:33824
    v_cvt_pk_bf16_f32 v48, v32, v33
    v_mfma_f32_16x16x32_bf16 v[16:19], a[68:71], v[136:139], v[16:19]
    s_waitcnt lgkmcnt(9)
    ds_read_b64_tr_b16 a[98:99], v3 offset:33952
    v_cvt_pk_bf16_f32 v49, v34, v35
    v_mfma_f32_16x16x32_bf16 v[16:19], a[72:75], v[144:147], v[16:19]
    ds_read_b64_tr_b16 a[100:101], v3 offset:34080
    v_cvt_pk_bf16_f32 v50, v40, v41
    v_mfma_f32_16x16x32_bf16 v[16:19], a[76:79], v[152:155], v[16:19]
    s_waitcnt lgkmcnt(7)
    ds_read_b64_tr_b16 a[102:103], v3 offset:34208
    v_cvt_pk_bf16_f32 v51, v42, v43
    v_mfma_f32_16x16x32_bf16 v[16:19], a[80:83], v[192:195], v[16:19]
    s_mov_b32 s54, 2048
    ds_read_b64_tr_b16 a[104:105], v3 offset:34336
    ds_read_b64_tr_b16 a[106:107], v3 offset:34464
    v_mfma_f32_16x16x32_bf16 v[16:19], a[84:87], v[200:203], v[16:19]
    s_waitcnt lgkmcnt(6)
    v_permlane32_swap_b32 v48, v50
    v_mfma_f32_16x16x32_bf16 v[16:19], a[88:91], v[208:211], v[16:19]
    s_add_u32 m0, s44, 101184
    v_permlane32_swap_b32 v49, v51
    v_mfma_f32_16x16x32_bf16 v[16:19], a[92:95], v[216:219], v[16:19]
    buffer_load_dwordx4 v7, s[28:31], s45 offen offset:2304 lds
    ds_read_b64_tr_b16 a[108:109], v3 offset:34592
    ds_read_b64_tr_b16 a[110:111], v3 offset:34720
    buffer_store_dwordx4 v[48:51], v10, s[40:43], s54 offen offset:512
    v_mfma_f32_16x16x32_bf16 v[20:23], a[64:67], v[160:163], 0
    ds_read_b64_tr_b16 a[112:113], v3 offset:50720
    v_cvt_pk_bf16_f32 v52, v36, v37
    v_mfma_f32_16x16x32_bf16 v[20:23], a[68:71], v[168:171], v[20:23]
    ds_read_b64_tr_b16 a[114:115], v3 offset:50848
    v_cvt_pk_bf16_f32 v53, v38, v39
    v_mfma_f32_16x16x32_bf16 v[20:23], a[72:75], v[176:179], v[20:23]
    ds_read_b64_tr_b16 a[116:117], v3 offset:50976
    v_cvt_pk_bf16_f32 v54, v44, v45
    v_mfma_f32_16x16x32_bf16 v[20:23], a[76:79], v[184:187], v[20:23]
    ds_read_b64_tr_b16 a[118:119], v3 offset:51104
    v_cvt_pk_bf16_f32 v55, v46, v47
    v_mfma_f32_16x16x32_bf16 v[20:23], a[80:83], v[224:227], v[20:23]
    s_mov_b32 s54, 296960
    ds_read_b64_tr_b16 a[120:121], v3 offset:51232
    ds_read_b64_tr_b16 a[122:123], v3 offset:51360
    v_mfma_f32_16x16x32_bf16 v[20:23], a[84:87], v[232:235], v[20:23]
    v_permlane32_swap_b32 v52, v54
    v_mfma_f32_16x16x32_bf16 v[20:23], a[88:91], v[240:243], v[20:23]
    s_add_u32 m0, s44, 101088
    v_permlane32_swap_b32 v53, v55
    v_mfma_f32_16x16x32_bf16 v[20:23], a[92:95], v[248:251], v[20:23]
    s_waitcnt lgkmcnt(10)
    buffer_load_dwordx4 v7, s[28:31], s45 offen offset:3456 lds
    ds_read_b64_tr_b16 a[124:125], v3 offset:51488
    ds_read_b64_tr_b16 a[126:127], v3 offset:51616
    buffer_store_dwordx4 v[52:55], v10, s[40:43], s54 offen offset:512
    v_mfma_f32_16x16x32_bf16 v[24:27], a[96:99], v[128:131], 0
    ds_read_b64_tr_b16 a[64:65], v3 offset:33856
    ds_read_b64_tr_b16 a[66:67], v3 offset:33984
    v_mfma_f32_16x16x32_bf16 v[24:27], a[100:103], v[136:139], v[24:27]
    s_waitcnt lgkmcnt(10)
    ds_read_b64_tr_b16 a[68:69], v3 offset:34112
    ds_read_b64_tr_b16 a[70:71], v3 offset:34240
    v_mfma_f32_16x16x32_bf16 v[24:27], a[104:107], v[144:147], v[24:27]
    ds_read_b64_tr_b16 a[72:73], v3 offset:34368
    v_mfma_f32_16x16x32_bf16 v[24:27], a[108:111], v[152:155], v[24:27]
    s_waitcnt lgkmcnt(9)
    ds_read_b64_tr_b16 a[74:75], v3 offset:34496
    v_mfma_f32_16x16x32_bf16 v[24:27], a[112:115], v[192:195], v[24:27]
    ds_read_b64_tr_b16 a[76:77], v3 offset:34624
    v_mfma_f32_16x16x32_bf16 v[24:27], a[116:119], v[200:203], v[24:27]
    s_mov_b32 s45, 148096
    s_waitcnt lgkmcnt(7)
    ds_read_b64_tr_b16 a[78:79], v3 offset:34752
    v_mfma_f32_16x16x32_bf16 v[24:27], a[120:123], v[208:211], v[24:27]
    s_add_u32 m0, s44, 118272
    ds_read_b64_tr_b16 a[80:81], v3 offset:50752
    v_mfma_f32_16x16x32_bf16 v[24:27], a[124:127], v[216:219], v[24:27]
    buffer_load_dwordx4 v7, s[28:31], s45 offen offset:0 lds
    v_mfma_f32_16x16x32_bf16 v[28:31], a[96:99], v[160:163], 0
    ds_read_b64_tr_b16 a[82:83], v3 offset:50880
    v_mfma_f32_16x16x32_bf16 v[28:31], a[100:103], v[168:171], v[28:31]
    ds_read_b64_tr_b16 a[84:85], v3 offset:51008
    v_mfma_f32_16x16x32_bf16 v[28:31], a[104:107], v[176:179], v[28:31]
    ds_read_b64_tr_b16 a[86:87], v3 offset:51136
    v_mfma_f32_16x16x32_bf16 v[28:31], a[108:111], v[184:187], v[28:31]
    ds_read_b64_tr_b16 a[88:89], v3 offset:51264
    v_mfma_f32_16x16x32_bf16 v[28:31], a[112:115], v[224:227], v[28:31]
    ds_read_b64_tr_b16 a[90:91], v3 offset:51392
    v_mfma_f32_16x16x32_bf16 v[28:31], a[116:119], v[232:235], v[28:31]
    ds_read_b64_tr_b16 a[92:93], v3 offset:51520
    v_mfma_f32_16x16x32_bf16 v[28:31], a[120:123], v[240:243], v[28:31]
    s_add_u32 m0, s44, 118176
    ds_read_b64_tr_b16 a[94:95], v3 offset:51648
    v_mfma_f32_16x16x32_bf16 v[28:31], a[124:127], v[248:251], v[28:31]
    s_waitcnt lgkmcnt(12)
    buffer_load_dwordx4 v7, s[28:31], s45 offen offset:1152 lds
    v_mfma_f32_16x16x32_bf16 v[32:35], a[64:67], v[128:131], 0
    ds_read_b64_tr_b16 a[96:97], v3 offset:33888
    v_cvt_pk_bf16_f32 v48, v16, v17
    v_mfma_f32_16x16x32_bf16 v[32:35], a[68:71], v[136:139], v[32:35]
    s_waitcnt lgkmcnt(9)
    ds_read_b64_tr_b16 a[98:99], v3 offset:34016
    v_cvt_pk_bf16_f32 v49, v18, v19
    v_mfma_f32_16x16x32_bf16 v[32:35], a[72:75], v[144:147], v[32:35]
    ds_read_b64_tr_b16 a[100:101], v3 offset:34144
    v_cvt_pk_bf16_f32 v50, v24, v25
    v_mfma_f32_16x16x32_bf16 v[32:35], a[76:79], v[152:155], v[32:35]
    s_waitcnt lgkmcnt(7)
    ds_read_b64_tr_b16 a[102:103], v3 offset:34272
    v_cvt_pk_bf16_f32 v51, v26, v27
    v_mfma_f32_16x16x32_bf16 v[32:35], a[80:83], v[192:195], v[32:35]
    s_mov_b32 s54, 3072
    ds_read_b64_tr_b16 a[104:105], v3 offset:34400
    ds_read_b64_tr_b16 a[106:107], v3 offset:34528
    v_mfma_f32_16x16x32_bf16 v[32:35], a[84:87], v[200:203], v[32:35]
    s_waitcnt lgkmcnt(6)
    v_permlane32_swap_b32 v48, v50
    v_mfma_f32_16x16x32_bf16 v[32:35], a[88:91], v[208:211], v[32:35]
    s_add_u32 m0, s44, 118080
    v_permlane32_swap_b32 v49, v51
    v_mfma_f32_16x16x32_bf16 v[32:35], a[92:95], v[216:219], v[32:35]
    buffer_load_dwordx4 v7, s[28:31], s45 offen offset:2304 lds
    ds_read_b64_tr_b16 a[108:109], v3 offset:34656
    ds_read_b64_tr_b16 a[110:111], v3 offset:34784
    buffer_store_dwordx4 v[48:51], v10, s[40:43], s54 offen offset:0
    v_mfma_f32_16x16x32_bf16 v[36:39], a[64:67], v[160:163], 0
    ds_read_b64_tr_b16 a[112:113], v3 offset:50784
    v_cvt_pk_bf16_f32 v52, v20, v21
    v_mfma_f32_16x16x32_bf16 v[36:39], a[68:71], v[168:171], v[36:39]
    ds_read_b64_tr_b16 a[114:115], v3 offset:50912
    v_cvt_pk_bf16_f32 v53, v22, v23
    v_mfma_f32_16x16x32_bf16 v[36:39], a[72:75], v[176:179], v[36:39]
    ds_read_b64_tr_b16 a[116:117], v3 offset:51040
    v_cvt_pk_bf16_f32 v54, v28, v29
    v_mfma_f32_16x16x32_bf16 v[36:39], a[76:79], v[184:187], v[36:39]
    ds_read_b64_tr_b16 a[118:119], v3 offset:51168
    v_cvt_pk_bf16_f32 v55, v30, v31
    v_mfma_f32_16x16x32_bf16 v[36:39], a[80:83], v[224:227], v[36:39]
    s_mov_b32 s54, 297984
    ds_read_b64_tr_b16 a[120:121], v3 offset:51296
    ds_read_b64_tr_b16 a[122:123], v3 offset:51424
    v_mfma_f32_16x16x32_bf16 v[36:39], a[84:87], v[232:235], v[36:39]
    v_permlane32_swap_b32 v52, v54
    v_mfma_f32_16x16x32_bf16 v[36:39], a[88:91], v[240:243], v[36:39]
    s_add_u32 m0, s44, 117984
    v_permlane32_swap_b32 v53, v55
    v_mfma_f32_16x16x32_bf16 v[36:39], a[92:95], v[248:251], v[36:39]
    s_waitcnt vmcnt(11)
    s_barrier
    s_waitcnt lgkmcnt(10)
    buffer_load_dwordx4 v7, s[28:31], s45 offen offset:3456 lds
    ds_read_b64_tr_b16 a[124:125], v3 offset:51552
    ds_read_b64_tr_b16 a[126:127], v3 offset:51680
    buffer_store_dwordx4 v[52:55], v10, s[40:43], s54 offen offset:0
    v_mfma_f32_16x16x32_bf16 v[40:43], a[96:99], v[128:131], 0
    ds_read_b64_tr_b16 a[64:65], v4 offset:0
    ds_read_b64_tr_b16 a[66:67], v4 offset:128
    v_mfma_f32_16x16x32_bf16 v[40:43], a[100:103], v[136:139], v[40:43]
    s_waitcnt lgkmcnt(10)
    ds_read_b64_tr_b16 a[68:69], v4 offset:256
    ds_read_b64_tr_b16 a[70:71], v4 offset:384
    v_mfma_f32_16x16x32_bf16 v[40:43], a[104:107], v[144:147], v[40:43]
    ds_read_b64_tr_b16 a[72:73], v4 offset:512
    v_mfma_f32_16x16x32_bf16 v[40:43], a[108:111], v[152:155], v[40:43]
    s_waitcnt lgkmcnt(9)
    ds_read_b64_tr_b16 a[74:75], v4 offset:640
    v_mfma_f32_16x16x32_bf16 v[40:43], a[112:115], v[192:195], v[40:43]
    ds_read_b64_tr_b16 a[76:77], v4 offset:768
    v_mfma_f32_16x16x32_bf16 v[40:43], a[116:119], v[200:203], v[40:43]
    s_mov_b32 s45, 768
    s_waitcnt lgkmcnt(7)
    ds_read_b64_tr_b16 a[78:79], v4 offset:896
    v_mfma_f32_16x16x32_bf16 v[40:43], a[120:123], v[208:211], v[40:43]
    s_add_u32 m0, s44, 0
    ds_read_b64_tr_b16 a[80:81], v4 offset:16896
    v_mfma_f32_16x16x32_bf16 v[40:43], a[124:127], v[216:219], v[40:43]
    buffer_load_dwordx4 v7, s[28:31], s45 offen offset:0 lds
    v_mfma_f32_16x16x32_bf16 v[44:47], a[96:99], v[160:163], 0
    ds_read_b64_tr_b16 a[82:83], v4 offset:17024
    v_mfma_f32_16x16x32_bf16 v[44:47], a[100:103], v[168:171], v[44:47]
    ds_read_b64_tr_b16 a[84:85], v4 offset:17152
    v_mfma_f32_16x16x32_bf16 v[44:47], a[104:107], v[176:179], v[44:47]
    ds_read_b64_tr_b16 a[86:87], v4 offset:17280
    v_mfma_f32_16x16x32_bf16 v[44:47], a[108:111], v[184:187], v[44:47]
    ds_read_b64_tr_b16 a[88:89], v4 offset:17408
    v_mfma_f32_16x16x32_bf16 v[44:47], a[112:115], v[224:227], v[44:47]
    ds_read_b64_tr_b16 a[90:91], v4 offset:17536
    v_mfma_f32_16x16x32_bf16 v[44:47], a[116:119], v[232:235], v[44:47]
    ds_read_b64_tr_b16 a[92:93], v4 offset:17664
    v_mfma_f32_16x16x32_bf16 v[44:47], a[120:123], v[240:243], v[44:47]
    s_add_u32 m0, s44, -96
    ds_read_b64_tr_b16 a[94:95], v4 offset:17792
    v_mfma_f32_16x16x32_bf16 v[44:47], a[124:127], v[248:251], v[44:47]
    s_waitcnt lgkmcnt(12)
    buffer_load_dwordx4 v7, s[28:31], s45 offen offset:1152 lds
    v_mfma_f32_16x16x32_bf16 v[16:19], a[64:67], v[128:131], 0
    ds_read_b64_tr_b16 a[96:97], v4 offset:32
    v_cvt_pk_bf16_f32 v48, v32, v33
    v_mfma_f32_16x16x32_bf16 v[16:19], a[68:71], v[136:139], v[16:19]
    s_waitcnt lgkmcnt(9)
    ds_read_b64_tr_b16 a[98:99], v4 offset:160
    v_cvt_pk_bf16_f32 v49, v34, v35
    v_mfma_f32_16x16x32_bf16 v[16:19], a[72:75], v[144:147], v[16:19]
    ds_read_b64_tr_b16 a[100:101], v4 offset:288
    v_cvt_pk_bf16_f32 v50, v40, v41
    v_mfma_f32_16x16x32_bf16 v[16:19], a[76:79], v[152:155], v[16:19]
    s_waitcnt lgkmcnt(7)
    ds_read_b64_tr_b16 a[102:103], v4 offset:416
    v_cvt_pk_bf16_f32 v51, v42, v43
    v_mfma_f32_16x16x32_bf16 v[16:19], a[80:83], v[192:195], v[16:19]
    s_mov_b32 s54, 3072
    ds_read_b64_tr_b16 a[104:105], v4 offset:544
    ds_read_b64_tr_b16 a[106:107], v4 offset:672
    v_mfma_f32_16x16x32_bf16 v[16:19], a[84:87], v[200:203], v[16:19]
    s_waitcnt lgkmcnt(6)
    v_permlane32_swap_b32 v48, v50
    v_mfma_f32_16x16x32_bf16 v[16:19], a[88:91], v[208:211], v[16:19]
    s_add_u32 m0, s44, -192
    v_permlane32_swap_b32 v49, v51
    v_mfma_f32_16x16x32_bf16 v[16:19], a[92:95], v[216:219], v[16:19]
    buffer_load_dwordx4 v7, s[28:31], s45 offen offset:2304 lds
    ds_read_b64_tr_b16 a[108:109], v4 offset:800
    ds_read_b64_tr_b16 a[110:111], v4 offset:928
    buffer_store_dwordx4 v[48:51], v10, s[40:43], s54 offen offset:512
    v_mfma_f32_16x16x32_bf16 v[20:23], a[64:67], v[160:163], 0
    ds_read_b64_tr_b16 a[112:113], v4 offset:16928
    v_cvt_pk_bf16_f32 v52, v36, v37
    v_mfma_f32_16x16x32_bf16 v[20:23], a[68:71], v[168:171], v[20:23]
    ds_read_b64_tr_b16 a[114:115], v4 offset:17056
    v_cvt_pk_bf16_f32 v53, v38, v39
    v_mfma_f32_16x16x32_bf16 v[20:23], a[72:75], v[176:179], v[20:23]
    ds_read_b64_tr_b16 a[116:117], v4 offset:17184
    v_cvt_pk_bf16_f32 v54, v44, v45
    v_mfma_f32_16x16x32_bf16 v[20:23], a[76:79], v[184:187], v[20:23]
    ds_read_b64_tr_b16 a[118:119], v4 offset:17312
    v_cvt_pk_bf16_f32 v55, v46, v47
    v_mfma_f32_16x16x32_bf16 v[20:23], a[80:83], v[224:227], v[20:23]
    s_mov_b32 s54, 297984
    ds_read_b64_tr_b16 a[120:121], v4 offset:17440
    ds_read_b64_tr_b16 a[122:123], v4 offset:17568
    v_mfma_f32_16x16x32_bf16 v[20:23], a[84:87], v[232:235], v[20:23]
    v_permlane32_swap_b32 v52, v54
    v_mfma_f32_16x16x32_bf16 v[20:23], a[88:91], v[240:243], v[20:23]
    s_add_u32 m0, s44, -288
    v_permlane32_swap_b32 v53, v55
    v_mfma_f32_16x16x32_bf16 v[20:23], a[92:95], v[248:251], v[20:23]
    s_waitcnt lgkmcnt(10)
    buffer_load_dwordx4 v7, s[28:31], s45 offen offset:3456 lds
    ds_read_b64_tr_b16 a[124:125], v4 offset:17696
    ds_read_b64_tr_b16 a[126:127], v4 offset:17824
    buffer_store_dwordx4 v[52:55], v10, s[40:43], s54 offen offset:512
    v_mfma_f32_16x16x32_bf16 v[24:27], a[96:99], v[128:131], 0
    ds_read_b64_tr_b16 a[64:65], v4 offset:64
    ds_read_b64_tr_b16 a[66:67], v4 offset:192
    v_mfma_f32_16x16x32_bf16 v[24:27], a[100:103], v[136:139], v[24:27]
    s_waitcnt lgkmcnt(10)
    ds_read_b64_tr_b16 a[68:69], v4 offset:320
    ds_read_b64_tr_b16 a[70:71], v4 offset:448
    v_mfma_f32_16x16x32_bf16 v[24:27], a[104:107], v[144:147], v[24:27]
    ds_read_b64_tr_b16 a[72:73], v4 offset:576
    v_mfma_f32_16x16x32_bf16 v[24:27], a[108:111], v[152:155], v[24:27]
    s_waitcnt lgkmcnt(9)
    ds_read_b64_tr_b16 a[74:75], v4 offset:704
    v_mfma_f32_16x16x32_bf16 v[24:27], a[112:115], v[192:195], v[24:27]
    ds_read_b64_tr_b16 a[76:77], v4 offset:832
    v_mfma_f32_16x16x32_bf16 v[24:27], a[116:119], v[200:203], v[24:27]
    s_mov_b32 s45, 148224
    s_waitcnt lgkmcnt(7)
    ds_read_b64_tr_b16 a[78:79], v4 offset:960
    v_mfma_f32_16x16x32_bf16 v[24:27], a[120:123], v[208:211], v[24:27]
    s_add_u32 m0, s44, 16896
    ds_read_b64_tr_b16 a[80:81], v4 offset:16960
    v_mfma_f32_16x16x32_bf16 v[24:27], a[124:127], v[216:219], v[24:27]
    buffer_load_dwordx4 v7, s[28:31], s45 offen offset:0 lds
    v_mfma_f32_16x16x32_bf16 v[28:31], a[96:99], v[160:163], 0
    ds_read_b64_tr_b16 a[82:83], v4 offset:17088
    v_mfma_f32_16x16x32_bf16 v[28:31], a[100:103], v[168:171], v[28:31]
    ds_read_b64_tr_b16 a[84:85], v4 offset:17216
    v_mfma_f32_16x16x32_bf16 v[28:31], a[104:107], v[176:179], v[28:31]
    ds_read_b64_tr_b16 a[86:87], v4 offset:17344
    v_mfma_f32_16x16x32_bf16 v[28:31], a[108:111], v[184:187], v[28:31]
    ds_read_b64_tr_b16 a[88:89], v4 offset:17472
    v_mfma_f32_16x16x32_bf16 v[28:31], a[112:115], v[224:227], v[28:31]
    ds_read_b64_tr_b16 a[90:91], v4 offset:17600
    v_mfma_f32_16x16x32_bf16 v[28:31], a[116:119], v[232:235], v[28:31]
    ds_read_b64_tr_b16 a[92:93], v4 offset:17728
    v_mfma_f32_16x16x32_bf16 v[28:31], a[120:123], v[240:243], v[28:31]
    s_add_u32 m0, s44, 16800
    ds_read_b64_tr_b16 a[94:95], v4 offset:17856
    v_mfma_f32_16x16x32_bf16 v[28:31], a[124:127], v[248:251], v[28:31]
    s_waitcnt lgkmcnt(12)
    buffer_load_dwordx4 v7, s[28:31], s45 offen offset:1152 lds
    v_mfma_f32_16x16x32_bf16 v[32:35], a[64:67], v[128:131], 0
    ds_read_b64_tr_b16 a[96:97], v4 offset:96
    v_cvt_pk_bf16_f32 v48, v16, v17
    v_mfma_f32_16x16x32_bf16 v[32:35], a[68:71], v[136:139], v[32:35]
    s_waitcnt lgkmcnt(9)
    ds_read_b64_tr_b16 a[98:99], v4 offset:224
    v_cvt_pk_bf16_f32 v49, v18, v19
    v_mfma_f32_16x16x32_bf16 v[32:35], a[72:75], v[144:147], v[32:35]
    ds_read_b64_tr_b16 a[100:101], v4 offset:352
    v_cvt_pk_bf16_f32 v50, v24, v25
    v_mfma_f32_16x16x32_bf16 v[32:35], a[76:79], v[152:155], v[32:35]
    s_waitcnt lgkmcnt(7)
    ds_read_b64_tr_b16 a[102:103], v4 offset:480
    v_cvt_pk_bf16_f32 v51, v26, v27
    v_mfma_f32_16x16x32_bf16 v[32:35], a[80:83], v[192:195], v[32:35]
    s_mov_b32 s54, 4096
    ds_read_b64_tr_b16 a[104:105], v4 offset:608
    ds_read_b64_tr_b16 a[106:107], v4 offset:736
    v_mfma_f32_16x16x32_bf16 v[32:35], a[84:87], v[200:203], v[32:35]
    s_waitcnt lgkmcnt(6)
    v_permlane32_swap_b32 v48, v50
    v_mfma_f32_16x16x32_bf16 v[32:35], a[88:91], v[208:211], v[32:35]
    s_add_u32 m0, s44, 16704
    v_permlane32_swap_b32 v49, v51
    v_mfma_f32_16x16x32_bf16 v[32:35], a[92:95], v[216:219], v[32:35]
    buffer_load_dwordx4 v7, s[28:31], s45 offen offset:2304 lds
    ds_read_b64_tr_b16 a[108:109], v4 offset:864
    ds_read_b64_tr_b16 a[110:111], v4 offset:992
    buffer_store_dwordx4 v[48:51], v10, s[40:43], s54 offen offset:0
    v_mfma_f32_16x16x32_bf16 v[36:39], a[64:67], v[160:163], 0
    ds_read_b64_tr_b16 a[112:113], v4 offset:16992
    v_cvt_pk_bf16_f32 v52, v20, v21
    v_mfma_f32_16x16x32_bf16 v[36:39], a[68:71], v[168:171], v[36:39]
    ds_read_b64_tr_b16 a[114:115], v4 offset:17120
    v_cvt_pk_bf16_f32 v53, v22, v23
    v_mfma_f32_16x16x32_bf16 v[36:39], a[72:75], v[176:179], v[36:39]
    ds_read_b64_tr_b16 a[116:117], v4 offset:17248
    v_cvt_pk_bf16_f32 v54, v28, v29
    v_mfma_f32_16x16x32_bf16 v[36:39], a[76:79], v[184:187], v[36:39]
    ds_read_b64_tr_b16 a[118:119], v4 offset:17376
    v_cvt_pk_bf16_f32 v55, v30, v31
    v_mfma_f32_16x16x32_bf16 v[36:39], a[80:83], v[224:227], v[36:39]
    s_mov_b32 s54, 299008
    ds_read_b64_tr_b16 a[120:121], v4 offset:17504
    ds_read_b64_tr_b16 a[122:123], v4 offset:17632
    v_mfma_f32_16x16x32_bf16 v[36:39], a[84:87], v[232:235], v[36:39]
    v_permlane32_swap_b32 v52, v54
    v_mfma_f32_16x16x32_bf16 v[36:39], a[88:91], v[240:243], v[36:39]
    s_add_u32 m0, s44, 16608
    v_permlane32_swap_b32 v53, v55
    v_mfma_f32_16x16x32_bf16 v[36:39], a[92:95], v[248:251], v[36:39]
    s_waitcnt vmcnt(11)
    s_barrier
    s_waitcnt lgkmcnt(10)
    buffer_load_dwordx4 v7, s[28:31], s45 offen offset:3456 lds
    ds_read_b64_tr_b16 a[124:125], v4 offset:17760
    ds_read_b64_tr_b16 a[126:127], v4 offset:17888
    buffer_store_dwordx4 v[52:55], v10, s[40:43], s54 offen offset:0
    v_mfma_f32_16x16x32_bf16 v[40:43], a[96:99], v[128:131], 0
    ds_read_b64_tr_b16 a[64:65], v4 offset:33792
    ds_read_b64_tr_b16 a[66:67], v4 offset:33920
    v_mfma_f32_16x16x32_bf16 v[40:43], a[100:103], v[136:139], v[40:43]
    s_waitcnt lgkmcnt(10)
    ds_read_b64_tr_b16 a[68:69], v4 offset:34048
    ds_read_b64_tr_b16 a[70:71], v4 offset:34176
    v_mfma_f32_16x16x32_bf16 v[40:43], a[104:107], v[144:147], v[40:43]
    ds_read_b64_tr_b16 a[72:73], v4 offset:34304
    v_mfma_f32_16x16x32_bf16 v[40:43], a[108:111], v[152:155], v[40:43]
    s_waitcnt lgkmcnt(9)
    ds_read_b64_tr_b16 a[74:75], v4 offset:34432
    v_mfma_f32_16x16x32_bf16 v[40:43], a[112:115], v[192:195], v[40:43]
    ds_read_b64_tr_b16 a[76:77], v4 offset:34560
    v_mfma_f32_16x16x32_bf16 v[40:43], a[116:119], v[200:203], v[40:43]
    s_mov_b32 s45, 896
    s_waitcnt lgkmcnt(7)
    ds_read_b64_tr_b16 a[78:79], v4 offset:34688
    v_mfma_f32_16x16x32_bf16 v[40:43], a[120:123], v[208:211], v[40:43]
    s_add_u32 m0, s44, 33792
    ds_read_b64_tr_b16 a[80:81], v4 offset:50688
    v_mfma_f32_16x16x32_bf16 v[40:43], a[124:127], v[216:219], v[40:43]
    buffer_load_dwordx4 v7, s[28:31], s45 offen offset:0 lds
    v_mfma_f32_16x16x32_bf16 v[44:47], a[96:99], v[160:163], 0
    ds_read_b64_tr_b16 a[82:83], v4 offset:50816
    v_mfma_f32_16x16x32_bf16 v[44:47], a[100:103], v[168:171], v[44:47]
    ds_read_b64_tr_b16 a[84:85], v4 offset:50944
    v_mfma_f32_16x16x32_bf16 v[44:47], a[104:107], v[176:179], v[44:47]
    ds_read_b64_tr_b16 a[86:87], v4 offset:51072
    v_mfma_f32_16x16x32_bf16 v[44:47], a[108:111], v[184:187], v[44:47]
    ds_read_b64_tr_b16 a[88:89], v4 offset:51200
    v_mfma_f32_16x16x32_bf16 v[44:47], a[112:115], v[224:227], v[44:47]
    ds_read_b64_tr_b16 a[90:91], v4 offset:51328
    v_mfma_f32_16x16x32_bf16 v[44:47], a[116:119], v[232:235], v[44:47]
    ds_read_b64_tr_b16 a[92:93], v4 offset:51456
    v_mfma_f32_16x16x32_bf16 v[44:47], a[120:123], v[240:243], v[44:47]
    s_add_u32 m0, s44, 33696
    ds_read_b64_tr_b16 a[94:95], v4 offset:51584
    v_mfma_f32_16x16x32_bf16 v[44:47], a[124:127], v[248:251], v[44:47]
    s_waitcnt lgkmcnt(12)
    buffer_load_dwordx4 v7, s[28:31], s45 offen offset:1152 lds
    v_mfma_f32_16x16x32_bf16 v[16:19], a[64:67], v[128:131], 0
    ds_read_b64_tr_b16 a[96:97], v4 offset:33824
    v_cvt_pk_bf16_f32 v48, v32, v33
    v_mfma_f32_16x16x32_bf16 v[16:19], a[68:71], v[136:139], v[16:19]
    s_waitcnt lgkmcnt(9)
    ds_read_b64_tr_b16 a[98:99], v4 offset:33952
    v_cvt_pk_bf16_f32 v49, v34, v35
    v_mfma_f32_16x16x32_bf16 v[16:19], a[72:75], v[144:147], v[16:19]
    ds_read_b64_tr_b16 a[100:101], v4 offset:34080
    v_cvt_pk_bf16_f32 v50, v40, v41
    v_mfma_f32_16x16x32_bf16 v[16:19], a[76:79], v[152:155], v[16:19]
    s_waitcnt lgkmcnt(7)
    ds_read_b64_tr_b16 a[102:103], v4 offset:34208
    v_cvt_pk_bf16_f32 v51, v42, v43
    v_mfma_f32_16x16x32_bf16 v[16:19], a[80:83], v[192:195], v[16:19]
    s_mov_b32 s54, 4096
    ds_read_b64_tr_b16 a[104:105], v4 offset:34336
    ds_read_b64_tr_b16 a[106:107], v4 offset:34464
    v_mfma_f32_16x16x32_bf16 v[16:19], a[84:87], v[200:203], v[16:19]
    s_waitcnt lgkmcnt(6)
    v_permlane32_swap_b32 v48, v50
    v_mfma_f32_16x16x32_bf16 v[16:19], a[88:91], v[208:211], v[16:19]
    s_add_u32 m0, s44, 33600
    v_permlane32_swap_b32 v49, v51
    v_mfma_f32_16x16x32_bf16 v[16:19], a[92:95], v[216:219], v[16:19]
    buffer_load_dwordx4 v7, s[28:31], s45 offen offset:2304 lds
    ds_read_b64_tr_b16 a[108:109], v4 offset:34592
    ds_read_b64_tr_b16 a[110:111], v4 offset:34720
    buffer_store_dwordx4 v[48:51], v10, s[40:43], s54 offen offset:512
    v_mfma_f32_16x16x32_bf16 v[20:23], a[64:67], v[160:163], 0
    ds_read_b64_tr_b16 a[112:113], v4 offset:50720
    v_cvt_pk_bf16_f32 v52, v36, v37
    v_mfma_f32_16x16x32_bf16 v[20:23], a[68:71], v[168:171], v[20:23]
    ds_read_b64_tr_b16 a[114:115], v4 offset:50848
    v_cvt_pk_bf16_f32 v53, v38, v39
    v_mfma_f32_16x16x32_bf16 v[20:23], a[72:75], v[176:179], v[20:23]
    ds_read_b64_tr_b16 a[116:117], v4 offset:50976
    v_cvt_pk_bf16_f32 v54, v44, v45
    v_mfma_f32_16x16x32_bf16 v[20:23], a[76:79], v[184:187], v[20:23]
    ds_read_b64_tr_b16 a[118:119], v4 offset:51104
    v_cvt_pk_bf16_f32 v55, v46, v47
    v_mfma_f32_16x16x32_bf16 v[20:23], a[80:83], v[224:227], v[20:23]
    s_mov_b32 s54, 299008
    ds_read_b64_tr_b16 a[120:121], v4 offset:51232
    ds_read_b64_tr_b16 a[122:123], v4 offset:51360
    v_mfma_f32_16x16x32_bf16 v[20:23], a[84:87], v[232:235], v[20:23]
    v_permlane32_swap_b32 v52, v54
    v_mfma_f32_16x16x32_bf16 v[20:23], a[88:91], v[240:243], v[20:23]
    s_add_u32 m0, s44, 33504
    v_permlane32_swap_b32 v53, v55
    v_mfma_f32_16x16x32_bf16 v[20:23], a[92:95], v[248:251], v[20:23]
    s_waitcnt lgkmcnt(10)
    buffer_load_dwordx4 v7, s[28:31], s45 offen offset:3456 lds
    ds_read_b64_tr_b16 a[124:125], v4 offset:51488
    ds_read_b64_tr_b16 a[126:127], v4 offset:51616
    buffer_store_dwordx4 v[52:55], v10, s[40:43], s54 offen offset:512
    v_mfma_f32_16x16x32_bf16 v[24:27], a[96:99], v[128:131], 0
    ds_read_b64_tr_b16 a[64:65], v4 offset:33856
    ds_read_b64_tr_b16 a[66:67], v4 offset:33984
    v_mfma_f32_16x16x32_bf16 v[24:27], a[100:103], v[136:139], v[24:27]
    s_waitcnt lgkmcnt(10)
    ds_read_b64_tr_b16 a[68:69], v4 offset:34112
    ds_read_b64_tr_b16 a[70:71], v4 offset:34240
    v_mfma_f32_16x16x32_bf16 v[24:27], a[104:107], v[144:147], v[24:27]
    ds_read_b64_tr_b16 a[72:73], v4 offset:34368
    v_mfma_f32_16x16x32_bf16 v[24:27], a[108:111], v[152:155], v[24:27]
    s_waitcnt lgkmcnt(9)
    ds_read_b64_tr_b16 a[74:75], v4 offset:34496
    v_mfma_f32_16x16x32_bf16 v[24:27], a[112:115], v[192:195], v[24:27]
    ds_read_b64_tr_b16 a[76:77], v4 offset:34624
    v_mfma_f32_16x16x32_bf16 v[24:27], a[116:119], v[200:203], v[24:27]
    s_mov_b32 s45, 148352
    s_waitcnt lgkmcnt(7)
    ds_read_b64_tr_b16 a[78:79], v4 offset:34752
    v_mfma_f32_16x16x32_bf16 v[24:27], a[120:123], v[208:211], v[24:27]
    s_add_u32 m0, s44, 50688
    ds_read_b64_tr_b16 a[80:81], v4 offset:50752
    v_mfma_f32_16x16x32_bf16 v[24:27], a[124:127], v[216:219], v[24:27]
    buffer_load_dwordx4 v7, s[28:31], s45 offen offset:0 lds
    v_mfma_f32_16x16x32_bf16 v[28:31], a[96:99], v[160:163], 0
    ds_read_b64_tr_b16 a[82:83], v4 offset:50880
    v_mfma_f32_16x16x32_bf16 v[28:31], a[100:103], v[168:171], v[28:31]
    ds_read_b64_tr_b16 a[84:85], v4 offset:51008
    v_mfma_f32_16x16x32_bf16 v[28:31], a[104:107], v[176:179], v[28:31]
    ds_read_b64_tr_b16 a[86:87], v4 offset:51136
    v_mfma_f32_16x16x32_bf16 v[28:31], a[108:111], v[184:187], v[28:31]
    ds_read_b64_tr_b16 a[88:89], v4 offset:51264
    v_mfma_f32_16x16x32_bf16 v[28:31], a[112:115], v[224:227], v[28:31]
    ds_read_b64_tr_b16 a[90:91], v4 offset:51392
    v_mfma_f32_16x16x32_bf16 v[28:31], a[116:119], v[232:235], v[28:31]
    ds_read_b64_tr_b16 a[92:93], v4 offset:51520
    v_mfma_f32_16x16x32_bf16 v[28:31], a[120:123], v[240:243], v[28:31]
    s_add_u32 m0, s44, 50592
    ds_read_b64_tr_b16 a[94:95], v4 offset:51648
    v_mfma_f32_16x16x32_bf16 v[28:31], a[124:127], v[248:251], v[28:31]
    s_waitcnt lgkmcnt(12)
    buffer_load_dwordx4 v7, s[28:31], s45 offen offset:1152 lds
    v_mfma_f32_16x16x32_bf16 v[32:35], a[64:67], v[128:131], 0
    ds_read_b64_tr_b16 a[96:97], v4 offset:33888
    v_cvt_pk_bf16_f32 v48, v16, v17
    v_mfma_f32_16x16x32_bf16 v[32:35], a[68:71], v[136:139], v[32:35]
    s_waitcnt lgkmcnt(9)
    ds_read_b64_tr_b16 a[98:99], v4 offset:34016
    v_cvt_pk_bf16_f32 v49, v18, v19
    v_mfma_f32_16x16x32_bf16 v[32:35], a[72:75], v[144:147], v[32:35]
    ds_read_b64_tr_b16 a[100:101], v4 offset:34144
    v_cvt_pk_bf16_f32 v50, v24, v25
    v_mfma_f32_16x16x32_bf16 v[32:35], a[76:79], v[152:155], v[32:35]
    s_waitcnt lgkmcnt(7)
    ds_read_b64_tr_b16 a[102:103], v4 offset:34272
    v_cvt_pk_bf16_f32 v51, v26, v27
    v_mfma_f32_16x16x32_bf16 v[32:35], a[80:83], v[192:195], v[32:35]
    s_mov_b32 s54, 5120
    ds_read_b64_tr_b16 a[104:105], v4 offset:34400
    ds_read_b64_tr_b16 a[106:107], v4 offset:34528
    v_mfma_f32_16x16x32_bf16 v[32:35], a[84:87], v[200:203], v[32:35]
    s_waitcnt lgkmcnt(6)
    v_permlane32_swap_b32 v48, v50
    v_mfma_f32_16x16x32_bf16 v[32:35], a[88:91], v[208:211], v[32:35]
    s_add_u32 m0, s44, 50496
    v_permlane32_swap_b32 v49, v51
    v_mfma_f32_16x16x32_bf16 v[32:35], a[92:95], v[216:219], v[32:35]
    buffer_load_dwordx4 v7, s[28:31], s45 offen offset:2304 lds
    ds_read_b64_tr_b16 a[108:109], v4 offset:34656
    ds_read_b64_tr_b16 a[110:111], v4 offset:34784
    buffer_store_dwordx4 v[48:51], v10, s[40:43], s54 offen offset:0
    v_mfma_f32_16x16x32_bf16 v[36:39], a[64:67], v[160:163], 0
    ds_read_b64_tr_b16 a[112:113], v4 offset:50784
    v_cvt_pk_bf16_f32 v52, v20, v21
    v_mfma_f32_16x16x32_bf16 v[36:39], a[68:71], v[168:171], v[36:39]
    ds_read_b64_tr_b16 a[114:115], v4 offset:50912
    v_cvt_pk_bf16_f32 v53, v22, v23
    v_mfma_f32_16x16x32_bf16 v[36:39], a[72:75], v[176:179], v[36:39]
    ds_read_b64_tr_b16 a[116:117], v4 offset:51040
    v_cvt_pk_bf16_f32 v54, v28, v29
    v_mfma_f32_16x16x32_bf16 v[36:39], a[76:79], v[184:187], v[36:39]
    ds_read_b64_tr_b16 a[118:119], v4 offset:51168
    v_cvt_pk_bf16_f32 v55, v30, v31
    v_mfma_f32_16x16x32_bf16 v[36:39], a[80:83], v[224:227], v[36:39]
    s_mov_b32 s54, 300032
    ds_read_b64_tr_b16 a[120:121], v4 offset:51296
    ds_read_b64_tr_b16 a[122:123], v4 offset:51424
    v_mfma_f32_16x16x32_bf16 v[36:39], a[84:87], v[232:235], v[36:39]
    v_permlane32_swap_b32 v52, v54
    v_mfma_f32_16x16x32_bf16 v[36:39], a[88:91], v[240:243], v[36:39]
    s_add_u32 m0, s44, 50400
    v_permlane32_swap_b32 v53, v55
    v_mfma_f32_16x16x32_bf16 v[36:39], a[92:95], v[248:251], v[36:39]
    s_waitcnt vmcnt(11)
    s_barrier
    s_waitcnt lgkmcnt(10)
    buffer_load_dwordx4 v7, s[28:31], s45 offen offset:3456 lds
    ds_read_b64_tr_b16 a[124:125], v4 offset:51552
    ds_read_b64_tr_b16 a[126:127], v4 offset:51680
    buffer_store_dwordx4 v[52:55], v10, s[40:43], s54 offen offset:0
    v_mfma_f32_16x16x32_bf16 v[40:43], a[96:99], v[128:131], 0
    ds_read_b64_tr_b16 a[64:65], v3 offset:0
    ds_read_b64_tr_b16 a[66:67], v3 offset:128
    v_mfma_f32_16x16x32_bf16 v[40:43], a[100:103], v[136:139], v[40:43]
    s_waitcnt lgkmcnt(10)
    ds_read_b64_tr_b16 a[68:69], v3 offset:256
    ds_read_b64_tr_b16 a[70:71], v3 offset:384
    v_mfma_f32_16x16x32_bf16 v[40:43], a[104:107], v[144:147], v[40:43]
    ds_read_b64_tr_b16 a[72:73], v3 offset:512
    v_mfma_f32_16x16x32_bf16 v[40:43], a[108:111], v[152:155], v[40:43]
    s_waitcnt lgkmcnt(9)
    ds_read_b64_tr_b16 a[74:75], v3 offset:640
    v_mfma_f32_16x16x32_bf16 v[40:43], a[112:115], v[192:195], v[40:43]
    ds_read_b64_tr_b16 a[76:77], v3 offset:768
    v_mfma_f32_16x16x32_bf16 v[40:43], a[116:119], v[200:203], v[40:43]
    s_mov_b32 s45, 1024
    s_waitcnt lgkmcnt(7)
    ds_read_b64_tr_b16 a[78:79], v3 offset:896
    v_mfma_f32_16x16x32_bf16 v[40:43], a[120:123], v[208:211], v[40:43]
    s_add_u32 m0, s44, 67584
    ds_read_b64_tr_b16 a[80:81], v3 offset:16896
    v_mfma_f32_16x16x32_bf16 v[40:43], a[124:127], v[216:219], v[40:43]
    buffer_load_dwordx4 v7, s[28:31], s45 offen offset:0 lds
    v_mfma_f32_16x16x32_bf16 v[44:47], a[96:99], v[160:163], 0
    ds_read_b64_tr_b16 a[82:83], v3 offset:17024
    v_mfma_f32_16x16x32_bf16 v[44:47], a[100:103], v[168:171], v[44:47]
    ds_read_b64_tr_b16 a[84:85], v3 offset:17152
    v_mfma_f32_16x16x32_bf16 v[44:47], a[104:107], v[176:179], v[44:47]
    ds_read_b64_tr_b16 a[86:87], v3 offset:17280
    v_mfma_f32_16x16x32_bf16 v[44:47], a[108:111], v[184:187], v[44:47]
    ds_read_b64_tr_b16 a[88:89], v3 offset:17408
    v_mfma_f32_16x16x32_bf16 v[44:47], a[112:115], v[224:227], v[44:47]
    ds_read_b64_tr_b16 a[90:91], v3 offset:17536
    v_mfma_f32_16x16x32_bf16 v[44:47], a[116:119], v[232:235], v[44:47]
    ds_read_b64_tr_b16 a[92:93], v3 offset:17664
    v_mfma_f32_16x16x32_bf16 v[44:47], a[120:123], v[240:243], v[44:47]
    s_add_u32 m0, s44, 67488
    ds_read_b64_tr_b16 a[94:95], v3 offset:17792
    v_mfma_f32_16x16x32_bf16 v[44:47], a[124:127], v[248:251], v[44:47]
    s_waitcnt lgkmcnt(12)
    buffer_load_dwordx4 v7, s[28:31], s45 offen offset:1152 lds
    v_mfma_f32_16x16x32_bf16 v[16:19], a[64:67], v[128:131], 0
    ds_read_b64_tr_b16 a[96:97], v3 offset:32
    v_cvt_pk_bf16_f32 v48, v32, v33
    v_mfma_f32_16x16x32_bf16 v[16:19], a[68:71], v[136:139], v[16:19]
    s_waitcnt lgkmcnt(9)
    ds_read_b64_tr_b16 a[98:99], v3 offset:160
    v_cvt_pk_bf16_f32 v49, v34, v35
    v_mfma_f32_16x16x32_bf16 v[16:19], a[72:75], v[144:147], v[16:19]
    ds_read_b64_tr_b16 a[100:101], v3 offset:288
    v_cvt_pk_bf16_f32 v50, v40, v41
    v_mfma_f32_16x16x32_bf16 v[16:19], a[76:79], v[152:155], v[16:19]
    s_waitcnt lgkmcnt(7)
    ds_read_b64_tr_b16 a[102:103], v3 offset:416
    v_cvt_pk_bf16_f32 v51, v42, v43
    v_mfma_f32_16x16x32_bf16 v[16:19], a[80:83], v[192:195], v[16:19]
    s_mov_b32 s54, 5120
    ds_read_b64_tr_b16 a[104:105], v3 offset:544
    ds_read_b64_tr_b16 a[106:107], v3 offset:672
    v_mfma_f32_16x16x32_bf16 v[16:19], a[84:87], v[200:203], v[16:19]
    s_waitcnt lgkmcnt(6)
    v_permlane32_swap_b32 v48, v50
    v_mfma_f32_16x16x32_bf16 v[16:19], a[88:91], v[208:211], v[16:19]
    s_add_u32 m0, s44, 67392
    v_permlane32_swap_b32 v49, v51
    v_mfma_f32_16x16x32_bf16 v[16:19], a[92:95], v[216:219], v[16:19]
    buffer_load_dwordx4 v7, s[28:31], s45 offen offset:2304 lds
    ds_read_b64_tr_b16 a[108:109], v3 offset:800
    ds_read_b64_tr_b16 a[110:111], v3 offset:928
    buffer_store_dwordx4 v[48:51], v10, s[40:43], s54 offen offset:512
    v_mfma_f32_16x16x32_bf16 v[20:23], a[64:67], v[160:163], 0
    ds_read_b64_tr_b16 a[112:113], v3 offset:16928
    v_cvt_pk_bf16_f32 v52, v36, v37
    v_mfma_f32_16x16x32_bf16 v[20:23], a[68:71], v[168:171], v[20:23]
    ds_read_b64_tr_b16 a[114:115], v3 offset:17056
    v_cvt_pk_bf16_f32 v53, v38, v39
    v_mfma_f32_16x16x32_bf16 v[20:23], a[72:75], v[176:179], v[20:23]
    ds_read_b64_tr_b16 a[116:117], v3 offset:17184
    v_cvt_pk_bf16_f32 v54, v44, v45
    v_mfma_f32_16x16x32_bf16 v[20:23], a[76:79], v[184:187], v[20:23]
    ds_read_b64_tr_b16 a[118:119], v3 offset:17312
    v_cvt_pk_bf16_f32 v55, v46, v47
    v_mfma_f32_16x16x32_bf16 v[20:23], a[80:83], v[224:227], v[20:23]
    s_mov_b32 s54, 300032
    ds_read_b64_tr_b16 a[120:121], v3 offset:17440
    ds_read_b64_tr_b16 a[122:123], v3 offset:17568
    v_mfma_f32_16x16x32_bf16 v[20:23], a[84:87], v[232:235], v[20:23]
    v_permlane32_swap_b32 v52, v54
    v_mfma_f32_16x16x32_bf16 v[20:23], a[88:91], v[240:243], v[20:23]
    s_add_u32 m0, s44, 67296
    v_permlane32_swap_b32 v53, v55
    v_mfma_f32_16x16x32_bf16 v[20:23], a[92:95], v[248:251], v[20:23]
    s_waitcnt lgkmcnt(10)
    buffer_load_dwordx4 v7, s[28:31], s45 offen offset:3456 lds
    ds_read_b64_tr_b16 a[124:125], v3 offset:17696
    ds_read_b64_tr_b16 a[126:127], v3 offset:17824
    buffer_store_dwordx4 v[52:55], v10, s[40:43], s54 offen offset:512
    v_mfma_f32_16x16x32_bf16 v[24:27], a[96:99], v[128:131], 0
    ds_read_b64_tr_b16 a[64:65], v3 offset:64
    ds_read_b64_tr_b16 a[66:67], v3 offset:192
    v_mfma_f32_16x16x32_bf16 v[24:27], a[100:103], v[136:139], v[24:27]
    s_waitcnt lgkmcnt(10)
    ds_read_b64_tr_b16 a[68:69], v3 offset:320
    ds_read_b64_tr_b16 a[70:71], v3 offset:448
    v_mfma_f32_16x16x32_bf16 v[24:27], a[104:107], v[144:147], v[24:27]
    ds_read_b64_tr_b16 a[72:73], v3 offset:576
    v_mfma_f32_16x16x32_bf16 v[24:27], a[108:111], v[152:155], v[24:27]
    s_waitcnt lgkmcnt(9)
    ds_read_b64_tr_b16 a[74:75], v3 offset:704
    v_mfma_f32_16x16x32_bf16 v[24:27], a[112:115], v[192:195], v[24:27]
    ds_read_b64_tr_b16 a[76:77], v3 offset:832
    v_mfma_f32_16x16x32_bf16 v[24:27], a[116:119], v[200:203], v[24:27]
    s_mov_b32 s45, 148480
    s_waitcnt lgkmcnt(7)
    ds_read_b64_tr_b16 a[78:79], v3 offset:960
    v_mfma_f32_16x16x32_bf16 v[24:27], a[120:123], v[208:211], v[24:27]
    s_add_u32 m0, s44, 84480
    ds_read_b64_tr_b16 a[80:81], v3 offset:16960
    v_mfma_f32_16x16x32_bf16 v[24:27], a[124:127], v[216:219], v[24:27]
    buffer_load_dwordx4 v7, s[28:31], s45 offen offset:0 lds
    v_mfma_f32_16x16x32_bf16 v[28:31], a[96:99], v[160:163], 0
    ds_read_b64_tr_b16 a[82:83], v3 offset:17088
    v_mfma_f32_16x16x32_bf16 v[28:31], a[100:103], v[168:171], v[28:31]
    ds_read_b64_tr_b16 a[84:85], v3 offset:17216
    v_mfma_f32_16x16x32_bf16 v[28:31], a[104:107], v[176:179], v[28:31]
    ds_read_b64_tr_b16 a[86:87], v3 offset:17344
    v_mfma_f32_16x16x32_bf16 v[28:31], a[108:111], v[184:187], v[28:31]
    ds_read_b64_tr_b16 a[88:89], v3 offset:17472
    v_mfma_f32_16x16x32_bf16 v[28:31], a[112:115], v[224:227], v[28:31]
    ds_read_b64_tr_b16 a[90:91], v3 offset:17600
    v_mfma_f32_16x16x32_bf16 v[28:31], a[116:119], v[232:235], v[28:31]
    ds_read_b64_tr_b16 a[92:93], v3 offset:17728
    v_mfma_f32_16x16x32_bf16 v[28:31], a[120:123], v[240:243], v[28:31]
    s_add_u32 m0, s44, 84384
    ds_read_b64_tr_b16 a[94:95], v3 offset:17856
    v_mfma_f32_16x16x32_bf16 v[28:31], a[124:127], v[248:251], v[28:31]
    s_waitcnt lgkmcnt(12)
    buffer_load_dwordx4 v7, s[28:31], s45 offen offset:1152 lds
    v_mfma_f32_16x16x32_bf16 v[32:35], a[64:67], v[128:131], 0
    ds_read_b64_tr_b16 a[96:97], v3 offset:96
    v_cvt_pk_bf16_f32 v48, v16, v17
    v_mfma_f32_16x16x32_bf16 v[32:35], a[68:71], v[136:139], v[32:35]
    s_waitcnt lgkmcnt(9)
    ds_read_b64_tr_b16 a[98:99], v3 offset:224
    v_cvt_pk_bf16_f32 v49, v18, v19
    v_mfma_f32_16x16x32_bf16 v[32:35], a[72:75], v[144:147], v[32:35]
    ds_read_b64_tr_b16 a[100:101], v3 offset:352
    v_cvt_pk_bf16_f32 v50, v24, v25
    v_mfma_f32_16x16x32_bf16 v[32:35], a[76:79], v[152:155], v[32:35]
    s_waitcnt lgkmcnt(7)
    ds_read_b64_tr_b16 a[102:103], v3 offset:480
    v_cvt_pk_bf16_f32 v51, v26, v27
    v_mfma_f32_16x16x32_bf16 v[32:35], a[80:83], v[192:195], v[32:35]
    s_mov_b32 s54, 6144
    ds_read_b64_tr_b16 a[104:105], v3 offset:608
    ds_read_b64_tr_b16 a[106:107], v3 offset:736
    v_mfma_f32_16x16x32_bf16 v[32:35], a[84:87], v[200:203], v[32:35]
    s_waitcnt lgkmcnt(6)
    v_permlane32_swap_b32 v48, v50
    v_mfma_f32_16x16x32_bf16 v[32:35], a[88:91], v[208:211], v[32:35]
    s_add_u32 m0, s44, 84288
    v_permlane32_swap_b32 v49, v51
    v_mfma_f32_16x16x32_bf16 v[32:35], a[92:95], v[216:219], v[32:35]
    buffer_load_dwordx4 v7, s[28:31], s45 offen offset:2304 lds
    ds_read_b64_tr_b16 a[108:109], v3 offset:864
    ds_read_b64_tr_b16 a[110:111], v3 offset:992
    buffer_store_dwordx4 v[48:51], v10, s[40:43], s54 offen offset:0
    v_mfma_f32_16x16x32_bf16 v[36:39], a[64:67], v[160:163], 0
    ds_read_b64_tr_b16 a[112:113], v3 offset:16992
    v_cvt_pk_bf16_f32 v52, v20, v21
    v_mfma_f32_16x16x32_bf16 v[36:39], a[68:71], v[168:171], v[36:39]
    ds_read_b64_tr_b16 a[114:115], v3 offset:17120
    v_cvt_pk_bf16_f32 v53, v22, v23
    v_mfma_f32_16x16x32_bf16 v[36:39], a[72:75], v[176:179], v[36:39]
    ds_read_b64_tr_b16 a[116:117], v3 offset:17248
    v_cvt_pk_bf16_f32 v54, v28, v29
    v_mfma_f32_16x16x32_bf16 v[36:39], a[76:79], v[184:187], v[36:39]
    ds_read_b64_tr_b16 a[118:119], v3 offset:17376
    v_cvt_pk_bf16_f32 v55, v30, v31
    v_mfma_f32_16x16x32_bf16 v[36:39], a[80:83], v[224:227], v[36:39]
    s_mov_b32 s54, 301056
    ds_read_b64_tr_b16 a[120:121], v3 offset:17504
    ds_read_b64_tr_b16 a[122:123], v3 offset:17632
    v_mfma_f32_16x16x32_bf16 v[36:39], a[84:87], v[232:235], v[36:39]
    v_permlane32_swap_b32 v52, v54
    v_mfma_f32_16x16x32_bf16 v[36:39], a[88:91], v[240:243], v[36:39]
    s_add_u32 m0, s44, 84192
    v_permlane32_swap_b32 v53, v55
    v_mfma_f32_16x16x32_bf16 v[36:39], a[92:95], v[248:251], v[36:39]
    s_waitcnt vmcnt(11)
    s_barrier
    s_waitcnt lgkmcnt(10)
    buffer_load_dwordx4 v7, s[28:31], s45 offen offset:3456 lds
    ds_read_b64_tr_b16 a[124:125], v3 offset:17760
    ds_read_b64_tr_b16 a[126:127], v3 offset:17888
    buffer_store_dwordx4 v[52:55], v10, s[40:43], s54 offen offset:0
    v_mfma_f32_16x16x32_bf16 v[40:43], a[96:99], v[128:131], 0
    ds_read_b64_tr_b16 a[64:65], v3 offset:33792
    v_mfma_f32_16x16x32_bf16 v[40:43], a[100:103], v[136:139], v[40:43]
    s_waitcnt lgkmcnt(9)
    ds_read_b64_tr_b16 a[66:67], v3 offset:33920
    v_mfma_f32_16x16x32_bf16 v[40:43], a[104:107], v[144:147], v[40:43]
    ds_read_b64_tr_b16 a[68:69], v3 offset:34048
    v_mfma_f32_16x16x32_bf16 v[40:43], a[108:111], v[152:155], v[40:43]
    s_waitcnt lgkmcnt(7)
    ds_read_b64_tr_b16 a[70:71], v3 offset:34176
    v_mfma_f32_16x16x32_bf16 v[40:43], a[112:115], v[192:195], v[40:43]
    ds_read_b64_tr_b16 a[72:73], v3 offset:34304
    v_mfma_f32_16x16x32_bf16 v[40:43], a[116:119], v[200:203], v[40:43]
    s_waitcnt lgkmcnt(5)
    ds_read_b64_tr_b16 a[74:75], v3 offset:34432
    v_mfma_f32_16x16x32_bf16 v[40:43], a[120:123], v[208:211], v[40:43]
    ds_read_b64_tr_b16 a[76:77], v3 offset:34560
    v_mfma_f32_16x16x32_bf16 v[40:43], a[124:127], v[216:219], v[40:43]
    ds_read_b64_tr_b16 a[78:79], v3 offset:34688
    v_mfma_f32_16x16x32_bf16 v[44:47], a[96:99], v[160:163], 0
    ds_read_b64_tr_b16 a[80:81], v3 offset:50688
    v_mfma_f32_16x16x32_bf16 v[44:47], a[100:103], v[168:171], v[44:47]
    ds_read_b64_tr_b16 a[82:83], v3 offset:50816
    v_mfma_f32_16x16x32_bf16 v[44:47], a[104:107], v[176:179], v[44:47]
    ds_read_b64_tr_b16 a[84:85], v3 offset:50944
    v_mfma_f32_16x16x32_bf16 v[44:47], a[108:111], v[184:187], v[44:47]
    ds_read_b64_tr_b16 a[86:87], v3 offset:51072
    v_mfma_f32_16x16x32_bf16 v[44:47], a[112:115], v[224:227], v[44:47]
    ds_read_b64_tr_b16 a[88:89], v3 offset:51200
    v_mfma_f32_16x16x32_bf16 v[44:47], a[116:119], v[232:235], v[44:47]
    ds_read_b64_tr_b16 a[90:91], v3 offset:51328
    v_mfma_f32_16x16x32_bf16 v[44:47], a[120:123], v[240:243], v[44:47]
    ds_read_b64_tr_b16 a[92:93], v3 offset:51456
    v_mfma_f32_16x16x32_bf16 v[44:47], a[124:127], v[248:251], v[44:47]
    s_waitcnt lgkmcnt(11)
    ds_read_b64_tr_b16 a[94:95], v3 offset:51584
    v_mfma_f32_16x16x32_bf16 v[16:19], a[64:67], v[128:131], 0
    ds_read_b64_tr_b16 a[96:97], v3 offset:33824
    v_cvt_pk_bf16_f32 v48, v32, v33
    v_mfma_f32_16x16x32_bf16 v[16:19], a[68:71], v[136:139], v[16:19]
    s_waitcnt lgkmcnt(9)
    ds_read_b64_tr_b16 a[98:99], v3 offset:33952
    v_cvt_pk_bf16_f32 v49, v34, v35
    v_mfma_f32_16x16x32_bf16 v[16:19], a[72:75], v[144:147], v[16:19]
    ds_read_b64_tr_b16 a[100:101], v3 offset:34080
    v_cvt_pk_bf16_f32 v50, v40, v41
    v_mfma_f32_16x16x32_bf16 v[16:19], a[76:79], v[152:155], v[16:19]
    s_waitcnt lgkmcnt(7)
    ds_read_b64_tr_b16 a[102:103], v3 offset:34208
    v_cvt_pk_bf16_f32 v51, v42, v43
    v_mfma_f32_16x16x32_bf16 v[16:19], a[80:83], v[192:195], v[16:19]
    s_mov_b32 s54, 6144
    ds_read_b64_tr_b16 a[104:105], v3 offset:34336
    ds_read_b64_tr_b16 a[106:107], v3 offset:34464
    v_mfma_f32_16x16x32_bf16 v[16:19], a[84:87], v[200:203], v[16:19]
    s_waitcnt lgkmcnt(6)
    v_permlane32_swap_b32 v48, v50
    v_mfma_f32_16x16x32_bf16 v[16:19], a[88:91], v[208:211], v[16:19]
    v_permlane32_swap_b32 v49, v51
    v_mfma_f32_16x16x32_bf16 v[16:19], a[92:95], v[216:219], v[16:19]
    ds_read_b64_tr_b16 a[108:109], v3 offset:34592
    ds_read_b64_tr_b16 a[110:111], v3 offset:34720
    buffer_store_dwordx4 v[48:51], v10, s[40:43], s54 offen offset:512
    v_mfma_f32_16x16x32_bf16 v[20:23], a[64:67], v[160:163], 0
    ds_read_b64_tr_b16 a[112:113], v3 offset:50720
    v_cvt_pk_bf16_f32 v52, v36, v37
    v_mfma_f32_16x16x32_bf16 v[20:23], a[68:71], v[168:171], v[20:23]
    ds_read_b64_tr_b16 a[114:115], v3 offset:50848
    v_cvt_pk_bf16_f32 v53, v38, v39
    v_mfma_f32_16x16x32_bf16 v[20:23], a[72:75], v[176:179], v[20:23]
    ds_read_b64_tr_b16 a[116:117], v3 offset:50976
    v_cvt_pk_bf16_f32 v54, v44, v45
    v_mfma_f32_16x16x32_bf16 v[20:23], a[76:79], v[184:187], v[20:23]
    ds_read_b64_tr_b16 a[118:119], v3 offset:51104
    v_cvt_pk_bf16_f32 v55, v46, v47
    v_mfma_f32_16x16x32_bf16 v[20:23], a[80:83], v[224:227], v[20:23]
    s_mov_b32 s54, 301056
    ds_read_b64_tr_b16 a[120:121], v3 offset:51232
    ds_read_b64_tr_b16 a[122:123], v3 offset:51360
    v_mfma_f32_16x16x32_bf16 v[20:23], a[84:87], v[232:235], v[20:23]
    v_permlane32_swap_b32 v52, v54
    v_mfma_f32_16x16x32_bf16 v[20:23], a[88:91], v[240:243], v[20:23]
    v_permlane32_swap_b32 v53, v55
    v_mfma_f32_16x16x32_bf16 v[20:23], a[92:95], v[248:251], v[20:23]
    s_waitcnt lgkmcnt(10)
    ds_read_b64_tr_b16 a[124:125], v3 offset:51488
    ds_read_b64_tr_b16 a[126:127], v3 offset:51616
    buffer_store_dwordx4 v[52:55], v10, s[40:43], s54 offen offset:512
    v_mfma_f32_16x16x32_bf16 v[24:27], a[96:99], v[128:131], 0
    ds_read_b64_tr_b16 a[64:65], v3 offset:33856
    v_mfma_f32_16x16x32_bf16 v[24:27], a[100:103], v[136:139], v[24:27]
    s_waitcnt lgkmcnt(9)
    ds_read_b64_tr_b16 a[66:67], v3 offset:33984
    v_mfma_f32_16x16x32_bf16 v[24:27], a[104:107], v[144:147], v[24:27]
    ds_read_b64_tr_b16 a[68:69], v3 offset:34112
    v_mfma_f32_16x16x32_bf16 v[24:27], a[108:111], v[152:155], v[24:27]
    s_waitcnt lgkmcnt(7)
    ds_read_b64_tr_b16 a[70:71], v3 offset:34240
    v_mfma_f32_16x16x32_bf16 v[24:27], a[112:115], v[192:195], v[24:27]
    ds_read_b64_tr_b16 a[72:73], v3 offset:34368
    v_mfma_f32_16x16x32_bf16 v[24:27], a[116:119], v[200:203], v[24:27]
    s_waitcnt lgkmcnt(5)
    ds_read_b64_tr_b16 a[74:75], v3 offset:34496
    v_mfma_f32_16x16x32_bf16 v[24:27], a[120:123], v[208:211], v[24:27]
    ds_read_b64_tr_b16 a[76:77], v3 offset:34624
    v_mfma_f32_16x16x32_bf16 v[24:27], a[124:127], v[216:219], v[24:27]
    ds_read_b64_tr_b16 a[78:79], v3 offset:34752
    v_mfma_f32_16x16x32_bf16 v[28:31], a[96:99], v[160:163], 0
    ds_read_b64_tr_b16 a[80:81], v3 offset:50752
    v_mfma_f32_16x16x32_bf16 v[28:31], a[100:103], v[168:171], v[28:31]
    ds_read_b64_tr_b16 a[82:83], v3 offset:50880
    v_mfma_f32_16x16x32_bf16 v[28:31], a[104:107], v[176:179], v[28:31]
    ds_read_b64_tr_b16 a[84:85], v3 offset:51008
    v_mfma_f32_16x16x32_bf16 v[28:31], a[108:111], v[184:187], v[28:31]
    ds_read_b64_tr_b16 a[86:87], v3 offset:51136
    v_mfma_f32_16x16x32_bf16 v[28:31], a[112:115], v[224:227], v[28:31]
    ds_read_b64_tr_b16 a[88:89], v3 offset:51264
    v_mfma_f32_16x16x32_bf16 v[28:31], a[116:119], v[232:235], v[28:31]
    ds_read_b64_tr_b16 a[90:91], v3 offset:51392
    v_mfma_f32_16x16x32_bf16 v[28:31], a[120:123], v[240:243], v[28:31]
    ds_read_b64_tr_b16 a[92:93], v3 offset:51520
    v_mfma_f32_16x16x32_bf16 v[28:31], a[124:127], v[248:251], v[28:31]
    s_waitcnt lgkmcnt(11)
    ds_read_b64_tr_b16 a[94:95], v3 offset:51648
    v_mfma_f32_16x16x32_bf16 v[32:35], a[64:67], v[128:131], 0
    ds_read_b64_tr_b16 a[96:97], v3 offset:33888
    v_cvt_pk_bf16_f32 v48, v16, v17
    v_mfma_f32_16x16x32_bf16 v[32:35], a[68:71], v[136:139], v[32:35]
    s_waitcnt lgkmcnt(9)
    ds_read_b64_tr_b16 a[98:99], v3 offset:34016
    v_cvt_pk_bf16_f32 v49, v18, v19
    v_mfma_f32_16x16x32_bf16 v[32:35], a[72:75], v[144:147], v[32:35]
    ds_read_b64_tr_b16 a[100:101], v3 offset:34144
    v_cvt_pk_bf16_f32 v50, v24, v25
    v_mfma_f32_16x16x32_bf16 v[32:35], a[76:79], v[152:155], v[32:35]
    s_waitcnt lgkmcnt(7)
    ds_read_b64_tr_b16 a[102:103], v3 offset:34272
    v_cvt_pk_bf16_f32 v51, v26, v27
    v_mfma_f32_16x16x32_bf16 v[32:35], a[80:83], v[192:195], v[32:35]
    s_mov_b32 s54, 7168
    ds_read_b64_tr_b16 a[104:105], v3 offset:34400
    ds_read_b64_tr_b16 a[106:107], v3 offset:34528
    v_mfma_f32_16x16x32_bf16 v[32:35], a[84:87], v[200:203], v[32:35]
    s_waitcnt lgkmcnt(6)
    v_permlane32_swap_b32 v48, v50
    v_mfma_f32_16x16x32_bf16 v[32:35], a[88:91], v[208:211], v[32:35]
    v_permlane32_swap_b32 v49, v51
    v_mfma_f32_16x16x32_bf16 v[32:35], a[92:95], v[216:219], v[32:35]
    ds_read_b64_tr_b16 a[108:109], v3 offset:34656
    ds_read_b64_tr_b16 a[110:111], v3 offset:34784
    buffer_store_dwordx4 v[48:51], v10, s[40:43], s54 offen offset:0
    v_mfma_f32_16x16x32_bf16 v[36:39], a[64:67], v[160:163], 0
    ds_read_b64_tr_b16 a[112:113], v3 offset:50784
    v_cvt_pk_bf16_f32 v52, v20, v21
    v_mfma_f32_16x16x32_bf16 v[36:39], a[68:71], v[168:171], v[36:39]
    ds_read_b64_tr_b16 a[114:115], v3 offset:50912
    v_cvt_pk_bf16_f32 v53, v22, v23
    v_mfma_f32_16x16x32_bf16 v[36:39], a[72:75], v[176:179], v[36:39]
    ds_read_b64_tr_b16 a[116:117], v3 offset:51040
    v_cvt_pk_bf16_f32 v54, v28, v29
    v_mfma_f32_16x16x32_bf16 v[36:39], a[76:79], v[184:187], v[36:39]
    ds_read_b64_tr_b16 a[118:119], v3 offset:51168
    v_cvt_pk_bf16_f32 v55, v30, v31
    v_mfma_f32_16x16x32_bf16 v[36:39], a[80:83], v[224:227], v[36:39]
    s_mov_b32 s54, 302080
    ds_read_b64_tr_b16 a[120:121], v3 offset:51296
    ds_read_b64_tr_b16 a[122:123], v3 offset:51424
    v_mfma_f32_16x16x32_bf16 v[36:39], a[84:87], v[232:235], v[36:39]
    v_permlane32_swap_b32 v52, v54
    v_mfma_f32_16x16x32_bf16 v[36:39], a[88:91], v[240:243], v[36:39]
    v_permlane32_swap_b32 v53, v55
    v_mfma_f32_16x16x32_bf16 v[36:39], a[92:95], v[248:251], v[36:39]
    s_waitcnt vmcnt(4)
    s_barrier
    s_waitcnt lgkmcnt(10)
    ds_read_b64_tr_b16 a[124:125], v3 offset:51552
    ds_read_b64_tr_b16 a[126:127], v3 offset:51680
    buffer_store_dwordx4 v[52:55], v10, s[40:43], s54 offen offset:0
    v_mfma_f32_16x16x32_bf16 v[40:43], a[96:99], v[128:131], 0
    ds_read_b64_tr_b16 a[64:65], v4 offset:0
    v_mfma_f32_16x16x32_bf16 v[40:43], a[100:103], v[136:139], v[40:43]
    s_waitcnt lgkmcnt(9)
    ds_read_b64_tr_b16 a[66:67], v4 offset:128
    v_mfma_f32_16x16x32_bf16 v[40:43], a[104:107], v[144:147], v[40:43]
    ds_read_b64_tr_b16 a[68:69], v4 offset:256
    v_mfma_f32_16x16x32_bf16 v[40:43], a[108:111], v[152:155], v[40:43]
    s_waitcnt lgkmcnt(7)
    ds_read_b64_tr_b16 a[70:71], v4 offset:384
    v_mfma_f32_16x16x32_bf16 v[40:43], a[112:115], v[192:195], v[40:43]
    ds_read_b64_tr_b16 a[72:73], v4 offset:512
    v_mfma_f32_16x16x32_bf16 v[40:43], a[116:119], v[200:203], v[40:43]
    s_waitcnt lgkmcnt(5)
    ds_read_b64_tr_b16 a[74:75], v4 offset:640
    v_mfma_f32_16x16x32_bf16 v[40:43], a[120:123], v[208:211], v[40:43]
    ds_read_b64_tr_b16 a[76:77], v4 offset:768
    v_mfma_f32_16x16x32_bf16 v[40:43], a[124:127], v[216:219], v[40:43]
    ds_read_b64_tr_b16 a[78:79], v4 offset:896
    v_mfma_f32_16x16x32_bf16 v[44:47], a[96:99], v[160:163], 0
    ds_read_b64_tr_b16 a[80:81], v4 offset:16896
    v_mfma_f32_16x16x32_bf16 v[44:47], a[100:103], v[168:171], v[44:47]
    ds_read_b64_tr_b16 a[82:83], v4 offset:17024
    v_mfma_f32_16x16x32_bf16 v[44:47], a[104:107], v[176:179], v[44:47]
    ds_read_b64_tr_b16 a[84:85], v4 offset:17152
    v_mfma_f32_16x16x32_bf16 v[44:47], a[108:111], v[184:187], v[44:47]
    ds_read_b64_tr_b16 a[86:87], v4 offset:17280
    v_mfma_f32_16x16x32_bf16 v[44:47], a[112:115], v[224:227], v[44:47]
    ds_read_b64_tr_b16 a[88:89], v4 offset:17408
    v_mfma_f32_16x16x32_bf16 v[44:47], a[116:119], v[232:235], v[44:47]
    ds_read_b64_tr_b16 a[90:91], v4 offset:17536
    v_mfma_f32_16x16x32_bf16 v[44:47], a[120:123], v[240:243], v[44:47]
    ds_read_b64_tr_b16 a[92:93], v4 offset:17664
    v_mfma_f32_16x16x32_bf16 v[44:47], a[124:127], v[248:251], v[44:47]
    s_waitcnt lgkmcnt(11)
    ds_read_b64_tr_b16 a[94:95], v4 offset:17792
    v_mfma_f32_16x16x32_bf16 v[16:19], a[64:67], v[128:131], 0
    ds_read_b64_tr_b16 a[96:97], v4 offset:32
    v_cvt_pk_bf16_f32 v48, v32, v33
    v_mfma_f32_16x16x32_bf16 v[16:19], a[68:71], v[136:139], v[16:19]
    s_waitcnt lgkmcnt(9)
    ds_read_b64_tr_b16 a[98:99], v4 offset:160
    v_cvt_pk_bf16_f32 v49, v34, v35
    v_mfma_f32_16x16x32_bf16 v[16:19], a[72:75], v[144:147], v[16:19]
    ds_read_b64_tr_b16 a[100:101], v4 offset:288
    v_cvt_pk_bf16_f32 v50, v40, v41
    v_mfma_f32_16x16x32_bf16 v[16:19], a[76:79], v[152:155], v[16:19]
    s_waitcnt lgkmcnt(7)
    ds_read_b64_tr_b16 a[102:103], v4 offset:416
    v_cvt_pk_bf16_f32 v51, v42, v43
    v_mfma_f32_16x16x32_bf16 v[16:19], a[80:83], v[192:195], v[16:19]
    s_mov_b32 s54, 7168
    ds_read_b64_tr_b16 a[104:105], v4 offset:544
    ds_read_b64_tr_b16 a[106:107], v4 offset:672
    v_mfma_f32_16x16x32_bf16 v[16:19], a[84:87], v[200:203], v[16:19]
    s_waitcnt lgkmcnt(6)
    v_permlane32_swap_b32 v48, v50
    v_mfma_f32_16x16x32_bf16 v[16:19], a[88:91], v[208:211], v[16:19]
    v_permlane32_swap_b32 v49, v51
    v_mfma_f32_16x16x32_bf16 v[16:19], a[92:95], v[216:219], v[16:19]
    ds_read_b64_tr_b16 a[108:109], v4 offset:800
    ds_read_b64_tr_b16 a[110:111], v4 offset:928
    buffer_store_dwordx4 v[48:51], v10, s[40:43], s54 offen offset:512
    v_mfma_f32_16x16x32_bf16 v[20:23], a[64:67], v[160:163], 0
    ds_read_b64_tr_b16 a[112:113], v4 offset:16928
    v_cvt_pk_bf16_f32 v52, v36, v37
    v_mfma_f32_16x16x32_bf16 v[20:23], a[68:71], v[168:171], v[20:23]
    ds_read_b64_tr_b16 a[114:115], v4 offset:17056
    v_cvt_pk_bf16_f32 v53, v38, v39
    v_mfma_f32_16x16x32_bf16 v[20:23], a[72:75], v[176:179], v[20:23]
    ds_read_b64_tr_b16 a[116:117], v4 offset:17184
    v_cvt_pk_bf16_f32 v54, v44, v45
    v_mfma_f32_16x16x32_bf16 v[20:23], a[76:79], v[184:187], v[20:23]
    ds_read_b64_tr_b16 a[118:119], v4 offset:17312
    v_cvt_pk_bf16_f32 v55, v46, v47
    v_mfma_f32_16x16x32_bf16 v[20:23], a[80:83], v[224:227], v[20:23]
    s_mov_b32 s54, 302080
    ds_read_b64_tr_b16 a[120:121], v4 offset:17440
    ds_read_b64_tr_b16 a[122:123], v4 offset:17568
    v_mfma_f32_16x16x32_bf16 v[20:23], a[84:87], v[232:235], v[20:23]
    v_permlane32_swap_b32 v52, v54
    v_mfma_f32_16x16x32_bf16 v[20:23], a[88:91], v[240:243], v[20:23]
    v_permlane32_swap_b32 v53, v55
    v_mfma_f32_16x16x32_bf16 v[20:23], a[92:95], v[248:251], v[20:23]
    s_waitcnt lgkmcnt(10)
    ds_read_b64_tr_b16 a[124:125], v4 offset:17696
    ds_read_b64_tr_b16 a[126:127], v4 offset:17824
    buffer_store_dwordx4 v[52:55], v10, s[40:43], s54 offen offset:512
    v_mfma_f32_16x16x32_bf16 v[24:27], a[96:99], v[128:131], 0
    ds_read_b64_tr_b16 a[64:65], v4 offset:64
    v_mfma_f32_16x16x32_bf16 v[24:27], a[100:103], v[136:139], v[24:27]
    s_waitcnt lgkmcnt(9)
    ds_read_b64_tr_b16 a[66:67], v4 offset:192
    v_mfma_f32_16x16x32_bf16 v[24:27], a[104:107], v[144:147], v[24:27]
    ds_read_b64_tr_b16 a[68:69], v4 offset:320
    v_mfma_f32_16x16x32_bf16 v[24:27], a[108:111], v[152:155], v[24:27]
    s_waitcnt lgkmcnt(7)
    ds_read_b64_tr_b16 a[70:71], v4 offset:448
    v_mfma_f32_16x16x32_bf16 v[24:27], a[112:115], v[192:195], v[24:27]
    ds_read_b64_tr_b16 a[72:73], v4 offset:576
    v_mfma_f32_16x16x32_bf16 v[24:27], a[116:119], v[200:203], v[24:27]
    s_waitcnt lgkmcnt(5)
    ds_read_b64_tr_b16 a[74:75], v4 offset:704
    v_mfma_f32_16x16x32_bf16 v[24:27], a[120:123], v[208:211], v[24:27]
    ds_read_b64_tr_b16 a[76:77], v4 offset:832
    v_mfma_f32_16x16x32_bf16 v[24:27], a[124:127], v[216:219], v[24:27]
    ds_read_b64_tr_b16 a[78:79], v4 offset:960
    v_mfma_f32_16x16x32_bf16 v[28:31], a[96:99], v[160:163], 0
    ds_read_b64_tr_b16 a[80:81], v4 offset:16960
    v_mfma_f32_16x16x32_bf16 v[28:31], a[100:103], v[168:171], v[28:31]
    ds_read_b64_tr_b16 a[82:83], v4 offset:17088
    v_mfma_f32_16x16x32_bf16 v[28:31], a[104:107], v[176:179], v[28:31]
    ds_read_b64_tr_b16 a[84:85], v4 offset:17216
    v_mfma_f32_16x16x32_bf16 v[28:31], a[108:111], v[184:187], v[28:31]
    ds_read_b64_tr_b16 a[86:87], v4 offset:17344
    v_mfma_f32_16x16x32_bf16 v[28:31], a[112:115], v[224:227], v[28:31]
    ds_read_b64_tr_b16 a[88:89], v4 offset:17472
    v_mfma_f32_16x16x32_bf16 v[28:31], a[116:119], v[232:235], v[28:31]
    ds_read_b64_tr_b16 a[90:91], v4 offset:17600
    v_mfma_f32_16x16x32_bf16 v[28:31], a[120:123], v[240:243], v[28:31]
    ds_read_b64_tr_b16 a[92:93], v4 offset:17728
    v_mfma_f32_16x16x32_bf16 v[28:31], a[124:127], v[248:251], v[28:31]
    s_waitcnt lgkmcnt(11)
    ds_read_b64_tr_b16 a[94:95], v4 offset:17856
    v_mfma_f32_16x16x32_bf16 v[32:35], a[64:67], v[128:131], 0
    ds_read_b64_tr_b16 a[96:97], v4 offset:96
    v_cvt_pk_bf16_f32 v48, v16, v17
    v_mfma_f32_16x16x32_bf16 v[32:35], a[68:71], v[136:139], v[32:35]
    s_waitcnt lgkmcnt(9)
    ds_read_b64_tr_b16 a[98:99], v4 offset:224
    v_cvt_pk_bf16_f32 v49, v18, v19
    v_mfma_f32_16x16x32_bf16 v[32:35], a[72:75], v[144:147], v[32:35]
    ds_read_b64_tr_b16 a[100:101], v4 offset:352
    v_cvt_pk_bf16_f32 v50, v24, v25
    v_mfma_f32_16x16x32_bf16 v[32:35], a[76:79], v[152:155], v[32:35]
    s_waitcnt lgkmcnt(7)
    ds_read_b64_tr_b16 a[102:103], v4 offset:480
    v_cvt_pk_bf16_f32 v51, v26, v27
    v_mfma_f32_16x16x32_bf16 v[32:35], a[80:83], v[192:195], v[32:35]
    s_mov_b32 s54, 8192
    ds_read_b64_tr_b16 a[104:105], v4 offset:608
    ds_read_b64_tr_b16 a[106:107], v4 offset:736
    v_mfma_f32_16x16x32_bf16 v[32:35], a[84:87], v[200:203], v[32:35]
    s_waitcnt lgkmcnt(6)
    v_permlane32_swap_b32 v48, v50
    v_mfma_f32_16x16x32_bf16 v[32:35], a[88:91], v[208:211], v[32:35]
    v_permlane32_swap_b32 v49, v51
    v_mfma_f32_16x16x32_bf16 v[32:35], a[92:95], v[216:219], v[32:35]
    ds_read_b64_tr_b16 a[108:109], v4 offset:864
    ds_read_b64_tr_b16 a[110:111], v4 offset:992
    buffer_store_dwordx4 v[48:51], v10, s[40:43], s54 offen offset:0
    v_mfma_f32_16x16x32_bf16 v[36:39], a[64:67], v[160:163], 0
    ds_read_b64_tr_b16 a[112:113], v4 offset:16992
    v_cvt_pk_bf16_f32 v52, v20, v21
    v_mfma_f32_16x16x32_bf16 v[36:39], a[68:71], v[168:171], v[36:39]
    ds_read_b64_tr_b16 a[114:115], v4 offset:17120
    v_cvt_pk_bf16_f32 v53, v22, v23
    v_mfma_f32_16x16x32_bf16 v[36:39], a[72:75], v[176:179], v[36:39]
    ds_read_b64_tr_b16 a[116:117], v4 offset:17248
    v_cvt_pk_bf16_f32 v54, v28, v29
    v_mfma_f32_16x16x32_bf16 v[36:39], a[76:79], v[184:187], v[36:39]
    ds_read_b64_tr_b16 a[118:119], v4 offset:17376
    v_cvt_pk_bf16_f32 v55, v30, v31
    v_mfma_f32_16x16x32_bf16 v[36:39], a[80:83], v[224:227], v[36:39]
    s_mov_b32 s54, 303104
    ds_read_b64_tr_b16 a[120:121], v4 offset:17504
    ds_read_b64_tr_b16 a[122:123], v4 offset:17632
    v_mfma_f32_16x16x32_bf16 v[36:39], a[84:87], v[232:235], v[36:39]
    v_permlane32_swap_b32 v52, v54
    v_mfma_f32_16x16x32_bf16 v[36:39], a[88:91], v[240:243], v[36:39]
    v_permlane32_swap_b32 v53, v55
    v_mfma_f32_16x16x32_bf16 v[36:39], a[92:95], v[248:251], v[36:39]
    s_waitcnt lgkmcnt(10)
    ds_read_b64_tr_b16 a[124:125], v4 offset:17760
    ds_read_b64_tr_b16 a[126:127], v4 offset:17888
    buffer_store_dwordx4 v[52:55], v10, s[40:43], s54 offen offset:0
    v_mfma_f32_16x16x32_bf16 v[40:43], a[96:99], v[128:131], 0
    v_mfma_f32_16x16x32_bf16 v[40:43], a[100:103], v[136:139], v[40:43]
    s_waitcnt lgkmcnt(8)
    v_mfma_f32_16x16x32_bf16 v[40:43], a[104:107], v[144:147], v[40:43]
    v_mfma_f32_16x16x32_bf16 v[40:43], a[108:111], v[152:155], v[40:43]
    s_waitcnt lgkmcnt(4)
    v_mfma_f32_16x16x32_bf16 v[40:43], a[112:115], v[192:195], v[40:43]
    v_mfma_f32_16x16x32_bf16 v[40:43], a[116:119], v[200:203], v[40:43]
    s_waitcnt lgkmcnt(0)
    v_mfma_f32_16x16x32_bf16 v[40:43], a[120:123], v[208:211], v[40:43]
    v_mfma_f32_16x16x32_bf16 v[40:43], a[124:127], v[216:219], v[40:43]
    v_mfma_f32_16x16x32_bf16 v[44:47], a[96:99], v[160:163], 0
    v_mfma_f32_16x16x32_bf16 v[44:47], a[100:103], v[168:171], v[44:47]
    v_mfma_f32_16x16x32_bf16 v[44:47], a[104:107], v[176:179], v[44:47]
    v_mfma_f32_16x16x32_bf16 v[44:47], a[108:111], v[184:187], v[44:47]
    v_mfma_f32_16x16x32_bf16 v[44:47], a[112:115], v[224:227], v[44:47]
    v_mfma_f32_16x16x32_bf16 v[44:47], a[116:119], v[232:235], v[44:47]
    v_mfma_f32_16x16x32_bf16 v[44:47], a[120:123], v[240:243], v[44:47]
    v_mfma_f32_16x16x32_bf16 v[44:47], a[124:127], v[248:251], v[44:47]
    s_nop 7
    v_cvt_pk_bf16_f32 v48, v32, v33
    v_cvt_pk_bf16_f32 v49, v34, v35
    v_cvt_pk_bf16_f32 v50, v40, v41
    v_cvt_pk_bf16_f32 v51, v42, v43
    s_nop 1
    v_permlane32_swap_b32 v48, v50
    v_permlane32_swap_b32 v49, v51
    s_mov_b32 s54, 8192
    buffer_store_dwordx4 v[48:51], v10, s[40:43], s54 offen offset:512
    v_cvt_pk_bf16_f32 v52, v36, v37
    v_cvt_pk_bf16_f32 v53, v38, v39
    v_cvt_pk_bf16_f32 v54, v44, v45
    v_cvt_pk_bf16_f32 v55, v46, v47
    s_nop 1
    v_permlane32_swap_b32 v52, v54
    v_permlane32_swap_b32 v53, v55
    s_mov_b32 s54, 303104
    buffer_store_dwordx4 v[52:55], v10, s[40:43], s54 offen offset:512
L2_end:
    s_endpgm
L2_fallback:
    s_waitcnt vmcnt(0) lgkmcnt(0)
    s_barrier
    v_lshrrev_b32 v14, 2, v0
    v_mul_u32_u24 v14, 1056, v14
    v_and_b32 v15, 3, v0
    v_lshl_add_u32 v14, v15, 3, v14
    v_add_u32 v2, 92672, v14
    v_and_b32 v14, 15, v0
    v_mul_u32_u24 v14, 1056, v14
    v_lshrrev_b32 v15, 4, v0
    v_lshl_add_u32 v14, v15, 4, v14
    v_add_u32 v1, 75776, v14
    v_mov_b32 v32, 0xff800000
    v_mov_b32 v33, 0xff800000
    v_mov_b32 v34, 0xff800000
    v_mov_b32 v35, 0xff800000
    s_mov_b32 s50, 1
    s_mov_b32 s46, 0
L2_fb_loop:
    s_add_u32 m0, s44, 67584
    s_nop 0
    buffer_load_dwordx4 v5, s[16:19], s46 offen offset:0 lds
    s_add_u32 m0, s44, 67616
    s_nop 0
    buffer_load_dwordx4 v5, s[16:19], s46 offen offset:1024 lds
    s_add_u32 m0, s44, 67648
    s_nop 0
    buffer_load_dwordx4 v5, s[16:19], s46 offen offset:2048 lds
    s_add_u32 m0, s44, 67680
    s_nop 0
    buffer_load_dwordx4 v5, s[16:19], s46 offen offset:3072 lds
    s_waitcnt vmcnt(0) lgkmcnt(0)
    s_barrier
    ds_read_b128 a[64:67], v1 offset:0
    ds_read_b128 a[68:71], v1 offset:64
    ds_read_b128 a[72:75], v1 offset:128
    ds_read_b128 a[76:79], v1 offset:192
    ds_read_b128 a[80:83], v1 offset:256
    ds_read_b128 a[84:87], v1 offset:320
    ds_read_b128 a[88:91], v1 offset:384
    ds_read_b128 a[92:95], v1 offset:448
    ds_read_b128 a[96:99], v1 offset:512
    ds_read_b128 a[100:103], v1 offset:576
    ds_read_b128 a[104:107], v1 offset:640
    ds_read_b128 a[108:111], v1 offset:704
    ds_read_b128 a[112:115], v1 offset:768
    ds_read_b128 a[116:119], v1 offset:832
    ds_read_b128 a[120:123], v1 offset:896
    ds_read_b128 a[124:127], v1 offset:960
    s_waitcnt vmcnt(0) lgkmcnt(0)
    s_barrier
    v_mfma_f32_16x16x32_bf16 v[16:19], a[64:67], v[64:67], 0
    v_mfma_f32_16x16x32_bf16 v[16:19], a[68:71], v[68:71], v[16:19]
    v_mfma_f32_16x16x32_bf16 v[16:19], a[72:75], v[72:75], v[16:19]
    v_mfma_f32_16x16x32_bf16 v[16:19], a[76:79], v[76:79], v[16:19]
    v_mfma_f32_16x16x32_bf16 v[20:23], a[80:83], v[64:67], 0
    v_mfma_f32_16x16x32_bf16 v[20:23], a[84:87], v[68:71], v[20:23]
    v_mfma_f32_16x16x32_bf16 v[20:23], a[88:91], v[72:75], v[20:23]
    v_mfma_f32_16x16x32_bf16 v[20:23], a[92:95], v[76:79], v[20:23]
    v_mfma_f32_16x16x32_bf16 v[24:27], a[96:99], v[64:67], 0
    v_mfma_f32_16x16x32_bf16 v[24:27], a[100:103], v[68:71], v[24:27]
    v_mfma_f32_16x16x32_bf16 v[24:27], a[104:107], v[72:75], v[24:27]
    v_mfma_f32_16x16x32_bf16 v[24:27], a[108:111], v[76:79], v[24:27]
    v_mfma_f32_16x16x32_bf16 v[28:31], a[112:115], v[64:67], 0
    v_mfma_f32_16x16x32_bf16 v[28:31], a[116:119], v[68:71], v[28:31]
    v_mfma_f32_16x16x32_bf16 v[28:31], a[120:123], v[72:75], v[28:31]
    v_mfma_f32_16x16x32_bf16 v[28:31], a[124:127], v[76:79], v[28:31]
    s_nop 7
    v_max3_f32 v32, v32, v16, v17
    v_max3_f32 v32, v32, v18, v19
    v_max3_f32 v32, v32, v20, v21
    v_max3_f32 v32, v32, v22, v23
    v_max3_f32 v32, v32, v24, v25
    v_max3_f32 v32, v32, v26, v27
    v_max3_f32 v32, v32, v28, v29
    v_max3_f32 v32, v32, v30, v31
    v_mfma_f32_16x16x32_bf16 v[16:19], a[64:67], v[80:83], 0
    v_mfma_f32_16x16x32_bf16 v[16:19], a[68:71], v[84:87], v[16:19]
    v_mfma_f32_16x16x32_bf16 v[16:19], a[72:75], v[88:91], v[16:19]
    v_mfma_f32_16x16x32_bf16 v[16:19], a[76:79], v[92:95], v[16:19]
    v_mfma_f32_16x16x32_bf16 v[20:23], a[80:83], v[80:83], 0
    v_mfma_f32_16x16x32_bf16 v[20:23], a[84:87], v[84:87], v[20:23]
    v_mfma_f32_16x16x32_bf16 v[20:23], a[88:91], v[88:91], v[20:23]
    v_mfma_f32_16x16x32_bf16 v[20:23], a[92:95], v[92:95], v[20:23]
    v_mfma_f32_16x16x32_bf16 v[24:27], a[96:99], v[80:83], 0
    v_mfma_f32_16x16x32_bf16 v[24:27], a[100:103], v[84:87], v[24:27]
    v_mfma_f32_16x16x32_bf16 v[24:27], a[104:107], v[88:91], v[24:27]
    v_mfma_f32_16x16x32_bf16 v[24:27], a[108:111], v[92:95], v[24:27]
    v_mfma_f32_16x16x32_bf16 v[28:31], a[112:115], v[80:83], 0
    v_mfma_f32_16x16x32_bf16 v[28:31], a[116:119], v[84:87], v[28:31]
    v_mfma_f32_16x16x32_bf16 v[28:31], a[120:123], v[88:91], v[28:31]
    v_mfma_f32_16x16x32_bf16 v[28:31], a[124:127], v[92:95], v[28:31]
    s_nop 7
    v_max3_f32 v33, v33, v16, v17
    v_max3_f32 v33, v33, v18, v19
    v_max3_f32 v33, v33, v20, v21
    v_max3_f32 v33, v33, v22, v23
    v_max3_f32 v33, v33, v24, v25
    v_max3_f32 v33, v33, v26, v27
    v_max3_f32 v33, v33, v28, v29
    v_max3_f32 v33, v33, v30, v31
    v_mfma_f32_16x16x32_bf16 v[16:19], a[64:67], v[96:99], 0
    v_mfma_f32_16x16x32_bf16 v[16:19], a[68:71], v[100:103], v[16:19]
    v_mfma_f32_16x16x32_bf16 v[16:19], a[72:75], v[104:107], v[16:19]
    v_mfma_f32_16x16x32_bf16 v[16:19], a[76:79], v[108:111], v[16:19]
    v_mfma_f32_16x16x32_bf16 v[20:23], a[80:83], v[96:99], 0
    v_mfma_f32_16x16x32_bf16 v[20:23], a[84:87], v[100:103], v[20:23]
    v_mfma_f32_16x16x32_bf16 v[20:23], a[88:91], v[104:107], v[20:23]
    v_mfma_f32_16x16x32_bf16 v[20:23], a[92:95], v[108:111], v[20:23]
    v_mfma_f32_16x16x32_bf16 v[24:27], a[96:99], v[96:99], 0
    v_mfma_f32_16x16x32_bf16 v[24:27], a[100:103], v[100:103], v[24:27]
    v_mfma_f32_16x16x32_bf16 v[24:27], a[104:107], v[104:107], v[24:27]
    v_mfma_f32_16x16x32_bf16 v[24:27], a[108:111], v[108:111], v[24:27]
    v_mfma_f32_16x16x32_bf16 v[28:31], a[112:115], v[96:99], 0
    v_mfma_f32_16x16x32_bf16 v[28:31], a[116:119], v[100:103], v[28:31]
    v_mfma_f32_16x16x32_bf16 v[28:31], a[120:123], v[104:107], v[28:31]
    v_mfma_f32_16x16x32_bf16 v[28:31], a[124:127], v[108:111], v[28:31]
    s_nop 7
    v_max3_f32 v34, v34, v16, v17
    v_max3_f32 v34, v34, v18, v19
    v_max3_f32 v34, v34, v20, v21
    v_max3_f32 v34, v34, v22, v23
    v_max3_f32 v34, v34, v24, v25
    v_max3_f32 v34, v34, v26, v27
    v_max3_f32 v34, v34, v28, v29
    v_max3_f32 v34, v34, v30, v31
    v_mfma_f32_16x16x32_bf16 v[16:19], a[64:67], v[112:115], 0
    v_mfma_f32_16x16x32_bf16 v[16:19], a[68:71], v[116:119], v[16:19]
    v_mfma_f32_16x16x32_bf16 v[16:19], a[72:75], v[120:123], v[16:19]
    v_mfma_f32_16x16x32_bf16 v[16:19], a[76:79], v[124:127], v[16:19]
    v_mfma_f32_16x16x32_bf16 v[20:23], a[80:83], v[112:115], 0
    v_mfma_f32_16x16x32_bf16 v[20:23], a[84:87], v[116:119], v[20:23]
    v_mfma_f32_16x16x32_bf16 v[20:23], a[88:91], v[120:123], v[20:23]
    v_mfma_f32_16x16x32_bf16 v[20:23], a[92:95], v[124:127], v[20:23]
    v_mfma_f32_16x16x32_bf16 v[24:27], a[96:99], v[112:115], 0
    v_mfma_f32_16x16x32_bf16 v[24:27], a[100:103], v[116:119], v[24:27]
    v_mfma_f32_16x16x32_bf16 v[24:27], a[104:107], v[120:123], v[24:27]
    v_mfma_f32_16x16x32_bf16 v[24:27], a[108:111], v[124:127], v[24:27]
    v_mfma_f32_16x16x32_bf16 v[28:31], a[112:115], v[112:115], 0
    v_mfma_f32_16x16x32_bf16 v[28:31], a[116:119], v[116:119], v[28:31]
    v_mfma_f32_16x16x32_bf16 v[28:31], a[120:123], v[120:123], v[28:31]
    v_mfma_f32_16x16x32_bf16 v[28:31], a[124:127], v[124:127], v[28:31]
    s_nop 7
    v_max3_f32 v35, v35, v16, v17
    v_max3_f32 v35, v35, v18, v19
    v_max3_f32 v35, v35, v20, v21
    v_max3_f32 v35, v35, v22, v23
    v_max3_f32 v35, v35, v24, v25
    v_max3_f32 v35, v35, v26, v27
    v_max3_f32 v35, v35, v28, v29
    v_max3_f32 v35, v35, v30, v31
    s_add_u32 s46, s46, 16384
    s_cmp_lt_u32 s46, 524288
    s_cbranch_scc1 L2_fb_loop
    v_mov_b32 v12, v32
    v_mov_b32 v13, v33
    v_mov_b32 v14, v34
    v_mov_b32 v15, v35
    v_permlane16_swap_b32 v12, v32
    v_permlane16_swap_b32 v13, v33
    v_permlane16_swap_b32 v14, v34
    v_permlane16_swap_b32 v15, v35
    v_max_f32 v32, v32, v12
    v_max_f32 v33, v33, v13
    v_max_f32 v34, v34, v14
    v_max_f32 v35, v35, v15
    v_mov_b32 v12, v32
    v_mov_b32 v13, v33
    v_mov_b32 v14, v34
    v_mov_b32 v15, v35
    v_permlane32_swap_b32 v12, v32
    v_permlane32_swap_b32 v13, v33
    v_permlane32_swap_b32 v14, v34
    v_permlane32_swap_b32 v15, v35
    v_max_f32 v32, v32, v12
    v_max_f32 v33, v33, v13
    v_max_f32 v34, v34, v14
    v_max_f32 v35, v35, v15
    v_sub_f32 v48, 0x80000000, v32
    v_sub_f32 v49, 0x80000000, v32
    v_sub_f32 v50, 0x80000000, v32
    v_sub_f32 v51, 0x80000000, v32
    v_sub_f32 v52, 0x80000000, v33
    v_sub_f32 v53, 0x80000000, v33
    v_sub_f32 v54, 0x80000000, v33
    v_sub_f32 v55, 0x80000000, v33
    v_sub_f32 v56, 0x80000000, v34
    v_sub_f32 v57, 0x80000000, v34
    v_sub_f32 v58, 0x80000000, v34
    v_sub_f32 v59, 0x80000000, v34
    v_sub_f32 v60, 0x80000000, v35
    v_sub_f32 v61, 0x80000000, v35
    v_sub_f32 v62, 0x80000000, v35
    v_sub_f32 v63, 0x80000000, v35
    s_add_u32 m0, s44, 67584
    s_mov_b32 s46, 0
    buffer_load_dwordx4 v5, s[16:19], s46 offen offset:0 lds
    s_add_u32 m0, s44, 67616
    s_nop 0
    buffer_load_dwordx4 v5, s[16:19], s46 offen offset:1024 lds
    s_add_u32 m0, s44, 67648
    s_nop 0
    buffer_load_dwordx4 v5, s[16:19], s46 offen offset:2048 lds
    s_add_u32 m0, s44, 67680
    s_nop 0
    buffer_load_dwordx4 v5, s[16:19], s46 offen offset:3072 lds
    s_add_u32 m0, s44, 84480
    s_nop 0
    buffer_load_dwordx4 v5, s[20:23], s46 offen offset:0 lds
    s_add_u32 m0, s44, 84512
    s_nop 0
    buffer_load_dwordx4 v5, s[20:23], s46 offen offset:1024 lds
    s_add_u32 m0, s44, 84544
    s_nop 0
    buffer_load_dwordx4 v5, s[20:23], s46 offen offset:2048 lds
    s_add_u32 m0, s44, 84576
    s_nop 0
    buffer_load_dwordx4 v5, s[20:23], s46 offen offset:3072 lds
    s_add_u32 m0, s44, 101376
    s_mov_b32 s46, 16384
    buffer_load_dwordx4 v5, s[16:19], s46 offen offset:0 lds
    s_add_u32 m0, s44, 101408
    s_nop 0
    buffer_load_dwordx4 v5, s[16:19], s46 offen offset:1024 lds
    s_add_u32 m0, s44, 101440
    s_nop 0
    buffer_load_dwordx4 v5, s[16:19], s46 offen offset:2048 lds
    s_add_u32 m0, s44, 101472
    s_nop 0
    buffer_load_dwordx4 v5, s[16:19], s46 offen offset:3072 lds
    s_add_u32 m0, s44, 118272
    s_nop 0
    buffer_load_dwordx4 v5, s[20:23], s46 offen offset:0 lds
    s_add_u32 m0, s44, 118304
    s_nop 0
    buffer_load_dwordx4 v5, s[20:23], s46 offen offset:1024 lds
    s_add_u32 m0, s44, 118336
    s_nop 0
    buffer_load_dwordx4 v5, s[20:23], s46 offen offset:2048 lds
    s_add_u32 m0, s44, 118368
    s_nop 0
    buffer_load_dwordx4 v5, s[20:23], s46 offen offset:3072 lds
    s_add_u32 m0, s44, 0
    s_mov_b32 s46, 32768
    buffer_load_dwordx4 v5, s[16:19], s46 offen offset:0 lds
    s_add_u32 m0, s44, 32
    s_nop 0
    buffer_load_dwordx4 v5, s[16:19], s46 offen offset:1024 lds
    s_add_u32 m0, s44, 64
    s_nop 0
    buffer_load_dwordx4 v5, s[16:19], s46 offen offset:2048 lds
    s_add_u32 m0, s44, 96
    s_nop 0
    buffer_load_dwordx4 v5, s[16:19], s46 offen offset:3072 lds
    s_add_u32 m0, s44, 16896
    s_nop 0
    buffer_load_dwordx4 v5, s[20:23], s46 offen offset:0 lds
    s_add_u32 m0, s44, 16928
    s_nop 0
    buffer_load_dwordx4 v5, s[20:23], s46 offen offset:1024 lds
    s_add_u32 m0, s44, 16960
    s_nop 0
    buffer_load_dwordx4 v5, s[20:23], s46 offen offset:2048 lds
    s_add_u32 m0, s44, 16992
    s_nop 0
    buffer_load_dwordx4 v5, s[20:23], s46 offen offset:3072 lds
    s_waitcnt vmcnt(0) lgkmcnt(0)
    s_barrier
    ds_read_b128 a[64:67], v1 offset:0
    ds_read_b128 a[68:71], v1 offset:64
    ds_read_b128 a[72:75], v1 offset:128
    ds_read_b128 a[76:79], v1 offset:192
    ds_read_b128 a[80:83], v1 offset:256
    ds_read_b128 a[84:87], v1 offset:320
    ds_read_b128 a[88:91], v1 offset:384
    ds_read_b128 a[92:95], v1 offset:448
    ds_read_b128 a[96:99], v1 offset:512
    ds_read_b128 a[100:103], v1 offset:576
    ds_read_b128 a[104:107], v1 offset:640
    ds_read_b128 a[108:111], v1 offset:704
    ds_read_b128 a[112:115], v1 offset:768
    ds_read_b128 a[116:119], v1 offset:832
    ds_read_b128 a[120:123], v1 offset:896
    ds_read_b128 a[124:127], v1 offset:960
    ds_read_b64_tr_b16 a[128:129], v2 offset:0
    ds_read_b64_tr_b16 a[130:131], v2 offset:256
    ds_read_b64_tr_b16 a[132:133], v2 offset:512
    ds_read_b64_tr_b16 a[134:135], v2 offset:768
    ds_read_b64_tr_b16 a[136:137], v2 offset:32
    ds_read_b64_tr_b16 a[138:139], v2 offset:288
    ds_read_b64_tr_b16 a[140:141], v2 offset:544
    ds_read_b64_tr_b16 a[142:143], v2 offset:800
    ds_read_b64_tr_b16 a[144:145], v2 offset:64
    ds_read_b64_tr_b16 a[146:147], v2 offset:320
    ds_read_b64_tr_b16 a[148:149], v2 offset:576
    ds_read_b64_tr_b16 a[150:151], v2 offset:832
    ds_read_b64_tr_b16 a[152:153], v2 offset:96
    ds_read_b64_tr_b16 a[154:155], v2 offset:352
    ds_read_b64_tr_b16 a[156:157], v2 offset:608
    ds_read_b64_tr_b16 a[158:159], v2 offset:864
    ds_read_b64_tr_b16 a[160:161], v2 offset:128
    ds_read_b64_tr_b16 a[162:163], v2 offset:384
    ds_read_b64_tr_b16 a[164:165], v2 offset:640
    ds_read_b64_tr_b16 a[166:167], v2 offset:896
    ds_read_b64_tr_b16 a[168:169], v2 offset:160
    ds_read_b64_tr_b16 a[170:171], v2 offset:416
    ds_read_b64_tr_b16 a[172:173], v2 offset:672
    ds_read_b64_tr_b16 a[174:175], v2 offset:928
    ds_read_b64_tr_b16 a[176:177], v2 offset:192
    ds_read_b64_tr_b16 a[178:179], v2 offset:448
    ds_read_b64_tr_b16 a[180:181], v2 offset:704
    ds_read_b64_tr_b16 a[182:183], v2 offset:960
    ds_read_b64_tr_b16 a[184:185], v2 offset:224
    ds_read_b64_tr_b16 a[186:187], v2 offset:480
    ds_read_b64_tr_b16 a[188:189], v2 offset:736
    ds_read_b64_tr_b16 a[190:191], v2 offset:992
    s_waitcnt vmcnt(0) lgkmcnt(0)
    s_branch L2_entry

.globl mid_kernel
.p2align 8
.type mid_kernel,@function
mid_kernel:
    s_cmp_ge_u32 s2, 256
    s_cbranch_scc1 L3_end
    s_load_dwordx2 s[4:5], s[0:1], 0
    s_load_dwordx2 s[6:7], s[0:1], 48
    s_load_dwordx2 s[8:9], s[0:1], 96
    s_load_dwordx2 s[10:11], s[0:1], 112
    v_lshlrev_b32 v1, 4, v0
    s_mul_i32 s3, s2, 147456
    s_add_u32 s3, s3, 8388608
    v_lshrrev_b32 v2, 3, v0
    v_and_b32 v3, 7, v0
    v_mul_u32_u24 v4, 1152, v3
    v_lshl_add_u32 v4, v2, 4, v4
    v_lshlrev_b32 v5, 5, v2
    v_lshlrev_b32 v6, 4, v2
    s_mul_i32 s32, s2, 9216
    s_waitcnt lgkmcnt(0)
    s_add_u32 s12, s10, s3
    s_addc_u32 s13, s11, 0
    s_mov_b32 s14, 147456
    s_mov_b32 s15, 0x20000
    s_mov_b32 s16, s4
    s_mov_b32 s17, s5
    s_mov_b32 s18, 2359296
    s_mov_b32 s19, 0x20000
    s_mov_b32 s20, s6
    s_mov_b32 s21, s7
    s_mov_b32 s22, 1152
    s_mov_b32 s23, 0x20000
    s_mov_b32 s24, s8
    s_mov_b32 s25, s9
    s_mov_b32 s26, 2359296
    s_mov_b32 s27, 0x20000
    s_mov_b32 s28, s10
    s_mov_b32 s29, s11
    s_mov_b32 s30, 6553600
    s_mov_b32 s31, 0x20000
    s_mov_b32 s3, 0
    buffer_load_dwordx4 v[64:67], v1, s[12:15], s3 offen
    s_add_u32 s3, s3, 9216
    buffer_load_dwordx4 v[68:71], v1, s[12:15], s3 offen
    s_add_u32 s3, s3, 9216
    buffer_load_dwordx4 v[72:75], v1, s[12:15], s3 offen
    s_add_u32 s3, s3, 9216
    buffer_load_dwordx4 v[76:79], v1, s[12:15], s3 offen
    s_add_u32 s3, s3, 9216
    buffer_load_dwordx4 v[80:83], v1, s[12:15], s3 offen
    s_add_u32 s3, s3, 9216
    buffer_load_dwordx4 v[84:87], v1, s[12:15], s3 offen
    s_add_u32 s3, s3, 9216
    buffer_load_dwordx4 v[88:91], v1, s[12:15], s3 offen
    s_add_u32 s3, s3, 9216
    buffer_load_dwordx4 v[92:95], v1, s[12:15], s3 offen
    s_add_u32 s3, s3, 9216
    buffer_load_dwordx4 v[96:99], v1, s[12:15], s3 offen
    s_add_u32 s3, s3, 9216
    buffer_load_dwordx4 v[100:103], v1, s[12:15], s3 offen
    s_add_u32 s3, s3, 9216
    buffer_load_dwordx4 v[104:107], v1, s[12:15], s3 offen
    s_add_u32 s3, s3, 9216
    buffer_load_dwordx4 v[108:111], v1, s[12:15], s3 offen
    s_add_u32 s3, s3, 9216
    buffer_load_dwordx4 v[112:115], v1, s[12:15], s3 offen
    s_add_u32 s3, s3, 9216
    buffer_load_dwordx4 v[116:119], v1, s[12:15], s3 offen
    s_add_u32 s3, s3, 9216
    buffer_load_dwordx4 v[120:123], v1, s[12:15], s3 offen
    s_add_u32 s3, s3, 9216
    buffer_load_dwordx4 v[124:127], v1, s[12:15], s3 offen
    buffer_load_dwordx4 v[8:11], v4, s[16:19], s32 offen
    s_mov_b32 s3, 8192
    buffer_load_dwordx4 v[24:27], v5, s[28:31], s3 offen offset:0
    buffer_load_dwordx4 v[28:31], v5, s[28:31], s3 offen offset:16
    s_mov_b32 s3, 10496
    buffer_load_dwordx4 v[32:35], v5, s[28:31], s3 offen offset:0
    buffer_load_dwordx4 v[36:39], v5, s[28:31], s3 offen offset:16
    s_mov_b32 s3, 12800
    buffer_load_dwordx4 v[40:43], v5, s[28:31], s3 offen offset:0
    buffer_load_dwordx4 v[44:47], v5, s[28:31], s3 offen offset:16
    s_mov_b32 s3, 15104
    buffer_load_dwordx4 v[48:51], v5, s[28:31], s3 offen offset:0
    buffer_load_dwordx4 v[52:55], v5, s[28:31], s3 offen offset:16
    buffer_load_dwordx4 v[12:15], v6, s[20:23], 0 offen
    v_lshrrev_b32 v7, 6, v0
    v_lshlrev_b32 v3, 6, v3
    v_lshl_add_u32 v7, v7, 2, v3
    s_waitcnt vmcnt(25)
    v_lshlrev_b32 v16, 16, v64
    v_and_b32 v17, 0xffff0000, v64
    v_lshlrev_b32 v18, 16, v65
    v_and_b32 v19, 0xffff0000, v65
    v_lshlrev_b32 v20, 16, v66
    v_and_b32 v21, 0xffff0000, v66
    v_lshlrev_b32 v22, 16, v67
    v_and_b32 v23, 0xffff0000, v67
    s_waitcnt vmcnt(24)
    v_lshlrev_b32 v56, 16, v68
    v_and_b32 v57, 0xffff0000, v68
    v_add_f32 v16, v16, v56
    v_add_f32 v17, v17, v57
    v_lshlrev_b32 v56, 16, v69
    v_and_b32 v57, 0xffff0000, v69
    v_add_f32 v18, v18, v56
    v_add_f32 v19, v19, v57
    v_lshlrev_b32 v56, 16, v70
    v_and_b32 v57, 0xffff0000, v70
    v_add_f32 v20, v20, v56
    v_add_f32 v21, v21, v57
    v_lshlrev_b32 v56, 16, v71
    v_and_b32 v57, 0xffff0000, v71
    v_add_f32 v22, v22, v56
    v_add_f32 v23, v23, v57
    s_waitcnt vmcnt(23)
    v_lshlrev_b32 v56, 16, v72
    v_and_b32 v57, 0xffff0000, v72
    v_add_f32 v16, v16, v56
    v_add_f32 v17, v17, v57
    v_lshlrev_b32 v56, 16, v73
    v_and_b32 v57, 0xffff0000, v73
    v_add_f32 v18, v18, v56
    v_add_f32 v19, v19, v57
    v_lshlrev_b32 v56, 16, v74
    v_and_b32 v57, 0xffff0000, v74
    v_add_f32 v20, v20, v56
    v_add_f32 v21, v21, v57
    v_lshlrev_b32 v56, 16, v75
    v_and_b32 v57, 0xffff0000, v75
    v_add_f32 v22, v22, v56
    v_add_f32 v23, v23, v57
    s_waitcnt vmcnt(22)
    v_lshlrev_b32 v56, 16, v76
    v_and_b32 v57, 0xffff0000, v76
    v_add_f32 v16, v16, v56
    v_add_f32 v17, v17, v57
    v_lshlrev_b32 v56, 16, v77
    v_and_b32 v57, 0xffff0000, v77
    v_add_f32 v18, v18, v56
    v_add_f32 v19, v19, v57
    v_lshlrev_b32 v56, 16, v78
    v_and_b32 v57, 0xffff0000, v78
    v_add_f32 v20, v20, v56
    v_add_f32 v21, v21, v57
    v_lshlrev_b32 v56, 16, v79
    v_and_b32 v57, 0xffff0000, v79
    v_add_f32 v22, v22, v56
    v_add_f32 v23, v23, v57
    s_waitcnt vmcnt(21)
    v_lshlrev_b32 v56, 16, v80
    v_and_b32 v57, 0xffff0000, v80
    v_add_f32 v16, v16, v56
    v_add_f32 v17, v17, v57
    v_lshlrev_b32 v56, 16, v81
    v_and_b32 v57, 0xffff0000, v81
    v_add_f32 v18, v18, v56
    v_add_f32 v19, v19, v57
    v_lshlrev_b32 v56, 16, v82
    v_and_b32 v57, 0xffff0000, v82
    v_add_f32 v20, v20, v56
    v_add_f32 v21, v21, v57
    v_lshlrev_b32 v56, 16, v83
    v_and_b32 v57, 0xffff0000, v83
    v_add_f32 v22, v22, v56
    v_add_f32 v23, v23, v57
    s_waitcnt vmcnt(20)
    v_lshlrev_b32 v56, 16, v84
    v_and_b32 v57, 0xffff0000, v84
    v_add_f32 v16, v16, v56
    v_add_f32 v17, v17, v57
    v_lshlrev_b32 v56, 16, v85
    v_and_b32 v57, 0xffff0000, v85
    v_add_f32 v18, v18, v56
    v_add_f32 v19, v19, v57
    v_lshlrev_b32 v56, 16, v86
    v_and_b32 v57, 0xffff0000, v86
    v_add_f32 v20, v20, v56
    v_add_f32 v21, v21, v57
    v_lshlrev_b32 v56, 16, v87
    v_and_b32 v57, 0xffff0000, v87
    v_add_f32 v22, v22, v56
    v_add_f32 v23, v23, v57
    s_waitcnt vmcnt(19)
    v_lshlrev_b32 v56, 16, v88
    v_and_b32 v57, 0xffff0000, v88
    v_add_f32 v16, v16, v56
    v_add_f32 v17, v17, v57
    v_lshlrev_b32 v56, 16, v89
    v_and_b32 v57, 0xffff0000, v89
    v_add_f32 v18, v18, v56
    v_add_f32 v19, v19, v57
    v_lshlrev_b32 v56, 16, v90
    v_and_b32 v57, 0xffff0000, v90
    v_add_f32 v20, v20, v56
    v_add_f32 v21, v21, v57
    v_lshlrev_b32 v56, 16, v91
    v_and_b32 v57, 0xffff0000, v91
    v_add_f32 v22, v22, v56
    v_add_f32 v23, v23, v57
    s_waitcnt vmcnt(18)
    v_lshlrev_b32 v56, 16, v92
    v_and_b32 v57, 0xffff0000, v92
    v_add_f32 v16, v16, v56
    v_add_f32 v17, v17, v57
    v_lshlrev_b32 v56, 16, v93
    v_and_b32 v57, 0xffff0000, v93
    v_add_f32 v18, v18, v56
    v_add_f32 v19, v19, v57
    v_lshlrev_b32 v56, 16, v94
    v_and_b32 v57, 0xffff0000, v94
    v_add_f32 v20, v20, v56
    v_add_f32 v21, v21, v57
    v_lshlrev_b32 v56, 16, v95
    v_and_b32 v57, 0xffff0000, v95
    v_add_f32 v22, v22, v56
    v_add_f32 v23, v23, v57
    s_waitcnt vmcnt(17)
    v_lshlrev_b32 v56, 16, v96
    v_and_b32 v57, 0xffff0000, v96
    v_add_f32 v16, v16, v56
    v_add_f32 v17, v17, v57
    v_lshlrev_b32 v56, 16, v97
    v_and_b32 v57, 0xffff0000, v97
    v_add_f32 v18, v18, v56
    v_add_f32 v19, v19, v57
    v_lshlrev_b32 v56, 16, v98
    v_and_b32 v57, 0xffff0000, v98
    v_add_f32 v20, v20, v56
    v_add_f32 v21, v21, v57
    v_lshlrev_b32 v56, 16, v99
    v_and_b32 v57, 0xffff0000, v99
    v_add_f32 v22, v22, v56
    v_add_f32 v23, v23, v57
    s_waitcnt vmcnt(16)
    v_lshlrev_b32 v56, 16, v100
    v_and_b32 v57, 0xffff0000, v100
    v_add_f32 v16, v16, v56
    v_add_f32 v17, v17, v57
    v_lshlrev_b32 v56, 16, v101
    v_and_b32 v57, 0xffff0000, v101
    v_add_f32 v18, v18, v56
    v_add_f32 v19, v19, v57
    v_lshlrev_b32 v56, 16, v102
    v_and_b32 v57, 0xffff0000, v102
    v_add_f32 v20, v20, v56
    v_add_f32 v21, v21, v57
    v_lshlrev_b32 v56, 16, v103
    v_and_b32 v57, 0xffff0000, v103
    v_add_f32 v22, v22, v56
    v_add_f32 v23, v23, v57
    s_waitcnt vmcnt(15)
    v_lshlrev_b32 v56, 16, v104
    v_and_b32 v57, 0xffff0000, v104
    v_add_f32 v16, v16, v56
    v_add_f32 v17, v17, v57
    v_lshlrev_b32 v56, 16, v105
    v_and_b32 v57, 0xffff0000, v105
    v_add_f32 v18, v18, v56
    v_add_f32 v19, v19, v57
    v_lshlrev_b32 v56, 16, v106
    v_and_b32 v57, 0xffff0000, v106
    v_add_f32 v20, v20, v56
    v_add_f32 v21, v21, v57
    v_lshlrev_b32 v56, 16, v107
    v_and_b32 v57, 0xffff0000, v107
    v_add_f32 v22, v22, v56
    v_add_f32 v23, v23, v57
    s_waitcnt vmcnt(14)
    v_lshlrev_b32 v56, 16, v108
    v_and_b32 v57, 0xffff0000, v108
    v_add_f32 v16, v16, v56
    v_add_f32 v17, v17, v57
    v_lshlrev_b32 v56, 16, v109
    v_and_b32 v57, 0xffff0000, v109
    v_add_f32 v18, v18, v56
    v_add_f32 v19, v19, v57
    v_lshlrev_b32 v56, 16, v110
    v_and_b32 v57, 0xffff0000, v110
    v_add_f32 v20, v20, v56
    v_add_f32 v21, v21, v57
    v_lshlrev_b32 v56, 16, v111
    v_and_b32 v57, 0xffff0000, v111
    v_add_f32 v22, v22, v56
    v_add_f32 v23, v23, v57
    s_waitcnt vmcnt(13)
    v_lshlrev_b32 v56, 16, v112
    v_and_b32 v57, 0xffff0000, v112
    v_add_f32 v16, v16, v56
    v_add_f32 v17, v17, v57
    v_lshlrev_b32 v56, 16, v113
    v_and_b32 v57, 0xffff0000, v113
    v_add_f32 v18, v18, v56
    v_add_f32 v19, v19, v57
    v_lshlrev_b32 v56, 16, v114
    v_and_b32 v57, 0xffff0000, v114
    v_add_f32 v20, v20, v56
    v_add_f32 v21, v21, v57
    v_lshlrev_b32 v56, 16, v115
    v_and_b32 v57, 0xffff0000, v115
    v_add_f32 v22, v22, v56
    v_add_f32 v23, v23, v57
    s_waitcnt vmcnt(12)
    v_lshlrev_b32 v56, 16, v116
    v_and_b32 v57, 0xffff0000, v116
    v_add_f32 v16, v16, v56
    v_add_f32 v17, v17, v57
    v_lshlrev_b32 v56, 16, v117
    v_and_b32 v57, 0xffff0000, v117
    v_add_f32 v18, v18, v56
    v_add_f32 v19, v19, v57
    v_lshlrev_b32 v56, 16, v118
    v_and_b32 v57, 0xffff0000, v118
    v_add_f32 v20, v20, v56
    v_add_f32 v21, v21, v57
    v_lshlrev_b32 v56, 16, v119
    v_and_b32 v57, 0xffff0000, v119
    v_add_f32 v22, v22, v56
    v_add_f32 v23, v23, v57
    s_waitcnt vmcnt(11)
    v_lshlrev_b32 v56, 16, v120
    v_and_b32 v57, 0xffff0000, v120
    v_add_f32 v16, v16, v56
    v_add_f32 v17, v17, v57
    v_lshlrev_b32 v56, 16, v121
    v_and_b32 v57, 0xffff0000, v121
    v_add_f32 v18, v18, v56
    v_add_f32 v19, v19, v57
    v_lshlrev_b32 v56, 16, v122
    v_and_b32 v57, 0xffff0000, v122
    v_add_f32 v20, v20, v56
    v_add_f32 v21, v21, v57
    v_lshlrev_b32 v56, 16, v123
    v_and_b32 v57, 0xffff0000, v123
    v_add_f32 v22, v22, v56
    v_add_f32 v23, v23, v57
    s_waitcnt vmcnt(10)
    v_lshlrev_b32 v56, 16, v124
    v_and_b32 v57, 0xffff0000, v124
    v_add_f32 v16, v16, v56
    v_add_f32 v17, v17, v57
    v_lshlrev_b32 v56, 16, v125
    v_and_b32 v57, 0xffff0000, v125
    v_add_f32 v18, v18, v56
    v_add_f32 v19, v19, v57
    v_lshlrev_b32 v56, 16, v126
    v_and_b32 v57, 0xffff0000, v126
    v_add_f32 v20, v20, v56
    v_add_f32 v21, v21, v57
    v_lshlrev_b32 v56, 16, v127
    v_and_b32 v57, 0xffff0000, v127
    v_add_f32 v22, v22, v56
    v_add_f32 v23, v23, v57
    s_waitcnt vmcnt(7)
    v_lshlrev_b32 v56, 16, v8
    v_and_b32 v57, 0xffff0000, v8
    v_fma_f32 v16, v16, v24, v56
    v_fma_f32 v17, v17, v25, v57
    v_lshlrev_b32 v56, 16, v9
    v_and_b32 v57, 0xffff0000, v9
    v_fma_f32 v18, v18, v26, v56
    v_fma_f32 v19, v19, v27, v57
    v_lshlrev_b32 v56, 16, v10
    v_and_b32 v57, 0xffff0000, v10
    v_fma_f32 v20, v20, v28, v56
    v_fma_f32 v21, v21, v29, v57
    v_lshlrev_b32 v56, 16, v11
    v_and_b32 v57, 0xffff0000, v11
    v_fma_f32 v22, v22, v30, v56
    v_fma_f32 v23, v23, v31, v57
    v_add_f32 v56, v16, v17
    v_add_f32 v58, v18, v19
    v_add_f32 v59, v20, v21
    v_add_f32 v60, v22, v23
    v_add_f32 v56, v56, v58
    v_add_f32 v59, v59, v60
    v_add_f32 v56, v56, v59
    s_nop 1
    v_add_f32_dpp v56, v56, v56 row_ror:8 row_mask:0xf bank_mask:0xf
    v_mov_b32 v57, v56
    s_nop 1
    v_permlane16_swap_b32 v57, v56
    v_add_f32 v56, v56, v57
    v_mov_b32 v57, v56
    s_nop 1
    v_permlane32_swap_b32 v57, v56
    v_add_f32 v56, v56, v57
    ds_write_b32 v7, v56 offset:0
    s_waitcnt lgkmcnt(0)
    s_barrier
    ds_read_b128 v[64:67], v3 offset:0
    ds_read_b128 v[68:71], v3 offset:16
    ds_read_b32 v56, v3 offset:32
    s_waitcnt lgkmcnt(0)
    v_add_f32 v64, v64, v68
    v_add_f32 v65, v65, v69
    v_add_f32 v66, v66, v70
    v_add_f32 v67, v67, v71
    v_add_f32 v64, v64, v65
    v_add_f32 v66, v66, v67
    v_add_f32 v56, v56, v64
    v_add_f32 v56, v56, v66
    v_mul_f32 v56, 0x3ae38e39, v56
    v_sub_f32 v72, v16, v56
    v_sub_f32 v73, v17, v56
    v_sub_f32 v74, v18, v56
    v_sub_f32 v75, v19, v56
    v_sub_f32 v76, v20, v56
    v_sub_f32 v77, v21, v56
    v_sub_f32 v78, v22, v56
    v_sub_f32 v79, v23, v56
    v_mul_f32 v56, v72, v72
    v_mul_f32 v58, v73, v73
    v_fmac_f32 v56, v74, v74
    v_fmac_f32 v58, v75, v75
    v_fmac_f32 v56, v76, v76
    v_fmac_f32 v58, v77, v77
    v_fmac_f32 v56, v78, v78
    v_fmac_f32 v58, v79, v79
    v_add_f32 v56, v56, v58
    s_nop 1
    v_add_f32_dpp v56, v56, v56 row_ror:8 row_mask:0xf bank_mask:0xf
    v_mov_b32 v57, v56
    s_nop 1
    v_permlane16_swap_b32 v57, v56
    v_add_f32 v56, v56, v57
    v_mov_b32 v57, v56
    s_nop 1
    v_permlane32_swap_b32 v57, v56
    v_add_f32 v56, v56, v57
    ds_write_b32 v7, v56 offset:512
    s_waitcnt lgkmcnt(0)
    s_barrier
    ds_read_b128 v[64:67], v3 offset:512
    ds_read_b128 v[68:71], v3 offset:528
    ds_read_b32 v56, v3 offset:544
    s_waitcnt lgkmcnt(0)
    v_add_f32 v64, v64, v68
    v_add_f32 v65, v65, v69
    v_add_f32 v66, v66, v70
    v_add_f32 v67, v67, v71
    v_add_f32 v64, v64, v65
    v_add_f32 v66, v66, v67
    v_add_f32 v56, v56, v64
    v_add_f32 v56, v56, v66
    v_mov_b32 v57, 0x3727c5ac
    v_fmac_f32 v57, 0x3ae38e39, v56
    v_rsq_f32 v57, v57
    s_waitcnt vmcnt(0)
    v_mul_f32 v72, v72, v57
    v_mul_f32 v73, v73, v57
    v_mul_f32 v74, v74, v57
    v_mul_f32 v75, v75, v57
    v_mul_f32 v76, v76, v57
    v_mul_f32 v77, v77, v57
    v_mul_f32 v78, v78, v57
    v_mul_f32 v79, v79, v57
    v_fma_f32 v72, v72, v40, v32
    v_fma_f32 v73, v73, v41, v33
    v_fma_f32 v74, v74, v42, v34
    v_fma_f32 v75, v75, v43, v35
    v_fma_f32 v76, v76, v44, v36
    v_fma_f32 v77, v77, v45, v37
    v_fma_f32 v78, v78, v46, v38
    v_fma_f32 v79, v79, v47, v39
    v_fmac_f32 v16, v72, v48
    v_fmac_f32 v17, v73, v49
    v_fmac_f32 v18, v74, v50
    v_fmac_f32 v19, v75, v51
    v_fmac_f32 v20, v76, v52
    v_fmac_f32 v21, v77, v53
    v_fmac_f32 v22, v78, v54
    v_fmac_f32 v23, v79, v55
    v_cvt_pk_bf16_f32 v8, v16, v17
    v_cvt_pk_bf16_f32 v9, v18, v19
    v_cvt_pk_bf16_f32 v10, v20, v21
    v_cvt_pk_bf16_f32 v11, v22, v23
    v_cvt_pk_bf16_f32 v80, v72, v73
    v_cvt_pk_bf16_f32 v81, v74, v75
    v_cvt_pk_bf16_f32 v82, v76, v77
    v_cvt_pk_bf16_f32 v83, v78, v79
    buffer_store_dwordx4 v[8:11], v4, s[24:27], s32 offen
    s_add_u32 s33, s32, 4194304
    buffer_store_dwordx4 v[80:83], v4, s[28:31], s33 offen
    v_lshlrev_b32 v58, 16, v12
    v_and_b32 v59, 0xffff0000, v12
    v_mul_f32 v56, v58, v72
    v_mul_f32 v60, v59, v73
    v_lshlrev_b32 v58, 16, v13
    v_and_b32 v59, 0xffff0000, v13
    v_fmac_f32 v56, v58, v74
    v_fmac_f32 v60, v59, v75
    v_lshlrev_b32 v58, 16, v14
    v_and_b32 v59, 0xffff0000, v14
    v_fmac_f32 v56, v58, v76
    v_fmac_f32 v60, v59, v77
    v_lshlrev_b32 v58, 16, v15
    v_and_b32 v59, 0xffff0000, v15
    v_fmac_f32 v56, v58, v78
    v_fmac_f32 v60, v59, v79
    v_add_f32 v56, v56, v60
    s_nop 1
    v_add_f32_dpp v56, v56, v56 row_ror:8 row_mask:0xf bank_mask:0xf
    v_mov_b32 v57, v56
    s_nop 1
    v_permlane16_swap_b32 v57, v56
    v_add_f32 v56, v56, v57
    v_mov_b32 v57, v56
    s_nop 1
    v_permlane32_swap_b32 v57, v56
    v_add_f32 v56, v56, v57
    ds_write_b32 v7, v56 offset:1024
    s_waitcnt lgkmcnt(0)
    s_barrier
    ds_read_b128 v[64:67], v3 offset:1024
    ds_read_b128 v[68:71], v3 offset:1040
    ds_read_b32 v56, v3 offset:1056
    s_waitcnt lgkmcnt(0)
    v_add_f32 v64, v64, v68
    v_add_f32 v65, v65, v69
    v_add_f32 v66, v66, v70
    v_add_f32 v67, v67, v71
    v_add_f32 v64, v64, v65
    v_add_f32 v66, v66, v67
    v_add_f32 v56, v56, v64
    v_add_f32 v56, v56, v66
    s_lshl_b32 s3, s2, 3
    v_add_u32 v58, s3, v0
    v_sub_u32 v59, 2047, v58
    v_lshlrev_b32 v58, 2, v58
    v_ashrrev_i32 v60, 31, v56
    v_or_b32 v60, 0x80000000, v60
    v_xor_b32 v60, v60, v56
    v_and_b32 v60, 0xfffff800, v60
    v_or_b32 v60, v60, v59
    v_cmp_gt_u32 vcc, 8, v0
    s_nop 0
    s_and_saveexec_b64 s[34:35], vcc
    s_cbranch_execz L3_end
    s_mov_b32 s3, 32768
    buffer_store_dword v56, v58, s[28:31], s3 offen
    s_mov_b32 s3, 40960
    buffer_store_dword v60, v58, s[28:31], s3 offen
L3_end:
    s_endpgm

.globl ffn_kernel
.p2align 8
.type ffn_kernel,@function
ffn_kernel:
    s_cmp_ge_u32 s2, 144
    s_cbranch_scc1 L4_end
    s_load_dwordx4 s[4:7], s[0:1], 56
    s_load_dwordx2 s[8:9], s[0:1], 72
    s_load_dwordx2 s[10:11], s[0:1], 112
    v_lshrrev_b32 v12, 6, v0
    v_and_b32 v0, 63, v0
    v_readfirstlane_b32 s33, v12
    v_lshlrev_b32 v1, 4, v0
    v_lshrrev_b32 v2, 2, v0
    v_mul_u32_u24 v2, 9216, v2
    v_and_b32 v3, 3, v0
    v_lshl_add_u32 v2, v3, 4, v2
    s_waitcnt lgkmcnt(0)
    s_mov_b32 s12, s4
    s_mov_b32 s13, s5
    s_mov_b32 s14, 5308416
    s_mov_b32 s15, 0x20000
    s_mov_b32 s16, s6
    s_mov_b32 s17, s7
    s_mov_b32 s18, 5308416
    s_mov_b32 s19, 0x20000
    s_mov_b32 s20, s8
    s_mov_b32 s21, s9
    s_mov_b32 s22, 5308416
    s_mov_b32 s23, 0x20000
    s_mov_b32 s24, s10
    s_mov_b32 s25, s11
    s_mov_b32 s26, 6553600
    s_mov_b32 s27, 0x20000
    s_mov_b32 s3, 40960
    buffer_load_dwordx4 v[16:19], v1, s[24:27], s3 offen offset:0
    buffer_load_dwordx4 v[20:23], v1, s[24:27], s3 offen offset:1024
    buffer_load_dwordx4 v[24:27], v1, s[24:27], s3 offen offset:2048
    buffer_load_dwordx4 v[28:31], v1, s[24:27], s3 offen offset:3072
    s_add_u32 s3, s3, 4096
    buffer_load_dwordx4 v[32:35], v1, s[24:27], s3 offen offset:0
    buffer_load_dwordx4 v[36:39], v1, s[24:27], s3 offen offset:1024
    buffer_load_dwordx4 v[40:43], v1, s[24:27], s3 offen offset:2048
    buffer_load_dwordx4 v[44:47], v1, s[24:27], s3 offen offset:3072
    s_mul_i32 s34, s33, 9216
    s_mul_i32 s35, s33, 1327104
    s_lshl_b32 s3, s2, 6
    s_add_u32 s35, s35, s3
    s_mul_i32 s36, s2, 36864
    s_add_u32 s36, s36, s34
    s_add_u32 m0, s34, 0
    s_nop 0
    buffer_load_dwordx4 v2, s[12:15], s35 offen lds
    s_add_u32 m0, s34, 36864
    s_nop 0
    buffer_load_dwordx4 v2, s[16:19], s35 offen lds
    s_add_u32 s35, s35, 147456
    s_add_u32 m0, s34, 1024
    s_nop 0
    buffer_load_dwordx4 v2, s[12:15], s35 offen lds
    s_add_u32 m0, s34, 37888
    s_nop 0
    buffer_load_dwordx4 v2, s[16:19], s35 offen lds
    s_add_u32 s35, s35, 147456
    s_add_u32 m0, s34, 2048
    s_nop 0
    buffer_load_dwordx4 v2, s[12:15], s35 offen lds
    s_add_u32 m0, s34, 38912
    s_nop 0
    buffer_load_dwordx4 v2, s[16:19], s35 offen lds
    s_add_u32 s35, s35, 147456
    s_add_u32 m0, s34, 3072
    s_nop 0
    buffer_load_dwordx4 v2, s[12:15], s35 offen lds
    s_add_u32 m0, s34, 39936
    s_nop 0
    buffer_load_dwordx4 v2, s[16:19], s35 offen lds
    s_add_u32 s35, s35, 147456
    s_add_u32 m0, s34, 4096
    s_nop 0
    buffer_load_dwordx4 v2, s[12:15], s35 offen lds
    s_add_u32 m0, s34, 40960
    s_nop 0
    buffer_load_dwordx4 v2, s[16:19], s35 offen lds
    s_add_u32 s35, s35, 147456
    s_add_u32 m0, s34, 5120
    s_nop 0
    buffer_load_dwordx4 v2, s[12:15], s35 offen lds
    s_add_u32 m0, s34, 41984
    s_nop 0
    buffer_load_dwordx4 v2, s[16:19], s35 offen lds
    s_add_u32 s35, s35, 147456
    s_add_u32 m0, s34, 6144
    s_nop 0
    buffer_load_dwordx4 v2, s[12:15], s35 offen lds
    s_add_u32 m0, s34, 43008
    s_nop 0
    buffer_load_dwordx4 v2, s[16:19], s35 offen lds
    s_add_u32 s35, s35, 147456
    s_add_u32 m0, s34, 7168
    s_nop 0
    buffer_load_dwordx4 v2, s[12:15], s35 offen lds
    s_add_u32 m0, s34, 44032
    s_nop 0
    buffer_load_dwordx4 v2, s[16:19], s35 offen lds
    s_add_u32 s35, s35, 147456
    s_add_u32 m0, s34, 8192
    s_nop 0
    buffer_load_dwordx4 v2, s[12:15], s35 offen lds
    s_add_u32 m0, s34, 45056
    s_nop 0
    buffer_load_dwordx4 v2, s[16:19], s35 offen lds
    s_add_u32 s35, s35, 147456
    s_add_u32 m0, s34, 73728
    s_nop 0
    buffer_load_dwordx4 v1, s[20:23], s36 offen lds
    s_add_u32 s36, s36, 1024
    s_add_u32 m0, s34, 74752
    s_nop 0
    buffer_load_dwordx4 v1, s[20:23], s36 offen lds
    s_add_u32 s36, s36, 1024
    s_add_u32 m0, s34, 75776
    s_nop 0
    buffer_load_dwordx4 v1, s[20:23], s36 offen lds
    s_add_u32 s36, s36, 1024
    s_add_u32 m0, s34, 76800
    s_nop 0
    buffer_load_dwordx4 v1, s[20:23], s36 offen lds
    s_add_u32 s36, s36, 1024
    s_add_u32 m0, s34, 77824
    s_nop 0
    buffer_load_dwordx4 v1, s[20:23], s36 offen lds
    s_add_u32 s36, s36, 1024
    s_add_u32 m0, s34, 78848
    s_nop 0
    buffer_load_dwordx4 v1, s[20:23], s36 offen lds
    s_add_u32 s36, s36, 1024
    s_add_u32 m0, s34, 79872
    s_nop 0
    buffer_load_dwordx4 v1, s[20:23], s36 offen lds
    s_add_u32 s36, s36, 1024
    s_add_u32 m0, s34, 80896
    s_nop 0
    buffer_load_dwordx4 v1, s[20:23], s36 offen lds
    s_add_u32 s36, s36, 1024
    s_add_u32 m0, s34, 81920
    s_nop 0
    buffer_load_dwordx4 v1, s[20:23], s36 offen lds
    s_add_u32 s36, s36, 1024
    v_mov_b32 v4, 0
    v_mov_b32 v5, 0
    s_waitcnt vmcnt(34)
    v_med3_u32 v5, v4, v5, v16
    v_max_u32 v4, v4, v16
    v_med3_u32 v5, v4, v5, v17
    v_max_u32 v4, v4, v17
    v_med3_u32 v5, v4, v5, v18
    v_max_u32 v4, v4, v18
    v_med3_u32 v5, v4, v5, v19
    v_max_u32 v4, v4, v19
    s_waitcnt vmcnt(33)
    v_med3_u32 v5, v4, v5, v20
    v_max_u32 v4, v4, v20
    v_med3_u32 v5, v4, v5, v21
    v_max_u32 v4, v4, v21
    v_med3_u32 v5, v4, v5, v22
    v_max_u32 v4, v4, v22
    v_med3_u32 v5, v4, v5, v23
    v_max_u32 v4, v4, v23
    s_waitcnt vmcnt(32)
    v_med3_u32 v5, v4, v5, v24
    v_max_u32 v4, v4, v24
    v_med3_u32 v5, v4, v5, v25
    v_max_u32 v4, v4, v25
    v_med3_u32 v5, v4, v5, v26
    v_max_u32 v4, v4, v26
    v_med3_u32 v5, v4, v5, v27
    v_max_u32 v4, v4, v27
    s_waitcnt vmcnt(31)
    v_med3_u32 v5, v4, v5, v28
    v_max_u32 v4, v4, v28
    v_med3_u32 v5, v4, v5, v29
    v_max_u32 v4, v4, v29
    v_med3_u32 v5, v4, v5, v30
    v_max_u32 v4, v4, v30
    v_med3_u32 v5, v4, v5, v31
    v_max_u32 v4, v4, v31
    s_waitcnt vmcnt(30)
    v_med3_u32 v5, v4, v5, v32
    v_max_u32 v4, v4, v32
    v_med3_u32 v5, v4, v5, v33
    v_max_u32 v4, v4, v33
    v_med3_u32 v5, v4, v5, v34
    v_max_u32 v4, v4, v34
    v_med3_u32 v5, v4, v5, v35
    v_max_u32 v4, v4, v35
    s_waitcnt vmcnt(29)
    v_med3_u32 v5, v4, v5, v36
    v_max_u32 v4, v4, v36
    v_med3_u32 v5, v4, v5, v37
    v_max_u32 v4, v4, v37
    v_med3_u32 v5, v4, v5, v38
    v_max_u32 v4, v4, v38
    v_med3_u32 v5, v4, v5, v39
    v_max_u32 v4, v4, v39
    s_waitcnt vmcnt(28)
    v_med3_u32 v5, v4, v5, v40
    v_max_u32 v4, v4, v40
    v_med3_u32 v5, v4, v5, v41
    v_max_u32 v4, v4, v41
    v_med3_u32 v5, v4, v5, v42
    v_max_u32 v4, v4, v42
    v_med3_u32 v5, v4, v5, v43
    v_max_u32 v4, v4, v43
    s_waitcnt vmcnt(27)
    v_med3_u32 v5, v4, v5, v44
    v_max_u32 v4, v4, v44
    v_med3_u32 v5, v4, v5, v45
    v_max_u32 v4, v4, v45
    v_med3_u32 v5, v4, v5, v46
    v_max_u32 v4, v4, v46
    v_med3_u32 v5, v4, v5, v47
    v_max_u32 v4, v4, v47
    s_nop 1
    v_mov_b32_dpp v6, v4 row_ror:1 row_mask:0xf bank_mask:0xf
    v_mov_b32_dpp v7, v5 row_ror:1 row_mask:0xf bank_mask:0xf
    v_max_u32 v5, v5, v7
    v_med3_u32 v5, v4, v6, v5
    v_max_u32 v4, v4, v6
    s_nop 1
    v_mov_b32_dpp v6, v4 row_ror:2 row_mask:0xf bank_mask:0xf
    v_mov_b32_dpp v7, v5 row_ror:2 row_mask:0xf bank_mask:0xf
    v_max_u32 v5, v5, v7
    v_med3_u32 v5, v4, v6, v5
    v_max_u32 v4, v4, v6
    s_nop 1
    v_mov_b32_dpp v6, v4 row_ror:4 row_mask:0xf bank_mask:0xf
    v_mov_b32_dpp v7, v5 row_ror:4 row_mask:0xf bank_mask:0xf
    v_max_u32 v5, v5, v7
    v_med3_u32 v5, v4, v6, v5
    v_max_u32 v4, v4, v6
    s_nop 1
    v_mov_b32_dpp v6, v4 row_ror:8 row_mask:0xf bank_mask:0xf
    v_mov_b32_dpp v7, v5 row_ror:8 row_mask:0xf bank_mask:0xf
    v_max_u32 v5, v5, v7
    v_med3_u32 v5, v4, v6, v5
    v_max_u32 v4, v4, v6
    v_mov_b32 v6, v4
    v_mov_b32 v7, v5
    s_nop 0
    v_permlane16_swap_b32 v6, v4
    v_permlane16_swap_b32 v7, v5
    v_max_u32 v5, v5, v7
    v_med3_u32 v5, v4, v6, v5
    v_max_u32 v4, v4, v6
    v_mov_b32 v6, v4
    v_mov_b32 v7, v5
    s_nop 0
    v_permlane32_swap_b32 v6, v4
    v_permlane32_swap_b32 v7, v5
    v_max_u32 v5, v5, v7
    v_med3_u32 v5, v4, v6, v5
    v_max_u32 v4, v4, v6
    v_and_b32 v6, 1, v0
    v_cmp_eq_u32 vcc, 0, v6
    s_nop 1
    v_cndmask_b32 v4, v5, v4, vcc
    v_and_b32 v4, 0x7ff, v4
    v_sub_u32 v4, 2047, v4
    v_lshrrev_b32 v7, 4, v0
    v_mul_u32_u24 v5, 1152, v4
    v_lshl_add_u32 v5, v7, 4, v5
    s_mov_b32 s3, 4194304
    buffer_load_dwordx4 v[16:19], v5, s[24:27], s3 offen offset:0
    buffer_load_dwordx4 v[20:23], v5, s[24:27], s3 offen offset:64
    buffer_load_dwordx4 v[24:27], v5, s[24:27], s3 offen offset:128
    buffer_load_dwordx4 v[28:31], v5, s[24:27], s3 offen offset:192
    buffer_load_dwordx4 v[32:35], v5, s[24:27], s3 offen offset:256
    buffer_load_dwordx4 v[36:39], v5, s[24:27], s3 offen offset:320
    buffer_load_dwordx4 v[40:43], v5, s[24:27], s3 offen offset:384
    buffer_load_dwordx4 v[44:47], v5, s[24:27], s3 offen offset:448
    buffer_load_dwordx4 v[48:51], v5, s[24:27], s3 offen offset:512
    buffer_load_dwordx4 v[52:55], v5, s[24:27], s3 offen offset:576
    buffer_load_dwordx4 v[56:59], v5, s[24:27], s3 offen offset:640
    buffer_load_dwordx4 v[60:63], v5, s[24:27], s3 offen offset:704
    buffer_load_dwordx4 v[64:67], v5, s[24:27], s3 offen offset:768
    buffer_load_dwordx4 v[68:71], v5, s[24:27], s3 offen offset:832
    buffer_load_dwordx4 v[72:75], v5, s[24:27], s3 offen offset:896
    buffer_load_dwordx4 v[76:79], v5, s[24:27], s3 offen offset:960
    buffer_load_dwordx4 v[80:83], v5, s[24:27], s3 offen offset:1024
    buffer_load_dwordx4 v[84:87], v5, s[24:27], s3 offen offset:1088
    s_or_b32 s37, s2, s33
    s_cmp_eq_u32 s37, 0
    s_cselect_b32 s37, 2, 0
    v_cmp_gt_u32 vcc, s37, v0
    v_lshlrev_b32 v8, 2, v0
    v_add_u32 v8, 49152, v8
    v_cndmask_b32 v8, -1, v8, vcc
    buffer_store_dword v4, v8, s[24:27], 0 offen
    v_bfe_u32 v8, v0, 2, 2
    v_lshl_add_u32 v8, v7, 3, v8
    v_lshlrev_b32 v9, 6, v8
    v_lshl_add_u32 v9, v3, 3, v9
    s_lshr_b32 s37, s33, 1
    s_mul_i32 s37, s37, 36864
    s_and_b32 s38, s33, 1
    s_lshl_b32 s38, s38, 5
    s_add_u32 s37, s37, s38
    v_add_u32 v9, s37, v9
    v_mul_u32_u24 v10, 1152, v8
    v_lshl_add_u32 v10, v3, 3, v10
    s_mul_i32 s37, s33, 288
    s_add_u32 s37, s37, 73728
    v_add_u32 v10, s37, v10
    s_waitcnt vmcnt(19)
    s_barrier
    ds_read_b64_tr_b16 a[0:1], v9 offset:0
    ds_read_b64_tr_b16 a[2:3], v9 offset:256
    ds_read_b64_tr_b16 a[4:5], v9 offset:2048
    ds_read_b64_tr_b16 a[6:7], v9 offset:2304
    ds_read_b64_tr_b16 a[8:9], v9 offset:4096
    ds_read_b64_tr_b16 a[10:11], v9 offset:4352
    ds_read_b64_tr_b16 a[12:13], v9 offset:6144
    ds_read_b64_tr_b16 a[14:15], v9 offset:6400
    ds_read_b64_tr_b16 a[16:17], v9 offset:8192
    ds_read_b64_tr_b16 a[18:19], v9 offset:8448
    ds_read_b64_tr_b16 a[20:21], v9 offset:10240
    ds_read_b64_tr_b16 a[22:23], v9 offset:10496
    ds_read_b64_tr_b16 a[24:25], v9 offset:12288
    ds_read_b64_tr_b16 a[26:27], v9 offset:12544
    ds_read_b64_tr_b16 a[28:29], v9 offset:14336
    ds_read_b64_tr_b16 a[30:31], v9 offset:14592
    ds_read_b64_tr_b16 a[32:33], v9 offset:16384
    ds_read_b64_tr_b16 a[34:35], v9 offset:16640
    ds_read_b64_tr_b16 a[36:37], v9 offset:18432
    ds_read_b64_tr_b16 a[38:39], v9 offset:18688
    ds_read_b64_tr_b16 a[40:41], v9 offset:20480
    ds_read_b64_tr_b16 a[42:43], v9 offset:20736
    ds_read_b64_tr_b16 a[44:45], v9 offset:22528
    ds_read_b64_tr_b16 a[46:47], v9 offset:22784
    ds_read_b64_tr_b16 a[48:49], v9 offset:24576
    ds_read_b64_tr_b16 a[50:51], v9 offset:24832
    ds_read_b64_tr_b16 a[52:53], v9 offset:26624
    ds_read_b64_tr_b16 a[54:55], v9 offset:26880
    ds_read_b64_tr_b16 a[56:57], v9 offset:28672
    ds_read_b64_tr_b16 a[58:59], v9 offset:28928
    ds_read_b64_tr_b16 a[60:61], v9 offset:30720
    ds_read_b64_tr_b16 a[62:63], v9 offset:30976
    ds_read_b64_tr_b16 a[64:65], v9 offset:32768
    ds_read_b64_tr_b16 a[66:67], v9 offset:33024
    ds_read_b64_tr_b16 a[68:69], v9 offset:34816
    ds_read_b64_tr_b16 a[70:71], v9 offset:35072
    ds_read_b64_tr_b16 a[72:73], v10 offset:0
    ds_read_b64_tr_b16 a[74:75], v10 offset:4608
    ds_read_b64_tr_b16 a[76:77], v10 offset:32
    ds_read_b64_tr_b16 a[78:79], v10 offset:4640
    ds_read_b64_tr_b16 a[80:81], v10 offset:64
    ds_read_b64_tr_b16 a[82:83], v10 offset:4672
    ds_read_b64_tr_b16 a[84:85], v10 offset:96
    ds_read_b64_tr_b16 a[86:87], v10 offset:4704
    ds_read_b64_tr_b16 a[88:89], v10 offset:128
    ds_read_b64_tr_b16 a[90:91], v10 offset:4736
    ds_read_b64_tr_b16 a[92:93], v10 offset:160
    ds_read_b64_tr_b16 a[94:95], v10 offset:4768
    ds_read_b64_tr_b16 a[96:97], v10 offset:192
    ds_read_b64_tr_b16 a[98:99], v10 offset:4800
    ds_read_b64_tr_b16 a[100:101], v10 offset:224
    ds_read_b64_tr_b16 a[102:103], v10 offset:4832
    ds_read_b64_tr_b16 a[104:105], v10 offset:256
    ds_read_b64_tr_b16 a[106:107], v10 offset:4864
    s_waitcnt vmcnt(18) lgkmcnt(15)
    v_mfma_f32_16x16x32_bf16 v[88:91], a[0:3], v[16:19], 0
    s_waitcnt vmcnt(17)
    v_mfma_f32_16x16x32_bf16 v[88:91], a[4:7], v[20:23], v[88:91]
    s_waitcnt vmcnt(16)
    v_mfma_f32_16x16x32_bf16 v[88:91], a[8:11], v[24:27], v[88:91]
    s_waitcnt vmcnt(15)
    v_mfma_f32_16x16x32_bf16 v[88:91], a[12:15], v[28:31], v[88:91]
    s_waitcnt vmcnt(14)
    v_mfma_f32_16x16x32_bf16 v[88:91], a[16:19], v[32:35], v[88:91]
    s_waitcnt vmcnt(13)
    v_mfma_f32_16x16x32_bf16 v[88:91], a[20:23], v[36:39], v[88:91]
    s_waitcnt vmcnt(12)
    v_mfma_f32_16x16x32_bf16 v[88:91], a[24:27], v[40:43], v[88:91]
    s_waitcnt vmcnt(11)
    v_mfma_f32_16x16x32_bf16 v[88:91], a[28:31], v[44:47], v[88:91]
    s_waitcnt vmcnt(10)
    v_mfma_f32_16x16x32_bf16 v[88:91], a[32:35], v[48:51], v[88:91]
    s_waitcnt vmcnt(9)
    v_mfma_f32_16x16x32_bf16 v[88:91], a[36:39], v[52:55], v[88:91]
    s_waitcnt vmcnt(8)
    v_mfma_f32_16x16x32_bf16 v[88:91], a[40:43], v[56:59], v[88:91]
    s_waitcnt vmcnt(7)
    v_mfma_f32_16x16x32_bf16 v[88:91], a[44:47], v[60:63], v[88:91]
    s_waitcnt vmcnt(6)
    v_mfma_f32_16x16x32_bf16 v[88:91], a[48:51], v[64:67], v[88:91]
    s_waitcnt vmcnt(5)
    v_mfma_f32_16x16x32_bf16 v[88:91], a[52:55], v[68:71], v[88:91]
    s_waitcnt vmcnt(4)
    v_mfma_f32_16x16x32_bf16 v[88:91], a[56:59], v[72:75], v[88:91]
    s_waitcnt vmcnt(3)
    v_mfma_f32_16x16x32_bf16 v[88:91], a[60:63], v[76:79], v[88:91]
    s_waitcnt vmcnt(2)
    v_mfma_f32_16x16x32_bf16 v[88:91], a[64:67], v[80:83], v[88:91]
    s_waitcnt vmcnt(1)
    v_mfma_f32_16x16x32_bf16 v[88:91], a[68:71], v[84:87], v[88:91]
    v_lshlrev_b32 v11, 7, v6
    v_lshl_add_u32 v13, v7, 5, v11
    v_add_u32 v13, 110592, v13
    v_lshl_add_u32 v11, v7, 4, v11
    s_lshr_b32 s37, s33, 1
    s_lshl_b32 s37, s37, 8
    s_lshl_b32 s38, s38, 1
    s_add_u32 s37, s37, s38
    s_add_u32 s37, s37, 110592
    v_add_u32 v11, s37, v11
    ds_write_b128 v11, v[88:91]
    s_waitcnt lgkmcnt(0)
    s_barrier
    ds_read_b128 v[16:19], v13 offset:0
    ds_read_b128 v[20:23], v13 offset:16
    ds_read_b128 v[24:27], v13 offset:256
    ds_read_b128 v[28:31], v13 offset:272
    s_waitcnt lgkmcnt(0)
    v_mul_f32 v32, 0xbfb8aa3b, v16
    v_mul_f32 v33, 0xbfb8aa3b, v17
    v_mul_f32 v34, 0xbfb8aa3b, v18
    v_mul_f32 v35, 0xbfb8aa3b, v19
    v_mul_f32 v36, 0xbfb8aa3b, v20
    v_mul_f32 v37, 0xbfb8aa3b, v21
    v_mul_f32 v38, 0xbfb8aa3b, v22
    v_mul_f32 v39, 0xbfb8aa3b, v23
    v_exp_f32 v32, v32
    v_exp_f32 v33, v33
    v_exp_f32 v34, v34
    v_exp_f32 v35, v35
    v_exp_f32 v36, v36
    v_exp_f32 v37, v37
    v_exp_f32 v38, v38
    v_exp_f32 v39, v39
    v_add_f32 v32, 1.0, v32
    v_add_f32 v33, 1.0, v33
    v_add_f32 v34, 1.0, v34
    v_add_f32 v35, 1.0, v35
    v_add_f32 v36, 1.0, v36
    v_add_f32 v37, 1.0, v37
    v_add_f32 v38, 1.0, v38
    v_add_f32 v39, 1.0, v39
    v_rcp_f32 v32, v32
    v_rcp_f32 v33, v33
    v_rcp_f32 v34, v34
    v_rcp_f32 v35, v35
    v_rcp_f32 v36, v36
    v_rcp_f32 v37, v37
    v_rcp_f32 v38, v38
    v_rcp_f32 v39, v39
    v_mul_f32 v16, v16, v32
    v_mul_f32 v17, v17, v33
    v_mul_f32 v18, v18, v34
    v_mul_f32 v19, v19, v35
    v_mul_f32 v20, v20, v36
    v_mul_f32 v21, v21, v37
    v_mul_f32 v22, v22, v38
    v_mul_f32 v23, v23, v39
    v_mul_f32 v16, v16, v24
    v_mul_f32 v17, v17, v25
    v_mul_f32 v18, v18, v26
    v_mul_f32 v19, v19, v27
    v_mul_f32 v20, v20, v28
    v_mul_f32 v21, v21, v29
    v_mul_f32 v22, v22, v30
    v_mul_f32 v23, v23, v31
    v_cvt_pk_bf16_f32 v40, v16, v17
    v_cvt_pk_bf16_f32 v41, v18, v19
    v_cvt_pk_bf16_f32 v42, v20, v21
    v_cvt_pk_bf16_f32 v43, v22, v23
    v_mul_u32_u24 v8, 2304, v6
    v_lshl_add_u32 v8, v7, 4, v8
    v_and_b32 v9, 15, v0
    v_cmp_gt_u32 vcc, 2, v9
    s_mul_i32 s3, s2, 4608
    s_mul_i32 s37, s33, 576
    s_add_u32 s3, s3, s37
    s_add_u32 s3, s3, 65536
    v_mfma_f32_16x16x32_bf16 v[48:51], a[72:75], v[40:43], 0
    v_mfma_f32_16x16x32_bf16 v[52:55], a[76:79], v[40:43], 0
    v_mfma_f32_16x16x32_bf16 v[56:59], a[80:83], v[40:43], 0
    v_mfma_f32_16x16x32_bf16 v[60:63], a[84:87], v[40:43], 0
    v_mfma_f32_16x16x32_bf16 v[64:67], a[88:91], v[40:43], 0
    v_mfma_f32_16x16x32_bf16 v[68:71], a[92:95], v[40:43], 0
    v_mfma_f32_16x16x32_bf16 v[72:75], a[96:99], v[40:43], 0
    v_mfma_f32_16x16x32_bf16 v[76:79], a[100:103], v[40:43], 0
    v_mfma_f32_16x16x32_bf16 v[80:83], a[104:107], v[40:43], 0
    s_and_saveexec_b64 s[40:41], vcc
    buffer_store_dwordx4 v[48:51], v8, s[24:27], s3 offen offset:0
    s_nop 7
    buffer_store_dwordx4 v[52:55], v8, s[24:27], s3 offen offset:64
    buffer_store_dwordx4 v[56:59], v8, s[24:27], s3 offen offset:128
    buffer_store_dwordx4 v[60:63], v8, s[24:27], s3 offen offset:192
    buffer_store_dwordx4 v[64:67], v8, s[24:27], s3 offen offset:256
    buffer_store_dwordx4 v[68:71], v8, s[24:27], s3 offen offset:320
    buffer_store_dwordx4 v[72:75], v8, s[24:27], s3 offen offset:384
    buffer_store_dwordx4 v[76:79], v8, s[24:27], s3 offen offset:448
    buffer_store_dwordx4 v[80:83], v8, s[24:27], s3 offen offset:512
L4_end:
    s_endpgm

.globl fin_kernel
.p2align 8
.type fin_kernel,@function
fin_kernel:
    s_cmp_ge_u32 s2, 36
    s_cbranch_scc1 L5_end
    s_load_dwordx2 s[8:9], s[0:1], 96
    s_load_dwordx2 s[10:11], s[0:1], 112
    v_and_b32 v1, 31, v0
    v_lshrrev_b32 v2, 5, v0
    v_mul_u32_u24 v3, 82944, v2
    v_lshl_add_u32 v3, v1, 2, v3
    s_lshl_b32 s3, s2, 7
    s_add_u32 s3, s3, 65536
    s_cmp_ge_u32 s2, 18
    s_cselect_b32 s28, 1, 0
    s_mul_i32 s29, s28, 18
    s_sub_u32 s29, s2, s29
    s_waitcnt lgkmcnt(0)
    s_mov_b32 s12, s8
    s_mov_b32 s13, s9
    s_mov_b32 s14, 2359296
    s_mov_b32 s15, 0x20000
    s_mov_b32 s16, s10
    s_mov_b32 s17, s11
    s_mov_b32 s18, 1048576
    s_mov_b32 s19, 0x20000
    s_lshl_b32 s28, s28, 2
    s_add_u32 s28, s28, 49152
    v_mov_b32 v4, s28
    buffer_load_dword v5, v4, s[16:19], 0 offen
    buffer_load_dword v16, v3, s[16:19], s3 offen
    s_add_u32 s3, s3, 4608
    buffer_load_dword v17, v3, s[16:19], s3 offen
    s_add_u32 s3, s3, 4608
    buffer_load_dword v18, v3, s[16:19], s3 offen
    s_add_u32 s3, s3, 4608
    buffer_load_dword v19, v3, s[16:19], s3 offen
    s_add_u32 s3, s3, 4608
    buffer_load_dword v20, v3, s[16:19], s3 offen
    s_add_u32 s3, s3, 4608
    buffer_load_dword v21, v3, s[16:19], s3 offen
    s_add_u32 s3, s3, 4608
    buffer_load_dword v22, v3, s[16:19], s3 offen
    s_add_u32 s3, s3, 4608
    buffer_load_dword v23, v3, s[16:19], s3 offen
    s_add_u32 s3, s3, 4608
    buffer_load_dword v24, v3, s[16:19], s3 offen
    s_add_u32 s3, s3, 4608
    buffer_load_dword v25, v3, s[16:19], s3 offen
    s_add_u32 s3, s3, 4608
    buffer_load_dword v26, v3, s[16:19], s3 offen
    s_add_u32 s3, s3, 4608
    buffer_load_dword v27, v3, s[16:19], s3 offen
    s_add_u32 s3, s3, 4608
    buffer_load_dword v28, v3, s[16:19], s3 offen
    s_add_u32 s3, s3, 4608
    buffer_load_dword v29, v3, s[16:19], s3 offen
    s_add_u32 s3, s3, 4608
    buffer_load_dword v30, v3, s[16:19], s3 offen
    s_add_u32 s3, s3, 4608
    buffer_load_dword v31, v3, s[16:19], s3 offen
    s_add_u32 s3, s3, 4608
    buffer_load_dword v32, v3, s[16:19], s3 offen
    s_add_u32 s3, s3, 4608
    buffer_load_dword v33, v3, s[16:19], s3 offen
    s_add_u32 s3, s3, 4608
    s_lshl_b32 s29, s29, 5
    v_add_u32 v6, s29, v1
    v_lshlrev_b32 v7, 2, v6
    s_mov_b32 s30, 15104
    buffer_load_dword v8, v7, s[16:19], s30 offen
    s_waitcnt vmcnt(19)
    v_and_b32 v5, 0x7ff, v5
    v_lshlrev_b32 v9, 2, v5
    v_mul_u32_u24 v10, 1152, v5
    v_lshl_add_u32 v10, v6, 1, v10
    s_mov_b32 s30, 32768
    buffer_load_dword v11, v9, s[16:19], s30 offen
    buffer_load_ushort v12, v10, s[12:15], 0 offen
    s_waitcnt vmcnt(3)
    v_add_f32 v16, v16, v25
    v_add_f32 v17, v17, v26
    v_add_f32 v18, v18, v27
    v_add_f32 v19, v19, v28
    v_add_f32 v20, v20, v29
    v_add_f32 v21, v21, v30
    v_add_f32 v22, v22, v31
    v_add_f32 v23, v23, v32
    v_add_f32 v24, v24, v33
    v_add_f32 v16, v16, v20
    v_add_f32 v17, v17, v21
    v_add_f32 v18, v18, v22
    v_add_f32 v19, v19, v23
    v_add_f32 v16, v16, v17
    v_add_f32 v18, v18, v19
    v_add_f32 v16, v16, v24
    v_add_f32 v16, v16, v18
    v_lshlrev_b32 v13, 5, v1
    v_lshl_add_u32 v14, v2, 2, v13
    ds_write_b32 v14, v16
    s_waitcnt lgkmcnt(0)
    s_barrier
    ds_read_b128 v[16:19], v13
    ds_read_b128 v[20:23], v13 offset:16
    s_waitcnt vmcnt(0)
    v_mul_f32 v11, 0xbfb8aa3b, v11
    v_exp_f32 v11, v11
    v_lshlrev_b32 v12, 16, v12
    v_add_f32 v11, 1.0, v11
    v_rcp_f32 v11, v11
    s_waitcnt lgkmcnt(0)
    v_add_f32 v16, v16, v20
    v_add_f32 v17, v17, v21
    v_add_f32 v18, v18, v22
    v_add_f32 v19, v19, v23
    v_add_f32 v16, v16, v17
    v_add_f32 v18, v18, v19
    v_add_f32 v16, v16, v18
    v_mul_f32 v16, v16, v11
    v_fmac_f32 v12, v16, v8
    v_cvt_pk_bf16_f32 v12, v12, v12
    v_cmp_gt_u32 vcc, 32, v0
    s_nop 0
    s_and_saveexec_b64 s[34:35], vcc
    s_cbranch_execz L5_end
    buffer_store_short v12, v10, s[12:15], 0 offen
L5_end:
    s_endpgm

.section .rodata,"a"
.p2align 6
.amdhsa_kernel front_kernel
  .amdhsa_next_free_vgpr 64
  .amdhsa_next_free_sgpr 96
  .amdhsa_accum_offset 64
  .amdhsa_group_segment_fixed_size 0
  .amdhsa_kernarg_size 120
  .amdhsa_user_sgpr_count 2
  .amdhsa_user_sgpr_kernarg_segment_ptr 1
  .amdhsa_system_sgpr_workgroup_id_x 1
  .amdhsa_float_denorm_mode_32 3
.end_amdhsa_kernel
.p2align 6
.amdhsa_kernel attn_kernel
  .amdhsa_next_free_vgpr 512
  .amdhsa_next_free_sgpr 96
  .amdhsa_accum_offset 256
  .amdhsa_group_segment_fixed_size 0
  .amdhsa_kernarg_size 120
  .amdhsa_user_sgpr_count 2
  .amdhsa_user_sgpr_kernarg_segment_ptr 1
  .amdhsa_system_sgpr_workgroup_id_x 1
  .amdhsa_float_denorm_mode_32 3
.end_amdhsa_kernel
.p2align 6
.amdhsa_kernel mid_kernel
  .amdhsa_next_free_vgpr 128
  .amdhsa_next_free_sgpr 96
  .amdhsa_accum_offset 128
  .amdhsa_group_segment_fixed_size 0
  .amdhsa_kernarg_size 120
  .amdhsa_user_sgpr_count 2
  .amdhsa_user_sgpr_kernarg_segment_ptr 1
  .amdhsa_system_sgpr_workgroup_id_x 1
  .amdhsa_float_denorm_mode_32 3
.end_amdhsa_kernel
.p2align 6
.amdhsa_kernel ffn_kernel
  .amdhsa_next_free_vgpr 256
  .amdhsa_next_free_sgpr 96
  .amdhsa_accum_offset 128
  .amdhsa_group_segment_fixed_size 0
  .amdhsa_kernarg_size 120
  .amdhsa_user_sgpr_count 2
  .amdhsa_user_sgpr_kernarg_segment_ptr 1
  .amdhsa_system_sgpr_workgroup_id_x 1
  .amdhsa_float_denorm_mode_32 3
.end_amdhsa_kernel
.p2align 6
.amdhsa_kernel fin_kernel
  .amdhsa_next_free_vgpr 64
  .amdhsa_next_free_sgpr 96
  .amdhsa_accum_offset 64
  .amdhsa_group_segment_fixed_size 0
  .amdhsa_kernarg_size 120
  .amdhsa_user_sgpr_count 2
  .amdhsa_user_sgpr_kernarg_segment_ptr 1
  .amdhsa_system_sgpr_workgroup_id_x 1
  .amdhsa_float_denorm_mode_32 3
.end_amdhsa_kernel
```

```asm
; @launch kernel=front_kernel grid=(256,1,1) block=(384,1,1) lds=3072
; @launch kernel=main_kernel grid=(256,1,1) block=(256,1,1) lds=163840
.amdgcn_target "amdgcn-amd-amdhsa--gfx950"
.text
.globl front_kernel
.p2align 8
.type front_kernel,@function
front_kernel:
    s_cmp_ge_u32 s2, 256
    s_cbranch_scc1 L1_end
    s_load_dwordx2 s[4:5], s[0:1], 0
    s_load_dwordx4 s[8:11], s[0:1], 80
    s_load_dwordx2 s[6:7], s[0:1], 112
    s_load_dwordx2 s[36:37], s[0:1], 48
    s_waitcnt lgkmcnt(0)
    s_mov_b32 s12, s4
    s_mov_b32 s13, s5
    s_mov_b32 s14, 2359296
    s_mov_b32 s15, 0x20000
    s_mov_b32 s16, s8
    s_mov_b32 s17, s9
    s_mov_b32 s18, 1152
    s_mov_b32 s19, 0x20000
    s_mov_b32 s20, s10
    s_mov_b32 s21, s11
    s_mov_b32 s22, 3981312
    s_mov_b32 s23, 0x20000
    s_mov_b32 s24, s6
    s_mov_b32 s25, s7
    s_mov_b32 s26, 3407872
    s_mov_b32 s27, 0x20000
    s_mov_b32 s40, s36
    s_mov_b32 s41, s37
    s_mov_b32 s42, 1152
    s_mov_b32 s43, 0x20000
    s_cmp_ge_u32 s2, 236
    s_cbranch_scc1 L1_clr
    s_cmp_ge_u32 s2, 108
    s_cbranch_scc1 L1_ln
    v_and_b32 v1, 3, v0
    v_lshrrev_b32 v2, 2, v0
    v_mul_u32_u24 v3, 6912, v2
    v_lshl_add_u32 v3, v1, 4, v3
    v_lshlrev_b32 v4, 1, v2
    s_lshl_b32 s3, s2, 6
    buffer_load_ushort v8, v4, s[16:19], 0 offen offset:0
    buffer_load_ushort v9, v4, s[16:19], 0 offen offset:192
    buffer_load_ushort v10, v4, s[16:19], 0 offen offset:384
    buffer_load_ushort v11, v4, s[16:19], 0 offen offset:576
    buffer_load_ushort v12, v4, s[16:19], 0 offen offset:768
    buffer_load_ushort v13, v4, s[16:19], 0 offen offset:960
    buffer_load_dwordx4 v[16:19], v3, s[20:23], s3 offen
    s_add_u32 s3, s3, 663552
    buffer_load_dwordx4 v[20:23], v3, s[20:23], s3 offen
    s_add_u32 s3, s3, 663552
    buffer_load_dwordx4 v[24:27], v3, s[20:23], s3 offen
    s_add_u32 s3, s3, 663552
    buffer_load_dwordx4 v[28:31], v3, s[20:23], s3 offen
    s_add_u32 s3, s3, 663552
    buffer_load_dwordx4 v[32:35], v3, s[20:23], s3 offen
    s_add_u32 s3, s3, 663552
    buffer_load_dwordx4 v[36:39], v3, s[20:23], s3 offen
    s_mul_i32 s28, s2, 3641
    s_lshr_b32 s28, s28, 16
    s_mul_i32 s29, s28, 18
    s_sub_u32 s29, s2, s29
    s_mov_b32 s30, 1.0
    s_mov_b32 s31, 0
    s_cmp_lt_u32 s28, 2
    s_cselect_b32 s30, 0x3e0293ee, s30
    s_cmp_eq_u32 s28, 1
    s_cselect_b32 s31, 0x3e0293ee, s31
    s_cmp_eq_u32 s28, 4
    s_cselect_b32 s31, 1.0, s31
    s_waitcnt vmcnt(6)
    v_lshlrev_b32 v8, 16, v8
    v_lshlrev_b32 v9, 16, v9
    v_lshlrev_b32 v10, 16, v10
    v_lshlrev_b32 v11, 16, v11
    v_lshlrev_b32 v12, 16, v12
    v_lshlrev_b32 v13, 16, v13
    v_mul_f32 v40, 0xbfb8aa3b, v8
    v_mul_f32 v41, 0xbfb8aa3b, v9
    v_mul_f32 v42, 0xbfb8aa3b, v10
    v_mul_f32 v43, 0xbfb8aa3b, v11
    v_mul_f32 v44, 0xbfb8aa3b, v12
    v_mul_f32 v45, 0xbfb8aa3b, v13
    v_exp_f32 v40, v40
    v_exp_f32 v41, v41
    v_exp_f32 v42, v42
    v_exp_f32 v43, v43
    v_exp_f32 v44, v44
    v_exp_f32 v45, v45
    v_add_f32 v40, 1.0, v40
    v_add_f32 v41, 1.0, v41
    v_add_f32 v42, 1.0, v42
    v_add_f32 v43, 1.0, v43
    v_add_f32 v44, 1.0, v44
    v_add_f32 v45, 1.0, v45
    v_rcp_f32 v40, v40
    v_rcp_f32 v41, v41
    v_rcp_f32 v42, v42
    v_rcp_f32 v43, v43
    v_rcp_f32 v44, v44
    v_rcp_f32 v45, v45
    v_mul_f32 v8, v8, v40
    v_mul_f32 v9, v9, v41
    v_mul_f32 v10, v10, v42
    v_mul_f32 v11, v11, v43
    v_mul_f32 v12, v12, v44
    v_mul_f32 v13, v13, v45
    s_waitcnt vmcnt(5)
    v_lshlrev_b32 v40, 16, v16
    v_and_b32 v41, 0xffff0000, v16
    v_mul_f32 v48, v40, v8
    v_mul_f32 v49, v41, v8
    v_lshlrev_b32 v40, 16, v17
    v_and_b32 v41, 0xffff0000, v17
    v_mul_f32 v50, v40, v8
    v_mul_f32 v51, v41, v8
    v_lshlrev_b32 v40, 16, v18
    v_and_b32 v41, 0xffff0000, v18
    v_mul_f32 v52, v40, v8
    v_mul_f32 v53, v41, v8
    v_lshlrev_b32 v40, 16, v19
    v_and_b32 v41, 0xffff0000, v19
    v_mul_f32 v54, v40, v8
    v_mul_f32 v55, v41, v8
    s_waitcnt vmcnt(4)
    v_lshlrev_b32 v40, 16, v20
    v_and_b32 v41, 0xffff0000, v20
    v_fmac_f32 v48, v40, v9
    v_fmac_f32 v49, v41, v9
    v_lshlrev_b32 v40, 16, v21
    v_and_b32 v41, 0xffff0000, v21
    v_fmac_f32 v50, v40, v9
    v_fmac_f32 v51, v41, v9
    v_lshlrev_b32 v40, 16, v22
    v_and_b32 v41, 0xffff0000, v22
    v_fmac_f32 v52, v40, v9
    v_fmac_f32 v53, v41, v9
    v_lshlrev_b32 v40, 16, v23
    v_and_b32 v41, 0xffff0000, v23
    v_fmac_f32 v54, v40, v9
    v_fmac_f32 v55, v41, v9
    s_waitcnt vmcnt(3)
    v_lshlrev_b32 v40, 16, v24
    v_and_b32 v41, 0xffff0000, v24
    v_fmac_f32 v48, v40, v10
    v_fmac_f32 v49, v41, v10
    v_lshlrev_b32 v40, 16, v25
    v_and_b32 v41, 0xffff0000, v25
    v_fmac_f32 v50, v40, v10
    v_fmac_f32 v51, v41, v10
    v_lshlrev_b32 v40, 16, v26
    v_and_b32 v41, 0xffff0000, v26
    v_fmac_f32 v52, v40, v10
    v_fmac_f32 v53, v41, v10
    v_lshlrev_b32 v40, 16, v27
    v_and_b32 v41, 0xffff0000, v27
    v_fmac_f32 v54, v40, v10
    v_fmac_f32 v55, v41, v10
    s_waitcnt vmcnt(2)
    v_lshlrev_b32 v40, 16, v28
    v_and_b32 v41, 0xffff0000, v28
    v_fmac_f32 v48, v40, v11
    v_fmac_f32 v49, v41, v11
    v_lshlrev_b32 v40, 16, v29
    v_and_b32 v41, 0xffff0000, v29
    v_fmac_f32 v50, v40, v11
    v_fmac_f32 v51, v41, v11
    v_lshlrev_b32 v40, 16, v30
    v_and_b32 v41, 0xffff0000, v30
    v_fmac_f32 v52, v40, v11
    v_fmac_f32 v53, v41, v11
    v_lshlrev_b32 v40, 16, v31
    v_and_b32 v41, 0xffff0000, v31
    v_fmac_f32 v54, v40, v11
    v_fmac_f32 v55, v41, v11
    s_waitcnt vmcnt(1)
    v_lshlrev_b32 v40, 16, v32
    v_and_b32 v41, 0xffff0000, v32
    v_fmac_f32 v48, v40, v12
    v_fmac_f32 v49, v41, v12
    v_lshlrev_b32 v40, 16, v33
    v_and_b32 v41, 0xffff0000, v33
    v_fmac_f32 v50, v40, v12
    v_fmac_f32 v51, v41, v12
    v_lshlrev_b32 v40, 16, v34
    v_and_b32 v41, 0xffff0000, v34
    v_fmac_f32 v52, v40, v12
    v_fmac_f32 v53, v41, v12
    v_lshlrev_b32 v40, 16, v35
    v_and_b32 v41, 0xffff0000, v35
    v_fmac_f32 v54, v40, v12
    v_fmac_f32 v55, v41, v12
    s_waitcnt vmcnt(0)
    v_lshlrev_b32 v40, 16, v36
    v_and_b32 v41, 0xffff0000, v36
    v_fmac_f32 v48, v40, v13
    v_fmac_f32 v49, v41, v13
    v_lshlrev_b32 v40, 16, v37
    v_and_b32 v41, 0xffff0000, v37
    v_fmac_f32 v50, v40, v13
    v_fmac_f32 v51, v41, v13
    v_lshlrev_b32 v40, 16, v38
    v_and_b32 v41, 0xffff0000, v38
    v_fmac_f32 v52, v40, v13
    v_fmac_f32 v53, v41, v13
    v_lshlrev_b32 v40, 16, v39
    v_and_b32 v41, 0xffff0000, v39
    v_fmac_f32 v54, v40, v13
    v_fmac_f32 v55, v41, v13
    s_nop 1
    v_add_f32_dpp v48, v48, v48 row_ror:4 row_mask:0xf bank_mask:0xf
    v_add_f32_dpp v49, v49, v49 row_ror:4 row_mask:0xf bank_mask:0xf
    v_add_f32_dpp v50, v50, v50 row_ror:4 row_mask:0xf bank_mask:0xf
    v_add_f32_dpp v51, v51, v51 row_ror:4 row_mask:0xf bank_mask:0xf
    v_add_f32_dpp v52, v52, v52 row_ror:4 row_mask:0xf bank_mask:0xf
    v_add_f32_dpp v53, v53, v53 row_ror:4 row_mask:0xf bank_mask:0xf
    v_add_f32_dpp v54, v54, v54 row_ror:4 row_mask:0xf bank_mask:0xf
    v_add_f32_dpp v55, v55, v55 row_ror:4 row_mask:0xf bank_mask:0xf
    s_nop 1
    v_add_f32_dpp v48, v48, v48 row_ror:8 row_mask:0xf bank_mask:0xf
    v_add_f32_dpp v49, v49, v49 row_ror:8 row_mask:0xf bank_mask:0xf
    v_add_f32_dpp v50, v50, v50 row_ror:8 row_mask:0xf bank_mask:0xf
    v_add_f32_dpp v51, v51, v51 row_ror:8 row_mask:0xf bank_mask:0xf
    v_add_f32_dpp v52, v52, v52 row_ror:8 row_mask:0xf bank_mask:0xf
    v_add_f32_dpp v53, v53, v53 row_ror:8 row_mask:0xf bank_mask:0xf
    v_add_f32_dpp v54, v54, v54 row_ror:8 row_mask:0xf bank_mask:0xf
    v_add_f32_dpp v55, v55, v55 row_ror:8 row_mask:0xf bank_mask:0xf
    v_lshrrev_b32 v5, 4, v0
    v_lshlrev_b32 v5, 7, v5
    v_lshl_add_u32 v5, v1, 5, v5
    v_and_b32 v6, 15, v0
    v_cmp_gt_u32 vcc, 4, v6
    s_nop 0
    s_and_saveexec_b64 s[32:33], vcc
    ds_write_b128 v5, v[48:51]
    ds_write_b128 v5, v[52:55] offset:16
    s_mov_b64 exec, s[32:33]
    s_waitcnt lgkmcnt(0)
    s_barrier
    v_readfirstlane_b32 s34, v0
    s_nop 0
    s_cmp_ge_u32 s34, 64
    s_cbranch_scc1 L1_end
    v_and_b32 v6, 31, v0
    v_lshrrev_b32 v7, 5, v0
    v_mul_u32_u24 v7, 1536, v7
    v_lshl_add_u32 v7, v6, 2, v7
    ds_read_b32 v16, v7 offset:0
    ds_read_b32 v17, v7 offset:128
    ds_read_b32 v18, v7 offset:256
    ds_read_b32 v19, v7 offset:384
    ds_read_b32 v20, v7 offset:512
    ds_read_b32 v21, v7 offset:640
    ds_read_b32 v22, v7 offset:768
    ds_read_b32 v23, v7 offset:896
    ds_read_b32 v24, v7 offset:1024
    ds_read_b32 v25, v7 offset:1152
    ds_read_b32 v26, v7 offset:1280
    ds_read_b32 v27, v7 offset:1408
    s_lshl_b32 s29, s29, 5
    v_add_u32 v6, s29, v6
    v_lshrrev_b32 v8, 3, v6
    v_lshlrev_b32 v8, 6, v8
    v_and_b32 v9, 7, v6
    v_lshl_add_u32 v8, v9, 2, v8
    v_lshlrev_b32 v9, 2, v6
    s_mul_i32 s35, s28, 2304
    s_add_u32 s35, s35, 3584
    s_cmp_eq_u32 s28, 0
    s_cselect_b32 s35, 32, s35
    s_cmp_eq_u32 s28, 1
    s_cselect_b32 s35, 0, s35
    s_cmp_lt_u32 s28, 2
    s_cselect_b64 vcc, -1, 0
    v_cndmask_b32 v8, v9, v8, vcc
    s_waitcnt lgkmcnt(0)
    v_add_f32 v16, v16, v22
    v_add_f32 v17, v17, v23
    v_add_f32 v18, v18, v24
    v_add_f32 v19, v19, v25
    v_add_f32 v20, v20, v26
    v_add_f32 v21, v21, v27
    v_add_f32 v16, v16, v19
    v_add_f32 v17, v17, v20
    v_add_f32 v18, v18, v21
    v_add_f32 v16, v16, v17
    v_add_f32 v16, v16, v18
    v_mov_b32 v17, v16
    s_nop 1
    v_permlane32_swap_b32 v17, v16
    v_add_f32 v16, v16, v17
    v_mov_b32 v17, s31
    v_fma_f32 v16, v16, s30, v17
    s_mov_b64 exec, 0xffffffff
    buffer_store_dword v16, v8, s[24:27], s35 offen
    s_endpgm
L1_clr:
    s_sub_u32 s3, s2, 236
    v_lshlrev_b32 v1, 4, v0
    s_cmp_ge_u32 s3, 18
    s_cbranch_scc1 L1_clr2
    s_mul_i32 s3, s3, 36864
    s_add_u32 s3, s3, 98304
    v_mov_b32 v4, -1
    v_mov_b32 v5, -1
    v_mov_b32 v6, -1
    v_mov_b32 v7, -1
    buffer_store_dwordx4 v[4:7], v1, s[24:27], s3 offen
    s_add_u32 s3, s3, 6144
    buffer_store_dwordx4 v[4:7], v1, s[24:27], s3 offen
    s_add_u32 s3, s3, 6144
    buffer_store_dwordx4 v[4:7], v1, s[24:27], s3 offen
    s_add_u32 s3, s3, 6144
    buffer_store_dwordx4 v[4:7], v1, s[24:27], s3 offen
    s_add_u32 s3, s3, 6144
    buffer_store_dwordx4 v[4:7], v1, s[24:27], s3 offen
    s_add_u32 s3, s3, 6144
    buffer_store_dwordx4 v[4:7], v1, s[24:27], s3 offen
    s_add_u32 s3, s3, 6144
    s_endpgm
L1_clr2:
    v_lshlrev_b32 v2, 2, v0
    buffer_load_dword v3, v2, s[40:43], 0 offen
    v_mov_b32 v4, 0
    v_mov_b32 v5, 0
    v_mov_b32 v6, 0
    v_mov_b32 v7, 0
    s_sub_u32 s3, s3, 18
    s_mul_i32 s3, s3, 81920
    s_add_u32 s3, s3, 786432
    v_lshlrev_b32 v1, 7, v0
    buffer_store_dwordx2 v[4:5], v1, s[24:27], s3 offen
    s_add_u32 s3, s3, 32768
    v_lshlrev_b32 v2, 3, v0
    v_mov_b32 v10, 0x40000000
    buffer_store_dwordx2 v[4:5], v1, s[24:27], s3 offen
    v_cmp_gt_u32 vcc, 288, v0
    s_mov_b32 s3, 17408
    s_waitcnt vmcnt(2)
    v_cndmask_b32 v2, v10, v2, vcc
    v_lshlrev_b32 v8, 16, v3
    v_and_b32 v9, 0xffff0000, v3
    buffer_store_dwordx2 v[8:9], v2, s[24:27], s3 offen
    s_endpgm
L1_ln:
    s_sub_u32 s3, s2, 108
    v_lshrrev_b32 v1, 6, v0
    v_and_b32 v2, 15, v0
    v_bfe_u32 v3, v0, 4, 2
    v_mul_u32_u24 v4, 1152, v2
    v_lshl_add_u32 v4, v3, 4, v4
    v_mul_u32_u24 v5, 192, v1
    v_add_u32 v4, v4, v5
    s_mul_i32 s28, s3, 18432
    buffer_load_dwordx4 v[8:11], v4, s[12:15], s28 offen offset:0
    buffer_load_dwordx4 v[12:15], v4, s[12:15], s28 offen offset:64
    buffer_load_dwordx4 v[16:19], v4, s[12:15], s28 offen offset:128
    v_lshlrev_b32 v6, 5, v2
    v_lshl_add_u32 v7, v1, 2, v6
    v_and_b32 v5, 63, v0
    v_lshlrev_b32 v5, 4, v5
    v_mul_u32_u24 v1, 3072, v1
    v_add_u32 v5, v5, v1
    s_add_u32 s28, s28, 1048576
    s_waitcnt vmcnt(2)
    v_lshlrev_b32 v24, 16, v8
    v_and_b32 v25, 0xffff0000, v8
    v_lshlrev_b32 v26, 16, v9
    v_and_b32 v27, 0xffff0000, v9
    v_lshlrev_b32 v28, 16, v10
    v_and_b32 v29, 0xffff0000, v10
    v_lshlrev_b32 v30, 16, v11
    v_and_b32 v31, 0xffff0000, v11
    s_waitcnt vmcnt(1)
    v_lshlrev_b32 v32, 16, v12
    v_and_b32 v33, 0xffff0000, v12
    v_lshlrev_b32 v34, 16, v13
    v_and_b32 v35, 0xffff0000, v13
    v_lshlrev_b32 v36, 16, v14
    v_and_b32 v37, 0xffff0000, v14
    v_lshlrev_b32 v38, 16, v15
    v_and_b32 v39, 0xffff0000, v15
    s_waitcnt vmcnt(0)
    v_lshlrev_b32 v40, 16, v16
    v_and_b32 v41, 0xffff0000, v16
    v_lshlrev_b32 v42, 16, v17
    v_and_b32 v43, 0xffff0000, v17
    v_lshlrev_b32 v44, 16, v18
    v_and_b32 v45, 0xffff0000, v18
    v_lshlrev_b32 v46, 16, v19
    v_and_b32 v47, 0xffff0000, v19
    v_add_f32 v20, v24, v25
    v_add_f32 v22, v26, v27
    v_add_f32 v20, v20, v28
    v_add_f32 v22, v22, v29
    v_add_f32 v20, v20, v30
    v_add_f32 v22, v22, v31
    v_add_f32 v20, v20, v32
    v_add_f32 v22, v22, v33
    v_add_f32 v20, v20, v34
    v_add_f32 v22, v22, v35
    v_add_f32 v20, v20, v36
    v_add_f32 v22, v22, v37
    v_add_f32 v20, v20, v38
    v_add_f32 v22, v22, v39
    v_add_f32 v20, v20, v40
    v_add_f32 v22, v22, v41
    v_add_f32 v20, v20, v42
    v_add_f32 v22, v22, v43
    v_add_f32 v20, v20, v44
    v_add_f32 v22, v22, v45
    v_add_f32 v20, v20, v46
    v_add_f32 v22, v22, v47
    v_add_f32 v20, v20, v22
    v_mov_b32 v21, v20
    s_nop 1
    v_permlane16_swap_b32 v21, v20
    v_add_f32 v20, v20, v21
    v_mov_b32 v21, v20
    s_nop 1
    v_permlane32_swap_b32 v21, v20
    v_add_f32 v20, v20, v21
    ds_write_b32 v7, v20 offset:0
    s_waitcnt lgkmcnt(0)
    s_barrier
    ds_read_b128 v[8:11], v6 offset:0
    ds_read_b64 v[12:13], v6 offset:16
    s_waitcnt lgkmcnt(0)
    v_add_f32 v8, v8, v9
    v_add_f32 v10, v10, v11
    v_add_f32 v12, v12, v13
    v_add_f32 v8, v8, v10
    v_add_f32 v20, v8, v12
    v_mul_f32 v20, 0x3ae38e39, v20
    v_sub_f32 v24, v24, v20
    v_sub_f32 v25, v25, v20
    v_sub_f32 v26, v26, v20
    v_sub_f32 v27, v27, v20
    v_sub_f32 v28, v28, v20
    v_sub_f32 v29, v29, v20
    v_sub_f32 v30, v30, v20
    v_sub_f32 v31, v31, v20
    v_sub_f32 v32, v32, v20
    v_sub_f32 v33, v33, v20
    v_sub_f32 v34, v34, v20
    v_sub_f32 v35, v35, v20
    v_sub_f32 v36, v36, v20
    v_sub_f32 v37, v37, v20
    v_sub_f32 v38, v38, v20
    v_sub_f32 v39, v39, v20
    v_sub_f32 v40, v40, v20
    v_sub_f32 v41, v41, v20
    v_sub_f32 v42, v42, v20
    v_sub_f32 v43, v43, v20
    v_sub_f32 v44, v44, v20
    v_sub_f32 v45, v45, v20
    v_sub_f32 v46, v46, v20
    v_sub_f32 v47, v47, v20
    v_mul_f32 v20, v24, v24
    v_mul_f32 v22, v25, v25
    v_fmac_f32 v20, v26, v26
    v_fmac_f32 v22, v27, v27
    v_fmac_f32 v20, v28, v28
    v_fmac_f32 v22, v29, v29
    v_fmac_f32 v20, v30, v30
    v_fmac_f32 v22, v31, v31
    v_fmac_f32 v20, v32, v32
    v_fmac_f32 v22, v33, v33
    v_fmac_f32 v20, v34, v34
    v_fmac_f32 v22, v35, v35
    v_fmac_f32 v20, v36, v36
    v_fmac_f32 v22, v37, v37
    v_fmac_f32 v20, v38, v38
    v_fmac_f32 v22, v39, v39
    v_fmac_f32 v20, v40, v40
    v_fmac_f32 v22, v41, v41
    v_fmac_f32 v20, v42, v42
    v_fmac_f32 v22, v43, v43
    v_fmac_f32 v20, v44, v44
    v_fmac_f32 v22, v45, v45
    v_fmac_f32 v20, v46, v46
    v_fmac_f32 v22, v47, v47
    v_add_f32 v20, v20, v22
    v_mov_b32 v21, v20
    s_nop 1
    v_permlane16_swap_b32 v21, v20
    v_add_f32 v20, v20, v21
    v_mov_b32 v21, v20
    s_nop 1
    v_permlane32_swap_b32 v21, v20
    v_add_f32 v20, v20, v21
    ds_write_b32 v7, v20 offset:512
    s_waitcnt lgkmcnt(0)
    s_barrier
    ds_read_b128 v[8:11], v6 offset:512
    ds_read_b64 v[12:13], v6 offset:528
    s_waitcnt lgkmcnt(0)
    v_add_f32 v8, v8, v9
    v_add_f32 v10, v10, v11
    v_add_f32 v12, v12, v13
    v_add_f32 v8, v8, v10
    v_add_f32 v20, v8, v12
    v_mov_b32 v21, 0x3727c5ac
    v_fmac_f32 v21, 0x3ae38e39, v20
    v_rsq_f32 v21, v21
    s_nop 0
    v_mul_f32 v24, v24, v21
    v_mul_f32 v25, v25, v21
    v_mul_f32 v26, v26, v21
    v_mul_f32 v27, v27, v21
    v_mul_f32 v28, v28, v21
    v_mul_f32 v29, v29, v21
    v_mul_f32 v30, v30, v21
    v_mul_f32 v31, v31, v21
    v_mul_f32 v32, v32, v21
    v_mul_f32 v33, v33, v21
    v_mul_f32 v34, v34, v21
    v_mul_f32 v35, v35, v21
    v_mul_f32 v36, v36, v21
    v_mul_f32 v37, v37, v21
    v_mul_f32 v38, v38, v21
    v_mul_f32 v39, v39, v21
    v_mul_f32 v40, v40, v21
    v_mul_f32 v41, v41, v21
    v_mul_f32 v42, v42, v21
    v_mul_f32 v43, v43, v21
    v_mul_f32 v44, v44, v21
    v_mul_f32 v45, v45, v21
    v_mul_f32 v46, v46, v21
    v_mul_f32 v47, v47, v21
    v_cvt_pk_f16_f32 v8, v24, v25
    v_cvt_pk_f16_f32 v9, v26, v27
    v_cvt_pk_f16_f32 v10, v28, v29
    v_cvt_pk_f16_f32 v11, v30, v31
    buffer_store_dwordx4 v[8:11], v5, s[24:27], s28 offen offset:0
    v_cvt_pk_f16_f32 v12, v32, v33
    v_cvt_pk_f16_f32 v13, v34, v35
    v_cvt_pk_f16_f32 v14, v36, v37
    v_cvt_pk_f16_f32 v15, v38, v39
    buffer_store_dwordx4 v[12:15], v5, s[24:27], s28 offen offset:1024
    v_cvt_pk_f16_f32 v16, v40, v41
    v_cvt_pk_f16_f32 v17, v42, v43
    v_cvt_pk_f16_f32 v18, v44, v45
    v_cvt_pk_f16_f32 v19, v46, v47
    buffer_store_dwordx4 v[16:19], v5, s[24:27], s28 offen offset:2048
L1_end:
    s_endpgm

.globl main_kernel
.p2align 8
.type main_kernel,@function
main_kernel:
L2_begin:
    s_getpc_b64 s[98:99]
    s_cmp_ge_u32 s2, 256
    s_cbranch_scc1 L2_end
    s_load_dwordx8 s[4:11], s[0:1], 8
    s_load_dwordx2 s[12:13], s[0:1], 112
    s_load_dwordx2 s[64:65], s[0:1], 56
    s_load_dwordx2 s[68:69], s[0:1], 64
    s_load_dwordx2 s[72:73], s[0:1], 72
    s_load_dwordx2 s[76:77], s[0:1], 0
    s_load_dwordx2 s[80:81], s[0:1], 96
    v_lshrrev_b32 v12, 6, v0
    v_and_b32 v0, 63, v0
    v_readfirstlane_b32 s51, v12
    s_and_b32 s3, s2, 7
    s_lshr_b32 s14, s2, 3
    s_and_b32 s52, s3, 3
    s_lshl_b32 s52, s52, 2
    s_and_b32 s15, s14, 3
    s_add_u32 s52, s52, s15
    s_lshr_b32 s53, s3, 2
    s_mul_i32 s53, s53, 8
    s_lshr_b32 s15, s14, 2
    s_add_u32 s53, s53, s15
    s_mul_i32 s44, s51, 4224
    s_add_u32 s44, s44, 16384
    v_lshlrev_b32 v8, 4, v0
    v_lshl_add_u32 v5, v12, 12, v8
    v_lshrrev_b32 v13, 5, v0
    v_lshl_add_u32 v13, v12, 1, v13
    v_lshlrev_b32 v13, 15, v13
    v_and_b32 v14, 31, v0
    v_lshl_add_u32 v6, v14, 4, v13
    s_waitcnt lgkmcnt(0)
    s_lshl_b32 s3, s52, 9
    s_add_u32 s24, s8, s3
    s_addc_u32 s25, s9, 0
    s_mov_b32 s26, 0
    s_mov_b32 s27, 0x20000
    s_sub_u32 s26, 4718592, s3
    s_mov_b32 s36, s12
    s_mov_b32 s37, s13
    s_mov_b32 s38, 4608
    s_mov_b32 s39, 0x20000
    s_lshl_b32 s3, s53, 2
    s_add_u32 s3, s3, s51
    s_mul_i32 s14, s3, 36864
    s_add_u32 s14, s14, 1048576
    s_add_u32 s32, s12, s14
    s_addc_u32 s33, s13, 0
    s_mov_b32 s34, 36864
    s_mov_b32 s35, 0x20000
    s_lshl_b32 m0, s51, 10
    s_lshl_b32 s45, s51, 10
    buffer_load_dwordx4 v8, s[36:39], s45 offen lds
    s_add_u32 m0, m0, 4096
    s_add_u32 s45, s45, 4096
    buffer_load_dwordx4 v8, s[36:39], s45 offen lds
    s_mov_b32 s54, 0
    buffer_load_dwordx4 v[80:83], v8, s[32:35], s54 offen
    s_mov_b32 s54, 1024
    buffer_load_dwordx4 v[84:87], v8, s[32:35], s54 offen
    s_mov_b32 s54, 18432
    buffer_load_dwordx4 v[88:91], v8, s[32:35], s54 offen
    s_mov_b32 s54, 19456
    buffer_load_dwordx4 v[92:95], v8, s[32:35], s54 offen
    s_add_u32 m0, s44, 36864
    s_mov_b32 s45, 0
    buffer_load_dwordx4 v6, s[24:27], s45 offen lds
    s_add_u32 m0, s44, 37920
    s_mov_b32 s45, 8192
    buffer_load_dwordx4 v6, s[24:27], s45 offen lds
    s_add_u32 m0, s44, 38976
    s_mov_b32 s45, 16384
    buffer_load_dwordx4 v6, s[24:27], s45 offen lds
    s_add_u32 m0, s44, 40032
    s_mov_b32 s45, 24576
    buffer_load_dwordx4 v6, s[24:27], s45 offen lds
    s_add_u32 m0, s44, 53760
    s_mov_b32 s45, 262144
    buffer_load_dwordx4 v6, s[24:27], s45 offen lds
    s_add_u32 m0, s44, 54816
    s_mov_b32 s45, 270336
    buffer_load_dwordx4 v6, s[24:27], s45 offen lds
    s_add_u32 m0, s44, 55872
    s_mov_b32 s45, 278528
    buffer_load_dwordx4 v6, s[24:27], s45 offen lds
    s_add_u32 m0, s44, 56928
    s_mov_b32 s45, 286720
    buffer_load_dwordx4 v6, s[24:27], s45 offen lds
    s_mov_b32 s54, 2048
    buffer_load_dwordx4 v[96:99], v8, s[32:35], s54 offen
    s_mov_b32 s54, 3072
    buffer_load_dwordx4 v[100:103], v8, s[32:35], s54 offen
    s_mov_b32 s54, 20480
    buffer_load_dwordx4 v[104:107], v8, s[32:35], s54 offen
    s_mov_b32 s54, 21504
    buffer_load_dwordx4 v[108:111], v8, s[32:35], s54 offen
    s_add_u32 m0, s44, 73728
    s_mov_b32 s45, 524288
    buffer_load_dwordx4 v6, s[24:27], s45 offen lds
    s_add_u32 m0, s44, 74784
    s_mov_b32 s45, 532480
    buffer_load_dwordx4 v6, s[24:27], s45 offen lds
    s_add_u32 m0, s44, 75840
    s_mov_b32 s45, 540672
    buffer_load_dwordx4 v6, s[24:27], s45 offen lds
    s_add_u32 m0, s44, 76896
    s_mov_b32 s45, 548864
    buffer_load_dwordx4 v6, s[24:27], s45 offen lds
    s_add_u32 m0, s44, 90624
    s_mov_b32 s45, 786432
    buffer_load_dwordx4 v6, s[24:27], s45 offen lds
    s_add_u32 m0, s44, 91680
    s_mov_b32 s45, 794624
    buffer_load_dwordx4 v6, s[24:27], s45 offen lds
    s_add_u32 m0, s44, 92736
    s_mov_b32 s45, 802816
    buffer_load_dwordx4 v6, s[24:27], s45 offen lds
    s_add_u32 m0, s44, 93792
    s_mov_b32 s45, 811008
    buffer_load_dwordx4 v6, s[24:27], s45 offen lds
    s_mov_b32 s54, 4096
    buffer_load_dwordx4 v[112:115], v8, s[32:35], s54 offen
    s_mov_b32 s54, 5120
    buffer_load_dwordx4 v[116:119], v8, s[32:35], s54 offen
    s_mov_b32 s54, 22528
    buffer_load_dwordx4 v[120:123], v8, s[32:35], s54 offen
    s_mov_b32 s54, 23552
    buffer_load_dwordx4 v[124:127], v8, s[32:35], s54 offen
    v_lshl_add_u32 v13, v12, 7, v0
    v_lshlrev_b32 v13, 7, v13
    v_min_u32 v14, L2_codeend-L2_begin-8, v13
    global_load_dword a63, v14, s[98:99]
    v_add_u32 v13, 8192, v13
    v_min_u32 v14, L2_codeend-L2_begin-8, v13
    global_load_dword a63, v14, s[98:99]
    s_mul_i32 s14, s3, 589824
    s_mul_i32 s15, s52, 9216
    s_add_u32 s14, s14, s15
    s_add_u32 s14, s14, 8388608
    s_add_u32 s40, s12, s14
    s_addc_u32 s41, s13, 0
    s_mov_b32 s42, 0
    s_mov_b32 s43, 0x20000
    s_sub_u32 s42, 589824, s15
    s_lshl_b32 s3, s52, 19
    s_add_u32 s16, s4, s3
    s_addc_u32 s17, s5, 0
    s_mov_b32 s18, 524288
    s_mov_b32 s19, 0x20000
    s_add_u32 s20, s6, s3
    s_addc_u32 s21, s7, 0
    s_mov_b32 s22, 524288
    s_mov_b32 s23, 0x20000
    s_mul_i32 s3, s52, 294912
    s_add_u32 s28, s10, s3
    s_addc_u32 s29, s11, 0
    s_mov_b32 s30, 294912
    s_mov_b32 s31, 0x20000
    s_mov_b64 s[4:5], s[64:65]
    s_mov_b64 s[6:7], s[68:69]
    s_mov_b64 s[8:9], s[72:73]
    s_mov_b32 s50, 0
    s_mul_i32 s55, s51, 9216
    s_lshl_b32 s96, s53, 4
    s_add_u32 s96, s96, s52
    s_min_u32 s15, s2, 143
    s_and_b32 s3, s15, 7
    s_mul_i32 s3, s3, 18
    s_lshr_b32 s15, s15, 3
    s_add_u32 s15, s15, s3
    s_lshl_b32 s3, s15, 6
    s_add_u32 s64, s64, s3
    s_addc_u32 s65, s65, 0
    s_mov_b32 s66, 0
    s_mov_b32 s67, 0x20000
    s_add_u32 s68, s68, s3
    s_addc_u32 s69, s69, 0
    s_mov_b32 s70, 0
    s_mov_b32 s71, 0x20000
    s_sub_u32 s14, 5308416, s3
    s_mul_i32 s3, s15, 36864
    s_add_u32 s72, s72, s3
    s_addc_u32 s73, s73, 0
    s_mov_b32 s74, 0
    s_mov_b32 s75, 0x20000
    s_cmp_lt_u32 s2, 144
    s_cselect_b32 s66, s14, 0
    s_cselect_b32 s70, s14, 0
    s_cselect_b32 s74, 36864, 0
    s_mul_i32 s3, s96, 9216
    s_add_u32 s76, s76, s3
    s_addc_u32 s77, s77, 0
    s_mov_b32 s78, 9216
    s_mov_b32 s79, 0x20000
    s_mov_b32 s82, 2359296
    s_mov_b32 s83, 0x20000
    s_mov_b32 s84, s12
    s_mov_b32 s85, s13
    s_mov_b32 s86, 6553600
    s_mov_b32 s87, 0x20000
    s_mul_i32 s3, s96, 147456
    s_add_u32 s3, s3, 8388608
    s_add_u32 s88, s12, s3
    s_addc_u32 s89, s13, 0
    s_mov_b32 s90, 147456
    s_mov_b32 s91, 0x20000
    v_lshrrev_b32 v13, 4, v0
    v_lshlrev_b32 v9, 6, v13
    v_lshrrev_b32 v14, 2, v0
    v_mul_u32_u24 v14, 1056, v14
    v_add_u32 v14, 16384, v14
    v_and_b32 v15, 1, v0
    v_lshlrev_b32 v15, 4, v15
    v_add_u32 v3, v14, v15
    v_and_b32 v15, 2, v0
    v_lshl_add_u32 v3, v15, 2, v3
    v_add_u32 v4, 73728, v3
    v_lshrrev_b32 v14, 3, v0
    v_lshlrev_b32 v14, 2, v14
    v_add_u32 v14, v14, v12
    v_mul_u32_u24 v14, 4608, v14
    v_and_b32 v15, 7, v0
    v_lshl_add_u32 v7, v15, 4, v14
    v_lshlrev_b32 v10, 4, v15
    v_lshl_add_u32 v10, v13, 7, v10
    v_bfe_u32 v14, v0, 3, 1
    v_mul_u32_u24 v14, 147456, v14
    v_add_u32 v10, v10, v14
    v_lshrrev_b32 v14, 2, v0
    v_mul_u32_u24 v14, 1056, v14
    v_and_b32 v15, 3, v0
    v_lshl_add_u32 v14, v15, 3, v14
    v_add_u32 v2, 107008, v14
    v_and_b32 v14, 15, v0
    v_mul_u32_u24 v14, 1056, v14
    v_lshrrev_b32 v15, 4, v0
    v_lshl_add_u32 v14, v15, 4, v14
    v_add_u32 v1, 90112, v14
    v_and_b32 v14, 1, v0
    v_cmp_eq_u32 vcc, 0, v14
    v_mov_b32 v11, 0xeeeeeeee
    v_mov_b32 v15, 0x44444444
    v_cndmask_b32 v11, v11, v15, vcc
    v_and_b32 v14, 2, v0
    v_cmp_eq_u32 vcc, 0, v14
    v_mov_b32 v15, 0x3f803f80
    s_nop 0
    v_cndmask_b32 v15, 0, v15, vcc
    v_accvgpr_write_b32 a16, v15
    v_accvgpr_write_b32 a17, v15
    v_accvgpr_write_b32 a18, v15
    v_accvgpr_write_b32 a19, v15
    s_waitcnt vmcnt(24)
    s_barrier
    ds_read_b128 v[16:19], v9 offset:0
    ds_read_b128 v[20:23], v9 offset:32
    ds_read_b128 v[24:27], v9 offset:16
    ds_read_b128 v[28:31], v9 offset:48
    s_waitcnt lgkmcnt(2)
    v_fma_mix_f32 v32, v80, v16, v20 op_sel:[0,0,0] op_sel_hi:[1,0,0]
    v_fma_mix_f32 v33, v80, v17, v21 op_sel:[1,0,0] op_sel_hi:[1,0,0]
    v_fma_mix_f32 v34, v81, v18, v22 op_sel:[0,0,0] op_sel_hi:[1,0,0]
    v_fma_mix_f32 v35, v81, v19, v23 op_sel:[1,0,0] op_sel_hi:[1,0,0]
    v_cvt_pk_bf16_f32 v80, v32, v33
    v_cvt_pk_bf16_f32 v81, v34, v35
    v_fma_mix_f32 v36, v88, v16, v20 op_sel:[0,0,0] op_sel_hi:[1,0,0]
    v_fma_mix_f32 v37, v88, v17, v21 op_sel:[1,0,0] op_sel_hi:[1,0,0]
    v_fma_mix_f32 v38, v89, v18, v22 op_sel:[0,0,0] op_sel_hi:[1,0,0]
    v_fma_mix_f32 v39, v89, v19, v23 op_sel:[1,0,0] op_sel_hi:[1,0,0]
    v_cvt_pk_bf16_f32 v88, v36, v37
    v_cvt_pk_bf16_f32 v89, v38, v39
    ds_read_b128 v[16:19], v9 offset:256
    ds_read_b128 v[20:23], v9 offset:288
    s_waitcnt lgkmcnt(2)
    v_fma_mix_f32 v32, v82, v24, v28 op_sel:[0,0,0] op_sel_hi:[1,0,0]
    v_fma_mix_f32 v33, v82, v25, v29 op_sel:[1,0,0] op_sel_hi:[1,0,0]
    v_fma_mix_f32 v34, v83, v26, v30 op_sel:[0,0,0] op_sel_hi:[1,0,0]
    v_fma_mix_f32 v35, v83, v27, v31 op_sel:[1,0,0] op_sel_hi:[1,0,0]
    v_cvt_pk_bf16_f32 v82, v32, v33
    v_cvt_pk_bf16_f32 v83, v34, v35
    v_fma_mix_f32 v36, v90, v24, v28 op_sel:[0,0,0] op_sel_hi:[1,0,0]
    v_fma_mix_f32 v37, v90, v25, v29 op_sel:[1,0,0] op_sel_hi:[1,0,0]
    v_fma_mix_f32 v38, v91, v26, v30 op_sel:[0,0,0] op_sel_hi:[1,0,0]
    v_fma_mix_f32 v39, v91, v27, v31 op_sel:[1,0,0] op_sel_hi:[1,0,0]
    v_cvt_pk_bf16_f32 v90, v36, v37
    v_cvt_pk_bf16_f32 v91, v38, v39
    ds_read_b128 v[24:27], v9 offset:272
    ds_read_b128 v[28:31], v9 offset:304
    s_waitcnt lgkmcnt(2)
    v_fma_mix_f32 v32, v84, v16, v20 op_sel:[0,0,0] op_sel_hi:[1,0,0]
    v_fma_mix_f32 v33, v84, v17, v21 op_sel:[1,0,0] op_sel_hi:[1,0,0]
    v_fma_mix_f32 v34, v85, v18, v22 op_sel:[0,0,0] op_sel_hi:[1,0,0]
    v_fma_mix_f32 v35, v85, v19, v23 op_sel:[1,0,0] op_sel_hi:[1,0,0]
    v_cvt_pk_bf16_f32 v84, v32, v33
    v_cvt_pk_bf16_f32 v85, v34, v35
    v_fma_mix_f32 v36, v92, v16, v20 op_sel:[0,0,0] op_sel_hi:[1,0,0]
    v_fma_mix_f32 v37, v92, v17, v21 op_sel:[1,0,0] op_sel_hi:[1,0,0]
    v_fma_mix_f32 v38, v93, v18, v22 op_sel:[0,0,0] op_sel_hi:[1,0,0]
    v_fma_mix_f32 v39, v93, v19, v23 op_sel:[1,0,0] op_sel_hi:[1,0,0]
    v_cvt_pk_bf16_f32 v92, v36, v37
    v_cvt_pk_bf16_f32 v93, v38, v39
    ds_read_b128 v[16:19], v9 offset:512
    ds_read_b128 v[20:23], v9 offset:544
    s_waitcnt lgkmcnt(2)
    v_fma_mix_f32 v32, v86, v24, v28 op_sel:[0,0,0] op_sel_hi:[1,0,0]
    v_fma_mix_f32 v33, v86, v25, v29 op_sel:[1,0,0] op_sel_hi:[1,0,0]
    v_fma_mix_f32 v34, v87, v26, v30 op_sel:[0,0,0] op_sel_hi:[1,0,0]
    v_fma_mix_f32 v35, v87, v27, v31 op_sel:[1,0,0] op_sel_hi:[1,0,0]
    v_cvt_pk_bf16_f32 v86, v32, v33
    v_cvt_pk_bf16_f32 v87, v34, v35
    v_fma_mix_f32 v36, v94, v24, v28 op_sel:[0,0,0] op_sel_hi:[1,0,0]
    v_fma_mix_f32 v37, v94, v25, v29 op_sel:[1,0,0] op_sel_hi:[1,0,0]
    v_fma_mix_f32 v38, v95, v26, v30 op_sel:[0,0,0] op_sel_hi:[1,0,0]
    v_fma_mix_f32 v39, v95, v27, v31 op_sel:[1,0,0] op_sel_hi:[1,0,0]
    v_cvt_pk_bf16_f32 v94, v36, v37
    v_cvt_pk_bf16_f32 v95, v38, v39
    s_waitcnt vmcnt(16)
    s_barrier
    ds_read_b64_tr_b16 a[192:193], v3 offset:36864
    ds_read_b64_tr_b16 a[194:195], v3 offset:37376
    ds_read_b64_tr_b16 a[196:197], v3 offset:53760
    ds_read_b64_tr_b16 a[198:199], v3 offset:54272
    ds_read_b64_tr_b16 a[200:201], v3 offset:36896
    ds_read_b64_tr_b16 a[202:203], v3 offset:37408
    ds_read_b64_tr_b16 a[204:205], v3 offset:53792
    ds_read_b64_tr_b16 a[206:207], v3 offset:54304
    ds_read_b64_tr_b16 a[208:209], v3 offset:36928
    ds_read_b64_tr_b16 a[210:211], v3 offset:37440
    ds_read_b64_tr_b16 a[212:213], v3 offset:53824
    ds_read_b64_tr_b16 a[214:215], v3 offset:54336
    s_waitcnt lgkmcnt(8)
    v_mfma_f32_16x16x32_bf16 v[128:131], a[192:195], v[80:83], 0
    s_waitcnt vmcnt(12)
    ds_read_b64_tr_b16 a[216:217], v3 offset:36960
    ds_read_b128 v[24:27], v9 offset:528
    v_mfma_f32_16x16x32_bf16 v[128:131], a[196:199], v[84:87], v[128:131]
    ds_read_b64_tr_b16 a[218:219], v3 offset:37472
    ds_read_b64_tr_b16 a[220:221], v3 offset:53856
    v_fma_mix_f32 v32, v96, v16, v20 op_sel:[0,0,0] op_sel_hi:[1,0,0]
    v_mfma_f32_16x16x32_bf16 v[160:163], a[192:195], v[88:91], 0
    s_add_u32 m0, s44, 110592
    ds_read_b64_tr_b16 a[222:223], v3 offset:54368
    ds_read_b128 v[28:31], v9 offset:560
    v_mfma_f32_16x16x32_bf16 v[160:163], a[196:199], v[92:95], v[160:163]
    s_mov_b32 s45, 1048576
    s_waitcnt lgkmcnt(10)
    buffer_load_dwordx4 v6, s[24:27], s45 offen lds
    v_mfma_f32_16x16x32_bf16 v[132:135], a[200:203], v[80:83], 0
    ds_read_b64_tr_b16 a[224:225], v3 offset:36992
    v_fma_mix_f32 v33, v96, v17, v21 op_sel:[1,0,0] op_sel_hi:[1,0,0]
    v_mfma_f32_16x16x32_bf16 v[132:135], a[204:207], v[84:87], v[132:135]
    ds_read_b64_tr_b16 a[226:227], v3 offset:37504
    ds_read_b64_tr_b16 a[228:229], v3 offset:53888
    v_fma_mix_f32 v34, v97, v18, v22 op_sel:[0,0,0] op_sel_hi:[1,0,0]
    v_mfma_f32_16x16x32_bf16 v[164:167], a[200:203], v[88:91], 0
    s_add_u32 m0, s44, 111648
    ds_read_b64_tr_b16 a[230:231], v3 offset:54400
    v_fma_mix_f32 v35, v97, v19, v23 op_sel:[1,0,0] op_sel_hi:[1,0,0]
    v_mfma_f32_16x16x32_bf16 v[164:167], a[204:207], v[92:95], v[164:167]
    s_mov_b32 s45, 1056768
    s_waitcnt lgkmcnt(10)
    buffer_load_dwordx4 v6, s[24:27], s45 offen lds
    v_mfma_f32_16x16x32_bf16 v[136:139], a[208:211], v[80:83], 0
    ds_read_b64_tr_b16 a[232:233], v3 offset:37024
    v_cvt_pk_bf16_f32 v96, v32, v33
    v_mfma_f32_16x16x32_bf16 v[136:139], a[212:215], v[84:87], v[136:139]
    ds_read_b64_tr_b16 a[234:235], v3 offset:37536
    ds_read_b64_tr_b16 a[236:237], v3 offset:53920
    v_cvt_pk_bf16_f32 v97, v34, v35
    v_mfma_f32_16x16x32_bf16 v[168:171], a[208:211], v[88:91], 0
    s_add_u32 m0, s44, 112704
    ds_read_b64_tr_b16 a[238:239], v3 offset:54432
    v_fma_mix_f32 v36, v104, v16, v20 op_sel:[0,0,0] op_sel_hi:[1,0,0]
    v_mfma_f32_16x16x32_bf16 v[168:171], a[212:215], v[92:95], v[168:171]
    s_mov_b32 s45, 1064960
    s_waitcnt lgkmcnt(9)
    buffer_load_dwordx4 v6, s[24:27], s45 offen lds
    v_fma_mix_f32 v37, v104, v17, v21 op_sel:[1,0,0] op_sel_hi:[1,0,0]
    v_mfma_f32_16x16x32_bf16 v[140:143], a[216:219], v[80:83], 0
    ds_read_b64_tr_b16 a[240:241], v3 offset:37056
    v_fma_mix_f32 v38, v105, v18, v22 op_sel:[0,0,0] op_sel_hi:[1,0,0]
    v_mfma_f32_16x16x32_bf16 v[140:143], a[220:223], v[84:87], v[140:143]
    ds_read_b64_tr_b16 a[242:243], v3 offset:37568
    ds_read_b64_tr_b16 a[244:245], v3 offset:53952
    v_fma_mix_f32 v39, v105, v19, v23 op_sel:[1,0,0] op_sel_hi:[1,0,0]
    v_mfma_f32_16x16x32_bf16 v[172:175], a[216:219], v[88:91], 0
    s_add_u32 m0, s44, 113760
    ds_read_b64_tr_b16 a[246:247], v3 offset:54464
    v_cvt_pk_bf16_f32 v104, v36, v37
    v_mfma_f32_16x16x32_bf16 v[172:175], a[220:223], v[92:95], v[172:175]
    s_mov_b32 s45, 1073152
    s_waitcnt lgkmcnt(8)
    buffer_load_dwordx4 v6, s[24:27], s45 offen lds
    v_cvt_pk_bf16_f32 v105, v38, v39
    v_mfma_f32_16x16x32_bf16 v[144:147], a[224:227], v[80:83], 0
    ds_read_b64_tr_b16 a[248:249], v3 offset:37088
    ds_read_b128 v[16:19], v9 offset:768
    v_mfma_f32_16x16x32_bf16 v[144:147], a[228:231], v[84:87], v[144:147]
    ds_read_b64_tr_b16 a[250:251], v3 offset:37600
    ds_read_b64_tr_b16 a[252:253], v3 offset:53984
    v_fma_mix_f32 v32, v98, v24, v28 op_sel:[0,0,0] op_sel_hi:[1,0,0]
    v_mfma_f32_16x16x32_bf16 v[176:179], a[224:227], v[88:91], 0
    s_add_u32 m0, s44, 127488
    ds_read_b64_tr_b16 a[254:255], v3 offset:54496
    ds_read_b128 v[20:23], v9 offset:800
    v_mfma_f32_16x16x32_bf16 v[176:179], a[228:231], v[92:95], v[176:179]
    s_mov_b32 s45, 1310720
    s_waitcnt lgkmcnt(10)
    buffer_load_dwordx4 v6, s[24:27], s45 offen lds
    v_mfma_f32_16x16x32_bf16 v[148:151], a[232:235], v[80:83], 0
    ds_read_b64_tr_b16 a[192:193], v3 offset:37120
    v_fma_mix_f32 v33, v98, v25, v29 op_sel:[1,0,0] op_sel_hi:[1,0,0]
    v_mfma_f32_16x16x32_bf16 v[148:151], a[236:239], v[84:87], v[148:151]
    ds_read_b64_tr_b16 a[194:195], v3 offset:37632
    ds_read_b64_tr_b16 a[196:197], v3 offset:54016
    v_fma_mix_f32 v34, v99, v26, v30 op_sel:[0,0,0] op_sel_hi:[1,0,0]
    v_mfma_f32_16x16x32_bf16 v[180:183], a[232:235], v[88:91], 0
    s_add_u32 m0, s44, 128544
    ds_read_b64_tr_b16 a[198:199], v3 offset:54528
    v_fma_mix_f32 v35, v99, v27, v31 op_sel:[1,0,0] op_sel_hi:[1,0,0]
    v_mfma_f32_16x16x32_bf16 v[180:183], a[236:239], v[92:95], v[180:183]
    s_mov_b32 s45, 1318912
    s_waitcnt lgkmcnt(10)
    buffer_load_dwordx4 v6, s[24:27], s45 offen lds
    v_mfma_f32_16x16x32_bf16 v[152:155], a[240:243], v[80:83], 0
    ds_read_b64_tr_b16 a[200:201], v3 offset:37152
    v_cvt_pk_bf16_f32 v98, v32, v33
    v_mfma_f32_16x16x32_bf16 v[152:155], a[244:247], v[84:87], v[152:155]
    ds_read_b64_tr_b16 a[202:203], v3 offset:37664
    ds_read_b64_tr_b16 a[204:205], v3 offset:54048
    v_cvt_pk_bf16_f32 v99, v34, v35
    v_mfma_f32_16x16x32_bf16 v[184:187], a[240:243], v[88:91], 0
    s_add_u32 m0, s44, 129600
    ds_read_b64_tr_b16 a[206:207], v3 offset:54560
    v_fma_mix_f32 v36, v106, v24, v28 op_sel:[0,0,0] op_sel_hi:[1,0,0]
    v_mfma_f32_16x16x32_bf16 v[184:187], a[244:247], v[92:95], v[184:187]
    s_mov_b32 s45, 1327104
    s_waitcnt lgkmcnt(9)
    buffer_load_dwordx4 v6, s[24:27], s45 offen lds
    v_fma_mix_f32 v37, v106, v25, v29 op_sel:[1,0,0] op_sel_hi:[1,0,0]
    v_mfma_f32_16x16x32_bf16 v[156:159], a[248:251], v[80:83], 0
    ds_read_b64_tr_b16 a[208:209], v3 offset:37184
    v_fma_mix_f32 v38, v107, v26, v30 op_sel:[0,0,0] op_sel_hi:[1,0,0]
    v_mfma_f32_16x16x32_bf16 v[156:159], a[252:255], v[84:87], v[156:159]
    ds_read_b64_tr_b16 a[210:211], v3 offset:37696
    ds_read_b64_tr_b16 a[212:213], v3 offset:54080
    v_fma_mix_f32 v39, v107, v27, v31 op_sel:[1,0,0] op_sel_hi:[1,0,0]
    v_mfma_f32_16x16x32_bf16 v[188:191], a[248:251], v[88:91], 0
    s_add_u32 m0, s44, 130656
    ds_read_b64_tr_b16 a[214:215], v3 offset:54592
    v_cvt_pk_bf16_f32 v106, v36, v37
    v_mfma_f32_16x16x32_bf16 v[188:191], a[252:255], v[92:95], v[188:191]
    s_mov_b32 s45, 1335296
    s_waitcnt lgkmcnt(8)
    buffer_load_dwordx4 v6, s[24:27], s45 offen lds
    v_cvt_pk_bf16_f32 v107, v38, v39
    v_mfma_f32_16x16x32_bf16 v[192:195], a[192:195], v[80:83], 0
    ds_read_b64_tr_b16 a[216:217], v3 offset:37216
    ds_read_b128 v[24:27], v9 offset:784
    v_mfma_f32_16x16x32_bf16 v[192:195], a[196:199], v[84:87], v[192:195]
    ds_read_b64_tr_b16 a[218:219], v3 offset:37728
    ds_read_b64_tr_b16 a[220:221], v3 offset:54112
    v_fma_mix_f32 v32, v100, v16, v20 op_sel:[0,0,0] op_sel_hi:[1,0,0]
    v_mfma_f32_16x16x32_bf16 v[224:227], a[192:195], v[88:91], 0
    s_mov_b32 s54, 6144
    ds_read_b64_tr_b16 a[222:223], v3 offset:54624
    ds_read_b128 v[28:31], v9 offset:816
    v_mfma_f32_16x16x32_bf16 v[224:227], a[196:199], v[92:95], v[224:227]
    s_waitcnt lgkmcnt(10)
    buffer_load_dwordx4 v[48:51], v8, s[32:35], s54 offen
    v_mfma_f32_16x16x32_bf16 v[196:199], a[200:203], v[80:83], 0
    ds_read_b64_tr_b16 a[224:225], v3 offset:37248
    v_fma_mix_f32 v33, v100, v17, v21 op_sel:[1,0,0] op_sel_hi:[1,0,0]
    v_mfma_f32_16x16x32_bf16 v[196:199], a[204:207], v[84:87], v[196:199]
    ds_read_b64_tr_b16 a[226:227], v3 offset:37760
    ds_read_b64_tr_b16 a[228:229], v3 offset:54144
    v_fma_mix_f32 v34, v101, v18, v22 op_sel:[0,0,0] op_sel_hi:[1,0,0]
    v_mfma_f32_16x16x32_bf16 v[228:231], a[200:203], v[88:91], 0
    s_mov_b32 s54, 7168
    ds_read_b64_tr_b16 a[230:231], v3 offset:54656
    v_fma_mix_f32 v35, v101, v19, v23 op_sel:[1,0,0] op_sel_hi:[1,0,0]
    v_mfma_f32_16x16x32_bf16 v[228:231], a[204:207], v[92:95], v[228:231]
    s_waitcnt lgkmcnt(10)
    buffer_load_dwordx4 v[52:55], v8, s[32:35], s54 offen
    v_mfma_f32_16x16x32_bf16 v[200:203], a[208:211], v[80:83], 0
    ds_read_b64_tr_b16 a[232:233], v3 offset:37280
    v_cvt_pk_bf16_f32 v100, v32, v33
    v_mfma_f32_16x16x32_bf16 v[200:203], a[212:215], v[84:87], v[200:203]
    ds_read_b64_tr_b16 a[234:235], v3 offset:37792
    ds_read_b64_tr_b16 a[236:237], v3 offset:54176
    v_cvt_pk_bf16_f32 v101, v34, v35
    v_mfma_f32_16x16x32_bf16 v[232:235], a[208:211], v[88:91], 0
    s_mov_b32 s54, 24576
    ds_read_b64_tr_b16 a[238:239], v3 offset:54688
    v_fma_mix_f32 v36, v108, v16, v20 op_sel:[0,0,0] op_sel_hi:[1,0,0]
    v_mfma_f32_16x16x32_bf16 v[232:235], a[212:215], v[92:95], v[232:235]
    s_waitcnt lgkmcnt(9)
    buffer_load_dwordx4 v[56:59], v8, s[32:35], s54 offen
    v_fma_mix_f32 v37, v108, v17, v21 op_sel:[1,0,0] op_sel_hi:[1,0,0]
    v_mfma_f32_16x16x32_bf16 v[204:207], a[216:219], v[80:83], 0
    ds_read_b64_tr_b16 a[240:241], v3 offset:37312
    v_fma_mix_f32 v38, v109, v18, v22 op_sel:[0,0,0] op_sel_hi:[1,0,0]
    v_mfma_f32_16x16x32_bf16 v[204:207], a[220:223], v[84:87], v[204:207]
    ds_read_b64_tr_b16 a[242:243], v3 offset:37824
    ds_read_b64_tr_b16 a[244:245], v3 offset:54208
    v_fma_mix_f32 v39, v109, v19, v23 op_sel:[1,0,0] op_sel_hi:[1,0,0]
    v_mfma_f32_16x16x32_bf16 v[236:239], a[216:219], v[88:91], 0
    s_mov_b32 s54, 25600
    ds_read_b64_tr_b16 a[246:247], v3 offset:54720
    v_cvt_pk_bf16_f32 v108, v36, v37
    v_mfma_f32_16x16x32_bf16 v[236:239], a[220:223], v[92:95], v[236:239]
    s_waitcnt lgkmcnt(8)
    buffer_load_dwordx4 v[60:63], v8, s[32:35], s54 offen
    v_cvt_pk_bf16_f32 v109, v38, v39
    v_mfma_f32_16x16x32_bf16 v[208:211], a[224:227], v[80:83], 0
    ds_read_b64_tr_b16 a[248:249], v3 offset:37344
    ds_read_b128 v[16:19], v9 offset:1024
    v_mfma_f32_16x16x32_bf16 v[208:211], a[228:231], v[84:87], v[208:211]
    ds_read_b64_tr_b16 a[250:251], v3 offset:37856
    ds_read_b128 v[20:23], v9 offset:1056
    v_mfma_f32_16x16x32_bf16 v[240:243], a[224:227], v[88:91], 0
    ds_read_b64_tr_b16 a[252:253], v3 offset:54240
    v_fma_mix_f32 v32, v102, v24, v28 op_sel:[0,0,0] op_sel_hi:[1,0,0]
    v_mfma_f32_16x16x32_bf16 v[240:243], a[228:231], v[92:95], v[240:243]
    s_waitcnt vmcnt(16)
    s_barrier
    s_waitcnt lgkmcnt(9)
    ds_read_b64_tr_b16 a[254:255], v3 offset:54752
    v_fma_mix_f32 v33, v102, v25, v29 op_sel:[1,0,0] op_sel_hi:[1,0,0]
    v_fma_mix_f32 v34, v103, v26, v30 op_sel:[0,0,0] op_sel_hi:[1,0,0]
    v_mfma_f32_16x16x32_bf16 v[212:215], a[232:235], v[80:83], 0
    ds_read_b64_tr_b16 a[192:193], v4 offset:0
    v_fma_mix_f32 v35, v103, v27, v31 op_sel:[1,0,0] op_sel_hi:[1,0,0]
    v_mfma_f32_16x16x32_bf16 v[212:215], a[236:239], v[84:87], v[212:215]
    ds_read_b64_tr_b16 a[194:195], v4 offset:512
    ds_read_b64_tr_b16 a[196:197], v4 offset:16896
    v_cvt_pk_bf16_f32 v102, v32, v33
    v_mfma_f32_16x16x32_bf16 v[244:247], a[232:235], v[88:91], 0
    s_add_u32 m0, s44, 0
    ds_read_b64_tr_b16 a[198:199], v4 offset:17408
    v_cvt_pk_bf16_f32 v103, v34, v35
    v_mfma_f32_16x16x32_bf16 v[244:247], a[236:239], v[92:95], v[244:247]
    s_mov_b32 s45, 1572864
    s_waitcnt lgkmcnt(10)
    buffer_load_dwordx4 v6, s[24:27], s45 offen lds
    v_mfma_f32_16x16x32_bf16 v[216:219], a[240:243], v[80:83], 0
    ds_read_b64_tr_b16 a[200:201], v4 offset:32
    v_fma_mix_f32 v36, v110, v24, v28 op_sel:[0,0,0] op_sel_hi:[1,0,0]
    v_mfma_f32_16x16x32_bf16 v[216:219], a[244:247], v[84:87], v[216:219]
    ds_read_b64_tr_b16 a[202:203], v4 offset:544
    ds_read_b64_tr_b16 a[204:205], v4 offset:16928
    v_fma_mix_f32 v37, v110, v25, v29 op_sel:[1,0,0] op_sel_hi:[1,0,0]
    v_mfma_f32_16x16x32_bf16 v[248:251], a[240:243], v[88:91], 0
    s_add_u32 m0, s44, 1056
    ds_read_b64_tr_b16 a[206:207], v4 offset:17440
    v_fma_mix_f32 v38, v111, v26, v30 op_sel:[0,0,0] op_sel_hi:[1,0,0]
    v_mfma_f32_16x16x32_bf16 v[248:251], a[244:247], v[92:95], v[248:251]
    s_mov_b32 s45, 1581056
    s_waitcnt lgkmcnt(8)
    buffer_load_dwordx4 v6, s[24:27], s45 offen lds
    v_mfma_f32_16x16x32_bf16 v[220:223], a[248:251], v[80:83], 0
    ds_read_b64_tr_b16 a[208:209], v4 offset:64
    v_fma_mix_f32 v39, v111, v27, v31 op_sel:[1,0,0] op_sel_hi:[1,0,0]
    v_mfma_f32_16x16x32_bf16 v[220:223], a[252:255], v[84:87], v[220:223]
    ds_read_b64_tr_b16 a[210:211], v4 offset:576
    ds_read_b64_tr_b16 a[212:213], v4 offset:16960
    v_cvt_pk_bf16_f32 v110, v36, v37
    v_mfma_f32_16x16x32_bf16 v[252:255], a[248:251], v[88:91], 0
    s_add_u32 m0, s44, 2112
    ds_read_b64_tr_b16 a[214:215], v4 offset:17472
    v_cvt_pk_bf16_f32 v111, v38, v39
    v_mfma_f32_16x16x32_bf16 v[252:255], a[252:255], v[92:95], v[252:255]
    s_mov_b32 s45, 1589248
    s_waitcnt lgkmcnt(8)
    buffer_load_dwordx4 v6, s[24:27], s45 offen lds
    v_mfma_f32_16x16x32_bf16 v[128:131], a[192:195], v[96:99], v[128:131]
    s_waitcnt vmcnt(15)
    ds_read_b64_tr_b16 a[216:217], v4 offset:96
    ds_read_b128 v[24:27], v9 offset:1040
    v_mfma_f32_16x16x32_bf16 v[128:131], a[196:199], v[100:103], v[128:131]
    ds_read_b64_tr_b16 a[218:219], v4 offset:608
    ds_read_b64_tr_b16 a[220:221], v4 offset:16992
    v_fma_mix_f32 v32, v112, v16, v20 op_sel:[0,0,0] op_sel_hi:[1,0,0]
    v_mfma_f32_16x16x32_bf16 v[160:163], a[192:195], v[104:107], v[160:163]
    s_add_u32 m0, s44, 3168
    ds_read_b64_tr_b16 a[222:223], v4 offset:17504
    ds_read_b128 v[28:31], v9 offset:1072
    v_mfma_f32_16x16x32_bf16 v[160:163], a[196:199], v[108:111], v[160:163]
    s_mov_b32 s45, 1597440
    s_waitcnt lgkmcnt(10)
    buffer_load_dwordx4 v6, s[24:27], s45 offen lds
    v_mfma_f32_16x16x32_bf16 v[132:135], a[200:203], v[96:99], v[132:135]
    ds_read_b64_tr_b16 a[224:225], v4 offset:128
    v_fma_mix_f32 v33, v112, v17, v21 op_sel:[1,0,0] op_sel_hi:[1,0,0]
    v_mfma_f32_16x16x32_bf16 v[132:135], a[204:207], v[100:103], v[132:135]
    ds_read_b64_tr_b16 a[226:227], v4 offset:640
    ds_read_b64_tr_b16 a[228:229], v4 offset:17024
    v_fma_mix_f32 v34, v113, v18, v22 op_sel:[0,0,0] op_sel_hi:[1,0,0]
    v_mfma_f32_16x16x32_bf16 v[164:167], a[200:203], v[104:107], v[164:167]
    s_add_u32 m0, s44, 16896
    ds_read_b64_tr_b16 a[230:231], v4 offset:17536
    v_fma_mix_f32 v35, v113, v19, v23 op_sel:[1,0,0] op_sel_hi:[1,0,0]
    v_mfma_f32_16x16x32_bf16 v[164:167], a[204:207], v[108:111], v[164:167]
    s_mov_b32 s45, 1835008
    s_waitcnt lgkmcnt(10)
    buffer_load_dwordx4 v6, s[24:27], s45 offen lds
    v_mfma_f32_16x16x32_bf16 v[136:139], a[208:211], v[96:99], v[136:139]
    ds_read_b64_tr_b16 a[232:233], v4 offset:160
    v_cvt_pk_bf16_f32 v112, v32, v33
    v_mfma_f32_16x16x32_bf16 v[136:139], a[212:215], v[100:103], v[136:139]
    ds_read_b64_tr_b16 a[234:235], v4 offset:672
    ds_read_b64_tr_b16 a[236:237], v4 offset:17056
    v_cvt_pk_bf16_f32 v113, v34, v35
    v_mfma_f32_16x16x32_bf16 v[168:171], a[208:211], v[104:107], v[168:171]
    s_add_u32 m0, s44, 17952
    ds_read_b64_tr_b16 a[238:239], v4 offset:17568
    v_fma_mix_f32 v36, v120, v16, v20 op_sel:[0,0,0] op_sel_hi:[1,0,0]
    v_mfma_f32_16x16x32_bf16 v[168:171], a[212:215], v[108:111], v[168:171]
    s_mov_b32 s45, 1843200
    s_waitcnt lgkmcnt(9)
    buffer_load_dwordx4 v6, s[24:27], s45 offen lds
    v_fma_mix_f32 v37, v120, v17, v21 op_sel:[1,0,0] op_sel_hi:[1,0,0]
    v_mfma_f32_16x16x32_bf16 v[140:143], a[216:219], v[96:99], v[140:143]
    ds_read_b64_tr_b16 a[240:241], v4 offset:192
    v_fma_mix_f32 v38, v121, v18, v22 op_sel:[0,0,0] op_sel_hi:[1,0,0]
    v_mfma_f32_16x16x32_bf16 v[140:143], a[220:223], v[100:103], v[140:143]
    ds_read_b64_tr_b16 a[242:243], v4 offset:704
    ds_read_b64_tr_b16 a[244:245], v4 offset:17088
    v_fma_mix_f32 v39, v121, v19, v23 op_sel:[1,0,0] op_sel_hi:[1,0,0]
    v_mfma_f32_16x16x32_bf16 v[172:175], a[216:219], v[104:107], v[172:175]
    s_add_u32 m0, s44, 19008
    ds_read_b64_tr_b16 a[246:247], v4 offset:17600
    v_cvt_pk_bf16_f32 v120, v36, v37
    v_mfma_f32_16x16x32_bf16 v[172:175], a[220:223], v[108:111], v[172:175]
    s_mov_b32 s45, 1851392
    s_waitcnt lgkmcnt(8)
    buffer_load_dwordx4 v6, s[24:27], s45 offen lds
    v_cvt_pk_bf16_f32 v121, v38, v39
    v_mfma_f32_16x16x32_bf16 v[144:147], a[224:227], v[96:99], v[144:147]
    ds_read_b64_tr_b16 a[248:249], v4 offset:224
    ds_read_b128 v[16:19], v9 offset:1280
    v_mfma_f32_16x16x32_bf16 v[144:147], a[228:231], v[100:103], v[144:147]
    ds_read_b64_tr_b16 a[250:251], v4 offset:736
    ds_read_b64_tr_b16 a[252:253], v4 offset:17120
    v_mfma_f32_16x16x32_bf16 v[176:179], a[224:227], v[104:107], v[176:179]
    s_add_u32 m0, s44, 20064
    ds_read_b64_tr_b16 a[254:255], v4 offset:17632
    ds_read_b128 v[20:23], v9 offset:1312
    v_mfma_f32_16x16x32_bf16 v[176:179], a[228:231], v[108:111], v[176:179]
    s_mov_b32 s45, 1859584
    s_waitcnt lgkmcnt(10)
    buffer_load_dwordx4 v6, s[24:27], s45 offen lds
    v_mfma_f32_16x16x32_bf16 v[148:151], a[232:235], v[96:99], v[148:151]
    ds_read_b64_tr_b16 a[192:193], v4 offset:256
    v_fma_mix_f32 v32, v114, v24, v28 op_sel:[0,0,0] op_sel_hi:[1,0,0]
    v_mfma_f32_16x16x32_bf16 v[148:151], a[236:239], v[100:103], v[148:151]
    ds_read_b64_tr_b16 a[194:195], v4 offset:768
    v_fma_mix_f32 v33, v114, v25, v29 op_sel:[1,0,0] op_sel_hi:[1,0,0]
    v_mfma_f32_16x16x32_bf16 v[180:183], a[232:235], v[104:107], v[180:183]
    ds_read_b64_tr_b16 a[196:197], v4 offset:17152
    v_fma_mix_f32 v34, v115, v26, v30 op_sel:[0,0,0] op_sel_hi:[1,0,0]
    v_mfma_f32_16x16x32_bf16 v[180:183], a[236:239], v[108:111], v[180:183]
    s_waitcnt lgkmcnt(9)
    ds_read_b64_tr_b16 a[198:199], v4 offset:17664
    v_fma_mix_f32 v35, v115, v27, v31 op_sel:[1,0,0] op_sel_hi:[1,0,0]
    v_mfma_f32_16x16x32_bf16 v[152:155], a[240:243], v[96:99], v[152:155]
    ds_read_b64_tr_b16 a[200:201], v4 offset:288
    v_cvt_pk_bf16_f32 v114, v32, v33
    v_mfma_f32_16x16x32_bf16 v[152:155], a[244:247], v[100:103], v[152:155]
    ds_read_b64_tr_b16 a[202:203], v4 offset:800
    v_cvt_pk_bf16_f32 v115, v34, v35
    v_mfma_f32_16x16x32_bf16 v[184:187], a[240:243], v[104:107], v[184:187]
    ds_read_b64_tr_b16 a[204:205], v4 offset:17184
    v_fma_mix_f32 v36, v122, v24, v28 op_sel:[0,0,0] op_sel_hi:[1,0,0]
    v_mfma_f32_16x16x32_bf16 v[184:187], a[244:247], v[108:111], v[184:187]
    s_waitcnt lgkmcnt(8)
    ds_read_b64_tr_b16 a[206:207], v4 offset:17696
    v_fma_mix_f32 v37, v122, v25, v29 op_sel:[1,0,0] op_sel_hi:[1,0,0]
    v_mfma_f32_16x16x32_bf16 v[156:159], a[248:251], v[96:99], v[156:159]
    ds_read_b64_tr_b16 a[208:209], v4 offset:320
    v_fma_mix_f32 v38, v123, v26, v30 op_sel:[0,0,0] op_sel_hi:[1,0,0]
    v_mfma_f32_16x16x32_bf16 v[156:159], a[252:255], v[100:103], v[156:159]
    ds_read_b64_tr_b16 a[210:211], v4 offset:832
    v_fma_mix_f32 v39, v123, v27, v31 op_sel:[1,0,0] op_sel_hi:[1,0,0]
    v_mfma_f32_16x16x32_bf16 v[188:191], a[248:251], v[104:107], v[188:191]
    ds_read_b64_tr_b16 a[212:213], v4 offset:17216
    v_cvt_pk_bf16_f32 v122, v36, v37
    v_mfma_f32_16x16x32_bf16 v[188:191], a[252:255], v[108:111], v[188:191]
    s_waitcnt lgkmcnt(7)
    ds_read_b64_tr_b16 a[214:215], v4 offset:17728
    v_cvt_pk_bf16_f32 v123, v38, v39
    v_mfma_f32_16x16x32_bf16 v[192:195], a[192:195], v[96:99], v[192:195]
    ds_read_b64_tr_b16 a[216:217], v4 offset:352
    ds_read_b128 v[24:27], v9 offset:1296
    v_mfma_f32_16x16x32_bf16 v[192:195], a[196:199], v[100:103], v[192:195]
    ds_read_b64_tr_b16 a[218:219], v4 offset:864
    ds_read_b64_tr_b16 a[220:221], v4 offset:17248
    v_fma_mix_f32 v32, v116, v16, v20 op_sel:[0,0,0] op_sel_hi:[1,0,0]
    v_mfma_f32_16x16x32_bf16 v[224:227], a[192:195], v[104:107], v[224:227]
    s_mov_b32 s54, 8192
    ds_read_b64_tr_b16 a[222:223], v4 offset:17760
    ds_read_b128 v[28:31], v9 offset:1328
    v_mfma_f32_16x16x32_bf16 v[224:227], a[196:199], v[108:111], v[224:227]
    s_waitcnt lgkmcnt(10)
    buffer_load_dwordx4 v[64:67], v8, s[32:35], s54 offen
    v_mfma_f32_16x16x32_bf16 v[196:199], a[200:203], v[96:99], v[196:199]
    ds_read_b64_tr_b16 a[224:225], v4 offset:384
    v_fma_mix_f32 v33, v116, v17, v21 op_sel:[1,0,0] op_sel_hi:[1,0,0]
    v_mfma_f32_16x16x32_bf16 v[196:199], a[204:207], v[100:103], v[196:199]
    ds_read_b64_tr_b16 a[226:227], v4 offset:896
    ds_read_b64_tr_b16 a[228:229], v4 offset:17280
    v_fma_mix_f32 v34, v117, v18, v22 op_sel:[0,0,0] op_sel_hi:[1,0,0]
    v_mfma_f32_16x16x32_bf16 v[228:231], a[200:203], v[104:107], v[228:231]
    s_mov_b32 s54, 9216
    ds_read_b64_tr_b16 a[230:231], v4 offset:17792
    v_fma_mix_f32 v35, v117, v19, v23 op_sel:[1,0,0] op_sel_hi:[1,0,0]
    v_mfma_f32_16x16x32_bf16 v[228:231], a[204:207], v[108:111], v[228:231]
    s_waitcnt lgkmcnt(10)
    buffer_load_dwordx4 v[68:71], v8, s[32:35], s54 offen
    v_mfma_f32_16x16x32_bf16 v[200:203], a[208:211], v[96:99], v[200:203]
    ds_read_b64_tr_b16 a[232:233], v4 offset:416
    v_cvt_pk_bf16_f32 v116, v32, v33
    v_mfma_f32_16x16x32_bf16 v[200:203], a[212:215], v[100:103], v[200:203]
    ds_read_b64_tr_b16 a[234:235], v4 offset:928
    ds_read_b64_tr_b16 a[236:237], v4 offset:17312
    v_cvt_pk_bf16_f32 v117, v34, v35
    v_mfma_f32_16x16x32_bf16 v[232:235], a[208:211], v[104:107], v[232:235]
    s_mov_b32 s54, 26624
    ds_read_b64_tr_b16 a[238:239], v4 offset:17824
    v_fma_mix_f32 v36, v124, v16, v20 op_sel:[0,0,0] op_sel_hi:[1,0,0]
    v_mfma_f32_16x16x32_bf16 v[232:235], a[212:215], v[108:111], v[232:235]
    s_waitcnt lgkmcnt(9)
    buffer_load_dwordx4 v[72:75], v8, s[32:35], s54 offen
    v_fma_mix_f32 v37, v124, v17, v21 op_sel:[1,0,0] op_sel_hi:[1,0,0]
    v_mfma_f32_16x16x32_bf16 v[204:207], a[216:219], v[96:99], v[204:207]
    ds_read_b64_tr_b16 a[240:241], v4 offset:448
    v_fma_mix_f32 v38, v125, v18, v22 op_sel:[0,0,0] op_sel_hi:[1,0,0]
    v_mfma_f32_16x16x32_bf16 v[204:207], a[220:223], v[100:103], v[204:207]
    ds_read_b64_tr_b16 a[242:243], v4 offset:960
    ds_read_b64_tr_b16 a[244:245], v4 offset:17344
    v_fma_mix_f32 v39, v125, v19, v23 op_sel:[1,0,0] op_sel_hi:[1,0,0]
    v_mfma_f32_16x16x32_bf16 v[236:239], a[216:219], v[104:107], v[236:239]
    s_mov_b32 s54, 27648
    ds_read_b64_tr_b16 a[246:247], v4 offset:17856
    v_cvt_pk_bf16_f32 v124, v36, v37
    v_mfma_f32_16x16x32_bf16 v[236:239], a[220:223], v[108:111], v[236:239]
    s_waitcnt lgkmcnt(8)
    buffer_load_dwordx4 v[76:79], v8, s[32:35], s54 offen
    v_cvt_pk_bf16_f32 v125, v38, v39
    v_mfma_f32_16x16x32_bf16 v[208:211], a[224:227], v[96:99], v[208:211]
    ds_read_b64_tr_b16 a[248:249], v4 offset:480
    ds_read_b128 v[16:19], v9 offset:1536
    v_mfma_f32_16x16x32_bf16 v[208:211], a[228:231], v[100:103], v[208:211]
    ds_read_b64_tr_b16 a[250:251], v4 offset:992
    ds_read_b128 v[20:23], v9 offset:1568
    v_mfma_f32_16x16x32_bf16 v[240:243], a[224:227], v[104:107], v[240:243]
    ds_read_b64_tr_b16 a[252:253], v4 offset:17376
    v_fma_mix_f32 v32, v118, v24, v28 op_sel:[0,0,0] op_sel_hi:[1,0,0]
    v_mfma_f32_16x16x32_bf16 v[240:243], a[228:231], v[108:111], v[240:243]
    s_waitcnt vmcnt(16)
    s_barrier
    s_waitcnt lgkmcnt(9)
    ds_read_b64_tr_b16 a[254:255], v4 offset:17888
    v_fma_mix_f32 v33, v118, v25, v29 op_sel:[1,0,0] op_sel_hi:[1,0,0]
    v_fma_mix_f32 v34, v119, v26, v30 op_sel:[0,0,0] op_sel_hi:[1,0,0]
    v_mfma_f32_16x16x32_bf16 v[212:215], a[232:235], v[96:99], v[212:215]
    ds_read_b64_tr_b16 a[192:193], v4 offset:36864
    v_fma_mix_f32 v35, v119, v27, v31 op_sel:[1,0,0] op_sel_hi:[1,0,0]
    v_mfma_f32_16x16x32_bf16 v[212:215], a[236:239], v[100:103], v[212:215]
    ds_read_b64_tr_b16 a[194:195], v4 offset:37376
    ds_read_b64_tr_b16 a[196:197], v4 offset:53760
    v_cvt_pk_bf16_f32 v118, v32, v33
    v_mfma_f32_16x16x32_bf16 v[244:247], a[232:235], v[104:107], v[244:247]
    s_add_u32 m0, s44, 36864
    ds_read_b64_tr_b16 a[198:199], v4 offset:54272
    v_cvt_pk_bf16_f32 v119, v34, v35
    v_mfma_f32_16x16x32_bf16 v[244:247], a[236:239], v[108:111], v[244:247]
    s_mov_b32 s45, 2097152
    s_waitcnt lgkmcnt(10)
    buffer_load_dwordx4 v6, s[24:27], s45 offen lds
    v_mfma_f32_16x16x32_bf16 v[216:219], a[240:243], v[96:99], v[216:219]
    ds_read_b64_tr_b16 a[200:201], v4 offset:36896
    v_fma_mix_f32 v36, v126, v24, v28 op_sel:[0,0,0] op_sel_hi:[1,0,0]
    v_mfma_f32_16x16x32_bf16 v[216:219], a[244:247], v[100:103], v[216:219]
    ds_read_b64_tr_b16 a[202:203], v4 offset:37408
    ds_read_b64_tr_b16 a[204:205], v4 offset:53792
    v_fma_mix_f32 v37, v126, v25, v29 op_sel:[1,0,0] op_sel_hi:[1,0,0]
    v_mfma_f32_16x16x32_bf16 v[248:251], a[240:243], v[104:107], v[248:251]
    s_add_u32 m0, s44, 37920
    ds_read_b64_tr_b16 a[206:207], v4 offset:54304
    v_fma_mix_f32 v38, v127, v26, v30 op_sel:[0,0,0] op_sel_hi:[1,0,0]
    v_mfma_f32_16x16x32_bf16 v[248:251], a[244:247], v[108:111], v[248:251]
    s_mov_b32 s45, 2105344
    s_waitcnt lgkmcnt(8)
    buffer_load_dwordx4 v6, s[24:27], s45 offen lds
    v_mfma_f32_16x16x32_bf16 v[220:223], a[248:251], v[96:99], v[220:223]
    ds_read_b64_tr_b16 a[208:209], v4 offset:36928
    v_fma_mix_f32 v39, v127, v27, v31 op_sel:[1,0,0] op_sel_hi:[1,0,0]
    v_mfma_f32_16x16x32_bf16 v[220:223], a[252:255], v[100:103], v[220:223]
    ds_read_b64_tr_b16 a[210:211], v4 offset:37440
    ds_read_b64_tr_b16 a[212:213], v4 offset:53824
    v_cvt_pk_bf16_f32 v126, v36, v37
    v_mfma_f32_16x16x32_bf16 v[252:255], a[248:251], v[104:107], v[252:255]
    s_add_u32 m0, s44, 38976
    ds_read_b64_tr_b16 a[214:215], v4 offset:54336
    v_cvt_pk_bf16_f32 v127, v38, v39
    v_mfma_f32_16x16x32_bf16 v[252:255], a[252:255], v[108:111], v[252:255]
    s_mov_b32 s45, 2113536
    s_waitcnt lgkmcnt(8)
    buffer_load_dwordx4 v6, s[24:27], s45 offen lds
    v_mfma_f32_16x16x32_bf16 v[128:131], a[192:195], v[112:115], v[128:131]
    s_waitcnt vmcnt(15)
    ds_read_b64_tr_b16 a[216:217], v4 offset:36960
    ds_read_b128 v[24:27], v9 offset:1552
    v_mfma_f32_16x16x32_bf16 v[128:131], a[196:199], v[116:119], v[128:131]
    ds_read_b64_tr_b16 a[218:219], v4 offset:37472
    ds_read_b64_tr_b16 a[220:221], v4 offset:53856
    v_fma_mix_f32 v32, v48, v16, v20 op_sel:[0,0,0] op_sel_hi:[1,0,0]
    v_mfma_f32_16x16x32_bf16 v[160:163], a[192:195], v[120:123], v[160:163]
    s_add_u32 m0, s44, 40032
    ds_read_b64_tr_b16 a[222:223], v4 offset:54368
    ds_read_b128 v[28:31], v9 offset:1584
    v_mfma_f32_16x16x32_bf16 v[160:163], a[196:199], v[124:127], v[160:163]
    s_mov_b32 s45, 2121728
    s_waitcnt lgkmcnt(10)
    buffer_load_dwordx4 v6, s[24:27], s45 offen lds
    v_mfma_f32_16x16x32_bf16 v[132:135], a[200:203], v[112:115], v[132:135]
    ds_read_b64_tr_b16 a[224:225], v4 offset:36992
    v_fma_mix_f32 v33, v48, v17, v21 op_sel:[1,0,0] op_sel_hi:[1,0,0]
    v_mfma_f32_16x16x32_bf16 v[132:135], a[204:207], v[116:119], v[132:135]
    ds_read_b64_tr_b16 a[226:227], v4 offset:37504
    ds_read_b64_tr_b16 a[228:229], v4 offset:53888
    v_fma_mix_f32 v34, v49, v18, v22 op_sel:[0,0,0] op_sel_hi:[1,0,0]
    v_mfma_f32_16x16x32_bf16 v[164:167], a[200:203], v[120:123], v[164:167]
    s_add_u32 m0, s44, 53760
    ds_read_b64_tr_b16 a[230:231], v4 offset:54400
    v_fma_mix_f32 v35, v49, v19, v23 op_sel:[1,0,0] op_sel_hi:[1,0,0]
    v_mfma_f32_16x16x32_bf16 v[164:167], a[204:207], v[124:127], v[164:167]
    s_mov_b32 s45, 2359296
    s_waitcnt lgkmcnt(10)
    buffer_load_dwordx4 v6, s[24:27], s45 offen lds
    v_mfma_f32_16x16x32_bf16 v[136:139], a[208:211], v[112:115], v[136:139]
    ds_read_b64_tr_b16 a[232:233], v4 offset:37024
    v_cvt_pk_bf16_f32 v48, v32, v33
    v_mfma_f32_16x16x32_bf16 v[136:139], a[212:215], v[116:119], v[136:139]
    ds_read_b64_tr_b16 a[234:235], v4 offset:37536
    ds_read_b64_tr_b16 a[236:237], v4 offset:53920
    v_cvt_pk_bf16_f32 v49, v34, v35
    v_mfma_f32_16x16x32_bf16 v[168:171], a[208:211], v[120:123], v[168:171]
    s_add_u32 m0, s44, 54816
    ds_read_b64_tr_b16 a[238:239], v4 offset:54432
    v_fma_mix_f32 v36, v56, v16, v20 op_sel:[0,0,0] op_sel_hi:[1,0,0]
    v_mfma_f32_16x16x32_bf16 v[168:171], a[212:215], v[124:127], v[168:171]
    s_mov_b32 s45, 2367488
    s_waitcnt lgkmcnt(9)
    buffer_load_dwordx4 v6, s[24:27], s45 offen lds
    v_fma_mix_f32 v37, v56, v17, v21 op_sel:[1,0,0] op_sel_hi:[1,0,0]
    v_mfma_f32_16x16x32_bf16 v[140:143], a[216:219], v[112:115], v[140:143]
    ds_read_b64_tr_b16 a[240:241], v4 offset:37056
    v_fma_mix_f32 v38, v57, v18, v22 op_sel:[0,0,0] op_sel_hi:[1,0,0]
    v_mfma_f32_16x16x32_bf16 v[140:143], a[220:223], v[116:119], v[140:143]
    ds_read_b64_tr_b16 a[242:243], v4 offset:37568
    ds_read_b64_tr_b16 a[244:245], v4 offset:53952
    v_fma_mix_f32 v39, v57, v19, v23 op_sel:[1,0,0] op_sel_hi:[1,0,0]
    v_mfma_f32_16x16x32_bf16 v[172:175], a[216:219], v[120:123], v[172:175]
    s_add_u32 m0, s44, 55872
    ds_read_b64_tr_b16 a[246:247], v4 offset:54464
    v_cvt_pk_bf16_f32 v56, v36, v37
    v_mfma_f32_16x16x32_bf16 v[172:175], a[220:223], v[124:127], v[172:175]
    s_mov_b32 s45, 2375680
    s_waitcnt lgkmcnt(8)
    buffer_load_dwordx4 v6, s[24:27], s45 offen lds
    v_cvt_pk_bf16_f32 v57, v38, v39
    v_mfma_f32_16x16x32_bf16 v[144:147], a[224:227], v[112:115], v[144:147]
    ds_read_b64_tr_b16 a[248:249], v4 offset:37088
    ds_read_b128 v[16:19], v9 offset:1792
    v_mfma_f32_16x16x32_bf16 v[144:147], a[228:231], v[116:119], v[144:147]
    ds_read_b64_tr_b16 a[250:251], v4 offset:37600
    ds_read_b64_tr_b16 a[252:253], v4 offset:53984
    v_mfma_f32_16x16x32_bf16 v[176:179], a[224:227], v[120:123], v[176:179]
    s_add_u32 m0, s44, 56928
    ds_read_b64_tr_b16 a[254:255], v4 offset:54496
    ds_read_b128 v[20:23], v9 offset:1824
    v_mfma_f32_16x16x32_bf16 v[176:179], a[228:231], v[124:127], v[176:179]
    s_mov_b32 s45, 2383872
    s_waitcnt lgkmcnt(10)
    buffer_load_dwordx4 v6, s[24:27], s45 offen lds
    v_mfma_f32_16x16x32_bf16 v[148:151], a[232:235], v[112:115], v[148:151]
    ds_read_b64_tr_b16 a[192:193], v4 offset:37120
    v_fma_mix_f32 v32, v50, v24, v28 op_sel:[0,0,0] op_sel_hi:[1,0,0]
    v_mfma_f32_16x16x32_bf16 v[148:151], a[236:239], v[116:119], v[148:151]
    ds_read_b64_tr_b16 a[194:195], v4 offset:37632
    v_fma_mix_f32 v33, v50, v25, v29 op_sel:[1,0,0] op_sel_hi:[1,0,0]
    v_mfma_f32_16x16x32_bf16 v[180:183], a[232:235], v[120:123], v[180:183]
    ds_read_b64_tr_b16 a[196:197], v4 offset:54016
    v_fma_mix_f32 v34, v51, v26, v30 op_sel:[0,0,0] op_sel_hi:[1,0,0]
    v_mfma_f32_16x16x32_bf16 v[180:183], a[236:239], v[124:127], v[180:183]
    s_waitcnt lgkmcnt(9)
    ds_read_b64_tr_b16 a[198:199], v4 offset:54528
    v_fma_mix_f32 v35, v51, v27, v31 op_sel:[1,0,0] op_sel_hi:[1,0,0]
    v_mfma_f32_16x16x32_bf16 v[152:155], a[240:243], v[112:115], v[152:155]
    ds_read_b64_tr_b16 a[200:201], v4 offset:37152
    v_cvt_pk_bf16_f32 v50, v32, v33
    v_mfma_f32_16x16x32_bf16 v[152:155], a[244:247], v[116:119], v[152:155]
    ds_read_b64_tr_b16 a[202:203], v4 offset:37664
    v_cvt_pk_bf16_f32 v51, v34, v35
    v_mfma_f32_16x16x32_bf16 v[184:187], a[240:243], v[120:123], v[184:187]
    ds_read_b64_tr_b16 a[204:205], v4 offset:54048
    v_fma_mix_f32 v36, v58, v24, v28 op_sel:[0,0,0] op_sel_hi:[1,0,0]
    v_mfma_f32_16x16x32_bf16 v[184:187], a[244:247], v[124:127], v[184:187]
    s_waitcnt lgkmcnt(8)
    ds_read_b64_tr_b16 a[206:207], v4 offset:54560
    v_fma_mix_f32 v37, v58, v25, v29 op_sel:[1,0,0] op_sel_hi:[1,0,0]
    v_mfma_f32_16x16x32_bf16 v[156:159], a[248:251], v[112:115], v[156:159]
    ds_read_b64_tr_b16 a[208:209], v4 offset:37184
    v_fma_mix_f32 v38, v59, v26, v30 op_sel:[0,0,0] op_sel_hi:[1,0,0]
    v_mfma_f32_16x16x32_bf16 v[156:159], a[252:255], v[116:119], v[156:159]
    ds_read_b64_tr_b16 a[210:211], v4 offset:37696
    v_fma_mix_f32 v39, v59, v27, v31 op_sel:[1,0,0] op_sel_hi:[1,0,0]
    v_mfma_f32_16x16x32_bf16 v[188:191], a[248:251], v[120:123], v[188:191]
    ds_read_b64_tr_b16 a[212:213], v4 offset:54080
    v_cvt_pk_bf16_f32 v58, v36, v37
    v_mfma_f32_16x16x32_bf16 v[188:191], a[252:255], v[124:127], v[188:191]
    s_waitcnt lgkmcnt(7)
    ds_read_b64_tr_b16 a[214:215], v4 offset:54592
    v_cvt_pk_bf16_f32 v59, v38, v39
    v_mfma_f32_16x16x32_bf16 v[192:195], a[192:195], v[112:115], v[192:195]
    ds_read_b64_tr_b16 a[216:217], v4 offset:37216
    ds_read_b128 v[24:27], v9 offset:1808
    v_mfma_f32_16x16x32_bf16 v[192:195], a[196:199], v[116:119], v[192:195]
    ds_read_b64_tr_b16 a[218:219], v4 offset:37728
    ds_read_b64_tr_b16 a[220:221], v4 offset:54112
    v_fma_mix_f32 v32, v52, v16, v20 op_sel:[0,0,0] op_sel_hi:[1,0,0]
    v_mfma_f32_16x16x32_bf16 v[224:227], a[192:195], v[120:123], v[224:227]
    s_mov_b32 s54, 10240
    ds_read_b64_tr_b16 a[222:223], v4 offset:54624
    ds_read_b128 v[28:31], v9 offset:1840
    v_mfma_f32_16x16x32_bf16 v[224:227], a[196:199], v[124:127], v[224:227]
    s_waitcnt lgkmcnt(10)
    buffer_load_dwordx4 v[80:83], v8, s[32:35], s54 offen
    v_mfma_f32_16x16x32_bf16 v[196:199], a[200:203], v[112:115], v[196:199]
    ds_read_b64_tr_b16 a[224:225], v4 offset:37248
    v_fma_mix_f32 v33, v52, v17, v21 op_sel:[1,0,0] op_sel_hi:[1,0,0]
    v_mfma_f32_16x16x32_bf16 v[196:199], a[204:207], v[116:119], v[196:199]
    ds_read_b64_tr_b16 a[226:227], v4 offset:37760
    ds_read_b64_tr_b16 a[228:229], v4 offset:54144
    v_fma_mix_f32 v34, v53, v18, v22 op_sel:[0,0,0] op_sel_hi:[1,0,0]
    v_mfma_f32_16x16x32_bf16 v[228:231], a[200:203], v[120:123], v[228:231]
    s_mov_b32 s54, 11264
    ds_read_b64_tr_b16 a[230:231], v4 offset:54656
    v_fma_mix_f32 v35, v53, v19, v23 op_sel:[1,0,0] op_sel_hi:[1,0,0]
    v_mfma_f32_16x16x32_bf16 v[228:231], a[204:207], v[124:127], v[228:231]
    s_waitcnt lgkmcnt(10)
    buffer_load_dwordx4 v[84:87], v8, s[32:35], s54 offen
    v_mfma_f32_16x16x32_bf16 v[200:203], a[208:211], v[112:115], v[200:203]
    ds_read_b64_tr_b16 a[232:233], v4 offset:37280
    v_cvt_pk_bf16_f32 v52, v32, v33
    v_mfma_f32_16x16x32_bf16 v[200:203], a[212:215], v[116:119], v[200:203]
    ds_read_b64_tr_b16 a[234:235], v4 offset:37792
    ds_read_b64_tr_b16 a[236:237], v4 offset:54176
    v_cvt_pk_bf16_f32 v53, v34, v35
    v_mfma_f32_16x16x32_bf16 v[232:235], a[208:211], v[120:123], v[232:235]
    s_mov_b32 s54, 28672
    ds_read_b64_tr_b16 a[238:239], v4 offset:54688
    v_fma_mix_f32 v36, v60, v16, v20 op_sel:[0,0,0] op_sel_hi:[1,0,0]
    v_mfma_f32_16x16x32_bf16 v[232:235], a[212:215], v[124:127], v[232:235]
    s_waitcnt lgkmcnt(9)
    buffer_load_dwordx4 v[88:91], v8, s[32:35], s54 offen
    v_fma_mix_f32 v37, v60, v17, v21 op_sel:[1,0,0] op_sel_hi:[1,0,0]
    v_mfma_f32_16x16x32_bf16 v[204:207], a[216:219], v[112:115], v[204:207]
    ds_read_b64_tr_b16 a[240:241], v4 offset:37312
    v_fma_mix_f32 v38, v61, v18, v22 op_sel:[0,0,0] op_sel_hi:[1,0,0]
    v_mfma_f32_16x16x32_bf16 v[204:207], a[220:223], v[116:119], v[204:207]
    ds_read_b64_tr_b16 a[242:243], v4 offset:37824
    ds_read_b64_tr_b16 a[244:245], v4 offset:54208
    v_fma_mix_f32 v39, v61, v19, v23 op_sel:[1,0,0] op_sel_hi:[1,0,0]
    v_mfma_f32_16x16x32_bf16 v[236:239], a[216:219], v[120:123], v[236:239]
    s_mov_b32 s54, 29696
    ds_read_b64_tr_b16 a[246:247], v4 offset:54720
    v_cvt_pk_bf16_f32 v60, v36, v37
    v_mfma_f32_16x16x32_bf16 v[236:239], a[220:223], v[124:127], v[236:239]
    s_waitcnt lgkmcnt(8)
    buffer_load_dwordx4 v[92:95], v8, s[32:35], s54 offen
    v_cvt_pk_bf16_f32 v61, v38, v39
    v_mfma_f32_16x16x32_bf16 v[208:211], a[224:227], v[112:115], v[208:211]
    ds_read_b64_tr_b16 a[248:249], v4 offset:37344
    ds_read_b128 v[16:19], v9 offset:2048
    v_mfma_f32_16x16x32_bf16 v[208:211], a[228:231], v[116:119], v[208:211]
    ds_read_b64_tr_b16 a[250:251], v4 offset:37856
    ds_read_b128 v[20:23], v9 offset:2080
    v_mfma_f32_16x16x32_bf16 v[240:243], a[224:227], v[120:123], v[240:243]
    ds_read_b64_tr_b16 a[252:253], v4 offset:54240
    v_fma_mix_f32 v32, v54, v24, v28 op_sel:[0,0,0] op_sel_hi:[1,0,0]
    v_mfma_f32_16x16x32_bf16 v[240:243], a[228:231], v[124:127], v[240:243]
    s_waitcnt vmcnt(16)
    s_barrier
    s_waitcnt lgkmcnt(9)
    ds_read_b64_tr_b16 a[254:255], v4 offset:54752
    v_fma_mix_f32 v33, v54, v25, v29 op_sel:[1,0,0] op_sel_hi:[1,0,0]
    v_fma_mix_f32 v34, v55, v26, v30 op_sel:[0,0,0] op_sel_hi:[1,0,0]
    v_mfma_f32_16x16x32_bf16 v[212:215], a[232:235], v[112:115], v[212:215]
    ds_read_b64_tr_b16 a[192:193], v3 offset:0
    v_fma_mix_f32 v35, v55, v27, v31 op_sel:[1,0,0] op_sel_hi:[1,0,0]
    v_mfma_f32_16x16x32_bf16 v[212:215], a[236:239], v[116:119], v[212:215]
    ds_read_b64_tr_b16 a[194:195], v3 offset:512
    ds_read_b64_tr_b16 a[196:197], v3 offset:16896
    v_cvt_pk_bf16_f32 v54, v32, v33
    v_mfma_f32_16x16x32_bf16 v[244:247], a[232:235], v[120:123], v[244:247]
    s_add_u32 m0, s44, 73728
    ds_read_b64_tr_b16 a[198:199], v3 offset:17408
    v_cvt_pk_bf16_f32 v55, v34, v35
    v_mfma_f32_16x16x32_bf16 v[244:247], a[236:239], v[124:127], v[244:247]
    s_mov_b32 s45, 2621440
    s_waitcnt lgkmcnt(10)
    buffer_load_dwordx4 v6, s[24:27], s45 offen lds
    v_mfma_f32_16x16x32_bf16 v[216:219], a[240:243], v[112:115], v[216:219]
    ds_read_b64_tr_b16 a[200:201], v3 offset:32
    v_fma_mix_f32 v36, v62, v24, v28 op_sel:[0,0,0] op_sel_hi:[1,0,0]
    v_mfma_f32_16x16x32_bf16 v[216:219], a[244:247], v[116:119], v[216:219]
    ds_read_b64_tr_b16 a[202:203], v3 offset:544
    ds_read_b64_tr_b16 a[204:205], v3 offset:16928
    v_fma_mix_f32 v37, v62, v25, v29 op_sel:[1,0,0] op_sel_hi:[1,0,0]
    v_mfma_f32_16x16x32_bf16 v[248:251], a[240:243], v[120:123], v[248:251]
    s_add_u32 m0, s44, 74784
    ds_read_b64_tr_b16 a[206:207], v3 offset:17440
    v_fma_mix_f32 v38, v63, v26, v30 op_sel:[0,0,0] op_sel_hi:[1,0,0]
    v_mfma_f32_16x16x32_bf16 v[248:251], a[244:247], v[124:127], v[248:251]
    s_mov_b32 s45, 2629632
    s_waitcnt lgkmcnt(8)
    buffer_load_dwordx4 v6, s[24:27], s45 offen lds
    v_mfma_f32_16x16x32_bf16 v[220:223], a[248:251], v[112:115], v[220:223]
    ds_read_b64_tr_b16 a[208:209], v3 offset:64
    v_fma_mix_f32 v39, v63, v27, v31 op_sel:[1,0,0] op_sel_hi:[1,0,0]
    v_mfma_f32_16x16x32_bf16 v[220:223], a[252:255], v[116:119], v[220:223]
    ds_read_b64_tr_b16 a[210:211], v3 offset:576
    ds_read_b64_tr_b16 a[212:213], v3 offset:16960
    v_cvt_pk_bf16_f32 v62, v36, v37
    v_mfma_f32_16x16x32_bf16 v[252:255], a[248:251], v[120:123], v[252:255]
    s_add_u32 m0, s44, 75840
    ds_read_b64_tr_b16 a[214:215], v3 offset:17472
    v_cvt_pk_bf16_f32 v63, v38, v39
    v_mfma_f32_16x16x32_bf16 v[252:255], a[252:255], v[124:127], v[252:255]
    s_mov_b32 s45, 2637824
    s_waitcnt lgkmcnt(8)
    buffer_load_dwordx4 v6, s[24:27], s45 offen lds
    v_mfma_f32_16x16x32_bf16 v[128:131], a[192:195], v[48:51], v[128:131]
    s_waitcnt vmcnt(15)
    ds_read_b64_tr_b16 a[216:217], v3 offset:96
    ds_read_b128 v[24:27], v9 offset:2064
    v_mfma_f32_16x16x32_bf16 v[128:131], a[196:199], v[52:55], v[128:131]
    ds_read_b64_tr_b16 a[218:219], v3 offset:608
    ds_read_b64_tr_b16 a[220:221], v3 offset:16992
    v_fma_mix_f32 v32, v64, v16, v20 op_sel:[0,0,0] op_sel_hi:[1,0,0]
    v_mfma_f32_16x16x32_bf16 v[160:163], a[192:195], v[56:59], v[160:163]
    s_add_u32 m0, s44, 76896
    ds_read_b64_tr_b16 a[222:223], v3 offset:17504
    ds_read_b128 v[28:31], v9 offset:2096
    v_mfma_f32_16x16x32_bf16 v[160:163], a[196:199], v[60:63], v[160:163]
    s_mov_b32 s45, 2646016
    s_waitcnt lgkmcnt(10)
    buffer_load_dwordx4 v6, s[24:27], s45 offen lds
    v_mfma_f32_16x16x32_bf16 v[132:135], a[200:203], v[48:51], v[132:135]
    ds_read_b64_tr_b16 a[224:225], v3 offset:128
    v_fma_mix_f32 v33, v64, v17, v21 op_sel:[1,0,0] op_sel_hi:[1,0,0]
    v_mfma_f32_16x16x32_bf16 v[132:135], a[204:207], v[52:55], v[132:135]
    ds_read_b64_tr_b16 a[226:227], v3 offset:640
    ds_read_b64_tr_b16 a[228:229], v3 offset:17024
    v_fma_mix_f32 v34, v65, v18, v22 op_sel:[0,0,0] op_sel_hi:[1,0,0]
    v_mfma_f32_16x16x32_bf16 v[164:167], a[200:203], v[56:59], v[164:167]
    s_add_u32 m0, s44, 90624
    ds_read_b64_tr_b16 a[230:231], v3 offset:17536
    v_fma_mix_f32 v35, v65, v19, v23 op_sel:[1,0,0] op_sel_hi:[1,0,0]
    v_mfma_f32_16x16x32_bf16 v[164:167], a[204:207], v[60:63], v[164:167]
    s_mov_b32 s45, 2883584
    s_waitcnt lgkmcnt(10)
    buffer_load_dwordx4 v6, s[24:27], s45 offen lds
    v_mfma_f32_16x16x32_bf16 v[136:139], a[208:211], v[48:51], v[136:139]
    ds_read_b64_tr_b16 a[232:233], v3 offset:160
    v_cvt_pk_bf16_f32 v64, v32, v33
    v_mfma_f32_16x16x32_bf16 v[136:139], a[212:215], v[52:55], v[136:139]
    ds_read_b64_tr_b16 a[234:235], v3 offset:672
    ds_read_b64_tr_b16 a[236:237], v3 offset:17056
    v_cvt_pk_bf16_f32 v65, v34, v35
    v_mfma_f32_16x16x32_bf16 v[168:171], a[208:211], v[56:59], v[168:171]
    s_add_u32 m0, s44, 91680
    ds_read_b64_tr_b16 a[238:239], v3 offset:17568
    v_fma_mix_f32 v36, v72, v16, v20 op_sel:[0,0,0] op_sel_hi:[1,0,0]
    v_mfma_f32_16x16x32_bf16 v[168:171], a[212:215], v[60:63], v[168:171]
    s_mov_b32 s45, 2891776
    s_waitcnt lgkmcnt(9)
    buffer_load_dwordx4 v6, s[24:27], s45 offen lds
    v_fma_mix_f32 v37, v72, v17, v21 op_sel:[1,0,0] op_sel_hi:[1,0,0]
    v_mfma_f32_16x16x32_bf16 v[140:143], a[216:219], v[48:51], v[140:143]
    ds_read_b64_tr_b16 a[240:241], v3 offset:192
    v_fma_mix_f32 v38, v73, v18, v22 op_sel:[0,0,0] op_sel_hi:[1,0,0]
    v_mfma_f32_16x16x32_bf16 v[140:143], a[220:223], v[52:55], v[140:143]
    ds_read_b64_tr_b16 a[242:243], v3 offset:704
    ds_read_b64_tr_b16 a[244:245], v3 offset:17088
    v_fma_mix_f32 v39, v73, v19, v23 op_sel:[1,0,0] op_sel_hi:[1,0,0]
    v_mfma_f32_16x16x32_bf16 v[172:175], a[216:219], v[56:59], v[172:175]
    s_add_u32 m0, s44, 92736
    ds_read_b64_tr_b16 a[246:247], v3 offset:17600
    v_cvt_pk_bf16_f32 v72, v36, v37
    v_mfma_f32_16x16x32_bf16 v[172:175], a[220:223], v[60:63], v[172:175]
    s_mov_b32 s45, 2899968
    s_waitcnt lgkmcnt(8)
    buffer_load_dwordx4 v6, s[24:27], s45 offen lds
    v_cvt_pk_bf16_f32 v73, v38, v39
    v_mfma_f32_16x16x32_bf16 v[144:147], a[224:227], v[48:51], v[144:147]
    ds_read_b64_tr_b16 a[248:249], v3 offset:224
    ds_read_b128 v[16:19], v9 offset:2304
    v_mfma_f32_16x16x32_bf16 v[144:147], a[228:231], v[52:55], v[144:147]
    ds_read_b64_tr_b16 a[250:251], v3 offset:736
    ds_read_b64_tr_b16 a[252:253], v3 offset:17120
    v_mfma_f32_16x16x32_bf16 v[176:179], a[224:227], v[56:59], v[176:179]
    s_add_u32 m0, s44, 93792
    ds_read_b64_tr_b16 a[254:255], v3 offset:17632
    ds_read_b128 v[20:23], v9 offset:2336
    v_mfma_f32_16x16x32_bf16 v[176:179], a[228:231], v[60:63], v[176:179]
    s_mov_b32 s45, 2908160
    s_waitcnt lgkmcnt(10)
    buffer_load_dwordx4 v6, s[24:27], s45 offen lds
    v_mfma_f32_16x16x32_bf16 v[148:151], a[232:235], v[48:51], v[148:151]
    ds_read_b64_tr_b16 a[192:193], v3 offset:256
    v_fma_mix_f32 v32, v66, v24, v28 op_sel:[0,0,0] op_sel_hi:[1,0,0]
    v_mfma_f32_16x16x32_bf16 v[148:151], a[236:239], v[52:55], v[148:151]
    ds_read_b64_tr_b16 a[194:195], v3 offset:768
    v_fma_mix_f32 v33, v66, v25, v29 op_sel:[1,0,0] op_sel_hi:[1,0,0]
    v_mfma_f32_16x16x32_bf16 v[180:183], a[232:235], v[56:59], v[180:183]
    ds_read_b64_tr_b16 a[196:197], v3 offset:17152
    v_fma_mix_f32 v34, v67, v26, v30 op_sel:[0,0,0] op_sel_hi:[1,0,0]
    v_mfma_f32_16x16x32_bf16 v[180:183], a[236:239], v[60:63], v[180:183]
    s_waitcnt lgkmcnt(9)
    ds_read_b64_tr_b16 a[198:199], v3 offset:17664
    v_fma_mix_f32 v35, v67, v27, v31 op_sel:[1,0,0] op_sel_hi:[1,0,0]
    v_mfma_f32_16x16x32_bf16 v[152:155], a[240:243], v[48:51], v[152:155]
    ds_read_b64_tr_b16 a[200:201], v3 offset:288
    v_cvt_pk_bf16_f32 v66, v32, v33
    v_mfma_f32_16x16x32_bf16 v[152:155], a[244:247], v[52:55], v[152:155]
    ds_read_b64_tr_b16 a[202:203], v3 offset:800
    v_cvt_pk_bf16_f32 v67, v34, v35
    v_mfma_f32_16x16x32_bf16 v[184:187], a[240:243], v[56:59], v[184:187]
    ds_read_b64_tr_b16 a[204:205], v3 offset:17184
    v_fma_mix_f32 v36, v74, v24, v28 op_sel:[0,0,0] op_sel_hi:[1,0,0]
    v_mfma_f32_16x16x32_bf16 v[184:187], a[244:247], v[60:63], v[184:187]
    s_waitcnt lgkmcnt(8)
    ds_read_b64_tr_b16 a[206:207], v3 offset:17696
    v_fma_mix_f32 v37, v74, v25, v29 op_sel:[1,0,0] op_sel_hi:[1,0,0]
    v_mfma_f32_16x16x32_bf16 v[156:159], a[248:251], v[48:51], v[156:159]
    ds_read_b64_tr_b16 a[208:209], v3 offset:320
    v_fma_mix_f32 v38, v75, v26, v30 op_sel:[0,0,0] op_sel_hi:[1,0,0]
    v_mfma_f32_16x16x32_bf16 v[156:159], a[252:255], v[52:55], v[156:159]
    ds_read_b64_tr_b16 a[210:211], v3 offset:832
    v_fma_mix_f32 v39, v75, v27, v31 op_sel:[1,0,0] op_sel_hi:[1,0,0]
    v_mfma_f32_16x16x32_bf16 v[188:191], a[248:251], v[56:59], v[188:191]
    ds_read_b64_tr_b16 a[212:213], v3 offset:17216
    v_cvt_pk_bf16_f32 v74, v36, v37
    v_mfma_f32_16x16x32_bf16 v[188:191], a[252:255], v[60:63], v[188:191]
    s_waitcnt lgkmcnt(7)
    ds_read_b64_tr_b16 a[214:215], v3 offset:17728
    v_cvt_pk_bf16_f32 v75, v38, v39
    v_mfma_f32_16x16x32_bf16 v[192:195], a[192:195], v[48:51], v[192:195]
    ds_read_b64_tr_b16 a[216:217], v3 offset:352
    ds_read_b128 v[24:27], v9 offset:2320
    v_mfma_f32_16x16x32_bf16 v[192:195], a[196:199], v[52:55], v[192:195]
    ds_read_b64_tr_b16 a[218:219], v3 offset:864
    ds_read_b64_tr_b16 a[220:221], v3 offset:17248
    v_fma_mix_f32 v32, v68, v16, v20 op_sel:[0,0,0] op_sel_hi:[1,0,0]
    v_mfma_f32_16x16x32_bf16 v[224:227], a[192:195], v[56:59], v[224:227]
    s_mov_b32 s54, 12288
    ds_read_b64_tr_b16 a[222:223], v3 offset:17760
    ds_read_b128 v[28:31], v9 offset:2352
    v_mfma_f32_16x16x32_bf16 v[224:227], a[196:199], v[60:63], v[224:227]
    s_waitcnt lgkmcnt(10)
    buffer_load_dwordx4 v[96:99], v8, s[32:35], s54 offen
    v_mfma_f32_16x16x32_bf16 v[196:199], a[200:203], v[48:51], v[196:199]
    ds_read_b64_tr_b16 a[224:225], v3 offset:384
    v_fma_mix_f32 v33, v68, v17, v21 op_sel:[1,0,0] op_sel_hi:[1,0,0]
    v_mfma_f32_16x16x32_bf16 v[196:199], a[204:207], v[52:55], v[196:199]
    ds_read_b64_tr_b16 a[226:227], v3 offset:896
    ds_read_b64_tr_b16 a[228:229], v3 offset:17280
    v_fma_mix_f32 v34, v69, v18, v22 op_sel:[0,0,0] op_sel_hi:[1,0,0]
    v_mfma_f32_16x16x32_bf16 v[228:231], a[200:203], v[56:59], v[228:231]
    s_mov_b32 s54, 13312
    ds_read_b64_tr_b16 a[230:231], v3 offset:17792
    v_fma_mix_f32 v35, v69, v19, v23 op_sel:[1,0,0] op_sel_hi:[1,0,0]
    v_mfma_f32_16x16x32_bf16 v[228:231], a[204:207], v[60:63], v[228:231]
    s_waitcnt lgkmcnt(10)
    buffer_load_dwordx4 v[100:103], v8, s[32:35], s54 offen
    v_mfma_f32_16x16x32_bf16 v[200:203], a[208:211], v[48:51], v[200:203]
    ds_read_b64_tr_b16 a[232:233], v3 offset:416
    v_cvt_pk_bf16_f32 v68, v32, v33
    v_mfma_f32_16x16x32_bf16 v[200:203], a[212:215], v[52:55], v[200:203]
    ds_read_b64_tr_b16 a[234:235], v3 offset:928
    ds_read_b64_tr_b16 a[236:237], v3 offset:17312
    v_cvt_pk_bf16_f32 v69, v34, v35
    v_mfma_f32_16x16x32_bf16 v[232:235], a[208:211], v[56:59], v[232:235]
    s_mov_b32 s54, 30720
    ds_read_b64_tr_b16 a[238:239], v3 offset:17824
    v_fma_mix_f32 v36, v76, v16, v20 op_sel:[0,0,0] op_sel_hi:[1,0,0]
    v_mfma_f32_16x16x32_bf16 v[232:235], a[212:215], v[60:63], v[232:235]
    s_waitcnt lgkmcnt(9)
    buffer_load_dwordx4 v[104:107], v8, s[32:35], s54 offen
    v_fma_mix_f32 v37, v76, v17, v21 op_sel:[1,0,0] op_sel_hi:[1,0,0]
    v_mfma_f32_16x16x32_bf16 v[204:207], a[216:219], v[48:51], v[204:207]
    ds_read_b64_tr_b16 a[240:241], v3 offset:448
    v_fma_mix_f32 v38, v77, v18, v22 op_sel:[0,0,0] op_sel_hi:[1,0,0]
    v_mfma_f32_16x16x32_bf16 v[204:207], a[220:223], v[52:55], v[204:207]
    ds_read_b64_tr_b16 a[242:243], v3 offset:960
    ds_read_b64_tr_b16 a[244:245], v3 offset:17344
    v_fma_mix_f32 v39, v77, v19, v23 op_sel:[1,0,0] op_sel_hi:[1,0,0]
    v_mfma_f32_16x16x32_bf16 v[236:239], a[216:219], v[56:59], v[236:239]
    s_mov_b32 s54, 31744
    ds_read_b64_tr_b16 a[246:247], v3 offset:17856
    v_cvt_pk_bf16_f32 v76, v36, v37
    v_mfma_f32_16x16x32_bf16 v[236:239], a[220:223], v[60:63], v[236:239]
    s_waitcnt lgkmcnt(8)
    buffer_load_dwordx4 v[108:111], v8, s[32:35], s54 offen
    v_cvt_pk_bf16_f32 v77, v38, v39
    v_mfma_f32_16x16x32_bf16 v[208:211], a[224:227], v[48:51], v[208:211]
    ds_read_b64_tr_b16 a[248:249], v3 offset:480
    ds_read_b128 v[16:19], v9 offset:2560
    v_mfma_f32_16x16x32_bf16 v[208:211], a[228:231], v[52:55], v[208:211]
    ds_read_b64_tr_b16 a[250:251], v3 offset:992
    ds_read_b128 v[20:23], v9 offset:2592
    v_mfma_f32_16x16x32_bf16 v[240:243], a[224:227], v[56:59], v[240:243]
    ds_read_b64_tr_b16 a[252:253], v3 offset:17376
    v_fma_mix_f32 v32, v70, v24, v28 op_sel:[0,0,0] op_sel_hi:[1,0,0]
    v_mfma_f32_16x16x32_bf16 v[240:243], a[228:231], v[60:63], v[240:243]
    s_waitcnt vmcnt(16)
    s_barrier
    s_waitcnt lgkmcnt(9)
    ds_read_b64_tr_b16 a[254:255], v3 offset:17888
    v_fma_mix_f32 v33, v70, v25, v29 op_sel:[1,0,0] op_sel_hi:[1,0,0]
    v_fma_mix_f32 v34, v71, v26, v30 op_sel:[0,0,0] op_sel_hi:[1,0,0]
    v_mfma_f32_16x16x32_bf16 v[212:215], a[232:235], v[48:51], v[212:215]
    ds_read_b64_tr_b16 a[192:193], v3 offset:36864
    v_fma_mix_f32 v35, v71, v27, v31 op_sel:[1,0,0] op_sel_hi:[1,0,0]
    v_mfma_f32_16x16x32_bf16 v[212:215], a[236:239], v[52:55], v[212:215]
    ds_read_b64_tr_b16 a[194:195], v3 offset:37376
    ds_read_b64_tr_b16 a[196:197], v3 offset:53760
    v_cvt_pk_bf16_f32 v70, v32, v33
    v_mfma_f32_16x16x32_bf16 v[244:247], a[232:235], v[56:59], v[244:247]
    s_add_u32 m0, s44, 110592
    ds_read_b64_tr_b16 a[198:199], v3 offset:54272
    v_cvt_pk_bf16_f32 v71, v34, v35
    v_mfma_f32_16x16x32_bf16 v[244:247], a[236:239], v[60:63], v[244:247]
    s_mov_b32 s45, 3145728
    s_waitcnt lgkmcnt(10)
    buffer_load_dwordx4 v6, s[24:27], s45 offen lds
    v_mfma_f32_16x16x32_bf16 v[216:219], a[240:243], v[48:51], v[216:219]
    ds_read_b64_tr_b16 a[200:201], v3 offset:36896
    v_fma_mix_f32 v36, v78, v24, v28 op_sel:[0,0,0] op_sel_hi:[1,0,0]
    v_mfma_f32_16x16x32_bf16 v[216:219], a[244:247], v[52:55], v[216:219]
    ds_read_b64_tr_b16 a[202:203], v3 offset:37408
    ds_read_b64_tr_b16 a[204:205], v3 offset:53792
    v_fma_mix_f32 v37, v78, v25, v29 op_sel:[1,0,0] op_sel_hi:[1,0,0]
    v_mfma_f32_16x16x32_bf16 v[248:251], a[240:243], v[56:59], v[248:251]
    s_add_u32 m0, s44, 111648
    ds_read_b64_tr_b16 a[206:207], v3 offset:54304
    v_fma_mix_f32 v38, v79, v26, v30 op_sel:[0,0,0] op_sel_hi:[1,0,0]
    v_mfma_f32_16x16x32_bf16 v[248:251], a[244:247], v[60:63], v[248:251]
    s_mov_b32 s45, 3153920
    s_waitcnt lgkmcnt(8)
    buffer_load_dwordx4 v6, s[24:27], s45 offen lds
    v_mfma_f32_16x16x32_bf16 v[220:223], a[248:251], v[48:51], v[220:223]
    ds_read_b64_tr_b16 a[208:209], v3 offset:36928
    v_fma_mix_f32 v39, v79, v27, v31 op_sel:[1,0,0] op_sel_hi:[1,0,0]
    v_mfma_f32_16x16x32_bf16 v[220:223], a[252:255], v[52:55], v[220:223]
    ds_read_b64_tr_b16 a[210:211], v3 offset:37440
    ds_read_b64_tr_b16 a[212:213], v3 offset:53824
    v_cvt_pk_bf16_f32 v78, v36, v37
    v_mfma_f32_16x16x32_bf16 v[252:255], a[248:251], v[56:59], v[252:255]
    s_add_u32 m0, s44, 112704
    ds_read_b64_tr_b16 a[214:215], v3 offset:54336
    v_cvt_pk_bf16_f32 v79, v38, v39
    v_mfma_f32_16x16x32_bf16 v[252:255], a[252:255], v[60:63], v[252:255]
    s_mov_b32 s45, 3162112
    s_waitcnt lgkmcnt(8)
    buffer_load_dwordx4 v6, s[24:27], s45 offen lds
    v_mfma_f32_16x16x32_bf16 v[128:131], a[192:195], v[64:67], v[128:131]
    s_waitcnt vmcnt(15)
    ds_read_b64_tr_b16 a[216:217], v3 offset:36960
    ds_read_b128 v[24:27], v9 offset:2576
    v_mfma_f32_16x16x32_bf16 v[128:131], a[196:199], v[68:71], v[128:131]
    ds_read_b64_tr_b16 a[218:219], v3 offset:37472
    ds_read_b64_tr_b16 a[220:221], v3 offset:53856
    v_fma_mix_f32 v32, v80, v16, v20 op_sel:[0,0,0] op_sel_hi:[1,0,0]
    v_mfma_f32_16x16x32_bf16 v[160:163], a[192:195], v[72:75], v[160:163]
    s_add_u32 m0, s44, 113760
    ds_read_b64_tr_b16 a[222:223], v3 offset:54368
    ds_read_b128 v[28:31], v9 offset:2608
    v_mfma_f32_16x16x32_bf16 v[160:163], a[196:199], v[76:79], v[160:163]
    s_mov_b32 s45, 3170304
    s_waitcnt lgkmcnt(10)
    buffer_load_dwordx4 v6, s[24:27], s45 offen lds
    v_mfma_f32_16x16x32_bf16 v[132:135], a[200:203], v[64:67], v[132:135]
    ds_read_b64_tr_b16 a[224:225], v3 offset:36992
    v_fma_mix_f32 v33, v80, v17, v21 op_sel:[1,0,0] op_sel_hi:[1,0,0]
    v_mfma_f32_16x16x32_bf16 v[132:135], a[204:207], v[68:71], v[132:135]
    ds_read_b64_tr_b16 a[226:227], v3 offset:37504
    ds_read_b64_tr_b16 a[228:229], v3 offset:53888
    v_fma_mix_f32 v34, v81, v18, v22 op_sel:[0,0,0] op_sel_hi:[1,0,0]
    v_mfma_f32_16x16x32_bf16 v[164:167], a[200:203], v[72:75], v[164:167]
    s_add_u32 m0, s44, 127488
    ds_read_b64_tr_b16 a[230:231], v3 offset:54400
    v_fma_mix_f32 v35, v81, v19, v23 op_sel:[1,0,0] op_sel_hi:[1,0,0]
    v_mfma_f32_16x16x32_bf16 v[164:167], a[204:207], v[76:79], v[164:167]
    s_mov_b32 s45, 3407872
    s_waitcnt lgkmcnt(10)
    buffer_load_dwordx4 v6, s[24:27], s45 offen lds
    v_mfma_f32_16x16x32_bf16 v[136:139], a[208:211], v[64:67], v[136:139]
    ds_read_b64_tr_b16 a[232:233], v3 offset:37024
    v_cvt_pk_bf16_f32 v80, v32, v33
    v_mfma_f32_16x16x32_bf16 v[136:139], a[212:215], v[68:71], v[136:139]
    ds_read_b64_tr_b16 a[234:235], v3 offset:37536
    ds_read_b64_tr_b16 a[236:237], v3 offset:53920
    v_cvt_pk_bf16_f32 v81, v34, v35
    v_mfma_f32_16x16x32_bf16 v[168:171], a[208:211], v[72:75], v[168:171]
    s_add_u32 m0, s44, 128544
    ds_read_b64_tr_b16 a[238:239], v3 offset:54432
    v_fma_mix_f32 v36, v88, v16, v20 op_sel:[0,0,0] op_sel_hi:[1,0,0]
    v_mfma_f32_16x16x32_bf16 v[168:171], a[212:215], v[76:79], v[168:171]
    s_mov_b32 s45, 3416064
    s_waitcnt lgkmcnt(9)
    buffer_load_dwordx4 v6, s[24:27], s45 offen lds
    v_fma_mix_f32 v37, v88, v17, v21 op_sel:[1,0,0] op_sel_hi:[1,0,0]
    v_mfma_f32_16x16x32_bf16 v[140:143], a[216:219], v[64:67], v[140:143]
    ds_read_b64_tr_b16 a[240:241], v3 offset:37056
    v_fma_mix_f32 v38, v89, v18, v22 op_sel:[0,0,0] op_sel_hi:[1,0,0]
    v_mfma_f32_16x16x32_bf16 v[140:143], a[220:223], v[68:71], v[140:143]
    ds_read_b64_tr_b16 a[242:243], v3 offset:37568
    ds_read_b64_tr_b16 a[244:245], v3 offset:53952
    v_fma_mix_f32 v39, v89, v19, v23 op_sel:[1,0,0] op_sel_hi:[1,0,0]
    v_mfma_f32_16x16x32_bf16 v[172:175], a[216:219], v[72:75], v[172:175]
    s_add_u32 m0, s44, 129600
    ds_read_b64_tr_b16 a[246:247], v3 offset:54464
    v_cvt_pk_bf16_f32 v88, v36, v37
    v_mfma_f32_16x16x32_bf16 v[172:175], a[220:223], v[76:79], v[172:175]
    s_mov_b32 s45, 3424256
    s_waitcnt lgkmcnt(8)
    buffer_load_dwordx4 v6, s[24:27], s45 offen lds
    v_cvt_pk_bf16_f32 v89, v38, v39
    v_mfma_f32_16x16x32_bf16 v[144:147], a[224:227], v[64:67], v[144:147]
    ds_read_b64_tr_b16 a[248:249], v3 offset:37088
    ds_read_b128 v[16:19], v9 offset:2816
    v_mfma_f32_16x16x32_bf16 v[144:147], a[228:231], v[68:71], v[144:147]
    ds_read_b64_tr_b16 a[250:251], v3 offset:37600
    ds_read_b64_tr_b16 a[252:253], v3 offset:53984
    v_mfma_f32_16x16x32_bf16 v[176:179], a[224:227], v[72:75], v[176:179]
    s_add_u32 m0, s44, 130656
    ds_read_b64_tr_b16 a[254:255], v3 offset:54496
    ds_read_b128 v[20:23], v9 offset:2848
    v_mfma_f32_16x16x32_bf16 v[176:179], a[228:231], v[76:79], v[176:179]
    s_mov_b32 s45, 3432448
    s_waitcnt lgkmcnt(10)
    buffer_load_dwordx4 v6, s[24:27], s45 offen lds
    v_mfma_f32_16x16x32_bf16 v[148:151], a[232:235], v[64:67], v[148:151]
    ds_read_b64_tr_b16 a[192:193], v3 offset:37120
    v_fma_mix_f32 v32, v82, v24, v28 op_sel:[0,0,0] op_sel_hi:[1,0,0]
    v_mfma_f32_16x16x32_bf16 v[148:151], a[236:239], v[68:71], v[148:151]
    ds_read_b64_tr_b16 a[194:195], v3 offset:37632
    v_fma_mix_f32 v33, v82, v25, v29 op_sel:[1,0,0] op_sel_hi:[1,0,0]
    v_mfma_f32_16x16x32_bf16 v[180:183], a[232:235], v[72:75], v[180:183]
    ds_read_b64_tr_b16 a[196:197], v3 offset:54016
    v_fma_mix_f32 v34, v83, v26, v30 op_sel:[0,0,0] op_sel_hi:[1,0,0]
    v_mfma_f32_16x16x32_bf16 v[180:183], a[236:239], v[76:79], v[180:183]
    s_waitcnt lgkmcnt(9)
    ds_read_b64_tr_b16 a[198:199], v3 offset:54528
    v_fma_mix_f32 v35, v83, v27, v31 op_sel:[1,0,0] op_sel_hi:[1,0,0]
    v_mfma_f32_16x16x32_bf16 v[152:155], a[240:243], v[64:67], v[152:155]
    ds_read_b64_tr_b16 a[200:201], v3 offset:37152
    v_cvt_pk_bf16_f32 v82, v32, v33
    v_mfma_f32_16x16x32_bf16 v[152:155], a[244:247], v[68:71], v[152:155]
    ds_read_b64_tr_b16 a[202:203], v3 offset:37664
    v_cvt_pk_bf16_f32 v83, v34, v35
    v_mfma_f32_16x16x32_bf16 v[184:187], a[240:243], v[72:75], v[184:187]
    ds_read_b64_tr_b16 a[204:205], v3 offset:54048
    v_fma_mix_f32 v36, v90, v24, v28 op_sel:[0,0,0] op_sel_hi:[1,0,0]
    v_mfma_f32_16x16x32_bf16 v[184:187], a[244:247], v[76:79], v[184:187]
    s_waitcnt lgkmcnt(8)
    ds_read_b64_tr_b16 a[206:207], v3 offset:54560
    v_fma_mix_f32 v37, v90, v25, v29 op_sel:[1,0,0] op_sel_hi:[1,0,0]
    v_mfma_f32_16x16x32_bf16 v[156:159], a[248:251], v[64:67], v[156:159]
    ds_read_b64_tr_b16 a[208:209], v3 offset:37184
    v_fma_mix_f32 v38, v91, v26, v30 op_sel:[0,0,0] op_sel_hi:[1,0,0]
    v_mfma_f32_16x16x32_bf16 v[156:159], a[252:255], v[68:71], v[156:159]
    ds_read_b64_tr_b16 a[210:211], v3 offset:37696
    v_fma_mix_f32 v39, v91, v27, v31 op_sel:[1,0,0] op_sel_hi:[1,0,0]
    v_mfma_f32_16x16x32_bf16 v[188:191], a[248:251], v[72:75], v[188:191]
    ds_read_b64_tr_b16 a[212:213], v3 offset:54080
    v_cvt_pk_bf16_f32 v90, v36, v37
    v_mfma_f32_16x16x32_bf16 v[188:191], a[252:255], v[76:79], v[188:191]
    s_waitcnt lgkmcnt(7)
    ds_read_b64_tr_b16 a[214:215], v3 offset:54592
    v_cvt_pk_bf16_f32 v91, v38, v39
    v_mfma_f32_16x16x32_bf16 v[192:195], a[192:195], v[64:67], v[192:195]
    ds_read_b64_tr_b16 a[216:217], v3 offset:37216
    ds_read_b128 v[24:27], v9 offset:2832
    v_mfma_f32_16x16x32_bf16 v[192:195], a[196:199], v[68:71], v[192:195]
    ds_read_b64_tr_b16 a[218:219], v3 offset:37728
    ds_read_b64_tr_b16 a[220:221], v3 offset:54112
    v_fma_mix_f32 v32, v84, v16, v20 op_sel:[0,0,0] op_sel_hi:[1,0,0]
    v_mfma_f32_16x16x32_bf16 v[224:227], a[192:195], v[72:75], v[224:227]
    s_mov_b32 s54, 14336
    ds_read_b64_tr_b16 a[222:223], v3 offset:54624
    ds_read_b128 v[28:31], v9 offset:2864
    v_mfma_f32_16x16x32_bf16 v[224:227], a[196:199], v[76:79], v[224:227]
    s_waitcnt lgkmcnt(10)
    buffer_load_dwordx4 v[112:115], v8, s[32:35], s54 offen
    v_mfma_f32_16x16x32_bf16 v[196:199], a[200:203], v[64:67], v[196:199]
    ds_read_b64_tr_b16 a[224:225], v3 offset:37248
    v_fma_mix_f32 v33, v84, v17, v21 op_sel:[1,0,0] op_sel_hi:[1,0,0]
    v_mfma_f32_16x16x32_bf16 v[196:199], a[204:207], v[68:71], v[196:199]
    ds_read_b64_tr_b16 a[226:227], v3 offset:37760
    ds_read_b64_tr_b16 a[228:229], v3 offset:54144
    v_fma_mix_f32 v34, v85, v18, v22 op_sel:[0,0,0] op_sel_hi:[1,0,0]
    v_mfma_f32_16x16x32_bf16 v[228:231], a[200:203], v[72:75], v[228:231]
    s_mov_b32 s54, 15360
    ds_read_b64_tr_b16 a[230:231], v3 offset:54656
    v_fma_mix_f32 v35, v85, v19, v23 op_sel:[1,0,0] op_sel_hi:[1,0,0]
    v_mfma_f32_16x16x32_bf16 v[228:231], a[204:207], v[76:79], v[228:231]
    s_waitcnt lgkmcnt(10)
    buffer_load_dwordx4 v[116:119], v8, s[32:35], s54 offen
    v_mfma_f32_16x16x32_bf16 v[200:203], a[208:211], v[64:67], v[200:203]
    ds_read_b64_tr_b16 a[232:233], v3 offset:37280
    v_cvt_pk_bf16_f32 v84, v32, v33
    v_mfma_f32_16x16x32_bf16 v[200:203], a[212:215], v[68:71], v[200:203]
    ds_read_b64_tr_b16 a[234:235], v3 offset:37792
    ds_read_b64_tr_b16 a[236:237], v3 offset:54176
    v_cvt_pk_bf16_f32 v85, v34, v35
    v_mfma_f32_16x16x32_bf16 v[232:235], a[208:211], v[72:75], v[232:235]
    s_mov_b32 s54, 32768
    ds_read_b64_tr_b16 a[238:239], v3 offset:54688
    v_fma_mix_f32 v36, v92, v16, v20 op_sel:[0,0,0] op_sel_hi:[1,0,0]
    v_mfma_f32_16x16x32_bf16 v[232:235], a[212:215], v[76:79], v[232:235]
    s_waitcnt lgkmcnt(9)
    buffer_load_dwordx4 v[120:123], v8, s[32:35], s54 offen
    v_fma_mix_f32 v37, v92, v17, v21 op_sel:[1,0,0] op_sel_hi:[1,0,0]
    v_mfma_f32_16x16x32_bf16 v[204:207], a[216:219], v[64:67], v[204:207]
    ds_read_b64_tr_b16 a[240:241], v3 offset:37312
    v_fma_mix_f32 v38, v93, v18, v22 op_sel:[0,0,0] op_sel_hi:[1,0,0]
    v_mfma_f32_16x16x32_bf16 v[204:207], a[220:223], v[68:71], v[204:207]
    ds_read_b64_tr_b16 a[242:243], v3 offset:37824
    ds_read_b64_tr_b16 a[244:245], v3 offset:54208
    v_fma_mix_f32 v39, v93, v19, v23 op_sel:[1,0,0] op_sel_hi:[1,0,0]
    v_mfma_f32_16x16x32_bf16 v[236:239], a[216:219], v[72:75], v[236:239]
    s_mov_b32 s54, 33792
    ds_read_b64_tr_b16 a[246:247], v3 offset:54720
    v_cvt_pk_bf16_f32 v92, v36, v37
    v_mfma_f32_16x16x32_bf16 v[236:239], a[220:223], v[76:79], v[236:239]
    s_waitcnt lgkmcnt(8)
    buffer_load_dwordx4 v[124:127], v8, s[32:35], s54 offen
    v_cvt_pk_bf16_f32 v93, v38, v39
    v_mfma_f32_16x16x32_bf16 v[208:211], a[224:227], v[64:67], v[208:211]
    ds_read_b64_tr_b16 a[248:249], v3 offset:37344
    ds_read_b128 v[16:19], v9 offset:3072
    v_mfma_f32_16x16x32_bf16 v[208:211], a[228:231], v[68:71], v[208:211]
    ds_read_b64_tr_b16 a[250:251], v3 offset:37856
    ds_read_b128 v[20:23], v9 offset:3104
    v_mfma_f32_16x16x32_bf16 v[240:243], a[224:227], v[72:75], v[240:243]
    ds_read_b64_tr_b16 a[252:253], v3 offset:54240
    v_fma_mix_f32 v32, v86, v24, v28 op_sel:[0,0,0] op_sel_hi:[1,0,0]
    v_mfma_f32_16x16x32_bf16 v[240:243], a[228:231], v[76:79], v[240:243]
    s_waitcnt vmcnt(16)
    s_barrier
    s_waitcnt lgkmcnt(9)
    ds_read_b64_tr_b16 a[254:255], v3 offset:54752
    v_fma_mix_f32 v33, v86, v25, v29 op_sel:[1,0,0] op_sel_hi:[1,0,0]
    v_fma_mix_f32 v34, v87, v26, v30 op_sel:[0,0,0] op_sel_hi:[1,0,0]
    v_mfma_f32_16x16x32_bf16 v[212:215], a[232:235], v[64:67], v[212:215]
    ds_read_b64_tr_b16 a[192:193], v4 offset:0
    v_fma_mix_f32 v35, v87, v27, v31 op_sel:[1,0,0] op_sel_hi:[1,0,0]
    v_mfma_f32_16x16x32_bf16 v[212:215], a[236:239], v[68:71], v[212:215]
    ds_read_b64_tr_b16 a[194:195], v4 offset:512
    ds_read_b64_tr_b16 a[196:197], v4 offset:16896
    v_cvt_pk_bf16_f32 v86, v32, v33
    v_mfma_f32_16x16x32_bf16 v[244:247], a[232:235], v[72:75], v[244:247]
    s_add_u32 m0, s44, 0
    ds_read_b64_tr_b16 a[198:199], v4 offset:17408
    v_cvt_pk_bf16_f32 v87, v34, v35
    v_mfma_f32_16x16x32_bf16 v[244:247], a[236:239], v[76:79], v[244:247]
    s_mov_b32 s45, 3670016
    s_waitcnt lgkmcnt(10)
    buffer_load_dwordx4 v6, s[24:27], s45 offen lds
    v_mfma_f32_16x16x32_bf16 v[216:219], a[240:243], v[64:67], v[216:219]
    ds_read_b64_tr_b16 a[200:201], v4 offset:32
    v_fma_mix_f32 v36, v94, v24, v28 op_sel:[0,0,0] op_sel_hi:[1,0,0]
    v_mfma_f32_16x16x32_bf16 v[216:219], a[244:247], v[68:71], v[216:219]
    ds_read_b64_tr_b16 a[202:203], v4 offset:544
    ds_read_b64_tr_b16 a[204:205], v4 offset:16928
    v_fma_mix_f32 v37, v94, v25, v29 op_sel:[1,0,0] op_sel_hi:[1,0,0]
    v_mfma_f32_16x16x32_bf16 v[248:251], a[240:243], v[72:75], v[248:251]
    s_add_u32 m0, s44, 1056
    ds_read_b64_tr_b16 a[206:207], v4 offset:17440
    v_fma_mix_f32 v38, v95, v26, v30 op_sel:[0,0,0] op_sel_hi:[1,0,0]
    v_mfma_f32_16x16x32_bf16 v[248:251], a[244:247], v[76:79], v[248:251]
    s_mov_b32 s45, 3678208
    s_waitcnt lgkmcnt(8)
    buffer_load_dwordx4 v6, s[24:27], s45 offen lds
    v_mfma_f32_16x16x32_bf16 v[220:223], a[248:251], v[64:67], v[220:223]
    ds_read_b64_tr_b16 a[208:209], v4 offset:64
    v_fma_mix_f32 v39, v95, v27, v31 op_sel:[1,0,0] op_sel_hi:[1,0,0]
    v_mfma_f32_16x16x32_bf16 v[220:223], a[252:255], v[68:71], v[220:223]
    ds_read_b64_tr_b16 a[210:211], v4 offset:576
    ds_read_b64_tr_b16 a[212:213], v4 offset:16960
    v_cvt_pk_bf16_f32 v94, v36, v37
    v_mfma_f32_16x16x32_bf16 v[252:255], a[248:251], v[72:75], v[252:255]
    s_add_u32 m0, s44, 2112
    ds_read_b64_tr_b16 a[214:215], v4 offset:17472
    v_cvt_pk_bf16_f32 v95, v38, v39
    v_mfma_f32_16x16x32_bf16 v[252:255], a[252:255], v[76:79], v[252:255]
    s_mov_b32 s45, 3686400
    s_waitcnt lgkmcnt(8)
    buffer_load_dwordx4 v6, s[24:27], s45 offen lds
    v_mfma_f32_16x16x32_bf16 v[128:131], a[192:195], v[80:83], v[128:131]
    s_waitcnt vmcnt(15)
    ds_read_b64_tr_b16 a[216:217], v4 offset:96
    ds_read_b128 v[24:27], v9 offset:3088
    v_mfma_f32_16x16x32_bf16 v[128:131], a[196:199], v[84:87], v[128:131]
    ds_read_b64_tr_b16 a[218:219], v4 offset:608
    ds_read_b64_tr_b16 a[220:221], v4 offset:16992
    v_fma_mix_f32 v32, v96, v16, v20 op_sel:[0,0,0] op_sel_hi:[1,0,0]
    v_mfma_f32_16x16x32_bf16 v[160:163], a[192:195], v[88:91], v[160:163]
    s_add_u32 m0, s44, 3168
    ds_read_b64_tr_b16 a[222:223], v4 offset:17504
    ds_read_b128 v[28:31], v9 offset:3120
    v_mfma_f32_16x16x32_bf16 v[160:163], a[196:199], v[92:95], v[160:163]
    s_mov_b32 s45, 3694592
    s_waitcnt lgkmcnt(10)
    buffer_load_dwordx4 v6, s[24:27], s45 offen lds
    v_mfma_f32_16x16x32_bf16 v[132:135], a[200:203], v[80:83], v[132:135]
    ds_read_b64_tr_b16 a[224:225], v4 offset:128
    v_fma_mix_f32 v33, v96, v17, v21 op_sel:[1,0,0] op_sel_hi:[1,0,0]
    v_mfma_f32_16x16x32_bf16 v[132:135], a[204:207], v[84:87], v[132:135]
    ds_read_b64_tr_b16 a[226:227], v4 offset:640
    ds_read_b64_tr_b16 a[228:229], v4 offset:17024
    v_fma_mix_f32 v34, v97, v18, v22 op_sel:[0,0,0] op_sel_hi:[1,0,0]
    v_mfma_f32_16x16x32_bf16 v[164:167], a[200:203], v[88:91], v[164:167]
    s_add_u32 m0, s44, 16896
    ds_read_b64_tr_b16 a[230:231], v4 offset:17536
    v_fma_mix_f32 v35, v97, v19, v23 op_sel:[1,0,0] op_sel_hi:[1,0,0]
    v_mfma_f32_16x16x32_bf16 v[164:167], a[204:207], v[92:95], v[164:167]
    s_mov_b32 s45, 3932160
    s_waitcnt lgkmcnt(10)
    buffer_load_dwordx4 v6, s[24:27], s45 offen lds
    v_mfma_f32_16x16x32_bf16 v[136:139], a[208:211], v[80:83], v[136:139]
    ds_read_b64_tr_b16 a[232:233], v4 offset:160
    v_cvt_pk_bf16_f32 v96, v32, v33
    v_mfma_f32_16x16x32_bf16 v[136:139], a[212:215], v[84:87], v[136:139]
    ds_read_b64_tr_b16 a[234:235], v4 offset:672
    ds_read_b64_tr_b16 a[236:237], v4 offset:17056
    v_cvt_pk_bf16_f32 v97, v34, v35
    v_mfma_f32_16x16x32_bf16 v[168:171], a[208:211], v[88:91], v[168:171]
    s_add_u32 m0, s44, 17952
    ds_read_b64_tr_b16 a[238:239], v4 offset:17568
    v_fma_mix_f32 v36, v104, v16, v20 op_sel:[0,0,0] op_sel_hi:[1,0,0]
    v_mfma_f32_16x16x32_bf16 v[168:171], a[212:215], v[92:95], v[168:171]
    s_mov_b32 s45, 3940352
    s_waitcnt lgkmcnt(9)
    buffer_load_dwordx4 v6, s[24:27], s45 offen lds
    v_fma_mix_f32 v37, v104, v17, v21 op_sel:[1,0,0] op_sel_hi:[1,0,0]
    v_mfma_f32_16x16x32_bf16 v[140:143], a[216:219], v[80:83], v[140:143]
    ds_read_b64_tr_b16 a[240:241], v4 offset:192
    v_fma_mix_f32 v38, v105, v18, v22 op_sel:[0,0,0] op_sel_hi:[1,0,0]
    v_mfma_f32_16x16x32_bf16 v[140:143], a[220:223], v[84:87], v[140:143]
    ds_read_b64_tr_b16 a[242:243], v4 offset:704
    ds_read_b64_tr_b16 a[244:245], v4 offset:17088
    v_fma_mix_f32 v39, v105, v19, v23 op_sel:[1,0,0] op_sel_hi:[1,0,0]
    v_mfma_f32_16x16x32_bf16 v[172:175], a[216:219], v[88:91], v[172:175]
    s_add_u32 m0, s44, 19008
    ds_read_b64_tr_b16 a[246:247], v4 offset:17600
    v_cvt_pk_bf16_f32 v104, v36, v37
    v_mfma_f32_16x16x32_bf16 v[172:175], a[220:223], v[92:95], v[172:175]
    s_mov_b32 s45, 3948544
    s_waitcnt lgkmcnt(8)
    buffer_load_dwordx4 v6, s[24:27], s45 offen lds
    v_cvt_pk_bf16_f32 v105, v38, v39
    v_mfma_f32_16x16x32_bf16 v[144:147], a[224:227], v[80:83], v[144:147]
    ds_read_b64_tr_b16 a[248:249], v4 offset:224
    ds_read_b128 v[16:19], v9 offset:3328
    v_mfma_f32_16x16x32_bf16 v[144:147], a[228:231], v[84:87], v[144:147]
    ds_read_b64_tr_b16 a[250:251], v4 offset:736
    ds_read_b64_tr_b16 a[252:253], v4 offset:17120
    v_mfma_f32_16x16x32_bf16 v[176:179], a[224:227], v[88:91], v[176:179]
    s_add_u32 m0, s44, 20064
    ds_read_b64_tr_b16 a[254:255], v4 offset:17632
    ds_read_b128 v[20:23], v9 offset:3360
    v_mfma_f32_16x16x32_bf16 v[176:179], a[228:231], v[92:95], v[176:179]
    s_mov_b32 s45, 3956736
    s_waitcnt lgkmcnt(10)
    buffer_load_dwordx4 v6, s[24:27], s45 offen lds
    v_mfma_f32_16x16x32_bf16 v[148:151], a[232:235], v[80:83], v[148:151]
    ds_read_b64_tr_b16 a[192:193], v4 offset:256
    v_fma_mix_f32 v32, v98, v24, v28 op_sel:[0,0,0] op_sel_hi:[1,0,0]
    v_mfma_f32_16x16x32_bf16 v[148:151], a[236:239], v[84:87], v[148:151]
    ds_read_b64_tr_b16 a[194:195], v4 offset:768
    v_fma_mix_f32 v33, v98, v25, v29 op_sel:[1,0,0] op_sel_hi:[1,0,0]
    v_mfma_f32_16x16x32_bf16 v[180:183], a[232:235], v[88:91], v[180:183]
    ds_read_b64_tr_b16 a[196:197], v4 offset:17152
    v_fma_mix_f32 v34, v99, v26, v30 op_sel:[0,0,0] op_sel_hi:[1,0,0]
    v_mfma_f32_16x16x32_bf16 v[180:183], a[236:239], v[92:95], v[180:183]
    s_waitcnt lgkmcnt(9)
    ds_read_b64_tr_b16 a[198:199], v4 offset:17664
    v_fma_mix_f32 v35, v99, v27, v31 op_sel:[1,0,0] op_sel_hi:[1,0,0]
    v_mfma_f32_16x16x32_bf16 v[152:155], a[240:243], v[80:83], v[152:155]
    ds_read_b64_tr_b16 a[200:201], v4 offset:288
    v_cvt_pk_bf16_f32 v98, v32, v33
    v_mfma_f32_16x16x32_bf16 v[152:155], a[244:247], v[84:87], v[152:155]
    ds_read_b64_tr_b16 a[202:203], v4 offset:800
    v_cvt_pk_bf16_f32 v99, v34, v35
    v_mfma_f32_16x16x32_bf16 v[184:187], a[240:243], v[88:91], v[184:187]
    ds_read_b64_tr_b16 a[204:205], v4 offset:17184
    v_fma_mix_f32 v36, v106, v24, v28 op_sel:[0,0,0] op_sel_hi:[1,0,0]
    v_mfma_f32_16x16x32_bf16 v[184:187], a[244:247], v[92:95], v[184:187]
    s_waitcnt lgkmcnt(8)
    ds_read_b64_tr_b16 a[206:207], v4 offset:17696
    v_fma_mix_f32 v37, v106, v25, v29 op_sel:[1,0,0] op_sel_hi:[1,0,0]
    v_mfma_f32_16x16x32_bf16 v[156:159], a[248:251], v[80:83], v[156:159]
    ds_read_b64_tr_b16 a[208:209], v4 offset:320
    v_fma_mix_f32 v38, v107, v26, v30 op_sel:[0,0,0] op_sel_hi:[1,0,0]
    v_mfma_f32_16x16x32_bf16 v[156:159], a[252:255], v[84:87], v[156:159]
    ds_read_b64_tr_b16 a[210:211], v4 offset:832
    v_fma_mix_f32 v39, v107, v27, v31 op_sel:[1,0,0] op_sel_hi:[1,0,0]
    v_mfma_f32_16x16x32_bf16 v[188:191], a[248:251], v[88:91], v[188:191]
    ds_read_b64_tr_b16 a[212:213], v4 offset:17216
    v_cvt_pk_bf16_f32 v106, v36, v37
    v_mfma_f32_16x16x32_bf16 v[188:191], a[252:255], v[92:95], v[188:191]
    s_waitcnt lgkmcnt(7)
    ds_read_b64_tr_b16 a[214:215], v4 offset:17728
    v_cvt_pk_bf16_f32 v107, v38, v39
    v_mfma_f32_16x16x32_bf16 v[192:195], a[192:195], v[80:83], v[192:195]
    ds_read_b64_tr_b16 a[216:217], v4 offset:352
    ds_read_b128 v[24:27], v9 offset:3344
    v_mfma_f32_16x16x32_bf16 v[192:195], a[196:199], v[84:87], v[192:195]
    ds_read_b64_tr_b16 a[218:219], v4 offset:864
    ds_read_b64_tr_b16 a[220:221], v4 offset:17248
    v_fma_mix_f32 v32, v100, v16, v20 op_sel:[0,0,0] op_sel_hi:[1,0,0]
    v_mfma_f32_16x16x32_bf16 v[224:227], a[192:195], v[88:91], v[224:227]
    s_mov_b32 s54, 16384
    ds_read_b64_tr_b16 a[222:223], v4 offset:17760
    ds_read_b128 v[28:31], v9 offset:3376
    v_mfma_f32_16x16x32_bf16 v[224:227], a[196:199], v[92:95], v[224:227]
    s_waitcnt lgkmcnt(10)
    buffer_load_dwordx4 v[48:51], v8, s[32:35], s54 offen
    v_mfma_f32_16x16x32_bf16 v[196:199], a[200:203], v[80:83], v[196:199]
    ds_read_b64_tr_b16 a[224:225], v4 offset:384
    v_fma_mix_f32 v33, v100, v17, v21 op_sel:[1,0,0] op_sel_hi:[1,0,0]
    v_mfma_f32_16x16x32_bf16 v[196:199], a[204:207], v[84:87], v[196:199]
    ds_read_b64_tr_b16 a[226:227], v4 offset:896
    ds_read_b64_tr_b16 a[228:229], v4 offset:17280
    v_fma_mix_f32 v34, v101, v18, v22 op_sel:[0,0,0] op_sel_hi:[1,0,0]
    v_mfma_f32_16x16x32_bf16 v[228:231], a[200:203], v[88:91], v[228:231]
    s_mov_b32 s54, 17408
    ds_read_b64_tr_b16 a[230:231], v4 offset:17792
    v_fma_mix_f32 v35, v101, v19, v23 op_sel:[1,0,0] op_sel_hi:[1,0,0]
    v_mfma_f32_16x16x32_bf16 v[228:231], a[204:207], v[92:95], v[228:231]
    s_waitcnt lgkmcnt(10)
    buffer_load_dwordx4 v[52:55], v8, s[32:35], s54 offen
    v_mfma_f32_16x16x32_bf16 v[200:203], a[208:211], v[80:83], v[200:203]
    ds_read_b64_tr_b16 a[232:233], v4 offset:416
    v_cvt_pk_bf16_f32 v100, v32, v33
    v_mfma_f32_16x16x32_bf16 v[200:203], a[212:215], v[84:87], v[200:203]
    ds_read_b64_tr_b16 a[234:235], v4 offset:928
    ds_read_b64_tr_b16 a[236:237], v4 offset:17312
    v_cvt_pk_bf16_f32 v101, v34, v35
    v_mfma_f32_16x16x32_bf16 v[232:235], a[208:211], v[88:91], v[232:235]
    s_mov_b32 s54, 34816
    ds_read_b64_tr_b16 a[238:239], v4 offset:17824
    v_fma_mix_f32 v36, v108, v16, v20 op_sel:[0,0,0] op_sel_hi:[1,0,0]
    v_mfma_f32_16x16x32_bf16 v[232:235], a[212:215], v[92:95], v[232:235]
    s_waitcnt lgkmcnt(9)
    buffer_load_dwordx4 v[56:59], v8, s[32:35], s54 offen
    v_fma_mix_f32 v37, v108, v17, v21 op_sel:[1,0,0] op_sel_hi:[1,0,0]
    v_mfma_f32_16x16x32_bf16 v[204:207], a[216:219], v[80:83], v[204:207]
    ds_read_b64_tr_b16 a[240:241], v4 offset:448
    v_fma_mix_f32 v38, v109, v18, v22 op_sel:[0,0,0] op_sel_hi:[1,0,0]
    v_mfma_f32_16x16x32_bf16 v[204:207], a[220:223], v[84:87], v[204:207]
    ds_read_b64_tr_b16 a[242:243], v4 offset:960
    ds_read_b64_tr_b16 a[244:245], v4 offset:17344
    v_fma_mix_f32 v39, v109, v19, v23 op_sel:[1,0,0] op_sel_hi:[1,0,0]
    v_mfma_f32_16x16x32_bf16 v[236:239], a[216:219], v[88:91], v[236:239]
    s_mov_b32 s54, 35840
    ds_read_b64_tr_b16 a[246:247], v4 offset:17856
    v_cvt_pk_bf16_f32 v108, v36, v37
    v_mfma_f32_16x16x32_bf16 v[236:239], a[220:223], v[92:95], v[236:239]
    s_waitcnt lgkmcnt(8)
    buffer_load_dwordx4 v[60:63], v8, s[32:35], s54 offen
    v_cvt_pk_bf16_f32 v109, v38, v39
    v_mfma_f32_16x16x32_bf16 v[208:211], a[224:227], v[80:83], v[208:211]
    ds_read_b64_tr_b16 a[248:249], v4 offset:480
    ds_read_b128 v[16:19], v9 offset:3584
    v_mfma_f32_16x16x32_bf16 v[208:211], a[228:231], v[84:87], v[208:211]
    ds_read_b64_tr_b16 a[250:251], v4 offset:992
    ds_read_b128 v[20:23], v9 offset:3616
    v_mfma_f32_16x16x32_bf16 v[240:243], a[224:227], v[88:91], v[240:243]
    ds_read_b64_tr_b16 a[252:253], v4 offset:17376
    v_fma_mix_f32 v32, v102, v24, v28 op_sel:[0,0,0] op_sel_hi:[1,0,0]
    v_mfma_f32_16x16x32_bf16 v[240:243], a[228:231], v[92:95], v[240:243]
    s_waitcnt vmcnt(16)
    s_barrier
    s_waitcnt lgkmcnt(9)
    ds_read_b64_tr_b16 a[254:255], v4 offset:17888
    v_fma_mix_f32 v33, v102, v25, v29 op_sel:[1,0,0] op_sel_hi:[1,0,0]
    v_fma_mix_f32 v34, v103, v26, v30 op_sel:[0,0,0] op_sel_hi:[1,0,0]
    v_mfma_f32_16x16x32_bf16 v[212:215], a[232:235], v[80:83], v[212:215]
    ds_read_b64_tr_b16 a[192:193], v4 offset:36864
    v_fma_mix_f32 v35, v103, v27, v31 op_sel:[1,0,0] op_sel_hi:[1,0,0]
    v_mfma_f32_16x16x32_bf16 v[212:215], a[236:239], v[84:87], v[212:215]
    ds_read_b64_tr_b16 a[194:195], v4 offset:37376
    ds_read_b64_tr_b16 a[196:197], v4 offset:53760
    v_cvt_pk_bf16_f32 v102, v32, v33
    v_mfma_f32_16x16x32_bf16 v[244:247], a[232:235], v[88:91], v[244:247]
    s_add_u32 m0, s44, 36864
    ds_read_b64_tr_b16 a[198:199], v4 offset:54272
    v_cvt_pk_bf16_f32 v103, v34, v35
    v_mfma_f32_16x16x32_bf16 v[244:247], a[236:239], v[92:95], v[244:247]
    s_mov_b32 s45, 4194304
    s_waitcnt lgkmcnt(10)
    buffer_load_dwordx4 v6, s[24:27], s45 offen lds
    v_mfma_f32_16x16x32_bf16 v[216:219], a[240:243], v[80:83], v[216:219]
    ds_read_b64_tr_b16 a[200:201], v4 offset:36896
    v_fma_mix_f32 v36, v110, v24, v28 op_sel:[0,0,0] op_sel_hi:[1,0,0]
    v_mfma_f32_16x16x32_bf16 v[216:219], a[244:247], v[84:87], v[216:219]
    ds_read_b64_tr_b16 a[202:203], v4 offset:37408
    ds_read_b64_tr_b16 a[204:205], v4 offset:53792
    v_fma_mix_f32 v37, v110, v25, v29 op_sel:[1,0,0] op_sel_hi:[1,0,0]
    v_mfma_f32_16x16x32_bf16 v[248:251], a[240:243], v[88:91], v[248:251]
    s_add_u32 m0, s44, 37920
    ds_read_b64_tr_b16 a[206:207], v4 offset:54304
    v_fma_mix_f32 v38, v111, v26, v30 op_sel:[0,0,0] op_sel_hi:[1,0,0]
    v_mfma_f32_16x16x32_bf16 v[248:251], a[244:247], v[92:95], v[248:251]
    s_mov_b32 s45, 4202496
    s_waitcnt lgkmcnt(8)
    buffer_load_dwordx4 v6, s[24:27], s45 offen lds
    v_mfma_f32_16x16x32_bf16 v[220:223], a[248:251], v[80:83], v[220:223]
    ds_read_b64_tr_b16 a[208:209], v4 offset:36928
    v_fma_mix_f32 v39, v111, v27, v31 op_sel:[1,0,0] op_sel_hi:[1,0,0]
    v_mfma_f32_16x16x32_bf16 v[220:223], a[252:255], v[84:87], v[220:223]
    ds_read_b64_tr_b16 a[210:211], v4 offset:37440
    ds_read_b64_tr_b16 a[212:213], v4 offset:53824
    v_cvt_pk_bf16_f32 v110, v36, v37
    v_mfma_f32_16x16x32_bf16 v[252:255], a[248:251], v[88:91], v[252:255]
    s_add_u32 m0, s44, 38976
    ds_read_b64_tr_b16 a[214:215], v4 offset:54336
    v_cvt_pk_bf16_f32 v111, v38, v39
    v_mfma_f32_16x16x32_bf16 v[252:255], a[252:255], v[92:95], v[252:255]
    s_mov_b32 s45, 4210688
    s_waitcnt lgkmcnt(8)
    buffer_load_dwordx4 v6, s[24:27], s45 offen lds
    v_mfma_f32_16x16x32_bf16 v[128:131], a[192:195], v[96:99], v[128:131]
    s_waitcnt vmcnt(15)
    ds_read_b64_tr_b16 a[216:217], v4 offset:36960
    ds_read_b128 v[24:27], v9 offset:3600
    v_mfma_f32_16x16x32_bf16 v[128:131], a[196:199], v[100:103], v[128:131]
    ds_read_b64_tr_b16 a[218:219], v4 offset:37472
    ds_read_b64_tr_b16 a[220:221], v4 offset:53856
    v_fma_mix_f32 v32, v112, v16, v20 op_sel:[0,0,0] op_sel_hi:[1,0,0]
    v_mfma_f32_16x16x32_bf16 v[160:163], a[192:195], v[104:107], v[160:163]
    s_add_u32 m0, s44, 40032
    ds_read_b64_tr_b16 a[222:223], v4 offset:54368
    ds_read_b128 v[28:31], v9 offset:3632
    v_mfma_f32_16x16x32_bf16 v[160:163], a[196:199], v[108:111], v[160:163]
    s_mov_b32 s45, 4218880
    s_waitcnt lgkmcnt(10)
    buffer_load_dwordx4 v6, s[24:27], s45 offen lds
    v_mfma_f32_16x16x32_bf16 v[132:135], a[200:203], v[96:99], v[132:135]
    ds_read_b64_tr_b16 a[224:225], v4 offset:36992
    v_fma_mix_f32 v33, v112, v17, v21 op_sel:[1,0,0] op_sel_hi:[1,0,0]
    v_mfma_f32_16x16x32_bf16 v[132:135], a[204:207], v[100:103], v[132:135]
    ds_read_b64_tr_b16 a[226:227], v4 offset:37504
    ds_read_b64_tr_b16 a[228:229], v4 offset:53888
    v_fma_mix_f32 v34, v113, v18, v22 op_sel:[0,0,0] op_sel_hi:[1,0,0]
    v_mfma_f32_16x16x32_bf16 v[164:167], a[200:203], v[104:107], v[164:167]
    s_add_u32 m0, s44, 53760
    ds_read_b64_tr_b16 a[230:231], v4 offset:54400
    v_fma_mix_f32 v35, v113, v19, v23 op_sel:[1,0,0] op_sel_hi:[1,0,0]
    v_mfma_f32_16x16x32_bf16 v[164:167], a[204:207], v[108:111], v[164:167]
    s_mov_b32 s45, 4456448
    s_waitcnt lgkmcnt(10)
    buffer_load_dwordx4 v6, s[24:27], s45 offen lds
    v_mfma_f32_16x16x32_bf16 v[136:139], a[208:211], v[96:99], v[136:139]
    ds_read_b64_tr_b16 a[232:233], v4 offset:37024
    v_cvt_pk_bf16_f32 v112, v32, v33
    v_mfma_f32_16x16x32_bf16 v[136:139], a[212:215], v[100:103], v[136:139]
    ds_read_b64_tr_b16 a[234:235], v4 offset:37536
    ds_read_b64_tr_b16 a[236:237], v4 offset:53920
    v_cvt_pk_bf16_f32 v113, v34, v35
    v_mfma_f32_16x16x32_bf16 v[168:171], a[208:211], v[104:107], v[168:171]
    s_add_u32 m0, s44, 54816
    ds_read_b64_tr_b16 a[238:239], v4 offset:54432
    v_fma_mix_f32 v36, v120, v16, v20 op_sel:[0,0,0] op_sel_hi:[1,0,0]
    v_mfma_f32_16x16x32_bf16 v[168:171], a[212:215], v[108:111], v[168:171]
    s_mov_b32 s45, 4464640
    s_waitcnt lgkmcnt(9)
    buffer_load_dwordx4 v6, s[24:27], s45 offen lds
    v_fma_mix_f32 v37, v120, v17, v21 op_sel:[1,0,0] op_sel_hi:[1,0,0]
    v_mfma_f32_16x16x32_bf16 v[140:143], a[216:219], v[96:99], v[140:143]
    ds_read_b64_tr_b16 a[240:241], v4 offset:37056
    v_fma_mix_f32 v38, v121, v18, v22 op_sel:[0,0,0] op_sel_hi:[1,0,0]
    v_mfma_f32_16x16x32_bf16 v[140:143], a[220:223], v[100:103], v[140:143]
    ds_read_b64_tr_b16 a[242:243], v4 offset:37568
    ds_read_b64_tr_b16 a[244:245], v4 offset:53952
    v_fma_mix_f32 v39, v121, v19, v23 op_sel:[1,0,0] op_sel_hi:[1,0,0]
    v_mfma_f32_16x16x32_bf16 v[172:175], a[216:219], v[104:107], v[172:175]
    s_add_u32 m0, s44, 55872
    ds_read_b64_tr_b16 a[246:247], v4 offset:54464
    v_cvt_pk_bf16_f32 v120, v36, v37
    v_mfma_f32_16x16x32_bf16 v[172:175], a[220:223], v[108:111], v[172:175]
    s_mov_b32 s45, 4472832
    s_waitcnt lgkmcnt(8)
    buffer_load_dwordx4 v6, s[24:27], s45 offen lds
    v_cvt_pk_bf16_f32 v121, v38, v39
    v_mfma_f32_16x16x32_bf16 v[144:147], a[224:227], v[96:99], v[144:147]
    ds_read_b64_tr_b16 a[248:249], v4 offset:37088
    ds_read_b128 v[16:19], v9 offset:3840
    v_mfma_f32_16x16x32_bf16 v[144:147], a[228:231], v[100:103], v[144:147]
    ds_read_b64_tr_b16 a[250:251], v4 offset:37600
    ds_read_b64_tr_b16 a[252:253], v4 offset:53984
    v_mfma_f32_16x16x32_bf16 v[176:179], a[224:227], v[104:107], v[176:179]
    s_add_u32 m0, s44, 56928
    ds_read_b64_tr_b16 a[254:255], v4 offset:54496
    ds_read_b128 v[20:23], v9 offset:3872
    v_mfma_f32_16x16x32_bf16 v[176:179], a[228:231], v[108:111], v[176:179]
    s_mov_b32 s45, 4481024
    s_waitcnt lgkmcnt(10)
    buffer_load_dwordx4 v6, s[24:27], s45 offen lds
    v_mfma_f32_16x16x32_bf16 v[148:151], a[232:235], v[96:99], v[148:151]
    ds_read_b64_tr_b16 a[192:193], v4 offset:37120
    v_fma_mix_f32 v32, v114, v24, v28 op_sel:[0,0,0] op_sel_hi:[1,0,0]
    v_mfma_f32_16x16x32_bf16 v[148:151], a[236:239], v[100:103], v[148:151]
    ds_read_b64_tr_b16 a[194:195], v4 offset:37632
    v_fma_mix_f32 v33, v114, v25, v29 op_sel:[1,0,0] op_sel_hi:[1,0,0]
    v_mfma_f32_16x16x32_bf16 v[180:183], a[232:235], v[104:107], v[180:183]
    ds_read_b64_tr_b16 a[196:197], v4 offset:54016
    v_fma_mix_f32 v34, v115, v26, v30 op_sel:[0,0,0] op_sel_hi:[1,0,0]
    v_mfma_f32_16x16x32_bf16 v[180:183], a[236:239], v[108:111], v[180:183]
    s_waitcnt lgkmcnt(9)
    ds_read_b64_tr_b16 a[198:199], v4 offset:54528
    v_fma_mix_f32 v35, v115, v27, v31 op_sel:[1,0,0] op_sel_hi:[1,0,0]
    v_mfma_f32_16x16x32_bf16 v[152:155], a[240:243], v[96:99], v[152:155]
    ds_read_b64_tr_b16 a[200:201], v4 offset:37152
    v_cvt_pk_bf16_f32 v114, v32, v33
    v_mfma_f32_16x16x32_bf16 v[152:155], a[244:247], v[100:103], v[152:155]
    ds_read_b64_tr_b16 a[202:203], v4 offset:37664
    v_cvt_pk_bf16_f32 v115, v34, v35
    v_mfma_f32_16x16x32_bf16 v[184:187], a[240:243], v[104:107], v[184:187]
    ds_read_b64_tr_b16 a[204:205], v4 offset:54048
    v_fma_mix_f32 v36, v122, v24, v28 op_sel:[0,0,0] op_sel_hi:[1,0,0]
    v_mfma_f32_16x16x32_bf16 v[184:187], a[244:247], v[108:111], v[184:187]
    s_waitcnt lgkmcnt(8)
    ds_read_b64_tr_b16 a[206:207], v4 offset:54560
    v_fma_mix_f32 v37, v122, v25, v29 op_sel:[1,0,0] op_sel_hi:[1,0,0]
    v_mfma_f32_16x16x32_bf16 v[156:159], a[248:251], v[96:99], v[156:159]
    ds_read_b64_tr_b16 a[208:209], v4 offset:37184
    v_fma_mix_f32 v38, v123, v26, v30 op_sel:[0,0,0] op_sel_hi:[1,0,0]
    v_mfma_f32_16x16x32_bf16 v[156:159], a[252:255], v[100:103], v[156:159]
    ds_read_b64_tr_b16 a[210:211], v4 offset:37696
    v_fma_mix_f32 v39, v123, v27, v31 op_sel:[1,0,0] op_sel_hi:[1,0,0]
    v_mfma_f32_16x16x32_bf16 v[188:191], a[248:251], v[104:107], v[188:191]
    ds_read_b64_tr_b16 a[212:213], v4 offset:54080
    v_cvt_pk_bf16_f32 v122, v36, v37
    v_mfma_f32_16x16x32_bf16 v[188:191], a[252:255], v[108:111], v[188:191]
    s_waitcnt lgkmcnt(7)
    ds_read_b64_tr_b16 a[214:215], v4 offset:54592
    v_cvt_pk_bf16_f32 v123, v38, v39
    v_mfma_f32_16x16x32_bf16 v[192:195], a[192:195], v[96:99], v[192:195]
    ds_read_b64_tr_b16 a[216:217], v4 offset:37216
    ds_read_b128 v[24:27], v9 offset:3856
    v_mfma_f32_16x16x32_bf16 v[192:195], a[196:199], v[100:103], v[192:195]
    ds_read_b64_tr_b16 a[218:219], v4 offset:37728
    ds_read_b128 v[28:31], v9 offset:3888
    v_mfma_f32_16x16x32_bf16 v[224:227], a[192:195], v[104:107], v[224:227]
    ds_read_b64_tr_b16 a[220:221], v4 offset:54112
    v_fma_mix_f32 v32, v116, v16, v20 op_sel:[0,0,0] op_sel_hi:[1,0,0]
    v_mfma_f32_16x16x32_bf16 v[224:227], a[196:199], v[108:111], v[224:227]
    s_waitcnt lgkmcnt(9)
    ds_read_b64_tr_b16 a[222:223], v4 offset:54624
    v_fma_mix_f32 v33, v116, v17, v21 op_sel:[1,0,0] op_sel_hi:[1,0,0]
    v_mfma_f32_16x16x32_bf16 v[196:199], a[200:203], v[96:99], v[196:199]
    ds_read_b64_tr_b16 a[224:225], v4 offset:37248
    v_fma_mix_f32 v34, v117, v18, v22 op_sel:[0,0,0] op_sel_hi:[1,0,0]
    v_mfma_f32_16x16x32_bf16 v[196:199], a[204:207], v[100:103], v[196:199]
    ds_read_b64_tr_b16 a[226:227], v4 offset:37760
    v_fma_mix_f32 v35, v117, v19, v23 op_sel:[1,0,0] op_sel_hi:[1,0,0]
    v_mfma_f32_16x16x32_bf16 v[228:231], a[200:203], v[104:107], v[228:231]
    ds_read_b64_tr_b16 a[228:229], v4 offset:54144
    v_cvt_pk_bf16_f32 v116, v32, v33
    v_mfma_f32_16x16x32_bf16 v[228:231], a[204:207], v[108:111], v[228:231]
    s_waitcnt lgkmcnt(9)
    ds_read_b64_tr_b16 a[230:231], v4 offset:54656
    v_cvt_pk_bf16_f32 v117, v34, v35
    v_mfma_f32_16x16x32_bf16 v[200:203], a[208:211], v[96:99], v[200:203]
    ds_read_b64_tr_b16 a[232:233], v4 offset:37280
    v_fma_mix_f32 v36, v124, v16, v20 op_sel:[0,0,0] op_sel_hi:[1,0,0]
    v_mfma_f32_16x16x32_bf16 v[200:203], a[212:215], v[100:103], v[200:203]
    ds_read_b64_tr_b16 a[234:235], v4 offset:37792
    v_fma_mix_f32 v37, v124, v17, v21 op_sel:[1,0,0] op_sel_hi:[1,0,0]
    v_mfma_f32_16x16x32_bf16 v[232:235], a[208:211], v[104:107], v[232:235]
    ds_read_b64_tr_b16 a[236:237], v4 offset:54176
    v_fma_mix_f32 v38, v125, v18, v22 op_sel:[0,0,0] op_sel_hi:[1,0,0]
    v_mfma_f32_16x16x32_bf16 v[232:235], a[212:215], v[108:111], v[232:235]
    s_waitcnt lgkmcnt(7)
    ds_read_b64_tr_b16 a[238:239], v4 offset:54688
    v_fma_mix_f32 v39, v125, v19, v23 op_sel:[1,0,0] op_sel_hi:[1,0,0]
    v_mfma_f32_16x16x32_bf16 v[204:207], a[216:219], v[96:99], v[204:207]
    ds_read_b64_tr_b16 a[240:241], v4 offset:37312
    v_cvt_pk_bf16_f32 v124, v36, v37
    v_mfma_f32_16x16x32_bf16 v[204:207], a[220:223], v[100:103], v[204:207]
    ds_read_b64_tr_b16 a[242:243], v4 offset:37824
    v_cvt_pk_bf16_f32 v125, v38, v39
    v_mfma_f32_16x16x32_bf16 v[236:239], a[216:219], v[104:107], v[236:239]
    ds_read_b64_tr_b16 a[244:245], v4 offset:54208
    v_mfma_f32_16x16x32_bf16 v[236:239], a[220:223], v[108:111], v[236:239]
    s_waitcnt lgkmcnt(7)
    ds_read_b64_tr_b16 a[246:247], v4 offset:54720
    v_mfma_f32_16x16x32_bf16 v[208:211], a[224:227], v[96:99], v[208:211]
    ds_read_b64_tr_b16 a[248:249], v4 offset:37344
    ds_read_b128 v[16:19], v9 offset:4096
    v_mfma_f32_16x16x32_bf16 v[208:211], a[228:231], v[100:103], v[208:211]
    ds_read_b64_tr_b16 a[250:251], v4 offset:37856
    ds_read_b128 v[20:23], v9 offset:4128
    v_mfma_f32_16x16x32_bf16 v[240:243], a[224:227], v[104:107], v[240:243]
    ds_read_b64_tr_b16 a[252:253], v4 offset:54240
    v_fma_mix_f32 v32, v118, v24, v28 op_sel:[0,0,0] op_sel_hi:[1,0,0]
    v_mfma_f32_16x16x32_bf16 v[240:243], a[228:231], v[108:111], v[240:243]
    s_waitcnt vmcnt(12)
    s_barrier
    s_waitcnt lgkmcnt(9)
    ds_read_b64_tr_b16 a[254:255], v4 offset:54752
    v_fma_mix_f32 v33, v118, v25, v29 op_sel:[1,0,0] op_sel_hi:[1,0,0]
    v_fma_mix_f32 v34, v119, v26, v30 op_sel:[0,0,0] op_sel_hi:[1,0,0]
    v_mfma_f32_16x16x32_bf16 v[212:215], a[232:235], v[96:99], v[212:215]
    ds_read_b64_tr_b16 a[192:193], v3 offset:0
    v_fma_mix_f32 v35, v119, v27, v31 op_sel:[1,0,0] op_sel_hi:[1,0,0]
    v_mfma_f32_16x16x32_bf16 v[212:215], a[236:239], v[100:103], v[212:215]
    ds_read_b64_tr_b16 a[194:195], v3 offset:512
    ds_read_b64_tr_b16 a[196:197], v3 offset:16896
    v_cvt_pk_bf16_f32 v118, v32, v33
    v_mfma_f32_16x16x32_bf16 v[244:247], a[232:235], v[104:107], v[244:247]
    s_add_u32 m0, s44, 73728
    ds_read_b64_tr_b16 a[198:199], v3 offset:17408
    v_cvt_pk_bf16_f32 v119, v34, v35
    v_mfma_f32_16x16x32_bf16 v[244:247], a[236:239], v[108:111], v[244:247]
    s_mov_b32 s46, 0
    s_waitcnt lgkmcnt(10)
    buffer_load_dwordx4 v5, s[16:19], s46 offen offset:0 lds
    v_mfma_f32_16x16x32_bf16 v[216:219], a[240:243], v[96:99], v[216:219]
    ds_read_b64_tr_b16 a[200:201], v3 offset:32
    v_fma_mix_f32 v36, v126, v24, v28 op_sel:[0,0,0] op_sel_hi:[1,0,0]
    v_mfma_f32_16x16x32_bf16 v[216:219], a[244:247], v[100:103], v[216:219]
    ds_read_b64_tr_b16 a[202:203], v3 offset:544
    ds_read_b64_tr_b16 a[204:205], v3 offset:16928
    v_fma_mix_f32 v37, v126, v25, v29 op_sel:[1,0,0] op_sel_hi:[1,0,0]
    v_mfma_f32_16x16x32_bf16 v[248:251], a[240:243], v[104:107], v[248:251]
    s_add_u32 m0, s44, 73760
    ds_read_b64_tr_b16 a[206:207], v3 offset:17440
    v_fma_mix_f32 v38, v127, v26, v30 op_sel:[0,0,0] op_sel_hi:[1,0,0]
    v_mfma_f32_16x16x32_bf16 v[248:251], a[244:247], v[108:111], v[248:251]
    s_waitcnt lgkmcnt(8)
    buffer_load_dwordx4 v5, s[16:19], s46 offen offset:1024 lds
    v_mfma_f32_16x16x32_bf16 v[220:223], a[248:251], v[96:99], v[220:223]
    ds_read_b64_tr_b16 a[208:209], v3 offset:64
    v_fma_mix_f32 v39, v127, v27, v31 op_sel:[1,0,0] op_sel_hi:[1,0,0]
    v_mfma_f32_16x16x32_bf16 v[220:223], a[252:255], v[100:103], v[220:223]
    ds_read_b64_tr_b16 a[210:211], v3 offset:576
    ds_read_b64_tr_b16 a[212:213], v3 offset:16960
    v_cvt_pk_bf16_f32 v126, v36, v37
    v_mfma_f32_16x16x32_bf16 v[252:255], a[248:251], v[104:107], v[252:255]
    s_add_u32 m0, s44, 73792
    ds_read_b64_tr_b16 a[214:215], v3 offset:17472
    v_cvt_pk_bf16_f32 v127, v38, v39
    v_mfma_f32_16x16x32_bf16 v[252:255], a[252:255], v[108:111], v[252:255]
    s_waitcnt lgkmcnt(8)
    buffer_load_dwordx4 v5, s[16:19], s46 offen offset:2048 lds
    v_mfma_f32_16x16x32_bf16 v[128:131], a[192:195], v[112:115], v[128:131]
    s_waitcnt vmcnt(11)
    ds_read_b64_tr_b16 a[216:217], v3 offset:96
    ds_read_b128 v[24:27], v9 offset:4112
    v_mfma_f32_16x16x32_bf16 v[128:131], a[196:199], v[116:119], v[128:131]
    ds_read_b64_tr_b16 a[218:219], v3 offset:608
    ds_read_b64_tr_b16 a[220:221], v3 offset:16992
    v_fma_mix_f32 v32, v48, v16, v20 op_sel:[0,0,0] op_sel_hi:[1,0,0]
    v_mfma_f32_16x16x32_bf16 v[160:163], a[192:195], v[120:123], v[160:163]
    s_add_u32 m0, s44, 73824
    ds_read_b64_tr_b16 a[222:223], v3 offset:17504
    ds_read_b128 v[28:31], v9 offset:4144
    v_mfma_f32_16x16x32_bf16 v[160:163], a[196:199], v[124:127], v[160:163]
    s_waitcnt lgkmcnt(10)
    buffer_load_dwordx4 v5, s[16:19], s46 offen offset:3072 lds
    v_mfma_f32_16x16x32_bf16 v[132:135], a[200:203], v[112:115], v[132:135]
    ds_read_b64_tr_b16 a[224:225], v3 offset:128
    v_fma_mix_f32 v33, v48, v17, v21 op_sel:[1,0,0] op_sel_hi:[1,0,0]
    v_mfma_f32_16x16x32_bf16 v[132:135], a[204:207], v[116:119], v[132:135]
    ds_read_b64_tr_b16 a[226:227], v3 offset:640
    ds_read_b64_tr_b16 a[228:229], v3 offset:17024
    v_fma_mix_f32 v34, v49, v18, v22 op_sel:[0,0,0] op_sel_hi:[1,0,0]
    v_mfma_f32_16x16x32_bf16 v[164:167], a[200:203], v[120:123], v[164:167]
    s_add_u32 m0, s44, 90624
    ds_read_b64_tr_b16 a[230:231], v3 offset:17536
    v_fma_mix_f32 v35, v49, v19, v23 op_sel:[1,0,0] op_sel_hi:[1,0,0]
    v_mfma_f32_16x16x32_bf16 v[164:167], a[204:207], v[124:127], v[164:167]
    s_waitcnt lgkmcnt(10)
    buffer_load_dwordx4 v5, s[20:23], s46 offen offset:0 lds
    v_mfma_f32_16x16x32_bf16 v[136:139], a[208:211], v[112:115], v[136:139]
    ds_read_b64_tr_b16 a[232:233], v3 offset:160
    v_cvt_pk_bf16_f32 v48, v32, v33
    v_mfma_f32_16x16x32_bf16 v[136:139], a[212:215], v[116:119], v[136:139]
    ds_read_b64_tr_b16 a[234:235], v3 offset:672
    ds_read_b64_tr_b16 a[236:237], v3 offset:17056
    v_cvt_pk_bf16_f32 v49, v34, v35
    v_mfma_f32_16x16x32_bf16 v[168:171], a[208:211], v[120:123], v[168:171]
    s_add_u32 m0, s44, 90656
    ds_read_b64_tr_b16 a[238:239], v3 offset:17568
    v_fma_mix_f32 v36, v56, v16, v20 op_sel:[0,0,0] op_sel_hi:[1,0,0]
    v_mfma_f32_16x16x32_bf16 v[168:171], a[212:215], v[124:127], v[168:171]
    s_waitcnt lgkmcnt(9)
    buffer_load_dwordx4 v5, s[20:23], s46 offen offset:1024 lds
    v_fma_mix_f32 v37, v56, v17, v21 op_sel:[1,0,0] op_sel_hi:[1,0,0]
    v_mfma_f32_16x16x32_bf16 v[140:143], a[216:219], v[112:115], v[140:143]
    ds_read_b64_tr_b16 a[240:241], v3 offset:192
    v_fma_mix_f32 v38, v57, v18, v22 op_sel:[0,0,0] op_sel_hi:[1,0,0]
    v_mfma_f32_16x16x32_bf16 v[140:143], a[220:223], v[116:119], v[140:143]
    ds_read_b64_tr_b16 a[242:243], v3 offset:704
    ds_read_b64_tr_b16 a[244:245], v3 offset:17088
    v_fma_mix_f32 v39, v57, v19, v23 op_sel:[1,0,0] op_sel_hi:[1,0,0]
    v_mfma_f32_16x16x32_bf16 v[172:175], a[216:219], v[120:123], v[172:175]
    s_add_u32 m0, s44, 90688
    ds_read_b64_tr_b16 a[246:247], v3 offset:17600
    v_cvt_pk_bf16_f32 v56, v36, v37
    v_mfma_f32_16x16x32_bf16 v[172:175], a[220:223], v[124:127], v[172:175]
    s_waitcnt lgkmcnt(8)
    buffer_load_dwordx4 v5, s[20:23], s46 offen offset:2048 lds
    v_cvt_pk_bf16_f32 v57, v38, v39
    v_mfma_f32_16x16x32_bf16 v[144:147], a[224:227], v[112:115], v[144:147]
    ds_read_b64_tr_b16 a[248:249], v3 offset:224
    ds_read_b128 v[16:19], v9 offset:4352
    v_mfma_f32_16x16x32_bf16 v[144:147], a[228:231], v[116:119], v[144:147]
    ds_read_b64_tr_b16 a[250:251], v3 offset:736
    ds_read_b64_tr_b16 a[252:253], v3 offset:17120
    v_mfma_f32_16x16x32_bf16 v[176:179], a[224:227], v[120:123], v[176:179]
    s_add_u32 m0, s44, 90720
    ds_read_b64_tr_b16 a[254:255], v3 offset:17632
    ds_read_b128 v[20:23], v9 offset:4384
    v_mfma_f32_16x16x32_bf16 v[176:179], a[228:231], v[124:127], v[176:179]
    s_waitcnt lgkmcnt(10)
    buffer_load_dwordx4 v5, s[20:23], s46 offen offset:3072 lds
    v_mfma_f32_16x16x32_bf16 v[148:151], a[232:235], v[112:115], v[148:151]
    ds_read_b64_tr_b16 a[192:193], v3 offset:256
    v_fma_mix_f32 v32, v50, v24, v28 op_sel:[0,0,0] op_sel_hi:[1,0,0]
    v_mfma_f32_16x16x32_bf16 v[148:151], a[236:239], v[116:119], v[148:151]
    ds_read_b64_tr_b16 a[194:195], v3 offset:768
    v_fma_mix_f32 v33, v50, v25, v29 op_sel:[1,0,0] op_sel_hi:[1,0,0]
    v_mfma_f32_16x16x32_bf16 v[180:183], a[232:235], v[120:123], v[180:183]
    ds_read_b64_tr_b16 a[196:197], v3 offset:17152
    v_fma_mix_f32 v34, v51, v26, v30 op_sel:[0,0,0] op_sel_hi:[1,0,0]
    v_mfma_f32_16x16x32_bf16 v[180:183], a[236:239], v[124:127], v[180:183]
    s_waitcnt lgkmcnt(9)
    ds_read_b64_tr_b16 a[198:199], v3 offset:17664
    v_fma_mix_f32 v35, v51, v27, v31 op_sel:[1,0,0] op_sel_hi:[1,0,0]
    v_mfma_f32_16x16x32_bf16 v[152:155], a[240:243], v[112:115], v[152:155]
    ds_read_b64_tr_b16 a[200:201], v3 offset:288
    v_cvt_pk_bf16_f32 v50, v32, v33
    v_mfma_f32_16x16x32_bf16 v[152:155], a[244:247], v[116:119], v[152:155]
    ds_read_b64_tr_b16 a[202:203], v3 offset:800
    v_cvt_pk_bf16_f32 v51, v34, v35
    v_mfma_f32_16x16x32_bf16 v[184:187], a[240:243], v[120:123], v[184:187]
    ds_read_b64_tr_b16 a[204:205], v3 offset:17184
    v_fma_mix_f32 v36, v58, v24, v28 op_sel:[0,0,0] op_sel_hi:[1,0,0]
    v_mfma_f32_16x16x32_bf16 v[184:187], a[244:247], v[124:127], v[184:187]
    s_waitcnt lgkmcnt(8)
    ds_read_b64_tr_b16 a[206:207], v3 offset:17696
    v_fma_mix_f32 v37, v58, v25, v29 op_sel:[1,0,0] op_sel_hi:[1,0,0]
    v_mfma_f32_16x16x32_bf16 v[156:159], a[248:251], v[112:115], v[156:159]
    ds_read_b64_tr_b16 a[208:209], v3 offset:320
    v_fma_mix_f32 v38, v59, v26, v30 op_sel:[0,0,0] op_sel_hi:[1,0,0]
    v_mfma_f32_16x16x32_bf16 v[156:159], a[252:255], v[116:119], v[156:159]
    ds_read_b64_tr_b16 a[210:211], v3 offset:832
    v_fma_mix_f32 v39, v59, v27, v31 op_sel:[1,0,0] op_sel_hi:[1,0,0]
    v_mfma_f32_16x16x32_bf16 v[188:191], a[248:251], v[120:123], v[188:191]
    ds_read_b64_tr_b16 a[212:213], v3 offset:17216
    v_cvt_pk_bf16_f32 v58, v36, v37
    v_mfma_f32_16x16x32_bf16 v[188:191], a[252:255], v[124:127], v[188:191]
    s_waitcnt lgkmcnt(7)
    ds_read_b64_tr_b16 a[214:215], v3 offset:17728
    v_cvt_pk_bf16_f32 v59, v38, v39
    v_mfma_f32_16x16x32_bf16 v[192:195], a[192:195], v[112:115], v[192:195]
    ds_read_b64_tr_b16 a[216:217], v3 offset:352
    ds_read_b128 v[24:27], v9 offset:4368
    v_mfma_f32_16x16x32_bf16 v[192:195], a[196:199], v[116:119], v[192:195]
    ds_read_b64_tr_b16 a[218:219], v3 offset:864
    ds_read_b128 v[28:31], v9 offset:4400
    v_mfma_f32_16x16x32_bf16 v[224:227], a[192:195], v[120:123], v[224:227]
    ds_read_b64_tr_b16 a[220:221], v3 offset:17248
    v_fma_mix_f32 v32, v52, v16, v20 op_sel:[0,0,0] op_sel_hi:[1,0,0]
    v_mfma_f32_16x16x32_bf16 v[224:227], a[196:199], v[124:127], v[224:227]
    s_waitcnt lgkmcnt(9)
    ds_read_b64_tr_b16 a[222:223], v3 offset:17760
    v_fma_mix_f32 v33, v52, v17, v21 op_sel:[1,0,0] op_sel_hi:[1,0,0]
    v_mfma_f32_16x16x32_bf16 v[196:199], a[200:203], v[112:115], v[196:199]
    ds_read_b64_tr_b16 a[224:225], v3 offset:384
    v_fma_mix_f32 v34, v53, v18, v22 op_sel:[0,0,0] op_sel_hi:[1,0,0]
    v_mfma_f32_16x16x32_bf16 v[196:199], a[204:207], v[116:119], v[196:199]
    ds_read_b64_tr_b16 a[226:227], v3 offset:896
    v_fma_mix_f32 v35, v53, v19, v23 op_sel:[1,0,0] op_sel_hi:[1,0,0]
    v_mfma_f32_16x16x32_bf16 v[228:231], a[200:203], v[120:123], v[228:231]
    ds_read_b64_tr_b16 a[228:229], v3 offset:17280
    v_cvt_pk_bf16_f32 v52, v32, v33
    v_mfma_f32_16x16x32_bf16 v[228:231], a[204:207], v[124:127], v[228:231]
    s_waitcnt lgkmcnt(9)
    ds_read_b64_tr_b16 a[230:231], v3 offset:17792
    v_cvt_pk_bf16_f32 v53, v34, v35
    v_mfma_f32_16x16x32_bf16 v[200:203], a[208:211], v[112:115], v[200:203]
    ds_read_b64_tr_b16 a[232:233], v3 offset:416
    v_fma_mix_f32 v36, v60, v16, v20 op_sel:[0,0,0] op_sel_hi:[1,0,0]
    v_mfma_f32_16x16x32_bf16 v[200:203], a[212:215], v[116:119], v[200:203]
    ds_read_b64_tr_b16 a[234:235], v3 offset:928
    v_fma_mix_f32 v37, v60, v17, v21 op_sel:[1,0,0] op_sel_hi:[1,0,0]
    v_mfma_f32_16x16x32_bf16 v[232:235], a[208:211], v[120:123], v[232:235]
    ds_read_b64_tr_b16 a[236:237], v3 offset:17312
    v_fma_mix_f32 v38, v61, v18, v22 op_sel:[0,0,0] op_sel_hi:[1,0,0]
    v_mfma_f32_16x16x32_bf16 v[232:235], a[212:215], v[124:127], v[232:235]
    s_waitcnt lgkmcnt(7)
    ds_read_b64_tr_b16 a[238:239], v3 offset:17824
    v_fma_mix_f32 v39, v61, v19, v23 op_sel:[1,0,0] op_sel_hi:[1,0,0]
    v_mfma_f32_16x16x32_bf16 v[204:207], a[216:219], v[112:115], v[204:207]
    ds_read_b64_tr_b16 a[240:241], v3 offset:448
    v_cvt_pk_bf16_f32 v60, v36, v37
    v_mfma_f32_16x16x32_bf16 v[204:207], a[220:223], v[116:119], v[204:207]
    ds_read_b64_tr_b16 a[242:243], v3 offset:960
    v_cvt_pk_bf16_f32 v61, v38, v39
    v_mfma_f32_16x16x32_bf16 v[236:239], a[216:219], v[120:123], v[236:239]
    ds_read_b64_tr_b16 a[244:245], v3 offset:17344
    v_mfma_f32_16x16x32_bf16 v[236:239], a[220:223], v[124:127], v[236:239]
    s_waitcnt lgkmcnt(7)
    ds_read_b64_tr_b16 a[246:247], v3 offset:17856
    v_mfma_f32_16x16x32_bf16 v[208:211], a[224:227], v[112:115], v[208:211]
    ds_read_b64_tr_b16 a[248:249], v3 offset:480
    v_fma_mix_f32 v32, v54, v24, v28 op_sel:[0,0,0] op_sel_hi:[1,0,0]
    v_mfma_f32_16x16x32_bf16 v[208:211], a[228:231], v[116:119], v[208:211]
    ds_read_b64_tr_b16 a[250:251], v3 offset:992
    v_fma_mix_f32 v33, v54, v25, v29 op_sel:[1,0,0] op_sel_hi:[1,0,0]
    v_mfma_f32_16x16x32_bf16 v[240:243], a[224:227], v[120:123], v[240:243]
    ds_read_b64_tr_b16 a[252:253], v3 offset:17376
    v_fma_mix_f32 v34, v55, v26, v30 op_sel:[0,0,0] op_sel_hi:[1,0,0]
    v_mfma_f32_16x16x32_bf16 v[240:243], a[228:231], v[124:127], v[240:243]
    s_waitcnt vmcnt(8)
    s_barrier
    s_waitcnt lgkmcnt(7)
    ds_read_b64_tr_b16 a[254:255], v3 offset:17888
    v_fma_mix_f32 v35, v55, v27, v31 op_sel:[1,0,0] op_sel_hi:[1,0,0]
    v_mfma_f32_16x16x32_bf16 v[212:215], a[232:235], v[112:115], v[212:215]
    ds_read_b64_tr_b16 a[192:193], v3 offset:36864
    v_cvt_pk_bf16_f32 v54, v32, v33
    v_mfma_f32_16x16x32_bf16 v[212:215], a[236:239], v[116:119], v[212:215]
    ds_read_b64_tr_b16 a[194:195], v3 offset:37376
    ds_read_b64_tr_b16 a[196:197], v3 offset:53760
    v_mfma_f32_16x16x32_bf16 v[244:247], a[232:235], v[120:123], v[244:247]
    s_add_u32 m0, s44, 110592
    ds_read_b64_tr_b16 a[198:199], v3 offset:54272
    v_cvt_pk_bf16_f32 v55, v34, v35
    v_mfma_f32_16x16x32_bf16 v[244:247], a[236:239], v[124:127], v[244:247]
    s_mov_b32 s46, 16384
    s_waitcnt lgkmcnt(8)
    buffer_load_dwordx4 v5, s[16:19], s46 offen offset:0 lds
    v_mfma_f32_16x16x32_bf16 v[216:219], a[240:243], v[112:115], v[216:219]
    ds_read_b64_tr_b16 a[200:201], v3 offset:36896
    v_fma_mix_f32 v36, v62, v24, v28 op_sel:[0,0,0] op_sel_hi:[1,0,0]
    v_mfma_f32_16x16x32_bf16 v[216:219], a[244:247], v[116:119], v[216:219]
    ds_read_b64_tr_b16 a[202:203], v3 offset:37408
    ds_read_b64_tr_b16 a[204:205], v3 offset:53792
    v_fma_mix_f32 v37, v62, v25, v29 op_sel:[1,0,0] op_sel_hi:[1,0,0]
    v_mfma_f32_16x16x32_bf16 v[248:251], a[240:243], v[120:123], v[248:251]
    s_add_u32 m0, s44, 110624
    ds_read_b64_tr_b16 a[206:207], v3 offset:54304
    v_fma_mix_f32 v38, v63, v26, v30 op_sel:[0,0,0] op_sel_hi:[1,0,0]
    v_mfma_f32_16x16x32_bf16 v[248:251], a[244:247], v[124:127], v[248:251]
    s_waitcnt lgkmcnt(8)
    buffer_load_dwordx4 v5, s[16:19], s46 offen offset:1024 lds
    v_mfma_f32_16x16x32_bf16 v[220:223], a[248:251], v[112:115], v[220:223]
    ds_read_b64_tr_b16 a[208:209], v3 offset:36928
    v_fma_mix_f32 v39, v63, v27, v31 op_sel:[1,0,0] op_sel_hi:[1,0,0]
    v_mfma_f32_16x16x32_bf16 v[220:223], a[252:255], v[116:119], v[220:223]
    ds_read_b64_tr_b16 a[210:211], v3 offset:37440
    ds_read_b64_tr_b16 a[212:213], v3 offset:53824
    v_cvt_pk_bf16_f32 v62, v36, v37
    v_mfma_f32_16x16x32_bf16 v[252:255], a[248:251], v[120:123], v[252:255]
    s_add_u32 m0, s44, 110656
    ds_read_b64_tr_b16 a[214:215], v3 offset:54336
    v_cvt_pk_bf16_f32 v63, v38, v39
    v_mfma_f32_16x16x32_bf16 v[252:255], a[252:255], v[124:127], v[252:255]
    s_waitcnt lgkmcnt(8)
    buffer_load_dwordx4 v5, s[16:19], s46 offen offset:2048 lds
    v_mfma_f32_16x16x32_bf16 v[128:131], a[192:195], v[48:51], v[128:131]
    ds_read_b64_tr_b16 a[216:217], v3 offset:36960
    v_mfma_f32_16x16x32_bf16 v[128:131], a[196:199], v[52:55], v[128:131]
    ds_read_b64_tr_b16 a[218:219], v3 offset:37472
    ds_read_b64_tr_b16 a[220:221], v3 offset:53856
    v_mfma_f32_16x16x32_bf16 v[160:163], a[192:195], v[56:59], v[160:163]
    s_add_u32 m0, s44, 110688
    ds_read_b64_tr_b16 a[222:223], v3 offset:54368
    v_mfma_f32_16x16x32_bf16 v[160:163], a[196:199], v[60:63], v[160:163]
    s_waitcnt lgkmcnt(8)
    buffer_load_dwordx4 v5, s[16:19], s46 offen offset:3072 lds
    v_mfma_f32_16x16x32_bf16 v[132:135], a[200:203], v[48:51], v[132:135]
    ds_read_b64_tr_b16 a[224:225], v3 offset:36992
    v_mfma_f32_16x16x32_bf16 v[132:135], a[204:207], v[52:55], v[132:135]
    ds_read_b64_tr_b16 a[226:227], v3 offset:37504
    ds_read_b64_tr_b16 a[228:229], v3 offset:53888
    v_mfma_f32_16x16x32_bf16 v[164:167], a[200:203], v[56:59], v[164:167]
    s_add_u32 m0, s44, 127488
    ds_read_b64_tr_b16 a[230:231], v3 offset:54400
    v_mfma_f32_16x16x32_bf16 v[164:167], a[204:207], v[60:63], v[164:167]
    s_waitcnt lgkmcnt(8)
    buffer_load_dwordx4 v5, s[20:23], s46 offen offset:0 lds
    v_mfma_f32_16x16x32_bf16 v[136:139], a[208:211], v[48:51], v[136:139]
    ds_read_b64_tr_b16 a[232:233], v3 offset:37024
    v_mfma_f32_16x16x32_bf16 v[136:139], a[212:215], v[52:55], v[136:139]
    ds_read_b64_tr_b16 a[234:235], v3 offset:37536
    ds_read_b64_tr_b16 a[236:237], v3 offset:53920
    v_mfma_f32_16x16x32_bf16 v[168:171], a[208:211], v[56:59], v[168:171]
    s_add_u32 m0, s44, 127520
    ds_read_b64_tr_b16 a[238:239], v3 offset:54432
    v_mfma_f32_16x16x32_bf16 v[168:171], a[212:215], v[60:63], v[168:171]
    s_waitcnt lgkmcnt(8)
    buffer_load_dwordx4 v5, s[20:23], s46 offen offset:1024 lds
    v_mfma_f32_16x16x32_bf16 v[140:143], a[216:219], v[48:51], v[140:143]
    ds_read_b64_tr_b16 a[240:241], v3 offset:37056
    v_cvt_pk_bf16_f32 v64, v128, v129
    v_mfma_f32_16x16x32_bf16 v[140:143], a[220:223], v[52:55], v[140:143]
    ds_read_b64_tr_b16 a[242:243], v3 offset:37568
    ds_read_b64_tr_b16 a[244:245], v3 offset:53952
    v_mfma_f32_16x16x32_bf16 v[172:175], a[216:219], v[56:59], v[172:175]
    s_add_u32 m0, s44, 127552
    ds_read_b64_tr_b16 a[246:247], v3 offset:54464
    v_cvt_pk_bf16_f32 v65, v130, v131
    v_mfma_f32_16x16x32_bf16 v[172:175], a[220:223], v[60:63], v[172:175]
    s_waitcnt lgkmcnt(8)
    buffer_load_dwordx4 v5, s[20:23], s46 offen offset:2048 lds
    v_mfma_f32_16x16x32_bf16 v[144:147], a[224:227], v[48:51], v[144:147]
    ds_read_b64_tr_b16 a[248:249], v3 offset:37088
    v_cvt_pk_bf16_f32 v66, v132, v133
    v_mfma_f32_16x16x32_bf16 v[144:147], a[228:231], v[52:55], v[144:147]
    ds_read_b64_tr_b16 a[250:251], v3 offset:37600
    ds_read_b64_tr_b16 a[252:253], v3 offset:53984
    v_mfma_f32_16x16x32_bf16 v[176:179], a[224:227], v[56:59], v[176:179]
    s_add_u32 m0, s44, 127584
    ds_read_b64_tr_b16 a[254:255], v3 offset:54496
    v_cvt_pk_bf16_f32 v67, v134, v135
    v_mfma_f32_16x16x32_bf16 v[176:179], a[228:231], v[60:63], v[176:179]
    s_waitcnt lgkmcnt(8)
    buffer_load_dwordx4 v5, s[20:23], s46 offen offset:3072 lds
    v_mfma_f32_16x16x32_bf16 v[148:151], a[232:235], v[48:51], v[148:151]
    ds_read_b64_tr_b16 a[192:193], v3 offset:37120
    v_cvt_pk_bf16_f32 v80, v160, v161
    v_mfma_f32_16x16x32_bf16 v[148:151], a[236:239], v[52:55], v[148:151]
    ds_read_b64_tr_b16 a[194:195], v3 offset:37632
    v_cvt_pk_bf16_f32 v81, v162, v163
    v_mfma_f32_16x16x32_bf16 v[180:183], a[232:235], v[56:59], v[180:183]
    ds_read_b64_tr_b16 a[196:197], v3 offset:54016
    v_cvt_pk_bf16_f32 v82, v164, v165
    v_mfma_f32_16x16x32_bf16 v[180:183], a[236:239], v[60:63], v[180:183]
    s_waitcnt lgkmcnt(7)
    ds_read_b64_tr_b16 a[198:199], v3 offset:54528
    v_cvt_pk_bf16_f32 v83, v166, v167
    v_mfma_f32_16x16x32_bf16 v[152:155], a[240:243], v[48:51], v[152:155]
    ds_read_b64_tr_b16 a[200:201], v3 offset:37152
    v_cvt_pk_bf16_f32 v68, v136, v137
    v_mfma_f32_16x16x32_bf16 v[152:155], a[244:247], v[52:55], v[152:155]
    ds_read_b64_tr_b16 a[202:203], v3 offset:37664
    v_cvt_pk_bf16_f32 v69, v138, v139
    v_mfma_f32_16x16x32_bf16 v[184:187], a[240:243], v[56:59], v[184:187]
    ds_read_b64_tr_b16 a[204:205], v3 offset:54048
    v_cvt_pk_bf16_f32 v70, v140, v141
    v_mfma_f32_16x16x32_bf16 v[184:187], a[244:247], v[60:63], v[184:187]
    s_waitcnt lgkmcnt(7)
    ds_read_b64_tr_b16 a[206:207], v3 offset:54560
    v_cvt_pk_bf16_f32 v71, v142, v143
    v_mfma_f32_16x16x32_bf16 v[156:159], a[248:251], v[48:51], v[156:159]
    ds_read_b64_tr_b16 a[208:209], v3 offset:37184
    v_cvt_pk_bf16_f32 v84, v168, v169
    v_mfma_f32_16x16x32_bf16 v[156:159], a[252:255], v[52:55], v[156:159]
    ds_read_b64_tr_b16 a[210:211], v3 offset:37696
    v_cvt_pk_bf16_f32 v85, v170, v171
    v_mfma_f32_16x16x32_bf16 v[188:191], a[248:251], v[56:59], v[188:191]
    ds_read_b64_tr_b16 a[212:213], v3 offset:54080
    v_cvt_pk_bf16_f32 v86, v172, v173
    v_mfma_f32_16x16x32_bf16 v[188:191], a[252:255], v[60:63], v[188:191]
    s_waitcnt lgkmcnt(7)
    ds_read_b64_tr_b16 a[214:215], v3 offset:54592
    v_cvt_pk_bf16_f32 v87, v174, v175
    v_mfma_f32_16x16x32_bf16 v[192:195], a[192:195], v[48:51], v[192:195]
    ds_read_b64_tr_b16 a[216:217], v3 offset:37216
    v_cvt_pk_bf16_f32 v72, v144, v145
    v_mfma_f32_16x16x32_bf16 v[192:195], a[196:199], v[52:55], v[192:195]
    ds_read_b64_tr_b16 a[218:219], v3 offset:37728
    v_cvt_pk_bf16_f32 v73, v146, v147
    v_mfma_f32_16x16x32_bf16 v[224:227], a[192:195], v[56:59], v[224:227]
    ds_read_b64_tr_b16 a[220:221], v3 offset:54112
    v_cvt_pk_bf16_f32 v74, v148, v149
    v_mfma_f32_16x16x32_bf16 v[224:227], a[196:199], v[60:63], v[224:227]
    s_waitcnt lgkmcnt(7)
    ds_read_b64_tr_b16 a[222:223], v3 offset:54624
    v_cvt_pk_bf16_f32 v75, v150, v151
    v_mfma_f32_16x16x32_bf16 v[196:199], a[200:203], v[48:51], v[196:199]
    ds_read_b64_tr_b16 a[224:225], v3 offset:37248
    v_cvt_pk_bf16_f32 v88, v176, v177
    v_mfma_f32_16x16x32_bf16 v[196:199], a[204:207], v[52:55], v[196:199]
    ds_read_b64_tr_b16 a[226:227], v3 offset:37760
    v_cvt_pk_bf16_f32 v89, v178, v179
    v_mfma_f32_16x16x32_bf16 v[228:231], a[200:203], v[56:59], v[228:231]
    ds_read_b64_tr_b16 a[228:229], v3 offset:54144
    v_cvt_pk_bf16_f32 v90, v180, v181
    v_mfma_f32_16x16x32_bf16 v[228:231], a[204:207], v[60:63], v[228:231]
    s_waitcnt lgkmcnt(7)
    ds_read_b64_tr_b16 a[230:231], v3 offset:54656
    v_cvt_pk_bf16_f32 v91, v182, v183
    v_mfma_f32_16x16x32_bf16 v[200:203], a[208:211], v[48:51], v[200:203]
    ds_read_b64_tr_b16 a[232:233], v3 offset:37280
    v_cvt_pk_bf16_f32 v76, v152, v153
    v_mfma_f32_16x16x32_bf16 v[200:203], a[212:215], v[52:55], v[200:203]
    ds_read_b64_tr_b16 a[234:235], v3 offset:37792
    v_cvt_pk_bf16_f32 v77, v154, v155
    v_mfma_f32_16x16x32_bf16 v[232:235], a[208:211], v[56:59], v[232:235]
    ds_read_b64_tr_b16 a[236:237], v3 offset:54176
    v_cvt_pk_bf16_f32 v78, v156, v157
    v_mfma_f32_16x16x32_bf16 v[232:235], a[212:215], v[60:63], v[232:235]
    s_waitcnt lgkmcnt(7)
    ds_read_b64_tr_b16 a[238:239], v3 offset:54688
    v_cvt_pk_bf16_f32 v79, v158, v159
    v_mfma_f32_16x16x32_bf16 v[204:207], a[216:219], v[48:51], v[204:207]
    ds_read_b64_tr_b16 a[240:241], v3 offset:37312
    v_cvt_pk_bf16_f32 v92, v184, v185
    v_mfma_f32_16x16x32_bf16 v[204:207], a[220:223], v[52:55], v[204:207]
    ds_read_b64_tr_b16 a[242:243], v3 offset:37824
    v_cvt_pk_bf16_f32 v93, v186, v187
    v_mfma_f32_16x16x32_bf16 v[236:239], a[216:219], v[56:59], v[236:239]
    ds_read_b64_tr_b16 a[244:245], v3 offset:54208
    v_cvt_pk_bf16_f32 v94, v188, v189
    v_mfma_f32_16x16x32_bf16 v[236:239], a[220:223], v[60:63], v[236:239]
    s_waitcnt lgkmcnt(7)
    ds_read_b64_tr_b16 a[246:247], v3 offset:54720
    v_cvt_pk_bf16_f32 v95, v190, v191
    v_mfma_f32_16x16x32_bf16 v[208:211], a[224:227], v[48:51], v[208:211]
    ds_read_b64_tr_b16 a[248:249], v3 offset:37344
    v_cvt_pk_bf16_f32 v96, v192, v193
    v_mfma_f32_16x16x32_bf16 v[208:211], a[228:231], v[52:55], v[208:211]
    ds_read_b64_tr_b16 a[250:251], v3 offset:37856
    v_cvt_pk_bf16_f32 v97, v194, v195
    v_mfma_f32_16x16x32_bf16 v[240:243], a[224:227], v[56:59], v[240:243]
    ds_read_b64_tr_b16 a[252:253], v3 offset:54240
    v_cvt_pk_bf16_f32 v98, v196, v197
    v_mfma_f32_16x16x32_bf16 v[240:243], a[228:231], v[60:63], v[240:243]
    s_waitcnt vmcnt(8)
    s_barrier
    s_waitcnt lgkmcnt(7)
    ds_read_b64_tr_b16 a[254:255], v3 offset:54752
    v_cvt_pk_bf16_f32 v99, v198, v199
    v_mfma_f32_16x16x32_bf16 v[212:215], a[232:235], v[48:51], v[212:215]
    ds_read_b128 a[64:67], v1 offset:0
    v_cvt_pk_bf16_f32 v112, v224, v225
    v_mfma_f32_16x16x32_bf16 v[212:215], a[236:239], v[52:55], v[212:215]
    ds_read_b128 a[68:71], v1 offset:64
    v_cvt_pk_bf16_f32 v113, v226, v227
    v_mfma_f32_16x16x32_bf16 v[244:247], a[232:235], v[56:59], v[244:247]
    s_add_u32 m0, s44, 0
    ds_read_b128 a[72:75], v1 offset:128
    v_cvt_pk_bf16_f32 v114, v228, v229
    v_mfma_f32_16x16x32_bf16 v[244:247], a[236:239], v[60:63], v[244:247]
    s_mov_b32 s46, 32768
    s_waitcnt lgkmcnt(7)
    buffer_load_dwordx4 v5, s[16:19], s46 offen offset:0 lds
    v_mfma_f32_16x16x32_bf16 v[216:219], a[240:243], v[48:51], v[216:219]
    ds_read_b128 a[76:79], v1 offset:192
    v_cvt_pk_bf16_f32 v115, v230, v231
    v_mfma_f32_16x16x32_bf16 v[216:219], a[244:247], v[52:55], v[216:219]
    ds_read_b128 a[80:83], v1 offset:256
    v_cvt_pk_bf16_f32 v100, v200, v201
    v_mfma_f32_16x16x32_bf16 v[248:251], a[240:243], v[56:59], v[248:251]
    s_add_u32 m0, s44, 32
    ds_read_b128 a[84:87], v1 offset:320
    v_cvt_pk_bf16_f32 v101, v202, v203
    v_mfma_f32_16x16x32_bf16 v[248:251], a[244:247], v[60:63], v[248:251]
    s_waitcnt lgkmcnt(6)
    buffer_load_dwordx4 v5, s[16:19], s46 offen offset:1024 lds
    v_mfma_f32_16x16x32_bf16 v[220:223], a[248:251], v[48:51], v[220:223]
    ds_read_b128 a[88:91], v1 offset:384
    v_cvt_pk_bf16_f32 v102, v204, v205
    v_mfma_f32_16x16x32_bf16 v[220:223], a[252:255], v[52:55], v[220:223]
    ds_read_b128 a[92:95], v1 offset:448
    v_cvt_pk_bf16_f32 v103, v206, v207
    v_mfma_f32_16x16x32_bf16 v[252:255], a[248:251], v[56:59], v[252:255]
    s_add_u32 m0, s44, 64
    ds_read_b128 a[96:99], v1 offset:512
    v_cvt_pk_bf16_f32 v116, v232, v233
    v_mfma_f32_16x16x32_bf16 v[252:255], a[252:255], v[60:63], v[252:255]
    buffer_load_dwordx4 v5, s[16:19], s46 offen offset:2048 lds
    s_add_u32 m0, s44, 96
    s_nop 0
    buffer_load_dwordx4 v5, s[16:19], s46 offen offset:3072 lds
    s_add_u32 m0, s44, 16896
    s_nop 0
    buffer_load_dwordx4 v5, s[20:23], s46 offen offset:0 lds
    s_add_u32 m0, s44, 16928
    s_nop 0
    buffer_load_dwordx4 v5, s[20:23], s46 offen offset:1024 lds
    s_add_u32 m0, s44, 16960
    s_nop 0
    buffer_load_dwordx4 v5, s[20:23], s46 offen offset:2048 lds
    s_add_u32 m0, s44, 16992
    s_nop 0
    buffer_load_dwordx4 v5, s[20:23], s46 offen offset:3072 lds
    ds_read_b128 a[100:103], v1 offset:576
    ds_read_b128 a[104:107], v1 offset:640
    ds_read_b128 a[108:111], v1 offset:704
    ds_read_b128 a[112:115], v1 offset:768
    ds_read_b128 a[116:119], v1 offset:832
    ds_read_b128 a[120:123], v1 offset:896
    ds_read_b128 a[124:127], v1 offset:960
    ds_read_b64_tr_b16 a[128:129], v2 offset:0
    ds_read_b64_tr_b16 a[130:131], v2 offset:256
    ds_read_b64_tr_b16 a[132:133], v2 offset:512
    ds_read_b64_tr_b16 a[134:135], v2 offset:768
    ds_read_b64_tr_b16 a[136:137], v2 offset:32
    ds_read_b64_tr_b16 a[138:139], v2 offset:288
    ds_read_b64_tr_b16 a[140:141], v2 offset:544
    ds_read_b64_tr_b16 a[142:143], v2 offset:800
    ds_read_b64_tr_b16 a[144:145], v2 offset:64
    ds_read_b64_tr_b16 a[146:147], v2 offset:320
    ds_read_b64_tr_b16 a[148:149], v2 offset:576
    ds_read_b64_tr_b16 a[150:151], v2 offset:832
    ds_read_b64_tr_b16 a[152:153], v2 offset:96
    ds_read_b64_tr_b16 a[154:155], v2 offset:352
    ds_read_b64_tr_b16 a[156:157], v2 offset:608
    ds_read_b64_tr_b16 a[158:159], v2 offset:864
    ds_read_b64_tr_b16 a[160:161], v2 offset:128
    ds_read_b64_tr_b16 a[162:163], v2 offset:384
    ds_read_b64_tr_b16 a[164:165], v2 offset:640
    ds_read_b64_tr_b16 a[166:167], v2 offset:896
    ds_read_b64_tr_b16 a[168:169], v2 offset:160
    ds_read_b64_tr_b16 a[170:171], v2 offset:416
    ds_read_b64_tr_b16 a[172:173], v2 offset:672
    ds_read_b64_tr_b16 a[174:175], v2 offset:928
    ds_read_b64_tr_b16 a[176:177], v2 offset:192
    ds_read_b64_tr_b16 a[178:179], v2 offset:448
    ds_read_b64_tr_b16 a[180:181], v2 offset:704
    ds_read_b64_tr_b16 a[182:183], v2 offset:960
    ds_read_b64_tr_b16 a[184:185], v2 offset:224
    ds_read_b64_tr_b16 a[186:187], v2 offset:480
    ds_read_b64_tr_b16 a[188:189], v2 offset:736
    ds_read_b64_tr_b16 a[190:191], v2 offset:992
    v_cvt_pk_bf16_f32 v117, v234, v235
    v_cvt_pk_bf16_f32 v118, v236, v237
    v_cvt_pk_bf16_f32 v119, v238, v239
    v_cvt_pk_bf16_f32 v104, v208, v209
    v_cvt_pk_bf16_f32 v105, v210, v211
    v_cvt_pk_bf16_f32 v106, v212, v213
    v_cvt_pk_bf16_f32 v107, v214, v215
    v_cvt_pk_bf16_f32 v120, v240, v241
    v_cvt_pk_bf16_f32 v121, v242, v243
    v_cvt_pk_bf16_f32 v122, v244, v245
    v_cvt_pk_bf16_f32 v123, v246, v247
    v_cvt_pk_bf16_f32 v108, v216, v217
    v_cvt_pk_bf16_f32 v109, v218, v219
    v_cvt_pk_bf16_f32 v110, v220, v221
    v_cvt_pk_bf16_f32 v111, v222, v223
    v_cvt_pk_bf16_f32 v124, v248, v249
    v_cvt_pk_bf16_f32 v125, v250, v251
    v_cvt_pk_bf16_f32 v126, v252, v253
    v_cvt_pk_bf16_f32 v127, v254, v255
    s_nop 0
    v_permlane32_swap_b32 v64, v66
    v_permlane32_swap_b32 v65, v67
    v_permlane32_swap_b32 v80, v82
    v_permlane32_swap_b32 v81, v83
    v_permlane32_swap_b32 v68, v70
    v_permlane32_swap_b32 v69, v71
    v_permlane32_swap_b32 v84, v86
    v_permlane32_swap_b32 v85, v87
    v_permlane32_swap_b32 v72, v74
    v_permlane32_swap_b32 v73, v75
    v_permlane32_swap_b32 v88, v90
    v_permlane32_swap_b32 v89, v91
    v_permlane32_swap_b32 v76, v78
    v_permlane32_swap_b32 v77, v79
    v_permlane32_swap_b32 v92, v94
    v_permlane32_swap_b32 v93, v95
    v_permlane32_swap_b32 v96, v98
    v_permlane32_swap_b32 v97, v99
    v_permlane32_swap_b32 v112, v114
    v_permlane32_swap_b32 v113, v115
    v_permlane32_swap_b32 v100, v102
    v_permlane32_swap_b32 v101, v103
    v_permlane32_swap_b32 v116, v118
    v_permlane32_swap_b32 v117, v119
    v_permlane32_swap_b32 v104, v106
    v_permlane32_swap_b32 v105, v107
    v_permlane32_swap_b32 v120, v122
    v_permlane32_swap_b32 v121, v123
    v_permlane32_swap_b32 v108, v110
    v_permlane32_swap_b32 v109, v111
    v_permlane32_swap_b32 v124, v126
    v_permlane32_swap_b32 v125, v127
    s_waitcnt lgkmcnt(15)
    v_mfma_f32_16x16x32_bf16 v[16:19], a[64:67], v[64:67], 0
    v_mfma_f32_16x16x32_bf16 v[16:19], a[68:71], v[68:71], v[16:19]
    v_mfma_f32_16x16x32_bf16 v[16:19], a[72:75], v[72:75], v[16:19]
    v_mfma_f32_16x16x32_bf16 v[16:19], a[76:79], v[76:79], v[16:19]
    v_mfma_f32_16x16x32_bf16 v[20:23], a[64:67], v[80:83], 0
    v_mfma_f32_16x16x32_bf16 v[20:23], a[68:71], v[84:87], v[20:23]
    v_mfma_f32_16x16x32_bf16 v[20:23], a[72:75], v[88:91], v[20:23]
    v_mfma_f32_16x16x32_bf16 v[20:23], a[76:79], v[92:95], v[20:23]
    v_mfma_f32_16x16x32_bf16 v[24:27], a[64:67], v[96:99], 0
    v_mfma_f32_16x16x32_bf16 v[24:27], a[68:71], v[100:103], v[24:27]
    v_mfma_f32_16x16x32_bf16 v[24:27], a[72:75], v[104:107], v[24:27]
    v_mfma_f32_16x16x32_bf16 v[24:27], a[76:79], v[108:111], v[24:27]
    v_mfma_f32_16x16x32_bf16 v[28:31], a[64:67], v[112:115], 0
    v_mfma_f32_16x16x32_bf16 v[28:31], a[68:71], v[116:119], v[28:31]
    v_mfma_f32_16x16x32_bf16 v[28:31], a[72:75], v[120:123], v[28:31]
    v_mfma_f32_16x16x32_bf16 v[28:31], a[76:79], v[124:127], v[28:31]
    s_nop 1
    v_max3_f32 v16, v16, v17, v18
    v_max_f32 v16, v16, v19
    v_max3_f32 v20, v20, v21, v22
    v_max_f32 v20, v20, v23
    v_max3_f32 v24, v24, v25, v26
    v_max_f32 v24, v24, v27
    v_max3_f32 v28, v28, v29, v30
    v_max_f32 v28, v28, v31
    v_mov_b32 v12, v16
    v_mov_b32 v13, v20
    v_mov_b32 v14, v24
    v_mov_b32 v15, v28
    v_permlane16_swap_b32 v12, v16
    v_permlane16_swap_b32 v13, v20
    v_permlane16_swap_b32 v14, v24
    v_permlane16_swap_b32 v15, v28
    v_max_f32 v16, v16, v12
    v_max_f32 v20, v20, v13
    v_max_f32 v24, v24, v14
    v_max_f32 v28, v28, v15
    v_mov_b32 v12, v16
    v_mov_b32 v13, v20
    v_mov_b32 v14, v24
    v_mov_b32 v15, v28
    v_permlane32_swap_b32 v12, v16
    v_permlane32_swap_b32 v13, v20
    v_permlane32_swap_b32 v14, v24
    v_permlane32_swap_b32 v15, v28
    v_max_f32 v16, v16, v12
    v_max_f32 v20, v20, v13
    v_max_f32 v24, v24, v14
    v_max_f32 v28, v28, v15
    v_sub_f32 v48, 0xc2000000, v16
    v_sub_f32 v49, 0xc2000000, v16
    v_sub_f32 v50, 0xc2000000, v16
    v_sub_f32 v51, 0xc2000000, v16
    v_sub_f32 v52, 0xc2000000, v20
    v_sub_f32 v53, 0xc2000000, v20
    v_sub_f32 v54, 0xc2000000, v20
    v_sub_f32 v55, 0xc2000000, v20
    v_sub_f32 v56, 0xc2000000, v24
    v_sub_f32 v57, 0xc2000000, v24
    v_sub_f32 v58, 0xc2000000, v24
    v_sub_f32 v59, 0xc2000000, v24
    v_sub_f32 v60, 0xc2000000, v28
    v_sub_f32 v61, 0xc2000000, v28
    v_sub_f32 v62, 0xc2000000, v28
    v_sub_f32 v63, 0xc2000000, v28
L2_entry:
    v_accvgpr_write_b32 a0, 0
    v_accvgpr_write_b32 a1, 0
    v_accvgpr_write_b32 a2, 0
    v_accvgpr_write_b32 a3, 0
    v_accvgpr_write_b32 a4, 0
    v_accvgpr_write_b32 a5, 0
    v_accvgpr_write_b32 a6, 0
    v_accvgpr_write_b32 a7, 0
    v_accvgpr_write_b32 a8, 0
    v_accvgpr_write_b32 a9, 0
    v_accvgpr_write_b32 a10, 0
    v_accvgpr_write_b32 a11, 0
    v_accvgpr_write_b32 a12, 0
    v_accvgpr_write_b32 a13, 0
    v_accvgpr_write_b32 a14, 0
    v_accvgpr_write_b32 a15, 0
    v_mov_b32 v224, 0
    v_mov_b32 v225, 0
    v_mov_b32 v226, 0
    v_mov_b32 v227, 0
    v_mov_b32 v228, 0
    v_mov_b32 v229, 0
    v_mov_b32 v230, 0
    v_mov_b32 v231, 0
    v_mov_b32 v232, 0
    v_mov_b32 v233, 0
    v_mov_b32 v234, 0
    v_mov_b32 v235, 0
    v_mov_b32 v236, 0
    v_mov_b32 v237, 0
    v_mov_b32 v238, 0
    v_mov_b32 v239, 0
    v_mov_b32 v240, 0
    v_mov_b32 v241, 0
    v_mov_b32 v242, 0
    v_mov_b32 v243, 0
    v_mov_b32 v244, 0
    v_mov_b32 v245, 0
    v_mov_b32 v246, 0
    v_mov_b32 v247, 0
    v_mov_b32 v248, 0
    v_mov_b32 v249, 0
    v_mov_b32 v250, 0
    v_mov_b32 v251, 0
    v_mov_b32 v252, 0
    v_mov_b32 v253, 0
    v_mov_b32 v254, 0
    v_mov_b32 v255, 0
    s_mov_b32 s47, s44
    s_mov_b32 s48, -73728
    s_mov_b32 s49, 15
    s_mov_b32 s46, 49152
    v_lshrrev_b32 v14, 2, v0
    s_mul_i32 s3, s51, 144
    v_add_u32 v14, s3, v14
    v_mul_u32_u24 v14, 9216, v14
    v_and_b32 v15, 3, v0
    v_lshl_add_u32 v6, v15, 4, v14
    s_lshr_b32 s3, s2, 3
    s_lshl_b32 s3, s3, 2
    s_add_u32 s3, s3, s51
    s_and_b32 s15, s2, 7
    s_mul_i32 s14, s3, 9
    s_lshr_b32 s14, s14, 1
    v_min_u32 v15, 44, v0
    v_mul_u32_u24 v12, 7282, v15
    v_lshrrev_b32 v12, 16, v12
    v_mul_u32_u24 v13, 63, v12
    v_add_u32 v12, v15, v13
    s_mul_i32 s14, s14, 72
    s_mul_i32 s56, s15, 9
    s_add_u32 s14, s14, s56
    v_add_u32 v12, s14, v12
    v_lshlrev_b32 v12, 7, v12
    s_mul_i32 s14, s3, 81
    s_lshr_b32 s14, s14, 1
    s_mul_i32 s56, s15, 5184
    s_add_u32 s14, s14, s56
    v_min_u32 v13, 40, v0
    v_add_u32 v13, s14, v13
    v_lshlrev_b32 v13, 7, v13
    s_mul_i32 s14, s3, 72
    s_andn2_b32 s56, s52, 3
    s_mul_i32 s56, s56, 2304
    s_add_u32 s14, s14, s56
    v_min_u32 v14, 35, v0
    v_add_u32 v14, s14, v14
    v_lshlrev_b32 v14, 7, v14
    v_add_u32 v15, 4608, v14
    s_waitcnt vmcnt(8) lgkmcnt(0)
    s_barrier
    v_mfma_f32_16x16x32_bf16 v[16:19], a[64:67], v[64:67], v[48:51]
    v_mfma_f32_16x16x32_bf16 v[16:19], a[68:71], v[68:71], v[16:19]
    v_mfma_f32_16x16x32_bf16 v[16:19], a[72:75], v[72:75], v[16:19]
    s_add_u32 m0, s47, 36864
    v_mfma_f32_16x16x32_bf16 v[16:19], a[76:79], v[76:79], v[16:19]
    buffer_load_dwordx4 v5, s[16:19], s46 offen offset:0 lds
    v_mfma_f32_16x16x32_bf16 v[20:23], a[80:83], v[64:67], v[48:51]
    v_mfma_f32_16x16x32_bf16 v[20:23], a[84:87], v[68:71], v[20:23]
    v_mfma_f32_16x16x32_bf16 v[20:23], a[88:91], v[72:75], v[20:23]
    s_add_u32 m0, s47, 36896
    v_mfma_f32_16x16x32_bf16 v[20:23], a[92:95], v[76:79], v[20:23]
    buffer_load_dwordx4 v5, s[16:19], s46 offen offset:1024 lds
    v_mfma_f32_16x16x32_bf16 v[24:27], a[96:99], v[64:67], v[48:51]
    s_nop 1
    v_exp_f32 v16, v16
    v_mfma_f32_16x16x32_bf16 v[24:27], a[100:103], v[68:71], v[24:27]
    v_mfma_f32_16x16x32_bf16 v[24:27], a[104:107], v[72:75], v[24:27]
    s_add_u32 m0, s47, 36928
    v_exp_f32 v17, v17
    v_mfma_f32_16x16x32_bf16 v[24:27], a[108:111], v[76:79], v[24:27]
    buffer_load_dwordx4 v5, s[16:19], s46 offen offset:2048 lds
    v_mfma_f32_16x16x32_bf16 v[28:31], a[112:115], v[64:67], v[48:51]
    v_exp_f32 v18, v18
    v_mfma_f32_16x16x32_bf16 v[28:31], a[116:119], v[68:71], v[28:31]
    v_cvt_pk_bf16_f32 v32, v16, v17
    v_mfma_f32_16x16x32_bf16 v[28:31], a[120:123], v[72:75], v[28:31]
    s_add_u32 m0, s47, 36960
    v_exp_f32 v19, v19
    v_mfma_f32_16x16x32_bf16 v[28:31], a[124:127], v[76:79], v[28:31]
    buffer_load_dwordx4 v5, s[16:19], s46 offen offset:3072 lds
    s_nop 3
    v_exp_f32 v20, v20
    s_nop 0
    ds_read_b64_tr_b16 a[192:193], v2 offset:36864
    v_cvt_pk_bf16_f32 v33, v18, v19
    s_add_u32 m0, s47, 53760
    v_exp_f32 v21, v21
    s_nop 0
    buffer_load_dwordx4 v5, s[20:23], s46 offen offset:0 lds
    v_exp_f32 v22, v22
    s_nop 0
    ds_read_b64_tr_b16 a[194:195], v2 offset:37120
    v_cvt_pk_bf16_f32 v34, v20, v21
    s_add_u32 m0, s47, 53792
    v_exp_f32 v23, v23
    s_nop 0
    buffer_load_dwordx4 v5, s[20:23], s46 offen offset:1024 lds
    v_exp_f32 v24, v24
    s_nop 0
    ds_read_b64_tr_b16 a[196:197], v2 offset:37376
    v_cvt_pk_bf16_f32 v35, v22, v23
    s_add_u32 m0, s47, 53824
    v_exp_f32 v25, v25
    s_nop 0
    buffer_load_dwordx4 v5, s[20:23], s46 offen offset:2048 lds
    v_exp_f32 v26, v26
    s_nop 0
    ds_read_b64_tr_b16 a[198:199], v2 offset:37632
    v_cvt_pk_bf16_f32 v36, v24, v25
    s_add_u32 m0, s47, 53856
    v_exp_f32 v27, v27
    s_nop 0
    buffer_load_dwordx4 v5, s[20:23], s46 offen offset:3072 lds
    ds_read_b64_tr_b16 a[200:201], v2 offset:36896
    s_nop 0
    v_mfma_f32_16x16x32_bf16 v[16:19], a[64:67], v[80:83], v[52:55]
    v_exp_f32 v28, v28
    v_mfma_f32_16x16x32_bf16 v[16:19], a[68:71], v[84:87], v[16:19]
    ds_read_b64_tr_b16 a[202:203], v2 offset:37152
    v_cvt_pk_bf16_f32 v37, v26, v27
    v_mfma_f32_16x16x32_bf16 v[16:19], a[72:75], v[88:91], v[16:19]
    s_mul_i32 m0, s51, 3072
    v_exp_f32 v29, v29
    v_mfma_f32_16x16x32_bf16 v[16:19], a[76:79], v[92:95], v[16:19]
    s_add_u32 s54, m0, 8192
    buffer_load_dwordx4 v8, s[84:87], s54 offen lds
    v_mfma_f32_16x16x32_bf16 v[20:23], a[80:83], v[80:83], v[52:55]
    v_exp_f32 v30, v30
    v_mfma_f32_16x16x32_bf16 v[20:23], a[84:87], v[84:87], v[20:23]
    ds_read_b64_tr_b16 a[204:205], v2 offset:37408
    v_cvt_pk_bf16_f32 v38, v28, v29
    v_mfma_f32_16x16x32_bf16 v[20:23], a[88:91], v[88:91], v[20:23]
    s_add_u32 m0, m0, 1024
    v_exp_f32 v31, v31
    v_mfma_f32_16x16x32_bf16 v[20:23], a[92:95], v[92:95], v[20:23]
    s_add_u32 s54, m0, 8192
    buffer_load_dwordx4 v8, s[84:87], s54 offen lds
    v_mfma_f32_16x16x32_bf16 v[24:27], a[96:99], v[80:83], v[52:55]
    v_exp_f32 v16, v16
    v_mfma_f32_16x16x32_bf16 v[24:27], a[100:103], v[84:87], v[24:27]
    ds_read_b64_tr_b16 a[206:207], v2 offset:37664
    v_cvt_pk_bf16_f32 v39, v30, v31
    v_mfma_f32_16x16x32_bf16 v[24:27], a[104:107], v[88:91], v[24:27]
    s_add_u32 m0, m0, 1024
    v_exp_f32 v17, v17
    v_mfma_f32_16x16x32_bf16 v[24:27], a[108:111], v[92:95], v[24:27]
    s_add_u32 s54, m0, 8192
    buffer_load_dwordx4 v8, s[84:87], s54 offen lds
    v_mfma_f32_16x16x32_bf16 v[28:31], a[112:115], v[80:83], v[52:55]
    v_exp_f32 v18, v18
    v_mfma_f32_16x16x32_bf16 v[28:31], a[116:119], v[84:87], v[28:31]
    ds_read_b64_tr_b16 a[208:209], v2 offset:36928
    v_cvt_pk_bf16_f32 v40, v16, v17
    v_mfma_f32_16x16x32_bf16 v[28:31], a[120:123], v[88:91], v[28:31]
    v_exp_f32 v19, v19
    v_mfma_f32_16x16x32_bf16 v[28:31], a[124:127], v[92:95], v[28:31]
    ds_read_b64_tr_b16 a[210:211], v2 offset:37184
    v_mfma_f32_16x16x32_bf16 v[128:131], a[128:131], v[32:35], 0
    v_exp_f32 v20, v20
    v_mfma_f32_16x16x32_bf16 v[128:131], a[132:135], v[36:39], v[128:131]
    ds_read_b64_tr_b16 a[212:213], v2 offset:37440
    v_cvt_pk_bf16_f32 v41, v18, v19
    v_mfma_f32_16x16x32_bf16 v[132:135], a[136:139], v[32:35], 0
    v_exp_f32 v21, v21
    v_mfma_f32_16x16x32_bf16 v[132:135], a[140:143], v[36:39], v[132:135]
    ds_read_b64_tr_b16 a[214:215], v2 offset:37696
    v_mfma_f32_16x16x32_bf16 v[136:139], a[144:147], v[32:35], 0
    v_exp_f32 v22, v22
    v_mfma_f32_16x16x32_bf16 v[136:139], a[148:151], v[36:39], v[136:139]
    ds_read_b64_tr_b16 a[216:217], v2 offset:36960
    v_cvt_pk_bf16_f32 v42, v20, v21
    v_mfma_f32_16x16x32_bf16 v[140:143], a[152:155], v[32:35], 0
    v_exp_f32 v23, v23
    v_mfma_f32_16x16x32_bf16 v[140:143], a[156:159], v[36:39], v[140:143]
    ds_read_b64_tr_b16 a[218:219], v2 offset:37216
    v_mfma_f32_16x16x32_bf16 v[144:147], a[160:163], v[32:35], 0
    v_exp_f32 v24, v24
    v_mfma_f32_16x16x32_bf16 v[144:147], a[164:167], v[36:39], v[144:147]
    ds_read_b64_tr_b16 a[220:221], v2 offset:37472
    v_cvt_pk_bf16_f32 v43, v22, v23
    v_mfma_f32_16x16x32_bf16 v[148:151], a[168:171], v[32:35], 0
    v_exp_f32 v25, v25
    v_mfma_f32_16x16x32_bf16 v[148:151], a[172:175], v[36:39], v[148:151]
    ds_read_b64_tr_b16 a[222:223], v2 offset:37728
    v_mfma_f32_16x16x32_bf16 v[152:155], a[176:179], v[32:35], 0
    v_exp_f32 v26, v26
    v_mfma_f32_16x16x32_bf16 v[152:155], a[180:183], v[36:39], v[152:155]
    ds_read_b64_tr_b16 a[224:225], v2 offset:36992
    v_cvt_pk_bf16_f32 v44, v24, v25
    v_mfma_f32_16x16x32_bf16 v[156:159], a[184:187], v[32:35], 0
    v_exp_f32 v27, v27
    v_mfma_f32_16x16x32_bf16 v[156:159], a[188:191], v[36:39], v[156:159]
    ds_read_b64_tr_b16 a[226:227], v2 offset:37248
    v_smfmac_f32_16x16x64_bf16 a[0:3], a[16:19], v[32:39], v11
    ds_read_b64_tr_b16 a[228:229], v2 offset:37504
    v_mfma_f32_16x16x32_bf16 v[16:19], a[64:67], v[96:99], v[56:59]
    v_exp_f32 v28, v28
    v_mfma_f32_16x16x32_bf16 v[16:19], a[68:71], v[100:103], v[16:19]
    ds_read_b64_tr_b16 a[230:231], v2 offset:37760
    v_cvt_pk_bf16_f32 v45, v26, v27
    v_mfma_f32_16x16x32_bf16 v[16:19], a[72:75], v[104:107], v[16:19]
    v_exp_f32 v29, v29
    v_mfma_f32_16x16x32_bf16 v[16:19], a[76:79], v[108:111], v[16:19]
    ds_read_b64_tr_b16 a[232:233], v2 offset:37024
    v_mfma_f32_16x16x32_bf16 v[20:23], a[80:83], v[96:99], v[56:59]
    v_exp_f32 v30, v30
    v_mfma_f32_16x16x32_bf16 v[20:23], a[84:87], v[100:103], v[20:23]
    ds_read_b64_tr_b16 a[234:235], v2 offset:37280
    v_cvt_pk_bf16_f32 v46, v28, v29
    v_mfma_f32_16x16x32_bf16 v[20:23], a[88:91], v[104:107], v[20:23]
    v_exp_f32 v31, v31
    v_mfma_f32_16x16x32_bf16 v[20:23], a[92:95], v[108:111], v[20:23]
    ds_read_b64_tr_b16 a[236:237], v2 offset:37536
    v_mfma_f32_16x16x32_bf16 v[24:27], a[96:99], v[96:99], v[56:59]
    v_exp_f32 v16, v16
    v_mfma_f32_16x16x32_bf16 v[24:27], a[100:103], v[100:103], v[24:27]
    ds_read_b64_tr_b16 a[238:239], v2 offset:37792
    v_cvt_pk_bf16_f32 v47, v30, v31
    v_mfma_f32_16x16x32_bf16 v[24:27], a[104:107], v[104:107], v[24:27]
    v_exp_f32 v17, v17
    v_mfma_f32_16x16x32_bf16 v[24:27], a[108:111], v[108:111], v[24:27]
    ds_read_b64_tr_b16 a[240:241], v2 offset:37056
    v_mfma_f32_16x16x32_bf16 v[28:31], a[112:115], v[96:99], v[56:59]
    v_exp_f32 v18, v18
    v_mfma_f32_16x16x32_bf16 v[28:31], a[116:119], v[100:103], v[28:31]
    ds_read_b64_tr_b16 a[242:243], v2 offset:37312
    v_cvt_pk_bf16_f32 v32, v16, v17
    v_mfma_f32_16x16x32_bf16 v[28:31], a[120:123], v[104:107], v[28:31]
    v_exp_f32 v19, v19
    v_mfma_f32_16x16x32_bf16 v[28:31], a[124:127], v[108:111], v[28:31]
    ds_read_b64_tr_b16 a[244:245], v2 offset:37568
    v_mfma_f32_16x16x32_bf16 v[160:163], a[128:131], v[40:43], 0
    v_exp_f32 v20, v20
    v_mfma_f32_16x16x32_bf16 v[160:163], a[132:135], v[44:47], v[160:163]
    ds_read_b64_tr_b16 a[246:247], v2 offset:37824
    v_cvt_pk_bf16_f32 v33, v18, v19
    v_mfma_f32_16x16x32_bf16 v[164:167], a[136:139], v[40:43], 0
    v_exp_f32 v21, v21
    v_mfma_f32_16x16x32_bf16 v[164:167], a[140:143], v[44:47], v[164:167]
    ds_read_b64_tr_b16 a[248:249], v2 offset:37088
    v_mfma_f32_16x16x32_bf16 v[168:171], a[144:147], v[40:43], 0
    v_exp_f32 v22, v22
    v_mfma_f32_16x16x32_bf16 v[168:171], a[148:151], v[44:47], v[168:171]
    ds_read_b64_tr_b16 a[250:251], v2 offset:37344
    v_cvt_pk_bf16_f32 v34, v20, v21
    v_mfma_f32_16x16x32_bf16 v[172:175], a[152:155], v[40:43], 0
    v_exp_f32 v23, v23
    v_mfma_f32_16x16x32_bf16 v[172:175], a[156:159], v[44:47], v[172:175]
    ds_read_b64_tr_b16 a[252:253], v2 offset:37600
    v_mfma_f32_16x16x32_bf16 v[176:179], a[160:163], v[40:43], 0
    v_exp_f32 v24, v24
    v_mfma_f32_16x16x32_bf16 v[176:179], a[164:167], v[44:47], v[176:179]
    ds_read_b64_tr_b16 a[254:255], v2 offset:37856
    v_cvt_pk_bf16_f32 v35, v22, v23
    v_mfma_f32_16x16x32_bf16 v[180:183], a[168:171], v[40:43], 0
    v_exp_f32 v25, v25
    v_mfma_f32_16x16x32_bf16 v[180:183], a[172:175], v[44:47], v[180:183]
    v_mfma_f32_16x16x32_bf16 v[184:187], a[176:179], v[40:43], 0
    v_exp_f32 v26, v26
    v_mfma_f32_16x16x32_bf16 v[184:187], a[180:183], v[44:47], v[184:187]
    v_cvt_pk_bf16_f32 v36, v24, v25
    v_mfma_f32_16x16x32_bf16 v[188:191], a[184:187], v[40:43], 0
    v_exp_f32 v27, v27
    v_mfma_f32_16x16x32_bf16 v[188:191], a[188:191], v[44:47], v[188:191]
    v_smfmac_f32_16x16x64_bf16 a[4:7], a[16:19], v[40:47], v11
    v_mfma_f32_16x16x32_bf16 v[16:19], a[64:67], v[112:115], v[60:63]
    v_exp_f32 v28, v28
    v_mfma_f32_16x16x32_bf16 v[16:19], a[68:71], v[116:119], v[16:19]
    s_add_u32 s46, s46, 16384
    ds_read_b128 a[64:67], v1 offset:36864
    v_cvt_pk_bf16_f32 v37, v26, v27
    v_mfma_f32_16x16x32_bf16 v[16:19], a[72:75], v[120:123], v[16:19]
    s_min_u32 s46, s46, 507904
    v_exp_f32 v29, v29
    v_mfma_f32_16x16x32_bf16 v[16:19], a[76:79], v[124:127], v[16:19]
    ds_read_b128 a[68:71], v1 offset:36928
    v_mfma_f32_16x16x32_bf16 v[20:23], a[80:83], v[112:115], v[60:63]
    v_exp_f32 v30, v30
    v_mfma_f32_16x16x32_bf16 v[20:23], a[84:87], v[116:119], v[20:23]
    ds_read_b128 a[72:75], v1 offset:36992
    v_cvt_pk_bf16_f32 v38, v28, v29
    v_mfma_f32_16x16x32_bf16 v[20:23], a[88:91], v[120:123], v[20:23]
    v_exp_f32 v31, v31
    v_mfma_f32_16x16x32_bf16 v[20:23], a[92:95], v[124:127], v[20:23]
    ds_read_b128 a[76:79], v1 offset:37056
    v_mfma_f32_16x16x32_bf16 v[24:27], a[96:99], v[112:115], v[60:63]
    v_exp_f32 v16, v16
    v_mfma_f32_16x16x32_bf16 v[24:27], a[100:103], v[116:119], v[24:27]
    ds_read_b128 a[80:83], v1 offset:37120
    v_cvt_pk_bf16_f32 v39, v30, v31
    v_mfma_f32_16x16x32_bf16 v[24:27], a[104:107], v[120:123], v[24:27]
    v_exp_f32 v17, v17
    v_mfma_f32_16x16x32_bf16 v[24:27], a[108:111], v[124:127], v[24:27]
    ds_read_b128 a[84:87], v1 offset:37184
    v_mfma_f32_16x16x32_bf16 v[28:31], a[112:115], v[112:115], v[60:63]
    v_exp_f32 v18, v18
    v_mfma_f32_16x16x32_bf16 v[28:31], a[116:119], v[116:119], v[28:31]
    ds_read_b128 a[88:91], v1 offset:37248
    v_cvt_pk_bf16_f32 v40, v16, v17
    v_mfma_f32_16x16x32_bf16 v[28:31], a[120:123], v[120:123], v[28:31]
    v_exp_f32 v19, v19
    v_mfma_f32_16x16x32_bf16 v[28:31], a[124:127], v[124:127], v[28:31]
    ds_read_b128 a[92:95], v1 offset:37312
    v_mfma_f32_16x16x32_bf16 v[192:195], a[128:131], v[32:35], 0
    v_exp_f32 v20, v20
    v_mfma_f32_16x16x32_bf16 v[192:195], a[132:135], v[36:39], v[192:195]
    ds_read_b128 a[96:99], v1 offset:37376
    v_cvt_pk_bf16_f32 v41, v18, v19
    v_mfma_f32_16x16x32_bf16 v[196:199], a[136:139], v[32:35], 0
    v_exp_f32 v21, v21
    v_mfma_f32_16x16x32_bf16 v[196:199], a[140:143], v[36:39], v[196:199]
    ds_read_b128 a[100:103], v1 offset:37440
    v_mfma_f32_16x16x32_bf16 v[200:203], a[144:147], v[32:35], 0
    v_exp_f32 v22, v22
    v_mfma_f32_16x16x32_bf16 v[200:203], a[148:151], v[36:39], v[200:203]
    ds_read_b128 a[104:107], v1 offset:37504
    v_cvt_pk_bf16_f32 v42, v20, v21
    v_mfma_f32_16x16x32_bf16 v[204:207], a[152:155], v[32:35], 0
    v_exp_f32 v23, v23
    v_mfma_f32_16x16x32_bf16 v[204:207], a[156:159], v[36:39], v[204:207]
    ds_read_b128 a[108:111], v1 offset:37568
    v_mfma_f32_16x16x32_bf16 v[208:211], a[160:163], v[32:35], 0
    v_exp_f32 v24, v24
    v_mfma_f32_16x16x32_bf16 v[208:211], a[164:167], v[36:39], v[208:211]
    ds_read_b128 a[112:115], v1 offset:37632
    v_cvt_pk_bf16_f32 v43, v22, v23
    v_mfma_f32_16x16x32_bf16 v[212:215], a[168:171], v[32:35], 0
    v_exp_f32 v25, v25
    v_mfma_f32_16x16x32_bf16 v[212:215], a[172:175], v[36:39], v[212:215]
    ds_read_b128 a[116:119], v1 offset:37696
    v_mfma_f32_16x16x32_bf16 v[216:219], a[176:179], v[32:35], 0
    v_exp_f32 v26, v26
    v_mfma_f32_16x16x32_bf16 v[216:219], a[180:183], v[36:39], v[216:219]
    ds_read_b128 a[120:123], v1 offset:37760
    v_cvt_pk_bf16_f32 v44, v24, v25
    v_mfma_f32_16x16x32_bf16 v[220:223], a[184:187], v[32:35], 0
    v_exp_f32 v27, v27
    v_mfma_f32_16x16x32_bf16 v[220:223], a[188:191], v[36:39], v[220:223]
    ds_read_b128 a[124:127], v1 offset:37824
    v_smfmac_f32_16x16x64_bf16 a[8:11], a[16:19], v[32:39], v11
    s_waitcnt vmcnt(8) lgkmcnt(12)
    s_barrier
    s_branch L2_loop
L2_pf:
    s_cmp_lg_u32 s49, 5
    s_cbranch_scc1 L2_pf5
    global_load_dword a63, v12, s[4:5]
    s_branch L2_pfret
L2_pf5:
    s_cmp_lg_u32 s49, 4
    s_cbranch_scc1 L2_pf4
    global_load_dword a63, v12, s[6:7]
    s_branch L2_pfret
L2_pf4:
    s_cmp_lg_u32 s49, 3
    s_cbranch_scc1 L2_pf3
    global_load_dword a63, v13, s[8:9]
    s_branch L2_pfret
L2_pf3:
    s_cmp_lg_u32 s49, 2
    s_cbranch_scc1 L2_pf2
    global_load_dword a63, v14, s[10:11]
    s_branch L2_pfret
L2_pf2:
    s_cmp_lg_u32 s49, 1
    s_cbranch_scc1 L2_pf1
    global_load_dword a63, v15, s[10:11]
    s_branch L2_pfret
L2_pf1:
    s_branch L2_pfret
.p2align 5
L2_loop:
    v_mfma_f32_16x16x32_bf16 v[16:19], a[64:67], v[64:67], v[48:51]
    s_sub_u32 s47, s47, s48
    v_exp_f32 v28, v28
    v_mfma_f32_16x16x32_bf16 v[16:19], a[68:71], v[68:71], v[16:19]
    v_cvt_pk_bf16_f32 v45, v26, v27
    v_add_u32 v1, s48, v1
    v_mfma_f32_16x16x32_bf16 v[16:19], a[72:75], v[72:75], v[16:19]
    s_add_u32 m0, s47, 0
    v_exp_f32 v29, v29
    v_mfma_f32_16x16x32_bf16 v[16:19], a[76:79], v[76:79], v[16:19]
    s_waitcnt lgkmcnt(8)
    buffer_load_dwordx4 v5, s[16:19], s46 offen offset:0 lds
    v_mfma_f32_16x16x32_bf16 v[20:23], a[80:83], v[64:67], v[48:51]
    v_exp_f32 v30, v30
    v_mfma_f32_16x16x32_bf16 v[20:23], a[84:87], v[68:71], v[20:23]
    v_cvt_pk_bf16_f32 v46, v28, v29
    v_add_u32 v2, s48, v2
    v_mfma_f32_16x16x32_bf16 v[20:23], a[88:91], v[72:75], v[20:23]
    s_add_u32 m0, s47, 32
    v_exp_f32 v31, v31
    v_mfma_f32_16x16x32_bf16 v[20:23], a[92:95], v[76:79], v[20:23]
    s_waitcnt lgkmcnt(4)
    buffer_load_dwordx4 v5, s[16:19], s46 offen offset:1024 lds
    v_mfma_f32_16x16x32_bf16 v[24:27], a[96:99], v[64:67], v[48:51]
    s_sub_u32 s48, 0, s48
    v_exp_f32 v16, v16
    v_mfma_f32_16x16x32_bf16 v[24:27], a[100:103], v[68:71], v[24:27]
    v_cvt_pk_bf16_f32 v47, v30, v31
    v_mfma_f32_16x16x32_bf16 v[24:27], a[104:107], v[72:75], v[24:27]
    s_add_u32 m0, s47, 64
    v_exp_f32 v17, v17
    v_mfma_f32_16x16x32_bf16 v[24:27], a[108:111], v[76:79], v[24:27]
    s_waitcnt lgkmcnt(0)
    buffer_load_dwordx4 v5, s[16:19], s46 offen offset:2048 lds
    v_mfma_f32_16x16x32_bf16 v[28:31], a[112:115], v[64:67], v[48:51]
    v_exp_f32 v18, v18
    v_mfma_f32_16x16x32_bf16 v[28:31], a[116:119], v[68:71], v[28:31]
    v_cvt_pk_bf16_f32 v32, v16, v17
    v_mfma_f32_16x16x32_bf16 v[28:31], a[120:123], v[72:75], v[28:31]
    s_add_u32 m0, s47, 96
    v_exp_f32 v19, v19
    v_mfma_f32_16x16x32_bf16 v[28:31], a[124:127], v[76:79], v[28:31]
    buffer_load_dwordx4 v5, s[16:19], s46 offen offset:3072 lds
    v_mfma_f32_16x16x32_bf16 v[224:227], a[128:131], v[40:43], v[224:227]
    v_exp_f32 v20, v20
    v_mfma_f32_16x16x32_bf16 v[224:227], a[132:135], v[44:47], v[224:227]
    ds_read_b64_tr_b16 a[128:129], v2 offset:0
    v_cvt_pk_bf16_f32 v33, v18, v19
    v_mfma_f32_16x16x32_bf16 v[228:231], a[136:139], v[40:43], v[228:231]
    s_add_u32 m0, s47, 16896
    v_exp_f32 v21, v21
    v_mfma_f32_16x16x32_bf16 v[228:231], a[140:143], v[44:47], v[228:231]
    buffer_load_dwordx4 v5, s[20:23], s46 offen offset:0 lds
    v_mfma_f32_16x16x32_bf16 v[232:235], a[144:147], v[40:43], v[232:235]
    v_exp_f32 v22, v22
    v_mfma_f32_16x16x32_bf16 v[232:235], a[148:151], v[44:47], v[232:235]
    ds_read_b64_tr_b16 a[130:131], v2 offset:256
    v_cvt_pk_bf16_f32 v34, v20, v21
    v_mfma_f32_16x16x32_bf16 v[236:239], a[152:155], v[40:43], v[236:239]
    s_add_u32 m0, s47, 16928
    v_exp_f32 v23, v23
    v_mfma_f32_16x16x32_bf16 v[236:239], a[156:159], v[44:47], v[236:239]
    buffer_load_dwordx4 v5, s[20:23], s46 offen offset:1024 lds
    v_mfma_f32_16x16x32_bf16 v[240:243], a[160:163], v[40:43], v[240:243]
    v_exp_f32 v24, v24
    v_mfma_f32_16x16x32_bf16 v[240:243], a[164:167], v[44:47], v[240:243]
    ds_read_b64_tr_b16 a[132:133], v2 offset:512
    v_cvt_pk_bf16_f32 v35, v22, v23
    v_mfma_f32_16x16x32_bf16 v[244:247], a[168:171], v[40:43], v[244:247]
    s_add_u32 m0, s47, 16960
    v_exp_f32 v25, v25
    v_mfma_f32_16x16x32_bf16 v[244:247], a[172:175], v[44:47], v[244:247]
    buffer_load_dwordx4 v5, s[20:23], s46 offen offset:2048 lds
    v_mfma_f32_16x16x32_bf16 v[248:251], a[176:179], v[40:43], v[248:251]
    v_exp_f32 v26, v26
    v_mfma_f32_16x16x32_bf16 v[248:251], a[180:183], v[44:47], v[248:251]
    ds_read_b64_tr_b16 a[134:135], v2 offset:768
    v_cvt_pk_bf16_f32 v36, v24, v25
    v_mfma_f32_16x16x32_bf16 v[252:255], a[184:187], v[40:43], v[252:255]
    s_add_u32 m0, s47, 16992
    v_exp_f32 v27, v27
    v_mfma_f32_16x16x32_bf16 v[252:255], a[188:191], v[44:47], v[252:255]
    buffer_load_dwordx4 v5, s[20:23], s46 offen offset:3072 lds
    v_smfmac_f32_16x16x64_bf16 a[12:15], a[16:19], v[40:47], v11
    ds_read_b64_tr_b16 a[136:137], v2 offset:32
    v_mfma_f32_16x16x32_bf16 v[16:19], a[64:67], v[80:83], v[52:55]
    v_exp_f32 v28, v28
    v_mfma_f32_16x16x32_bf16 v[16:19], a[68:71], v[84:87], v[16:19]
    ds_read_b64_tr_b16 a[138:139], v2 offset:288
    v_cvt_pk_bf16_f32 v37, v26, v27
    v_mfma_f32_16x16x32_bf16 v[16:19], a[72:75], v[88:91], v[16:19]
    s_cmp_le_u32 s49, 5
    v_exp_f32 v29, v29
    v_mfma_f32_16x16x32_bf16 v[16:19], a[76:79], v[92:95], v[16:19]
    s_cbranch_scc1 L2_pf
L2_pfret:
    ds_read_b64_tr_b16 a[140:141], v2 offset:544
    v_mfma_f32_16x16x32_bf16 v[20:23], a[80:83], v[80:83], v[52:55]
    v_exp_f32 v30, v30
    v_mfma_f32_16x16x32_bf16 v[20:23], a[84:87], v[84:87], v[20:23]
    ds_read_b64_tr_b16 a[142:143], v2 offset:800
    v_cvt_pk_bf16_f32 v38, v28, v29
    v_mfma_f32_16x16x32_bf16 v[20:23], a[88:91], v[88:91], v[20:23]
    v_exp_f32 v31, v31
    v_mfma_f32_16x16x32_bf16 v[20:23], a[92:95], v[92:95], v[20:23]
    ds_read_b64_tr_b16 a[144:145], v2 offset:64
    v_mfma_f32_16x16x32_bf16 v[24:27], a[96:99], v[80:83], v[52:55]
    v_exp_f32 v16, v16
    v_mfma_f32_16x16x32_bf16 v[24:27], a[100:103], v[84:87], v[24:27]
    ds_read_b64_tr_b16 a[146:147], v2 offset:320
    v_cvt_pk_bf16_f32 v39, v30, v31
    v_mfma_f32_16x16x32_bf16 v[24:27], a[104:107], v[88:91], v[24:27]
    v_exp_f32 v17, v17
    v_mfma_f32_16x16x32_bf16 v[24:27], a[108:111], v[92:95], v[24:27]
    ds_read_b64_tr_b16 a[148:149], v2 offset:576
    v_mfma_f32_16x16x32_bf16 v[28:31], a[112:115], v[80:83], v[52:55]
    v_exp_f32 v18, v18
    v_mfma_f32_16x16x32_bf16 v[28:31], a[116:119], v[84:87], v[28:31]
    ds_read_b64_tr_b16 a[150:151], v2 offset:832
    v_cvt_pk_bf16_f32 v40, v16, v17
    v_mfma_f32_16x16x32_bf16 v[28:31], a[120:123], v[88:91], v[28:31]
    v_exp_f32 v19, v19
    v_mfma_f32_16x16x32_bf16 v[28:31], a[124:127], v[92:95], v[28:31]
    ds_read_b64_tr_b16 a[152:153], v2 offset:96
    v_mfma_f32_16x16x32_bf16 v[128:131], a[192:195], v[32:35], v[128:131]
    v_exp_f32 v20, v20
    v_mfma_f32_16x16x32_bf16 v[128:131], a[196:199], v[36:39], v[128:131]
    ds_read_b64_tr_b16 a[154:155], v2 offset:352
    v_cvt_pk_bf16_f32 v41, v18, v19
    v_mfma_f32_16x16x32_bf16 v[132:135], a[200:203], v[32:35], v[132:135]
    v_exp_f32 v21, v21
    v_mfma_f32_16x16x32_bf16 v[132:135], a[204:207], v[36:39], v[132:135]
    ds_read_b64_tr_b16 a[156:157], v2 offset:608
    v_mfma_f32_16x16x32_bf16 v[136:139], a[208:211], v[32:35], v[136:139]
    v_exp_f32 v22, v22
    v_mfma_f32_16x16x32_bf16 v[136:139], a[212:215], v[36:39], v[136:139]
    ds_read_b64_tr_b16 a[158:159], v2 offset:864
    v_cvt_pk_bf16_f32 v42, v20, v21
    v_mfma_f32_16x16x32_bf16 v[140:143], a[216:219], v[32:35], v[140:143]
    v_exp_f32 v23, v23
    v_mfma_f32_16x16x32_bf16 v[140:143], a[220:223], v[36:39], v[140:143]
    ds_read_b64_tr_b16 a[160:161], v2 offset:128
    v_mfma_f32_16x16x32_bf16 v[144:147], a[224:227], v[32:35], v[144:147]
    v_exp_f32 v24, v24
    v_mfma_f32_16x16x32_bf16 v[144:147], a[228:231], v[36:39], v[144:147]
    ds_read_b64_tr_b16 a[162:163], v2 offset:384
    v_cvt_pk_bf16_f32 v43, v22, v23
    v_mfma_f32_16x16x32_bf16 v[148:151], a[232:235], v[32:35], v[148:151]
    v_exp_f32 v25, v25
    v_mfma_f32_16x16x32_bf16 v[148:151], a[236:239], v[36:39], v[148:151]
    ds_read_b64_tr_b16 a[164:165], v2 offset:640
    v_mfma_f32_16x16x32_bf16 v[152:155], a[240:243], v[32:35], v[152:155]
    v_exp_f32 v26, v26
    v_mfma_f32_16x16x32_bf16 v[152:155], a[244:247], v[36:39], v[152:155]
    ds_read_b64_tr_b16 a[166:167], v2 offset:896
    v_cvt_pk_bf16_f32 v44, v24, v25
    v_mfma_f32_16x16x32_bf16 v[156:159], a[248:251], v[32:35], v[156:159]
    v_exp_f32 v27, v27
    v_mfma_f32_16x16x32_bf16 v[156:159], a[252:255], v[36:39], v[156:159]
    ds_read_b64_tr_b16 a[168:169], v2 offset:160
    v_smfmac_f32_16x16x64_bf16 a[0:3], a[16:19], v[32:39], v11
    ds_read_b64_tr_b16 a[170:171], v2 offset:416
    v_mfma_f32_16x16x32_bf16 v[16:19], a[64:67], v[96:99], v[56:59]
    v_exp_f32 v28, v28
    v_mfma_f32_16x16x32_bf16 v[16:19], a[68:71], v[100:103], v[16:19]
    ds_read_b64_tr_b16 a[172:173], v2 offset:672
    v_cvt_pk_bf16_f32 v45, v26, v27
    v_mfma_f32_16x16x32_bf16 v[16:19], a[72:75], v[104:107], v[16:19]
    v_exp_f32 v29, v29
    v_mfma_f32_16x16x32_bf16 v[16:19], a[76:79], v[108:111], v[16:19]
    ds_read_b64_tr_b16 a[174:175], v2 offset:928
    v_mfma_f32_16x16x32_bf16 v[20:23], a[80:83], v[96:99], v[56:59]
    v_exp_f32 v30, v30
    v_mfma_f32_16x16x32_bf16 v[20:23], a[84:87], v[100:103], v[20:23]
    ds_read_b64_tr_b16 a[176:177], v2 offset:192
    v_cvt_pk_bf16_f32 v46, v28, v29
    v_mfma_f32_16x16x32_bf16 v[20:23], a[88:91], v[104:107], v[20:23]
    v_exp_f32 v31, v31
    v_mfma_f32_16x16x32_bf16 v[20:23], a[92:95], v[108:111], v[20:23]
    ds_read_b64_tr_b16 a[178:179], v2 offset:448
    v_mfma_f32_16x16x32_bf16 v[24:27], a[96:99], v[96:99], v[56:59]
    v_exp_f32 v16, v16
    v_mfma_f32_16x16x32_bf16 v[24:27], a[100:103], v[100:103], v[24:27]
    ds_read_b64_tr_b16 a[180:181], v2 offset:704
    v_cvt_pk_bf16_f32 v47, v30, v31
    v_mfma_f32_16x16x32_bf16 v[24:27], a[104:107], v[104:107], v[24:27]
    v_exp_f32 v17, v17
    v_mfma_f32_16x16x32_bf16 v[24:27], a[108:111], v[108:111], v[24:27]
    ds_read_b64_tr_b16 a[182:183], v2 offset:960
    v_mfma_f32_16x16x32_bf16 v[28:31], a[112:115], v[96:99], v[56:59]
    v_exp_f32 v18, v18
    v_mfma_f32_16x16x32_bf16 v[28:31], a[116:119], v[100:103], v[28:31]
    ds_read_b64_tr_b16 a[184:185], v2 offset:224
    v_cvt_pk_bf16_f32 v32, v16, v17
    v_mfma_f32_16x16x32_bf16 v[28:31], a[120:123], v[104:107], v[28:31]
    v_exp_f32 v19, v19
    v_mfma_f32_16x16x32_bf16 v[28:31], a[124:127], v[108:111], v[28:31]
    ds_read_b64_tr_b16 a[186:187], v2 offset:480
    v_mfma_f32_16x16x32_bf16 v[160:163], a[192:195], v[40:43], v[160:163]
    v_exp_f32 v20, v20
    v_mfma_f32_16x16x32_bf16 v[160:163], a[196:199], v[44:47], v[160:163]
    ds_read_b64_tr_b16 a[188:189], v2 offset:736
    v_cvt_pk_bf16_f32 v33, v18, v19
    v_mfma_f32_16x16x32_bf16 v[164:167], a[200:203], v[40:43], v[164:167]
    v_exp_f32 v21, v21
    v_mfma_f32_16x16x32_bf16 v[164:167], a[204:207], v[44:47], v[164:167]
    ds_read_b64_tr_b16 a[190:191], v2 offset:992
    v_mfma_f32_16x16x32_bf16 v[168:171], a[208:211], v[40:43], v[168:171]
    v_exp_f32 v22, v22
    v_mfma_f32_16x16x32_bf16 v[168:171], a[212:215], v[44:47], v[168:171]
    v_cvt_pk_bf16_f32 v34, v20, v21
    v_mfma_f32_16x16x32_bf16 v[172:175], a[216:219], v[40:43], v[172:175]
    v_exp_f32 v23, v23
    v_mfma_f32_16x16x32_bf16 v[172:175], a[220:223], v[44:47], v[172:175]
    v_mfma_f32_16x16x32_bf16 v[176:179], a[224:227], v[40:43], v[176:179]
    v_exp_f32 v24, v24
    v_mfma_f32_16x16x32_bf16 v[176:179], a[228:231], v[44:47], v[176:179]
    v_cvt_pk_bf16_f32 v35, v22, v23
    v_mfma_f32_16x16x32_bf16 v[180:183], a[232:235], v[40:43], v[180:183]
    v_exp_f32 v25, v25
    v_mfma_f32_16x16x32_bf16 v[180:183], a[236:239], v[44:47], v[180:183]
    v_mfma_f32_16x16x32_bf16 v[184:187], a[240:243], v[40:43], v[184:187]
    v_exp_f32 v26, v26
    v_mfma_f32_16x16x32_bf16 v[184:187], a[244:247], v[44:47], v[184:187]
    v_cvt_pk_bf16_f32 v36, v24, v25
    v_mfma_f32_16x16x32_bf16 v[188:191], a[248:251], v[40:43], v[188:191]
    v_exp_f32 v27, v27
    v_mfma_f32_16x16x32_bf16 v[188:191], a[252:255], v[44:47], v[188:191]
    v_smfmac_f32_16x16x64_bf16 a[4:7], a[16:19], v[40:47], v11
    v_mfma_f32_16x16x32_bf16 v[16:19], a[64:67], v[112:115], v[60:63]
    v_exp_f32 v28, v28
    v_mfma_f32_16x16x32_bf16 v[16:19], a[68:71], v[116:119], v[16:19]
    s_add_u32 s46, s46, 16384
    ds_read_b128 a[64:67], v1 offset:0
    v_cvt_pk_bf16_f32 v37, v26, v27
    v_mfma_f32_16x16x32_bf16 v[16:19], a[72:75], v[120:123], v[16:19]
    s_min_u32 s46, s46, 507904
    v_exp_f32 v29, v29
    v_mfma_f32_16x16x32_bf16 v[16:19], a[76:79], v[124:127], v[16:19]
    ds_read_b128 a[68:71], v1 offset:64
    v_mfma_f32_16x16x32_bf16 v[20:23], a[80:83], v[112:115], v[60:63]
    v_exp_f32 v30, v30
    v_mfma_f32_16x16x32_bf16 v[20:23], a[84:87], v[116:119], v[20:23]
    ds_read_b128 a[72:75], v1 offset:128
    v_cvt_pk_bf16_f32 v38, v28, v29
    v_mfma_f32_16x16x32_bf16 v[20:23], a[88:91], v[120:123], v[20:23]
    v_exp_f32 v31, v31
    v_mfma_f32_16x16x32_bf16 v[20:23], a[92:95], v[124:127], v[20:23]
    ds_read_b128 a[76:79], v1 offset:192
    v_mfma_f32_16x16x32_bf16 v[24:27], a[96:99], v[112:115], v[60:63]
    v_exp_f32 v16, v16
    v_mfma_f32_16x16x32_bf16 v[24:27], a[100:103], v[116:119], v[24:27]
    ds_read_b128 a[80:83], v1 offset:256
    v_cvt_pk_bf16_f32 v39, v30, v31
    v_mfma_f32_16x16x32_bf16 v[24:27], a[104:107], v[120:123], v[24:27]
    v_exp_f32 v17, v17
    v_mfma_f32_16x16x32_bf16 v[24:27], a[108:111], v[124:127], v[24:27]
    ds_read_b128 a[84:87], v1 offset:320
    v_mfma_f32_16x16x32_bf16 v[28:31], a[112:115], v[112:115], v[60:63]
    v_exp_f32 v18, v18
    v_mfma_f32_16x16x32_bf16 v[28:31], a[116:119], v[116:119], v[28:31]
    ds_read_b128 a[88:91], v1 offset:384
    v_cvt_pk_bf16_f32 v40, v16, v17
    v_mfma_f32_16x16x32_bf16 v[28:31], a[120:123], v[120:123], v[28:31]
    v_exp_f32 v19, v19
    v_mfma_f32_16x16x32_bf16 v[28:31], a[124:127], v[124:127], v[28:31]
    ds_read_b128 a[92:95], v1 offset:448
    v_mfma_f32_16x16x32_bf16 v[192:195], a[192:195], v[32:35], v[192:195]
    v_exp_f32 v20, v20
    v_mfma_f32_16x16x32_bf16 v[192:195], a[196:199], v[36:39], v[192:195]
    ds_read_b128 a[96:99], v1 offset:512
    v_cvt_pk_bf16_f32 v41, v18, v19
    v_mfma_f32_16x16x32_bf16 v[196:199], a[200:203], v[32:35], v[196:199]
    v_exp_f32 v21, v21
    v_mfma_f32_16x16x32_bf16 v[196:199], a[204:207], v[36:39], v[196:199]
    ds_read_b128 a[100:103], v1 offset:576
    v_mfma_f32_16x16x32_bf16 v[200:203], a[208:211], v[32:35], v[200:203]
    v_exp_f32 v22, v22
    v_mfma_f32_16x16x32_bf16 v[200:203], a[212:215], v[36:39], v[200:203]
    ds_read_b128 a[104:107], v1 offset:640
    v_cvt_pk_bf16_f32 v42, v20, v21
    v_mfma_f32_16x16x32_bf16 v[204:207], a[216:219], v[32:35], v[204:207]
    v_exp_f32 v23, v23
    v_mfma_f32_16x16x32_bf16 v[204:207], a[220:223], v[36:39], v[204:207]
    ds_read_b128 a[108:111], v1 offset:704
    v_mfma_f32_16x16x32_bf16 v[208:211], a[224:227], v[32:35], v[208:211]
    v_exp_f32 v24, v24
    v_mfma_f32_16x16x32_bf16 v[208:211], a[228:231], v[36:39], v[208:211]
    ds_read_b128 a[112:115], v1 offset:768
    v_cvt_pk_bf16_f32 v43, v22, v23
    v_mfma_f32_16x16x32_bf16 v[212:215], a[232:235], v[32:35], v[212:215]
    v_exp_f32 v25, v25
    v_mfma_f32_16x16x32_bf16 v[212:215], a[236:239], v[36:39], v[212:215]
    ds_read_b128 a[116:119], v1 offset:832
    v_mfma_f32_16x16x32_bf16 v[216:219], a[240:243], v[32:35], v[216:219]
    v_exp_f32 v26, v26
    v_mfma_f32_16x16x32_bf16 v[216:219], a[244:247], v[36:39], v[216:219]
    ds_read_b128 a[120:123], v1 offset:896
    v_cvt_pk_bf16_f32 v44, v24, v25
    v_mfma_f32_16x16x32_bf16 v[220:223], a[248:251], v[32:35], v[220:223]
    v_exp_f32 v27, v27
    v_mfma_f32_16x16x32_bf16 v[220:223], a[252:255], v[36:39], v[220:223]
    ds_read_b128 a[124:127], v1 offset:960
    v_smfmac_f32_16x16x64_bf16 a[8:11], a[16:19], v[32:39], v11
    s_waitcnt vmcnt(8) lgkmcnt(12)
    s_barrier
    v_mfma_f32_16x16x32_bf16 v[16:19], a[64:67], v[64:67], v[48:51]
    v_exp_f32 v28, v28
    v_mfma_f32_16x16x32_bf16 v[16:19], a[68:71], v[68:71], v[16:19]
    v_cvt_pk_bf16_f32 v45, v26, v27
    v_mfma_f32_16x16x32_bf16 v[16:19], a[72:75], v[72:75], v[16:19]
    s_add_u32 m0, s47, 36864
    v_exp_f32 v29, v29
    v_mfma_f32_16x16x32_bf16 v[16:19], a[76:79], v[76:79], v[16:19]
    s_waitcnt lgkmcnt(8)
    buffer_load_dwordx4 v5, s[16:19], s46 offen offset:0 lds
    v_mfma_f32_16x16x32_bf16 v[20:23], a[80:83], v[64:67], v[48:51]
    v_exp_f32 v30, v30
    v_mfma_f32_16x16x32_bf16 v[20:23], a[84:87], v[68:71], v[20:23]
    v_cvt_pk_bf16_f32 v46, v28, v29
    v_mfma_f32_16x16x32_bf16 v[20:23], a[88:91], v[72:75], v[20:23]
    s_add_u32 m0, s47, 36896
    v_exp_f32 v31, v31
    v_mfma_f32_16x16x32_bf16 v[20:23], a[92:95], v[76:79], v[20:23]
    s_waitcnt lgkmcnt(4)
    buffer_load_dwordx4 v5, s[16:19], s46 offen offset:1024 lds
    v_mfma_f32_16x16x32_bf16 v[24:27], a[96:99], v[64:67], v[48:51]
    v_exp_f32 v16, v16
    v_mfma_f32_16x16x32_bf16 v[24:27], a[100:103], v[68:71], v[24:27]
    v_cvt_pk_bf16_f32 v47, v30, v31
    v_mfma_f32_16x16x32_bf16 v[24:27], a[104:107], v[72:75], v[24:27]
    s_add_u32 m0, s47, 36928
    v_exp_f32 v17, v17
    v_mfma_f32_16x16x32_bf16 v[24:27], a[108:111], v[76:79], v[24:27]
    s_waitcnt lgkmcnt(0)
    buffer_load_dwordx4 v5, s[16:19], s46 offen offset:2048 lds
    v_mfma_f32_16x16x32_bf16 v[28:31], a[112:115], v[64:67], v[48:51]
    v_exp_f32 v18, v18
    v_mfma_f32_16x16x32_bf16 v[28:31], a[116:119], v[68:71], v[28:31]
    v_cvt_pk_bf16_f32 v32, v16, v17
    v_mfma_f32_16x16x32_bf16 v[28:31], a[120:123], v[72:75], v[28:31]
    s_add_u32 m0, s47, 36960
    v_exp_f32 v19, v19
    v_mfma_f32_16x16x32_bf16 v[28:31], a[124:127], v[76:79], v[28:31]
    buffer_load_dwordx4 v5, s[16:19], s46 offen offset:3072 lds
    v_mfma_f32_16x16x32_bf16 v[224:227], a[192:195], v[40:43], v[224:227]
    v_exp_f32 v20, v20
    v_mfma_f32_16x16x32_bf16 v[224:227], a[196:199], v[44:47], v[224:227]
    ds_read_b64_tr_b16 a[192:193], v2 offset:36864
    v_cvt_pk_bf16_f32 v33, v18, v19
    v_mfma_f32_16x16x32_bf16 v[228:231], a[200:203], v[40:43], v[228:231]
    s_add_u32 m0, s47, 53760
    v_exp_f32 v21, v21
    v_mfma_f32_16x16x32_bf16 v[228:231], a[204:207], v[44:47], v[228:231]
    buffer_load_dwordx4 v5, s[20:23], s46 offen offset:0 lds
    v_mfma_f32_16x16x32_bf16 v[232:235], a[208:211], v[40:43], v[232:235]
    v_exp_f32 v22, v22
    v_mfma_f32_16x16x32_bf16 v[232:235], a[212:215], v[44:47], v[232:235]
    ds_read_b64_tr_b16 a[194:195], v2 offset:37120
    v_cvt_pk_bf16_f32 v34, v20, v21
    v_mfma_f32_16x16x32_bf16 v[236:239], a[216:219], v[40:43], v[236:239]
    s_add_u32 m0, s47, 53792
    v_exp_f32 v23, v23
    v_mfma_f32_16x16x32_bf16 v[236:239], a[220:223], v[44:47], v[236:239]
    buffer_load_dwordx4 v5, s[20:23], s46 offen offset:1024 lds
    v_mfma_f32_16x16x32_bf16 v[240:243], a[224:227], v[40:43], v[240:243]
    v_exp_f32 v24, v24
    v_mfma_f32_16x16x32_bf16 v[240:243], a[228:231], v[44:47], v[240:243]
    ds_read_b64_tr_b16 a[196:197], v2 offset:37376
    v_cvt_pk_bf16_f32 v35, v22, v23
    v_mfma_f32_16x16x32_bf16 v[244:247], a[232:235], v[40:43], v[244:247]
    s_add_u32 m0, s47, 53824
    v_exp_f32 v25, v25
    v_mfma_f32_16x16x32_bf16 v[244:247], a[236:239], v[44:47], v[244:247]
    buffer_load_dwordx4 v5, s[20:23], s46 offen offset:2048 lds
    v_mfma_f32_16x16x32_bf16 v[248:251], a[240:243], v[40:43], v[248:251]
    v_exp_f32 v26, v26
    v_mfma_f32_16x16x32_bf16 v[248:251], a[244:247], v[44:47], v[248:251]
    ds_read_b64_tr_b16 a[198:199], v2 offset:37632
    v_cvt_pk_bf16_f32 v36, v24, v25
    v_mfma_f32_16x16x32_bf16 v[252:255], a[248:251], v[40:43], v[252:255]
    s_add_u32 m0, s47, 53856
    v_exp_f32 v27, v27
    v_mfma_f32_16x16x32_bf16 v[252:255], a[252:255], v[44:47], v[252:255]
    buffer_load_dwordx4 v5, s[20:23], s46 offen offset:3072 lds
    v_smfmac_f32_16x16x64_bf16 a[12:15], a[16:19], v[40:47], v11
    ds_read_b64_tr_b16 a[200:201], v2 offset:36896
    v_mfma_f32_16x16x32_bf16 v[16:19], a[64:67], v[80:83], v[52:55]
    v_exp_f32 v28, v28
    v_mfma_f32_16x16x32_bf16 v[16:19], a[68:71], v[84:87], v[16:19]
    ds_read_b64_tr_b16 a[202:203], v2 offset:37152
    v_cvt_pk_bf16_f32 v37, v26, v27
    v_mfma_f32_16x16x32_bf16 v[16:19], a[72:75], v[88:91], v[16:19]
    v_exp_f32 v29, v29
    v_mfma_f32_16x16x32_bf16 v[16:19], a[76:79], v[92:95], v[16:19]
    ds_read_b64_tr_b16 a[204:205], v2 offset:37408
    v_mfma_f32_16x16x32_bf16 v[20:23], a[80:83], v[80:83], v[52:55]
    v_exp_f32 v30, v30
    v_mfma_f32_16x16x32_bf16 v[20:23], a[84:87], v[84:87], v[20:23]
    ds_read_b64_tr_b16 a[206:207], v2 offset:37664
    v_cvt_pk_bf16_f32 v38, v28, v29
    v_mfma_f32_16x16x32_bf16 v[20:23], a[88:91], v[88:91], v[20:23]
    v_exp_f32 v31, v31
    v_mfma_f32_16x16x32_bf16 v[20:23], a[92:95], v[92:95], v[20:23]
    ds_read_b64_tr_b16 a[208:209], v2 offset:36928
    v_mfma_f32_16x16x32_bf16 v[24:27], a[96:99], v[80:83], v[52:55]
    v_exp_f32 v16, v16
    v_mfma_f32_16x16x32_bf16 v[24:27], a[100:103], v[84:87], v[24:27]
    ds_read_b64_tr_b16 a[210:211], v2 offset:37184
    v_cvt_pk_bf16_f32 v39, v30, v31
    v_mfma_f32_16x16x32_bf16 v[24:27], a[104:107], v[88:91], v[24:27]
    v_exp_f32 v17, v17
    v_mfma_f32_16x16x32_bf16 v[24:27], a[108:111], v[92:95], v[24:27]
    ds_read_b64_tr_b16 a[212:213], v2 offset:37440
    v_mfma_f32_16x16x32_bf16 v[28:31], a[112:115], v[80:83], v[52:55]
    v_exp_f32 v18, v18
    v_mfma_f32_16x16x32_bf16 v[28:31], a[116:119], v[84:87], v[28:31]
    ds_read_b64_tr_b16 a[214:215], v2 offset:37696
    v_cvt_pk_bf16_f32 v40, v16, v17
    v_mfma_f32_16x16x32_bf16 v[28:31], a[120:123], v[88:91], v[28:31]
    v_exp_f32 v19, v19
    v_mfma_f32_16x16x32_bf16 v[28:31], a[124:127], v[92:95], v[28:31]
    ds_read_b64_tr_b16 a[216:217], v2 offset:36960
    v_mfma_f32_16x16x32_bf16 v[128:131], a[128:131], v[32:35], v[128:131]
    v_exp_f32 v20, v20
    v_mfma_f32_16x16x32_bf16 v[128:131], a[132:135], v[36:39], v[128:131]
    ds_read_b64_tr_b16 a[218:219], v2 offset:37216
    v_cvt_pk_bf16_f32 v41, v18, v19
    v_mfma_f32_16x16x32_bf16 v[132:135], a[136:139], v[32:35], v[132:135]
    v_exp_f32 v21, v21
    v_mfma_f32_16x16x32_bf16 v[132:135], a[140:143], v[36:39], v[132:135]
    ds_read_b64_tr_b16 a[220:221], v2 offset:37472
    v_mfma_f32_16x16x32_bf16 v[136:139], a[144:147], v[32:35], v[136:139]
    v_exp_f32 v22, v22
    v_mfma_f32_16x16x32_bf16 v[136:139], a[148:151], v[36:39], v[136:139]
    ds_read_b64_tr_b16 a[222:223], v2 offset:37728
    v_cvt_pk_bf16_f32 v42, v20, v21
    v_mfma_f32_16x16x32_bf16 v[140:143], a[152:155], v[32:35], v[140:143]
    v_exp_f32 v23, v23
    v_mfma_f32_16x16x32_bf16 v[140:143], a[156:159], v[36:39], v[140:143]
    ds_read_b64_tr_b16 a[224:225], v2 offset:36992
    v_mfma_f32_16x16x32_bf16 v[144:147], a[160:163], v[32:35], v[144:147]
    v_exp_f32 v24, v24
    v_mfma_f32_16x16x32_bf16 v[144:147], a[164:167], v[36:39], v[144:147]
    ds_read_b64_tr_b16 a[226:227], v2 offset:37248
    v_cvt_pk_bf16_f32 v43, v22, v23
    v_mfma_f32_16x16x32_bf16 v[148:151], a[168:171], v[32:35], v[148:151]
    v_exp_f32 v25, v25
    v_mfma_f32_16x16x32_bf16 v[148:151], a[172:175], v[36:39], v[148:151]
    ds_read_b64_tr_b16 a[228:229], v2 offset:37504
    v_mfma_f32_16x16x32_bf16 v[152:155], a[176:179], v[32:35], v[152:155]
    v_exp_f32 v26, v26
    v_mfma_f32_16x16x32_bf16 v[152:155], a[180:183], v[36:39], v[152:155]
    ds_read_b64_tr_b16 a[230:231], v2 offset:37760
    v_cvt_pk_bf16_f32 v44, v24, v25
    v_mfma_f32_16x16x32_bf16 v[156:159], a[184:187], v[32:35], v[156:159]
    v_exp_f32 v27, v27
    v_mfma_f32_16x16x32_bf16 v[156:159], a[188:191], v[36:39], v[156:159]
    ds_read_b64_tr_b16 a[232:233], v2 offset:37024
    v_smfmac_f32_16x16x64_bf16 a[0:3], a[16:19], v[32:39], v11
    ds_read_b64_tr_b16 a[234:235], v2 offset:37280
    v_mfma_f32_16x16x32_bf16 v[16:19], a[64:67], v[96:99], v[56:59]
    v_exp_f32 v28, v28
    v_mfma_f32_16x16x32_bf16 v[16:19], a[68:71], v[100:103], v[16:19]
    ds_read_b64_tr_b16 a[236:237], v2 offset:37536
    v_cvt_pk_bf16_f32 v45, v26, v27
    v_mfma_f32_16x16x32_bf16 v[16:19], a[72:75], v[104:107], v[16:19]
    v_exp_f32 v29, v29
    v_mfma_f32_16x16x32_bf16 v[16:19], a[76:79], v[108:111], v[16:19]
    ds_read_b64_tr_b16 a[238:239], v2 offset:37792
    v_mfma_f32_16x16x32_bf16 v[20:23], a[80:83], v[96:99], v[56:59]
    v_exp_f32 v30, v30
    v_mfma_f32_16x16x32_bf16 v[20:23], a[84:87], v[100:103], v[20:23]
    ds_read_b64_tr_b16 a[240:241], v2 offset:37056
    v_cvt_pk_bf16_f32 v46, v28, v29
    v_mfma_f32_16x16x32_bf16 v[20:23], a[88:91], v[104:107], v[20:23]
    v_exp_f32 v31, v31
    v_mfma_f32_16x16x32_bf16 v[20:23], a[92:95], v[108:111], v[20:23]
    ds_read_b64_tr_b16 a[242:243], v2 offset:37312
    v_mfma_f32_16x16x32_bf16 v[24:27], a[96:99], v[96:99], v[56:59]
    v_exp_f32 v16, v16
    v_mfma_f32_16x16x32_bf16 v[24:27], a[100:103], v[100:103], v[24:27]
    ds_read_b64_tr_b16 a[244:245], v2 offset:37568
    v_cvt_pk_bf16_f32 v47, v30, v31
    v_mfma_f32_16x16x32_bf16 v[24:27], a[104:107], v[104:107], v[24:27]
    v_exp_f32 v17, v17
    v_mfma_f32_16x16x32_bf16 v[24:27], a[108:111], v[108:111], v[24:27]
    ds_read_b64_tr_b16 a[246:247], v2 offset:37824
    v_mfma_f32_16x16x32_bf16 v[28:31], a[112:115], v[96:99], v[56:59]
    v_exp_f32 v18, v18
    v_mfma_f32_16x16x32_bf16 v[28:31], a[116:119], v[100:103], v[28:31]
    ds_read_b64_tr_b16 a[248:249], v2 offset:37088
    v_cvt_pk_bf16_f32 v32, v16, v17
    v_mfma_f32_16x16x32_bf16 v[28:31], a[120:123], v[104:107], v[28:31]
    v_exp_f32 v19, v19
    v_mfma_f32_16x16x32_bf16 v[28:31], a[124:127], v[108:111], v[28:31]
    ds_read_b64_tr_b16 a[250:251], v2 offset:37344
    v_mfma_f32_16x16x32_bf16 v[160:163], a[128:131], v[40:43], v[160:163]
    v_exp_f32 v20, v20
    v_mfma_f32_16x16x32_bf16 v[160:163], a[132:135], v[44:47], v[160:163]
    ds_read_b64_tr_b16 a[252:253], v2 offset:37600
    v_cvt_pk_bf16_f32 v33, v18, v19
    v_mfma_f32_16x16x32_bf16 v[164:167], a[136:139], v[40:43], v[164:167]
    v_exp_f32 v21, v21
    v_mfma_f32_16x16x32_bf16 v[164:167], a[140:143], v[44:47], v[164:167]
    ds_read_b64_tr_b16 a[254:255], v2 offset:37856
    v_mfma_f32_16x16x32_bf16 v[168:171], a[144:147], v[40:43], v[168:171]
    v_exp_f32 v22, v22
    v_mfma_f32_16x16x32_bf16 v[168:171], a[148:151], v[44:47], v[168:171]
    v_cvt_pk_bf16_f32 v34, v20, v21
    v_mfma_f32_16x16x32_bf16 v[172:175], a[152:155], v[40:43], v[172:175]
    v_exp_f32 v23, v23
    v_mfma_f32_16x16x32_bf16 v[172:175], a[156:159], v[44:47], v[172:175]
    v_mfma_f32_16x16x32_bf16 v[176:179], a[160:163], v[40:43], v[176:179]
    v_exp_f32 v24, v24
    v_mfma_f32_16x16x32_bf16 v[176:179], a[164:167], v[44:47], v[176:179]
    v_cvt_pk_bf16_f32 v35, v22, v23
    v_mfma_f32_16x16x32_bf16 v[180:183], a[168:171], v[40:43], v[180:183]
    v_exp_f32 v25, v25
    v_mfma_f32_16x16x32_bf16 v[180:183], a[172:175], v[44:47], v[180:183]
    v_mfma_f32_16x16x32_bf16 v[184:187], a[176:179], v[40:43], v[184:187]
    v_exp_f32 v26, v26
    v_mfma_f32_16x16x32_bf16 v[184:187], a[180:183], v[44:47], v[184:187]
    v_cvt_pk_bf16_f32 v36, v24, v25
    v_mfma_f32_16x16x32_bf16 v[188:191], a[184:187], v[40:43], v[188:191]
    v_exp_f32 v27, v27
    v_mfma_f32_16x16x32_bf16 v[188:191], a[188:191], v[44:47], v[188:191]
    v_smfmac_f32_16x16x64_bf16 a[4:7], a[16:19], v[40:47], v11
    v_mfma_f32_16x16x32_bf16 v[16:19], a[64:67], v[112:115], v[60:63]
    v_exp_f32 v28, v28
    v_mfma_f32_16x16x32_bf16 v[16:19], a[68:71], v[116:119], v[16:19]
    s_add_u32 s46, s46, 16384
    ds_read_b128 a[64:67], v1 offset:36864
    v_cvt_pk_bf16_f32 v37, v26, v27
    v_mfma_f32_16x16x32_bf16 v[16:19], a[72:75], v[120:123], v[16:19]
    s_min_u32 s46, s46, 507904
    v_exp_f32 v29, v29
    v_mfma_f32_16x16x32_bf16 v[16:19], a[76:79], v[124:127], v[16:19]
    ds_read_b128 a[68:71], v1 offset:36928
    v_mfma_f32_16x16x32_bf16 v[20:23], a[80:83], v[112:115], v[60:63]
    v_exp_f32 v30, v30
    v_mfma_f32_16x16x32_bf16 v[20:23], a[84:87], v[116:119], v[20:23]
    ds_read_b128 a[72:75], v1 offset:36992
    v_cvt_pk_bf16_f32 v38, v28, v29
    v_mfma_f32_16x16x32_bf16 v[20:23], a[88:91], v[120:123], v[20:23]
    v_exp_f32 v31, v31
    v_mfma_f32_16x16x32_bf16 v[20:23], a[92:95], v[124:127], v[20:23]
    ds_read_b128 a[76:79], v1 offset:37056
    v_mfma_f32_16x16x32_bf16 v[24:27], a[96:99], v[112:115], v[60:63]
    v_exp_f32 v16, v16
    v_mfma_f32_16x16x32_bf16 v[24:27], a[100:103], v[116:119], v[24:27]
    ds_read_b128 a[80:83], v1 offset:37120
    v_cvt_pk_bf16_f32 v39, v30, v31
    v_mfma_f32_16x16x32_bf16 v[24:27], a[104:107], v[120:123], v[24:27]
    v_exp_f32 v17, v17
    v_mfma_f32_16x16x32_bf16 v[24:27], a[108:111], v[124:127], v[24:27]
    ds_read_b128 a[84:87], v1 offset:37184
    v_mfma_f32_16x16x32_bf16 v[28:31], a[112:115], v[112:115], v[60:63]
    v_exp_f32 v18, v18
    v_mfma_f32_16x16x32_bf16 v[28:31], a[116:119], v[116:119], v[28:31]
    ds_read_b128 a[88:91], v1 offset:37248
    v_cvt_pk_bf16_f32 v40, v16, v17
    v_mfma_f32_16x16x32_bf16 v[28:31], a[120:123], v[120:123], v[28:31]
    v_exp_f32 v19, v19
    v_mfma_f32_16x16x32_bf16 v[28:31], a[124:127], v[124:127], v[28:31]
    ds_read_b128 a[92:95], v1 offset:37312
    v_mfma_f32_16x16x32_bf16 v[192:195], a[128:131], v[32:35], v[192:195]
    v_exp_f32 v20, v20
    v_mfma_f32_16x16x32_bf16 v[192:195], a[132:135], v[36:39], v[192:195]
    ds_read_b128 a[96:99], v1 offset:37376
    v_cvt_pk_bf16_f32 v41, v18, v19
    v_mfma_f32_16x16x32_bf16 v[196:199], a[136:139], v[32:35], v[196:199]
    v_exp_f32 v21, v21
    v_mfma_f32_16x16x32_bf16 v[196:199], a[140:143], v[36:39], v[196:199]
    ds_read_b128 a[100:103], v1 offset:37440
    v_mfma_f32_16x16x32_bf16 v[200:203], a[144:147], v[32:35], v[200:203]
    v_exp_f32 v22, v22
    v_mfma_f32_16x16x32_bf16 v[200:203], a[148:151], v[36:39], v[200:203]
    ds_read_b128 a[104:107], v1 offset:37504
    v_cvt_pk_bf16_f32 v42, v20, v21
    v_mfma_f32_16x16x32_bf16 v[204:207], a[152:155], v[32:35], v[204:207]
    v_exp_f32 v23, v23
    v_mfma_f32_16x16x32_bf16 v[204:207], a[156:159], v[36:39], v[204:207]
    ds_read_b128 a[108:111], v1 offset:37568
    v_mfma_f32_16x16x32_bf16 v[208:211], a[160:163], v[32:35], v[208:211]
    v_exp_f32 v24, v24
    v_mfma_f32_16x16x32_bf16 v[208:211], a[164:167], v[36:39], v[208:211]
    ds_read_b128 a[112:115], v1 offset:37632
    v_cvt_pk_bf16_f32 v43, v22, v23
    v_mfma_f32_16x16x32_bf16 v[212:215], a[168:171], v[32:35], v[212:215]
    v_exp_f32 v25, v25
    v_mfma_f32_16x16x32_bf16 v[212:215], a[172:175], v[36:39], v[212:215]
    ds_read_b128 a[116:119], v1 offset:37696
    v_mfma_f32_16x16x32_bf16 v[216:219], a[176:179], v[32:35], v[216:219]
    v_exp_f32 v26, v26
    v_mfma_f32_16x16x32_bf16 v[216:219], a[180:183], v[36:39], v[216:219]
    s_sub_u32 s49, s49, 1
    ds_read_b128 a[120:123], v1 offset:37760
    v_cvt_pk_bf16_f32 v44, v24, v25
    v_mfma_f32_16x16x32_bf16 v[220:223], a[184:187], v[32:35], v[220:223]
    s_cmp_lg_u32 s49, 0
    v_exp_f32 v27, v27
    v_mfma_f32_16x16x32_bf16 v[220:223], a[188:191], v[36:39], v[220:223]
    ds_read_b128 a[124:127], v1 offset:37824
    v_smfmac_f32_16x16x64_bf16 a[8:11], a[16:19], v[32:39], v11
    s_waitcnt vmcnt(8) lgkmcnt(12)
    s_barrier
    s_cbranch_scc1 L2_loop
    v_mfma_f32_16x16x32_bf16 v[16:19], a[64:67], v[64:67], v[48:51]
    v_exp_f32 v28, v28
    v_mfma_f32_16x16x32_bf16 v[16:19], a[68:71], v[68:71], v[16:19]
    v_cvt_pk_bf16_f32 v45, v26, v27
    v_mfma_f32_16x16x32_bf16 v[16:19], a[72:75], v[72:75], v[16:19]
    s_add_u32 m0, s44, 73728
    v_exp_f32 v29, v29
    v_mfma_f32_16x16x32_bf16 v[16:19], a[76:79], v[76:79], v[16:19]
    s_waitcnt lgkmcnt(8)
    s_mov_b32 s45, 0
    buffer_load_dwordx4 v7, s[28:31], s45 offen offset:0 lds
    v_mfma_f32_16x16x32_bf16 v[20:23], a[80:83], v[64:67], v[48:51]
    v_exp_f32 v30, v30
    v_mfma_f32_16x16x32_bf16 v[20:23], a[84:87], v[68:71], v[20:23]
    v_cvt_pk_bf16_f32 v46, v28, v29
    v_mfma_f32_16x16x32_bf16 v[20:23], a[88:91], v[72:75], v[20:23]
    s_add_u32 m0, s44, 73632
    v_exp_f32 v31, v31
    v_mfma_f32_16x16x32_bf16 v[20:23], a[92:95], v[76:79], v[20:23]
    s_waitcnt lgkmcnt(4)
    buffer_load_dwordx4 v7, s[28:31], s45 offen offset:1152 lds
    v_mfma_f32_16x16x32_bf16 v[24:27], a[96:99], v[64:67], v[48:51]
    v_exp_f32 v16, v16
    v_mfma_f32_16x16x32_bf16 v[24:27], a[100:103], v[68:71], v[24:27]
    v_cvt_pk_bf16_f32 v47, v30, v31
    v_mfma_f32_16x16x32_bf16 v[24:27], a[104:107], v[72:75], v[24:27]
    s_add_u32 m0, s44, 73536
    v_exp_f32 v17, v17
    v_mfma_f32_16x16x32_bf16 v[24:27], a[108:111], v[76:79], v[24:27]
    s_waitcnt lgkmcnt(0)
    buffer_load_dwordx4 v7, s[28:31], s45 offen offset:2304 lds
    v_mfma_f32_16x16x32_bf16 v[28:31], a[112:115], v[64:67], v[48:51]
    v_exp_f32 v18, v18
    v_mfma_f32_16x16x32_bf16 v[28:31], a[116:119], v[68:71], v[28:31]
    v_cvt_pk_bf16_f32 v32, v16, v17
    v_mfma_f32_16x16x32_bf16 v[28:31], a[120:123], v[72:75], v[28:31]
    s_add_u32 m0, s44, 73440
    v_exp_f32 v19, v19
    v_mfma_f32_16x16x32_bf16 v[28:31], a[124:127], v[76:79], v[28:31]
    buffer_load_dwordx4 v7, s[28:31], s45 offen offset:3456 lds
    v_mfma_f32_16x16x32_bf16 v[224:227], a[128:131], v[40:43], v[224:227]
    v_exp_f32 v20, v20
    v_mfma_f32_16x16x32_bf16 v[224:227], a[132:135], v[44:47], v[224:227]
    v_cvt_pk_bf16_f32 v33, v18, v19
    v_mfma_f32_16x16x32_bf16 v[228:231], a[136:139], v[40:43], v[228:231]
    s_add_u32 m0, s44, 90624
    v_exp_f32 v21, v21
    v_mfma_f32_16x16x32_bf16 v[228:231], a[140:143], v[44:47], v[228:231]
    s_mov_b32 s45, 147456
    buffer_load_dwordx4 v7, s[28:31], s45 offen offset:0 lds
    v_mfma_f32_16x16x32_bf16 v[232:235], a[144:147], v[40:43], v[232:235]
    v_exp_f32 v22, v22
    v_mfma_f32_16x16x32_bf16 v[232:235], a[148:151], v[44:47], v[232:235]
    v_cvt_pk_bf16_f32 v34, v20, v21
    v_mfma_f32_16x16x32_bf16 v[236:239], a[152:155], v[40:43], v[236:239]
    s_add_u32 m0, s44, 90528
    v_exp_f32 v23, v23
    v_mfma_f32_16x16x32_bf16 v[236:239], a[156:159], v[44:47], v[236:239]
    buffer_load_dwordx4 v7, s[28:31], s45 offen offset:1152 lds
    v_mfma_f32_16x16x32_bf16 v[240:243], a[160:163], v[40:43], v[240:243]
    v_exp_f32 v24, v24
    v_mfma_f32_16x16x32_bf16 v[240:243], a[164:167], v[44:47], v[240:243]
    v_cvt_pk_bf16_f32 v35, v22, v23
    v_mfma_f32_16x16x32_bf16 v[244:247], a[168:171], v[40:43], v[244:247]
    s_add_u32 m0, s44, 90432
    v_exp_f32 v25, v25
    v_mfma_f32_16x16x32_bf16 v[244:247], a[172:175], v[44:47], v[244:247]
    buffer_load_dwordx4 v7, s[28:31], s45 offen offset:2304 lds
    v_mfma_f32_16x16x32_bf16 v[248:251], a[176:179], v[40:43], v[248:251]
    v_exp_f32 v26, v26
    v_mfma_f32_16x16x32_bf16 v[248:251], a[180:183], v[44:47], v[248:251]
    v_cvt_pk_bf16_f32 v36, v24, v25
    v_mfma_f32_16x16x32_bf16 v[252:255], a[184:187], v[40:43], v[252:255]
    s_add_u32 m0, s44, 90336
    v_exp_f32 v27, v27
    v_mfma_f32_16x16x32_bf16 v[252:255], a[188:191], v[44:47], v[252:255]
    buffer_load_dwordx4 v7, s[28:31], s45 offen offset:3456 lds
    v_smfmac_f32_16x16x64_bf16 a[12:15], a[16:19], v[40:47], v11
    v_mfma_f32_16x16x32_bf16 v[16:19], a[64:67], v[80:83], v[52:55]
    v_exp_f32 v28, v28
    v_mfma_f32_16x16x32_bf16 v[16:19], a[68:71], v[84:87], v[16:19]
    v_cvt_pk_bf16_f32 v37, v26, v27
    v_mfma_f32_16x16x32_bf16 v[16:19], a[72:75], v[88:91], v[16:19]
    s_add_u32 m0, s44, 110592
    v_exp_f32 v29, v29
    v_mfma_f32_16x16x32_bf16 v[16:19], a[76:79], v[92:95], v[16:19]
    s_mov_b32 s45, 128
    buffer_load_dwordx4 v7, s[28:31], s45 offen offset:0 lds
    v_mfma_f32_16x16x32_bf16 v[20:23], a[80:83], v[80:83], v[52:55]
    v_exp_f32 v30, v30
    v_mfma_f32_16x16x32_bf16 v[20:23], a[84:87], v[84:87], v[20:23]
    v_cvt_pk_bf16_f32 v38, v28, v29
    v_mfma_f32_16x16x32_bf16 v[20:23], a[88:91], v[88:91], v[20:23]
    s_add_u32 m0, s44, 110496
    v_exp_f32 v31, v31
    v_mfma_f32_16x16x32_bf16 v[20:23], a[92:95], v[92:95], v[20:23]
    buffer_load_dwordx4 v7, s[28:31], s45 offen offset:1152 lds
    v_mfma_f32_16x16x32_bf16 v[24:27], a[96:99], v[80:83], v[52:55]
    v_exp_f32 v16, v16
    v_mfma_f32_16x16x32_bf16 v[24:27], a[100:103], v[84:87], v[24:27]
    v_cvt_pk_bf16_f32 v39, v30, v31
    v_mfma_f32_16x16x32_bf16 v[24:27], a[104:107], v[88:91], v[24:27]
    s_add_u32 m0, s44, 110400
    v_exp_f32 v17, v17
    v_mfma_f32_16x16x32_bf16 v[24:27], a[108:111], v[92:95], v[24:27]
    buffer_load_dwordx4 v7, s[28:31], s45 offen offset:2304 lds
    v_mfma_f32_16x16x32_bf16 v[28:31], a[112:115], v[80:83], v[52:55]
    v_exp_f32 v18, v18
    v_mfma_f32_16x16x32_bf16 v[28:31], a[116:119], v[84:87], v[28:31]
    v_cvt_pk_bf16_f32 v40, v16, v17
    v_mfma_f32_16x16x32_bf16 v[28:31], a[120:123], v[88:91], v[28:31]
    s_add_u32 m0, s44, 110304
    v_exp_f32 v19, v19
    v_mfma_f32_16x16x32_bf16 v[28:31], a[124:127], v[92:95], v[28:31]
    buffer_load_dwordx4 v7, s[28:31], s45 offen offset:3456 lds
    v_mfma_f32_16x16x32_bf16 v[128:131], a[192:195], v[32:35], v[128:131]
    v_exp_f32 v20, v20
    v_mfma_f32_16x16x32_bf16 v[128:131], a[196:199], v[36:39], v[128:131]
    v_cvt_pk_bf16_f32 v41, v18, v19
    v_mfma_f32_16x16x32_bf16 v[132:135], a[200:203], v[32:35], v[132:135]
    s_add_u32 m0, s44, 127488
    v_exp_f32 v21, v21
    v_mfma_f32_16x16x32_bf16 v[132:135], a[204:207], v[36:39], v[132:135]
    s_mov_b32 s45, 147584
    buffer_load_dwordx4 v7, s[28:31], s45 offen offset:0 lds
    v_mfma_f32_16x16x32_bf16 v[136:139], a[208:211], v[32:35], v[136:139]
    v_exp_f32 v22, v22
    v_mfma_f32_16x16x32_bf16 v[136:139], a[212:215], v[36:39], v[136:139]
    v_cvt_pk_bf16_f32 v42, v20, v21
    v_mfma_f32_16x16x32_bf16 v[140:143], a[216:219], v[32:35], v[140:143]
    s_add_u32 m0, s44, 127392
    v_exp_f32 v23, v23
    v_mfma_f32_16x16x32_bf16 v[140:143], a[220:223], v[36:39], v[140:143]
    buffer_load_dwordx4 v7, s[28:31], s45 offen offset:1152 lds
    v_mfma_f32_16x16x32_bf16 v[144:147], a[224:227], v[32:35], v[144:147]
    v_exp_f32 v24, v24
    v_mfma_f32_16x16x32_bf16 v[144:147], a[228:231], v[36:39], v[144:147]
    v_cvt_pk_bf16_f32 v43, v22, v23
    v_mfma_f32_16x16x32_bf16 v[148:151], a[232:235], v[32:35], v[148:151]
    s_add_u32 m0, s44, 127296
    v_exp_f32 v25, v25
    v_mfma_f32_16x16x32_bf16 v[148:151], a[236:239], v[36:39], v[148:151]
    buffer_load_dwordx4 v7, s[28:31], s45 offen offset:2304 lds
    v_mfma_f32_16x16x32_bf16 v[152:155], a[240:243], v[32:35], v[152:155]
    v_exp_f32 v26, v26
    v_mfma_f32_16x16x32_bf16 v[152:155], a[244:247], v[36:39], v[152:155]
    v_cvt_pk_bf16_f32 v44, v24, v25
    v_mfma_f32_16x16x32_bf16 v[156:159], a[248:251], v[32:35], v[156:159]
    s_add_u32 m0, s44, 127200
    v_exp_f32 v27, v27
    v_mfma_f32_16x16x32_bf16 v[156:159], a[252:255], v[36:39], v[156:159]
    buffer_load_dwordx4 v7, s[28:31], s45 offen offset:3456 lds
    v_smfmac_f32_16x16x64_bf16 a[0:3], a[16:19], v[32:39], v11
    v_mfma_f32_16x16x32_bf16 v[16:19], a[64:67], v[96:99], v[56:59]
    v_exp_f32 v28, v28
    v_mfma_f32_16x16x32_bf16 v[16:19], a[68:71], v[100:103], v[16:19]
    v_cvt_pk_bf16_f32 v45, v26, v27
    v_mfma_f32_16x16x32_bf16 v[16:19], a[72:75], v[104:107], v[16:19]
    s_add_u32 m0, s44, 0
    v_exp_f32 v29, v29
    v_mfma_f32_16x16x32_bf16 v[16:19], a[76:79], v[108:111], v[16:19]
    s_mov_b32 s45, 256
    buffer_load_dwordx4 v7, s[28:31], s45 offen offset:0 lds
    v_mfma_f32_16x16x32_bf16 v[20:23], a[80:83], v[96:99], v[56:59]
    v_exp_f32 v30, v30
    v_mfma_f32_16x16x32_bf16 v[20:23], a[84:87], v[100:103], v[20:23]
    v_cvt_pk_bf16_f32 v46, v28, v29
    v_mfma_f32_16x16x32_bf16 v[20:23], a[88:91], v[104:107], v[20:23]
    s_add_u32 m0, s44, -96
    v_exp_f32 v31, v31
    v_mfma_f32_16x16x32_bf16 v[20:23], a[92:95], v[108:111], v[20:23]
    buffer_load_dwordx4 v7, s[28:31], s45 offen offset:1152 lds
    v_mfma_f32_16x16x32_bf16 v[24:27], a[96:99], v[96:99], v[56:59]
    v_exp_f32 v16, v16
    v_mfma_f32_16x16x32_bf16 v[24:27], a[100:103], v[100:103], v[24:27]
    v_cvt_pk_bf16_f32 v47, v30, v31
    v_mfma_f32_16x16x32_bf16 v[24:27], a[104:107], v[104:107], v[24:27]
    s_add_u32 m0, s44, -192
    v_exp_f32 v17, v17
    v_mfma_f32_16x16x32_bf16 v[24:27], a[108:111], v[108:111], v[24:27]
    buffer_load_dwordx4 v7, s[28:31], s45 offen offset:2304 lds
    v_mfma_f32_16x16x32_bf16 v[28:31], a[112:115], v[96:99], v[56:59]
    v_exp_f32 v18, v18
    v_mfma_f32_16x16x32_bf16 v[28:31], a[116:119], v[100:103], v[28:31]
    v_cvt_pk_bf16_f32 v32, v16, v17
    v_mfma_f32_16x16x32_bf16 v[28:31], a[120:123], v[104:107], v[28:31]
    s_add_u32 m0, s44, -288
    v_exp_f32 v19, v19
    v_mfma_f32_16x16x32_bf16 v[28:31], a[124:127], v[108:111], v[28:31]
    buffer_load_dwordx4 v7, s[28:31], s45 offen offset:3456 lds
    v_mfma_f32_16x16x32_bf16 v[160:163], a[192:195], v[40:43], v[160:163]
    v_exp_f32 v20, v20
    v_mfma_f32_16x16x32_bf16 v[160:163], a[196:199], v[44:47], v[160:163]
    v_cvt_pk_bf16_f32 v33, v18, v19
    v_mfma_f32_16x16x32_bf16 v[164:167], a[200:203], v[40:43], v[164:167]
    s_add_u32 m0, s44, 16896
    v_exp_f32 v21, v21
    v_mfma_f32_16x16x32_bf16 v[164:167], a[204:207], v[44:47], v[164:167]
    s_mov_b32 s45, 147712
    buffer_load_dwordx4 v7, s[28:31], s45 offen offset:0 lds
    v_mfma_f32_16x16x32_bf16 v[168:171], a[208:211], v[40:43], v[168:171]
    v_exp_f32 v22, v22
    v_mfma_f32_16x16x32_bf16 v[168:171], a[212:215], v[44:47], v[168:171]
    v_cvt_pk_bf16_f32 v34, v20, v21
    v_mfma_f32_16x16x32_bf16 v[172:175], a[216:219], v[40:43], v[172:175]
    s_add_u32 m0, s44, 16800
    v_exp_f32 v23, v23
    v_mfma_f32_16x16x32_bf16 v[172:175], a[220:223], v[44:47], v[172:175]
    buffer_load_dwordx4 v7, s[28:31], s45 offen offset:1152 lds
    v_mfma_f32_16x16x32_bf16 v[176:179], a[224:227], v[40:43], v[176:179]
    v_exp_f32 v24, v24
    v_mfma_f32_16x16x32_bf16 v[176:179], a[228:231], v[44:47], v[176:179]
    v_cvt_pk_bf16_f32 v35, v22, v23
    v_mfma_f32_16x16x32_bf16 v[180:183], a[232:235], v[40:43], v[180:183]
    s_add_u32 m0, s44, 16704
    v_exp_f32 v25, v25
    v_mfma_f32_16x16x32_bf16 v[180:183], a[236:239], v[44:47], v[180:183]
    buffer_load_dwordx4 v7, s[28:31], s45 offen offset:2304 lds
    v_mfma_f32_16x16x32_bf16 v[184:187], a[240:243], v[40:43], v[184:187]
    v_exp_f32 v26, v26
    v_mfma_f32_16x16x32_bf16 v[184:187], a[244:247], v[44:47], v[184:187]
    v_cvt_pk_bf16_f32 v36, v24, v25
    v_mfma_f32_16x16x32_bf16 v[188:191], a[248:251], v[40:43], v[188:191]
    s_add_u32 m0, s44, 16608
    v_exp_f32 v27, v27
    v_mfma_f32_16x16x32_bf16 v[188:191], a[252:255], v[44:47], v[188:191]
    buffer_load_dwordx4 v7, s[28:31], s45 offen offset:3456 lds
    v_smfmac_f32_16x16x64_bf16 a[4:7], a[16:19], v[40:47], v11
    v_mfma_f32_16x16x32_bf16 v[16:19], a[64:67], v[112:115], v[60:63]
    v_exp_f32 v28, v28
    v_mfma_f32_16x16x32_bf16 v[16:19], a[68:71], v[116:119], v[16:19]
    v_cvt_pk_bf16_f32 v37, v26, v27
    v_mfma_f32_16x16x32_bf16 v[16:19], a[72:75], v[120:123], v[16:19]
    s_mov_b32 s54, 0
    v_exp_f32 v29, v29
    v_mfma_f32_16x16x32_bf16 v[16:19], a[76:79], v[124:127], v[16:19]
    buffer_load_dwordx4 a[128:131], v6, s[64:67], s54 offen
    v_mfma_f32_16x16x32_bf16 v[20:23], a[80:83], v[112:115], v[60:63]
    v_exp_f32 v30, v30
    v_mfma_f32_16x16x32_bf16 v[20:23], a[84:87], v[116:119], v[20:23]
    v_cvt_pk_bf16_f32 v38, v28, v29
    v_mfma_f32_16x16x32_bf16 v[20:23], a[88:91], v[120:123], v[20:23]
    s_mov_b32 s54, 147456
    v_exp_f32 v31, v31
    v_mfma_f32_16x16x32_bf16 v[20:23], a[92:95], v[124:127], v[20:23]
    buffer_load_dwordx4 a[132:135], v6, s[64:67], s54 offen
    v_mfma_f32_16x16x32_bf16 v[24:27], a[96:99], v[112:115], v[60:63]
    v_exp_f32 v16, v16
    v_mfma_f32_16x16x32_bf16 v[24:27], a[100:103], v[116:119], v[24:27]
    v_cvt_pk_bf16_f32 v39, v30, v31
    v_mfma_f32_16x16x32_bf16 v[24:27], a[104:107], v[120:123], v[24:27]
    s_mov_b32 s54, 294912
    v_exp_f32 v17, v17
    v_mfma_f32_16x16x32_bf16 v[24:27], a[108:111], v[124:127], v[24:27]
    buffer_load_dwordx4 a[136:139], v6, s[64:67], s54 offen
    v_mfma_f32_16x16x32_bf16 v[28:31], a[112:115], v[112:115], v[60:63]
    v_exp_f32 v18, v18
    v_mfma_f32_16x16x32_bf16 v[28:31], a[116:119], v[116:119], v[28:31]
    v_cvt_pk_bf16_f32 v40, v16, v17
    v_mfma_f32_16x16x32_bf16 v[28:31], a[120:123], v[120:123], v[28:31]
    s_mov_b32 s54, 442368
    v_exp_f32 v19, v19
    v_mfma_f32_16x16x32_bf16 v[28:31], a[124:127], v[124:127], v[28:31]
    buffer_load_dwordx4 a[140:143], v6, s[64:67], s54 offen
    v_mfma_f32_16x16x32_bf16 v[192:195], a[192:195], v[32:35], v[192:195]
    v_exp_f32 v20, v20
    v_mfma_f32_16x16x32_bf16 v[192:195], a[196:199], v[36:39], v[192:195]
    v_cvt_pk_bf16_f32 v41, v18, v19
    v_mfma_f32_16x16x32_bf16 v[196:199], a[200:203], v[32:35], v[196:199]
    s_mov_b32 s54, 589824
    v_exp_f32 v21, v21
    v_mfma_f32_16x16x32_bf16 v[196:199], a[204:207], v[36:39], v[196:199]
    buffer_load_dwordx4 a[144:147], v6, s[64:67], s54 offen
    v_mfma_f32_16x16x32_bf16 v[200:203], a[208:211], v[32:35], v[200:203]
    v_exp_f32 v22, v22
    v_mfma_f32_16x16x32_bf16 v[200:203], a[212:215], v[36:39], v[200:203]
    v_cvt_pk_bf16_f32 v42, v20, v21
    v_mfma_f32_16x16x32_bf16 v[204:207], a[216:219], v[32:35], v[204:207]
    s_mov_b32 s54, 737280
    v_exp_f32 v23, v23
    v_mfma_f32_16x16x32_bf16 v[204:207], a[220:223], v[36:39], v[204:207]
    buffer_load_dwordx4 a[148:151], v6, s[64:67], s54 offen
    v_mfma_f32_16x16x32_bf16 v[208:211], a[224:227], v[32:35], v[208:211]
    v_exp_f32 v24, v24
    v_mfma_f32_16x16x32_bf16 v[208:211], a[228:231], v[36:39], v[208:211]
    v_cvt_pk_bf16_f32 v43, v22, v23
    v_mfma_f32_16x16x32_bf16 v[212:215], a[232:235], v[32:35], v[212:215]
    s_mov_b32 s54, 884736
    v_exp_f32 v25, v25
    v_mfma_f32_16x16x32_bf16 v[212:215], a[236:239], v[36:39], v[212:215]
    buffer_load_dwordx4 a[152:155], v6, s[64:67], s54 offen
    v_mfma_f32_16x16x32_bf16 v[216:219], a[240:243], v[32:35], v[216:219]
    v_exp_f32 v26, v26
    v_mfma_f32_16x16x32_bf16 v[216:219], a[244:247], v[36:39], v[216:219]
    v_cvt_pk_bf16_f32 v44, v24, v25
    v_mfma_f32_16x16x32_bf16 v[220:223], a[248:251], v[32:35], v[220:223]
    s_mov_b32 s54, 1032192
    v_exp_f32 v27, v27
    v_mfma_f32_16x16x32_bf16 v[220:223], a[252:255], v[36:39], v[220:223]
    buffer_load_dwordx4 a[156:159], v6, s[64:67], s54 offen
    v_smfmac_f32_16x16x64_bf16 a[8:11], a[16:19], v[32:39], v11
    v_exp_f32 v28, v28
    s_nop 0
    v_cvt_pk_bf16_f32 v45, v26, v27
    v_exp_f32 v29, v29
    s_nop 0
    v_exp_f32 v30, v30
    s_nop 0
    v_cvt_pk_bf16_f32 v46, v28, v29
    v_exp_f32 v31, v31
    s_nop 0
    v_cvt_pk_bf16_f32 v47, v30, v31
    s_nop 1
    v_mfma_f32_16x16x32_bf16 v[224:227], a[192:195], v[40:43], v[224:227]
    s_mov_b32 s54, 1179648
    v_mfma_f32_16x16x32_bf16 v[224:227], a[196:199], v[44:47], v[224:227]
    buffer_load_dwordx4 a[160:163], v6, s[64:67], s54 offen
    v_mfma_f32_16x16x32_bf16 v[228:231], a[200:203], v[40:43], v[228:231]
    s_mov_b32 s54, 0
    v_mfma_f32_16x16x32_bf16 v[228:231], a[204:207], v[44:47], v[228:231]
    buffer_load_dwordx4 a[164:167], v6, s[68:71], s54 offen
    v_mfma_f32_16x16x32_bf16 v[232:235], a[208:211], v[40:43], v[232:235]
    s_mov_b32 s54, 147456
    v_mfma_f32_16x16x32_bf16 v[232:235], a[212:215], v[44:47], v[232:235]
    buffer_load_dwordx4 a[168:171], v6, s[68:71], s54 offen
    v_mfma_f32_16x16x32_bf16 v[236:239], a[216:219], v[40:43], v[236:239]
    s_mov_b32 s54, 294912
    v_mfma_f32_16x16x32_bf16 v[236:239], a[220:223], v[44:47], v[236:239]
    buffer_load_dwordx4 a[172:175], v6, s[68:71], s54 offen
    v_mfma_f32_16x16x32_bf16 v[240:243], a[224:227], v[40:43], v[240:243]
    s_mov_b32 s54, 442368
    v_mfma_f32_16x16x32_bf16 v[240:243], a[228:231], v[44:47], v[240:243]
    buffer_load_dwordx4 a[176:179], v6, s[68:71], s54 offen
    v_mfma_f32_16x16x32_bf16 v[244:247], a[232:235], v[40:43], v[244:247]
    s_mov_b32 s54, 589824
    v_mfma_f32_16x16x32_bf16 v[244:247], a[236:239], v[44:47], v[244:247]
    buffer_load_dwordx4 a[180:183], v6, s[68:71], s54 offen
    v_mfma_f32_16x16x32_bf16 v[248:251], a[240:243], v[40:43], v[248:251]
    s_mov_b32 s54, 737280
    v_mfma_f32_16x16x32_bf16 v[248:251], a[244:247], v[44:47], v[248:251]
    buffer_load_dwordx4 a[184:187], v6, s[68:71], s54 offen
    v_mfma_f32_16x16x32_bf16 v[252:255], a[248:251], v[40:43], v[252:255]
    s_mov_b32 s54, 884736
    v_mfma_f32_16x16x32_bf16 v[252:255], a[252:255], v[44:47], v[252:255]
    buffer_load_dwordx4 a[188:191], v6, s[68:71], s54 offen
    v_smfmac_f32_16x16x64_bf16 a[12:15], a[16:19], v[40:47], v11
    s_nop 7
    v_accvgpr_read_b32 v12, a0
    v_accvgpr_read_b32 v16, a1
    v_accvgpr_read_b32 v13, a4
    v_accvgpr_read_b32 v17, a5
    v_accvgpr_read_b32 v14, a8
    v_accvgpr_read_b32 v18, a9
    v_accvgpr_read_b32 v15, a12
    v_accvgpr_read_b32 v19, a13
    v_add_f32 v12, v12, v16
    v_add_f32 v13, v13, v17
    v_add_f32 v14, v14, v18
    v_add_f32 v15, v15, v19
    s_mov_b32 s3, 0x5d800000
    v_cmp_nlt_f32 s[56:57], v12, s3
    v_cmp_nlt_f32 s[58:59], v13, s3
    v_cmp_nlt_f32 s[60:61], v14, s3
    v_cmp_nlt_f32 s[62:63], v15, s3
    s_or_b64 s[56:57], s[56:57], s[58:59]
    s_or_b64 s[60:61], s[60:61], s[62:63]
    s_or_b64 s[56:57], s[56:57], s[60:61]
    s_cselect_b32 s3, 1, 0
    s_lshl_b32 s14, s51, 2
    s_add_u32 s14, s14, 12288
    v_mov_b32 v16, s3
    v_mov_b32 v17, s14
    v_mov_b32 v18, 12288
    ds_write_b32 v17, v16
    v_rcp_f32 v12, v12
    v_rcp_f32 v13, v13
    v_rcp_f32 v14, v14
    v_rcp_f32 v15, v15
    s_waitcnt vmcnt(32) lgkmcnt(0)
    s_barrier
    ds_read_b128 v[20:23], v18
    ds_read_b64_tr_b16 a[64:65], v4 offset:0
    ds_read_b64_tr_b16 a[66:67], v4 offset:128
    ds_read_b64_tr_b16 a[68:69], v4 offset:256
    ds_read_b64_tr_b16 a[70:71], v4 offset:384
    ds_read_b64_tr_b16 a[72:73], v4 offset:512
    ds_read_b64_tr_b16 a[74:75], v4 offset:640
    ds_read_b64_tr_b16 a[76:77], v4 offset:768
    ds_read_b64_tr_b16 a[78:79], v4 offset:896
    ds_read_b64_tr_b16 a[80:81], v4 offset:16896
    ds_read_b64_tr_b16 a[82:83], v4 offset:17024
    ds_read_b64_tr_b16 a[84:85], v4 offset:17152
    ds_read_b64_tr_b16 a[86:87], v4 offset:17280
    ds_read_b64_tr_b16 a[88:89], v4 offset:17408
    ds_read_b64_tr_b16 a[90:91], v4 offset:17536
    ds_read_b64_tr_b16 a[92:93], v4 offset:17664
    ds_read_b64_tr_b16 a[94:95], v4 offset:17792
    v_mul_f32 v128, v128, v12
    v_mul_f32 v129, v129, v12
    v_mul_f32 v130, v130, v12
    v_mul_f32 v131, v131, v12
    v_mul_f32 v132, v132, v12
    v_mul_f32 v133, v133, v12
    v_mul_f32 v134, v134, v12
    v_mul_f32 v135, v135, v12
    v_cvt_pk_bf16_f32 v128, v128, v129
    v_cvt_pk_bf16_f32 v129, v130, v131
    v_cvt_pk_bf16_f32 v130, v132, v133
    v_cvt_pk_bf16_f32 v131, v134, v135
    s_mov_b32 s54, 1032192
    buffer_load_dwordx4 a[192:195], v6, s[68:71], s54 offen
    v_mul_f32 v160, v160, v13
    v_mul_f32 v161, v161, v13
    v_mul_f32 v162, v162, v13
    v_mul_f32 v163, v163, v13
    v_mul_f32 v164, v164, v13
    v_mul_f32 v165, v165, v13
    v_mul_f32 v166, v166, v13
    v_mul_f32 v167, v167, v13
    v_cvt_pk_bf16_f32 v160, v160, v161
    v_cvt_pk_bf16_f32 v161, v162, v163
    v_cvt_pk_bf16_f32 v162, v164, v165
    v_cvt_pk_bf16_f32 v163, v166, v167
    s_mov_b32 s54, 1179648
    buffer_load_dwordx4 a[196:199], v6, s[68:71], s54 offen
    v_mul_f32 v136, v136, v12
    v_mul_f32 v137, v137, v12
    v_mul_f32 v138, v138, v12
    v_mul_f32 v139, v139, v12
    v_mul_f32 v140, v140, v12
    v_mul_f32 v141, v141, v12
    v_mul_f32 v142, v142, v12
    v_mul_f32 v143, v143, v12
    v_cvt_pk_bf16_f32 v136, v136, v137
    v_cvt_pk_bf16_f32 v137, v138, v139
    v_cvt_pk_bf16_f32 v138, v140, v141
    v_cvt_pk_bf16_f32 v139, v142, v143
    s_add_u32 s54, s55, 0
    buffer_load_dwordx4 a[200:203], v8, s[72:75], s54 offen
    v_mul_f32 v168, v168, v13
    v_mul_f32 v169, v169, v13
    v_mul_f32 v170, v170, v13
    v_mul_f32 v171, v171, v13
    v_mul_f32 v172, v172, v13
    v_mul_f32 v173, v173, v13
    v_mul_f32 v174, v174, v13
    v_mul_f32 v175, v175, v13
    v_cvt_pk_bf16_f32 v168, v168, v169
    v_cvt_pk_bf16_f32 v169, v170, v171
    v_cvt_pk_bf16_f32 v170, v172, v173
    v_cvt_pk_bf16_f32 v171, v174, v175
    s_add_u32 s54, s55, 1024
    buffer_load_dwordx4 a[204:207], v8, s[72:75], s54 offen
    v_mul_f32 v144, v144, v12
    v_mul_f32 v145, v145, v12
    v_mul_f32 v146, v146, v12
    v_mul_f32 v147, v147, v12
    v_mul_f32 v148, v148, v12
    v_mul_f32 v149, v149, v12
    v_mul_f32 v150, v150, v12
    v_mul_f32 v151, v151, v12
    v_cvt_pk_bf16_f32 v144, v144, v145
    v_cvt_pk_bf16_f32 v145, v146, v147
    v_cvt_pk_bf16_f32 v146, v148, v149
    v_cvt_pk_bf16_f32 v147, v150, v151
    s_add_u32 s54, s55, 2048
    buffer_load_dwordx4 a[208:211], v8, s[72:75], s54 offen
    v_mul_f32 v176, v176, v13
    v_mul_f32 v177, v177, v13
    v_mul_f32 v178, v178, v13
    v_mul_f32 v179, v179, v13
    v_mul_f32 v180, v180, v13
    v_mul_f32 v181, v181, v13
    v_mul_f32 v182, v182, v13
    v_mul_f32 v183, v183, v13
    v_cvt_pk_bf16_f32 v176, v176, v177
    v_cvt_pk_bf16_f32 v177, v178, v179
    v_cvt_pk_bf16_f32 v178, v180, v181
    v_cvt_pk_bf16_f32 v179, v182, v183
    s_add_u32 s54, s55, 3072
    buffer_load_dwordx4 a[212:215], v8, s[72:75], s54 offen
    v_mul_f32 v152, v152, v12
    v_mul_f32 v153, v153, v12
    v_mul_f32 v154, v154, v12
    v_mul_f32 v155, v155, v12
    v_mul_f32 v156, v156, v12
    v_mul_f32 v157, v157, v12
    v_mul_f32 v158, v158, v12
    v_mul_f32 v159, v159, v12
    v_cvt_pk_bf16_f32 v152, v152, v153
    v_cvt_pk_bf16_f32 v153, v154, v155
    v_cvt_pk_bf16_f32 v154, v156, v157
    v_cvt_pk_bf16_f32 v155, v158, v159
    s_add_u32 s54, s55, 4096
    buffer_load_dwordx4 a[216:219], v8, s[72:75], s54 offen
    v_mul_f32 v184, v184, v13
    v_mul_f32 v185, v185, v13
    v_mul_f32 v186, v186, v13
    v_mul_f32 v187, v187, v13
    v_mul_f32 v188, v188, v13
    v_mul_f32 v189, v189, v13
    v_mul_f32 v190, v190, v13
    v_mul_f32 v191, v191, v13
    v_cvt_pk_bf16_f32 v184, v184, v185
    v_cvt_pk_bf16_f32 v185, v186, v187
    v_cvt_pk_bf16_f32 v186, v188, v189
    v_cvt_pk_bf16_f32 v187, v190, v191
    s_add_u32 s54, s55, 5120
    buffer_load_dwordx4 a[220:223], v8, s[72:75], s54 offen
    v_mul_f32 v192, v192, v14
    v_mul_f32 v193, v193, v14
    v_mul_f32 v194, v194, v14
    v_mul_f32 v195, v195, v14
    v_mul_f32 v196, v196, v14
    v_mul_f32 v197, v197, v14
    v_mul_f32 v198, v198, v14
    v_mul_f32 v199, v199, v14
    v_cvt_pk_bf16_f32 v192, v192, v193
    v_cvt_pk_bf16_f32 v193, v194, v195
    v_cvt_pk_bf16_f32 v194, v196, v197
    v_cvt_pk_bf16_f32 v195, v198, v199
    s_add_u32 s54, s55, 6144
    buffer_load_dwordx4 a[224:227], v8, s[72:75], s54 offen
    v_mul_f32 v224, v224, v15
    v_mul_f32 v225, v225, v15
    v_mul_f32 v226, v226, v15
    v_mul_f32 v227, v227, v15
    v_mul_f32 v228, v228, v15
    v_mul_f32 v229, v229, v15
    v_mul_f32 v230, v230, v15
    v_mul_f32 v231, v231, v15
    v_cvt_pk_bf16_f32 v224, v224, v225
    v_cvt_pk_bf16_f32 v225, v226, v227
    v_cvt_pk_bf16_f32 v226, v228, v229
    v_cvt_pk_bf16_f32 v227, v230, v231
    s_add_u32 s54, s55, 7168
    buffer_load_dwordx4 a[228:231], v8, s[72:75], s54 offen
    v_mul_f32 v200, v200, v14
    v_mul_f32 v201, v201, v14
    v_mul_f32 v202, v202, v14
    v_mul_f32 v203, v203, v14
    v_mul_f32 v204, v204, v14
    v_mul_f32 v205, v205, v14
    v_mul_f32 v206, v206, v14
    v_mul_f32 v207, v207, v14
    v_cvt_pk_bf16_f32 v200, v200, v201
    v_cvt_pk_bf16_f32 v201, v202, v203
    v_cvt_pk_bf16_f32 v202, v204, v205
    v_cvt_pk_bf16_f32 v203, v206, v207
    s_add_u32 s54, s55, 8192
    buffer_load_dwordx4 a[232:235], v8, s[72:75], s54 offen
    v_mul_f32 v232, v232, v15
    v_mul_f32 v233, v233, v15
    v_mul_f32 v234, v234, v15
    v_mul_f32 v235, v235, v15
    v_mul_f32 v236, v236, v15
    v_mul_f32 v237, v237, v15
    v_mul_f32 v238, v238, v15
    v_mul_f32 v239, v239, v15
    v_cvt_pk_bf16_f32 v232, v232, v233
    v_cvt_pk_bf16_f32 v233, v234, v235
    v_cvt_pk_bf16_f32 v234, v236, v237
    v_cvt_pk_bf16_f32 v235, v238, v239
    v_mul_f32 v208, v208, v14
    v_mul_f32 v209, v209, v14
    v_mul_f32 v210, v210, v14
    v_mul_f32 v211, v211, v14
    v_mul_f32 v212, v212, v14
    v_mul_f32 v213, v213, v14
    v_mul_f32 v214, v214, v14
    v_mul_f32 v215, v215, v14
    v_cvt_pk_bf16_f32 v208, v208, v209
    v_cvt_pk_bf16_f32 v209, v210, v211
    v_cvt_pk_bf16_f32 v210, v212, v213
    v_cvt_pk_bf16_f32 v211, v214, v215
    v_mul_f32 v240, v240, v15
    v_mul_f32 v241, v241, v15
    v_mul_f32 v242, v242, v15
    v_mul_f32 v243, v243, v15
    v_mul_f32 v244, v244, v15
    v_mul_f32 v245, v245, v15
    v_mul_f32 v246, v246, v15
    v_mul_f32 v247, v247, v15
    v_cvt_pk_bf16_f32 v240, v240, v241
    v_cvt_pk_bf16_f32 v241, v242, v243
    v_cvt_pk_bf16_f32 v242, v244, v245
    v_cvt_pk_bf16_f32 v243, v246, v247
    v_mul_f32 v216, v216, v14
    v_mul_f32 v217, v217, v14
    v_mul_f32 v218, v218, v14
    v_mul_f32 v219, v219, v14
    v_mul_f32 v220, v220, v14
    v_mul_f32 v221, v221, v14
    v_mul_f32 v222, v222, v14
    v_mul_f32 v223, v223, v14
    v_cvt_pk_bf16_f32 v216, v216, v217
    v_cvt_pk_bf16_f32 v217, v218, v219
    v_cvt_pk_bf16_f32 v218, v220, v221
    v_cvt_pk_bf16_f32 v219, v222, v223
    v_mul_f32 v248, v248, v15
    v_mul_f32 v249, v249, v15
    v_mul_f32 v250, v250, v15
    v_mul_f32 v251, v251, v15
    v_mul_f32 v252, v252, v15
    v_mul_f32 v253, v253, v15
    v_mul_f32 v254, v254, v15
    v_mul_f32 v255, v255, v15
    v_cvt_pk_bf16_f32 v248, v248, v249
    v_cvt_pk_bf16_f32 v249, v250, v251
    v_cvt_pk_bf16_f32 v250, v252, v253
    v_cvt_pk_bf16_f32 v251, v254, v255
    s_waitcnt lgkmcnt(12)
    v_or3_b32 v20, v20, v21, v22
    v_or_b32 v20, v20, v23
    s_nop 0
    v_readfirstlane_b32 s3, v20
    s_nop 0
    s_andn2_b32 s3, s3, s50
    s_cbranch_scc1 L2_fallback
    s_mul_i32 s3, s51, 288
    v_and_b32 v14, 7, v0
    v_mul_u32_u24 v14, 1152, v14
    v_add_u32 v14, s3, v14
    v_lshrrev_b32 v15, 3, v0
    v_lshl_add_u32 v1, v15, 4, v14
    v_and_b32 v15, 1, v15
    v_lshl_add_u32 v2, v15, 4, v14
    v_add_u32 v2, 256, v2
    v_mfma_f32_16x16x32_bf16 v[16:19], a[64:67], v[128:131], 0
    ds_read_b64_tr_b16 a[96:97], v4 offset:32
    ds_read_b64_tr_b16 a[98:99], v4 offset:160
    v_mfma_f32_16x16x32_bf16 v[16:19], a[68:71], v[136:139], v[16:19]
    s_waitcnt lgkmcnt(10)
    ds_read_b64_tr_b16 a[100:101], v4 offset:288
    ds_read_b64_tr_b16 a[102:103], v4 offset:416
    v_mfma_f32_16x16x32_bf16 v[16:19], a[72:75], v[144:147], v[16:19]
    s_add_u32 m0, s44, 36864
    ds_read_b64_tr_b16 a[104:105], v4 offset:544
    ds_read_b64_tr_b16 a[106:107], v4 offset:672
    v_mfma_f32_16x16x32_bf16 v[16:19], a[76:79], v[152:155], v[16:19]
    s_mov_b32 s45, 384
    s_waitcnt lgkmcnt(10)
    buffer_load_dwordx4 v7, s[28:31], s45 offen offset:0 lds
    v_mfma_f32_16x16x32_bf16 v[16:19], a[80:83], v[192:195], v[16:19]
    s_add_u32 m0, s44, 36768
    ds_read_b64_tr_b16 a[108:109], v4 offset:800
    ds_read_b64_tr_b16 a[110:111], v4 offset:928
    v_mfma_f32_16x16x32_bf16 v[16:19], a[84:87], v[200:203], v[16:19]
    s_waitcnt lgkmcnt(8)
    buffer_load_dwordx4 v7, s[28:31], s45 offen offset:1152 lds
    v_mfma_f32_16x16x32_bf16 v[16:19], a[88:91], v[208:211], v[16:19]
    s_add_u32 m0, s44, 36672
    ds_read_b64_tr_b16 a[112:113], v4 offset:16928
    ds_read_b64_tr_b16 a[114:115], v4 offset:17056
    v_mfma_f32_16x16x32_bf16 v[16:19], a[92:95], v[216:219], v[16:19]
    buffer_load_dwordx4 v7, s[28:31], s45 offen offset:2304 lds
    v_mfma_f32_16x16x32_bf16 v[20:23], a[64:67], v[160:163], 0
    s_add_u32 m0, s44, 36576
    ds_read_b64_tr_b16 a[116:117], v4 offset:17184
    ds_read_b64_tr_b16 a[118:119], v4 offset:17312
    v_mfma_f32_16x16x32_bf16 v[20:23], a[68:71], v[168:171], v[20:23]
    buffer_load_dwordx4 v7, s[28:31], s45 offen offset:3456 lds
    v_mfma_f32_16x16x32_bf16 v[20:23], a[72:75], v[176:179], v[20:23]
    s_add_u32 m0, s44, 53760
    ds_read_b64_tr_b16 a[120:121], v4 offset:17440
    ds_read_b64_tr_b16 a[122:123], v4 offset:17568
    v_mfma_f32_16x16x32_bf16 v[20:23], a[76:79], v[184:187], v[20:23]
    s_mov_b32 s45, 147840
    buffer_load_dwordx4 v7, s[28:31], s45 offen offset:0 lds
    v_mfma_f32_16x16x32_bf16 v[20:23], a[80:83], v[224:227], v[20:23]
    s_add_u32 m0, s44, 53664
    ds_read_b64_tr_b16 a[124:125], v4 offset:17696
    v_mfma_f32_16x16x32_bf16 v[20:23], a[84:87], v[232:235], v[20:23]
    buffer_load_dwordx4 v7, s[28:31], s45 offen offset:1152 lds
    v_mfma_f32_16x16x32_bf16 v[20:23], a[88:91], v[240:243], v[20:23]
    s_add_u32 m0, s44, 53568
    ds_read_b64_tr_b16 a[126:127], v4 offset:17824
    v_mfma_f32_16x16x32_bf16 v[20:23], a[92:95], v[248:251], v[20:23]
    s_waitcnt lgkmcnt(12)
    buffer_load_dwordx4 v7, s[28:31], s45 offen offset:2304 lds
    v_mfma_f32_16x16x32_bf16 v[24:27], a[96:99], v[128:131], 0
    s_add_u32 m0, s44, 53472
    ds_read_b64_tr_b16 a[64:65], v4 offset:64
    ds_read_b64_tr_b16 a[66:67], v4 offset:192
    v_mfma_f32_16x16x32_bf16 v[24:27], a[100:103], v[136:139], v[24:27]
    s_waitcnt lgkmcnt(10)
    buffer_load_dwordx4 v7, s[28:31], s45 offen offset:3456 lds
    v_mfma_f32_16x16x32_bf16 v[24:27], a[104:107], v[144:147], v[24:27]
    ds_read_b64_tr_b16 a[68:69], v4 offset:320
    ds_read_b64_tr_b16 a[70:71], v4 offset:448
    v_mfma_f32_16x16x32_bf16 v[24:27], a[108:111], v[152:155], v[24:27]
    s_waitcnt lgkmcnt(8)
    buffer_load_dwordx4 v[64:67], v1, s[76:79], 0 offen offset:0
    v_mfma_f32_16x16x32_bf16 v[24:27], a[112:115], v[192:195], v[24:27]
    ds_read_b64_tr_b16 a[72:73], v4 offset:576
    ds_read_b64_tr_b16 a[74:75], v4 offset:704
    v_mfma_f32_16x16x32_bf16 v[24:27], a[116:119], v[200:203], v[24:27]
    s_waitcnt lgkmcnt(6)
    buffer_load_dwordx4 v[68:71], v1, s[76:79], 0 offen offset:128
    v_mfma_f32_16x16x32_bf16 v[24:27], a[120:123], v[208:211], v[24:27]
    ds_read_b64_tr_b16 a[76:77], v4 offset:832
    ds_read_b64_tr_b16 a[78:79], v4 offset:960
    v_mfma_f32_16x16x32_bf16 v[24:27], a[124:127], v[216:219], v[24:27]
    buffer_load_dwordx4 v[72:75], v2, s[76:79], 0 offen offset:0
    v_mfma_f32_16x16x32_bf16 v[28:31], a[96:99], v[160:163], 0
    ds_read_b64_tr_b16 a[80:81], v4 offset:16960
    v_mfma_f32_16x16x32_bf16 v[28:31], a[100:103], v[168:171], v[28:31]
    ds_read_b64_tr_b16 a[82:83], v4 offset:17088
    v_mfma_f32_16x16x32_bf16 v[28:31], a[104:107], v[176:179], v[28:31]
    ds_read_b64_tr_b16 a[84:85], v4 offset:17216
    v_mfma_f32_16x16x32_bf16 v[28:31], a[108:111], v[184:187], v[28:31]
    ds_read_b64_tr_b16 a[86:87], v4 offset:17344
    v_mfma_f32_16x16x32_bf16 v[28:31], a[112:115], v[224:227], v[28:31]
    ds_read_b64_tr_b16 a[88:89], v4 offset:17472
    v_mfma_f32_16x16x32_bf16 v[28:31], a[116:119], v[232:235], v[28:31]
    ds_read_b64_tr_b16 a[90:91], v4 offset:17600
    v_mfma_f32_16x16x32_bf16 v[28:31], a[120:123], v[240:243], v[28:31]
    ds_read_b64_tr_b16 a[92:93], v4 offset:17728
    v_mfma_f32_16x16x32_bf16 v[28:31], a[124:127], v[248:251], v[28:31]
    s_waitcnt lgkmcnt(11)
    ds_read_b64_tr_b16 a[94:95], v4 offset:17856
    v_mfma_f32_16x16x32_bf16 v[32:35], a[64:67], v[128:131], 0
    ds_read_b64_tr_b16 a[96:97], v4 offset:96
    v_cvt_pk_bf16_f32 v48, v16, v17
    v_mfma_f32_16x16x32_bf16 v[32:35], a[68:71], v[136:139], v[32:35]
    s_waitcnt lgkmcnt(9)
    ds_read_b64_tr_b16 a[98:99], v4 offset:224
    v_cvt_pk_bf16_f32 v49, v18, v19
    v_mfma_f32_16x16x32_bf16 v[32:35], a[72:75], v[144:147], v[32:35]
    ds_read_b64_tr_b16 a[100:101], v4 offset:352
    v_cvt_pk_bf16_f32 v50, v24, v25
    v_mfma_f32_16x16x32_bf16 v[32:35], a[76:79], v[152:155], v[32:35]
    s_waitcnt lgkmcnt(7)
    ds_read_b64_tr_b16 a[102:103], v4 offset:480
    v_cvt_pk_bf16_f32 v51, v26, v27
    v_mfma_f32_16x16x32_bf16 v[32:35], a[80:83], v[192:195], v[32:35]
    s_mov_b32 s54, 0
    ds_read_b64_tr_b16 a[104:105], v4 offset:608
    ds_read_b64_tr_b16 a[106:107], v4 offset:736
    v_mfma_f32_16x16x32_bf16 v[32:35], a[84:87], v[200:203], v[32:35]
    s_waitcnt lgkmcnt(6)
    v_permlane32_swap_b32 v48, v50
    v_mfma_f32_16x16x32_bf16 v[32:35], a[88:91], v[208:211], v[32:35]
    v_permlane32_swap_b32 v49, v51
    v_mfma_f32_16x16x32_bf16 v[32:35], a[92:95], v[216:219], v[32:35]
    ds_read_b64_tr_b16 a[108:109], v4 offset:864
    ds_read_b64_tr_b16 a[110:111], v4 offset:992
    buffer_store_dwordx4 v[48:51], v10, s[40:43], s54 offen offset:0 sc1
    v_mfma_f32_16x16x32_bf16 v[36:39], a[64:67], v[160:163], 0
    ds_read_b64_tr_b16 a[112:113], v4 offset:16992
    v_cvt_pk_bf16_f32 v52, v20, v21
    v_mfma_f32_16x16x32_bf16 v[36:39], a[68:71], v[168:171], v[36:39]
    ds_read_b64_tr_b16 a[114:115], v4 offset:17120
    v_cvt_pk_bf16_f32 v53, v22, v23
    v_mfma_f32_16x16x32_bf16 v[36:39], a[72:75], v[176:179], v[36:39]
    ds_read_b64_tr_b16 a[116:117], v4 offset:17248
    v_cvt_pk_bf16_f32 v54, v28, v29
    v_mfma_f32_16x16x32_bf16 v[36:39], a[76:79], v[184:187], v[36:39]
    ds_read_b64_tr_b16 a[118:119], v4 offset:17376
    v_cvt_pk_bf16_f32 v55, v30, v31
    v_mfma_f32_16x16x32_bf16 v[36:39], a[80:83], v[224:227], v[36:39]
    s_mov_b32 s54, 294912
    ds_read_b64_tr_b16 a[120:121], v4 offset:17504
    ds_read_b64_tr_b16 a[122:123], v4 offset:17632
    v_mfma_f32_16x16x32_bf16 v[36:39], a[84:87], v[232:235], v[36:39]
    v_permlane32_swap_b32 v52, v54
    v_mfma_f32_16x16x32_bf16 v[36:39], a[88:91], v[240:243], v[36:39]
    v_permlane32_swap_b32 v53, v55
    v_mfma_f32_16x16x32_bf16 v[36:39], a[92:95], v[248:251], v[36:39]
    s_waitcnt vmcnt(47)
    s_barrier
    s_waitcnt lgkmcnt(10)
    ds_read_b64_tr_b16 a[124:125], v4 offset:17760
    ds_read_b64_tr_b16 a[126:127], v4 offset:17888
    buffer_store_dwordx4 v[52:55], v10, s[40:43], s54 offen offset:0 sc1
    v_mfma_f32_16x16x32_bf16 v[40:43], a[96:99], v[128:131], 0
    ds_read_b64_tr_b16 a[64:65], v4 offset:36864
    v_mfma_f32_16x16x32_bf16 v[40:43], a[100:103], v[136:139], v[40:43]
    s_waitcnt lgkmcnt(9)
    ds_read_b64_tr_b16 a[66:67], v4 offset:36992
    v_mfma_f32_16x16x32_bf16 v[40:43], a[104:107], v[144:147], v[40:43]
    ds_read_b64_tr_b16 a[68:69], v4 offset:37120
    v_mfma_f32_16x16x32_bf16 v[40:43], a[108:111], v[152:155], v[40:43]
    s_waitcnt lgkmcnt(7)
    ds_read_b64_tr_b16 a[70:71], v4 offset:37248
    v_mfma_f32_16x16x32_bf16 v[40:43], a[112:115], v[192:195], v[40:43]
    ds_read_b64_tr_b16 a[72:73], v4 offset:37376
    v_mfma_f32_16x16x32_bf16 v[40:43], a[116:119], v[200:203], v[40:43]
    s_waitcnt lgkmcnt(5)
    ds_read_b64_tr_b16 a[74:75], v4 offset:37504
    v_mfma_f32_16x16x32_bf16 v[40:43], a[120:123], v[208:211], v[40:43]
    ds_read_b64_tr_b16 a[76:77], v4 offset:37632
    v_mfma_f32_16x16x32_bf16 v[40:43], a[124:127], v[216:219], v[40:43]
    ds_read_b64_tr_b16 a[78:79], v4 offset:37760
    v_mfma_f32_16x16x32_bf16 v[44:47], a[96:99], v[160:163], 0
    ds_read_b64_tr_b16 a[80:81], v4 offset:53760
    v_mfma_f32_16x16x32_bf16 v[44:47], a[100:103], v[168:171], v[44:47]
    ds_read_b64_tr_b16 a[82:83], v4 offset:53888
    v_mfma_f32_16x16x32_bf16 v[44:47], a[104:107], v[176:179], v[44:47]
    ds_read_b64_tr_b16 a[84:85], v4 offset:54016
    v_mfma_f32_16x16x32_bf16 v[44:47], a[108:111], v[184:187], v[44:47]
    ds_read_b64_tr_b16 a[86:87], v4 offset:54144
    v_mfma_f32_16x16x32_bf16 v[44:47], a[112:115], v[224:227], v[44:47]
    ds_read_b64_tr_b16 a[88:89], v4 offset:54272
    v_mfma_f32_16x16x32_bf16 v[44:47], a[116:119], v[232:235], v[44:47]
    ds_read_b64_tr_b16 a[90:91], v4 offset:54400
    v_mfma_f32_16x16x32_bf16 v[44:47], a[120:123], v[240:243], v[44:47]
    ds_read_b64_tr_b16 a[92:93], v4 offset:54528
    v_mfma_f32_16x16x32_bf16 v[44:47], a[124:127], v[248:251], v[44:47]
    s_waitcnt lgkmcnt(11)
    ds_read_b64_tr_b16 a[94:95], v4 offset:54656
    v_mfma_f32_16x16x32_bf16 v[16:19], a[64:67], v[128:131], 0
    ds_read_b64_tr_b16 a[96:97], v4 offset:36896
    v_cvt_pk_bf16_f32 v48, v32, v33
    v_mfma_f32_16x16x32_bf16 v[16:19], a[68:71], v[136:139], v[16:19]
    s_waitcnt lgkmcnt(9)
    ds_read_b64_tr_b16 a[98:99], v4 offset:37024
    v_cvt_pk_bf16_f32 v49, v34, v35
    v_mfma_f32_16x16x32_bf16 v[16:19], a[72:75], v[144:147], v[16:19]
    ds_read_b64_tr_b16 a[100:101], v4 offset:37152
    v_cvt_pk_bf16_f32 v50, v40, v41
    v_mfma_f32_16x16x32_bf16 v[16:19], a[76:79], v[152:155], v[16:19]
    s_waitcnt lgkmcnt(7)
    ds_read_b64_tr_b16 a[102:103], v4 offset:37280
    v_cvt_pk_bf16_f32 v51, v42, v43
    v_mfma_f32_16x16x32_bf16 v[16:19], a[80:83], v[192:195], v[16:19]
    s_mov_b32 s54, 0
    ds_read_b64_tr_b16 a[104:105], v4 offset:37408
    ds_read_b64_tr_b16 a[106:107], v4 offset:37536
    v_mfma_f32_16x16x32_bf16 v[16:19], a[84:87], v[200:203], v[16:19]
    s_waitcnt lgkmcnt(6)
    v_permlane32_swap_b32 v48, v50
    v_mfma_f32_16x16x32_bf16 v[16:19], a[88:91], v[208:211], v[16:19]
    v_permlane32_swap_b32 v49, v51
    v_mfma_f32_16x16x32_bf16 v[16:19], a[92:95], v[216:219], v[16:19]
    ds_read_b64_tr_b16 a[108:109], v4 offset:37664
    ds_read_b64_tr_b16 a[110:111], v4 offset:37792
    buffer_store_dwordx4 v[48:51], v10, s[40:43], s54 offen offset:512 sc1
    v_mfma_f32_16x16x32_bf16 v[20:23], a[64:67], v[160:163], 0
    ds_read_b64_tr_b16 a[112:113], v4 offset:53792
    v_cvt_pk_bf16_f32 v52, v36, v37
    v_mfma_f32_16x16x32_bf16 v[20:23], a[68:71], v[168:171], v[20:23]
    ds_read_b64_tr_b16 a[114:115], v4 offset:53920
    v_cvt_pk_bf16_f32 v53, v38, v39
    v_mfma_f32_16x16x32_bf16 v[20:23], a[72:75], v[176:179], v[20:23]
    ds_read_b64_tr_b16 a[116:117], v4 offset:54048
    v_cvt_pk_bf16_f32 v54, v44, v45
    v_mfma_f32_16x16x32_bf16 v[20:23], a[76:79], v[184:187], v[20:23]
    ds_read_b64_tr_b16 a[118:119], v4 offset:54176
    v_cvt_pk_bf16_f32 v55, v46, v47
    v_mfma_f32_16x16x32_bf16 v[20:23], a[80:83], v[224:227], v[20:23]
    s_mov_b32 s54, 294912
    ds_read_b64_tr_b16 a[120:121], v4 offset:54304
    ds_read_b64_tr_b16 a[122:123], v4 offset:54432
    v_mfma_f32_16x16x32_bf16 v[20:23], a[84:87], v[232:235], v[20:23]
    v_permlane32_swap_b32 v52, v54
    v_mfma_f32_16x16x32_bf16 v[20:23], a[88:91], v[240:243], v[20:23]
    v_permlane32_swap_b32 v53, v55
    v_mfma_f32_16x16x32_bf16 v[20:23], a[92:95], v[248:251], v[20:23]
    s_waitcnt lgkmcnt(10)
    ds_read_b64_tr_b16 a[124:125], v4 offset:54560
    ds_read_b64_tr_b16 a[126:127], v4 offset:54688
    buffer_store_dwordx4 v[52:55], v10, s[40:43], s54 offen offset:512 sc1
    v_mfma_f32_16x16x32_bf16 v[24:27], a[96:99], v[128:131], 0
    ds_read_b64_tr_b16 a[64:65], v4 offset:36928
    v_mfma_f32_16x16x32_bf16 v[24:27], a[100:103], v[136:139], v[24:27]
    s_waitcnt lgkmcnt(9)
    ds_read_b64_tr_b16 a[66:67], v4 offset:37056
    v_mfma_f32_16x16x32_bf16 v[24:27], a[104:107], v[144:147], v[24:27]
    ds_read_b64_tr_b16 a[68:69], v4 offset:37184
    v_mfma_f32_16x16x32_bf16 v[24:27], a[108:111], v[152:155], v[24:27]
    s_waitcnt lgkmcnt(7)
    ds_read_b64_tr_b16 a[70:71], v4 offset:37312
    v_mfma_f32_16x16x32_bf16 v[24:27], a[112:115], v[192:195], v[24:27]
    ds_read_b64_tr_b16 a[72:73], v4 offset:37440
    v_mfma_f32_16x16x32_bf16 v[24:27], a[116:119], v[200:203], v[24:27]
    s_waitcnt lgkmcnt(5)
    ds_read_b64_tr_b16 a[74:75], v4 offset:37568
    v_mfma_f32_16x16x32_bf16 v[24:27], a[120:123], v[208:211], v[24:27]
    ds_read_b64_tr_b16 a[76:77], v4 offset:37696
    v_mfma_f32_16x16x32_bf16 v[24:27], a[124:127], v[216:219], v[24:27]
    ds_read_b64_tr_b16 a[78:79], v4 offset:37824
    v_mfma_f32_16x16x32_bf16 v[28:31], a[96:99], v[160:163], 0
    ds_read_b64_tr_b16 a[80:81], v4 offset:53824
    v_mfma_f32_16x16x32_bf16 v[28:31], a[100:103], v[168:171], v[28:31]
    ds_read_b64_tr_b16 a[82:83], v4 offset:53952
    v_mfma_f32_16x16x32_bf16 v[28:31], a[104:107], v[176:179], v[28:31]
    ds_read_b64_tr_b16 a[84:85], v4 offset:54080
    v_mfma_f32_16x16x32_bf16 v[28:31], a[108:111], v[184:187], v[28:31]
    ds_read_b64_tr_b16 a[86:87], v4 offset:54208
    v_mfma_f32_16x16x32_bf16 v[28:31], a[112:115], v[224:227], v[28:31]
    ds_read_b64_tr_b16 a[88:89], v4 offset:54336
    v_mfma_f32_16x16x32_bf16 v[28:31], a[116:119], v[232:235], v[28:31]
    ds_read_b64_tr_b16 a[90:91], v4 offset:54464
    v_mfma_f32_16x16x32_bf16 v[28:31], a[120:123], v[240:243], v[28:31]
    ds_read_b64_tr_b16 a[92:93], v4 offset:54592
    v_mfma_f32_16x16x32_bf16 v[28:31], a[124:127], v[248:251], v[28:31]
    s_waitcnt lgkmcnt(11)
    ds_read_b64_tr_b16 a[94:95], v4 offset:54720
    v_mfma_f32_16x16x32_bf16 v[32:35], a[64:67], v[128:131], 0
    ds_read_b64_tr_b16 a[96:97], v4 offset:36960
    v_cvt_pk_bf16_f32 v48, v16, v17
    v_mfma_f32_16x16x32_bf16 v[32:35], a[68:71], v[136:139], v[32:35]
    s_waitcnt lgkmcnt(9)
    ds_read_b64_tr_b16 a[98:99], v4 offset:37088
    v_cvt_pk_bf16_f32 v49, v18, v19
    v_mfma_f32_16x16x32_bf16 v[32:35], a[72:75], v[144:147], v[32:35]
    ds_read_b64_tr_b16 a[100:101], v4 offset:37216
    v_cvt_pk_bf16_f32 v50, v24, v25
    v_mfma_f32_16x16x32_bf16 v[32:35], a[76:79], v[152:155], v[32:35]
    s_waitcnt lgkmcnt(7)
    ds_read_b64_tr_b16 a[102:103], v4 offset:37344
    v_cvt_pk_bf16_f32 v51, v26, v27
    v_mfma_f32_16x16x32_bf16 v[32:35], a[80:83], v[192:195], v[32:35]
    s_mov_b32 s54, 1024
    ds_read_b64_tr_b16 a[104:105], v4 offset:37472
    ds_read_b64_tr_b16 a[106:107], v4 offset:37600
    v_mfma_f32_16x16x32_bf16 v[32:35], a[84:87], v[200:203], v[32:35]
    s_waitcnt lgkmcnt(6)
    v_permlane32_swap_b32 v48, v50
    v_mfma_f32_16x16x32_bf16 v[32:35], a[88:91], v[208:211], v[32:35]
    v_permlane32_swap_b32 v49, v51
    v_mfma_f32_16x16x32_bf16 v[32:35], a[92:95], v[216:219], v[32:35]
    ds_read_b64_tr_b16 a[108:109], v4 offset:37728
    ds_read_b64_tr_b16 a[110:111], v4 offset:37856
    buffer_store_dwordx4 v[48:51], v10, s[40:43], s54 offen offset:0 sc1
    v_mfma_f32_16x16x32_bf16 v[36:39], a[64:67], v[160:163], 0
    ds_read_b64_tr_b16 a[112:113], v4 offset:53856
    v_cvt_pk_bf16_f32 v52, v20, v21
    v_mfma_f32_16x16x32_bf16 v[36:39], a[68:71], v[168:171], v[36:39]
    ds_read_b64_tr_b16 a[114:115], v4 offset:53984
    v_cvt_pk_bf16_f32 v53, v22, v23
    v_mfma_f32_16x16x32_bf16 v[36:39], a[72:75], v[176:179], v[36:39]
    ds_read_b64_tr_b16 a[116:117], v4 offset:54112
    v_cvt_pk_bf16_f32 v54, v28, v29
    v_mfma_f32_16x16x32_bf16 v[36:39], a[76:79], v[184:187], v[36:39]
    ds_read_b64_tr_b16 a[118:119], v4 offset:54240
    v_cvt_pk_bf16_f32 v55, v30, v31
    v_mfma_f32_16x16x32_bf16 v[36:39], a[80:83], v[224:227], v[36:39]
    s_mov_b32 s54, 295936
    ds_read_b64_tr_b16 a[120:121], v4 offset:54368
    ds_read_b64_tr_b16 a[122:123], v4 offset:54496
    v_mfma_f32_16x16x32_bf16 v[36:39], a[84:87], v[232:235], v[36:39]
    v_permlane32_swap_b32 v52, v54
    v_mfma_f32_16x16x32_bf16 v[36:39], a[88:91], v[240:243], v[36:39]
    v_permlane32_swap_b32 v53, v55
    v_mfma_f32_16x16x32_bf16 v[36:39], a[92:95], v[248:251], v[36:39]
    s_waitcnt vmcnt(43)
    s_barrier
    s_waitcnt lgkmcnt(10)
    ds_read_b64_tr_b16 a[124:125], v4 offset:54624
    ds_read_b64_tr_b16 a[126:127], v4 offset:54752
    buffer_store_dwordx4 v[52:55], v10, s[40:43], s54 offen offset:0 sc1
    v_mfma_f32_16x16x32_bf16 v[40:43], a[96:99], v[128:131], 0
    s_add_u32 m0, s44, 73728
    ds_read_b64_tr_b16 a[64:65], v3 offset:0
    ds_read_b64_tr_b16 a[66:67], v3 offset:128
    v_mfma_f32_16x16x32_bf16 v[40:43], a[100:103], v[136:139], v[40:43]
    s_mov_b32 s45, 512
    s_waitcnt lgkmcnt(10)
    buffer_load_dwordx4 v7, s[28:31], s45 offen offset:0 lds
    v_mfma_f32_16x16x32_bf16 v[40:43], a[104:107], v[144:147], v[40:43]
    s_add_u32 m0, s44, 73632
    ds_read_b64_tr_b16 a[68:69], v3 offset:256
    ds_read_b64_tr_b16 a[70:71], v3 offset:384
    v_mfma_f32_16x16x32_bf16 v[40:43], a[108:111], v[152:155], v[40:43]
    s_waitcnt lgkmcnt(8)
    buffer_load_dwordx4 v7, s[28:31], s45 offen offset:1152 lds
    v_mfma_f32_16x16x32_bf16 v[40:43], a[112:115], v[192:195], v[40:43]
    s_add_u32 m0, s44, 73536
    ds_read_b64_tr_b16 a[72:73], v3 offset:512
    ds_read_b64_tr_b16 a[74:75], v3 offset:640
    v_mfma_f32_16x16x32_bf16 v[40:43], a[116:119], v[200:203], v[40:43]
    s_waitcnt lgkmcnt(6)
    buffer_load_dwordx4 v7, s[28:31], s45 offen offset:2304 lds
    v_mfma_f32_16x16x32_bf16 v[40:43], a[120:123], v[208:211], v[40:43]
    s_add_u32 m0, s44, 73440
    ds_read_b64_tr_b16 a[76:77], v3 offset:768
    ds_read_b64_tr_b16 a[78:79], v3 offset:896
    v_mfma_f32_16x16x32_bf16 v[40:43], a[124:127], v[216:219], v[40:43]
    buffer_load_dwordx4 v7, s[28:31], s45 offen offset:3456 lds
    v_mfma_f32_16x16x32_bf16 v[44:47], a[96:99], v[160:163], 0
    s_add_u32 m0, s44, 90624
    ds_read_b64_tr_b16 a[80:81], v3 offset:16896
    ds_read_b64_tr_b16 a[82:83], v3 offset:17024
    v_mfma_f32_16x16x32_bf16 v[44:47], a[100:103], v[168:171], v[44:47]
    s_mov_b32 s45, 147968
    buffer_load_dwordx4 v7, s[28:31], s45 offen offset:0 lds
    v_mfma_f32_16x16x32_bf16 v[44:47], a[104:107], v[176:179], v[44:47]
    s_add_u32 m0, s44, 90528
    ds_read_b64_tr_b16 a[84:85], v3 offset:17152
    ds_read_b64_tr_b16 a[86:87], v3 offset:17280
    v_mfma_f32_16x16x32_bf16 v[44:47], a[108:111], v[184:187], v[44:47]
    buffer_load_dwordx4 v7, s[28:31], s45 offen offset:1152 lds
    v_mfma_f32_16x16x32_bf16 v[44:47], a[112:115], v[224:227], v[44:47]
    s_add_u32 m0, s44, 90432
    ds_read_b64_tr_b16 a[88:89], v3 offset:17408
    ds_read_b64_tr_b16 a[90:91], v3 offset:17536
    v_mfma_f32_16x16x32_bf16 v[44:47], a[116:119], v[232:235], v[44:47]
    buffer_load_dwordx4 v7, s[28:31], s45 offen offset:2304 lds
    v_mfma_f32_16x16x32_bf16 v[44:47], a[120:123], v[240:243], v[44:47]
    s_add_u32 m0, s44, 90336
    ds_read_b64_tr_b16 a[92:93], v3 offset:17664
    ds_read_b64_tr_b16 a[94:95], v3 offset:17792
    v_mfma_f32_16x16x32_bf16 v[44:47], a[124:127], v[248:251], v[44:47]
    s_waitcnt lgkmcnt(12)
    buffer_load_dwordx4 v7, s[28:31], s45 offen offset:3456 lds
    v_mfma_f32_16x16x32_bf16 v[16:19], a[64:67], v[128:131], 0
    ds_read_b64_tr_b16 a[96:97], v3 offset:32
    v_cvt_pk_bf16_f32 v48, v32, v33
    v_mfma_f32_16x16x32_bf16 v[16:19], a[68:71], v[136:139], v[16:19]
    s_waitcnt lgkmcnt(9)
    ds_read_b64_tr_b16 a[98:99], v3 offset:160
    v_cvt_pk_bf16_f32 v49, v34, v35
    v_mfma_f32_16x16x32_bf16 v[16:19], a[72:75], v[144:147], v[16:19]
    ds_read_b64_tr_b16 a[100:101], v3 offset:288
    v_cvt_pk_bf16_f32 v50, v40, v41
    v_mfma_f32_16x16x32_bf16 v[16:19], a[76:79], v[152:155], v[16:19]
    s_waitcnt lgkmcnt(7)
    ds_read_b64_tr_b16 a[102:103], v3 offset:416
    v_cvt_pk_bf16_f32 v51, v42, v43
    v_mfma_f32_16x16x32_bf16 v[16:19], a[80:83], v[192:195], v[16:19]
    s_mov_b32 s54, 1024
    ds_read_b64_tr_b16 a[104:105], v3 offset:544
    ds_read_b64_tr_b16 a[106:107], v3 offset:672
    v_mfma_f32_16x16x32_bf16 v[16:19], a[84:87], v[200:203], v[16:19]
    s_waitcnt lgkmcnt(6)
    v_permlane32_swap_b32 v48, v50
    v_mfma_f32_16x16x32_bf16 v[16:19], a[88:91], v[208:211], v[16:19]
    v_permlane32_swap_b32 v49, v51
    v_mfma_f32_16x16x32_bf16 v[16:19], a[92:95], v[216:219], v[16:19]
    ds_read_b64_tr_b16 a[108:109], v3 offset:800
    ds_read_b64_tr_b16 a[110:111], v3 offset:928
    buffer_store_dwordx4 v[48:51], v10, s[40:43], s54 offen offset:512 sc1
    v_mfma_f32_16x16x32_bf16 v[20:23], a[64:67], v[160:163], 0
    ds_read_b64_tr_b16 a[112:113], v3 offset:16928
    v_cvt_pk_bf16_f32 v52, v36, v37
    v_mfma_f32_16x16x32_bf16 v[20:23], a[68:71], v[168:171], v[20:23]
    ds_read_b64_tr_b16 a[114:115], v3 offset:17056
    v_cvt_pk_bf16_f32 v53, v38, v39
    v_mfma_f32_16x16x32_bf16 v[20:23], a[72:75], v[176:179], v[20:23]
    ds_read_b64_tr_b16 a[116:117], v3 offset:17184
    v_cvt_pk_bf16_f32 v54, v44, v45
    v_mfma_f32_16x16x32_bf16 v[20:23], a[76:79], v[184:187], v[20:23]
    ds_read_b64_tr_b16 a[118:119], v3 offset:17312
    v_cvt_pk_bf16_f32 v55, v46, v47
    v_mfma_f32_16x16x32_bf16 v[20:23], a[80:83], v[224:227], v[20:23]
    s_mov_b32 s54, 295936
    ds_read_b64_tr_b16 a[120:121], v3 offset:17440
    ds_read_b64_tr_b16 a[122:123], v3 offset:17568
    v_mfma_f32_16x16x32_bf16 v[20:23], a[84:87], v[232:235], v[20:23]
    v_permlane32_swap_b32 v52, v54
    v_mfma_f32_16x16x32_bf16 v[20:23], a[88:91], v[240:243], v[20:23]
    v_permlane32_swap_b32 v53, v55
    v_mfma_f32_16x16x32_bf16 v[20:23], a[92:95], v[248:251], v[20:23]
    s_waitcnt lgkmcnt(10)
    ds_read_b64_tr_b16 a[124:125], v3 offset:17696
    ds_read_b64_tr_b16 a[126:127], v3 offset:17824
    buffer_store_dwordx4 v[52:55], v10, s[40:43], s54 offen offset:512 sc1
    v_mfma_f32_16x16x32_bf16 v[24:27], a[96:99], v[128:131], 0
    ds_read_b64_tr_b16 a[64:65], v3 offset:64
    v_mfma_f32_16x16x32_bf16 v[24:27], a[100:103], v[136:139], v[24:27]
    s_waitcnt lgkmcnt(9)
    ds_read_b64_tr_b16 a[66:67], v3 offset:192
    v_mfma_f32_16x16x32_bf16 v[24:27], a[104:107], v[144:147], v[24:27]
    ds_read_b64_tr_b16 a[68:69], v3 offset:320
    v_mfma_f32_16x16x32_bf16 v[24:27], a[108:111], v[152:155], v[24:27]
    s_waitcnt lgkmcnt(7)
    ds_read_b64_tr_b16 a[70:71], v3 offset:448
    v_mfma_f32_16x16x32_bf16 v[24:27], a[112:115], v[192:195], v[24:27]
    ds_read_b64_tr_b16 a[72:73], v3 offset:576
    v_mfma_f32_16x16x32_bf16 v[24:27], a[116:119], v[200:203], v[24:27]
    s_waitcnt lgkmcnt(5)
    ds_read_b64_tr_b16 a[74:75], v3 offset:704
    v_mfma_f32_16x16x32_bf16 v[24:27], a[120:123], v[208:211], v[24:27]
    ds_read_b64_tr_b16 a[76:77], v3 offset:832
    v_mfma_f32_16x16x32_bf16 v[24:27], a[124:127], v[216:219], v[24:27]
    ds_read_b64_tr_b16 a[78:79], v3 offset:960
    v_mfma_f32_16x16x32_bf16 v[28:31], a[96:99], v[160:163], 0
    ds_read_b64_tr_b16 a[80:81], v3 offset:16960
    v_mfma_f32_16x16x32_bf16 v[28:31], a[100:103], v[168:171], v[28:31]
    ds_read_b64_tr_b16 a[82:83], v3 offset:17088
    v_mfma_f32_16x16x32_bf16 v[28:31], a[104:107], v[176:179], v[28:31]
    ds_read_b64_tr_b16 a[84:85], v3 offset:17216
    v_mfma_f32_16x16x32_bf16 v[28:31], a[108:111], v[184:187], v[28:31]
    ds_read_b64_tr_b16 a[86:87], v3 offset:17344
    v_mfma_f32_16x16x32_bf16 v[28:31], a[112:115], v[224:227], v[28:31]
    ds_read_b64_tr_b16 a[88:89], v3 offset:17472
    v_mfma_f32_16x16x32_bf16 v[28:31], a[116:119], v[232:235], v[28:31]
    ds_read_b64_tr_b16 a[90:91], v3 offset:17600
    v_mfma_f32_16x16x32_bf16 v[28:31], a[120:123], v[240:243], v[28:31]
    ds_read_b64_tr_b16 a[92:93], v3 offset:17728
    v_mfma_f32_16x16x32_bf16 v[28:31], a[124:127], v[248:251], v[28:31]
    s_waitcnt lgkmcnt(11)
    ds_read_b64_tr_b16 a[94:95], v3 offset:17856
    v_mfma_f32_16x16x32_bf16 v[32:35], a[64:67], v[128:131], 0
    ds_read_b64_tr_b16 a[96:97], v3 offset:96
    v_cvt_pk_bf16_f32 v48, v16, v17
    v_mfma_f32_16x16x32_bf16 v[32:35], a[68:71], v[136:139], v[32:35]
    s_waitcnt lgkmcnt(9)
    ds_read_b64_tr_b16 a[98:99], v3 offset:224
    v_cvt_pk_bf16_f32 v49, v18, v19
    v_mfma_f32_16x16x32_bf16 v[32:35], a[72:75], v[144:147], v[32:35]
    ds_read_b64_tr_b16 a[100:101], v3 offset:352
    v_cvt_pk_bf16_f32 v50, v24, v25
    v_mfma_f32_16x16x32_bf16 v[32:35], a[76:79], v[152:155], v[32:35]
    s_waitcnt lgkmcnt(7)
    ds_read_b64_tr_b16 a[102:103], v3 offset:480
    v_cvt_pk_bf16_f32 v51, v26, v27
    v_mfma_f32_16x16x32_bf16 v[32:35], a[80:83], v[192:195], v[32:35]
    s_mov_b32 s54, 2048
    ds_read_b64_tr_b16 a[104:105], v3 offset:608
    ds_read_b64_tr_b16 a[106:107], v3 offset:736
    v_mfma_f32_16x16x32_bf16 v[32:35], a[84:87], v[200:203], v[32:35]
    s_waitcnt lgkmcnt(6)
    v_permlane32_swap_b32 v48, v50
    v_mfma_f32_16x16x32_bf16 v[32:35], a[88:91], v[208:211], v[32:35]
    v_permlane32_swap_b32 v49, v51
    v_mfma_f32_16x16x32_bf16 v[32:35], a[92:95], v[216:219], v[32:35]
    ds_read_b64_tr_b16 a[108:109], v3 offset:864
    ds_read_b64_tr_b16 a[110:111], v3 offset:992
    buffer_store_dwordx4 v[48:51], v10, s[40:43], s54 offen offset:0 sc1
    v_mfma_f32_16x16x32_bf16 v[36:39], a[64:67], v[160:163], 0
    ds_read_b64_tr_b16 a[112:113], v3 offset:16992
    v_cvt_pk_bf16_f32 v52, v20, v21
    v_mfma_f32_16x16x32_bf16 v[36:39], a[68:71], v[168:171], v[36:39]
    ds_read_b64_tr_b16 a[114:115], v3 offset:17120
    v_cvt_pk_bf16_f32 v53, v22, v23
    v_mfma_f32_16x16x32_bf16 v[36:39], a[72:75], v[176:179], v[36:39]
    ds_read_b64_tr_b16 a[116:117], v3 offset:17248
    v_cvt_pk_bf16_f32 v54, v28, v29
    v_mfma_f32_16x16x32_bf16 v[36:39], a[76:79], v[184:187], v[36:39]
    ds_read_b64_tr_b16 a[118:119], v3 offset:17376
    v_cvt_pk_bf16_f32 v55, v30, v31
    v_mfma_f32_16x16x32_bf16 v[36:39], a[80:83], v[224:227], v[36:39]
    s_mov_b32 s54, 296960
    ds_read_b64_tr_b16 a[120:121], v3 offset:17504
    ds_read_b64_tr_b16 a[122:123], v3 offset:17632
    v_mfma_f32_16x16x32_bf16 v[36:39], a[84:87], v[232:235], v[36:39]
    v_permlane32_swap_b32 v52, v54
    v_mfma_f32_16x16x32_bf16 v[36:39], a[88:91], v[240:243], v[36:39]
    v_permlane32_swap_b32 v53, v55
    v_mfma_f32_16x16x32_bf16 v[36:39], a[92:95], v[248:251], v[36:39]
    s_waitcnt vmcnt(20)
    s_barrier
    s_waitcnt lgkmcnt(10)
    ds_read_b64_tr_b16 a[124:125], v3 offset:17760
    ds_read_b64_tr_b16 a[126:127], v3 offset:17888
    buffer_store_dwordx4 v[52:55], v10, s[40:43], s54 offen offset:0 sc1
    v_mfma_f32_16x16x32_bf16 v[40:43], a[96:99], v[128:131], 0
    s_add_u32 m0, s44, 110592
    ds_read_b64_tr_b16 a[64:65], v3 offset:36864
    ds_read_b64_tr_b16 a[66:67], v3 offset:36992
    v_mfma_f32_16x16x32_bf16 v[40:43], a[100:103], v[136:139], v[40:43]
    s_mov_b32 s45, 640
    s_waitcnt lgkmcnt(10)
    buffer_load_dwordx4 v7, s[28:31], s45 offen offset:0 lds
    v_mfma_f32_16x16x32_bf16 v[40:43], a[104:107], v[144:147], v[40:43]
    s_add_u32 m0, s44, 110496
    ds_read_b64_tr_b16 a[68:69], v3 offset:37120
    ds_read_b64_tr_b16 a[70:71], v3 offset:37248
    v_mfma_f32_16x16x32_bf16 v[40:43], a[108:111], v[152:155], v[40:43]
    s_waitcnt lgkmcnt(8)
    buffer_load_dwordx4 v7, s[28:31], s45 offen offset:1152 lds
    v_mfma_f32_16x16x32_bf16 v[40:43], a[112:115], v[192:195], v[40:43]
    s_add_u32 m0, s44, 110400
    ds_read_b64_tr_b16 a[72:73], v3 offset:37376
    ds_read_b64_tr_b16 a[74:75], v3 offset:37504
    v_mfma_f32_16x16x32_bf16 v[40:43], a[116:119], v[200:203], v[40:43]
    s_waitcnt lgkmcnt(6)
    buffer_load_dwordx4 v7, s[28:31], s45 offen offset:2304 lds
    v_mfma_f32_16x16x32_bf16 v[40:43], a[120:123], v[208:211], v[40:43]
    s_add_u32 m0, s44, 110304
    ds_read_b64_tr_b16 a[76:77], v3 offset:37632
    ds_read_b64_tr_b16 a[78:79], v3 offset:37760
    v_mfma_f32_16x16x32_bf16 v[40:43], a[124:127], v[216:219], v[40:43]
    buffer_load_dwordx4 v7, s[28:31], s45 offen offset:3456 lds
    v_mfma_f32_16x16x32_bf16 v[44:47], a[96:99], v[160:163], 0
    s_add_u32 m0, s44, 127488
    ds_read_b64_tr_b16 a[80:81], v3 offset:53760
    ds_read_b64_tr_b16 a[82:83], v3 offset:53888
    v_mfma_f32_16x16x32_bf16 v[44:47], a[100:103], v[168:171], v[44:47]
    s_mov_b32 s45, 148096
    buffer_load_dwordx4 v7, s[28:31], s45 offen offset:0 lds
    v_mfma_f32_16x16x32_bf16 v[44:47], a[104:107], v[176:179], v[44:47]
    s_add_u32 m0, s44, 127392
    ds_read_b64_tr_b16 a[84:85], v3 offset:54016
    ds_read_b64_tr_b16 a[86:87], v3 offset:54144
    v_mfma_f32_16x16x32_bf16 v[44:47], a[108:111], v[184:187], v[44:47]
    buffer_load_dwordx4 v7, s[28:31], s45 offen offset:1152 lds
    v_mfma_f32_16x16x32_bf16 v[44:47], a[112:115], v[224:227], v[44:47]
    s_add_u32 m0, s44, 127296
    ds_read_b64_tr_b16 a[88:89], v3 offset:54272
    ds_read_b64_tr_b16 a[90:91], v3 offset:54400
    v_mfma_f32_16x16x32_bf16 v[44:47], a[116:119], v[232:235], v[44:47]
    buffer_load_dwordx4 v7, s[28:31], s45 offen offset:2304 lds
    v_mfma_f32_16x16x32_bf16 v[44:47], a[120:123], v[240:243], v[44:47]
    s_add_u32 m0, s44, 127200
    ds_read_b64_tr_b16 a[92:93], v3 offset:54528
    ds_read_b64_tr_b16 a[94:95], v3 offset:54656
    v_mfma_f32_16x16x32_bf16 v[44:47], a[124:127], v[248:251], v[44:47]
    s_waitcnt lgkmcnt(12)
    buffer_load_dwordx4 v7, s[28:31], s45 offen offset:3456 lds
    v_mfma_f32_16x16x32_bf16 v[16:19], a[64:67], v[128:131], 0
    ds_read_b64_tr_b16 a[96:97], v3 offset:36896
    v_cvt_pk_bf16_f32 v48, v32, v33
    v_mfma_f32_16x16x32_bf16 v[16:19], a[68:71], v[136:139], v[16:19]
    s_waitcnt lgkmcnt(9)
    ds_read_b64_tr_b16 a[98:99], v3 offset:37024
    v_cvt_pk_bf16_f32 v49, v34, v35
    v_mfma_f32_16x16x32_bf16 v[16:19], a[72:75], v[144:147], v[16:19]
    ds_read_b64_tr_b16 a[100:101], v3 offset:37152
    v_cvt_pk_bf16_f32 v50, v40, v41
    v_mfma_f32_16x16x32_bf16 v[16:19], a[76:79], v[152:155], v[16:19]
    s_waitcnt lgkmcnt(7)
    ds_read_b64_tr_b16 a[102:103], v3 offset:37280
    v_cvt_pk_bf16_f32 v51, v42, v43
    v_mfma_f32_16x16x32_bf16 v[16:19], a[80:83], v[192:195], v[16:19]
    s_mov_b32 s54, 2048
    ds_read_b64_tr_b16 a[104:105], v3 offset:37408
    ds_read_b64_tr_b16 a[106:107], v3 offset:37536
    v_mfma_f32_16x16x32_bf16 v[16:19], a[84:87], v[200:203], v[16:19]
    s_waitcnt lgkmcnt(6)
    v_permlane32_swap_b32 v48, v50
    v_mfma_f32_16x16x32_bf16 v[16:19], a[88:91], v[208:211], v[16:19]
    v_permlane32_swap_b32 v49, v51
    v_mfma_f32_16x16x32_bf16 v[16:19], a[92:95], v[216:219], v[16:19]
    ds_read_b64_tr_b16 a[108:109], v3 offset:37664
    ds_read_b64_tr_b16 a[110:111], v3 offset:37792
    buffer_store_dwordx4 v[48:51], v10, s[40:43], s54 offen offset:512 sc1
    v_mfma_f32_16x16x32_bf16 v[20:23], a[64:67], v[160:163], 0
    ds_read_b64_tr_b16 a[112:113], v3 offset:53792
    v_cvt_pk_bf16_f32 v52, v36, v37
    v_mfma_f32_16x16x32_bf16 v[20:23], a[68:71], v[168:171], v[20:23]
    ds_read_b64_tr_b16 a[114:115], v3 offset:53920
    v_cvt_pk_bf16_f32 v53, v38, v39
    v_mfma_f32_16x16x32_bf16 v[20:23], a[72:75], v[176:179], v[20:23]
    ds_read_b64_tr_b16 a[116:117], v3 offset:54048
    v_cvt_pk_bf16_f32 v54, v44, v45
    v_mfma_f32_16x16x32_bf16 v[20:23], a[76:79], v[184:187], v[20:23]
    ds_read_b64_tr_b16 a[118:119], v3 offset:54176
    v_cvt_pk_bf16_f32 v55, v46, v47
    v_mfma_f32_16x16x32_bf16 v[20:23], a[80:83], v[224:227], v[20:23]
    s_mov_b32 s54, 296960
    ds_read_b64_tr_b16 a[120:121], v3 offset:54304
    ds_read_b64_tr_b16 a[122:123], v3 offset:54432
    v_mfma_f32_16x16x32_bf16 v[20:23], a[84:87], v[232:235], v[20:23]
    v_permlane32_swap_b32 v52, v54
    v_mfma_f32_16x16x32_bf16 v[20:23], a[88:91], v[240:243], v[20:23]
    v_permlane32_swap_b32 v53, v55
    v_mfma_f32_16x16x32_bf16 v[20:23], a[92:95], v[248:251], v[20:23]
    s_waitcnt lgkmcnt(10)
    ds_read_b64_tr_b16 a[124:125], v3 offset:54560
    ds_read_b64_tr_b16 a[126:127], v3 offset:54688
    buffer_store_dwordx4 v[52:55], v10, s[40:43], s54 offen offset:512 sc1
    v_mfma_f32_16x16x32_bf16 v[24:27], a[96:99], v[128:131], 0
    ds_read_b64_tr_b16 a[64:65], v3 offset:36928
    v_mfma_f32_16x16x32_bf16 v[24:27], a[100:103], v[136:139], v[24:27]
    s_waitcnt lgkmcnt(9)
    ds_read_b64_tr_b16 a[66:67], v3 offset:37056
    v_mfma_f32_16x16x32_bf16 v[24:27], a[104:107], v[144:147], v[24:27]
    ds_read_b64_tr_b16 a[68:69], v3 offset:37184
    v_mfma_f32_16x16x32_bf16 v[24:27], a[108:111], v[152:155], v[24:27]
    s_waitcnt lgkmcnt(7)
    ds_read_b64_tr_b16 a[70:71], v3 offset:37312
    v_mfma_f32_16x16x32_bf16 v[24:27], a[112:115], v[192:195], v[24:27]
    ds_read_b64_tr_b16 a[72:73], v3 offset:37440
    v_mfma_f32_16x16x32_bf16 v[24:27], a[116:119], v[200:203], v[24:27]
    s_waitcnt lgkmcnt(5)
    ds_read_b64_tr_b16 a[74:75], v3 offset:37568
    v_mfma_f32_16x16x32_bf16 v[24:27], a[120:123], v[208:211], v[24:27]
    ds_read_b64_tr_b16 a[76:77], v3 offset:37696
    v_mfma_f32_16x16x32_bf16 v[24:27], a[124:127], v[216:219], v[24:27]
    ds_read_b64_tr_b16 a[78:79], v3 offset:37824
    v_mfma_f32_16x16x32_bf16 v[28:31], a[96:99], v[160:163], 0
    ds_read_b64_tr_b16 a[80:81], v3 offset:53824
    v_mfma_f32_16x16x32_bf16 v[28:31], a[100:103], v[168:171], v[28:31]
    ds_read_b64_tr_b16 a[82:83], v3 offset:53952
    v_mfma_f32_16x16x32_bf16 v[28:31], a[104:107], v[176:179], v[28:31]
    ds_read_b64_tr_b16 a[84:85], v3 offset:54080
    v_mfma_f32_16x16x32_bf16 v[28:31], a[108:111], v[184:187], v[28:31]
    ds_read_b64_tr_b16 a[86:87], v3 offset:54208
    v_mfma_f32_16x16x32_bf16 v[28:31], a[112:115], v[224:227], v[28:31]
    ds_read_b64_tr_b16 a[88:89], v3 offset:54336
    v_mfma_f32_16x16x32_bf16 v[28:31], a[116:119], v[232:235], v[28:31]
    ds_read_b64_tr_b16 a[90:91], v3 offset:54464
    v_mfma_f32_16x16x32_bf16 v[28:31], a[120:123], v[240:243], v[28:31]
    ds_read_b64_tr_b16 a[92:93], v3 offset:54592
    v_mfma_f32_16x16x32_bf16 v[28:31], a[124:127], v[248:251], v[28:31]
    s_waitcnt lgkmcnt(11)
    ds_read_b64_tr_b16 a[94:95], v3 offset:54720
    v_mfma_f32_16x16x32_bf16 v[32:35], a[64:67], v[128:131], 0
    ds_read_b64_tr_b16 a[96:97], v3 offset:36960
    v_cvt_pk_bf16_f32 v48, v16, v17
    v_mfma_f32_16x16x32_bf16 v[32:35], a[68:71], v[136:139], v[32:35]
    s_waitcnt lgkmcnt(9)
    ds_read_b64_tr_b16 a[98:99], v3 offset:37088
    v_cvt_pk_bf16_f32 v49, v18, v19
    v_mfma_f32_16x16x32_bf16 v[32:35], a[72:75], v[144:147], v[32:35]
    ds_read_b64_tr_b16 a[100:101], v3 offset:37216
    v_cvt_pk_bf16_f32 v50, v24, v25
    v_mfma_f32_16x16x32_bf16 v[32:35], a[76:79], v[152:155], v[32:35]
    s_waitcnt lgkmcnt(7)
    ds_read_b64_tr_b16 a[102:103], v3 offset:37344
    v_cvt_pk_bf16_f32 v51, v26, v27
    v_mfma_f32_16x16x32_bf16 v[32:35], a[80:83], v[192:195], v[32:35]
    s_mov_b32 s54, 3072
    ds_read_b64_tr_b16 a[104:105], v3 offset:37472
    ds_read_b64_tr_b16 a[106:107], v3 offset:37600
    v_mfma_f32_16x16x32_bf16 v[32:35], a[84:87], v[200:203], v[32:35]
    s_waitcnt lgkmcnt(6)
    v_permlane32_swap_b32 v48, v50
    v_mfma_f32_16x16x32_bf16 v[32:35], a[88:91], v[208:211], v[32:35]
    v_permlane32_swap_b32 v49, v51
    v_mfma_f32_16x16x32_bf16 v[32:35], a[92:95], v[216:219], v[32:35]
    ds_read_b64_tr_b16 a[108:109], v3 offset:37728
    ds_read_b64_tr_b16 a[110:111], v3 offset:37856
    buffer_store_dwordx4 v[48:51], v10, s[40:43], s54 offen offset:0 sc1
    v_mfma_f32_16x16x32_bf16 v[36:39], a[64:67], v[160:163], 0
    ds_read_b64_tr_b16 a[112:113], v3 offset:53856
    v_cvt_pk_bf16_f32 v52, v20, v21
    v_mfma_f32_16x16x32_bf16 v[36:39], a[68:71], v[168:171], v[36:39]
    ds_read_b64_tr_b16 a[114:115], v3 offset:53984
    v_cvt_pk_bf16_f32 v53, v22, v23
    v_mfma_f32_16x16x32_bf16 v[36:39], a[72:75], v[176:179], v[36:39]
    ds_read_b64_tr_b16 a[116:117], v3 offset:54112
    v_cvt_pk_bf16_f32 v54, v28, v29
    v_mfma_f32_16x16x32_bf16 v[36:39], a[76:79], v[184:187], v[36:39]
    ds_read_b64_tr_b16 a[118:119], v3 offset:54240
    v_cvt_pk_bf16_f32 v55, v30, v31
    v_mfma_f32_16x16x32_bf16 v[36:39], a[80:83], v[224:227], v[36:39]
    s_mov_b32 s54, 297984
    ds_read_b64_tr_b16 a[120:121], v3 offset:54368
    ds_read_b64_tr_b16 a[122:123], v3 offset:54496
    v_mfma_f32_16x16x32_bf16 v[36:39], a[84:87], v[232:235], v[36:39]
    v_permlane32_swap_b32 v52, v54
    v_mfma_f32_16x16x32_bf16 v[36:39], a[88:91], v[240:243], v[36:39]
    v_permlane32_swap_b32 v53, v55
    v_mfma_f32_16x16x32_bf16 v[36:39], a[92:95], v[248:251], v[36:39]
    s_waitcnt vmcnt(15)
    s_barrier
    s_waitcnt lgkmcnt(10)
    ds_read_b64_tr_b16 a[124:125], v3 offset:54624
    ds_read_b64_tr_b16 a[126:127], v3 offset:54752
    buffer_store_dwordx4 v[52:55], v10, s[40:43], s54 offen offset:0 sc1
    v_mfma_f32_16x16x32_bf16 v[40:43], a[96:99], v[128:131], 0
    s_add_u32 m0, s44, 0
    ds_read_b64_tr_b16 a[64:65], v4 offset:0
    ds_read_b64_tr_b16 a[66:67], v4 offset:128
    v_mfma_f32_16x16x32_bf16 v[40:43], a[100:103], v[136:139], v[40:43]
    s_mov_b32 s45, 768
    s_waitcnt lgkmcnt(10)
    buffer_load_dwordx4 v7, s[28:31], s45 offen offset:0 lds
    v_mfma_f32_16x16x32_bf16 v[40:43], a[104:107], v[144:147], v[40:43]
    s_add_u32 m0, s44, -96
    ds_read_b64_tr_b16 a[68:69], v4 offset:256
    ds_read_b64_tr_b16 a[70:71], v4 offset:384
    v_mfma_f32_16x16x32_bf16 v[40:43], a[108:111], v[152:155], v[40:43]
    s_waitcnt lgkmcnt(8)
    buffer_load_dwordx4 v7, s[28:31], s45 offen offset:1152 lds
    v_mfma_f32_16x16x32_bf16 v[40:43], a[112:115], v[192:195], v[40:43]
    s_add_u32 m0, s44, -192
    ds_read_b64_tr_b16 a[72:73], v4 offset:512
    ds_read_b64_tr_b16 a[74:75], v4 offset:640
    v_mfma_f32_16x16x32_bf16 v[40:43], a[116:119], v[200:203], v[40:43]
    s_waitcnt lgkmcnt(6)
    buffer_load_dwordx4 v7, s[28:31], s45 offen offset:2304 lds
    v_mfma_f32_16x16x32_bf16 v[40:43], a[120:123], v[208:211], v[40:43]
    s_add_u32 m0, s44, -288
    ds_read_b64_tr_b16 a[76:77], v4 offset:768
    ds_read_b64_tr_b16 a[78:79], v4 offset:896
    v_mfma_f32_16x16x32_bf16 v[40:43], a[124:127], v[216:219], v[40:43]
    buffer_load_dwordx4 v7, s[28:31], s45 offen offset:3456 lds
    v_mfma_f32_16x16x32_bf16 v[44:47], a[96:99], v[160:163], 0
    s_add_u32 m0, s44, 16896
    ds_read_b64_tr_b16 a[80:81], v4 offset:16896
    ds_read_b64_tr_b16 a[82:83], v4 offset:17024
    v_mfma_f32_16x16x32_bf16 v[44:47], a[100:103], v[168:171], v[44:47]
    s_mov_b32 s45, 148224
    buffer_load_dwordx4 v7, s[28:31], s45 offen offset:0 lds
    v_mfma_f32_16x16x32_bf16 v[44:47], a[104:107], v[176:179], v[44:47]
    s_add_u32 m0, s44, 16800
    ds_read_b64_tr_b16 a[84:85], v4 offset:17152
    ds_read_b64_tr_b16 a[86:87], v4 offset:17280
    v_mfma_f32_16x16x32_bf16 v[44:47], a[108:111], v[184:187], v[44:47]
    buffer_load_dwordx4 v7, s[28:31], s45 offen offset:1152 lds
    v_mfma_f32_16x16x32_bf16 v[44:47], a[112:115], v[224:227], v[44:47]
    s_add_u32 m0, s44, 16704
    ds_read_b64_tr_b16 a[88:89], v4 offset:17408
    ds_read_b64_tr_b16 a[90:91], v4 offset:17536
    v_mfma_f32_16x16x32_bf16 v[44:47], a[116:119], v[232:235], v[44:47]
    buffer_load_dwordx4 v7, s[28:31], s45 offen offset:2304 lds
    v_mfma_f32_16x16x32_bf16 v[44:47], a[120:123], v[240:243], v[44:47]
    s_add_u32 m0, s44, 16608
    ds_read_b64_tr_b16 a[92:93], v4 offset:17664
    ds_read_b64_tr_b16 a[94:95], v4 offset:17792
    v_mfma_f32_16x16x32_bf16 v[44:47], a[124:127], v[248:251], v[44:47]
    s_waitcnt lgkmcnt(12)
    buffer_load_dwordx4 v7, s[28:31], s45 offen offset:3456 lds
    v_mfma_f32_16x16x32_bf16 v[16:19], a[64:67], v[128:131], 0
    ds_read_b64_tr_b16 a[96:97], v4 offset:32
    v_cvt_pk_bf16_f32 v48, v32, v33
    v_mfma_f32_16x16x32_bf16 v[16:19], a[68:71], v[136:139], v[16:19]
    s_waitcnt lgkmcnt(9)
    ds_read_b64_tr_b16 a[98:99], v4 offset:160
    v_cvt_pk_bf16_f32 v49, v34, v35
    v_mfma_f32_16x16x32_bf16 v[16:19], a[72:75], v[144:147], v[16:19]
    ds_read_b64_tr_b16 a[100:101], v4 offset:288
    v_cvt_pk_bf16_f32 v50, v40, v41
    v_mfma_f32_16x16x32_bf16 v[16:19], a[76:79], v[152:155], v[16:19]
    s_waitcnt lgkmcnt(7)
    ds_read_b64_tr_b16 a[102:103], v4 offset:416
    v_cvt_pk_bf16_f32 v51, v42, v43
    v_mfma_f32_16x16x32_bf16 v[16:19], a[80:83], v[192:195], v[16:19]
    s_mov_b32 s54, 3072
    ds_read_b64_tr_b16 a[104:105], v4 offset:544
    ds_read_b64_tr_b16 a[106:107], v4 offset:672
    v_mfma_f32_16x16x32_bf16 v[16:19], a[84:87], v[200:203], v[16:19]
    s_waitcnt lgkmcnt(6)
    v_permlane32_swap_b32 v48, v50
    v_mfma_f32_16x16x32_bf16 v[16:19], a[88:91], v[208:211], v[16:19]
    v_permlane32_swap_b32 v49, v51
    v_mfma_f32_16x16x32_bf16 v[16:19], a[92:95], v[216:219], v[16:19]
    ds_read_b64_tr_b16 a[108:109], v4 offset:800
    ds_read_b64_tr_b16 a[110:111], v4 offset:928
    buffer_store_dwordx4 v[48:51], v10, s[40:43], s54 offen offset:512 sc1
    v_mfma_f32_16x16x32_bf16 v[20:23], a[64:67], v[160:163], 0
    ds_read_b64_tr_b16 a[112:113], v4 offset:16928
    v_cvt_pk_bf16_f32 v52, v36, v37
    v_mfma_f32_16x16x32_bf16 v[20:23], a[68:71], v[168:171], v[20:23]
    ds_read_b64_tr_b16 a[114:115], v4 offset:17056
    v_cvt_pk_bf16_f32 v53, v38, v39
    v_mfma_f32_16x16x32_bf16 v[20:23], a[72:75], v[176:179], v[20:23]
    ds_read_b64_tr_b16 a[116:117], v4 offset:17184
    v_cvt_pk_bf16_f32 v54, v44, v45
    v_mfma_f32_16x16x32_bf16 v[20:23], a[76:79], v[184:187], v[20:23]
    ds_read_b64_tr_b16 a[118:119], v4 offset:17312
    v_cvt_pk_bf16_f32 v55, v46, v47
    v_mfma_f32_16x16x32_bf16 v[20:23], a[80:83], v[224:227], v[20:23]
    s_mov_b32 s54, 297984
    ds_read_b64_tr_b16 a[120:121], v4 offset:17440
    ds_read_b64_tr_b16 a[122:123], v4 offset:17568
    v_mfma_f32_16x16x32_bf16 v[20:23], a[84:87], v[232:235], v[20:23]
    v_permlane32_swap_b32 v52, v54
    v_mfma_f32_16x16x32_bf16 v[20:23], a[88:91], v[240:243], v[20:23]
    v_permlane32_swap_b32 v53, v55
    v_mfma_f32_16x16x32_bf16 v[20:23], a[92:95], v[248:251], v[20:23]
    s_waitcnt lgkmcnt(10)
    ds_read_b64_tr_b16 a[124:125], v4 offset:17696
    ds_read_b64_tr_b16 a[126:127], v4 offset:17824
    buffer_store_dwordx4 v[52:55], v10, s[40:43], s54 offen offset:512 sc1
    v_mfma_f32_16x16x32_bf16 v[24:27], a[96:99], v[128:131], 0
    ds_read_b64_tr_b16 a[64:65], v4 offset:64
    v_mfma_f32_16x16x32_bf16 v[24:27], a[100:103], v[136:139], v[24:27]
    s_waitcnt lgkmcnt(9)
    ds_read_b64_tr_b16 a[66:67], v4 offset:192
    v_mfma_f32_16x16x32_bf16 v[24:27], a[104:107], v[144:147], v[24:27]
    ds_read_b64_tr_b16 a[68:69], v4 offset:320
    v_mfma_f32_16x16x32_bf16 v[24:27], a[108:111], v[152:155], v[24:27]
    s_waitcnt lgkmcnt(7)
    ds_read_b64_tr_b16 a[70:71], v4 offset:448
    v_mfma_f32_16x16x32_bf16 v[24:27], a[112:115], v[192:195], v[24:27]
    ds_read_b64_tr_b16 a[72:73], v4 offset:576
    v_mfma_f32_16x16x32_bf16 v[24:27], a[116:119], v[200:203], v[24:27]
    s_waitcnt lgkmcnt(5)
    ds_read_b64_tr_b16 a[74:75], v4 offset:704
    v_mfma_f32_16x16x32_bf16 v[24:27], a[120:123], v[208:211], v[24:27]
    ds_read_b64_tr_b16 a[76:77], v4 offset:832
    v_mfma_f32_16x16x32_bf16 v[24:27], a[124:127], v[216:219], v[24:27]
    ds_read_b64_tr_b16 a[78:79], v4 offset:960
    v_mfma_f32_16x16x32_bf16 v[28:31], a[96:99], v[160:163], 0
    ds_read_b64_tr_b16 a[80:81], v4 offset:16960
    v_mfma_f32_16x16x32_bf16 v[28:31], a[100:103], v[168:171], v[28:31]
    ds_read_b64_tr_b16 a[82:83], v4 offset:17088
    v_mfma_f32_16x16x32_bf16 v[28:31], a[104:107], v[176:179], v[28:31]
    ds_read_b64_tr_b16 a[84:85], v4 offset:17216
    v_mfma_f32_16x16x32_bf16 v[28:31], a[108:111], v[184:187], v[28:31]
    ds_read_b64_tr_b16 a[86:87], v4 offset:17344
    v_mfma_f32_16x16x32_bf16 v[28:31], a[112:115], v[224:227], v[28:31]
    ds_read_b64_tr_b16 a[88:89], v4 offset:17472
    v_mfma_f32_16x16x32_bf16 v[28:31], a[116:119], v[232:235], v[28:31]
    ds_read_b64_tr_b16 a[90:91], v4 offset:17600
    v_mfma_f32_16x16x32_bf16 v[28:31], a[120:123], v[240:243], v[28:31]
    ds_read_b64_tr_b16 a[92:93], v4 offset:17728
    v_mfma_f32_16x16x32_bf16 v[28:31], a[124:127], v[248:251], v[28:31]
    s_waitcnt lgkmcnt(11)
    ds_read_b64_tr_b16 a[94:95], v4 offset:17856
    v_mfma_f32_16x16x32_bf16 v[32:35], a[64:67], v[128:131], 0
    ds_read_b64_tr_b16 a[96:97], v4 offset:96
    v_cvt_pk_bf16_f32 v48, v16, v17
    v_mfma_f32_16x16x32_bf16 v[32:35], a[68:71], v[136:139], v[32:35]
    s_waitcnt lgkmcnt(9)
    ds_read_b64_tr_b16 a[98:99], v4 offset:224
    v_cvt_pk_bf16_f32 v49, v18, v19
    v_mfma_f32_16x16x32_bf16 v[32:35], a[72:75], v[144:147], v[32:35]
    ds_read_b64_tr_b16 a[100:101], v4 offset:352
    v_cvt_pk_bf16_f32 v50, v24, v25
    v_mfma_f32_16x16x32_bf16 v[32:35], a[76:79], v[152:155], v[32:35]
    s_waitcnt lgkmcnt(7)
    ds_read_b64_tr_b16 a[102:103], v4 offset:480
    v_cvt_pk_bf16_f32 v51, v26, v27
    v_mfma_f32_16x16x32_bf16 v[32:35], a[80:83], v[192:195], v[32:35]
    s_mov_b32 s54, 4096
    ds_read_b64_tr_b16 a[104:105], v4 offset:608
    ds_read_b64_tr_b16 a[106:107], v4 offset:736
    v_mfma_f32_16x16x32_bf16 v[32:35], a[84:87], v[200:203], v[32:35]
    s_waitcnt lgkmcnt(6)
    v_permlane32_swap_b32 v48, v50
    v_mfma_f32_16x16x32_bf16 v[32:35], a[88:91], v[208:211], v[32:35]
    v_permlane32_swap_b32 v49, v51
    v_mfma_f32_16x16x32_bf16 v[32:35], a[92:95], v[216:219], v[32:35]
    ds_read_b64_tr_b16 a[108:109], v4 offset:864
    ds_read_b64_tr_b16 a[110:111], v4 offset:992
    buffer_store_dwordx4 v[48:51], v10, s[40:43], s54 offen offset:0 sc1
    v_mfma_f32_16x16x32_bf16 v[36:39], a[64:67], v[160:163], 0
    ds_read_b64_tr_b16 a[112:113], v4 offset:16992
    v_cvt_pk_bf16_f32 v52, v20, v21
    v_mfma_f32_16x16x32_bf16 v[36:39], a[68:71], v[168:171], v[36:39]
    ds_read_b64_tr_b16 a[114:115], v4 offset:17120
    v_cvt_pk_bf16_f32 v53, v22, v23
    v_mfma_f32_16x16x32_bf16 v[36:39], a[72:75], v[176:179], v[36:39]
    ds_read_b64_tr_b16 a[116:117], v4 offset:17248
    v_cvt_pk_bf16_f32 v54, v28, v29
    v_mfma_f32_16x16x32_bf16 v[36:39], a[76:79], v[184:187], v[36:39]
    ds_read_b64_tr_b16 a[118:119], v4 offset:17376
    v_cvt_pk_bf16_f32 v55, v30, v31
    v_mfma_f32_16x16x32_bf16 v[36:39], a[80:83], v[224:227], v[36:39]
    s_mov_b32 s54, 299008
    ds_read_b64_tr_b16 a[120:121], v4 offset:17504
    ds_read_b64_tr_b16 a[122:123], v4 offset:17632
    v_mfma_f32_16x16x32_bf16 v[36:39], a[84:87], v[232:235], v[36:39]
    v_permlane32_swap_b32 v52, v54
    v_mfma_f32_16x16x32_bf16 v[36:39], a[88:91], v[240:243], v[36:39]
    v_permlane32_swap_b32 v53, v55
    v_mfma_f32_16x16x32_bf16 v[36:39], a[92:95], v[248:251], v[36:39]
    s_waitcnt vmcnt(15)
    s_barrier
    s_waitcnt lgkmcnt(10)
    ds_read_b64_tr_b16 a[124:125], v4 offset:17760
    ds_read_b64_tr_b16 a[126:127], v4 offset:17888
    buffer_store_dwordx4 v[52:55], v10, s[40:43], s54 offen offset:0 sc1
    v_mfma_f32_16x16x32_bf16 v[40:43], a[96:99], v[128:131], 0
    s_add_u32 m0, s44, 36864
    ds_read_b64_tr_b16 a[64:65], v4 offset:36864
    ds_read_b64_tr_b16 a[66:67], v4 offset:36992
    v_mfma_f32_16x16x32_bf16 v[40:43], a[100:103], v[136:139], v[40:43]
    s_mov_b32 s45, 896
    s_waitcnt lgkmcnt(10)
    buffer_load_dwordx4 v7, s[28:31], s45 offen offset:0 lds
    v_mfma_f32_16x16x32_bf16 v[40:43], a[104:107], v[144:147], v[40:43]
    s_add_u32 m0, s44, 36768
    ds_read_b64_tr_b16 a[68:69], v4 offset:37120
    ds_read_b64_tr_b16 a[70:71], v4 offset:37248
    v_mfma_f32_16x16x32_bf16 v[40:43], a[108:111], v[152:155], v[40:43]
    s_waitcnt lgkmcnt(8)
    buffer_load_dwordx4 v7, s[28:31], s45 offen offset:1152 lds
    v_mfma_f32_16x16x32_bf16 v[40:43], a[112:115], v[192:195], v[40:43]
    s_add_u32 m0, s44, 36672
    ds_read_b64_tr_b16 a[72:73], v4 offset:37376
    ds_read_b64_tr_b16 a[74:75], v4 offset:37504
    v_mfma_f32_16x16x32_bf16 v[40:43], a[116:119], v[200:203], v[40:43]
    s_waitcnt lgkmcnt(6)
    buffer_load_dwordx4 v7, s[28:31], s45 offen offset:2304 lds
    v_mfma_f32_16x16x32_bf16 v[40:43], a[120:123], v[208:211], v[40:43]
    s_add_u32 m0, s44, 36576
    ds_read_b64_tr_b16 a[76:77], v4 offset:37632
    ds_read_b64_tr_b16 a[78:79], v4 offset:37760
    v_mfma_f32_16x16x32_bf16 v[40:43], a[124:127], v[216:219], v[40:43]
    buffer_load_dwordx4 v7, s[28:31], s45 offen offset:3456 lds
    v_mfma_f32_16x16x32_bf16 v[44:47], a[96:99], v[160:163], 0
    s_add_u32 m0, s44, 53760
    ds_read_b64_tr_b16 a[80:81], v4 offset:53760
    ds_read_b64_tr_b16 a[82:83], v4 offset:53888
    v_mfma_f32_16x16x32_bf16 v[44:47], a[100:103], v[168:171], v[44:47]
    s_mov_b32 s45, 148352
    buffer_load_dwordx4 v7, s[28:31], s45 offen offset:0 lds
    v_mfma_f32_16x16x32_bf16 v[44:47], a[104:107], v[176:179], v[44:47]
    s_add_u32 m0, s44, 53664
    ds_read_b64_tr_b16 a[84:85], v4 offset:54016
    ds_read_b64_tr_b16 a[86:87], v4 offset:54144
    v_mfma_f32_16x16x32_bf16 v[44:47], a[108:111], v[184:187], v[44:47]
    buffer_load_dwordx4 v7, s[28:31], s45 offen offset:1152 lds
    v_mfma_f32_16x16x32_bf16 v[44:47], a[112:115], v[224:227], v[44:47]
    s_add_u32 m0, s44, 53568
    ds_read_b64_tr_b16 a[88:89], v4 offset:54272
    ds_read_b64_tr_b16 a[90:91], v4 offset:54400
    v_mfma_f32_16x16x32_bf16 v[44:47], a[116:119], v[232:235], v[44:47]
    buffer_load_dwordx4 v7, s[28:31], s45 offen offset:2304 lds
    v_mfma_f32_16x16x32_bf16 v[44:47], a[120:123], v[240:243], v[44:47]
    s_add_u32 m0, s44, 53472
    ds_read_b64_tr_b16 a[92:93], v4 offset:54528
    ds_read_b64_tr_b16 a[94:95], v4 offset:54656
    v_mfma_f32_16x16x32_bf16 v[44:47], a[124:127], v[248:251], v[44:47]
    s_waitcnt lgkmcnt(12)
    buffer_load_dwordx4 v7, s[28:31], s45 offen offset:3456 lds
    v_mfma_f32_16x16x32_bf16 v[16:19], a[64:67], v[128:131], 0
    ds_read_b64_tr_b16 a[96:97], v4 offset:36896
    v_cvt_pk_bf16_f32 v48, v32, v33
    v_mfma_f32_16x16x32_bf16 v[16:19], a[68:71], v[136:139], v[16:19]
    s_waitcnt lgkmcnt(9)
    ds_read_b64_tr_b16 a[98:99], v4 offset:37024
    v_cvt_pk_bf16_f32 v49, v34, v35
    v_mfma_f32_16x16x32_bf16 v[16:19], a[72:75], v[144:147], v[16:19]
    ds_read_b64_tr_b16 a[100:101], v4 offset:37152
    v_cvt_pk_bf16_f32 v50, v40, v41
    v_mfma_f32_16x16x32_bf16 v[16:19], a[76:79], v[152:155], v[16:19]
    s_waitcnt lgkmcnt(7)
    ds_read_b64_tr_b16 a[102:103], v4 offset:37280
    v_cvt_pk_bf16_f32 v51, v42, v43
    v_mfma_f32_16x16x32_bf16 v[16:19], a[80:83], v[192:195], v[16:19]
    s_mov_b32 s54, 4096
    ds_read_b64_tr_b16 a[104:105], v4 offset:37408
    ds_read_b64_tr_b16 a[106:107], v4 offset:37536
    v_mfma_f32_16x16x32_bf16 v[16:19], a[84:87], v[200:203], v[16:19]
    s_waitcnt lgkmcnt(6)
    v_permlane32_swap_b32 v48, v50
    v_mfma_f32_16x16x32_bf16 v[16:19], a[88:91], v[208:211], v[16:19]
    v_permlane32_swap_b32 v49, v51
    v_mfma_f32_16x16x32_bf16 v[16:19], a[92:95], v[216:219], v[16:19]
    ds_read_b64_tr_b16 a[108:109], v4 offset:37664
    ds_read_b64_tr_b16 a[110:111], v4 offset:37792
    buffer_store_dwordx4 v[48:51], v10, s[40:43], s54 offen offset:512 sc1
    v_mfma_f32_16x16x32_bf16 v[20:23], a[64:67], v[160:163], 0
    ds_read_b64_tr_b16 a[112:113], v4 offset:53792
    v_cvt_pk_bf16_f32 v52, v36, v37
    v_mfma_f32_16x16x32_bf16 v[20:23], a[68:71], v[168:171], v[20:23]
    ds_read_b64_tr_b16 a[114:115], v4 offset:53920
    v_cvt_pk_bf16_f32 v53, v38, v39
    v_mfma_f32_16x16x32_bf16 v[20:23], a[72:75], v[176:179], v[20:23]
    ds_read_b64_tr_b16 a[116:117], v4 offset:54048
    v_cvt_pk_bf16_f32 v54, v44, v45
    v_mfma_f32_16x16x32_bf16 v[20:23], a[76:79], v[184:187], v[20:23]
    ds_read_b64_tr_b16 a[118:119], v4 offset:54176
    v_cvt_pk_bf16_f32 v55, v46, v47
    v_mfma_f32_16x16x32_bf16 v[20:23], a[80:83], v[224:227], v[20:23]
    s_mov_b32 s54, 299008
    ds_read_b64_tr_b16 a[120:121], v4 offset:54304
    ds_read_b64_tr_b16 a[122:123], v4 offset:54432
    v_mfma_f32_16x16x32_bf16 v[20:23], a[84:87], v[232:235], v[20:23]
    v_permlane32_swap_b32 v52, v54
    v_mfma_f32_16x16x32_bf16 v[20:23], a[88:91], v[240:243], v[20:23]
    v_permlane32_swap_b32 v53, v55
    v_mfma_f32_16x16x32_bf16 v[20:23], a[92:95], v[248:251], v[20:23]
    s_waitcnt lgkmcnt(10)
    ds_read_b64_tr_b16 a[124:125], v4 offset:54560
    ds_read_b64_tr_b16 a[126:127], v4 offset:54688
    buffer_store_dwordx4 v[52:55], v10, s[40:43], s54 offen offset:512 sc1
    v_mfma_f32_16x16x32_bf16 v[24:27], a[96:99], v[128:131], 0
    ds_read_b64_tr_b16 a[64:65], v4 offset:36928
    v_mfma_f32_16x16x32_bf16 v[24:27], a[100:103], v[136:139], v[24:27]
    s_waitcnt lgkmcnt(9)
    ds_read_b64_tr_b16 a[66:67], v4 offset:37056
    v_mfma_f32_16x16x32_bf16 v[24:27], a[104:107], v[144:147], v[24:27]
    ds_read_b64_tr_b16 a[68:69], v4 offset:37184
    v_mfma_f32_16x16x32_bf16 v[24:27], a[108:111], v[152:155], v[24:27]
    s_waitcnt lgkmcnt(7)
    ds_read_b64_tr_b16 a[70:71], v4 offset:37312
    v_mfma_f32_16x16x32_bf16 v[24:27], a[112:115], v[192:195], v[24:27]
    ds_read_b64_tr_b16 a[72:73], v4 offset:37440
    v_mfma_f32_16x16x32_bf16 v[24:27], a[116:119], v[200:203], v[24:27]
    s_waitcnt lgkmcnt(5)
    ds_read_b64_tr_b16 a[74:75], v4 offset:37568
    v_mfma_f32_16x16x32_bf16 v[24:27], a[120:123], v[208:211], v[24:27]
    ds_read_b64_tr_b16 a[76:77], v4 offset:37696
    v_mfma_f32_16x16x32_bf16 v[24:27], a[124:127], v[216:219], v[24:27]
    ds_read_b64_tr_b16 a[78:79], v4 offset:37824
    v_mfma_f32_16x16x32_bf16 v[28:31], a[96:99], v[160:163], 0
    ds_read_b64_tr_b16 a[80:81], v4 offset:53824
    v_mfma_f32_16x16x32_bf16 v[28:31], a[100:103], v[168:171], v[28:31]
    ds_read_b64_tr_b16 a[82:83], v4 offset:53952
    v_mfma_f32_16x16x32_bf16 v[28:31], a[104:107], v[176:179], v[28:31]
    ds_read_b64_tr_b16 a[84:85], v4 offset:54080
    v_mfma_f32_16x16x32_bf16 v[28:31], a[108:111], v[184:187], v[28:31]
    ds_read_b64_tr_b16 a[86:87], v4 offset:54208
    v_mfma_f32_16x16x32_bf16 v[28:31], a[112:115], v[224:227], v[28:31]
    ds_read_b64_tr_b16 a[88:89], v4 offset:54336
    v_mfma_f32_16x16x32_bf16 v[28:31], a[116:119], v[232:235], v[28:31]
    ds_read_b64_tr_b16 a[90:91], v4 offset:54464
    v_mfma_f32_16x16x32_bf16 v[28:31], a[120:123], v[240:243], v[28:31]
    ds_read_b64_tr_b16 a[92:93], v4 offset:54592
    v_mfma_f32_16x16x32_bf16 v[28:31], a[124:127], v[248:251], v[28:31]
    s_waitcnt lgkmcnt(11)
    ds_read_b64_tr_b16 a[94:95], v4 offset:54720
    v_mfma_f32_16x16x32_bf16 v[32:35], a[64:67], v[128:131], 0
    ds_read_b64_tr_b16 a[96:97], v4 offset:36960
    v_cvt_pk_bf16_f32 v48, v16, v17
    v_mfma_f32_16x16x32_bf16 v[32:35], a[68:71], v[136:139], v[32:35]
    s_waitcnt lgkmcnt(9)
    ds_read_b64_tr_b16 a[98:99], v4 offset:37088
    v_cvt_pk_bf16_f32 v49, v18, v19
    v_mfma_f32_16x16x32_bf16 v[32:35], a[72:75], v[144:147], v[32:35]
    ds_read_b64_tr_b16 a[100:101], v4 offset:37216
    v_cvt_pk_bf16_f32 v50, v24, v25
    v_mfma_f32_16x16x32_bf16 v[32:35], a[76:79], v[152:155], v[32:35]
    s_waitcnt lgkmcnt(7)
    ds_read_b64_tr_b16 a[102:103], v4 offset:37344
    v_cvt_pk_bf16_f32 v51, v26, v27
    v_mfma_f32_16x16x32_bf16 v[32:35], a[80:83], v[192:195], v[32:35]
    s_mov_b32 s54, 5120
    ds_read_b64_tr_b16 a[104:105], v4 offset:37472
    ds_read_b64_tr_b16 a[106:107], v4 offset:37600
    v_mfma_f32_16x16x32_bf16 v[32:35], a[84:87], v[200:203], v[32:35]
    s_waitcnt lgkmcnt(6)
    v_permlane32_swap_b32 v48, v50
    v_mfma_f32_16x16x32_bf16 v[32:35], a[88:91], v[208:211], v[32:35]
    v_permlane32_swap_b32 v49, v51
    v_mfma_f32_16x16x32_bf16 v[32:35], a[92:95], v[216:219], v[32:35]
    ds_read_b64_tr_b16 a[108:109], v4 offset:37728
    ds_read_b64_tr_b16 a[110:111], v4 offset:37856
    buffer_store_dwordx4 v[48:51], v10, s[40:43], s54 offen offset:0 sc1
    v_mfma_f32_16x16x32_bf16 v[36:39], a[64:67], v[160:163], 0
    ds_read_b64_tr_b16 a[112:113], v4 offset:53856
    v_cvt_pk_bf16_f32 v52, v20, v21
    v_mfma_f32_16x16x32_bf16 v[36:39], a[68:71], v[168:171], v[36:39]
    ds_read_b64_tr_b16 a[114:115], v4 offset:53984
    v_cvt_pk_bf16_f32 v53, v22, v23
    v_mfma_f32_16x16x32_bf16 v[36:39], a[72:75], v[176:179], v[36:39]
    ds_read_b64_tr_b16 a[116:117], v4 offset:54112
    v_cvt_pk_bf16_f32 v54, v28, v29
    v_mfma_f32_16x16x32_bf16 v[36:39], a[76:79], v[184:187], v[36:39]
    ds_read_b64_tr_b16 a[118:119], v4 offset:54240
    v_cvt_pk_bf16_f32 v55, v30, v31
    v_mfma_f32_16x16x32_bf16 v[36:39], a[80:83], v[224:227], v[36:39]
    s_mov_b32 s54, 300032
    ds_read_b64_tr_b16 a[120:121], v4 offset:54368
    ds_read_b64_tr_b16 a[122:123], v4 offset:54496
    v_mfma_f32_16x16x32_bf16 v[36:39], a[84:87], v[232:235], v[36:39]
    v_permlane32_swap_b32 v52, v54
    v_mfma_f32_16x16x32_bf16 v[36:39], a[88:91], v[240:243], v[36:39]
    v_permlane32_swap_b32 v53, v55
    v_mfma_f32_16x16x32_bf16 v[36:39], a[92:95], v[248:251], v[36:39]
    s_waitcnt vmcnt(15)
    s_barrier
    s_waitcnt lgkmcnt(10)
    ds_read_b64_tr_b16 a[124:125], v4 offset:54624
    ds_read_b64_tr_b16 a[126:127], v4 offset:54752
    buffer_store_dwordx4 v[52:55], v10, s[40:43], s54 offen offset:0 sc1
    v_mfma_f32_16x16x32_bf16 v[40:43], a[96:99], v[128:131], 0
    s_add_u32 m0, s44, 73728
    ds_read_b64_tr_b16 a[64:65], v3 offset:0
    ds_read_b64_tr_b16 a[66:67], v3 offset:128
    v_mfma_f32_16x16x32_bf16 v[40:43], a[100:103], v[136:139], v[40:43]
    s_mov_b32 s45, 1024
    s_waitcnt lgkmcnt(10)
    buffer_load_dwordx4 v7, s[28:31], s45 offen offset:0 lds
    v_mfma_f32_16x16x32_bf16 v[40:43], a[104:107], v[144:147], v[40:43]
    s_add_u32 m0, s44, 73632
    ds_read_b64_tr_b16 a[68:69], v3 offset:256
    ds_read_b64_tr_b16 a[70:71], v3 offset:384
    v_mfma_f32_16x16x32_bf16 v[40:43], a[108:111], v[152:155], v[40:43]
    s_waitcnt lgkmcnt(8)
    buffer_load_dwordx4 v7, s[28:31], s45 offen offset:1152 lds
    v_mfma_f32_16x16x32_bf16 v[40:43], a[112:115], v[192:195], v[40:43]
    s_add_u32 m0, s44, 73536
    ds_read_b64_tr_b16 a[72:73], v3 offset:512
    ds_read_b64_tr_b16 a[74:75], v3 offset:640
    v_mfma_f32_16x16x32_bf16 v[40:43], a[116:119], v[200:203], v[40:43]
    s_waitcnt lgkmcnt(6)
    buffer_load_dwordx4 v7, s[28:31], s45 offen offset:2304 lds
    v_mfma_f32_16x16x32_bf16 v[40:43], a[120:123], v[208:211], v[40:43]
    s_add_u32 m0, s44, 73440
    ds_read_b64_tr_b16 a[76:77], v3 offset:768
    ds_read_b64_tr_b16 a[78:79], v3 offset:896
    v_mfma_f32_16x16x32_bf16 v[40:43], a[124:127], v[216:219], v[40:43]
    buffer_load_dwordx4 v7, s[28:31], s45 offen offset:3456 lds
    v_mfma_f32_16x16x32_bf16 v[44:47], a[96:99], v[160:163], 0
    s_add_u32 m0, s44, 90624
    ds_read_b64_tr_b16 a[80:81], v3 offset:16896
    ds_read_b64_tr_b16 a[82:83], v3 offset:17024
    v_mfma_f32_16x16x32_bf16 v[44:47], a[100:103], v[168:171], v[44:47]
    s_mov_b32 s45, 148480
    buffer_load_dwordx4 v7, s[28:31], s45 offen offset:0 lds
    v_mfma_f32_16x16x32_bf16 v[44:47], a[104:107], v[176:179], v[44:47]
    s_add_u32 m0, s44, 90528
    ds_read_b64_tr_b16 a[84:85], v3 offset:17152
    ds_read_b64_tr_b16 a[86:87], v3 offset:17280
    v_mfma_f32_16x16x32_bf16 v[44:47], a[108:111], v[184:187], v[44:47]
    buffer_load_dwordx4 v7, s[28:31], s45 offen offset:1152 lds
    v_mfma_f32_16x16x32_bf16 v[44:47], a[112:115], v[224:227], v[44:47]
    s_add_u32 m0, s44, 90432
    ds_read_b64_tr_b16 a[88:89], v3 offset:17408
    ds_read_b64_tr_b16 a[90:91], v3 offset:17536
    v_mfma_f32_16x16x32_bf16 v[44:47], a[116:119], v[232:235], v[44:47]
    buffer_load_dwordx4 v7, s[28:31], s45 offen offset:2304 lds
    v_mfma_f32_16x16x32_bf16 v[44:47], a[120:123], v[240:243], v[44:47]
    s_add_u32 m0, s44, 90336
    ds_read_b64_tr_b16 a[92:93], v3 offset:17664
    ds_read_b64_tr_b16 a[94:95], v3 offset:17792
    v_mfma_f32_16x16x32_bf16 v[44:47], a[124:127], v[248:251], v[44:47]
    s_waitcnt lgkmcnt(12)
    buffer_load_dwordx4 v7, s[28:31], s45 offen offset:3456 lds
    v_mfma_f32_16x16x32_bf16 v[16:19], a[64:67], v[128:131], 0
    ds_read_b64_tr_b16 a[96:97], v3 offset:32
    v_cvt_pk_bf16_f32 v48, v32, v33
    v_mfma_f32_16x16x32_bf16 v[16:19], a[68:71], v[136:139], v[16:19]
    s_waitcnt lgkmcnt(9)
    ds_read_b64_tr_b16 a[98:99], v3 offset:160
    v_cvt_pk_bf16_f32 v49, v34, v35
    v_mfma_f32_16x16x32_bf16 v[16:19], a[72:75], v[144:147], v[16:19]
    ds_read_b64_tr_b16 a[100:101], v3 offset:288
    v_cvt_pk_bf16_f32 v50, v40, v41
    v_mfma_f32_16x16x32_bf16 v[16:19], a[76:79], v[152:155], v[16:19]
    s_waitcnt lgkmcnt(7)
    ds_read_b64_tr_b16 a[102:103], v3 offset:416
    v_cvt_pk_bf16_f32 v51, v42, v43
    v_mfma_f32_16x16x32_bf16 v[16:19], a[80:83], v[192:195], v[16:19]
    s_mov_b32 s54, 5120
    ds_read_b64_tr_b16 a[104:105], v3 offset:544
    ds_read_b64_tr_b16 a[106:107], v3 offset:672
    v_mfma_f32_16x16x32_bf16 v[16:19], a[84:87], v[200:203], v[16:19]
    s_waitcnt lgkmcnt(6)
    v_permlane32_swap_b32 v48, v50
    v_mfma_f32_16x16x32_bf16 v[16:19], a[88:91], v[208:211], v[16:19]
    v_permlane32_swap_b32 v49, v51
    v_mfma_f32_16x16x32_bf16 v[16:19], a[92:95], v[216:219], v[16:19]
    ds_read_b64_tr_b16 a[108:109], v3 offset:800
    ds_read_b64_tr_b16 a[110:111], v3 offset:928
    buffer_store_dwordx4 v[48:51], v10, s[40:43], s54 offen offset:512 sc1
    v_mfma_f32_16x16x32_bf16 v[20:23], a[64:67], v[160:163], 0
    ds_read_b64_tr_b16 a[112:113], v3 offset:16928
    v_cvt_pk_bf16_f32 v52, v36, v37
    v_mfma_f32_16x16x32_bf16 v[20:23], a[68:71], v[168:171], v[20:23]
    ds_read_b64_tr_b16 a[114:115], v3 offset:17056
    v_cvt_pk_bf16_f32 v53, v38, v39
    v_mfma_f32_16x16x32_bf16 v[20:23], a[72:75], v[176:179], v[20:23]
    ds_read_b64_tr_b16 a[116:117], v3 offset:17184
    v_cvt_pk_bf16_f32 v54, v44, v45
    v_mfma_f32_16x16x32_bf16 v[20:23], a[76:79], v[184:187], v[20:23]
    ds_read_b64_tr_b16 a[118:119], v3 offset:17312
    v_cvt_pk_bf16_f32 v55, v46, v47
    v_mfma_f32_16x16x32_bf16 v[20:23], a[80:83], v[224:227], v[20:23]
    s_mov_b32 s54, 300032
    ds_read_b64_tr_b16 a[120:121], v3 offset:17440
    ds_read_b64_tr_b16 a[122:123], v3 offset:17568
    v_mfma_f32_16x16x32_bf16 v[20:23], a[84:87], v[232:235], v[20:23]
    v_permlane32_swap_b32 v52, v54
    v_mfma_f32_16x16x32_bf16 v[20:23], a[88:91], v[240:243], v[20:23]
    v_permlane32_swap_b32 v53, v55
    v_mfma_f32_16x16x32_bf16 v[20:23], a[92:95], v[248:251], v[20:23]
    s_waitcnt lgkmcnt(10)
    ds_read_b64_tr_b16 a[124:125], v3 offset:17696
    ds_read_b64_tr_b16 a[126:127], v3 offset:17824
    buffer_store_dwordx4 v[52:55], v10, s[40:43], s54 offen offset:512 sc1
    v_mfma_f32_16x16x32_bf16 v[24:27], a[96:99], v[128:131], 0
    ds_read_b64_tr_b16 a[64:65], v3 offset:64
    v_mfma_f32_16x16x32_bf16 v[24:27], a[100:103], v[136:139], v[24:27]
    s_waitcnt lgkmcnt(9)
    ds_read_b64_tr_b16 a[66:67], v3 offset:192
    v_mfma_f32_16x16x32_bf16 v[24:27], a[104:107], v[144:147], v[24:27]
    ds_read_b64_tr_b16 a[68:69], v3 offset:320
    v_mfma_f32_16x16x32_bf16 v[24:27], a[108:111], v[152:155], v[24:27]
    s_waitcnt lgkmcnt(7)
    ds_read_b64_tr_b16 a[70:71], v3 offset:448
    v_mfma_f32_16x16x32_bf16 v[24:27], a[112:115], v[192:195], v[24:27]
    ds_read_b64_tr_b16 a[72:73], v3 offset:576
    v_mfma_f32_16x16x32_bf16 v[24:27], a[116:119], v[200:203], v[24:27]
    s_waitcnt lgkmcnt(5)
    ds_read_b64_tr_b16 a[74:75], v3 offset:704
    v_mfma_f32_16x16x32_bf16 v[24:27], a[120:123], v[208:211], v[24:27]
    ds_read_b64_tr_b16 a[76:77], v3 offset:832
    v_mfma_f32_16x16x32_bf16 v[24:27], a[124:127], v[216:219], v[24:27]
    ds_read_b64_tr_b16 a[78:79], v3 offset:960
    v_mfma_f32_16x16x32_bf16 v[28:31], a[96:99], v[160:163], 0
    ds_read_b64_tr_b16 a[80:81], v3 offset:16960
    v_mfma_f32_16x16x32_bf16 v[28:31], a[100:103], v[168:171], v[28:31]
    ds_read_b64_tr_b16 a[82:83], v3 offset:17088
    v_mfma_f32_16x16x32_bf16 v[28:31], a[104:107], v[176:179], v[28:31]
    ds_read_b64_tr_b16 a[84:85], v3 offset:17216
    v_mfma_f32_16x16x32_bf16 v[28:31], a[108:111], v[184:187], v[28:31]
    ds_read_b64_tr_b16 a[86:87], v3 offset:17344
    v_mfma_f32_16x16x32_bf16 v[28:31], a[112:115], v[224:227], v[28:31]
    ds_read_b64_tr_b16 a[88:89], v3 offset:17472
    v_mfma_f32_16x16x32_bf16 v[28:31], a[116:119], v[232:235], v[28:31]
    ds_read_b64_tr_b16 a[90:91], v3 offset:17600
    v_mfma_f32_16x16x32_bf16 v[28:31], a[120:123], v[240:243], v[28:31]
    ds_read_b64_tr_b16 a[92:93], v3 offset:17728
    v_mfma_f32_16x16x32_bf16 v[28:31], a[124:127], v[248:251], v[28:31]
    s_waitcnt lgkmcnt(11)
    ds_read_b64_tr_b16 a[94:95], v3 offset:17856
    v_mfma_f32_16x16x32_bf16 v[32:35], a[64:67], v[128:131], 0
    ds_read_b64_tr_b16 a[96:97], v3 offset:96
    v_cvt_pk_bf16_f32 v48, v16, v17
    v_mfma_f32_16x16x32_bf16 v[32:35], a[68:71], v[136:139], v[32:35]
    s_waitcnt lgkmcnt(9)
    ds_read_b64_tr_b16 a[98:99], v3 offset:224
    v_cvt_pk_bf16_f32 v49, v18, v19
    v_mfma_f32_16x16x32_bf16 v[32:35], a[72:75], v[144:147], v[32:35]
    ds_read_b64_tr_b16 a[100:101], v3 offset:352
    v_cvt_pk_bf16_f32 v50, v24, v25
    v_mfma_f32_16x16x32_bf16 v[32:35], a[76:79], v[152:155], v[32:35]
    s_waitcnt lgkmcnt(7)
    ds_read_b64_tr_b16 a[102:103], v3 offset:480
    v_cvt_pk_bf16_f32 v51, v26, v27
    v_mfma_f32_16x16x32_bf16 v[32:35], a[80:83], v[192:195], v[32:35]
    s_mov_b32 s54, 6144
    ds_read_b64_tr_b16 a[104:105], v3 offset:608
    ds_read_b64_tr_b16 a[106:107], v3 offset:736
    v_mfma_f32_16x16x32_bf16 v[32:35], a[84:87], v[200:203], v[32:35]
    s_waitcnt lgkmcnt(6)
    v_permlane32_swap_b32 v48, v50
    v_mfma_f32_16x16x32_bf16 v[32:35], a[88:91], v[208:211], v[32:35]
    v_permlane32_swap_b32 v49, v51
    v_mfma_f32_16x16x32_bf16 v[32:35], a[92:95], v[216:219], v[32:35]
    ds_read_b64_tr_b16 a[108:109], v3 offset:864
    ds_read_b64_tr_b16 a[110:111], v3 offset:992
    buffer_store_dwordx4 v[48:51], v10, s[40:43], s54 offen offset:0 sc1
    v_mfma_f32_16x16x32_bf16 v[36:39], a[64:67], v[160:163], 0
    ds_read_b64_tr_b16 a[112:113], v3 offset:16992
    v_cvt_pk_bf16_f32 v52, v20, v21
    v_mfma_f32_16x16x32_bf16 v[36:39], a[68:71], v[168:171], v[36:39]
    ds_read_b64_tr_b16 a[114:115], v3 offset:17120
    v_cvt_pk_bf16_f32 v53, v22, v23
    v_mfma_f32_16x16x32_bf16 v[36:39], a[72:75], v[176:179], v[36:39]
    ds_read_b64_tr_b16 a[116:117], v3 offset:17248
    v_cvt_pk_bf16_f32 v54, v28, v29
    v_mfma_f32_16x16x32_bf16 v[36:39], a[76:79], v[184:187], v[36:39]
    ds_read_b64_tr_b16 a[118:119], v3 offset:17376
    v_cvt_pk_bf16_f32 v55, v30, v31
    v_mfma_f32_16x16x32_bf16 v[36:39], a[80:83], v[224:227], v[36:39]
    s_mov_b32 s54, 301056
    ds_read_b64_tr_b16 a[120:121], v3 offset:17504
    ds_read_b64_tr_b16 a[122:123], v3 offset:17632
    v_mfma_f32_16x16x32_bf16 v[36:39], a[84:87], v[232:235], v[36:39]
    v_permlane32_swap_b32 v52, v54
    v_mfma_f32_16x16x32_bf16 v[36:39], a[88:91], v[240:243], v[36:39]
    v_permlane32_swap_b32 v53, v55
    v_mfma_f32_16x16x32_bf16 v[36:39], a[92:95], v[248:251], v[36:39]
    s_waitcnt vmcnt(15)
    s_barrier
    s_waitcnt lgkmcnt(10)
    ds_read_b64_tr_b16 a[124:125], v3 offset:17760
    ds_read_b64_tr_b16 a[126:127], v3 offset:17888
    buffer_store_dwordx4 v[52:55], v10, s[40:43], s54 offen offset:0 sc1
    v_mfma_f32_16x16x32_bf16 v[40:43], a[96:99], v[128:131], 0
    ds_read_b64_tr_b16 a[64:65], v3 offset:36864
    v_mfma_f32_16x16x32_bf16 v[40:43], a[100:103], v[136:139], v[40:43]
    s_waitcnt lgkmcnt(9)
    ds_read_b64_tr_b16 a[66:67], v3 offset:36992
    v_mfma_f32_16x16x32_bf16 v[40:43], a[104:107], v[144:147], v[40:43]
    ds_read_b64_tr_b16 a[68:69], v3 offset:37120
    v_mfma_f32_16x16x32_bf16 v[40:43], a[108:111], v[152:155], v[40:43]
    s_waitcnt lgkmcnt(7)
    ds_read_b64_tr_b16 a[70:71], v3 offset:37248
    v_mfma_f32_16x16x32_bf16 v[40:43], a[112:115], v[192:195], v[40:43]
    ds_read_b64_tr_b16 a[72:73], v3 offset:37376
    v_mfma_f32_16x16x32_bf16 v[40:43], a[116:119], v[200:203], v[40:43]
    s_waitcnt lgkmcnt(5)
    ds_read_b64_tr_b16 a[74:75], v3 offset:37504
    v_mfma_f32_16x16x32_bf16 v[40:43], a[120:123], v[208:211], v[40:43]
    ds_read_b64_tr_b16 a[76:77], v3 offset:37632
    v_mfma_f32_16x16x32_bf16 v[40:43], a[124:127], v[216:219], v[40:43]
    ds_read_b64_tr_b16 a[78:79], v3 offset:37760
    v_mfma_f32_16x16x32_bf16 v[44:47], a[96:99], v[160:163], 0
    ds_read_b64_tr_b16 a[80:81], v3 offset:53760
    v_mfma_f32_16x16x32_bf16 v[44:47], a[100:103], v[168:171], v[44:47]
    ds_read_b64_tr_b16 a[82:83], v3 offset:53888
    v_mfma_f32_16x16x32_bf16 v[44:47], a[104:107], v[176:179], v[44:47]
    ds_read_b64_tr_b16 a[84:85], v3 offset:54016
    v_mfma_f32_16x16x32_bf16 v[44:47], a[108:111], v[184:187], v[44:47]
    ds_read_b64_tr_b16 a[86:87], v3 offset:54144
    v_mfma_f32_16x16x32_bf16 v[44:47], a[112:115], v[224:227], v[44:47]
    ds_read_b64_tr_b16 a[88:89], v3 offset:54272
    v_mfma_f32_16x16x32_bf16 v[44:47], a[116:119], v[232:235], v[44:47]
    ds_read_b64_tr_b16 a[90:91], v3 offset:54400
    v_mfma_f32_16x16x32_bf16 v[44:47], a[120:123], v[240:243], v[44:47]
    ds_read_b64_tr_b16 a[92:93], v3 offset:54528
    v_mfma_f32_16x16x32_bf16 v[44:47], a[124:127], v[248:251], v[44:47]
    s_waitcnt lgkmcnt(11)
    ds_read_b64_tr_b16 a[94:95], v3 offset:54656
    v_mfma_f32_16x16x32_bf16 v[16:19], a[64:67], v[128:131], 0
    ds_read_b64_tr_b16 a[96:97], v3 offset:36896
    v_cvt_pk_bf16_f32 v48, v32, v33
    v_mfma_f32_16x16x32_bf16 v[16:19], a[68:71], v[136:139], v[16:19]
    s_waitcnt lgkmcnt(9)
    ds_read_b64_tr_b16 a[98:99], v3 offset:37024
    v_cvt_pk_bf16_f32 v49, v34, v35
    v_mfma_f32_16x16x32_bf16 v[16:19], a[72:75], v[144:147], v[16:19]
    ds_read_b64_tr_b16 a[100:101], v3 offset:37152
    v_cvt_pk_bf16_f32 v50, v40, v41
    v_mfma_f32_16x16x32_bf16 v[16:19], a[76:79], v[152:155], v[16:19]
    s_waitcnt lgkmcnt(7)
    ds_read_b64_tr_b16 a[102:103], v3 offset:37280
    v_cvt_pk_bf16_f32 v51, v42, v43
    v_mfma_f32_16x16x32_bf16 v[16:19], a[80:83], v[192:195], v[16:19]
    s_mov_b32 s54, 6144
    ds_read_b64_tr_b16 a[104:105], v3 offset:37408
    ds_read_b64_tr_b16 a[106:107], v3 offset:37536
    v_mfma_f32_16x16x32_bf16 v[16:19], a[84:87], v[200:203], v[16:19]
    s_waitcnt lgkmcnt(6)
    v_permlane32_swap_b32 v48, v50
    v_mfma_f32_16x16x32_bf16 v[16:19], a[88:91], v[208:211], v[16:19]
    v_permlane32_swap_b32 v49, v51
    v_mfma_f32_16x16x32_bf16 v[16:19], a[92:95], v[216:219], v[16:19]
    ds_read_b64_tr_b16 a[108:109], v3 offset:37664
    ds_read_b64_tr_b16 a[110:111], v3 offset:37792
    buffer_store_dwordx4 v[48:51], v10, s[40:43], s54 offen offset:512 sc1
    v_mfma_f32_16x16x32_bf16 v[20:23], a[64:67], v[160:163], 0
    ds_read_b64_tr_b16 a[112:113], v3 offset:53792
    v_cvt_pk_bf16_f32 v52, v36, v37
    v_mfma_f32_16x16x32_bf16 v[20:23], a[68:71], v[168:171], v[20:23]
    ds_read_b64_tr_b16 a[114:115], v3 offset:53920
    v_cvt_pk_bf16_f32 v53, v38, v39
    v_mfma_f32_16x16x32_bf16 v[20:23], a[72:75], v[176:179], v[20:23]
    ds_read_b64_tr_b16 a[116:117], v3 offset:54048
    v_cvt_pk_bf16_f32 v54, v44, v45
    v_mfma_f32_16x16x32_bf16 v[20:23], a[76:79], v[184:187], v[20:23]
    ds_read_b64_tr_b16 a[118:119], v3 offset:54176
    v_cvt_pk_bf16_f32 v55, v46, v47
    v_mfma_f32_16x16x32_bf16 v[20:23], a[80:83], v[224:227], v[20:23]
    s_mov_b32 s54, 301056
    ds_read_b64_tr_b16 a[120:121], v3 offset:54304
    ds_read_b64_tr_b16 a[122:123], v3 offset:54432
    v_mfma_f32_16x16x32_bf16 v[20:23], a[84:87], v[232:235], v[20:23]
    v_permlane32_swap_b32 v52, v54
    v_mfma_f32_16x16x32_bf16 v[20:23], a[88:91], v[240:243], v[20:23]
    v_permlane32_swap_b32 v53, v55
    v_mfma_f32_16x16x32_bf16 v[20:23], a[92:95], v[248:251], v[20:23]
    s_waitcnt lgkmcnt(10)
    ds_read_b64_tr_b16 a[124:125], v3 offset:54560
    ds_read_b64_tr_b16 a[126:127], v3 offset:54688
    buffer_store_dwordx4 v[52:55], v10, s[40:43], s54 offen offset:512 sc1
    v_mfma_f32_16x16x32_bf16 v[24:27], a[96:99], v[128:131], 0
    ds_read_b64_tr_b16 a[64:65], v3 offset:36928
    v_mfma_f32_16x16x32_bf16 v[24:27], a[100:103], v[136:139], v[24:27]
    s_waitcnt lgkmcnt(9)
    ds_read_b64_tr_b16 a[66:67], v3 offset:37056
    v_mfma_f32_16x16x32_bf16 v[24:27], a[104:107], v[144:147], v[24:27]
    ds_read_b64_tr_b16 a[68:69], v3 offset:37184
    v_mfma_f32_16x16x32_bf16 v[24:27], a[108:111], v[152:155], v[24:27]
    s_waitcnt lgkmcnt(7)
    ds_read_b64_tr_b16 a[70:71], v3 offset:37312
    v_mfma_f32_16x16x32_bf16 v[24:27], a[112:115], v[192:195], v[24:27]
    ds_read_b64_tr_b16 a[72:73], v3 offset:37440
    v_mfma_f32_16x16x32_bf16 v[24:27], a[116:119], v[200:203], v[24:27]
    s_waitcnt lgkmcnt(5)
    ds_read_b64_tr_b16 a[74:75], v3 offset:37568
    v_mfma_f32_16x16x32_bf16 v[24:27], a[120:123], v[208:211], v[24:27]
    ds_read_b64_tr_b16 a[76:77], v3 offset:37696
    v_mfma_f32_16x16x32_bf16 v[24:27], a[124:127], v[216:219], v[24:27]
    ds_read_b64_tr_b16 a[78:79], v3 offset:37824
    v_mfma_f32_16x16x32_bf16 v[28:31], a[96:99], v[160:163], 0
    ds_read_b64_tr_b16 a[80:81], v3 offset:53824
    v_mfma_f32_16x16x32_bf16 v[28:31], a[100:103], v[168:171], v[28:31]
    ds_read_b64_tr_b16 a[82:83], v3 offset:53952
    v_mfma_f32_16x16x32_bf16 v[28:31], a[104:107], v[176:179], v[28:31]
    ds_read_b64_tr_b16 a[84:85], v3 offset:54080
    v_mfma_f32_16x16x32_bf16 v[28:31], a[108:111], v[184:187], v[28:31]
    ds_read_b64_tr_b16 a[86:87], v3 offset:54208
    v_mfma_f32_16x16x32_bf16 v[28:31], a[112:115], v[224:227], v[28:31]
    ds_read_b64_tr_b16 a[88:89], v3 offset:54336
    v_mfma_f32_16x16x32_bf16 v[28:31], a[116:119], v[232:235], v[28:31]
    ds_read_b64_tr_b16 a[90:91], v3 offset:54464
    v_mfma_f32_16x16x32_bf16 v[28:31], a[120:123], v[240:243], v[28:31]
    ds_read_b64_tr_b16 a[92:93], v3 offset:54592
    v_mfma_f32_16x16x32_bf16 v[28:31], a[124:127], v[248:251], v[28:31]
    s_waitcnt lgkmcnt(11)
    ds_read_b64_tr_b16 a[94:95], v3 offset:54720
    v_mfma_f32_16x16x32_bf16 v[32:35], a[64:67], v[128:131], 0
    ds_read_b64_tr_b16 a[96:97], v3 offset:36960
    v_cvt_pk_bf16_f32 v48, v16, v17
    v_mfma_f32_16x16x32_bf16 v[32:35], a[68:71], v[136:139], v[32:35]
    s_waitcnt lgkmcnt(9)
    ds_read_b64_tr_b16 a[98:99], v3 offset:37088
    v_cvt_pk_bf16_f32 v49, v18, v19
    v_mfma_f32_16x16x32_bf16 v[32:35], a[72:75], v[144:147], v[32:35]
    ds_read_b64_tr_b16 a[100:101], v3 offset:37216
    v_cvt_pk_bf16_f32 v50, v24, v25
    v_mfma_f32_16x16x32_bf16 v[32:35], a[76:79], v[152:155], v[32:35]
    s_waitcnt lgkmcnt(7)
    ds_read_b64_tr_b16 a[102:103], v3 offset:37344
    v_cvt_pk_bf16_f32 v51, v26, v27
    v_mfma_f32_16x16x32_bf16 v[32:35], a[80:83], v[192:195], v[32:35]
    s_mov_b32 s54, 7168
    ds_read_b64_tr_b16 a[104:105], v3 offset:37472
    ds_read_b64_tr_b16 a[106:107], v3 offset:37600
    v_mfma_f32_16x16x32_bf16 v[32:35], a[84:87], v[200:203], v[32:35]
    s_waitcnt lgkmcnt(6)
    v_permlane32_swap_b32 v48, v50
    v_mfma_f32_16x16x32_bf16 v[32:35], a[88:91], v[208:211], v[32:35]
    v_permlane32_swap_b32 v49, v51
    v_mfma_f32_16x16x32_bf16 v[32:35], a[92:95], v[216:219], v[32:35]
    ds_read_b64_tr_b16 a[108:109], v3 offset:37728
    ds_read_b64_tr_b16 a[110:111], v3 offset:37856
    buffer_store_dwordx4 v[48:51], v10, s[40:43], s54 offen offset:0 sc1
    v_mfma_f32_16x16x32_bf16 v[36:39], a[64:67], v[160:163], 0
    ds_read_b64_tr_b16 a[112:113], v3 offset:53856
    v_cvt_pk_bf16_f32 v52, v20, v21
    v_mfma_f32_16x16x32_bf16 v[36:39], a[68:71], v[168:171], v[36:39]
    ds_read_b64_tr_b16 a[114:115], v3 offset:53984
    v_cvt_pk_bf16_f32 v53, v22, v23
    v_mfma_f32_16x16x32_bf16 v[36:39], a[72:75], v[176:179], v[36:39]
    ds_read_b64_tr_b16 a[116:117], v3 offset:54112
    v_cvt_pk_bf16_f32 v54, v28, v29
    v_mfma_f32_16x16x32_bf16 v[36:39], a[76:79], v[184:187], v[36:39]
    ds_read_b64_tr_b16 a[118:119], v3 offset:54240
    v_cvt_pk_bf16_f32 v55, v30, v31
    v_mfma_f32_16x16x32_bf16 v[36:39], a[80:83], v[224:227], v[36:39]
    s_mov_b32 s54, 302080
    ds_read_b64_tr_b16 a[120:121], v3 offset:54368
    ds_read_b64_tr_b16 a[122:123], v3 offset:54496
    v_mfma_f32_16x16x32_bf16 v[36:39], a[84:87], v[232:235], v[36:39]
    v_permlane32_swap_b32 v52, v54
    v_mfma_f32_16x16x32_bf16 v[36:39], a[88:91], v[240:243], v[36:39]
    v_permlane32_swap_b32 v53, v55
    v_mfma_f32_16x16x32_bf16 v[36:39], a[92:95], v[248:251], v[36:39]
    s_waitcnt vmcnt(7)
    s_barrier
    s_waitcnt lgkmcnt(10)
    ds_read_b64_tr_b16 a[124:125], v3 offset:54624
    ds_read_b64_tr_b16 a[126:127], v3 offset:54752
    buffer_store_dwordx4 v[52:55], v10, s[40:43], s54 offen offset:0 sc1
    v_mfma_f32_16x16x32_bf16 v[40:43], a[96:99], v[128:131], 0
    ds_read_b64_tr_b16 a[64:65], v4 offset:0
    v_mfma_f32_16x16x32_bf16 v[40:43], a[100:103], v[136:139], v[40:43]
    s_waitcnt lgkmcnt(9)
    ds_read_b64_tr_b16 a[66:67], v4 offset:128
    v_mfma_f32_16x16x32_bf16 v[40:43], a[104:107], v[144:147], v[40:43]
    ds_read_b64_tr_b16 a[68:69], v4 offset:256
    v_mfma_f32_16x16x32_bf16 v[40:43], a[108:111], v[152:155], v[40:43]
    s_waitcnt lgkmcnt(7)
    ds_read_b64_tr_b16 a[70:71], v4 offset:384
    v_mfma_f32_16x16x32_bf16 v[40:43], a[112:115], v[192:195], v[40:43]
    ds_read_b64_tr_b16 a[72:73], v4 offset:512
    v_mfma_f32_16x16x32_bf16 v[40:43], a[116:119], v[200:203], v[40:43]
    s_waitcnt lgkmcnt(5)
    ds_read_b64_tr_b16 a[74:75], v4 offset:640
    v_mfma_f32_16x16x32_bf16 v[40:43], a[120:123], v[208:211], v[40:43]
    ds_read_b64_tr_b16 a[76:77], v4 offset:768
    v_mfma_f32_16x16x32_bf16 v[40:43], a[124:127], v[216:219], v[40:43]
    ds_read_b64_tr_b16 a[78:79], v4 offset:896
    v_mfma_f32_16x16x32_bf16 v[44:47], a[96:99], v[160:163], 0
    ds_read_b64_tr_b16 a[80:81], v4 offset:16896
    v_mfma_f32_16x16x32_bf16 v[44:47], a[100:103], v[168:171], v[44:47]
    ds_read_b64_tr_b16 a[82:83], v4 offset:17024
    v_mfma_f32_16x16x32_bf16 v[44:47], a[104:107], v[176:179], v[44:47]
    ds_read_b64_tr_b16 a[84:85], v4 offset:17152
    v_mfma_f32_16x16x32_bf16 v[44:47], a[108:111], v[184:187], v[44:47]
    ds_read_b64_tr_b16 a[86:87], v4 offset:17280
    v_mfma_f32_16x16x32_bf16 v[44:47], a[112:115], v[224:227], v[44:47]
    ds_read_b64_tr_b16 a[88:89], v4 offset:17408
    v_mfma_f32_16x16x32_bf16 v[44:47], a[116:119], v[232:235], v[44:47]
    ds_read_b64_tr_b16 a[90:91], v4 offset:17536
    v_mfma_f32_16x16x32_bf16 v[44:47], a[120:123], v[240:243], v[44:47]
    ds_read_b64_tr_b16 a[92:93], v4 offset:17664
    v_mfma_f32_16x16x32_bf16 v[44:47], a[124:127], v[248:251], v[44:47]
    s_waitcnt lgkmcnt(11)
    ds_read_b64_tr_b16 a[94:95], v4 offset:17792
    v_mfma_f32_16x16x32_bf16 v[16:19], a[64:67], v[128:131], 0
    ds_read_b64_tr_b16 a[96:97], v4 offset:32
    v_cvt_pk_bf16_f32 v48, v32, v33
    v_mfma_f32_16x16x32_bf16 v[16:19], a[68:71], v[136:139], v[16:19]
    s_waitcnt lgkmcnt(9)
    ds_read_b64_tr_b16 a[98:99], v4 offset:160
    v_cvt_pk_bf16_f32 v49, v34, v35
    v_mfma_f32_16x16x32_bf16 v[16:19], a[72:75], v[144:147], v[16:19]
    ds_read_b64_tr_b16 a[100:101], v4 offset:288
    v_cvt_pk_bf16_f32 v50, v40, v41
    v_mfma_f32_16x16x32_bf16 v[16:19], a[76:79], v[152:155], v[16:19]
    s_waitcnt lgkmcnt(7)
    ds_read_b64_tr_b16 a[102:103], v4 offset:416
    v_cvt_pk_bf16_f32 v51, v42, v43
    v_mfma_f32_16x16x32_bf16 v[16:19], a[80:83], v[192:195], v[16:19]
    s_mov_b32 s54, 7168
    ds_read_b64_tr_b16 a[104:105], v4 offset:544
    ds_read_b64_tr_b16 a[106:107], v4 offset:672
    v_mfma_f32_16x16x32_bf16 v[16:19], a[84:87], v[200:203], v[16:19]
    s_waitcnt lgkmcnt(6)
    v_permlane32_swap_b32 v48, v50
    v_mfma_f32_16x16x32_bf16 v[16:19], a[88:91], v[208:211], v[16:19]
    v_permlane32_swap_b32 v49, v51
    v_mfma_f32_16x16x32_bf16 v[16:19], a[92:95], v[216:219], v[16:19]
    ds_read_b64_tr_b16 a[108:109], v4 offset:800
    ds_read_b64_tr_b16 a[110:111], v4 offset:928
    buffer_store_dwordx4 v[48:51], v10, s[40:43], s54 offen offset:512 sc1
    v_mfma_f32_16x16x32_bf16 v[20:23], a[64:67], v[160:163], 0
    ds_read_b64_tr_b16 a[112:113], v4 offset:16928
    v_cvt_pk_bf16_f32 v52, v36, v37
    v_mfma_f32_16x16x32_bf16 v[20:23], a[68:71], v[168:171], v[20:23]
    ds_read_b64_tr_b16 a[114:115], v4 offset:17056
    v_cvt_pk_bf16_f32 v53, v38, v39
    v_mfma_f32_16x16x32_bf16 v[20:23], a[72:75], v[176:179], v[20:23]
    ds_read_b64_tr_b16 a[116:117], v4 offset:17184
    v_cvt_pk_bf16_f32 v54, v44, v45
    v_mfma_f32_16x16x32_bf16 v[20:23], a[76:79], v[184:187], v[20:23]
    ds_read_b64_tr_b16 a[118:119], v4 offset:17312
    v_cvt_pk_bf16_f32 v55, v46, v47
    v_mfma_f32_16x16x32_bf16 v[20:23], a[80:83], v[224:227], v[20:23]
    s_mov_b32 s54, 302080
    ds_read_b64_tr_b16 a[120:121], v4 offset:17440
    ds_read_b64_tr_b16 a[122:123], v4 offset:17568
    v_mfma_f32_16x16x32_bf16 v[20:23], a[84:87], v[232:235], v[20:23]
    v_permlane32_swap_b32 v52, v54
    v_mfma_f32_16x16x32_bf16 v[20:23], a[88:91], v[240:243], v[20:23]
    v_permlane32_swap_b32 v53, v55
    v_mfma_f32_16x16x32_bf16 v[20:23], a[92:95], v[248:251], v[20:23]
    s_waitcnt lgkmcnt(10)
    ds_read_b64_tr_b16 a[124:125], v4 offset:17696
    ds_read_b64_tr_b16 a[126:127], v4 offset:17824
    buffer_store_dwordx4 v[52:55], v10, s[40:43], s54 offen offset:512 sc1
    v_mfma_f32_16x16x32_bf16 v[24:27], a[96:99], v[128:131], 0
    ds_read_b64_tr_b16 a[64:65], v4 offset:64
    v_mfma_f32_16x16x32_bf16 v[24:27], a[100:103], v[136:139], v[24:27]
    s_waitcnt lgkmcnt(9)
    ds_read_b64_tr_b16 a[66:67], v4 offset:192
    v_mfma_f32_16x16x32_bf16 v[24:27], a[104:107], v[144:147], v[24:27]
    ds_read_b64_tr_b16 a[68:69], v4 offset:320
    v_mfma_f32_16x16x32_bf16 v[24:27], a[108:111], v[152:155], v[24:27]
    s_waitcnt lgkmcnt(7)
    ds_read_b64_tr_b16 a[70:71], v4 offset:448
    v_mfma_f32_16x16x32_bf16 v[24:27], a[112:115], v[192:195], v[24:27]
    ds_read_b64_tr_b16 a[72:73], v4 offset:576
    v_mfma_f32_16x16x32_bf16 v[24:27], a[116:119], v[200:203], v[24:27]
    s_waitcnt lgkmcnt(5)
    ds_read_b64_tr_b16 a[74:75], v4 offset:704
    v_mfma_f32_16x16x32_bf16 v[24:27], a[120:123], v[208:211], v[24:27]
    ds_read_b64_tr_b16 a[76:77], v4 offset:832
    v_mfma_f32_16x16x32_bf16 v[24:27], a[124:127], v[216:219], v[24:27]
    ds_read_b64_tr_b16 a[78:79], v4 offset:960
    v_mfma_f32_16x16x32_bf16 v[28:31], a[96:99], v[160:163], 0
    ds_read_b64_tr_b16 a[80:81], v4 offset:16960
    v_mfma_f32_16x16x32_bf16 v[28:31], a[100:103], v[168:171], v[28:31]
    ds_read_b64_tr_b16 a[82:83], v4 offset:17088
    v_mfma_f32_16x16x32_bf16 v[28:31], a[104:107], v[176:179], v[28:31]
    ds_read_b64_tr_b16 a[84:85], v4 offset:17216
    v_mfma_f32_16x16x32_bf16 v[28:31], a[108:111], v[184:187], v[28:31]
    ds_read_b64_tr_b16 a[86:87], v4 offset:17344
    v_mfma_f32_16x16x32_bf16 v[28:31], a[112:115], v[224:227], v[28:31]
    ds_read_b64_tr_b16 a[88:89], v4 offset:17472
    v_mfma_f32_16x16x32_bf16 v[28:31], a[116:119], v[232:235], v[28:31]
    ds_read_b64_tr_b16 a[90:91], v4 offset:17600
    v_mfma_f32_16x16x32_bf16 v[28:31], a[120:123], v[240:243], v[28:31]
    ds_read_b64_tr_b16 a[92:93], v4 offset:17728
    v_mfma_f32_16x16x32_bf16 v[28:31], a[124:127], v[248:251], v[28:31]
    s_waitcnt lgkmcnt(11)
    ds_read_b64_tr_b16 a[94:95], v4 offset:17856
    v_mfma_f32_16x16x32_bf16 v[32:35], a[64:67], v[128:131], 0
    ds_read_b64_tr_b16 a[96:97], v4 offset:96
    v_cvt_pk_bf16_f32 v48, v16, v17
    v_mfma_f32_16x16x32_bf16 v[32:35], a[68:71], v[136:139], v[32:35]
    s_waitcnt lgkmcnt(9)
    ds_read_b64_tr_b16 a[98:99], v4 offset:224
    v_cvt_pk_bf16_f32 v49, v18, v19
    v_mfma_f32_16x16x32_bf16 v[32:35], a[72:75], v[144:147], v[32:35]
    ds_read_b64_tr_b16 a[100:101], v4 offset:352
    v_cvt_pk_bf16_f32 v50, v24, v25
    v_mfma_f32_16x16x32_bf16 v[32:35], a[76:79], v[152:155], v[32:35]
    s_waitcnt lgkmcnt(7)
    ds_read_b64_tr_b16 a[102:103], v4 offset:480
    v_cvt_pk_bf16_f32 v51, v26, v27
    v_mfma_f32_16x16x32_bf16 v[32:35], a[80:83], v[192:195], v[32:35]
    s_mov_b32 s54, 8192
    ds_read_b64_tr_b16 a[104:105], v4 offset:608
    ds_read_b64_tr_b16 a[106:107], v4 offset:736
    v_mfma_f32_16x16x32_bf16 v[32:35], a[84:87], v[200:203], v[32:35]
    s_waitcnt lgkmcnt(6)
    v_permlane32_swap_b32 v48, v50
    v_mfma_f32_16x16x32_bf16 v[32:35], a[88:91], v[208:211], v[32:35]
    v_permlane32_swap_b32 v49, v51
    v_mfma_f32_16x16x32_bf16 v[32:35], a[92:95], v[216:219], v[32:35]
    ds_read_b64_tr_b16 a[108:109], v4 offset:864
    ds_read_b64_tr_b16 a[110:111], v4 offset:992
    buffer_store_dwordx4 v[48:51], v10, s[40:43], s54 offen offset:0 sc1
    v_mfma_f32_16x16x32_bf16 v[36:39], a[64:67], v[160:163], 0
    ds_read_b64_tr_b16 a[112:113], v4 offset:16992
    v_cvt_pk_bf16_f32 v52, v20, v21
    v_mfma_f32_16x16x32_bf16 v[36:39], a[68:71], v[168:171], v[36:39]
    ds_read_b64_tr_b16 a[114:115], v4 offset:17120
    v_cvt_pk_bf16_f32 v53, v22, v23
    v_mfma_f32_16x16x32_bf16 v[36:39], a[72:75], v[176:179], v[36:39]
    ds_read_b64_tr_b16 a[116:117], v4 offset:17248
    v_cvt_pk_bf16_f32 v54, v28, v29
    v_mfma_f32_16x16x32_bf16 v[36:39], a[76:79], v[184:187], v[36:39]
    ds_read_b64_tr_b16 a[118:119], v4 offset:17376
    v_cvt_pk_bf16_f32 v55, v30, v31
    v_mfma_f32_16x16x32_bf16 v[36:39], a[80:83], v[224:227], v[36:39]
    s_mov_b32 s54, 303104
    ds_read_b64_tr_b16 a[120:121], v4 offset:17504
    ds_read_b64_tr_b16 a[122:123], v4 offset:17632
    v_mfma_f32_16x16x32_bf16 v[36:39], a[84:87], v[232:235], v[36:39]
    v_permlane32_swap_b32 v52, v54
    v_mfma_f32_16x16x32_bf16 v[36:39], a[88:91], v[240:243], v[36:39]
    v_permlane32_swap_b32 v53, v55
    v_mfma_f32_16x16x32_bf16 v[36:39], a[92:95], v[248:251], v[36:39]
    s_waitcnt lgkmcnt(10)
    ds_read_b64_tr_b16 a[124:125], v4 offset:17760
    ds_read_b64_tr_b16 a[126:127], v4 offset:17888
    buffer_store_dwordx4 v[52:55], v10, s[40:43], s54 offen offset:0 sc1
    v_mfma_f32_16x16x32_bf16 v[40:43], a[96:99], v[128:131], 0
    v_mfma_f32_16x16x32_bf16 v[40:43], a[100:103], v[136:139], v[40:43]
    s_waitcnt lgkmcnt(8)
    v_mfma_f32_16x16x32_bf16 v[40:43], a[104:107], v[144:147], v[40:43]
    v_mfma_f32_16x16x32_bf16 v[40:43], a[108:111], v[152:155], v[40:43]
    s_waitcnt lgkmcnt(4)
    v_mfma_f32_16x16x32_bf16 v[40:43], a[112:115], v[192:195], v[40:43]
    v_mfma_f32_16x16x32_bf16 v[40:43], a[116:119], v[200:203], v[40:43]
    s_waitcnt lgkmcnt(0)
    v_mfma_f32_16x16x32_bf16 v[40:43], a[120:123], v[208:211], v[40:43]
    v_mfma_f32_16x16x32_bf16 v[40:43], a[124:127], v[216:219], v[40:43]
    v_mfma_f32_16x16x32_bf16 v[44:47], a[96:99], v[160:163], 0
    v_mfma_f32_16x16x32_bf16 v[44:47], a[100:103], v[168:171], v[44:47]
    v_mfma_f32_16x16x32_bf16 v[44:47], a[104:107], v[176:179], v[44:47]
    v_mfma_f32_16x16x32_bf16 v[44:47], a[108:111], v[184:187], v[44:47]
    v_mfma_f32_16x16x32_bf16 v[44:47], a[112:115], v[224:227], v[44:47]
    v_mfma_f32_16x16x32_bf16 v[44:47], a[116:119], v[232:235], v[44:47]
    v_mfma_f32_16x16x32_bf16 v[44:47], a[120:123], v[240:243], v[44:47]
    v_mfma_f32_16x16x32_bf16 v[44:47], a[124:127], v[248:251], v[44:47]
    s_nop 7
    v_cvt_pk_bf16_f32 v48, v32, v33
    v_cvt_pk_bf16_f32 v49, v34, v35
    v_cvt_pk_bf16_f32 v50, v40, v41
    v_cvt_pk_bf16_f32 v51, v42, v43
    s_nop 1
    v_permlane32_swap_b32 v48, v50
    v_permlane32_swap_b32 v49, v51
    s_mov_b32 s54, 8192
    buffer_store_dwordx4 v[48:51], v10, s[40:43], s54 offen offset:512 sc1
    v_cvt_pk_bf16_f32 v52, v36, v37
    v_cvt_pk_bf16_f32 v53, v38, v39
    v_cvt_pk_bf16_f32 v54, v44, v45
    v_cvt_pk_bf16_f32 v55, v46, v47
    s_nop 1
    v_permlane32_swap_b32 v52, v54
    v_permlane32_swap_b32 v53, v55
    s_mov_b32 s54, 303104
    buffer_store_dwordx4 v[52:55], v10, s[40:43], s54 offen offset:512 sc1
    v_lshlrev_b32 v12, 7, v0
    v_mov_b32 v13, 1
    s_lshl_b32 s15, s53, 13
    s_add_u32 s15, s15, 786432
    s_lshl_b32 s3, s51, 4
    s_add_u32 s3, s3, s52
    s_lshl_b32 s3, s3, 7
    s_add_u32 s3, s3, s15
    s_and_b32 s14, s52, 12
    s_lshl_b32 s14, s14, 9
    s_add_u32 s15, s15, s14
    s_mul_i32 s14, s51, 2304
    v_add_u32 v5, s14, v8
    v_lshrrev_b32 v14, 4, v0
    v_mul_u32_u24 v14, 8960, v14
    v_add_u32 v7, v5, v14
    s_waitcnt vmcnt(0)
    s_mov_b64 exec, 1
    buffer_store_dword v13, v12, s[84:87], s3 offen sc1
    s_mov_b64 exec, 0xffff
    s_mov_b32 s97, 0x20000
L2_p1:
    buffer_load_dword v13, v12, s[84:87], s15 offen sc1
    s_waitcnt vmcnt(0)
    v_cmp_eq_u32 vcc, 0, v13
    s_sub_u32 s97, s97, 1
    s_cselect_b64 vcc, 0, vcc
    s_cmp_eq_u64 vcc, 0
    s_cbranch_scc1 L2_p1_ok
    s_sleep 1
    s_branch L2_p1
L2_p1_ok:
    s_mov_b64 exec, -1
    s_mov_b32 s45, 0
    buffer_load_dwordx4 v[112:115], v7, s[88:91], s45 offen offset:2048 sc1
    s_mov_b32 s45, 36864
    buffer_load_dwordx4 v[116:119], v7, s[88:91], s45 offen offset:2048 sc1
    s_mov_b32 s45, 73728
    buffer_load_dwordx4 v[120:123], v7, s[88:91], s45 offen offset:2048 sc1
    s_mov_b32 s45, 110592
    buffer_load_dwordx4 v[124:127], v7, s[88:91], s45 offen offset:2048 sc1
    s_mov_b32 s45, 0
    buffer_load_dwordx4 v[128:131], v5, s[88:91], s45 offen offset:0 sc1
    buffer_load_dwordx4 v[132:135], v5, s[88:91], s45 offen offset:1024 sc1
    s_mov_b32 s45, 9216
    buffer_load_dwordx4 v[136:139], v5, s[88:91], s45 offen offset:0 sc1
    buffer_load_dwordx4 v[140:143], v5, s[88:91], s45 offen offset:1024 sc1
    s_barrier
    s_add_u32 s14, s55, 16384
    v_add_u32 v105, s14, v8
    v_add_u32 v106, 73728, v105
    s_mul_i32 s14, s51, 576
    v_lshrrev_b32 v14, 3, v0
    v_lshlrev_b32 v3, 5, v14
    v_add_u32 v3, s14, v3
    v_and_b32 v14, 1, v14
    v_lshlrev_b32 v4, 5, v14
    v_add_u32 v4, s14, v4
    ds_read_b128 v[16:19], v3 offset:9216
    ds_read_b128 v[20:23], v3 offset:9232
    ds_read_b128 v[24:27], v3 offset:9472
    ds_read_b128 v[28:31], v3 offset:9488
    ds_read_b128 v[32:35], v4 offset:9728
    ds_read_b128 v[36:39], v4 offset:9744
    ds_read_b128 v[76:79], v3 offset:4608
    ds_read_b128 v[80:83], v3 offset:4624
    ds_read_b128 v[84:87], v3 offset:4864
    ds_read_b128 v[88:91], v3 offset:4880
    ds_read_b128 v[92:95], v4 offset:5120
    ds_read_b128 v[96:99], v4 offset:5136
    ds_read_b128 v[40:43], v3 offset:2304
    ds_read_b128 v[44:47], v3 offset:2320
    ds_read_b128 v[48:51], v3 offset:2560
    ds_read_b128 v[52:55], v3 offset:2576
    ds_read_b128 v[56:59], v4 offset:2816
    ds_read_b128 v[60:63], v4 offset:2832
    s_waitcnt lgkmcnt(6)
    v_mul_f32 v76, v76, v16
    v_mul_f32 v77, v77, v17
    v_mul_f32 v78, v78, v18
    v_mul_f32 v79, v79, v19
    v_mul_f32 v80, v80, v20
    v_mul_f32 v81, v81, v21
    v_mul_f32 v82, v82, v22
    v_mul_f32 v83, v83, v23
    v_mul_f32 v84, v84, v24
    v_mul_f32 v85, v85, v25
    v_mul_f32 v86, v86, v26
    v_mul_f32 v87, v87, v27
    v_mul_f32 v88, v88, v28
    v_mul_f32 v89, v89, v29
    v_mul_f32 v90, v90, v30
    v_mul_f32 v91, v91, v31
    v_mul_f32 v92, v92, v32
    v_mul_f32 v93, v93, v33
    v_mul_f32 v94, v94, v34
    v_mul_f32 v95, v95, v35
    v_mul_f32 v96, v96, v36
    v_mul_f32 v97, v97, v37
    v_mul_f32 v98, v98, v38
    v_mul_f32 v99, v99, v39
    s_waitcnt lgkmcnt(0)
    v_add_f32 v100, v76, v77
    v_add_f32 v100, v100, v78
    v_add_f32 v100, v100, v79
    v_add_f32 v100, v100, v80
    v_add_f32 v100, v100, v81
    v_add_f32 v100, v100, v82
    v_add_f32 v100, v100, v83
    v_add_f32 v100, v100, v84
    v_add_f32 v100, v100, v85
    v_add_f32 v100, v100, v86
    v_add_f32 v100, v100, v87
    v_add_f32 v100, v100, v88
    v_add_f32 v100, v100, v89
    v_add_f32 v100, v100, v90
    v_add_f32 v100, v100, v91
    v_add_f32 v102, v92, v93
    v_add_f32 v102, v102, v94
    v_add_f32 v102, v102, v95
    v_add_f32 v102, v102, v96
    v_add_f32 v102, v102, v97
    v_add_f32 v102, v102, v98
    v_add_f32 v102, v102, v99
    v_fmac_f32 v100, 0x3e800000, v102
    v_mul_f32 v101, v40, v16
    v_fmac_f32 v101, v41, v17
    v_fmac_f32 v101, v42, v18
    v_fmac_f32 v101, v43, v19
    v_fmac_f32 v101, v44, v20
    v_fmac_f32 v101, v45, v21
    v_fmac_f32 v101, v46, v22
    v_fmac_f32 v101, v47, v23
    v_fmac_f32 v101, v48, v24
    v_fmac_f32 v101, v49, v25
    v_fmac_f32 v101, v50, v26
    v_fmac_f32 v101, v51, v27
    v_fmac_f32 v101, v52, v28
    v_fmac_f32 v101, v53, v29
    v_fmac_f32 v101, v54, v30
    v_fmac_f32 v101, v55, v31
    v_mul_f32 v102, v56, v32
    v_fmac_f32 v102, v57, v33
    v_fmac_f32 v102, v58, v34
    v_fmac_f32 v102, v59, v35
    v_fmac_f32 v102, v60, v36
    v_fmac_f32 v102, v61, v37
    v_fmac_f32 v102, v62, v38
    v_fmac_f32 v102, v63, v39
    v_fmac_f32 v101, 0x3e800000, v102
    ds_read_b128 v[40:43], v3 offset:0
    ds_read_b128 v[44:47], v3 offset:16
    ds_read_b128 v[48:51], v3 offset:256
    ds_read_b128 v[52:55], v3 offset:272
    ds_read_b128 v[56:59], v4 offset:512
    ds_read_b128 v[60:63], v4 offset:528
    s_waitcnt vmcnt(7)
    s_mov_b32 s45, 18432
    buffer_load_dwordx4 v[144:147], v5, s[88:91], s45 offen offset:0 sc1
    ds_write_b128 v106, a[128:131] offset:36864
    s_waitcnt vmcnt(7)
    buffer_load_dwordx4 v[148:151], v5, s[88:91], s45 offen offset:1024 sc1
    ds_write_b128 v106, a[132:135] offset:37888
    s_waitcnt vmcnt(7)
    s_mov_b32 s45, 27648
    buffer_load_dwordx4 v[152:155], v5, s[88:91], s45 offen offset:0 sc1
    ds_write_b128 v106, a[136:139] offset:38912
    s_waitcnt vmcnt(7)
    buffer_load_dwordx4 v[156:159], v5, s[88:91], s45 offen offset:1024 sc1
    ds_write_b128 v106, a[140:143] offset:39936
    s_nop 1
    v_add_f32_dpp v100, v100, v100 row_ror:8 row_mask:0xf bank_mask:0xf
    v_add_f32_dpp v101, v101, v101 row_ror:8 row_mask:0xf bank_mask:0xf
    v_mov_b32 v102, v100
    v_mov_b32 v103, v101
    s_nop 0
    v_permlane16_swap_b32 v102, v100
    v_permlane16_swap_b32 v103, v101
    v_add_f32 v100, v100, v102
    v_add_f32 v101, v101, v103
    v_mov_b32 v102, v100
    v_mov_b32 v103, v101
    s_nop 0
    v_permlane32_swap_b32 v102, v100
    v_permlane32_swap_b32 v103, v101
    v_add_f32 v100, v100, v102
    v_add_f32 v101, v101, v103
    v_and_b32 v14, 7, v0
    v_lshlrev_b32 v11, 4, v14
    v_add_u32 v11, 12544, v11
    s_lshl_b32 s3, s51, 2
    v_add_u32 v10, s3, v11
    ds_write_b32 v10, v100 offset:384
    ds_write_b32 v10, v101 offset:512
    v_lshl_add_u32 v1, v14, 4, v1
    v_lshl_add_u32 v2, v14, 4, v2
    v_add_u32 v1, 90112, v1
    v_add_u32 v2, 90112, v2
    s_and_b32 s3, s51, 1
    s_mul_i32 s3, s3, 288
    v_add_u32 v14, s3, v0
    v_lshlrev_b32 v9, 4, v14
    s_lshr_b32 s14, s51, 1
    s_mul_i32 s14, s14, 9344
    s_add_u32 s14, s14, 90112
    v_add_u32 v15, 0, v14
    v_mul_u32_u24 v12, 911, v15
    v_lshrrev_b32 v12, 16, v12
    v_add_u32 v15, v15, v12
    v_lshl_add_u32 v107, v15, 4, s14
    v_add_u32 v15, 64, v14
    v_mul_u32_u24 v12, 911, v15
    v_lshrrev_b32 v12, 16, v12
    v_add_u32 v15, v15, v12
    v_lshl_add_u32 v108, v15, 4, s14
    v_add_u32 v15, 128, v14
    v_mul_u32_u24 v12, 911, v15
    v_lshrrev_b32 v12, 16, v12
    v_add_u32 v15, v15, v12
    v_lshl_add_u32 v109, v15, 4, s14
    v_add_u32 v15, 192, v14
    v_mul_u32_u24 v12, 911, v15
    v_lshrrev_b32 v12, 16, v12
    v_add_u32 v15, v15, v12
    v_lshl_add_u32 v110, v15, 4, s14
    v_add_u32 v15, 256, v14
    v_mul_u32_u24 v12, 911, v15
    v_lshrrev_b32 v12, 16, v12
    v_add_u32 v15, v15, v12
    v_lshl_add_u32 v111, v15, 4, s14
    s_mul_i32 s3, s96, 9216
    s_add_u32 s14, s3, 4194304
    s_cmp_lt_u32 s51, 2
    s_cselect_b32 s3, s3, s14
    s_cselect_b64 s[24:25], s[80:81], s[84:85]
    s_add_u32 s24, s24, s3
    s_addc_u32 s25, s25, 0
    s_mov_b32 s26, 9216
    s_mov_b32 s27, 0x20000
    s_waitcnt vmcnt(7)
    s_mov_b32 s45, 36864
    buffer_load_dwordx4 v[160:163], v5, s[88:91], s45 offen offset:0 sc1
    ds_write_b128 v106, a[144:147] offset:40960
    v_lshlrev_b32 v32, 16, v112
    v_and_b32 v33, 0xffff0000, v112
    v_lshlrev_b32 v34, 16, v113
    v_and_b32 v35, 0xffff0000, v113
    v_lshlrev_b32 v36, 16, v114
    v_and_b32 v37, 0xffff0000, v114
    v_lshlrev_b32 v38, 16, v115
    v_and_b32 v39, 0xffff0000, v115
    s_waitcnt vmcnt(7)
    buffer_load_dwordx4 v[164:167], v5, s[88:91], s45 offen offset:1024 sc1
    ds_write_b128 v106, a[148:151] offset:41984
    v_lshlrev_b32 v12, 16, v116
    v_and_b32 v13, 0xffff0000, v116
    v_pk_add_f32 v[32:33], v[32:33], v[12:13]
    v_lshlrev_b32 v14, 16, v117
    v_and_b32 v15, 0xffff0000, v117
    v_pk_add_f32 v[34:35], v[34:35], v[14:15]
    v_lshlrev_b32 v12, 16, v118
    v_and_b32 v13, 0xffff0000, v118
    v_pk_add_f32 v[36:37], v[36:37], v[12:13]
    v_lshlrev_b32 v14, 16, v119
    v_and_b32 v15, 0xffff0000, v119
    v_pk_add_f32 v[38:39], v[38:39], v[14:15]
    s_waitcnt vmcnt(7)
    s_mov_b32 s45, 46080
    buffer_load_dwordx4 v[168:171], v5, s[88:91], s45 offen offset:0 sc1
    ds_write_b128 v106, a[152:155] offset:43008
    v_lshlrev_b32 v12, 16, v120
    v_and_b32 v13, 0xffff0000, v120
    v_pk_add_f32 v[32:33], v[32:33], v[12:13]
    v_lshlrev_b32 v14, 16, v121
    v_and_b32 v15, 0xffff0000, v121
    v_pk_add_f32 v[34:35], v[34:35], v[14:15]
    v_lshlrev_b32 v12, 16, v122
    v_and_b32 v13, 0xffff0000, v122
    v_pk_add_f32 v[36:37], v[36:37], v[12:13]
    v_lshlrev_b32 v14, 16, v123
    v_and_b32 v15, 0xffff0000, v123
    v_pk_add_f32 v[38:39], v[38:39], v[14:15]
    s_waitcnt vmcnt(7)
    buffer_load_dwordx4 v[172:175], v5, s[88:91], s45 offen offset:1024 sc1
    ds_write_b128 v106, a[156:159] offset:44032
    v_lshlrev_b32 v12, 16, v124
    v_and_b32 v13, 0xffff0000, v124
    v_pk_add_f32 v[32:33], v[32:33], v[12:13]
    v_lshlrev_b32 v14, 16, v125
    v_and_b32 v15, 0xffff0000, v125
    v_pk_add_f32 v[34:35], v[34:35], v[14:15]
    v_lshlrev_b32 v12, 16, v126
    v_and_b32 v13, 0xffff0000, v126
    v_pk_add_f32 v[36:37], v[36:37], v[12:13]
    v_lshlrev_b32 v14, 16, v127
    v_and_b32 v15, 0xffff0000, v127
    v_pk_add_f32 v[38:39], v[38:39], v[14:15]
    v_mov_b32 v112, v32
    v_mov_b32 v113, v33
    v_mov_b32 v114, v34
    v_mov_b32 v115, v35
    v_mov_b32 v116, v36
    v_mov_b32 v117, v37
    v_mov_b32 v118, v38
    v_mov_b32 v119, v39
    v_permlane16_swap_b32 v112, v32
    v_permlane16_swap_b32 v113, v33
    v_permlane16_swap_b32 v114, v34
    v_permlane16_swap_b32 v115, v35
    v_permlane16_swap_b32 v116, v36
    v_permlane16_swap_b32 v117, v37
    v_permlane16_swap_b32 v118, v38
    v_permlane16_swap_b32 v119, v39
    v_add_f32 v32, v32, v112
    v_add_f32 v33, v33, v113
    v_add_f32 v34, v34, v114
    v_add_f32 v35, v35, v115
    v_add_f32 v36, v36, v116
    v_add_f32 v37, v37, v117
    v_add_f32 v38, v38, v118
    v_add_f32 v39, v39, v119
    v_mov_b32 v112, v32
    v_mov_b32 v113, v33
    v_mov_b32 v114, v34
    v_mov_b32 v115, v35
    v_mov_b32 v116, v36
    v_mov_b32 v117, v37
    v_mov_b32 v118, v38
    v_mov_b32 v119, v39
    v_permlane32_swap_b32 v112, v32
    v_permlane32_swap_b32 v113, v33
    v_permlane32_swap_b32 v114, v34
    v_permlane32_swap_b32 v115, v35
    v_permlane32_swap_b32 v116, v36
    v_permlane32_swap_b32 v117, v37
    v_permlane32_swap_b32 v118, v38
    v_permlane32_swap_b32 v119, v39
    v_add_f32 v32, v32, v112
    v_add_f32 v33, v33, v113
    v_add_f32 v34, v34, v114
    v_add_f32 v35, v35, v115
    v_add_f32 v36, v36, v116
    v_add_f32 v37, v37, v117
    v_add_f32 v38, v38, v118
    v_add_f32 v39, v39, v119
    s_waitcnt vmcnt(7)
    s_mov_b32 s45, 55296
    buffer_load_dwordx4 v[176:179], v5, s[88:91], s45 offen offset:0 sc1
    ds_write_b128 v106, a[160:163] offset:45056
    v_lshlrev_b32 v16, 16, v128
    v_and_b32 v17, 0xffff0000, v128
    v_lshlrev_b32 v18, 16, v129
    v_and_b32 v19, 0xffff0000, v129
    v_lshlrev_b32 v20, 16, v130
    v_and_b32 v21, 0xffff0000, v130
    v_lshlrev_b32 v22, 16, v131
    v_and_b32 v23, 0xffff0000, v131
    s_waitcnt vmcnt(7)
    buffer_load_dwordx4 v[180:183], v5, s[88:91], s45 offen offset:1024 sc1
    ds_write_b128 v105, a[164:167] offset:0
    v_lshlrev_b32 v24, 16, v132
    v_and_b32 v25, 0xffff0000, v132
    v_lshlrev_b32 v26, 16, v133
    v_and_b32 v27, 0xffff0000, v133
    v_lshlrev_b32 v28, 16, v134
    v_and_b32 v29, 0xffff0000, v134
    v_lshlrev_b32 v30, 16, v135
    v_and_b32 v31, 0xffff0000, v135
    s_waitcnt vmcnt(7)
    s_mov_b32 s45, 64512
    buffer_load_dwordx4 v[184:187], v5, s[88:91], s45 offen offset:0 sc1
    ds_write_b128 v105, a[168:171] offset:1024
    v_lshlrev_b32 v12, 16, v136
    v_and_b32 v13, 0xffff0000, v136
    v_pk_add_f32 v[16:17], v[16:17], v[12:13]
    v_lshlrev_b32 v14, 16, v137
    v_and_b32 v15, 0xffff0000, v137
    v_pk_add_f32 v[18:19], v[18:19], v[14:15]
    v_lshlrev_b32 v12, 16, v138
    v_and_b32 v13, 0xffff0000, v138
    v_pk_add_f32 v[20:21], v[20:21], v[12:13]
    v_lshlrev_b32 v14, 16, v139
    v_and_b32 v15, 0xffff0000, v139
    v_pk_add_f32 v[22:23], v[22:23], v[14:15]
    s_waitcnt vmcnt(7)
    buffer_load_dwordx4 v[188:191], v5, s[88:91], s45 offen offset:1024 sc1
    ds_write_b128 v105, a[172:175] offset:2048
    v_lshlrev_b32 v12, 16, v140
    v_and_b32 v13, 0xffff0000, v140
    v_pk_add_f32 v[24:25], v[24:25], v[12:13]
    v_lshlrev_b32 v14, 16, v141
    v_and_b32 v15, 0xffff0000, v141
    v_pk_add_f32 v[26:27], v[26:27], v[14:15]
    v_lshlrev_b32 v12, 16, v142
    v_and_b32 v13, 0xffff0000, v142
    v_pk_add_f32 v[28:29], v[28:29], v[12:13]
    v_lshlrev_b32 v14, 16, v143
    v_and_b32 v15, 0xffff0000, v143
    v_pk_add_f32 v[30:31], v[30:31], v[14:15]
    s_waitcnt vmcnt(7)
    s_mov_b32 s45, 73728
    buffer_load_dwordx4 v[192:195], v5, s[88:91], s45 offen offset:0 sc1
    ds_write_b128 v105, a[176:179] offset:3072
    v_lshlrev_b32 v12, 16, v144
    v_and_b32 v13, 0xffff0000, v144
    v_pk_add_f32 v[16:17], v[16:17], v[12:13]
    v_lshlrev_b32 v14, 16, v145
    v_and_b32 v15, 0xffff0000, v145
    v_pk_add_f32 v[18:19], v[18:19], v[14:15]
    v_lshlrev_b32 v12, 16, v146
    v_and_b32 v13, 0xffff0000, v146
    v_pk_add_f32 v[20:21], v[20:21], v[12:13]
    v_lshlrev_b32 v14, 16, v147
    v_and_b32 v15, 0xffff0000, v147
    v_pk_add_f32 v[22:23], v[22:23], v[14:15]
    s_waitcnt vmcnt(7)
    buffer_load_dwordx4 v[196:199], v5, s[88:91], s45 offen offset:1024 sc1
    ds_write_b128 v105, a[180:183] offset:4096
    v_lshlrev_b32 v12, 16, v148
    v_and_b32 v13, 0xffff0000, v148
    v_pk_add_f32 v[24:25], v[24:25], v[12:13]
    v_lshlrev_b32 v14, 16, v149
    v_and_b32 v15, 0xffff0000, v149
    v_pk_add_f32 v[26:27], v[26:27], v[14:15]
    v_lshlrev_b32 v12, 16, v150
    v_and_b32 v13, 0xffff0000, v150
    v_pk_add_f32 v[28:29], v[28:29], v[12:13]
    v_lshlrev_b32 v14, 16, v151
    v_and_b32 v15, 0xffff0000, v151
    v_pk_add_f32 v[30:31], v[30:31], v[14:15]
    s_waitcnt vmcnt(7)
    s_mov_b32 s45, 82944
    buffer_load_dwordx4 v[200:203], v5, s[88:91], s45 offen offset:0 sc1
    ds_write_b128 v105, a[184:187] offset:5120
    v_lshlrev_b32 v12, 16, v152
    v_and_b32 v13, 0xffff0000, v152
    v_pk_add_f32 v[16:17], v[16:17], v[12:13]
    v_lshlrev_b32 v14, 16, v153
    v_and_b32 v15, 0xffff0000, v153
    v_pk_add_f32 v[18:19], v[18:19], v[14:15]
    v_lshlrev_b32 v12, 16, v154
    v_and_b32 v13, 0xffff0000, v154
    v_pk_add_f32 v[20:21], v[20:21], v[12:13]
    v_lshlrev_b32 v14, 16, v155
    v_and_b32 v15, 0xffff0000, v155
    v_pk_add_f32 v[22:23], v[22:23], v[14:15]
    s_waitcnt vmcnt(7)
    buffer_load_dwordx4 v[204:207], v5, s[88:91], s45 offen offset:1024 sc1
    ds_write_b128 v105, a[188:191] offset:6144
    v_lshlrev_b32 v12, 16, v156
    v_and_b32 v13, 0xffff0000, v156
    v_pk_add_f32 v[24:25], v[24:25], v[12:13]
    v_lshlrev_b32 v14, 16, v157
    v_and_b32 v15, 0xffff0000, v157
    v_pk_add_f32 v[26:27], v[26:27], v[14:15]
    v_lshlrev_b32 v12, 16, v158
    v_and_b32 v13, 0xffff0000, v158
    v_pk_add_f32 v[28:29], v[28:29], v[12:13]
    v_lshlrev_b32 v14, 16, v159
    v_and_b32 v15, 0xffff0000, v159
    v_pk_add_f32 v[30:31], v[30:31], v[14:15]
    s_waitcnt vmcnt(7)
    s_mov_b32 s45, 92160
    buffer_load_dwordx4 v[208:211], v5, s[88:91], s45 offen offset:0 sc1
    ds_write_b128 v105, a[192:195] offset:7168
    v_lshlrev_b32 v12, 16, v160
    v_and_b32 v13, 0xffff0000, v160
    v_pk_add_f32 v[16:17], v[16:17], v[12:13]
    v_lshlrev_b32 v14, 16, v161
    v_and_b32 v15, 0xffff0000, v161
    v_pk_add_f32 v[18:19], v[18:19], v[14:15]
    v_lshlrev_b32 v12, 16, v162
    v_and_b32 v13, 0xffff0000, v162
    v_pk_add_f32 v[20:21], v[20:21], v[12:13]
    v_lshlrev_b32 v14, 16, v163
    v_and_b32 v15, 0xffff0000, v163
    v_pk_add_f32 v[22:23], v[22:23], v[14:15]
    s_waitcnt vmcnt(7)
    buffer_load_dwordx4 v[212:215], v5, s[88:91], s45 offen offset:1024 sc1
    ds_write_b128 v105, a[196:199] offset:8192
    v_lshlrev_b32 v12, 16, v164
    v_and_b32 v13, 0xffff0000, v164
    v_pk_add_f32 v[24:25], v[24:25], v[12:13]
    v_lshlrev_b32 v14, 16, v165
    v_and_b32 v15, 0xffff0000, v165
    v_pk_add_f32 v[26:27], v[26:27], v[14:15]
    v_lshlrev_b32 v12, 16, v166
    v_and_b32 v13, 0xffff0000, v166
    v_pk_add_f32 v[28:29], v[28:29], v[12:13]
    v_lshlrev_b32 v14, 16, v167
    v_and_b32 v15, 0xffff0000, v167
    v_pk_add_f32 v[30:31], v[30:31], v[14:15]
    s_waitcnt vmcnt(7)
    s_mov_b32 s45, 101376
    buffer_load_dwordx4 v[216:219], v5, s[88:91], s45 offen offset:0 sc1
    ds_write_b128 v105, a[200:203] offset:36864
    v_lshlrev_b32 v12, 16, v168
    v_and_b32 v13, 0xffff0000, v168
    v_pk_add_f32 v[16:17], v[16:17], v[12:13]
    v_lshlrev_b32 v14, 16, v169
    v_and_b32 v15, 0xffff0000, v169
    v_pk_add_f32 v[18:19], v[18:19], v[14:15]
    v_lshlrev_b32 v12, 16, v170
    v_and_b32 v13, 0xffff0000, v170
    v_pk_add_f32 v[20:21], v[20:21], v[12:13]
    v_lshlrev_b32 v14, 16, v171
    v_and_b32 v15, 0xffff0000, v171
    v_pk_add_f32 v[22:23], v[22:23], v[14:15]
    s_waitcnt vmcnt(7)
    buffer_load_dwordx4 v[220:223], v5, s[88:91], s45 offen offset:1024 sc1
    ds_write_b128 v105, a[204:207] offset:37888
    v_lshlrev_b32 v12, 16, v172
    v_and_b32 v13, 0xffff0000, v172
    v_pk_add_f32 v[24:25], v[24:25], v[12:13]
    v_lshlrev_b32 v14, 16, v173
    v_and_b32 v15, 0xffff0000, v173
    v_pk_add_f32 v[26:27], v[26:27], v[14:15]
    v_lshlrev_b32 v12, 16, v174
    v_and_b32 v13, 0xffff0000, v174
    v_pk_add_f32 v[28:29], v[28:29], v[12:13]
    v_lshlrev_b32 v14, 16, v175
    v_and_b32 v15, 0xffff0000, v175
    v_pk_add_f32 v[30:31], v[30:31], v[14:15]
    s_waitcnt vmcnt(7)
    s_mov_b32 s45, 110592
    buffer_load_dwordx4 v[224:227], v5, s[88:91], s45 offen offset:0 sc1
    ds_write_b128 v105, a[208:211] offset:38912
    v_lshlrev_b32 v12, 16, v176
    v_and_b32 v13, 0xffff0000, v176
    v_pk_add_f32 v[16:17], v[16:17], v[12:13]
    v_lshlrev_b32 v14, 16, v177
    v_and_b32 v15, 0xffff0000, v177
    v_pk_add_f32 v[18:19], v[18:19], v[14:15]
    v_lshlrev_b32 v12, 16, v178
    v_and_b32 v13, 0xffff0000, v178
    v_pk_add_f32 v[20:21], v[20:21], v[12:13]
    v_lshlrev_b32 v14, 16, v179
    v_and_b32 v15, 0xffff0000, v179
    v_pk_add_f32 v[22:23], v[22:23], v[14:15]
    s_waitcnt vmcnt(7)
    buffer_load_dwordx4 v[228:231], v5, s[88:91], s45 offen offset:1024 sc1
    ds_write_b128 v105, a[212:215] offset:39936
    v_lshlrev_b32 v12, 16, v180
    v_and_b32 v13, 0xffff0000, v180
    v_pk_add_f32 v[24:25], v[24:25], v[12:13]
    v_lshlrev_b32 v14, 16, v181
    v_and_b32 v15, 0xffff0000, v181
    v_pk_add_f32 v[26:27], v[26:27], v[14:15]
    v_lshlrev_b32 v12, 16, v182
    v_and_b32 v13, 0xffff0000, v182
    v_pk_add_f32 v[28:29], v[28:29], v[12:13]
    v_lshlrev_b32 v14, 16, v183
    v_and_b32 v15, 0xffff0000, v183
    v_pk_add_f32 v[30:31], v[30:31], v[14:15]
    s_waitcnt vmcnt(7)
    s_mov_b32 s45, 119808
    buffer_load_dwordx4 v[232:235], v5, s[88:91], s45 offen offset:0 sc1
    ds_write_b128 v105, a[216:219] offset:40960
    v_lshlrev_b32 v12, 16, v184
    v_and_b32 v13, 0xffff0000, v184
    v_pk_add_f32 v[16:17], v[16:17], v[12:13]
    v_lshlrev_b32 v14, 16, v185
    v_and_b32 v15, 0xffff0000, v185
    v_pk_add_f32 v[18:19], v[18:19], v[14:15]
    v_lshlrev_b32 v12, 16, v186
    v_and_b32 v13, 0xffff0000, v186
    v_pk_add_f32 v[20:21], v[20:21], v[12:13]
    v_lshlrev_b32 v14, 16, v187
    v_and_b32 v15, 0xffff0000, v187
    v_pk_add_f32 v[22:23], v[22:23], v[14:15]
    s_waitcnt vmcnt(7)
    buffer_load_dwordx4 v[236:239], v5, s[88:91], s45 offen offset:1024 sc1
    ds_write_b128 v105, a[220:223] offset:41984
    v_lshlrev_b32 v12, 16, v188
    v_and_b32 v13, 0xffff0000, v188
    v_pk_add_f32 v[24:25], v[24:25], v[12:13]
    v_lshlrev_b32 v14, 16, v189
    v_and_b32 v15, 0xffff0000, v189
    v_pk_add_f32 v[26:27], v[26:27], v[14:15]
    v_lshlrev_b32 v12, 16, v190
    v_and_b32 v13, 0xffff0000, v190
    v_pk_add_f32 v[28:29], v[28:29], v[12:13]
    v_lshlrev_b32 v14, 16, v191
    v_and_b32 v15, 0xffff0000, v191
    v_pk_add_f32 v[30:31], v[30:31], v[14:15]
    s_waitcnt vmcnt(7)
    s_mov_b32 s45, 129024
    buffer_load_dwordx4 v[240:243], v5, s[88:91], s45 offen offset:0 sc1
    ds_write_b128 v105, a[224:227] offset:43008
    v_lshlrev_b32 v12, 16, v192
    v_and_b32 v13, 0xffff0000, v192
    v_pk_add_f32 v[16:17], v[16:17], v[12:13]
    v_lshlrev_b32 v14, 16, v193
    v_and_b32 v15, 0xffff0000, v193
    v_pk_add_f32 v[18:19], v[18:19], v[14:15]
    v_lshlrev_b32 v12, 16, v194
    v_and_b32 v13, 0xffff0000, v194
    v_pk_add_f32 v[20:21], v[20:21], v[12:13]
    v_lshlrev_b32 v14, 16, v195
    v_and_b32 v15, 0xffff0000, v195
    v_pk_add_f32 v[22:23], v[22:23], v[14:15]
    s_waitcnt vmcnt(7)
    buffer_load_dwordx4 v[244:247], v5, s[88:91], s45 offen offset:1024 sc1
    ds_write_b128 v105, a[228:231] offset:44032
    v_lshlrev_b32 v12, 16, v196
    v_and_b32 v13, 0xffff0000, v196
    v_pk_add_f32 v[24:25], v[24:25], v[12:13]
    v_lshlrev_b32 v14, 16, v197
    v_and_b32 v15, 0xffff0000, v197
    v_pk_add_f32 v[26:27], v[26:27], v[14:15]
    v_lshlrev_b32 v12, 16, v198
    v_and_b32 v13, 0xffff0000, v198
    v_pk_add_f32 v[28:29], v[28:29], v[12:13]
    v_lshlrev_b32 v14, 16, v199
    v_and_b32 v15, 0xffff0000, v199
    v_pk_add_f32 v[30:31], v[30:31], v[14:15]
    ds_read_b128 v[112:115], v3 offset:4608
    ds_read_b128 v[116:119], v3 offset:4624
    ds_read_b128 v[120:123], v3 offset:4864
    ds_read_b128 v[124:127], v3 offset:4880
    ds_read_b128 v[128:131], v4 offset:5120
    ds_read_b128 v[132:135], v4 offset:5136
    ds_read_b128 v[136:139], v3 offset:2304
    ds_read_b128 v[140:143], v3 offset:2320
    ds_read_b128 v[144:147], v3 offset:2560
    ds_read_b128 v[148:151], v3 offset:2576
    ds_read_b128 v[152:155], v4 offset:2816
    ds_read_b128 v[156:159], v4 offset:2832
    ds_read_b128 v[160:163], v3 offset:6912
    ds_read_b128 v[164:167], v3 offset:6928
    ds_read_b128 v[168:171], v3 offset:7168
    ds_read_b128 v[172:175], v3 offset:7184
    ds_read_b128 v[176:179], v4 offset:7424
    ds_read_b128 v[180:183], v4 offset:7440
    s_waitcnt vmcnt(7)
    s_mov_b32 s45, 138240
    buffer_load_dwordx4 v[248:251], v5, s[88:91], s45 offen offset:0 sc1
    ds_write_b128 v105, a[232:235] offset:45056
    v_lshlrev_b32 v12, 16, v200
    v_and_b32 v13, 0xffff0000, v200
    v_pk_add_f32 v[16:17], v[16:17], v[12:13]
    v_lshlrev_b32 v14, 16, v201
    v_and_b32 v15, 0xffff0000, v201
    v_pk_add_f32 v[18:19], v[18:19], v[14:15]
    v_lshlrev_b32 v12, 16, v202
    v_and_b32 v13, 0xffff0000, v202
    v_pk_add_f32 v[20:21], v[20:21], v[12:13]
    v_lshlrev_b32 v14, 16, v203
    v_and_b32 v15, 0xffff0000, v203
    v_pk_add_f32 v[22:23], v[22:23], v[14:15]
    s_waitcnt vmcnt(7)
    buffer_load_dwordx4 v[252:255], v5, s[88:91], s45 offen offset:1024 sc1
    v_lshlrev_b32 v12, 16, v204
    v_and_b32 v13, 0xffff0000, v204
    v_pk_add_f32 v[24:25], v[24:25], v[12:13]
    v_lshlrev_b32 v14, 16, v205
    v_and_b32 v15, 0xffff0000, v205
    v_pk_add_f32 v[26:27], v[26:27], v[14:15]
    v_lshlrev_b32 v12, 16, v206
    v_and_b32 v13, 0xffff0000, v206
    v_pk_add_f32 v[28:29], v[28:29], v[12:13]
    v_lshlrev_b32 v14, 16, v207
    v_and_b32 v15, 0xffff0000, v207
    v_pk_add_f32 v[30:31], v[30:31], v[14:15]
    v_lshlrev_b32 v12, 16, v208
    v_and_b32 v13, 0xffff0000, v208
    v_pk_add_f32 v[16:17], v[16:17], v[12:13]
    v_lshlrev_b32 v14, 16, v209
    v_and_b32 v15, 0xffff0000, v209
    v_pk_add_f32 v[18:19], v[18:19], v[14:15]
    v_lshlrev_b32 v12, 16, v210
    v_and_b32 v13, 0xffff0000, v210
    v_pk_add_f32 v[20:21], v[20:21], v[12:13]
    v_lshlrev_b32 v14, 16, v211
    v_and_b32 v15, 0xffff0000, v211
    v_pk_add_f32 v[22:23], v[22:23], v[14:15]
    v_lshlrev_b32 v12, 16, v212
    v_and_b32 v13, 0xffff0000, v212
    v_pk_add_f32 v[24:25], v[24:25], v[12:13]
    v_lshlrev_b32 v14, 16, v213
    v_and_b32 v15, 0xffff0000, v213
    v_pk_add_f32 v[26:27], v[26:27], v[14:15]
    v_lshlrev_b32 v12, 16, v214
    v_and_b32 v13, 0xffff0000, v214
    v_pk_add_f32 v[28:29], v[28:29], v[12:13]
    v_lshlrev_b32 v14, 16, v215
    v_and_b32 v15, 0xffff0000, v215
    v_pk_add_f32 v[30:31], v[30:31], v[14:15]
    v_lshlrev_b32 v12, 16, v216
    v_and_b32 v13, 0xffff0000, v216
    v_pk_add_f32 v[16:17], v[16:17], v[12:13]
    v_lshlrev_b32 v14, 16, v217
    v_and_b32 v15, 0xffff0000, v217
    v_pk_add_f32 v[18:19], v[18:19], v[14:15]
    v_lshlrev_b32 v12, 16, v218
    v_and_b32 v13, 0xffff0000, v218
    v_pk_add_f32 v[20:21], v[20:21], v[12:13]
    v_lshlrev_b32 v14, 16, v219
    v_and_b32 v15, 0xffff0000, v219
    v_pk_add_f32 v[22:23], v[22:23], v[14:15]
    v_lshlrev_b32 v12, 16, v220
    v_and_b32 v13, 0xffff0000, v220
    v_pk_add_f32 v[24:25], v[24:25], v[12:13]
    v_lshlrev_b32 v14, 16, v221
    v_and_b32 v15, 0xffff0000, v221
    v_pk_add_f32 v[26:27], v[26:27], v[14:15]
    v_lshlrev_b32 v12, 16, v222
    v_and_b32 v13, 0xffff0000, v222
    v_pk_add_f32 v[28:29], v[28:29], v[12:13]
    v_lshlrev_b32 v14, 16, v223
    v_and_b32 v15, 0xffff0000, v223
    v_pk_add_f32 v[30:31], v[30:31], v[14:15]
    s_waitcnt vmcnt(7)
    v_lshlrev_b32 v12, 16, v224
    v_and_b32 v13, 0xffff0000, v224
    v_pk_add_f32 v[16:17], v[16:17], v[12:13]
    v_lshlrev_b32 v14, 16, v225
    v_and_b32 v15, 0xffff0000, v225
    v_pk_add_f32 v[18:19], v[18:19], v[14:15]
    v_lshlrev_b32 v12, 16, v226
    v_and_b32 v13, 0xffff0000, v226
    v_pk_add_f32 v[20:21], v[20:21], v[12:13]
    v_lshlrev_b32 v14, 16, v227
    v_and_b32 v15, 0xffff0000, v227
    v_pk_add_f32 v[22:23], v[22:23], v[14:15]
    s_waitcnt vmcnt(6)
    v_lshlrev_b32 v12, 16, v228
    v_and_b32 v13, 0xffff0000, v228
    v_pk_add_f32 v[24:25], v[24:25], v[12:13]
    v_lshlrev_b32 v14, 16, v229
    v_and_b32 v15, 0xffff0000, v229
    v_pk_add_f32 v[26:27], v[26:27], v[14:15]
    v_lshlrev_b32 v12, 16, v230
    v_and_b32 v13, 0xffff0000, v230
    v_pk_add_f32 v[28:29], v[28:29], v[12:13]
    v_lshlrev_b32 v14, 16, v231
    v_and_b32 v15, 0xffff0000, v231
    v_pk_add_f32 v[30:31], v[30:31], v[14:15]
    s_waitcnt vmcnt(5)
    v_lshlrev_b32 v12, 16, v232
    v_and_b32 v13, 0xffff0000, v232
    v_pk_add_f32 v[16:17], v[16:17], v[12:13]
    v_lshlrev_b32 v14, 16, v233
    v_and_b32 v15, 0xffff0000, v233
    v_pk_add_f32 v[18:19], v[18:19], v[14:15]
    v_lshlrev_b32 v12, 16, v234
    v_and_b32 v13, 0xffff0000, v234
    v_pk_add_f32 v[20:21], v[20:21], v[12:13]
    v_lshlrev_b32 v14, 16, v235
    v_and_b32 v15, 0xffff0000, v235
    v_pk_add_f32 v[22:23], v[22:23], v[14:15]
    s_waitcnt vmcnt(4)
    v_lshlrev_b32 v12, 16, v236
    v_and_b32 v13, 0xffff0000, v236
    v_pk_add_f32 v[24:25], v[24:25], v[12:13]
    v_lshlrev_b32 v14, 16, v237
    v_and_b32 v15, 0xffff0000, v237
    v_pk_add_f32 v[26:27], v[26:27], v[14:15]
    v_lshlrev_b32 v12, 16, v238
    v_and_b32 v13, 0xffff0000, v238
    v_pk_add_f32 v[28:29], v[28:29], v[12:13]
    v_lshlrev_b32 v14, 16, v239
    v_and_b32 v15, 0xffff0000, v239
    v_pk_add_f32 v[30:31], v[30:31], v[14:15]
    s_waitcnt vmcnt(3)
    v_lshlrev_b32 v12, 16, v240
    v_and_b32 v13, 0xffff0000, v240
    v_pk_add_f32 v[16:17], v[16:17], v[12:13]
    v_lshlrev_b32 v14, 16, v241
    v_and_b32 v15, 0xffff0000, v241
    v_pk_add_f32 v[18:19], v[18:19], v[14:15]
    v_lshlrev_b32 v12, 16, v242
    v_and_b32 v13, 0xffff0000, v242
    v_pk_add_f32 v[20:21], v[20:21], v[12:13]
    v_lshlrev_b32 v14, 16, v243
    v_and_b32 v15, 0xffff0000, v243
    v_pk_add_f32 v[22:23], v[22:23], v[14:15]
    s_waitcnt vmcnt(2)
    v_lshlrev_b32 v12, 16, v244
    v_and_b32 v13, 0xffff0000, v244
    v_pk_add_f32 v[24:25], v[24:25], v[12:13]
    v_lshlrev_b32 v14, 16, v245
    v_and_b32 v15, 0xffff0000, v245
    v_pk_add_f32 v[26:27], v[26:27], v[14:15]
    v_lshlrev_b32 v12, 16, v246
    v_and_b32 v13, 0xffff0000, v246
    v_pk_add_f32 v[28:29], v[28:29], v[12:13]
    v_lshlrev_b32 v14, 16, v247
    v_and_b32 v15, 0xffff0000, v247
    v_pk_add_f32 v[30:31], v[30:31], v[14:15]
    s_waitcnt vmcnt(1)
    v_lshlrev_b32 v12, 16, v248
    v_and_b32 v13, 0xffff0000, v248
    v_pk_add_f32 v[16:17], v[16:17], v[12:13]
    v_lshlrev_b32 v14, 16, v249
    v_and_b32 v15, 0xffff0000, v249
    v_pk_add_f32 v[18:19], v[18:19], v[14:15]
    v_lshlrev_b32 v12, 16, v250
    v_and_b32 v13, 0xffff0000, v250
    v_pk_add_f32 v[20:21], v[20:21], v[12:13]
    v_lshlrev_b32 v14, 16, v251
    v_and_b32 v15, 0xffff0000, v251
    v_pk_add_f32 v[22:23], v[22:23], v[14:15]
    s_waitcnt vmcnt(0)
    v_lshlrev_b32 v12, 16, v252
    v_and_b32 v13, 0xffff0000, v252
    v_pk_add_f32 v[24:25], v[24:25], v[12:13]
    v_lshlrev_b32 v14, 16, v253
    v_and_b32 v15, 0xffff0000, v253
    v_pk_add_f32 v[26:27], v[26:27], v[14:15]
    v_lshlrev_b32 v12, 16, v254
    v_and_b32 v13, 0xffff0000, v254
    v_pk_add_f32 v[28:29], v[28:29], v[12:13]
    v_lshlrev_b32 v14, 16, v255
    v_and_b32 v15, 0xffff0000, v255
    v_pk_add_f32 v[30:31], v[30:31], v[14:15]
    s_waitcnt lgkmcnt(15)
    v_lshlrev_b32 v12, 16, v64
    v_and_b32 v13, 0xffff0000, v64
    v_pk_fma_f32 v[16:17], v[16:17], v[40:41], v[12:13]
    v_lshlrev_b32 v12, 16, v65
    v_and_b32 v13, 0xffff0000, v65
    v_pk_fma_f32 v[18:19], v[18:19], v[42:43], v[12:13]
    v_lshlrev_b32 v12, 16, v66
    v_and_b32 v13, 0xffff0000, v66
    v_pk_fma_f32 v[20:21], v[20:21], v[44:45], v[12:13]
    v_lshlrev_b32 v12, 16, v67
    v_and_b32 v13, 0xffff0000, v67
    v_pk_fma_f32 v[22:23], v[22:23], v[46:47], v[12:13]
    v_lshlrev_b32 v12, 16, v68
    v_and_b32 v13, 0xffff0000, v68
    v_pk_fma_f32 v[24:25], v[24:25], v[48:49], v[12:13]
    v_lshlrev_b32 v12, 16, v69
    v_and_b32 v13, 0xffff0000, v69
    v_pk_fma_f32 v[26:27], v[26:27], v[50:51], v[12:13]
    v_lshlrev_b32 v12, 16, v70
    v_and_b32 v13, 0xffff0000, v70
    v_pk_fma_f32 v[28:29], v[28:29], v[52:53], v[12:13]
    v_lshlrev_b32 v12, 16, v71
    v_and_b32 v13, 0xffff0000, v71
    v_pk_fma_f32 v[30:31], v[30:31], v[54:55], v[12:13]
    v_lshlrev_b32 v12, 16, v72
    v_and_b32 v13, 0xffff0000, v72
    v_pk_fma_f32 v[32:33], v[32:33], v[56:57], v[12:13]
    v_lshlrev_b32 v12, 16, v73
    v_and_b32 v13, 0xffff0000, v73
    v_pk_fma_f32 v[34:35], v[34:35], v[58:59], v[12:13]
    v_lshlrev_b32 v12, 16, v74
    v_and_b32 v13, 0xffff0000, v74
    v_pk_fma_f32 v[36:37], v[36:37], v[60:61], v[12:13]
    v_lshlrev_b32 v12, 16, v75
    v_and_b32 v13, 0xffff0000, v75
    v_pk_fma_f32 v[38:39], v[38:39], v[62:63], v[12:13]
    v_add_f32 v100, v16, v17
    v_add_f32 v100, v100, v18
    v_add_f32 v100, v100, v19
    v_add_f32 v100, v100, v20
    v_add_f32 v100, v100, v21
    v_add_f32 v100, v100, v22
    v_add_f32 v100, v100, v23
    v_add_f32 v100, v100, v24
    v_add_f32 v100, v100, v25
    v_add_f32 v100, v100, v26
    v_add_f32 v100, v100, v27
    v_add_f32 v100, v100, v28
    v_add_f32 v100, v100, v29
    v_add_f32 v100, v100, v30
    v_add_f32 v100, v100, v31
    v_add_f32 v103, v32, v33
    v_add_f32 v103, v103, v34
    v_add_f32 v103, v103, v35
    v_add_f32 v103, v103, v36
    v_add_f32 v103, v103, v37
    v_add_f32 v103, v103, v38
    v_add_f32 v103, v103, v39
    v_fmac_f32 v100, 0x3e800000, v103
    s_nop 1
    v_add_f32_dpp v100, v100, v100 row_ror:8 row_mask:0xf bank_mask:0xf
    v_mov_b32 v103, v100
    s_nop 1
    v_permlane16_swap_b32 v103, v100
    v_add_f32 v100, v100, v103
    v_mov_b32 v103, v100
    s_nop 1
    v_permlane32_swap_b32 v103, v100
    v_add_f32 v100, v100, v103
    v_mul_f32 v100, 0x3be38e39, v100
    v_sub_f32 v184, v16, v100
    v_sub_f32 v185, v17, v100
    v_sub_f32 v186, v18, v100
    v_sub_f32 v187, v19, v100
    v_sub_f32 v188, v20, v100
    v_sub_f32 v189, v21, v100
    v_sub_f32 v190, v22, v100
    v_sub_f32 v191, v23, v100
    v_sub_f32 v192, v24, v100
    v_sub_f32 v193, v25, v100
    v_sub_f32 v194, v26, v100
    v_sub_f32 v195, v27, v100
    v_sub_f32 v196, v28, v100
    v_sub_f32 v197, v29, v100
    v_sub_f32 v198, v30, v100
    v_sub_f32 v199, v31, v100
    v_sub_f32 v200, v32, v100
    v_sub_f32 v201, v33, v100
    v_sub_f32 v202, v34, v100
    v_sub_f32 v203, v35, v100
    v_sub_f32 v204, v36, v100
    v_sub_f32 v205, v37, v100
    v_sub_f32 v206, v38, v100
    v_sub_f32 v207, v39, v100
    v_mul_f32 v101, v184, v184
    v_fmac_f32 v101, v185, v185
    v_fmac_f32 v101, v186, v186
    v_fmac_f32 v101, v187, v187
    v_fmac_f32 v101, v188, v188
    v_fmac_f32 v101, v189, v189
    v_fmac_f32 v101, v190, v190
    v_fmac_f32 v101, v191, v191
    v_fmac_f32 v101, v192, v192
    v_fmac_f32 v101, v193, v193
    v_fmac_f32 v101, v194, v194
    v_fmac_f32 v101, v195, v195
    v_fmac_f32 v101, v196, v196
    v_fmac_f32 v101, v197, v197
    v_fmac_f32 v101, v198, v198
    v_fmac_f32 v101, v199, v199
    v_mul_f32 v103, v200, v200
    v_fmac_f32 v103, v201, v201
    v_fmac_f32 v103, v202, v202
    v_fmac_f32 v103, v203, v203
    v_fmac_f32 v103, v204, v204
    v_fmac_f32 v103, v205, v205
    v_fmac_f32 v103, v206, v206
    v_fmac_f32 v103, v207, v207
    v_fmac_f32 v101, 0x3e800000, v103
    v_mul_f32 v102, v184, v76
    v_fmac_f32 v102, v185, v77
    v_fmac_f32 v102, v186, v78
    v_fmac_f32 v102, v187, v79
    v_fmac_f32 v102, v188, v80
    v_fmac_f32 v102, v189, v81
    v_fmac_f32 v102, v190, v82
    v_fmac_f32 v102, v191, v83
    v_fmac_f32 v102, v192, v84
    v_fmac_f32 v102, v193, v85
    v_fmac_f32 v102, v194, v86
    v_fmac_f32 v102, v195, v87
    v_fmac_f32 v102, v196, v88
    v_fmac_f32 v102, v197, v89
    v_fmac_f32 v102, v198, v90
    v_fmac_f32 v102, v199, v91
    v_mul_f32 v103, v200, v92
    v_fmac_f32 v103, v201, v93
    v_fmac_f32 v103, v202, v94
    v_fmac_f32 v103, v203, v95
    v_fmac_f32 v103, v204, v96
    v_fmac_f32 v103, v205, v97
    v_fmac_f32 v103, v206, v98
    v_fmac_f32 v103, v207, v99
    v_fmac_f32 v102, 0x3e800000, v103
    s_nop 1
    v_add_f32_dpp v101, v101, v101 row_ror:8 row_mask:0xf bank_mask:0xf
    v_add_f32_dpp v102, v102, v102 row_ror:8 row_mask:0xf bank_mask:0xf
    v_mov_b32 v103, v101
    v_mov_b32 v104, v102
    s_nop 0
    v_permlane16_swap_b32 v103, v101
    v_permlane16_swap_b32 v104, v102
    v_add_f32 v101, v101, v103
    v_add_f32 v102, v102, v104
    v_mov_b32 v103, v101
    v_mov_b32 v104, v102
    s_nop 0
    v_permlane32_swap_b32 v103, v101
    v_permlane32_swap_b32 v104, v102
    v_add_f32 v101, v101, v103
    v_add_f32 v102, v102, v104
    ds_write_b32 v10, v100 offset:0
    ds_write_b32 v10, v101 offset:128
    ds_write_b32 v10, v102 offset:256
    s_waitcnt lgkmcnt(0)
    s_barrier
    ds_read_b128 v[40:43], v11 offset:0
    ds_read_b128 v[44:47], v11 offset:128
    ds_read_b128 v[48:51], v11 offset:256
    ds_read_b128 v[52:55], v11 offset:384
    ds_read_b128 v[56:59], v11 offset:512
    s_waitcnt lgkmcnt(4)
    v_add_f32 v12, v40, v41
    v_add_f32 v13, v42, v43
    v_add_f32 v12, v12, v13
    v_mul_f32 v12, 0x3e800000, v12
    v_sub_f32 v40, v40, v12
    v_sub_f32 v41, v41, v12
    v_sub_f32 v42, v42, v12
    v_sub_f32 v43, v43, v12
    v_sub_f32 v100, v100, v12
    v_mul_f32 v13, v40, v40
    v_fmac_f32 v13, v41, v41
    v_fmac_f32 v13, v42, v42
    v_fmac_f32 v13, v43, v43
    s_waitcnt lgkmcnt(3)
    v_add_f32 v14, v44, v45
    v_add_f32 v15, v46, v47
    v_add_f32 v14, v14, v15
    v_fmac_f32 v14, 0x43100000, v13
    v_mov_b32 v13, 0x3727c5ac
    v_fmac_f32 v13, 0x3ae38e39, v14
    v_rsq_f32 v13, v13
    s_waitcnt lgkmcnt(0)
    v_mul_f32 v100, v100, v13
    v_fma_f32 v184, v184, v13, v100
    v_fma_f32 v185, v185, v13, v100
    v_fma_f32 v186, v186, v13, v100
    v_fma_f32 v187, v187, v13, v100
    v_fma_f32 v188, v188, v13, v100
    v_fma_f32 v189, v189, v13, v100
    v_fma_f32 v190, v190, v13, v100
    v_fma_f32 v191, v191, v13, v100
    v_fma_f32 v192, v192, v13, v100
    v_fma_f32 v193, v193, v13, v100
    v_fma_f32 v194, v194, v13, v100
    v_fma_f32 v195, v195, v13, v100
    v_fma_f32 v196, v196, v13, v100
    v_fma_f32 v197, v197, v13, v100
    v_fma_f32 v198, v198, v13, v100
    v_fma_f32 v199, v199, v13, v100
    v_fma_f32 v200, v200, v13, v100
    v_fma_f32 v201, v201, v13, v100
    v_fma_f32 v202, v202, v13, v100
    v_fma_f32 v203, v203, v13, v100
    v_fma_f32 v204, v204, v13, v100
    v_fma_f32 v205, v205, v13, v100
    v_fma_f32 v206, v206, v13, v100
    v_fma_f32 v207, v207, v13, v100
    v_pk_fma_f32 v[184:185], v[184:185], v[112:113], v[136:137]
    v_pk_fma_f32 v[186:187], v[186:187], v[114:115], v[138:139]
    v_pk_fma_f32 v[188:189], v[188:189], v[116:117], v[140:141]
    v_pk_fma_f32 v[190:191], v[190:191], v[118:119], v[142:143]
    v_pk_fma_f32 v[192:193], v[192:193], v[120:121], v[144:145]
    v_pk_fma_f32 v[194:195], v[194:195], v[122:123], v[146:147]
    v_pk_fma_f32 v[196:197], v[196:197], v[124:125], v[148:149]
    v_pk_fma_f32 v[198:199], v[198:199], v[126:127], v[150:151]
    v_pk_fma_f32 v[200:201], v[200:201], v[128:129], v[152:153]
    v_pk_fma_f32 v[202:203], v[202:203], v[130:131], v[154:155]
    v_pk_fma_f32 v[204:205], v[204:205], v[132:133], v[156:157]
    v_pk_fma_f32 v[206:207], v[206:207], v[134:135], v[158:159]
    v_pk_fma_f32 v[16:17], v[184:185], v[160:161], v[16:17]
    v_pk_fma_f32 v[18:19], v[186:187], v[162:163], v[18:19]
    v_pk_fma_f32 v[20:21], v[188:189], v[164:165], v[20:21]
    v_pk_fma_f32 v[22:23], v[190:191], v[166:167], v[22:23]
    v_pk_fma_f32 v[24:25], v[192:193], v[168:169], v[24:25]
    v_pk_fma_f32 v[26:27], v[194:195], v[170:171], v[26:27]
    v_pk_fma_f32 v[28:29], v[196:197], v[172:173], v[28:29]
    v_pk_fma_f32 v[30:31], v[198:199], v[174:175], v[30:31]
    v_pk_fma_f32 v[32:33], v[200:201], v[176:177], v[32:33]
    v_pk_fma_f32 v[34:35], v[202:203], v[178:179], v[34:35]
    v_pk_fma_f32 v[36:37], v[204:205], v[180:181], v[36:37]
    v_pk_fma_f32 v[38:39], v[206:207], v[182:183], v[38:39]
    v_cvt_pk_bf16_f32 v112, v16, v17
    v_cvt_pk_bf16_f32 v113, v18, v19
    v_cvt_pk_bf16_f32 v114, v20, v21
    v_cvt_pk_bf16_f32 v115, v22, v23
    ds_write_b128 v1, v[112:115] offset:0
    v_cvt_pk_bf16_f32 v116, v24, v25
    v_cvt_pk_bf16_f32 v117, v26, v27
    v_cvt_pk_bf16_f32 v118, v28, v29
    v_cvt_pk_bf16_f32 v119, v30, v31
    ds_write_b128 v1, v[116:119] offset:128
    v_cvt_pk_bf16_f32 v120, v32, v33
    v_cvt_pk_bf16_f32 v121, v34, v35
    v_cvt_pk_bf16_f32 v122, v36, v37
    v_cvt_pk_bf16_f32 v123, v38, v39
    ds_write_b128 v2, v[120:123] offset:0
    v_cvt_pk_bf16_f32 v124, v184, v185
    v_cvt_pk_bf16_f32 v125, v186, v187
    v_cvt_pk_bf16_f32 v126, v188, v189
    v_cvt_pk_bf16_f32 v127, v190, v191
    ds_write_b128 v1, v[124:127] offset:9344
    v_cvt_pk_bf16_f32 v128, v192, v193
    v_cvt_pk_bf16_f32 v129, v194, v195
    v_cvt_pk_bf16_f32 v130, v196, v197
    v_cvt_pk_bf16_f32 v131, v198, v199
    ds_write_b128 v1, v[128:131] offset:9472
    v_cvt_pk_bf16_f32 v132, v200, v201
    v_cvt_pk_bf16_f32 v133, v202, v203
    v_cvt_pk_bf16_f32 v134, v204, v205
    v_cvt_pk_bf16_f32 v135, v206, v207
    ds_write_b128 v2, v[132:135] offset:9344
    v_fmac_f32 v48, v40, v52
    v_fmac_f32 v49, v41, v53
    v_fmac_f32 v50, v42, v54
    v_fmac_f32 v51, v43, v55
    v_add_f32 v14, v48, v49
    v_add_f32 v15, v50, v51
    v_add_f32 v14, v14, v15
    v_add_f32 v15, v56, v57
    v_add_f32 v12, v58, v59
    v_add_f32 v15, v15, v12
    v_fmac_f32 v15, v14, v13
    s_waitcnt lgkmcnt(0)
    s_barrier
    ds_read_b128 v[160:163], v107
    ds_read_b128 v[164:167], v108
    ds_read_b128 v[168:171], v109
    ds_read_b128 v[172:175], v110
    ds_read_b128 v[176:179], v111
    s_lshl_b32 s3, s96, 3
    s_sub_u32 s3, 0xfff, s3
    v_and_b32 v14, 7, v0
    v_sub_u32 v14, s3, v14
    v_ashrrev_i32 v12, 31, v15
    v_or_b32 v12, 0x80000000, v12
    v_xor_b32 v12, v12, v15
    v_and_b32 v12, 0xfffff000, v12
    v_or_b32 v100, v12, v14
    v_mov_b32 v101, 0
    s_waitcnt lgkmcnt(4)
    buffer_store_dwordx4 v[160:163], v9, s[24:27], 0 offen offset:0 sc1
    s_waitcnt lgkmcnt(3)
    buffer_store_dwordx4 v[164:167], v9, s[24:27], 0 offen offset:1024 sc1
    s_waitcnt lgkmcnt(2)
    buffer_store_dwordx4 v[168:171], v9, s[24:27], 0 offen offset:2048 sc1
    s_waitcnt lgkmcnt(1)
    buffer_store_dwordx4 v[172:175], v9, s[24:27], 0 offen offset:3072 sc1
    s_waitcnt lgkmcnt(0)
    s_mov_b32 exec_hi, 0
    s_mov_b32 s3, 4096
    buffer_store_dwordx4 v[176:179], v9, s[24:27], s3 offen offset:0 sc1
    s_mov_b64 exec, -1
    s_nop 1
    v_mov_b32_dpp v12, v100 row_ror:1 row_mask:0xf bank_mask:0xf
    v_mov_b32_dpp v13, v101 row_ror:1 row_mask:0xf bank_mask:0xf
    v_max_u32 v101, v101, v13
    v_med3_u32 v101, v100, v12, v101
    v_max_u32 v100, v100, v12
    s_nop 1
    v_mov_b32_dpp v12, v100 row_ror:2 row_mask:0xf bank_mask:0xf
    v_mov_b32_dpp v13, v101 row_ror:2 row_mask:0xf bank_mask:0xf
    v_max_u32 v101, v101, v13
    v_med3_u32 v101, v100, v12, v101
    v_max_u32 v100, v100, v12
    s_nop 1
    v_mov_b32_dpp v12, v100 row_ror:4 row_mask:0xf bank_mask:0xf
    v_mov_b32_dpp v13, v101 row_ror:4 row_mask:0xf bank_mask:0xf
    v_max_u32 v101, v101, v13
    v_med3_u32 v101, v100, v12, v101
    v_max_u32 v100, v100, v12
    s_lshl_b32 s3, s96, 7
    s_add_u32 s3, s3, 917504
    v_lshlrev_b32 v14, 7, v0
    s_lshl_b32 s15, s51, 13
    s_add_u32 s15, s15, 917504
    s_waitcnt vmcnt(0)
    s_barrier
    s_cmp_lg_u32 s51, 0
    s_cbranch_scc1 L2_nokey
    s_mov_b64 exec, 1
    buffer_store_dwordx2 v[100:101], v14, s[84:87], s3 offen sc1
    s_mov_b64 exec, -1
L2_nokey:
    s_cmp_ge_u32 s2, 180
    s_cbranch_scc1 L2_fin
    s_cmp_ge_u32 s2, 144
    s_cbranch_scc1 L2_gather
    v_lshrrev_b32 v21, 4, v0
    v_bfe_u32 v20, v0, 2, 2
    v_lshl_add_u32 v20, v21, 3, v20
    v_and_b32 v21, 3, v0
    v_lshlrev_b32 v22, 6, v20
    v_lshl_add_u32 v22, v21, 3, v22
    s_cmp_lt_u32 s51, 2
    s_cselect_b32 s3, 126976, 0
    s_cselect_b32 s14, 0, 16384
    s_add_u32 s3, s3, s14
    s_and_b32 s14, s51, 1
    s_lshl_b32 s14, s14, 5
    s_add_u32 s3, s3, s14
    v_add_u32 v22, s3, v22
    v_mul_u32_u24 v23, 1152, v20
    v_lshl_add_u32 v23, v21, 3, v23
    s_mul_i32 s3, s51, 288
    s_add_u32 s3, s3, 53248
    v_add_u32 v23, s3, v23
    ds_read_b64_tr_b16 a[64:65], v22 offset:0
    ds_read_b64_tr_b16 a[66:67], v22 offset:256
    ds_read_b64_tr_b16 a[68:69], v22 offset:2048
    ds_read_b64_tr_b16 a[70:71], v22 offset:2304
    ds_read_b64_tr_b16 a[72:73], v22 offset:4096
    ds_read_b64_tr_b16 a[74:75], v22 offset:4352
    ds_read_b64_tr_b16 a[76:77], v22 offset:6144
    ds_read_b64_tr_b16 a[78:79], v22 offset:6400
    ds_read_b64_tr_b16 a[80:81], v22 offset:8192
    ds_read_b64_tr_b16 a[82:83], v22 offset:8448
    ds_read_b64_tr_b16 a[84:85], v22 offset:10240
    ds_read_b64_tr_b16 a[86:87], v22 offset:10496
    ds_read_b64_tr_b16 a[88:89], v22 offset:12288
    ds_read_b64_tr_b16 a[90:91], v22 offset:12544
    ds_read_b64_tr_b16 a[92:93], v22 offset:14336
    ds_read_b64_tr_b16 a[94:95], v22 offset:14592
    ds_read_b64_tr_b16 a[96:97], v22 offset:16384
    ds_read_b64_tr_b16 a[98:99], v22 offset:16640
    ds_read_b64_tr_b16 a[100:101], v22 offset:18432
    ds_read_b64_tr_b16 a[102:103], v22 offset:18688
    ds_read_b64_tr_b16 a[104:105], v22 offset:20480
    ds_read_b64_tr_b16 a[106:107], v22 offset:20736
    ds_read_b64_tr_b16 a[108:109], v22 offset:22528
    ds_read_b64_tr_b16 a[110:111], v22 offset:22784
    ds_read_b64_tr_b16 a[112:113], v22 offset:24576
    ds_read_b64_tr_b16 a[114:115], v22 offset:24832
    ds_read_b64_tr_b16 a[116:117], v22 offset:26624
    ds_read_b64_tr_b16 a[118:119], v22 offset:26880
    ds_read_b64_tr_b16 a[120:121], v22 offset:28672
    ds_read_b64_tr_b16 a[122:123], v22 offset:28928
    ds_read_b64_tr_b16 a[124:125], v22 offset:30720
    ds_read_b64_tr_b16 a[126:127], v22 offset:30976
    ds_read_b64_tr_b16 a[128:129], v22 offset:32768
    ds_read_b64_tr_b16 a[130:131], v22 offset:33024
    ds_read_b64_tr_b16 a[132:133], v22 offset:34816
    ds_read_b64_tr_b16 a[134:135], v22 offset:35072
    ds_read_b64_tr_b16 a[136:137], v23 offset:0
    ds_read_b64_tr_b16 a[138:139], v23 offset:4608
    ds_read_b64_tr_b16 a[140:141], v23 offset:32
    ds_read_b64_tr_b16 a[142:143], v23 offset:4640
    ds_read_b64_tr_b16 a[144:145], v23 offset:64
    ds_read_b64_tr_b16 a[146:147], v23 offset:4672
    ds_read_b64_tr_b16 a[148:149], v23 offset:96
    ds_read_b64_tr_b16 a[150:151], v23 offset:4704
    ds_read_b64_tr_b16 a[152:153], v23 offset:128
    ds_read_b64_tr_b16 a[154:155], v23 offset:4736
    ds_read_b64_tr_b16 a[156:157], v23 offset:160
    ds_read_b64_tr_b16 a[158:159], v23 offset:4768
    ds_read_b64_tr_b16 a[160:161], v23 offset:192
    ds_read_b64_tr_b16 a[162:163], v23 offset:4800
    ds_read_b64_tr_b16 a[164:165], v23 offset:224
    ds_read_b64_tr_b16 a[166:167], v23 offset:4832
    ds_read_b64_tr_b16 a[168:169], v23 offset:256
    ds_read_b64_tr_b16 a[170:171], v23 offset:4864
L2_gather:
    s_mov_b32 s97, 0x20000
L2_p2:
    buffer_load_dwordx2 v[16:17], v14, s[84:87], s15 offen sc1
    s_waitcnt vmcnt(0)
    v_min_u32 v12, v16, v17
    v_cmp_eq_u32 vcc, 0, v12
    s_sub_u32 s97, s97, 1
    s_cselect_b64 vcc, 0, vcc
    s_cmp_eq_u64 vcc, 0
    s_cbranch_scc1 L2_p2_ok
    s_mov_b64 exec, vcc
    s_sleep 1
    s_branch L2_p2
L2_p2_ok:
    s_mov_b64 exec, -1
    s_nop 1
    v_mov_b32_dpp v12, v16 row_ror:1 row_mask:0xf bank_mask:0xf
    v_mov_b32_dpp v13, v17 row_ror:1 row_mask:0xf bank_mask:0xf
    v_max_u32 v17, v17, v13
    v_med3_u32 v17, v16, v12, v17
    v_max_u32 v16, v16, v12
    s_nop 1
    v_mov_b32_dpp v12, v16 row_ror:2 row_mask:0xf bank_mask:0xf
    v_mov_b32_dpp v13, v17 row_ror:2 row_mask:0xf bank_mask:0xf
    v_max_u32 v17, v17, v13
    v_med3_u32 v17, v16, v12, v17
    v_max_u32 v16, v16, v12
    s_nop 1
    v_mov_b32_dpp v12, v16 row_ror:4 row_mask:0xf bank_mask:0xf
    v_mov_b32_dpp v13, v17 row_ror:4 row_mask:0xf bank_mask:0xf
    v_max_u32 v17, v17, v13
    v_med3_u32 v17, v16, v12, v17
    v_max_u32 v16, v16, v12
    s_nop 1
    v_mov_b32_dpp v12, v16 row_ror:8 row_mask:0xf bank_mask:0xf
    v_mov_b32_dpp v13, v17 row_ror:8 row_mask:0xf bank_mask:0xf
    v_max_u32 v17, v17, v13
    v_med3_u32 v17, v16, v12, v17
    v_max_u32 v16, v16, v12
    v_mov_b32 v12, v16
    v_mov_b32 v13, v17
    s_nop 0
    v_permlane16_swap_b32 v12, v16
    v_permlane16_swap_b32 v13, v17
    v_max_u32 v17, v17, v13
    v_med3_u32 v17, v16, v12, v17
    v_max_u32 v16, v16, v12
    v_mov_b32 v12, v16
    v_mov_b32 v13, v17
    s_nop 0
    v_permlane32_swap_b32 v12, v16
    v_permlane32_swap_b32 v13, v17
    v_max_u32 v17, v17, v13
    v_med3_u32 v17, v16, v12, v17
    v_max_u32 v16, v16, v12
    s_lshl_b32 s3, s51, 3
    s_add_u32 s3, s3, 14080
    v_mov_b32 v12, s3
    v_mov_b32 v13, 14080
    ds_write_b64 v12, v[16:17]
    s_waitcnt lgkmcnt(0)
    s_barrier
    ds_read_b128 v[16:19], v13
    ds_read_b128 v[20:23], v13 offset:16
    v_and_b32 v6, 1, v0
    v_lshrrev_b32 v7, 4, v0
    s_waitcnt lgkmcnt(0)
    v_max_u32 v17, v17, v19
    v_med3_u32 v17, v16, v18, v17
    v_max_u32 v16, v16, v18
    v_max_u32 v21, v21, v23
    v_med3_u32 v21, v20, v22, v21
    v_max_u32 v20, v20, v22
    v_max_u32 v17, v17, v21
    v_med3_u32 v17, v16, v20, v17
    v_max_u32 v16, v16, v20
    s_cmp_ge_u32 s2, 144
    s_cbranch_scc1 L2_red
    v_cmp_eq_u32 vcc, 0, v6
    s_nop 1
    v_cndmask_b32 v4, v17, v16, vcc
    v_and_b32 v4, 0x7ff, v4
    v_sub_u32 v4, 2047, v4
    v_mul_u32_u24 v5, 1152, v4
    v_lshl_add_u32 v5, v7, 4, v5
    s_mov_b32 s3, 4194304
    s_mov_b32 exec_lo, 0x30003
    s_mov_b32 exec_hi, 0x30003
    buffer_load_dwordx4 v[128:131], v5, s[84:87], s3 offen offset:0 sc1
    buffer_load_dwordx4 v[132:135], v5, s[84:87], s3 offen offset:64 sc1
    buffer_load_dwordx4 v[136:139], v5, s[84:87], s3 offen offset:128 sc1
    buffer_load_dwordx4 v[140:143], v5, s[84:87], s3 offen offset:192 sc1
    buffer_load_dwordx4 v[144:147], v5, s[84:87], s3 offen offset:256 sc1
    buffer_load_dwordx4 v[148:151], v5, s[84:87], s3 offen offset:320 sc1
    buffer_load_dwordx4 v[152:155], v5, s[84:87], s3 offen offset:384 sc1
    buffer_load_dwordx4 v[156:159], v5, s[84:87], s3 offen offset:448 sc1
    buffer_load_dwordx4 v[160:163], v5, s[84:87], s3 offen offset:512 sc1
    buffer_load_dwordx4 v[164:167], v5, s[84:87], s3 offen offset:576 sc1
    buffer_load_dwordx4 v[168:171], v5, s[84:87], s3 offen offset:640 sc1
    buffer_load_dwordx4 v[172:175], v5, s[84:87], s3 offen offset:704 sc1
    buffer_load_dwordx4 v[176:179], v5, s[84:87], s3 offen offset:768 sc1
    buffer_load_dwordx4 v[180:183], v5, s[84:87], s3 offen offset:832 sc1
    buffer_load_dwordx4 v[184:187], v5, s[84:87], s3 offen offset:896 sc1
    buffer_load_dwordx4 v[188:191], v5, s[84:87], s3 offen offset:960 sc1
    buffer_load_dwordx4 v[192:195], v5, s[84:87], s3 offen offset:1024 sc1
    buffer_load_dwordx4 v[196:199], v5, s[84:87], s3 offen offset:1088 sc1
    s_mov_b64 exec, -1
    v_lshlrev_b32 v11, 7, v6
    v_lshl_add_u32 v13, v7, 5, v11
    v_add_u32 v13, 13312, v13
    v_lshl_add_u32 v11, v7, 4, v11
    s_lshr_b32 s3, s51, 1
    s_lshl_b32 s3, s3, 8
    s_and_b32 s14, s51, 1
    s_lshl_b32 s14, s14, 6
    s_add_u32 s3, s3, s14
    s_add_u32 s3, s3, 13312
    v_add_u32 v11, s3, v11
    s_mul_i32 s14, s51, 1152
    s_add_u32 s3, s14, 110592
    v_mul_u32_u24 v9, 576, v6
    v_lshl_add_u32 v9, v7, 4, v9
    v_add_u32 v9, s3, v9
    v_add_u32 v10, s3, v8
    s_mul_i32 s15, s2, 4608
    s_add_u32 s15, s15, s14
    s_add_u32 s15, s15, 98304
    s_waitcnt vmcnt(17)
    v_mfma_f32_16x16x32_bf16 v[88:91], a[64:67], v[128:131], 0
    s_waitcnt vmcnt(16)
    v_mfma_f32_16x16x32_bf16 v[88:91], a[68:71], v[132:135], v[88:91]
    s_waitcnt vmcnt(15)
    v_mfma_f32_16x16x32_bf16 v[88:91], a[72:75], v[136:139], v[88:91]
    s_waitcnt vmcnt(14)
    v_mfma_f32_16x16x32_bf16 v[88:91], a[76:79], v[140:143], v[88:91]
    s_waitcnt vmcnt(13)
    v_mfma_f32_16x16x32_bf16 v[88:91], a[80:83], v[144:147], v[88:91]
    s_waitcnt vmcnt(12)
    v_mfma_f32_16x16x32_bf16 v[88:91], a[84:87], v[148:151], v[88:91]
    s_waitcnt vmcnt(11)
    v_mfma_f32_16x16x32_bf16 v[88:91], a[88:91], v[152:155], v[88:91]
    s_waitcnt vmcnt(10)
    v_mfma_f32_16x16x32_bf16 v[88:91], a[92:95], v[156:159], v[88:91]
    s_waitcnt vmcnt(9)
    v_mfma_f32_16x16x32_bf16 v[88:91], a[96:99], v[160:163], v[88:91]
    s_waitcnt vmcnt(8)
    v_mfma_f32_16x16x32_bf16 v[88:91], a[100:103], v[164:167], v[88:91]
    s_waitcnt vmcnt(7)
    v_mfma_f32_16x16x32_bf16 v[88:91], a[104:107], v[168:171], v[88:91]
    s_waitcnt vmcnt(6)
    v_mfma_f32_16x16x32_bf16 v[88:91], a[108:111], v[172:175], v[88:91]
    s_waitcnt vmcnt(5)
    v_mfma_f32_16x16x32_bf16 v[88:91], a[112:115], v[176:179], v[88:91]
    s_waitcnt vmcnt(4)
    v_mfma_f32_16x16x32_bf16 v[88:91], a[116:119], v[180:183], v[88:91]
    s_waitcnt vmcnt(3)
    v_mfma_f32_16x16x32_bf16 v[88:91], a[120:123], v[184:187], v[88:91]
    s_waitcnt vmcnt(2)
    v_mfma_f32_16x16x32_bf16 v[88:91], a[124:127], v[188:191], v[88:91]
    s_waitcnt vmcnt(1)
    v_mfma_f32_16x16x32_bf16 v[88:91], a[128:131], v[192:195], v[88:91]
    s_waitcnt vmcnt(0)
    v_mfma_f32_16x16x32_bf16 v[88:91], a[132:135], v[196:199], v[88:91]
    s_nop 5
    s_mov_b32 exec_lo, 0x30003
    s_mov_b32 exec_hi, 0x30003
    ds_write_b128 v11, v[88:91]
    s_mov_b64 exec, -1
    s_waitcnt lgkmcnt(0)
    s_barrier
    ds_read_b128 v[16:19], v13 offset:0
    ds_read_b128 v[20:23], v13 offset:16
    ds_read_b128 v[24:27], v13 offset:256
    ds_read_b128 v[28:31], v13 offset:272
    s_waitcnt lgkmcnt(2)
    v_mul_f32 v32, 0xbfb8aa3b, v16
    v_mul_f32 v33, 0xbfb8aa3b, v17
    v_mul_f32 v34, 0xbfb8aa3b, v18
    v_mul_f32 v35, 0xbfb8aa3b, v19
    v_mul_f32 v36, 0xbfb8aa3b, v20
    v_mul_f32 v37, 0xbfb8aa3b, v21
    v_mul_f32 v38, 0xbfb8aa3b, v22
    v_mul_f32 v39, 0xbfb8aa3b, v23
    v_exp_f32 v32, v32
    v_exp_f32 v33, v33
    v_exp_f32 v34, v34
    v_exp_f32 v35, v35
    v_exp_f32 v36, v36
    v_exp_f32 v37, v37
    v_exp_f32 v38, v38
    v_exp_f32 v39, v39
    v_add_f32 v32, 1.0, v32
    v_add_f32 v33, 1.0, v33
    v_add_f32 v34, 1.0, v34
    v_add_f32 v35, 1.0, v35
    v_add_f32 v36, 1.0, v36
    v_add_f32 v37, 1.0, v37
    v_add_f32 v38, 1.0, v38
    v_add_f32 v39, 1.0, v39
    v_rcp_f32 v32, v32
    v_rcp_f32 v33, v33
    v_rcp_f32 v34, v34
    v_rcp_f32 v35, v35
    v_rcp_f32 v36, v36
    v_rcp_f32 v37, v37
    v_rcp_f32 v38, v38
    v_rcp_f32 v39, v39
    s_waitcnt lgkmcnt(0)
    v_mul_f32 v16, v16, v32
    v_mul_f32 v17, v17, v33
    v_mul_f32 v18, v18, v34
    v_mul_f32 v19, v19, v35
    v_mul_f32 v20, v20, v36
    v_mul_f32 v21, v21, v37
    v_mul_f32 v22, v22, v38
    v_mul_f32 v23, v23, v39
    v_mul_f32 v16, v16, v24
    v_mul_f32 v17, v17, v25
    v_mul_f32 v18, v18, v26
    v_mul_f32 v19, v19, v27
    v_mul_f32 v20, v20, v28
    v_mul_f32 v21, v21, v29
    v_mul_f32 v22, v22, v30
    v_mul_f32 v23, v23, v31
    v_cvt_pk_bf16_f32 v40, v16, v17
    v_cvt_pk_bf16_f32 v41, v18, v19
    v_cvt_pk_bf16_f32 v42, v20, v21
    v_cvt_pk_bf16_f32 v43, v22, v23
    s_nop 1
    v_mfma_f32_16x16x32_bf16 v[48:51], a[136:139], v[40:43], 0
    v_mfma_f32_16x16x32_bf16 v[52:55], a[140:143], v[40:43], 0
    v_mfma_f32_16x16x32_bf16 v[56:59], a[144:147], v[40:43], 0
    v_mfma_f32_16x16x32_bf16 v[60:63], a[148:151], v[40:43], 0
    v_mfma_f32_16x16x32_bf16 v[64:67], a[152:155], v[40:43], 0
    v_mfma_f32_16x16x32_bf16 v[68:71], a[156:159], v[40:43], 0
    v_mfma_f32_16x16x32_bf16 v[72:75], a[160:163], v[40:43], 0
    v_mfma_f32_16x16x32_bf16 v[76:79], a[164:167], v[40:43], 0
    v_mfma_f32_16x16x32_bf16 v[80:83], a[168:171], v[40:43], 0
    s_mov_b32 exec_lo, 0x30003
    s_mov_b32 exec_hi, 0x30003
    ds_write_b128 v9, v[48:51] offset:0
    ds_write_b128 v9, v[52:55] offset:64
    ds_write_b128 v9, v[56:59] offset:128
    ds_write_b128 v9, v[60:63] offset:192
    ds_write_b128 v9, v[64:67] offset:256
    ds_write_b128 v9, v[68:71] offset:320
    ds_write_b128 v9, v[72:75] offset:384
    ds_write_b128 v9, v[76:79] offset:448
    ds_write_b128 v9, v[80:83] offset:512
    s_mov_b64 exec, -1
    ds_read_b128 v[16:19], v10
    ds_read_b128 v[20:23], v10 offset:1024
    s_waitcnt lgkmcnt(0)
    v_min_u32 v16, -2, v16
    v_min_u32 v17, -2, v17
    v_min_u32 v18, -2, v18
    v_min_u32 v19, -2, v19
    v_min_u32 v20, -2, v20
    v_min_u32 v21, -2, v21
    v_min_u32 v22, -2, v22
    v_min_u32 v23, -2, v23
    buffer_store_dwordx4 v[16:19], v8, s[84:87], s15 offen sc1
    s_mov_b64 exec, 0xff
    buffer_store_dwordx4 v[20:23], v8, s[84:87], s15 offen offset:1024 sc1
    s_branch L2_fin
L2_red:
    s_mov_b32 s3, 98304
    s_add_u32 s32, s84, s3
    s_addc_u32 s33, s85, 0
    s_mov_b32 s34, 663552
    s_mov_b32 s35, 0x20000
    s_sub_u32 s3, s2, 144
    s_mul_i32 s14, s3, 7282
    s_lshr_b32 s14, s14, 16
    s_mul_i32 s15, s14, 9
    s_sub_u32 s15, s3, s15
    s_lshl_b32 s15, s15, 5
    s_mul_i32 s14, s14, 144
    v_and_b32 v6, 7, v0
    v_lshl_add_u32 v7, v6, 2, s15
    v_cmp_gt_u32 vcc, 144, v7
    v_subrev_u32 v9, 144, v7
    v_lshrrev_b32 v10, 3, v0
    v_cndmask_b32 v7, v9, v7, vcc
    v_cndmask_b32 v16, v17, v16, vcc
    v_add_u32 v7, s14, v7
    v_and_b32 v9, 0x7ff, v16
    v_sub_u32 v9, 2047, v9
    v_mul_u32_u24 v9, 1152, v9
    v_lshl_add_u32 v9, v7, 1, v9
    v_lshlrev_b32 v7, 2, v7
    buffer_load_dwordx2 v[18:19], v9, s[80:83], 0 offen sc1
    ds_read_b128 v[20:23], v7 offset:6912
    s_lshl_b32 s14, s51, 3
    v_add_u32 v10, s14, v10
    v_mul_u32_u24 v10, 4608, v10
    v_lshl_add_u32 v10, v6, 4, v10
    s_lshl_b32 s3, s3, 7
    v_add_u32 v24, s3, v10
    v_add_u32 v25, 147456, v24
    v_add_u32 v26, 294912, v24
    v_add_u32 v27, 442368, v24
    v_add_u32 v28, 589824, v24
    v_and_b32 v16, 0xfffff800, v16
    v_not_b32 v12, v16
    v_ashrrev_i32 v12, 31, v12
    v_or_b32 v12, 0x80000000, v12
    v_xor_b32 v16, v16, v12
    v_mul_f32 v16, 0xbfb8aa3b, v16
    v_exp_f32 v16, v16
    s_nop 0
    v_add_f32 v16, 1.0, v16
    v_rcp_f32 v16, v16
    s_waitcnt lgkmcnt(0)
    v_mul_f32 v20, v20, v16
    v_mul_f32 v21, v21, v16
    v_mul_f32 v22, v22, v16
    v_mul_f32 v23, v23, v16
    v_lshlrev_b32 v11, 4, v6
    v_add_u32 v11, 14336, v11
    s_lshl_b32 s14, s51, 7
    v_add_u32 v10, s14, v11
    s_mov_b32 s97, 0x20000
L2_p3:
    buffer_load_dwordx4 v[32:35], v24, s[32:35], 0 offen sc1
    buffer_load_dwordx4 v[36:39], v25, s[32:35], 0 offen sc1
    buffer_load_dwordx4 v[40:43], v26, s[32:35], 0 offen sc1
    buffer_load_dwordx4 v[44:47], v27, s[32:35], 0 offen sc1
    buffer_load_dwordx4 v[48:51], v28, s[32:35], 0 offen sc1
    s_waitcnt vmcnt(0)
    v_max3_u32 v12, v32, v33, v34
    v_max3_u32 v12, v12, v35, v36
    v_max3_u32 v12, v12, v37, v38
    v_max3_u32 v12, v12, v39, v40
    v_max3_u32 v12, v12, v41, v42
    v_max3_u32 v12, v12, v43, v44
    v_max3_u32 v12, v12, v45, v46
    v_max3_u32 v12, v12, v47, v48
    v_max3_u32 v12, v12, v49, v50
    v_max_u32 v12, v12, v51
    v_cmp_eq_u32 vcc, -1, v12
    s_sub_u32 s97, s97, 1
    s_cselect_b64 vcc, 0, vcc
    s_cmp_eq_u64 vcc, 0
    s_cbranch_scc1 L2_p3_ok
    s_sleep 1
    s_branch L2_p3
L2_p3_ok:
    v_pk_add_f32 v[32:33], v[32:33], v[36:37]
    v_pk_add_f32 v[40:41], v[40:41], v[44:45]
    v_pk_add_f32 v[32:33], v[32:33], v[48:49]
    v_pk_add_f32 v[32:33], v[32:33], v[40:41]
    v_pk_add_f32 v[34:35], v[34:35], v[38:39]
    v_pk_add_f32 v[42:43], v[42:43], v[46:47]
    v_pk_add_f32 v[34:35], v[34:35], v[50:51]
    v_pk_add_f32 v[34:35], v[34:35], v[42:43]
    s_nop 1
    v_add_f32_dpp v32, v32, v32 row_ror:8 row_mask:0xf bank_mask:0xf
    v_add_f32_dpp v33, v33, v33 row_ror:8 row_mask:0xf bank_mask:0xf
    v_add_f32_dpp v34, v34, v34 row_ror:8 row_mask:0xf bank_mask:0xf
    v_add_f32_dpp v35, v35, v35 row_ror:8 row_mask:0xf bank_mask:0xf
    v_mov_b32 v12, v32
    v_mov_b32 v13, v33
    v_mov_b32 v14, v34
    v_mov_b32 v15, v35
    v_permlane16_swap_b32 v12, v32
    v_permlane16_swap_b32 v13, v33
    v_permlane16_swap_b32 v14, v34
    v_permlane16_swap_b32 v15, v35
    v_add_f32 v32, v32, v12
    v_add_f32 v33, v33, v13
    v_add_f32 v34, v34, v14
    v_add_f32 v35, v35, v15
    v_mov_b32 v12, v32
    v_mov_b32 v13, v33
    v_mov_b32 v14, v34
    v_mov_b32 v15, v35
    v_permlane32_swap_b32 v12, v32
    v_permlane32_swap_b32 v13, v33
    v_permlane32_swap_b32 v14, v34
    v_permlane32_swap_b32 v15, v35
    v_add_f32 v32, v32, v12
    v_add_f32 v33, v33, v13
    v_add_f32 v34, v34, v14
    v_add_f32 v35, v35, v15
    ds_write_b128 v10, v[32:35]
    s_waitcnt lgkmcnt(0)
    s_barrier
    ds_read_b128 v[32:35], v11 offset:0
    ds_read_b128 v[36:39], v11 offset:128
    ds_read_b128 v[40:43], v11 offset:256
    ds_read_b128 v[44:47], v11 offset:384
    v_lshlrev_b32 v12, 16, v18
    v_and_b32 v13, 0xffff0000, v18
    v_lshlrev_b32 v14, 16, v19
    v_and_b32 v15, 0xffff0000, v19
    s_waitcnt lgkmcnt(0)
    v_pk_add_f32 v[32:33], v[32:33], v[36:37]
    v_pk_add_f32 v[40:41], v[40:41], v[44:45]
    v_pk_add_f32 v[32:33], v[32:33], v[40:41]
    v_pk_fma_f32 v[12:13], v[32:33], v[20:21], v[12:13]
    v_pk_add_f32 v[34:35], v[34:35], v[38:39]
    v_pk_add_f32 v[42:43], v[42:43], v[46:47]
    v_pk_add_f32 v[34:35], v[34:35], v[42:43]
    v_pk_fma_f32 v[14:15], v[34:35], v[22:23], v[14:15]
    v_cvt_pk_bf16_f32 v12, v12, v13
    v_cvt_pk_bf16_f32 v13, v14, v15
    s_cmp_lg_u32 s51, 0
    s_cbranch_scc1 L2_fin
    s_mov_b64 exec, 0xff
    buffer_store_dwordx2 v[12:13], v9, s[80:83], 0 offen sc1
L2_fin:
L2_end:
    s_endpgm
L2_fallback:
    s_waitcnt vmcnt(0) lgkmcnt(0)
    s_barrier
    v_lshrrev_b32 v14, 2, v0
    v_mul_u32_u24 v14, 1056, v14
    v_and_b32 v15, 3, v0
    v_lshl_add_u32 v14, v15, 3, v14
    v_add_u32 v2, 107008, v14
    v_and_b32 v14, 15, v0
    v_mul_u32_u24 v14, 1056, v14
    v_lshrrev_b32 v15, 4, v0
    v_lshl_add_u32 v14, v15, 4, v14
    v_add_u32 v1, 90112, v14
    v_mov_b32 v32, 0xff800000
    v_mov_b32 v33, 0xff800000
    v_mov_b32 v34, 0xff800000
    v_mov_b32 v35, 0xff800000
    s_mov_b32 s50, 1
    s_mov_b32 s46, 0
L2_fb_loop:
    s_add_u32 m0, s44, 73728
    s_nop 0
    buffer_load_dwordx4 v5, s[16:19], s46 offen offset:0 lds
    s_add_u32 m0, s44, 73760
    s_nop 0
    buffer_load_dwordx4 v5, s[16:19], s46 offen offset:1024 lds
    s_add_u32 m0, s44, 73792
    s_nop 0
    buffer_load_dwordx4 v5, s[16:19], s46 offen offset:2048 lds
    s_add_u32 m0, s44, 73824
    s_nop 0
    buffer_load_dwordx4 v5, s[16:19], s46 offen offset:3072 lds
    s_waitcnt vmcnt(0) lgkmcnt(0)
    s_barrier
    ds_read_b128 a[64:67], v1 offset:0
    ds_read_b128 a[68:71], v1 offset:64
    ds_read_b128 a[72:75], v1 offset:128
    ds_read_b128 a[76:79], v1 offset:192
    ds_read_b128 a[80:83], v1 offset:256
    ds_read_b128 a[84:87], v1 offset:320
    ds_read_b128 a[88:91], v1 offset:384
    ds_read_b128 a[92:95], v1 offset:448
    ds_read_b128 a[96:99], v1 offset:512
    ds_read_b128 a[100:103], v1 offset:576
    ds_read_b128 a[104:107], v1 offset:640
    ds_read_b128 a[108:111], v1 offset:704
    ds_read_b128 a[112:115], v1 offset:768
    ds_read_b128 a[116:119], v1 offset:832
    ds_read_b128 a[120:123], v1 offset:896
    ds_read_b128 a[124:127], v1 offset:960
    s_waitcnt vmcnt(0) lgkmcnt(0)
    s_barrier
    v_mfma_f32_16x16x32_bf16 v[16:19], a[64:67], v[64:67], 0
    v_mfma_f32_16x16x32_bf16 v[16:19], a[68:71], v[68:71], v[16:19]
    v_mfma_f32_16x16x32_bf16 v[16:19], a[72:75], v[72:75], v[16:19]
    v_mfma_f32_16x16x32_bf16 v[16:19], a[76:79], v[76:79], v[16:19]
    v_mfma_f32_16x16x32_bf16 v[20:23], a[80:83], v[64:67], 0
    v_mfma_f32_16x16x32_bf16 v[20:23], a[84:87], v[68:71], v[20:23]
    v_mfma_f32_16x16x32_bf16 v[20:23], a[88:91], v[72:75], v[20:23]
    v_mfma_f32_16x16x32_bf16 v[20:23], a[92:95], v[76:79], v[20:23]
    v_mfma_f32_16x16x32_bf16 v[24:27], a[96:99], v[64:67], 0
    v_mfma_f32_16x16x32_bf16 v[24:27], a[100:103], v[68:71], v[24:27]
    v_mfma_f32_16x16x32_bf16 v[24:27], a[104:107], v[72:75], v[24:27]
    v_mfma_f32_16x16x32_bf16 v[24:27], a[108:111], v[76:79], v[24:27]
    v_mfma_f32_16x16x32_bf16 v[28:31], a[112:115], v[64:67], 0
    v_mfma_f32_16x16x32_bf16 v[28:31], a[116:119], v[68:71], v[28:31]
    v_mfma_f32_16x16x32_bf16 v[28:31], a[120:123], v[72:75], v[28:31]
    v_mfma_f32_16x16x32_bf16 v[28:31], a[124:127], v[76:79], v[28:31]
    s_nop 7
    v_max3_f32 v32, v32, v16, v17
    v_max3_f32 v32, v32, v18, v19
    v_max3_f32 v32, v32, v20, v21
    v_max3_f32 v32, v32, v22, v23
    v_max3_f32 v32, v32, v24, v25
    v_max3_f32 v32, v32, v26, v27
    v_max3_f32 v32, v32, v28, v29
    v_max3_f32 v32, v32, v30, v31
    v_mfma_f32_16x16x32_bf16 v[16:19], a[64:67], v[80:83], 0
    v_mfma_f32_16x16x32_bf16 v[16:19], a[68:71], v[84:87], v[16:19]
    v_mfma_f32_16x16x32_bf16 v[16:19], a[72:75], v[88:91], v[16:19]
    v_mfma_f32_16x16x32_bf16 v[16:19], a[76:79], v[92:95], v[16:19]
    v_mfma_f32_16x16x32_bf16 v[20:23], a[80:83], v[80:83], 0
    v_mfma_f32_16x16x32_bf16 v[20:23], a[84:87], v[84:87], v[20:23]
    v_mfma_f32_16x16x32_bf16 v[20:23], a[88:91], v[88:91], v[20:23]
    v_mfma_f32_16x16x32_bf16 v[20:23], a[92:95], v[92:95], v[20:23]
    v_mfma_f32_16x16x32_bf16 v[24:27], a[96:99], v[80:83], 0
    v_mfma_f32_16x16x32_bf16 v[24:27], a[100:103], v[84:87], v[24:27]
    v_mfma_f32_16x16x32_bf16 v[24:27], a[104:107], v[88:91], v[24:27]
    v_mfma_f32_16x16x32_bf16 v[24:27], a[108:111], v[92:95], v[24:27]
    v_mfma_f32_16x16x32_bf16 v[28:31], a[112:115], v[80:83], 0
    v_mfma_f32_16x16x32_bf16 v[28:31], a[116:119], v[84:87], v[28:31]
    v_mfma_f32_16x16x32_bf16 v[28:31], a[120:123], v[88:91], v[28:31]
    v_mfma_f32_16x16x32_bf16 v[28:31], a[124:127], v[92:95], v[28:31]
    s_nop 7
    v_max3_f32 v33, v33, v16, v17
    v_max3_f32 v33, v33, v18, v19
    v_max3_f32 v33, v33, v20, v21
    v_max3_f32 v33, v33, v22, v23
    v_max3_f32 v33, v33, v24, v25
    v_max3_f32 v33, v33, v26, v27
    v_max3_f32 v33, v33, v28, v29
    v_max3_f32 v33, v33, v30, v31
    v_mfma_f32_16x16x32_bf16 v[16:19], a[64:67], v[96:99], 0
    v_mfma_f32_16x16x32_bf16 v[16:19], a[68:71], v[100:103], v[16:19]
    v_mfma_f32_16x16x32_bf16 v[16:19], a[72:75], v[104:107], v[16:19]
    v_mfma_f32_16x16x32_bf16 v[16:19], a[76:79], v[108:111], v[16:19]
    v_mfma_f32_16x16x32_bf16 v[20:23], a[80:83], v[96:99], 0
    v_mfma_f32_16x16x32_bf16 v[20:23], a[84:87], v[100:103], v[20:23]
    v_mfma_f32_16x16x32_bf16 v[20:23], a[88:91], v[104:107], v[20:23]
    v_mfma_f32_16x16x32_bf16 v[20:23], a[92:95], v[108:111], v[20:23]
    v_mfma_f32_16x16x32_bf16 v[24:27], a[96:99], v[96:99], 0
    v_mfma_f32_16x16x32_bf16 v[24:27], a[100:103], v[100:103], v[24:27]
    v_mfma_f32_16x16x32_bf16 v[24:27], a[104:107], v[104:107], v[24:27]
    v_mfma_f32_16x16x32_bf16 v[24:27], a[108:111], v[108:111], v[24:27]
    v_mfma_f32_16x16x32_bf16 v[28:31], a[112:115], v[96:99], 0
    v_mfma_f32_16x16x32_bf16 v[28:31], a[116:119], v[100:103], v[28:31]
    v_mfma_f32_16x16x32_bf16 v[28:31], a[120:123], v[104:107], v[28:31]
    v_mfma_f32_16x16x32_bf16 v[28:31], a[124:127], v[108:111], v[28:31]
    s_nop 7
    v_max3_f32 v34, v34, v16, v17
    v_max3_f32 v34, v34, v18, v19
    v_max3_f32 v34, v34, v20, v21
    v_max3_f32 v34, v34, v22, v23
    v_max3_f32 v34, v34, v24, v25
    v_max3_f32 v34, v34, v26, v27
    v_max3_f32 v34, v34, v28, v29
    v_max3_f32 v34, v34, v30, v31
    v_mfma_f32_16x16x32_bf16 v[16:19], a[64:67], v[112:115], 0
    v_mfma_f32_16x16x32_bf16 v[16:19], a[68:71], v[116:119], v[16:19]
    v_mfma_f32_16x16x32_bf16 v[16:19], a[72:75], v[120:123], v[16:19]
    v_mfma_f32_16x16x32_bf16 v[16:19], a[76:79], v[124:127], v[16:19]
    v_mfma_f32_16x16x32_bf16 v[20:23], a[80:83], v[112:115], 0
    v_mfma_f32_16x16x32_bf16 v[20:23], a[84:87], v[116:119], v[20:23]
    v_mfma_f32_16x16x32_bf16 v[20:23], a[88:91], v[120:123], v[20:23]
    v_mfma_f32_16x16x32_bf16 v[20:23], a[92:95], v[124:127], v[20:23]
    v_mfma_f32_16x16x32_bf16 v[24:27], a[96:99], v[112:115], 0
    v_mfma_f32_16x16x32_bf16 v[24:27], a[100:103], v[116:119], v[24:27]
    v_mfma_f32_16x16x32_bf16 v[24:27], a[104:107], v[120:123], v[24:27]
    v_mfma_f32_16x16x32_bf16 v[24:27], a[108:111], v[124:127], v[24:27]
    v_mfma_f32_16x16x32_bf16 v[28:31], a[112:115], v[112:115], 0
    v_mfma_f32_16x16x32_bf16 v[28:31], a[116:119], v[116:119], v[28:31]
    v_mfma_f32_16x16x32_bf16 v[28:31], a[120:123], v[120:123], v[28:31]
    v_mfma_f32_16x16x32_bf16 v[28:31], a[124:127], v[124:127], v[28:31]
    s_nop 7
    v_max3_f32 v35, v35, v16, v17
    v_max3_f32 v35, v35, v18, v19
    v_max3_f32 v35, v35, v20, v21
    v_max3_f32 v35, v35, v22, v23
    v_max3_f32 v35, v35, v24, v25
    v_max3_f32 v35, v35, v26, v27
    v_max3_f32 v35, v35, v28, v29
    v_max3_f32 v35, v35, v30, v31
    s_add_u32 s46, s46, 16384
    s_cmp_lt_u32 s46, 524288
    s_cbranch_scc1 L2_fb_loop
    v_mov_b32 v12, v32
    v_mov_b32 v13, v33
    v_mov_b32 v14, v34
    v_mov_b32 v15, v35
    v_permlane16_swap_b32 v12, v32
    v_permlane16_swap_b32 v13, v33
    v_permlane16_swap_b32 v14, v34
    v_permlane16_swap_b32 v15, v35
    v_max_f32 v32, v32, v12
    v_max_f32 v33, v33, v13
    v_max_f32 v34, v34, v14
    v_max_f32 v35, v35, v15
    v_mov_b32 v12, v32
    v_mov_b32 v13, v33
    v_mov_b32 v14, v34
    v_mov_b32 v15, v35
    v_permlane32_swap_b32 v12, v32
    v_permlane32_swap_b32 v13, v33
    v_permlane32_swap_b32 v14, v34
    v_permlane32_swap_b32 v15, v35
    v_max_f32 v32, v32, v12
    v_max_f32 v33, v33, v13
    v_max_f32 v34, v34, v14
    v_max_f32 v35, v35, v15
    v_sub_f32 v48, 0x80000000, v32
    v_sub_f32 v49, 0x80000000, v32
    v_sub_f32 v50, 0x80000000, v32
    v_sub_f32 v51, 0x80000000, v32
    v_sub_f32 v52, 0x80000000, v33
    v_sub_f32 v53, 0x80000000, v33
    v_sub_f32 v54, 0x80000000, v33
    v_sub_f32 v55, 0x80000000, v33
    v_sub_f32 v56, 0x80000000, v34
    v_sub_f32 v57, 0x80000000, v34
    v_sub_f32 v58, 0x80000000, v34
    v_sub_f32 v59, 0x80000000, v34
    v_sub_f32 v60, 0x80000000, v35
    v_sub_f32 v61, 0x80000000, v35
    v_sub_f32 v62, 0x80000000, v35
    v_sub_f32 v63, 0x80000000, v35
    s_add_u32 m0, s44, 73728
    s_mov_b32 s46, 0
    buffer_load_dwordx4 v5, s[16:19], s46 offen offset:0 lds
    s_add_u32 m0, s44, 73760
    s_nop 0
    buffer_load_dwordx4 v5, s[16:19], s46 offen offset:1024 lds
    s_add_u32 m0, s44, 73792
    s_nop 0
    buffer_load_dwordx4 v5, s[16:19], s46 offen offset:2048 lds
    s_add_u32 m0, s44, 73824
    s_nop 0
    buffer_load_dwordx4 v5, s[16:19], s46 offen offset:3072 lds
    s_add_u32 m0, s44, 90624
    s_nop 0
    buffer_load_dwordx4 v5, s[20:23], s46 offen offset:0 lds
    s_add_u32 m0, s44, 90656
    s_nop 0
    buffer_load_dwordx4 v5, s[20:23], s46 offen offset:1024 lds
    s_add_u32 m0, s44, 90688
    s_nop 0
    buffer_load_dwordx4 v5, s[20:23], s46 offen offset:2048 lds
    s_add_u32 m0, s44, 90720
    s_nop 0
    buffer_load_dwordx4 v5, s[20:23], s46 offen offset:3072 lds
    s_add_u32 m0, s44, 110592
    s_mov_b32 s46, 16384
    buffer_load_dwordx4 v5, s[16:19], s46 offen offset:0 lds
    s_add_u32 m0, s44, 110624
    s_nop 0
    buffer_load_dwordx4 v5, s[16:19], s46 offen offset:1024 lds
    s_add_u32 m0, s44, 110656
    s_nop 0
    buffer_load_dwordx4 v5, s[16:19], s46 offen offset:2048 lds
    s_add_u32 m0, s44, 110688
    s_nop 0
    buffer_load_dwordx4 v5, s[16:19], s46 offen offset:3072 lds
    s_add_u32 m0, s44, 127488
    s_nop 0
    buffer_load_dwordx4 v5, s[20:23], s46 offen offset:0 lds
    s_add_u32 m0, s44, 127520
    s_nop 0
    buffer_load_dwordx4 v5, s[20:23], s46 offen offset:1024 lds
    s_add_u32 m0, s44, 127552
    s_nop 0
    buffer_load_dwordx4 v5, s[20:23], s46 offen offset:2048 lds
    s_add_u32 m0, s44, 127584
    s_nop 0
    buffer_load_dwordx4 v5, s[20:23], s46 offen offset:3072 lds
    s_add_u32 m0, s44, 0
    s_mov_b32 s46, 32768
    buffer_load_dwordx4 v5, s[16:19], s46 offen offset:0 lds
    s_add_u32 m0, s44, 32
    s_nop 0
    buffer_load_dwordx4 v5, s[16:19], s46 offen offset:1024 lds
    s_add_u32 m0, s44, 64
    s_nop 0
    buffer_load_dwordx4 v5, s[16:19], s46 offen offset:2048 lds
    s_add_u32 m0, s44, 96
    s_nop 0
    buffer_load_dwordx4 v5, s[16:19], s46 offen offset:3072 lds
    s_add_u32 m0, s44, 16896
    s_nop 0
    buffer_load_dwordx4 v5, s[20:23], s46 offen offset:0 lds
    s_add_u32 m0, s44, 16928
    s_nop 0
    buffer_load_dwordx4 v5, s[20:23], s46 offen offset:1024 lds
    s_add_u32 m0, s44, 16960
    s_nop 0
    buffer_load_dwordx4 v5, s[20:23], s46 offen offset:2048 lds
    s_add_u32 m0, s44, 16992
    s_nop 0
    buffer_load_dwordx4 v5, s[20:23], s46 offen offset:3072 lds
    s_waitcnt vmcnt(0) lgkmcnt(0)
    s_barrier
    ds_read_b128 a[64:67], v1 offset:0
    ds_read_b128 a[68:71], v1 offset:64
    ds_read_b128 a[72:75], v1 offset:128
    ds_read_b128 a[76:79], v1 offset:192
    ds_read_b128 a[80:83], v1 offset:256
    ds_read_b128 a[84:87], v1 offset:320
    ds_read_b128 a[88:91], v1 offset:384
    ds_read_b128 a[92:95], v1 offset:448
    ds_read_b128 a[96:99], v1 offset:512
    ds_read_b128 a[100:103], v1 offset:576
    ds_read_b128 a[104:107], v1 offset:640
    ds_read_b128 a[108:111], v1 offset:704
    ds_read_b128 a[112:115], v1 offset:768
    ds_read_b128 a[116:119], v1 offset:832
    ds_read_b128 a[120:123], v1 offset:896
    ds_read_b128 a[124:127], v1 offset:960
    ds_read_b64_tr_b16 a[128:129], v2 offset:0
    ds_read_b64_tr_b16 a[130:131], v2 offset:256
    ds_read_b64_tr_b16 a[132:133], v2 offset:512
    ds_read_b64_tr_b16 a[134:135], v2 offset:768
    ds_read_b64_tr_b16 a[136:137], v2 offset:32
    ds_read_b64_tr_b16 a[138:139], v2 offset:288
    ds_read_b64_tr_b16 a[140:141], v2 offset:544
    ds_read_b64_tr_b16 a[142:143], v2 offset:800
    ds_read_b64_tr_b16 a[144:145], v2 offset:64
    ds_read_b64_tr_b16 a[146:147], v2 offset:320
    ds_read_b64_tr_b16 a[148:149], v2 offset:576
    ds_read_b64_tr_b16 a[150:151], v2 offset:832
    ds_read_b64_tr_b16 a[152:153], v2 offset:96
    ds_read_b64_tr_b16 a[154:155], v2 offset:352
    ds_read_b64_tr_b16 a[156:157], v2 offset:608
    ds_read_b64_tr_b16 a[158:159], v2 offset:864
    ds_read_b64_tr_b16 a[160:161], v2 offset:128
    ds_read_b64_tr_b16 a[162:163], v2 offset:384
    ds_read_b64_tr_b16 a[164:165], v2 offset:640
    ds_read_b64_tr_b16 a[166:167], v2 offset:896
    ds_read_b64_tr_b16 a[168:169], v2 offset:160
    ds_read_b64_tr_b16 a[170:171], v2 offset:416
    ds_read_b64_tr_b16 a[172:173], v2 offset:672
    ds_read_b64_tr_b16 a[174:175], v2 offset:928
    ds_read_b64_tr_b16 a[176:177], v2 offset:192
    ds_read_b64_tr_b16 a[178:179], v2 offset:448
    ds_read_b64_tr_b16 a[180:181], v2 offset:704
    ds_read_b64_tr_b16 a[182:183], v2 offset:960
    ds_read_b64_tr_b16 a[184:185], v2 offset:224
    ds_read_b64_tr_b16 a[186:187], v2 offset:480
    ds_read_b64_tr_b16 a[188:189], v2 offset:736
    ds_read_b64_tr_b16 a[190:191], v2 offset:992
    s_waitcnt vmcnt(0) lgkmcnt(0)
    s_branch L2_entry
L2_codeend:

.section .rodata,"a"
.p2align 6
.amdhsa_kernel front_kernel
  .amdhsa_next_free_vgpr 64
  .amdhsa_next_free_sgpr 102
  .amdhsa_accum_offset 64
  .amdhsa_group_segment_fixed_size 0
  .amdhsa_kernarg_size 120
  .amdhsa_user_sgpr_count 2
  .amdhsa_user_sgpr_kernarg_segment_ptr 1
  .amdhsa_system_sgpr_workgroup_id_x 1
  .amdhsa_float_denorm_mode_32 3
.end_amdhsa_kernel
.p2align 6
.amdhsa_kernel main_kernel
  .amdhsa_next_free_vgpr 512
  .amdhsa_next_free_sgpr 102
  .amdhsa_accum_offset 256
  .amdhsa_group_segment_fixed_size 0
  .amdhsa_kernarg_size 120
  .amdhsa_user_sgpr_count 2
  .amdhsa_user_sgpr_kernarg_segment_ptr 1
  .amdhsa_system_sgpr_workgroup_id_x 1
  .amdhsa_float_denorm_mode_32 3
.end_amdhsa_kernel
```

```asm
; @launch grid=(256,1,1) block=(256,1,1) lds=163840
.amdgcn_target "amdgcn-amd-amdhsa--gfx950"
.text
.globl adaLN_cond__gqa_block_cached__moe_arch_mod__prompt_kernel
.p2align 8
.type adaLN_cond__gqa_block_cached__moe_arch_mod__prompt_kernel,@function
adaLN_cond__gqa_block_cached__moe_arch_mod__prompt_kernel:
L2_begin:
    s_getpc_b64 s[98:99]
    s_cmp_ge_u32 s2, 256
    s_cbranch_scc1 L2_end
    s_load_dwordx2 s[76:77], s[0:1], 0
    s_load_dwordx2 s[16:17], s[0:1], 80
    s_load_dwordx2 s[88:89], s[0:1], 88
    s_load_dwordx2 s[12:13], s[0:1], 112
    s_load_dwordx2 s[60:61], s[0:1], 104
    s_and_b32 s3, s2, 7
    s_lshr_b32 s14, s2, 3
    v_mov_b32 v155, v0
    v_lshrrev_b32 v10, 6, v0
    v_and_b32 v0, 63, v0
    s_lshl_b32 s15, s14, 9
    v_lshl_add_u32 v13, v10, 7, s15
    v_lshl_add_u32 v13, v0, 14, v13
    v_min_u32 v13, L2_codeend-L2_begin-8, v13
    s_mov_b64 exec, 15
    global_load_dword a63, v13, s[98:99]
    s_mov_b64 exec, -1
    v_readfirstlane_b32 s51, v10
    s_and_b32 s52, s3, 3
    s_and_b32 s15, s14, 3
    s_lshl2_add_u32 s52, s52, s15
    s_lshr_b32 s53, s3, 2
    s_lshr_b32 s15, s14, 2
    s_lshl3_add_u32 s53, s53, s15
    s_lshl4_add_u32 s96, s53, s52
    s_mul_i32 s49, s3, 27
    s_max_u32 s14, s14, 5
    s_add_u32 s49, s49, s14
    s_sub_u32 s49, s49, 5
    s_lshr_b32 s55, s3, 2
    s_mul_i32 s15, s55, 108
    s_sub_u32 s50, s49, s15
    s_mul_i32 s3, s51, 288
    v_lshrrev_b32 v15, 3, v0
    v_lshl_add_u32 v12, v15, 4, s3
    v_and_b32 v15, 1, v15
    v_lshl_add_u32 v13, v15, 4, s3
    v_and_b32 v14, 7, v0
    v_mul_u32_u24 v14, 1152, v14
    v_add_u32 v1, v14, v12
    v_add_u32 v2, v14, v13
    v_add_u32 v2, 256, v2
    v_and_b32 v4, 0xfc, v155
    v_and_b32 v7, 3, v0
    v_mul_u32_u24 v3, 6912, v4
    v_lshl_add_u32 v153, v7, 4, v3
    s_mul_i32 s3, s96, 9216
    s_movk_i32 s78, 9216
    s_mov_b32 s79, 0x20000
    s_mov_b32 s91, s79
    v_lshlrev_b32 v8, 4, v0
    s_mov_b32 s86, 6553600
    s_mov_b32 s87, s79
    s_movk_i32 s62, 256
    s_mov_b32 s63, s79
    s_lshl_b32 s14, s50, 6
    s_sub_u32 s90, 1990656, s14
    s_cmp_ge_u32 s2, 40
    s_cselect_b32 s90, s90, 0
    s_mul_i32 s15, s55, 1990656
    s_add_u32 s14, s14, s15
    s_waitcnt lgkmcnt(0)
    s_add_u32 s76, s76, s3
    s_addc_u32 s77, s77, 0
    buffer_load_dwordx4 v[64:67], v1, s[76:79], 0 offen offset:0
    buffer_load_dwordx4 v[68:71], v1, s[76:79], 0 offen offset:128
    buffer_load_dwordx4 v[72:75], v2, s[76:79], 0 offen offset:0
    s_add_u32 s88, s88, s14
    s_addc_u32 s89, s89, 0
    s_mov_b64 s[84:85], s[12:13]
    s_cmp_ge_u32 s2, 8
    s_cbranch_scc1 L2_noclr
    s_cmp_lt_u32 s2, 4
    s_cselect_b32 s3, -1, 0
    v_mov_b32 v52, s3
    v_mov_b32 v53, s3
    v_mov_b32 v54, s3
    v_mov_b32 v55, s3
    s_lshl2_add_u32 s3, s2, s51
    s_mul_i32 s3, s3, 2048
    buffer_store_dwordx4 v[52:55], v8, s[84:87], s3 offen offset:0 sc1
    buffer_store_dwordx4 v[52:55], v8, s[84:87], s3 offen offset:1024 sc1
L2_noclr:
    buffer_load_dwordx4 v[128:131], v153, s[88:91], 0 offen
    s_movk_i32 s3, 6912
    buffer_load_dwordx4 v[132:135], v153, s[88:91], s3 offen
    s_movk_i32 s3, 13824
    buffer_load_dwordx4 v[136:139], v153, s[88:91], s3 offen
    s_movk_i32 s3, 20736
    buffer_load_dwordx4 v[140:143], v153, s[88:91], s3 offen
    v_lshrrev_b32 v3, 2, v3
    v_lshl_add_u32 v3, v7, 4, v3
    v_add_u32 v154, 1769472, v3
    v_lshrrev_b32 v3, 1, v4
    v_lshlrev_b32 v4, 1, v4
    s_mul_i32 s3, s55, 576
    s_add_u32 s16, s16, s3
    s_addc_u32 s17, s17, 0
    s_mov_b32 s18, 576
    s_mov_b32 s19, 0x20000
    buffer_load_dwordx2 v[148:149], v4, s[16:19], 0 offen
    v_mov_b32 v144, 0
    v_mov_b32 v145, 0
    v_mov_b32 v146, 0
    v_mov_b32 v147, 0
    v_mov_b32 v150, 0
    s_cmp_ge_u32 s51, 2
    s_cbranch_scc1 L2_w23
    buffer_load_dwordx4 v[144:147], v154, s[88:91], 0 offen
    buffer_load_ushort v150, v3, s[16:19], 0 offen offset:512
L2_w23:
    s_load_dwordx8 s[4:11], s[0:1], 8
    s_load_dwordx2 s[64:65], s[0:1], 56
    s_load_dwordx2 s[68:69], s[0:1], 64
    s_load_dwordx2 s[72:73], s[0:1], 72
    s_load_dwordx2 s[80:81], s[0:1], 96
    s_load_dwordx2 s[36:37], s[0:1], 48
    s_cmp_eq_u32 s51, 0
    s_cselect_b32 s3, 0, 0x40000000
    v_mul_u32_u24 v156, 32, v0
    v_or_b32 v156, s3, v156
    s_mul_i32 s44, s51, 4224
    s_add_u32 s44, s44, 16384
    v_lshl_add_u32 v5, v10, 12, v8
    v_lshrrev_b32 v13, 5, v0
    v_lshl_add_u32 v13, v10, 1, v13
    v_lshlrev_b32 v13, 15, v13
    v_and_b32 v14, 31, v0
    v_lshl_add_u32 v6, v14, 4, v13
    v_mov_b32 v56, 0
    v_mov_b32 v60, -1
    v_mov_b32 v57, 0
    v_mov_b32 v61, -1
    v_mov_b32 v58, 0
    v_mov_b32 v62, -1
    v_mov_b32 v59, 0
    v_mov_b32 v63, -1
    s_and_b32 s14, s53, 7
    s_lshl2_add_u32 s14, s14, s51
    v_lshrrev_b32 v13, 2, v0
    v_lshl_add_u32 v13, v13, 5, s14
    v_lshlrev_b32 v13, 13, v13
    v_lshl_add_u32 v13, v7, 7, v13
    s_waitcnt lgkmcnt(0)
    s_lshl_b32 s3, s52, 9
    s_add_u32 s24, s8, s3
    s_addc_u32 s25, s9, 0
    s_mov_b32 s26, 0
    s_mov_b32 s27, 0x20000
    s_sub_u32 s26, 4718592, s3
    s_mov_b64 exec, 0xffff
    buffer_load_dword a63, v13, s[24:27], 0 offen
    s_mov_b64 exec, -1
    s_mov_b32 s38, 1152
    s_mov_b32 s39, 0x20000
    v_and_b32 v14, 7, v0
    v_lshlrev_b32 v157, 4, v14
    v_add_u32 v157, 14080, v157
    v_lshl_add_u32 v158, v10, 2, v157
    s_mul_i32 s3, s51, 4608
    v_lshl_add_u32 v14, v14, 4, s3
    v_lshrrev_b32 v15, 3, v0
    v_lshl_add_u32 v159, v15, 8, v14
    s_lshr_b32 s3, s96, 1
    s_mul_i32 s3, s3, 18432
    s_and_b32 s14, s96, 1
    s_lshl_b32 s14, s14, 7
    s_add_u32 s3, s3, s14
    s_add_u32 s58, s3, 1048576
    s_lshl_b32 s3, s53, 2
    s_add_u32 s3, s3, s51
    s_lshl_b32 s14, s3, 4
    s_add_u32 s14, s14, s52
    s_lshl_b32 s14, s14, 7
    s_add_u32 s56, s14, 786432
    s_lshl_b32 s14, s3, 9
    s_add_u32 s59, s14, 32768
    v_and_b32 v14, 3, v0
    v_lshlrev_b32 v163, 7, v14
    s_mul_i32 s14, s3, 36864
    s_add_u32 s14, s14, 1048576
    s_add_u32 s32, s12, s14
    s_addc_u32 s33, s13, 0
    s_mov_b32 s34, 36864
    s_mov_b32 s35, 0x20000
    s_mul_i32 s15, s2, 4608
    s_mul_i32 s14, s51, 1152
    s_add_u32 s15, s15, s14
    s_add_u32 s57, s15, 98304
    s_cmp_ge_u32 s2, 144
    s_cselect_b32 s14, 0x40000000, 0
    v_or_b32 v160, s14, v8
    v_lshrrev_b32 v12, 4, v155
    v_lshlrev_b32 v12, 7, v12
    v_lshl_add_u32 v161, v7, 5, v12
    v_lshlrev_b32 v162, 2, v0
    s_mul_i32 s3, s50, 3641
    s_lshr_b32 s3, s3, 16
    s_mov_b32 s47, 1.0
    s_mov_b32 s48, 0
    s_cmp_lt_u32 s3, 2
    s_cselect_b32 s47, 0x3e0293ee, s47
    s_cmp_eq_u32 s3, 1
    s_cselect_b32 s48, 0x3e0293ee, s48
    s_cmp_eq_u32 s3, 4
    s_cselect_b32 s48, 1.0, s48
    s_cmp_eq_u32 s55, 0
    s_cselect_b32 s48, s48, 0
    s_lshl_b32 s100, s49, 7
    s_lshl_b32 s14, s96, 7
    s_add_u32 s101, s14, 32768
    s_mul_i32 s3, s51, 1152
    v_add_u32 v166, s3, v8
    s_and_b32 s3, s51, 1
    s_mul_i32 s3, s3, 2304
    s_cmp_lt_u32 s51, 2
    s_cselect_b32 s14, 32, 0
    s_add_u32 s3, s3, s14
    s_add_u32 s3, s3, 9216
    v_lshrrev_b32 v14, 1, v0
    v_lshl_add_u32 v14, v14, 6, s3
    v_and_b32 v15, 1, v0
    v_lshl_add_u32 v167, v15, 4, v14
    s_cmp_eq_u32 s51, 1
    s_cselect_b32 s3, 40, 256
    s_cmp_ge_u32 s2, s3
    s_cselect_b32 s3, 0, 0x40000000
    v_or_b32 v164, s3, v162
    v_mov_b32 v172, 0
    v_mov_b32 v180, 0
    v_mov_b32 v173, 0
    v_mov_b32 v181, 0
    v_mov_b32 v174, 0
    v_mov_b32 v182, 0
    v_mov_b32 v175, 0
    v_mov_b32 v183, 0
    s_lshl_b32 s3, s53, 2
    s_add_u32 s3, s3, s51
    v_mov_b32 v12, v10
    s_mul_i32 s14, s3, 589824
    s_mul_i32 s15, s52, 9216
    s_add_u32 s14, s14, s15
    s_add_u32 s14, s14, 8388608
    s_add_u32 s40, s12, s14
    s_addc_u32 s41, s13, 0
    s_mov_b32 s42, 0
    s_mov_b32 s43, 0x20000
    s_sub_u32 s42, 589824, s15
    s_lshl_b32 s3, s52, 19
    s_add_u32 s16, s4, s3
    s_addc_u32 s17, s5, 0
    s_mov_b32 s18, 524288
    s_mov_b32 s19, 0x20000
    s_add_u32 s20, s6, s3
    s_addc_u32 s21, s7, 0
    s_mov_b32 s22, 524288
    s_mov_b32 s23, 0x20000
    s_mul_i32 s3, s52, 294912
    s_add_u32 s28, s10, s3
    s_addc_u32 s29, s11, 0
    s_mov_b32 s30, 294912
    s_mov_b32 s31, 0x20000
    s_mov_b64 s[4:5], s[64:65]
    s_mov_b64 s[6:7], s[68:69]
    s_mov_b64 s[8:9], s[72:73]
    s_mov_b32 s50, 0
    s_mul_i32 s55, s51, 9216
    s_min_u32 s15, s2, 143
    s_and_b32 s3, s15, 7
    s_mul_i32 s3, s3, 18
    s_lshr_b32 s15, s15, 3
    s_add_u32 s15, s15, s3
    s_lshl_b32 s3, s15, 6
    s_add_u32 s64, s64, s3
    s_addc_u32 s65, s65, 0
    s_mov_b32 s66, 0
    s_mov_b32 s67, 0x20000
    s_add_u32 s68, s68, s3
    s_addc_u32 s69, s69, 0
    s_mov_b32 s70, 0
    s_mov_b32 s71, 0x20000
    s_sub_u32 s14, 5308416, s3
    s_mul_i32 s3, s15, 36864
    s_add_u32 s72, s72, s3
    s_addc_u32 s73, s73, 0
    s_mov_b32 s74, 0
    s_mov_b32 s75, 0x20000
    s_cmp_lt_u32 s2, 144
    s_cselect_b32 s66, s14, 0
    s_cselect_b32 s70, s14, 0
    s_cselect_b32 s74, 36864, 0
    s_mov_b32 s82, 2359296
    s_mov_b32 s83, 0x20000
    v_lshrrev_b32 v13, 4, v0
    v_lshlrev_b32 v9, 6, v13
    v_lshrrev_b32 v14, 2, v0
    v_mul_u32_u24 v14, 1056, v14
    v_add_u32 v14, 16384, v14
    v_and_b32 v15, 1, v0
    v_lshlrev_b32 v15, 4, v15
    v_add_u32 v3, v14, v15
    v_and_b32 v15, 2, v0
    v_lshl_add_u32 v3, v15, 2, v3
    v_add_u32 v4, 73728, v3
    v_lshrrev_b32 v14, 3, v0
    v_lshlrev_b32 v14, 2, v14
    v_add_u32 v14, v14, v12
    v_mul_u32_u24 v14, 4608, v14
    v_and_b32 v15, 7, v0
    v_lshl_add_u32 v7, v15, 4, v14
    v_lshlrev_b32 v10, 4, v15
    v_lshl_add_u32 v10, v13, 7, v10
    v_bfe_u32 v14, v0, 3, 1
    v_mul_u32_u24 v14, 147456, v14
    v_add_u32 v10, v10, v14
    v_lshrrev_b32 v14, 2, v0
    v_mul_u32_u24 v14, 1056, v14
    v_and_b32 v15, 3, v0
    v_lshl_add_u32 v14, v15, 3, v14
    v_add_u32 v2, 107008, v14
    v_and_b32 v14, 15, v0
    v_mul_u32_u24 v14, 1056, v14
    v_lshrrev_b32 v15, 4, v0
    v_lshl_add_u32 v14, v15, 4, v14
    v_add_u32 v1, 90112, v14
    v_and_b32 v14, 1, v0
    v_cmp_eq_u32 vcc, 0, v14
    v_mov_b32 v11, 0xeeeeeeee
    v_mov_b32 v15, 0x44444444
    v_cndmask_b32 v11, v11, v15, vcc
    v_and_b32 v14, 2, v0
    v_cmp_eq_u32 vcc, 0, v14
    v_mov_b32 v15, 0x3f803f80
    s_nop 0
    v_cndmask_b32 v15, 0, v15, vcc
    v_accvgpr_write_b32 a16, v15
    v_accvgpr_write_b32 a17, v15
    v_accvgpr_write_b32 a18, v15
    v_accvgpr_write_b32 a19, v15
    s_cmp_ge_u32 s2, 8
    s_cbranch_scc1 L2_noclr2
    s_mul_i32 s14, s2, 32
    s_mov_b64 exec, 1
    s_waitcnt vmcnt(6)
    s_barrier
    buffer_store_dword v60, v156, s[60:63], s14 offen sc1
    s_mov_b64 exec, -1
L2_noclr2:
    s_waitcnt vmcnt(6)
    v_lshlrev_b32 v24, 16, v64
    v_and_b32 v25, 0xffff0000, v64
    v_lshlrev_b32 v26, 16, v65
    v_and_b32 v27, 0xffff0000, v65
    v_lshlrev_b32 v28, 16, v66
    v_and_b32 v29, 0xffff0000, v66
    v_lshlrev_b32 v30, 16, v67
    v_and_b32 v31, 0xffff0000, v67
    v_lshlrev_b32 v32, 16, v68
    v_and_b32 v33, 0xffff0000, v68
    v_lshlrev_b32 v34, 16, v69
    v_and_b32 v35, 0xffff0000, v69
    v_lshlrev_b32 v36, 16, v70
    v_and_b32 v37, 0xffff0000, v70
    v_lshlrev_b32 v38, 16, v71
    v_and_b32 v39, 0xffff0000, v71
    v_lshlrev_b32 v40, 16, v72
    v_and_b32 v41, 0xffff0000, v72
    v_lshlrev_b32 v42, 16, v73
    v_and_b32 v43, 0xffff0000, v73
    v_lshlrev_b32 v44, 16, v74
    v_and_b32 v45, 0xffff0000, v74
    v_lshlrev_b32 v46, 16, v75
    v_and_b32 v47, 0xffff0000, v75
    v_add_f32 v48, v24, v25
    v_add_f32 v48, v48, v26
    v_add_f32 v48, v48, v27
    v_add_f32 v48, v48, v28
    v_add_f32 v48, v48, v29
    v_add_f32 v48, v48, v30
    v_add_f32 v48, v48, v31
    v_add_f32 v48, v48, v32
    v_add_f32 v48, v48, v33
    v_add_f32 v48, v48, v34
    v_add_f32 v48, v48, v35
    v_add_f32 v48, v48, v36
    v_add_f32 v48, v48, v37
    v_add_f32 v48, v48, v38
    v_add_f32 v48, v48, v39
    v_add_f32 v50, v40, v41
    v_add_f32 v50, v50, v42
    v_add_f32 v50, v50, v43
    v_add_f32 v50, v50, v44
    v_add_f32 v50, v50, v45
    v_add_f32 v50, v50, v46
    v_add_f32 v50, v50, v47
    v_fmac_f32 v48, 0x3e800000, v50
    s_nop 1
    v_add_f32_dpp v48, v48, v48 row_ror:8 row_mask:0xf bank_mask:0xf
    v_mov_b32 v50, v48
    s_nop 1
    v_permlane16_swap_b32 v50, v48
    v_add_f32 v48, v48, v50
    v_mov_b32 v50, v48
    s_nop 1
    v_permlane32_swap_b32 v50, v48
    v_add_f32 v48, v48, v50
    v_mul_f32 v48, 0x3be38e39, v48
    v_pk_add_f32 v[24:25], v[24:25], v[48:49] op_sel_hi:[1,0] neg_lo:[0,1] neg_hi:[0,1]
    v_pk_add_f32 v[26:27], v[26:27], v[48:49] op_sel_hi:[1,0] neg_lo:[0,1] neg_hi:[0,1]
    v_pk_add_f32 v[28:29], v[28:29], v[48:49] op_sel_hi:[1,0] neg_lo:[0,1] neg_hi:[0,1]
    v_pk_add_f32 v[30:31], v[30:31], v[48:49] op_sel_hi:[1,0] neg_lo:[0,1] neg_hi:[0,1]
    v_pk_add_f32 v[32:33], v[32:33], v[48:49] op_sel_hi:[1,0] neg_lo:[0,1] neg_hi:[0,1]
    v_pk_add_f32 v[34:35], v[34:35], v[48:49] op_sel_hi:[1,0] neg_lo:[0,1] neg_hi:[0,1]
    v_pk_add_f32 v[36:37], v[36:37], v[48:49] op_sel_hi:[1,0] neg_lo:[0,1] neg_hi:[0,1]
    v_pk_add_f32 v[38:39], v[38:39], v[48:49] op_sel_hi:[1,0] neg_lo:[0,1] neg_hi:[0,1]
    v_pk_add_f32 v[40:41], v[40:41], v[48:49] op_sel_hi:[1,0] neg_lo:[0,1] neg_hi:[0,1]
    v_pk_add_f32 v[42:43], v[42:43], v[48:49] op_sel_hi:[1,0] neg_lo:[0,1] neg_hi:[0,1]
    v_pk_add_f32 v[44:45], v[44:45], v[48:49] op_sel_hi:[1,0] neg_lo:[0,1] neg_hi:[0,1]
    v_pk_add_f32 v[46:47], v[46:47], v[48:49] op_sel_hi:[1,0] neg_lo:[0,1] neg_hi:[0,1]
    v_mul_f32 v49, v24, v24
    v_fmac_f32 v49, v25, v25
    v_fmac_f32 v49, v26, v26
    v_fmac_f32 v49, v27, v27
    v_fmac_f32 v49, v28, v28
    v_fmac_f32 v49, v29, v29
    v_fmac_f32 v49, v30, v30
    v_fmac_f32 v49, v31, v31
    v_fmac_f32 v49, v32, v32
    v_fmac_f32 v49, v33, v33
    v_fmac_f32 v49, v34, v34
    v_fmac_f32 v49, v35, v35
    v_fmac_f32 v49, v36, v36
    v_fmac_f32 v49, v37, v37
    v_fmac_f32 v49, v38, v38
    v_fmac_f32 v49, v39, v39
    v_mul_f32 v50, v40, v40
    v_fmac_f32 v50, v41, v41
    v_fmac_f32 v50, v42, v42
    v_fmac_f32 v50, v43, v43
    v_fmac_f32 v50, v44, v44
    v_fmac_f32 v50, v45, v45
    v_fmac_f32 v50, v46, v46
    v_fmac_f32 v50, v47, v47
    v_fmac_f32 v49, 0x3e800000, v50
    s_nop 1
    v_add_f32_dpp v49, v49, v49 row_ror:8 row_mask:0xf bank_mask:0xf
    v_mov_b32 v50, v49
    s_nop 1
    v_permlane16_swap_b32 v50, v49
    v_add_f32 v49, v49, v50
    v_mov_b32 v50, v49
    s_nop 1
    v_permlane32_swap_b32 v50, v49
    v_add_f32 v49, v49, v50
    ds_write_b32 v158, v48
    ds_write_b32 v158, v49 offset:128
    s_waitcnt lgkmcnt(0)
    s_barrier
    ds_read_b128 v[16:19], v157
    ds_read_b128 v[20:23], v157 offset:128
    s_add_u32 s14, s58, 4096
    s_waitcnt lgkmcnt(1)
    v_add_f32 v12, v16, v17
    v_add_f32 v13, v18, v19
    v_add_f32 v12, v12, v13
    v_mul_f32 v12, 0x3e800000, v12
    v_sub_f32 v16, v16, v12
    v_sub_f32 v17, v17, v12
    v_sub_f32 v18, v18, v12
    v_sub_f32 v19, v19, v12
    v_sub_f32 v48, v48, v12
    v_mul_f32 v13, v16, v16
    v_fmac_f32 v13, v17, v17
    v_fmac_f32 v13, v18, v18
    v_fmac_f32 v13, v19, v19
    s_waitcnt lgkmcnt(0)
    v_add_f32 v14, v20, v21
    v_add_f32 v15, v22, v23
    v_add_f32 v14, v14, v15
    v_fmac_f32 v14, 0x43100000, v13
    v_mov_b32 v12, 0x3727c5ac
    v_fmac_f32 v12, 0x3ae38e39, v14
    v_rsq_f32 v12, v12
    s_nop 0
    v_mul_f32 v48, v48, v12
    v_pk_fma_f32 v[24:25], v[24:25], v[12:13], v[48:49] op_sel_hi:[1,0,0]
    v_pk_fma_f32 v[26:27], v[26:27], v[12:13], v[48:49] op_sel_hi:[1,0,0]
    v_pk_fma_f32 v[28:29], v[28:29], v[12:13], v[48:49] op_sel_hi:[1,0,0]
    v_pk_fma_f32 v[30:31], v[30:31], v[12:13], v[48:49] op_sel_hi:[1,0,0]
    v_cvt_pk_f16_f32 v64, v24, v25
    v_cvt_pk_f16_f32 v65, v26, v27
    v_cvt_pk_f16_f32 v66, v28, v29
    v_cvt_pk_f16_f32 v67, v30, v31
    buffer_store_dwordx4 v[64:67], v159, s[84:87], s58 offen offset:0 sc1
    v_pk_fma_f32 v[32:33], v[32:33], v[12:13], v[48:49] op_sel_hi:[1,0,0]
    v_pk_fma_f32 v[34:35], v[34:35], v[12:13], v[48:49] op_sel_hi:[1,0,0]
    v_pk_fma_f32 v[36:37], v[36:37], v[12:13], v[48:49] op_sel_hi:[1,0,0]
    v_pk_fma_f32 v[38:39], v[38:39], v[12:13], v[48:49] op_sel_hi:[1,0,0]
    v_cvt_pk_f16_f32 v68, v32, v33
    v_cvt_pk_f16_f32 v69, v34, v35
    v_cvt_pk_f16_f32 v70, v36, v37
    v_cvt_pk_f16_f32 v71, v38, v39
    buffer_store_dwordx4 v[68:71], v159, s[84:87], s58 offen offset:2048 sc1
    v_pk_fma_f32 v[40:41], v[40:41], v[12:13], v[48:49] op_sel_hi:[1,0,0]
    v_pk_fma_f32 v[42:43], v[42:43], v[12:13], v[48:49] op_sel_hi:[1,0,0]
    v_pk_fma_f32 v[44:45], v[44:45], v[12:13], v[48:49] op_sel_hi:[1,0,0]
    v_pk_fma_f32 v[46:47], v[46:47], v[12:13], v[48:49] op_sel_hi:[1,0,0]
    v_cvt_pk_f16_f32 v72, v40, v41
    v_cvt_pk_f16_f32 v73, v42, v43
    v_cvt_pk_f16_f32 v74, v44, v45
    v_cvt_pk_f16_f32 v75, v46, v47
    s_mov_b64 exec, 0xffff
    buffer_store_dwordx4 v[72:75], v159, s[84:87], s14 offen offset:0 sc1
    s_mov_b64 exec, 0xff
    buffer_store_dwordx4 v[56:59], v8, s[84:87], s56 offen sc1
    buffer_store_dwordx4 v[60:63], v160, s[84:87], s57 offen offset:1024 sc1
    s_mov_b64 exec, -1
    buffer_store_dwordx4 v[60:63], v160, s[84:87], s57 offen sc1
    s_mov_b64 exec, 255
    buffer_load_dword v51, v156, s[60:63], 0 offen sc1
    s_mov_b64 exec, -1
    s_mul_i32 s3, s96, 147456
    s_add_u32 s3, s3, 8388608
    s_add_u32 s88, s12, s3
    s_addc_u32 s89, s13, 0
    s_mov_b32 s90, 147456
    s_mov_b32 s91, 0x20000
    s_waitcnt vmcnt(7)
    v_lshlrev_b32 v40, 16, v148
    v_and_b32 v41, 0xffff0000, v148
    v_lshlrev_b32 v42, 16, v149
    v_and_b32 v43, 0xffff0000, v149
    v_lshlrev_b32 v44, 16, v150
    v_mul_f32 v16, 0xbfb8aa3b, v40
    v_mul_f32 v17, 0xbfb8aa3b, v41
    v_mul_f32 v18, 0xbfb8aa3b, v42
    v_mul_f32 v19, 0xbfb8aa3b, v43
    v_mul_f32 v20, 0xbfb8aa3b, v44
    v_exp_f32 v16, v16
    v_exp_f32 v17, v17
    v_exp_f32 v18, v18
    v_exp_f32 v19, v19
    v_exp_f32 v20, v20
    v_add_f32 v16, 1.0, v16
    v_add_f32 v17, 1.0, v17
    v_add_f32 v18, 1.0, v18
    v_add_f32 v19, 1.0, v19
    v_add_f32 v20, 1.0, v20
    v_rcp_f32 v16, v16
    v_rcp_f32 v17, v17
    v_rcp_f32 v18, v18
    v_rcp_f32 v19, v19
    v_rcp_f32 v20, v20
    v_mul_f32 v24, v40, v16
    v_mul_f32 v26, v41, v17
    v_mul_f32 v28, v42, v18
    v_mul_f32 v30, v43, v19
    v_mul_f32 v32, v44, v20
    v_lshlrev_b32 v12, 16, v128
    v_and_b32 v13, 0xffff0000, v128
    v_pk_mul_f32 v[16:17], v[12:13], v[24:25] op_sel_hi:[1,0]
    v_lshlrev_b32 v14, 16, v129
    v_and_b32 v15, 0xffff0000, v129
    v_pk_mul_f32 v[18:19], v[14:15], v[24:25] op_sel_hi:[1,0]
    v_lshlrev_b32 v12, 16, v130
    v_and_b32 v13, 0xffff0000, v130
    v_pk_mul_f32 v[20:21], v[12:13], v[24:25] op_sel_hi:[1,0]
    v_lshlrev_b32 v14, 16, v131
    v_and_b32 v15, 0xffff0000, v131
    v_pk_mul_f32 v[22:23], v[14:15], v[24:25] op_sel_hi:[1,0]
    v_lshlrev_b32 v12, 16, v132
    v_and_b32 v13, 0xffff0000, v132
    v_pk_fma_f32 v[16:17], v[12:13], v[26:27], v[16:17] op_sel_hi:[1,0,1]
    v_lshlrev_b32 v14, 16, v133
    v_and_b32 v15, 0xffff0000, v133
    v_pk_fma_f32 v[18:19], v[14:15], v[26:27], v[18:19] op_sel_hi:[1,0,1]
    v_lshlrev_b32 v12, 16, v134
    v_and_b32 v13, 0xffff0000, v134
    v_pk_fma_f32 v[20:21], v[12:13], v[26:27], v[20:21] op_sel_hi:[1,0,1]
    v_lshlrev_b32 v14, 16, v135
    v_and_b32 v15, 0xffff0000, v135
    v_pk_fma_f32 v[22:23], v[14:15], v[26:27], v[22:23] op_sel_hi:[1,0,1]
    v_lshlrev_b32 v12, 16, v136
    v_and_b32 v13, 0xffff0000, v136
    v_pk_fma_f32 v[16:17], v[12:13], v[28:29], v[16:17] op_sel_hi:[1,0,1]
    v_lshlrev_b32 v14, 16, v137
    v_and_b32 v15, 0xffff0000, v137
    v_pk_fma_f32 v[18:19], v[14:15], v[28:29], v[18:19] op_sel_hi:[1,0,1]
    v_lshlrev_b32 v12, 16, v138
    v_and_b32 v13, 0xffff0000, v138
    v_pk_fma_f32 v[20:21], v[12:13], v[28:29], v[20:21] op_sel_hi:[1,0,1]
    v_lshlrev_b32 v14, 16, v139
    v_and_b32 v15, 0xffff0000, v139
    v_pk_fma_f32 v[22:23], v[14:15], v[28:29], v[22:23] op_sel_hi:[1,0,1]
    v_lshlrev_b32 v12, 16, v140
    v_and_b32 v13, 0xffff0000, v140
    v_pk_fma_f32 v[16:17], v[12:13], v[30:31], v[16:17] op_sel_hi:[1,0,1]
    v_lshlrev_b32 v14, 16, v141
    v_and_b32 v15, 0xffff0000, v141
    v_pk_fma_f32 v[18:19], v[14:15], v[30:31], v[18:19] op_sel_hi:[1,0,1]
    v_lshlrev_b32 v12, 16, v142
    v_and_b32 v13, 0xffff0000, v142
    v_pk_fma_f32 v[20:21], v[12:13], v[30:31], v[20:21] op_sel_hi:[1,0,1]
    v_lshlrev_b32 v14, 16, v143
    v_and_b32 v15, 0xffff0000, v143
    v_pk_fma_f32 v[22:23], v[14:15], v[30:31], v[22:23] op_sel_hi:[1,0,1]
    v_lshlrev_b32 v12, 16, v144
    v_and_b32 v13, 0xffff0000, v144
    v_pk_fma_f32 v[16:17], v[12:13], v[32:33], v[16:17] op_sel_hi:[1,0,1]
    v_lshlrev_b32 v14, 16, v145
    v_and_b32 v15, 0xffff0000, v145
    v_pk_fma_f32 v[18:19], v[14:15], v[32:33], v[18:19] op_sel_hi:[1,0,1]
    v_lshlrev_b32 v12, 16, v146
    v_and_b32 v13, 0xffff0000, v146
    v_pk_fma_f32 v[20:21], v[12:13], v[32:33], v[20:21] op_sel_hi:[1,0,1]
    v_lshlrev_b32 v14, 16, v147
    v_and_b32 v15, 0xffff0000, v147
    v_pk_fma_f32 v[22:23], v[14:15], v[32:33], v[22:23] op_sel_hi:[1,0,1]
    v_add_f32_dpp v16, v16, v16 row_ror:4 row_mask:0xf bank_mask:0xf
    v_add_f32_dpp v17, v17, v17 row_ror:4 row_mask:0xf bank_mask:0xf
    v_add_f32_dpp v18, v18, v18 row_ror:4 row_mask:0xf bank_mask:0xf
    v_add_f32_dpp v19, v19, v19 row_ror:4 row_mask:0xf bank_mask:0xf
    v_add_f32_dpp v20, v20, v20 row_ror:4 row_mask:0xf bank_mask:0xf
    v_add_f32_dpp v21, v21, v21 row_ror:4 row_mask:0xf bank_mask:0xf
    v_add_f32_dpp v22, v22, v22 row_ror:4 row_mask:0xf bank_mask:0xf
    v_add_f32_dpp v23, v23, v23 row_ror:4 row_mask:0xf bank_mask:0xf
    v_add_f32_dpp v16, v16, v16 row_ror:8 row_mask:0xf bank_mask:0xf
    v_add_f32_dpp v17, v17, v17 row_ror:8 row_mask:0xf bank_mask:0xf
    v_add_f32_dpp v18, v18, v18 row_ror:8 row_mask:0xf bank_mask:0xf
    v_add_f32_dpp v19, v19, v19 row_ror:8 row_mask:0xf bank_mask:0xf
    v_add_f32_dpp v20, v20, v20 row_ror:8 row_mask:0xf bank_mask:0xf
    v_add_f32_dpp v21, v21, v21 row_ror:8 row_mask:0xf bank_mask:0xf
    v_add_f32_dpp v22, v22, v22 row_ror:8 row_mask:0xf bank_mask:0xf
    v_add_f32_dpp v23, v23, v23 row_ror:8 row_mask:0xf bank_mask:0xf
    s_mov_b32 exec_lo, 0xf000f
    s_mov_b32 exec_hi, 0xf000f
    ds_write_b128 v161, v[16:19] offset:16384
    ds_write_b128 v161, v[20:23] offset:16400
    s_mov_b64 exec, 255
    s_waitcnt vmcnt(0)
    v_cmp_eq_u32 vcc, s51, v51
    s_nop 0
    s_cmp_lg_u64 vcc, 0
    s_cbranch_scc1 L2_p0s
L2_p0r:
    s_mov_b64 exec, 1
    s_waitcnt lgkmcnt(0)
    s_barrier
    buffer_store_dword v60, v156, s[84:87], s101 offen sc1
    s_mov_b64 exec, -1
    ds_read_b32 v24, v162 offset:16384
    ds_read_b32 v25, v162 offset:16640
    ds_read_b32 v26, v162 offset:16896
    ds_read_b32 v27, v162 offset:17152
    ds_read_b32 v28, v162 offset:17408
    ds_read_b32 v29, v162 offset:17664
    ds_read_b32 v30, v162 offset:17920
    ds_read_b32 v31, v162 offset:18176
    s_waitcnt lgkmcnt(0)
    v_pk_add_f32 v[24:25], v[24:25], v[26:27]
    v_pk_add_f32 v[28:29], v[28:29], v[30:31]
    v_pk_add_f32 v[24:25], v[24:25], v[28:29]
    v_add_f32 v52, v24, v25
    v_mov_b32 v53, v52
    v_mov_b32 v54, s48
    s_nop 0
    v_permlane32_swap_b32 v53, v52
    v_add_f32 v52, v52, v53
    v_fma_f32 v52, v52, s47, v54
    v_min_u32 v52, -2, v52
    s_mov_b32 exec_hi, 0
    buffer_store_dword v52, v164, s[84:87], s100 offen sc1
    s_mov_b64 exec, -1
    s_add_u32 m0, s44, 36864
    s_mov_b32 s45, 0
    buffer_load_dwordx4 v6, s[24:27], s45 offen lds
    s_add_u32 m0, s44, 37920
    s_mov_b32 s45, 8192
    buffer_load_dwordx4 v6, s[24:27], s45 offen lds
    s_add_u32 m0, s44, 38976
    s_mov_b32 s45, 16384
    buffer_load_dwordx4 v6, s[24:27], s45 offen lds
    s_add_u32 m0, s44, 40032
    s_mov_b32 s45, 24576
    buffer_load_dwordx4 v6, s[24:27], s45 offen lds
    s_add_u32 m0, s44, 53760
    s_mov_b32 s45, 262144
    buffer_load_dwordx4 v6, s[24:27], s45 offen lds
    s_add_u32 m0, s44, 54816
    s_mov_b32 s45, 270336
    buffer_load_dwordx4 v6, s[24:27], s45 offen lds
    s_add_u32 m0, s44, 55872
    s_mov_b32 s45, 278528
    buffer_load_dwordx4 v6, s[24:27], s45 offen lds
    s_add_u32 m0, s44, 56928
    s_mov_b32 s45, 286720
    buffer_load_dwordx4 v6, s[24:27], s45 offen lds
    s_add_u32 m0, s44, 73728
    s_mov_b32 s45, 524288
    buffer_load_dwordx4 v6, s[24:27], s45 offen lds
    s_add_u32 m0, s44, 74784
    s_mov_b32 s45, 532480
    buffer_load_dwordx4 v6, s[24:27], s45 offen lds
    s_add_u32 m0, s44, 75840
    s_mov_b32 s45, 540672
    buffer_load_dwordx4 v6, s[24:27], s45 offen lds
    s_add_u32 m0, s44, 76896
    s_mov_b32 s45, 548864
    buffer_load_dwordx4 v6, s[24:27], s45 offen lds
    s_add_u32 m0, s44, 90624
    s_mov_b32 s45, 786432
    buffer_load_dwordx4 v6, s[24:27], s45 offen lds
    s_add_u32 m0, s44, 91680
    s_mov_b32 s45, 794624
    buffer_load_dwordx4 v6, s[24:27], s45 offen lds
    s_add_u32 m0, s44, 92736
    s_mov_b32 s45, 802816
    buffer_load_dwordx4 v6, s[24:27], s45 offen lds
    s_add_u32 m0, s44, 93792
    s_mov_b32 s45, 811008
    buffer_load_dwordx4 v6, s[24:27], s45 offen lds
    s_mov_b64 exec, 15
    s_mov_b32 s97, 0x20000
L2_px:
    buffer_load_dword v13, v163, s[84:87], s59 offen sc1
    s_waitcnt vmcnt(0)
    v_cmp_eq_u32 vcc, 0, v13
    s_sub_u32 s97, s97, 1
    s_cselect_b64 vcc, 0, vcc
    s_cmp_eq_u64 vcc, 0
    s_cbranch_scc1 L2_px_ok
    s_sleep 1
    s_branch L2_px
L2_px_ok:
    s_mov_b64 exec, -1
    s_movk_i32 s14, 13824
    buffer_load_dwordx4 v[168:171], v166, s[84:87], 0 offen sc1
    buffer_load_dwordx4 v[176:179], v166, s[84:87], s14 offen sc1
    s_mov_b64 exec, 0xff
    buffer_load_dwordx4 v[172:175], v166, s[84:87], 0 offen offset:1024 sc1
    buffer_load_dwordx4 v[180:183], v166, s[84:87], s14 offen offset:1024 sc1
    s_mov_b64 exec, -1
    s_mov_b32 s54, 0
    buffer_load_dwordx4 v[80:83], v8, s[32:35], s54 offen sc1
    s_mov_b32 s54, 1024
    buffer_load_dwordx4 v[84:87], v8, s[32:35], s54 offen sc1
    s_mov_b32 s54, 18432
    buffer_load_dwordx4 v[88:91], v8, s[32:35], s54 offen sc1
    s_mov_b32 s54, 19456
    buffer_load_dwordx4 v[92:95], v8, s[32:35], s54 offen sc1
    s_mov_b32 s54, 2048
    buffer_load_dwordx4 v[96:99], v8, s[32:35], s54 offen sc1
    s_mov_b32 s54, 3072
    buffer_load_dwordx4 v[100:103], v8, s[32:35], s54 offen sc1
    s_mov_b32 s54, 20480
    buffer_load_dwordx4 v[104:107], v8, s[32:35], s54 offen sc1
    s_mov_b32 s54, 21504
    buffer_load_dwordx4 v[108:111], v8, s[32:35], s54 offen sc1
    s_waitcnt vmcnt(8)
    v_max_u32 v13, v168, v169
    v_max3_u32 v13, v13, v170, v171
    v_max3_u32 v13, v13, v172, v173
    v_max3_u32 v13, v13, v174, v175
    v_max3_u32 v13, v13, v176, v177
    v_max3_u32 v13, v13, v178, v179
    v_max3_u32 v13, v13, v180, v181
    v_max3_u32 v13, v13, v182, v183
    v_cmp_eq_u32 vcc, -1, v13
    s_nop 0
    s_cmp_lg_u64 vcc, 0
    s_cbranch_scc1 L2_pms
L2_pmr:
    v_pk_add_f32 v[168:169], v[168:169], v[176:177]
    v_pk_add_f32 v[170:171], v[170:171], v[178:179]
    v_pk_add_f32 v[172:173], v[172:173], v[180:181]
    v_pk_add_f32 v[174:175], v[174:175], v[182:183]
    ds_write_b128 v167, v[168:171]
    s_mov_b64 exec, 0xff
    ds_write_b128 v167, v[172:175] offset:2048
    s_mov_b64 exec, -1
    s_mov_b32 s54, 4096
    buffer_load_dwordx4 v[112:115], v8, s[32:35], s54 offen sc1
    s_mov_b32 s54, 5120
    buffer_load_dwordx4 v[116:119], v8, s[32:35], s54 offen sc1
    s_mov_b32 s54, 22528
    buffer_load_dwordx4 v[120:123], v8, s[32:35], s54 offen sc1
    s_mov_b32 s54, 23552
    buffer_load_dwordx4 v[124:127], v8, s[32:35], s54 offen sc1
    s_waitcnt lgkmcnt(0)
    s_barrier
    ds_read_b128 v[16:19], v9 offset:9216
    ds_read_b128 v[20:23], v9 offset:9248
    ds_read_b128 v[24:27], v9 offset:9232
    ds_read_b128 v[28:31], v9 offset:9264
    s_waitcnt vmcnt(8)
    s_waitcnt lgkmcnt(2)
    v_fma_mix_f32 v32, v80, v16, v20 op_sel:[0,0,0] op_sel_hi:[1,0,0]
    v_fma_mix_f32 v33, v80, v17, v21 op_sel:[1,0,0] op_sel_hi:[1,0,0]
    v_fma_mix_f32 v34, v81, v18, v22 op_sel:[0,0,0] op_sel_hi:[1,0,0]
    v_fma_mix_f32 v35, v81, v19, v23 op_sel:[1,0,0] op_sel_hi:[1,0,0]
    v_cvt_pk_bf16_f32 v80, v32, v33
    v_cvt_pk_bf16_f32 v81, v34, v35
    v_fma_mix_f32 v36, v88, v16, v20 op_sel:[0,0,0] op_sel_hi:[1,0,0]
    v_fma_mix_f32 v37, v88, v17, v21 op_sel:[1,0,0] op_sel_hi:[1,0,0]
    v_fma_mix_f32 v38, v89, v18, v22 op_sel:[0,0,0] op_sel_hi:[1,0,0]
    v_fma_mix_f32 v39, v89, v19, v23 op_sel:[1,0,0] op_sel_hi:[1,0,0]
    v_cvt_pk_bf16_f32 v88, v36, v37
    v_cvt_pk_bf16_f32 v89, v38, v39
    ds_read_b128 v[16:19], v9 offset:9472
    ds_read_b128 v[20:23], v9 offset:9504
    s_waitcnt lgkmcnt(2)
    v_fma_mix_f32 v32, v82, v24, v28 op_sel:[0,0,0] op_sel_hi:[1,0,0]
    v_fma_mix_f32 v33, v82, v25, v29 op_sel:[1,0,0] op_sel_hi:[1,0,0]
    v_fma_mix_f32 v34, v83, v26, v30 op_sel:[0,0,0] op_sel_hi:[1,0,0]
    v_fma_mix_f32 v35, v83, v27, v31 op_sel:[1,0,0] op_sel_hi:[1,0,0]
    v_cvt_pk_bf16_f32 v82, v32, v33
    v_cvt_pk_bf16_f32 v83, v34, v35
    v_fma_mix_f32 v36, v90, v24, v28 op_sel:[0,0,0] op_sel_hi:[1,0,0]
    v_fma_mix_f32 v37, v90, v25, v29 op_sel:[1,0,0] op_sel_hi:[1,0,0]
    v_fma_mix_f32 v38, v91, v26, v30 op_sel:[0,0,0] op_sel_hi:[1,0,0]
    v_fma_mix_f32 v39, v91, v27, v31 op_sel:[1,0,0] op_sel_hi:[1,0,0]
    v_cvt_pk_bf16_f32 v90, v36, v37
    v_cvt_pk_bf16_f32 v91, v38, v39
    ds_read_b128 v[24:27], v9 offset:9488
    ds_read_b128 v[28:31], v9 offset:9520
    s_waitcnt lgkmcnt(2)
    v_fma_mix_f32 v32, v84, v16, v20 op_sel:[0,0,0] op_sel_hi:[1,0,0]
    v_fma_mix_f32 v33, v84, v17, v21 op_sel:[1,0,0] op_sel_hi:[1,0,0]
    v_fma_mix_f32 v34, v85, v18, v22 op_sel:[0,0,0] op_sel_hi:[1,0,0]
    v_fma_mix_f32 v35, v85, v19, v23 op_sel:[1,0,0] op_sel_hi:[1,0,0]
    v_cvt_pk_bf16_f32 v84, v32, v33
    v_cvt_pk_bf16_f32 v85, v34, v35
    v_fma_mix_f32 v36, v92, v16, v20 op_sel:[0,0,0] op_sel_hi:[1,0,0]
    v_fma_mix_f32 v37, v92, v17, v21 op_sel:[1,0,0] op_sel_hi:[1,0,0]
    v_fma_mix_f32 v38, v93, v18, v22 op_sel:[0,0,0] op_sel_hi:[1,0,0]
    v_fma_mix_f32 v39, v93, v19, v23 op_sel:[1,0,0] op_sel_hi:[1,0,0]
    v_cvt_pk_bf16_f32 v92, v36, v37
    v_cvt_pk_bf16_f32 v93, v38, v39
    ds_read_b128 v[16:19], v9 offset:9728
    ds_read_b128 v[20:23], v9 offset:9760
    ds_read_b64_tr_b16 a[192:193], v3 offset:36864
    ds_read_b64_tr_b16 a[194:195], v3 offset:37376
    ds_read_b64_tr_b16 a[196:197], v3 offset:53760
    ds_read_b64_tr_b16 a[198:199], v3 offset:54272
    ds_read_b64_tr_b16 a[200:201], v3 offset:36896
    ds_read_b64_tr_b16 a[202:203], v3 offset:37408
    ds_read_b64_tr_b16 a[204:205], v3 offset:53792
    ds_read_b64_tr_b16 a[206:207], v3 offset:54304
    ds_read_b64_tr_b16 a[208:209], v3 offset:36928
    ds_read_b64_tr_b16 a[210:211], v3 offset:37440
    ds_read_b64_tr_b16 a[212:213], v3 offset:53824
    ds_read_b64_tr_b16 a[214:215], v3 offset:54336
    s_waitcnt lgkmcnt(14)
    v_fma_mix_f32 v32, v86, v24, v28 op_sel:[0,0,0] op_sel_hi:[1,0,0]
    v_fma_mix_f32 v33, v86, v25, v29 op_sel:[1,0,0] op_sel_hi:[1,0,0]
    v_fma_mix_f32 v34, v87, v26, v30 op_sel:[0,0,0] op_sel_hi:[1,0,0]
    v_fma_mix_f32 v35, v87, v27, v31 op_sel:[1,0,0] op_sel_hi:[1,0,0]
    v_cvt_pk_bf16_f32 v86, v32, v33
    v_cvt_pk_bf16_f32 v87, v34, v35
    v_fma_mix_f32 v36, v94, v24, v28 op_sel:[0,0,0] op_sel_hi:[1,0,0]
    v_fma_mix_f32 v37, v94, v25, v29 op_sel:[1,0,0] op_sel_hi:[1,0,0]
    v_fma_mix_f32 v38, v95, v26, v30 op_sel:[0,0,0] op_sel_hi:[1,0,0]
    v_fma_mix_f32 v39, v95, v27, v31 op_sel:[1,0,0] op_sel_hi:[1,0,0]
    v_cvt_pk_bf16_f32 v94, v36, v37
    v_cvt_pk_bf16_f32 v95, v38, v39
    s_waitcnt lgkmcnt(8)
    v_mfma_f32_16x16x32_bf16 v[128:131], a[192:195], v[80:83], 0
    s_waitcnt vmcnt(4)
    ds_read_b64_tr_b16 a[216:217], v3 offset:36960
    ds_read_b128 v[24:27], v9 offset:9744
    v_mfma_f32_16x16x32_bf16 v[128:131], a[196:199], v[84:87], v[128:131]
    ds_read_b64_tr_b16 a[218:219], v3 offset:37472
    ds_read_b64_tr_b16 a[220:221], v3 offset:53856
    v_fma_mix_f32 v32, v96, v16, v20 op_sel:[0,0,0] op_sel_hi:[1,0,0]
    v_mfma_f32_16x16x32_bf16 v[160:163], a[192:195], v[88:91], 0
    s_add_u32 m0, s44, 110592
    ds_read_b64_tr_b16 a[222:223], v3 offset:54368
    ds_read_b128 v[28:31], v9 offset:9776
    v_mfma_f32_16x16x32_bf16 v[160:163], a[196:199], v[92:95], v[160:163]
    s_mov_b32 s45, 1048576
    s_waitcnt lgkmcnt(10)
    buffer_load_dwordx4 v6, s[24:27], s45 offen lds
    v_mfma_f32_16x16x32_bf16 v[132:135], a[200:203], v[80:83], 0
    ds_read_b64_tr_b16 a[224:225], v3 offset:36992
    v_fma_mix_f32 v33, v96, v17, v21 op_sel:[1,0,0] op_sel_hi:[1,0,0]
    v_mfma_f32_16x16x32_bf16 v[132:135], a[204:207], v[84:87], v[132:135]
    ds_read_b64_tr_b16 a[226:227], v3 offset:37504
    ds_read_b64_tr_b16 a[228:229], v3 offset:53888
    v_fma_mix_f32 v34, v97, v18, v22 op_sel:[0,0,0] op_sel_hi:[1,0,0]
    v_mfma_f32_16x16x32_bf16 v[164:167], a[200:203], v[88:91], 0
    s_add_u32 m0, s44, 111648
    ds_read_b64_tr_b16 a[230:231], v3 offset:54400
    v_fma_mix_f32 v35, v97, v19, v23 op_sel:[1,0,0] op_sel_hi:[1,0,0]
    v_mfma_f32_16x16x32_bf16 v[164:167], a[204:207], v[92:95], v[164:167]
    s_mov_b32 s45, 1056768
    s_waitcnt lgkmcnt(10)
    buffer_load_dwordx4 v6, s[24:27], s45 offen lds
    v_mfma_f32_16x16x32_bf16 v[136:139], a[208:211], v[80:83], 0
    ds_read_b64_tr_b16 a[232:233], v3 offset:37024
    v_cvt_pk_bf16_f32 v96, v32, v33
    v_mfma_f32_16x16x32_bf16 v[136:139], a[212:215], v[84:87], v[136:139]
    ds_read_b64_tr_b16 a[234:235], v3 offset:37536
    ds_read_b64_tr_b16 a[236:237], v3 offset:53920
    v_cvt_pk_bf16_f32 v97, v34, v35
    v_mfma_f32_16x16x32_bf16 v[168:171], a[208:211], v[88:91], 0
    s_add_u32 m0, s44, 112704
    ds_read_b64_tr_b16 a[238:239], v3 offset:54432
    v_fma_mix_f32 v36, v104, v16, v20 op_sel:[0,0,0] op_sel_hi:[1,0,0]
    v_mfma_f32_16x16x32_bf16 v[168:171], a[212:215], v[92:95], v[168:171]
    s_mov_b32 s45, 1064960
    s_waitcnt lgkmcnt(9)
    buffer_load_dwordx4 v6, s[24:27], s45 offen lds
    v_fma_mix_f32 v37, v104, v17, v21 op_sel:[1,0,0] op_sel_hi:[1,0,0]
    v_mfma_f32_16x16x32_bf16 v[140:143], a[216:219], v[80:83], 0
    ds_read_b64_tr_b16 a[240:241], v3 offset:37056
    v_fma_mix_f32 v38, v105, v18, v22 op_sel:[0,0,0] op_sel_hi:[1,0,0]
    v_mfma_f32_16x16x32_bf16 v[140:143], a[220:223], v[84:87], v[140:143]
    ds_read_b64_tr_b16 a[242:243], v3 offset:37568
    ds_read_b64_tr_b16 a[244:245], v3 offset:53952
    v_fma_mix_f32 v39, v105, v19, v23 op_sel:[1,0,0] op_sel_hi:[1,0,0]
    v_mfma_f32_16x16x32_bf16 v[172:175], a[216:219], v[88:91], 0
    s_add_u32 m0, s44, 113760
    ds_read_b64_tr_b16 a[246:247], v3 offset:54464
    v_cvt_pk_bf16_f32 v104, v36, v37
    v_mfma_f32_16x16x32_bf16 v[172:175], a[220:223], v[92:95], v[172:175]
    s_mov_b32 s45, 1073152
    s_waitcnt lgkmcnt(8)
    buffer_load_dwordx4 v6, s[24:27], s45 offen lds
    v_cvt_pk_bf16_f32 v105, v38, v39
    v_mfma_f32_16x16x32_bf16 v[144:147], a[224:227], v[80:83], 0
    ds_read_b64_tr_b16 a[248:249], v3 offset:37088
    ds_read_b128 v[16:19], v9 offset:9984
    v_mfma_f32_16x16x32_bf16 v[144:147], a[228:231], v[84:87], v[144:147]
    ds_read_b64_tr_b16 a[250:251], v3 offset:37600
    ds_read_b64_tr_b16 a[252:253], v3 offset:53984
    v_fma_mix_f32 v32, v98, v24, v28 op_sel:[0,0,0] op_sel_hi:[1,0,0]
    v_mfma_f32_16x16x32_bf16 v[176:179], a[224:227], v[88:91], 0
    s_add_u32 m0, s44, 127488
    ds_read_b64_tr_b16 a[254:255], v3 offset:54496
    ds_read_b128 v[20:23], v9 offset:10016
    v_mfma_f32_16x16x32_bf16 v[176:179], a[228:231], v[92:95], v[176:179]
    s_mov_b32 s45, 1310720
    s_waitcnt lgkmcnt(10)
    buffer_load_dwordx4 v6, s[24:27], s45 offen lds
    v_mfma_f32_16x16x32_bf16 v[148:151], a[232:235], v[80:83], 0
    ds_read_b64_tr_b16 a[192:193], v3 offset:37120
    v_fma_mix_f32 v33, v98, v25, v29 op_sel:[1,0,0] op_sel_hi:[1,0,0]
    v_mfma_f32_16x16x32_bf16 v[148:151], a[236:239], v[84:87], v[148:151]
    ds_read_b64_tr_b16 a[194:195], v3 offset:37632
    ds_read_b64_tr_b16 a[196:197], v3 offset:54016
    v_fma_mix_f32 v34, v99, v26, v30 op_sel:[0,0,0] op_sel_hi:[1,0,0]
    v_mfma_f32_16x16x32_bf16 v[180:183], a[232:235], v[88:91], 0
    s_add_u32 m0, s44, 128544
    ds_read_b64_tr_b16 a[198:199], v3 offset:54528
    v_fma_mix_f32 v35, v99, v27, v31 op_sel:[1,0,0] op_sel_hi:[1,0,0]
    v_mfma_f32_16x16x32_bf16 v[180:183], a[236:239], v[92:95], v[180:183]
    s_mov_b32 s45, 1318912
    s_waitcnt lgkmcnt(10)
    buffer_load_dwordx4 v6, s[24:27], s45 offen lds
    v_mfma_f32_16x16x32_bf16 v[152:155], a[240:243], v[80:83], 0
    ds_read_b64_tr_b16 a[200:201], v3 offset:37152
    v_cvt_pk_bf16_f32 v98, v32, v33
    v_mfma_f32_16x16x32_bf16 v[152:155], a[244:247], v[84:87], v[152:155]
    ds_read_b64_tr_b16 a[202:203], v3 offset:37664
    ds_read_b64_tr_b16 a[204:205], v3 offset:54048
    v_cvt_pk_bf16_f32 v99, v34, v35
    v_mfma_f32_16x16x32_bf16 v[184:187], a[240:243], v[88:91], 0
    s_add_u32 m0, s44, 129600
    ds_read_b64_tr_b16 a[206:207], v3 offset:54560
    v_fma_mix_f32 v36, v106, v24, v28 op_sel:[0,0,0] op_sel_hi:[1,0,0]
    v_mfma_f32_16x16x32_bf16 v[184:187], a[244:247], v[92:95], v[184:187]
    s_mov_b32 s45, 1327104
    s_waitcnt lgkmcnt(9)
    buffer_load_dwordx4 v6, s[24:27], s45 offen lds
    v_fma_mix_f32 v37, v106, v25, v29 op_sel:[1,0,0] op_sel_hi:[1,0,0]
    v_mfma_f32_16x16x32_bf16 v[156:159], a[248:251], v[80:83], 0
    ds_read_b64_tr_b16 a[208:209], v3 offset:37184
    v_fma_mix_f32 v38, v107, v26, v30 op_sel:[0,0,0] op_sel_hi:[1,0,0]
    v_mfma_f32_16x16x32_bf16 v[156:159], a[252:255], v[84:87], v[156:159]
    ds_read_b64_tr_b16 a[210:211], v3 offset:37696
    ds_read_b64_tr_b16 a[212:213], v3 offset:54080
    v_fma_mix_f32 v39, v107, v27, v31 op_sel:[1,0,0] op_sel_hi:[1,0,0]
    v_mfma_f32_16x16x32_bf16 v[188:191], a[248:251], v[88:91], 0
    s_add_u32 m0, s44, 130656
    ds_read_b64_tr_b16 a[214:215], v3 offset:54592
    v_cvt_pk_bf16_f32 v106, v36, v37
    v_mfma_f32_16x16x32_bf16 v[188:191], a[252:255], v[92:95], v[188:191]
    s_mov_b32 s45, 1335296
    s_waitcnt lgkmcnt(8)
    buffer_load_dwordx4 v6, s[24:27], s45 offen lds
    v_cvt_pk_bf16_f32 v107, v38, v39
    v_mfma_f32_16x16x32_bf16 v[192:195], a[192:195], v[80:83], 0
    ds_read_b64_tr_b16 a[216:217], v3 offset:37216
    ds_read_b128 v[24:27], v9 offset:10000
    v_mfma_f32_16x16x32_bf16 v[192:195], a[196:199], v[84:87], v[192:195]
    ds_read_b64_tr_b16 a[218:219], v3 offset:37728
    ds_read_b64_tr_b16 a[220:221], v3 offset:54112
    v_fma_mix_f32 v32, v100, v16, v20 op_sel:[0,0,0] op_sel_hi:[1,0,0]
    v_mfma_f32_16x16x32_bf16 v[224:227], a[192:195], v[88:91], 0
    s_mov_b32 s54, 6144
    ds_read_b64_tr_b16 a[222:223], v3 offset:54624
    ds_read_b128 v[28:31], v9 offset:10032
    v_mfma_f32_16x16x32_bf16 v[224:227], a[196:199], v[92:95], v[224:227]
    s_waitcnt lgkmcnt(10)
    buffer_load_dwordx4 v[48:51], v8, s[32:35], s54 offen sc1
    v_mfma_f32_16x16x32_bf16 v[196:199], a[200:203], v[80:83], 0
    ds_read_b64_tr_b16 a[224:225], v3 offset:37248
    v_fma_mix_f32 v33, v100, v17, v21 op_sel:[1,0,0] op_sel_hi:[1,0,0]
    v_mfma_f32_16x16x32_bf16 v[196:199], a[204:207], v[84:87], v[196:199]
    ds_read_b64_tr_b16 a[226:227], v3 offset:37760
    ds_read_b64_tr_b16 a[228:229], v3 offset:54144
    v_fma_mix_f32 v34, v101, v18, v22 op_sel:[0,0,0] op_sel_hi:[1,0,0]
    v_mfma_f32_16x16x32_bf16 v[228:231], a[200:203], v[88:91], 0
    s_mov_b32 s54, 7168
    ds_read_b64_tr_b16 a[230:231], v3 offset:54656
    v_fma_mix_f32 v35, v101, v19, v23 op_sel:[1,0,0] op_sel_hi:[1,0,0]
    v_mfma_f32_16x16x32_bf16 v[228:231], a[204:207], v[92:95], v[228:231]
    s_waitcnt lgkmcnt(10)
    buffer_load_dwordx4 v[52:55], v8, s[32:35], s54 offen sc1
    v_mfma_f32_16x16x32_bf16 v[200:203], a[208:211], v[80:83], 0
    ds_read_b64_tr_b16 a[232:233], v3 offset:37280
    v_cvt_pk_bf16_f32 v100, v32, v33
    v_mfma_f32_16x16x32_bf16 v[200:203], a[212:215], v[84:87], v[200:203]
    ds_read_b64_tr_b16 a[234:235], v3 offset:37792
    ds_read_b64_tr_b16 a[236:237], v3 offset:54176
    v_cvt_pk_bf16_f32 v101, v34, v35
    v_mfma_f32_16x16x32_bf16 v[232:235], a[208:211], v[88:91], 0
    s_mov_b32 s54, 24576
    ds_read_b64_tr_b16 a[238:239], v3 offset:54688
    v_fma_mix_f32 v36, v108, v16, v20 op_sel:[0,0,0] op_sel_hi:[1,0,0]
    v_mfma_f32_16x16x32_bf16 v[232:235], a[212:215], v[92:95], v[232:235]
    s_waitcnt lgkmcnt(9)
    buffer_load_dwordx4 v[56:59], v8, s[32:35], s54 offen sc1
    v_fma_mix_f32 v37, v108, v17, v21 op_sel:[1,0,0] op_sel_hi:[1,0,0]
    v_mfma_f32_16x16x32_bf16 v[204:207], a[216:219], v[80:83], 0
    ds_read_b64_tr_b16 a[240:241], v3 offset:37312
    v_fma_mix_f32 v38, v109, v18, v22 op_sel:[0,0,0] op_sel_hi:[1,0,0]
    v_mfma_f32_16x16x32_bf16 v[204:207], a[220:223], v[84:87], v[204:207]
    ds_read_b64_tr_b16 a[242:243], v3 offset:37824
    ds_read_b64_tr_b16 a[244:245], v3 offset:54208
    v_fma_mix_f32 v39, v109, v19, v23 op_sel:[1,0,0] op_sel_hi:[1,0,0]
    v_mfma_f32_16x16x32_bf16 v[236:239], a[216:219], v[88:91], 0
    s_mov_b32 s54, 25600
    ds_read_b64_tr_b16 a[246:247], v3 offset:54720
    v_cvt_pk_bf16_f32 v108, v36, v37
    v_mfma_f32_16x16x32_bf16 v[236:239], a[220:223], v[92:95], v[236:239]
    s_waitcnt lgkmcnt(8)
    buffer_load_dwordx4 v[60:63], v8, s[32:35], s54 offen sc1
    v_cvt_pk_bf16_f32 v109, v38, v39
    v_mfma_f32_16x16x32_bf16 v[208:211], a[224:227], v[80:83], 0
    ds_read_b64_tr_b16 a[248:249], v3 offset:37344
    ds_read_b128 v[16:19], v9 offset:10240
    v_mfma_f32_16x16x32_bf16 v[208:211], a[228:231], v[84:87], v[208:211]
    ds_read_b64_tr_b16 a[250:251], v3 offset:37856
    ds_read_b128 v[20:23], v9 offset:10272
    v_mfma_f32_16x16x32_bf16 v[240:243], a[224:227], v[88:91], 0
    ds_read_b64_tr_b16 a[252:253], v3 offset:54240
    v_fma_mix_f32 v32, v102, v24, v28 op_sel:[0,0,0] op_sel_hi:[1,0,0]
    v_mfma_f32_16x16x32_bf16 v[240:243], a[228:231], v[92:95], v[240:243]
    s_barrier
    s_waitcnt lgkmcnt(9)
    ds_read_b64_tr_b16 a[254:255], v3 offset:54752
    v_fma_mix_f32 v33, v102, v25, v29 op_sel:[1,0,0] op_sel_hi:[1,0,0]
    v_fma_mix_f32 v34, v103, v26, v30 op_sel:[0,0,0] op_sel_hi:[1,0,0]
    v_mfma_f32_16x16x32_bf16 v[212:215], a[232:235], v[80:83], 0
    ds_read_b64_tr_b16 a[192:193], v4 offset:0
    v_fma_mix_f32 v35, v103, v27, v31 op_sel:[1,0,0] op_sel_hi:[1,0,0]
    v_mfma_f32_16x16x32_bf16 v[212:215], a[236:239], v[84:87], v[212:215]
    ds_read_b64_tr_b16 a[194:195], v4 offset:512
    ds_read_b64_tr_b16 a[196:197], v4 offset:16896
    v_cvt_pk_bf16_f32 v102, v32, v33
    v_mfma_f32_16x16x32_bf16 v[244:247], a[232:235], v[88:91], 0
    s_add_u32 m0, s44, 0
    ds_read_b64_tr_b16 a[198:199], v4 offset:17408
    v_cvt_pk_bf16_f32 v103, v34, v35
    v_mfma_f32_16x16x32_bf16 v[244:247], a[236:239], v[92:95], v[244:247]
    s_mov_b32 s45, 1572864
    s_waitcnt lgkmcnt(10)
    buffer_load_dwordx4 v6, s[24:27], s45 offen lds
    v_mfma_f32_16x16x32_bf16 v[216:219], a[240:243], v[80:83], 0
    ds_read_b64_tr_b16 a[200:201], v4 offset:32
    v_fma_mix_f32 v36, v110, v24, v28 op_sel:[0,0,0] op_sel_hi:[1,0,0]
    v_mfma_f32_16x16x32_bf16 v[216:219], a[244:247], v[84:87], v[216:219]
    ds_read_b64_tr_b16 a[202:203], v4 offset:544
    ds_read_b64_tr_b16 a[204:205], v4 offset:16928
    v_fma_mix_f32 v37, v110, v25, v29 op_sel:[1,0,0] op_sel_hi:[1,0,0]
    v_mfma_f32_16x16x32_bf16 v[248:251], a[240:243], v[88:91], 0
    s_add_u32 m0, s44, 1056
    ds_read_b64_tr_b16 a[206:207], v4 offset:17440
    v_fma_mix_f32 v38, v111, v26, v30 op_sel:[0,0,0] op_sel_hi:[1,0,0]
    v_mfma_f32_16x16x32_bf16 v[248:251], a[244:247], v[92:95], v[248:251]
    s_mov_b32 s45, 1581056
    s_waitcnt lgkmcnt(8)
    buffer_load_dwordx4 v6, s[24:27], s45 offen lds
    v_mfma_f32_16x16x32_bf16 v[220:223], a[248:251], v[80:83], 0
    ds_read_b64_tr_b16 a[208:209], v4 offset:64
    v_fma_mix_f32 v39, v111, v27, v31 op_sel:[1,0,0] op_sel_hi:[1,0,0]
    v_mfma_f32_16x16x32_bf16 v[220:223], a[252:255], v[84:87], v[220:223]
    ds_read_b64_tr_b16 a[210:211], v4 offset:576
    ds_read_b64_tr_b16 a[212:213], v4 offset:16960
    v_cvt_pk_bf16_f32 v110, v36, v37
    v_mfma_f32_16x16x32_bf16 v[252:255], a[248:251], v[88:91], 0
    s_add_u32 m0, s44, 2112
    ds_read_b64_tr_b16 a[214:215], v4 offset:17472
    v_cvt_pk_bf16_f32 v111, v38, v39
    v_mfma_f32_16x16x32_bf16 v[252:255], a[252:255], v[92:95], v[252:255]
    s_mov_b32 s45, 1589248
    s_waitcnt lgkmcnt(8)
    buffer_load_dwordx4 v6, s[24:27], s45 offen lds
    v_mfma_f32_16x16x32_bf16 v[128:131], a[192:195], v[96:99], v[128:131]
    s_waitcnt vmcnt(15)
    ds_read_b64_tr_b16 a[216:217], v4 offset:96
    ds_read_b128 v[24:27], v9 offset:10256
    v_mfma_f32_16x16x32_bf16 v[128:131], a[196:199], v[100:103], v[128:131]
    ds_read_b64_tr_b16 a[218:219], v4 offset:608
    ds_read_b64_tr_b16 a[220:221], v4 offset:16992
    v_fma_mix_f32 v32, v112, v16, v20 op_sel:[0,0,0] op_sel_hi:[1,0,0]
    v_mfma_f32_16x16x32_bf16 v[160:163], a[192:195], v[104:107], v[160:163]
    s_add_u32 m0, s44, 3168
    ds_read_b64_tr_b16 a[222:223], v4 offset:17504
    ds_read_b128 v[28:31], v9 offset:10288
    v_mfma_f32_16x16x32_bf16 v[160:163], a[196:199], v[108:111], v[160:163]
    s_mov_b32 s45, 1597440
    s_waitcnt lgkmcnt(10)
    buffer_load_dwordx4 v6, s[24:27], s45 offen lds
    v_mfma_f32_16x16x32_bf16 v[132:135], a[200:203], v[96:99], v[132:135]
    ds_read_b64_tr_b16 a[224:225], v4 offset:128
    v_fma_mix_f32 v33, v112, v17, v21 op_sel:[1,0,0] op_sel_hi:[1,0,0]
    v_mfma_f32_16x16x32_bf16 v[132:135], a[204:207], v[100:103], v[132:135]
    ds_read_b64_tr_b16 a[226:227], v4 offset:640
    ds_read_b64_tr_b16 a[228:229], v4 offset:17024
    v_fma_mix_f32 v34, v113, v18, v22 op_sel:[0,0,0] op_sel_hi:[1,0,0]
    v_mfma_f32_16x16x32_bf16 v[164:167], a[200:203], v[104:107], v[164:167]
    s_add_u32 m0, s44, 16896
    ds_read_b64_tr_b16 a[230:231], v4 offset:17536
    v_fma_mix_f32 v35, v113, v19, v23 op_sel:[1,0,0] op_sel_hi:[1,0,0]
    v_mfma_f32_16x16x32_bf16 v[164:167], a[204:207], v[108:111], v[164:167]
    s_mov_b32 s45, 1835008
    s_waitcnt lgkmcnt(10)
    buffer_load_dwordx4 v6, s[24:27], s45 offen lds
    v_mfma_f32_16x16x32_bf16 v[136:139], a[208:211], v[96:99], v[136:139]
    ds_read_b64_tr_b16 a[232:233], v4 offset:160
    v_cvt_pk_bf16_f32 v112, v32, v33
    v_mfma_f32_16x16x32_bf16 v[136:139], a[212:215], v[100:103], v[136:139]
    ds_read_b64_tr_b16 a[234:235], v4 offset:672
    ds_read_b64_tr_b16 a[236:237], v4 offset:17056
    v_cvt_pk_bf16_f32 v113, v34, v35
    v_mfma_f32_16x16x32_bf16 v[168:171], a[208:211], v[104:107], v[168:171]
    s_add_u32 m0, s44, 17952
    ds_read_b64_tr_b16 a[238:239], v4 offset:17568
    v_fma_mix_f32 v36, v120, v16, v20 op_sel:[0,0,0] op_sel_hi:[1,0,0]
    v_mfma_f32_16x16x32_bf16 v[168:171], a[212:215], v[108:111], v[168:171]
    s_mov_b32 s45, 1843200
    s_waitcnt lgkmcnt(9)
    buffer_load_dwordx4 v6, s[24:27], s45 offen lds
    v_fma_mix_f32 v37, v120, v17, v21 op_sel:[1,0,0] op_sel_hi:[1,0,0]
    v_mfma_f32_16x16x32_bf16 v[140:143], a[216:219], v[96:99], v[140:143]
    ds_read_b64_tr_b16 a[240:241], v4 offset:192
    v_fma_mix_f32 v38, v121, v18, v22 op_sel:[0,0,0] op_sel_hi:[1,0,0]
    v_mfma_f32_16x16x32_bf16 v[140:143], a[220:223], v[100:103], v[140:143]
    ds_read_b64_tr_b16 a[242:243], v4 offset:704
    ds_read_b64_tr_b16 a[244:245], v4 offset:17088
    v_fma_mix_f32 v39, v121, v19, v23 op_sel:[1,0,0] op_sel_hi:[1,0,0]
    v_mfma_f32_16x16x32_bf16 v[172:175], a[216:219], v[104:107], v[172:175]
    s_add_u32 m0, s44, 19008
    ds_read_b64_tr_b16 a[246:247], v4 offset:17600
    v_cvt_pk_bf16_f32 v120, v36, v37
    v_mfma_f32_16x16x32_bf16 v[172:175], a[220:223], v[108:111], v[172:175]
    s_mov_b32 s45, 1851392
    s_waitcnt lgkmcnt(8)
    buffer_load_dwordx4 v6, s[24:27], s45 offen lds
    v_cvt_pk_bf16_f32 v121, v38, v39
    v_mfma_f32_16x16x32_bf16 v[144:147], a[224:227], v[96:99], v[144:147]
    ds_read_b64_tr_b16 a[248:249], v4 offset:224
    ds_read_b128 v[16:19], v9 offset:10496
    v_mfma_f32_16x16x32_bf16 v[144:147], a[228:231], v[100:103], v[144:147]
    ds_read_b64_tr_b16 a[250:251], v4 offset:736
    ds_read_b64_tr_b16 a[252:253], v4 offset:17120
    v_mfma_f32_16x16x32_bf16 v[176:179], a[224:227], v[104:107], v[176:179]
    s_add_u32 m0, s44, 20064
    ds_read_b64_tr_b16 a[254:255], v4 offset:17632
    ds_read_b128 v[20:23], v9 offset:10528
    v_mfma_f32_16x16x32_bf16 v[176:179], a[228:231], v[108:111], v[176:179]
    s_mov_b32 s45, 1859584
    s_waitcnt lgkmcnt(10)
    buffer_load_dwordx4 v6, s[24:27], s45 offen lds
    v_mfma_f32_16x16x32_bf16 v[148:151], a[232:235], v[96:99], v[148:151]
    ds_read_b64_tr_b16 a[192:193], v4 offset:256
    v_fma_mix_f32 v32, v114, v24, v28 op_sel:[0,0,0] op_sel_hi:[1,0,0]
    v_mfma_f32_16x16x32_bf16 v[148:151], a[236:239], v[100:103], v[148:151]
    ds_read_b64_tr_b16 a[194:195], v4 offset:768
    v_fma_mix_f32 v33, v114, v25, v29 op_sel:[1,0,0] op_sel_hi:[1,0,0]
    v_mfma_f32_16x16x32_bf16 v[180:183], a[232:235], v[104:107], v[180:183]
    ds_read_b64_tr_b16 a[196:197], v4 offset:17152
    v_fma_mix_f32 v34, v115, v26, v30 op_sel:[0,0,0] op_sel_hi:[1,0,0]
    v_mfma_f32_16x16x32_bf16 v[180:183], a[236:239], v[108:111], v[180:183]
    s_waitcnt lgkmcnt(9)
    ds_read_b64_tr_b16 a[198:199], v4 offset:17664
    v_fma_mix_f32 v35, v115, v27, v31 op_sel:[1,0,0] op_sel_hi:[1,0,0]
    v_mfma_f32_16x16x32_bf16 v[152:155], a[240:243], v[96:99], v[152:155]
    ds_read_b64_tr_b16 a[200:201], v4 offset:288
    v_cvt_pk_bf16_f32 v114, v32, v33
    v_mfma_f32_16x16x32_bf16 v[152:155], a[244:247], v[100:103], v[152:155]
    ds_read_b64_tr_b16 a[202:203], v4 offset:800
    v_cvt_pk_bf16_f32 v115, v34, v35
    v_mfma_f32_16x16x32_bf16 v[184:187], a[240:243], v[104:107], v[184:187]
    ds_read_b64_tr_b16 a[204:205], v4 offset:17184
    v_fma_mix_f32 v36, v122, v24, v28 op_sel:[0,0,0] op_sel_hi:[1,0,0]
    v_mfma_f32_16x16x32_bf16 v[184:187], a[244:247], v[108:111], v[184:187]
    s_waitcnt lgkmcnt(8)
    ds_read_b64_tr_b16 a[206:207], v4 offset:17696
    v_fma_mix_f32 v37, v122, v25, v29 op_sel:[1,0,0] op_sel_hi:[1,0,0]
    v_mfma_f32_16x16x32_bf16 v[156:159], a[248:251], v[96:99], v[156:159]
    ds_read_b64_tr_b16 a[208:209], v4 offset:320
    v_fma_mix_f32 v38, v123, v26, v30 op_sel:[0,0,0] op_sel_hi:[1,0,0]
    v_mfma_f32_16x16x32_bf16 v[156:159], a[252:255], v[100:103], v[156:159]
    ds_read_b64_tr_b16 a[210:211], v4 offset:832
    v_fma_mix_f32 v39, v123, v27, v31 op_sel:[1,0,0] op_sel_hi:[1,0,0]
    v_mfma_f32_16x16x32_bf16 v[188:191], a[248:251], v[104:107], v[188:191]
    ds_read_b64_tr_b16 a[212:213], v4 offset:17216
    v_cvt_pk_bf16_f32 v122, v36, v37
    v_mfma_f32_16x16x32_bf16 v[188:191], a[252:255], v[108:111], v[188:191]
    s_waitcnt lgkmcnt(7)
    ds_read_b64_tr_b16 a[214:215], v4 offset:17728
    v_cvt_pk_bf16_f32 v123, v38, v39
    v_mfma_f32_16x16x32_bf16 v[192:195], a[192:195], v[96:99], v[192:195]
    ds_read_b64_tr_b16 a[216:217], v4 offset:352
    ds_read_b128 v[24:27], v9 offset:10512
    v_mfma_f32_16x16x32_bf16 v[192:195], a[196:199], v[100:103], v[192:195]
    ds_read_b64_tr_b16 a[218:219], v4 offset:864
    ds_read_b64_tr_b16 a[220:221], v4 offset:17248
    v_fma_mix_f32 v32, v116, v16, v20 op_sel:[0,0,0] op_sel_hi:[1,0,0]
    v_mfma_f32_16x16x32_bf16 v[224:227], a[192:195], v[104:107], v[224:227]
    s_mov_b32 s54, 8192
    ds_read_b64_tr_b16 a[222:223], v4 offset:17760
    ds_read_b128 v[28:31], v9 offset:10544
    v_mfma_f32_16x16x32_bf16 v[224:227], a[196:199], v[108:111], v[224:227]
    s_waitcnt lgkmcnt(10)
    buffer_load_dwordx4 v[64:67], v8, s[32:35], s54 offen sc1
    v_mfma_f32_16x16x32_bf16 v[196:199], a[200:203], v[96:99], v[196:199]
    ds_read_b64_tr_b16 a[224:225], v4 offset:384
    v_fma_mix_f32 v33, v116, v17, v21 op_sel:[1,0,0] op_sel_hi:[1,0,0]
    v_mfma_f32_16x16x32_bf16 v[196:199], a[204:207], v[100:103], v[196:199]
    ds_read_b64_tr_b16 a[226:227], v4 offset:896
    ds_read_b64_tr_b16 a[228:229], v4 offset:17280
    v_fma_mix_f32 v34, v117, v18, v22 op_sel:[0,0,0] op_sel_hi:[1,0,0]
    v_mfma_f32_16x16x32_bf16 v[228:231], a[200:203], v[104:107], v[228:231]
    s_mov_b32 s54, 9216
    ds_read_b64_tr_b16 a[230:231], v4 offset:17792
    v_fma_mix_f32 v35, v117, v19, v23 op_sel:[1,0,0] op_sel_hi:[1,0,0]
    v_mfma_f32_16x16x32_bf16 v[228:231], a[204:207], v[108:111], v[228:231]
    s_waitcnt lgkmcnt(10)
    buffer_load_dwordx4 v[68:71], v8, s[32:35], s54 offen sc1
    v_mfma_f32_16x16x32_bf16 v[200:203], a[208:211], v[96:99], v[200:203]
    ds_read_b64_tr_b16 a[232:233], v4 offset:416
    v_cvt_pk_bf16_f32 v116, v32, v33
    v_mfma_f32_16x16x32_bf16 v[200:203], a[212:215], v[100:103], v[200:203]
    ds_read_b64_tr_b16 a[234:235], v4 offset:928
    ds_read_b64_tr_b16 a[236:237], v4 offset:17312
    v_cvt_pk_bf16_f32 v117, v34, v35
    v_mfma_f32_16x16x32_bf16 v[232:235], a[208:211], v[104:107], v[232:235]
    s_mov_b32 s54, 26624
    ds_read_b64_tr_b16 a[238:239], v4 offset:17824
    v_fma_mix_f32 v36, v124, v16, v20 op_sel:[0,0,0] op_sel_hi:[1,0,0]
    v_mfma_f32_16x16x32_bf16 v[232:235], a[212:215], v[108:111], v[232:235]
    s_waitcnt lgkmcnt(9)
    buffer_load_dwordx4 v[72:75], v8, s[32:35], s54 offen sc1
    v_fma_mix_f32 v37, v124, v17, v21 op_sel:[1,0,0] op_sel_hi:[1,0,0]
    v_mfma_f32_16x16x32_bf16 v[204:207], a[216:219], v[96:99], v[204:207]
    ds_read_b64_tr_b16 a[240:241], v4 offset:448
    v_fma_mix_f32 v38, v125, v18, v22 op_sel:[0,0,0] op_sel_hi:[1,0,0]
    v_mfma_f32_16x16x32_bf16 v[204:207], a[220:223], v[100:103], v[204:207]
    ds_read_b64_tr_b16 a[242:243], v4 offset:960
    ds_read_b64_tr_b16 a[244:245], v4 offset:17344
    v_fma_mix_f32 v39, v125, v19, v23 op_sel:[1,0,0] op_sel_hi:[1,0,0]
    v_mfma_f32_16x16x32_bf16 v[236:239], a[216:219], v[104:107], v[236:239]
    s_mov_b32 s54, 27648
    ds_read_b64_tr_b16 a[246:247], v4 offset:17856
    v_cvt_pk_bf16_f32 v124, v36, v37
    v_mfma_f32_16x16x32_bf16 v[236:239], a[220:223], v[108:111], v[236:239]
    s_waitcnt lgkmcnt(8)
    buffer_load_dwordx4 v[76:79], v8, s[32:35], s54 offen sc1
    v_cvt_pk_bf16_f32 v125, v38, v39
    v_mfma_f32_16x16x32_bf16 v[208:211], a[224:227], v[96:99], v[208:211]
    ds_read_b64_tr_b16 a[248:249], v4 offset:480
    ds_read_b128 v[16:19], v9 offset:10752
    v_mfma_f32_16x16x32_bf16 v[208:211], a[228:231], v[100:103], v[208:211]
    ds_read_b64_tr_b16 a[250:251], v4 offset:992
    ds_read_b128 v[20:23], v9 offset:10784
    v_mfma_f32_16x16x32_bf16 v[240:243], a[224:227], v[104:107], v[240:243]
    ds_read_b64_tr_b16 a[252:253], v4 offset:17376
    v_fma_mix_f32 v32, v118, v24, v28 op_sel:[0,0,0] op_sel_hi:[1,0,0]
    v_mfma_f32_16x16x32_bf16 v[240:243], a[228:231], v[108:111], v[240:243]
    s_waitcnt vmcnt(16)
    s_barrier
    s_waitcnt lgkmcnt(9)
    ds_read_b64_tr_b16 a[254:255], v4 offset:17888
    v_fma_mix_f32 v33, v118, v25, v29 op_sel:[1,0,0] op_sel_hi:[1,0,0]
    v_fma_mix_f32 v34, v119, v26, v30 op_sel:[0,0,0] op_sel_hi:[1,0,0]
    v_mfma_f32_16x16x32_bf16 v[212:215], a[232:235], v[96:99], v[212:215]
    ds_read_b64_tr_b16 a[192:193], v4 offset:36864
    v_fma_mix_f32 v35, v119, v27, v31 op_sel:[1,0,0] op_sel_hi:[1,0,0]
    v_mfma_f32_16x16x32_bf16 v[212:215], a[236:239], v[100:103], v[212:215]
    ds_read_b64_tr_b16 a[194:195], v4 offset:37376
    ds_read_b64_tr_b16 a[196:197], v4 offset:53760
    v_cvt_pk_bf16_f32 v118, v32, v33
    v_mfma_f32_16x16x32_bf16 v[244:247], a[232:235], v[104:107], v[244:247]
    s_add_u32 m0, s44, 36864
    ds_read_b64_tr_b16 a[198:199], v4 offset:54272
    v_cvt_pk_bf16_f32 v119, v34, v35
    v_mfma_f32_16x16x32_bf16 v[244:247], a[236:239], v[108:111], v[244:247]
    s_mov_b32 s45, 2097152
    s_waitcnt lgkmcnt(10)
    buffer_load_dwordx4 v6, s[24:27], s45 offen lds
    v_mfma_f32_16x16x32_bf16 v[216:219], a[240:243], v[96:99], v[216:219]
    ds_read_b64_tr_b16 a[200:201], v4 offset:36896
    v_fma_mix_f32 v36, v126, v24, v28 op_sel:[0,0,0] op_sel_hi:[1,0,0]
    v_mfma_f32_16x16x32_bf16 v[216:219], a[244:247], v[100:103], v[216:219]
    ds_read_b64_tr_b16 a[202:203], v4 offset:37408
    ds_read_b64_tr_b16 a[204:205], v4 offset:53792
    v_fma_mix_f32 v37, v126, v25, v29 op_sel:[1,0,0] op_sel_hi:[1,0,0]
    v_mfma_f32_16x16x32_bf16 v[248:251], a[240:243], v[104:107], v[248:251]
    s_add_u32 m0, s44, 37920
    ds_read_b64_tr_b16 a[206:207], v4 offset:54304
    v_fma_mix_f32 v38, v127, v26, v30 op_sel:[0,0,0] op_sel_hi:[1,0,0]
    v_mfma_f32_16x16x32_bf16 v[248:251], a[244:247], v[108:111], v[248:251]
    s_mov_b32 s45, 2105344
    s_waitcnt lgkmcnt(8)
    buffer_load_dwordx4 v6, s[24:27], s45 offen lds
    v_mfma_f32_16x16x32_bf16 v[220:223], a[248:251], v[96:99], v[220:223]
    ds_read_b64_tr_b16 a[208:209], v4 offset:36928
    v_fma_mix_f32 v39, v127, v27, v31 op_sel:[1,0,0] op_sel_hi:[1,0,0]
    v_mfma_f32_16x16x32_bf16 v[220:223], a[252:255], v[100:103], v[220:223]
    ds_read_b64_tr_b16 a[210:211], v4 offset:37440
    ds_read_b64_tr_b16 a[212:213], v4 offset:53824
    v_cvt_pk_bf16_f32 v126, v36, v37
    v_mfma_f32_16x16x32_bf16 v[252:255], a[248:251], v[104:107], v[252:255]
    s_add_u32 m0, s44, 38976
    ds_read_b64_tr_b16 a[214:215], v4 offset:54336
    v_cvt_pk_bf16_f32 v127, v38, v39
    v_mfma_f32_16x16x32_bf16 v[252:255], a[252:255], v[108:111], v[252:255]
    s_mov_b32 s45, 2113536
    s_waitcnt lgkmcnt(8)
    buffer_load_dwordx4 v6, s[24:27], s45 offen lds
    v_mfma_f32_16x16x32_bf16 v[128:131], a[192:195], v[112:115], v[128:131]
    s_waitcnt vmcnt(15)
    ds_read_b64_tr_b16 a[216:217], v4 offset:36960
    ds_read_b128 v[24:27], v9 offset:10768
    v_mfma_f32_16x16x32_bf16 v[128:131], a[196:199], v[116:119], v[128:131]
    ds_read_b64_tr_b16 a[218:219], v4 offset:37472
    ds_read_b64_tr_b16 a[220:221], v4 offset:53856
    v_fma_mix_f32 v32, v48, v16, v20 op_sel:[0,0,0] op_sel_hi:[1,0,0]
    v_mfma_f32_16x16x32_bf16 v[160:163], a[192:195], v[120:123], v[160:163]
    s_add_u32 m0, s44, 40032
    ds_read_b64_tr_b16 a[222:223], v4 offset:54368
    ds_read_b128 v[28:31], v9 offset:10800
    v_mfma_f32_16x16x32_bf16 v[160:163], a[196:199], v[124:127], v[160:163]
    s_mov_b32 s45, 2121728
    s_waitcnt lgkmcnt(10)
    buffer_load_dwordx4 v6, s[24:27], s45 offen lds
    v_mfma_f32_16x16x32_bf16 v[132:135], a[200:203], v[112:115], v[132:135]
    ds_read_b64_tr_b16 a[224:225], v4 offset:36992
    v_fma_mix_f32 v33, v48, v17, v21 op_sel:[1,0,0] op_sel_hi:[1,0,0]
    v_mfma_f32_16x16x32_bf16 v[132:135], a[204:207], v[116:119], v[132:135]
    ds_read_b64_tr_b16 a[226:227], v4 offset:37504
    ds_read_b64_tr_b16 a[228:229], v4 offset:53888
    v_fma_mix_f32 v34, v49, v18, v22 op_sel:[0,0,0] op_sel_hi:[1,0,0]
    v_mfma_f32_16x16x32_bf16 v[164:167], a[200:203], v[120:123], v[164:167]
    s_add_u32 m0, s44, 53760
    ds_read_b64_tr_b16 a[230:231], v4 offset:54400
    v_fma_mix_f32 v35, v49, v19, v23 op_sel:[1,0,0] op_sel_hi:[1,0,0]
    v_mfma_f32_16x16x32_bf16 v[164:167], a[204:207], v[124:127], v[164:167]
    s_mov_b32 s45, 2359296
    s_waitcnt lgkmcnt(10)
    buffer_load_dwordx4 v6, s[24:27], s45 offen lds
    v_mfma_f32_16x16x32_bf16 v[136:139], a[208:211], v[112:115], v[136:139]
    ds_read_b64_tr_b16 a[232:233], v4 offset:37024
    v_cvt_pk_bf16_f32 v48, v32, v33
    v_mfma_f32_16x16x32_bf16 v[136:139], a[212:215], v[116:119], v[136:139]
    ds_read_b64_tr_b16 a[234:235], v4 offset:37536
    ds_read_b64_tr_b16 a[236:237], v4 offset:53920
    v_cvt_pk_bf16_f32 v49, v34, v35
    v_mfma_f32_16x16x32_bf16 v[168:171], a[208:211], v[120:123], v[168:171]
    s_add_u32 m0, s44, 54816
    ds_read_b64_tr_b16 a[238:239], v4 offset:54432
    v_fma_mix_f32 v36, v56, v16, v20 op_sel:[0,0,0] op_sel_hi:[1,0,0]
    v_mfma_f32_16x16x32_bf16 v[168:171], a[212:215], v[124:127], v[168:171]
    s_mov_b32 s45, 2367488
    s_waitcnt lgkmcnt(9)
    buffer_load_dwordx4 v6, s[24:27], s45 offen lds
    v_fma_mix_f32 v37, v56, v17, v21 op_sel:[1,0,0] op_sel_hi:[1,0,0]
    v_mfma_f32_16x16x32_bf16 v[140:143], a[216:219], v[112:115], v[140:143]
    ds_read_b64_tr_b16 a[240:241], v4 offset:37056
    v_fma_mix_f32 v38, v57, v18, v22 op_sel:[0,0,0] op_sel_hi:[1,0,0]
    v_mfma_f32_16x16x32_bf16 v[140:143], a[220:223], v[116:119], v[140:143]
    ds_read_b64_tr_b16 a[242:243], v4 offset:37568
    ds_read_b64_tr_b16 a[244:245], v4 offset:53952
    v_fma_mix_f32 v39, v57, v19, v23 op_sel:[1,0,0] op_sel_hi:[1,0,0]
    v_mfma_f32_16x16x32_bf16 v[172:175], a[216:219], v[120:123], v[172:175]
    s_add_u32 m0, s44, 55872
    ds_read_b64_tr_b16 a[246:247], v4 offset:54464
    v_cvt_pk_bf16_f32 v56, v36, v37
    v_mfma_f32_16x16x32_bf16 v[172:175], a[220:223], v[124:127], v[172:175]
    s_mov_b32 s45, 2375680
    s_waitcnt lgkmcnt(8)
    buffer_load_dwordx4 v6, s[24:27], s45 offen lds
    v_cvt_pk_bf16_f32 v57, v38, v39
    v_mfma_f32_16x16x32_bf16 v[144:147], a[224:227], v[112:115], v[144:147]
    ds_read_b64_tr_b16 a[248:249], v4 offset:37088
    ds_read_b128 v[16:19], v9 offset:11008
    v_mfma_f32_16x16x32_bf16 v[144:147], a[228:231], v[116:119], v[144:147]
    ds_read_b64_tr_b16 a[250:251], v4 offset:37600
    ds_read_b64_tr_b16 a[252:253], v4 offset:53984
    v_mfma_f32_16x16x32_bf16 v[176:179], a[224:227], v[120:123], v[176:179]
    s_add_u32 m0, s44, 56928
    ds_read_b64_tr_b16 a[254:255], v4 offset:54496
    ds_read_b128 v[20:23], v9 offset:11040
    v_mfma_f32_16x16x32_bf16 v[176:179], a[228:231], v[124:127], v[176:179]
    s_mov_b32 s45, 2383872
    s_waitcnt lgkmcnt(10)
    buffer_load_dwordx4 v6, s[24:27], s45 offen lds
    v_mfma_f32_16x16x32_bf16 v[148:151], a[232:235], v[112:115], v[148:151]
    ds_read_b64_tr_b16 a[192:193], v4 offset:37120
    v_fma_mix_f32 v32, v50, v24, v28 op_sel:[0,0,0] op_sel_hi:[1,0,0]
    v_mfma_f32_16x16x32_bf16 v[148:151], a[236:239], v[116:119], v[148:151]
    ds_read_b64_tr_b16 a[194:195], v4 offset:37632
    v_fma_mix_f32 v33, v50, v25, v29 op_sel:[1,0,0] op_sel_hi:[1,0,0]
    v_mfma_f32_16x16x32_bf16 v[180:183], a[232:235], v[120:123], v[180:183]
    ds_read_b64_tr_b16 a[196:197], v4 offset:54016
    v_fma_mix_f32 v34, v51, v26, v30 op_sel:[0,0,0] op_sel_hi:[1,0,0]
    v_mfma_f32_16x16x32_bf16 v[180:183], a[236:239], v[124:127], v[180:183]
    s_waitcnt lgkmcnt(9)
    ds_read_b64_tr_b16 a[198:199], v4 offset:54528
    v_fma_mix_f32 v35, v51, v27, v31 op_sel:[1,0,0] op_sel_hi:[1,0,0]
    v_mfma_f32_16x16x32_bf16 v[152:155], a[240:243], v[112:115], v[152:155]
    ds_read_b64_tr_b16 a[200:201], v4 offset:37152
    v_cvt_pk_bf16_f32 v50, v32, v33
    v_mfma_f32_16x16x32_bf16 v[152:155], a[244:247], v[116:119], v[152:155]
    ds_read_b64_tr_b16 a[202:203], v4 offset:37664
    v_cvt_pk_bf16_f32 v51, v34, v35
    v_mfma_f32_16x16x32_bf16 v[184:187], a[240:243], v[120:123], v[184:187]
    ds_read_b64_tr_b16 a[204:205], v4 offset:54048
    v_fma_mix_f32 v36, v58, v24, v28 op_sel:[0,0,0] op_sel_hi:[1,0,0]
    v_mfma_f32_16x16x32_bf16 v[184:187], a[244:247], v[124:127], v[184:187]
    s_waitcnt lgkmcnt(8)
    ds_read_b64_tr_b16 a[206:207], v4 offset:54560
    v_fma_mix_f32 v37, v58, v25, v29 op_sel:[1,0,0] op_sel_hi:[1,0,0]
    v_mfma_f32_16x16x32_bf16 v[156:159], a[248:251], v[112:115], v[156:159]
    ds_read_b64_tr_b16 a[208:209], v4 offset:37184
    v_fma_mix_f32 v38, v59, v26, v30 op_sel:[0,0,0] op_sel_hi:[1,0,0]
    v_mfma_f32_16x16x32_bf16 v[156:159], a[252:255], v[116:119], v[156:159]
    ds_read_b64_tr_b16 a[210:211], v4 offset:37696
    v_fma_mix_f32 v39, v59, v27, v31 op_sel:[1,0,0] op_sel_hi:[1,0,0]
    v_mfma_f32_16x16x32_bf16 v[188:191], a[248:251], v[120:123], v[188:191]
    ds_read_b64_tr_b16 a[212:213], v4 offset:54080
    v_cvt_pk_bf16_f32 v58, v36, v37
    v_mfma_f32_16x16x32_bf16 v[188:191], a[252:255], v[124:127], v[188:191]
    s_waitcnt lgkmcnt(7)
    ds_read_b64_tr_b16 a[214:215], v4 offset:54592
    v_cvt_pk_bf16_f32 v59, v38, v39
    v_mfma_f32_16x16x32_bf16 v[192:195], a[192:195], v[112:115], v[192:195]
    ds_read_b64_tr_b16 a[216:217], v4 offset:37216
    ds_read_b128 v[24:27], v9 offset:11024
    v_mfma_f32_16x16x32_bf16 v[192:195], a[196:199], v[116:119], v[192:195]
    ds_read_b64_tr_b16 a[218:219], v4 offset:37728
    ds_read_b64_tr_b16 a[220:221], v4 offset:54112
    v_fma_mix_f32 v32, v52, v16, v20 op_sel:[0,0,0] op_sel_hi:[1,0,0]
    v_mfma_f32_16x16x32_bf16 v[224:227], a[192:195], v[120:123], v[224:227]
    s_mov_b32 s54, 10240
    ds_read_b64_tr_b16 a[222:223], v4 offset:54624
    ds_read_b128 v[28:31], v9 offset:11056
    v_mfma_f32_16x16x32_bf16 v[224:227], a[196:199], v[124:127], v[224:227]
    s_waitcnt lgkmcnt(10)
    buffer_load_dwordx4 v[80:83], v8, s[32:35], s54 offen sc1
    v_mfma_f32_16x16x32_bf16 v[196:199], a[200:203], v[112:115], v[196:199]
    ds_read_b64_tr_b16 a[224:225], v4 offset:37248
    v_fma_mix_f32 v33, v52, v17, v21 op_sel:[1,0,0] op_sel_hi:[1,0,0]
    v_mfma_f32_16x16x32_bf16 v[196:199], a[204:207], v[116:119], v[196:199]
    ds_read_b64_tr_b16 a[226:227], v4 offset:37760
    ds_read_b64_tr_b16 a[228:229], v4 offset:54144
    v_fma_mix_f32 v34, v53, v18, v22 op_sel:[0,0,0] op_sel_hi:[1,0,0]
    v_mfma_f32_16x16x32_bf16 v[228:231], a[200:203], v[120:123], v[228:231]
    s_mov_b32 s54, 11264
    ds_read_b64_tr_b16 a[230:231], v4 offset:54656
    v_fma_mix_f32 v35, v53, v19, v23 op_sel:[1,0,0] op_sel_hi:[1,0,0]
    v_mfma_f32_16x16x32_bf16 v[228:231], a[204:207], v[124:127], v[228:231]
    s_waitcnt lgkmcnt(10)
    buffer_load_dwordx4 v[84:87], v8, s[32:35], s54 offen sc1
    v_mfma_f32_16x16x32_bf16 v[200:203], a[208:211], v[112:115], v[200:203]
    ds_read_b64_tr_b16 a[232:233], v4 offset:37280
    v_cvt_pk_bf16_f32 v52, v32, v33
    v_mfma_f32_16x16x32_bf16 v[200:203], a[212:215], v[116:119], v[200:203]
    ds_read_b64_tr_b16 a[234:235], v4 offset:37792
    ds_read_b64_tr_b16 a[236:237], v4 offset:54176
    v_cvt_pk_bf16_f32 v53, v34, v35
    v_mfma_f32_16x16x32_bf16 v[232:235], a[208:211], v[120:123], v[232:235]
    s_mov_b32 s54, 28672
    ds_read_b64_tr_b16 a[238:239], v4 offset:54688
    v_fma_mix_f32 v36, v60, v16, v20 op_sel:[0,0,0] op_sel_hi:[1,0,0]
    v_mfma_f32_16x16x32_bf16 v[232:235], a[212:215], v[124:127], v[232:235]
    s_waitcnt lgkmcnt(9)
    buffer_load_dwordx4 v[88:91], v8, s[32:35], s54 offen sc1
    v_fma_mix_f32 v37, v60, v17, v21 op_sel:[1,0,0] op_sel_hi:[1,0,0]
    v_mfma_f32_16x16x32_bf16 v[204:207], a[216:219], v[112:115], v[204:207]
    ds_read_b64_tr_b16 a[240:241], v4 offset:37312
    v_fma_mix_f32 v38, v61, v18, v22 op_sel:[0,0,0] op_sel_hi:[1,0,0]
    v_mfma_f32_16x16x32_bf16 v[204:207], a[220:223], v[116:119], v[204:207]
    ds_read_b64_tr_b16 a[242:243], v4 offset:37824
    ds_read_b64_tr_b16 a[244:245], v4 offset:54208
    v_fma_mix_f32 v39, v61, v19, v23 op_sel:[1,0,0] op_sel_hi:[1,0,0]
    v_mfma_f32_16x16x32_bf16 v[236:239], a[216:219], v[120:123], v[236:239]
    s_mov_b32 s54, 29696
    ds_read_b64_tr_b16 a[246:247], v4 offset:54720
    v_cvt_pk_bf16_f32 v60, v36, v37
    v_mfma_f32_16x16x32_bf16 v[236:239], a[220:223], v[124:127], v[236:239]
    s_waitcnt lgkmcnt(8)
    buffer_load_dwordx4 v[92:95], v8, s[32:35], s54 offen sc1
    v_cvt_pk_bf16_f32 v61, v38, v39
    v_mfma_f32_16x16x32_bf16 v[208:211], a[224:227], v[112:115], v[208:211]
    ds_read_b64_tr_b16 a[248:249], v4 offset:37344
    ds_read_b128 v[16:19], v9 offset:11264
    v_mfma_f32_16x16x32_bf16 v[208:211], a[228:231], v[116:119], v[208:211]
    ds_read_b64_tr_b16 a[250:251], v4 offset:37856
    ds_read_b128 v[20:23], v9 offset:11296
    v_mfma_f32_16x16x32_bf16 v[240:243], a[224:227], v[120:123], v[240:243]
    ds_read_b64_tr_b16 a[252:253], v4 offset:54240
    v_fma_mix_f32 v32, v54, v24, v28 op_sel:[0,0,0] op_sel_hi:[1,0,0]
    v_mfma_f32_16x16x32_bf16 v[240:243], a[228:231], v[124:127], v[240:243]
    s_waitcnt vmcnt(16)
    s_barrier
    s_waitcnt lgkmcnt(9)
    ds_read_b64_tr_b16 a[254:255], v4 offset:54752
    v_fma_mix_f32 v33, v54, v25, v29 op_sel:[1,0,0] op_sel_hi:[1,0,0]
    v_fma_mix_f32 v34, v55, v26, v30 op_sel:[0,0,0] op_sel_hi:[1,0,0]
    v_mfma_f32_16x16x32_bf16 v[212:215], a[232:235], v[112:115], v[212:215]
    ds_read_b64_tr_b16 a[192:193], v3 offset:0
    v_fma_mix_f32 v35, v55, v27, v31 op_sel:[1,0,0] op_sel_hi:[1,0,0]
    v_mfma_f32_16x16x32_bf16 v[212:215], a[236:239], v[116:119], v[212:215]
    ds_read_b64_tr_b16 a[194:195], v3 offset:512
    ds_read_b64_tr_b16 a[196:197], v3 offset:16896
    v_cvt_pk_bf16_f32 v54, v32, v33
    v_mfma_f32_16x16x32_bf16 v[244:247], a[232:235], v[120:123], v[244:247]
    s_add_u32 m0, s44, 73728
    ds_read_b64_tr_b16 a[198:199], v3 offset:17408
    v_cvt_pk_bf16_f32 v55, v34, v35
    v_mfma_f32_16x16x32_bf16 v[244:247], a[236:239], v[124:127], v[244:247]
    s_mov_b32 s45, 2621440
    s_waitcnt lgkmcnt(10)
    buffer_load_dwordx4 v6, s[24:27], s45 offen lds
    v_mfma_f32_16x16x32_bf16 v[216:219], a[240:243], v[112:115], v[216:219]
    ds_read_b64_tr_b16 a[200:201], v3 offset:32
    v_fma_mix_f32 v36, v62, v24, v28 op_sel:[0,0,0] op_sel_hi:[1,0,0]
    v_mfma_f32_16x16x32_bf16 v[216:219], a[244:247], v[116:119], v[216:219]
    ds_read_b64_tr_b16 a[202:203], v3 offset:544
    ds_read_b64_tr_b16 a[204:205], v3 offset:16928
    v_fma_mix_f32 v37, v62, v25, v29 op_sel:[1,0,0] op_sel_hi:[1,0,0]
    v_mfma_f32_16x16x32_bf16 v[248:251], a[240:243], v[120:123], v[248:251]
    s_add_u32 m0, s44, 74784
    ds_read_b64_tr_b16 a[206:207], v3 offset:17440
    v_fma_mix_f32 v38, v63, v26, v30 op_sel:[0,0,0] op_sel_hi:[1,0,0]
    v_mfma_f32_16x16x32_bf16 v[248:251], a[244:247], v[124:127], v[248:251]
    s_mov_b32 s45, 2629632
    s_waitcnt lgkmcnt(8)
    buffer_load_dwordx4 v6, s[24:27], s45 offen lds
    v_mfma_f32_16x16x32_bf16 v[220:223], a[248:251], v[112:115], v[220:223]
    ds_read_b64_tr_b16 a[208:209], v3 offset:64
    v_fma_mix_f32 v39, v63, v27, v31 op_sel:[1,0,0] op_sel_hi:[1,0,0]
    v_mfma_f32_16x16x32_bf16 v[220:223], a[252:255], v[116:119], v[220:223]
    ds_read_b64_tr_b16 a[210:211], v3 offset:576
    ds_read_b64_tr_b16 a[212:213], v3 offset:16960
    v_cvt_pk_bf16_f32 v62, v36, v37
    v_mfma_f32_16x16x32_bf16 v[252:255], a[248:251], v[120:123], v[252:255]
    s_add_u32 m0, s44, 75840
    ds_read_b64_tr_b16 a[214:215], v3 offset:17472
    v_cvt_pk_bf16_f32 v63, v38, v39
    v_mfma_f32_16x16x32_bf16 v[252:255], a[252:255], v[124:127], v[252:255]
    s_mov_b32 s45, 2637824
    s_waitcnt lgkmcnt(8)
    buffer_load_dwordx4 v6, s[24:27], s45 offen lds
    v_mfma_f32_16x16x32_bf16 v[128:131], a[192:195], v[48:51], v[128:131]
    s_waitcnt vmcnt(15)
    ds_read_b64_tr_b16 a[216:217], v3 offset:96
    ds_read_b128 v[24:27], v9 offset:11280
    v_mfma_f32_16x16x32_bf16 v[128:131], a[196:199], v[52:55], v[128:131]
    ds_read_b64_tr_b16 a[218:219], v3 offset:608
    ds_read_b64_tr_b16 a[220:221], v3 offset:16992
    v_fma_mix_f32 v32, v64, v16, v20 op_sel:[0,0,0] op_sel_hi:[1,0,0]
    v_mfma_f32_16x16x32_bf16 v[160:163], a[192:195], v[56:59], v[160:163]
    s_add_u32 m0, s44, 76896
    ds_read_b64_tr_b16 a[222:223], v3 offset:17504
    ds_read_b128 v[28:31], v9 offset:11312
    v_mfma_f32_16x16x32_bf16 v[160:163], a[196:199], v[60:63], v[160:163]
    s_mov_b32 s45, 2646016
    s_waitcnt lgkmcnt(10)
    buffer_load_dwordx4 v6, s[24:27], s45 offen lds
    v_mfma_f32_16x16x32_bf16 v[132:135], a[200:203], v[48:51], v[132:135]
    ds_read_b64_tr_b16 a[224:225], v3 offset:128
    v_fma_mix_f32 v33, v64, v17, v21 op_sel:[1,0,0] op_sel_hi:[1,0,0]
    v_mfma_f32_16x16x32_bf16 v[132:135], a[204:207], v[52:55], v[132:135]
    ds_read_b64_tr_b16 a[226:227], v3 offset:640
    ds_read_b64_tr_b16 a[228:229], v3 offset:17024
    v_fma_mix_f32 v34, v65, v18, v22 op_sel:[0,0,0] op_sel_hi:[1,0,0]
    v_mfma_f32_16x16x32_bf16 v[164:167], a[200:203], v[56:59], v[164:167]
    s_add_u32 m0, s44, 90624
    ds_read_b64_tr_b16 a[230:231], v3 offset:17536
    v_fma_mix_f32 v35, v65, v19, v23 op_sel:[1,0,0] op_sel_hi:[1,0,0]
    v_mfma_f32_16x16x32_bf16 v[164:167], a[204:207], v[60:63], v[164:167]
    s_mov_b32 s45, 2883584
    s_waitcnt lgkmcnt(10)
    buffer_load_dwordx4 v6, s[24:27], s45 offen lds
    v_mfma_f32_16x16x32_bf16 v[136:139], a[208:211], v[48:51], v[136:139]
    ds_read_b64_tr_b16 a[232:233], v3 offset:160
    v_cvt_pk_bf16_f32 v64, v32, v33
    v_mfma_f32_16x16x32_bf16 v[136:139], a[212:215], v[52:55], v[136:139]
    ds_read_b64_tr_b16 a[234:235], v3 offset:672
    ds_read_b64_tr_b16 a[236:237], v3 offset:17056
    v_cvt_pk_bf16_f32 v65, v34, v35
    v_mfma_f32_16x16x32_bf16 v[168:171], a[208:211], v[56:59], v[168:171]
    s_add_u32 m0, s44, 91680
    ds_read_b64_tr_b16 a[238:239], v3 offset:17568
    v_fma_mix_f32 v36, v72, v16, v20 op_sel:[0,0,0] op_sel_hi:[1,0,0]
    v_mfma_f32_16x16x32_bf16 v[168:171], a[212:215], v[60:63], v[168:171]
    s_mov_b32 s45, 2891776
    s_waitcnt lgkmcnt(9)
    buffer_load_dwordx4 v6, s[24:27], s45 offen lds
    v_fma_mix_f32 v37, v72, v17, v21 op_sel:[1,0,0] op_sel_hi:[1,0,0]
    v_mfma_f32_16x16x32_bf16 v[140:143], a[216:219], v[48:51], v[140:143]
    ds_read_b64_tr_b16 a[240:241], v3 offset:192
    v_fma_mix_f32 v38, v73, v18, v22 op_sel:[0,0,0] op_sel_hi:[1,0,0]
    v_mfma_f32_16x16x32_bf16 v[140:143], a[220:223], v[52:55], v[140:143]
    ds_read_b64_tr_b16 a[242:243], v3 offset:704
    ds_read_b64_tr_b16 a[244:245], v3 offset:17088
    v_fma_mix_f32 v39, v73, v19, v23 op_sel:[1,0,0] op_sel_hi:[1,0,0]
    v_mfma_f32_16x16x32_bf16 v[172:175], a[216:219], v[56:59], v[172:175]
    s_add_u32 m0, s44, 92736
    ds_read_b64_tr_b16 a[246:247], v3 offset:17600
    v_cvt_pk_bf16_f32 v72, v36, v37
    v_mfma_f32_16x16x32_bf16 v[172:175], a[220:223], v[60:63], v[172:175]
    s_mov_b32 s45, 2899968
    s_waitcnt lgkmcnt(8)
    buffer_load_dwordx4 v6, s[24:27], s45 offen lds
    v_cvt_pk_bf16_f32 v73, v38, v39
    v_mfma_f32_16x16x32_bf16 v[144:147], a[224:227], v[48:51], v[144:147]
    ds_read_b64_tr_b16 a[248:249], v3 offset:224
    ds_read_b128 v[16:19], v9 offset:11520
    v_mfma_f32_16x16x32_bf16 v[144:147], a[228:231], v[52:55], v[144:147]
    ds_read_b64_tr_b16 a[250:251], v3 offset:736
    ds_read_b64_tr_b16 a[252:253], v3 offset:17120
    v_mfma_f32_16x16x32_bf16 v[176:179], a[224:227], v[56:59], v[176:179]
    s_add_u32 m0, s44, 93792
    ds_read_b64_tr_b16 a[254:255], v3 offset:17632
    ds_read_b128 v[20:23], v9 offset:11552
    v_mfma_f32_16x16x32_bf16 v[176:179], a[228:231], v[60:63], v[176:179]
    s_mov_b32 s45, 2908160
    s_waitcnt lgkmcnt(10)
    buffer_load_dwordx4 v6, s[24:27], s45 offen lds
    v_mfma_f32_16x16x32_bf16 v[148:151], a[232:235], v[48:51], v[148:151]
    ds_read_b64_tr_b16 a[192:193], v3 offset:256
    v_fma_mix_f32 v32, v66, v24, v28 op_sel:[0,0,0] op_sel_hi:[1,0,0]
    v_mfma_f32_16x16x32_bf16 v[148:151], a[236:239], v[52:55], v[148:151]
    ds_read_b64_tr_b16 a[194:195], v3 offset:768
    v_fma_mix_f32 v33, v66, v25, v29 op_sel:[1,0,0] op_sel_hi:[1,0,0]
    v_mfma_f32_16x16x32_bf16 v[180:183], a[232:235], v[56:59], v[180:183]
    ds_read_b64_tr_b16 a[196:197], v3 offset:17152
    v_fma_mix_f32 v34, v67, v26, v30 op_sel:[0,0,0] op_sel_hi:[1,0,0]
    v_mfma_f32_16x16x32_bf16 v[180:183], a[236:239], v[60:63], v[180:183]
    s_waitcnt lgkmcnt(9)
    ds_read_b64_tr_b16 a[198:199], v3 offset:17664
    v_fma_mix_f32 v35, v67, v27, v31 op_sel:[1,0,0] op_sel_hi:[1,0,0]
    v_mfma_f32_16x16x32_bf16 v[152:155], a[240:243], v[48:51], v[152:155]
    ds_read_b64_tr_b16 a[200:201], v3 offset:288
    v_cvt_pk_bf16_f32 v66, v32, v33
    v_mfma_f32_16x16x32_bf16 v[152:155], a[244:247], v[52:55], v[152:155]
    ds_read_b64_tr_b16 a[202:203], v3 offset:800
    v_cvt_pk_bf16_f32 v67, v34, v35
    v_mfma_f32_16x16x32_bf16 v[184:187], a[240:243], v[56:59], v[184:187]
    ds_read_b64_tr_b16 a[204:205], v3 offset:17184
    v_fma_mix_f32 v36, v74, v24, v28 op_sel:[0,0,0] op_sel_hi:[1,0,0]
    v_mfma_f32_16x16x32_bf16 v[184:187], a[244:247], v[60:63], v[184:187]
    s_waitcnt lgkmcnt(8)
    ds_read_b64_tr_b16 a[206:207], v3 offset:17696
    v_fma_mix_f32 v37, v74, v25, v29 op_sel:[1,0,0] op_sel_hi:[1,0,0]
    v_mfma_f32_16x16x32_bf16 v[156:159], a[248:251], v[48:51], v[156:159]
    ds_read_b64_tr_b16 a[208:209], v3 offset:320
    v_fma_mix_f32 v38, v75, v26, v30 op_sel:[0,0,0] op_sel_hi:[1,0,0]
    v_mfma_f32_16x16x32_bf16 v[156:159], a[252:255], v[52:55], v[156:159]
    ds_read_b64_tr_b16 a[210:211], v3 offset:832
    v_fma_mix_f32 v39, v75, v27, v31 op_sel:[1,0,0] op_sel_hi:[1,0,0]
    v_mfma_f32_16x16x32_bf16 v[188:191], a[248:251], v[56:59], v[188:191]
    ds_read_b64_tr_b16 a[212:213], v3 offset:17216
    v_cvt_pk_bf16_f32 v74, v36, v37
    v_mfma_f32_16x16x32_bf16 v[188:191], a[252:255], v[60:63], v[188:191]
    s_waitcnt lgkmcnt(7)
    ds_read_b64_tr_b16 a[214:215], v3 offset:17728
    v_cvt_pk_bf16_f32 v75, v38, v39
    v_mfma_f32_16x16x32_bf16 v[192:195], a[192:195], v[48:51], v[192:195]
    ds_read_b64_tr_b16 a[216:217], v3 offset:352
    ds_read_b128 v[24:27], v9 offset:11536
    v_mfma_f32_16x16x32_bf16 v[192:195], a[196:199], v[52:55], v[192:195]
    ds_read_b64_tr_b16 a[218:219], v3 offset:864
    ds_read_b64_tr_b16 a[220:221], v3 offset:17248
    v_fma_mix_f32 v32, v68, v16, v20 op_sel:[0,0,0] op_sel_hi:[1,0,0]
    v_mfma_f32_16x16x32_bf16 v[224:227], a[192:195], v[56:59], v[224:227]
    s_mov_b32 s54, 12288
    ds_read_b64_tr_b16 a[222:223], v3 offset:17760
    ds_read_b128 v[28:31], v9 offset:11568
    v_mfma_f32_16x16x32_bf16 v[224:227], a[196:199], v[60:63], v[224:227]
    s_waitcnt lgkmcnt(10)
    buffer_load_dwordx4 v[96:99], v8, s[32:35], s54 offen sc1
    v_mfma_f32_16x16x32_bf16 v[196:199], a[200:203], v[48:51], v[196:199]
    ds_read_b64_tr_b16 a[224:225], v3 offset:384
    v_fma_mix_f32 v33, v68, v17, v21 op_sel:[1,0,0] op_sel_hi:[1,0,0]
    v_mfma_f32_16x16x32_bf16 v[196:199], a[204:207], v[52:55], v[196:199]
    ds_read_b64_tr_b16 a[226:227], v3 offset:896
    ds_read_b64_tr_b16 a[228:229], v3 offset:17280
    v_fma_mix_f32 v34, v69, v18, v22 op_sel:[0,0,0] op_sel_hi:[1,0,0]
    v_mfma_f32_16x16x32_bf16 v[228:231], a[200:203], v[56:59], v[228:231]
    s_mov_b32 s54, 13312
    ds_read_b64_tr_b16 a[230:231], v3 offset:17792
    v_fma_mix_f32 v35, v69, v19, v23 op_sel:[1,0,0] op_sel_hi:[1,0,0]
    v_mfma_f32_16x16x32_bf16 v[228:231], a[204:207], v[60:63], v[228:231]
    s_waitcnt lgkmcnt(10)
    buffer_load_dwordx4 v[100:103], v8, s[32:35], s54 offen sc1
    v_mfma_f32_16x16x32_bf16 v[200:203], a[208:211], v[48:51], v[200:203]
    ds_read_b64_tr_b16 a[232:233], v3 offset:416
    v_cvt_pk_bf16_f32 v68, v32, v33
    v_mfma_f32_16x16x32_bf16 v[200:203], a[212:215], v[52:55], v[200:203]
    ds_read_b64_tr_b16 a[234:235], v3 offset:928
    ds_read_b64_tr_b16 a[236:237], v3 offset:17312
    v_cvt_pk_bf16_f32 v69, v34, v35
    v_mfma_f32_16x16x32_bf16 v[232:235], a[208:211], v[56:59], v[232:235]
    s_mov_b32 s54, 30720
    ds_read_b64_tr_b16 a[238:239], v3 offset:17824
    v_fma_mix_f32 v36, v76, v16, v20 op_sel:[0,0,0] op_sel_hi:[1,0,0]
    v_mfma_f32_16x16x32_bf16 v[232:235], a[212:215], v[60:63], v[232:235]
    s_waitcnt lgkmcnt(9)
    buffer_load_dwordx4 v[104:107], v8, s[32:35], s54 offen sc1
    v_fma_mix_f32 v37, v76, v17, v21 op_sel:[1,0,0] op_sel_hi:[1,0,0]
    v_mfma_f32_16x16x32_bf16 v[204:207], a[216:219], v[48:51], v[204:207]
    ds_read_b64_tr_b16 a[240:241], v3 offset:448
    v_fma_mix_f32 v38, v77, v18, v22 op_sel:[0,0,0] op_sel_hi:[1,0,0]
    v_mfma_f32_16x16x32_bf16 v[204:207], a[220:223], v[52:55], v[204:207]
    ds_read_b64_tr_b16 a[242:243], v3 offset:960
    ds_read_b64_tr_b16 a[244:245], v3 offset:17344
    v_fma_mix_f32 v39, v77, v19, v23 op_sel:[1,0,0] op_sel_hi:[1,0,0]
    v_mfma_f32_16x16x32_bf16 v[236:239], a[216:219], v[56:59], v[236:239]
    s_mov_b32 s54, 31744
    ds_read_b64_tr_b16 a[246:247], v3 offset:17856
    v_cvt_pk_bf16_f32 v76, v36, v37
    v_mfma_f32_16x16x32_bf16 v[236:239], a[220:223], v[60:63], v[236:239]
    s_waitcnt lgkmcnt(8)
    buffer_load_dwordx4 v[108:111], v8, s[32:35], s54 offen sc1
    v_cvt_pk_bf16_f32 v77, v38, v39
    v_mfma_f32_16x16x32_bf16 v[208:211], a[224:227], v[48:51], v[208:211]
    ds_read_b64_tr_b16 a[248:249], v3 offset:480
    ds_read_b128 v[16:19], v9 offset:11776
    v_mfma_f32_16x16x32_bf16 v[208:211], a[228:231], v[52:55], v[208:211]
    ds_read_b64_tr_b16 a[250:251], v3 offset:992
    ds_read_b128 v[20:23], v9 offset:11808
    v_mfma_f32_16x16x32_bf16 v[240:243], a[224:227], v[56:59], v[240:243]
    ds_read_b64_tr_b16 a[252:253], v3 offset:17376
    v_fma_mix_f32 v32, v70, v24, v28 op_sel:[0,0,0] op_sel_hi:[1,0,0]
    v_mfma_f32_16x16x32_bf16 v[240:243], a[228:231], v[60:63], v[240:243]
    s_waitcnt vmcnt(16)
    s_barrier
    s_waitcnt lgkmcnt(9)
    ds_read_b64_tr_b16 a[254:255], v3 offset:17888
    v_fma_mix_f32 v33, v70, v25, v29 op_sel:[1,0,0] op_sel_hi:[1,0,0]
    v_fma_mix_f32 v34, v71, v26, v30 op_sel:[0,0,0] op_sel_hi:[1,0,0]
    v_mfma_f32_16x16x32_bf16 v[212:215], a[232:235], v[48:51], v[212:215]
    ds_read_b64_tr_b16 a[192:193], v3 offset:36864
    v_fma_mix_f32 v35, v71, v27, v31 op_sel:[1,0,0] op_sel_hi:[1,0,0]
    v_mfma_f32_16x16x32_bf16 v[212:215], a[236:239], v[52:55], v[212:215]
    ds_read_b64_tr_b16 a[194:195], v3 offset:37376
    ds_read_b64_tr_b16 a[196:197], v3 offset:53760
    v_cvt_pk_bf16_f32 v70, v32, v33
    v_mfma_f32_16x16x32_bf16 v[244:247], a[232:235], v[56:59], v[244:247]
    s_add_u32 m0, s44, 110592
    ds_read_b64_tr_b16 a[198:199], v3 offset:54272
    v_cvt_pk_bf16_f32 v71, v34, v35
    v_mfma_f32_16x16x32_bf16 v[244:247], a[236:239], v[60:63], v[244:247]
    s_mov_b32 s45, 3145728
    s_waitcnt lgkmcnt(10)
    buffer_load_dwordx4 v6, s[24:27], s45 offen lds
    v_mfma_f32_16x16x32_bf16 v[216:219], a[240:243], v[48:51], v[216:219]
    ds_read_b64_tr_b16 a[200:201], v3 offset:36896
    v_fma_mix_f32 v36, v78, v24, v28 op_sel:[0,0,0] op_sel_hi:[1,0,0]
    v_mfma_f32_16x16x32_bf16 v[216:219], a[244:247], v[52:55], v[216:219]
    ds_read_b64_tr_b16 a[202:203], v3 offset:37408
    ds_read_b64_tr_b16 a[204:205], v3 offset:53792
    v_fma_mix_f32 v37, v78, v25, v29 op_sel:[1,0,0] op_sel_hi:[1,0,0]
    v_mfma_f32_16x16x32_bf16 v[248:251], a[240:243], v[56:59], v[248:251]
    s_add_u32 m0, s44, 111648
    ds_read_b64_tr_b16 a[206:207], v3 offset:54304
    v_fma_mix_f32 v38, v79, v26, v30 op_sel:[0,0,0] op_sel_hi:[1,0,0]
    v_mfma_f32_16x16x32_bf16 v[248:251], a[244:247], v[60:63], v[248:251]
    s_mov_b32 s45, 3153920
    s_waitcnt lgkmcnt(8)
    buffer_load_dwordx4 v6, s[24:27], s45 offen lds
    v_mfma_f32_16x16x32_bf16 v[220:223], a[248:251], v[48:51], v[220:223]
    ds_read_b64_tr_b16 a[208:209], v3 offset:36928
    v_fma_mix_f32 v39, v79, v27, v31 op_sel:[1,0,0] op_sel_hi:[1,0,0]
    v_mfma_f32_16x16x32_bf16 v[220:223], a[252:255], v[52:55], v[220:223]
    ds_read_b64_tr_b16 a[210:211], v3 offset:37440
    ds_read_b64_tr_b16 a[212:213], v3 offset:53824
    v_cvt_pk_bf16_f32 v78, v36, v37
    v_mfma_f32_16x16x32_bf16 v[252:255], a[248:251], v[56:59], v[252:255]
    s_add_u32 m0, s44, 112704
    ds_read_b64_tr_b16 a[214:215], v3 offset:54336
    v_cvt_pk_bf16_f32 v79, v38, v39
    v_mfma_f32_16x16x32_bf16 v[252:255], a[252:255], v[60:63], v[252:255]
    s_mov_b32 s45, 3162112
    s_waitcnt lgkmcnt(8)
    buffer_load_dwordx4 v6, s[24:27], s45 offen lds
    v_mfma_f32_16x16x32_bf16 v[128:131], a[192:195], v[64:67], v[128:131]
    s_waitcnt vmcnt(15)
    ds_read_b64_tr_b16 a[216:217], v3 offset:36960
    ds_read_b128 v[24:27], v9 offset:11792
    v_mfma_f32_16x16x32_bf16 v[128:131], a[196:199], v[68:71], v[128:131]
    ds_read_b64_tr_b16 a[218:219], v3 offset:37472
    ds_read_b64_tr_b16 a[220:221], v3 offset:53856
    v_fma_mix_f32 v32, v80, v16, v20 op_sel:[0,0,0] op_sel_hi:[1,0,0]
    v_mfma_f32_16x16x32_bf16 v[160:163], a[192:195], v[72:75], v[160:163]
    s_add_u32 m0, s44, 113760
    ds_read_b64_tr_b16 a[222:223], v3 offset:54368
    ds_read_b128 v[28:31], v9 offset:11824
    v_mfma_f32_16x16x32_bf16 v[160:163], a[196:199], v[76:79], v[160:163]
    s_mov_b32 s45, 3170304
    s_waitcnt lgkmcnt(10)
    buffer_load_dwordx4 v6, s[24:27], s45 offen lds
    v_mfma_f32_16x16x32_bf16 v[132:135], a[200:203], v[64:67], v[132:135]
    ds_read_b64_tr_b16 a[224:225], v3 offset:36992
    v_fma_mix_f32 v33, v80, v17, v21 op_sel:[1,0,0] op_sel_hi:[1,0,0]
    v_mfma_f32_16x16x32_bf16 v[132:135], a[204:207], v[68:71], v[132:135]
    ds_read_b64_tr_b16 a[226:227], v3 offset:37504
    ds_read_b64_tr_b16 a[228:229], v3 offset:53888
    v_fma_mix_f32 v34, v81, v18, v22 op_sel:[0,0,0] op_sel_hi:[1,0,0]
    v_mfma_f32_16x16x32_bf16 v[164:167], a[200:203], v[72:75], v[164:167]
    s_add_u32 m0, s44, 127488
    ds_read_b64_tr_b16 a[230:231], v3 offset:54400
    v_fma_mix_f32 v35, v81, v19, v23 op_sel:[1,0,0] op_sel_hi:[1,0,0]
    v_mfma_f32_16x16x32_bf16 v[164:167], a[204:207], v[76:79], v[164:167]
    s_mov_b32 s45, 3407872
    s_waitcnt lgkmcnt(10)
    buffer_load_dwordx4 v6, s[24:27], s45 offen lds
    v_mfma_f32_16x16x32_bf16 v[136:139], a[208:211], v[64:67], v[136:139]
    ds_read_b64_tr_b16 a[232:233], v3 offset:37024
    v_cvt_pk_bf16_f32 v80, v32, v33
    v_mfma_f32_16x16x32_bf16 v[136:139], a[212:215], v[68:71], v[136:139]
    ds_read_b64_tr_b16 a[234:235], v3 offset:37536
    ds_read_b64_tr_b16 a[236:237], v3 offset:53920
    v_cvt_pk_bf16_f32 v81, v34, v35
    v_mfma_f32_16x16x32_bf16 v[168:171], a[208:211], v[72:75], v[168:171]
    s_add_u32 m0, s44, 128544
    ds_read_b64_tr_b16 a[238:239], v3 offset:54432
    v_fma_mix_f32 v36, v88, v16, v20 op_sel:[0,0,0] op_sel_hi:[1,0,0]
    v_mfma_f32_16x16x32_bf16 v[168:171], a[212:215], v[76:79], v[168:171]
    s_mov_b32 s45, 3416064
    s_waitcnt lgkmcnt(9)
    buffer_load_dwordx4 v6, s[24:27], s45 offen lds
    v_fma_mix_f32 v37, v88, v17, v21 op_sel:[1,0,0] op_sel_hi:[1,0,0]
    v_mfma_f32_16x16x32_bf16 v[140:143], a[216:219], v[64:67], v[140:143]
    ds_read_b64_tr_b16 a[240:241], v3 offset:37056
    v_fma_mix_f32 v38, v89, v18, v22 op_sel:[0,0,0] op_sel_hi:[1,0,0]
    v_mfma_f32_16x16x32_bf16 v[140:143], a[220:223], v[68:71], v[140:143]
    ds_read_b64_tr_b16 a[242:243], v3 offset:37568
    ds_read_b64_tr_b16 a[244:245], v3 offset:53952
    v_fma_mix_f32 v39, v89, v19, v23 op_sel:[1,0,0] op_sel_hi:[1,0,0]
    v_mfma_f32_16x16x32_bf16 v[172:175], a[216:219], v[72:75], v[172:175]
    s_add_u32 m0, s44, 129600
    ds_read_b64_tr_b16 a[246:247], v3 offset:54464
    v_cvt_pk_bf16_f32 v88, v36, v37
    v_mfma_f32_16x16x32_bf16 v[172:175], a[220:223], v[76:79], v[172:175]
    s_mov_b32 s45, 3424256
    s_waitcnt lgkmcnt(8)
    buffer_load_dwordx4 v6, s[24:27], s45 offen lds
    v_cvt_pk_bf16_f32 v89, v38, v39
    v_mfma_f32_16x16x32_bf16 v[144:147], a[224:227], v[64:67], v[144:147]
    ds_read_b64_tr_b16 a[248:249], v3 offset:37088
    ds_read_b128 v[16:19], v9 offset:12032
    v_mfma_f32_16x16x32_bf16 v[144:147], a[228:231], v[68:71], v[144:147]
    ds_read_b64_tr_b16 a[250:251], v3 offset:37600
    ds_read_b64_tr_b16 a[252:253], v3 offset:53984
    v_mfma_f32_16x16x32_bf16 v[176:179], a[224:227], v[72:75], v[176:179]
    s_add_u32 m0, s44, 130656
    ds_read_b64_tr_b16 a[254:255], v3 offset:54496
    ds_read_b128 v[20:23], v9 offset:12064
    v_mfma_f32_16x16x32_bf16 v[176:179], a[228:231], v[76:79], v[176:179]
    s_mov_b32 s45, 3432448
    s_waitcnt lgkmcnt(10)
    buffer_load_dwordx4 v6, s[24:27], s45 offen lds
    v_mfma_f32_16x16x32_bf16 v[148:151], a[232:235], v[64:67], v[148:151]
    ds_read_b64_tr_b16 a[192:193], v3 offset:37120
    v_fma_mix_f32 v32, v82, v24, v28 op_sel:[0,0,0] op_sel_hi:[1,0,0]
    v_mfma_f32_16x16x32_bf16 v[148:151], a[236:239], v[68:71], v[148:151]
    ds_read_b64_tr_b16 a[194:195], v3 offset:37632
    v_fma_mix_f32 v33, v82, v25, v29 op_sel:[1,0,0] op_sel_hi:[1,0,0]
    v_mfma_f32_16x16x32_bf16 v[180:183], a[232:235], v[72:75], v[180:183]
    ds_read_b64_tr_b16 a[196:197], v3 offset:54016
    v_fma_mix_f32 v34, v83, v26, v30 op_sel:[0,0,0] op_sel_hi:[1,0,0]
    v_mfma_f32_16x16x32_bf16 v[180:183], a[236:239], v[76:79], v[180:183]
    s_waitcnt lgkmcnt(9)
    ds_read_b64_tr_b16 a[198:199], v3 offset:54528
    v_fma_mix_f32 v35, v83, v27, v31 op_sel:[1,0,0] op_sel_hi:[1,0,0]
    v_mfma_f32_16x16x32_bf16 v[152:155], a[240:243], v[64:67], v[152:155]
    ds_read_b64_tr_b16 a[200:201], v3 offset:37152
    v_cvt_pk_bf16_f32 v82, v32, v33
    v_mfma_f32_16x16x32_bf16 v[152:155], a[244:247], v[68:71], v[152:155]
    ds_read_b64_tr_b16 a[202:203], v3 offset:37664
    v_cvt_pk_bf16_f32 v83, v34, v35
    v_mfma_f32_16x16x32_bf16 v[184:187], a[240:243], v[72:75], v[184:187]
    ds_read_b64_tr_b16 a[204:205], v3 offset:54048
    v_fma_mix_f32 v36, v90, v24, v28 op_sel:[0,0,0] op_sel_hi:[1,0,0]
    v_mfma_f32_16x16x32_bf16 v[184:187], a[244:247], v[76:79], v[184:187]
    s_waitcnt lgkmcnt(8)
    ds_read_b64_tr_b16 a[206:207], v3 offset:54560
    v_fma_mix_f32 v37, v90, v25, v29 op_sel:[1,0,0] op_sel_hi:[1,0,0]
    v_mfma_f32_16x16x32_bf16 v[156:159], a[248:251], v[64:67], v[156:159]
    ds_read_b64_tr_b16 a[208:209], v3 offset:37184
    v_fma_mix_f32 v38, v91, v26, v30 op_sel:[0,0,0] op_sel_hi:[1,0,0]
    v_mfma_f32_16x16x32_bf16 v[156:159], a[252:255], v[68:71], v[156:159]
    ds_read_b64_tr_b16 a[210:211], v3 offset:37696
    v_fma_mix_f32 v39, v91, v27, v31 op_sel:[1,0,0] op_sel_hi:[1,0,0]
    v_mfma_f32_16x16x32_bf16 v[188:191], a[248:251], v[72:75], v[188:191]
    ds_read_b64_tr_b16 a[212:213], v3 offset:54080
    v_cvt_pk_bf16_f32 v90, v36, v37
    v_mfma_f32_16x16x32_bf16 v[188:191], a[252:255], v[76:79], v[188:191]
    s_waitcnt lgkmcnt(7)
    ds_read_b64_tr_b16 a[214:215], v3 offset:54592
    v_cvt_pk_bf16_f32 v91, v38, v39
    v_mfma_f32_16x16x32_bf16 v[192:195], a[192:195], v[64:67], v[192:195]
    ds_read_b64_tr_b16 a[216:217], v3 offset:37216
    ds_read_b128 v[24:27], v9 offset:12048
    v_mfma_f32_16x16x32_bf16 v[192:195], a[196:199], v[68:71], v[192:195]
    ds_read_b64_tr_b16 a[218:219], v3 offset:37728
    ds_read_b64_tr_b16 a[220:221], v3 offset:54112
    v_fma_mix_f32 v32, v84, v16, v20 op_sel:[0,0,0] op_sel_hi:[1,0,0]
    v_mfma_f32_16x16x32_bf16 v[224:227], a[192:195], v[72:75], v[224:227]
    s_mov_b32 s54, 14336
    ds_read_b64_tr_b16 a[222:223], v3 offset:54624
    ds_read_b128 v[28:31], v9 offset:12080
    v_mfma_f32_16x16x32_bf16 v[224:227], a[196:199], v[76:79], v[224:227]
    s_waitcnt lgkmcnt(10)
    buffer_load_dwordx4 v[112:115], v8, s[32:35], s54 offen sc1
    v_mfma_f32_16x16x32_bf16 v[196:199], a[200:203], v[64:67], v[196:199]
    ds_read_b64_tr_b16 a[224:225], v3 offset:37248
    v_fma_mix_f32 v33, v84, v17, v21 op_sel:[1,0,0] op_sel_hi:[1,0,0]
    v_mfma_f32_16x16x32_bf16 v[196:199], a[204:207], v[68:71], v[196:199]
    ds_read_b64_tr_b16 a[226:227], v3 offset:37760
    ds_read_b64_tr_b16 a[228:229], v3 offset:54144
    v_fma_mix_f32 v34, v85, v18, v22 op_sel:[0,0,0] op_sel_hi:[1,0,0]
    v_mfma_f32_16x16x32_bf16 v[228:231], a[200:203], v[72:75], v[228:231]
    s_mov_b32 s54, 15360
    ds_read_b64_tr_b16 a[230:231], v3 offset:54656
    v_fma_mix_f32 v35, v85, v19, v23 op_sel:[1,0,0] op_sel_hi:[1,0,0]
    v_mfma_f32_16x16x32_bf16 v[228:231], a[204:207], v[76:79], v[228:231]
    s_waitcnt lgkmcnt(10)
    buffer_load_dwordx4 v[116:119], v8, s[32:35], s54 offen sc1
    v_mfma_f32_16x16x32_bf16 v[200:203], a[208:211], v[64:67], v[200:203]
    ds_read_b64_tr_b16 a[232:233], v3 offset:37280
    v_cvt_pk_bf16_f32 v84, v32, v33
    v_mfma_f32_16x16x32_bf16 v[200:203], a[212:215], v[68:71], v[200:203]
    ds_read_b64_tr_b16 a[234:235], v3 offset:37792
    ds_read_b64_tr_b16 a[236:237], v3 offset:54176
    v_cvt_pk_bf16_f32 v85, v34, v35
    v_mfma_f32_16x16x32_bf16 v[232:235], a[208:211], v[72:75], v[232:235]
    s_mov_b32 s54, 32768
    ds_read_b64_tr_b16 a[238:239], v3 offset:54688
    v_fma_mix_f32 v36, v92, v16, v20 op_sel:[0,0,0] op_sel_hi:[1,0,0]
    v_mfma_f32_16x16x32_bf16 v[232:235], a[212:215], v[76:79], v[232:235]
    s_waitcnt lgkmcnt(9)
    buffer_load_dwordx4 v[120:123], v8, s[32:35], s54 offen sc1
    v_fma_mix_f32 v37, v92, v17, v21 op_sel:[1,0,0] op_sel_hi:[1,0,0]
    v_mfma_f32_16x16x32_bf16 v[204:207], a[216:219], v[64:67], v[204:207]
    ds_read_b64_tr_b16 a[240:241], v3 offset:37312
    v_fma_mix_f32 v38, v93, v18, v22 op_sel:[0,0,0] op_sel_hi:[1,0,0]
    v_mfma_f32_16x16x32_bf16 v[204:207], a[220:223], v[68:71], v[204:207]
    ds_read_b64_tr_b16 a[242:243], v3 offset:37824
    ds_read_b64_tr_b16 a[244:245], v3 offset:54208
    v_fma_mix_f32 v39, v93, v19, v23 op_sel:[1,0,0] op_sel_hi:[1,0,0]
    v_mfma_f32_16x16x32_bf16 v[236:239], a[216:219], v[72:75], v[236:239]
    s_mov_b32 s54, 33792
    ds_read_b64_tr_b16 a[246:247], v3 offset:54720
    v_cvt_pk_bf16_f32 v92, v36, v37
    v_mfma_f32_16x16x32_bf16 v[236:239], a[220:223], v[76:79], v[236:239]
    s_waitcnt lgkmcnt(8)
    buffer_load_dwordx4 v[124:127], v8, s[32:35], s54 offen sc1
    v_cvt_pk_bf16_f32 v93, v38, v39
    v_mfma_f32_16x16x32_bf16 v[208:211], a[224:227], v[64:67], v[208:211]
    ds_read_b64_tr_b16 a[248:249], v3 offset:37344
    ds_read_b128 v[16:19], v9 offset:12288
    v_mfma_f32_16x16x32_bf16 v[208:211], a[228:231], v[68:71], v[208:211]
    ds_read_b64_tr_b16 a[250:251], v3 offset:37856
    ds_read_b128 v[20:23], v9 offset:12320
    v_mfma_f32_16x16x32_bf16 v[240:243], a[224:227], v[72:75], v[240:243]
    ds_read_b64_tr_b16 a[252:253], v3 offset:54240
    v_fma_mix_f32 v32, v86, v24, v28 op_sel:[0,0,0] op_sel_hi:[1,0,0]
    v_mfma_f32_16x16x32_bf16 v[240:243], a[228:231], v[76:79], v[240:243]
    s_waitcnt vmcnt(16)
    s_barrier
    s_waitcnt lgkmcnt(9)
    ds_read_b64_tr_b16 a[254:255], v3 offset:54752
    v_fma_mix_f32 v33, v86, v25, v29 op_sel:[1,0,0] op_sel_hi:[1,0,0]
    v_fma_mix_f32 v34, v87, v26, v30 op_sel:[0,0,0] op_sel_hi:[1,0,0]
    v_mfma_f32_16x16x32_bf16 v[212:215], a[232:235], v[64:67], v[212:215]
    ds_read_b64_tr_b16 a[192:193], v4 offset:0
    v_fma_mix_f32 v35, v87, v27, v31 op_sel:[1,0,0] op_sel_hi:[1,0,0]
    v_mfma_f32_16x16x32_bf16 v[212:215], a[236:239], v[68:71], v[212:215]
    ds_read_b64_tr_b16 a[194:195], v4 offset:512
    ds_read_b64_tr_b16 a[196:197], v4 offset:16896
    v_cvt_pk_bf16_f32 v86, v32, v33
    v_mfma_f32_16x16x32_bf16 v[244:247], a[232:235], v[72:75], v[244:247]
    s_add_u32 m0, s44, 0
    ds_read_b64_tr_b16 a[198:199], v4 offset:17408
    v_cvt_pk_bf16_f32 v87, v34, v35
    v_mfma_f32_16x16x32_bf16 v[244:247], a[236:239], v[76:79], v[244:247]
    s_mov_b32 s45, 3670016
    s_waitcnt lgkmcnt(10)
    buffer_load_dwordx4 v6, s[24:27], s45 offen lds
    v_mfma_f32_16x16x32_bf16 v[216:219], a[240:243], v[64:67], v[216:219]
    ds_read_b64_tr_b16 a[200:201], v4 offset:32
    v_fma_mix_f32 v36, v94, v24, v28 op_sel:[0,0,0] op_sel_hi:[1,0,0]
    v_mfma_f32_16x16x32_bf16 v[216:219], a[244:247], v[68:71], v[216:219]
    ds_read_b64_tr_b16 a[202:203], v4 offset:544
    ds_read_b64_tr_b16 a[204:205], v4 offset:16928
    v_fma_mix_f32 v37, v94, v25, v29 op_sel:[1,0,0] op_sel_hi:[1,0,0]
    v_mfma_f32_16x16x32_bf16 v[248:251], a[240:243], v[72:75], v[248:251]
    s_add_u32 m0, s44, 1056
    ds_read_b64_tr_b16 a[206:207], v4 offset:17440
    v_fma_mix_f32 v38, v95, v26, v30 op_sel:[0,0,0] op_sel_hi:[1,0,0]
    v_mfma_f32_16x16x32_bf16 v[248:251], a[244:247], v[76:79], v[248:251]
    s_mov_b32 s45, 3678208
    s_waitcnt lgkmcnt(8)
    buffer_load_dwordx4 v6, s[24:27], s45 offen lds
    v_mfma_f32_16x16x32_bf16 v[220:223], a[248:251], v[64:67], v[220:223]
    ds_read_b64_tr_b16 a[208:209], v4 offset:64
    v_fma_mix_f32 v39, v95, v27, v31 op_sel:[1,0,0] op_sel_hi:[1,0,0]
    v_mfma_f32_16x16x32_bf16 v[220:223], a[252:255], v[68:71], v[220:223]
    ds_read_b64_tr_b16 a[210:211], v4 offset:576
    ds_read_b64_tr_b16 a[212:213], v4 offset:16960
    v_cvt_pk_bf16_f32 v94, v36, v37
    v_mfma_f32_16x16x32_bf16 v[252:255], a[248:251], v[72:75], v[252:255]
    s_add_u32 m0, s44, 2112
    ds_read_b64_tr_b16 a[214:215], v4 offset:17472
    v_cvt_pk_bf16_f32 v95, v38, v39
    v_mfma_f32_16x16x32_bf16 v[252:255], a[252:255], v[76:79], v[252:255]
    s_mov_b32 s45, 3686400
    s_waitcnt lgkmcnt(8)
    buffer_load_dwordx4 v6, s[24:27], s45 offen lds
    v_mfma_f32_16x16x32_bf16 v[128:131], a[192:195], v[80:83], v[128:131]
    s_waitcnt vmcnt(15)
    ds_read_b64_tr_b16 a[216:217], v4 offset:96
    ds_read_b128 v[24:27], v9 offset:12304
    v_mfma_f32_16x16x32_bf16 v[128:131], a[196:199], v[84:87], v[128:131]
    ds_read_b64_tr_b16 a[218:219], v4 offset:608
    ds_read_b64_tr_b16 a[220:221], v4 offset:16992
    v_fma_mix_f32 v32, v96, v16, v20 op_sel:[0,0,0] op_sel_hi:[1,0,0]
    v_mfma_f32_16x16x32_bf16 v[160:163], a[192:195], v[88:91], v[160:163]
    s_add_u32 m0, s44, 3168
    ds_read_b64_tr_b16 a[222:223], v4 offset:17504
    ds_read_b128 v[28:31], v9 offset:12336
    v_mfma_f32_16x16x32_bf16 v[160:163], a[196:199], v[92:95], v[160:163]
    s_mov_b32 s45, 3694592
    s_waitcnt lgkmcnt(10)
    buffer_load_dwordx4 v6, s[24:27], s45 offen lds
    v_mfma_f32_16x16x32_bf16 v[132:135], a[200:203], v[80:83], v[132:135]
    ds_read_b64_tr_b16 a[224:225], v4 offset:128
    v_fma_mix_f32 v33, v96, v17, v21 op_sel:[1,0,0] op_sel_hi:[1,0,0]
    v_mfma_f32_16x16x32_bf16 v[132:135], a[204:207], v[84:87], v[132:135]
    ds_read_b64_tr_b16 a[226:227], v4 offset:640
    ds_read_b64_tr_b16 a[228:229], v4 offset:17024
    v_fma_mix_f32 v34, v97, v18, v22 op_sel:[0,0,0] op_sel_hi:[1,0,0]
    v_mfma_f32_16x16x32_bf16 v[164:167], a[200:203], v[88:91], v[164:167]
    s_add_u32 m0, s44, 16896
    ds_read_b64_tr_b16 a[230:231], v4 offset:17536
    v_fma_mix_f32 v35, v97, v19, v23 op_sel:[1,0,0] op_sel_hi:[1,0,0]
    v_mfma_f32_16x16x32_bf16 v[164:167], a[204:207], v[92:95], v[164:167]
    s_mov_b32 s45, 3932160
    s_waitcnt lgkmcnt(10)
    buffer_load_dwordx4 v6, s[24:27], s45 offen lds
    v_mfma_f32_16x16x32_bf16 v[136:139], a[208:211], v[80:83], v[136:139]
    ds_read_b64_tr_b16 a[232:233], v4 offset:160
    v_cvt_pk_bf16_f32 v96, v32, v33
    v_mfma_f32_16x16x32_bf16 v[136:139], a[212:215], v[84:87], v[136:139]
    ds_read_b64_tr_b16 a[234:235], v4 offset:672
    ds_read_b64_tr_b16 a[236:237], v4 offset:17056
    v_cvt_pk_bf16_f32 v97, v34, v35
    v_mfma_f32_16x16x32_bf16 v[168:171], a[208:211], v[88:91], v[168:171]
    s_add_u32 m0, s44, 17952
    ds_read_b64_tr_b16 a[238:239], v4 offset:17568
    v_fma_mix_f32 v36, v104, v16, v20 op_sel:[0,0,0] op_sel_hi:[1,0,0]
    v_mfma_f32_16x16x32_bf16 v[168:171], a[212:215], v[92:95], v[168:171]
    s_mov_b32 s45, 3940352
    s_waitcnt lgkmcnt(9)
    buffer_load_dwordx4 v6, s[24:27], s45 offen lds
    v_fma_mix_f32 v37, v104, v17, v21 op_sel:[1,0,0] op_sel_hi:[1,0,0]
    v_mfma_f32_16x16x32_bf16 v[140:143], a[216:219], v[80:83], v[140:143]
    ds_read_b64_tr_b16 a[240:241], v4 offset:192
    v_fma_mix_f32 v38, v105, v18, v22 op_sel:[0,0,0] op_sel_hi:[1,0,0]
    v_mfma_f32_16x16x32_bf16 v[140:143], a[220:223], v[84:87], v[140:143]
    ds_read_b64_tr_b16 a[242:243], v4 offset:704
    ds_read_b64_tr_b16 a[244:245], v4 offset:17088
    v_fma_mix_f32 v39, v105, v19, v23 op_sel:[1,0,0] op_sel_hi:[1,0,0]
    v_mfma_f32_16x16x32_bf16 v[172:175], a[216:219], v[88:91], v[172:175]
    s_add_u32 m0, s44, 19008
    ds_read_b64_tr_b16 a[246:247], v4 offset:17600
    v_cvt_pk_bf16_f32 v104, v36, v37
    v_mfma_f32_16x16x32_bf16 v[172:175], a[220:223], v[92:95], v[172:175]
    s_mov_b32 s45, 3948544
    s_waitcnt lgkmcnt(8)
    buffer_load_dwordx4 v6, s[24:27], s45 offen lds
    v_cvt_pk_bf16_f32 v105, v38, v39
    v_mfma_f32_16x16x32_bf16 v[144:147], a[224:227], v[80:83], v[144:147]
    ds_read_b64_tr_b16 a[248:249], v4 offset:224
    ds_read_b128 v[16:19], v9 offset:12544
    v_mfma_f32_16x16x32_bf16 v[144:147], a[228:231], v[84:87], v[144:147]
    ds_read_b64_tr_b16 a[250:251], v4 offset:736
    ds_read_b64_tr_b16 a[252:253], v4 offset:17120
    v_mfma_f32_16x16x32_bf16 v[176:179], a[224:227], v[88:91], v[176:179]
    s_add_u32 m0, s44, 20064
    ds_read_b64_tr_b16 a[254:255], v4 offset:17632
    ds_read_b128 v[20:23], v9 offset:12576
    v_mfma_f32_16x16x32_bf16 v[176:179], a[228:231], v[92:95], v[176:179]
    s_mov_b32 s45, 3956736
    s_waitcnt lgkmcnt(10)
    buffer_load_dwordx4 v6, s[24:27], s45 offen lds
    v_mfma_f32_16x16x32_bf16 v[148:151], a[232:235], v[80:83], v[148:151]
    ds_read_b64_tr_b16 a[192:193], v4 offset:256
    v_fma_mix_f32 v32, v98, v24, v28 op_sel:[0,0,0] op_sel_hi:[1,0,0]
    v_mfma_f32_16x16x32_bf16 v[148:151], a[236:239], v[84:87], v[148:151]
    ds_read_b64_tr_b16 a[194:195], v4 offset:768
    v_fma_mix_f32 v33, v98, v25, v29 op_sel:[1,0,0] op_sel_hi:[1,0,0]
    v_mfma_f32_16x16x32_bf16 v[180:183], a[232:235], v[88:91], v[180:183]
    ds_read_b64_tr_b16 a[196:197], v4 offset:17152
    v_fma_mix_f32 v34, v99, v26, v30 op_sel:[0,0,0] op_sel_hi:[1,0,0]
    v_mfma_f32_16x16x32_bf16 v[180:183], a[236:239], v[92:95], v[180:183]
    s_waitcnt lgkmcnt(9)
    ds_read_b64_tr_b16 a[198:199], v4 offset:17664
    v_fma_mix_f32 v35, v99, v27, v31 op_sel:[1,0,0] op_sel_hi:[1,0,0]
    v_mfma_f32_16x16x32_bf16 v[152:155], a[240:243], v[80:83], v[152:155]
    ds_read_b64_tr_b16 a[200:201], v4 offset:288
    v_cvt_pk_bf16_f32 v98, v32, v33
    v_mfma_f32_16x16x32_bf16 v[152:155], a[244:247], v[84:87], v[152:155]
    ds_read_b64_tr_b16 a[202:203], v4 offset:800
    v_cvt_pk_bf16_f32 v99, v34, v35
    v_mfma_f32_16x16x32_bf16 v[184:187], a[240:243], v[88:91], v[184:187]
    ds_read_b64_tr_b16 a[204:205], v4 offset:17184
    v_fma_mix_f32 v36, v106, v24, v28 op_sel:[0,0,0] op_sel_hi:[1,0,0]
    v_mfma_f32_16x16x32_bf16 v[184:187], a[244:247], v[92:95], v[184:187]
    s_waitcnt lgkmcnt(8)
    ds_read_b64_tr_b16 a[206:207], v4 offset:17696
    v_fma_mix_f32 v37, v106, v25, v29 op_sel:[1,0,0] op_sel_hi:[1,0,0]
    v_mfma_f32_16x16x32_bf16 v[156:159], a[248:251], v[80:83], v[156:159]
    ds_read_b64_tr_b16 a[208:209], v4 offset:320
    v_fma_mix_f32 v38, v107, v26, v30 op_sel:[0,0,0] op_sel_hi:[1,0,0]
    v_mfma_f32_16x16x32_bf16 v[156:159], a[252:255], v[84:87], v[156:159]
    ds_read_b64_tr_b16 a[210:211], v4 offset:832
    v_fma_mix_f32 v39, v107, v27, v31 op_sel:[1,0,0] op_sel_hi:[1,0,0]
    v_mfma_f32_16x16x32_bf16 v[188:191], a[248:251], v[88:91], v[188:191]
    ds_read_b64_tr_b16 a[212:213], v4 offset:17216
    v_cvt_pk_bf16_f32 v106, v36, v37
    v_mfma_f32_16x16x32_bf16 v[188:191], a[252:255], v[92:95], v[188:191]
    s_waitcnt lgkmcnt(7)
    ds_read_b64_tr_b16 a[214:215], v4 offset:17728
    v_cvt_pk_bf16_f32 v107, v38, v39
    v_mfma_f32_16x16x32_bf16 v[192:195], a[192:195], v[80:83], v[192:195]
    ds_read_b64_tr_b16 a[216:217], v4 offset:352
    ds_read_b128 v[24:27], v9 offset:12560
    v_mfma_f32_16x16x32_bf16 v[192:195], a[196:199], v[84:87], v[192:195]
    ds_read_b64_tr_b16 a[218:219], v4 offset:864
    ds_read_b64_tr_b16 a[220:221], v4 offset:17248
    v_fma_mix_f32 v32, v100, v16, v20 op_sel:[0,0,0] op_sel_hi:[1,0,0]
    v_mfma_f32_16x16x32_bf16 v[224:227], a[192:195], v[88:91], v[224:227]
    s_mov_b32 s54, 16384
    ds_read_b64_tr_b16 a[222:223], v4 offset:17760
    ds_read_b128 v[28:31], v9 offset:12592
    v_mfma_f32_16x16x32_bf16 v[224:227], a[196:199], v[92:95], v[224:227]
    s_waitcnt lgkmcnt(10)
    buffer_load_dwordx4 v[48:51], v8, s[32:35], s54 offen sc1
    v_mfma_f32_16x16x32_bf16 v[196:199], a[200:203], v[80:83], v[196:199]
    ds_read_b64_tr_b16 a[224:225], v4 offset:384
    v_fma_mix_f32 v33, v100, v17, v21 op_sel:[1,0,0] op_sel_hi:[1,0,0]
    v_mfma_f32_16x16x32_bf16 v[196:199], a[204:207], v[84:87], v[196:199]
    ds_read_b64_tr_b16 a[226:227], v4 offset:896
    ds_read_b64_tr_b16 a[228:229], v4 offset:17280
    v_fma_mix_f32 v34, v101, v18, v22 op_sel:[0,0,0] op_sel_hi:[1,0,0]
    v_mfma_f32_16x16x32_bf16 v[228:231], a[200:203], v[88:91], v[228:231]
    s_mov_b32 s54, 17408
    ds_read_b64_tr_b16 a[230:231], v4 offset:17792
    v_fma_mix_f32 v35, v101, v19, v23 op_sel:[1,0,0] op_sel_hi:[1,0,0]
    v_mfma_f32_16x16x32_bf16 v[228:231], a[204:207], v[92:95], v[228:231]
    s_waitcnt lgkmcnt(10)
    buffer_load_dwordx4 v[52:55], v8, s[32:35], s54 offen sc1
    v_mfma_f32_16x16x32_bf16 v[200:203], a[208:211], v[80:83], v[200:203]
    ds_read_b64_tr_b16 a[232:233], v4 offset:416
    v_cvt_pk_bf16_f32 v100, v32, v33
    v_mfma_f32_16x16x32_bf16 v[200:203], a[212:215], v[84:87], v[200:203]
    ds_read_b64_tr_b16 a[234:235], v4 offset:928
    ds_read_b64_tr_b16 a[236:237], v4 offset:17312
    v_cvt_pk_bf16_f32 v101, v34, v35
    v_mfma_f32_16x16x32_bf16 v[232:235], a[208:211], v[88:91], v[232:235]
    s_mov_b32 s54, 34816
    ds_read_b64_tr_b16 a[238:239], v4 offset:17824
    v_fma_mix_f32 v36, v108, v16, v20 op_sel:[0,0,0] op_sel_hi:[1,0,0]
    v_mfma_f32_16x16x32_bf16 v[232:235], a[212:215], v[92:95], v[232:235]
    s_waitcnt lgkmcnt(9)
    buffer_load_dwordx4 v[56:59], v8, s[32:35], s54 offen sc1
    v_fma_mix_f32 v37, v108, v17, v21 op_sel:[1,0,0] op_sel_hi:[1,0,0]
    v_mfma_f32_16x16x32_bf16 v[204:207], a[216:219], v[80:83], v[204:207]
    ds_read_b64_tr_b16 a[240:241], v4 offset:448
    v_fma_mix_f32 v38, v109, v18, v22 op_sel:[0,0,0] op_sel_hi:[1,0,0]
    v_mfma_f32_16x16x32_bf16 v[204:207], a[220:223], v[84:87], v[204:207]
    ds_read_b64_tr_b16 a[242:243], v4 offset:960
    ds_read_b64_tr_b16 a[244:245], v4 offset:17344
    v_fma_mix_f32 v39, v109, v19, v23 op_sel:[1,0,0] op_sel_hi:[1,0,0]
    v_mfma_f32_16x16x32_bf16 v[236:239], a[216:219], v[88:91], v[236:239]
    s_mov_b32 s54, 35840
    ds_read_b64_tr_b16 a[246:247], v4 offset:17856
    v_cvt_pk_bf16_f32 v108, v36, v37
    v_mfma_f32_16x16x32_bf16 v[236:239], a[220:223], v[92:95], v[236:239]
    s_waitcnt lgkmcnt(8)
    buffer_load_dwordx4 v[60:63], v8, s[32:35], s54 offen sc1
    v_cvt_pk_bf16_f32 v109, v38, v39
    v_mfma_f32_16x16x32_bf16 v[208:211], a[224:227], v[80:83], v[208:211]
    ds_read_b64_tr_b16 a[248:249], v4 offset:480
    ds_read_b128 v[16:19], v9 offset:12800
    v_mfma_f32_16x16x32_bf16 v[208:211], a[228:231], v[84:87], v[208:211]
    ds_read_b64_tr_b16 a[250:251], v4 offset:992
    ds_read_b128 v[20:23], v9 offset:12832
    v_mfma_f32_16x16x32_bf16 v[240:243], a[224:227], v[88:91], v[240:243]
    ds_read_b64_tr_b16 a[252:253], v4 offset:17376
    v_fma_mix_f32 v32, v102, v24, v28 op_sel:[0,0,0] op_sel_hi:[1,0,0]
    v_mfma_f32_16x16x32_bf16 v[240:243], a[228:231], v[92:95], v[240:243]
    s_waitcnt vmcnt(16)
    s_barrier
    s_waitcnt lgkmcnt(9)
    ds_read_b64_tr_b16 a[254:255], v4 offset:17888
    v_fma_mix_f32 v33, v102, v25, v29 op_sel:[1,0,0] op_sel_hi:[1,0,0]
    v_fma_mix_f32 v34, v103, v26, v30 op_sel:[0,0,0] op_sel_hi:[1,0,0]
    v_mfma_f32_16x16x32_bf16 v[212:215], a[232:235], v[80:83], v[212:215]
    ds_read_b64_tr_b16 a[192:193], v4 offset:36864
    v_fma_mix_f32 v35, v103, v27, v31 op_sel:[1,0,0] op_sel_hi:[1,0,0]
    v_mfma_f32_16x16x32_bf16 v[212:215], a[236:239], v[84:87], v[212:215]
    ds_read_b64_tr_b16 a[194:195], v4 offset:37376
    ds_read_b64_tr_b16 a[196:197], v4 offset:53760
    v_cvt_pk_bf16_f32 v102, v32, v33
    v_mfma_f32_16x16x32_bf16 v[244:247], a[232:235], v[88:91], v[244:247]
    s_add_u32 m0, s44, 36864
    ds_read_b64_tr_b16 a[198:199], v4 offset:54272
    v_cvt_pk_bf16_f32 v103, v34, v35
    v_mfma_f32_16x16x32_bf16 v[244:247], a[236:239], v[92:95], v[244:247]
    s_mov_b32 s45, 4194304
    s_waitcnt lgkmcnt(10)
    buffer_load_dwordx4 v6, s[24:27], s45 offen lds
    v_mfma_f32_16x16x32_bf16 v[216:219], a[240:243], v[80:83], v[216:219]
    ds_read_b64_tr_b16 a[200:201], v4 offset:36896
    v_fma_mix_f32 v36, v110, v24, v28 op_sel:[0,0,0] op_sel_hi:[1,0,0]
    v_mfma_f32_16x16x32_bf16 v[216:219], a[244:247], v[84:87], v[216:219]
    ds_read_b64_tr_b16 a[202:203], v4 offset:37408
    ds_read_b64_tr_b16 a[204:205], v4 offset:53792
    v_fma_mix_f32 v37, v110, v25, v29 op_sel:[1,0,0] op_sel_hi:[1,0,0]
    v_mfma_f32_16x16x32_bf16 v[248:251], a[240:243], v[88:91], v[248:251]
    s_add_u32 m0, s44, 37920
    ds_read_b64_tr_b16 a[206:207], v4 offset:54304
    v_fma_mix_f32 v38, v111, v26, v30 op_sel:[0,0,0] op_sel_hi:[1,0,0]
    v_mfma_f32_16x16x32_bf16 v[248:251], a[244:247], v[92:95], v[248:251]
    s_mov_b32 s45, 4202496
    s_waitcnt lgkmcnt(8)
    buffer_load_dwordx4 v6, s[24:27], s45 offen lds
    v_mfma_f32_16x16x32_bf16 v[220:223], a[248:251], v[80:83], v[220:223]
    ds_read_b64_tr_b16 a[208:209], v4 offset:36928
    v_fma_mix_f32 v39, v111, v27, v31 op_sel:[1,0,0] op_sel_hi:[1,0,0]
    v_mfma_f32_16x16x32_bf16 v[220:223], a[252:255], v[84:87], v[220:223]
    ds_read_b64_tr_b16 a[210:211], v4 offset:37440
    ds_read_b64_tr_b16 a[212:213], v4 offset:53824
    v_cvt_pk_bf16_f32 v110, v36, v37
    v_mfma_f32_16x16x32_bf16 v[252:255], a[248:251], v[88:91], v[252:255]
    s_add_u32 m0, s44, 38976
    ds_read_b64_tr_b16 a[214:215], v4 offset:54336
    v_cvt_pk_bf16_f32 v111, v38, v39
    v_mfma_f32_16x16x32_bf16 v[252:255], a[252:255], v[92:95], v[252:255]
    s_mov_b32 s45, 4210688
    s_waitcnt lgkmcnt(8)
    buffer_load_dwordx4 v6, s[24:27], s45 offen lds
    v_mfma_f32_16x16x32_bf16 v[128:131], a[192:195], v[96:99], v[128:131]
    s_waitcnt vmcnt(15)
    ds_read_b64_tr_b16 a[216:217], v4 offset:36960
    ds_read_b128 v[24:27], v9 offset:12816
    v_mfma_f32_16x16x32_bf16 v[128:131], a[196:199], v[100:103], v[128:131]
    ds_read_b64_tr_b16 a[218:219], v4 offset:37472
    ds_read_b64_tr_b16 a[220:221], v4 offset:53856
    v_fma_mix_f32 v32, v112, v16, v20 op_sel:[0,0,0] op_sel_hi:[1,0,0]
    v_mfma_f32_16x16x32_bf16 v[160:163], a[192:195], v[104:107], v[160:163]
    s_add_u32 m0, s44, 40032
    ds_read_b64_tr_b16 a[222:223], v4 offset:54368
    ds_read_b128 v[28:31], v9 offset:12848
    v_mfma_f32_16x16x32_bf16 v[160:163], a[196:199], v[108:111], v[160:163]
    s_mov_b32 s45, 4218880
    s_waitcnt lgkmcnt(10)
    buffer_load_dwordx4 v6, s[24:27], s45 offen lds
    v_mfma_f32_16x16x32_bf16 v[132:135], a[200:203], v[96:99], v[132:135]
    ds_read_b64_tr_b16 a[224:225], v4 offset:36992
    v_fma_mix_f32 v33, v112, v17, v21 op_sel:[1,0,0] op_sel_hi:[1,0,0]
    v_mfma_f32_16x16x32_bf16 v[132:135], a[204:207], v[100:103], v[132:135]
    ds_read_b64_tr_b16 a[226:227], v4 offset:37504
    ds_read_b64_tr_b16 a[228:229], v4 offset:53888
    v_fma_mix_f32 v34, v113, v18, v22 op_sel:[0,0,0] op_sel_hi:[1,0,0]
    v_mfma_f32_16x16x32_bf16 v[164:167], a[200:203], v[104:107], v[164:167]
    s_add_u32 m0, s44, 53760
    ds_read_b64_tr_b16 a[230:231], v4 offset:54400
    v_fma_mix_f32 v35, v113, v19, v23 op_sel:[1,0,0] op_sel_hi:[1,0,0]
    v_mfma_f32_16x16x32_bf16 v[164:167], a[204:207], v[108:111], v[164:167]
    s_mov_b32 s45, 4456448
    s_waitcnt lgkmcnt(10)
    buffer_load_dwordx4 v6, s[24:27], s45 offen lds
    v_mfma_f32_16x16x32_bf16 v[136:139], a[208:211], v[96:99], v[136:139]
    ds_read_b64_tr_b16 a[232:233], v4 offset:37024
    v_cvt_pk_bf16_f32 v112, v32, v33
    v_mfma_f32_16x16x32_bf16 v[136:139], a[212:215], v[100:103], v[136:139]
    ds_read_b64_tr_b16 a[234:235], v4 offset:37536
    ds_read_b64_tr_b16 a[236:237], v4 offset:53920
    v_cvt_pk_bf16_f32 v113, v34, v35
    v_mfma_f32_16x16x32_bf16 v[168:171], a[208:211], v[104:107], v[168:171]
    s_add_u32 m0, s44, 54816
    ds_read_b64_tr_b16 a[238:239], v4 offset:54432
    v_fma_mix_f32 v36, v120, v16, v20 op_sel:[0,0,0] op_sel_hi:[1,0,0]
    v_mfma_f32_16x16x32_bf16 v[168:171], a[212:215], v[108:111], v[168:171]
    s_mov_b32 s45, 4464640
    s_waitcnt lgkmcnt(9)
    buffer_load_dwordx4 v6, s[24:27], s45 offen lds
    v_fma_mix_f32 v37, v120, v17, v21 op_sel:[1,0,0] op_sel_hi:[1,0,0]
    v_mfma_f32_16x16x32_bf16 v[140:143], a[216:219], v[96:99], v[140:143]
    ds_read_b64_tr_b16 a[240:241], v4 offset:37056
    v_fma_mix_f32 v38, v121, v18, v22 op_sel:[0,0,0] op_sel_hi:[1,0,0]
    v_mfma_f32_16x16x32_bf16 v[140:143], a[220:223], v[100:103], v[140:143]
    ds_read_b64_tr_b16 a[242:243], v4 offset:37568
    ds_read_b64_tr_b16 a[244:245], v4 offset:53952
    v_fma_mix_f32 v39, v121, v19, v23 op_sel:[1,0,0] op_sel_hi:[1,0,0]
    v_mfma_f32_16x16x32_bf16 v[172:175], a[216:219], v[104:107], v[172:175]
    s_add_u32 m0, s44, 55872
    ds_read_b64_tr_b16 a[246:247], v4 offset:54464
    v_cvt_pk_bf16_f32 v120, v36, v37
    v_mfma_f32_16x16x32_bf16 v[172:175], a[220:223], v[108:111], v[172:175]
    s_mov_b32 s45, 4472832
    s_waitcnt lgkmcnt(8)
    buffer_load_dwordx4 v6, s[24:27], s45 offen lds
    v_cvt_pk_bf16_f32 v121, v38, v39
    v_mfma_f32_16x16x32_bf16 v[144:147], a[224:227], v[96:99], v[144:147]
    ds_read_b64_tr_b16 a[248:249], v4 offset:37088
    ds_read_b128 v[16:19], v9 offset:13056
    v_mfma_f32_16x16x32_bf16 v[144:147], a[228:231], v[100:103], v[144:147]
    ds_read_b64_tr_b16 a[250:251], v4 offset:37600
    ds_read_b64_tr_b16 a[252:253], v4 offset:53984
    v_mfma_f32_16x16x32_bf16 v[176:179], a[224:227], v[104:107], v[176:179]
    s_add_u32 m0, s44, 56928
    ds_read_b64_tr_b16 a[254:255], v4 offset:54496
    ds_read_b128 v[20:23], v9 offset:13088
    v_mfma_f32_16x16x32_bf16 v[176:179], a[228:231], v[108:111], v[176:179]
    s_mov_b32 s45, 4481024
    s_waitcnt lgkmcnt(10)
    buffer_load_dwordx4 v6, s[24:27], s45 offen lds
    v_mfma_f32_16x16x32_bf16 v[148:151], a[232:235], v[96:99], v[148:151]
    ds_read_b64_tr_b16 a[192:193], v4 offset:37120
    v_fma_mix_f32 v32, v114, v24, v28 op_sel:[0,0,0] op_sel_hi:[1,0,0]
    v_mfma_f32_16x16x32_bf16 v[148:151], a[236:239], v[100:103], v[148:151]
    ds_read_b64_tr_b16 a[194:195], v4 offset:37632
    v_fma_mix_f32 v33, v114, v25, v29 op_sel:[1,0,0] op_sel_hi:[1,0,0]
    v_mfma_f32_16x16x32_bf16 v[180:183], a[232:235], v[104:107], v[180:183]
    ds_read_b64_tr_b16 a[196:197], v4 offset:54016
    v_fma_mix_f32 v34, v115, v26, v30 op_sel:[0,0,0] op_sel_hi:[1,0,0]
    v_mfma_f32_16x16x32_bf16 v[180:183], a[236:239], v[108:111], v[180:183]
    s_waitcnt lgkmcnt(9)
    ds_read_b64_tr_b16 a[198:199], v4 offset:54528
    v_fma_mix_f32 v35, v115, v27, v31 op_sel:[1,0,0] op_sel_hi:[1,0,0]
    v_mfma_f32_16x16x32_bf16 v[152:155], a[240:243], v[96:99], v[152:155]
    ds_read_b64_tr_b16 a[200:201], v4 offset:37152
    v_cvt_pk_bf16_f32 v114, v32, v33
    v_mfma_f32_16x16x32_bf16 v[152:155], a[244:247], v[100:103], v[152:155]
    ds_read_b64_tr_b16 a[202:203], v4 offset:37664
    v_cvt_pk_bf16_f32 v115, v34, v35
    v_mfma_f32_16x16x32_bf16 v[184:187], a[240:243], v[104:107], v[184:187]
    ds_read_b64_tr_b16 a[204:205], v4 offset:54048
    v_fma_mix_f32 v36, v122, v24, v28 op_sel:[0,0,0] op_sel_hi:[1,0,0]
    v_mfma_f32_16x16x32_bf16 v[184:187], a[244:247], v[108:111], v[184:187]
    s_waitcnt lgkmcnt(8)
    ds_read_b64_tr_b16 a[206:207], v4 offset:54560
    v_fma_mix_f32 v37, v122, v25, v29 op_sel:[1,0,0] op_sel_hi:[1,0,0]
    v_mfma_f32_16x16x32_bf16 v[156:159], a[248:251], v[96:99], v[156:159]
    ds_read_b64_tr_b16 a[208:209], v4 offset:37184
    v_fma_mix_f32 v38, v123, v26, v30 op_sel:[0,0,0] op_sel_hi:[1,0,0]
    v_mfma_f32_16x16x32_bf16 v[156:159], a[252:255], v[100:103], v[156:159]
    ds_read_b64_tr_b16 a[210:211], v4 offset:37696
    v_fma_mix_f32 v39, v123, v27, v31 op_sel:[1,0,0] op_sel_hi:[1,0,0]
    v_mfma_f32_16x16x32_bf16 v[188:191], a[248:251], v[104:107], v[188:191]
    ds_read_b64_tr_b16 a[212:213], v4 offset:54080
    v_cvt_pk_bf16_f32 v122, v36, v37
    v_mfma_f32_16x16x32_bf16 v[188:191], a[252:255], v[108:111], v[188:191]
    s_waitcnt lgkmcnt(7)
    ds_read_b64_tr_b16 a[214:215], v4 offset:54592
    v_cvt_pk_bf16_f32 v123, v38, v39
    v_mfma_f32_16x16x32_bf16 v[192:195], a[192:195], v[96:99], v[192:195]
    ds_read_b64_tr_b16 a[216:217], v4 offset:37216
    ds_read_b128 v[24:27], v9 offset:13072
    v_mfma_f32_16x16x32_bf16 v[192:195], a[196:199], v[100:103], v[192:195]
    ds_read_b64_tr_b16 a[218:219], v4 offset:37728
    ds_read_b128 v[28:31], v9 offset:13104
    v_mfma_f32_16x16x32_bf16 v[224:227], a[192:195], v[104:107], v[224:227]
    ds_read_b64_tr_b16 a[220:221], v4 offset:54112
    v_fma_mix_f32 v32, v116, v16, v20 op_sel:[0,0,0] op_sel_hi:[1,0,0]
    v_mfma_f32_16x16x32_bf16 v[224:227], a[196:199], v[108:111], v[224:227]
    s_waitcnt lgkmcnt(9)
    ds_read_b64_tr_b16 a[222:223], v4 offset:54624
    v_fma_mix_f32 v33, v116, v17, v21 op_sel:[1,0,0] op_sel_hi:[1,0,0]
    v_mfma_f32_16x16x32_bf16 v[196:199], a[200:203], v[96:99], v[196:199]
    ds_read_b64_tr_b16 a[224:225], v4 offset:37248
    v_fma_mix_f32 v34, v117, v18, v22 op_sel:[0,0,0] op_sel_hi:[1,0,0]
    v_mfma_f32_16x16x32_bf16 v[196:199], a[204:207], v[100:103], v[196:199]
    ds_read_b64_tr_b16 a[226:227], v4 offset:37760
    v_fma_mix_f32 v35, v117, v19, v23 op_sel:[1,0,0] op_sel_hi:[1,0,0]
    v_mfma_f32_16x16x32_bf16 v[228:231], a[200:203], v[104:107], v[228:231]
    ds_read_b64_tr_b16 a[228:229], v4 offset:54144
    v_cvt_pk_bf16_f32 v116, v32, v33
    v_mfma_f32_16x16x32_bf16 v[228:231], a[204:207], v[108:111], v[228:231]
    s_waitcnt lgkmcnt(9)
    ds_read_b64_tr_b16 a[230:231], v4 offset:54656
    v_cvt_pk_bf16_f32 v117, v34, v35
    v_mfma_f32_16x16x32_bf16 v[200:203], a[208:211], v[96:99], v[200:203]
    ds_read_b64_tr_b16 a[232:233], v4 offset:37280
    v_fma_mix_f32 v36, v124, v16, v20 op_sel:[0,0,0] op_sel_hi:[1,0,0]
    v_mfma_f32_16x16x32_bf16 v[200:203], a[212:215], v[100:103], v[200:203]
    ds_read_b64_tr_b16 a[234:235], v4 offset:37792
    v_fma_mix_f32 v37, v124, v17, v21 op_sel:[1,0,0] op_sel_hi:[1,0,0]
    v_mfma_f32_16x16x32_bf16 v[232:235], a[208:211], v[104:107], v[232:235]
    ds_read_b64_tr_b16 a[236:237], v4 offset:54176
    v_fma_mix_f32 v38, v125, v18, v22 op_sel:[0,0,0] op_sel_hi:[1,0,0]
    v_mfma_f32_16x16x32_bf16 v[232:235], a[212:215], v[108:111], v[232:235]
    s_waitcnt lgkmcnt(7)
    ds_read_b64_tr_b16 a[238:239], v4 offset:54688
    v_fma_mix_f32 v39, v125, v19, v23 op_sel:[1,0,0] op_sel_hi:[1,0,0]
    v_mfma_f32_16x16x32_bf16 v[204:207], a[216:219], v[96:99], v[204:207]
    ds_read_b64_tr_b16 a[240:241], v4 offset:37312
    v_cvt_pk_bf16_f32 v124, v36, v37
    v_mfma_f32_16x16x32_bf16 v[204:207], a[220:223], v[100:103], v[204:207]
    ds_read_b64_tr_b16 a[242:243], v4 offset:37824
    v_cvt_pk_bf16_f32 v125, v38, v39
    v_mfma_f32_16x16x32_bf16 v[236:239], a[216:219], v[104:107], v[236:239]
    ds_read_b64_tr_b16 a[244:245], v4 offset:54208
    v_mfma_f32_16x16x32_bf16 v[236:239], a[220:223], v[108:111], v[236:239]
    s_waitcnt lgkmcnt(7)
    ds_read_b64_tr_b16 a[246:247], v4 offset:54720
    v_mfma_f32_16x16x32_bf16 v[208:211], a[224:227], v[96:99], v[208:211]
    ds_read_b64_tr_b16 a[248:249], v4 offset:37344
    ds_read_b128 v[16:19], v9 offset:13312
    v_mfma_f32_16x16x32_bf16 v[208:211], a[228:231], v[100:103], v[208:211]
    ds_read_b64_tr_b16 a[250:251], v4 offset:37856
    ds_read_b128 v[20:23], v9 offset:13344
    v_mfma_f32_16x16x32_bf16 v[240:243], a[224:227], v[104:107], v[240:243]
    ds_read_b64_tr_b16 a[252:253], v4 offset:54240
    v_fma_mix_f32 v32, v118, v24, v28 op_sel:[0,0,0] op_sel_hi:[1,0,0]
    v_mfma_f32_16x16x32_bf16 v[240:243], a[228:231], v[108:111], v[240:243]
    s_waitcnt vmcnt(12)
    s_barrier
    s_waitcnt lgkmcnt(9)
    ds_read_b64_tr_b16 a[254:255], v4 offset:54752
    v_fma_mix_f32 v33, v118, v25, v29 op_sel:[1,0,0] op_sel_hi:[1,0,0]
    v_fma_mix_f32 v34, v119, v26, v30 op_sel:[0,0,0] op_sel_hi:[1,0,0]
    v_mfma_f32_16x16x32_bf16 v[212:215], a[232:235], v[96:99], v[212:215]
    ds_read_b64_tr_b16 a[192:193], v3 offset:0
    v_fma_mix_f32 v35, v119, v27, v31 op_sel:[1,0,0] op_sel_hi:[1,0,0]
    v_mfma_f32_16x16x32_bf16 v[212:215], a[236:239], v[100:103], v[212:215]
    ds_read_b64_tr_b16 a[194:195], v3 offset:512
    ds_read_b64_tr_b16 a[196:197], v3 offset:16896
    v_cvt_pk_bf16_f32 v118, v32, v33
    v_mfma_f32_16x16x32_bf16 v[244:247], a[232:235], v[104:107], v[244:247]
    s_add_u32 m0, s44, 73728
    ds_read_b64_tr_b16 a[198:199], v3 offset:17408
    v_cvt_pk_bf16_f32 v119, v34, v35
    v_mfma_f32_16x16x32_bf16 v[244:247], a[236:239], v[108:111], v[244:247]
    s_mov_b32 s46, 0
    s_waitcnt lgkmcnt(10)
    buffer_load_dwordx4 v5, s[16:19], s46 offen offset:0 lds
    v_mfma_f32_16x16x32_bf16 v[216:219], a[240:243], v[96:99], v[216:219]
    ds_read_b64_tr_b16 a[200:201], v3 offset:32
    v_fma_mix_f32 v36, v126, v24, v28 op_sel:[0,0,0] op_sel_hi:[1,0,0]
    v_mfma_f32_16x16x32_bf16 v[216:219], a[244:247], v[100:103], v[216:219]
    ds_read_b64_tr_b16 a[202:203], v3 offset:544
    ds_read_b64_tr_b16 a[204:205], v3 offset:16928
    v_fma_mix_f32 v37, v126, v25, v29 op_sel:[1,0,0] op_sel_hi:[1,0,0]
    v_mfma_f32_16x16x32_bf16 v[248:251], a[240:243], v[104:107], v[248:251]
    s_add_u32 m0, s44, 73760
    ds_read_b64_tr_b16 a[206:207], v3 offset:17440
    v_fma_mix_f32 v38, v127, v26, v30 op_sel:[0,0,0] op_sel_hi:[1,0,0]
    v_mfma_f32_16x16x32_bf16 v[248:251], a[244:247], v[108:111], v[248:251]
    s_waitcnt lgkmcnt(8)
    buffer_load_dwordx4 v5, s[16:19], s46 offen offset:1024 lds
    v_mfma_f32_16x16x32_bf16 v[220:223], a[248:251], v[96:99], v[220:223]
    ds_read_b64_tr_b16 a[208:209], v3 offset:64
    v_fma_mix_f32 v39, v127, v27, v31 op_sel:[1,0,0] op_sel_hi:[1,0,0]
    v_mfma_f32_16x16x32_bf16 v[220:223], a[252:255], v[100:103], v[220:223]
    ds_read_b64_tr_b16 a[210:211], v3 offset:576
    ds_read_b64_tr_b16 a[212:213], v3 offset:16960
    v_cvt_pk_bf16_f32 v126, v36, v37
    v_mfma_f32_16x16x32_bf16 v[252:255], a[248:251], v[104:107], v[252:255]
    s_add_u32 m0, s44, 73792
    ds_read_b64_tr_b16 a[214:215], v3 offset:17472
    v_cvt_pk_bf16_f32 v127, v38, v39
    v_mfma_f32_16x16x32_bf16 v[252:255], a[252:255], v[108:111], v[252:255]
    s_waitcnt lgkmcnt(8)
    buffer_load_dwordx4 v5, s[16:19], s46 offen offset:2048 lds
    v_mfma_f32_16x16x32_bf16 v[128:131], a[192:195], v[112:115], v[128:131]
    s_waitcnt vmcnt(11)
    ds_read_b64_tr_b16 a[216:217], v3 offset:96
    ds_read_b128 v[24:27], v9 offset:13328
    v_mfma_f32_16x16x32_bf16 v[128:131], a[196:199], v[116:119], v[128:131]
    ds_read_b64_tr_b16 a[218:219], v3 offset:608
    ds_read_b64_tr_b16 a[220:221], v3 offset:16992
    v_fma_mix_f32 v32, v48, v16, v20 op_sel:[0,0,0] op_sel_hi:[1,0,0]
    v_mfma_f32_16x16x32_bf16 v[160:163], a[192:195], v[120:123], v[160:163]
    s_add_u32 m0, s44, 73824
    ds_read_b64_tr_b16 a[222:223], v3 offset:17504
    ds_read_b128 v[28:31], v9 offset:13360
    v_mfma_f32_16x16x32_bf16 v[160:163], a[196:199], v[124:127], v[160:163]
    s_waitcnt lgkmcnt(10)
    buffer_load_dwordx4 v5, s[16:19], s46 offen offset:3072 lds
    v_mfma_f32_16x16x32_bf16 v[132:135], a[200:203], v[112:115], v[132:135]
    ds_read_b64_tr_b16 a[224:225], v3 offset:128
    v_fma_mix_f32 v33, v48, v17, v21 op_sel:[1,0,0] op_sel_hi:[1,0,0]
    v_mfma_f32_16x16x32_bf16 v[132:135], a[204:207], v[116:119], v[132:135]
    ds_read_b64_tr_b16 a[226:227], v3 offset:640
    ds_read_b64_tr_b16 a[228:229], v3 offset:17024
    v_fma_mix_f32 v34, v49, v18, v22 op_sel:[0,0,0] op_sel_hi:[1,0,0]
    v_mfma_f32_16x16x32_bf16 v[164:167], a[200:203], v[120:123], v[164:167]
    s_add_u32 m0, s44, 90624
    ds_read_b64_tr_b16 a[230:231], v3 offset:17536
    v_fma_mix_f32 v35, v49, v19, v23 op_sel:[1,0,0] op_sel_hi:[1,0,0]
    v_mfma_f32_16x16x32_bf16 v[164:167], a[204:207], v[124:127], v[164:167]
    s_waitcnt lgkmcnt(10)
    buffer_load_dwordx4 v5, s[20:23], s46 offen offset:0 lds
    v_mfma_f32_16x16x32_bf16 v[136:139], a[208:211], v[112:115], v[136:139]
    ds_read_b64_tr_b16 a[232:233], v3 offset:160
    v_cvt_pk_bf16_f32 v48, v32, v33
    v_mfma_f32_16x16x32_bf16 v[136:139], a[212:215], v[116:119], v[136:139]
    ds_read_b64_tr_b16 a[234:235], v3 offset:672
    ds_read_b64_tr_b16 a[236:237], v3 offset:17056
    v_cvt_pk_bf16_f32 v49, v34, v35
    v_mfma_f32_16x16x32_bf16 v[168:171], a[208:211], v[120:123], v[168:171]
    s_add_u32 m0, s44, 90656
    ds_read_b64_tr_b16 a[238:239], v3 offset:17568
    v_fma_mix_f32 v36, v56, v16, v20 op_sel:[0,0,0] op_sel_hi:[1,0,0]
    v_mfma_f32_16x16x32_bf16 v[168:171], a[212:215], v[124:127], v[168:171]
    s_waitcnt lgkmcnt(9)
    buffer_load_dwordx4 v5, s[20:23], s46 offen offset:1024 lds
    v_fma_mix_f32 v37, v56, v17, v21 op_sel:[1,0,0] op_sel_hi:[1,0,0]
    v_mfma_f32_16x16x32_bf16 v[140:143], a[216:219], v[112:115], v[140:143]
    ds_read_b64_tr_b16 a[240:241], v3 offset:192
    v_fma_mix_f32 v38, v57, v18, v22 op_sel:[0,0,0] op_sel_hi:[1,0,0]
    v_mfma_f32_16x16x32_bf16 v[140:143], a[220:223], v[116:119], v[140:143]
    ds_read_b64_tr_b16 a[242:243], v3 offset:704
    ds_read_b64_tr_b16 a[244:245], v3 offset:17088
    v_fma_mix_f32 v39, v57, v19, v23 op_sel:[1,0,0] op_sel_hi:[1,0,0]
    v_mfma_f32_16x16x32_bf16 v[172:175], a[216:219], v[120:123], v[172:175]
    s_add_u32 m0, s44, 90688
    ds_read_b64_tr_b16 a[246:247], v3 offset:17600
    v_cvt_pk_bf16_f32 v56, v36, v37
    v_mfma_f32_16x16x32_bf16 v[172:175], a[220:223], v[124:127], v[172:175]
    s_waitcnt lgkmcnt(8)
    buffer_load_dwordx4 v5, s[20:23], s46 offen offset:2048 lds
    v_cvt_pk_bf16_f32 v57, v38, v39
    v_mfma_f32_16x16x32_bf16 v[144:147], a[224:227], v[112:115], v[144:147]
    ds_read_b64_tr_b16 a[248:249], v3 offset:224
    ds_read_b128 v[16:19], v9 offset:13568
    v_mfma_f32_16x16x32_bf16 v[144:147], a[228:231], v[116:119], v[144:147]
    ds_read_b64_tr_b16 a[250:251], v3 offset:736
    ds_read_b64_tr_b16 a[252:253], v3 offset:17120
    v_mfma_f32_16x16x32_bf16 v[176:179], a[224:227], v[120:123], v[176:179]
    s_add_u32 m0, s44, 90720
    ds_read_b64_tr_b16 a[254:255], v3 offset:17632
    ds_read_b128 v[20:23], v9 offset:13600
    v_mfma_f32_16x16x32_bf16 v[176:179], a[228:231], v[124:127], v[176:179]
    s_waitcnt lgkmcnt(10)
    buffer_load_dwordx4 v5, s[20:23], s46 offen offset:3072 lds
    v_mfma_f32_16x16x32_bf16 v[148:151], a[232:235], v[112:115], v[148:151]
    ds_read_b64_tr_b16 a[192:193], v3 offset:256
    v_fma_mix_f32 v32, v50, v24, v28 op_sel:[0,0,0] op_sel_hi:[1,0,0]
    v_mfma_f32_16x16x32_bf16 v[148:151], a[236:239], v[116:119], v[148:151]
    ds_read_b64_tr_b16 a[194:195], v3 offset:768
    v_fma_mix_f32 v33, v50, v25, v29 op_sel:[1,0,0] op_sel_hi:[1,0,0]
    v_mfma_f32_16x16x32_bf16 v[180:183], a[232:235], v[120:123], v[180:183]
    ds_read_b64_tr_b16 a[196:197], v3 offset:17152
    v_fma_mix_f32 v34, v51, v26, v30 op_sel:[0,0,0] op_sel_hi:[1,0,0]
    v_mfma_f32_16x16x32_bf16 v[180:183], a[236:239], v[124:127], v[180:183]
    s_waitcnt lgkmcnt(9)
    ds_read_b64_tr_b16 a[198:199], v3 offset:17664
    v_fma_mix_f32 v35, v51, v27, v31 op_sel:[1,0,0] op_sel_hi:[1,0,0]
    v_mfma_f32_16x16x32_bf16 v[152:155], a[240:243], v[112:115], v[152:155]
    ds_read_b64_tr_b16 a[200:201], v3 offset:288
    v_cvt_pk_bf16_f32 v50, v32, v33
    v_mfma_f32_16x16x32_bf16 v[152:155], a[244:247], v[116:119], v[152:155]
    ds_read_b64_tr_b16 a[202:203], v3 offset:800
    v_cvt_pk_bf16_f32 v51, v34, v35
    v_mfma_f32_16x16x32_bf16 v[184:187], a[240:243], v[120:123], v[184:187]
    ds_read_b64_tr_b16 a[204:205], v3 offset:17184
    v_fma_mix_f32 v36, v58, v24, v28 op_sel:[0,0,0] op_sel_hi:[1,0,0]
    v_mfma_f32_16x16x32_bf16 v[184:187], a[244:247], v[124:127], v[184:187]
    s_waitcnt lgkmcnt(8)
    ds_read_b64_tr_b16 a[206:207], v3 offset:17696
    v_fma_mix_f32 v37, v58, v25, v29 op_sel:[1,0,0] op_sel_hi:[1,0,0]
    v_mfma_f32_16x16x32_bf16 v[156:159], a[248:251], v[112:115], v[156:159]
    ds_read_b64_tr_b16 a[208:209], v3 offset:320
    v_fma_mix_f32 v38, v59, v26, v30 op_sel:[0,0,0] op_sel_hi:[1,0,0]
    v_mfma_f32_16x16x32_bf16 v[156:159], a[252:255], v[116:119], v[156:159]
    ds_read_b64_tr_b16 a[210:211], v3 offset:832
    v_fma_mix_f32 v39, v59, v27, v31 op_sel:[1,0,0] op_sel_hi:[1,0,0]
    v_mfma_f32_16x16x32_bf16 v[188:191], a[248:251], v[120:123], v[188:191]
    ds_read_b64_tr_b16 a[212:213], v3 offset:17216
    v_cvt_pk_bf16_f32 v58, v36, v37
    v_mfma_f32_16x16x32_bf16 v[188:191], a[252:255], v[124:127], v[188:191]
    s_waitcnt lgkmcnt(7)
    ds_read_b64_tr_b16 a[214:215], v3 offset:17728
    v_cvt_pk_bf16_f32 v59, v38, v39
    v_mfma_f32_16x16x32_bf16 v[192:195], a[192:195], v[112:115], v[192:195]
    ds_read_b64_tr_b16 a[216:217], v3 offset:352
    ds_read_b128 v[24:27], v9 offset:13584
    v_mfma_f32_16x16x32_bf16 v[192:195], a[196:199], v[116:119], v[192:195]
    ds_read_b64_tr_b16 a[218:219], v3 offset:864
    ds_read_b128 v[28:31], v9 offset:13616
    v_mfma_f32_16x16x32_bf16 v[224:227], a[192:195], v[120:123], v[224:227]
    ds_read_b64_tr_b16 a[220:221], v3 offset:17248
    v_fma_mix_f32 v32, v52, v16, v20 op_sel:[0,0,0] op_sel_hi:[1,0,0]
    v_mfma_f32_16x16x32_bf16 v[224:227], a[196:199], v[124:127], v[224:227]
    s_waitcnt lgkmcnt(9)
    ds_read_b64_tr_b16 a[222:223], v3 offset:17760
    v_fma_mix_f32 v33, v52, v17, v21 op_sel:[1,0,0] op_sel_hi:[1,0,0]
    v_mfma_f32_16x16x32_bf16 v[196:199], a[200:203], v[112:115], v[196:199]
    ds_read_b64_tr_b16 a[224:225], v3 offset:384
    v_fma_mix_f32 v34, v53, v18, v22 op_sel:[0,0,0] op_sel_hi:[1,0,0]
    v_mfma_f32_16x16x32_bf16 v[196:199], a[204:207], v[116:119], v[196:199]
    ds_read_b64_tr_b16 a[226:227], v3 offset:896
    v_fma_mix_f32 v35, v53, v19, v23 op_sel:[1,0,0] op_sel_hi:[1,0,0]
    v_mfma_f32_16x16x32_bf16 v[228:231], a[200:203], v[120:123], v[228:231]
    ds_read_b64_tr_b16 a[228:229], v3 offset:17280
    v_cvt_pk_bf16_f32 v52, v32, v33
    v_mfma_f32_16x16x32_bf16 v[228:231], a[204:207], v[124:127], v[228:231]
    s_waitcnt lgkmcnt(9)
    ds_read_b64_tr_b16 a[230:231], v3 offset:17792
    v_cvt_pk_bf16_f32 v53, v34, v35
    v_mfma_f32_16x16x32_bf16 v[200:203], a[208:211], v[112:115], v[200:203]
    ds_read_b64_tr_b16 a[232:233], v3 offset:416
    v_fma_mix_f32 v36, v60, v16, v20 op_sel:[0,0,0] op_sel_hi:[1,0,0]
    v_mfma_f32_16x16x32_bf16 v[200:203], a[212:215], v[116:119], v[200:203]
    ds_read_b64_tr_b16 a[234:235], v3 offset:928
    v_fma_mix_f32 v37, v60, v17, v21 op_sel:[1,0,0] op_sel_hi:[1,0,0]
    v_mfma_f32_16x16x32_bf16 v[232:235], a[208:211], v[120:123], v[232:235]
    ds_read_b64_tr_b16 a[236:237], v3 offset:17312
    v_fma_mix_f32 v38, v61, v18, v22 op_sel:[0,0,0] op_sel_hi:[1,0,0]
    v_mfma_f32_16x16x32_bf16 v[232:235], a[212:215], v[124:127], v[232:235]
    s_waitcnt lgkmcnt(7)
    ds_read_b64_tr_b16 a[238:239], v3 offset:17824
    v_fma_mix_f32 v39, v61, v19, v23 op_sel:[1,0,0] op_sel_hi:[1,0,0]
    v_mfma_f32_16x16x32_bf16 v[204:207], a[216:219], v[112:115], v[204:207]
    ds_read_b64_tr_b16 a[240:241], v3 offset:448
    v_cvt_pk_bf16_f32 v60, v36, v37
    v_mfma_f32_16x16x32_bf16 v[204:207], a[220:223], v[116:119], v[204:207]
    ds_read_b64_tr_b16 a[242:243], v3 offset:960
    v_cvt_pk_bf16_f32 v61, v38, v39
    v_mfma_f32_16x16x32_bf16 v[236:239], a[216:219], v[120:123], v[236:239]
    ds_read_b64_tr_b16 a[244:245], v3 offset:17344
    v_mfma_f32_16x16x32_bf16 v[236:239], a[220:223], v[124:127], v[236:239]
    s_waitcnt lgkmcnt(7)
    ds_read_b64_tr_b16 a[246:247], v3 offset:17856
    v_mfma_f32_16x16x32_bf16 v[208:211], a[224:227], v[112:115], v[208:211]
    ds_read_b64_tr_b16 a[248:249], v3 offset:480
    v_fma_mix_f32 v32, v54, v24, v28 op_sel:[0,0,0] op_sel_hi:[1,0,0]
    v_mfma_f32_16x16x32_bf16 v[208:211], a[228:231], v[116:119], v[208:211]
    ds_read_b64_tr_b16 a[250:251], v3 offset:992
    v_fma_mix_f32 v33, v54, v25, v29 op_sel:[1,0,0] op_sel_hi:[1,0,0]
    v_mfma_f32_16x16x32_bf16 v[240:243], a[224:227], v[120:123], v[240:243]
    ds_read_b64_tr_b16 a[252:253], v3 offset:17376
    v_fma_mix_f32 v34, v55, v26, v30 op_sel:[0,0,0] op_sel_hi:[1,0,0]
    v_mfma_f32_16x16x32_bf16 v[240:243], a[228:231], v[124:127], v[240:243]
    s_waitcnt vmcnt(8)
    s_barrier
    s_waitcnt lgkmcnt(7)
    ds_read_b64_tr_b16 a[254:255], v3 offset:17888
    v_fma_mix_f32 v35, v55, v27, v31 op_sel:[1,0,0] op_sel_hi:[1,0,0]
    v_mfma_f32_16x16x32_bf16 v[212:215], a[232:235], v[112:115], v[212:215]
    ds_read_b64_tr_b16 a[192:193], v3 offset:36864
    v_cvt_pk_bf16_f32 v54, v32, v33
    v_mfma_f32_16x16x32_bf16 v[212:215], a[236:239], v[116:119], v[212:215]
    ds_read_b64_tr_b16 a[194:195], v3 offset:37376
    ds_read_b64_tr_b16 a[196:197], v3 offset:53760
    v_mfma_f32_16x16x32_bf16 v[244:247], a[232:235], v[120:123], v[244:247]
    s_add_u32 m0, s44, 110592
    ds_read_b64_tr_b16 a[198:199], v3 offset:54272
    v_cvt_pk_bf16_f32 v55, v34, v35
    v_mfma_f32_16x16x32_bf16 v[244:247], a[236:239], v[124:127], v[244:247]
    s_mov_b32 s46, 16384
    s_waitcnt lgkmcnt(8)
    buffer_load_dwordx4 v5, s[16:19], s46 offen offset:0 lds
    v_mfma_f32_16x16x32_bf16 v[216:219], a[240:243], v[112:115], v[216:219]
    ds_read_b64_tr_b16 a[200:201], v3 offset:36896
    v_fma_mix_f32 v36, v62, v24, v28 op_sel:[0,0,0] op_sel_hi:[1,0,0]
    v_mfma_f32_16x16x32_bf16 v[216:219], a[244:247], v[116:119], v[216:219]
    ds_read_b64_tr_b16 a[202:203], v3 offset:37408
    ds_read_b64_tr_b16 a[204:205], v3 offset:53792
    v_fma_mix_f32 v37, v62, v25, v29 op_sel:[1,0,0] op_sel_hi:[1,0,0]
    v_mfma_f32_16x16x32_bf16 v[248:251], a[240:243], v[120:123], v[248:251]
    s_add_u32 m0, s44, 110624
    ds_read_b64_tr_b16 a[206:207], v3 offset:54304
    v_fma_mix_f32 v38, v63, v26, v30 op_sel:[0,0,0] op_sel_hi:[1,0,0]
    v_mfma_f32_16x16x32_bf16 v[248:251], a[244:247], v[124:127], v[248:251]
    s_waitcnt lgkmcnt(8)
    buffer_load_dwordx4 v5, s[16:19], s46 offen offset:1024 lds
    v_mfma_f32_16x16x32_bf16 v[220:223], a[248:251], v[112:115], v[220:223]
    ds_read_b64_tr_b16 a[208:209], v3 offset:36928
    v_fma_mix_f32 v39, v63, v27, v31 op_sel:[1,0,0] op_sel_hi:[1,0,0]
    v_mfma_f32_16x16x32_bf16 v[220:223], a[252:255], v[116:119], v[220:223]
    ds_read_b64_tr_b16 a[210:211], v3 offset:37440
    ds_read_b64_tr_b16 a[212:213], v3 offset:53824
    v_cvt_pk_bf16_f32 v62, v36, v37
    v_mfma_f32_16x16x32_bf16 v[252:255], a[248:251], v[120:123], v[252:255]
    s_add_u32 m0, s44, 110656
    ds_read_b64_tr_b16 a[214:215], v3 offset:54336
    v_cvt_pk_bf16_f32 v63, v38, v39
    v_mfma_f32_16x16x32_bf16 v[252:255], a[252:255], v[124:127], v[252:255]
    s_waitcnt lgkmcnt(8)
    buffer_load_dwordx4 v5, s[16:19], s46 offen offset:2048 lds
    v_mfma_f32_16x16x32_bf16 v[128:131], a[192:195], v[48:51], v[128:131]
    ds_read_b64_tr_b16 a[216:217], v3 offset:36960
    v_mfma_f32_16x16x32_bf16 v[128:131], a[196:199], v[52:55], v[128:131]
    ds_read_b64_tr_b16 a[218:219], v3 offset:37472
    ds_read_b64_tr_b16 a[220:221], v3 offset:53856
    v_mfma_f32_16x16x32_bf16 v[160:163], a[192:195], v[56:59], v[160:163]
    s_add_u32 m0, s44, 110688
    ds_read_b64_tr_b16 a[222:223], v3 offset:54368
    v_mfma_f32_16x16x32_bf16 v[160:163], a[196:199], v[60:63], v[160:163]
    s_waitcnt lgkmcnt(8)
    buffer_load_dwordx4 v5, s[16:19], s46 offen offset:3072 lds
    v_mfma_f32_16x16x32_bf16 v[132:135], a[200:203], v[48:51], v[132:135]
    ds_read_b64_tr_b16 a[224:225], v3 offset:36992
    v_mfma_f32_16x16x32_bf16 v[132:135], a[204:207], v[52:55], v[132:135]
    ds_read_b64_tr_b16 a[226:227], v3 offset:37504
    ds_read_b64_tr_b16 a[228:229], v3 offset:53888
    v_mfma_f32_16x16x32_bf16 v[164:167], a[200:203], v[56:59], v[164:167]
    s_add_u32 m0, s44, 127488
    ds_read_b64_tr_b16 a[230:231], v3 offset:54400
    v_mfma_f32_16x16x32_bf16 v[164:167], a[204:207], v[60:63], v[164:167]
    s_waitcnt lgkmcnt(8)
    buffer_load_dwordx4 v5, s[20:23], s46 offen offset:0 lds
    v_mfma_f32_16x16x32_bf16 v[136:139], a[208:211], v[48:51], v[136:139]
    ds_read_b64_tr_b16 a[232:233], v3 offset:37024
    v_mfma_f32_16x16x32_bf16 v[136:139], a[212:215], v[52:55], v[136:139]
    ds_read_b64_tr_b16 a[234:235], v3 offset:37536
    ds_read_b64_tr_b16 a[236:237], v3 offset:53920
    v_mfma_f32_16x16x32_bf16 v[168:171], a[208:211], v[56:59], v[168:171]
    s_add_u32 m0, s44, 127520
    ds_read_b64_tr_b16 a[238:239], v3 offset:54432
    v_mfma_f32_16x16x32_bf16 v[168:171], a[212:215], v[60:63], v[168:171]
    s_waitcnt lgkmcnt(8)
    buffer_load_dwordx4 v5, s[20:23], s46 offen offset:1024 lds
    v_mfma_f32_16x16x32_bf16 v[140:143], a[216:219], v[48:51], v[140:143]
    ds_read_b64_tr_b16 a[240:241], v3 offset:37056
    v_cvt_pk_bf16_f32 v64, v128, v129
    v_mfma_f32_16x16x32_bf16 v[140:143], a[220:223], v[52:55], v[140:143]
    ds_read_b64_tr_b16 a[242:243], v3 offset:37568
    ds_read_b64_tr_b16 a[244:245], v3 offset:53952
    v_mfma_f32_16x16x32_bf16 v[172:175], a[216:219], v[56:59], v[172:175]
    s_add_u32 m0, s44, 127552
    ds_read_b64_tr_b16 a[246:247], v3 offset:54464
    v_cvt_pk_bf16_f32 v65, v130, v131
    v_mfma_f32_16x16x32_bf16 v[172:175], a[220:223], v[60:63], v[172:175]
    s_waitcnt lgkmcnt(8)
    buffer_load_dwordx4 v5, s[20:23], s46 offen offset:2048 lds
    v_mfma_f32_16x16x32_bf16 v[144:147], a[224:227], v[48:51], v[144:147]
    ds_read_b64_tr_b16 a[248:249], v3 offset:37088
    v_cvt_pk_bf16_f32 v66, v132, v133
    v_mfma_f32_16x16x32_bf16 v[144:147], a[228:231], v[52:55], v[144:147]
    ds_read_b64_tr_b16 a[250:251], v3 offset:37600
    ds_read_b64_tr_b16 a[252:253], v3 offset:53984
    v_mfma_f32_16x16x32_bf16 v[176:179], a[224:227], v[56:59], v[176:179]
    s_add_u32 m0, s44, 127584
    ds_read_b64_tr_b16 a[254:255], v3 offset:54496
    v_cvt_pk_bf16_f32 v67, v134, v135
    v_mfma_f32_16x16x32_bf16 v[176:179], a[228:231], v[60:63], v[176:179]
    s_waitcnt lgkmcnt(8)
    buffer_load_dwordx4 v5, s[20:23], s46 offen offset:3072 lds
    v_mfma_f32_16x16x32_bf16 v[148:151], a[232:235], v[48:51], v[148:151]
    ds_read_b64_tr_b16 a[192:193], v3 offset:37120
    v_cvt_pk_bf16_f32 v80, v160, v161
    v_mfma_f32_16x16x32_bf16 v[148:151], a[236:239], v[52:55], v[148:151]
    ds_read_b64_tr_b16 a[194:195], v3 offset:37632
    v_cvt_pk_bf16_f32 v81, v162, v163
    v_mfma_f32_16x16x32_bf16 v[180:183], a[232:235], v[56:59], v[180:183]
    ds_read_b64_tr_b16 a[196:197], v3 offset:54016
    v_cvt_pk_bf16_f32 v82, v164, v165
    v_mfma_f32_16x16x32_bf16 v[180:183], a[236:239], v[60:63], v[180:183]
    s_waitcnt lgkmcnt(7)
    ds_read_b64_tr_b16 a[198:199], v3 offset:54528
    v_cvt_pk_bf16_f32 v83, v166, v167
    v_mfma_f32_16x16x32_bf16 v[152:155], a[240:243], v[48:51], v[152:155]
    ds_read_b64_tr_b16 a[200:201], v3 offset:37152
    v_cvt_pk_bf16_f32 v68, v136, v137
    v_mfma_f32_16x16x32_bf16 v[152:155], a[244:247], v[52:55], v[152:155]
    ds_read_b64_tr_b16 a[202:203], v3 offset:37664
    v_cvt_pk_bf16_f32 v69, v138, v139
    v_mfma_f32_16x16x32_bf16 v[184:187], a[240:243], v[56:59], v[184:187]
    ds_read_b64_tr_b16 a[204:205], v3 offset:54048
    v_cvt_pk_bf16_f32 v70, v140, v141
    v_mfma_f32_16x16x32_bf16 v[184:187], a[244:247], v[60:63], v[184:187]
    s_waitcnt lgkmcnt(7)
    ds_read_b64_tr_b16 a[206:207], v3 offset:54560
    v_cvt_pk_bf16_f32 v71, v142, v143
    v_mfma_f32_16x16x32_bf16 v[156:159], a[248:251], v[48:51], v[156:159]
    ds_read_b64_tr_b16 a[208:209], v3 offset:37184
    v_cvt_pk_bf16_f32 v84, v168, v169
    v_mfma_f32_16x16x32_bf16 v[156:159], a[252:255], v[52:55], v[156:159]
    ds_read_b64_tr_b16 a[210:211], v3 offset:37696
    v_cvt_pk_bf16_f32 v85, v170, v171
    v_mfma_f32_16x16x32_bf16 v[188:191], a[248:251], v[56:59], v[188:191]
    ds_read_b64_tr_b16 a[212:213], v3 offset:54080
    v_cvt_pk_bf16_f32 v86, v172, v173
    v_mfma_f32_16x16x32_bf16 v[188:191], a[252:255], v[60:63], v[188:191]
    s_waitcnt lgkmcnt(7)
    ds_read_b64_tr_b16 a[214:215], v3 offset:54592
    v_cvt_pk_bf16_f32 v87, v174, v175
    v_mfma_f32_16x16x32_bf16 v[192:195], a[192:195], v[48:51], v[192:195]
    ds_read_b64_tr_b16 a[216:217], v3 offset:37216
    v_cvt_pk_bf16_f32 v72, v144, v145
    v_mfma_f32_16x16x32_bf16 v[192:195], a[196:199], v[52:55], v[192:195]
    ds_read_b64_tr_b16 a[218:219], v3 offset:37728
    v_cvt_pk_bf16_f32 v73, v146, v147
    v_mfma_f32_16x16x32_bf16 v[224:227], a[192:195], v[56:59], v[224:227]
    ds_read_b64_tr_b16 a[220:221], v3 offset:54112
    v_cvt_pk_bf16_f32 v74, v148, v149
    v_mfma_f32_16x16x32_bf16 v[224:227], a[196:199], v[60:63], v[224:227]
    s_waitcnt lgkmcnt(7)
    ds_read_b64_tr_b16 a[222:223], v3 offset:54624
    v_cvt_pk_bf16_f32 v75, v150, v151
    v_mfma_f32_16x16x32_bf16 v[196:199], a[200:203], v[48:51], v[196:199]
    ds_read_b64_tr_b16 a[224:225], v3 offset:37248
    v_cvt_pk_bf16_f32 v88, v176, v177
    v_mfma_f32_16x16x32_bf16 v[196:199], a[204:207], v[52:55], v[196:199]
    ds_read_b64_tr_b16 a[226:227], v3 offset:37760
    v_cvt_pk_bf16_f32 v89, v178, v179
    v_mfma_f32_16x16x32_bf16 v[228:231], a[200:203], v[56:59], v[228:231]
    ds_read_b64_tr_b16 a[228:229], v3 offset:54144
    v_cvt_pk_bf16_f32 v90, v180, v181
    v_mfma_f32_16x16x32_bf16 v[228:231], a[204:207], v[60:63], v[228:231]
    s_waitcnt lgkmcnt(7)
    ds_read_b64_tr_b16 a[230:231], v3 offset:54656
    v_cvt_pk_bf16_f32 v91, v182, v183
    v_mfma_f32_16x16x32_bf16 v[200:203], a[208:211], v[48:51], v[200:203]
    ds_read_b64_tr_b16 a[232:233], v3 offset:37280
    v_cvt_pk_bf16_f32 v76, v152, v153
    v_mfma_f32_16x16x32_bf16 v[200:203], a[212:215], v[52:55], v[200:203]
    ds_read_b64_tr_b16 a[234:235], v3 offset:37792
    v_cvt_pk_bf16_f32 v77, v154, v155
    v_mfma_f32_16x16x32_bf16 v[232:235], a[208:211], v[56:59], v[232:235]
    ds_read_b64_tr_b16 a[236:237], v3 offset:54176
    v_cvt_pk_bf16_f32 v78, v156, v157
    v_mfma_f32_16x16x32_bf16 v[232:235], a[212:215], v[60:63], v[232:235]
    s_waitcnt lgkmcnt(7)
    ds_read_b64_tr_b16 a[238:239], v3 offset:54688
    v_cvt_pk_bf16_f32 v79, v158, v159
    v_mfma_f32_16x16x32_bf16 v[204:207], a[216:219], v[48:51], v[204:207]
    ds_read_b64_tr_b16 a[240:241], v3 offset:37312
    v_cvt_pk_bf16_f32 v92, v184, v185
    v_mfma_f32_16x16x32_bf16 v[204:207], a[220:223], v[52:55], v[204:207]
    ds_read_b64_tr_b16 a[242:243], v3 offset:37824
    v_cvt_pk_bf16_f32 v93, v186, v187
    v_mfma_f32_16x16x32_bf16 v[236:239], a[216:219], v[56:59], v[236:239]
    ds_read_b64_tr_b16 a[244:245], v3 offset:54208
    v_cvt_pk_bf16_f32 v94, v188, v189
    v_mfma_f32_16x16x32_bf16 v[236:239], a[220:223], v[60:63], v[236:239]
    s_waitcnt lgkmcnt(7)
    ds_read_b64_tr_b16 a[246:247], v3 offset:54720
    v_cvt_pk_bf16_f32 v95, v190, v191
    v_mfma_f32_16x16x32_bf16 v[208:211], a[224:227], v[48:51], v[208:211]
    ds_read_b64_tr_b16 a[248:249], v3 offset:37344
    v_cvt_pk_bf16_f32 v96, v192, v193
    v_mfma_f32_16x16x32_bf16 v[208:211], a[228:231], v[52:55], v[208:211]
    ds_read_b64_tr_b16 a[250:251], v3 offset:37856
    v_cvt_pk_bf16_f32 v97, v194, v195
    v_mfma_f32_16x16x32_bf16 v[240:243], a[224:227], v[56:59], v[240:243]
    ds_read_b64_tr_b16 a[252:253], v3 offset:54240
    v_cvt_pk_bf16_f32 v98, v196, v197
    v_mfma_f32_16x16x32_bf16 v[240:243], a[228:231], v[60:63], v[240:243]
    s_waitcnt vmcnt(8)
    s_barrier
    s_waitcnt lgkmcnt(7)
    ds_read_b64_tr_b16 a[254:255], v3 offset:54752
    v_cvt_pk_bf16_f32 v99, v198, v199
    v_mfma_f32_16x16x32_bf16 v[212:215], a[232:235], v[48:51], v[212:215]
    ds_read_b128 a[64:67], v1 offset:0
    v_cvt_pk_bf16_f32 v112, v224, v225
    v_mfma_f32_16x16x32_bf16 v[212:215], a[236:239], v[52:55], v[212:215]
    ds_read_b128 a[68:71], v1 offset:64
    v_cvt_pk_bf16_f32 v113, v226, v227
    v_mfma_f32_16x16x32_bf16 v[244:247], a[232:235], v[56:59], v[244:247]
    s_add_u32 m0, s44, 0
    ds_read_b128 a[72:75], v1 offset:128
    v_cvt_pk_bf16_f32 v114, v228, v229
    v_mfma_f32_16x16x32_bf16 v[244:247], a[236:239], v[60:63], v[244:247]
    s_mov_b32 s46, 32768
    s_waitcnt lgkmcnt(7)
    buffer_load_dwordx4 v5, s[16:19], s46 offen offset:0 lds
    v_mfma_f32_16x16x32_bf16 v[216:219], a[240:243], v[48:51], v[216:219]
    ds_read_b128 a[76:79], v1 offset:192
    v_cvt_pk_bf16_f32 v115, v230, v231
    v_mfma_f32_16x16x32_bf16 v[216:219], a[244:247], v[52:55], v[216:219]
    ds_read_b128 a[80:83], v1 offset:256
    v_cvt_pk_bf16_f32 v100, v200, v201
    v_mfma_f32_16x16x32_bf16 v[248:251], a[240:243], v[56:59], v[248:251]
    s_add_u32 m0, s44, 32
    ds_read_b128 a[84:87], v1 offset:320
    v_cvt_pk_bf16_f32 v101, v202, v203
    v_mfma_f32_16x16x32_bf16 v[248:251], a[244:247], v[60:63], v[248:251]
    s_waitcnt lgkmcnt(6)
    buffer_load_dwordx4 v5, s[16:19], s46 offen offset:1024 lds
    v_mfma_f32_16x16x32_bf16 v[220:223], a[248:251], v[48:51], v[220:223]
    ds_read_b128 a[88:91], v1 offset:384
    v_cvt_pk_bf16_f32 v102, v204, v205
    v_mfma_f32_16x16x32_bf16 v[220:223], a[252:255], v[52:55], v[220:223]
    ds_read_b128 a[92:95], v1 offset:448
    v_cvt_pk_bf16_f32 v103, v206, v207
    v_mfma_f32_16x16x32_bf16 v[252:255], a[248:251], v[56:59], v[252:255]
    s_add_u32 m0, s44, 64
    ds_read_b128 a[96:99], v1 offset:512
    v_cvt_pk_bf16_f32 v116, v232, v233
    v_mfma_f32_16x16x32_bf16 v[252:255], a[252:255], v[60:63], v[252:255]
    buffer_load_dwordx4 v5, s[16:19], s46 offen offset:2048 lds
    v_mov_b32 v40, 0
    v_mov_b32 v52, 0
    v_mov_b32 v41, 0
    v_mov_b32 v53, 0
    v_mov_b32 v42, 0
    v_mov_b32 v54, 0
    v_mov_b32 v43, 0
    v_mov_b32 v55, 0
    s_mul_i32 s15, s51, 2304
    v_add_u32 v9, s15, v8
    v_lshlrev_b32 v14, 7, v0
    s_movk_i32 s3, 4608
    s_movk_i32 s14, 18432
    buffer_load_dwordx4 v[32:35], v9, s[84:87], s3 offen offset:0 sc1
    buffer_load_dwordx4 v[44:47], v9, s[84:87], s14 offen offset:0 sc1
    buffer_load_dwordx4 v[36:39], v9, s[84:87], s3 offen offset:1024 sc1
    buffer_load_dwordx4 v[48:51], v9, s[84:87], s14 offen offset:1024 sc1
    s_mov_b64 exec, 0xffff
    buffer_load_dwordx4 v[40:43], v9, s[84:87], s3 offen offset:2048 sc1
    buffer_load_dwordx4 v[52:55], v9, s[84:87], s14 offen offset:2048 sc1
    s_mov_b64 exec, -1
    s_add_u32 m0, s44, 96
    s_nop 0
    buffer_load_dwordx4 v5, s[16:19], s46 offen offset:3072 lds
    s_add_u32 m0, s44, 16896
    s_nop 0
    buffer_load_dwordx4 v5, s[20:23], s46 offen offset:0 lds
    s_add_u32 m0, s44, 16928
    s_nop 0
    buffer_load_dwordx4 v5, s[20:23], s46 offen offset:1024 lds
    s_add_u32 m0, s44, 16960
    s_nop 0
    buffer_load_dwordx4 v5, s[20:23], s46 offen offset:2048 lds
    s_add_u32 m0, s44, 16992
    s_nop 0
    buffer_load_dwordx4 v5, s[20:23], s46 offen offset:3072 lds
    buffer_load_dword a63, v14, s[36:39], 0 offen
    ds_read_b128 a[100:103], v1 offset:576
    ds_read_b128 a[104:107], v1 offset:640
    ds_read_b128 a[108:111], v1 offset:704
    ds_read_b128 a[112:115], v1 offset:768
    ds_read_b128 a[116:119], v1 offset:832
    ds_read_b128 a[120:123], v1 offset:896
    ds_read_b128 a[124:127], v1 offset:960
    ds_read_b64_tr_b16 a[128:129], v2 offset:0
    ds_read_b64_tr_b16 a[130:131], v2 offset:256
    ds_read_b64_tr_b16 a[132:133], v2 offset:512
    ds_read_b64_tr_b16 a[134:135], v2 offset:768
    ds_read_b64_tr_b16 a[136:137], v2 offset:32
    ds_read_b64_tr_b16 a[138:139], v2 offset:288
    ds_read_b64_tr_b16 a[140:141], v2 offset:544
    ds_read_b64_tr_b16 a[142:143], v2 offset:800
    ds_read_b64_tr_b16 a[144:145], v2 offset:64
    ds_read_b64_tr_b16 a[146:147], v2 offset:320
    ds_read_b64_tr_b16 a[148:149], v2 offset:576
    ds_read_b64_tr_b16 a[150:151], v2 offset:832
    ds_read_b64_tr_b16 a[152:153], v2 offset:96
    ds_read_b64_tr_b16 a[154:155], v2 offset:352
    ds_read_b64_tr_b16 a[156:157], v2 offset:608
    ds_read_b64_tr_b16 a[158:159], v2 offset:864
    ds_read_b64_tr_b16 a[160:161], v2 offset:128
    ds_read_b64_tr_b16 a[162:163], v2 offset:384
    ds_read_b64_tr_b16 a[164:165], v2 offset:640
    ds_read_b64_tr_b16 a[166:167], v2 offset:896
    ds_read_b64_tr_b16 a[168:169], v2 offset:160
    ds_read_b64_tr_b16 a[170:171], v2 offset:416
    ds_read_b64_tr_b16 a[172:173], v2 offset:672
    ds_read_b64_tr_b16 a[174:175], v2 offset:928
    ds_read_b64_tr_b16 a[176:177], v2 offset:192
    ds_read_b64_tr_b16 a[178:179], v2 offset:448
    ds_read_b64_tr_b16 a[180:181], v2 offset:704
    ds_read_b64_tr_b16 a[182:183], v2 offset:960
    ds_read_b64_tr_b16 a[184:185], v2 offset:224
    ds_read_b64_tr_b16 a[186:187], v2 offset:480
    ds_read_b64_tr_b16 a[188:189], v2 offset:736
    ds_read_b64_tr_b16 a[190:191], v2 offset:992
    v_cvt_pk_bf16_f32 v117, v234, v235
    v_cvt_pk_bf16_f32 v118, v236, v237
    v_cvt_pk_bf16_f32 v119, v238, v239
    v_cvt_pk_bf16_f32 v104, v208, v209
    v_cvt_pk_bf16_f32 v105, v210, v211
    v_cvt_pk_bf16_f32 v106, v212, v213
    v_cvt_pk_bf16_f32 v107, v214, v215
    v_cvt_pk_bf16_f32 v120, v240, v241
    v_cvt_pk_bf16_f32 v121, v242, v243
    v_cvt_pk_bf16_f32 v122, v244, v245
    v_cvt_pk_bf16_f32 v123, v246, v247
    v_cvt_pk_bf16_f32 v108, v216, v217
    v_cvt_pk_bf16_f32 v109, v218, v219
    v_cvt_pk_bf16_f32 v110, v220, v221
    v_cvt_pk_bf16_f32 v111, v222, v223
    v_cvt_pk_bf16_f32 v124, v248, v249
    v_cvt_pk_bf16_f32 v125, v250, v251
    v_cvt_pk_bf16_f32 v126, v252, v253
    v_cvt_pk_bf16_f32 v127, v254, v255
    s_nop 0
    v_permlane32_swap_b32 v64, v66
    v_permlane32_swap_b32 v65, v67
    v_permlane32_swap_b32 v80, v82
    v_permlane32_swap_b32 v81, v83
    v_permlane32_swap_b32 v68, v70
    v_permlane32_swap_b32 v69, v71
    v_permlane32_swap_b32 v84, v86
    v_permlane32_swap_b32 v85, v87
    v_permlane32_swap_b32 v72, v74
    v_permlane32_swap_b32 v73, v75
    v_permlane32_swap_b32 v88, v90
    v_permlane32_swap_b32 v89, v91
    v_permlane32_swap_b32 v76, v78
    v_permlane32_swap_b32 v77, v79
    v_permlane32_swap_b32 v92, v94
    v_permlane32_swap_b32 v93, v95
    v_permlane32_swap_b32 v96, v98
    v_permlane32_swap_b32 v97, v99
    v_permlane32_swap_b32 v112, v114
    v_permlane32_swap_b32 v113, v115
    v_permlane32_swap_b32 v100, v102
    v_permlane32_swap_b32 v101, v103
    v_permlane32_swap_b32 v116, v118
    v_permlane32_swap_b32 v117, v119
    v_permlane32_swap_b32 v104, v106
    v_permlane32_swap_b32 v105, v107
    v_permlane32_swap_b32 v120, v122
    v_permlane32_swap_b32 v121, v123
    v_permlane32_swap_b32 v108, v110
    v_permlane32_swap_b32 v109, v111
    v_permlane32_swap_b32 v124, v126
    v_permlane32_swap_b32 v125, v127
    s_waitcnt lgkmcnt(15)
    v_mfma_f32_16x16x32_bf16 v[16:19], a[64:67], v[64:67], 0
    v_mfma_f32_16x16x32_bf16 v[16:19], a[68:71], v[68:71], v[16:19]
    v_mfma_f32_16x16x32_bf16 v[16:19], a[72:75], v[72:75], v[16:19]
    v_mfma_f32_16x16x32_bf16 v[16:19], a[76:79], v[76:79], v[16:19]
    v_mfma_f32_16x16x32_bf16 v[20:23], a[64:67], v[80:83], 0
    v_mfma_f32_16x16x32_bf16 v[20:23], a[68:71], v[84:87], v[20:23]
    v_mfma_f32_16x16x32_bf16 v[20:23], a[72:75], v[88:91], v[20:23]
    v_mfma_f32_16x16x32_bf16 v[20:23], a[76:79], v[92:95], v[20:23]
    v_mfma_f32_16x16x32_bf16 v[24:27], a[64:67], v[96:99], 0
    v_mfma_f32_16x16x32_bf16 v[24:27], a[68:71], v[100:103], v[24:27]
    v_mfma_f32_16x16x32_bf16 v[24:27], a[72:75], v[104:107], v[24:27]
    v_mfma_f32_16x16x32_bf16 v[24:27], a[76:79], v[108:111], v[24:27]
    v_mfma_f32_16x16x32_bf16 v[28:31], a[64:67], v[112:115], 0
    v_mfma_f32_16x16x32_bf16 v[28:31], a[68:71], v[116:119], v[28:31]
    v_mfma_f32_16x16x32_bf16 v[28:31], a[72:75], v[120:123], v[28:31]
    v_mfma_f32_16x16x32_bf16 v[28:31], a[76:79], v[124:127], v[28:31]
    s_waitcnt vmcnt(6)
    v_max_u32 v13, v32, v33
    v_max3_u32 v13, v13, v34, v35
    v_max3_u32 v13, v13, v36, v37
    v_max3_u32 v13, v13, v38, v39
    v_max3_u32 v13, v13, v40, v41
    v_max3_u32 v13, v13, v42, v43
    v_max3_u32 v13, v13, v44, v45
    v_max3_u32 v13, v13, v46, v47
    v_max3_u32 v13, v13, v48, v49
    v_max3_u32 v13, v13, v50, v51
    v_max3_u32 v13, v13, v52, v53
    v_max3_u32 v13, v13, v54, v55
    v_cmp_eq_u32 vcc, -1, v13
    s_nop 0
    s_cmp_lg_u64 vcc, 0
    s_cbranch_scc1 L2_pns
L2_pnr:
    v_pk_add_f32 v[32:33], v[32:33], v[44:45]
    v_pk_add_f32 v[34:35], v[34:35], v[46:47]
    v_pk_add_f32 v[36:37], v[36:37], v[48:49]
    v_pk_add_f32 v[38:39], v[38:39], v[50:51]
    v_pk_add_f32 v[40:41], v[40:41], v[52:53]
    v_pk_add_f32 v[42:43], v[42:43], v[54:55]
    ds_write_b128 v9, v[32:35] offset:0
    ds_write_b128 v9, v[36:39] offset:1024
    s_mov_b64 exec, 0xffff
    ds_write_b128 v9, v[40:43] offset:2048
    s_mov_b64 exec, -1
    v_max3_f32 v16, v16, v17, v18
    v_max_f32 v16, v16, v19
    v_max3_f32 v20, v20, v21, v22
    v_max_f32 v20, v20, v23
    v_max3_f32 v24, v24, v25, v26
    v_max_f32 v24, v24, v27
    v_max3_f32 v28, v28, v29, v30
    v_max_f32 v28, v28, v31
    v_mov_b32 v12, v16
    v_mov_b32 v13, v20
    v_mov_b32 v14, v24
    v_mov_b32 v15, v28
    v_permlane16_swap_b32 v12, v16
    v_permlane16_swap_b32 v13, v20
    v_permlane16_swap_b32 v14, v24
    v_permlane16_swap_b32 v15, v28
    v_max_f32 v16, v16, v12
    v_max_f32 v20, v20, v13
    v_max_f32 v24, v24, v14
    v_max_f32 v28, v28, v15
    v_mov_b32 v12, v16
    v_mov_b32 v13, v20
    v_mov_b32 v14, v24
    v_mov_b32 v15, v28
    v_permlane32_swap_b32 v12, v16
    v_permlane32_swap_b32 v13, v20
    v_permlane32_swap_b32 v14, v24
    v_permlane32_swap_b32 v15, v28
    v_max_f32 v16, v16, v12
    v_max_f32 v20, v20, v13
    v_max_f32 v24, v24, v14
    v_max_f32 v28, v28, v15
    v_sub_f32 v48, 0xc2000000, v16
    v_sub_f32 v49, 0xc2000000, v16
    v_sub_f32 v50, 0xc2000000, v16
    v_sub_f32 v51, 0xc2000000, v16
    v_sub_f32 v52, 0xc2000000, v20
    v_sub_f32 v53, 0xc2000000, v20
    v_sub_f32 v54, 0xc2000000, v20
    v_sub_f32 v55, 0xc2000000, v20
    v_sub_f32 v56, 0xc2000000, v24
    v_sub_f32 v57, 0xc2000000, v24
    v_sub_f32 v58, 0xc2000000, v24
    v_sub_f32 v59, 0xc2000000, v24
    v_sub_f32 v60, 0xc2000000, v28
    v_sub_f32 v61, 0xc2000000, v28
    v_sub_f32 v62, 0xc2000000, v28
    v_sub_f32 v63, 0xc2000000, v28
L2_entry:
    v_accvgpr_write_b32 a0, 0
    v_accvgpr_write_b32 a1, 0
    v_accvgpr_write_b32 a2, 0
    v_accvgpr_write_b32 a3, 0
    v_accvgpr_write_b32 a4, 0
    v_accvgpr_write_b32 a5, 0
    v_accvgpr_write_b32 a6, 0
    v_accvgpr_write_b32 a7, 0
    v_accvgpr_write_b32 a8, 0
    v_accvgpr_write_b32 a9, 0
    v_accvgpr_write_b32 a10, 0
    v_accvgpr_write_b32 a11, 0
    v_accvgpr_write_b32 a12, 0
    v_accvgpr_write_b32 a13, 0
    v_accvgpr_write_b32 a14, 0
    v_accvgpr_write_b32 a15, 0
    v_mov_b32 v224, 0
    v_mov_b32 v225, 0
    v_mov_b32 v226, 0
    v_mov_b32 v227, 0
    v_mov_b32 v228, 0
    v_mov_b32 v229, 0
    v_mov_b32 v230, 0
    v_mov_b32 v231, 0
    v_mov_b32 v232, 0
    v_mov_b32 v233, 0
    v_mov_b32 v234, 0
    v_mov_b32 v235, 0
    v_mov_b32 v236, 0
    v_mov_b32 v237, 0
    v_mov_b32 v238, 0
    v_mov_b32 v239, 0
    v_mov_b32 v240, 0
    v_mov_b32 v241, 0
    v_mov_b32 v242, 0
    v_mov_b32 v243, 0
    v_mov_b32 v244, 0
    v_mov_b32 v245, 0
    v_mov_b32 v246, 0
    v_mov_b32 v247, 0
    v_mov_b32 v248, 0
    v_mov_b32 v249, 0
    v_mov_b32 v250, 0
    v_mov_b32 v251, 0
    v_mov_b32 v252, 0
    v_mov_b32 v253, 0
    v_mov_b32 v254, 0
    v_mov_b32 v255, 0
    s_mov_b32 s47, s44
    s_mov_b32 s48, -73728
    s_mov_b32 s49, 15
    s_mov_b32 s46, 49152
    v_lshrrev_b32 v14, 2, v0
    s_mul_i32 s3, s51, 144
    v_add_u32 v14, s3, v14
    v_mul_u32_u24 v14, 9216, v14
    v_and_b32 v15, 3, v0
    v_lshl_add_u32 v6, v15, 4, v14
    s_lshr_b32 s3, s2, 3
    s_lshl_b32 s3, s3, 2
    s_add_u32 s3, s3, s51
    s_and_b32 s15, s2, 7
    s_mul_i32 s14, s3, 9
    s_lshr_b32 s14, s14, 1
    v_min_u32 v15, 44, v0
    v_mul_u32_u24 v12, 7282, v15
    v_lshrrev_b32 v12, 16, v12
    v_mul_u32_u24 v13, 63, v12
    v_add_u32 v12, v15, v13
    s_mul_i32 s14, s14, 72
    s_mul_i32 s56, s15, 9
    s_add_u32 s14, s14, s56
    v_add_u32 v12, s14, v12
    v_lshlrev_b32 v12, 7, v12
    s_mul_i32 s14, s3, 81
    s_lshr_b32 s14, s14, 1
    s_mul_i32 s56, s15, 5184
    s_add_u32 s14, s14, s56
    v_min_u32 v13, 40, v0
    v_add_u32 v13, s14, v13
    v_lshlrev_b32 v13, 7, v13
    s_mul_i32 s14, s3, 72
    s_andn2_b32 s56, s52, 3
    s_mul_i32 s56, s56, 2304
    s_add_u32 s14, s14, s56
    v_min_u32 v14, 35, v0
    v_add_u32 v14, s14, v14
    v_lshlrev_b32 v14, 7, v14
    v_add_u32 v15, 4608, v14
    s_waitcnt lgkmcnt(0)
    s_barrier
    v_mfma_f32_16x16x32_bf16 v[16:19], a[64:67], v[64:67], v[48:51]
    v_mfma_f32_16x16x32_bf16 v[16:19], a[68:71], v[68:71], v[16:19]
    v_mfma_f32_16x16x32_bf16 v[16:19], a[72:75], v[72:75], v[16:19]
    s_add_u32 m0, s47, 36864
    v_mfma_f32_16x16x32_bf16 v[16:19], a[76:79], v[76:79], v[16:19]
    buffer_load_dwordx4 v5, s[16:19], s46 offen offset:0 lds
    v_mfma_f32_16x16x32_bf16 v[20:23], a[80:83], v[64:67], v[48:51]
    v_mfma_f32_16x16x32_bf16 v[20:23], a[84:87], v[68:71], v[20:23]
    v_mfma_f32_16x16x32_bf16 v[20:23], a[88:91], v[72:75], v[20:23]
    s_add_u32 m0, s47, 36896
    v_mfma_f32_16x16x32_bf16 v[20:23], a[92:95], v[76:79], v[20:23]
    buffer_load_dwordx4 v5, s[16:19], s46 offen offset:1024 lds
    v_mfma_f32_16x16x32_bf16 v[24:27], a[96:99], v[64:67], v[48:51]
    s_nop 1
    v_exp_f32 v16, v16
    v_mfma_f32_16x16x32_bf16 v[24:27], a[100:103], v[68:71], v[24:27]
    v_mfma_f32_16x16x32_bf16 v[24:27], a[104:107], v[72:75], v[24:27]
    s_add_u32 m0, s47, 36928
    v_exp_f32 v17, v17
    v_mfma_f32_16x16x32_bf16 v[24:27], a[108:111], v[76:79], v[24:27]
    buffer_load_dwordx4 v5, s[16:19], s46 offen offset:2048 lds
    v_mfma_f32_16x16x32_bf16 v[28:31], a[112:115], v[64:67], v[48:51]
    v_exp_f32 v18, v18
    v_mfma_f32_16x16x32_bf16 v[28:31], a[116:119], v[68:71], v[28:31]
    v_cvt_pk_bf16_f32 v32, v16, v17
    v_mfma_f32_16x16x32_bf16 v[28:31], a[120:123], v[72:75], v[28:31]
    s_add_u32 m0, s47, 36960
    v_exp_f32 v19, v19
    v_mfma_f32_16x16x32_bf16 v[28:31], a[124:127], v[76:79], v[28:31]
    buffer_load_dwordx4 v5, s[16:19], s46 offen offset:3072 lds
    s_nop 3
    v_exp_f32 v20, v20
    s_nop 0
    ds_read_b64_tr_b16 a[192:193], v2 offset:36864
    v_cvt_pk_bf16_f32 v33, v18, v19
    s_add_u32 m0, s47, 53760
    v_exp_f32 v21, v21
    s_nop 0
    buffer_load_dwordx4 v5, s[20:23], s46 offen offset:0 lds
    v_exp_f32 v22, v22
    s_nop 0
    ds_read_b64_tr_b16 a[194:195], v2 offset:37120
    v_cvt_pk_bf16_f32 v34, v20, v21
    s_add_u32 m0, s47, 53792
    v_exp_f32 v23, v23
    s_nop 0
    buffer_load_dwordx4 v5, s[20:23], s46 offen offset:1024 lds
    v_exp_f32 v24, v24
    s_nop 0
    ds_read_b64_tr_b16 a[196:197], v2 offset:37376
    v_cvt_pk_bf16_f32 v35, v22, v23
    s_add_u32 m0, s47, 53824
    v_exp_f32 v25, v25
    s_nop 0
    buffer_load_dwordx4 v5, s[20:23], s46 offen offset:2048 lds
    v_exp_f32 v26, v26
    s_nop 0
    ds_read_b64_tr_b16 a[198:199], v2 offset:37632
    v_cvt_pk_bf16_f32 v36, v24, v25
    s_add_u32 m0, s47, 53856
    v_exp_f32 v27, v27
    s_nop 0
    buffer_load_dwordx4 v5, s[20:23], s46 offen offset:3072 lds
    ds_read_b64_tr_b16 a[200:201], v2 offset:36896
    s_nop 0
    v_mfma_f32_16x16x32_bf16 v[16:19], a[64:67], v[80:83], v[52:55]
    v_exp_f32 v28, v28
    v_mfma_f32_16x16x32_bf16 v[16:19], a[68:71], v[84:87], v[16:19]
    ds_read_b64_tr_b16 a[202:203], v2 offset:37152
    v_cvt_pk_bf16_f32 v37, v26, v27
    v_mfma_f32_16x16x32_bf16 v[16:19], a[72:75], v[88:91], v[16:19]
    v_exp_f32 v29, v29
    v_mfma_f32_16x16x32_bf16 v[16:19], a[76:79], v[92:95], v[16:19]
    ds_read_b64_tr_b16 a[204:205], v2 offset:37408
    v_mfma_f32_16x16x32_bf16 v[20:23], a[80:83], v[80:83], v[52:55]
    v_exp_f32 v30, v30
    v_mfma_f32_16x16x32_bf16 v[20:23], a[84:87], v[84:87], v[20:23]
    ds_read_b64_tr_b16 a[206:207], v2 offset:37664
    v_cvt_pk_bf16_f32 v38, v28, v29
    v_mfma_f32_16x16x32_bf16 v[20:23], a[88:91], v[88:91], v[20:23]
    v_exp_f32 v31, v31
    v_mfma_f32_16x16x32_bf16 v[20:23], a[92:95], v[92:95], v[20:23]
    ds_read_b64_tr_b16 a[208:209], v2 offset:36928
    v_mfma_f32_16x16x32_bf16 v[24:27], a[96:99], v[80:83], v[52:55]
    v_exp_f32 v16, v16
    v_mfma_f32_16x16x32_bf16 v[24:27], a[100:103], v[84:87], v[24:27]
    ds_read_b64_tr_b16 a[210:211], v2 offset:37184
    v_cvt_pk_bf16_f32 v39, v30, v31
    v_mfma_f32_16x16x32_bf16 v[24:27], a[104:107], v[88:91], v[24:27]
    v_exp_f32 v17, v17
    v_mfma_f32_16x16x32_bf16 v[24:27], a[108:111], v[92:95], v[24:27]
    ds_read_b64_tr_b16 a[212:213], v2 offset:37440
    v_mfma_f32_16x16x32_bf16 v[28:31], a[112:115], v[80:83], v[52:55]
    v_exp_f32 v18, v18
    v_mfma_f32_16x16x32_bf16 v[28:31], a[116:119], v[84:87], v[28:31]
    ds_read_b64_tr_b16 a[214:215], v2 offset:37696
    v_cvt_pk_bf16_f32 v40, v16, v17
    v_mfma_f32_16x16x32_bf16 v[28:31], a[120:123], v[88:91], v[28:31]
    v_exp_f32 v19, v19
    v_mfma_f32_16x16x32_bf16 v[28:31], a[124:127], v[92:95], v[28:31]
    ds_read_b64_tr_b16 a[216:217], v2 offset:36960
    v_mfma_f32_16x16x32_bf16 v[128:131], a[128:131], v[32:35], 0
    v_exp_f32 v20, v20
    v_mfma_f32_16x16x32_bf16 v[128:131], a[132:135], v[36:39], v[128:131]
    ds_read_b64_tr_b16 a[218:219], v2 offset:37216
    v_cvt_pk_bf16_f32 v41, v18, v19
    v_mfma_f32_16x16x32_bf16 v[132:135], a[136:139], v[32:35], 0
    v_exp_f32 v21, v21
    v_mfma_f32_16x16x32_bf16 v[132:135], a[140:143], v[36:39], v[132:135]
    ds_read_b64_tr_b16 a[220:221], v2 offset:37472
    v_mfma_f32_16x16x32_bf16 v[136:139], a[144:147], v[32:35], 0
    v_exp_f32 v22, v22
    v_mfma_f32_16x16x32_bf16 v[136:139], a[148:151], v[36:39], v[136:139]
    ds_read_b64_tr_b16 a[222:223], v2 offset:37728
    v_cvt_pk_bf16_f32 v42, v20, v21
    v_mfma_f32_16x16x32_bf16 v[140:143], a[152:155], v[32:35], 0
    v_exp_f32 v23, v23
    v_mfma_f32_16x16x32_bf16 v[140:143], a[156:159], v[36:39], v[140:143]
    ds_read_b64_tr_b16 a[224:225], v2 offset:36992
    v_mfma_f32_16x16x32_bf16 v[144:147], a[160:163], v[32:35], 0
    v_exp_f32 v24, v24
    v_mfma_f32_16x16x32_bf16 v[144:147], a[164:167], v[36:39], v[144:147]
    ds_read_b64_tr_b16 a[226:227], v2 offset:37248
    v_cvt_pk_bf16_f32 v43, v22, v23
    v_mfma_f32_16x16x32_bf16 v[148:151], a[168:171], v[32:35], 0
    v_exp_f32 v25, v25
    v_mfma_f32_16x16x32_bf16 v[148:151], a[172:175], v[36:39], v[148:151]
    ds_read_b64_tr_b16 a[228:229], v2 offset:37504
    v_mfma_f32_16x16x32_bf16 v[152:155], a[176:179], v[32:35], 0
    v_exp_f32 v26, v26
    v_mfma_f32_16x16x32_bf16 v[152:155], a[180:183], v[36:39], v[152:155]
    ds_read_b64_tr_b16 a[230:231], v2 offset:37760
    v_cvt_pk_bf16_f32 v44, v24, v25
    v_mfma_f32_16x16x32_bf16 v[156:159], a[184:187], v[32:35], 0
    v_exp_f32 v27, v27
    v_mfma_f32_16x16x32_bf16 v[156:159], a[188:191], v[36:39], v[156:159]
    ds_read_b64_tr_b16 a[232:233], v2 offset:37024
    v_smfmac_f32_16x16x64_bf16 a[0:3], a[16:19], v[32:39], v11
    ds_read_b64_tr_b16 a[234:235], v2 offset:37280
    v_mfma_f32_16x16x32_bf16 v[16:19], a[64:67], v[96:99], v[56:59]
    v_exp_f32 v28, v28
    v_mfma_f32_16x16x32_bf16 v[16:19], a[68:71], v[100:103], v[16:19]
    ds_read_b64_tr_b16 a[236:237], v2 offset:37536
    v_cvt_pk_bf16_f32 v45, v26, v27
    v_mfma_f32_16x16x32_bf16 v[16:19], a[72:75], v[104:107], v[16:19]
    v_exp_f32 v29, v29
    v_mfma_f32_16x16x32_bf16 v[16:19], a[76:79], v[108:111], v[16:19]
    ds_read_b64_tr_b16 a[238:239], v2 offset:37792
    v_mfma_f32_16x16x32_bf16 v[20:23], a[80:83], v[96:99], v[56:59]
    v_exp_f32 v30, v30
    v_mfma_f32_16x16x32_bf16 v[20:23], a[84:87], v[100:103], v[20:23]
    ds_read_b64_tr_b16 a[240:241], v2 offset:37056
    v_cvt_pk_bf16_f32 v46, v28, v29
    v_mfma_f32_16x16x32_bf16 v[20:23], a[88:91], v[104:107], v[20:23]
    v_exp_f32 v31, v31
    v_mfma_f32_16x16x32_bf16 v[20:23], a[92:95], v[108:111], v[20:23]
    ds_read_b64_tr_b16 a[242:243], v2 offset:37312
    v_mfma_f32_16x16x32_bf16 v[24:27], a[96:99], v[96:99], v[56:59]
    v_exp_f32 v16, v16
    v_mfma_f32_16x16x32_bf16 v[24:27], a[100:103], v[100:103], v[24:27]
    ds_read_b64_tr_b16 a[244:245], v2 offset:37568
    v_cvt_pk_bf16_f32 v47, v30, v31
    v_mfma_f32_16x16x32_bf16 v[24:27], a[104:107], v[104:107], v[24:27]
    v_exp_f32 v17, v17
    v_mfma_f32_16x16x32_bf16 v[24:27], a[108:111], v[108:111], v[24:27]
    ds_read_b64_tr_b16 a[246:247], v2 offset:37824
    v_mfma_f32_16x16x32_bf16 v[28:31], a[112:115], v[96:99], v[56:59]
    v_exp_f32 v18, v18
    v_mfma_f32_16x16x32_bf16 v[28:31], a[116:119], v[100:103], v[28:31]
    ds_read_b64_tr_b16 a[248:249], v2 offset:37088
    v_cvt_pk_bf16_f32 v32, v16, v17
    v_mfma_f32_16x16x32_bf16 v[28:31], a[120:123], v[104:107], v[28:31]
    v_exp_f32 v19, v19
    v_mfma_f32_16x16x32_bf16 v[28:31], a[124:127], v[108:111], v[28:31]
    ds_read_b64_tr_b16 a[250:251], v2 offset:37344
    v_mfma_f32_16x16x32_bf16 v[160:163], a[128:131], v[40:43], 0
    v_exp_f32 v20, v20
    v_mfma_f32_16x16x32_bf16 v[160:163], a[132:135], v[44:47], v[160:163]
    ds_read_b64_tr_b16 a[252:253], v2 offset:37600
    v_cvt_pk_bf16_f32 v33, v18, v19
    v_mfma_f32_16x16x32_bf16 v[164:167], a[136:139], v[40:43], 0
    v_exp_f32 v21, v21
    v_mfma_f32_16x16x32_bf16 v[164:167], a[140:143], v[44:47], v[164:167]
    ds_read_b64_tr_b16 a[254:255], v2 offset:37856
    v_mfma_f32_16x16x32_bf16 v[168:171], a[144:147], v[40:43], 0
    v_exp_f32 v22, v22
    v_mfma_f32_16x16x32_bf16 v[168:171], a[148:151], v[44:47], v[168:171]
    v_cvt_pk_bf16_f32 v34, v20, v21
    v_mfma_f32_16x16x32_bf16 v[172:175], a[152:155], v[40:43], 0
    v_exp_f32 v23, v23
    v_mfma_f32_16x16x32_bf16 v[172:175], a[156:159], v[44:47], v[172:175]
    v_mfma_f32_16x16x32_bf16 v[176:179], a[160:163], v[40:43], 0
    v_exp_f32 v24, v24
    v_mfma_f32_16x16x32_bf16 v[176:179], a[164:167], v[44:47], v[176:179]
    v_cvt_pk_bf16_f32 v35, v22, v23
    v_mfma_f32_16x16x32_bf16 v[180:183], a[168:171], v[40:43], 0
    v_exp_f32 v25, v25
    v_mfma_f32_16x16x32_bf16 v[180:183], a[172:175], v[44:47], v[180:183]
    v_mfma_f32_16x16x32_bf16 v[184:187], a[176:179], v[40:43], 0
    v_exp_f32 v26, v26
    v_mfma_f32_16x16x32_bf16 v[184:187], a[180:183], v[44:47], v[184:187]
    v_cvt_pk_bf16_f32 v36, v24, v25
    v_mfma_f32_16x16x32_bf16 v[188:191], a[184:187], v[40:43], 0
    v_exp_f32 v27, v27
    v_mfma_f32_16x16x32_bf16 v[188:191], a[188:191], v[44:47], v[188:191]
    v_smfmac_f32_16x16x64_bf16 a[4:7], a[16:19], v[40:47], v11
    v_mfma_f32_16x16x32_bf16 v[16:19], a[64:67], v[112:115], v[60:63]
    v_exp_f32 v28, v28
    v_mfma_f32_16x16x32_bf16 v[16:19], a[68:71], v[116:119], v[16:19]
    s_add_u32 s46, s46, 16384
    ds_read_b128 a[64:67], v1 offset:36864
    v_cvt_pk_bf16_f32 v37, v26, v27
    v_mfma_f32_16x16x32_bf16 v[16:19], a[72:75], v[120:123], v[16:19]
    s_min_u32 s46, s46, 507904
    v_exp_f32 v29, v29
    v_mfma_f32_16x16x32_bf16 v[16:19], a[76:79], v[124:127], v[16:19]
    ds_read_b128 a[68:71], v1 offset:36928
    v_mfma_f32_16x16x32_bf16 v[20:23], a[80:83], v[112:115], v[60:63]
    v_exp_f32 v30, v30
    v_mfma_f32_16x16x32_bf16 v[20:23], a[84:87], v[116:119], v[20:23]
    ds_read_b128 a[72:75], v1 offset:36992
    v_cvt_pk_bf16_f32 v38, v28, v29
    v_mfma_f32_16x16x32_bf16 v[20:23], a[88:91], v[120:123], v[20:23]
    v_exp_f32 v31, v31
    v_mfma_f32_16x16x32_bf16 v[20:23], a[92:95], v[124:127], v[20:23]
    ds_read_b128 a[76:79], v1 offset:37056
    v_mfma_f32_16x16x32_bf16 v[24:27], a[96:99], v[112:115], v[60:63]
    v_exp_f32 v16, v16
    v_mfma_f32_16x16x32_bf16 v[24:27], a[100:103], v[116:119], v[24:27]
    ds_read_b128 a[80:83], v1 offset:37120
    v_cvt_pk_bf16_f32 v39, v30, v31
    v_mfma_f32_16x16x32_bf16 v[24:27], a[104:107], v[120:123], v[24:27]
    v_exp_f32 v17, v17
    v_mfma_f32_16x16x32_bf16 v[24:27], a[108:111], v[124:127], v[24:27]
    ds_read_b128 a[84:87], v1 offset:37184
    v_mfma_f32_16x16x32_bf16 v[28:31], a[112:115], v[112:115], v[60:63]
    v_exp_f32 v18, v18
    v_mfma_f32_16x16x32_bf16 v[28:31], a[116:119], v[116:119], v[28:31]
    ds_read_b128 a[88:91], v1 offset:37248
    v_cvt_pk_bf16_f32 v40, v16, v17
    v_mfma_f32_16x16x32_bf16 v[28:31], a[120:123], v[120:123], v[28:31]
    v_exp_f32 v19, v19
    v_mfma_f32_16x16x32_bf16 v[28:31], a[124:127], v[124:127], v[28:31]
    ds_read_b128 a[92:95], v1 offset:37312
    v_mfma_f32_16x16x32_bf16 v[192:195], a[128:131], v[32:35], 0
    v_exp_f32 v20, v20
    v_mfma_f32_16x16x32_bf16 v[192:195], a[132:135], v[36:39], v[192:195]
    ds_read_b128 a[96:99], v1 offset:37376
    v_cvt_pk_bf16_f32 v41, v18, v19
    v_mfma_f32_16x16x32_bf16 v[196:199], a[136:139], v[32:35], 0
    v_exp_f32 v21, v21
    v_mfma_f32_16x16x32_bf16 v[196:199], a[140:143], v[36:39], v[196:199]
    ds_read_b128 a[100:103], v1 offset:37440
    v_mfma_f32_16x16x32_bf16 v[200:203], a[144:147], v[32:35], 0
    v_exp_f32 v22, v22
    v_mfma_f32_16x16x32_bf16 v[200:203], a[148:151], v[36:39], v[200:203]
    ds_read_b128 a[104:107], v1 offset:37504
    v_cvt_pk_bf16_f32 v42, v20, v21
    v_mfma_f32_16x16x32_bf16 v[204:207], a[152:155], v[32:35], 0
    v_exp_f32 v23, v23
    v_mfma_f32_16x16x32_bf16 v[204:207], a[156:159], v[36:39], v[204:207]
    ds_read_b128 a[108:111], v1 offset:37568
    v_mfma_f32_16x16x32_bf16 v[208:211], a[160:163], v[32:35], 0
    v_exp_f32 v24, v24
    v_mfma_f32_16x16x32_bf16 v[208:211], a[164:167], v[36:39], v[208:211]
    ds_read_b128 a[112:115], v1 offset:37632
    v_cvt_pk_bf16_f32 v43, v22, v23
    v_mfma_f32_16x16x32_bf16 v[212:215], a[168:171], v[32:35], 0
    v_exp_f32 v25, v25
    v_mfma_f32_16x16x32_bf16 v[212:215], a[172:175], v[36:39], v[212:215]
    ds_read_b128 a[116:119], v1 offset:37696
    v_mfma_f32_16x16x32_bf16 v[216:219], a[176:179], v[32:35], 0
    v_exp_f32 v26, v26
    v_mfma_f32_16x16x32_bf16 v[216:219], a[180:183], v[36:39], v[216:219]
    ds_read_b128 a[120:123], v1 offset:37760
    v_cvt_pk_bf16_f32 v44, v24, v25
    v_mfma_f32_16x16x32_bf16 v[220:223], a[184:187], v[32:35], 0
    v_exp_f32 v27, v27
    v_mfma_f32_16x16x32_bf16 v[220:223], a[188:191], v[36:39], v[220:223]
    ds_read_b128 a[124:127], v1 offset:37824
    v_smfmac_f32_16x16x64_bf16 a[8:11], a[16:19], v[32:39], v11
    s_waitcnt vmcnt(9) lgkmcnt(12)
    s_barrier
    s_branch L2_loop
L2_pf:
    s_cmp_lg_u32 s49, 5
    s_cbranch_scc1 L2_pf5
    global_load_dword a63, v12, s[4:5]
    s_branch L2_pfret
L2_pf5:
    s_cmp_lg_u32 s49, 4
    s_cbranch_scc1 L2_pf4
    global_load_dword a63, v12, s[6:7]
    s_branch L2_pfret
L2_pf4:
    s_cmp_lg_u32 s49, 3
    s_cbranch_scc1 L2_pf3
    global_load_dword a63, v13, s[8:9]
    s_branch L2_pfret
L2_pf3:
    s_cmp_lg_u32 s49, 2
    s_cbranch_scc1 L2_pf2
    global_load_dword a63, v14, s[10:11]
    s_branch L2_pfret
L2_pf2:
    s_cmp_lg_u32 s49, 1
    s_cbranch_scc1 L2_pf1
    global_load_dword a63, v15, s[10:11]
    s_branch L2_pfret
L2_pf1:
    s_branch L2_pfret
.p2align 5
L2_loop:
    v_mfma_f32_16x16x32_bf16 v[16:19], a[64:67], v[64:67], v[48:51]
    s_sub_u32 s47, s47, s48
    v_exp_f32 v28, v28
    v_mfma_f32_16x16x32_bf16 v[16:19], a[68:71], v[68:71], v[16:19]
    v_cvt_pk_bf16_f32 v45, v26, v27
    v_add_u32 v1, s48, v1
    v_mfma_f32_16x16x32_bf16 v[16:19], a[72:75], v[72:75], v[16:19]
    s_add_u32 m0, s47, 0
    v_exp_f32 v29, v29
    v_mfma_f32_16x16x32_bf16 v[16:19], a[76:79], v[76:79], v[16:19]
    s_waitcnt lgkmcnt(8)
    buffer_load_dwordx4 v5, s[16:19], s46 offen offset:0 lds
    v_mfma_f32_16x16x32_bf16 v[20:23], a[80:83], v[64:67], v[48:51]
    v_exp_f32 v30, v30
    v_mfma_f32_16x16x32_bf16 v[20:23], a[84:87], v[68:71], v[20:23]
    v_cvt_pk_bf16_f32 v46, v28, v29
    v_add_u32 v2, s48, v2
    v_mfma_f32_16x16x32_bf16 v[20:23], a[88:91], v[72:75], v[20:23]
    s_add_u32 m0, s47, 32
    v_exp_f32 v31, v31
    v_mfma_f32_16x16x32_bf16 v[20:23], a[92:95], v[76:79], v[20:23]
    s_waitcnt lgkmcnt(4)
    buffer_load_dwordx4 v5, s[16:19], s46 offen offset:1024 lds
    v_mfma_f32_16x16x32_bf16 v[24:27], a[96:99], v[64:67], v[48:51]
    s_sub_u32 s48, 0, s48
    v_exp_f32 v16, v16
    v_mfma_f32_16x16x32_bf16 v[24:27], a[100:103], v[68:71], v[24:27]
    v_cvt_pk_bf16_f32 v47, v30, v31
    v_mfma_f32_16x16x32_bf16 v[24:27], a[104:107], v[72:75], v[24:27]
    s_add_u32 m0, s47, 64
    v_exp_f32 v17, v17
    v_mfma_f32_16x16x32_bf16 v[24:27], a[108:111], v[76:79], v[24:27]
    s_waitcnt lgkmcnt(0)
    buffer_load_dwordx4 v5, s[16:19], s46 offen offset:2048 lds
    v_mfma_f32_16x16x32_bf16 v[28:31], a[112:115], v[64:67], v[48:51]
    v_exp_f32 v18, v18
    v_mfma_f32_16x16x32_bf16 v[28:31], a[116:119], v[68:71], v[28:31]
    v_cvt_pk_bf16_f32 v32, v16, v17
    v_mfma_f32_16x16x32_bf16 v[28:31], a[120:123], v[72:75], v[28:31]
    s_add_u32 m0, s47, 96
    v_exp_f32 v19, v19
    v_mfma_f32_16x16x32_bf16 v[28:31], a[124:127], v[76:79], v[28:31]
    buffer_load_dwordx4 v5, s[16:19], s46 offen offset:3072 lds
    v_mfma_f32_16x16x32_bf16 v[224:227], a[128:131], v[40:43], v[224:227]
    v_exp_f32 v20, v20
    v_mfma_f32_16x16x32_bf16 v[224:227], a[132:135], v[44:47], v[224:227]
    ds_read_b64_tr_b16 a[128:129], v2 offset:0
    v_cvt_pk_bf16_f32 v33, v18, v19
    v_mfma_f32_16x16x32_bf16 v[228:231], a[136:139], v[40:43], v[228:231]
    s_add_u32 m0, s47, 16896
    v_exp_f32 v21, v21
    v_mfma_f32_16x16x32_bf16 v[228:231], a[140:143], v[44:47], v[228:231]
    buffer_load_dwordx4 v5, s[20:23], s46 offen offset:0 lds
    v_mfma_f32_16x16x32_bf16 v[232:235], a[144:147], v[40:43], v[232:235]
    v_exp_f32 v22, v22
    v_mfma_f32_16x16x32_bf16 v[232:235], a[148:151], v[44:47], v[232:235]
    ds_read_b64_tr_b16 a[130:131], v2 offset:256
    v_cvt_pk_bf16_f32 v34, v20, v21
    v_mfma_f32_16x16x32_bf16 v[236:239], a[152:155], v[40:43], v[236:239]
    s_add_u32 m0, s47, 16928
    v_exp_f32 v23, v23
    v_mfma_f32_16x16x32_bf16 v[236:239], a[156:159], v[44:47], v[236:239]
    buffer_load_dwordx4 v5, s[20:23], s46 offen offset:1024 lds
    v_mfma_f32_16x16x32_bf16 v[240:243], a[160:163], v[40:43], v[240:243]
    v_exp_f32 v24, v24
    v_mfma_f32_16x16x32_bf16 v[240:243], a[164:167], v[44:47], v[240:243]
    ds_read_b64_tr_b16 a[132:133], v2 offset:512
    v_cvt_pk_bf16_f32 v35, v22, v23
    v_mfma_f32_16x16x32_bf16 v[244:247], a[168:171], v[40:43], v[244:247]
    s_add_u32 m0, s47, 16960
    v_exp_f32 v25, v25
    v_mfma_f32_16x16x32_bf16 v[244:247], a[172:175], v[44:47], v[244:247]
    buffer_load_dwordx4 v5, s[20:23], s46 offen offset:2048 lds
    v_mfma_f32_16x16x32_bf16 v[248:251], a[176:179], v[40:43], v[248:251]
    v_exp_f32 v26, v26
    v_mfma_f32_16x16x32_bf16 v[248:251], a[180:183], v[44:47], v[248:251]
    ds_read_b64_tr_b16 a[134:135], v2 offset:768
    v_cvt_pk_bf16_f32 v36, v24, v25
    v_mfma_f32_16x16x32_bf16 v[252:255], a[184:187], v[40:43], v[252:255]
    s_add_u32 m0, s47, 16992
    v_exp_f32 v27, v27
    v_mfma_f32_16x16x32_bf16 v[252:255], a[188:191], v[44:47], v[252:255]
    buffer_load_dwordx4 v5, s[20:23], s46 offen offset:3072 lds
    v_smfmac_f32_16x16x64_bf16 a[12:15], a[16:19], v[40:47], v11
    ds_read_b64_tr_b16 a[136:137], v2 offset:32
    v_mfma_f32_16x16x32_bf16 v[16:19], a[64:67], v[80:83], v[52:55]
    v_exp_f32 v28, v28
    v_mfma_f32_16x16x32_bf16 v[16:19], a[68:71], v[84:87], v[16:19]
    ds_read_b64_tr_b16 a[138:139], v2 offset:288
    v_cvt_pk_bf16_f32 v37, v26, v27
    v_mfma_f32_16x16x32_bf16 v[16:19], a[72:75], v[88:91], v[16:19]
    s_cmp_le_u32 s49, 5
    v_exp_f32 v29, v29
    v_mfma_f32_16x16x32_bf16 v[16:19], a[76:79], v[92:95], v[16:19]
    s_cbranch_scc1 L2_pf
L2_pfret:
    ds_read_b64_tr_b16 a[140:141], v2 offset:544
    v_mfma_f32_16x16x32_bf16 v[20:23], a[80:83], v[80:83], v[52:55]
    v_exp_f32 v30, v30
    v_mfma_f32_16x16x32_bf16 v[20:23], a[84:87], v[84:87], v[20:23]
    ds_read_b64_tr_b16 a[142:143], v2 offset:800
    v_cvt_pk_bf16_f32 v38, v28, v29
    v_mfma_f32_16x16x32_bf16 v[20:23], a[88:91], v[88:91], v[20:23]
    v_exp_f32 v31, v31
    v_mfma_f32_16x16x32_bf16 v[20:23], a[92:95], v[92:95], v[20:23]
    ds_read_b64_tr_b16 a[144:145], v2 offset:64
    v_mfma_f32_16x16x32_bf16 v[24:27], a[96:99], v[80:83], v[52:55]
    v_exp_f32 v16, v16
    v_mfma_f32_16x16x32_bf16 v[24:27], a[100:103], v[84:87], v[24:27]
    ds_read_b64_tr_b16 a[146:147], v2 offset:320
    v_cvt_pk_bf16_f32 v39, v30, v31
    v_mfma_f32_16x16x32_bf16 v[24:27], a[104:107], v[88:91], v[24:27]
    v_exp_f32 v17, v17
    v_mfma_f32_16x16x32_bf16 v[24:27], a[108:111], v[92:95], v[24:27]
    ds_read_b64_tr_b16 a[148:149], v2 offset:576
    v_mfma_f32_16x16x32_bf16 v[28:31], a[112:115], v[80:83], v[52:55]
    v_exp_f32 v18, v18
    v_mfma_f32_16x16x32_bf16 v[28:31], a[116:119], v[84:87], v[28:31]
    ds_read_b64_tr_b16 a[150:151], v2 offset:832
    v_cvt_pk_bf16_f32 v40, v16, v17
    v_mfma_f32_16x16x32_bf16 v[28:31], a[120:123], v[88:91], v[28:31]
    v_exp_f32 v19, v19
    v_mfma_f32_16x16x32_bf16 v[28:31], a[124:127], v[92:95], v[28:31]
    ds_read_b64_tr_b16 a[152:153], v2 offset:96
    v_mfma_f32_16x16x32_bf16 v[128:131], a[192:195], v[32:35], v[128:131]
    v_exp_f32 v20, v20
    v_mfma_f32_16x16x32_bf16 v[128:131], a[196:199], v[36:39], v[128:131]
    ds_read_b64_tr_b16 a[154:155], v2 offset:352
    v_cvt_pk_bf16_f32 v41, v18, v19
    v_mfma_f32_16x16x32_bf16 v[132:135], a[200:203], v[32:35], v[132:135]
    v_exp_f32 v21, v21
    v_mfma_f32_16x16x32_bf16 v[132:135], a[204:207], v[36:39], v[132:135]
    ds_read_b64_tr_b16 a[156:157], v2 offset:608
    v_mfma_f32_16x16x32_bf16 v[136:139], a[208:211], v[32:35], v[136:139]
    v_exp_f32 v22, v22
    v_mfma_f32_16x16x32_bf16 v[136:139], a[212:215], v[36:39], v[136:139]
    ds_read_b64_tr_b16 a[158:159], v2 offset:864
    v_cvt_pk_bf16_f32 v42, v20, v21
    v_mfma_f32_16x16x32_bf16 v[140:143], a[216:219], v[32:35], v[140:143]
    v_exp_f32 v23, v23
    v_mfma_f32_16x16x32_bf16 v[140:143], a[220:223], v[36:39], v[140:143]
    ds_read_b64_tr_b16 a[160:161], v2 offset:128
    v_mfma_f32_16x16x32_bf16 v[144:147], a[224:227], v[32:35], v[144:147]
    v_exp_f32 v24, v24
    v_mfma_f32_16x16x32_bf16 v[144:147], a[228:231], v[36:39], v[144:147]
    ds_read_b64_tr_b16 a[162:163], v2 offset:384
    v_cvt_pk_bf16_f32 v43, v22, v23
    v_mfma_f32_16x16x32_bf16 v[148:151], a[232:235], v[32:35], v[148:151]
    v_exp_f32 v25, v25
    v_mfma_f32_16x16x32_bf16 v[148:151], a[236:239], v[36:39], v[148:151]
    ds_read_b64_tr_b16 a[164:165], v2 offset:640
    v_mfma_f32_16x16x32_bf16 v[152:155], a[240:243], v[32:35], v[152:155]
    v_exp_f32 v26, v26
    v_mfma_f32_16x16x32_bf16 v[152:155], a[244:247], v[36:39], v[152:155]
    ds_read_b64_tr_b16 a[166:167], v2 offset:896
    v_cvt_pk_bf16_f32 v44, v24, v25
    v_mfma_f32_16x16x32_bf16 v[156:159], a[248:251], v[32:35], v[156:159]
    v_exp_f32 v27, v27
    v_mfma_f32_16x16x32_bf16 v[156:159], a[252:255], v[36:39], v[156:159]
    ds_read_b64_tr_b16 a[168:169], v2 offset:160
    v_smfmac_f32_16x16x64_bf16 a[0:3], a[16:19], v[32:39], v11
    ds_read_b64_tr_b16 a[170:171], v2 offset:416
    v_mfma_f32_16x16x32_bf16 v[16:19], a[64:67], v[96:99], v[56:59]
    v_exp_f32 v28, v28
    v_mfma_f32_16x16x32_bf16 v[16:19], a[68:71], v[100:103], v[16:19]
    ds_read_b64_tr_b16 a[172:173], v2 offset:672
    v_cvt_pk_bf16_f32 v45, v26, v27
    v_mfma_f32_16x16x32_bf16 v[16:19], a[72:75], v[104:107], v[16:19]
    v_exp_f32 v29, v29
    v_mfma_f32_16x16x32_bf16 v[16:19], a[76:79], v[108:111], v[16:19]
    ds_read_b64_tr_b16 a[174:175], v2 offset:928
    v_mfma_f32_16x16x32_bf16 v[20:23], a[80:83], v[96:99], v[56:59]
    v_exp_f32 v30, v30
    v_mfma_f32_16x16x32_bf16 v[20:23], a[84:87], v[100:103], v[20:23]
    ds_read_b64_tr_b16 a[176:177], v2 offset:192
    v_cvt_pk_bf16_f32 v46, v28, v29
    v_mfma_f32_16x16x32_bf16 v[20:23], a[88:91], v[104:107], v[20:23]
    v_exp_f32 v31, v31
    v_mfma_f32_16x16x32_bf16 v[20:23], a[92:95], v[108:111], v[20:23]
    ds_read_b64_tr_b16 a[178:179], v2 offset:448
    v_mfma_f32_16x16x32_bf16 v[24:27], a[96:99], v[96:99], v[56:59]
    v_exp_f32 v16, v16
    v_mfma_f32_16x16x32_bf16 v[24:27], a[100:103], v[100:103], v[24:27]
    ds_read_b64_tr_b16 a[180:181], v2 offset:704
    v_cvt_pk_bf16_f32 v47, v30, v31
    v_mfma_f32_16x16x32_bf16 v[24:27], a[104:107], v[104:107], v[24:27]
    v_exp_f32 v17, v17
    v_mfma_f32_16x16x32_bf16 v[24:27], a[108:111], v[108:111], v[24:27]
    ds_read_b64_tr_b16 a[182:183], v2 offset:960
    v_mfma_f32_16x16x32_bf16 v[28:31], a[112:115], v[96:99], v[56:59]
    v_exp_f32 v18, v18
    v_mfma_f32_16x16x32_bf16 v[28:31], a[116:119], v[100:103], v[28:31]
    ds_read_b64_tr_b16 a[184:185], v2 offset:224
    v_cvt_pk_bf16_f32 v32, v16, v17
    v_mfma_f32_16x16x32_bf16 v[28:31], a[120:123], v[104:107], v[28:31]
    v_exp_f32 v19, v19
    v_mfma_f32_16x16x32_bf16 v[28:31], a[124:127], v[108:111], v[28:31]
    ds_read_b64_tr_b16 a[186:187], v2 offset:480
    v_mfma_f32_16x16x32_bf16 v[160:163], a[192:195], v[40:43], v[160:163]
    v_exp_f32 v20, v20
    v_mfma_f32_16x16x32_bf16 v[160:163], a[196:199], v[44:47], v[160:163]
    ds_read_b64_tr_b16 a[188:189], v2 offset:736
    v_cvt_pk_bf16_f32 v33, v18, v19
    v_mfma_f32_16x16x32_bf16 v[164:167], a[200:203], v[40:43], v[164:167]
    v_exp_f32 v21, v21
    v_mfma_f32_16x16x32_bf16 v[164:167], a[204:207], v[44:47], v[164:167]
    ds_read_b64_tr_b16 a[190:191], v2 offset:992
    v_mfma_f32_16x16x32_bf16 v[168:171], a[208:211], v[40:43], v[168:171]
    v_exp_f32 v22, v22
    v_mfma_f32_16x16x32_bf16 v[168:171], a[212:215], v[44:47], v[168:171]
    v_cvt_pk_bf16_f32 v34, v20, v21
    v_mfma_f32_16x16x32_bf16 v[172:175], a[216:219], v[40:43], v[172:175]
    v_exp_f32 v23, v23
    v_mfma_f32_16x16x32_bf16 v[172:175], a[220:223], v[44:47], v[172:175]
    v_mfma_f32_16x16x32_bf16 v[176:179], a[224:227], v[40:43], v[176:179]
    v_exp_f32 v24, v24
    v_mfma_f32_16x16x32_bf16 v[176:179], a[228:231], v[44:47], v[176:179]
    v_cvt_pk_bf16_f32 v35, v22, v23
    v_mfma_f32_16x16x32_bf16 v[180:183], a[232:235], v[40:43], v[180:183]
    v_exp_f32 v25, v25
    v_mfma_f32_16x16x32_bf16 v[180:183], a[236:239], v[44:47], v[180:183]
    v_mfma_f32_16x16x32_bf16 v[184:187], a[240:243], v[40:43], v[184:187]
    v_exp_f32 v26, v26
    v_mfma_f32_16x16x32_bf16 v[184:187], a[244:247], v[44:47], v[184:187]
    v_cvt_pk_bf16_f32 v36, v24, v25
    v_mfma_f32_16x16x32_bf16 v[188:191], a[248:251], v[40:43], v[188:191]
    v_exp_f32 v27, v27
    v_mfma_f32_16x16x32_bf16 v[188:191], a[252:255], v[44:47], v[188:191]
    v_smfmac_f32_16x16x64_bf16 a[4:7], a[16:19], v[40:47], v11
    v_mfma_f32_16x16x32_bf16 v[16:19], a[64:67], v[112:115], v[60:63]
    v_exp_f32 v28, v28
    v_mfma_f32_16x16x32_bf16 v[16:19], a[68:71], v[116:119], v[16:19]
    s_add_u32 s46, s46, 16384
    ds_read_b128 a[64:67], v1 offset:0
    v_cvt_pk_bf16_f32 v37, v26, v27
    v_mfma_f32_16x16x32_bf16 v[16:19], a[72:75], v[120:123], v[16:19]
    s_min_u32 s46, s46, 507904
    v_exp_f32 v29, v29
    v_mfma_f32_16x16x32_bf16 v[16:19], a[76:79], v[124:127], v[16:19]
    ds_read_b128 a[68:71], v1 offset:64
    v_mfma_f32_16x16x32_bf16 v[20:23], a[80:83], v[112:115], v[60:63]
    v_exp_f32 v30, v30
    v_mfma_f32_16x16x32_bf16 v[20:23], a[84:87], v[116:119], v[20:23]
    ds_read_b128 a[72:75], v1 offset:128
    v_cvt_pk_bf16_f32 v38, v28, v29
    v_mfma_f32_16x16x32_bf16 v[20:23], a[88:91], v[120:123], v[20:23]
    v_exp_f32 v31, v31
    v_mfma_f32_16x16x32_bf16 v[20:23], a[92:95], v[124:127], v[20:23]
    ds_read_b128 a[76:79], v1 offset:192
    v_mfma_f32_16x16x32_bf16 v[24:27], a[96:99], v[112:115], v[60:63]
    v_exp_f32 v16, v16
    v_mfma_f32_16x16x32_bf16 v[24:27], a[100:103], v[116:119], v[24:27]
    ds_read_b128 a[80:83], v1 offset:256
    v_cvt_pk_bf16_f32 v39, v30, v31
    v_mfma_f32_16x16x32_bf16 v[24:27], a[104:107], v[120:123], v[24:27]
    v_exp_f32 v17, v17
    v_mfma_f32_16x16x32_bf16 v[24:27], a[108:111], v[124:127], v[24:27]
    ds_read_b128 a[84:87], v1 offset:320
    v_mfma_f32_16x16x32_bf16 v[28:31], a[112:115], v[112:115], v[60:63]
    v_exp_f32 v18, v18
    v_mfma_f32_16x16x32_bf16 v[28:31], a[116:119], v[116:119], v[28:31]
    ds_read_b128 a[88:91], v1 offset:384
    v_cvt_pk_bf16_f32 v40, v16, v17
    v_mfma_f32_16x16x32_bf16 v[28:31], a[120:123], v[120:123], v[28:31]
    v_exp_f32 v19, v19
    v_mfma_f32_16x16x32_bf16 v[28:31], a[124:127], v[124:127], v[28:31]
    ds_read_b128 a[92:95], v1 offset:448
    v_mfma_f32_16x16x32_bf16 v[192:195], a[192:195], v[32:35], v[192:195]
    v_exp_f32 v20, v20
    v_mfma_f32_16x16x32_bf16 v[192:195], a[196:199], v[36:39], v[192:195]
    ds_read_b128 a[96:99], v1 offset:512
    v_cvt_pk_bf16_f32 v41, v18, v19
    v_mfma_f32_16x16x32_bf16 v[196:199], a[200:203], v[32:35], v[196:199]
    v_exp_f32 v21, v21
    v_mfma_f32_16x16x32_bf16 v[196:199], a[204:207], v[36:39], v[196:199]
    ds_read_b128 a[100:103], v1 offset:576
    v_mfma_f32_16x16x32_bf16 v[200:203], a[208:211], v[32:35], v[200:203]
    v_exp_f32 v22, v22
    v_mfma_f32_16x16x32_bf16 v[200:203], a[212:215], v[36:39], v[200:203]
    ds_read_b128 a[104:107], v1 offset:640
    v_cvt_pk_bf16_f32 v42, v20, v21
    v_mfma_f32_16x16x32_bf16 v[204:207], a[216:219], v[32:35], v[204:207]
    v_exp_f32 v23, v23
    v_mfma_f32_16x16x32_bf16 v[204:207], a[220:223], v[36:39], v[204:207]
    ds_read_b128 a[108:111], v1 offset:704
    v_mfma_f32_16x16x32_bf16 v[208:211], a[224:227], v[32:35], v[208:211]
    v_exp_f32 v24, v24
    v_mfma_f32_16x16x32_bf16 v[208:211], a[228:231], v[36:39], v[208:211]
    ds_read_b128 a[112:115], v1 offset:768
    v_cvt_pk_bf16_f32 v43, v22, v23
    v_mfma_f32_16x16x32_bf16 v[212:215], a[232:235], v[32:35], v[212:215]
    v_exp_f32 v25, v25
    v_mfma_f32_16x16x32_bf16 v[212:215], a[236:239], v[36:39], v[212:215]
    ds_read_b128 a[116:119], v1 offset:832
    v_mfma_f32_16x16x32_bf16 v[216:219], a[240:243], v[32:35], v[216:219]
    v_exp_f32 v26, v26
    v_mfma_f32_16x16x32_bf16 v[216:219], a[244:247], v[36:39], v[216:219]
    ds_read_b128 a[120:123], v1 offset:896
    v_cvt_pk_bf16_f32 v44, v24, v25
    v_mfma_f32_16x16x32_bf16 v[220:223], a[248:251], v[32:35], v[220:223]
    v_exp_f32 v27, v27
    v_mfma_f32_16x16x32_bf16 v[220:223], a[252:255], v[36:39], v[220:223]
    ds_read_b128 a[124:127], v1 offset:960
    v_smfmac_f32_16x16x64_bf16 a[8:11], a[16:19], v[32:39], v11
    s_waitcnt vmcnt(8) lgkmcnt(12)
    s_barrier
    v_mfma_f32_16x16x32_bf16 v[16:19], a[64:67], v[64:67], v[48:51]
    v_exp_f32 v28, v28
    v_mfma_f32_16x16x32_bf16 v[16:19], a[68:71], v[68:71], v[16:19]
    v_cvt_pk_bf16_f32 v45, v26, v27
    v_mfma_f32_16x16x32_bf16 v[16:19], a[72:75], v[72:75], v[16:19]
    s_add_u32 m0, s47, 36864
    v_exp_f32 v29, v29
    v_mfma_f32_16x16x32_bf16 v[16:19], a[76:79], v[76:79], v[16:19]
    s_waitcnt lgkmcnt(8)
    buffer_load_dwordx4 v5, s[16:19], s46 offen offset:0 lds
    v_mfma_f32_16x16x32_bf16 v[20:23], a[80:83], v[64:67], v[48:51]
    v_exp_f32 v30, v30
    v_mfma_f32_16x16x32_bf16 v[20:23], a[84:87], v[68:71], v[20:23]
    v_cvt_pk_bf16_f32 v46, v28, v29
    v_mfma_f32_16x16x32_bf16 v[20:23], a[88:91], v[72:75], v[20:23]
    s_add_u32 m0, s47, 36896
    v_exp_f32 v31, v31
    v_mfma_f32_16x16x32_bf16 v[20:23], a[92:95], v[76:79], v[20:23]
    s_waitcnt lgkmcnt(4)
    buffer_load_dwordx4 v5, s[16:19], s46 offen offset:1024 lds
    v_mfma_f32_16x16x32_bf16 v[24:27], a[96:99], v[64:67], v[48:51]
    v_exp_f32 v16, v16
    v_mfma_f32_16x16x32_bf16 v[24:27], a[100:103], v[68:71], v[24:27]
    v_cvt_pk_bf16_f32 v47, v30, v31
    v_mfma_f32_16x16x32_bf16 v[24:27], a[104:107], v[72:75], v[24:27]
    s_add_u32 m0, s47, 36928
    v_exp_f32 v17, v17
    v_mfma_f32_16x16x32_bf16 v[24:27], a[108:111], v[76:79], v[24:27]
    s_waitcnt lgkmcnt(0)
    buffer_load_dwordx4 v5, s[16:19], s46 offen offset:2048 lds
    v_mfma_f32_16x16x32_bf16 v[28:31], a[112:115], v[64:67], v[48:51]
    v_exp_f32 v18, v18
    v_mfma_f32_16x16x32_bf16 v[28:31], a[116:119], v[68:71], v[28:31]
    v_cvt_pk_bf16_f32 v32, v16, v17
    v_mfma_f32_16x16x32_bf16 v[28:31], a[120:123], v[72:75], v[28:31]
    s_add_u32 m0, s47, 36960
    v_exp_f32 v19, v19
    v_mfma_f32_16x16x32_bf16 v[28:31], a[124:127], v[76:79], v[28:31]
    buffer_load_dwordx4 v5, s[16:19], s46 offen offset:3072 lds
    v_mfma_f32_16x16x32_bf16 v[224:227], a[192:195], v[40:43], v[224:227]
    v_exp_f32 v20, v20
    v_mfma_f32_16x16x32_bf16 v[224:227], a[196:199], v[44:47], v[224:227]
    ds_read_b64_tr_b16 a[192:193], v2 offset:36864
    v_cvt_pk_bf16_f32 v33, v18, v19
    v_mfma_f32_16x16x32_bf16 v[228:231], a[200:203], v[40:43], v[228:231]
    s_add_u32 m0, s47, 53760
    v_exp_f32 v21, v21
    v_mfma_f32_16x16x32_bf16 v[228:231], a[204:207], v[44:47], v[228:231]
    buffer_load_dwordx4 v5, s[20:23], s46 offen offset:0 lds
    v_mfma_f32_16x16x32_bf16 v[232:235], a[208:211], v[40:43], v[232:235]
    v_exp_f32 v22, v22
    v_mfma_f32_16x16x32_bf16 v[232:235], a[212:215], v[44:47], v[232:235]
    ds_read_b64_tr_b16 a[194:195], v2 offset:37120
    v_cvt_pk_bf16_f32 v34, v20, v21
    v_mfma_f32_16x16x32_bf16 v[236:239], a[216:219], v[40:43], v[236:239]
    s_add_u32 m0, s47, 53792
    v_exp_f32 v23, v23
    v_mfma_f32_16x16x32_bf16 v[236:239], a[220:223], v[44:47], v[236:239]
    buffer_load_dwordx4 v5, s[20:23], s46 offen offset:1024 lds
    v_mfma_f32_16x16x32_bf16 v[240:243], a[224:227], v[40:43], v[240:243]
    v_exp_f32 v24, v24
    v_mfma_f32_16x16x32_bf16 v[240:243], a[228:231], v[44:47], v[240:243]
    ds_read_b64_tr_b16 a[196:197], v2 offset:37376
    v_cvt_pk_bf16_f32 v35, v22, v23
    v_mfma_f32_16x16x32_bf16 v[244:247], a[232:235], v[40:43], v[244:247]
    s_add_u32 m0, s47, 53824
    v_exp_f32 v25, v25
    v_mfma_f32_16x16x32_bf16 v[244:247], a[236:239], v[44:47], v[244:247]
    buffer_load_dwordx4 v5, s[20:23], s46 offen offset:2048 lds
    v_mfma_f32_16x16x32_bf16 v[248:251], a[240:243], v[40:43], v[248:251]
    v_exp_f32 v26, v26
    v_mfma_f32_16x16x32_bf16 v[248:251], a[244:247], v[44:47], v[248:251]
    ds_read_b64_tr_b16 a[198:199], v2 offset:37632
    v_cvt_pk_bf16_f32 v36, v24, v25
    v_mfma_f32_16x16x32_bf16 v[252:255], a[248:251], v[40:43], v[252:255]
    s_add_u32 m0, s47, 53856
    v_exp_f32 v27, v27
    v_mfma_f32_16x16x32_bf16 v[252:255], a[252:255], v[44:47], v[252:255]
    buffer_load_dwordx4 v5, s[20:23], s46 offen offset:3072 lds
    v_smfmac_f32_16x16x64_bf16 a[12:15], a[16:19], v[40:47], v11
    ds_read_b64_tr_b16 a[200:201], v2 offset:36896
    v_mfma_f32_16x16x32_bf16 v[16:19], a[64:67], v[80:83], v[52:55]
    v_exp_f32 v28, v28
    v_mfma_f32_16x16x32_bf16 v[16:19], a[68:71], v[84:87], v[16:19]
    ds_read_b64_tr_b16 a[202:203], v2 offset:37152
    v_cvt_pk_bf16_f32 v37, v26, v27
    v_mfma_f32_16x16x32_bf16 v[16:19], a[72:75], v[88:91], v[16:19]
    v_exp_f32 v29, v29
    v_mfma_f32_16x16x32_bf16 v[16:19], a[76:79], v[92:95], v[16:19]
    ds_read_b64_tr_b16 a[204:205], v2 offset:37408
    v_mfma_f32_16x16x32_bf16 v[20:23], a[80:83], v[80:83], v[52:55]
    v_exp_f32 v30, v30
    v_mfma_f32_16x16x32_bf16 v[20:23], a[84:87], v[84:87], v[20:23]
    ds_read_b64_tr_b16 a[206:207], v2 offset:37664
    v_cvt_pk_bf16_f32 v38, v28, v29
    v_mfma_f32_16x16x32_bf16 v[20:23], a[88:91], v[88:91], v[20:23]
    v_exp_f32 v31, v31
    v_mfma_f32_16x16x32_bf16 v[20:23], a[92:95], v[92:95], v[20:23]
    ds_read_b64_tr_b16 a[208:209], v2 offset:36928
    v_mfma_f32_16x16x32_bf16 v[24:27], a[96:99], v[80:83], v[52:55]
    v_exp_f32 v16, v16
    v_mfma_f32_16x16x32_bf16 v[24:27], a[100:103], v[84:87], v[24:27]
    ds_read_b64_tr_b16 a[210:211], v2 offset:37184
    v_cvt_pk_bf16_f32 v39, v30, v31
    v_mfma_f32_16x16x32_bf16 v[24:27], a[104:107], v[88:91], v[24:27]
    v_exp_f32 v17, v17
    v_mfma_f32_16x16x32_bf16 v[24:27], a[108:111], v[92:95], v[24:27]
    ds_read_b64_tr_b16 a[212:213], v2 offset:37440
    v_mfma_f32_16x16x32_bf16 v[28:31], a[112:115], v[80:83], v[52:55]
    v_exp_f32 v18, v18
    v_mfma_f32_16x16x32_bf16 v[28:31], a[116:119], v[84:87], v[28:31]
    ds_read_b64_tr_b16 a[214:215], v2 offset:37696
    v_cvt_pk_bf16_f32 v40, v16, v17
    v_mfma_f32_16x16x32_bf16 v[28:31], a[120:123], v[88:91], v[28:31]
    v_exp_f32 v19, v19
    v_mfma_f32_16x16x32_bf16 v[28:31], a[124:127], v[92:95], v[28:31]
    ds_read_b64_tr_b16 a[216:217], v2 offset:36960
    v_mfma_f32_16x16x32_bf16 v[128:131], a[128:131], v[32:35], v[128:131]
    v_exp_f32 v20, v20
    v_mfma_f32_16x16x32_bf16 v[128:131], a[132:135], v[36:39], v[128:131]
    ds_read_b64_tr_b16 a[218:219], v2 offset:37216
    v_cvt_pk_bf16_f32 v41, v18, v19
    v_mfma_f32_16x16x32_bf16 v[132:135], a[136:139], v[32:35], v[132:135]
    v_exp_f32 v21, v21
    v_mfma_f32_16x16x32_bf16 v[132:135], a[140:143], v[36:39], v[132:135]
    ds_read_b64_tr_b16 a[220:221], v2 offset:37472
    v_mfma_f32_16x16x32_bf16 v[136:139], a[144:147], v[32:35], v[136:139]
    v_exp_f32 v22, v22
    v_mfma_f32_16x16x32_bf16 v[136:139], a[148:151], v[36:39], v[136:139]
    ds_read_b64_tr_b16 a[222:223], v2 offset:37728
    v_cvt_pk_bf16_f32 v42, v20, v21
    v_mfma_f32_16x16x32_bf16 v[140:143], a[152:155], v[32:35], v[140:143]
    v_exp_f32 v23, v23
    v_mfma_f32_16x16x32_bf16 v[140:143], a[156:159], v[36:39], v[140:143]
    ds_read_b64_tr_b16 a[224:225], v2 offset:36992
    v_mfma_f32_16x16x32_bf16 v[144:147], a[160:163], v[32:35], v[144:147]
    v_exp_f32 v24, v24
    v_mfma_f32_16x16x32_bf16 v[144:147], a[164:167], v[36:39], v[144:147]
    ds_read_b64_tr_b16 a[226:227], v2 offset:37248
    v_cvt_pk_bf16_f32 v43, v22, v23
    v_mfma_f32_16x16x32_bf16 v[148:151], a[168:171], v[32:35], v[148:151]
    v_exp_f32 v25, v25
    v_mfma_f32_16x16x32_bf16 v[148:151], a[172:175], v[36:39], v[148:151]
    ds_read_b64_tr_b16 a[228:229], v2 offset:37504
    v_mfma_f32_16x16x32_bf16 v[152:155], a[176:179], v[32:35], v[152:155]
    v_exp_f32 v26, v26
    v_mfma_f32_16x16x32_bf16 v[152:155], a[180:183], v[36:39], v[152:155]
    ds_read_b64_tr_b16 a[230:231], v2 offset:37760
    v_cvt_pk_bf16_f32 v44, v24, v25
    v_mfma_f32_16x16x32_bf16 v[156:159], a[184:187], v[32:35], v[156:159]
    v_exp_f32 v27, v27
    v_mfma_f32_16x16x32_bf16 v[156:159], a[188:191], v[36:39], v[156:159]
    ds_read_b64_tr_b16 a[232:233], v2 offset:37024
    v_smfmac_f32_16x16x64_bf16 a[0:3], a[16:19], v[32:39], v11
    ds_read_b64_tr_b16 a[234:235], v2 offset:37280
    v_mfma_f32_16x16x32_bf16 v[16:19], a[64:67], v[96:99], v[56:59]
    v_exp_f32 v28, v28
    v_mfma_f32_16x16x32_bf16 v[16:19], a[68:71], v[100:103], v[16:19]
    ds_read_b64_tr_b16 a[236:237], v2 offset:37536
    v_cvt_pk_bf16_f32 v45, v26, v27
    v_mfma_f32_16x16x32_bf16 v[16:19], a[72:75], v[104:107], v[16:19]
    v_exp_f32 v29, v29
    v_mfma_f32_16x16x32_bf16 v[16:19], a[76:79], v[108:111], v[16:19]
    ds_read_b64_tr_b16 a[238:239], v2 offset:37792
    v_mfma_f32_16x16x32_bf16 v[20:23], a[80:83], v[96:99], v[56:59]
    v_exp_f32 v30, v30
    v_mfma_f32_16x16x32_bf16 v[20:23], a[84:87], v[100:103], v[20:23]
    ds_read_b64_tr_b16 a[240:241], v2 offset:37056
    v_cvt_pk_bf16_f32 v46, v28, v29
    v_mfma_f32_16x16x32_bf16 v[20:23], a[88:91], v[104:107], v[20:23]
    v_exp_f32 v31, v31
    v_mfma_f32_16x16x32_bf16 v[20:23], a[92:95], v[108:111], v[20:23]
    ds_read_b64_tr_b16 a[242:243], v2 offset:37312
    v_mfma_f32_16x16x32_bf16 v[24:27], a[96:99], v[96:99], v[56:59]
    v_exp_f32 v16, v16
    v_mfma_f32_16x16x32_bf16 v[24:27], a[100:103], v[100:103], v[24:27]
    ds_read_b64_tr_b16 a[244:245], v2 offset:37568
    v_cvt_pk_bf16_f32 v47, v30, v31
    v_mfma_f32_16x16x32_bf16 v[24:27], a[104:107], v[104:107], v[24:27]
    v_exp_f32 v17, v17
    v_mfma_f32_16x16x32_bf16 v[24:27], a[108:111], v[108:111], v[24:27]
    ds_read_b64_tr_b16 a[246:247], v2 offset:37824
    v_mfma_f32_16x16x32_bf16 v[28:31], a[112:115], v[96:99], v[56:59]
    v_exp_f32 v18, v18
    v_mfma_f32_16x16x32_bf16 v[28:31], a[116:119], v[100:103], v[28:31]
    ds_read_b64_tr_b16 a[248:249], v2 offset:37088
    v_cvt_pk_bf16_f32 v32, v16, v17
    v_mfma_f32_16x16x32_bf16 v[28:31], a[120:123], v[104:107], v[28:31]
    v_exp_f32 v19, v19
    v_mfma_f32_16x16x32_bf16 v[28:31], a[124:127], v[108:111], v[28:31]
    ds_read_b64_tr_b16 a[250:251], v2 offset:37344
    v_mfma_f32_16x16x32_bf16 v[160:163], a[128:131], v[40:43], v[160:163]
    v_exp_f32 v20, v20
    v_mfma_f32_16x16x32_bf16 v[160:163], a[132:135], v[44:47], v[160:163]
    ds_read_b64_tr_b16 a[252:253], v2 offset:37600
    v_cvt_pk_bf16_f32 v33, v18, v19
    v_mfma_f32_16x16x32_bf16 v[164:167], a[136:139], v[40:43], v[164:167]
    v_exp_f32 v21, v21
    v_mfma_f32_16x16x32_bf16 v[164:167], a[140:143], v[44:47], v[164:167]
    ds_read_b64_tr_b16 a[254:255], v2 offset:37856
    v_mfma_f32_16x16x32_bf16 v[168:171], a[144:147], v[40:43], v[168:171]
    v_exp_f32 v22, v22
    v_mfma_f32_16x16x32_bf16 v[168:171], a[148:151], v[44:47], v[168:171]
    v_cvt_pk_bf16_f32 v34, v20, v21
    v_mfma_f32_16x16x32_bf16 v[172:175], a[152:155], v[40:43], v[172:175]
    v_exp_f32 v23, v23
    v_mfma_f32_16x16x32_bf16 v[172:175], a[156:159], v[44:47], v[172:175]
    v_mfma_f32_16x16x32_bf16 v[176:179], a[160:163], v[40:43], v[176:179]
    v_exp_f32 v24, v24
    v_mfma_f32_16x16x32_bf16 v[176:179], a[164:167], v[44:47], v[176:179]
    v_cvt_pk_bf16_f32 v35, v22, v23
    v_mfma_f32_16x16x32_bf16 v[180:183], a[168:171], v[40:43], v[180:183]
    v_exp_f32 v25, v25
    v_mfma_f32_16x16x32_bf16 v[180:183], a[172:175], v[44:47], v[180:183]
    v_mfma_f32_16x16x32_bf16 v[184:187], a[176:179], v[40:43], v[184:187]
    v_exp_f32 v26, v26
    v_mfma_f32_16x16x32_bf16 v[184:187], a[180:183], v[44:47], v[184:187]
    v_cvt_pk_bf16_f32 v36, v24, v25
    v_mfma_f32_16x16x32_bf16 v[188:191], a[184:187], v[40:43], v[188:191]
    v_exp_f32 v27, v27
    v_mfma_f32_16x16x32_bf16 v[188:191], a[188:191], v[44:47], v[188:191]
    v_smfmac_f32_16x16x64_bf16 a[4:7], a[16:19], v[40:47], v11
    v_mfma_f32_16x16x32_bf16 v[16:19], a[64:67], v[112:115], v[60:63]
    v_exp_f32 v28, v28
    v_mfma_f32_16x16x32_bf16 v[16:19], a[68:71], v[116:119], v[16:19]
    s_add_u32 s46, s46, 16384
    ds_read_b128 a[64:67], v1 offset:36864
    v_cvt_pk_bf16_f32 v37, v26, v27
    v_mfma_f32_16x16x32_bf16 v[16:19], a[72:75], v[120:123], v[16:19]
    s_min_u32 s46, s46, 507904
    v_exp_f32 v29, v29
    v_mfma_f32_16x16x32_bf16 v[16:19], a[76:79], v[124:127], v[16:19]
    ds_read_b128 a[68:71], v1 offset:36928
    v_mfma_f32_16x16x32_bf16 v[20:23], a[80:83], v[112:115], v[60:63]
    v_exp_f32 v30, v30
    v_mfma_f32_16x16x32_bf16 v[20:23], a[84:87], v[116:119], v[20:23]
    ds_read_b128 a[72:75], v1 offset:36992
    v_cvt_pk_bf16_f32 v38, v28, v29
    v_mfma_f32_16x16x32_bf16 v[20:23], a[88:91], v[120:123], v[20:23]
    v_exp_f32 v31, v31
    v_mfma_f32_16x16x32_bf16 v[20:23], a[92:95], v[124:127], v[20:23]
    ds_read_b128 a[76:79], v1 offset:37056
    v_mfma_f32_16x16x32_bf16 v[24:27], a[96:99], v[112:115], v[60:63]
    v_exp_f32 v16, v16
    v_mfma_f32_16x16x32_bf16 v[24:27], a[100:103], v[116:119], v[24:27]
    ds_read_b128 a[80:83], v1 offset:37120
    v_cvt_pk_bf16_f32 v39, v30, v31
    v_mfma_f32_16x16x32_bf16 v[24:27], a[104:107], v[120:123], v[24:27]
    v_exp_f32 v17, v17
    v_mfma_f32_16x16x32_bf16 v[24:27], a[108:111], v[124:127], v[24:27]
    ds_read_b128 a[84:87], v1 offset:37184
    v_mfma_f32_16x16x32_bf16 v[28:31], a[112:115], v[112:115], v[60:63]
    v_exp_f32 v18, v18
    v_mfma_f32_16x16x32_bf16 v[28:31], a[116:119], v[116:119], v[28:31]
    ds_read_b128 a[88:91], v1 offset:37248
    v_cvt_pk_bf16_f32 v40, v16, v17
    v_mfma_f32_16x16x32_bf16 v[28:31], a[120:123], v[120:123], v[28:31]
    v_exp_f32 v19, v19
    v_mfma_f32_16x16x32_bf16 v[28:31], a[124:127], v[124:127], v[28:31]
    ds_read_b128 a[92:95], v1 offset:37312
    v_mfma_f32_16x16x32_bf16 v[192:195], a[128:131], v[32:35], v[192:195]
    v_exp_f32 v20, v20
    v_mfma_f32_16x16x32_bf16 v[192:195], a[132:135], v[36:39], v[192:195]
    ds_read_b128 a[96:99], v1 offset:37376
    v_cvt_pk_bf16_f32 v41, v18, v19
    v_mfma_f32_16x16x32_bf16 v[196:199], a[136:139], v[32:35], v[196:199]
    v_exp_f32 v21, v21
    v_mfma_f32_16x16x32_bf16 v[196:199], a[140:143], v[36:39], v[196:199]
    ds_read_b128 a[100:103], v1 offset:37440
    v_mfma_f32_16x16x32_bf16 v[200:203], a[144:147], v[32:35], v[200:203]
    v_exp_f32 v22, v22
    v_mfma_f32_16x16x32_bf16 v[200:203], a[148:151], v[36:39], v[200:203]
    ds_read_b128 a[104:107], v1 offset:37504
    v_cvt_pk_bf16_f32 v42, v20, v21
    v_mfma_f32_16x16x32_bf16 v[204:207], a[152:155], v[32:35], v[204:207]
    v_exp_f32 v23, v23
    v_mfma_f32_16x16x32_bf16 v[204:207], a[156:159], v[36:39], v[204:207]
    ds_read_b128 a[108:111], v1 offset:37568
    v_mfma_f32_16x16x32_bf16 v[208:211], a[160:163], v[32:35], v[208:211]
    v_exp_f32 v24, v24
    v_mfma_f32_16x16x32_bf16 v[208:211], a[164:167], v[36:39], v[208:211]
    ds_read_b128 a[112:115], v1 offset:37632
    v_cvt_pk_bf16_f32 v43, v22, v23
    v_mfma_f32_16x16x32_bf16 v[212:215], a[168:171], v[32:35], v[212:215]
    v_exp_f32 v25, v25
    v_mfma_f32_16x16x32_bf16 v[212:215], a[172:175], v[36:39], v[212:215]
    ds_read_b128 a[116:119], v1 offset:37696
    v_mfma_f32_16x16x32_bf16 v[216:219], a[176:179], v[32:35], v[216:219]
    v_exp_f32 v26, v26
    v_mfma_f32_16x16x32_bf16 v[216:219], a[180:183], v[36:39], v[216:219]
    s_sub_u32 s49, s49, 1
    ds_read_b128 a[120:123], v1 offset:37760
    v_cvt_pk_bf16_f32 v44, v24, v25
    v_mfma_f32_16x16x32_bf16 v[220:223], a[184:187], v[32:35], v[220:223]
    s_cmp_lg_u32 s49, 0
    v_exp_f32 v27, v27
    v_mfma_f32_16x16x32_bf16 v[220:223], a[188:191], v[36:39], v[220:223]
    ds_read_b128 a[124:127], v1 offset:37824
    v_smfmac_f32_16x16x64_bf16 a[8:11], a[16:19], v[32:39], v11
    s_waitcnt vmcnt(8) lgkmcnt(12)
    s_barrier
    s_cbranch_scc1 L2_loop
    v_mfma_f32_16x16x32_bf16 v[16:19], a[64:67], v[64:67], v[48:51]
    v_exp_f32 v28, v28
    v_mfma_f32_16x16x32_bf16 v[16:19], a[68:71], v[68:71], v[16:19]
    v_cvt_pk_bf16_f32 v45, v26, v27
    v_mfma_f32_16x16x32_bf16 v[16:19], a[72:75], v[72:75], v[16:19]
    s_add_u32 m0, s44, 73728
    v_exp_f32 v29, v29
    v_mfma_f32_16x16x32_bf16 v[16:19], a[76:79], v[76:79], v[16:19]
    s_waitcnt lgkmcnt(8)
    s_mov_b32 s45, 0
    buffer_load_dwordx4 v7, s[28:31], s45 offen offset:0 lds
    v_mfma_f32_16x16x32_bf16 v[20:23], a[80:83], v[64:67], v[48:51]
    v_exp_f32 v30, v30
    v_mfma_f32_16x16x32_bf16 v[20:23], a[84:87], v[68:71], v[20:23]
    v_cvt_pk_bf16_f32 v46, v28, v29
    v_mfma_f32_16x16x32_bf16 v[20:23], a[88:91], v[72:75], v[20:23]
    s_add_u32 m0, s44, 73632
    v_exp_f32 v31, v31
    v_mfma_f32_16x16x32_bf16 v[20:23], a[92:95], v[76:79], v[20:23]
    s_waitcnt lgkmcnt(4)
    buffer_load_dwordx4 v7, s[28:31], s45 offen offset:1152 lds
    v_mfma_f32_16x16x32_bf16 v[24:27], a[96:99], v[64:67], v[48:51]
    v_exp_f32 v16, v16
    v_mfma_f32_16x16x32_bf16 v[24:27], a[100:103], v[68:71], v[24:27]
    v_cvt_pk_bf16_f32 v47, v30, v31
    v_mfma_f32_16x16x32_bf16 v[24:27], a[104:107], v[72:75], v[24:27]
    s_add_u32 m0, s44, 73536
    v_exp_f32 v17, v17
    v_mfma_f32_16x16x32_bf16 v[24:27], a[108:111], v[76:79], v[24:27]
    s_waitcnt lgkmcnt(0)
    buffer_load_dwordx4 v7, s[28:31], s45 offen offset:2304 lds
    v_mfma_f32_16x16x32_bf16 v[28:31], a[112:115], v[64:67], v[48:51]
    v_exp_f32 v18, v18
    v_mfma_f32_16x16x32_bf16 v[28:31], a[116:119], v[68:71], v[28:31]
    v_cvt_pk_bf16_f32 v32, v16, v17
    v_mfma_f32_16x16x32_bf16 v[28:31], a[120:123], v[72:75], v[28:31]
    s_add_u32 m0, s44, 73440
    v_exp_f32 v19, v19
    v_mfma_f32_16x16x32_bf16 v[28:31], a[124:127], v[76:79], v[28:31]
    buffer_load_dwordx4 v7, s[28:31], s45 offen offset:3456 lds
    v_mfma_f32_16x16x32_bf16 v[224:227], a[128:131], v[40:43], v[224:227]
    v_exp_f32 v20, v20
    v_mfma_f32_16x16x32_bf16 v[224:227], a[132:135], v[44:47], v[224:227]
    v_cvt_pk_bf16_f32 v33, v18, v19
    v_mfma_f32_16x16x32_bf16 v[228:231], a[136:139], v[40:43], v[228:231]
    s_add_u32 m0, s44, 90624
    v_exp_f32 v21, v21
    v_mfma_f32_16x16x32_bf16 v[228:231], a[140:143], v[44:47], v[228:231]
    s_mov_b32 s45, 147456
    buffer_load_dwordx4 v7, s[28:31], s45 offen offset:0 lds
    v_mfma_f32_16x16x32_bf16 v[232:235], a[144:147], v[40:43], v[232:235]
    v_exp_f32 v22, v22
    v_mfma_f32_16x16x32_bf16 v[232:235], a[148:151], v[44:47], v[232:235]
    v_cvt_pk_bf16_f32 v34, v20, v21
    v_mfma_f32_16x16x32_bf16 v[236:239], a[152:155], v[40:43], v[236:239]
    s_add_u32 m0, s44, 90528
    v_exp_f32 v23, v23
    v_mfma_f32_16x16x32_bf16 v[236:239], a[156:159], v[44:47], v[236:239]
    buffer_load_dwordx4 v7, s[28:31], s45 offen offset:1152 lds
    v_mfma_f32_16x16x32_bf16 v[240:243], a[160:163], v[40:43], v[240:243]
    v_exp_f32 v24, v24
    v_mfma_f32_16x16x32_bf16 v[240:243], a[164:167], v[44:47], v[240:243]
    v_cvt_pk_bf16_f32 v35, v22, v23
    v_mfma_f32_16x16x32_bf16 v[244:247], a[168:171], v[40:43], v[244:247]
    s_add_u32 m0, s44, 90432
    v_exp_f32 v25, v25
    v_mfma_f32_16x16x32_bf16 v[244:247], a[172:175], v[44:47], v[244:247]
    buffer_load_dwordx4 v7, s[28:31], s45 offen offset:2304 lds
    v_mfma_f32_16x16x32_bf16 v[248:251], a[176:179], v[40:43], v[248:251]
    v_exp_f32 v26, v26
    v_mfma_f32_16x16x32_bf16 v[248:251], a[180:183], v[44:47], v[248:251]
    v_cvt_pk_bf16_f32 v36, v24, v25
    v_mfma_f32_16x16x32_bf16 v[252:255], a[184:187], v[40:43], v[252:255]
    s_add_u32 m0, s44, 90336
    v_exp_f32 v27, v27
    v_mfma_f32_16x16x32_bf16 v[252:255], a[188:191], v[44:47], v[252:255]
    buffer_load_dwordx4 v7, s[28:31], s45 offen offset:3456 lds
    v_smfmac_f32_16x16x64_bf16 a[12:15], a[16:19], v[40:47], v11
    v_mfma_f32_16x16x32_bf16 v[16:19], a[64:67], v[80:83], v[52:55]
    v_exp_f32 v28, v28
    v_mfma_f32_16x16x32_bf16 v[16:19], a[68:71], v[84:87], v[16:19]
    v_cvt_pk_bf16_f32 v37, v26, v27
    v_mfma_f32_16x16x32_bf16 v[16:19], a[72:75], v[88:91], v[16:19]
    s_add_u32 m0, s44, 110592
    v_exp_f32 v29, v29
    v_mfma_f32_16x16x32_bf16 v[16:19], a[76:79], v[92:95], v[16:19]
    s_mov_b32 s45, 128
    buffer_load_dwordx4 v7, s[28:31], s45 offen offset:0 lds
    v_mfma_f32_16x16x32_bf16 v[20:23], a[80:83], v[80:83], v[52:55]
    v_exp_f32 v30, v30
    v_mfma_f32_16x16x32_bf16 v[20:23], a[84:87], v[84:87], v[20:23]
    v_cvt_pk_bf16_f32 v38, v28, v29
    v_mfma_f32_16x16x32_bf16 v[20:23], a[88:91], v[88:91], v[20:23]
    s_add_u32 m0, s44, 110496
    v_exp_f32 v31, v31
    v_mfma_f32_16x16x32_bf16 v[20:23], a[92:95], v[92:95], v[20:23]
    buffer_load_dwordx4 v7, s[28:31], s45 offen offset:1152 lds
    v_mfma_f32_16x16x32_bf16 v[24:27], a[96:99], v[80:83], v[52:55]
    v_exp_f32 v16, v16
    v_mfma_f32_16x16x32_bf16 v[24:27], a[100:103], v[84:87], v[24:27]
    v_cvt_pk_bf16_f32 v39, v30, v31
    v_mfma_f32_16x16x32_bf16 v[24:27], a[104:107], v[88:91], v[24:27]
    s_add_u32 m0, s44, 110400
    v_exp_f32 v17, v17
    v_mfma_f32_16x16x32_bf16 v[24:27], a[108:111], v[92:95], v[24:27]
    buffer_load_dwordx4 v7, s[28:31], s45 offen offset:2304 lds
    v_mfma_f32_16x16x32_bf16 v[28:31], a[112:115], v[80:83], v[52:55]
    v_exp_f32 v18, v18
    v_mfma_f32_16x16x32_bf16 v[28:31], a[116:119], v[84:87], v[28:31]
    v_cvt_pk_bf16_f32 v40, v16, v17
    v_mfma_f32_16x16x32_bf16 v[28:31], a[120:123], v[88:91], v[28:31]
    s_add_u32 m0, s44, 110304
    v_exp_f32 v19, v19
    v_mfma_f32_16x16x32_bf16 v[28:31], a[124:127], v[92:95], v[28:31]
    buffer_load_dwordx4 v7, s[28:31], s45 offen offset:3456 lds
    v_mfma_f32_16x16x32_bf16 v[128:131], a[192:195], v[32:35], v[128:131]
    v_exp_f32 v20, v20
    v_mfma_f32_16x16x32_bf16 v[128:131], a[196:199], v[36:39], v[128:131]
    v_cvt_pk_bf16_f32 v41, v18, v19
    v_mfma_f32_16x16x32_bf16 v[132:135], a[200:203], v[32:35], v[132:135]
    s_add_u32 m0, s44, 127488
    v_exp_f32 v21, v21
    v_mfma_f32_16x16x32_bf16 v[132:135], a[204:207], v[36:39], v[132:135]
    s_mov_b32 s45, 147584
    buffer_load_dwordx4 v7, s[28:31], s45 offen offset:0 lds
    v_mfma_f32_16x16x32_bf16 v[136:139], a[208:211], v[32:35], v[136:139]
    v_exp_f32 v22, v22
    v_mfma_f32_16x16x32_bf16 v[136:139], a[212:215], v[36:39], v[136:139]
    v_cvt_pk_bf16_f32 v42, v20, v21
    v_mfma_f32_16x16x32_bf16 v[140:143], a[216:219], v[32:35], v[140:143]
    s_add_u32 m0, s44, 127392
    v_exp_f32 v23, v23
    v_mfma_f32_16x16x32_bf16 v[140:143], a[220:223], v[36:39], v[140:143]
    buffer_load_dwordx4 v7, s[28:31], s45 offen offset:1152 lds
    v_mfma_f32_16x16x32_bf16 v[144:147], a[224:227], v[32:35], v[144:147]
    v_exp_f32 v24, v24
    v_mfma_f32_16x16x32_bf16 v[144:147], a[228:231], v[36:39], v[144:147]
    v_cvt_pk_bf16_f32 v43, v22, v23
    v_mfma_f32_16x16x32_bf16 v[148:151], a[232:235], v[32:35], v[148:151]
    s_add_u32 m0, s44, 127296
    v_exp_f32 v25, v25
    v_mfma_f32_16x16x32_bf16 v[148:151], a[236:239], v[36:39], v[148:151]
    buffer_load_dwordx4 v7, s[28:31], s45 offen offset:2304 lds
    v_mfma_f32_16x16x32_bf16 v[152:155], a[240:243], v[32:35], v[152:155]
    v_exp_f32 v26, v26
    v_mfma_f32_16x16x32_bf16 v[152:155], a[244:247], v[36:39], v[152:155]
    v_cvt_pk_bf16_f32 v44, v24, v25
    v_mfma_f32_16x16x32_bf16 v[156:159], a[248:251], v[32:35], v[156:159]
    s_add_u32 m0, s44, 127200
    v_exp_f32 v27, v27
    v_mfma_f32_16x16x32_bf16 v[156:159], a[252:255], v[36:39], v[156:159]
    buffer_load_dwordx4 v7, s[28:31], s45 offen offset:3456 lds
    v_smfmac_f32_16x16x64_bf16 a[0:3], a[16:19], v[32:39], v11
    v_mfma_f32_16x16x32_bf16 v[16:19], a[64:67], v[96:99], v[56:59]
    v_exp_f32 v28, v28
    v_mfma_f32_16x16x32_bf16 v[16:19], a[68:71], v[100:103], v[16:19]
    v_cvt_pk_bf16_f32 v45, v26, v27
    v_mfma_f32_16x16x32_bf16 v[16:19], a[72:75], v[104:107], v[16:19]
    s_add_u32 m0, s44, 0
    v_exp_f32 v29, v29
    v_mfma_f32_16x16x32_bf16 v[16:19], a[76:79], v[108:111], v[16:19]
    s_mov_b32 s45, 256
    buffer_load_dwordx4 v7, s[28:31], s45 offen offset:0 lds
    v_mfma_f32_16x16x32_bf16 v[20:23], a[80:83], v[96:99], v[56:59]
    v_exp_f32 v30, v30
    v_mfma_f32_16x16x32_bf16 v[20:23], a[84:87], v[100:103], v[20:23]
    v_cvt_pk_bf16_f32 v46, v28, v29
    v_mfma_f32_16x16x32_bf16 v[20:23], a[88:91], v[104:107], v[20:23]
    s_add_u32 m0, s44, -96
    v_exp_f32 v31, v31
    v_mfma_f32_16x16x32_bf16 v[20:23], a[92:95], v[108:111], v[20:23]
    buffer_load_dwordx4 v7, s[28:31], s45 offen offset:1152 lds
    v_mfma_f32_16x16x32_bf16 v[24:27], a[96:99], v[96:99], v[56:59]
    v_exp_f32 v16, v16
    v_mfma_f32_16x16x32_bf16 v[24:27], a[100:103], v[100:103], v[24:27]
    v_cvt_pk_bf16_f32 v47, v30, v31
    v_mfma_f32_16x16x32_bf16 v[24:27], a[104:107], v[104:107], v[24:27]
    s_add_u32 m0, s44, -192
    v_exp_f32 v17, v17
    v_mfma_f32_16x16x32_bf16 v[24:27], a[108:111], v[108:111], v[24:27]
    buffer_load_dwordx4 v7, s[28:31], s45 offen offset:2304 lds
    v_mfma_f32_16x16x32_bf16 v[28:31], a[112:115], v[96:99], v[56:59]
    v_exp_f32 v18, v18
    v_mfma_f32_16x16x32_bf16 v[28:31], a[116:119], v[100:103], v[28:31]
    v_cvt_pk_bf16_f32 v32, v16, v17
    v_mfma_f32_16x16x32_bf16 v[28:31], a[120:123], v[104:107], v[28:31]
    s_add_u32 m0, s44, -288
    v_exp_f32 v19, v19
    v_mfma_f32_16x16x32_bf16 v[28:31], a[124:127], v[108:111], v[28:31]
    buffer_load_dwordx4 v7, s[28:31], s45 offen offset:3456 lds
    v_mfma_f32_16x16x32_bf16 v[160:163], a[192:195], v[40:43], v[160:163]
    v_exp_f32 v20, v20
    v_mfma_f32_16x16x32_bf16 v[160:163], a[196:199], v[44:47], v[160:163]
    v_cvt_pk_bf16_f32 v33, v18, v19
    v_mfma_f32_16x16x32_bf16 v[164:167], a[200:203], v[40:43], v[164:167]
    s_add_u32 m0, s44, 16896
    v_exp_f32 v21, v21
    v_mfma_f32_16x16x32_bf16 v[164:167], a[204:207], v[44:47], v[164:167]
    s_mov_b32 s45, 147712
    buffer_load_dwordx4 v7, s[28:31], s45 offen offset:0 lds
    v_mfma_f32_16x16x32_bf16 v[168:171], a[208:211], v[40:43], v[168:171]
    v_exp_f32 v22, v22
    v_mfma_f32_16x16x32_bf16 v[168:171], a[212:215], v[44:47], v[168:171]
    v_cvt_pk_bf16_f32 v34, v20, v21
    v_mfma_f32_16x16x32_bf16 v[172:175], a[216:219], v[40:43], v[172:175]
    s_add_u32 m0, s44, 16800
    v_exp_f32 v23, v23
    v_mfma_f32_16x16x32_bf16 v[172:175], a[220:223], v[44:47], v[172:175]
    buffer_load_dwordx4 v7, s[28:31], s45 offen offset:1152 lds
    v_mfma_f32_16x16x32_bf16 v[176:179], a[224:227], v[40:43], v[176:179]
    v_exp_f32 v24, v24
    v_mfma_f32_16x16x32_bf16 v[176:179], a[228:231], v[44:47], v[176:179]
    v_cvt_pk_bf16_f32 v35, v22, v23
    v_mfma_f32_16x16x32_bf16 v[180:183], a[232:235], v[40:43], v[180:183]
    s_add_u32 m0, s44, 16704
    v_exp_f32 v25, v25
    v_mfma_f32_16x16x32_bf16 v[180:183], a[236:239], v[44:47], v[180:183]
    buffer_load_dwordx4 v7, s[28:31], s45 offen offset:2304 lds
    v_mfma_f32_16x16x32_bf16 v[184:187], a[240:243], v[40:43], v[184:187]
    v_exp_f32 v26, v26
    v_mfma_f32_16x16x32_bf16 v[184:187], a[244:247], v[44:47], v[184:187]
    v_cvt_pk_bf16_f32 v36, v24, v25
    v_mfma_f32_16x16x32_bf16 v[188:191], a[248:251], v[40:43], v[188:191]
    s_add_u32 m0, s44, 16608
    v_exp_f32 v27, v27
    v_mfma_f32_16x16x32_bf16 v[188:191], a[252:255], v[44:47], v[188:191]
    buffer_load_dwordx4 v7, s[28:31], s45 offen offset:3456 lds
    v_smfmac_f32_16x16x64_bf16 a[4:7], a[16:19], v[40:47], v11
    v_mfma_f32_16x16x32_bf16 v[16:19], a[64:67], v[112:115], v[60:63]
    v_exp_f32 v28, v28
    v_mfma_f32_16x16x32_bf16 v[16:19], a[68:71], v[116:119], v[16:19]
    v_cvt_pk_bf16_f32 v37, v26, v27
    v_mfma_f32_16x16x32_bf16 v[16:19], a[72:75], v[120:123], v[16:19]
    s_mov_b32 s54, 0
    v_exp_f32 v29, v29
    v_mfma_f32_16x16x32_bf16 v[16:19], a[76:79], v[124:127], v[16:19]
    buffer_load_dwordx4 a[128:131], v6, s[64:67], s54 offen
    v_mfma_f32_16x16x32_bf16 v[20:23], a[80:83], v[112:115], v[60:63]
    v_exp_f32 v30, v30
    v_mfma_f32_16x16x32_bf16 v[20:23], a[84:87], v[116:119], v[20:23]
    v_cvt_pk_bf16_f32 v38, v28, v29
    v_mfma_f32_16x16x32_bf16 v[20:23], a[88:91], v[120:123], v[20:23]
    s_mov_b32 s54, 147456
    v_exp_f32 v31, v31
    v_mfma_f32_16x16x32_bf16 v[20:23], a[92:95], v[124:127], v[20:23]
    buffer_load_dwordx4 a[132:135], v6, s[64:67], s54 offen
    v_mfma_f32_16x16x32_bf16 v[24:27], a[96:99], v[112:115], v[60:63]
    v_exp_f32 v16, v16
    v_mfma_f32_16x16x32_bf16 v[24:27], a[100:103], v[116:119], v[24:27]
    v_cvt_pk_bf16_f32 v39, v30, v31
    v_mfma_f32_16x16x32_bf16 v[24:27], a[104:107], v[120:123], v[24:27]
    s_mov_b32 s54, 294912
    v_exp_f32 v17, v17
    v_mfma_f32_16x16x32_bf16 v[24:27], a[108:111], v[124:127], v[24:27]
    buffer_load_dwordx4 a[136:139], v6, s[64:67], s54 offen
    v_mfma_f32_16x16x32_bf16 v[28:31], a[112:115], v[112:115], v[60:63]
    v_exp_f32 v18, v18
    v_mfma_f32_16x16x32_bf16 v[28:31], a[116:119], v[116:119], v[28:31]
    v_cvt_pk_bf16_f32 v40, v16, v17
    v_mfma_f32_16x16x32_bf16 v[28:31], a[120:123], v[120:123], v[28:31]
    s_mov_b32 s54, 442368
    v_exp_f32 v19, v19
    v_mfma_f32_16x16x32_bf16 v[28:31], a[124:127], v[124:127], v[28:31]
    buffer_load_dwordx4 a[140:143], v6, s[64:67], s54 offen
    v_mfma_f32_16x16x32_bf16 v[192:195], a[192:195], v[32:35], v[192:195]
    v_exp_f32 v20, v20
    v_mfma_f32_16x16x32_bf16 v[192:195], a[196:199], v[36:39], v[192:195]
    v_cvt_pk_bf16_f32 v41, v18, v19
    v_mfma_f32_16x16x32_bf16 v[196:199], a[200:203], v[32:35], v[196:199]
    s_mov_b32 s54, 589824
    v_exp_f32 v21, v21
    v_mfma_f32_16x16x32_bf16 v[196:199], a[204:207], v[36:39], v[196:199]
    buffer_load_dwordx4 a[144:147], v6, s[64:67], s54 offen
    v_mfma_f32_16x16x32_bf16 v[200:203], a[208:211], v[32:35], v[200:203]
    v_exp_f32 v22, v22
    v_mfma_f32_16x16x32_bf16 v[200:203], a[212:215], v[36:39], v[200:203]
    v_cvt_pk_bf16_f32 v42, v20, v21
    v_mfma_f32_16x16x32_bf16 v[204:207], a[216:219], v[32:35], v[204:207]
    s_mov_b32 s54, 737280
    v_exp_f32 v23, v23
    v_mfma_f32_16x16x32_bf16 v[204:207], a[220:223], v[36:39], v[204:207]
    buffer_load_dwordx4 a[148:151], v6, s[64:67], s54 offen
    v_mfma_f32_16x16x32_bf16 v[208:211], a[224:227], v[32:35], v[208:211]
    v_exp_f32 v24, v24
    v_mfma_f32_16x16x32_bf16 v[208:211], a[228:231], v[36:39], v[208:211]
    v_cvt_pk_bf16_f32 v43, v22, v23
    v_mfma_f32_16x16x32_bf16 v[212:215], a[232:235], v[32:35], v[212:215]
    s_mov_b32 s54, 884736
    v_exp_f32 v25, v25
    v_mfma_f32_16x16x32_bf16 v[212:215], a[236:239], v[36:39], v[212:215]
    buffer_load_dwordx4 a[152:155], v6, s[64:67], s54 offen
    v_mfma_f32_16x16x32_bf16 v[216:219], a[240:243], v[32:35], v[216:219]
    v_exp_f32 v26, v26
    v_mfma_f32_16x16x32_bf16 v[216:219], a[244:247], v[36:39], v[216:219]
    v_cvt_pk_bf16_f32 v44, v24, v25
    v_mfma_f32_16x16x32_bf16 v[220:223], a[248:251], v[32:35], v[220:223]
    s_mov_b32 s54, 1032192
    v_exp_f32 v27, v27
    v_mfma_f32_16x16x32_bf16 v[220:223], a[252:255], v[36:39], v[220:223]
    buffer_load_dwordx4 a[156:159], v6, s[64:67], s54 offen
    v_smfmac_f32_16x16x64_bf16 a[8:11], a[16:19], v[32:39], v11
    v_exp_f32 v28, v28
    s_nop 0
    v_cvt_pk_bf16_f32 v45, v26, v27
    v_exp_f32 v29, v29
    s_nop 0
    v_exp_f32 v30, v30
    s_nop 0
    v_cvt_pk_bf16_f32 v46, v28, v29
    v_exp_f32 v31, v31
    s_nop 0
    v_cvt_pk_bf16_f32 v47, v30, v31
    s_nop 1
    v_mfma_f32_16x16x32_bf16 v[224:227], a[192:195], v[40:43], v[224:227]
    s_mov_b32 s54, 1179648
    v_mfma_f32_16x16x32_bf16 v[224:227], a[196:199], v[44:47], v[224:227]
    buffer_load_dwordx4 a[160:163], v6, s[64:67], s54 offen
    v_mfma_f32_16x16x32_bf16 v[228:231], a[200:203], v[40:43], v[228:231]
    s_mov_b32 s54, 0
    v_mfma_f32_16x16x32_bf16 v[228:231], a[204:207], v[44:47], v[228:231]
    buffer_load_dwordx4 a[164:167], v6, s[68:71], s54 offen
    v_mfma_f32_16x16x32_bf16 v[232:235], a[208:211], v[40:43], v[232:235]
    s_mov_b32 s54, 147456
    v_mfma_f32_16x16x32_bf16 v[232:235], a[212:215], v[44:47], v[232:235]
    buffer_load_dwordx4 a[168:171], v6, s[68:71], s54 offen
    v_mfma_f32_16x16x32_bf16 v[236:239], a[216:219], v[40:43], v[236:239]
    s_mov_b32 s54, 294912
    v_mfma_f32_16x16x32_bf16 v[236:239], a[220:223], v[44:47], v[236:239]
    buffer_load_dwordx4 a[172:175], v6, s[68:71], s54 offen
    v_mfma_f32_16x16x32_bf16 v[240:243], a[224:227], v[40:43], v[240:243]
    s_mov_b32 s54, 442368
    v_mfma_f32_16x16x32_bf16 v[240:243], a[228:231], v[44:47], v[240:243]
    buffer_load_dwordx4 a[176:179], v6, s[68:71], s54 offen
    v_mfma_f32_16x16x32_bf16 v[244:247], a[232:235], v[40:43], v[244:247]
    s_mov_b32 s54, 589824
    v_mfma_f32_16x16x32_bf16 v[244:247], a[236:239], v[44:47], v[244:247]
    buffer_load_dwordx4 a[180:183], v6, s[68:71], s54 offen
    v_mfma_f32_16x16x32_bf16 v[248:251], a[240:243], v[40:43], v[248:251]
    s_mov_b32 s54, 737280
    v_mfma_f32_16x16x32_bf16 v[248:251], a[244:247], v[44:47], v[248:251]
    buffer_load_dwordx4 a[184:187], v6, s[68:71], s54 offen
    v_mfma_f32_16x16x32_bf16 v[252:255], a[248:251], v[40:43], v[252:255]
    s_mov_b32 s54, 884736
    v_mfma_f32_16x16x32_bf16 v[252:255], a[252:255], v[44:47], v[252:255]
    buffer_load_dwordx4 a[188:191], v6, s[68:71], s54 offen
    v_smfmac_f32_16x16x64_bf16 a[12:15], a[16:19], v[40:47], v11
    s_nop 7
    v_accvgpr_read_b32 v12, a0
    v_accvgpr_read_b32 v16, a1
    v_accvgpr_read_b32 v13, a4
    v_accvgpr_read_b32 v17, a5
    v_accvgpr_read_b32 v14, a8
    v_accvgpr_read_b32 v18, a9
    v_accvgpr_read_b32 v15, a12
    v_accvgpr_read_b32 v19, a13
    v_add_f32 v12, v12, v16
    v_add_f32 v13, v13, v17
    v_add_f32 v14, v14, v18
    v_add_f32 v15, v15, v19
    s_mov_b32 s3, 0x5d800000
    v_cmp_nlt_f32 s[56:57], v12, s3
    v_cmp_nlt_f32 s[58:59], v13, s3
    v_cmp_nlt_f32 s[60:61], v14, s3
    v_cmp_nlt_f32 s[62:63], v15, s3
    s_or_b64 s[56:57], s[56:57], s[58:59]
    s_or_b64 s[60:61], s[60:61], s[62:63]
    s_or_b64 s[56:57], s[56:57], s[60:61]
    s_cselect_b32 s3, 1, 0
    s_lshl_b32 s14, s51, 2
    s_add_u32 s14, s14, 13824
    v_mov_b32 v16, s3
    v_mov_b32 v17, s14
    v_mov_b32 v18, 13824
    ds_write_b32 v17, v16
    v_rcp_f32 v12, v12
    v_rcp_f32 v13, v13
    v_rcp_f32 v14, v14
    v_rcp_f32 v15, v15
    s_waitcnt vmcnt(32) lgkmcnt(0)
    s_barrier
    ds_read_b128 v[20:23], v18
    ds_read_b64_tr_b16 a[64:65], v4 offset:0
    ds_read_b64_tr_b16 a[66:67], v4 offset:128
    ds_read_b64_tr_b16 a[68:69], v4 offset:256
    ds_read_b64_tr_b16 a[70:71], v4 offset:384
    ds_read_b64_tr_b16 a[72:73], v4 offset:512
    ds_read_b64_tr_b16 a[74:75], v4 offset:640
    ds_read_b64_tr_b16 a[76:77], v4 offset:768
    ds_read_b64_tr_b16 a[78:79], v4 offset:896
    ds_read_b64_tr_b16 a[80:81], v4 offset:16896
    ds_read_b64_tr_b16 a[82:83], v4 offset:17024
    ds_read_b64_tr_b16 a[84:85], v4 offset:17152
    ds_read_b64_tr_b16 a[86:87], v4 offset:17280
    ds_read_b64_tr_b16 a[88:89], v4 offset:17408
    ds_read_b64_tr_b16 a[90:91], v4 offset:17536
    ds_read_b64_tr_b16 a[92:93], v4 offset:17664
    ds_read_b64_tr_b16 a[94:95], v4 offset:17792
    v_mul_f32 v128, v128, v12
    v_mul_f32 v129, v129, v12
    v_mul_f32 v130, v130, v12
    v_mul_f32 v131, v131, v12
    v_mul_f32 v132, v132, v12
    v_mul_f32 v133, v133, v12
    v_mul_f32 v134, v134, v12
    v_mul_f32 v135, v135, v12
    v_cvt_pk_bf16_f32 v128, v128, v129
    v_cvt_pk_bf16_f32 v129, v130, v131
    v_cvt_pk_bf16_f32 v130, v132, v133
    v_cvt_pk_bf16_f32 v131, v134, v135
    s_mov_b32 s54, 1032192
    buffer_load_dwordx4 a[192:195], v6, s[68:71], s54 offen
    v_mul_f32 v160, v160, v13
    v_mul_f32 v161, v161, v13
    v_mul_f32 v162, v162, v13
    v_mul_f32 v163, v163, v13
    v_mul_f32 v164, v164, v13
    v_mul_f32 v165, v165, v13
    v_mul_f32 v166, v166, v13
    v_mul_f32 v167, v167, v13
    v_cvt_pk_bf16_f32 v160, v160, v161
    v_cvt_pk_bf16_f32 v161, v162, v163
    v_cvt_pk_bf16_f32 v162, v164, v165
    v_cvt_pk_bf16_f32 v163, v166, v167
    s_mov_b32 s54, 1179648
    buffer_load_dwordx4 a[196:199], v6, s[68:71], s54 offen
    v_mul_f32 v136, v136, v12
    v_mul_f32 v137, v137, v12
    v_mul_f32 v138, v138, v12
    v_mul_f32 v139, v139, v12
    v_mul_f32 v140, v140, v12
    v_mul_f32 v141, v141, v12
    v_mul_f32 v142, v142, v12
    v_mul_f32 v143, v143, v12
    v_cvt_pk_bf16_f32 v136, v136, v137
    v_cvt_pk_bf16_f32 v137, v138, v139
    v_cvt_pk_bf16_f32 v138, v140, v141
    v_cvt_pk_bf16_f32 v139, v142, v143
    s_add_u32 s54, s55, 0
    buffer_load_dwordx4 a[200:203], v8, s[72:75], s54 offen
    v_mul_f32 v168, v168, v13
    v_mul_f32 v169, v169, v13
    v_mul_f32 v170, v170, v13
    v_mul_f32 v171, v171, v13
    v_mul_f32 v172, v172, v13
    v_mul_f32 v173, v173, v13
    v_mul_f32 v174, v174, v13
    v_mul_f32 v175, v175, v13
    v_cvt_pk_bf16_f32 v168, v168, v169
    v_cvt_pk_bf16_f32 v169, v170, v171
    v_cvt_pk_bf16_f32 v170, v172, v173
    v_cvt_pk_bf16_f32 v171, v174, v175
    s_add_u32 s54, s55, 1024
    buffer_load_dwordx4 a[204:207], v8, s[72:75], s54 offen
    v_mul_f32 v144, v144, v12
    v_mul_f32 v145, v145, v12
    v_mul_f32 v146, v146, v12
    v_mul_f32 v147, v147, v12
    v_mul_f32 v148, v148, v12
    v_mul_f32 v149, v149, v12
    v_mul_f32 v150, v150, v12
    v_mul_f32 v151, v151, v12
    v_cvt_pk_bf16_f32 v144, v144, v145
    v_cvt_pk_bf16_f32 v145, v146, v147
    v_cvt_pk_bf16_f32 v146, v148, v149
    v_cvt_pk_bf16_f32 v147, v150, v151
    s_add_u32 s54, s55, 2048
    buffer_load_dwordx4 a[208:211], v8, s[72:75], s54 offen
    v_mul_f32 v176, v176, v13
    v_mul_f32 v177, v177, v13
    v_mul_f32 v178, v178, v13
    v_mul_f32 v179, v179, v13
    v_mul_f32 v180, v180, v13
    v_mul_f32 v181, v181, v13
    v_mul_f32 v182, v182, v13
    v_mul_f32 v183, v183, v13
    v_cvt_pk_bf16_f32 v176, v176, v177
    v_cvt_pk_bf16_f32 v177, v178, v179
    v_cvt_pk_bf16_f32 v178, v180, v181
    v_cvt_pk_bf16_f32 v179, v182, v183
    s_add_u32 s54, s55, 3072
    buffer_load_dwordx4 a[212:215], v8, s[72:75], s54 offen
    v_mul_f32 v152, v152, v12
    v_mul_f32 v153, v153, v12
    v_mul_f32 v154, v154, v12
    v_mul_f32 v155, v155, v12
    v_mul_f32 v156, v156, v12
    v_mul_f32 v157, v157, v12
    v_mul_f32 v158, v158, v12
    v_mul_f32 v159, v159, v12
    v_cvt_pk_bf16_f32 v152, v152, v153
    v_cvt_pk_bf16_f32 v153, v154, v155
    v_cvt_pk_bf16_f32 v154, v156, v157
    v_cvt_pk_bf16_f32 v155, v158, v159
    s_add_u32 s54, s55, 4096
    buffer_load_dwordx4 a[216:219], v8, s[72:75], s54 offen
    v_mul_f32 v184, v184, v13
    v_mul_f32 v185, v185, v13
    v_mul_f32 v186, v186, v13
    v_mul_f32 v187, v187, v13
    v_mul_f32 v188, v188, v13
    v_mul_f32 v189, v189, v13
    v_mul_f32 v190, v190, v13
    v_mul_f32 v191, v191, v13
    v_cvt_pk_bf16_f32 v184, v184, v185
    v_cvt_pk_bf16_f32 v185, v186, v187
    v_cvt_pk_bf16_f32 v186, v188, v189
    v_cvt_pk_bf16_f32 v187, v190, v191
    s_add_u32 s54, s55, 5120
    buffer_load_dwordx4 a[220:223], v8, s[72:75], s54 offen
    v_mul_f32 v192, v192, v14
    v_mul_f32 v193, v193, v14
    v_mul_f32 v194, v194, v14
    v_mul_f32 v195, v195, v14
    v_mul_f32 v196, v196, v14
    v_mul_f32 v197, v197, v14
    v_mul_f32 v198, v198, v14
    v_mul_f32 v199, v199, v14
    v_cvt_pk_bf16_f32 v192, v192, v193
    v_cvt_pk_bf16_f32 v193, v194, v195
    v_cvt_pk_bf16_f32 v194, v196, v197
    v_cvt_pk_bf16_f32 v195, v198, v199
    s_add_u32 s54, s55, 6144
    buffer_load_dwordx4 a[224:227], v8, s[72:75], s54 offen
    v_mul_f32 v224, v224, v15
    v_mul_f32 v225, v225, v15
    v_mul_f32 v226, v226, v15
    v_mul_f32 v227, v227, v15
    v_mul_f32 v228, v228, v15
    v_mul_f32 v229, v229, v15
    v_mul_f32 v230, v230, v15
    v_mul_f32 v231, v231, v15
    v_cvt_pk_bf16_f32 v224, v224, v225
    v_cvt_pk_bf16_f32 v225, v226, v227
    v_cvt_pk_bf16_f32 v226, v228, v229
    v_cvt_pk_bf16_f32 v227, v230, v231
    s_add_u32 s54, s55, 7168
    buffer_load_dwordx4 a[228:231], v8, s[72:75], s54 offen
    v_mul_f32 v200, v200, v14
    v_mul_f32 v201, v201, v14
    v_mul_f32 v202, v202, v14
    v_mul_f32 v203, v203, v14
    v_mul_f32 v204, v204, v14
    v_mul_f32 v205, v205, v14
    v_mul_f32 v206, v206, v14
    v_mul_f32 v207, v207, v14
    v_cvt_pk_bf16_f32 v200, v200, v201
    v_cvt_pk_bf16_f32 v201, v202, v203
    v_cvt_pk_bf16_f32 v202, v204, v205
    v_cvt_pk_bf16_f32 v203, v206, v207
    s_add_u32 s54, s55, 8192
    buffer_load_dwordx4 a[232:235], v8, s[72:75], s54 offen
    v_mul_f32 v232, v232, v15
    v_mul_f32 v233, v233, v15
    v_mul_f32 v234, v234, v15
    v_mul_f32 v235, v235, v15
    v_mul_f32 v236, v236, v15
    v_mul_f32 v237, v237, v15
    v_mul_f32 v238, v238, v15
    v_mul_f32 v239, v239, v15
    v_cvt_pk_bf16_f32 v232, v232, v233
    v_cvt_pk_bf16_f32 v233, v234, v235
    v_cvt_pk_bf16_f32 v234, v236, v237
    v_cvt_pk_bf16_f32 v235, v238, v239
    v_mul_f32 v208, v208, v14
    v_mul_f32 v209, v209, v14
    v_mul_f32 v210, v210, v14
    v_mul_f32 v211, v211, v14
    v_mul_f32 v212, v212, v14
    v_mul_f32 v213, v213, v14
    v_mul_f32 v214, v214, v14
    v_mul_f32 v215, v215, v14
    v_cvt_pk_bf16_f32 v208, v208, v209
    v_cvt_pk_bf16_f32 v209, v210, v211
    v_cvt_pk_bf16_f32 v210, v212, v213
    v_cvt_pk_bf16_f32 v211, v214, v215
    v_mul_f32 v240, v240, v15
    v_mul_f32 v241, v241, v15
    v_mul_f32 v242, v242, v15
    v_mul_f32 v243, v243, v15
    v_mul_f32 v244, v244, v15
    v_mul_f32 v245, v245, v15
    v_mul_f32 v246, v246, v15
    v_mul_f32 v247, v247, v15
    v_cvt_pk_bf16_f32 v240, v240, v241
    v_cvt_pk_bf16_f32 v241, v242, v243
    v_cvt_pk_bf16_f32 v242, v244, v245
    v_cvt_pk_bf16_f32 v243, v246, v247
    v_mul_f32 v216, v216, v14
    v_mul_f32 v217, v217, v14
    v_mul_f32 v218, v218, v14
    v_mul_f32 v219, v219, v14
    v_mul_f32 v220, v220, v14
    v_mul_f32 v221, v221, v14
    v_mul_f32 v222, v222, v14
    v_mul_f32 v223, v223, v14
    v_cvt_pk_bf16_f32 v216, v216, v217
    v_cvt_pk_bf16_f32 v217, v218, v219
    v_cvt_pk_bf16_f32 v218, v220, v221
    v_cvt_pk_bf16_f32 v219, v222, v223
    v_mul_f32 v248, v248, v15
    v_mul_f32 v249, v249, v15
    v_mul_f32 v250, v250, v15
    v_mul_f32 v251, v251, v15
    v_mul_f32 v252, v252, v15
    v_mul_f32 v253, v253, v15
    v_mul_f32 v254, v254, v15
    v_mul_f32 v255, v255, v15
    v_cvt_pk_bf16_f32 v248, v248, v249
    v_cvt_pk_bf16_f32 v249, v250, v251
    v_cvt_pk_bf16_f32 v250, v252, v253
    v_cvt_pk_bf16_f32 v251, v254, v255
    s_waitcnt lgkmcnt(12)
    v_or3_b32 v20, v20, v21, v22
    v_or_b32 v20, v20, v23
    s_nop 0
    v_readfirstlane_b32 s3, v20
    s_nop 0
    s_andn2_b32 s3, s3, s50
    s_cbranch_scc1 L2_fallback
    s_mul_i32 s3, s51, 288
    v_lshrrev_b32 v15, 3, v0
    v_lshl_add_u32 v12, v15, 4, s3
    v_and_b32 v15, 1, v15
    v_lshl_add_u32 v13, v15, 4, s3
    v_and_b32 v14, 7, v0
    v_mul_u32_u24 v14, 1152, v14
    v_add_u32 v1, v14, v12
    v_add_u32 v2, v14, v13
    v_add_u32 v2, 256, v2
    v_mfma_f32_16x16x32_bf16 v[16:19], a[64:67], v[128:131], 0
    ds_read_b64_tr_b16 a[96:97], v4 offset:32
    ds_read_b64_tr_b16 a[98:99], v4 offset:160
    v_mfma_f32_16x16x32_bf16 v[16:19], a[68:71], v[136:139], v[16:19]
    s_waitcnt lgkmcnt(10)
    ds_read_b64_tr_b16 a[100:101], v4 offset:288
    ds_read_b64_tr_b16 a[102:103], v4 offset:416
    v_mfma_f32_16x16x32_bf16 v[16:19], a[72:75], v[144:147], v[16:19]
    s_add_u32 m0, s44, 36864
    ds_read_b64_tr_b16 a[104:105], v4 offset:544
    ds_read_b64_tr_b16 a[106:107], v4 offset:672
    v_mfma_f32_16x16x32_bf16 v[16:19], a[76:79], v[152:155], v[16:19]
    s_mov_b32 s45, 384
    s_waitcnt lgkmcnt(10)
    buffer_load_dwordx4 v7, s[28:31], s45 offen offset:0 lds
    v_mfma_f32_16x16x32_bf16 v[16:19], a[80:83], v[192:195], v[16:19]
    s_add_u32 m0, s44, 36768
    ds_read_b64_tr_b16 a[108:109], v4 offset:800
    ds_read_b64_tr_b16 a[110:111], v4 offset:928
    v_mfma_f32_16x16x32_bf16 v[16:19], a[84:87], v[200:203], v[16:19]
    s_waitcnt lgkmcnt(8)
    buffer_load_dwordx4 v7, s[28:31], s45 offen offset:1152 lds
    v_mfma_f32_16x16x32_bf16 v[16:19], a[88:91], v[208:211], v[16:19]
    s_add_u32 m0, s44, 36672
    ds_read_b64_tr_b16 a[112:113], v4 offset:16928
    ds_read_b64_tr_b16 a[114:115], v4 offset:17056
    v_mfma_f32_16x16x32_bf16 v[16:19], a[92:95], v[216:219], v[16:19]
    buffer_load_dwordx4 v7, s[28:31], s45 offen offset:2304 lds
    v_mfma_f32_16x16x32_bf16 v[20:23], a[64:67], v[160:163], 0
    s_add_u32 m0, s44, 36576
    ds_read_b64_tr_b16 a[116:117], v4 offset:17184
    ds_read_b64_tr_b16 a[118:119], v4 offset:17312
    v_mfma_f32_16x16x32_bf16 v[20:23], a[68:71], v[168:171], v[20:23]
    buffer_load_dwordx4 v7, s[28:31], s45 offen offset:3456 lds
    v_mfma_f32_16x16x32_bf16 v[20:23], a[72:75], v[176:179], v[20:23]
    s_add_u32 m0, s44, 53760
    ds_read_b64_tr_b16 a[120:121], v4 offset:17440
    ds_read_b64_tr_b16 a[122:123], v4 offset:17568
    v_mfma_f32_16x16x32_bf16 v[20:23], a[76:79], v[184:187], v[20:23]
    s_mov_b32 s45, 147840
    buffer_load_dwordx4 v7, s[28:31], s45 offen offset:0 lds
    v_mfma_f32_16x16x32_bf16 v[20:23], a[80:83], v[224:227], v[20:23]
    s_add_u32 m0, s44, 53664
    ds_read_b64_tr_b16 a[124:125], v4 offset:17696
    v_mfma_f32_16x16x32_bf16 v[20:23], a[84:87], v[232:235], v[20:23]
    buffer_load_dwordx4 v7, s[28:31], s45 offen offset:1152 lds
    v_mfma_f32_16x16x32_bf16 v[20:23], a[88:91], v[240:243], v[20:23]
    s_add_u32 m0, s44, 53568
    ds_read_b64_tr_b16 a[126:127], v4 offset:17824
    v_mfma_f32_16x16x32_bf16 v[20:23], a[92:95], v[248:251], v[20:23]
    s_waitcnt lgkmcnt(12)
    buffer_load_dwordx4 v7, s[28:31], s45 offen offset:2304 lds
    v_mfma_f32_16x16x32_bf16 v[24:27], a[96:99], v[128:131], 0
    s_add_u32 m0, s44, 53472
    ds_read_b64_tr_b16 a[64:65], v4 offset:64
    ds_read_b64_tr_b16 a[66:67], v4 offset:192
    v_mfma_f32_16x16x32_bf16 v[24:27], a[100:103], v[136:139], v[24:27]
    s_waitcnt lgkmcnt(10)
    buffer_load_dwordx4 v7, s[28:31], s45 offen offset:3456 lds
    v_mfma_f32_16x16x32_bf16 v[24:27], a[104:107], v[144:147], v[24:27]
    ds_read_b64_tr_b16 a[68:69], v4 offset:320
    ds_read_b64_tr_b16 a[70:71], v4 offset:448
    v_mfma_f32_16x16x32_bf16 v[24:27], a[108:111], v[152:155], v[24:27]
    s_waitcnt lgkmcnt(8)
    buffer_load_dwordx4 v[64:67], v1, s[76:79], 0 offen offset:0
    v_mfma_f32_16x16x32_bf16 v[24:27], a[112:115], v[192:195], v[24:27]
    ds_read_b64_tr_b16 a[72:73], v4 offset:576
    ds_read_b64_tr_b16 a[74:75], v4 offset:704
    v_mfma_f32_16x16x32_bf16 v[24:27], a[116:119], v[200:203], v[24:27]
    s_waitcnt lgkmcnt(6)
    buffer_load_dwordx4 v[68:71], v1, s[76:79], 0 offen offset:128
    v_mfma_f32_16x16x32_bf16 v[24:27], a[120:123], v[208:211], v[24:27]
    ds_read_b64_tr_b16 a[76:77], v4 offset:832
    ds_read_b64_tr_b16 a[78:79], v4 offset:960
    v_mfma_f32_16x16x32_bf16 v[24:27], a[124:127], v[216:219], v[24:27]
    buffer_load_dwordx4 v[72:75], v2, s[76:79], 0 offen offset:0
    v_mfma_f32_16x16x32_bf16 v[28:31], a[96:99], v[160:163], 0
    ds_read_b64_tr_b16 a[80:81], v4 offset:16960
    ds_read_b64_tr_b16 a[82:83], v4 offset:17088
    v_mfma_f32_16x16x32_bf16 v[28:31], a[100:103], v[168:171], v[28:31]
    buffer_load_dwordx4 v[112:115], v12, s[36:39], 0 offen offset:0
    v_mfma_f32_16x16x32_bf16 v[28:31], a[104:107], v[176:179], v[28:31]
    ds_read_b64_tr_b16 a[84:85], v4 offset:17216
    ds_read_b64_tr_b16 a[86:87], v4 offset:17344
    v_mfma_f32_16x16x32_bf16 v[28:31], a[108:111], v[184:187], v[28:31]
    buffer_load_dwordx4 v[116:119], v12, s[36:39], 0 offen offset:128
    v_mfma_f32_16x16x32_bf16 v[28:31], a[112:115], v[224:227], v[28:31]
    ds_read_b64_tr_b16 a[88:89], v4 offset:17472
    ds_read_b64_tr_b16 a[90:91], v4 offset:17600
    v_mfma_f32_16x16x32_bf16 v[28:31], a[116:119], v[232:235], v[28:31]
    buffer_load_dwordx4 v[120:123], v13, s[36:39], 0 offen offset:256
    v_mfma_f32_16x16x32_bf16 v[28:31], a[120:123], v[240:243], v[28:31]
    ds_read_b64_tr_b16 a[92:93], v4 offset:17728
    v_mfma_f32_16x16x32_bf16 v[28:31], a[124:127], v[248:251], v[28:31]
    s_waitcnt lgkmcnt(11)
    ds_read_b64_tr_b16 a[94:95], v4 offset:17856
    v_mfma_f32_16x16x32_bf16 v[32:35], a[64:67], v[128:131], 0
    ds_read_b64_tr_b16 a[96:97], v4 offset:96
    v_cvt_pk_bf16_f32 v48, v16, v17
    v_mfma_f32_16x16x32_bf16 v[32:35], a[68:71], v[136:139], v[32:35]
    s_waitcnt lgkmcnt(9)
    ds_read_b64_tr_b16 a[98:99], v4 offset:224
    v_cvt_pk_bf16_f32 v49, v18, v19
    v_mfma_f32_16x16x32_bf16 v[32:35], a[72:75], v[144:147], v[32:35]
    ds_read_b64_tr_b16 a[100:101], v4 offset:352
    v_cvt_pk_bf16_f32 v50, v24, v25
    v_mfma_f32_16x16x32_bf16 v[32:35], a[76:79], v[152:155], v[32:35]
    s_waitcnt lgkmcnt(7)
    ds_read_b64_tr_b16 a[102:103], v4 offset:480
    v_cvt_pk_bf16_f32 v51, v26, v27
    v_mfma_f32_16x16x32_bf16 v[32:35], a[80:83], v[192:195], v[32:35]
    s_mov_b32 s54, 0
    ds_read_b64_tr_b16 a[104:105], v4 offset:608
    ds_read_b64_tr_b16 a[106:107], v4 offset:736
    v_mfma_f32_16x16x32_bf16 v[32:35], a[84:87], v[200:203], v[32:35]
    s_waitcnt lgkmcnt(6)
    v_permlane32_swap_b32 v48, v50
    v_mfma_f32_16x16x32_bf16 v[32:35], a[88:91], v[208:211], v[32:35]
    v_permlane32_swap_b32 v49, v51
    v_mfma_f32_16x16x32_bf16 v[32:35], a[92:95], v[216:219], v[32:35]
    ds_read_b64_tr_b16 a[108:109], v4 offset:864
    ds_read_b64_tr_b16 a[110:111], v4 offset:992
    buffer_store_dwordx4 v[48:51], v10, s[40:43], s54 offen offset:0 sc1
    v_mfma_f32_16x16x32_bf16 v[36:39], a[64:67], v[160:163], 0
    ds_read_b64_tr_b16 a[112:113], v4 offset:16992
    v_cvt_pk_bf16_f32 v52, v20, v21
    v_mfma_f32_16x16x32_bf16 v[36:39], a[68:71], v[168:171], v[36:39]
    ds_read_b64_tr_b16 a[114:115], v4 offset:17120
    v_cvt_pk_bf16_f32 v53, v22, v23
    v_mfma_f32_16x16x32_bf16 v[36:39], a[72:75], v[176:179], v[36:39]
    ds_read_b64_tr_b16 a[116:117], v4 offset:17248
    v_cvt_pk_bf16_f32 v54, v28, v29
    v_mfma_f32_16x16x32_bf16 v[36:39], a[76:79], v[184:187], v[36:39]
    ds_read_b64_tr_b16 a[118:119], v4 offset:17376
    v_cvt_pk_bf16_f32 v55, v30, v31
    v_mfma_f32_16x16x32_bf16 v[36:39], a[80:83], v[224:227], v[36:39]
    s_mov_b32 s54, 294912
    ds_read_b64_tr_b16 a[120:121], v4 offset:17504
    ds_read_b64_tr_b16 a[122:123], v4 offset:17632
    v_mfma_f32_16x16x32_bf16 v[36:39], a[84:87], v[232:235], v[36:39]
    v_permlane32_swap_b32 v52, v54
    v_mfma_f32_16x16x32_bf16 v[36:39], a[88:91], v[240:243], v[36:39]
    v_permlane32_swap_b32 v53, v55
    v_mfma_f32_16x16x32_bf16 v[36:39], a[92:95], v[248:251], v[36:39]
    s_waitcnt vmcnt(50)
    s_barrier
    s_waitcnt lgkmcnt(10)
    ds_read_b64_tr_b16 a[124:125], v4 offset:17760
    ds_read_b64_tr_b16 a[126:127], v4 offset:17888
    buffer_store_dwordx4 v[52:55], v10, s[40:43], s54 offen offset:0 sc1
    v_mfma_f32_16x16x32_bf16 v[40:43], a[96:99], v[128:131], 0
    ds_read_b64_tr_b16 a[64:65], v4 offset:36864
    v_mfma_f32_16x16x32_bf16 v[40:43], a[100:103], v[136:139], v[40:43]
    s_waitcnt lgkmcnt(9)
    ds_read_b64_tr_b16 a[66:67], v4 offset:36992
    v_mfma_f32_16x16x32_bf16 v[40:43], a[104:107], v[144:147], v[40:43]
    ds_read_b64_tr_b16 a[68:69], v4 offset:37120
    v_mfma_f32_16x16x32_bf16 v[40:43], a[108:111], v[152:155], v[40:43]
    s_waitcnt lgkmcnt(7)
    ds_read_b64_tr_b16 a[70:71], v4 offset:37248
    v_mfma_f32_16x16x32_bf16 v[40:43], a[112:115], v[192:195], v[40:43]
    ds_read_b64_tr_b16 a[72:73], v4 offset:37376
    v_mfma_f32_16x16x32_bf16 v[40:43], a[116:119], v[200:203], v[40:43]
    s_waitcnt lgkmcnt(5)
    ds_read_b64_tr_b16 a[74:75], v4 offset:37504
    v_mfma_f32_16x16x32_bf16 v[40:43], a[120:123], v[208:211], v[40:43]
    ds_read_b64_tr_b16 a[76:77], v4 offset:37632
    v_mfma_f32_16x16x32_bf16 v[40:43], a[124:127], v[216:219], v[40:43]
    ds_read_b64_tr_b16 a[78:79], v4 offset:37760
    v_mfma_f32_16x16x32_bf16 v[44:47], a[96:99], v[160:163], 0
    ds_read_b64_tr_b16 a[80:81], v4 offset:53760
    v_mfma_f32_16x16x32_bf16 v[44:47], a[100:103], v[168:171], v[44:47]
    ds_read_b64_tr_b16 a[82:83], v4 offset:53888
    v_mfma_f32_16x16x32_bf16 v[44:47], a[104:107], v[176:179], v[44:47]
    ds_read_b64_tr_b16 a[84:85], v4 offset:54016
    v_mfma_f32_16x16x32_bf16 v[44:47], a[108:111], v[184:187], v[44:47]
    ds_read_b64_tr_b16 a[86:87], v4 offset:54144
    v_mfma_f32_16x16x32_bf16 v[44:47], a[112:115], v[224:227], v[44:47]
    ds_read_b64_tr_b16 a[88:89], v4 offset:54272
    v_mfma_f32_16x16x32_bf16 v[44:47], a[116:119], v[232:235], v[44:47]
    ds_read_b64_tr_b16 a[90:91], v4 offset:54400
    v_mfma_f32_16x16x32_bf16 v[44:47], a[120:123], v[240:243], v[44:47]
    ds_read_b64_tr_b16 a[92:93], v4 offset:54528
    v_mfma_f32_16x16x32_bf16 v[44:47], a[124:127], v[248:251], v[44:47]
    s_waitcnt lgkmcnt(11)
    ds_read_b64_tr_b16 a[94:95], v4 offset:54656
    v_mfma_f32_16x16x32_bf16 v[16:19], a[64:67], v[128:131], 0
    ds_read_b64_tr_b16 a[96:97], v4 offset:36896
    v_cvt_pk_bf16_f32 v48, v32, v33
    v_mfma_f32_16x16x32_bf16 v[16:19], a[68:71], v[136:139], v[16:19]
    s_waitcnt lgkmcnt(9)
    ds_read_b64_tr_b16 a[98:99], v4 offset:37024
    v_cvt_pk_bf16_f32 v49, v34, v35
    v_mfma_f32_16x16x32_bf16 v[16:19], a[72:75], v[144:147], v[16:19]
    ds_read_b64_tr_b16 a[100:101], v4 offset:37152
    v_cvt_pk_bf16_f32 v50, v40, v41
    v_mfma_f32_16x16x32_bf16 v[16:19], a[76:79], v[152:155], v[16:19]
    s_waitcnt lgkmcnt(7)
    ds_read_b64_tr_b16 a[102:103], v4 offset:37280
    v_cvt_pk_bf16_f32 v51, v42, v43
    v_mfma_f32_16x16x32_bf16 v[16:19], a[80:83], v[192:195], v[16:19]
    s_mov_b32 s54, 0
    ds_read_b64_tr_b16 a[104:105], v4 offset:37408
    ds_read_b64_tr_b16 a[106:107], v4 offset:37536
    v_mfma_f32_16x16x32_bf16 v[16:19], a[84:87], v[200:203], v[16:19]
    s_waitcnt lgkmcnt(6)
    v_permlane32_swap_b32 v48, v50
    v_mfma_f32_16x16x32_bf16 v[16:19], a[88:91], v[208:211], v[16:19]
    v_permlane32_swap_b32 v49, v51
    v_mfma_f32_16x16x32_bf16 v[16:19], a[92:95], v[216:219], v[16:19]
    ds_read_b64_tr_b16 a[108:109], v4 offset:37664
    ds_read_b64_tr_b16 a[110:111], v4 offset:37792
    buffer_store_dwordx4 v[48:51], v10, s[40:43], s54 offen offset:512 sc1
    v_mfma_f32_16x16x32_bf16 v[20:23], a[64:67], v[160:163], 0
    ds_read_b64_tr_b16 a[112:113], v4 offset:53792
    v_cvt_pk_bf16_f32 v52, v36, v37
    v_mfma_f32_16x16x32_bf16 v[20:23], a[68:71], v[168:171], v[20:23]
    ds_read_b64_tr_b16 a[114:115], v4 offset:53920
    v_cvt_pk_bf16_f32 v53, v38, v39
    v_mfma_f32_16x16x32_bf16 v[20:23], a[72:75], v[176:179], v[20:23]
    ds_read_b64_tr_b16 a[116:117], v4 offset:54048
    v_cvt_pk_bf16_f32 v54, v44, v45
    v_mfma_f32_16x16x32_bf16 v[20:23], a[76:79], v[184:187], v[20:23]
    ds_read_b64_tr_b16 a[118:119], v4 offset:54176
    v_cvt_pk_bf16_f32 v55, v46, v47
    v_mfma_f32_16x16x32_bf16 v[20:23], a[80:83], v[224:227], v[20:23]
    s_mov_b32 s54, 294912
    ds_read_b64_tr_b16 a[120:121], v4 offset:54304
    ds_read_b64_tr_b16 a[122:123], v4 offset:54432
    v_mfma_f32_16x16x32_bf16 v[20:23], a[84:87], v[232:235], v[20:23]
    v_permlane32_swap_b32 v52, v54
    v_mfma_f32_16x16x32_bf16 v[20:23], a[88:91], v[240:243], v[20:23]
    v_permlane32_swap_b32 v53, v55
    v_mfma_f32_16x16x32_bf16 v[20:23], a[92:95], v[248:251], v[20:23]
    s_waitcnt lgkmcnt(10)
    ds_read_b64_tr_b16 a[124:125], v4 offset:54560
    ds_read_b64_tr_b16 a[126:127], v4 offset:54688
    buffer_store_dwordx4 v[52:55], v10, s[40:43], s54 offen offset:512 sc1
    v_mfma_f32_16x16x32_bf16 v[24:27], a[96:99], v[128:131], 0
    ds_read_b64_tr_b16 a[64:65], v4 offset:36928
    v_mfma_f32_16x16x32_bf16 v[24:27], a[100:103], v[136:139], v[24:27]
    s_waitcnt lgkmcnt(9)
    ds_read_b64_tr_b16 a[66:67], v4 offset:37056
    v_mfma_f32_16x16x32_bf16 v[24:27], a[104:107], v[144:147], v[24:27]
    ds_read_b64_tr_b16 a[68:69], v4 offset:37184
    v_mfma_f32_16x16x32_bf16 v[24:27], a[108:111], v[152:155], v[24:27]
    s_waitcnt lgkmcnt(7)
    ds_read_b64_tr_b16 a[70:71], v4 offset:37312
    v_mfma_f32_16x16x32_bf16 v[24:27], a[112:115], v[192:195], v[24:27]
    ds_read_b64_tr_b16 a[72:73], v4 offset:37440
    v_mfma_f32_16x16x32_bf16 v[24:27], a[116:119], v[200:203], v[24:27]
    s_waitcnt lgkmcnt(5)
    ds_read_b64_tr_b16 a[74:75], v4 offset:37568
    v_mfma_f32_16x16x32_bf16 v[24:27], a[120:123], v[208:211], v[24:27]
    ds_read_b64_tr_b16 a[76:77], v4 offset:37696
    v_mfma_f32_16x16x32_bf16 v[24:27], a[124:127], v[216:219], v[24:27]
    ds_read_b64_tr_b16 a[78:79], v4 offset:37824
    v_mfma_f32_16x16x32_bf16 v[28:31], a[96:99], v[160:163], 0
    ds_read_b64_tr_b16 a[80:81], v4 offset:53824
    v_mfma_f32_16x16x32_bf16 v[28:31], a[100:103], v[168:171], v[28:31]
    ds_read_b64_tr_b16 a[82:83], v4 offset:53952
    v_mfma_f32_16x16x32_bf16 v[28:31], a[104:107], v[176:179], v[28:31]
    ds_read_b64_tr_b16 a[84:85], v4 offset:54080
    v_mfma_f32_16x16x32_bf16 v[28:31], a[108:111], v[184:187], v[28:31]
    ds_read_b64_tr_b16 a[86:87], v4 offset:54208
    v_mfma_f32_16x16x32_bf16 v[28:31], a[112:115], v[224:227], v[28:31]
    ds_read_b64_tr_b16 a[88:89], v4 offset:54336
    v_mfma_f32_16x16x32_bf16 v[28:31], a[116:119], v[232:235], v[28:31]
    ds_read_b64_tr_b16 a[90:91], v4 offset:54464
    v_mfma_f32_16x16x32_bf16 v[28:31], a[120:123], v[240:243], v[28:31]
    ds_read_b64_tr_b16 a[92:93], v4 offset:54592
    v_mfma_f32_16x16x32_bf16 v[28:31], a[124:127], v[248:251], v[28:31]
    s_waitcnt lgkmcnt(11)
    ds_read_b64_tr_b16 a[94:95], v4 offset:54720
    v_mfma_f32_16x16x32_bf16 v[32:35], a[64:67], v[128:131], 0
    ds_read_b64_tr_b16 a[96:97], v4 offset:36960
    v_cvt_pk_bf16_f32 v48, v16, v17
    v_mfma_f32_16x16x32_bf16 v[32:35], a[68:71], v[136:139], v[32:35]
    s_waitcnt lgkmcnt(9)
    ds_read_b64_tr_b16 a[98:99], v4 offset:37088
    v_cvt_pk_bf16_f32 v49, v18, v19
    v_mfma_f32_16x16x32_bf16 v[32:35], a[72:75], v[144:147], v[32:35]
    ds_read_b64_tr_b16 a[100:101], v4 offset:37216
    v_cvt_pk_bf16_f32 v50, v24, v25
    v_mfma_f32_16x16x32_bf16 v[32:35], a[76:79], v[152:155], v[32:35]
    s_waitcnt lgkmcnt(7)
    ds_read_b64_tr_b16 a[102:103], v4 offset:37344
    v_cvt_pk_bf16_f32 v51, v26, v27
    v_mfma_f32_16x16x32_bf16 v[32:35], a[80:83], v[192:195], v[32:35]
    s_mov_b32 s54, 1024
    ds_read_b64_tr_b16 a[104:105], v4 offset:37472
    ds_read_b64_tr_b16 a[106:107], v4 offset:37600
    v_mfma_f32_16x16x32_bf16 v[32:35], a[84:87], v[200:203], v[32:35]
    s_waitcnt lgkmcnt(6)
    v_permlane32_swap_b32 v48, v50
    v_mfma_f32_16x16x32_bf16 v[32:35], a[88:91], v[208:211], v[32:35]
    v_permlane32_swap_b32 v49, v51
    v_mfma_f32_16x16x32_bf16 v[32:35], a[92:95], v[216:219], v[32:35]
    ds_read_b64_tr_b16 a[108:109], v4 offset:37728
    ds_read_b64_tr_b16 a[110:111], v4 offset:37856
    buffer_store_dwordx4 v[48:51], v10, s[40:43], s54 offen offset:0 sc1
    v_mfma_f32_16x16x32_bf16 v[36:39], a[64:67], v[160:163], 0
    ds_read_b64_tr_b16 a[112:113], v4 offset:53856
    v_cvt_pk_bf16_f32 v52, v20, v21
    v_mfma_f32_16x16x32_bf16 v[36:39], a[68:71], v[168:171], v[36:39]
    ds_read_b64_tr_b16 a[114:115], v4 offset:53984
    v_cvt_pk_bf16_f32 v53, v22, v23
    v_mfma_f32_16x16x32_bf16 v[36:39], a[72:75], v[176:179], v[36:39]
    ds_read_b64_tr_b16 a[116:117], v4 offset:54112
    v_cvt_pk_bf16_f32 v54, v28, v29
    v_mfma_f32_16x16x32_bf16 v[36:39], a[76:79], v[184:187], v[36:39]
    ds_read_b64_tr_b16 a[118:119], v4 offset:54240
    v_cvt_pk_bf16_f32 v55, v30, v31
    v_mfma_f32_16x16x32_bf16 v[36:39], a[80:83], v[224:227], v[36:39]
    s_mov_b32 s54, 295936
    ds_read_b64_tr_b16 a[120:121], v4 offset:54368
    ds_read_b64_tr_b16 a[122:123], v4 offset:54496
    v_mfma_f32_16x16x32_bf16 v[36:39], a[84:87], v[232:235], v[36:39]
    v_permlane32_swap_b32 v52, v54
    v_mfma_f32_16x16x32_bf16 v[36:39], a[88:91], v[240:243], v[36:39]
    v_permlane32_swap_b32 v53, v55
    v_mfma_f32_16x16x32_bf16 v[36:39], a[92:95], v[248:251], v[36:39]
    s_waitcnt vmcnt(46)
    s_barrier
    s_waitcnt lgkmcnt(10)
    ds_read_b64_tr_b16 a[124:125], v4 offset:54624
    ds_read_b64_tr_b16 a[126:127], v4 offset:54752
    buffer_store_dwordx4 v[52:55], v10, s[40:43], s54 offen offset:0 sc1
    v_mfma_f32_16x16x32_bf16 v[40:43], a[96:99], v[128:131], 0
    s_add_u32 m0, s44, 73728
    ds_read_b64_tr_b16 a[64:65], v3 offset:0
    ds_read_b64_tr_b16 a[66:67], v3 offset:128
    v_mfma_f32_16x16x32_bf16 v[40:43], a[100:103], v[136:139], v[40:43]
    s_mov_b32 s45, 512
    s_waitcnt lgkmcnt(10)
    buffer_load_dwordx4 v7, s[28:31], s45 offen offset:0 lds
    v_mfma_f32_16x16x32_bf16 v[40:43], a[104:107], v[144:147], v[40:43]
    s_add_u32 m0, s44, 73632
    ds_read_b64_tr_b16 a[68:69], v3 offset:256
    ds_read_b64_tr_b16 a[70:71], v3 offset:384
    v_mfma_f32_16x16x32_bf16 v[40:43], a[108:111], v[152:155], v[40:43]
    s_waitcnt lgkmcnt(8)
    buffer_load_dwordx4 v7, s[28:31], s45 offen offset:1152 lds
    v_mfma_f32_16x16x32_bf16 v[40:43], a[112:115], v[192:195], v[40:43]
    s_add_u32 m0, s44, 73536
    ds_read_b64_tr_b16 a[72:73], v3 offset:512
    ds_read_b64_tr_b16 a[74:75], v3 offset:640
    v_mfma_f32_16x16x32_bf16 v[40:43], a[116:119], v[200:203], v[40:43]
    s_waitcnt lgkmcnt(6)
    buffer_load_dwordx4 v7, s[28:31], s45 offen offset:2304 lds
    v_mfma_f32_16x16x32_bf16 v[40:43], a[120:123], v[208:211], v[40:43]
    s_add_u32 m0, s44, 73440
    ds_read_b64_tr_b16 a[76:77], v3 offset:768
    ds_read_b64_tr_b16 a[78:79], v3 offset:896
    v_mfma_f32_16x16x32_bf16 v[40:43], a[124:127], v[216:219], v[40:43]
    buffer_load_dwordx4 v7, s[28:31], s45 offen offset:3456 lds
    v_mfma_f32_16x16x32_bf16 v[44:47], a[96:99], v[160:163], 0
    s_add_u32 m0, s44, 90624
    ds_read_b64_tr_b16 a[80:81], v3 offset:16896
    ds_read_b64_tr_b16 a[82:83], v3 offset:17024
    v_mfma_f32_16x16x32_bf16 v[44:47], a[100:103], v[168:171], v[44:47]
    s_mov_b32 s45, 147968
    buffer_load_dwordx4 v7, s[28:31], s45 offen offset:0 lds
    v_mfma_f32_16x16x32_bf16 v[44:47], a[104:107], v[176:179], v[44:47]
    s_add_u32 m0, s44, 90528
    ds_read_b64_tr_b16 a[84:85], v3 offset:17152
    ds_read_b64_tr_b16 a[86:87], v3 offset:17280
    v_mfma_f32_16x16x32_bf16 v[44:47], a[108:111], v[184:187], v[44:47]
    buffer_load_dwordx4 v7, s[28:31], s45 offen offset:1152 lds
    v_mfma_f32_16x16x32_bf16 v[44:47], a[112:115], v[224:227], v[44:47]
    s_add_u32 m0, s44, 90432
    ds_read_b64_tr_b16 a[88:89], v3 offset:17408
    ds_read_b64_tr_b16 a[90:91], v3 offset:17536
    v_mfma_f32_16x16x32_bf16 v[44:47], a[116:119], v[232:235], v[44:47]
    buffer_load_dwordx4 v7, s[28:31], s45 offen offset:2304 lds
    v_mfma_f32_16x16x32_bf16 v[44:47], a[120:123], v[240:243], v[44:47]
    s_add_u32 m0, s44, 90336
    ds_read_b64_tr_b16 a[92:93], v3 offset:17664
    ds_read_b64_tr_b16 a[94:95], v3 offset:17792
    v_mfma_f32_16x16x32_bf16 v[44:47], a[124:127], v[248:251], v[44:47]
    s_waitcnt lgkmcnt(12)
    buffer_load_dwordx4 v7, s[28:31], s45 offen offset:3456 lds
    v_mfma_f32_16x16x32_bf16 v[16:19], a[64:67], v[128:131], 0
    ds_read_b64_tr_b16 a[96:97], v3 offset:32
    v_cvt_pk_bf16_f32 v48, v32, v33
    v_mfma_f32_16x16x32_bf16 v[16:19], a[68:71], v[136:139], v[16:19]
    s_waitcnt lgkmcnt(9)
    ds_read_b64_tr_b16 a[98:99], v3 offset:160
    v_cvt_pk_bf16_f32 v49, v34, v35
    v_mfma_f32_16x16x32_bf16 v[16:19], a[72:75], v[144:147], v[16:19]
    ds_read_b64_tr_b16 a[100:101], v3 offset:288
    v_cvt_pk_bf16_f32 v50, v40, v41
    v_mfma_f32_16x16x32_bf16 v[16:19], a[76:79], v[152:155], v[16:19]
    s_waitcnt lgkmcnt(7)
    ds_read_b64_tr_b16 a[102:103], v3 offset:416
    v_cvt_pk_bf16_f32 v51, v42, v43
    v_mfma_f32_16x16x32_bf16 v[16:19], a[80:83], v[192:195], v[16:19]
    s_mov_b32 s54, 1024
    ds_read_b64_tr_b16 a[104:105], v3 offset:544
    ds_read_b64_tr_b16 a[106:107], v3 offset:672
    v_mfma_f32_16x16x32_bf16 v[16:19], a[84:87], v[200:203], v[16:19]
    s_waitcnt lgkmcnt(6)
    v_permlane32_swap_b32 v48, v50
    v_mfma_f32_16x16x32_bf16 v[16:19], a[88:91], v[208:211], v[16:19]
    v_permlane32_swap_b32 v49, v51
    v_mfma_f32_16x16x32_bf16 v[16:19], a[92:95], v[216:219], v[16:19]
    ds_read_b64_tr_b16 a[108:109], v3 offset:800
    ds_read_b64_tr_b16 a[110:111], v3 offset:928
    buffer_store_dwordx4 v[48:51], v10, s[40:43], s54 offen offset:512 sc1
    v_mfma_f32_16x16x32_bf16 v[20:23], a[64:67], v[160:163], 0
    ds_read_b64_tr_b16 a[112:113], v3 offset:16928
    v_cvt_pk_bf16_f32 v52, v36, v37
    v_mfma_f32_16x16x32_bf16 v[20:23], a[68:71], v[168:171], v[20:23]
    ds_read_b64_tr_b16 a[114:115], v3 offset:17056
    v_cvt_pk_bf16_f32 v53, v38, v39
    v_mfma_f32_16x16x32_bf16 v[20:23], a[72:75], v[176:179], v[20:23]
    ds_read_b64_tr_b16 a[116:117], v3 offset:17184
    v_cvt_pk_bf16_f32 v54, v44, v45
    v_mfma_f32_16x16x32_bf16 v[20:23], a[76:79], v[184:187], v[20:23]
    ds_read_b64_tr_b16 a[118:119], v3 offset:17312
    v_cvt_pk_bf16_f32 v55, v46, v47
    v_mfma_f32_16x16x32_bf16 v[20:23], a[80:83], v[224:227], v[20:23]
    s_mov_b32 s54, 295936
    ds_read_b64_tr_b16 a[120:121], v3 offset:17440
    ds_read_b64_tr_b16 a[122:123], v3 offset:17568
    v_mfma_f32_16x16x32_bf16 v[20:23], a[84:87], v[232:235], v[20:23]
    v_permlane32_swap_b32 v52, v54
    v_mfma_f32_16x16x32_bf16 v[20:23], a[88:91], v[240:243], v[20:23]
    v_permlane32_swap_b32 v53, v55
    v_mfma_f32_16x16x32_bf16 v[20:23], a[92:95], v[248:251], v[20:23]
    s_waitcnt lgkmcnt(10)
    ds_read_b64_tr_b16 a[124:125], v3 offset:17696
    ds_read_b64_tr_b16 a[126:127], v3 offset:17824
    buffer_store_dwordx4 v[52:55], v10, s[40:43], s54 offen offset:512 sc1
    v_mfma_f32_16x16x32_bf16 v[24:27], a[96:99], v[128:131], 0
    ds_read_b64_tr_b16 a[64:65], v3 offset:64
    v_mfma_f32_16x16x32_bf16 v[24:27], a[100:103], v[136:139], v[24:27]
    s_waitcnt lgkmcnt(9)
    ds_read_b64_tr_b16 a[66:67], v3 offset:192
    v_mfma_f32_16x16x32_bf16 v[24:27], a[104:107], v[144:147], v[24:27]
    ds_read_b64_tr_b16 a[68:69], v3 offset:320
    v_mfma_f32_16x16x32_bf16 v[24:27], a[108:111], v[152:155], v[24:27]
    s_waitcnt lgkmcnt(7)
    ds_read_b64_tr_b16 a[70:71], v3 offset:448
    v_mfma_f32_16x16x32_bf16 v[24:27], a[112:115], v[192:195], v[24:27]
    ds_read_b64_tr_b16 a[72:73], v3 offset:576
    v_mfma_f32_16x16x32_bf16 v[24:27], a[116:119], v[200:203], v[24:27]
    s_waitcnt lgkmcnt(5)
    ds_read_b64_tr_b16 a[74:75], v3 offset:704
    v_mfma_f32_16x16x32_bf16 v[24:27], a[120:123], v[208:211], v[24:27]
    ds_read_b64_tr_b16 a[76:77], v3 offset:832
    v_mfma_f32_16x16x32_bf16 v[24:27], a[124:127], v[216:219], v[24:27]
    ds_read_b64_tr_b16 a[78:79], v3 offset:960
    v_mfma_f32_16x16x32_bf16 v[28:31], a[96:99], v[160:163], 0
    ds_read_b64_tr_b16 a[80:81], v3 offset:16960
    v_mfma_f32_16x16x32_bf16 v[28:31], a[100:103], v[168:171], v[28:31]
    ds_read_b64_tr_b16 a[82:83], v3 offset:17088
    v_mfma_f32_16x16x32_bf16 v[28:31], a[104:107], v[176:179], v[28:31]
    ds_read_b64_tr_b16 a[84:85], v3 offset:17216
    v_mfma_f32_16x16x32_bf16 v[28:31], a[108:111], v[184:187], v[28:31]
    ds_read_b64_tr_b16 a[86:87], v3 offset:17344
    v_mfma_f32_16x16x32_bf16 v[28:31], a[112:115], v[224:227], v[28:31]
    ds_read_b64_tr_b16 a[88:89], v3 offset:17472
    v_mfma_f32_16x16x32_bf16 v[28:31], a[116:119], v[232:235], v[28:31]
    ds_read_b64_tr_b16 a[90:91], v3 offset:17600
    v_mfma_f32_16x16x32_bf16 v[28:31], a[120:123], v[240:243], v[28:31]
    ds_read_b64_tr_b16 a[92:93], v3 offset:17728
    v_mfma_f32_16x16x32_bf16 v[28:31], a[124:127], v[248:251], v[28:31]
    s_waitcnt lgkmcnt(11)
    ds_read_b64_tr_b16 a[94:95], v3 offset:17856
    v_mfma_f32_16x16x32_bf16 v[32:35], a[64:67], v[128:131], 0
    ds_read_b64_tr_b16 a[96:97], v3 offset:96
    v_cvt_pk_bf16_f32 v48, v16, v17
    v_mfma_f32_16x16x32_bf16 v[32:35], a[68:71], v[136:139], v[32:35]
    s_waitcnt lgkmcnt(9)
    ds_read_b64_tr_b16 a[98:99], v3 offset:224
    v_cvt_pk_bf16_f32 v49, v18, v19
    v_mfma_f32_16x16x32_bf16 v[32:35], a[72:75], v[144:147], v[32:35]
    ds_read_b64_tr_b16 a[100:101], v3 offset:352
    v_cvt_pk_bf16_f32 v50, v24, v25
    v_mfma_f32_16x16x32_bf16 v[32:35], a[76:79], v[152:155], v[32:35]
    s_waitcnt lgkmcnt(7)
    ds_read_b64_tr_b16 a[102:103], v3 offset:480
    v_cvt_pk_bf16_f32 v51, v26, v27
    v_mfma_f32_16x16x32_bf16 v[32:35], a[80:83], v[192:195], v[32:35]
    s_mov_b32 s54, 2048
    ds_read_b64_tr_b16 a[104:105], v3 offset:608
    ds_read_b64_tr_b16 a[106:107], v3 offset:736
    v_mfma_f32_16x16x32_bf16 v[32:35], a[84:87], v[200:203], v[32:35]
    s_waitcnt lgkmcnt(6)
    v_permlane32_swap_b32 v48, v50
    v_mfma_f32_16x16x32_bf16 v[32:35], a[88:91], v[208:211], v[32:35]
    v_permlane32_swap_b32 v49, v51
    v_mfma_f32_16x16x32_bf16 v[32:35], a[92:95], v[216:219], v[32:35]
    ds_read_b64_tr_b16 a[108:109], v3 offset:864
    ds_read_b64_tr_b16 a[110:111], v3 offset:992
    buffer_store_dwordx4 v[48:51], v10, s[40:43], s54 offen offset:0 sc1
    v_mfma_f32_16x16x32_bf16 v[36:39], a[64:67], v[160:163], 0
    ds_read_b64_tr_b16 a[112:113], v3 offset:16992
    v_cvt_pk_bf16_f32 v52, v20, v21
    v_mfma_f32_16x16x32_bf16 v[36:39], a[68:71], v[168:171], v[36:39]
    ds_read_b64_tr_b16 a[114:115], v3 offset:17120
    v_cvt_pk_bf16_f32 v53, v22, v23
    v_mfma_f32_16x16x32_bf16 v[36:39], a[72:75], v[176:179], v[36:39]
    ds_read_b64_tr_b16 a[116:117], v3 offset:17248
    v_cvt_pk_bf16_f32 v54, v28, v29
    v_mfma_f32_16x16x32_bf16 v[36:39], a[76:79], v[184:187], v[36:39]
    ds_read_b64_tr_b16 a[118:119], v3 offset:17376
    v_cvt_pk_bf16_f32 v55, v30, v31
    v_mfma_f32_16x16x32_bf16 v[36:39], a[80:83], v[224:227], v[36:39]
    s_mov_b32 s54, 296960
    ds_read_b64_tr_b16 a[120:121], v3 offset:17504
    ds_read_b64_tr_b16 a[122:123], v3 offset:17632
    v_mfma_f32_16x16x32_bf16 v[36:39], a[84:87], v[232:235], v[36:39]
    v_permlane32_swap_b32 v52, v54
    v_mfma_f32_16x16x32_bf16 v[36:39], a[88:91], v[240:243], v[36:39]
    v_permlane32_swap_b32 v53, v55
    v_mfma_f32_16x16x32_bf16 v[36:39], a[92:95], v[248:251], v[36:39]
    s_waitcnt vmcnt(23)
    s_barrier
    s_waitcnt lgkmcnt(10)
    ds_read_b64_tr_b16 a[124:125], v3 offset:17760
    ds_read_b64_tr_b16 a[126:127], v3 offset:17888
    buffer_store_dwordx4 v[52:55], v10, s[40:43], s54 offen offset:0 sc1
    v_mfma_f32_16x16x32_bf16 v[40:43], a[96:99], v[128:131], 0
    s_add_u32 m0, s44, 110592
    ds_read_b64_tr_b16 a[64:65], v3 offset:36864
    ds_read_b64_tr_b16 a[66:67], v3 offset:36992
    v_mfma_f32_16x16x32_bf16 v[40:43], a[100:103], v[136:139], v[40:43]
    s_mov_b32 s45, 640
    s_waitcnt lgkmcnt(10)
    buffer_load_dwordx4 v7, s[28:31], s45 offen offset:0 lds
    v_mfma_f32_16x16x32_bf16 v[40:43], a[104:107], v[144:147], v[40:43]
    s_add_u32 m0, s44, 110496
    ds_read_b64_tr_b16 a[68:69], v3 offset:37120
    ds_read_b64_tr_b16 a[70:71], v3 offset:37248
    v_mfma_f32_16x16x32_bf16 v[40:43], a[108:111], v[152:155], v[40:43]
    s_waitcnt lgkmcnt(8)
    buffer_load_dwordx4 v7, s[28:31], s45 offen offset:1152 lds
    v_mfma_f32_16x16x32_bf16 v[40:43], a[112:115], v[192:195], v[40:43]
    s_add_u32 m0, s44, 110400
    ds_read_b64_tr_b16 a[72:73], v3 offset:37376
    ds_read_b64_tr_b16 a[74:75], v3 offset:37504
    v_mfma_f32_16x16x32_bf16 v[40:43], a[116:119], v[200:203], v[40:43]
    s_waitcnt lgkmcnt(6)
    buffer_load_dwordx4 v7, s[28:31], s45 offen offset:2304 lds
    v_mfma_f32_16x16x32_bf16 v[40:43], a[120:123], v[208:211], v[40:43]
    s_add_u32 m0, s44, 110304
    ds_read_b64_tr_b16 a[76:77], v3 offset:37632
    ds_read_b64_tr_b16 a[78:79], v3 offset:37760
    v_mfma_f32_16x16x32_bf16 v[40:43], a[124:127], v[216:219], v[40:43]
    buffer_load_dwordx4 v7, s[28:31], s45 offen offset:3456 lds
    v_mfma_f32_16x16x32_bf16 v[44:47], a[96:99], v[160:163], 0
    s_add_u32 m0, s44, 127488
    ds_read_b64_tr_b16 a[80:81], v3 offset:53760
    ds_read_b64_tr_b16 a[82:83], v3 offset:53888
    v_mfma_f32_16x16x32_bf16 v[44:47], a[100:103], v[168:171], v[44:47]
    s_mov_b32 s45, 148096
    buffer_load_dwordx4 v7, s[28:31], s45 offen offset:0 lds
    v_mfma_f32_16x16x32_bf16 v[44:47], a[104:107], v[176:179], v[44:47]
    s_add_u32 m0, s44, 127392
    ds_read_b64_tr_b16 a[84:85], v3 offset:54016
    ds_read_b64_tr_b16 a[86:87], v3 offset:54144
    v_mfma_f32_16x16x32_bf16 v[44:47], a[108:111], v[184:187], v[44:47]
    buffer_load_dwordx4 v7, s[28:31], s45 offen offset:1152 lds
    v_mfma_f32_16x16x32_bf16 v[44:47], a[112:115], v[224:227], v[44:47]
    s_add_u32 m0, s44, 127296
    ds_read_b64_tr_b16 a[88:89], v3 offset:54272
    ds_read_b64_tr_b16 a[90:91], v3 offset:54400
    v_mfma_f32_16x16x32_bf16 v[44:47], a[116:119], v[232:235], v[44:47]
    buffer_load_dwordx4 v7, s[28:31], s45 offen offset:2304 lds
    v_mfma_f32_16x16x32_bf16 v[44:47], a[120:123], v[240:243], v[44:47]
    s_add_u32 m0, s44, 127200
    ds_read_b64_tr_b16 a[92:93], v3 offset:54528
    ds_read_b64_tr_b16 a[94:95], v3 offset:54656
    v_mfma_f32_16x16x32_bf16 v[44:47], a[124:127], v[248:251], v[44:47]
    s_waitcnt lgkmcnt(12)
    buffer_load_dwordx4 v7, s[28:31], s45 offen offset:3456 lds
    v_mfma_f32_16x16x32_bf16 v[16:19], a[64:67], v[128:131], 0
    ds_read_b64_tr_b16 a[96:97], v3 offset:36896
    v_cvt_pk_bf16_f32 v48, v32, v33
    v_mfma_f32_16x16x32_bf16 v[16:19], a[68:71], v[136:139], v[16:19]
    s_waitcnt lgkmcnt(9)
    ds_read_b64_tr_b16 a[98:99], v3 offset:37024
    v_cvt_pk_bf16_f32 v49, v34, v35
    v_mfma_f32_16x16x32_bf16 v[16:19], a[72:75], v[144:147], v[16:19]
    ds_read_b64_tr_b16 a[100:101], v3 offset:37152
    v_cvt_pk_bf16_f32 v50, v40, v41
    v_mfma_f32_16x16x32_bf16 v[16:19], a[76:79], v[152:155], v[16:19]
    s_waitcnt lgkmcnt(7)
    ds_read_b64_tr_b16 a[102:103], v3 offset:37280
    v_cvt_pk_bf16_f32 v51, v42, v43
    v_mfma_f32_16x16x32_bf16 v[16:19], a[80:83], v[192:195], v[16:19]
    s_mov_b32 s54, 2048
    ds_read_b64_tr_b16 a[104:105], v3 offset:37408
    ds_read_b64_tr_b16 a[106:107], v3 offset:37536
    v_mfma_f32_16x16x32_bf16 v[16:19], a[84:87], v[200:203], v[16:19]
    s_waitcnt lgkmcnt(6)
    v_permlane32_swap_b32 v48, v50
    v_mfma_f32_16x16x32_bf16 v[16:19], a[88:91], v[208:211], v[16:19]
    v_permlane32_swap_b32 v49, v51
    v_mfma_f32_16x16x32_bf16 v[16:19], a[92:95], v[216:219], v[16:19]
    ds_read_b64_tr_b16 a[108:109], v3 offset:37664
    ds_read_b64_tr_b16 a[110:111], v3 offset:37792
    buffer_store_dwordx4 v[48:51], v10, s[40:43], s54 offen offset:512 sc1
    v_mfma_f32_16x16x32_bf16 v[20:23], a[64:67], v[160:163], 0
    ds_read_b64_tr_b16 a[112:113], v3 offset:53792
    v_cvt_pk_bf16_f32 v52, v36, v37
    v_mfma_f32_16x16x32_bf16 v[20:23], a[68:71], v[168:171], v[20:23]
    ds_read_b64_tr_b16 a[114:115], v3 offset:53920
    v_cvt_pk_bf16_f32 v53, v38, v39
    v_mfma_f32_16x16x32_bf16 v[20:23], a[72:75], v[176:179], v[20:23]
    ds_read_b64_tr_b16 a[116:117], v3 offset:54048
    v_cvt_pk_bf16_f32 v54, v44, v45
    v_mfma_f32_16x16x32_bf16 v[20:23], a[76:79], v[184:187], v[20:23]
    ds_read_b64_tr_b16 a[118:119], v3 offset:54176
    v_cvt_pk_bf16_f32 v55, v46, v47
    v_mfma_f32_16x16x32_bf16 v[20:23], a[80:83], v[224:227], v[20:23]
    s_mov_b32 s54, 296960
    ds_read_b64_tr_b16 a[120:121], v3 offset:54304
    ds_read_b64_tr_b16 a[122:123], v3 offset:54432
    v_mfma_f32_16x16x32_bf16 v[20:23], a[84:87], v[232:235], v[20:23]
    v_permlane32_swap_b32 v52, v54
    v_mfma_f32_16x16x32_bf16 v[20:23], a[88:91], v[240:243], v[20:23]
    v_permlane32_swap_b32 v53, v55
    v_mfma_f32_16x16x32_bf16 v[20:23], a[92:95], v[248:251], v[20:23]
    s_waitcnt lgkmcnt(10)
    ds_read_b64_tr_b16 a[124:125], v3 offset:54560
    ds_read_b64_tr_b16 a[126:127], v3 offset:54688
    buffer_store_dwordx4 v[52:55], v10, s[40:43], s54 offen offset:512 sc1
    v_mfma_f32_16x16x32_bf16 v[24:27], a[96:99], v[128:131], 0
    ds_read_b64_tr_b16 a[64:65], v3 offset:36928
    v_mfma_f32_16x16x32_bf16 v[24:27], a[100:103], v[136:139], v[24:27]
    s_waitcnt lgkmcnt(9)
    ds_read_b64_tr_b16 a[66:67], v3 offset:37056
    v_mfma_f32_16x16x32_bf16 v[24:27], a[104:107], v[144:147], v[24:27]
    ds_read_b64_tr_b16 a[68:69], v3 offset:37184
    v_mfma_f32_16x16x32_bf16 v[24:27], a[108:111], v[152:155], v[24:27]
    s_waitcnt lgkmcnt(7)
    ds_read_b64_tr_b16 a[70:71], v3 offset:37312
    v_mfma_f32_16x16x32_bf16 v[24:27], a[112:115], v[192:195], v[24:27]
    ds_read_b64_tr_b16 a[72:73], v3 offset:37440
    v_mfma_f32_16x16x32_bf16 v[24:27], a[116:119], v[200:203], v[24:27]
    s_waitcnt lgkmcnt(5)
    ds_read_b64_tr_b16 a[74:75], v3 offset:37568
    v_mfma_f32_16x16x32_bf16 v[24:27], a[120:123], v[208:211], v[24:27]
    ds_read_b64_tr_b16 a[76:77], v3 offset:37696
    v_mfma_f32_16x16x32_bf16 v[24:27], a[124:127], v[216:219], v[24:27]
    ds_read_b64_tr_b16 a[78:79], v3 offset:37824
    v_mfma_f32_16x16x32_bf16 v[28:31], a[96:99], v[160:163], 0
    ds_read_b64_tr_b16 a[80:81], v3 offset:53824
    v_mfma_f32_16x16x32_bf16 v[28:31], a[100:103], v[168:171], v[28:31]
    ds_read_b64_tr_b16 a[82:83], v3 offset:53952
    v_mfma_f32_16x16x32_bf16 v[28:31], a[104:107], v[176:179], v[28:31]
    ds_read_b64_tr_b16 a[84:85], v3 offset:54080
    v_mfma_f32_16x16x32_bf16 v[28:31], a[108:111], v[184:187], v[28:31]
    ds_read_b64_tr_b16 a[86:87], v3 offset:54208
    v_mfma_f32_16x16x32_bf16 v[28:31], a[112:115], v[224:227], v[28:31]
    ds_read_b64_tr_b16 a[88:89], v3 offset:54336
    v_mfma_f32_16x16x32_bf16 v[28:31], a[116:119], v[232:235], v[28:31]
    ds_read_b64_tr_b16 a[90:91], v3 offset:54464
    v_mfma_f32_16x16x32_bf16 v[28:31], a[120:123], v[240:243], v[28:31]
    ds_read_b64_tr_b16 a[92:93], v3 offset:54592
    v_mfma_f32_16x16x32_bf16 v[28:31], a[124:127], v[248:251], v[28:31]
    s_waitcnt lgkmcnt(11)
    ds_read_b64_tr_b16 a[94:95], v3 offset:54720
    v_mfma_f32_16x16x32_bf16 v[32:35], a[64:67], v[128:131], 0
    ds_read_b64_tr_b16 a[96:97], v3 offset:36960
    v_cvt_pk_bf16_f32 v48, v16, v17
    v_mfma_f32_16x16x32_bf16 v[32:35], a[68:71], v[136:139], v[32:35]
    s_waitcnt lgkmcnt(9)
    ds_read_b64_tr_b16 a[98:99], v3 offset:37088
    v_cvt_pk_bf16_f32 v49, v18, v19
    v_mfma_f32_16x16x32_bf16 v[32:35], a[72:75], v[144:147], v[32:35]
    ds_read_b64_tr_b16 a[100:101], v3 offset:37216
    v_cvt_pk_bf16_f32 v50, v24, v25
    v_mfma_f32_16x16x32_bf16 v[32:35], a[76:79], v[152:155], v[32:35]
    s_waitcnt lgkmcnt(7)
    ds_read_b64_tr_b16 a[102:103], v3 offset:37344
    v_cvt_pk_bf16_f32 v51, v26, v27
    v_mfma_f32_16x16x32_bf16 v[32:35], a[80:83], v[192:195], v[32:35]
    s_mov_b32 s54, 3072
    ds_read_b64_tr_b16 a[104:105], v3 offset:37472
    ds_read_b64_tr_b16 a[106:107], v3 offset:37600
    v_mfma_f32_16x16x32_bf16 v[32:35], a[84:87], v[200:203], v[32:35]
    s_waitcnt lgkmcnt(6)
    v_permlane32_swap_b32 v48, v50
    v_mfma_f32_16x16x32_bf16 v[32:35], a[88:91], v[208:211], v[32:35]
    v_permlane32_swap_b32 v49, v51
    v_mfma_f32_16x16x32_bf16 v[32:35], a[92:95], v[216:219], v[32:35]
    ds_read_b64_tr_b16 a[108:109], v3 offset:37728
    ds_read_b64_tr_b16 a[110:111], v3 offset:37856
    buffer_store_dwordx4 v[48:51], v10, s[40:43], s54 offen offset:0 sc1
    v_mfma_f32_16x16x32_bf16 v[36:39], a[64:67], v[160:163], 0
    ds_read_b64_tr_b16 a[112:113], v3 offset:53856
    v_cvt_pk_bf16_f32 v52, v20, v21
    v_mfma_f32_16x16x32_bf16 v[36:39], a[68:71], v[168:171], v[36:39]
    ds_read_b64_tr_b16 a[114:115], v3 offset:53984
    v_cvt_pk_bf16_f32 v53, v22, v23
    v_mfma_f32_16x16x32_bf16 v[36:39], a[72:75], v[176:179], v[36:39]
    ds_read_b64_tr_b16 a[116:117], v3 offset:54112
    v_cvt_pk_bf16_f32 v54, v28, v29
    v_mfma_f32_16x16x32_bf16 v[36:39], a[76:79], v[184:187], v[36:39]
    ds_read_b64_tr_b16 a[118:119], v3 offset:54240
    v_cvt_pk_bf16_f32 v55, v30, v31
    v_mfma_f32_16x16x32_bf16 v[36:39], a[80:83], v[224:227], v[36:39]
    s_mov_b32 s54, 297984
    ds_read_b64_tr_b16 a[120:121], v3 offset:54368
    ds_read_b64_tr_b16 a[122:123], v3 offset:54496
    v_mfma_f32_16x16x32_bf16 v[36:39], a[84:87], v[232:235], v[36:39]
    v_permlane32_swap_b32 v52, v54
    v_mfma_f32_16x16x32_bf16 v[36:39], a[88:91], v[240:243], v[36:39]
    v_permlane32_swap_b32 v53, v55
    v_mfma_f32_16x16x32_bf16 v[36:39], a[92:95], v[248:251], v[36:39]
    s_waitcnt vmcnt(15)
    s_barrier
    s_waitcnt lgkmcnt(10)
    ds_read_b64_tr_b16 a[124:125], v3 offset:54624
    ds_read_b64_tr_b16 a[126:127], v3 offset:54752
    buffer_store_dwordx4 v[52:55], v10, s[40:43], s54 offen offset:0 sc1
    v_mfma_f32_16x16x32_bf16 v[40:43], a[96:99], v[128:131], 0
    s_add_u32 m0, s44, 0
    ds_read_b64_tr_b16 a[64:65], v4 offset:0
    ds_read_b64_tr_b16 a[66:67], v4 offset:128
    v_mfma_f32_16x16x32_bf16 v[40:43], a[100:103], v[136:139], v[40:43]
    s_mov_b32 s45, 768
    s_waitcnt lgkmcnt(10)
    buffer_load_dwordx4 v7, s[28:31], s45 offen offset:0 lds
    v_mfma_f32_16x16x32_bf16 v[40:43], a[104:107], v[144:147], v[40:43]
    s_add_u32 m0, s44, -96
    ds_read_b64_tr_b16 a[68:69], v4 offset:256
    ds_read_b64_tr_b16 a[70:71], v4 offset:384
    v_mfma_f32_16x16x32_bf16 v[40:43], a[108:111], v[152:155], v[40:43]
    s_waitcnt lgkmcnt(8)
    buffer_load_dwordx4 v7, s[28:31], s45 offen offset:1152 lds
    v_mfma_f32_16x16x32_bf16 v[40:43], a[112:115], v[192:195], v[40:43]
    s_add_u32 m0, s44, -192
    ds_read_b64_tr_b16 a[72:73], v4 offset:512
    ds_read_b64_tr_b16 a[74:75], v4 offset:640
    v_mfma_f32_16x16x32_bf16 v[40:43], a[116:119], v[200:203], v[40:43]
    s_waitcnt lgkmcnt(6)
    buffer_load_dwordx4 v7, s[28:31], s45 offen offset:2304 lds
    v_mfma_f32_16x16x32_bf16 v[40:43], a[120:123], v[208:211], v[40:43]
    s_add_u32 m0, s44, -288
    ds_read_b64_tr_b16 a[76:77], v4 offset:768
    ds_read_b64_tr_b16 a[78:79], v4 offset:896
    v_mfma_f32_16x16x32_bf16 v[40:43], a[124:127], v[216:219], v[40:43]
    buffer_load_dwordx4 v7, s[28:31], s45 offen offset:3456 lds
    v_mfma_f32_16x16x32_bf16 v[44:47], a[96:99], v[160:163], 0
    s_add_u32 m0, s44, 16896
    ds_read_b64_tr_b16 a[80:81], v4 offset:16896
    ds_read_b64_tr_b16 a[82:83], v4 offset:17024
    v_mfma_f32_16x16x32_bf16 v[44:47], a[100:103], v[168:171], v[44:47]
    s_mov_b32 s45, 148224
    buffer_load_dwordx4 v7, s[28:31], s45 offen offset:0 lds
    v_mfma_f32_16x16x32_bf16 v[44:47], a[104:107], v[176:179], v[44:47]
    s_add_u32 m0, s44, 16800
    ds_read_b64_tr_b16 a[84:85], v4 offset:17152
    ds_read_b64_tr_b16 a[86:87], v4 offset:17280
    v_mfma_f32_16x16x32_bf16 v[44:47], a[108:111], v[184:187], v[44:47]
    buffer_load_dwordx4 v7, s[28:31], s45 offen offset:1152 lds
    v_mfma_f32_16x16x32_bf16 v[44:47], a[112:115], v[224:227], v[44:47]
    s_add_u32 m0, s44, 16704
    ds_read_b64_tr_b16 a[88:89], v4 offset:17408
    ds_read_b64_tr_b16 a[90:91], v4 offset:17536
    v_mfma_f32_16x16x32_bf16 v[44:47], a[116:119], v[232:235], v[44:47]
    buffer_load_dwordx4 v7, s[28:31], s45 offen offset:2304 lds
    v_mfma_f32_16x16x32_bf16 v[44:47], a[120:123], v[240:243], v[44:47]
    s_add_u32 m0, s44, 16608
    ds_read_b64_tr_b16 a[92:93], v4 offset:17664
    ds_read_b64_tr_b16 a[94:95], v4 offset:17792
    v_mfma_f32_16x16x32_bf16 v[44:47], a[124:127], v[248:251], v[44:47]
    s_waitcnt lgkmcnt(12)
    buffer_load_dwordx4 v7, s[28:31], s45 offen offset:3456 lds
    v_mfma_f32_16x16x32_bf16 v[16:19], a[64:67], v[128:131], 0
    ds_read_b64_tr_b16 a[96:97], v4 offset:32
    v_cvt_pk_bf16_f32 v48, v32, v33
    v_mfma_f32_16x16x32_bf16 v[16:19], a[68:71], v[136:139], v[16:19]
    s_waitcnt lgkmcnt(9)
    ds_read_b64_tr_b16 a[98:99], v4 offset:160
    v_cvt_pk_bf16_f32 v49, v34, v35
    v_mfma_f32_16x16x32_bf16 v[16:19], a[72:75], v[144:147], v[16:19]
    ds_read_b64_tr_b16 a[100:101], v4 offset:288
    v_cvt_pk_bf16_f32 v50, v40, v41
    v_mfma_f32_16x16x32_bf16 v[16:19], a[76:79], v[152:155], v[16:19]
    s_waitcnt lgkmcnt(7)
    ds_read_b64_tr_b16 a[102:103], v4 offset:416
    v_cvt_pk_bf16_f32 v51, v42, v43
    v_mfma_f32_16x16x32_bf16 v[16:19], a[80:83], v[192:195], v[16:19]
    s_mov_b32 s54, 3072
    ds_read_b64_tr_b16 a[104:105], v4 offset:544
    ds_read_b64_tr_b16 a[106:107], v4 offset:672
    v_mfma_f32_16x16x32_bf16 v[16:19], a[84:87], v[200:203], v[16:19]
    s_waitcnt lgkmcnt(6)
    v_permlane32_swap_b32 v48, v50
    v_mfma_f32_16x16x32_bf16 v[16:19], a[88:91], v[208:211], v[16:19]
    v_permlane32_swap_b32 v49, v51
    v_mfma_f32_16x16x32_bf16 v[16:19], a[92:95], v[216:219], v[16:19]
    ds_read_b64_tr_b16 a[108:109], v4 offset:800
    ds_read_b64_tr_b16 a[110:111], v4 offset:928
    buffer_store_dwordx4 v[48:51], v10, s[40:43], s54 offen offset:512 sc1
    v_mfma_f32_16x16x32_bf16 v[20:23], a[64:67], v[160:163], 0
    ds_read_b64_tr_b16 a[112:113], v4 offset:16928
    v_cvt_pk_bf16_f32 v52, v36, v37
    v_mfma_f32_16x16x32_bf16 v[20:23], a[68:71], v[168:171], v[20:23]
    ds_read_b64_tr_b16 a[114:115], v4 offset:17056
    v_cvt_pk_bf16_f32 v53, v38, v39
    v_mfma_f32_16x16x32_bf16 v[20:23], a[72:75], v[176:179], v[20:23]
    ds_read_b64_tr_b16 a[116:117], v4 offset:17184
    v_cvt_pk_bf16_f32 v54, v44, v45
    v_mfma_f32_16x16x32_bf16 v[20:23], a[76:79], v[184:187], v[20:23]
    ds_read_b64_tr_b16 a[118:119], v4 offset:17312
    v_cvt_pk_bf16_f32 v55, v46, v47
    v_mfma_f32_16x16x32_bf16 v[20:23], a[80:83], v[224:227], v[20:23]
    s_mov_b32 s54, 297984
    ds_read_b64_tr_b16 a[120:121], v4 offset:17440
    ds_read_b64_tr_b16 a[122:123], v4 offset:17568
    v_mfma_f32_16x16x32_bf16 v[20:23], a[84:87], v[232:235], v[20:23]
    v_permlane32_swap_b32 v52, v54
    v_mfma_f32_16x16x32_bf16 v[20:23], a[88:91], v[240:243], v[20:23]
    v_permlane32_swap_b32 v53, v55
    v_mfma_f32_16x16x32_bf16 v[20:23], a[92:95], v[248:251], v[20:23]
    s_waitcnt lgkmcnt(10)
    ds_read_b64_tr_b16 a[124:125], v4 offset:17696
    ds_read_b64_tr_b16 a[126:127], v4 offset:17824
    buffer_store_dwordx4 v[52:55], v10, s[40:43], s54 offen offset:512 sc1
    v_mfma_f32_16x16x32_bf16 v[24:27], a[96:99], v[128:131], 0
    ds_read_b64_tr_b16 a[64:65], v4 offset:64
    v_mfma_f32_16x16x32_bf16 v[24:27], a[100:103], v[136:139], v[24:27]
    s_waitcnt lgkmcnt(9)
    ds_read_b64_tr_b16 a[66:67], v4 offset:192
    v_mfma_f32_16x16x32_bf16 v[24:27], a[104:107], v[144:147], v[24:27]
    ds_read_b64_tr_b16 a[68:69], v4 offset:320
    v_mfma_f32_16x16x32_bf16 v[24:27], a[108:111], v[152:155], v[24:27]
    s_waitcnt lgkmcnt(7)
    ds_read_b64_tr_b16 a[70:71], v4 offset:448
    v_mfma_f32_16x16x32_bf16 v[24:27], a[112:115], v[192:195], v[24:27]
    ds_read_b64_tr_b16 a[72:73], v4 offset:576
    v_mfma_f32_16x16x32_bf16 v[24:27], a[116:119], v[200:203], v[24:27]
    s_waitcnt lgkmcnt(5)
    ds_read_b64_tr_b16 a[74:75], v4 offset:704
    v_mfma_f32_16x16x32_bf16 v[24:27], a[120:123], v[208:211], v[24:27]
    ds_read_b64_tr_b16 a[76:77], v4 offset:832
    v_mfma_f32_16x16x32_bf16 v[24:27], a[124:127], v[216:219], v[24:27]
    ds_read_b64_tr_b16 a[78:79], v4 offset:960
    v_mfma_f32_16x16x32_bf16 v[28:31], a[96:99], v[160:163], 0
    ds_read_b64_tr_b16 a[80:81], v4 offset:16960
    v_mfma_f32_16x16x32_bf16 v[28:31], a[100:103], v[168:171], v[28:31]
    ds_read_b64_tr_b16 a[82:83], v4 offset:17088
    v_mfma_f32_16x16x32_bf16 v[28:31], a[104:107], v[176:179], v[28:31]
    ds_read_b64_tr_b16 a[84:85], v4 offset:17216
    v_mfma_f32_16x16x32_bf16 v[28:31], a[108:111], v[184:187], v[28:31]
    ds_read_b64_tr_b16 a[86:87], v4 offset:17344
    v_mfma_f32_16x16x32_bf16 v[28:31], a[112:115], v[224:227], v[28:31]
    ds_read_b64_tr_b16 a[88:89], v4 offset:17472
    v_mfma_f32_16x16x32_bf16 v[28:31], a[116:119], v[232:235], v[28:31]
    ds_read_b64_tr_b16 a[90:91], v4 offset:17600
    v_mfma_f32_16x16x32_bf16 v[28:31], a[120:123], v[240:243], v[28:31]
    ds_read_b64_tr_b16 a[92:93], v4 offset:17728
    v_mfma_f32_16x16x32_bf16 v[28:31], a[124:127], v[248:251], v[28:31]
    s_waitcnt lgkmcnt(11)
    ds_read_b64_tr_b16 a[94:95], v4 offset:17856
    v_mfma_f32_16x16x32_bf16 v[32:35], a[64:67], v[128:131], 0
    ds_read_b64_tr_b16 a[96:97], v4 offset:96
    v_cvt_pk_bf16_f32 v48, v16, v17
    v_mfma_f32_16x16x32_bf16 v[32:35], a[68:71], v[136:139], v[32:35]
    s_waitcnt lgkmcnt(9)
    ds_read_b64_tr_b16 a[98:99], v4 offset:224
    v_cvt_pk_bf16_f32 v49, v18, v19
    v_mfma_f32_16x16x32_bf16 v[32:35], a[72:75], v[144:147], v[32:35]
    ds_read_b64_tr_b16 a[100:101], v4 offset:352
    v_cvt_pk_bf16_f32 v50, v24, v25
    v_mfma_f32_16x16x32_bf16 v[32:35], a[76:79], v[152:155], v[32:35]
    s_waitcnt lgkmcnt(7)
    ds_read_b64_tr_b16 a[102:103], v4 offset:480
    v_cvt_pk_bf16_f32 v51, v26, v27
    v_mfma_f32_16x16x32_bf16 v[32:35], a[80:83], v[192:195], v[32:35]
    s_mov_b32 s54, 4096
    ds_read_b64_tr_b16 a[104:105], v4 offset:608
    ds_read_b64_tr_b16 a[106:107], v4 offset:736
    v_mfma_f32_16x16x32_bf16 v[32:35], a[84:87], v[200:203], v[32:35]
    s_waitcnt lgkmcnt(6)
    v_permlane32_swap_b32 v48, v50
    v_mfma_f32_16x16x32_bf16 v[32:35], a[88:91], v[208:211], v[32:35]
    v_permlane32_swap_b32 v49, v51
    v_mfma_f32_16x16x32_bf16 v[32:35], a[92:95], v[216:219], v[32:35]
    ds_read_b64_tr_b16 a[108:109], v4 offset:864
    ds_read_b64_tr_b16 a[110:111], v4 offset:992
    buffer_store_dwordx4 v[48:51], v10, s[40:43], s54 offen offset:0 sc1
    v_mfma_f32_16x16x32_bf16 v[36:39], a[64:67], v[160:163], 0
    ds_read_b64_tr_b16 a[112:113], v4 offset:16992
    v_cvt_pk_bf16_f32 v52, v20, v21
    v_mfma_f32_16x16x32_bf16 v[36:39], a[68:71], v[168:171], v[36:39]
    ds_read_b64_tr_b16 a[114:115], v4 offset:17120
    v_cvt_pk_bf16_f32 v53, v22, v23
    v_mfma_f32_16x16x32_bf16 v[36:39], a[72:75], v[176:179], v[36:39]
    ds_read_b64_tr_b16 a[116:117], v4 offset:17248
    v_cvt_pk_bf16_f32 v54, v28, v29
    v_mfma_f32_16x16x32_bf16 v[36:39], a[76:79], v[184:187], v[36:39]
    ds_read_b64_tr_b16 a[118:119], v4 offset:17376
    v_cvt_pk_bf16_f32 v55, v30, v31
    v_mfma_f32_16x16x32_bf16 v[36:39], a[80:83], v[224:227], v[36:39]
    s_mov_b32 s54, 299008
    ds_read_b64_tr_b16 a[120:121], v4 offset:17504
    ds_read_b64_tr_b16 a[122:123], v4 offset:17632
    v_mfma_f32_16x16x32_bf16 v[36:39], a[84:87], v[232:235], v[36:39]
    v_permlane32_swap_b32 v52, v54
    v_mfma_f32_16x16x32_bf16 v[36:39], a[88:91], v[240:243], v[36:39]
    v_permlane32_swap_b32 v53, v55
    v_mfma_f32_16x16x32_bf16 v[36:39], a[92:95], v[248:251], v[36:39]
    s_waitcnt vmcnt(15)
    s_barrier
    s_waitcnt lgkmcnt(10)
    ds_read_b64_tr_b16 a[124:125], v4 offset:17760
    ds_read_b64_tr_b16 a[126:127], v4 offset:17888
    buffer_store_dwordx4 v[52:55], v10, s[40:43], s54 offen offset:0 sc1
    v_mfma_f32_16x16x32_bf16 v[40:43], a[96:99], v[128:131], 0
    s_add_u32 m0, s44, 36864
    ds_read_b64_tr_b16 a[64:65], v4 offset:36864
    ds_read_b64_tr_b16 a[66:67], v4 offset:36992
    v_mfma_f32_16x16x32_bf16 v[40:43], a[100:103], v[136:139], v[40:43]
    s_mov_b32 s45, 896
    s_waitcnt lgkmcnt(10)
    buffer_load_dwordx4 v7, s[28:31], s45 offen offset:0 lds
    v_mfma_f32_16x16x32_bf16 v[40:43], a[104:107], v[144:147], v[40:43]
    s_add_u32 m0, s44, 36768
    ds_read_b64_tr_b16 a[68:69], v4 offset:37120
    ds_read_b64_tr_b16 a[70:71], v4 offset:37248
    v_mfma_f32_16x16x32_bf16 v[40:43], a[108:111], v[152:155], v[40:43]
    s_waitcnt lgkmcnt(8)
    buffer_load_dwordx4 v7, s[28:31], s45 offen offset:1152 lds
    v_mfma_f32_16x16x32_bf16 v[40:43], a[112:115], v[192:195], v[40:43]
    s_add_u32 m0, s44, 36672
    ds_read_b64_tr_b16 a[72:73], v4 offset:37376
    ds_read_b64_tr_b16 a[74:75], v4 offset:37504
    v_mfma_f32_16x16x32_bf16 v[40:43], a[116:119], v[200:203], v[40:43]
    s_waitcnt lgkmcnt(6)
    buffer_load_dwordx4 v7, s[28:31], s45 offen offset:2304 lds
    v_mfma_f32_16x16x32_bf16 v[40:43], a[120:123], v[208:211], v[40:43]
    s_add_u32 m0, s44, 36576
    ds_read_b64_tr_b16 a[76:77], v4 offset:37632
    ds_read_b64_tr_b16 a[78:79], v4 offset:37760
    v_mfma_f32_16x16x32_bf16 v[40:43], a[124:127], v[216:219], v[40:43]
    buffer_load_dwordx4 v7, s[28:31], s45 offen offset:3456 lds
    v_mfma_f32_16x16x32_bf16 v[44:47], a[96:99], v[160:163], 0
    s_add_u32 m0, s44, 53760
    ds_read_b64_tr_b16 a[80:81], v4 offset:53760
    ds_read_b64_tr_b16 a[82:83], v4 offset:53888
    v_mfma_f32_16x16x32_bf16 v[44:47], a[100:103], v[168:171], v[44:47]
    s_mov_b32 s45, 148352
    buffer_load_dwordx4 v7, s[28:31], s45 offen offset:0 lds
    v_mfma_f32_16x16x32_bf16 v[44:47], a[104:107], v[176:179], v[44:47]
    s_add_u32 m0, s44, 53664
    ds_read_b64_tr_b16 a[84:85], v4 offset:54016
    ds_read_b64_tr_b16 a[86:87], v4 offset:54144
    v_mfma_f32_16x16x32_bf16 v[44:47], a[108:111], v[184:187], v[44:47]
    buffer_load_dwordx4 v7, s[28:31], s45 offen offset:1152 lds
    v_mfma_f32_16x16x32_bf16 v[44:47], a[112:115], v[224:227], v[44:47]
    s_add_u32 m0, s44, 53568
    ds_read_b64_tr_b16 a[88:89], v4 offset:54272
    ds_read_b64_tr_b16 a[90:91], v4 offset:54400
    v_mfma_f32_16x16x32_bf16 v[44:47], a[116:119], v[232:235], v[44:47]
    buffer_load_dwordx4 v7, s[28:31], s45 offen offset:2304 lds
    v_mfma_f32_16x16x32_bf16 v[44:47], a[120:123], v[240:243], v[44:47]
    s_add_u32 m0, s44, 53472
    ds_read_b64_tr_b16 a[92:93], v4 offset:54528
    ds_read_b64_tr_b16 a[94:95], v4 offset:54656
    v_mfma_f32_16x16x32_bf16 v[44:47], a[124:127], v[248:251], v[44:47]
    s_waitcnt lgkmcnt(12)
    buffer_load_dwordx4 v7, s[28:31], s45 offen offset:3456 lds
    v_mfma_f32_16x16x32_bf16 v[16:19], a[64:67], v[128:131], 0
    ds_read_b64_tr_b16 a[96:97], v4 offset:36896
    v_cvt_pk_bf16_f32 v48, v32, v33
    v_mfma_f32_16x16x32_bf16 v[16:19], a[68:71], v[136:139], v[16:19]
    s_waitcnt lgkmcnt(9)
    ds_read_b64_tr_b16 a[98:99], v4 offset:37024
    v_cvt_pk_bf16_f32 v49, v34, v35
    v_mfma_f32_16x16x32_bf16 v[16:19], a[72:75], v[144:147], v[16:19]
    ds_read_b64_tr_b16 a[100:101], v4 offset:37152
    v_cvt_pk_bf16_f32 v50, v40, v41
    v_mfma_f32_16x16x32_bf16 v[16:19], a[76:79], v[152:155], v[16:19]
    s_waitcnt lgkmcnt(7)
    ds_read_b64_tr_b16 a[102:103], v4 offset:37280
    v_cvt_pk_bf16_f32 v51, v42, v43
    v_mfma_f32_16x16x32_bf16 v[16:19], a[80:83], v[192:195], v[16:19]
    s_mov_b32 s54, 4096
    ds_read_b64_tr_b16 a[104:105], v4 offset:37408
    ds_read_b64_tr_b16 a[106:107], v4 offset:37536
    v_mfma_f32_16x16x32_bf16 v[16:19], a[84:87], v[200:203], v[16:19]
    s_waitcnt lgkmcnt(6)
    v_permlane32_swap_b32 v48, v50
    v_mfma_f32_16x16x32_bf16 v[16:19], a[88:91], v[208:211], v[16:19]
    v_permlane32_swap_b32 v49, v51
    v_mfma_f32_16x16x32_bf16 v[16:19], a[92:95], v[216:219], v[16:19]
    ds_read_b64_tr_b16 a[108:109], v4 offset:37664
    ds_read_b64_tr_b16 a[110:111], v4 offset:37792
    buffer_store_dwordx4 v[48:51], v10, s[40:43], s54 offen offset:512 sc1
    v_mfma_f32_16x16x32_bf16 v[20:23], a[64:67], v[160:163], 0
    ds_read_b64_tr_b16 a[112:113], v4 offset:53792
    v_cvt_pk_bf16_f32 v52, v36, v37
    v_mfma_f32_16x16x32_bf16 v[20:23], a[68:71], v[168:171], v[20:23]
    ds_read_b64_tr_b16 a[114:115], v4 offset:53920
    v_cvt_pk_bf16_f32 v53, v38, v39
    v_mfma_f32_16x16x32_bf16 v[20:23], a[72:75], v[176:179], v[20:23]
    ds_read_b64_tr_b16 a[116:117], v4 offset:54048
    v_cvt_pk_bf16_f32 v54, v44, v45
    v_mfma_f32_16x16x32_bf16 v[20:23], a[76:79], v[184:187], v[20:23]
    ds_read_b64_tr_b16 a[118:119], v4 offset:54176
    v_cvt_pk_bf16_f32 v55, v46, v47
    v_mfma_f32_16x16x32_bf16 v[20:23], a[80:83], v[224:227], v[20:23]
    s_mov_b32 s54, 299008
    ds_read_b64_tr_b16 a[120:121], v4 offset:54304
    ds_read_b64_tr_b16 a[122:123], v4 offset:54432
    v_mfma_f32_16x16x32_bf16 v[20:23], a[84:87], v[232:235], v[20:23]
    v_permlane32_swap_b32 v52, v54
    v_mfma_f32_16x16x32_bf16 v[20:23], a[88:91], v[240:243], v[20:23]
    v_permlane32_swap_b32 v53, v55
    v_mfma_f32_16x16x32_bf16 v[20:23], a[92:95], v[248:251], v[20:23]
    s_waitcnt lgkmcnt(10)
    ds_read_b64_tr_b16 a[124:125], v4 offset:54560
    ds_read_b64_tr_b16 a[126:127], v4 offset:54688
    buffer_store_dwordx4 v[52:55], v10, s[40:43], s54 offen offset:512 sc1
    v_mfma_f32_16x16x32_bf16 v[24:27], a[96:99], v[128:131], 0
    ds_read_b64_tr_b16 a[64:65], v4 offset:36928
    v_mfma_f32_16x16x32_bf16 v[24:27], a[100:103], v[136:139], v[24:27]
    s_waitcnt lgkmcnt(9)
    ds_read_b64_tr_b16 a[66:67], v4 offset:37056
    v_mfma_f32_16x16x32_bf16 v[24:27], a[104:107], v[144:147], v[24:27]
    ds_read_b64_tr_b16 a[68:69], v4 offset:37184
    v_mfma_f32_16x16x32_bf16 v[24:27], a[108:111], v[152:155], v[24:27]
    s_waitcnt lgkmcnt(7)
    ds_read_b64_tr_b16 a[70:71], v4 offset:37312
    v_mfma_f32_16x16x32_bf16 v[24:27], a[112:115], v[192:195], v[24:27]
    ds_read_b64_tr_b16 a[72:73], v4 offset:37440
    v_mfma_f32_16x16x32_bf16 v[24:27], a[116:119], v[200:203], v[24:27]
    s_waitcnt lgkmcnt(5)
    ds_read_b64_tr_b16 a[74:75], v4 offset:37568
    v_mfma_f32_16x16x32_bf16 v[24:27], a[120:123], v[208:211], v[24:27]
    ds_read_b64_tr_b16 a[76:77], v4 offset:37696
    v_mfma_f32_16x16x32_bf16 v[24:27], a[124:127], v[216:219], v[24:27]
    ds_read_b64_tr_b16 a[78:79], v4 offset:37824
    v_mfma_f32_16x16x32_bf16 v[28:31], a[96:99], v[160:163], 0
    ds_read_b64_tr_b16 a[80:81], v4 offset:53824
    v_mfma_f32_16x16x32_bf16 v[28:31], a[100:103], v[168:171], v[28:31]
    ds_read_b64_tr_b16 a[82:83], v4 offset:53952
    v_mfma_f32_16x16x32_bf16 v[28:31], a[104:107], v[176:179], v[28:31]
    ds_read_b64_tr_b16 a[84:85], v4 offset:54080
    v_mfma_f32_16x16x32_bf16 v[28:31], a[108:111], v[184:187], v[28:31]
    ds_read_b64_tr_b16 a[86:87], v4 offset:54208
    v_mfma_f32_16x16x32_bf16 v[28:31], a[112:115], v[224:227], v[28:31]
    ds_read_b64_tr_b16 a[88:89], v4 offset:54336
    v_mfma_f32_16x16x32_bf16 v[28:31], a[116:119], v[232:235], v[28:31]
    ds_read_b64_tr_b16 a[90:91], v4 offset:54464
    v_mfma_f32_16x16x32_bf16 v[28:31], a[120:123], v[240:243], v[28:31]
    ds_read_b64_tr_b16 a[92:93], v4 offset:54592
    v_mfma_f32_16x16x32_bf16 v[28:31], a[124:127], v[248:251], v[28:31]
    s_waitcnt lgkmcnt(11)
    ds_read_b64_tr_b16 a[94:95], v4 offset:54720
    v_mfma_f32_16x16x32_bf16 v[32:35], a[64:67], v[128:131], 0
    ds_read_b64_tr_b16 a[96:97], v4 offset:36960
    v_cvt_pk_bf16_f32 v48, v16, v17
    v_mfma_f32_16x16x32_bf16 v[32:35], a[68:71], v[136:139], v[32:35]
    s_waitcnt lgkmcnt(9)
    ds_read_b64_tr_b16 a[98:99], v4 offset:37088
    v_cvt_pk_bf16_f32 v49, v18, v19
    v_mfma_f32_16x16x32_bf16 v[32:35], a[72:75], v[144:147], v[32:35]
    ds_read_b64_tr_b16 a[100:101], v4 offset:37216
    v_cvt_pk_bf16_f32 v50, v24, v25
    v_mfma_f32_16x16x32_bf16 v[32:35], a[76:79], v[152:155], v[32:35]
    s_waitcnt lgkmcnt(7)
    ds_read_b64_tr_b16 a[102:103], v4 offset:37344
    v_cvt_pk_bf16_f32 v51, v26, v27
    v_mfma_f32_16x16x32_bf16 v[32:35], a[80:83], v[192:195], v[32:35]
    s_mov_b32 s54, 5120
    ds_read_b64_tr_b16 a[104:105], v4 offset:37472
    ds_read_b64_tr_b16 a[106:107], v4 offset:37600
    v_mfma_f32_16x16x32_bf16 v[32:35], a[84:87], v[200:203], v[32:35]
    s_waitcnt lgkmcnt(6)
    v_permlane32_swap_b32 v48, v50
    v_mfma_f32_16x16x32_bf16 v[32:35], a[88:91], v[208:211], v[32:35]
    v_permlane32_swap_b32 v49, v51
    v_mfma_f32_16x16x32_bf16 v[32:35], a[92:95], v[216:219], v[32:35]
    ds_read_b64_tr_b16 a[108:109], v4 offset:37728
    ds_read_b64_tr_b16 a[110:111], v4 offset:37856
    buffer_store_dwordx4 v[48:51], v10, s[40:43], s54 offen offset:0 sc1
    v_mfma_f32_16x16x32_bf16 v[36:39], a[64:67], v[160:163], 0
    ds_read_b64_tr_b16 a[112:113], v4 offset:53856
    v_cvt_pk_bf16_f32 v52, v20, v21
    v_mfma_f32_16x16x32_bf16 v[36:39], a[68:71], v[168:171], v[36:39]
    ds_read_b64_tr_b16 a[114:115], v4 offset:53984
    v_cvt_pk_bf16_f32 v53, v22, v23
    v_mfma_f32_16x16x32_bf16 v[36:39], a[72:75], v[176:179], v[36:39]
    ds_read_b64_tr_b16 a[116:117], v4 offset:54112
    v_cvt_pk_bf16_f32 v54, v28, v29
    v_mfma_f32_16x16x32_bf16 v[36:39], a[76:79], v[184:187], v[36:39]
    ds_read_b64_tr_b16 a[118:119], v4 offset:54240
    v_cvt_pk_bf16_f32 v55, v30, v31
    v_mfma_f32_16x16x32_bf16 v[36:39], a[80:83], v[224:227], v[36:39]
    s_mov_b32 s54, 300032
    ds_read_b64_tr_b16 a[120:121], v4 offset:54368
    ds_read_b64_tr_b16 a[122:123], v4 offset:54496
    v_mfma_f32_16x16x32_bf16 v[36:39], a[84:87], v[232:235], v[36:39]
    v_permlane32_swap_b32 v52, v54
    v_mfma_f32_16x16x32_bf16 v[36:39], a[88:91], v[240:243], v[36:39]
    v_permlane32_swap_b32 v53, v55
    v_mfma_f32_16x16x32_bf16 v[36:39], a[92:95], v[248:251], v[36:39]
    s_waitcnt vmcnt(15)
    s_barrier
    s_waitcnt lgkmcnt(10)
    ds_read_b64_tr_b16 a[124:125], v4 offset:54624
    ds_read_b64_tr_b16 a[126:127], v4 offset:54752
    buffer_store_dwordx4 v[52:55], v10, s[40:43], s54 offen offset:0 sc1
    v_mfma_f32_16x16x32_bf16 v[40:43], a[96:99], v[128:131], 0
    s_add_u32 m0, s44, 73728
    ds_read_b64_tr_b16 a[64:65], v3 offset:0
    ds_read_b64_tr_b16 a[66:67], v3 offset:128
    v_mfma_f32_16x16x32_bf16 v[40:43], a[100:103], v[136:139], v[40:43]
    s_mov_b32 s45, 1024
    s_waitcnt lgkmcnt(10)
    buffer_load_dwordx4 v7, s[28:31], s45 offen offset:0 lds
    v_mfma_f32_16x16x32_bf16 v[40:43], a[104:107], v[144:147], v[40:43]
    s_add_u32 m0, s44, 73632
    ds_read_b64_tr_b16 a[68:69], v3 offset:256
    ds_read_b64_tr_b16 a[70:71], v3 offset:384
    v_mfma_f32_16x16x32_bf16 v[40:43], a[108:111], v[152:155], v[40:43]
    s_waitcnt lgkmcnt(8)
    buffer_load_dwordx4 v7, s[28:31], s45 offen offset:1152 lds
    v_mfma_f32_16x16x32_bf16 v[40:43], a[112:115], v[192:195], v[40:43]
    s_add_u32 m0, s44, 73536
    ds_read_b64_tr_b16 a[72:73], v3 offset:512
    ds_read_b64_tr_b16 a[74:75], v3 offset:640
    v_mfma_f32_16x16x32_bf16 v[40:43], a[116:119], v[200:203], v[40:43]
    s_waitcnt lgkmcnt(6)
    buffer_load_dwordx4 v7, s[28:31], s45 offen offset:2304 lds
    v_mfma_f32_16x16x32_bf16 v[40:43], a[120:123], v[208:211], v[40:43]
    s_add_u32 m0, s44, 73440
    ds_read_b64_tr_b16 a[76:77], v3 offset:768
    ds_read_b64_tr_b16 a[78:79], v3 offset:896
    v_mfma_f32_16x16x32_bf16 v[40:43], a[124:127], v[216:219], v[40:43]
    buffer_load_dwordx4 v7, s[28:31], s45 offen offset:3456 lds
    v_mfma_f32_16x16x32_bf16 v[44:47], a[96:99], v[160:163], 0
    s_add_u32 m0, s44, 90624
    ds_read_b64_tr_b16 a[80:81], v3 offset:16896
    ds_read_b64_tr_b16 a[82:83], v3 offset:17024
    v_mfma_f32_16x16x32_bf16 v[44:47], a[100:103], v[168:171], v[44:47]
    s_mov_b32 s45, 148480
    buffer_load_dwordx4 v7, s[28:31], s45 offen offset:0 lds
    v_mfma_f32_16x16x32_bf16 v[44:47], a[104:107], v[176:179], v[44:47]
    s_add_u32 m0, s44, 90528
    ds_read_b64_tr_b16 a[84:85], v3 offset:17152
    ds_read_b64_tr_b16 a[86:87], v3 offset:17280
    v_mfma_f32_16x16x32_bf16 v[44:47], a[108:111], v[184:187], v[44:47]
    buffer_load_dwordx4 v7, s[28:31], s45 offen offset:1152 lds
    v_mfma_f32_16x16x32_bf16 v[44:47], a[112:115], v[224:227], v[44:47]
    s_add_u32 m0, s44, 90432
    ds_read_b64_tr_b16 a[88:89], v3 offset:17408
    ds_read_b64_tr_b16 a[90:91], v3 offset:17536
    v_mfma_f32_16x16x32_bf16 v[44:47], a[116:119], v[232:235], v[44:47]
    buffer_load_dwordx4 v7, s[28:31], s45 offen offset:2304 lds
    v_mfma_f32_16x16x32_bf16 v[44:47], a[120:123], v[240:243], v[44:47]
    s_add_u32 m0, s44, 90336
    ds_read_b64_tr_b16 a[92:93], v3 offset:17664
    ds_read_b64_tr_b16 a[94:95], v3 offset:17792
    v_mfma_f32_16x16x32_bf16 v[44:47], a[124:127], v[248:251], v[44:47]
    s_waitcnt lgkmcnt(12)
    buffer_load_dwordx4 v7, s[28:31], s45 offen offset:3456 lds
    v_mfma_f32_16x16x32_bf16 v[16:19], a[64:67], v[128:131], 0
    ds_read_b64_tr_b16 a[96:97], v3 offset:32
    v_cvt_pk_bf16_f32 v48, v32, v33
    v_mfma_f32_16x16x32_bf16 v[16:19], a[68:71], v[136:139], v[16:19]
    s_waitcnt lgkmcnt(9)
    ds_read_b64_tr_b16 a[98:99], v3 offset:160
    v_cvt_pk_bf16_f32 v49, v34, v35
    v_mfma_f32_16x16x32_bf16 v[16:19], a[72:75], v[144:147], v[16:19]
    ds_read_b64_tr_b16 a[100:101], v3 offset:288
    v_cvt_pk_bf16_f32 v50, v40, v41
    v_mfma_f32_16x16x32_bf16 v[16:19], a[76:79], v[152:155], v[16:19]
    s_waitcnt lgkmcnt(7)
    ds_read_b64_tr_b16 a[102:103], v3 offset:416
    v_cvt_pk_bf16_f32 v51, v42, v43
    v_mfma_f32_16x16x32_bf16 v[16:19], a[80:83], v[192:195], v[16:19]
    s_mov_b32 s54, 5120
    ds_read_b64_tr_b16 a[104:105], v3 offset:544
    ds_read_b64_tr_b16 a[106:107], v3 offset:672
    v_mfma_f32_16x16x32_bf16 v[16:19], a[84:87], v[200:203], v[16:19]
    s_waitcnt lgkmcnt(6)
    v_permlane32_swap_b32 v48, v50
    v_mfma_f32_16x16x32_bf16 v[16:19], a[88:91], v[208:211], v[16:19]
    v_permlane32_swap_b32 v49, v51
    v_mfma_f32_16x16x32_bf16 v[16:19], a[92:95], v[216:219], v[16:19]
    ds_read_b64_tr_b16 a[108:109], v3 offset:800
    ds_read_b64_tr_b16 a[110:111], v3 offset:928
    buffer_store_dwordx4 v[48:51], v10, s[40:43], s54 offen offset:512 sc1
    v_mfma_f32_16x16x32_bf16 v[20:23], a[64:67], v[160:163], 0
    ds_read_b64_tr_b16 a[112:113], v3 offset:16928
    v_cvt_pk_bf16_f32 v52, v36, v37
    v_mfma_f32_16x16x32_bf16 v[20:23], a[68:71], v[168:171], v[20:23]
    ds_read_b64_tr_b16 a[114:115], v3 offset:17056
    v_cvt_pk_bf16_f32 v53, v38, v39
    v_mfma_f32_16x16x32_bf16 v[20:23], a[72:75], v[176:179], v[20:23]
    ds_read_b64_tr_b16 a[116:117], v3 offset:17184
    v_cvt_pk_bf16_f32 v54, v44, v45
    v_mfma_f32_16x16x32_bf16 v[20:23], a[76:79], v[184:187], v[20:23]
    ds_read_b64_tr_b16 a[118:119], v3 offset:17312
    v_cvt_pk_bf16_f32 v55, v46, v47
    v_mfma_f32_16x16x32_bf16 v[20:23], a[80:83], v[224:227], v[20:23]
    s_mov_b32 s54, 300032
    ds_read_b64_tr_b16 a[120:121], v3 offset:17440
    ds_read_b64_tr_b16 a[122:123], v3 offset:17568
    v_mfma_f32_16x16x32_bf16 v[20:23], a[84:87], v[232:235], v[20:23]
    v_permlane32_swap_b32 v52, v54
    v_mfma_f32_16x16x32_bf16 v[20:23], a[88:91], v[240:243], v[20:23]
    v_permlane32_swap_b32 v53, v55
    v_mfma_f32_16x16x32_bf16 v[20:23], a[92:95], v[248:251], v[20:23]
    s_waitcnt lgkmcnt(10)
    ds_read_b64_tr_b16 a[124:125], v3 offset:17696
    ds_read_b64_tr_b16 a[126:127], v3 offset:17824
    buffer_store_dwordx4 v[52:55], v10, s[40:43], s54 offen offset:512 sc1
    v_mfma_f32_16x16x32_bf16 v[24:27], a[96:99], v[128:131], 0
    ds_read_b64_tr_b16 a[64:65], v3 offset:64
    v_mfma_f32_16x16x32_bf16 v[24:27], a[100:103], v[136:139], v[24:27]
    s_waitcnt lgkmcnt(9)
    ds_read_b64_tr_b16 a[66:67], v3 offset:192
    v_mfma_f32_16x16x32_bf16 v[24:27], a[104:107], v[144:147], v[24:27]
    ds_read_b64_tr_b16 a[68:69], v3 offset:320
    v_mfma_f32_16x16x32_bf16 v[24:27], a[108:111], v[152:155], v[24:27]
    s_waitcnt lgkmcnt(7)
    ds_read_b64_tr_b16 a[70:71], v3 offset:448
    v_mfma_f32_16x16x32_bf16 v[24:27], a[112:115], v[192:195], v[24:27]
    ds_read_b64_tr_b16 a[72:73], v3 offset:576
    v_mfma_f32_16x16x32_bf16 v[24:27], a[116:119], v[200:203], v[24:27]
    s_waitcnt lgkmcnt(5)
    ds_read_b64_tr_b16 a[74:75], v3 offset:704
    v_mfma_f32_16x16x32_bf16 v[24:27], a[120:123], v[208:211], v[24:27]
    ds_read_b64_tr_b16 a[76:77], v3 offset:832
    v_mfma_f32_16x16x32_bf16 v[24:27], a[124:127], v[216:219], v[24:27]
    ds_read_b64_tr_b16 a[78:79], v3 offset:960
    v_mfma_f32_16x16x32_bf16 v[28:31], a[96:99], v[160:163], 0
    ds_read_b64_tr_b16 a[80:81], v3 offset:16960
    v_mfma_f32_16x16x32_bf16 v[28:31], a[100:103], v[168:171], v[28:31]
    ds_read_b64_tr_b16 a[82:83], v3 offset:17088
    v_mfma_f32_16x16x32_bf16 v[28:31], a[104:107], v[176:179], v[28:31]
    ds_read_b64_tr_b16 a[84:85], v3 offset:17216
    v_mfma_f32_16x16x32_bf16 v[28:31], a[108:111], v[184:187], v[28:31]
    ds_read_b64_tr_b16 a[86:87], v3 offset:17344
    v_mfma_f32_16x16x32_bf16 v[28:31], a[112:115], v[224:227], v[28:31]
    ds_read_b64_tr_b16 a[88:89], v3 offset:17472
    v_mfma_f32_16x16x32_bf16 v[28:31], a[116:119], v[232:235], v[28:31]
    ds_read_b64_tr_b16 a[90:91], v3 offset:17600
    v_mfma_f32_16x16x32_bf16 v[28:31], a[120:123], v[240:243], v[28:31]
    ds_read_b64_tr_b16 a[92:93], v3 offset:17728
    v_mfma_f32_16x16x32_bf16 v[28:31], a[124:127], v[248:251], v[28:31]
    s_waitcnt lgkmcnt(11)
    ds_read_b64_tr_b16 a[94:95], v3 offset:17856
    v_mfma_f32_16x16x32_bf16 v[32:35], a[64:67], v[128:131], 0
    ds_read_b64_tr_b16 a[96:97], v3 offset:96
    v_cvt_pk_bf16_f32 v48, v16, v17
    v_mfma_f32_16x16x32_bf16 v[32:35], a[68:71], v[136:139], v[32:35]
    s_waitcnt lgkmcnt(9)
    ds_read_b64_tr_b16 a[98:99], v3 offset:224
    v_cvt_pk_bf16_f32 v49, v18, v19
    v_mfma_f32_16x16x32_bf16 v[32:35], a[72:75], v[144:147], v[32:35]
    ds_read_b64_tr_b16 a[100:101], v3 offset:352
    v_cvt_pk_bf16_f32 v50, v24, v25
    v_mfma_f32_16x16x32_bf16 v[32:35], a[76:79], v[152:155], v[32:35]
    s_waitcnt lgkmcnt(7)
    ds_read_b64_tr_b16 a[102:103], v3 offset:480
    v_cvt_pk_bf16_f32 v51, v26, v27
    v_mfma_f32_16x16x32_bf16 v[32:35], a[80:83], v[192:195], v[32:35]
    s_mov_b32 s54, 6144
    ds_read_b64_tr_b16 a[104:105], v3 offset:608
    ds_read_b64_tr_b16 a[106:107], v3 offset:736
    v_mfma_f32_16x16x32_bf16 v[32:35], a[84:87], v[200:203], v[32:35]
    s_waitcnt lgkmcnt(6)
    v_permlane32_swap_b32 v48, v50
    v_mfma_f32_16x16x32_bf16 v[32:35], a[88:91], v[208:211], v[32:35]
    v_permlane32_swap_b32 v49, v51
    v_mfma_f32_16x16x32_bf16 v[32:35], a[92:95], v[216:219], v[32:35]
    ds_read_b64_tr_b16 a[108:109], v3 offset:864
    ds_read_b64_tr_b16 a[110:111], v3 offset:992
    buffer_store_dwordx4 v[48:51], v10, s[40:43], s54 offen offset:0 sc1
    v_mfma_f32_16x16x32_bf16 v[36:39], a[64:67], v[160:163], 0
    ds_read_b64_tr_b16 a[112:113], v3 offset:16992
    v_cvt_pk_bf16_f32 v52, v20, v21
    v_mfma_f32_16x16x32_bf16 v[36:39], a[68:71], v[168:171], v[36:39]
    ds_read_b64_tr_b16 a[114:115], v3 offset:17120
    v_cvt_pk_bf16_f32 v53, v22, v23
    v_mfma_f32_16x16x32_bf16 v[36:39], a[72:75], v[176:179], v[36:39]
    ds_read_b64_tr_b16 a[116:117], v3 offset:17248
    v_cvt_pk_bf16_f32 v54, v28, v29
    v_mfma_f32_16x16x32_bf16 v[36:39], a[76:79], v[184:187], v[36:39]
    ds_read_b64_tr_b16 a[118:119], v3 offset:17376
    v_cvt_pk_bf16_f32 v55, v30, v31
    v_mfma_f32_16x16x32_bf16 v[36:39], a[80:83], v[224:227], v[36:39]
    s_mov_b32 s54, 301056
    ds_read_b64_tr_b16 a[120:121], v3 offset:17504
    ds_read_b64_tr_b16 a[122:123], v3 offset:17632
    v_mfma_f32_16x16x32_bf16 v[36:39], a[84:87], v[232:235], v[36:39]
    v_permlane32_swap_b32 v52, v54
    v_mfma_f32_16x16x32_bf16 v[36:39], a[88:91], v[240:243], v[36:39]
    v_permlane32_swap_b32 v53, v55
    v_mfma_f32_16x16x32_bf16 v[36:39], a[92:95], v[248:251], v[36:39]
    s_waitcnt vmcnt(15)
    s_barrier
    s_waitcnt lgkmcnt(10)
    ds_read_b64_tr_b16 a[124:125], v3 offset:17760
    ds_read_b64_tr_b16 a[126:127], v3 offset:17888
    buffer_store_dwordx4 v[52:55], v10, s[40:43], s54 offen offset:0 sc1
    v_mfma_f32_16x16x32_bf16 v[40:43], a[96:99], v[128:131], 0
    ds_read_b64_tr_b16 a[64:65], v3 offset:36864
    v_mfma_f32_16x16x32_bf16 v[40:43], a[100:103], v[136:139], v[40:43]
    s_waitcnt lgkmcnt(9)
    ds_read_b64_tr_b16 a[66:67], v3 offset:36992
    v_mfma_f32_16x16x32_bf16 v[40:43], a[104:107], v[144:147], v[40:43]
    ds_read_b64_tr_b16 a[68:69], v3 offset:37120
    v_mfma_f32_16x16x32_bf16 v[40:43], a[108:111], v[152:155], v[40:43]
    s_waitcnt lgkmcnt(7)
    ds_read_b64_tr_b16 a[70:71], v3 offset:37248
    v_mfma_f32_16x16x32_bf16 v[40:43], a[112:115], v[192:195], v[40:43]
    ds_read_b64_tr_b16 a[72:73], v3 offset:37376
    v_mfma_f32_16x16x32_bf16 v[40:43], a[116:119], v[200:203], v[40:43]
    s_waitcnt lgkmcnt(5)
    ds_read_b64_tr_b16 a[74:75], v3 offset:37504
    v_mfma_f32_16x16x32_bf16 v[40:43], a[120:123], v[208:211], v[40:43]
    ds_read_b64_tr_b16 a[76:77], v3 offset:37632
    v_mfma_f32_16x16x32_bf16 v[40:43], a[124:127], v[216:219], v[40:43]
    ds_read_b64_tr_b16 a[78:79], v3 offset:37760
    v_mfma_f32_16x16x32_bf16 v[44:47], a[96:99], v[160:163], 0
    ds_read_b64_tr_b16 a[80:81], v3 offset:53760
    v_mfma_f32_16x16x32_bf16 v[44:47], a[100:103], v[168:171], v[44:47]
    ds_read_b64_tr_b16 a[82:83], v3 offset:53888
    v_mfma_f32_16x16x32_bf16 v[44:47], a[104:107], v[176:179], v[44:47]
    ds_read_b64_tr_b16 a[84:85], v3 offset:54016
    v_mfma_f32_16x16x32_bf16 v[44:47], a[108:111], v[184:187], v[44:47]
    ds_read_b64_tr_b16 a[86:87], v3 offset:54144
    v_mfma_f32_16x16x32_bf16 v[44:47], a[112:115], v[224:227], v[44:47]
    ds_read_b64_tr_b16 a[88:89], v3 offset:54272
    v_mfma_f32_16x16x32_bf16 v[44:47], a[116:119], v[232:235], v[44:47]
    ds_read_b64_tr_b16 a[90:91], v3 offset:54400
    v_mfma_f32_16x16x32_bf16 v[44:47], a[120:123], v[240:243], v[44:47]
    ds_read_b64_tr_b16 a[92:93], v3 offset:54528
    v_mfma_f32_16x16x32_bf16 v[44:47], a[124:127], v[248:251], v[44:47]
    s_waitcnt lgkmcnt(11)
    ds_read_b64_tr_b16 a[94:95], v3 offset:54656
    v_mfma_f32_16x16x32_bf16 v[16:19], a[64:67], v[128:131], 0
    ds_read_b64_tr_b16 a[96:97], v3 offset:36896
    v_cvt_pk_bf16_f32 v48, v32, v33
    v_mfma_f32_16x16x32_bf16 v[16:19], a[68:71], v[136:139], v[16:19]
    s_waitcnt lgkmcnt(9)
    ds_read_b64_tr_b16 a[98:99], v3 offset:37024
    v_cvt_pk_bf16_f32 v49, v34, v35
    v_mfma_f32_16x16x32_bf16 v[16:19], a[72:75], v[144:147], v[16:19]
    ds_read_b64_tr_b16 a[100:101], v3 offset:37152
    v_cvt_pk_bf16_f32 v50, v40, v41
    v_mfma_f32_16x16x32_bf16 v[16:19], a[76:79], v[152:155], v[16:19]
    s_waitcnt lgkmcnt(7)
    ds_read_b64_tr_b16 a[102:103], v3 offset:37280
    v_cvt_pk_bf16_f32 v51, v42, v43
    v_mfma_f32_16x16x32_bf16 v[16:19], a[80:83], v[192:195], v[16:19]
    s_mov_b32 s54, 6144
    ds_read_b64_tr_b16 a[104:105], v3 offset:37408
    ds_read_b64_tr_b16 a[106:107], v3 offset:37536
    v_mfma_f32_16x16x32_bf16 v[16:19], a[84:87], v[200:203], v[16:19]
    s_waitcnt lgkmcnt(6)
    v_permlane32_swap_b32 v48, v50
    v_mfma_f32_16x16x32_bf16 v[16:19], a[88:91], v[208:211], v[16:19]
    v_permlane32_swap_b32 v49, v51
    v_mfma_f32_16x16x32_bf16 v[16:19], a[92:95], v[216:219], v[16:19]
    ds_read_b64_tr_b16 a[108:109], v3 offset:37664
    ds_read_b64_tr_b16 a[110:111], v3 offset:37792
    buffer_store_dwordx4 v[48:51], v10, s[40:43], s54 offen offset:512 sc1
    v_mfma_f32_16x16x32_bf16 v[20:23], a[64:67], v[160:163], 0
    ds_read_b64_tr_b16 a[112:113], v3 offset:53792
    v_cvt_pk_bf16_f32 v52, v36, v37
    v_mfma_f32_16x16x32_bf16 v[20:23], a[68:71], v[168:171], v[20:23]
    ds_read_b64_tr_b16 a[114:115], v3 offset:53920
    v_cvt_pk_bf16_f32 v53, v38, v39
    v_mfma_f32_16x16x32_bf16 v[20:23], a[72:75], v[176:179], v[20:23]
    ds_read_b64_tr_b16 a[116:117], v3 offset:54048
    v_cvt_pk_bf16_f32 v54, v44, v45
    v_mfma_f32_16x16x32_bf16 v[20:23], a[76:79], v[184:187], v[20:23]
    ds_read_b64_tr_b16 a[118:119], v3 offset:54176
    v_cvt_pk_bf16_f32 v55, v46, v47
    v_mfma_f32_16x16x32_bf16 v[20:23], a[80:83], v[224:227], v[20:23]
    s_mov_b32 s54, 301056
    ds_read_b64_tr_b16 a[120:121], v3 offset:54304
    ds_read_b64_tr_b16 a[122:123], v3 offset:54432
    v_mfma_f32_16x16x32_bf16 v[20:23], a[84:87], v[232:235], v[20:23]
    v_permlane32_swap_b32 v52, v54
    v_mfma_f32_16x16x32_bf16 v[20:23], a[88:91], v[240:243], v[20:23]
    v_permlane32_swap_b32 v53, v55
    v_mfma_f32_16x16x32_bf16 v[20:23], a[92:95], v[248:251], v[20:23]
    s_waitcnt lgkmcnt(10)
    ds_read_b64_tr_b16 a[124:125], v3 offset:54560
    ds_read_b64_tr_b16 a[126:127], v3 offset:54688
    buffer_store_dwordx4 v[52:55], v10, s[40:43], s54 offen offset:512 sc1
    v_mfma_f32_16x16x32_bf16 v[24:27], a[96:99], v[128:131], 0
    ds_read_b64_tr_b16 a[64:65], v3 offset:36928
    v_mfma_f32_16x16x32_bf16 v[24:27], a[100:103], v[136:139], v[24:27]
    s_waitcnt lgkmcnt(9)
    ds_read_b64_tr_b16 a[66:67], v3 offset:37056
    v_mfma_f32_16x16x32_bf16 v[24:27], a[104:107], v[144:147], v[24:27]
    ds_read_b64_tr_b16 a[68:69], v3 offset:37184
    v_mfma_f32_16x16x32_bf16 v[24:27], a[108:111], v[152:155], v[24:27]
    s_waitcnt lgkmcnt(7)
    ds_read_b64_tr_b16 a[70:71], v3 offset:37312
    v_mfma_f32_16x16x32_bf16 v[24:27], a[112:115], v[192:195], v[24:27]
    ds_read_b64_tr_b16 a[72:73], v3 offset:37440
    v_mfma_f32_16x16x32_bf16 v[24:27], a[116:119], v[200:203], v[24:27]
    s_waitcnt lgkmcnt(5)
    ds_read_b64_tr_b16 a[74:75], v3 offset:37568
    v_mfma_f32_16x16x32_bf16 v[24:27], a[120:123], v[208:211], v[24:27]
    ds_read_b64_tr_b16 a[76:77], v3 offset:37696
    v_mfma_f32_16x16x32_bf16 v[24:27], a[124:127], v[216:219], v[24:27]
    ds_read_b64_tr_b16 a[78:79], v3 offset:37824
    v_mfma_f32_16x16x32_bf16 v[28:31], a[96:99], v[160:163], 0
    ds_read_b64_tr_b16 a[80:81], v3 offset:53824
    v_mfma_f32_16x16x32_bf16 v[28:31], a[100:103], v[168:171], v[28:31]
    ds_read_b64_tr_b16 a[82:83], v3 offset:53952
    v_mfma_f32_16x16x32_bf16 v[28:31], a[104:107], v[176:179], v[28:31]
    ds_read_b64_tr_b16 a[84:85], v3 offset:54080
    v_mfma_f32_16x16x32_bf16 v[28:31], a[108:111], v[184:187], v[28:31]
    ds_read_b64_tr_b16 a[86:87], v3 offset:54208
    v_mfma_f32_16x16x32_bf16 v[28:31], a[112:115], v[224:227], v[28:31]
    ds_read_b64_tr_b16 a[88:89], v3 offset:54336
    v_mfma_f32_16x16x32_bf16 v[28:31], a[116:119], v[232:235], v[28:31]
    ds_read_b64_tr_b16 a[90:91], v3 offset:54464
    v_mfma_f32_16x16x32_bf16 v[28:31], a[120:123], v[240:243], v[28:31]
    ds_read_b64_tr_b16 a[92:93], v3 offset:54592
    v_mfma_f32_16x16x32_bf16 v[28:31], a[124:127], v[248:251], v[28:31]
    s_waitcnt lgkmcnt(11)
    ds_read_b64_tr_b16 a[94:95], v3 offset:54720
    v_mfma_f32_16x16x32_bf16 v[32:35], a[64:67], v[128:131], 0
    ds_read_b64_tr_b16 a[96:97], v3 offset:36960
    v_cvt_pk_bf16_f32 v48, v16, v17
    v_mfma_f32_16x16x32_bf16 v[32:35], a[68:71], v[136:139], v[32:35]
    s_waitcnt lgkmcnt(9)
    ds_read_b64_tr_b16 a[98:99], v3 offset:37088
    v_cvt_pk_bf16_f32 v49, v18, v19
    v_mfma_f32_16x16x32_bf16 v[32:35], a[72:75], v[144:147], v[32:35]
    ds_read_b64_tr_b16 a[100:101], v3 offset:37216
    v_cvt_pk_bf16_f32 v50, v24, v25
    v_mfma_f32_16x16x32_bf16 v[32:35], a[76:79], v[152:155], v[32:35]
    s_waitcnt lgkmcnt(7)
    ds_read_b64_tr_b16 a[102:103], v3 offset:37344
    v_cvt_pk_bf16_f32 v51, v26, v27
    v_mfma_f32_16x16x32_bf16 v[32:35], a[80:83], v[192:195], v[32:35]
    s_mov_b32 s54, 7168
    ds_read_b64_tr_b16 a[104:105], v3 offset:37472
    ds_read_b64_tr_b16 a[106:107], v3 offset:37600
    v_mfma_f32_16x16x32_bf16 v[32:35], a[84:87], v[200:203], v[32:35]
    s_waitcnt lgkmcnt(6)
    v_permlane32_swap_b32 v48, v50
    v_mfma_f32_16x16x32_bf16 v[32:35], a[88:91], v[208:211], v[32:35]
    v_permlane32_swap_b32 v49, v51
    v_mfma_f32_16x16x32_bf16 v[32:35], a[92:95], v[216:219], v[32:35]
    ds_read_b64_tr_b16 a[108:109], v3 offset:37728
    ds_read_b64_tr_b16 a[110:111], v3 offset:37856
    buffer_store_dwordx4 v[48:51], v10, s[40:43], s54 offen offset:0 sc1
    v_mfma_f32_16x16x32_bf16 v[36:39], a[64:67], v[160:163], 0
    ds_read_b64_tr_b16 a[112:113], v3 offset:53856
    v_cvt_pk_bf16_f32 v52, v20, v21
    v_mfma_f32_16x16x32_bf16 v[36:39], a[68:71], v[168:171], v[36:39]
    ds_read_b64_tr_b16 a[114:115], v3 offset:53984
    v_cvt_pk_bf16_f32 v53, v22, v23
    v_mfma_f32_16x16x32_bf16 v[36:39], a[72:75], v[176:179], v[36:39]
    ds_read_b64_tr_b16 a[116:117], v3 offset:54112
    v_cvt_pk_bf16_f32 v54, v28, v29
    v_mfma_f32_16x16x32_bf16 v[36:39], a[76:79], v[184:187], v[36:39]
    ds_read_b64_tr_b16 a[118:119], v3 offset:54240
    v_cvt_pk_bf16_f32 v55, v30, v31
    v_mfma_f32_16x16x32_bf16 v[36:39], a[80:83], v[224:227], v[36:39]
    s_mov_b32 s54, 302080
    ds_read_b64_tr_b16 a[120:121], v3 offset:54368
    ds_read_b64_tr_b16 a[122:123], v3 offset:54496
    v_mfma_f32_16x16x32_bf16 v[36:39], a[84:87], v[232:235], v[36:39]
    v_permlane32_swap_b32 v52, v54
    v_mfma_f32_16x16x32_bf16 v[36:39], a[88:91], v[240:243], v[36:39]
    v_permlane32_swap_b32 v53, v55
    v_mfma_f32_16x16x32_bf16 v[36:39], a[92:95], v[248:251], v[36:39]
    s_waitcnt vmcnt(7)
    s_barrier
    s_waitcnt lgkmcnt(10)
    ds_read_b64_tr_b16 a[124:125], v3 offset:54624
    ds_read_b64_tr_b16 a[126:127], v3 offset:54752
    buffer_store_dwordx4 v[52:55], v10, s[40:43], s54 offen offset:0 sc1
    v_mfma_f32_16x16x32_bf16 v[40:43], a[96:99], v[128:131], 0
    ds_read_b64_tr_b16 a[64:65], v4 offset:0
    v_mfma_f32_16x16x32_bf16 v[40:43], a[100:103], v[136:139], v[40:43]
    s_waitcnt lgkmcnt(9)
    ds_read_b64_tr_b16 a[66:67], v4 offset:128
    v_mfma_f32_16x16x32_bf16 v[40:43], a[104:107], v[144:147], v[40:43]
    ds_read_b64_tr_b16 a[68:69], v4 offset:256
    v_mfma_f32_16x16x32_bf16 v[40:43], a[108:111], v[152:155], v[40:43]
    s_waitcnt lgkmcnt(7)
    ds_read_b64_tr_b16 a[70:71], v4 offset:384
    v_mfma_f32_16x16x32_bf16 v[40:43], a[112:115], v[192:195], v[40:43]
    ds_read_b64_tr_b16 a[72:73], v4 offset:512
    v_mfma_f32_16x16x32_bf16 v[40:43], a[116:119], v[200:203], v[40:43]
    s_waitcnt lgkmcnt(5)
    ds_read_b64_tr_b16 a[74:75], v4 offset:640
    v_mfma_f32_16x16x32_bf16 v[40:43], a[120:123], v[208:211], v[40:43]
    ds_read_b64_tr_b16 a[76:77], v4 offset:768
    v_mfma_f32_16x16x32_bf16 v[40:43], a[124:127], v[216:219], v[40:43]
    ds_read_b64_tr_b16 a[78:79], v4 offset:896
    v_mfma_f32_16x16x32_bf16 v[44:47], a[96:99], v[160:163], 0
    ds_read_b64_tr_b16 a[80:81], v4 offset:16896
    v_mfma_f32_16x16x32_bf16 v[44:47], a[100:103], v[168:171], v[44:47]
    ds_read_b64_tr_b16 a[82:83], v4 offset:17024
    v_mfma_f32_16x16x32_bf16 v[44:47], a[104:107], v[176:179], v[44:47]
    ds_read_b64_tr_b16 a[84:85], v4 offset:17152
    v_mfma_f32_16x16x32_bf16 v[44:47], a[108:111], v[184:187], v[44:47]
    ds_read_b64_tr_b16 a[86:87], v4 offset:17280
    v_mfma_f32_16x16x32_bf16 v[44:47], a[112:115], v[224:227], v[44:47]
    ds_read_b64_tr_b16 a[88:89], v4 offset:17408
    v_mfma_f32_16x16x32_bf16 v[44:47], a[116:119], v[232:235], v[44:47]
    ds_read_b64_tr_b16 a[90:91], v4 offset:17536
    v_mfma_f32_16x16x32_bf16 v[44:47], a[120:123], v[240:243], v[44:47]
    ds_read_b64_tr_b16 a[92:93], v4 offset:17664
    v_mfma_f32_16x16x32_bf16 v[44:47], a[124:127], v[248:251], v[44:47]
    s_waitcnt lgkmcnt(11)
    ds_read_b64_tr_b16 a[94:95], v4 offset:17792
    v_mfma_f32_16x16x32_bf16 v[16:19], a[64:67], v[128:131], 0
    ds_read_b64_tr_b16 a[96:97], v4 offset:32
    v_cvt_pk_bf16_f32 v48, v32, v33
    v_mfma_f32_16x16x32_bf16 v[16:19], a[68:71], v[136:139], v[16:19]
    s_waitcnt lgkmcnt(9)
    ds_read_b64_tr_b16 a[98:99], v4 offset:160
    v_cvt_pk_bf16_f32 v49, v34, v35
    v_mfma_f32_16x16x32_bf16 v[16:19], a[72:75], v[144:147], v[16:19]
    ds_read_b64_tr_b16 a[100:101], v4 offset:288
    v_cvt_pk_bf16_f32 v50, v40, v41
    v_mfma_f32_16x16x32_bf16 v[16:19], a[76:79], v[152:155], v[16:19]
    s_waitcnt lgkmcnt(7)
    ds_read_b64_tr_b16 a[102:103], v4 offset:416
    v_cvt_pk_bf16_f32 v51, v42, v43
    v_mfma_f32_16x16x32_bf16 v[16:19], a[80:83], v[192:195], v[16:19]
    s_mov_b32 s54, 7168
    ds_read_b64_tr_b16 a[104:105], v4 offset:544
    ds_read_b64_tr_b16 a[106:107], v4 offset:672
    v_mfma_f32_16x16x32_bf16 v[16:19], a[84:87], v[200:203], v[16:19]
    s_waitcnt lgkmcnt(6)
    v_permlane32_swap_b32 v48, v50
    v_mfma_f32_16x16x32_bf16 v[16:19], a[88:91], v[208:211], v[16:19]
    v_permlane32_swap_b32 v49, v51
    v_mfma_f32_16x16x32_bf16 v[16:19], a[92:95], v[216:219], v[16:19]
    ds_read_b64_tr_b16 a[108:109], v4 offset:800
    ds_read_b64_tr_b16 a[110:111], v4 offset:928
    buffer_store_dwordx4 v[48:51], v10, s[40:43], s54 offen offset:512 sc1
    v_mfma_f32_16x16x32_bf16 v[20:23], a[64:67], v[160:163], 0
    ds_read_b64_tr_b16 a[112:113], v4 offset:16928
    v_cvt_pk_bf16_f32 v52, v36, v37
    v_mfma_f32_16x16x32_bf16 v[20:23], a[68:71], v[168:171], v[20:23]
    ds_read_b64_tr_b16 a[114:115], v4 offset:17056
    v_cvt_pk_bf16_f32 v53, v38, v39
    v_mfma_f32_16x16x32_bf16 v[20:23], a[72:75], v[176:179], v[20:23]
    ds_read_b64_tr_b16 a[116:117], v4 offset:17184
    v_cvt_pk_bf16_f32 v54, v44, v45
    v_mfma_f32_16x16x32_bf16 v[20:23], a[76:79], v[184:187], v[20:23]
    ds_read_b64_tr_b16 a[118:119], v4 offset:17312
    v_cvt_pk_bf16_f32 v55, v46, v47
    v_mfma_f32_16x16x32_bf16 v[20:23], a[80:83], v[224:227], v[20:23]
    s_mov_b32 s54, 302080
    ds_read_b64_tr_b16 a[120:121], v4 offset:17440
    ds_read_b64_tr_b16 a[122:123], v4 offset:17568
    v_mfma_f32_16x16x32_bf16 v[20:23], a[84:87], v[232:235], v[20:23]
    v_permlane32_swap_b32 v52, v54
    v_mfma_f32_16x16x32_bf16 v[20:23], a[88:91], v[240:243], v[20:23]
    v_permlane32_swap_b32 v53, v55
    v_mfma_f32_16x16x32_bf16 v[20:23], a[92:95], v[248:251], v[20:23]
    s_waitcnt lgkmcnt(10)
    ds_read_b64_tr_b16 a[124:125], v4 offset:17696
    ds_read_b64_tr_b16 a[126:127], v4 offset:17824
    buffer_store_dwordx4 v[52:55], v10, s[40:43], s54 offen offset:512 sc1
    v_mfma_f32_16x16x32_bf16 v[24:27], a[96:99], v[128:131], 0
    ds_read_b64_tr_b16 a[64:65], v4 offset:64
    v_mfma_f32_16x16x32_bf16 v[24:27], a[100:103], v[136:139], v[24:27]
    s_waitcnt lgkmcnt(9)
    ds_read_b64_tr_b16 a[66:67], v4 offset:192
    v_mfma_f32_16x16x32_bf16 v[24:27], a[104:107], v[144:147], v[24:27]
    ds_read_b64_tr_b16 a[68:69], v4 offset:320
    v_mfma_f32_16x16x32_bf16 v[24:27], a[108:111], v[152:155], v[24:27]
    s_waitcnt lgkmcnt(7)
    ds_read_b64_tr_b16 a[70:71], v4 offset:448
    v_mfma_f32_16x16x32_bf16 v[24:27], a[112:115], v[192:195], v[24:27]
    ds_read_b64_tr_b16 a[72:73], v4 offset:576
    v_mfma_f32_16x16x32_bf16 v[24:27], a[116:119], v[200:203], v[24:27]
    s_waitcnt lgkmcnt(5)
    ds_read_b64_tr_b16 a[74:75], v4 offset:704
    v_mfma_f32_16x16x32_bf16 v[24:27], a[120:123], v[208:211], v[24:27]
    ds_read_b64_tr_b16 a[76:77], v4 offset:832
    v_mfma_f32_16x16x32_bf16 v[24:27], a[124:127], v[216:219], v[24:27]
    ds_read_b64_tr_b16 a[78:79], v4 offset:960
    v_mfma_f32_16x16x32_bf16 v[28:31], a[96:99], v[160:163], 0
    ds_read_b64_tr_b16 a[80:81], v4 offset:16960
    v_mfma_f32_16x16x32_bf16 v[28:31], a[100:103], v[168:171], v[28:31]
    ds_read_b64_tr_b16 a[82:83], v4 offset:17088
    v_mfma_f32_16x16x32_bf16 v[28:31], a[104:107], v[176:179], v[28:31]
    ds_read_b64_tr_b16 a[84:85], v4 offset:17216
    v_mfma_f32_16x16x32_bf16 v[28:31], a[108:111], v[184:187], v[28:31]
    ds_read_b64_tr_b16 a[86:87], v4 offset:17344
    v_mfma_f32_16x16x32_bf16 v[28:31], a[112:115], v[224:227], v[28:31]
    ds_read_b64_tr_b16 a[88:89], v4 offset:17472
    v_mfma_f32_16x16x32_bf16 v[28:31], a[116:119], v[232:235], v[28:31]
    ds_read_b64_tr_b16 a[90:91], v4 offset:17600
    v_mfma_f32_16x16x32_bf16 v[28:31], a[120:123], v[240:243], v[28:31]
    ds_read_b64_tr_b16 a[92:93], v4 offset:17728
    v_mfma_f32_16x16x32_bf16 v[28:31], a[124:127], v[248:251], v[28:31]
    s_waitcnt lgkmcnt(11)
    ds_read_b64_tr_b16 a[94:95], v4 offset:17856
    v_mfma_f32_16x16x32_bf16 v[32:35], a[64:67], v[128:131], 0
    ds_read_b64_tr_b16 a[96:97], v4 offset:96
    v_cvt_pk_bf16_f32 v48, v16, v17
    v_mfma_f32_16x16x32_bf16 v[32:35], a[68:71], v[136:139], v[32:35]
    s_waitcnt lgkmcnt(9)
    ds_read_b64_tr_b16 a[98:99], v4 offset:224
    v_cvt_pk_bf16_f32 v49, v18, v19
    v_mfma_f32_16x16x32_bf16 v[32:35], a[72:75], v[144:147], v[32:35]
    ds_read_b64_tr_b16 a[100:101], v4 offset:352
    v_cvt_pk_bf16_f32 v50, v24, v25
    v_mfma_f32_16x16x32_bf16 v[32:35], a[76:79], v[152:155], v[32:35]
    s_waitcnt lgkmcnt(7)
    ds_read_b64_tr_b16 a[102:103], v4 offset:480
    v_cvt_pk_bf16_f32 v51, v26, v27
    v_mfma_f32_16x16x32_bf16 v[32:35], a[80:83], v[192:195], v[32:35]
    s_mov_b32 s54, 8192
    ds_read_b64_tr_b16 a[104:105], v4 offset:608
    ds_read_b64_tr_b16 a[106:107], v4 offset:736
    v_mfma_f32_16x16x32_bf16 v[32:35], a[84:87], v[200:203], v[32:35]
    s_waitcnt lgkmcnt(6)
    v_permlane32_swap_b32 v48, v50
    v_mfma_f32_16x16x32_bf16 v[32:35], a[88:91], v[208:211], v[32:35]
    v_permlane32_swap_b32 v49, v51
    v_mfma_f32_16x16x32_bf16 v[32:35], a[92:95], v[216:219], v[32:35]
    ds_read_b64_tr_b16 a[108:109], v4 offset:864
    ds_read_b64_tr_b16 a[110:111], v4 offset:992
    buffer_store_dwordx4 v[48:51], v10, s[40:43], s54 offen offset:0 sc1
    v_mfma_f32_16x16x32_bf16 v[36:39], a[64:67], v[160:163], 0
    ds_read_b64_tr_b16 a[112:113], v4 offset:16992
    v_cvt_pk_bf16_f32 v52, v20, v21
    v_mfma_f32_16x16x32_bf16 v[36:39], a[68:71], v[168:171], v[36:39]
    ds_read_b64_tr_b16 a[114:115], v4 offset:17120
    v_cvt_pk_bf16_f32 v53, v22, v23
    v_mfma_f32_16x16x32_bf16 v[36:39], a[72:75], v[176:179], v[36:39]
    ds_read_b64_tr_b16 a[116:117], v4 offset:17248
    v_cvt_pk_bf16_f32 v54, v28, v29
    v_mfma_f32_16x16x32_bf16 v[36:39], a[76:79], v[184:187], v[36:39]
    ds_read_b64_tr_b16 a[118:119], v4 offset:17376
    v_cvt_pk_bf16_f32 v55, v30, v31
    v_mfma_f32_16x16x32_bf16 v[36:39], a[80:83], v[224:227], v[36:39]
    s_mov_b32 s54, 303104
    ds_read_b64_tr_b16 a[120:121], v4 offset:17504
    ds_read_b64_tr_b16 a[122:123], v4 offset:17632
    v_mfma_f32_16x16x32_bf16 v[36:39], a[84:87], v[232:235], v[36:39]
    v_permlane32_swap_b32 v52, v54
    v_mfma_f32_16x16x32_bf16 v[36:39], a[88:91], v[240:243], v[36:39]
    v_permlane32_swap_b32 v53, v55
    v_mfma_f32_16x16x32_bf16 v[36:39], a[92:95], v[248:251], v[36:39]
    s_waitcnt lgkmcnt(10)
    ds_read_b64_tr_b16 a[124:125], v4 offset:17760
    ds_read_b64_tr_b16 a[126:127], v4 offset:17888
    buffer_store_dwordx4 v[52:55], v10, s[40:43], s54 offen offset:0 sc1
    v_mfma_f32_16x16x32_bf16 v[40:43], a[96:99], v[128:131], 0
    v_mfma_f32_16x16x32_bf16 v[40:43], a[100:103], v[136:139], v[40:43]
    s_waitcnt lgkmcnt(8)
    v_mfma_f32_16x16x32_bf16 v[40:43], a[104:107], v[144:147], v[40:43]
    v_mfma_f32_16x16x32_bf16 v[40:43], a[108:111], v[152:155], v[40:43]
    s_waitcnt lgkmcnt(4)
    v_mfma_f32_16x16x32_bf16 v[40:43], a[112:115], v[192:195], v[40:43]
    v_mfma_f32_16x16x32_bf16 v[40:43], a[116:119], v[200:203], v[40:43]
    s_waitcnt lgkmcnt(0)
    v_mfma_f32_16x16x32_bf16 v[40:43], a[120:123], v[208:211], v[40:43]
    v_mfma_f32_16x16x32_bf16 v[40:43], a[124:127], v[216:219], v[40:43]
    v_mfma_f32_16x16x32_bf16 v[44:47], a[96:99], v[160:163], 0
    v_mfma_f32_16x16x32_bf16 v[44:47], a[100:103], v[168:171], v[44:47]
    v_mfma_f32_16x16x32_bf16 v[44:47], a[104:107], v[176:179], v[44:47]
    v_mfma_f32_16x16x32_bf16 v[44:47], a[108:111], v[184:187], v[44:47]
    v_mfma_f32_16x16x32_bf16 v[44:47], a[112:115], v[224:227], v[44:47]
    v_mfma_f32_16x16x32_bf16 v[44:47], a[116:119], v[232:235], v[44:47]
    v_mfma_f32_16x16x32_bf16 v[44:47], a[120:123], v[240:243], v[44:47]
    v_mfma_f32_16x16x32_bf16 v[44:47], a[124:127], v[248:251], v[44:47]
    s_nop 7
    v_cvt_pk_bf16_f32 v48, v32, v33
    v_cvt_pk_bf16_f32 v49, v34, v35
    v_cvt_pk_bf16_f32 v50, v40, v41
    v_cvt_pk_bf16_f32 v51, v42, v43
    s_nop 1
    v_permlane32_swap_b32 v48, v50
    v_permlane32_swap_b32 v49, v51
    s_mov_b32 s54, 8192
    buffer_store_dwordx4 v[48:51], v10, s[40:43], s54 offen offset:512 sc1
    v_cvt_pk_bf16_f32 v52, v36, v37
    v_cvt_pk_bf16_f32 v53, v38, v39
    v_cvt_pk_bf16_f32 v54, v44, v45
    v_cvt_pk_bf16_f32 v55, v46, v47
    s_nop 1
    v_permlane32_swap_b32 v52, v54
    v_permlane32_swap_b32 v53, v55
    s_mov_b32 s54, 303104
    buffer_store_dwordx4 v[52:55], v10, s[40:43], s54 offen offset:512 sc1
    v_lshlrev_b32 v12, 7, v0
    v_mov_b32 v13, 1
    s_lshl_b32 s15, s53, 13
    s_add_u32 s15, s15, 786432
    s_lshl_b32 s3, s51, 4
    s_add_u32 s3, s3, s52
    s_lshl_b32 s3, s3, 7
    s_add_u32 s3, s3, s15
    s_and_b32 s14, s52, 12
    s_lshl_b32 s14, s14, 9
    s_add_u32 s15, s15, s14
    s_mul_i32 s14, s51, 2304
    v_add_u32 v5, s14, v8
    v_lshrrev_b32 v14, 4, v0
    v_mul_u32_u24 v14, 8960, v14
    v_add_u32 v7, v5, v14
    v_lshlrev_b32 v16, 16, v112
    v_and_b32 v17, 0xffff0000, v112
    v_lshlrev_b32 v18, 16, v113
    v_and_b32 v19, 0xffff0000, v113
    v_lshlrev_b32 v20, 16, v114
    v_and_b32 v21, 0xffff0000, v114
    v_lshlrev_b32 v22, 16, v115
    v_and_b32 v23, 0xffff0000, v115
    v_lshlrev_b32 v24, 16, v116
    v_and_b32 v25, 0xffff0000, v116
    v_lshlrev_b32 v26, 16, v117
    v_and_b32 v27, 0xffff0000, v117
    v_lshlrev_b32 v28, 16, v118
    v_and_b32 v29, 0xffff0000, v118
    v_lshlrev_b32 v30, 16, v119
    v_and_b32 v31, 0xffff0000, v119
    v_lshlrev_b32 v32, 16, v120
    v_and_b32 v33, 0xffff0000, v120
    v_lshlrev_b32 v34, 16, v121
    v_and_b32 v35, 0xffff0000, v121
    v_lshlrev_b32 v36, 16, v122
    v_and_b32 v37, 0xffff0000, v122
    v_lshlrev_b32 v38, 16, v123
    v_and_b32 v39, 0xffff0000, v123
    s_waitcnt vmcnt(0)
    s_mov_b64 exec, 1
    buffer_store_dword v13, v12, s[84:87], s3 offen sc1
    s_mov_b64 exec, 0xffff
    s_mov_b32 s97, 0x20000
L2_p1:
    buffer_load_dword v13, v12, s[84:87], s15 offen sc1
    s_waitcnt vmcnt(0)
    v_cmp_eq_u32 vcc, 0, v13
    s_sub_u32 s97, s97, 1
    s_cselect_b64 vcc, 0, vcc
    s_cmp_eq_u64 vcc, 0
    s_cbranch_scc1 L2_p1_ok
    s_sleep 1
    s_branch L2_p1
L2_p1_ok:
    s_mov_b64 exec, -1
    s_mov_b32 s45, 0
    buffer_load_dwordx4 v[112:115], v7, s[88:91], s45 offen offset:2048 sc1
    s_mov_b32 s45, 36864
    buffer_load_dwordx4 v[116:119], v7, s[88:91], s45 offen offset:2048 sc1
    s_mov_b32 s45, 73728
    buffer_load_dwordx4 v[120:123], v7, s[88:91], s45 offen offset:2048 sc1
    s_mov_b32 s45, 110592
    buffer_load_dwordx4 v[124:127], v7, s[88:91], s45 offen offset:2048 sc1
    s_mov_b32 s45, 0
    buffer_load_dwordx4 v[128:131], v5, s[88:91], s45 offen offset:0 sc1
    buffer_load_dwordx4 v[132:135], v5, s[88:91], s45 offen offset:1024 sc1
    s_mov_b32 s45, 9216
    buffer_load_dwordx4 v[136:139], v5, s[88:91], s45 offen offset:0 sc1
    buffer_load_dwordx4 v[140:143], v5, s[88:91], s45 offen offset:1024 sc1
    s_barrier
    s_add_u32 s14, s55, 16384
    v_add_u32 v105, s14, v8
    v_add_u32 v106, 73728, v105
    s_mul_i32 s14, s51, 576
    v_lshrrev_b32 v14, 3, v0
    v_lshlrev_b32 v3, 5, v14
    v_add_u32 v3, s14, v3
    v_and_b32 v14, 1, v14
    v_lshlrev_b32 v4, 5, v14
    v_add_u32 v4, s14, v4
    ds_read_b128 v[76:79], v3 offset:4608
    ds_read_b128 v[80:83], v3 offset:4624
    ds_read_b128 v[84:87], v3 offset:4864
    ds_read_b128 v[88:91], v3 offset:4880
    ds_read_b128 v[92:95], v4 offset:5120
    ds_read_b128 v[96:99], v4 offset:5136
    ds_read_b128 v[40:43], v3 offset:2304
    ds_read_b128 v[44:47], v3 offset:2320
    ds_read_b128 v[48:51], v3 offset:2560
    ds_read_b128 v[52:55], v3 offset:2576
    ds_read_b128 v[56:59], v4 offset:2816
    ds_read_b128 v[60:63], v4 offset:2832
    s_waitcnt lgkmcnt(6)
    v_mul_f32 v76, v76, v16
    v_mul_f32 v77, v77, v17
    v_mul_f32 v78, v78, v18
    v_mul_f32 v79, v79, v19
    v_mul_f32 v80, v80, v20
    v_mul_f32 v81, v81, v21
    v_mul_f32 v82, v82, v22
    v_mul_f32 v83, v83, v23
    v_mul_f32 v84, v84, v24
    v_mul_f32 v85, v85, v25
    v_mul_f32 v86, v86, v26
    v_mul_f32 v87, v87, v27
    v_mul_f32 v88, v88, v28
    v_mul_f32 v89, v89, v29
    v_mul_f32 v90, v90, v30
    v_mul_f32 v91, v91, v31
    v_mul_f32 v92, v92, v32
    v_mul_f32 v93, v93, v33
    v_mul_f32 v94, v94, v34
    v_mul_f32 v95, v95, v35
    v_mul_f32 v96, v96, v36
    v_mul_f32 v97, v97, v37
    v_mul_f32 v98, v98, v38
    v_mul_f32 v99, v99, v39
    s_waitcnt lgkmcnt(0)
    v_add_f32 v100, v76, v77
    v_add_f32 v100, v100, v78
    v_add_f32 v100, v100, v79
    v_add_f32 v100, v100, v80
    v_add_f32 v100, v100, v81
    v_add_f32 v100, v100, v82
    v_add_f32 v100, v100, v83
    v_add_f32 v100, v100, v84
    v_add_f32 v100, v100, v85
    v_add_f32 v100, v100, v86
    v_add_f32 v100, v100, v87
    v_add_f32 v100, v100, v88
    v_add_f32 v100, v100, v89
    v_add_f32 v100, v100, v90
    v_add_f32 v100, v100, v91
    v_add_f32 v102, v92, v93
    v_add_f32 v102, v102, v94
    v_add_f32 v102, v102, v95
    v_add_f32 v102, v102, v96
    v_add_f32 v102, v102, v97
    v_add_f32 v102, v102, v98
    v_add_f32 v102, v102, v99
    v_fmac_f32 v100, 0x3e800000, v102
    v_mul_f32 v101, v40, v16
    v_fmac_f32 v101, v41, v17
    v_fmac_f32 v101, v42, v18
    v_fmac_f32 v101, v43, v19
    v_fmac_f32 v101, v44, v20
    v_fmac_f32 v101, v45, v21
    v_fmac_f32 v101, v46, v22
    v_fmac_f32 v101, v47, v23
    v_fmac_f32 v101, v48, v24
    v_fmac_f32 v101, v49, v25
    v_fmac_f32 v101, v50, v26
    v_fmac_f32 v101, v51, v27
    v_fmac_f32 v101, v52, v28
    v_fmac_f32 v101, v53, v29
    v_fmac_f32 v101, v54, v30
    v_fmac_f32 v101, v55, v31
    v_mul_f32 v102, v56, v32
    v_fmac_f32 v102, v57, v33
    v_fmac_f32 v102, v58, v34
    v_fmac_f32 v102, v59, v35
    v_fmac_f32 v102, v60, v36
    v_fmac_f32 v102, v61, v37
    v_fmac_f32 v102, v62, v38
    v_fmac_f32 v102, v63, v39
    v_fmac_f32 v101, 0x3e800000, v102
    ds_read_b128 v[40:43], v3 offset:0
    ds_read_b128 v[44:47], v3 offset:16
    ds_read_b128 v[48:51], v3 offset:256
    ds_read_b128 v[52:55], v3 offset:272
    ds_read_b128 v[56:59], v4 offset:512
    ds_read_b128 v[60:63], v4 offset:528
    s_waitcnt vmcnt(7)
    s_mov_b32 s45, 18432
    buffer_load_dwordx4 v[144:147], v5, s[88:91], s45 offen offset:0 sc1
    ds_write_b128 v106, a[128:131] offset:36864
    s_waitcnt vmcnt(7)
    buffer_load_dwordx4 v[148:151], v5, s[88:91], s45 offen offset:1024 sc1
    ds_write_b128 v106, a[132:135] offset:37888
    s_waitcnt vmcnt(7)
    s_mov_b32 s45, 27648
    buffer_load_dwordx4 v[152:155], v5, s[88:91], s45 offen offset:0 sc1
    ds_write_b128 v106, a[136:139] offset:38912
    s_waitcnt vmcnt(7)
    buffer_load_dwordx4 v[156:159], v5, s[88:91], s45 offen offset:1024 sc1
    ds_write_b128 v106, a[140:143] offset:39936
    s_nop 1
    v_add_f32_dpp v100, v100, v100 row_ror:8 row_mask:0xf bank_mask:0xf
    v_add_f32_dpp v101, v101, v101 row_ror:8 row_mask:0xf bank_mask:0xf
    v_mov_b32 v102, v100
    v_mov_b32 v103, v101
    s_nop 0
    v_permlane16_swap_b32 v102, v100
    v_permlane16_swap_b32 v103, v101
    v_add_f32 v100, v100, v102
    v_add_f32 v101, v101, v103
    v_mov_b32 v102, v100
    v_mov_b32 v103, v101
    s_nop 0
    v_permlane32_swap_b32 v102, v100
    v_permlane32_swap_b32 v103, v101
    v_add_f32 v100, v100, v102
    v_add_f32 v101, v101, v103
    v_and_b32 v14, 7, v0
    v_lshlrev_b32 v11, 4, v14
    v_add_u32 v11, 14080, v11
    s_lshl_b32 s3, s51, 2
    v_add_u32 v10, s3, v11
    ds_write_b32 v10, v100 offset:384
    ds_write_b32 v10, v101 offset:512
    v_lshl_add_u32 v1, v14, 4, v1
    v_lshl_add_u32 v2, v14, 4, v2
    v_add_u32 v1, 90112, v1
    v_add_u32 v2, 90112, v2
    s_and_b32 s3, s51, 1
    s_mul_i32 s3, s3, 288
    v_add_u32 v14, s3, v0
    v_lshlrev_b32 v9, 4, v14
    s_lshr_b32 s14, s51, 1
    s_mul_i32 s14, s14, 9344
    s_add_u32 s14, s14, 90112
    v_add_u32 v15, 0, v14
    v_mul_u32_u24 v12, 911, v15
    v_lshrrev_b32 v12, 16, v12
    v_add_u32 v15, v15, v12
    v_lshl_add_u32 v107, v15, 4, s14
    v_add_u32 v15, 64, v14
    v_mul_u32_u24 v12, 911, v15
    v_lshrrev_b32 v12, 16, v12
    v_add_u32 v15, v15, v12
    v_lshl_add_u32 v108, v15, 4, s14
    v_add_u32 v15, 128, v14
    v_mul_u32_u24 v12, 911, v15
    v_lshrrev_b32 v12, 16, v12
    v_add_u32 v15, v15, v12
    v_lshl_add_u32 v109, v15, 4, s14
    v_add_u32 v15, 192, v14
    v_mul_u32_u24 v12, 911, v15
    v_lshrrev_b32 v12, 16, v12
    v_add_u32 v15, v15, v12
    v_lshl_add_u32 v110, v15, 4, s14
    v_add_u32 v15, 256, v14
    v_mul_u32_u24 v12, 911, v15
    v_lshrrev_b32 v12, 16, v12
    v_add_u32 v15, v15, v12
    v_lshl_add_u32 v111, v15, 4, s14
    s_mul_i32 s3, s96, 9216
    s_add_u32 s14, s3, 4194304
    s_cmp_lt_u32 s51, 2
    s_cselect_b32 s3, s3, s14
    s_cselect_b64 s[24:25], s[80:81], s[84:85]
    s_add_u32 s24, s24, s3
    s_addc_u32 s25, s25, 0
    s_mov_b32 s26, 9216
    s_mov_b32 s27, 0x20000
    s_waitcnt vmcnt(7)
    s_mov_b32 s45, 36864
    buffer_load_dwordx4 v[160:163], v5, s[88:91], s45 offen offset:0 sc1
    ds_write_b128 v106, a[144:147] offset:40960
    v_lshlrev_b32 v32, 16, v112
    v_and_b32 v33, 0xffff0000, v112
    v_lshlrev_b32 v34, 16, v113
    v_and_b32 v35, 0xffff0000, v113
    v_lshlrev_b32 v36, 16, v114
    v_and_b32 v37, 0xffff0000, v114
    v_lshlrev_b32 v38, 16, v115
    v_and_b32 v39, 0xffff0000, v115
    s_waitcnt vmcnt(7)
    buffer_load_dwordx4 v[164:167], v5, s[88:91], s45 offen offset:1024 sc1
    ds_write_b128 v106, a[148:151] offset:41984
    v_lshlrev_b32 v12, 16, v116
    v_and_b32 v13, 0xffff0000, v116
    v_pk_add_f32 v[32:33], v[32:33], v[12:13]
    v_lshlrev_b32 v14, 16, v117
    v_and_b32 v15, 0xffff0000, v117
    v_pk_add_f32 v[34:35], v[34:35], v[14:15]
    v_lshlrev_b32 v12, 16, v118
    v_and_b32 v13, 0xffff0000, v118
    v_pk_add_f32 v[36:37], v[36:37], v[12:13]
    v_lshlrev_b32 v14, 16, v119
    v_and_b32 v15, 0xffff0000, v119
    v_pk_add_f32 v[38:39], v[38:39], v[14:15]
    s_waitcnt vmcnt(7)
    s_mov_b32 s45, 46080
    buffer_load_dwordx4 v[168:171], v5, s[88:91], s45 offen offset:0 sc1
    ds_write_b128 v106, a[152:155] offset:43008
    v_lshlrev_b32 v12, 16, v120
    v_and_b32 v13, 0xffff0000, v120
    v_pk_add_f32 v[32:33], v[32:33], v[12:13]
    v_lshlrev_b32 v14, 16, v121
    v_and_b32 v15, 0xffff0000, v121
    v_pk_add_f32 v[34:35], v[34:35], v[14:15]
    v_lshlrev_b32 v12, 16, v122
    v_and_b32 v13, 0xffff0000, v122
    v_pk_add_f32 v[36:37], v[36:37], v[12:13]
    v_lshlrev_b32 v14, 16, v123
    v_and_b32 v15, 0xffff0000, v123
    v_pk_add_f32 v[38:39], v[38:39], v[14:15]
    s_waitcnt vmcnt(7)
    buffer_load_dwordx4 v[172:175], v5, s[88:91], s45 offen offset:1024 sc1
    ds_write_b128 v106, a[156:159] offset:44032
    v_lshlrev_b32 v12, 16, v124
    v_and_b32 v13, 0xffff0000, v124
    v_pk_add_f32 v[32:33], v[32:33], v[12:13]
    v_lshlrev_b32 v14, 16, v125
    v_and_b32 v15, 0xffff0000, v125
    v_pk_add_f32 v[34:35], v[34:35], v[14:15]
    v_lshlrev_b32 v12, 16, v126
    v_and_b32 v13, 0xffff0000, v126
    v_pk_add_f32 v[36:37], v[36:37], v[12:13]
    v_lshlrev_b32 v14, 16, v127
    v_and_b32 v15, 0xffff0000, v127
    v_pk_add_f32 v[38:39], v[38:39], v[14:15]
    v_mov_b32 v112, v32
    v_mov_b32 v113, v33
    v_mov_b32 v114, v34
    v_mov_b32 v115, v35
    v_mov_b32 v116, v36
    v_mov_b32 v117, v37
    v_mov_b32 v118, v38
    v_mov_b32 v119, v39
    v_permlane16_swap_b32 v112, v32
    v_permlane16_swap_b32 v113, v33
    v_permlane16_swap_b32 v114, v34
    v_permlane16_swap_b32 v115, v35
    v_permlane16_swap_b32 v116, v36
    v_permlane16_swap_b32 v117, v37
    v_permlane16_swap_b32 v118, v38
    v_permlane16_swap_b32 v119, v39
    v_add_f32 v32, v32, v112
    v_add_f32 v33, v33, v113
    v_add_f32 v34, v34, v114
    v_add_f32 v35, v35, v115
    v_add_f32 v36, v36, v116
    v_add_f32 v37, v37, v117
    v_add_f32 v38, v38, v118
    v_add_f32 v39, v39, v119
    v_mov_b32 v112, v32
    v_mov_b32 v113, v33
    v_mov_b32 v114, v34
    v_mov_b32 v115, v35
    v_mov_b32 v116, v36
    v_mov_b32 v117, v37
    v_mov_b32 v118, v38
    v_mov_b32 v119, v39
    v_permlane32_swap_b32 v112, v32
    v_permlane32_swap_b32 v113, v33
    v_permlane32_swap_b32 v114, v34
    v_permlane32_swap_b32 v115, v35
    v_permlane32_swap_b32 v116, v36
    v_permlane32_swap_b32 v117, v37
    v_permlane32_swap_b32 v118, v38
    v_permlane32_swap_b32 v119, v39
    v_add_f32 v32, v32, v112
    v_add_f32 v33, v33, v113
    v_add_f32 v34, v34, v114
    v_add_f32 v35, v35, v115
    v_add_f32 v36, v36, v116
    v_add_f32 v37, v37, v117
    v_add_f32 v38, v38, v118
    v_add_f32 v39, v39, v119
    s_waitcnt vmcnt(7)
    s_mov_b32 s45, 55296
    buffer_load_dwordx4 v[176:179], v5, s[88:91], s45 offen offset:0 sc1
    ds_write_b128 v106, a[160:163] offset:45056
    v_lshlrev_b32 v16, 16, v128
    v_and_b32 v17, 0xffff0000, v128
    v_lshlrev_b32 v18, 16, v129
    v_and_b32 v19, 0xffff0000, v129
    v_lshlrev_b32 v20, 16, v130
    v_and_b32 v21, 0xffff0000, v130
    v_lshlrev_b32 v22, 16, v131
    v_and_b32 v23, 0xffff0000, v131
    s_waitcnt vmcnt(7)
    buffer_load_dwordx4 v[180:183], v5, s[88:91], s45 offen offset:1024 sc1
    ds_write_b128 v105, a[164:167] offset:0
    v_lshlrev_b32 v24, 16, v132
    v_and_b32 v25, 0xffff0000, v132
    v_lshlrev_b32 v26, 16, v133
    v_and_b32 v27, 0xffff0000, v133
    v_lshlrev_b32 v28, 16, v134
    v_and_b32 v29, 0xffff0000, v134
    v_lshlrev_b32 v30, 16, v135
    v_and_b32 v31, 0xffff0000, v135
    s_waitcnt vmcnt(7)
    s_mov_b32 s45, 64512
    buffer_load_dwordx4 v[184:187], v5, s[88:91], s45 offen offset:0 sc1
    ds_write_b128 v105, a[168:171] offset:1024
    v_lshlrev_b32 v12, 16, v136
    v_and_b32 v13, 0xffff0000, v136
    v_pk_add_f32 v[16:17], v[16:17], v[12:13]
    v_lshlrev_b32 v14, 16, v137
    v_and_b32 v15, 0xffff0000, v137
    v_pk_add_f32 v[18:19], v[18:19], v[14:15]
    v_lshlrev_b32 v12, 16, v138
    v_and_b32 v13, 0xffff0000, v138
    v_pk_add_f32 v[20:21], v[20:21], v[12:13]
    v_lshlrev_b32 v14, 16, v139
    v_and_b32 v15, 0xffff0000, v139
    v_pk_add_f32 v[22:23], v[22:23], v[14:15]
    s_waitcnt vmcnt(7)
    buffer_load_dwordx4 v[188:191], v5, s[88:91], s45 offen offset:1024 sc1
    ds_write_b128 v105, a[172:175] offset:2048
    v_lshlrev_b32 v12, 16, v140
    v_and_b32 v13, 0xffff0000, v140
    v_pk_add_f32 v[24:25], v[24:25], v[12:13]
    v_lshlrev_b32 v14, 16, v141
    v_and_b32 v15, 0xffff0000, v141
    v_pk_add_f32 v[26:27], v[26:27], v[14:15]
    v_lshlrev_b32 v12, 16, v142
    v_and_b32 v13, 0xffff0000, v142
    v_pk_add_f32 v[28:29], v[28:29], v[12:13]
    v_lshlrev_b32 v14, 16, v143
    v_and_b32 v15, 0xffff0000, v143
    v_pk_add_f32 v[30:31], v[30:31], v[14:15]
    s_waitcnt vmcnt(7)
    s_mov_b32 s45, 73728
    buffer_load_dwordx4 v[192:195], v5, s[88:91], s45 offen offset:0 sc1
    ds_write_b128 v105, a[176:179] offset:3072
    v_lshlrev_b32 v12, 16, v144
    v_and_b32 v13, 0xffff0000, v144
    v_pk_add_f32 v[16:17], v[16:17], v[12:13]
    v_lshlrev_b32 v14, 16, v145
    v_and_b32 v15, 0xffff0000, v145
    v_pk_add_f32 v[18:19], v[18:19], v[14:15]
    v_lshlrev_b32 v12, 16, v146
    v_and_b32 v13, 0xffff0000, v146
    v_pk_add_f32 v[20:21], v[20:21], v[12:13]
    v_lshlrev_b32 v14, 16, v147
    v_and_b32 v15, 0xffff0000, v147
    v_pk_add_f32 v[22:23], v[22:23], v[14:15]
    s_waitcnt vmcnt(7)
    buffer_load_dwordx4 v[196:199], v5, s[88:91], s45 offen offset:1024 sc1
    ds_write_b128 v105, a[180:183] offset:4096
    v_lshlrev_b32 v12, 16, v148
    v_and_b32 v13, 0xffff0000, v148
    v_pk_add_f32 v[24:25], v[24:25], v[12:13]
    v_lshlrev_b32 v14, 16, v149
    v_and_b32 v15, 0xffff0000, v149
    v_pk_add_f32 v[26:27], v[26:27], v[14:15]
    v_lshlrev_b32 v12, 16, v150
    v_and_b32 v13, 0xffff0000, v150
    v_pk_add_f32 v[28:29], v[28:29], v[12:13]
    v_lshlrev_b32 v14, 16, v151
    v_and_b32 v15, 0xffff0000, v151
    v_pk_add_f32 v[30:31], v[30:31], v[14:15]
    s_waitcnt vmcnt(7)
    s_mov_b32 s45, 82944
    buffer_load_dwordx4 v[200:203], v5, s[88:91], s45 offen offset:0 sc1
    ds_write_b128 v105, a[184:187] offset:5120
    v_lshlrev_b32 v12, 16, v152
    v_and_b32 v13, 0xffff0000, v152
    v_pk_add_f32 v[16:17], v[16:17], v[12:13]
    v_lshlrev_b32 v14, 16, v153
    v_and_b32 v15, 0xffff0000, v153
    v_pk_add_f32 v[18:19], v[18:19], v[14:15]
    v_lshlrev_b32 v12, 16, v154
    v_and_b32 v13, 0xffff0000, v154
    v_pk_add_f32 v[20:21], v[20:21], v[12:13]
    v_lshlrev_b32 v14, 16, v155
    v_and_b32 v15, 0xffff0000, v155
    v_pk_add_f32 v[22:23], v[22:23], v[14:15]
    s_waitcnt vmcnt(7)
    buffer_load_dwordx4 v[204:207], v5, s[88:91], s45 offen offset:1024 sc1
    ds_write_b128 v105, a[188:191] offset:6144
    v_lshlrev_b32 v12, 16, v156
    v_and_b32 v13, 0xffff0000, v156
    v_pk_add_f32 v[24:25], v[24:25], v[12:13]
    v_lshlrev_b32 v14, 16, v157
    v_and_b32 v15, 0xffff0000, v157
    v_pk_add_f32 v[26:27], v[26:27], v[14:15]
    v_lshlrev_b32 v12, 16, v158
    v_and_b32 v13, 0xffff0000, v158
    v_pk_add_f32 v[28:29], v[28:29], v[12:13]
    v_lshlrev_b32 v14, 16, v159
    v_and_b32 v15, 0xffff0000, v159
    v_pk_add_f32 v[30:31], v[30:31], v[14:15]
    s_waitcnt vmcnt(7)
    s_mov_b32 s45, 92160
    buffer_load_dwordx4 v[208:211], v5, s[88:91], s45 offen offset:0 sc1
    ds_write_b128 v105, a[192:195] offset:7168
    v_lshlrev_b32 v12, 16, v160
    v_and_b32 v13, 0xffff0000, v160
    v_pk_add_f32 v[16:17], v[16:17], v[12:13]
    v_lshlrev_b32 v14, 16, v161
    v_and_b32 v15, 0xffff0000, v161
    v_pk_add_f32 v[18:19], v[18:19], v[14:15]
    v_lshlrev_b32 v12, 16, v162
    v_and_b32 v13, 0xffff0000, v162
    v_pk_add_f32 v[20:21], v[20:21], v[12:13]
    v_lshlrev_b32 v14, 16, v163
    v_and_b32 v15, 0xffff0000, v163
    v_pk_add_f32 v[22:23], v[22:23], v[14:15]
    s_waitcnt vmcnt(7)
    buffer_load_dwordx4 v[212:215], v5, s[88:91], s45 offen offset:1024 sc1
    ds_write_b128 v105, a[196:199] offset:8192
    v_lshlrev_b32 v12, 16, v164
    v_and_b32 v13, 0xffff0000, v164
    v_pk_add_f32 v[24:25], v[24:25], v[12:13]
    v_lshlrev_b32 v14, 16, v165
    v_and_b32 v15, 0xffff0000, v165
    v_pk_add_f32 v[26:27], v[26:27], v[14:15]
    v_lshlrev_b32 v12, 16, v166
    v_and_b32 v13, 0xffff0000, v166
    v_pk_add_f32 v[28:29], v[28:29], v[12:13]
    v_lshlrev_b32 v14, 16, v167
    v_and_b32 v15, 0xffff0000, v167
    v_pk_add_f32 v[30:31], v[30:31], v[14:15]
    s_waitcnt vmcnt(7)
    s_mov_b32 s45, 101376
    buffer_load_dwordx4 v[216:219], v5, s[88:91], s45 offen offset:0 sc1
    ds_write_b128 v105, a[200:203] offset:36864
    v_lshlrev_b32 v12, 16, v168
    v_and_b32 v13, 0xffff0000, v168
    v_pk_add_f32 v[16:17], v[16:17], v[12:13]
    v_lshlrev_b32 v14, 16, v169
    v_and_b32 v15, 0xffff0000, v169
    v_pk_add_f32 v[18:19], v[18:19], v[14:15]
    v_lshlrev_b32 v12, 16, v170
    v_and_b32 v13, 0xffff0000, v170
    v_pk_add_f32 v[20:21], v[20:21], v[12:13]
    v_lshlrev_b32 v14, 16, v171
    v_and_b32 v15, 0xffff0000, v171
    v_pk_add_f32 v[22:23], v[22:23], v[14:15]
    s_waitcnt vmcnt(7)
    buffer_load_dwordx4 v[220:223], v5, s[88:91], s45 offen offset:1024 sc1
    ds_write_b128 v105, a[204:207] offset:37888
    v_lshlrev_b32 v12, 16, v172
    v_and_b32 v13, 0xffff0000, v172
    v_pk_add_f32 v[24:25], v[24:25], v[12:13]
    v_lshlrev_b32 v14, 16, v173
    v_and_b32 v15, 0xffff0000, v173
    v_pk_add_f32 v[26:27], v[26:27], v[14:15]
    v_lshlrev_b32 v12, 16, v174
    v_and_b32 v13, 0xffff0000, v174
    v_pk_add_f32 v[28:29], v[28:29], v[12:13]
    v_lshlrev_b32 v14, 16, v175
    v_and_b32 v15, 0xffff0000, v175
    v_pk_add_f32 v[30:31], v[30:31], v[14:15]
    s_waitcnt vmcnt(7)
    s_mov_b32 s45, 110592
    buffer_load_dwordx4 v[224:227], v5, s[88:91], s45 offen offset:0 sc1
    ds_write_b128 v105, a[208:211] offset:38912
    v_lshlrev_b32 v12, 16, v176
    v_and_b32 v13, 0xffff0000, v176
    v_pk_add_f32 v[16:17], v[16:17], v[12:13]
    v_lshlrev_b32 v14, 16, v177
    v_and_b32 v15, 0xffff0000, v177
    v_pk_add_f32 v[18:19], v[18:19], v[14:15]
    v_lshlrev_b32 v12, 16, v178
    v_and_b32 v13, 0xffff0000, v178
    v_pk_add_f32 v[20:21], v[20:21], v[12:13]
    v_lshlrev_b32 v14, 16, v179
    v_and_b32 v15, 0xffff0000, v179
    v_pk_add_f32 v[22:23], v[22:23], v[14:15]
    s_waitcnt vmcnt(7)
    buffer_load_dwordx4 v[228:231], v5, s[88:91], s45 offen offset:1024 sc1
    ds_write_b128 v105, a[212:215] offset:39936
    v_lshlrev_b32 v12, 16, v180
    v_and_b32 v13, 0xffff0000, v180
    v_pk_add_f32 v[24:25], v[24:25], v[12:13]
    v_lshlrev_b32 v14, 16, v181
    v_and_b32 v15, 0xffff0000, v181
    v_pk_add_f32 v[26:27], v[26:27], v[14:15]
    v_lshlrev_b32 v12, 16, v182
    v_and_b32 v13, 0xffff0000, v182
    v_pk_add_f32 v[28:29], v[28:29], v[12:13]
    v_lshlrev_b32 v14, 16, v183
    v_and_b32 v15, 0xffff0000, v183
    v_pk_add_f32 v[30:31], v[30:31], v[14:15]
    s_waitcnt vmcnt(7)
    s_mov_b32 s45, 119808
    buffer_load_dwordx4 v[232:235], v5, s[88:91], s45 offen offset:0 sc1
    ds_write_b128 v105, a[216:219] offset:40960
    v_lshlrev_b32 v12, 16, v184
    v_and_b32 v13, 0xffff0000, v184
    v_pk_add_f32 v[16:17], v[16:17], v[12:13]
    v_lshlrev_b32 v14, 16, v185
    v_and_b32 v15, 0xffff0000, v185
    v_pk_add_f32 v[18:19], v[18:19], v[14:15]
    v_lshlrev_b32 v12, 16, v186
    v_and_b32 v13, 0xffff0000, v186
    v_pk_add_f32 v[20:21], v[20:21], v[12:13]
    v_lshlrev_b32 v14, 16, v187
    v_and_b32 v15, 0xffff0000, v187
    v_pk_add_f32 v[22:23], v[22:23], v[14:15]
    s_waitcnt vmcnt(7)
    buffer_load_dwordx4 v[236:239], v5, s[88:91], s45 offen offset:1024 sc1
    ds_write_b128 v105, a[220:223] offset:41984
    v_lshlrev_b32 v12, 16, v188
    v_and_b32 v13, 0xffff0000, v188
    v_pk_add_f32 v[24:25], v[24:25], v[12:13]
    v_lshlrev_b32 v14, 16, v189
    v_and_b32 v15, 0xffff0000, v189
    v_pk_add_f32 v[26:27], v[26:27], v[14:15]
    v_lshlrev_b32 v12, 16, v190
    v_and_b32 v13, 0xffff0000, v190
    v_pk_add_f32 v[28:29], v[28:29], v[12:13]
    v_lshlrev_b32 v14, 16, v191
    v_and_b32 v15, 0xffff0000, v191
    v_pk_add_f32 v[30:31], v[30:31], v[14:15]
    s_waitcnt vmcnt(7)
    s_mov_b32 s45, 129024
    buffer_load_dwordx4 v[240:243], v5, s[88:91], s45 offen offset:0 sc1
    ds_write_b128 v105, a[224:227] offset:43008
    v_lshlrev_b32 v12, 16, v192
    v_and_b32 v13, 0xffff0000, v192
    v_pk_add_f32 v[16:17], v[16:17], v[12:13]
    v_lshlrev_b32 v14, 16, v193
    v_and_b32 v15, 0xffff0000, v193
    v_pk_add_f32 v[18:19], v[18:19], v[14:15]
    v_lshlrev_b32 v12, 16, v194
    v_and_b32 v13, 0xffff0000, v194
    v_pk_add_f32 v[20:21], v[20:21], v[12:13]
    v_lshlrev_b32 v14, 16, v195
    v_and_b32 v15, 0xffff0000, v195
    v_pk_add_f32 v[22:23], v[22:23], v[14:15]
    s_waitcnt vmcnt(7)
    buffer_load_dwordx4 v[244:247], v5, s[88:91], s45 offen offset:1024 sc1
    ds_write_b128 v105, a[228:231] offset:44032
    v_lshlrev_b32 v12, 16, v196
    v_and_b32 v13, 0xffff0000, v196
    v_pk_add_f32 v[24:25], v[24:25], v[12:13]
    v_lshlrev_b32 v14, 16, v197
    v_and_b32 v15, 0xffff0000, v197
    v_pk_add_f32 v[26:27], v[26:27], v[14:15]
    v_lshlrev_b32 v12, 16, v198
    v_and_b32 v13, 0xffff0000, v198
    v_pk_add_f32 v[28:29], v[28:29], v[12:13]
    v_lshlrev_b32 v14, 16, v199
    v_and_b32 v15, 0xffff0000, v199
    v_pk_add_f32 v[30:31], v[30:31], v[14:15]
    ds_read_b128 v[112:115], v3 offset:4608
    ds_read_b128 v[116:119], v3 offset:4624
    ds_read_b128 v[120:123], v3 offset:4864
    ds_read_b128 v[124:127], v3 offset:4880
    ds_read_b128 v[128:131], v4 offset:5120
    ds_read_b128 v[132:135], v4 offset:5136
    ds_read_b128 v[136:139], v3 offset:2304
    ds_read_b128 v[140:143], v3 offset:2320
    ds_read_b128 v[144:147], v3 offset:2560
    ds_read_b128 v[148:151], v3 offset:2576
    ds_read_b128 v[152:155], v4 offset:2816
    ds_read_b128 v[156:159], v4 offset:2832
    ds_read_b128 v[160:163], v3 offset:6912
    ds_read_b128 v[164:167], v3 offset:6928
    ds_read_b128 v[168:171], v3 offset:7168
    ds_read_b128 v[172:175], v3 offset:7184
    ds_read_b128 v[176:179], v4 offset:7424
    ds_read_b128 v[180:183], v4 offset:7440
    s_waitcnt vmcnt(7)
    s_mov_b32 s45, 138240
    buffer_load_dwordx4 v[248:251], v5, s[88:91], s45 offen offset:0 sc1
    ds_write_b128 v105, a[232:235] offset:45056
    v_lshlrev_b32 v12, 16, v200
    v_and_b32 v13, 0xffff0000, v200
    v_pk_add_f32 v[16:17], v[16:17], v[12:13]
    v_lshlrev_b32 v14, 16, v201
    v_and_b32 v15, 0xffff0000, v201
    v_pk_add_f32 v[18:19], v[18:19], v[14:15]
    v_lshlrev_b32 v12, 16, v202
    v_and_b32 v13, 0xffff0000, v202
    v_pk_add_f32 v[20:21], v[20:21], v[12:13]
    v_lshlrev_b32 v14, 16, v203
    v_and_b32 v15, 0xffff0000, v203
    v_pk_add_f32 v[22:23], v[22:23], v[14:15]
    s_waitcnt vmcnt(7)
    buffer_load_dwordx4 v[252:255], v5, s[88:91], s45 offen offset:1024 sc1
    v_lshlrev_b32 v12, 16, v204
    v_and_b32 v13, 0xffff0000, v204
    v_pk_add_f32 v[24:25], v[24:25], v[12:13]
    v_lshlrev_b32 v14, 16, v205
    v_and_b32 v15, 0xffff0000, v205
    v_pk_add_f32 v[26:27], v[26:27], v[14:15]
    v_lshlrev_b32 v12, 16, v206
    v_and_b32 v13, 0xffff0000, v206
    v_pk_add_f32 v[28:29], v[28:29], v[12:13]
    v_lshlrev_b32 v14, 16, v207
    v_and_b32 v15, 0xffff0000, v207
    v_pk_add_f32 v[30:31], v[30:31], v[14:15]
    v_lshlrev_b32 v12, 16, v208
    v_and_b32 v13, 0xffff0000, v208
    v_pk_add_f32 v[16:17], v[16:17], v[12:13]
    v_lshlrev_b32 v14, 16, v209
    v_and_b32 v15, 0xffff0000, v209
    v_pk_add_f32 v[18:19], v[18:19], v[14:15]
    v_lshlrev_b32 v12, 16, v210
    v_and_b32 v13, 0xffff0000, v210
    v_pk_add_f32 v[20:21], v[20:21], v[12:13]
    v_lshlrev_b32 v14, 16, v211
    v_and_b32 v15, 0xffff0000, v211
    v_pk_add_f32 v[22:23], v[22:23], v[14:15]
    v_lshlrev_b32 v12, 16, v212
    v_and_b32 v13, 0xffff0000, v212
    v_pk_add_f32 v[24:25], v[24:25], v[12:13]
    v_lshlrev_b32 v14, 16, v213
    v_and_b32 v15, 0xffff0000, v213
    v_pk_add_f32 v[26:27], v[26:27], v[14:15]
    v_lshlrev_b32 v12, 16, v214
    v_and_b32 v13, 0xffff0000, v214
    v_pk_add_f32 v[28:29], v[28:29], v[12:13]
    v_lshlrev_b32 v14, 16, v215
    v_and_b32 v15, 0xffff0000, v215
    v_pk_add_f32 v[30:31], v[30:31], v[14:15]
    v_lshlrev_b32 v12, 16, v216
    v_and_b32 v13, 0xffff0000, v216
    v_pk_add_f32 v[16:17], v[16:17], v[12:13]
    v_lshlrev_b32 v14, 16, v217
    v_and_b32 v15, 0xffff0000, v217
    v_pk_add_f32 v[18:19], v[18:19], v[14:15]
    v_lshlrev_b32 v12, 16, v218
    v_and_b32 v13, 0xffff0000, v218
    v_pk_add_f32 v[20:21], v[20:21], v[12:13]
    v_lshlrev_b32 v14, 16, v219
    v_and_b32 v15, 0xffff0000, v219
    v_pk_add_f32 v[22:23], v[22:23], v[14:15]
    v_lshlrev_b32 v12, 16, v220
    v_and_b32 v13, 0xffff0000, v220
    v_pk_add_f32 v[24:25], v[24:25], v[12:13]
    v_lshlrev_b32 v14, 16, v221
    v_and_b32 v15, 0xffff0000, v221
    v_pk_add_f32 v[26:27], v[26:27], v[14:15]
    v_lshlrev_b32 v12, 16, v222
    v_and_b32 v13, 0xffff0000, v222
    v_pk_add_f32 v[28:29], v[28:29], v[12:13]
    v_lshlrev_b32 v14, 16, v223
    v_and_b32 v15, 0xffff0000, v223
    v_pk_add_f32 v[30:31], v[30:31], v[14:15]
    s_waitcnt vmcnt(7)
    v_lshlrev_b32 v12, 16, v224
    v_and_b32 v13, 0xffff0000, v224
    v_pk_add_f32 v[16:17], v[16:17], v[12:13]
    v_lshlrev_b32 v14, 16, v225
    v_and_b32 v15, 0xffff0000, v225
    v_pk_add_f32 v[18:19], v[18:19], v[14:15]
    v_lshlrev_b32 v12, 16, v226
    v_and_b32 v13, 0xffff0000, v226
    v_pk_add_f32 v[20:21], v[20:21], v[12:13]
    v_lshlrev_b32 v14, 16, v227
    v_and_b32 v15, 0xffff0000, v227
    v_pk_add_f32 v[22:23], v[22:23], v[14:15]
    s_waitcnt vmcnt(6)
    v_lshlrev_b32 v12, 16, v228
    v_and_b32 v13, 0xffff0000, v228
    v_pk_add_f32 v[24:25], v[24:25], v[12:13]
    v_lshlrev_b32 v14, 16, v229
    v_and_b32 v15, 0xffff0000, v229
    v_pk_add_f32 v[26:27], v[26:27], v[14:15]
    v_lshlrev_b32 v12, 16, v230
    v_and_b32 v13, 0xffff0000, v230
    v_pk_add_f32 v[28:29], v[28:29], v[12:13]
    v_lshlrev_b32 v14, 16, v231
    v_and_b32 v15, 0xffff0000, v231
    v_pk_add_f32 v[30:31], v[30:31], v[14:15]
    s_waitcnt vmcnt(5)
    v_lshlrev_b32 v12, 16, v232
    v_and_b32 v13, 0xffff0000, v232
    v_pk_add_f32 v[16:17], v[16:17], v[12:13]
    v_lshlrev_b32 v14, 16, v233
    v_and_b32 v15, 0xffff0000, v233
    v_pk_add_f32 v[18:19], v[18:19], v[14:15]
    v_lshlrev_b32 v12, 16, v234
    v_and_b32 v13, 0xffff0000, v234
    v_pk_add_f32 v[20:21], v[20:21], v[12:13]
    v_lshlrev_b32 v14, 16, v235
    v_and_b32 v15, 0xffff0000, v235
    v_pk_add_f32 v[22:23], v[22:23], v[14:15]
    s_waitcnt vmcnt(4)
    v_lshlrev_b32 v12, 16, v236
    v_and_b32 v13, 0xffff0000, v236
    v_pk_add_f32 v[24:25], v[24:25], v[12:13]
    v_lshlrev_b32 v14, 16, v237
    v_and_b32 v15, 0xffff0000, v237
    v_pk_add_f32 v[26:27], v[26:27], v[14:15]
    v_lshlrev_b32 v12, 16, v238
    v_and_b32 v13, 0xffff0000, v238
    v_pk_add_f32 v[28:29], v[28:29], v[12:13]
    v_lshlrev_b32 v14, 16, v239
    v_and_b32 v15, 0xffff0000, v239
    v_pk_add_f32 v[30:31], v[30:31], v[14:15]
    s_waitcnt vmcnt(3)
    v_lshlrev_b32 v12, 16, v240
    v_and_b32 v13, 0xffff0000, v240
    v_pk_add_f32 v[16:17], v[16:17], v[12:13]
    v_lshlrev_b32 v14, 16, v241
    v_and_b32 v15, 0xffff0000, v241
    v_pk_add_f32 v[18:19], v[18:19], v[14:15]
    v_lshlrev_b32 v12, 16, v242
    v_and_b32 v13, 0xffff0000, v242
    v_pk_add_f32 v[20:21], v[20:21], v[12:13]
    v_lshlrev_b32 v14, 16, v243
    v_and_b32 v15, 0xffff0000, v243
    v_pk_add_f32 v[22:23], v[22:23], v[14:15]
    s_waitcnt vmcnt(2)
    v_lshlrev_b32 v12, 16, v244
    v_and_b32 v13, 0xffff0000, v244
    v_pk_add_f32 v[24:25], v[24:25], v[12:13]
    v_lshlrev_b32 v14, 16, v245
    v_and_b32 v15, 0xffff0000, v245
    v_pk_add_f32 v[26:27], v[26:27], v[14:15]
    v_lshlrev_b32 v12, 16, v246
    v_and_b32 v13, 0xffff0000, v246
    v_pk_add_f32 v[28:29], v[28:29], v[12:13]
    v_lshlrev_b32 v14, 16, v247
    v_and_b32 v15, 0xffff0000, v247
    v_pk_add_f32 v[30:31], v[30:31], v[14:15]
    s_waitcnt vmcnt(1)
    v_lshlrev_b32 v12, 16, v248
    v_and_b32 v13, 0xffff0000, v248
    v_pk_add_f32 v[16:17], v[16:17], v[12:13]
    v_lshlrev_b32 v14, 16, v249
    v_and_b32 v15, 0xffff0000, v249
    v_pk_add_f32 v[18:19], v[18:19], v[14:15]
    v_lshlrev_b32 v12, 16, v250
    v_and_b32 v13, 0xffff0000, v250
    v_pk_add_f32 v[20:21], v[20:21], v[12:13]
    v_lshlrev_b32 v14, 16, v251
    v_and_b32 v15, 0xffff0000, v251
    v_pk_add_f32 v[22:23], v[22:23], v[14:15]
    s_waitcnt vmcnt(0)
    v_lshlrev_b32 v12, 16, v252
    v_and_b32 v13, 0xffff0000, v252
    v_pk_add_f32 v[24:25], v[24:25], v[12:13]
    v_lshlrev_b32 v14, 16, v253
    v_and_b32 v15, 0xffff0000, v253
    v_pk_add_f32 v[26:27], v[26:27], v[14:15]
    v_lshlrev_b32 v12, 16, v254
    v_and_b32 v13, 0xffff0000, v254
    v_pk_add_f32 v[28:29], v[28:29], v[12:13]
    v_lshlrev_b32 v14, 16, v255
    v_and_b32 v15, 0xffff0000, v255
    v_pk_add_f32 v[30:31], v[30:31], v[14:15]
    s_waitcnt lgkmcnt(15)
    v_lshlrev_b32 v12, 16, v64
    v_and_b32 v13, 0xffff0000, v64
    v_pk_fma_f32 v[16:17], v[16:17], v[40:41], v[12:13]
    v_lshlrev_b32 v12, 16, v65
    v_and_b32 v13, 0xffff0000, v65
    v_pk_fma_f32 v[18:19], v[18:19], v[42:43], v[12:13]
    v_lshlrev_b32 v12, 16, v66
    v_and_b32 v13, 0xffff0000, v66
    v_pk_fma_f32 v[20:21], v[20:21], v[44:45], v[12:13]
    v_lshlrev_b32 v12, 16, v67
    v_and_b32 v13, 0xffff0000, v67
    v_pk_fma_f32 v[22:23], v[22:23], v[46:47], v[12:13]
    v_lshlrev_b32 v12, 16, v68
    v_and_b32 v13, 0xffff0000, v68
    v_pk_fma_f32 v[24:25], v[24:25], v[48:49], v[12:13]
    v_lshlrev_b32 v12, 16, v69
    v_and_b32 v13, 0xffff0000, v69
    v_pk_fma_f32 v[26:27], v[26:27], v[50:51], v[12:13]
    v_lshlrev_b32 v12, 16, v70
    v_and_b32 v13, 0xffff0000, v70
    v_pk_fma_f32 v[28:29], v[28:29], v[52:53], v[12:13]
    v_lshlrev_b32 v12, 16, v71
    v_and_b32 v13, 0xffff0000, v71
    v_pk_fma_f32 v[30:31], v[30:31], v[54:55], v[12:13]
    v_lshlrev_b32 v12, 16, v72
    v_and_b32 v13, 0xffff0000, v72
    v_pk_fma_f32 v[32:33], v[32:33], v[56:57], v[12:13]
    v_lshlrev_b32 v12, 16, v73
    v_and_b32 v13, 0xffff0000, v73
    v_pk_fma_f32 v[34:35], v[34:35], v[58:59], v[12:13]
    v_lshlrev_b32 v12, 16, v74
    v_and_b32 v13, 0xffff0000, v74
    v_pk_fma_f32 v[36:37], v[36:37], v[60:61], v[12:13]
    v_lshlrev_b32 v12, 16, v75
    v_and_b32 v13, 0xffff0000, v75
    v_pk_fma_f32 v[38:39], v[38:39], v[62:63], v[12:13]
    v_add_f32 v100, v16, v17
    v_add_f32 v100, v100, v18
    v_add_f32 v100, v100, v19
    v_add_f32 v100, v100, v20
    v_add_f32 v100, v100, v21
    v_add_f32 v100, v100, v22
    v_add_f32 v100, v100, v23
    v_add_f32 v100, v100, v24
    v_add_f32 v100, v100, v25
    v_add_f32 v100, v100, v26
    v_add_f32 v100, v100, v27
    v_add_f32 v100, v100, v28
    v_add_f32 v100, v100, v29
    v_add_f32 v100, v100, v30
    v_add_f32 v100, v100, v31
    v_add_f32 v103, v32, v33
    v_add_f32 v103, v103, v34
    v_add_f32 v103, v103, v35
    v_add_f32 v103, v103, v36
    v_add_f32 v103, v103, v37
    v_add_f32 v103, v103, v38
    v_add_f32 v103, v103, v39
    v_fmac_f32 v100, 0x3e800000, v103
    s_nop 1
    v_add_f32_dpp v100, v100, v100 row_ror:8 row_mask:0xf bank_mask:0xf
    v_mov_b32 v103, v100
    s_nop 1
    v_permlane16_swap_b32 v103, v100
    v_add_f32 v100, v100, v103
    v_mov_b32 v103, v100
    s_nop 1
    v_permlane32_swap_b32 v103, v100
    v_add_f32 v100, v100, v103
    v_mul_f32 v100, 0x3be38e39, v100
    v_sub_f32 v184, v16, v100
    v_sub_f32 v185, v17, v100
    v_sub_f32 v186, v18, v100
    v_sub_f32 v187, v19, v100
    v_sub_f32 v188, v20, v100
    v_sub_f32 v189, v21, v100
    v_sub_f32 v190, v22, v100
    v_sub_f32 v191, v23, v100
    v_sub_f32 v192, v24, v100
    v_sub_f32 v193, v25, v100
    v_sub_f32 v194, v26, v100
    v_sub_f32 v195, v27, v100
    v_sub_f32 v196, v28, v100
    v_sub_f32 v197, v29, v100
    v_sub_f32 v198, v30, v100
    v_sub_f32 v199, v31, v100
    v_sub_f32 v200, v32, v100
    v_sub_f32 v201, v33, v100
    v_sub_f32 v202, v34, v100
    v_sub_f32 v203, v35, v100
    v_sub_f32 v204, v36, v100
    v_sub_f32 v205, v37, v100
    v_sub_f32 v206, v38, v100
    v_sub_f32 v207, v39, v100
    v_mul_f32 v101, v184, v184
    v_fmac_f32 v101, v185, v185
    v_fmac_f32 v101, v186, v186
    v_fmac_f32 v101, v187, v187
    v_fmac_f32 v101, v188, v188
    v_fmac_f32 v101, v189, v189
    v_fmac_f32 v101, v190, v190
    v_fmac_f32 v101, v191, v191
    v_fmac_f32 v101, v192, v192
    v_fmac_f32 v101, v193, v193
    v_fmac_f32 v101, v194, v194
    v_fmac_f32 v101, v195, v195
    v_fmac_f32 v101, v196, v196
    v_fmac_f32 v101, v197, v197
    v_fmac_f32 v101, v198, v198
    v_fmac_f32 v101, v199, v199
    v_mul_f32 v103, v200, v200
    v_fmac_f32 v103, v201, v201
    v_fmac_f32 v103, v202, v202
    v_fmac_f32 v103, v203, v203
    v_fmac_f32 v103, v204, v204
    v_fmac_f32 v103, v205, v205
    v_fmac_f32 v103, v206, v206
    v_fmac_f32 v103, v207, v207
    v_fmac_f32 v101, 0x3e800000, v103
    v_mul_f32 v102, v184, v76
    v_fmac_f32 v102, v185, v77
    v_fmac_f32 v102, v186, v78
    v_fmac_f32 v102, v187, v79
    v_fmac_f32 v102, v188, v80
    v_fmac_f32 v102, v189, v81
    v_fmac_f32 v102, v190, v82
    v_fmac_f32 v102, v191, v83
    v_fmac_f32 v102, v192, v84
    v_fmac_f32 v102, v193, v85
    v_fmac_f32 v102, v194, v86
    v_fmac_f32 v102, v195, v87
    v_fmac_f32 v102, v196, v88
    v_fmac_f32 v102, v197, v89
    v_fmac_f32 v102, v198, v90
    v_fmac_f32 v102, v199, v91
    v_mul_f32 v103, v200, v92
    v_fmac_f32 v103, v201, v93
    v_fmac_f32 v103, v202, v94
    v_fmac_f32 v103, v203, v95
    v_fmac_f32 v103, v204, v96
    v_fmac_f32 v103, v205, v97
    v_fmac_f32 v103, v206, v98
    v_fmac_f32 v103, v207, v99
    v_fmac_f32 v102, 0x3e800000, v103
    s_nop 1
    v_add_f32_dpp v101, v101, v101 row_ror:8 row_mask:0xf bank_mask:0xf
    v_add_f32_dpp v102, v102, v102 row_ror:8 row_mask:0xf bank_mask:0xf
    v_mov_b32 v103, v101
    v_mov_b32 v104, v102
    s_nop 0
    v_permlane16_swap_b32 v103, v101
    v_permlane16_swap_b32 v104, v102
    v_add_f32 v101, v101, v103
    v_add_f32 v102, v102, v104
    v_mov_b32 v103, v101
    v_mov_b32 v104, v102
    s_nop 0
    v_permlane32_swap_b32 v103, v101
    v_permlane32_swap_b32 v104, v102
    v_add_f32 v101, v101, v103
    v_add_f32 v102, v102, v104
    ds_write_b32 v10, v100 offset:0
    ds_write_b32 v10, v101 offset:128
    ds_write_b32 v10, v102 offset:256
    s_waitcnt lgkmcnt(0)
    s_barrier
    ds_read_b128 v[40:43], v11 offset:0
    ds_read_b128 v[44:47], v11 offset:128
    ds_read_b128 v[48:51], v11 offset:256
    ds_read_b128 v[52:55], v11 offset:384
    ds_read_b128 v[56:59], v11 offset:512
    s_waitcnt lgkmcnt(4)
    v_add_f32 v12, v40, v41
    v_add_f32 v13, v42, v43
    v_add_f32 v12, v12, v13
    v_mul_f32 v12, 0x3e800000, v12
    v_sub_f32 v40, v40, v12
    v_sub_f32 v41, v41, v12
    v_sub_f32 v42, v42, v12
    v_sub_f32 v43, v43, v12
    v_sub_f32 v100, v100, v12
    v_mul_f32 v13, v40, v40
    v_fmac_f32 v13, v41, v41
    v_fmac_f32 v13, v42, v42
    v_fmac_f32 v13, v43, v43
    s_waitcnt lgkmcnt(3)
    v_add_f32 v14, v44, v45
    v_add_f32 v15, v46, v47
    v_add_f32 v14, v14, v15
    v_fmac_f32 v14, 0x43100000, v13
    v_mov_b32 v13, 0x3727c5ac
    v_fmac_f32 v13, 0x3ae38e39, v14
    v_rsq_f32 v13, v13
    s_waitcnt lgkmcnt(0)
    v_mul_f32 v100, v100, v13
    v_fma_f32 v184, v184, v13, v100
    v_fma_f32 v185, v185, v13, v100
    v_fma_f32 v186, v186, v13, v100
    v_fma_f32 v187, v187, v13, v100
    v_fma_f32 v188, v188, v13, v100
    v_fma_f32 v189, v189, v13, v100
    v_fma_f32 v190, v190, v13, v100
    v_fma_f32 v191, v191, v13, v100
    v_fma_f32 v192, v192, v13, v100
    v_fma_f32 v193, v193, v13, v100
    v_fma_f32 v194, v194, v13, v100
    v_fma_f32 v195, v195, v13, v100
    v_fma_f32 v196, v196, v13, v100
    v_fma_f32 v197, v197, v13, v100
    v_fma_f32 v198, v198, v13, v100
    v_fma_f32 v199, v199, v13, v100
    v_fma_f32 v200, v200, v13, v100
    v_fma_f32 v201, v201, v13, v100
    v_fma_f32 v202, v202, v13, v100
    v_fma_f32 v203, v203, v13, v100
    v_fma_f32 v204, v204, v13, v100
    v_fma_f32 v205, v205, v13, v100
    v_fma_f32 v206, v206, v13, v100
    v_fma_f32 v207, v207, v13, v100
    v_pk_fma_f32 v[184:185], v[184:185], v[112:113], v[136:137]
    v_pk_fma_f32 v[186:187], v[186:187], v[114:115], v[138:139]
    v_pk_fma_f32 v[188:189], v[188:189], v[116:117], v[140:141]
    v_pk_fma_f32 v[190:191], v[190:191], v[118:119], v[142:143]
    v_pk_fma_f32 v[192:193], v[192:193], v[120:121], v[144:145]
    v_pk_fma_f32 v[194:195], v[194:195], v[122:123], v[146:147]
    v_pk_fma_f32 v[196:197], v[196:197], v[124:125], v[148:149]
    v_pk_fma_f32 v[198:199], v[198:199], v[126:127], v[150:151]
    v_pk_fma_f32 v[200:201], v[200:201], v[128:129], v[152:153]
    v_pk_fma_f32 v[202:203], v[202:203], v[130:131], v[154:155]
    v_pk_fma_f32 v[204:205], v[204:205], v[132:133], v[156:157]
    v_pk_fma_f32 v[206:207], v[206:207], v[134:135], v[158:159]
    v_pk_fma_f32 v[16:17], v[184:185], v[160:161], v[16:17]
    v_pk_fma_f32 v[18:19], v[186:187], v[162:163], v[18:19]
    v_pk_fma_f32 v[20:21], v[188:189], v[164:165], v[20:21]
    v_pk_fma_f32 v[22:23], v[190:191], v[166:167], v[22:23]
    v_pk_fma_f32 v[24:25], v[192:193], v[168:169], v[24:25]
    v_pk_fma_f32 v[26:27], v[194:195], v[170:171], v[26:27]
    v_pk_fma_f32 v[28:29], v[196:197], v[172:173], v[28:29]
    v_pk_fma_f32 v[30:31], v[198:199], v[174:175], v[30:31]
    v_pk_fma_f32 v[32:33], v[200:201], v[176:177], v[32:33]
    v_pk_fma_f32 v[34:35], v[202:203], v[178:179], v[34:35]
    v_pk_fma_f32 v[36:37], v[204:205], v[180:181], v[36:37]
    v_pk_fma_f32 v[38:39], v[206:207], v[182:183], v[38:39]
    v_cvt_pk_bf16_f32 v112, v16, v17
    v_cvt_pk_bf16_f32 v113, v18, v19
    v_cvt_pk_bf16_f32 v114, v20, v21
    v_cvt_pk_bf16_f32 v115, v22, v23
    ds_write_b128 v1, v[112:115] offset:0
    v_cvt_pk_bf16_f32 v116, v24, v25
    v_cvt_pk_bf16_f32 v117, v26, v27
    v_cvt_pk_bf16_f32 v118, v28, v29
    v_cvt_pk_bf16_f32 v119, v30, v31
    ds_write_b128 v1, v[116:119] offset:128
    v_cvt_pk_bf16_f32 v120, v32, v33
    v_cvt_pk_bf16_f32 v121, v34, v35
    v_cvt_pk_bf16_f32 v122, v36, v37
    v_cvt_pk_bf16_f32 v123, v38, v39
    ds_write_b128 v2, v[120:123] offset:0
    v_cvt_pk_bf16_f32 v124, v184, v185
    v_cvt_pk_bf16_f32 v125, v186, v187
    v_cvt_pk_bf16_f32 v126, v188, v189
    v_cvt_pk_bf16_f32 v127, v190, v191
    ds_write_b128 v1, v[124:127] offset:9344
    v_cvt_pk_bf16_f32 v128, v192, v193
    v_cvt_pk_bf16_f32 v129, v194, v195
    v_cvt_pk_bf16_f32 v130, v196, v197
    v_cvt_pk_bf16_f32 v131, v198, v199
    ds_write_b128 v1, v[128:131] offset:9472
    v_cvt_pk_bf16_f32 v132, v200, v201
    v_cvt_pk_bf16_f32 v133, v202, v203
    v_cvt_pk_bf16_f32 v134, v204, v205
    v_cvt_pk_bf16_f32 v135, v206, v207
    ds_write_b128 v2, v[132:135] offset:9344
    v_fmac_f32 v48, v40, v52
    v_fmac_f32 v49, v41, v53
    v_fmac_f32 v50, v42, v54
    v_fmac_f32 v51, v43, v55
    v_add_f32 v14, v48, v49
    v_add_f32 v15, v50, v51
    v_add_f32 v14, v14, v15
    v_add_f32 v15, v56, v57
    v_add_f32 v12, v58, v59
    v_add_f32 v15, v15, v12
    v_fmac_f32 v15, v14, v13
    s_waitcnt lgkmcnt(0)
    s_barrier
    ds_read_b128 v[160:163], v107
    ds_read_b128 v[164:167], v108
    ds_read_b128 v[168:171], v109
    ds_read_b128 v[172:175], v110
    ds_read_b128 v[176:179], v111
    s_lshl_b32 s3, s96, 3
    s_sub_u32 s3, 0xfff, s3
    v_and_b32 v14, 7, v0
    v_sub_u32 v14, s3, v14
    v_ashrrev_i32 v12, 31, v15
    v_or_b32 v12, 0x80000000, v12
    v_xor_b32 v12, v12, v15
    v_and_b32 v12, 0xfffff000, v12
    v_or_b32 v100, v12, v14
    v_mov_b32 v101, 0
    s_waitcnt lgkmcnt(4)
    buffer_store_dwordx4 v[160:163], v9, s[24:27], 0 offen offset:0 sc1
    s_waitcnt lgkmcnt(3)
    buffer_store_dwordx4 v[164:167], v9, s[24:27], 0 offen offset:1024 sc1
    s_waitcnt lgkmcnt(2)
    buffer_store_dwordx4 v[168:171], v9, s[24:27], 0 offen offset:2048 sc1
    s_waitcnt lgkmcnt(1)
    buffer_store_dwordx4 v[172:175], v9, s[24:27], 0 offen offset:3072 sc1
    s_waitcnt lgkmcnt(0)
    s_mov_b32 exec_hi, 0
    s_mov_b32 s3, 4096
    buffer_store_dwordx4 v[176:179], v9, s[24:27], s3 offen offset:0 sc1
    s_mov_b64 exec, -1
    s_nop 1
    v_mov_b32_dpp v12, v100 row_ror:1 row_mask:0xf bank_mask:0xf
    v_mov_b32_dpp v13, v101 row_ror:1 row_mask:0xf bank_mask:0xf
    v_max_u32 v101, v101, v13
    v_med3_u32 v101, v100, v12, v101
    v_max_u32 v100, v100, v12
    s_nop 1
    v_mov_b32_dpp v12, v100 row_ror:2 row_mask:0xf bank_mask:0xf
    v_mov_b32_dpp v13, v101 row_ror:2 row_mask:0xf bank_mask:0xf
    v_max_u32 v101, v101, v13
    v_med3_u32 v101, v100, v12, v101
    v_max_u32 v100, v100, v12
    s_nop 1
    v_mov_b32_dpp v12, v100 row_ror:4 row_mask:0xf bank_mask:0xf
    v_mov_b32_dpp v13, v101 row_ror:4 row_mask:0xf bank_mask:0xf
    v_max_u32 v101, v101, v13
    v_med3_u32 v101, v100, v12, v101
    v_max_u32 v100, v100, v12
    s_lshl_b32 s3, s96, 7
    s_add_u32 s3, s3, 32776
    v_lshlrev_b32 v14, 7, v0
    s_lshl_b32 s15, s51, 13
    s_add_u32 s15, s15, 32776
    s_waitcnt vmcnt(0)
    s_barrier
    s_cmp_lg_u32 s51, 0
    s_cbranch_scc1 L2_nokey
    s_mov_b64 exec, 1
    buffer_store_dwordx2 v[100:101], v14, s[84:87], s3 offen sc1
    s_mov_b64 exec, -1
L2_nokey:
    s_cmp_ge_u32 s2, 180
    s_cbranch_scc1 L2_fin
    s_cmp_ge_u32 s2, 144
    s_cbranch_scc1 L2_gather
    v_lshrrev_b32 v21, 4, v0
    v_bfe_u32 v20, v0, 2, 2
    v_lshl_add_u32 v20, v21, 3, v20
    v_and_b32 v21, 3, v0
    v_lshlrev_b32 v22, 6, v20
    v_lshl_add_u32 v22, v21, 3, v22
    s_cmp_lt_u32 s51, 2
    s_cselect_b32 s3, 126976, 0
    s_cselect_b32 s14, 0, 16384
    s_add_u32 s3, s3, s14
    s_and_b32 s14, s51, 1
    s_lshl_b32 s14, s14, 5
    s_add_u32 s3, s3, s14
    v_add_u32 v22, s3, v22
    v_mul_u32_u24 v23, 1152, v20
    v_lshl_add_u32 v23, v21, 3, v23
    s_mul_i32 s3, s51, 288
    s_add_u32 s3, s3, 53248
    v_add_u32 v23, s3, v23
    ds_read_b64_tr_b16 a[64:65], v22 offset:0
    ds_read_b64_tr_b16 a[66:67], v22 offset:256
    ds_read_b64_tr_b16 a[68:69], v22 offset:2048
    ds_read_b64_tr_b16 a[70:71], v22 offset:2304
    ds_read_b64_tr_b16 a[72:73], v22 offset:4096
    ds_read_b64_tr_b16 a[74:75], v22 offset:4352
    ds_read_b64_tr_b16 a[76:77], v22 offset:6144
    ds_read_b64_tr_b16 a[78:79], v22 offset:6400
    ds_read_b64_tr_b16 a[80:81], v22 offset:8192
    ds_read_b64_tr_b16 a[82:83], v22 offset:8448
    ds_read_b64_tr_b16 a[84:85], v22 offset:10240
    ds_read_b64_tr_b16 a[86:87], v22 offset:10496
    ds_read_b64_tr_b16 a[88:89], v22 offset:12288
    ds_read_b64_tr_b16 a[90:91], v22 offset:12544
    ds_read_b64_tr_b16 a[92:93], v22 offset:14336
    ds_read_b64_tr_b16 a[94:95], v22 offset:14592
    ds_read_b64_tr_b16 a[96:97], v22 offset:16384
    ds_read_b64_tr_b16 a[98:99], v22 offset:16640
    ds_read_b64_tr_b16 a[100:101], v22 offset:18432
    ds_read_b64_tr_b16 a[102:103], v22 offset:18688
    ds_read_b64_tr_b16 a[104:105], v22 offset:20480
    ds_read_b64_tr_b16 a[106:107], v22 offset:20736
    ds_read_b64_tr_b16 a[108:109], v22 offset:22528
    ds_read_b64_tr_b16 a[110:111], v22 offset:22784
    ds_read_b64_tr_b16 a[112:113], v22 offset:24576
    ds_read_b64_tr_b16 a[114:115], v22 offset:24832
    ds_read_b64_tr_b16 a[116:117], v22 offset:26624
    ds_read_b64_tr_b16 a[118:119], v22 offset:26880
    ds_read_b64_tr_b16 a[120:121], v22 offset:28672
    ds_read_b64_tr_b16 a[122:123], v22 offset:28928
    ds_read_b64_tr_b16 a[124:125], v22 offset:30720
    ds_read_b64_tr_b16 a[126:127], v22 offset:30976
    ds_read_b64_tr_b16 a[128:129], v22 offset:32768
    ds_read_b64_tr_b16 a[130:131], v22 offset:33024
    ds_read_b64_tr_b16 a[132:133], v22 offset:34816
    ds_read_b64_tr_b16 a[134:135], v22 offset:35072
    ds_read_b64_tr_b16 a[136:137], v23 offset:0
    ds_read_b64_tr_b16 a[138:139], v23 offset:4608
    ds_read_b64_tr_b16 a[140:141], v23 offset:32
    ds_read_b64_tr_b16 a[142:143], v23 offset:4640
    ds_read_b64_tr_b16 a[144:145], v23 offset:64
    ds_read_b64_tr_b16 a[146:147], v23 offset:4672
    ds_read_b64_tr_b16 a[148:149], v23 offset:96
    ds_read_b64_tr_b16 a[150:151], v23 offset:4704
    ds_read_b64_tr_b16 a[152:153], v23 offset:128
    ds_read_b64_tr_b16 a[154:155], v23 offset:4736
    ds_read_b64_tr_b16 a[156:157], v23 offset:160
    ds_read_b64_tr_b16 a[158:159], v23 offset:4768
    ds_read_b64_tr_b16 a[160:161], v23 offset:192
    ds_read_b64_tr_b16 a[162:163], v23 offset:4800
    ds_read_b64_tr_b16 a[164:165], v23 offset:224
    ds_read_b64_tr_b16 a[166:167], v23 offset:4832
    ds_read_b64_tr_b16 a[168:169], v23 offset:256
    ds_read_b64_tr_b16 a[170:171], v23 offset:4864
L2_gather:
    s_mov_b32 s97, 0x20000
L2_p2:
    buffer_load_dwordx2 v[16:17], v14, s[84:87], s15 offen sc1
    s_waitcnt vmcnt(0)
    v_min_u32 v12, v16, v17
    v_cmp_eq_u32 vcc, 0, v12
    s_sub_u32 s97, s97, 1
    s_cselect_b64 vcc, 0, vcc
    s_cmp_eq_u64 vcc, 0
    s_cbranch_scc1 L2_p2_ok
    s_mov_b64 exec, vcc
    s_sleep 1
    s_branch L2_p2
L2_p2_ok:
    s_mov_b64 exec, -1
    s_nop 1
    v_mov_b32_dpp v12, v16 row_ror:1 row_mask:0xf bank_mask:0xf
    v_mov_b32_dpp v13, v17 row_ror:1 row_mask:0xf bank_mask:0xf
    v_max_u32 v17, v17, v13
    v_med3_u32 v17, v16, v12, v17
    v_max_u32 v16, v16, v12
    s_nop 1
    v_mov_b32_dpp v12, v16 row_ror:2 row_mask:0xf bank_mask:0xf
    v_mov_b32_dpp v13, v17 row_ror:2 row_mask:0xf bank_mask:0xf
    v_max_u32 v17, v17, v13
    v_med3_u32 v17, v16, v12, v17
    v_max_u32 v16, v16, v12
    s_nop 1
    v_mov_b32_dpp v12, v16 row_ror:4 row_mask:0xf bank_mask:0xf
    v_mov_b32_dpp v13, v17 row_ror:4 row_mask:0xf bank_mask:0xf
    v_max_u32 v17, v17, v13
    v_med3_u32 v17, v16, v12, v17
    v_max_u32 v16, v16, v12
    s_nop 1
    v_mov_b32_dpp v12, v16 row_ror:8 row_mask:0xf bank_mask:0xf
    v_mov_b32_dpp v13, v17 row_ror:8 row_mask:0xf bank_mask:0xf
    v_max_u32 v17, v17, v13
    v_med3_u32 v17, v16, v12, v17
    v_max_u32 v16, v16, v12
    v_mov_b32 v12, v16
    v_mov_b32 v13, v17
    s_nop 0
    v_permlane16_swap_b32 v12, v16
    v_permlane16_swap_b32 v13, v17
    v_max_u32 v17, v17, v13
    v_med3_u32 v17, v16, v12, v17
    v_max_u32 v16, v16, v12
    v_mov_b32 v12, v16
    v_mov_b32 v13, v17
    s_nop 0
    v_permlane32_swap_b32 v12, v16
    v_permlane32_swap_b32 v13, v17
    v_max_u32 v17, v17, v13
    v_med3_u32 v17, v16, v12, v17
    v_max_u32 v16, v16, v12
    s_lshl_b32 s3, s51, 3
    s_add_u32 s3, s3, 15616
    v_mov_b32 v12, s3
    v_mov_b32 v13, 15616
    ds_write_b64 v12, v[16:17]
    s_waitcnt lgkmcnt(0)
    s_barrier
    ds_read_b128 v[16:19], v13
    ds_read_b128 v[20:23], v13 offset:16
    v_and_b32 v6, 1, v0
    v_lshrrev_b32 v7, 4, v0
    s_waitcnt lgkmcnt(0)
    v_max_u32 v17, v17, v19
    v_med3_u32 v17, v16, v18, v17
    v_max_u32 v16, v16, v18
    v_max_u32 v21, v21, v23
    v_med3_u32 v21, v20, v22, v21
    v_max_u32 v20, v20, v22
    v_max_u32 v17, v17, v21
    v_med3_u32 v17, v16, v20, v17
    v_max_u32 v16, v16, v20
    s_cmp_ge_u32 s2, 144
    s_cbranch_scc1 L2_red
    v_cmp_eq_u32 vcc, 0, v6
    s_nop 1
    v_cndmask_b32 v4, v17, v16, vcc
    v_and_b32 v4, 0x7ff, v4
    v_sub_u32 v4, 2047, v4
    v_mul_u32_u24 v5, 1152, v4
    v_lshl_add_u32 v5, v7, 4, v5
    s_mov_b32 s3, 4194304
    s_mov_b32 exec_lo, 0x30003
    s_mov_b32 exec_hi, 0x30003
    buffer_load_dwordx4 v[128:131], v5, s[84:87], s3 offen offset:0 sc1
    buffer_load_dwordx4 v[132:135], v5, s[84:87], s3 offen offset:64 sc1
    buffer_load_dwordx4 v[136:139], v5, s[84:87], s3 offen offset:128 sc1
    buffer_load_dwordx4 v[140:143], v5, s[84:87], s3 offen offset:192 sc1
    buffer_load_dwordx4 v[144:147], v5, s[84:87], s3 offen offset:256 sc1
    buffer_load_dwordx4 v[148:151], v5, s[84:87], s3 offen offset:320 sc1
    buffer_load_dwordx4 v[152:155], v5, s[84:87], s3 offen offset:384 sc1
    buffer_load_dwordx4 v[156:159], v5, s[84:87], s3 offen offset:448 sc1
    buffer_load_dwordx4 v[160:163], v5, s[84:87], s3 offen offset:512 sc1
    buffer_load_dwordx4 v[164:167], v5, s[84:87], s3 offen offset:576 sc1
    buffer_load_dwordx4 v[168:171], v5, s[84:87], s3 offen offset:640 sc1
    buffer_load_dwordx4 v[172:175], v5, s[84:87], s3 offen offset:704 sc1
    buffer_load_dwordx4 v[176:179], v5, s[84:87], s3 offen offset:768 sc1
    buffer_load_dwordx4 v[180:183], v5, s[84:87], s3 offen offset:832 sc1
    buffer_load_dwordx4 v[184:187], v5, s[84:87], s3 offen offset:896 sc1
    buffer_load_dwordx4 v[188:191], v5, s[84:87], s3 offen offset:960 sc1
    buffer_load_dwordx4 v[192:195], v5, s[84:87], s3 offen offset:1024 sc1
    buffer_load_dwordx4 v[196:199], v5, s[84:87], s3 offen offset:1088 sc1
    s_mov_b64 exec, -1
    v_lshlrev_b32 v11, 7, v6
    v_lshl_add_u32 v13, v7, 5, v11
    v_add_u32 v13, 14848, v13
    v_lshl_add_u32 v11, v7, 4, v11
    s_lshr_b32 s3, s51, 1
    s_lshl_b32 s3, s3, 8
    s_and_b32 s14, s51, 1
    s_lshl_b32 s14, s14, 6
    s_add_u32 s3, s3, s14
    s_add_u32 s3, s3, 14848
    v_add_u32 v11, s3, v11
    s_mul_i32 s14, s51, 1152
    s_add_u32 s3, s14, 110592
    v_mul_u32_u24 v9, 576, v6
    v_lshl_add_u32 v9, v7, 4, v9
    v_add_u32 v9, s3, v9
    v_add_u32 v10, s3, v8
    s_mul_i32 s15, s2, 4608
    s_add_u32 s15, s15, s14
    s_add_u32 s15, s15, 98304
    s_waitcnt vmcnt(17)
    v_mfma_f32_16x16x32_bf16 v[88:91], a[64:67], v[128:131], 0
    s_waitcnt vmcnt(16)
    v_mfma_f32_16x16x32_bf16 v[88:91], a[68:71], v[132:135], v[88:91]
    s_waitcnt vmcnt(15)
    v_mfma_f32_16x16x32_bf16 v[88:91], a[72:75], v[136:139], v[88:91]
    s_waitcnt vmcnt(14)
    v_mfma_f32_16x16x32_bf16 v[88:91], a[76:79], v[140:143], v[88:91]
    s_waitcnt vmcnt(13)
    v_mfma_f32_16x16x32_bf16 v[88:91], a[80:83], v[144:147], v[88:91]
    s_waitcnt vmcnt(12)
    v_mfma_f32_16x16x32_bf16 v[88:91], a[84:87], v[148:151], v[88:91]
    s_waitcnt vmcnt(11)
    v_mfma_f32_16x16x32_bf16 v[88:91], a[88:91], v[152:155], v[88:91]
    s_waitcnt vmcnt(10)
    v_mfma_f32_16x16x32_bf16 v[88:91], a[92:95], v[156:159], v[88:91]
    s_waitcnt vmcnt(9)
    v_mfma_f32_16x16x32_bf16 v[88:91], a[96:99], v[160:163], v[88:91]
    s_waitcnt vmcnt(8)
    v_mfma_f32_16x16x32_bf16 v[88:91], a[100:103], v[164:167], v[88:91]
    s_waitcnt vmcnt(7)
    v_mfma_f32_16x16x32_bf16 v[88:91], a[104:107], v[168:171], v[88:91]
    s_waitcnt vmcnt(6)
    v_mfma_f32_16x16x32_bf16 v[88:91], a[108:111], v[172:175], v[88:91]
    s_waitcnt vmcnt(5)
    v_mfma_f32_16x16x32_bf16 v[88:91], a[112:115], v[176:179], v[88:91]
    s_waitcnt vmcnt(4)
    v_mfma_f32_16x16x32_bf16 v[88:91], a[116:119], v[180:183], v[88:91]
    s_waitcnt vmcnt(3)
    v_mfma_f32_16x16x32_bf16 v[88:91], a[120:123], v[184:187], v[88:91]
    s_waitcnt vmcnt(2)
    v_mfma_f32_16x16x32_bf16 v[88:91], a[124:127], v[188:191], v[88:91]
    s_waitcnt vmcnt(1)
    v_mfma_f32_16x16x32_bf16 v[88:91], a[128:131], v[192:195], v[88:91]
    s_waitcnt vmcnt(0)
    v_mfma_f32_16x16x32_bf16 v[88:91], a[132:135], v[196:199], v[88:91]
    s_nop 5
    s_mov_b32 exec_lo, 0x30003
    s_mov_b32 exec_hi, 0x30003
    ds_write_b128 v11, v[88:91]
    s_mov_b64 exec, -1
    s_waitcnt lgkmcnt(0)
    s_barrier
    ds_read_b128 v[16:19], v13 offset:0
    ds_read_b128 v[20:23], v13 offset:16
    ds_read_b128 v[24:27], v13 offset:256
    ds_read_b128 v[28:31], v13 offset:272
    s_waitcnt lgkmcnt(2)
    v_mul_f32 v32, 0xbfb8aa3b, v16
    v_mul_f32 v33, 0xbfb8aa3b, v17
    v_mul_f32 v34, 0xbfb8aa3b, v18
    v_mul_f32 v35, 0xbfb8aa3b, v19
    v_mul_f32 v36, 0xbfb8aa3b, v20
    v_mul_f32 v37, 0xbfb8aa3b, v21
    v_mul_f32 v38, 0xbfb8aa3b, v22
    v_mul_f32 v39, 0xbfb8aa3b, v23
    v_exp_f32 v32, v32
    v_exp_f32 v33, v33
    v_exp_f32 v34, v34
    v_exp_f32 v35, v35
    v_exp_f32 v36, v36
    v_exp_f32 v37, v37
    v_exp_f32 v38, v38
    v_exp_f32 v39, v39
    v_add_f32 v32, 1.0, v32
    v_add_f32 v33, 1.0, v33
    v_add_f32 v34, 1.0, v34
    v_add_f32 v35, 1.0, v35
    v_add_f32 v36, 1.0, v36
    v_add_f32 v37, 1.0, v37
    v_add_f32 v38, 1.0, v38
    v_add_f32 v39, 1.0, v39
    v_rcp_f32 v32, v32
    v_rcp_f32 v33, v33
    v_rcp_f32 v34, v34
    v_rcp_f32 v35, v35
    v_rcp_f32 v36, v36
    v_rcp_f32 v37, v37
    v_rcp_f32 v38, v38
    v_rcp_f32 v39, v39
    s_waitcnt lgkmcnt(0)
    v_mul_f32 v16, v16, v32
    v_mul_f32 v17, v17, v33
    v_mul_f32 v18, v18, v34
    v_mul_f32 v19, v19, v35
    v_mul_f32 v20, v20, v36
    v_mul_f32 v21, v21, v37
    v_mul_f32 v22, v22, v38
    v_mul_f32 v23, v23, v39
    v_mul_f32 v16, v16, v24
    v_mul_f32 v17, v17, v25
    v_mul_f32 v18, v18, v26
    v_mul_f32 v19, v19, v27
    v_mul_f32 v20, v20, v28
    v_mul_f32 v21, v21, v29
    v_mul_f32 v22, v22, v30
    v_mul_f32 v23, v23, v31
    v_cvt_pk_bf16_f32 v40, v16, v17
    v_cvt_pk_bf16_f32 v41, v18, v19
    v_cvt_pk_bf16_f32 v42, v20, v21
    v_cvt_pk_bf16_f32 v43, v22, v23
    s_nop 1
    v_mfma_f32_16x16x32_bf16 v[48:51], a[136:139], v[40:43], 0
    v_mfma_f32_16x16x32_bf16 v[52:55], a[140:143], v[40:43], 0
    v_mfma_f32_16x16x32_bf16 v[56:59], a[144:147], v[40:43], 0
    v_mfma_f32_16x16x32_bf16 v[60:63], a[148:151], v[40:43], 0
    v_mfma_f32_16x16x32_bf16 v[64:67], a[152:155], v[40:43], 0
    v_mfma_f32_16x16x32_bf16 v[68:71], a[156:159], v[40:43], 0
    v_mfma_f32_16x16x32_bf16 v[72:75], a[160:163], v[40:43], 0
    v_mfma_f32_16x16x32_bf16 v[76:79], a[164:167], v[40:43], 0
    v_mfma_f32_16x16x32_bf16 v[80:83], a[168:171], v[40:43], 0
    s_mov_b32 exec_lo, 0x30003
    s_mov_b32 exec_hi, 0x30003
    ds_write_b128 v9, v[48:51] offset:0
    ds_write_b128 v9, v[52:55] offset:64
    ds_write_b128 v9, v[56:59] offset:128
    ds_write_b128 v9, v[60:63] offset:192
    ds_write_b128 v9, v[64:67] offset:256
    ds_write_b128 v9, v[68:71] offset:320
    ds_write_b128 v9, v[72:75] offset:384
    ds_write_b128 v9, v[76:79] offset:448
    ds_write_b128 v9, v[80:83] offset:512
    s_mov_b64 exec, -1
    ds_read_b128 v[16:19], v10
    ds_read_b128 v[20:23], v10 offset:1024
    s_waitcnt lgkmcnt(0)
    v_min_u32 v16, -2, v16
    v_min_u32 v17, -2, v17
    v_min_u32 v18, -2, v18
    v_min_u32 v19, -2, v19
    v_min_u32 v20, -2, v20
    v_min_u32 v21, -2, v21
    v_min_u32 v22, -2, v22
    v_min_u32 v23, -2, v23
    buffer_store_dwordx4 v[16:19], v8, s[84:87], s15 offen sc1
    s_mov_b64 exec, 0xff
    buffer_store_dwordx4 v[20:23], v8, s[84:87], s15 offen offset:1024 sc1
    s_branch L2_fin
L2_red:
    s_mov_b32 s3, 98304
    s_add_u32 s32, s84, s3
    s_addc_u32 s33, s85, 0
    s_mov_b32 s34, 663552
    s_mov_b32 s35, 0x20000
    s_sub_u32 s3, s2, 144
    s_mul_i32 s14, s3, 7282
    s_lshr_b32 s14, s14, 16
    s_mul_i32 s15, s14, 9
    s_sub_u32 s15, s3, s15
    s_lshl_b32 s15, s15, 5
    s_mul_i32 s14, s14, 144
    v_and_b32 v6, 7, v0
    v_lshl_add_u32 v7, v6, 2, s15
    v_cmp_gt_u32 vcc, 144, v7
    v_subrev_u32 v9, 144, v7
    v_lshrrev_b32 v10, 3, v0
    v_cndmask_b32 v7, v9, v7, vcc
    v_cndmask_b32 v16, v17, v16, vcc
    v_add_u32 v7, s14, v7
    v_and_b32 v9, 0x7ff, v16
    v_sub_u32 v9, 2047, v9
    v_mul_u32_u24 v9, 1152, v9
    v_lshl_add_u32 v9, v7, 1, v9
    v_lshlrev_b32 v7, 2, v7
    buffer_load_dwordx2 v[18:19], v9, s[80:83], 0 offen sc1
    ds_read_b128 v[20:23], v7 offset:6912
    s_lshl_b32 s14, s51, 3
    v_add_u32 v10, s14, v10
    v_mul_u32_u24 v10, 4608, v10
    v_lshl_add_u32 v10, v6, 4, v10
    s_lshl_b32 s3, s3, 7
    v_add_u32 v24, s3, v10
    v_add_u32 v25, 147456, v24
    v_add_u32 v26, 294912, v24
    v_add_u32 v27, 442368, v24
    v_add_u32 v28, 589824, v24
    v_and_b32 v16, 0xfffff800, v16
    v_not_b32 v12, v16
    v_ashrrev_i32 v12, 31, v12
    v_or_b32 v12, 0x80000000, v12
    v_xor_b32 v16, v16, v12
    v_mul_f32 v16, 0xbfb8aa3b, v16
    v_exp_f32 v16, v16
    s_nop 0
    v_add_f32 v16, 1.0, v16
    v_rcp_f32 v16, v16
    s_waitcnt lgkmcnt(0)
    v_mul_f32 v20, v20, v16
    v_mul_f32 v21, v21, v16
    v_mul_f32 v22, v22, v16
    v_mul_f32 v23, v23, v16
    v_lshlrev_b32 v11, 4, v6
    v_add_u32 v11, 15872, v11
    s_lshl_b32 s14, s51, 7
    v_add_u32 v10, s14, v11
    s_mov_b32 s97, 0x20000
L2_p3:
    buffer_load_dwordx4 v[32:35], v24, s[32:35], 0 offen sc1
    buffer_load_dwordx4 v[36:39], v25, s[32:35], 0 offen sc1
    buffer_load_dwordx4 v[40:43], v26, s[32:35], 0 offen sc1
    buffer_load_dwordx4 v[44:47], v27, s[32:35], 0 offen sc1
    buffer_load_dwordx4 v[48:51], v28, s[32:35], 0 offen sc1
    s_waitcnt vmcnt(0)
    v_max3_u32 v12, v32, v33, v34
    v_max3_u32 v12, v12, v35, v36
    v_max3_u32 v12, v12, v37, v38
    v_max3_u32 v12, v12, v39, v40
    v_max3_u32 v12, v12, v41, v42
    v_max3_u32 v12, v12, v43, v44
    v_max3_u32 v12, v12, v45, v46
    v_max3_u32 v12, v12, v47, v48
    v_max3_u32 v12, v12, v49, v50
    v_max_u32 v12, v12, v51
    v_cmp_eq_u32 vcc, -1, v12
    s_sub_u32 s97, s97, 1
    s_cselect_b64 vcc, 0, vcc
    s_cmp_eq_u64 vcc, 0
    s_cbranch_scc1 L2_p3_ok
    s_sleep 1
    s_branch L2_p3
L2_p3_ok:
    v_pk_add_f32 v[32:33], v[32:33], v[36:37]
    v_pk_add_f32 v[40:41], v[40:41], v[44:45]
    v_pk_add_f32 v[32:33], v[32:33], v[48:49]
    v_pk_add_f32 v[32:33], v[32:33], v[40:41]
    v_pk_add_f32 v[34:35], v[34:35], v[38:39]
    v_pk_add_f32 v[42:43], v[42:43], v[46:47]
    v_pk_add_f32 v[34:35], v[34:35], v[50:51]
    v_pk_add_f32 v[34:35], v[34:35], v[42:43]
    s_nop 1
    v_add_f32_dpp v32, v32, v32 row_ror:8 row_mask:0xf bank_mask:0xf
    v_add_f32_dpp v33, v33, v33 row_ror:8 row_mask:0xf bank_mask:0xf
    v_add_f32_dpp v34, v34, v34 row_ror:8 row_mask:0xf bank_mask:0xf
    v_add_f32_dpp v35, v35, v35 row_ror:8 row_mask:0xf bank_mask:0xf
    v_mov_b32 v12, v32
    v_mov_b32 v13, v33
    v_mov_b32 v14, v34
    v_mov_b32 v15, v35
    v_permlane16_swap_b32 v12, v32
    v_permlane16_swap_b32 v13, v33
    v_permlane16_swap_b32 v14, v34
    v_permlane16_swap_b32 v15, v35
    v_add_f32 v32, v32, v12
    v_add_f32 v33, v33, v13
    v_add_f32 v34, v34, v14
    v_add_f32 v35, v35, v15
    v_mov_b32 v12, v32
    v_mov_b32 v13, v33
    v_mov_b32 v14, v34
    v_mov_b32 v15, v35
    v_permlane32_swap_b32 v12, v32
    v_permlane32_swap_b32 v13, v33
    v_permlane32_swap_b32 v14, v34
    v_permlane32_swap_b32 v15, v35
    v_add_f32 v32, v32, v12
    v_add_f32 v33, v33, v13
    v_add_f32 v34, v34, v14
    v_add_f32 v35, v35, v15
    ds_write_b128 v10, v[32:35]
    s_waitcnt lgkmcnt(0)
    s_barrier
    ds_read_b128 v[32:35], v11 offset:0
    ds_read_b128 v[36:39], v11 offset:128
    ds_read_b128 v[40:43], v11 offset:256
    ds_read_b128 v[44:47], v11 offset:384
    v_lshlrev_b32 v12, 16, v18
    v_and_b32 v13, 0xffff0000, v18
    v_lshlrev_b32 v14, 16, v19
    v_and_b32 v15, 0xffff0000, v19
    s_waitcnt lgkmcnt(0)
    v_pk_add_f32 v[32:33], v[32:33], v[36:37]
    v_pk_add_f32 v[40:41], v[40:41], v[44:45]
    v_pk_add_f32 v[32:33], v[32:33], v[40:41]
    v_pk_fma_f32 v[12:13], v[32:33], v[20:21], v[12:13]
    v_pk_add_f32 v[34:35], v[34:35], v[38:39]
    v_pk_add_f32 v[42:43], v[42:43], v[46:47]
    v_pk_add_f32 v[34:35], v[34:35], v[42:43]
    v_pk_fma_f32 v[14:15], v[34:35], v[22:23], v[14:15]
    v_cvt_pk_bf16_f32 v12, v12, v13
    v_cvt_pk_bf16_f32 v13, v14, v15
    s_cmp_lg_u32 s51, 0
    s_cbranch_scc1 L2_fin
    s_mov_b64 exec, 0xff
    buffer_store_dwordx2 v[12:13], v9, s[80:83], 0 offen sc1
L2_fin:
L2_end:
    s_endpgm
L2_p0s:
    s_mov_b32 s97, 0x20000
L2_p0:
    buffer_load_dword v51, v156, s[60:63], 0 offen sc1
    s_waitcnt vmcnt(0)
    v_cmp_eq_u32 vcc, 0, v51
    s_sub_u32 s97, s97, 1
    s_cselect_b64 vcc, 0, vcc
    s_cmp_eq_u64 vcc, 0
    s_cbranch_scc1 L2_p0_ok
    s_sleep 1
    s_branch L2_p0
L2_p0_ok:
    s_branch L2_p0r
L2_pms:
    s_mov_b32 s97, 0x20000
L2_pm:
    buffer_load_dwordx4 v[168:171], v166, s[84:87], 0 offen sc1
    buffer_load_dwordx4 v[176:179], v166, s[84:87], s14 offen sc1
    s_mov_b64 exec, 0xff
    buffer_load_dwordx4 v[172:175], v166, s[84:87], 0 offen offset:1024 sc1
    buffer_load_dwordx4 v[180:183], v166, s[84:87], s14 offen offset:1024 sc1
    s_mov_b64 exec, -1
    s_waitcnt vmcnt(0)
    v_max_u32 v13, v168, v169
    v_max3_u32 v13, v13, v170, v171
    v_max3_u32 v13, v13, v172, v173
    v_max3_u32 v13, v13, v174, v175
    v_max3_u32 v13, v13, v176, v177
    v_max3_u32 v13, v13, v178, v179
    v_max3_u32 v13, v13, v180, v181
    v_max3_u32 v13, v13, v182, v183
    v_cmp_eq_u32 vcc, -1, v13
    s_sub_u32 s97, s97, 1
    s_cselect_b64 vcc, 0, vcc
    s_cmp_eq_u64 vcc, 0
    s_cbranch_scc1 L2_pm_ok
    s_sleep 1
    s_branch L2_pm
L2_pm_ok:
    s_branch L2_pmr
L2_pns:
    s_mov_b32 s97, 0x20000
L2_pn:
    buffer_load_dwordx4 v[32:35], v9, s[84:87], s3 offen offset:0 sc1
    buffer_load_dwordx4 v[44:47], v9, s[84:87], s14 offen offset:0 sc1
    buffer_load_dwordx4 v[36:39], v9, s[84:87], s3 offen offset:1024 sc1
    buffer_load_dwordx4 v[48:51], v9, s[84:87], s14 offen offset:1024 sc1
    s_mov_b64 exec, 0xffff
    buffer_load_dwordx4 v[40:43], v9, s[84:87], s3 offen offset:2048 sc1
    buffer_load_dwordx4 v[52:55], v9, s[84:87], s14 offen offset:2048 sc1
    s_mov_b64 exec, -1
    s_waitcnt vmcnt(0)
    v_max_u32 v13, v32, v33
    v_max3_u32 v13, v13, v34, v35
    v_max3_u32 v13, v13, v36, v37
    v_max3_u32 v13, v13, v38, v39
    v_max3_u32 v13, v13, v40, v41
    v_max3_u32 v13, v13, v42, v43
    v_max3_u32 v13, v13, v44, v45
    v_max3_u32 v13, v13, v46, v47
    v_max3_u32 v13, v13, v48, v49
    v_max3_u32 v13, v13, v50, v51
    v_max3_u32 v13, v13, v52, v53
    v_max3_u32 v13, v13, v54, v55
    v_cmp_eq_u32 vcc, -1, v13
    s_sub_u32 s97, s97, 1
    s_cselect_b64 vcc, 0, vcc
    s_cmp_eq_u64 vcc, 0
    s_cbranch_scc1 L2_pn_ok
    s_sleep 1
    s_branch L2_pn
L2_pn_ok:
    s_branch L2_pnr
L2_fallback:
    s_waitcnt vmcnt(0) lgkmcnt(0)
    s_barrier
    v_lshrrev_b32 v14, 2, v0
    v_mul_u32_u24 v14, 1056, v14
    v_and_b32 v15, 3, v0
    v_lshl_add_u32 v14, v15, 3, v14
    v_add_u32 v2, 107008, v14
    v_and_b32 v14, 15, v0
    v_mul_u32_u24 v14, 1056, v14
    v_lshrrev_b32 v15, 4, v0
    v_lshl_add_u32 v14, v15, 4, v14
    v_add_u32 v1, 90112, v14
    v_mov_b32 v32, 0xff800000
    v_mov_b32 v33, 0xff800000
    v_mov_b32 v34, 0xff800000
    v_mov_b32 v35, 0xff800000
    s_mov_b32 s50, 1
    s_mov_b32 s46, 0
L2_fb_loop:
    s_add_u32 m0, s44, 73728
    s_nop 0
    buffer_load_dwordx4 v5, s[16:19], s46 offen offset:0 lds
    s_add_u32 m0, s44, 73760
    s_nop 0
    buffer_load_dwordx4 v5, s[16:19], s46 offen offset:1024 lds
    s_add_u32 m0, s44, 73792
    s_nop 0
    buffer_load_dwordx4 v5, s[16:19], s46 offen offset:2048 lds
    s_add_u32 m0, s44, 73824
    s_nop 0
    buffer_load_dwordx4 v5, s[16:19], s46 offen offset:3072 lds
    s_waitcnt vmcnt(0) lgkmcnt(0)
    s_barrier
    ds_read_b128 a[64:67], v1 offset:0
    ds_read_b128 a[68:71], v1 offset:64
    ds_read_b128 a[72:75], v1 offset:128
    ds_read_b128 a[76:79], v1 offset:192
    ds_read_b128 a[80:83], v1 offset:256
    ds_read_b128 a[84:87], v1 offset:320
    ds_read_b128 a[88:91], v1 offset:384
    ds_read_b128 a[92:95], v1 offset:448
    ds_read_b128 a[96:99], v1 offset:512
    ds_read_b128 a[100:103], v1 offset:576
    ds_read_b128 a[104:107], v1 offset:640
    ds_read_b128 a[108:111], v1 offset:704
    ds_read_b128 a[112:115], v1 offset:768
    ds_read_b128 a[116:119], v1 offset:832
    ds_read_b128 a[120:123], v1 offset:896
    ds_read_b128 a[124:127], v1 offset:960
    s_waitcnt vmcnt(0) lgkmcnt(0)
    s_barrier
    v_mfma_f32_16x16x32_bf16 v[16:19], a[64:67], v[64:67], 0
    v_mfma_f32_16x16x32_bf16 v[16:19], a[68:71], v[68:71], v[16:19]
    v_mfma_f32_16x16x32_bf16 v[16:19], a[72:75], v[72:75], v[16:19]
    v_mfma_f32_16x16x32_bf16 v[16:19], a[76:79], v[76:79], v[16:19]
    v_mfma_f32_16x16x32_bf16 v[20:23], a[80:83], v[64:67], 0
    v_mfma_f32_16x16x32_bf16 v[20:23], a[84:87], v[68:71], v[20:23]
    v_mfma_f32_16x16x32_bf16 v[20:23], a[88:91], v[72:75], v[20:23]
    v_mfma_f32_16x16x32_bf16 v[20:23], a[92:95], v[76:79], v[20:23]
    v_mfma_f32_16x16x32_bf16 v[24:27], a[96:99], v[64:67], 0
    v_mfma_f32_16x16x32_bf16 v[24:27], a[100:103], v[68:71], v[24:27]
    v_mfma_f32_16x16x32_bf16 v[24:27], a[104:107], v[72:75], v[24:27]
    v_mfma_f32_16x16x32_bf16 v[24:27], a[108:111], v[76:79], v[24:27]
    v_mfma_f32_16x16x32_bf16 v[28:31], a[112:115], v[64:67], 0
    v_mfma_f32_16x16x32_bf16 v[28:31], a[116:119], v[68:71], v[28:31]
    v_mfma_f32_16x16x32_bf16 v[28:31], a[120:123], v[72:75], v[28:31]
    v_mfma_f32_16x16x32_bf16 v[28:31], a[124:127], v[76:79], v[28:31]
    s_nop 7
    v_max3_f32 v32, v32, v16, v17
    v_max3_f32 v32, v32, v18, v19
    v_max3_f32 v32, v32, v20, v21
    v_max3_f32 v32, v32, v22, v23
    v_max3_f32 v32, v32, v24, v25
    v_max3_f32 v32, v32, v26, v27
    v_max3_f32 v32, v32, v28, v29
    v_max3_f32 v32, v32, v30, v31
    v_mfma_f32_16x16x32_bf16 v[16:19], a[64:67], v[80:83], 0
    v_mfma_f32_16x16x32_bf16 v[16:19], a[68:71], v[84:87], v[16:19]
    v_mfma_f32_16x16x32_bf16 v[16:19], a[72:75], v[88:91], v[16:19]
    v_mfma_f32_16x16x32_bf16 v[16:19], a[76:79], v[92:95], v[16:19]
    v_mfma_f32_16x16x32_bf16 v[20:23], a[80:83], v[80:83], 0
    v_mfma_f32_16x16x32_bf16 v[20:23], a[84:87], v[84:87], v[20:23]
    v_mfma_f32_16x16x32_bf16 v[20:23], a[88:91], v[88:91], v[20:23]
    v_mfma_f32_16x16x32_bf16 v[20:23], a[92:95], v[92:95], v[20:23]
    v_mfma_f32_16x16x32_bf16 v[24:27], a[96:99], v[80:83], 0
    v_mfma_f32_16x16x32_bf16 v[24:27], a[100:103], v[84:87], v[24:27]
    v_mfma_f32_16x16x32_bf16 v[24:27], a[104:107], v[88:91], v[24:27]
    v_mfma_f32_16x16x32_bf16 v[24:27], a[108:111], v[92:95], v[24:27]
    v_mfma_f32_16x16x32_bf16 v[28:31], a[112:115], v[80:83], 0
    v_mfma_f32_16x16x32_bf16 v[28:31], a[116:119], v[84:87], v[28:31]
    v_mfma_f32_16x16x32_bf16 v[28:31], a[120:123], v[88:91], v[28:31]
    v_mfma_f32_16x16x32_bf16 v[28:31], a[124:127], v[92:95], v[28:31]
    s_nop 7
    v_max3_f32 v33, v33, v16, v17
    v_max3_f32 v33, v33, v18, v19
    v_max3_f32 v33, v33, v20, v21
    v_max3_f32 v33, v33, v22, v23
    v_max3_f32 v33, v33, v24, v25
    v_max3_f32 v33, v33, v26, v27
    v_max3_f32 v33, v33, v28, v29
    v_max3_f32 v33, v33, v30, v31
    v_mfma_f32_16x16x32_bf16 v[16:19], a[64:67], v[96:99], 0
    v_mfma_f32_16x16x32_bf16 v[16:19], a[68:71], v[100:103], v[16:19]
    v_mfma_f32_16x16x32_bf16 v[16:19], a[72:75], v[104:107], v[16:19]
    v_mfma_f32_16x16x32_bf16 v[16:19], a[76:79], v[108:111], v[16:19]
    v_mfma_f32_16x16x32_bf16 v[20:23], a[80:83], v[96:99], 0
    v_mfma_f32_16x16x32_bf16 v[20:23], a[84:87], v[100:103], v[20:23]
    v_mfma_f32_16x16x32_bf16 v[20:23], a[88:91], v[104:107], v[20:23]
    v_mfma_f32_16x16x32_bf16 v[20:23], a[92:95], v[108:111], v[20:23]
    v_mfma_f32_16x16x32_bf16 v[24:27], a[96:99], v[96:99], 0
    v_mfma_f32_16x16x32_bf16 v[24:27], a[100:103], v[100:103], v[24:27]
    v_mfma_f32_16x16x32_bf16 v[24:27], a[104:107], v[104:107], v[24:27]
    v_mfma_f32_16x16x32_bf16 v[24:27], a[108:111], v[108:111], v[24:27]
    v_mfma_f32_16x16x32_bf16 v[28:31], a[112:115], v[96:99], 0
    v_mfma_f32_16x16x32_bf16 v[28:31], a[116:119], v[100:103], v[28:31]
    v_mfma_f32_16x16x32_bf16 v[28:31], a[120:123], v[104:107], v[28:31]
    v_mfma_f32_16x16x32_bf16 v[28:31], a[124:127], v[108:111], v[28:31]
    s_nop 7
    v_max3_f32 v34, v34, v16, v17
    v_max3_f32 v34, v34, v18, v19
    v_max3_f32 v34, v34, v20, v21
    v_max3_f32 v34, v34, v22, v23
    v_max3_f32 v34, v34, v24, v25
    v_max3_f32 v34, v34, v26, v27
    v_max3_f32 v34, v34, v28, v29
    v_max3_f32 v34, v34, v30, v31
    v_mfma_f32_16x16x32_bf16 v[16:19], a[64:67], v[112:115], 0
    v_mfma_f32_16x16x32_bf16 v[16:19], a[68:71], v[116:119], v[16:19]
    v_mfma_f32_16x16x32_bf16 v[16:19], a[72:75], v[120:123], v[16:19]
    v_mfma_f32_16x16x32_bf16 v[16:19], a[76:79], v[124:127], v[16:19]
    v_mfma_f32_16x16x32_bf16 v[20:23], a[80:83], v[112:115], 0
    v_mfma_f32_16x16x32_bf16 v[20:23], a[84:87], v[116:119], v[20:23]
    v_mfma_f32_16x16x32_bf16 v[20:23], a[88:91], v[120:123], v[20:23]
    v_mfma_f32_16x16x32_bf16 v[20:23], a[92:95], v[124:127], v[20:23]
    v_mfma_f32_16x16x32_bf16 v[24:27], a[96:99], v[112:115], 0
    v_mfma_f32_16x16x32_bf16 v[24:27], a[100:103], v[116:119], v[24:27]
    v_mfma_f32_16x16x32_bf16 v[24:27], a[104:107], v[120:123], v[24:27]
    v_mfma_f32_16x16x32_bf16 v[24:27], a[108:111], v[124:127], v[24:27]
    v_mfma_f32_16x16x32_bf16 v[28:31], a[112:115], v[112:115], 0
    v_mfma_f32_16x16x32_bf16 v[28:31], a[116:119], v[116:119], v[28:31]
    v_mfma_f32_16x16x32_bf16 v[28:31], a[120:123], v[120:123], v[28:31]
    v_mfma_f32_16x16x32_bf16 v[28:31], a[124:127], v[124:127], v[28:31]
    s_nop 7
    v_max3_f32 v35, v35, v16, v17
    v_max3_f32 v35, v35, v18, v19
    v_max3_f32 v35, v35, v20, v21
    v_max3_f32 v35, v35, v22, v23
    v_max3_f32 v35, v35, v24, v25
    v_max3_f32 v35, v35, v26, v27
    v_max3_f32 v35, v35, v28, v29
    v_max3_f32 v35, v35, v30, v31
    s_add_u32 s46, s46, 16384
    s_cmp_lt_u32 s46, 524288
    s_cbranch_scc1 L2_fb_loop
    v_mov_b32 v12, v32
    v_mov_b32 v13, v33
    v_mov_b32 v14, v34
    v_mov_b32 v15, v35
    v_permlane16_swap_b32 v12, v32
    v_permlane16_swap_b32 v13, v33
    v_permlane16_swap_b32 v14, v34
    v_permlane16_swap_b32 v15, v35
    v_max_f32 v32, v32, v12
    v_max_f32 v33, v33, v13
    v_max_f32 v34, v34, v14
    v_max_f32 v35, v35, v15
    v_mov_b32 v12, v32
    v_mov_b32 v13, v33
    v_mov_b32 v14, v34
    v_mov_b32 v15, v35
    v_permlane32_swap_b32 v12, v32
    v_permlane32_swap_b32 v13, v33
    v_permlane32_swap_b32 v14, v34
    v_permlane32_swap_b32 v15, v35
    v_max_f32 v32, v32, v12
    v_max_f32 v33, v33, v13
    v_max_f32 v34, v34, v14
    v_max_f32 v35, v35, v15
    v_sub_f32 v48, 0x80000000, v32
    v_sub_f32 v49, 0x80000000, v32
    v_sub_f32 v50, 0x80000000, v32
    v_sub_f32 v51, 0x80000000, v32
    v_sub_f32 v52, 0x80000000, v33
    v_sub_f32 v53, 0x80000000, v33
    v_sub_f32 v54, 0x80000000, v33
    v_sub_f32 v55, 0x80000000, v33
    v_sub_f32 v56, 0x80000000, v34
    v_sub_f32 v57, 0x80000000, v34
    v_sub_f32 v58, 0x80000000, v34
    v_sub_f32 v59, 0x80000000, v34
    v_sub_f32 v60, 0x80000000, v35
    v_sub_f32 v61, 0x80000000, v35
    v_sub_f32 v62, 0x80000000, v35
    v_sub_f32 v63, 0x80000000, v35
    s_add_u32 m0, s44, 73728
    s_mov_b32 s46, 0
    buffer_load_dwordx4 v5, s[16:19], s46 offen offset:0 lds
    s_add_u32 m0, s44, 73760
    s_nop 0
    buffer_load_dwordx4 v5, s[16:19], s46 offen offset:1024 lds
    s_add_u32 m0, s44, 73792
    s_nop 0
    buffer_load_dwordx4 v5, s[16:19], s46 offen offset:2048 lds
    s_add_u32 m0, s44, 73824
    s_nop 0
    buffer_load_dwordx4 v5, s[16:19], s46 offen offset:3072 lds
    s_add_u32 m0, s44, 90624
    s_nop 0
    buffer_load_dwordx4 v5, s[20:23], s46 offen offset:0 lds
    s_add_u32 m0, s44, 90656
    s_nop 0
    buffer_load_dwordx4 v5, s[20:23], s46 offen offset:1024 lds
    s_add_u32 m0, s44, 90688
    s_nop 0
    buffer_load_dwordx4 v5, s[20:23], s46 offen offset:2048 lds
    s_add_u32 m0, s44, 90720
    s_nop 0
    buffer_load_dwordx4 v5, s[20:23], s46 offen offset:3072 lds
    s_add_u32 m0, s44, 110592
    s_mov_b32 s46, 16384
    buffer_load_dwordx4 v5, s[16:19], s46 offen offset:0 lds
    s_add_u32 m0, s44, 110624
    s_nop 0
    buffer_load_dwordx4 v5, s[16:19], s46 offen offset:1024 lds
    s_add_u32 m0, s44, 110656
    s_nop 0
    buffer_load_dwordx4 v5, s[16:19], s46 offen offset:2048 lds
    s_add_u32 m0, s44, 110688
    s_nop 0
    buffer_load_dwordx4 v5, s[16:19], s46 offen offset:3072 lds
    s_add_u32 m0, s44, 127488
    s_nop 0
    buffer_load_dwordx4 v5, s[20:23], s46 offen offset:0 lds
    s_add_u32 m0, s44, 127520
    s_nop 0
    buffer_load_dwordx4 v5, s[20:23], s46 offen offset:1024 lds
    s_add_u32 m0, s44, 127552
    s_nop 0
    buffer_load_dwordx4 v5, s[20:23], s46 offen offset:2048 lds
    s_add_u32 m0, s44, 127584
    s_nop 0
    buffer_load_dwordx4 v5, s[20:23], s46 offen offset:3072 lds
    s_add_u32 m0, s44, 0
    s_mov_b32 s46, 32768
    buffer_load_dwordx4 v5, s[16:19], s46 offen offset:0 lds
    s_add_u32 m0, s44, 32
    s_nop 0
    buffer_load_dwordx4 v5, s[16:19], s46 offen offset:1024 lds
    s_add_u32 m0, s44, 64
    s_nop 0
    buffer_load_dwordx4 v5, s[16:19], s46 offen offset:2048 lds
    s_add_u32 m0, s44, 96
    s_nop 0
    buffer_load_dwordx4 v5, s[16:19], s46 offen offset:3072 lds
    s_add_u32 m0, s44, 16896
    s_nop 0
    buffer_load_dwordx4 v5, s[20:23], s46 offen offset:0 lds
    s_add_u32 m0, s44, 16928
    s_nop 0
    buffer_load_dwordx4 v5, s[20:23], s46 offen offset:1024 lds
    s_add_u32 m0, s44, 16960
    s_nop 0
    buffer_load_dwordx4 v5, s[20:23], s46 offen offset:2048 lds
    s_add_u32 m0, s44, 16992
    s_nop 0
    buffer_load_dwordx4 v5, s[20:23], s46 offen offset:3072 lds
    s_waitcnt vmcnt(0) lgkmcnt(0)
    s_barrier
    ds_read_b128 a[64:67], v1 offset:0
    ds_read_b128 a[68:71], v1 offset:64
    ds_read_b128 a[72:75], v1 offset:128
    ds_read_b128 a[76:79], v1 offset:192
    ds_read_b128 a[80:83], v1 offset:256
    ds_read_b128 a[84:87], v1 offset:320
    ds_read_b128 a[88:91], v1 offset:384
    ds_read_b128 a[92:95], v1 offset:448
    ds_read_b128 a[96:99], v1 offset:512
    ds_read_b128 a[100:103], v1 offset:576
    ds_read_b128 a[104:107], v1 offset:640
    ds_read_b128 a[108:111], v1 offset:704
    ds_read_b128 a[112:115], v1 offset:768
    ds_read_b128 a[116:119], v1 offset:832
    ds_read_b128 a[120:123], v1 offset:896
    ds_read_b128 a[124:127], v1 offset:960
    ds_read_b64_tr_b16 a[128:129], v2 offset:0
    ds_read_b64_tr_b16 a[130:131], v2 offset:256
    ds_read_b64_tr_b16 a[132:133], v2 offset:512
    ds_read_b64_tr_b16 a[134:135], v2 offset:768
    ds_read_b64_tr_b16 a[136:137], v2 offset:32
    ds_read_b64_tr_b16 a[138:139], v2 offset:288
    ds_read_b64_tr_b16 a[140:141], v2 offset:544
    ds_read_b64_tr_b16 a[142:143], v2 offset:800
    ds_read_b64_tr_b16 a[144:145], v2 offset:64
    ds_read_b64_tr_b16 a[146:147], v2 offset:320
    ds_read_b64_tr_b16 a[148:149], v2 offset:576
    ds_read_b64_tr_b16 a[150:151], v2 offset:832
    ds_read_b64_tr_b16 a[152:153], v2 offset:96
    ds_read_b64_tr_b16 a[154:155], v2 offset:352
    ds_read_b64_tr_b16 a[156:157], v2 offset:608
    ds_read_b64_tr_b16 a[158:159], v2 offset:864
    ds_read_b64_tr_b16 a[160:161], v2 offset:128
    ds_read_b64_tr_b16 a[162:163], v2 offset:384
    ds_read_b64_tr_b16 a[164:165], v2 offset:640
    ds_read_b64_tr_b16 a[166:167], v2 offset:896
    ds_read_b64_tr_b16 a[168:169], v2 offset:160
    ds_read_b64_tr_b16 a[170:171], v2 offset:416
    ds_read_b64_tr_b16 a[172:173], v2 offset:672
    ds_read_b64_tr_b16 a[174:175], v2 offset:928
    ds_read_b64_tr_b16 a[176:177], v2 offset:192
    ds_read_b64_tr_b16 a[178:179], v2 offset:448
    ds_read_b64_tr_b16 a[180:181], v2 offset:704
    ds_read_b64_tr_b16 a[182:183], v2 offset:960
    ds_read_b64_tr_b16 a[184:185], v2 offset:224
    ds_read_b64_tr_b16 a[186:187], v2 offset:480
    ds_read_b64_tr_b16 a[188:189], v2 offset:736
    ds_read_b64_tr_b16 a[190:191], v2 offset:992
    s_waitcnt vmcnt(0) lgkmcnt(0)
    s_branch L2_entry
L2_codeend:

.section .rodata,"a"
.p2align 6
.amdhsa_kernel adaLN_cond__gqa_block_cached__moe_arch_mod__prompt_kernel
  .amdhsa_next_free_vgpr 512
  .amdhsa_next_free_sgpr 102
  .amdhsa_accum_offset 256
  .amdhsa_group_segment_fixed_size 0
  .amdhsa_kernarg_size 120
  .amdhsa_user_sgpr_count 2
  .amdhsa_user_sgpr_kernarg_segment_ptr 1
  .amdhsa_system_sgpr_workgroup_id_x 1
  .amdhsa_float_denorm_mode_32 3
.end_amdhsa_kernel
```

```asm
; @launch grid=(256,1,1) block=(256,1,1) lds=163840
.amdgcn_target "amdgcn-amd-amdhsa--gfx950"
.text
.globl adaLN_cond__gqa_block_cached__moe_arch_mod__prompt_kernel
.p2align 8
.type adaLN_cond__gqa_block_cached__moe_arch_mod__prompt_kernel,@function
adaLN_cond__gqa_block_cached__moe_arch_mod__prompt_kernel:
L2_begin:
    s_getpc_b64 s[98:99]
    s_cmp_ge_u32 s2, 256
    s_cbranch_scc1 L2_end
    s_load_dwordx2 s[76:77], s[0:1], 0
    s_load_dwordx2 s[16:17], s[0:1], 80
    s_load_dwordx2 s[88:89], s[0:1], 88
    s_load_dwordx2 s[12:13], s[0:1], 112
    s_load_dwordx2 s[60:61], s[0:1], 104
    s_and_b32 s3, s2, 7
    s_lshr_b32 s14, s2, 3
    v_mov_b32 v155, v0
    v_lshrrev_b32 v10, 6, v0
    v_and_b32 v0, 63, v0
    s_lshl_b32 s15, s14, 9
    v_lshl_add_u32 v13, v10, 7, s15
    v_lshl_add_u32 v13, v0, 14, v13
    v_min_u32 v13, L2_codeend-L2_begin-8, v13
    s_mov_b64 exec, 31
    global_load_dword a63, v13, s[98:99]
    s_mov_b64 exec, -1
    v_readfirstlane_b32 s51, v10
    s_and_b32 s52, s3, 3
    s_and_b32 s15, s14, 3
    s_lshl2_add_u32 s52, s52, s15
    s_lshr_b32 s53, s3, 2
    s_lshr_b32 s15, s14, 2
    s_lshl3_add_u32 s53, s53, s15
    s_lshl4_add_u32 s96, s53, s52
    s_mul_i32 s49, s3, 27
    s_max_u32 s14, s14, 5
    s_add_u32 s49, s49, s14
    s_sub_u32 s49, s49, 5
    s_lshr_b32 s55, s3, 2
    s_mul_i32 s15, s55, 108
    s_sub_u32 s50, s49, s15
    s_mul_i32 s3, s51, 288
    v_lshrrev_b32 v15, 3, v0
    v_lshl_add_u32 v12, v15, 4, s3
    v_and_b32 v15, 1, v15
    v_lshl_add_u32 v13, v15, 4, s3
    v_and_b32 v14, 7, v0
    v_mul_u32_u24 v14, 1152, v14
    v_add_u32 v1, v14, v12
    v_add_u32 v2, v14, v13
    v_add_u32 v2, 256, v2
    v_and_b32 v4, 0xfc, v155
    v_and_b32 v7, 3, v0
    v_mul_u32_u24 v3, 6912, v4
    v_lshl_add_u32 v153, v7, 4, v3
    s_mul_i32 s3, s96, 9216
    s_movk_i32 s78, 9216
    s_mov_b32 s79, 0x20000
    s_mov_b32 s91, s79
    v_lshlrev_b32 v8, 4, v0
    s_mov_b32 s86, 6553600
    s_mov_b32 s87, s79
    s_movk_i32 s62, 256
    s_mov_b32 s63, s79
    s_lshl_b32 s14, s50, 6
    s_sub_u32 s90, 1990656, s14
    s_cmp_ge_u32 s2, 40
    s_cselect_b32 s90, s90, 0
    s_mul_i32 s15, s55, 1990656
    s_add_u32 s14, s14, s15
    s_waitcnt lgkmcnt(0)
    s_add_u32 s76, s76, s3
    s_addc_u32 s77, s77, 0
    buffer_load_dwordx4 v[64:67], v1, s[76:79], 0 offen offset:0
    buffer_load_dwordx4 v[68:71], v1, s[76:79], 0 offen offset:128
    buffer_load_dwordx4 v[72:75], v2, s[76:79], 0 offen offset:0
    s_add_u32 s88, s88, s14
    s_addc_u32 s89, s89, 0
    s_mov_b64 s[84:85], s[12:13]
    s_cmp_ge_u32 s2, 8
    s_cbranch_scc1 L2_noclr
    s_cmp_lt_u32 s2, 4
    s_cselect_b32 s3, -1, 0
    v_mov_b32 v52, s3
    v_mov_b32 v53, s3
    v_mov_b32 v54, s3
    v_mov_b32 v55, s3
    s_lshl2_add_u32 s3, s2, s51
    s_mul_i32 s3, s3, 2048
    buffer_store_dwordx4 v[52:55], v8, s[84:87], s3 offen offset:0 sc1
    buffer_store_dwordx4 v[52:55], v8, s[84:87], s3 offen offset:1024 sc1
L2_noclr:
    buffer_load_dwordx4 v[128:131], v153, s[88:91], 0 offen
    s_movk_i32 s3, 6912
    buffer_load_dwordx4 v[132:135], v153, s[88:91], s3 offen
    s_movk_i32 s3, 13824
    buffer_load_dwordx4 v[136:139], v153, s[88:91], s3 offen
    s_movk_i32 s3, 20736
    buffer_load_dwordx4 v[140:143], v153, s[88:91], s3 offen
    v_lshrrev_b32 v3, 2, v3
    v_lshl_add_u32 v3, v7, 4, v3
    v_add_u32 v154, 1769472, v3
    v_lshrrev_b32 v3, 1, v4
    v_lshlrev_b32 v4, 1, v4
    s_mul_i32 s3, s55, 576
    s_add_u32 s16, s16, s3
    s_addc_u32 s17, s17, 0
    s_mov_b32 s18, 576
    s_mov_b32 s19, 0x20000
    buffer_load_dwordx2 v[148:149], v4, s[16:19], 0 offen
    v_mov_b32 v144, 0
    v_mov_b32 v145, 0
    v_mov_b32 v146, 0
    v_mov_b32 v147, 0
    v_mov_b32 v150, 0
    s_cmp_ge_u32 s51, 2
    s_cbranch_scc1 L2_w23
    buffer_load_dwordx4 v[144:147], v154, s[88:91], 0 offen
    buffer_load_ushort v150, v3, s[16:19], 0 offen offset:512
L2_w23:
    s_load_dwordx8 s[4:11], s[0:1], 8
    s_load_dwordx2 s[64:65], s[0:1], 56
    s_load_dwordx2 s[68:69], s[0:1], 64
    s_load_dwordx2 s[72:73], s[0:1], 72
    s_load_dwordx2 s[80:81], s[0:1], 96
    s_load_dwordx2 s[36:37], s[0:1], 48
    s_cmp_eq_u32 s51, 0
    s_cselect_b32 s3, 0, 0x40000000
    v_mul_u32_u24 v156, 32, v0
    v_or_b32 v156, s3, v156
    s_mul_i32 s44, s51, 4224
    s_add_u32 s44, s44, 16384
    v_lshl_add_u32 v5, v10, 12, v8
    v_lshrrev_b32 v13, 5, v0
    v_lshl_add_u32 v13, v10, 1, v13
    v_lshlrev_b32 v13, 15, v13
    v_and_b32 v14, 31, v0
    v_lshl_add_u32 v6, v14, 4, v13
    v_mov_b32 v56, 0
    v_mov_b32 v60, -1
    v_mov_b32 v57, 0
    v_mov_b32 v61, -1
    v_mov_b32 v58, 0
    v_mov_b32 v62, -1
    v_mov_b32 v59, 0
    v_mov_b32 v63, -1
    s_and_b32 s14, s53, 7
    s_lshl2_add_u32 s14, s14, s51
    v_lshrrev_b32 v13, 2, v0
    v_lshl_add_u32 v13, v13, 5, s14
    v_lshlrev_b32 v13, 13, v13
    v_lshl_add_u32 v13, v7, 7, v13
    s_waitcnt lgkmcnt(0)
    s_lshl_b32 s3, s52, 9
    s_add_u32 s24, s8, s3
    s_addc_u32 s25, s9, 0
    s_mov_b32 s26, 0
    s_mov_b32 s27, 0x20000
    s_sub_u32 s26, 4718592, s3
    s_mov_b64 exec, 0xffff
    buffer_load_dword a63, v13, s[24:27], 0 offen
    s_mov_b64 exec, -1
    s_mov_b32 s38, 1152
    s_mov_b32 s39, 0x20000
    v_and_b32 v14, 7, v0
    v_lshlrev_b32 v157, 4, v14
    v_add_u32 v157, 14080, v157
    v_lshl_add_u32 v158, v10, 2, v157
    s_mul_i32 s3, s51, 4608
    v_lshl_add_u32 v14, v14, 4, s3
    v_lshrrev_b32 v15, 3, v0
    v_lshl_add_u32 v159, v15, 8, v14
    s_lshr_b32 s3, s96, 1
    s_mul_i32 s3, s3, 18432
    s_and_b32 s14, s96, 1
    s_lshl_b32 s14, s14, 7
    s_add_u32 s3, s3, s14
    s_add_u32 s58, s3, 1048576
    s_lshl_b32 s3, s53, 2
    s_add_u32 s3, s3, s51
    s_lshl_b32 s14, s3, 4
    s_add_u32 s14, s14, s52
    s_lshl_b32 s14, s14, 7
    s_add_u32 s56, s14, 786432
    s_lshl_b32 s14, s3, 9
    s_add_u32 s59, s14, 32768
    v_and_b32 v14, 3, v0
    v_lshlrev_b32 v163, 7, v14
    s_mul_i32 s14, s3, 36864
    s_add_u32 s14, s14, 1048576
    s_add_u32 s32, s12, s14
    s_addc_u32 s33, s13, 0
    s_mov_b32 s34, 36864
    s_mov_b32 s35, 0x20000
    s_mul_i32 s15, s2, 4608
    s_mul_i32 s14, s51, 1152
    s_add_u32 s15, s15, s14
    s_add_u32 s57, s15, 98304
    s_cmp_ge_u32 s2, 144
    s_cselect_b32 s14, 0x40000000, 0
    v_or_b32 v160, s14, v8
    v_lshrrev_b32 v12, 4, v155
    v_lshlrev_b32 v12, 7, v12
    v_lshl_add_u32 v161, v7, 5, v12
    v_lshlrev_b32 v162, 2, v0
    s_mul_i32 s3, s50, 3641
    s_lshr_b32 s3, s3, 16
    s_mov_b32 s47, 1.0
    s_mov_b32 s48, 0
    s_cmp_lt_u32 s3, 2
    s_cselect_b32 s47, 0x3e0293ee, s47
    s_cmp_eq_u32 s3, 1
    s_cselect_b32 s48, 0x3e0293ee, s48
    s_cmp_eq_u32 s3, 4
    s_cselect_b32 s48, 1.0, s48
    s_cmp_eq_u32 s55, 0
    s_cselect_b32 s48, s48, 0
    s_lshl_b32 s100, s49, 7
    s_lshl_b32 s14, s96, 7
    s_add_u32 s101, s14, 32768
    s_mul_i32 s3, s51, 1152
    v_add_u32 v166, s3, v8
    s_and_b32 s3, s51, 1
    s_mul_i32 s3, s3, 2304
    s_cmp_lt_u32 s51, 2
    s_cselect_b32 s14, 32, 0
    s_add_u32 s3, s3, s14
    s_add_u32 s3, s3, 9216
    v_lshrrev_b32 v14, 1, v0
    v_lshl_add_u32 v14, v14, 6, s3
    v_and_b32 v15, 1, v0
    v_lshl_add_u32 v167, v15, 4, v14
    s_cmp_eq_u32 s51, 1
    s_cselect_b32 s3, 40, 256
    s_cmp_ge_u32 s2, s3
    s_cselect_b32 s3, 0, 0x40000000
    v_or_b32 v164, s3, v162
    v_mov_b32 v172, 0
    v_mov_b32 v180, 0
    v_mov_b32 v173, 0
    v_mov_b32 v181, 0
    v_mov_b32 v174, 0
    v_mov_b32 v182, 0
    v_mov_b32 v175, 0
    v_mov_b32 v183, 0
    s_lshl_b32 s3, s53, 2
    s_add_u32 s3, s3, s51
    v_mov_b32 v12, v10
    s_mul_i32 s14, s3, 589824
    s_mul_i32 s15, s52, 9216
    s_add_u32 s14, s14, s15
    s_add_u32 s14, s14, 8388608
    s_add_u32 s40, s12, s14
    s_addc_u32 s41, s13, 0
    s_mov_b32 s42, 0
    s_mov_b32 s43, 0x20000
    s_sub_u32 s42, 589824, s15
    s_lshl_b32 s3, s52, 19
    s_add_u32 s16, s4, s3
    s_addc_u32 s17, s5, 0
    s_mov_b32 s18, 524288
    s_mov_b32 s19, 0x20000
    s_add_u32 s20, s6, s3
    s_addc_u32 s21, s7, 0
    s_mov_b32 s22, 524288
    s_mov_b32 s23, 0x20000
    s_mul_i32 s3, s52, 294912
    s_add_u32 s28, s10, s3
    s_addc_u32 s29, s11, 0
    s_mov_b32 s30, 294912
    s_mov_b32 s31, 0x20000
    s_mov_b64 s[4:5], s[64:65]
    s_mov_b64 s[6:7], s[68:69]
    s_mov_b64 s[8:9], s[72:73]
    s_mov_b32 s50, 0
    s_mul_i32 s55, s51, 9216
    s_min_u32 s15, s2, 143
    s_and_b32 s3, s15, 7
    s_mul_i32 s3, s3, 18
    s_lshr_b32 s15, s15, 3
    s_add_u32 s15, s15, s3
    s_lshl_b32 s3, s15, 6
    s_add_u32 s64, s64, s3
    s_addc_u32 s65, s65, 0
    s_mov_b32 s66, 0
    s_mov_b32 s67, 0x20000
    s_add_u32 s68, s68, s3
    s_addc_u32 s69, s69, 0
    s_mov_b32 s70, 0
    s_mov_b32 s71, 0x20000
    s_sub_u32 s14, 5308416, s3
    s_mul_i32 s3, s15, 36864
    s_add_u32 s72, s72, s3
    s_addc_u32 s73, s73, 0
    s_mov_b32 s74, 0
    s_mov_b32 s75, 0x20000
    s_cmp_lt_u32 s2, 144
    s_cselect_b32 s66, s14, 0
    s_cselect_b32 s70, s14, 0
    s_cselect_b32 s74, 36864, 0
    s_mov_b32 s82, 2359296
    s_mov_b32 s83, 0x20000
    v_lshrrev_b32 v13, 4, v0
    v_lshlrev_b32 v9, 6, v13
    v_lshrrev_b32 v14, 2, v0
    v_mul_u32_u24 v14, 1056, v14
    v_add_u32 v14, 16384, v14
    v_and_b32 v15, 1, v0
    v_lshlrev_b32 v15, 4, v15
    v_add_u32 v3, v14, v15
    v_and_b32 v15, 2, v0
    v_lshl_add_u32 v3, v15, 2, v3
    v_add_u32 v4, 73728, v3
    v_lshrrev_b32 v14, 3, v0
    v_lshlrev_b32 v14, 2, v14
    v_add_u32 v14, v14, v12
    v_mul_u32_u24 v14, 4608, v14
    v_and_b32 v15, 7, v0
    v_lshl_add_u32 v7, v15, 4, v14
    v_lshlrev_b32 v10, 4, v15
    v_lshl_add_u32 v10, v13, 7, v10
    v_bfe_u32 v14, v0, 3, 1
    v_mul_u32_u24 v14, 147456, v14
    v_add_u32 v10, v10, v14
    v_lshrrev_b32 v14, 2, v0
    v_mul_u32_u24 v14, 1056, v14
    v_and_b32 v15, 3, v0
    v_lshl_add_u32 v14, v15, 3, v14
    v_add_u32 v2, 107008, v14
    v_and_b32 v14, 15, v0
    v_mul_u32_u24 v14, 1056, v14
    v_lshrrev_b32 v15, 4, v0
    v_lshl_add_u32 v14, v15, 4, v14
    v_add_u32 v1, 90112, v14
    v_and_b32 v14, 1, v0
    v_cmp_eq_u32 vcc, 0, v14
    v_mov_b32 v11, 0xeeeeeeee
    v_mov_b32 v15, 0x44444444
    v_cndmask_b32 v11, v11, v15, vcc
    v_and_b32 v14, 2, v0
    v_cmp_eq_u32 vcc, 0, v14
    v_mov_b32 v15, 0x3f803f80
    s_nop 0
    v_cndmask_b32 v15, 0, v15, vcc
    v_accvgpr_write_b32 a16, v15
    v_accvgpr_write_b32 a17, v15
    v_accvgpr_write_b32 a18, v15
    v_accvgpr_write_b32 a19, v15
    s_cmp_ge_u32 s2, 8
    s_cbranch_scc1 L2_noclr2
    s_mul_i32 s14, s2, 32
    s_mov_b64 exec, 1
    s_waitcnt vmcnt(6)
    s_barrier
    buffer_store_dword v60, v156, s[60:63], s14 offen sc1
    s_mov_b64 exec, -1
L2_noclr2:
    s_waitcnt vmcnt(6)
    v_lshlrev_b32 v24, 16, v64
    v_and_b32 v25, 0xffff0000, v64
    v_lshlrev_b32 v26, 16, v65
    v_and_b32 v27, 0xffff0000, v65
    v_lshlrev_b32 v28, 16, v66
    v_and_b32 v29, 0xffff0000, v66
    v_lshlrev_b32 v30, 16, v67
    v_and_b32 v31, 0xffff0000, v67
    v_lshlrev_b32 v32, 16, v68
    v_and_b32 v33, 0xffff0000, v68
    v_lshlrev_b32 v34, 16, v69
    v_and_b32 v35, 0xffff0000, v69
    v_lshlrev_b32 v36, 16, v70
    v_and_b32 v37, 0xffff0000, v70
    v_lshlrev_b32 v38, 16, v71
    v_and_b32 v39, 0xffff0000, v71
    v_lshlrev_b32 v40, 16, v72
    v_and_b32 v41, 0xffff0000, v72
    v_lshlrev_b32 v42, 16, v73
    v_and_b32 v43, 0xffff0000, v73
    v_lshlrev_b32 v44, 16, v74
    v_and_b32 v45, 0xffff0000, v74
    v_lshlrev_b32 v46, 16, v75
    v_and_b32 v47, 0xffff0000, v75
    v_add_f32 v48, v24, v25
    v_add_f32 v48, v48, v26
    v_add_f32 v48, v48, v27
    v_add_f32 v48, v48, v28
    v_add_f32 v48, v48, v29
    v_add_f32 v48, v48, v30
    v_add_f32 v48, v48, v31
    v_add_f32 v48, v48, v32
    v_add_f32 v48, v48, v33
    v_add_f32 v48, v48, v34
    v_add_f32 v48, v48, v35
    v_add_f32 v48, v48, v36
    v_add_f32 v48, v48, v37
    v_add_f32 v48, v48, v38
    v_add_f32 v48, v48, v39
    v_add_f32 v50, v40, v41
    v_add_f32 v50, v50, v42
    v_add_f32 v50, v50, v43
    v_add_f32 v50, v50, v44
    v_add_f32 v50, v50, v45
    v_add_f32 v50, v50, v46
    v_add_f32 v50, v50, v47
    v_fmac_f32 v48, 0x3e800000, v50
    s_nop 1
    v_add_f32_dpp v48, v48, v48 row_ror:8 row_mask:0xf bank_mask:0xf
    v_mov_b32 v50, v48
    s_nop 1
    v_permlane16_swap_b32 v50, v48
    v_add_f32 v48, v48, v50
    v_mov_b32 v50, v48
    s_nop 1
    v_permlane32_swap_b32 v50, v48
    v_add_f32 v48, v48, v50
    v_mul_f32 v48, 0x3be38e39, v48
    v_pk_add_f32 v[24:25], v[24:25], v[48:49] op_sel_hi:[1,0] neg_lo:[0,1] neg_hi:[0,1]
    v_pk_add_f32 v[26:27], v[26:27], v[48:49] op_sel_hi:[1,0] neg_lo:[0,1] neg_hi:[0,1]
    v_pk_add_f32 v[28:29], v[28:29], v[48:49] op_sel_hi:[1,0] neg_lo:[0,1] neg_hi:[0,1]
    v_pk_add_f32 v[30:31], v[30:31], v[48:49] op_sel_hi:[1,0] neg_lo:[0,1] neg_hi:[0,1]
    v_pk_add_f32 v[32:33], v[32:33], v[48:49] op_sel_hi:[1,0] neg_lo:[0,1] neg_hi:[0,1]
    v_pk_add_f32 v[34:35], v[34:35], v[48:49] op_sel_hi:[1,0] neg_lo:[0,1] neg_hi:[0,1]
    v_pk_add_f32 v[36:37], v[36:37], v[48:49] op_sel_hi:[1,0] neg_lo:[0,1] neg_hi:[0,1]
    v_pk_add_f32 v[38:39], v[38:39], v[48:49] op_sel_hi:[1,0] neg_lo:[0,1] neg_hi:[0,1]
    v_pk_add_f32 v[40:41], v[40:41], v[48:49] op_sel_hi:[1,0] neg_lo:[0,1] neg_hi:[0,1]
    v_pk_add_f32 v[42:43], v[42:43], v[48:49] op_sel_hi:[1,0] neg_lo:[0,1] neg_hi:[0,1]
    v_pk_add_f32 v[44:45], v[44:45], v[48:49] op_sel_hi:[1,0] neg_lo:[0,1] neg_hi:[0,1]
    v_pk_add_f32 v[46:47], v[46:47], v[48:49] op_sel_hi:[1,0] neg_lo:[0,1] neg_hi:[0,1]
    v_mul_f32 v49, v24, v24
    v_fmac_f32 v49, v25, v25
    v_fmac_f32 v49, v26, v26
    v_fmac_f32 v49, v27, v27
    v_fmac_f32 v49, v28, v28
    v_fmac_f32 v49, v29, v29
    v_fmac_f32 v49, v30, v30
    v_fmac_f32 v49, v31, v31
    v_fmac_f32 v49, v32, v32
    v_fmac_f32 v49, v33, v33
    v_fmac_f32 v49, v34, v34
    v_fmac_f32 v49, v35, v35
    v_fmac_f32 v49, v36, v36
    v_fmac_f32 v49, v37, v37
    v_fmac_f32 v49, v38, v38
    v_fmac_f32 v49, v39, v39
    v_mul_f32 v50, v40, v40
    v_fmac_f32 v50, v41, v41
    v_fmac_f32 v50, v42, v42
    v_fmac_f32 v50, v43, v43
    v_fmac_f32 v50, v44, v44
    v_fmac_f32 v50, v45, v45
    v_fmac_f32 v50, v46, v46
    v_fmac_f32 v50, v47, v47
    v_fmac_f32 v49, 0x3e800000, v50
    s_nop 1
    v_add_f32_dpp v49, v49, v49 row_ror:8 row_mask:0xf bank_mask:0xf
    v_mov_b32 v50, v49
    s_nop 1
    v_permlane16_swap_b32 v50, v49
    v_add_f32 v49, v49, v50
    v_mov_b32 v50, v49
    s_nop 1
    v_permlane32_swap_b32 v50, v49
    v_add_f32 v49, v49, v50
    ds_write_b32 v158, v48
    ds_write_b32 v158, v49 offset:128
    s_waitcnt lgkmcnt(0)
    s_barrier
    ds_read_b128 v[16:19], v157
    ds_read_b128 v[20:23], v157 offset:128
    s_add_u32 s14, s58, 4096
    s_waitcnt lgkmcnt(1)
    v_add_f32 v12, v16, v17
    v_add_f32 v13, v18, v19
    v_add_f32 v12, v12, v13
    v_mul_f32 v12, 0x3e800000, v12
    v_sub_f32 v16, v16, v12
    v_sub_f32 v17, v17, v12
    v_sub_f32 v18, v18, v12
    v_sub_f32 v19, v19, v12
    v_sub_f32 v48, v48, v12
    v_mul_f32 v13, v16, v16
    v_fmac_f32 v13, v17, v17
    v_fmac_f32 v13, v18, v18
    v_fmac_f32 v13, v19, v19
    s_waitcnt lgkmcnt(0)
    v_add_f32 v14, v20, v21
    v_add_f32 v15, v22, v23
    v_add_f32 v14, v14, v15
    v_fmac_f32 v14, 0x43100000, v13
    v_mov_b32 v12, 0x3727c5ac
    v_fmac_f32 v12, 0x3ae38e39, v14
    v_rsq_f32 v12, v12
    s_nop 0
    v_mul_f32 v48, v48, v12
    v_pk_fma_f32 v[24:25], v[24:25], v[12:13], v[48:49] op_sel_hi:[1,0,0]
    v_pk_fma_f32 v[26:27], v[26:27], v[12:13], v[48:49] op_sel_hi:[1,0,0]
    v_pk_fma_f32 v[28:29], v[28:29], v[12:13], v[48:49] op_sel_hi:[1,0,0]
    v_pk_fma_f32 v[30:31], v[30:31], v[12:13], v[48:49] op_sel_hi:[1,0,0]
    v_cvt_pk_f16_f32 v64, v24, v25
    v_cvt_pk_f16_f32 v65, v26, v27
    v_cvt_pk_f16_f32 v66, v28, v29
    v_cvt_pk_f16_f32 v67, v30, v31
    buffer_store_dwordx4 v[64:67], v159, s[84:87], s58 offen offset:0 sc1
    v_pk_fma_f32 v[32:33], v[32:33], v[12:13], v[48:49] op_sel_hi:[1,0,0]
    v_pk_fma_f32 v[34:35], v[34:35], v[12:13], v[48:49] op_sel_hi:[1,0,0]
    v_pk_fma_f32 v[36:37], v[36:37], v[12:13], v[48:49] op_sel_hi:[1,0,0]
    v_pk_fma_f32 v[38:39], v[38:39], v[12:13], v[48:49] op_sel_hi:[1,0,0]
    v_cvt_pk_f16_f32 v68, v32, v33
    v_cvt_pk_f16_f32 v69, v34, v35
    v_cvt_pk_f16_f32 v70, v36, v37
    v_cvt_pk_f16_f32 v71, v38, v39
    buffer_store_dwordx4 v[68:71], v159, s[84:87], s58 offen offset:2048 sc1
    v_pk_fma_f32 v[40:41], v[40:41], v[12:13], v[48:49] op_sel_hi:[1,0,0]
    v_pk_fma_f32 v[42:43], v[42:43], v[12:13], v[48:49] op_sel_hi:[1,0,0]
    v_pk_fma_f32 v[44:45], v[44:45], v[12:13], v[48:49] op_sel_hi:[1,0,0]
    v_pk_fma_f32 v[46:47], v[46:47], v[12:13], v[48:49] op_sel_hi:[1,0,0]
    v_cvt_pk_f16_f32 v72, v40, v41
    v_cvt_pk_f16_f32 v73, v42, v43
    v_cvt_pk_f16_f32 v74, v44, v45
    v_cvt_pk_f16_f32 v75, v46, v47
    s_mov_b64 exec, 0xffff
    buffer_store_dwordx4 v[72:75], v159, s[84:87], s14 offen offset:0 sc1
    s_mov_b64 exec, 0xff
    buffer_store_dwordx4 v[56:59], v8, s[84:87], s56 offen sc1
    buffer_store_dwordx4 v[60:63], v160, s[84:87], s57 offen offset:1024 sc1
    s_mov_b64 exec, -1
    buffer_store_dwordx4 v[60:63], v160, s[84:87], s57 offen sc1
    s_mov_b64 exec, 255
    buffer_load_dword v51, v156, s[60:63], 0 offen sc1
    s_mov_b64 exec, -1
    s_mul_i32 s3, s96, 147456
    s_add_u32 s3, s3, 8388608
    s_add_u32 s88, s12, s3
    s_addc_u32 s89, s13, 0
    s_mov_b32 s90, 147456
    s_mov_b32 s91, 0x20000
    s_waitcnt vmcnt(7)
    v_lshlrev_b32 v40, 16, v148
    v_and_b32 v41, 0xffff0000, v148
    v_lshlrev_b32 v42, 16, v149
    v_and_b32 v43, 0xffff0000, v149
    v_lshlrev_b32 v44, 16, v150
    v_mul_f32 v16, 0xbfb8aa3b, v40
    v_mul_f32 v17, 0xbfb8aa3b, v41
    v_mul_f32 v18, 0xbfb8aa3b, v42
    v_mul_f32 v19, 0xbfb8aa3b, v43
    v_mul_f32 v20, 0xbfb8aa3b, v44
    v_exp_f32 v16, v16
    v_exp_f32 v17, v17
    v_exp_f32 v18, v18
    v_exp_f32 v19, v19
    v_exp_f32 v20, v20
    v_add_f32 v16, 1.0, v16
    v_add_f32 v17, 1.0, v17
    v_add_f32 v18, 1.0, v18
    v_add_f32 v19, 1.0, v19
    v_add_f32 v20, 1.0, v20
    v_rcp_f32 v16, v16
    v_rcp_f32 v17, v17
    v_rcp_f32 v18, v18
    v_rcp_f32 v19, v19
    v_rcp_f32 v20, v20
    v_mul_f32 v24, v40, v16
    v_mul_f32 v26, v41, v17
    v_mul_f32 v28, v42, v18
    v_mul_f32 v30, v43, v19
    v_mul_f32 v32, v44, v20
    v_lshlrev_b32 v12, 16, v128
    v_and_b32 v13, 0xffff0000, v128
    v_pk_mul_f32 v[16:17], v[12:13], v[24:25] op_sel_hi:[1,0]
    v_lshlrev_b32 v14, 16, v129
    v_and_b32 v15, 0xffff0000, v129
    v_pk_mul_f32 v[18:19], v[14:15], v[24:25] op_sel_hi:[1,0]
    v_lshlrev_b32 v12, 16, v130
    v_and_b32 v13, 0xffff0000, v130
    v_pk_mul_f32 v[20:21], v[12:13], v[24:25] op_sel_hi:[1,0]
    v_lshlrev_b32 v14, 16, v131
    v_and_b32 v15, 0xffff0000, v131
    v_pk_mul_f32 v[22:23], v[14:15], v[24:25] op_sel_hi:[1,0]
    v_lshlrev_b32 v12, 16, v132
    v_and_b32 v13, 0xffff0000, v132
    v_pk_fma_f32 v[16:17], v[12:13], v[26:27], v[16:17] op_sel_hi:[1,0,1]
    v_lshlrev_b32 v14, 16, v133
    v_and_b32 v15, 0xffff0000, v133
    v_pk_fma_f32 v[18:19], v[14:15], v[26:27], v[18:19] op_sel_hi:[1,0,1]
    v_lshlrev_b32 v12, 16, v134
    v_and_b32 v13, 0xffff0000, v134
    v_pk_fma_f32 v[20:21], v[12:13], v[26:27], v[20:21] op_sel_hi:[1,0,1]
    v_lshlrev_b32 v14, 16, v135
    v_and_b32 v15, 0xffff0000, v135
    v_pk_fma_f32 v[22:23], v[14:15], v[26:27], v[22:23] op_sel_hi:[1,0,1]
    v_lshlrev_b32 v12, 16, v136
    v_and_b32 v13, 0xffff0000, v136
    v_pk_fma_f32 v[16:17], v[12:13], v[28:29], v[16:17] op_sel_hi:[1,0,1]
    v_lshlrev_b32 v14, 16, v137
    v_and_b32 v15, 0xffff0000, v137
    v_pk_fma_f32 v[18:19], v[14:15], v[28:29], v[18:19] op_sel_hi:[1,0,1]
    v_lshlrev_b32 v12, 16, v138
    v_and_b32 v13, 0xffff0000, v138
    v_pk_fma_f32 v[20:21], v[12:13], v[28:29], v[20:21] op_sel_hi:[1,0,1]
    v_lshlrev_b32 v14, 16, v139
    v_and_b32 v15, 0xffff0000, v139
    v_pk_fma_f32 v[22:23], v[14:15], v[28:29], v[22:23] op_sel_hi:[1,0,1]
    v_lshlrev_b32 v12, 16, v140
    v_and_b32 v13, 0xffff0000, v140
    v_pk_fma_f32 v[16:17], v[12:13], v[30:31], v[16:17] op_sel_hi:[1,0,1]
    v_lshlrev_b32 v14, 16, v141
    v_and_b32 v15, 0xffff0000, v141
    v_pk_fma_f32 v[18:19], v[14:15], v[30:31], v[18:19] op_sel_hi:[1,0,1]
    v_lshlrev_b32 v12, 16, v142
    v_and_b32 v13, 0xffff0000, v142
    v_pk_fma_f32 v[20:21], v[12:13], v[30:31], v[20:21] op_sel_hi:[1,0,1]
    v_lshlrev_b32 v14, 16, v143
    v_and_b32 v15, 0xffff0000, v143
    v_pk_fma_f32 v[22:23], v[14:15], v[30:31], v[22:23] op_sel_hi:[1,0,1]
    v_lshlrev_b32 v12, 16, v144
    v_and_b32 v13, 0xffff0000, v144
    v_pk_fma_f32 v[16:17], v[12:13], v[32:33], v[16:17] op_sel_hi:[1,0,1]
    v_lshlrev_b32 v14, 16, v145
    v_and_b32 v15, 0xffff0000, v145
    v_pk_fma_f32 v[18:19], v[14:15], v[32:33], v[18:19] op_sel_hi:[1,0,1]
    v_lshlrev_b32 v12, 16, v146
    v_and_b32 v13, 0xffff0000, v146
    v_pk_fma_f32 v[20:21], v[12:13], v[32:33], v[20:21] op_sel_hi:[1,0,1]
    v_lshlrev_b32 v14, 16, v147
    v_and_b32 v15, 0xffff0000, v147
    v_pk_fma_f32 v[22:23], v[14:15], v[32:33], v[22:23] op_sel_hi:[1,0,1]
    v_add_f32_dpp v16, v16, v16 row_ror:4 row_mask:0xf bank_mask:0xf
    v_add_f32_dpp v17, v17, v17 row_ror:4 row_mask:0xf bank_mask:0xf
    v_add_f32_dpp v18, v18, v18 row_ror:4 row_mask:0xf bank_mask:0xf
    v_add_f32_dpp v19, v19, v19 row_ror:4 row_mask:0xf bank_mask:0xf
    v_add_f32_dpp v20, v20, v20 row_ror:4 row_mask:0xf bank_mask:0xf
    v_add_f32_dpp v21, v21, v21 row_ror:4 row_mask:0xf bank_mask:0xf
    v_add_f32_dpp v22, v22, v22 row_ror:4 row_mask:0xf bank_mask:0xf
    v_add_f32_dpp v23, v23, v23 row_ror:4 row_mask:0xf bank_mask:0xf
    v_add_f32_dpp v16, v16, v16 row_ror:8 row_mask:0xf bank_mask:0xf
    v_add_f32_dpp v17, v17, v17 row_ror:8 row_mask:0xf bank_mask:0xf
    v_add_f32_dpp v18, v18, v18 row_ror:8 row_mask:0xf bank_mask:0xf
    v_add_f32_dpp v19, v19, v19 row_ror:8 row_mask:0xf bank_mask:0xf
    v_add_f32_dpp v20, v20, v20 row_ror:8 row_mask:0xf bank_mask:0xf
    v_add_f32_dpp v21, v21, v21 row_ror:8 row_mask:0xf bank_mask:0xf
    v_add_f32_dpp v22, v22, v22 row_ror:8 row_mask:0xf bank_mask:0xf
    v_add_f32_dpp v23, v23, v23 row_ror:8 row_mask:0xf bank_mask:0xf
    s_mov_b32 exec_lo, 0xf000f
    s_mov_b32 exec_hi, 0xf000f
    ds_write_b128 v161, v[16:19] offset:16384
    ds_write_b128 v161, v[20:23] offset:16400
    s_mov_b64 exec, 255
    s_waitcnt vmcnt(0)
    v_cmp_eq_u32 vcc, s51, v51
    s_nop 0
    s_cmp_lg_u64 vcc, 0
    s_cbranch_scc1 L2_p0s
L2_p0r:
    s_mov_b64 exec, 1
    s_waitcnt lgkmcnt(0)
    s_barrier
    buffer_store_dword v60, v156, s[84:87], s101 offen sc1
    s_mov_b64 exec, -1
    ds_read_b32 v24, v162 offset:16384
    ds_read_b32 v25, v162 offset:16640
    ds_read_b32 v26, v162 offset:16896
    ds_read_b32 v27, v162 offset:17152
    ds_read_b32 v28, v162 offset:17408
    ds_read_b32 v29, v162 offset:17664
    ds_read_b32 v30, v162 offset:17920
    ds_read_b32 v31, v162 offset:18176
    s_waitcnt lgkmcnt(0)
    v_pk_add_f32 v[24:25], v[24:25], v[26:27]
    v_pk_add_f32 v[28:29], v[28:29], v[30:31]
    v_pk_add_f32 v[24:25], v[24:25], v[28:29]
    v_add_f32 v52, v24, v25
    v_mov_b32 v53, v52
    v_mov_b32 v54, s48
    s_nop 0
    v_permlane32_swap_b32 v53, v52
    v_add_f32 v52, v52, v53
    v_fma_f32 v52, v52, s47, v54
    v_min_u32 v52, -2, v52
    s_mov_b32 exec_hi, 0
    buffer_store_dword v52, v164, s[84:87], s100 offen sc1
    s_mov_b64 exec, -1
    s_add_u32 m0, s44, 36864
    s_mov_b32 s45, 0
    buffer_load_dwordx4 v6, s[24:27], s45 offen lds
    s_add_u32 m0, s44, 37920
    s_mov_b32 s45, 8192
    buffer_load_dwordx4 v6, s[24:27], s45 offen lds
    s_add_u32 m0, s44, 38976
    s_mov_b32 s45, 16384
    buffer_load_dwordx4 v6, s[24:27], s45 offen lds
    s_add_u32 m0, s44, 40032
    s_mov_b32 s45, 24576
    buffer_load_dwordx4 v6, s[24:27], s45 offen lds
    s_add_u32 m0, s44, 53760
    s_mov_b32 s45, 262144
    buffer_load_dwordx4 v6, s[24:27], s45 offen lds
    s_add_u32 m0, s44, 54816
    s_mov_b32 s45, 270336
    buffer_load_dwordx4 v6, s[24:27], s45 offen lds
    s_add_u32 m0, s44, 55872
    s_mov_b32 s45, 278528
    buffer_load_dwordx4 v6, s[24:27], s45 offen lds
    s_add_u32 m0, s44, 56928
    s_mov_b32 s45, 286720
    buffer_load_dwordx4 v6, s[24:27], s45 offen lds
    s_add_u32 m0, s44, 73728
    s_mov_b32 s45, 524288
    buffer_load_dwordx4 v6, s[24:27], s45 offen lds
    s_add_u32 m0, s44, 74784
    s_mov_b32 s45, 532480
    buffer_load_dwordx4 v6, s[24:27], s45 offen lds
    s_add_u32 m0, s44, 75840
    s_mov_b32 s45, 540672
    buffer_load_dwordx4 v6, s[24:27], s45 offen lds
    s_add_u32 m0, s44, 76896
    s_mov_b32 s45, 548864
    buffer_load_dwordx4 v6, s[24:27], s45 offen lds
    s_add_u32 m0, s44, 90624
    s_mov_b32 s45, 786432
    buffer_load_dwordx4 v6, s[24:27], s45 offen lds
    s_add_u32 m0, s44, 91680
    s_mov_b32 s45, 794624
    buffer_load_dwordx4 v6, s[24:27], s45 offen lds
    s_add_u32 m0, s44, 92736
    s_mov_b32 s45, 802816
    buffer_load_dwordx4 v6, s[24:27], s45 offen lds
    s_add_u32 m0, s44, 93792
    s_mov_b32 s45, 811008
    buffer_load_dwordx4 v6, s[24:27], s45 offen lds
    s_mov_b64 exec, 15
    s_mov_b32 s97, 0x20000
L2_px:
    buffer_load_dword v13, v163, s[84:87], s59 offen sc1
    s_waitcnt vmcnt(0)
    v_cmp_eq_u32 vcc, 0, v13
    s_sub_u32 s97, s97, 1
    s_cselect_b64 vcc, 0, vcc
    s_cmp_eq_u64 vcc, 0
    s_cbranch_scc1 L2_px_ok
    s_sleep 1
    s_branch L2_px
L2_px_ok:
    s_mov_b64 exec, -1
    s_movk_i32 s14, 13824
    buffer_load_dwordx4 v[168:171], v166, s[84:87], 0 offen sc1
    buffer_load_dwordx4 v[176:179], v166, s[84:87], s14 offen sc1
    s_mov_b64 exec, 0xff
    buffer_load_dwordx4 v[172:175], v166, s[84:87], 0 offen offset:1024 sc1
    buffer_load_dwordx4 v[180:183], v166, s[84:87], s14 offen offset:1024 sc1
    s_mov_b64 exec, -1
    s_mov_b32 s54, 0
    buffer_load_dwordx4 v[80:83], v8, s[32:35], s54 offen sc1
    s_mov_b32 s54, 1024
    buffer_load_dwordx4 v[84:87], v8, s[32:35], s54 offen sc1
    s_mov_b32 s54, 18432
    buffer_load_dwordx4 v[88:91], v8, s[32:35], s54 offen sc1
    s_mov_b32 s54, 19456
    buffer_load_dwordx4 v[92:95], v8, s[32:35], s54 offen sc1
    s_mov_b32 s54, 2048
    buffer_load_dwordx4 v[96:99], v8, s[32:35], s54 offen sc1
    s_mov_b32 s54, 3072
    buffer_load_dwordx4 v[100:103], v8, s[32:35], s54 offen sc1
    s_mov_b32 s54, 20480
    buffer_load_dwordx4 v[104:107], v8, s[32:35], s54 offen sc1
    s_mov_b32 s54, 21504
    buffer_load_dwordx4 v[108:111], v8, s[32:35], s54 offen sc1
    s_waitcnt vmcnt(8)
    v_max_u32 v13, v168, v169
    v_max3_u32 v13, v13, v170, v171
    v_max3_u32 v13, v13, v172, v173
    v_max3_u32 v13, v13, v174, v175
    v_max3_u32 v13, v13, v176, v177
    v_max3_u32 v13, v13, v178, v179
    v_max3_u32 v13, v13, v180, v181
    v_max3_u32 v13, v13, v182, v183
    v_cmp_eq_u32 vcc, -1, v13
    s_nop 0
    s_cmp_lg_u64 vcc, 0
    s_cbranch_scc1 L2_pms
L2_pmr:
    v_pk_add_f32 v[168:169], v[168:169], v[176:177]
    v_pk_add_f32 v[170:171], v[170:171], v[178:179]
    v_pk_add_f32 v[172:173], v[172:173], v[180:181]
    v_pk_add_f32 v[174:175], v[174:175], v[182:183]
    ds_write_b128 v167, v[168:171]
    s_mov_b64 exec, 0xff
    ds_write_b128 v167, v[172:175] offset:2048
    s_mov_b64 exec, -1
    s_mov_b32 s54, 4096
    buffer_load_dwordx4 v[112:115], v8, s[32:35], s54 offen sc1
    s_mov_b32 s54, 5120
    buffer_load_dwordx4 v[116:119], v8, s[32:35], s54 offen sc1
    s_mov_b32 s54, 22528
    buffer_load_dwordx4 v[120:123], v8, s[32:35], s54 offen sc1
    s_mov_b32 s54, 23552
    buffer_load_dwordx4 v[124:127], v8, s[32:35], s54 offen sc1
    s_waitcnt lgkmcnt(0)
    s_barrier
    ds_read_b128 v[16:19], v9 offset:9216
    ds_read_b128 v[20:23], v9 offset:9248
    ds_read_b128 v[24:27], v9 offset:9232
    ds_read_b128 v[28:31], v9 offset:9264
    s_waitcnt vmcnt(8)
    s_waitcnt lgkmcnt(2)
    v_fma_mix_f32 v32, v80, v16, v20 op_sel:[0,0,0] op_sel_hi:[1,0,0]
    v_fma_mix_f32 v33, v80, v17, v21 op_sel:[1,0,0] op_sel_hi:[1,0,0]
    v_fma_mix_f32 v34, v81, v18, v22 op_sel:[0,0,0] op_sel_hi:[1,0,0]
    v_fma_mix_f32 v35, v81, v19, v23 op_sel:[1,0,0] op_sel_hi:[1,0,0]
    v_cvt_pk_bf16_f32 v80, v32, v33
    v_cvt_pk_bf16_f32 v81, v34, v35
    v_fma_mix_f32 v36, v88, v16, v20 op_sel:[0,0,0] op_sel_hi:[1,0,0]
    v_fma_mix_f32 v37, v88, v17, v21 op_sel:[1,0,0] op_sel_hi:[1,0,0]
    v_fma_mix_f32 v38, v89, v18, v22 op_sel:[0,0,0] op_sel_hi:[1,0,0]
    v_fma_mix_f32 v39, v89, v19, v23 op_sel:[1,0,0] op_sel_hi:[1,0,0]
    v_cvt_pk_bf16_f32 v88, v36, v37
    v_cvt_pk_bf16_f32 v89, v38, v39
    ds_read_b128 v[16:19], v9 offset:9472
    ds_read_b128 v[20:23], v9 offset:9504
    s_waitcnt lgkmcnt(2)
    v_fma_mix_f32 v32, v82, v24, v28 op_sel:[0,0,0] op_sel_hi:[1,0,0]
    v_fma_mix_f32 v33, v82, v25, v29 op_sel:[1,0,0] op_sel_hi:[1,0,0]
    v_fma_mix_f32 v34, v83, v26, v30 op_sel:[0,0,0] op_sel_hi:[1,0,0]
    v_fma_mix_f32 v35, v83, v27, v31 op_sel:[1,0,0] op_sel_hi:[1,0,0]
    v_cvt_pk_bf16_f32 v82, v32, v33
    v_cvt_pk_bf16_f32 v83, v34, v35
    v_fma_mix_f32 v36, v90, v24, v28 op_sel:[0,0,0] op_sel_hi:[1,0,0]
    v_fma_mix_f32 v37, v90, v25, v29 op_sel:[1,0,0] op_sel_hi:[1,0,0]
    v_fma_mix_f32 v38, v91, v26, v30 op_sel:[0,0,0] op_sel_hi:[1,0,0]
    v_fma_mix_f32 v39, v91, v27, v31 op_sel:[1,0,0] op_sel_hi:[1,0,0]
    v_cvt_pk_bf16_f32 v90, v36, v37
    v_cvt_pk_bf16_f32 v91, v38, v39
    ds_read_b128 v[24:27], v9 offset:9488
    ds_read_b128 v[28:31], v9 offset:9520
    s_waitcnt lgkmcnt(2)
    v_fma_mix_f32 v32, v84, v16, v20 op_sel:[0,0,0] op_sel_hi:[1,0,0]
    v_fma_mix_f32 v33, v84, v17, v21 op_sel:[1,0,0] op_sel_hi:[1,0,0]
    v_fma_mix_f32 v34, v85, v18, v22 op_sel:[0,0,0] op_sel_hi:[1,0,0]
    v_fma_mix_f32 v35, v85, v19, v23 op_sel:[1,0,0] op_sel_hi:[1,0,0]
    v_cvt_pk_bf16_f32 v84, v32, v33
    v_cvt_pk_bf16_f32 v85, v34, v35
    v_fma_mix_f32 v36, v92, v16, v20 op_sel:[0,0,0] op_sel_hi:[1,0,0]
    v_fma_mix_f32 v37, v92, v17, v21 op_sel:[1,0,0] op_sel_hi:[1,0,0]
    v_fma_mix_f32 v38, v93, v18, v22 op_sel:[0,0,0] op_sel_hi:[1,0,0]
    v_fma_mix_f32 v39, v93, v19, v23 op_sel:[1,0,0] op_sel_hi:[1,0,0]
    v_cvt_pk_bf16_f32 v92, v36, v37
    v_cvt_pk_bf16_f32 v93, v38, v39
    ds_read_b128 v[16:19], v9 offset:9728
    ds_read_b128 v[20:23], v9 offset:9760
    ds_read_b64_tr_b16 a[192:193], v3 offset:36864
    ds_read_b64_tr_b16 a[194:195], v3 offset:37376
    ds_read_b64_tr_b16 a[196:197], v3 offset:53760
    ds_read_b64_tr_b16 a[198:199], v3 offset:54272
    ds_read_b64_tr_b16 a[200:201], v3 offset:36896
    ds_read_b64_tr_b16 a[202:203], v3 offset:37408
    ds_read_b64_tr_b16 a[204:205], v3 offset:53792
    ds_read_b64_tr_b16 a[206:207], v3 offset:54304
    ds_read_b64_tr_b16 a[208:209], v3 offset:36928
    ds_read_b64_tr_b16 a[210:211], v3 offset:37440
    ds_read_b64_tr_b16 a[212:213], v3 offset:53824
    ds_read_b64_tr_b16 a[214:215], v3 offset:54336
    s_waitcnt lgkmcnt(14)
    v_fma_mix_f32 v32, v86, v24, v28 op_sel:[0,0,0] op_sel_hi:[1,0,0]
    v_fma_mix_f32 v33, v86, v25, v29 op_sel:[1,0,0] op_sel_hi:[1,0,0]
    v_fma_mix_f32 v34, v87, v26, v30 op_sel:[0,0,0] op_sel_hi:[1,0,0]
    v_fma_mix_f32 v35, v87, v27, v31 op_sel:[1,0,0] op_sel_hi:[1,0,0]
    v_cvt_pk_bf16_f32 v86, v32, v33
    v_cvt_pk_bf16_f32 v87, v34, v35
    v_fma_mix_f32 v36, v94, v24, v28 op_sel:[0,0,0] op_sel_hi:[1,0,0]
    v_fma_mix_f32 v37, v94, v25, v29 op_sel:[1,0,0] op_sel_hi:[1,0,0]
    v_fma_mix_f32 v38, v95, v26, v30 op_sel:[0,0,0] op_sel_hi:[1,0,0]
    v_fma_mix_f32 v39, v95, v27, v31 op_sel:[1,0,0] op_sel_hi:[1,0,0]
    v_cvt_pk_bf16_f32 v94, v36, v37
    v_cvt_pk_bf16_f32 v95, v38, v39
    s_waitcnt lgkmcnt(8)
    v_mfma_f32_16x16x32_bf16 v[128:131], a[192:195], v[80:83], 0
    s_waitcnt vmcnt(4)
    ds_read_b64_tr_b16 a[216:217], v3 offset:36960
    ds_read_b128 v[24:27], v9 offset:9744
    v_mfma_f32_16x16x32_bf16 v[128:131], a[196:199], v[84:87], v[128:131]
    ds_read_b64_tr_b16 a[218:219], v3 offset:37472
    ds_read_b64_tr_b16 a[220:221], v3 offset:53856
    v_fma_mix_f32 v32, v96, v16, v20 op_sel:[0,0,0] op_sel_hi:[1,0,0]
    v_mfma_f32_16x16x32_bf16 v[160:163], a[192:195], v[88:91], 0
    s_add_u32 m0, s44, 110592
    ds_read_b64_tr_b16 a[222:223], v3 offset:54368
    ds_read_b128 v[28:31], v9 offset:9776
    v_mfma_f32_16x16x32_bf16 v[160:163], a[196:199], v[92:95], v[160:163]
    s_mov_b32 s45, 1048576
    s_waitcnt lgkmcnt(10)
    buffer_load_dwordx4 v6, s[24:27], s45 offen lds
    v_mfma_f32_16x16x32_bf16 v[132:135], a[200:203], v[80:83], 0
    ds_read_b64_tr_b16 a[224:225], v3 offset:36992
    v_fma_mix_f32 v33, v96, v17, v21 op_sel:[1,0,0] op_sel_hi:[1,0,0]
    v_mfma_f32_16x16x32_bf16 v[132:135], a[204:207], v[84:87], v[132:135]
    ds_read_b64_tr_b16 a[226:227], v3 offset:37504
    ds_read_b64_tr_b16 a[228:229], v3 offset:53888
    v_fma_mix_f32 v34, v97, v18, v22 op_sel:[0,0,0] op_sel_hi:[1,0,0]
    v_mfma_f32_16x16x32_bf16 v[164:167], a[200:203], v[88:91], 0
    s_add_u32 m0, s44, 111648
    ds_read_b64_tr_b16 a[230:231], v3 offset:54400
    v_fma_mix_f32 v35, v97, v19, v23 op_sel:[1,0,0] op_sel_hi:[1,0,0]
    v_mfma_f32_16x16x32_bf16 v[164:167], a[204:207], v[92:95], v[164:167]
    s_mov_b32 s45, 1056768
    s_waitcnt lgkmcnt(10)
    buffer_load_dwordx4 v6, s[24:27], s45 offen lds
    v_mfma_f32_16x16x32_bf16 v[136:139], a[208:211], v[80:83], 0
    ds_read_b64_tr_b16 a[232:233], v3 offset:37024
    v_cvt_pk_bf16_f32 v96, v32, v33
    v_mfma_f32_16x16x32_bf16 v[136:139], a[212:215], v[84:87], v[136:139]
    ds_read_b64_tr_b16 a[234:235], v3 offset:37536
    ds_read_b64_tr_b16 a[236:237], v3 offset:53920
    v_cvt_pk_bf16_f32 v97, v34, v35
    v_mfma_f32_16x16x32_bf16 v[168:171], a[208:211], v[88:91], 0
    s_add_u32 m0, s44, 112704
    ds_read_b64_tr_b16 a[238:239], v3 offset:54432
    v_fma_mix_f32 v36, v104, v16, v20 op_sel:[0,0,0] op_sel_hi:[1,0,0]
    v_mfma_f32_16x16x32_bf16 v[168:171], a[212:215], v[92:95], v[168:171]
    s_mov_b32 s45, 1064960
    s_waitcnt lgkmcnt(9)
    buffer_load_dwordx4 v6, s[24:27], s45 offen lds
    v_fma_mix_f32 v37, v104, v17, v21 op_sel:[1,0,0] op_sel_hi:[1,0,0]
    v_mfma_f32_16x16x32_bf16 v[140:143], a[216:219], v[80:83], 0
    ds_read_b64_tr_b16 a[240:241], v3 offset:37056
    v_fma_mix_f32 v38, v105, v18, v22 op_sel:[0,0,0] op_sel_hi:[1,0,0]
    v_mfma_f32_16x16x32_bf16 v[140:143], a[220:223], v[84:87], v[140:143]
    ds_read_b64_tr_b16 a[242:243], v3 offset:37568
    ds_read_b64_tr_b16 a[244:245], v3 offset:53952
    v_fma_mix_f32 v39, v105, v19, v23 op_sel:[1,0,0] op_sel_hi:[1,0,0]
    v_mfma_f32_16x16x32_bf16 v[172:175], a[216:219], v[88:91], 0
    s_add_u32 m0, s44, 113760
    ds_read_b64_tr_b16 a[246:247], v3 offset:54464
    v_cvt_pk_bf16_f32 v104, v36, v37
    v_mfma_f32_16x16x32_bf16 v[172:175], a[220:223], v[92:95], v[172:175]
    s_mov_b32 s45, 1073152
    s_waitcnt lgkmcnt(8)
    buffer_load_dwordx4 v6, s[24:27], s45 offen lds
    v_cvt_pk_bf16_f32 v105, v38, v39
    v_mfma_f32_16x16x32_bf16 v[144:147], a[224:227], v[80:83], 0
    ds_read_b64_tr_b16 a[248:249], v3 offset:37088
    ds_read_b128 v[16:19], v9 offset:9984
    v_mfma_f32_16x16x32_bf16 v[144:147], a[228:231], v[84:87], v[144:147]
    ds_read_b64_tr_b16 a[250:251], v3 offset:37600
    ds_read_b64_tr_b16 a[252:253], v3 offset:53984
    v_fma_mix_f32 v32, v98, v24, v28 op_sel:[0,0,0] op_sel_hi:[1,0,0]
    v_mfma_f32_16x16x32_bf16 v[176:179], a[224:227], v[88:91], 0
    s_add_u32 m0, s44, 127488
    ds_read_b64_tr_b16 a[254:255], v3 offset:54496
    ds_read_b128 v[20:23], v9 offset:10016
    v_mfma_f32_16x16x32_bf16 v[176:179], a[228:231], v[92:95], v[176:179]
    s_mov_b32 s45, 1310720
    s_waitcnt lgkmcnt(10)
    buffer_load_dwordx4 v6, s[24:27], s45 offen lds
    v_mfma_f32_16x16x32_bf16 v[148:151], a[232:235], v[80:83], 0
    ds_read_b64_tr_b16 a[192:193], v3 offset:37120
    v_fma_mix_f32 v33, v98, v25, v29 op_sel:[1,0,0] op_sel_hi:[1,0,0]
    v_mfma_f32_16x16x32_bf16 v[148:151], a[236:239], v[84:87], v[148:151]
    ds_read_b64_tr_b16 a[194:195], v3 offset:37632
    ds_read_b64_tr_b16 a[196:197], v3 offset:54016
    v_fma_mix_f32 v34, v99, v26, v30 op_sel:[0,0,0] op_sel_hi:[1,0,0]
    v_mfma_f32_16x16x32_bf16 v[180:183], a[232:235], v[88:91], 0
    s_add_u32 m0, s44, 128544
    ds_read_b64_tr_b16 a[198:199], v3 offset:54528
    v_fma_mix_f32 v35, v99, v27, v31 op_sel:[1,0,0] op_sel_hi:[1,0,0]
    v_mfma_f32_16x16x32_bf16 v[180:183], a[236:239], v[92:95], v[180:183]
    s_mov_b32 s45, 1318912
    s_waitcnt lgkmcnt(10)
    buffer_load_dwordx4 v6, s[24:27], s45 offen lds
    v_mfma_f32_16x16x32_bf16 v[152:155], a[240:243], v[80:83], 0
    ds_read_b64_tr_b16 a[200:201], v3 offset:37152
    v_cvt_pk_bf16_f32 v98, v32, v33
    v_mfma_f32_16x16x32_bf16 v[152:155], a[244:247], v[84:87], v[152:155]
    ds_read_b64_tr_b16 a[202:203], v3 offset:37664
    ds_read_b64_tr_b16 a[204:205], v3 offset:54048
    v_cvt_pk_bf16_f32 v99, v34, v35
    v_mfma_f32_16x16x32_bf16 v[184:187], a[240:243], v[88:91], 0
    s_add_u32 m0, s44, 129600
    ds_read_b64_tr_b16 a[206:207], v3 offset:54560
    v_fma_mix_f32 v36, v106, v24, v28 op_sel:[0,0,0] op_sel_hi:[1,0,0]
    v_mfma_f32_16x16x32_bf16 v[184:187], a[244:247], v[92:95], v[184:187]
    s_mov_b32 s45, 1327104
    s_waitcnt lgkmcnt(9)
    buffer_load_dwordx4 v6, s[24:27], s45 offen lds
    v_fma_mix_f32 v37, v106, v25, v29 op_sel:[1,0,0] op_sel_hi:[1,0,0]
    v_mfma_f32_16x16x32_bf16 v[156:159], a[248:251], v[80:83], 0
    ds_read_b64_tr_b16 a[208:209], v3 offset:37184
    v_fma_mix_f32 v38, v107, v26, v30 op_sel:[0,0,0] op_sel_hi:[1,0,0]
    v_mfma_f32_16x16x32_bf16 v[156:159], a[252:255], v[84:87], v[156:159]
    ds_read_b64_tr_b16 a[210:211], v3 offset:37696
    ds_read_b64_tr_b16 a[212:213], v3 offset:54080
    v_fma_mix_f32 v39, v107, v27, v31 op_sel:[1,0,0] op_sel_hi:[1,0,0]
    v_mfma_f32_16x16x32_bf16 v[188:191], a[248:251], v[88:91], 0
    s_add_u32 m0, s44, 130656
    ds_read_b64_tr_b16 a[214:215], v3 offset:54592
    v_cvt_pk_bf16_f32 v106, v36, v37
    v_mfma_f32_16x16x32_bf16 v[188:191], a[252:255], v[92:95], v[188:191]
    s_mov_b32 s45, 1335296
    s_waitcnt lgkmcnt(8)
    buffer_load_dwordx4 v6, s[24:27], s45 offen lds
    v_cvt_pk_bf16_f32 v107, v38, v39
    v_mfma_f32_16x16x32_bf16 v[192:195], a[192:195], v[80:83], 0
    ds_read_b64_tr_b16 a[216:217], v3 offset:37216
    ds_read_b128 v[24:27], v9 offset:10000
    v_mfma_f32_16x16x32_bf16 v[192:195], a[196:199], v[84:87], v[192:195]
    ds_read_b64_tr_b16 a[218:219], v3 offset:37728
    ds_read_b64_tr_b16 a[220:221], v3 offset:54112
    v_fma_mix_f32 v32, v100, v16, v20 op_sel:[0,0,0] op_sel_hi:[1,0,0]
    v_mfma_f32_16x16x32_bf16 v[224:227], a[192:195], v[88:91], 0
    s_mov_b32 s54, 6144
    ds_read_b64_tr_b16 a[222:223], v3 offset:54624
    ds_read_b128 v[28:31], v9 offset:10032
    v_mfma_f32_16x16x32_bf16 v[224:227], a[196:199], v[92:95], v[224:227]
    s_waitcnt lgkmcnt(10)
    buffer_load_dwordx4 v[48:51], v8, s[32:35], s54 offen sc1
    v_mfma_f32_16x16x32_bf16 v[196:199], a[200:203], v[80:83], 0
    ds_read_b64_tr_b16 a[224:225], v3 offset:37248
    v_fma_mix_f32 v33, v100, v17, v21 op_sel:[1,0,0] op_sel_hi:[1,0,0]
    v_mfma_f32_16x16x32_bf16 v[196:199], a[204:207], v[84:87], v[196:199]
    ds_read_b64_tr_b16 a[226:227], v3 offset:37760
    ds_read_b64_tr_b16 a[228:229], v3 offset:54144
    v_fma_mix_f32 v34, v101, v18, v22 op_sel:[0,0,0] op_sel_hi:[1,0,0]
    v_mfma_f32_16x16x32_bf16 v[228:231], a[200:203], v[88:91], 0
    s_mov_b32 s54, 7168
    ds_read_b64_tr_b16 a[230:231], v3 offset:54656
    v_fma_mix_f32 v35, v101, v19, v23 op_sel:[1,0,0] op_sel_hi:[1,0,0]
    v_mfma_f32_16x16x32_bf16 v[228:231], a[204:207], v[92:95], v[228:231]
    s_waitcnt lgkmcnt(10)
    buffer_load_dwordx4 v[52:55], v8, s[32:35], s54 offen sc1
    v_mfma_f32_16x16x32_bf16 v[200:203], a[208:211], v[80:83], 0
    ds_read_b64_tr_b16 a[232:233], v3 offset:37280
    v_cvt_pk_bf16_f32 v100, v32, v33
    v_mfma_f32_16x16x32_bf16 v[200:203], a[212:215], v[84:87], v[200:203]
    ds_read_b64_tr_b16 a[234:235], v3 offset:37792
    ds_read_b64_tr_b16 a[236:237], v3 offset:54176
    v_cvt_pk_bf16_f32 v101, v34, v35
    v_mfma_f32_16x16x32_bf16 v[232:235], a[208:211], v[88:91], 0
    s_mov_b32 s54, 24576
    ds_read_b64_tr_b16 a[238:239], v3 offset:54688
    v_fma_mix_f32 v36, v108, v16, v20 op_sel:[0,0,0] op_sel_hi:[1,0,0]
    v_mfma_f32_16x16x32_bf16 v[232:235], a[212:215], v[92:95], v[232:235]
    s_waitcnt lgkmcnt(9)
    buffer_load_dwordx4 v[56:59], v8, s[32:35], s54 offen sc1
    v_fma_mix_f32 v37, v108, v17, v21 op_sel:[1,0,0] op_sel_hi:[1,0,0]
    v_mfma_f32_16x16x32_bf16 v[204:207], a[216:219], v[80:83], 0
    ds_read_b64_tr_b16 a[240:241], v3 offset:37312
    v_fma_mix_f32 v38, v109, v18, v22 op_sel:[0,0,0] op_sel_hi:[1,0,0]
    v_mfma_f32_16x16x32_bf16 v[204:207], a[220:223], v[84:87], v[204:207]
    ds_read_b64_tr_b16 a[242:243], v3 offset:37824
    ds_read_b64_tr_b16 a[244:245], v3 offset:54208
    v_fma_mix_f32 v39, v109, v19, v23 op_sel:[1,0,0] op_sel_hi:[1,0,0]
    v_mfma_f32_16x16x32_bf16 v[236:239], a[216:219], v[88:91], 0
    s_mov_b32 s54, 25600
    ds_read_b64_tr_b16 a[246:247], v3 offset:54720
    v_cvt_pk_bf16_f32 v108, v36, v37
    v_mfma_f32_16x16x32_bf16 v[236:239], a[220:223], v[92:95], v[236:239]
    s_waitcnt lgkmcnt(8)
    buffer_load_dwordx4 v[60:63], v8, s[32:35], s54 offen sc1
    v_cvt_pk_bf16_f32 v109, v38, v39
    v_mfma_f32_16x16x32_bf16 v[208:211], a[224:227], v[80:83], 0
    ds_read_b64_tr_b16 a[248:249], v3 offset:37344
    ds_read_b128 v[16:19], v9 offset:10240
    v_mfma_f32_16x16x32_bf16 v[208:211], a[228:231], v[84:87], v[208:211]
    ds_read_b64_tr_b16 a[250:251], v3 offset:37856
    ds_read_b128 v[20:23], v9 offset:10272
    v_mfma_f32_16x16x32_bf16 v[240:243], a[224:227], v[88:91], 0
    ds_read_b64_tr_b16 a[252:253], v3 offset:54240
    v_fma_mix_f32 v32, v102, v24, v28 op_sel:[0,0,0] op_sel_hi:[1,0,0]
    v_mfma_f32_16x16x32_bf16 v[240:243], a[228:231], v[92:95], v[240:243]
    s_barrier
    s_waitcnt lgkmcnt(9)
    ds_read_b64_tr_b16 a[254:255], v3 offset:54752
    v_fma_mix_f32 v33, v102, v25, v29 op_sel:[1,0,0] op_sel_hi:[1,0,0]
    v_fma_mix_f32 v34, v103, v26, v30 op_sel:[0,0,0] op_sel_hi:[1,0,0]
    v_mfma_f32_16x16x32_bf16 v[212:215], a[232:235], v[80:83], 0
    ds_read_b64_tr_b16 a[192:193], v4 offset:0
    v_fma_mix_f32 v35, v103, v27, v31 op_sel:[1,0,0] op_sel_hi:[1,0,0]
    v_mfma_f32_16x16x32_bf16 v[212:215], a[236:239], v[84:87], v[212:215]
    ds_read_b64_tr_b16 a[194:195], v4 offset:512
    ds_read_b64_tr_b16 a[196:197], v4 offset:16896
    v_cvt_pk_bf16_f32 v102, v32, v33
    v_mfma_f32_16x16x32_bf16 v[244:247], a[232:235], v[88:91], 0
    s_add_u32 m0, s44, 0
    ds_read_b64_tr_b16 a[198:199], v4 offset:17408
    v_cvt_pk_bf16_f32 v103, v34, v35
    v_mfma_f32_16x16x32_bf16 v[244:247], a[236:239], v[92:95], v[244:247]
    s_mov_b32 s45, 1572864
    s_waitcnt lgkmcnt(10)
    buffer_load_dwordx4 v6, s[24:27], s45 offen lds
    v_mfma_f32_16x16x32_bf16 v[216:219], a[240:243], v[80:83], 0
    ds_read_b64_tr_b16 a[200:201], v4 offset:32
    v_fma_mix_f32 v36, v110, v24, v28 op_sel:[0,0,0] op_sel_hi:[1,0,0]
    v_mfma_f32_16x16x32_bf16 v[216:219], a[244:247], v[84:87], v[216:219]
    ds_read_b64_tr_b16 a[202:203], v4 offset:544
    ds_read_b64_tr_b16 a[204:205], v4 offset:16928
    v_fma_mix_f32 v37, v110, v25, v29 op_sel:[1,0,0] op_sel_hi:[1,0,0]
    v_mfma_f32_16x16x32_bf16 v[248:251], a[240:243], v[88:91], 0
    s_add_u32 m0, s44, 1056
    ds_read_b64_tr_b16 a[206:207], v4 offset:17440
    v_fma_mix_f32 v38, v111, v26, v30 op_sel:[0,0,0] op_sel_hi:[1,0,0]
    v_mfma_f32_16x16x32_bf16 v[248:251], a[244:247], v[92:95], v[248:251]
    s_mov_b32 s45, 1581056
    s_waitcnt lgkmcnt(8)
    buffer_load_dwordx4 v6, s[24:27], s45 offen lds
    v_mfma_f32_16x16x32_bf16 v[220:223], a[248:251], v[80:83], 0
    ds_read_b64_tr_b16 a[208:209], v4 offset:64
    v_fma_mix_f32 v39, v111, v27, v31 op_sel:[1,0,0] op_sel_hi:[1,0,0]
    v_mfma_f32_16x16x32_bf16 v[220:223], a[252:255], v[84:87], v[220:223]
    ds_read_b64_tr_b16 a[210:211], v4 offset:576
    ds_read_b64_tr_b16 a[212:213], v4 offset:16960
    v_cvt_pk_bf16_f32 v110, v36, v37
    v_mfma_f32_16x16x32_bf16 v[252:255], a[248:251], v[88:91], 0
    s_add_u32 m0, s44, 2112
    ds_read_b64_tr_b16 a[214:215], v4 offset:17472
    v_cvt_pk_bf16_f32 v111, v38, v39
    v_mfma_f32_16x16x32_bf16 v[252:255], a[252:255], v[92:95], v[252:255]
    s_mov_b32 s45, 1589248
    s_waitcnt lgkmcnt(8)
    buffer_load_dwordx4 v6, s[24:27], s45 offen lds
    v_mfma_f32_16x16x32_bf16 v[128:131], a[192:195], v[96:99], v[128:131]
    s_waitcnt vmcnt(15)
    ds_read_b64_tr_b16 a[216:217], v4 offset:96
    ds_read_b128 v[24:27], v9 offset:10256
    v_mfma_f32_16x16x32_bf16 v[128:131], a[196:199], v[100:103], v[128:131]
    ds_read_b64_tr_b16 a[218:219], v4 offset:608
    ds_read_b64_tr_b16 a[220:221], v4 offset:16992
    v_fma_mix_f32 v32, v112, v16, v20 op_sel:[0,0,0] op_sel_hi:[1,0,0]
    v_mfma_f32_16x16x32_bf16 v[160:163], a[192:195], v[104:107], v[160:163]
    s_add_u32 m0, s44, 3168
    ds_read_b64_tr_b16 a[222:223], v4 offset:17504
    ds_read_b128 v[28:31], v9 offset:10288
    v_mfma_f32_16x16x32_bf16 v[160:163], a[196:199], v[108:111], v[160:163]
    s_mov_b32 s45, 1597440
    s_waitcnt lgkmcnt(10)
    buffer_load_dwordx4 v6, s[24:27], s45 offen lds
    v_mfma_f32_16x16x32_bf16 v[132:135], a[200:203], v[96:99], v[132:135]
    ds_read_b64_tr_b16 a[224:225], v4 offset:128
    v_fma_mix_f32 v33, v112, v17, v21 op_sel:[1,0,0] op_sel_hi:[1,0,0]
    v_mfma_f32_16x16x32_bf16 v[132:135], a[204:207], v[100:103], v[132:135]
    ds_read_b64_tr_b16 a[226:227], v4 offset:640
    ds_read_b64_tr_b16 a[228:229], v4 offset:17024
    v_fma_mix_f32 v34, v113, v18, v22 op_sel:[0,0,0] op_sel_hi:[1,0,0]
    v_mfma_f32_16x16x32_bf16 v[164:167], a[200:203], v[104:107], v[164:167]
    s_add_u32 m0, s44, 16896
    ds_read_b64_tr_b16 a[230:231], v4 offset:17536
    v_fma_mix_f32 v35, v113, v19, v23 op_sel:[1,0,0] op_sel_hi:[1,0,0]
    v_mfma_f32_16x16x32_bf16 v[164:167], a[204:207], v[108:111], v[164:167]
    s_mov_b32 s45, 1835008
    s_waitcnt lgkmcnt(10)
    buffer_load_dwordx4 v6, s[24:27], s45 offen lds
    v_mfma_f32_16x16x32_bf16 v[136:139], a[208:211], v[96:99], v[136:139]
    ds_read_b64_tr_b16 a[232:233], v4 offset:160
    v_cvt_pk_bf16_f32 v112, v32, v33
    v_mfma_f32_16x16x32_bf16 v[136:139], a[212:215], v[100:103], v[136:139]
    ds_read_b64_tr_b16 a[234:235], v4 offset:672
    ds_read_b64_tr_b16 a[236:237], v4 offset:17056
    v_cvt_pk_bf16_f32 v113, v34, v35
    v_mfma_f32_16x16x32_bf16 v[168:171], a[208:211], v[104:107], v[168:171]
    s_add_u32 m0, s44, 17952
    ds_read_b64_tr_b16 a[238:239], v4 offset:17568
    v_fma_mix_f32 v36, v120, v16, v20 op_sel:[0,0,0] op_sel_hi:[1,0,0]
    v_mfma_f32_16x16x32_bf16 v[168:171], a[212:215], v[108:111], v[168:171]
    s_mov_b32 s45, 1843200
    s_waitcnt lgkmcnt(9)
    buffer_load_dwordx4 v6, s[24:27], s45 offen lds
    v_fma_mix_f32 v37, v120, v17, v21 op_sel:[1,0,0] op_sel_hi:[1,0,0]
    v_mfma_f32_16x16x32_bf16 v[140:143], a[216:219], v[96:99], v[140:143]
    ds_read_b64_tr_b16 a[240:241], v4 offset:192
    v_fma_mix_f32 v38, v121, v18, v22 op_sel:[0,0,0] op_sel_hi:[1,0,0]
    v_mfma_f32_16x16x32_bf16 v[140:143], a[220:223], v[100:103], v[140:143]
    ds_read_b64_tr_b16 a[242:243], v4 offset:704
    ds_read_b64_tr_b16 a[244:245], v4 offset:17088
    v_fma_mix_f32 v39, v121, v19, v23 op_sel:[1,0,0] op_sel_hi:[1,0,0]
    v_mfma_f32_16x16x32_bf16 v[172:175], a[216:219], v[104:107], v[172:175]
    s_add_u32 m0, s44, 19008
    ds_read_b64_tr_b16 a[246:247], v4 offset:17600
    v_cvt_pk_bf16_f32 v120, v36, v37
    v_mfma_f32_16x16x32_bf16 v[172:175], a[220:223], v[108:111], v[172:175]
    s_mov_b32 s45, 1851392
    s_waitcnt lgkmcnt(8)
    buffer_load_dwordx4 v6, s[24:27], s45 offen lds
    v_cvt_pk_bf16_f32 v121, v38, v39
    v_mfma_f32_16x16x32_bf16 v[144:147], a[224:227], v[96:99], v[144:147]
    ds_read_b64_tr_b16 a[248:249], v4 offset:224
    ds_read_b128 v[16:19], v9 offset:10496
    v_mfma_f32_16x16x32_bf16 v[144:147], a[228:231], v[100:103], v[144:147]
    ds_read_b64_tr_b16 a[250:251], v4 offset:736
    ds_read_b64_tr_b16 a[252:253], v4 offset:17120
    v_mfma_f32_16x16x32_bf16 v[176:179], a[224:227], v[104:107], v[176:179]
    s_add_u32 m0, s44, 20064
    ds_read_b64_tr_b16 a[254:255], v4 offset:17632
    ds_read_b128 v[20:23], v9 offset:10528
    v_mfma_f32_16x16x32_bf16 v[176:179], a[228:231], v[108:111], v[176:179]
    s_mov_b32 s45, 1859584
    s_waitcnt lgkmcnt(10)
    buffer_load_dwordx4 v6, s[24:27], s45 offen lds
    v_mfma_f32_16x16x32_bf16 v[148:151], a[232:235], v[96:99], v[148:151]
    ds_read_b64_tr_b16 a[192:193], v4 offset:256
    v_fma_mix_f32 v32, v114, v24, v28 op_sel:[0,0,0] op_sel_hi:[1,0,0]
    v_mfma_f32_16x16x32_bf16 v[148:151], a[236:239], v[100:103], v[148:151]
    ds_read_b64_tr_b16 a[194:195], v4 offset:768
    v_fma_mix_f32 v33, v114, v25, v29 op_sel:[1,0,0] op_sel_hi:[1,0,0]
    v_mfma_f32_16x16x32_bf16 v[180:183], a[232:235], v[104:107], v[180:183]
    ds_read_b64_tr_b16 a[196:197], v4 offset:17152
    v_fma_mix_f32 v34, v115, v26, v30 op_sel:[0,0,0] op_sel_hi:[1,0,0]
    v_mfma_f32_16x16x32_bf16 v[180:183], a[236:239], v[108:111], v[180:183]
    s_waitcnt lgkmcnt(9)
    ds_read_b64_tr_b16 a[198:199], v4 offset:17664
    v_fma_mix_f32 v35, v115, v27, v31 op_sel:[1,0,0] op_sel_hi:[1,0,0]
    v_mfma_f32_16x16x32_bf16 v[152:155], a[240:243], v[96:99], v[152:155]
    ds_read_b64_tr_b16 a[200:201], v4 offset:288
    v_cvt_pk_bf16_f32 v114, v32, v33
    v_mfma_f32_16x16x32_bf16 v[152:155], a[244:247], v[100:103], v[152:155]
    ds_read_b64_tr_b16 a[202:203], v4 offset:800
    v_cvt_pk_bf16_f32 v115, v34, v35
    v_mfma_f32_16x16x32_bf16 v[184:187], a[240:243], v[104:107], v[184:187]
    ds_read_b64_tr_b16 a[204:205], v4 offset:17184
    v_fma_mix_f32 v36, v122, v24, v28 op_sel:[0,0,0] op_sel_hi:[1,0,0]
    v_mfma_f32_16x16x32_bf16 v[184:187], a[244:247], v[108:111], v[184:187]
    s_waitcnt lgkmcnt(8)
    ds_read_b64_tr_b16 a[206:207], v4 offset:17696
    v_fma_mix_f32 v37, v122, v25, v29 op_sel:[1,0,0] op_sel_hi:[1,0,0]
    v_mfma_f32_16x16x32_bf16 v[156:159], a[248:251], v[96:99], v[156:159]
    ds_read_b64_tr_b16 a[208:209], v4 offset:320
    v_fma_mix_f32 v38, v123, v26, v30 op_sel:[0,0,0] op_sel_hi:[1,0,0]
    v_mfma_f32_16x16x32_bf16 v[156:159], a[252:255], v[100:103], v[156:159]
    ds_read_b64_tr_b16 a[210:211], v4 offset:832
    v_fma_mix_f32 v39, v123, v27, v31 op_sel:[1,0,0] op_sel_hi:[1,0,0]
    v_mfma_f32_16x16x32_bf16 v[188:191], a[248:251], v[104:107], v[188:191]
    ds_read_b64_tr_b16 a[212:213], v4 offset:17216
    v_cvt_pk_bf16_f32 v122, v36, v37
    v_mfma_f32_16x16x32_bf16 v[188:191], a[252:255], v[108:111], v[188:191]
    s_waitcnt lgkmcnt(7)
    ds_read_b64_tr_b16 a[214:215], v4 offset:17728
    v_cvt_pk_bf16_f32 v123, v38, v39
    v_mfma_f32_16x16x32_bf16 v[192:195], a[192:195], v[96:99], v[192:195]
    ds_read_b64_tr_b16 a[216:217], v4 offset:352
    ds_read_b128 v[24:27], v9 offset:10512
    v_mfma_f32_16x16x32_bf16 v[192:195], a[196:199], v[100:103], v[192:195]
    ds_read_b64_tr_b16 a[218:219], v4 offset:864
    ds_read_b64_tr_b16 a[220:221], v4 offset:17248
    v_fma_mix_f32 v32, v116, v16, v20 op_sel:[0,0,0] op_sel_hi:[1,0,0]
    v_mfma_f32_16x16x32_bf16 v[224:227], a[192:195], v[104:107], v[224:227]
    s_mov_b32 s54, 8192
    ds_read_b64_tr_b16 a[222:223], v4 offset:17760
    ds_read_b128 v[28:31], v9 offset:10544
    v_mfma_f32_16x16x32_bf16 v[224:227], a[196:199], v[108:111], v[224:227]
    s_waitcnt lgkmcnt(10)
    buffer_load_dwordx4 v[64:67], v8, s[32:35], s54 offen sc1
    v_mfma_f32_16x16x32_bf16 v[196:199], a[200:203], v[96:99], v[196:199]
    ds_read_b64_tr_b16 a[224:225], v4 offset:384
    v_fma_mix_f32 v33, v116, v17, v21 op_sel:[1,0,0] op_sel_hi:[1,0,0]
    v_mfma_f32_16x16x32_bf16 v[196:199], a[204:207], v[100:103], v[196:199]
    ds_read_b64_tr_b16 a[226:227], v4 offset:896
    ds_read_b64_tr_b16 a[228:229], v4 offset:17280
    v_fma_mix_f32 v34, v117, v18, v22 op_sel:[0,0,0] op_sel_hi:[1,0,0]
    v_mfma_f32_16x16x32_bf16 v[228:231], a[200:203], v[104:107], v[228:231]
    s_mov_b32 s54, 9216
    ds_read_b64_tr_b16 a[230:231], v4 offset:17792
    v_fma_mix_f32 v35, v117, v19, v23 op_sel:[1,0,0] op_sel_hi:[1,0,0]
    v_mfma_f32_16x16x32_bf16 v[228:231], a[204:207], v[108:111], v[228:231]
    s_waitcnt lgkmcnt(10)
    buffer_load_dwordx4 v[68:71], v8, s[32:35], s54 offen sc1
    v_mfma_f32_16x16x32_bf16 v[200:203], a[208:211], v[96:99], v[200:203]
    ds_read_b64_tr_b16 a[232:233], v4 offset:416
    v_cvt_pk_bf16_f32 v116, v32, v33
    v_mfma_f32_16x16x32_bf16 v[200:203], a[212:215], v[100:103], v[200:203]
    ds_read_b64_tr_b16 a[234:235], v4 offset:928
    ds_read_b64_tr_b16 a[236:237], v4 offset:17312
    v_cvt_pk_bf16_f32 v117, v34, v35
    v_mfma_f32_16x16x32_bf16 v[232:235], a[208:211], v[104:107], v[232:235]
    s_mov_b32 s54, 26624
    ds_read_b64_tr_b16 a[238:239], v4 offset:17824
    v_fma_mix_f32 v36, v124, v16, v20 op_sel:[0,0,0] op_sel_hi:[1,0,0]
    v_mfma_f32_16x16x32_bf16 v[232:235], a[212:215], v[108:111], v[232:235]
    s_waitcnt lgkmcnt(9)
    buffer_load_dwordx4 v[72:75], v8, s[32:35], s54 offen sc1
    v_fma_mix_f32 v37, v124, v17, v21 op_sel:[1,0,0] op_sel_hi:[1,0,0]
    v_mfma_f32_16x16x32_bf16 v[204:207], a[216:219], v[96:99], v[204:207]
    ds_read_b64_tr_b16 a[240:241], v4 offset:448
    v_fma_mix_f32 v38, v125, v18, v22 op_sel:[0,0,0] op_sel_hi:[1,0,0]
    v_mfma_f32_16x16x32_bf16 v[204:207], a[220:223], v[100:103], v[204:207]
    ds_read_b64_tr_b16 a[242:243], v4 offset:960
    ds_read_b64_tr_b16 a[244:245], v4 offset:17344
    v_fma_mix_f32 v39, v125, v19, v23 op_sel:[1,0,0] op_sel_hi:[1,0,0]
    v_mfma_f32_16x16x32_bf16 v[236:239], a[216:219], v[104:107], v[236:239]
    s_mov_b32 s54, 27648
    ds_read_b64_tr_b16 a[246:247], v4 offset:17856
    v_cvt_pk_bf16_f32 v124, v36, v37
    v_mfma_f32_16x16x32_bf16 v[236:239], a[220:223], v[108:111], v[236:239]
    s_waitcnt lgkmcnt(8)
    buffer_load_dwordx4 v[76:79], v8, s[32:35], s54 offen sc1
    v_cvt_pk_bf16_f32 v125, v38, v39
    v_mfma_f32_16x16x32_bf16 v[208:211], a[224:227], v[96:99], v[208:211]
    ds_read_b64_tr_b16 a[248:249], v4 offset:480
    ds_read_b128 v[16:19], v9 offset:10752
    v_mfma_f32_16x16x32_bf16 v[208:211], a[228:231], v[100:103], v[208:211]
    ds_read_b64_tr_b16 a[250:251], v4 offset:992
    ds_read_b128 v[20:23], v9 offset:10784
    v_mfma_f32_16x16x32_bf16 v[240:243], a[224:227], v[104:107], v[240:243]
    ds_read_b64_tr_b16 a[252:253], v4 offset:17376
    v_fma_mix_f32 v32, v118, v24, v28 op_sel:[0,0,0] op_sel_hi:[1,0,0]
    v_mfma_f32_16x16x32_bf16 v[240:243], a[228:231], v[108:111], v[240:243]
    s_waitcnt vmcnt(16)
    s_barrier
    s_waitcnt lgkmcnt(9)
    ds_read_b64_tr_b16 a[254:255], v4 offset:17888
    v_fma_mix_f32 v33, v118, v25, v29 op_sel:[1,0,0] op_sel_hi:[1,0,0]
    v_fma_mix_f32 v34, v119, v26, v30 op_sel:[0,0,0] op_sel_hi:[1,0,0]
    v_mfma_f32_16x16x32_bf16 v[212:215], a[232:235], v[96:99], v[212:215]
    ds_read_b64_tr_b16 a[192:193], v4 offset:36864
    v_fma_mix_f32 v35, v119, v27, v31 op_sel:[1,0,0] op_sel_hi:[1,0,0]
    v_mfma_f32_16x16x32_bf16 v[212:215], a[236:239], v[100:103], v[212:215]
    ds_read_b64_tr_b16 a[194:195], v4 offset:37376
    ds_read_b64_tr_b16 a[196:197], v4 offset:53760
    v_cvt_pk_bf16_f32 v118, v32, v33
    v_mfma_f32_16x16x32_bf16 v[244:247], a[232:235], v[104:107], v[244:247]
    s_add_u32 m0, s44, 36864
    ds_read_b64_tr_b16 a[198:199], v4 offset:54272
    v_cvt_pk_bf16_f32 v119, v34, v35
    v_mfma_f32_16x16x32_bf16 v[244:247], a[236:239], v[108:111], v[244:247]
    s_mov_b32 s45, 2097152
    s_waitcnt lgkmcnt(10)
    buffer_load_dwordx4 v6, s[24:27], s45 offen lds
    v_mfma_f32_16x16x32_bf16 v[216:219], a[240:243], v[96:99], v[216:219]
    ds_read_b64_tr_b16 a[200:201], v4 offset:36896
    v_fma_mix_f32 v36, v126, v24, v28 op_sel:[0,0,0] op_sel_hi:[1,0,0]
    v_mfma_f32_16x16x32_bf16 v[216:219], a[244:247], v[100:103], v[216:219]
    ds_read_b64_tr_b16 a[202:203], v4 offset:37408
    ds_read_b64_tr_b16 a[204:205], v4 offset:53792
    v_fma_mix_f32 v37, v126, v25, v29 op_sel:[1,0,0] op_sel_hi:[1,0,0]
    v_mfma_f32_16x16x32_bf16 v[248:251], a[240:243], v[104:107], v[248:251]
    s_add_u32 m0, s44, 37920
    ds_read_b64_tr_b16 a[206:207], v4 offset:54304
    v_fma_mix_f32 v38, v127, v26, v30 op_sel:[0,0,0] op_sel_hi:[1,0,0]
    v_mfma_f32_16x16x32_bf16 v[248:251], a[244:247], v[108:111], v[248:251]
    s_mov_b32 s45, 2105344
    s_waitcnt lgkmcnt(8)
    buffer_load_dwordx4 v6, s[24:27], s45 offen lds
    v_mfma_f32_16x16x32_bf16 v[220:223], a[248:251], v[96:99], v[220:223]
    ds_read_b64_tr_b16 a[208:209], v4 offset:36928
    v_fma_mix_f32 v39, v127, v27, v31 op_sel:[1,0,0] op_sel_hi:[1,0,0]
    v_mfma_f32_16x16x32_bf16 v[220:223], a[252:255], v[100:103], v[220:223]
    ds_read_b64_tr_b16 a[210:211], v4 offset:37440
    ds_read_b64_tr_b16 a[212:213], v4 offset:53824
    v_cvt_pk_bf16_f32 v126, v36, v37
    v_mfma_f32_16x16x32_bf16 v[252:255], a[248:251], v[104:107], v[252:255]
    s_add_u32 m0, s44, 38976
    ds_read_b64_tr_b16 a[214:215], v4 offset:54336
    v_cvt_pk_bf16_f32 v127, v38, v39
    v_mfma_f32_16x16x32_bf16 v[252:255], a[252:255], v[108:111], v[252:255]
    s_mov_b32 s45, 2113536
    s_waitcnt lgkmcnt(8)
    buffer_load_dwordx4 v6, s[24:27], s45 offen lds
    v_mfma_f32_16x16x32_bf16 v[128:131], a[192:195], v[112:115], v[128:131]
    s_waitcnt vmcnt(15)
    ds_read_b64_tr_b16 a[216:217], v4 offset:36960
    ds_read_b128 v[24:27], v9 offset:10768
    v_mfma_f32_16x16x32_bf16 v[128:131], a[196:199], v[116:119], v[128:131]
    ds_read_b64_tr_b16 a[218:219], v4 offset:37472
    ds_read_b64_tr_b16 a[220:221], v4 offset:53856
    v_fma_mix_f32 v32, v48, v16, v20 op_sel:[0,0,0] op_sel_hi:[1,0,0]
    v_mfma_f32_16x16x32_bf16 v[160:163], a[192:195], v[120:123], v[160:163]
    s_add_u32 m0, s44, 40032
    ds_read_b64_tr_b16 a[222:223], v4 offset:54368
    ds_read_b128 v[28:31], v9 offset:10800
    v_mfma_f32_16x16x32_bf16 v[160:163], a[196:199], v[124:127], v[160:163]
    s_mov_b32 s45, 2121728
    s_waitcnt lgkmcnt(10)
    buffer_load_dwordx4 v6, s[24:27], s45 offen lds
    v_mfma_f32_16x16x32_bf16 v[132:135], a[200:203], v[112:115], v[132:135]
    ds_read_b64_tr_b16 a[224:225], v4 offset:36992
    v_fma_mix_f32 v33, v48, v17, v21 op_sel:[1,0,0] op_sel_hi:[1,0,0]
    v_mfma_f32_16x16x32_bf16 v[132:135], a[204:207], v[116:119], v[132:135]
    ds_read_b64_tr_b16 a[226:227], v4 offset:37504
    ds_read_b64_tr_b16 a[228:229], v4 offset:53888
    v_fma_mix_f32 v34, v49, v18, v22 op_sel:[0,0,0] op_sel_hi:[1,0,0]
    v_mfma_f32_16x16x32_bf16 v[164:167], a[200:203], v[120:123], v[164:167]
    s_add_u32 m0, s44, 53760
    ds_read_b64_tr_b16 a[230:231], v4 offset:54400
    v_fma_mix_f32 v35, v49, v19, v23 op_sel:[1,0,0] op_sel_hi:[1,0,0]
    v_mfma_f32_16x16x32_bf16 v[164:167], a[204:207], v[124:127], v[164:167]
    s_mov_b32 s45, 2359296
    s_waitcnt lgkmcnt(10)
    buffer_load_dwordx4 v6, s[24:27], s45 offen lds
    v_mfma_f32_16x16x32_bf16 v[136:139], a[208:211], v[112:115], v[136:139]
    ds_read_b64_tr_b16 a[232:233], v4 offset:37024
    v_cvt_pk_bf16_f32 v48, v32, v33
    v_mfma_f32_16x16x32_bf16 v[136:139], a[212:215], v[116:119], v[136:139]
    ds_read_b64_tr_b16 a[234:235], v4 offset:37536
    ds_read_b64_tr_b16 a[236:237], v4 offset:53920
    v_cvt_pk_bf16_f32 v49, v34, v35
    v_mfma_f32_16x16x32_bf16 v[168:171], a[208:211], v[120:123], v[168:171]
    s_add_u32 m0, s44, 54816
    ds_read_b64_tr_b16 a[238:239], v4 offset:54432
    v_fma_mix_f32 v36, v56, v16, v20 op_sel:[0,0,0] op_sel_hi:[1,0,0]
    v_mfma_f32_16x16x32_bf16 v[168:171], a[212:215], v[124:127], v[168:171]
    s_mov_b32 s45, 2367488
    s_waitcnt lgkmcnt(9)
    buffer_load_dwordx4 v6, s[24:27], s45 offen lds
    v_fma_mix_f32 v37, v56, v17, v21 op_sel:[1,0,0] op_sel_hi:[1,0,0]
    v_mfma_f32_16x16x32_bf16 v[140:143], a[216:219], v[112:115], v[140:143]
    ds_read_b64_tr_b16 a[240:241], v4 offset:37056
    v_fma_mix_f32 v38, v57, v18, v22 op_sel:[0,0,0] op_sel_hi:[1,0,0]
    v_mfma_f32_16x16x32_bf16 v[140:143], a[220:223], v[116:119], v[140:143]
    ds_read_b64_tr_b16 a[242:243], v4 offset:37568
    ds_read_b64_tr_b16 a[244:245], v4 offset:53952
    v_fma_mix_f32 v39, v57, v19, v23 op_sel:[1,0,0] op_sel_hi:[1,0,0]
    v_mfma_f32_16x16x32_bf16 v[172:175], a[216:219], v[120:123], v[172:175]
    s_add_u32 m0, s44, 55872
    ds_read_b64_tr_b16 a[246:247], v4 offset:54464
    v_cvt_pk_bf16_f32 v56, v36, v37
    v_mfma_f32_16x16x32_bf16 v[172:175], a[220:223], v[124:127], v[172:175]
    s_mov_b32 s45, 2375680
    s_waitcnt lgkmcnt(8)
    buffer_load_dwordx4 v6, s[24:27], s45 offen lds
    v_cvt_pk_bf16_f32 v57, v38, v39
    v_mfma_f32_16x16x32_bf16 v[144:147], a[224:227], v[112:115], v[144:147]
    ds_read_b64_tr_b16 a[248:249], v4 offset:37088
    ds_read_b128 v[16:19], v9 offset:11008
    v_mfma_f32_16x16x32_bf16 v[144:147], a[228:231], v[116:119], v[144:147]
    ds_read_b64_tr_b16 a[250:251], v4 offset:37600
    ds_read_b64_tr_b16 a[252:253], v4 offset:53984
    v_mfma_f32_16x16x32_bf16 v[176:179], a[224:227], v[120:123], v[176:179]
    s_add_u32 m0, s44, 56928
    ds_read_b64_tr_b16 a[254:255], v4 offset:54496
    ds_read_b128 v[20:23], v9 offset:11040
    v_mfma_f32_16x16x32_bf16 v[176:179], a[228:231], v[124:127], v[176:179]
    s_mov_b32 s45, 2383872
    s_waitcnt lgkmcnt(10)
    buffer_load_dwordx4 v6, s[24:27], s45 offen lds
    v_mfma_f32_16x16x32_bf16 v[148:151], a[232:235], v[112:115], v[148:151]
    ds_read_b64_tr_b16 a[192:193], v4 offset:37120
    v_fma_mix_f32 v32, v50, v24, v28 op_sel:[0,0,0] op_sel_hi:[1,0,0]
    v_mfma_f32_16x16x32_bf16 v[148:151], a[236:239], v[116:119], v[148:151]
    ds_read_b64_tr_b16 a[194:195], v4 offset:37632
    v_fma_mix_f32 v33, v50, v25, v29 op_sel:[1,0,0] op_sel_hi:[1,0,0]
    v_mfma_f32_16x16x32_bf16 v[180:183], a[232:235], v[120:123], v[180:183]
    ds_read_b64_tr_b16 a[196:197], v4 offset:54016
    v_fma_mix_f32 v34, v51, v26, v30 op_sel:[0,0,0] op_sel_hi:[1,0,0]
    v_mfma_f32_16x16x32_bf16 v[180:183], a[236:239], v[124:127], v[180:183]
    s_waitcnt lgkmcnt(9)
    ds_read_b64_tr_b16 a[198:199], v4 offset:54528
    v_fma_mix_f32 v35, v51, v27, v31 op_sel:[1,0,0] op_sel_hi:[1,0,0]
    v_mfma_f32_16x16x32_bf16 v[152:155], a[240:243], v[112:115], v[152:155]
    ds_read_b64_tr_b16 a[200:201], v4 offset:37152
    v_cvt_pk_bf16_f32 v50, v32, v33
    v_mfma_f32_16x16x32_bf16 v[152:155], a[244:247], v[116:119], v[152:155]
    ds_read_b64_tr_b16 a[202:203], v4 offset:37664
    v_cvt_pk_bf16_f32 v51, v34, v35
    v_mfma_f32_16x16x32_bf16 v[184:187], a[240:243], v[120:123], v[184:187]
    ds_read_b64_tr_b16 a[204:205], v4 offset:54048
    v_fma_mix_f32 v36, v58, v24, v28 op_sel:[0,0,0] op_sel_hi:[1,0,0]
    v_mfma_f32_16x16x32_bf16 v[184:187], a[244:247], v[124:127], v[184:187]
    s_waitcnt lgkmcnt(8)
    ds_read_b64_tr_b16 a[206:207], v4 offset:54560
    v_fma_mix_f32 v37, v58, v25, v29 op_sel:[1,0,0] op_sel_hi:[1,0,0]
    v_mfma_f32_16x16x32_bf16 v[156:159], a[248:251], v[112:115], v[156:159]
    ds_read_b64_tr_b16 a[208:209], v4 offset:37184
    v_fma_mix_f32 v38, v59, v26, v30 op_sel:[0,0,0] op_sel_hi:[1,0,0]
    v_mfma_f32_16x16x32_bf16 v[156:159], a[252:255], v[116:119], v[156:159]
    ds_read_b64_tr_b16 a[210:211], v4 offset:37696
    v_fma_mix_f32 v39, v59, v27, v31 op_sel:[1,0,0] op_sel_hi:[1,0,0]
    v_mfma_f32_16x16x32_bf16 v[188:191], a[248:251], v[120:123], v[188:191]
    ds_read_b64_tr_b16 a[212:213], v4 offset:54080
    v_cvt_pk_bf16_f32 v58, v36, v37
    v_mfma_f32_16x16x32_bf16 v[188:191], a[252:255], v[124:127], v[188:191]
    s_waitcnt lgkmcnt(7)
    ds_read_b64_tr_b16 a[214:215], v4 offset:54592
    v_cvt_pk_bf16_f32 v59, v38, v39
    v_mfma_f32_16x16x32_bf16 v[192:195], a[192:195], v[112:115], v[192:195]
    ds_read_b64_tr_b16 a[216:217], v4 offset:37216
    ds_read_b128 v[24:27], v9 offset:11024
    v_mfma_f32_16x16x32_bf16 v[192:195], a[196:199], v[116:119], v[192:195]
    ds_read_b64_tr_b16 a[218:219], v4 offset:37728
    ds_read_b64_tr_b16 a[220:221], v4 offset:54112
    v_fma_mix_f32 v32, v52, v16, v20 op_sel:[0,0,0] op_sel_hi:[1,0,0]
    v_mfma_f32_16x16x32_bf16 v[224:227], a[192:195], v[120:123], v[224:227]
    s_mov_b32 s54, 10240
    ds_read_b64_tr_b16 a[222:223], v4 offset:54624
    ds_read_b128 v[28:31], v9 offset:11056
    v_mfma_f32_16x16x32_bf16 v[224:227], a[196:199], v[124:127], v[224:227]
    s_waitcnt lgkmcnt(10)
    buffer_load_dwordx4 v[80:83], v8, s[32:35], s54 offen sc1
    v_mfma_f32_16x16x32_bf16 v[196:199], a[200:203], v[112:115], v[196:199]
    ds_read_b64_tr_b16 a[224:225], v4 offset:37248
    v_fma_mix_f32 v33, v52, v17, v21 op_sel:[1,0,0] op_sel_hi:[1,0,0]
    v_mfma_f32_16x16x32_bf16 v[196:199], a[204:207], v[116:119], v[196:199]
    ds_read_b64_tr_b16 a[226:227], v4 offset:37760
    ds_read_b64_tr_b16 a[228:229], v4 offset:54144
    v_fma_mix_f32 v34, v53, v18, v22 op_sel:[0,0,0] op_sel_hi:[1,0,0]
    v_mfma_f32_16x16x32_bf16 v[228:231], a[200:203], v[120:123], v[228:231]
    s_mov_b32 s54, 11264
    ds_read_b64_tr_b16 a[230:231], v4 offset:54656
    v_fma_mix_f32 v35, v53, v19, v23 op_sel:[1,0,0] op_sel_hi:[1,0,0]
    v_mfma_f32_16x16x32_bf16 v[228:231], a[204:207], v[124:127], v[228:231]
    s_waitcnt lgkmcnt(10)
    buffer_load_dwordx4 v[84:87], v8, s[32:35], s54 offen sc1
    v_mfma_f32_16x16x32_bf16 v[200:203], a[208:211], v[112:115], v[200:203]
    ds_read_b64_tr_b16 a[232:233], v4 offset:37280
    v_cvt_pk_bf16_f32 v52, v32, v33
    v_mfma_f32_16x16x32_bf16 v[200:203], a[212:215], v[116:119], v[200:203]
    ds_read_b64_tr_b16 a[234:235], v4 offset:37792
    ds_read_b64_tr_b16 a[236:237], v4 offset:54176
    v_cvt_pk_bf16_f32 v53, v34, v35
    v_mfma_f32_16x16x32_bf16 v[232:235], a[208:211], v[120:123], v[232:235]
    s_mov_b32 s54, 28672
    ds_read_b64_tr_b16 a[238:239], v4 offset:54688
    v_fma_mix_f32 v36, v60, v16, v20 op_sel:[0,0,0] op_sel_hi:[1,0,0]
    v_mfma_f32_16x16x32_bf16 v[232:235], a[212:215], v[124:127], v[232:235]
    s_waitcnt lgkmcnt(9)
    buffer_load_dwordx4 v[88:91], v8, s[32:35], s54 offen sc1
    v_fma_mix_f32 v37, v60, v17, v21 op_sel:[1,0,0] op_sel_hi:[1,0,0]
    v_mfma_f32_16x16x32_bf16 v[204:207], a[216:219], v[112:115], v[204:207]
    ds_read_b64_tr_b16 a[240:241], v4 offset:37312
    v_fma_mix_f32 v38, v61, v18, v22 op_sel:[0,0,0] op_sel_hi:[1,0,0]
    v_mfma_f32_16x16x32_bf16 v[204:207], a[220:223], v[116:119], v[204:207]
    ds_read_b64_tr_b16 a[242:243], v4 offset:37824
    ds_read_b64_tr_b16 a[244:245], v4 offset:54208
    v_fma_mix_f32 v39, v61, v19, v23 op_sel:[1,0,0] op_sel_hi:[1,0,0]
    v_mfma_f32_16x16x32_bf16 v[236:239], a[216:219], v[120:123], v[236:239]
    s_mov_b32 s54, 29696
    ds_read_b64_tr_b16 a[246:247], v4 offset:54720
    v_cvt_pk_bf16_f32 v60, v36, v37
    v_mfma_f32_16x16x32_bf16 v[236:239], a[220:223], v[124:127], v[236:239]
    s_waitcnt lgkmcnt(8)
    buffer_load_dwordx4 v[92:95], v8, s[32:35], s54 offen sc1
    v_cvt_pk_bf16_f32 v61, v38, v39
    v_mfma_f32_16x16x32_bf16 v[208:211], a[224:227], v[112:115], v[208:211]
    ds_read_b64_tr_b16 a[248:249], v4 offset:37344
    ds_read_b128 v[16:19], v9 offset:11264
    v_mfma_f32_16x16x32_bf16 v[208:211], a[228:231], v[116:119], v[208:211]
    ds_read_b64_tr_b16 a[250:251], v4 offset:37856
    ds_read_b128 v[20:23], v9 offset:11296
    v_mfma_f32_16x16x32_bf16 v[240:243], a[224:227], v[120:123], v[240:243]
    ds_read_b64_tr_b16 a[252:253], v4 offset:54240
    v_fma_mix_f32 v32, v54, v24, v28 op_sel:[0,0,0] op_sel_hi:[1,0,0]
    v_mfma_f32_16x16x32_bf16 v[240:243], a[228:231], v[124:127], v[240:243]
    s_waitcnt vmcnt(16)
    s_barrier
    s_waitcnt lgkmcnt(9)
    ds_read_b64_tr_b16 a[254:255], v4 offset:54752
    v_fma_mix_f32 v33, v54, v25, v29 op_sel:[1,0,0] op_sel_hi:[1,0,0]
    v_fma_mix_f32 v34, v55, v26, v30 op_sel:[0,0,0] op_sel_hi:[1,0,0]
    v_mfma_f32_16x16x32_bf16 v[212:215], a[232:235], v[112:115], v[212:215]
    ds_read_b64_tr_b16 a[192:193], v3 offset:0
    v_fma_mix_f32 v35, v55, v27, v31 op_sel:[1,0,0] op_sel_hi:[1,0,0]
    v_mfma_f32_16x16x32_bf16 v[212:215], a[236:239], v[116:119], v[212:215]
    ds_read_b64_tr_b16 a[194:195], v3 offset:512
    ds_read_b64_tr_b16 a[196:197], v3 offset:16896
    v_cvt_pk_bf16_f32 v54, v32, v33
    v_mfma_f32_16x16x32_bf16 v[244:247], a[232:235], v[120:123], v[244:247]
    s_add_u32 m0, s44, 73728
    ds_read_b64_tr_b16 a[198:199], v3 offset:17408
    v_cvt_pk_bf16_f32 v55, v34, v35
    v_mfma_f32_16x16x32_bf16 v[244:247], a[236:239], v[124:127], v[244:247]
    s_mov_b32 s45, 2621440
    s_waitcnt lgkmcnt(10)
    buffer_load_dwordx4 v6, s[24:27], s45 offen lds
    v_mfma_f32_16x16x32_bf16 v[216:219], a[240:243], v[112:115], v[216:219]
    ds_read_b64_tr_b16 a[200:201], v3 offset:32
    v_fma_mix_f32 v36, v62, v24, v28 op_sel:[0,0,0] op_sel_hi:[1,0,0]
    v_mfma_f32_16x16x32_bf16 v[216:219], a[244:247], v[116:119], v[216:219]
    ds_read_b64_tr_b16 a[202:203], v3 offset:544
    ds_read_b64_tr_b16 a[204:205], v3 offset:16928
    v_fma_mix_f32 v37, v62, v25, v29 op_sel:[1,0,0] op_sel_hi:[1,0,0]
    v_mfma_f32_16x16x32_bf16 v[248:251], a[240:243], v[120:123], v[248:251]
    s_add_u32 m0, s44, 74784
    ds_read_b64_tr_b16 a[206:207], v3 offset:17440
    v_fma_mix_f32 v38, v63, v26, v30 op_sel:[0,0,0] op_sel_hi:[1,0,0]
    v_mfma_f32_16x16x32_bf16 v[248:251], a[244:247], v[124:127], v[248:251]
    s_mov_b32 s45, 2629632
    s_waitcnt lgkmcnt(8)
    buffer_load_dwordx4 v6, s[24:27], s45 offen lds
    v_mfma_f32_16x16x32_bf16 v[220:223], a[248:251], v[112:115], v[220:223]
    ds_read_b64_tr_b16 a[208:209], v3 offset:64
    v_fma_mix_f32 v39, v63, v27, v31 op_sel:[1,0,0] op_sel_hi:[1,0,0]
    v_mfma_f32_16x16x32_bf16 v[220:223], a[252:255], v[116:119], v[220:223]
    ds_read_b64_tr_b16 a[210:211], v3 offset:576
    ds_read_b64_tr_b16 a[212:213], v3 offset:16960
    v_cvt_pk_bf16_f32 v62, v36, v37
    v_mfma_f32_16x16x32_bf16 v[252:255], a[248:251], v[120:123], v[252:255]
    s_add_u32 m0, s44, 75840
    ds_read_b64_tr_b16 a[214:215], v3 offset:17472
    v_cvt_pk_bf16_f32 v63, v38, v39
    v_mfma_f32_16x16x32_bf16 v[252:255], a[252:255], v[124:127], v[252:255]
    s_mov_b32 s45, 2637824
    s_waitcnt lgkmcnt(8)
    buffer_load_dwordx4 v6, s[24:27], s45 offen lds
    v_mfma_f32_16x16x32_bf16 v[128:131], a[192:195], v[48:51], v[128:131]
    s_waitcnt vmcnt(15)
    ds_read_b64_tr_b16 a[216:217], v3 offset:96
    ds_read_b128 v[24:27], v9 offset:11280
    v_mfma_f32_16x16x32_bf16 v[128:131], a[196:199], v[52:55], v[128:131]
    ds_read_b64_tr_b16 a[218:219], v3 offset:608
    ds_read_b64_tr_b16 a[220:221], v3 offset:16992
    v_fma_mix_f32 v32, v64, v16, v20 op_sel:[0,0,0] op_sel_hi:[1,0,0]
    v_mfma_f32_16x16x32_bf16 v[160:163], a[192:195], v[56:59], v[160:163]
    s_add_u32 m0, s44, 76896
    ds_read_b64_tr_b16 a[222:223], v3 offset:17504
    ds_read_b128 v[28:31], v9 offset:11312
    v_mfma_f32_16x16x32_bf16 v[160:163], a[196:199], v[60:63], v[160:163]
    s_mov_b32 s45, 2646016
    s_waitcnt lgkmcnt(10)
    buffer_load_dwordx4 v6, s[24:27], s45 offen lds
    v_mfma_f32_16x16x32_bf16 v[132:135], a[200:203], v[48:51], v[132:135]
    ds_read_b64_tr_b16 a[224:225], v3 offset:128
    v_fma_mix_f32 v33, v64, v17, v21 op_sel:[1,0,0] op_sel_hi:[1,0,0]
    v_mfma_f32_16x16x32_bf16 v[132:135], a[204:207], v[52:55], v[132:135]
    ds_read_b64_tr_b16 a[226:227], v3 offset:640
    ds_read_b64_tr_b16 a[228:229], v3 offset:17024
    v_fma_mix_f32 v34, v65, v18, v22 op_sel:[0,0,0] op_sel_hi:[1,0,0]
    v_mfma_f32_16x16x32_bf16 v[164:167], a[200:203], v[56:59], v[164:167]
    s_add_u32 m0, s44, 90624
    ds_read_b64_tr_b16 a[230:231], v3 offset:17536
    v_fma_mix_f32 v35, v65, v19, v23 op_sel:[1,0,0] op_sel_hi:[1,0,0]
    v_mfma_f32_16x16x32_bf16 v[164:167], a[204:207], v[60:63], v[164:167]
    s_mov_b32 s45, 2883584
    s_waitcnt lgkmcnt(10)
    buffer_load_dwordx4 v6, s[24:27], s45 offen lds
    v_mfma_f32_16x16x32_bf16 v[136:139], a[208:211], v[48:51], v[136:139]
    ds_read_b64_tr_b16 a[232:233], v3 offset:160
    v_cvt_pk_bf16_f32 v64, v32, v33
    v_mfma_f32_16x16x32_bf16 v[136:139], a[212:215], v[52:55], v[136:139]
    ds_read_b64_tr_b16 a[234:235], v3 offset:672
    ds_read_b64_tr_b16 a[236:237], v3 offset:17056
    v_cvt_pk_bf16_f32 v65, v34, v35
    v_mfma_f32_16x16x32_bf16 v[168:171], a[208:211], v[56:59], v[168:171]
    s_add_u32 m0, s44, 91680
    ds_read_b64_tr_b16 a[238:239], v3 offset:17568
    v_fma_mix_f32 v36, v72, v16, v20 op_sel:[0,0,0] op_sel_hi:[1,0,0]
    v_mfma_f32_16x16x32_bf16 v[168:171], a[212:215], v[60:63], v[168:171]
    s_mov_b32 s45, 2891776
    s_waitcnt lgkmcnt(9)
    buffer_load_dwordx4 v6, s[24:27], s45 offen lds
    v_fma_mix_f32 v37, v72, v17, v21 op_sel:[1,0,0] op_sel_hi:[1,0,0]
    v_mfma_f32_16x16x32_bf16 v[140:143], a[216:219], v[48:51], v[140:143]
    ds_read_b64_tr_b16 a[240:241], v3 offset:192
    v_fma_mix_f32 v38, v73, v18, v22 op_sel:[0,0,0] op_sel_hi:[1,0,0]
    v_mfma_f32_16x16x32_bf16 v[140:143], a[220:223], v[52:55], v[140:143]
    ds_read_b64_tr_b16 a[242:243], v3 offset:704
    ds_read_b64_tr_b16 a[244:245], v3 offset:17088
    v_fma_mix_f32 v39, v73, v19, v23 op_sel:[1,0,0] op_sel_hi:[1,0,0]
    v_mfma_f32_16x16x32_bf16 v[172:175], a[216:219], v[56:59], v[172:175]
    s_add_u32 m0, s44, 92736
    ds_read_b64_tr_b16 a[246:247], v3 offset:17600
    v_cvt_pk_bf16_f32 v72, v36, v37
    v_mfma_f32_16x16x32_bf16 v[172:175], a[220:223], v[60:63], v[172:175]
    s_mov_b32 s45, 2899968
    s_waitcnt lgkmcnt(8)
    buffer_load_dwordx4 v6, s[24:27], s45 offen lds
    v_cvt_pk_bf16_f32 v73, v38, v39
    v_mfma_f32_16x16x32_bf16 v[144:147], a[224:227], v[48:51], v[144:147]
    ds_read_b64_tr_b16 a[248:249], v3 offset:224
    ds_read_b128 v[16:19], v9 offset:11520
    v_mfma_f32_16x16x32_bf16 v[144:147], a[228:231], v[52:55], v[144:147]
    ds_read_b64_tr_b16 a[250:251], v3 offset:736
    ds_read_b64_tr_b16 a[252:253], v3 offset:17120
    v_mfma_f32_16x16x32_bf16 v[176:179], a[224:227], v[56:59], v[176:179]
    s_add_u32 m0, s44, 93792
    ds_read_b64_tr_b16 a[254:255], v3 offset:17632
    ds_read_b128 v[20:23], v9 offset:11552
    v_mfma_f32_16x16x32_bf16 v[176:179], a[228:231], v[60:63], v[176:179]
    s_mov_b32 s45, 2908160
    s_waitcnt lgkmcnt(10)
    buffer_load_dwordx4 v6, s[24:27], s45 offen lds
    v_mfma_f32_16x16x32_bf16 v[148:151], a[232:235], v[48:51], v[148:151]
    ds_read_b64_tr_b16 a[192:193], v3 offset:256
    v_fma_mix_f32 v32, v66, v24, v28 op_sel:[0,0,0] op_sel_hi:[1,0,0]
    v_mfma_f32_16x16x32_bf16 v[148:151], a[236:239], v[52:55], v[148:151]
    ds_read_b64_tr_b16 a[194:195], v3 offset:768
    v_fma_mix_f32 v33, v66, v25, v29 op_sel:[1,0,0] op_sel_hi:[1,0,0]
    v_mfma_f32_16x16x32_bf16 v[180:183], a[232:235], v[56:59], v[180:183]
    ds_read_b64_tr_b16 a[196:197], v3 offset:17152
    v_fma_mix_f32 v34, v67, v26, v30 op_sel:[0,0,0] op_sel_hi:[1,0,0]
    v_mfma_f32_16x16x32_bf16 v[180:183], a[236:239], v[60:63], v[180:183]
    s_waitcnt lgkmcnt(9)
    ds_read_b64_tr_b16 a[198:199], v3 offset:17664
    v_fma_mix_f32 v35, v67, v27, v31 op_sel:[1,0,0] op_sel_hi:[1,0,0]
    v_mfma_f32_16x16x32_bf16 v[152:155], a[240:243], v[48:51], v[152:155]
    ds_read_b64_tr_b16 a[200:201], v3 offset:288
    v_cvt_pk_bf16_f32 v66, v32, v33
    v_mfma_f32_16x16x32_bf16 v[152:155], a[244:247], v[52:55], v[152:155]
    ds_read_b64_tr_b16 a[202:203], v3 offset:800
    v_cvt_pk_bf16_f32 v67, v34, v35
    v_mfma_f32_16x16x32_bf16 v[184:187], a[240:243], v[56:59], v[184:187]
    ds_read_b64_tr_b16 a[204:205], v3 offset:17184
    v_fma_mix_f32 v36, v74, v24, v28 op_sel:[0,0,0] op_sel_hi:[1,0,0]
    v_mfma_f32_16x16x32_bf16 v[184:187], a[244:247], v[60:63], v[184:187]
    s_waitcnt lgkmcnt(8)
    ds_read_b64_tr_b16 a[206:207], v3 offset:17696
    v_fma_mix_f32 v37, v74, v25, v29 op_sel:[1,0,0] op_sel_hi:[1,0,0]
    v_mfma_f32_16x16x32_bf16 v[156:159], a[248:251], v[48:51], v[156:159]
    ds_read_b64_tr_b16 a[208:209], v3 offset:320
    v_fma_mix_f32 v38, v75, v26, v30 op_sel:[0,0,0] op_sel_hi:[1,0,0]
    v_mfma_f32_16x16x32_bf16 v[156:159], a[252:255], v[52:55], v[156:159]
    ds_read_b64_tr_b16 a[210:211], v3 offset:832
    v_fma_mix_f32 v39, v75, v27, v31 op_sel:[1,0,0] op_sel_hi:[1,0,0]
    v_mfma_f32_16x16x32_bf16 v[188:191], a[248:251], v[56:59], v[188:191]
    ds_read_b64_tr_b16 a[212:213], v3 offset:17216
    v_cvt_pk_bf16_f32 v74, v36, v37
    v_mfma_f32_16x16x32_bf16 v[188:191], a[252:255], v[60:63], v[188:191]
    s_waitcnt lgkmcnt(7)
    ds_read_b64_tr_b16 a[214:215], v3 offset:17728
    v_cvt_pk_bf16_f32 v75, v38, v39
    v_mfma_f32_16x16x32_bf16 v[192:195], a[192:195], v[48:51], v[192:195]
    ds_read_b64_tr_b16 a[216:217], v3 offset:352
    ds_read_b128 v[24:27], v9 offset:11536
    v_mfma_f32_16x16x32_bf16 v[192:195], a[196:199], v[52:55], v[192:195]
    ds_read_b64_tr_b16 a[218:219], v3 offset:864
    ds_read_b64_tr_b16 a[220:221], v3 offset:17248
    v_fma_mix_f32 v32, v68, v16, v20 op_sel:[0,0,0] op_sel_hi:[1,0,0]
    v_mfma_f32_16x16x32_bf16 v[224:227], a[192:195], v[56:59], v[224:227]
    s_mov_b32 s54, 12288
    ds_read_b64_tr_b16 a[222:223], v3 offset:17760
    ds_read_b128 v[28:31], v9 offset:11568
    v_mfma_f32_16x16x32_bf16 v[224:227], a[196:199], v[60:63], v[224:227]
    s_waitcnt lgkmcnt(10)
    buffer_load_dwordx4 v[96:99], v8, s[32:35], s54 offen sc1
    v_mfma_f32_16x16x32_bf16 v[196:199], a[200:203], v[48:51], v[196:199]
    ds_read_b64_tr_b16 a[224:225], v3 offset:384
    v_fma_mix_f32 v33, v68, v17, v21 op_sel:[1,0,0] op_sel_hi:[1,0,0]
    v_mfma_f32_16x16x32_bf16 v[196:199], a[204:207], v[52:55], v[196:199]
    ds_read_b64_tr_b16 a[226:227], v3 offset:896
    ds_read_b64_tr_b16 a[228:229], v3 offset:17280
    v_fma_mix_f32 v34, v69, v18, v22 op_sel:[0,0,0] op_sel_hi:[1,0,0]
    v_mfma_f32_16x16x32_bf16 v[228:231], a[200:203], v[56:59], v[228:231]
    s_mov_b32 s54, 13312
    ds_read_b64_tr_b16 a[230:231], v3 offset:17792
    v_fma_mix_f32 v35, v69, v19, v23 op_sel:[1,0,0] op_sel_hi:[1,0,0]
    v_mfma_f32_16x16x32_bf16 v[228:231], a[204:207], v[60:63], v[228:231]
    s_waitcnt lgkmcnt(10)
    buffer_load_dwordx4 v[100:103], v8, s[32:35], s54 offen sc1
    v_mfma_f32_16x16x32_bf16 v[200:203], a[208:211], v[48:51], v[200:203]
    ds_read_b64_tr_b16 a[232:233], v3 offset:416
    v_cvt_pk_bf16_f32 v68, v32, v33
    v_mfma_f32_16x16x32_bf16 v[200:203], a[212:215], v[52:55], v[200:203]
    ds_read_b64_tr_b16 a[234:235], v3 offset:928
    ds_read_b64_tr_b16 a[236:237], v3 offset:17312
    v_cvt_pk_bf16_f32 v69, v34, v35
    v_mfma_f32_16x16x32_bf16 v[232:235], a[208:211], v[56:59], v[232:235]
    s_mov_b32 s54, 30720
    ds_read_b64_tr_b16 a[238:239], v3 offset:17824
    v_fma_mix_f32 v36, v76, v16, v20 op_sel:[0,0,0] op_sel_hi:[1,0,0]
    v_mfma_f32_16x16x32_bf16 v[232:235], a[212:215], v[60:63], v[232:235]
    s_waitcnt lgkmcnt(9)
    buffer_load_dwordx4 v[104:107], v8, s[32:35], s54 offen sc1
    v_fma_mix_f32 v37, v76, v17, v21 op_sel:[1,0,0] op_sel_hi:[1,0,0]
    v_mfma_f32_16x16x32_bf16 v[204:207], a[216:219], v[48:51], v[204:207]
    ds_read_b64_tr_b16 a[240:241], v3 offset:448
    v_fma_mix_f32 v38, v77, v18, v22 op_sel:[0,0,0] op_sel_hi:[1,0,0]
    v_mfma_f32_16x16x32_bf16 v[204:207], a[220:223], v[52:55], v[204:207]
    ds_read_b64_tr_b16 a[242:243], v3 offset:960
    ds_read_b64_tr_b16 a[244:245], v3 offset:17344
    v_fma_mix_f32 v39, v77, v19, v23 op_sel:[1,0,0] op_sel_hi:[1,0,0]
    v_mfma_f32_16x16x32_bf16 v[236:239], a[216:219], v[56:59], v[236:239]
    s_mov_b32 s54, 31744
    ds_read_b64_tr_b16 a[246:247], v3 offset:17856
    v_cvt_pk_bf16_f32 v76, v36, v37
    v_mfma_f32_16x16x32_bf16 v[236:239], a[220:223], v[60:63], v[236:239]
    s_waitcnt lgkmcnt(8)
    buffer_load_dwordx4 v[108:111], v8, s[32:35], s54 offen sc1
    v_cvt_pk_bf16_f32 v77, v38, v39
    v_mfma_f32_16x16x32_bf16 v[208:211], a[224:227], v[48:51], v[208:211]
    ds_read_b64_tr_b16 a[248:249], v3 offset:480
    ds_read_b128 v[16:19], v9 offset:11776
    v_mfma_f32_16x16x32_bf16 v[208:211], a[228:231], v[52:55], v[208:211]
    ds_read_b64_tr_b16 a[250:251], v3 offset:992
    ds_read_b128 v[20:23], v9 offset:11808
    v_mfma_f32_16x16x32_bf16 v[240:243], a[224:227], v[56:59], v[240:243]
    ds_read_b64_tr_b16 a[252:253], v3 offset:17376
    v_fma_mix_f32 v32, v70, v24, v28 op_sel:[0,0,0] op_sel_hi:[1,0,0]
    v_mfma_f32_16x16x32_bf16 v[240:243], a[228:231], v[60:63], v[240:243]
    s_waitcnt vmcnt(16)
    s_barrier
    s_waitcnt lgkmcnt(9)
    ds_read_b64_tr_b16 a[254:255], v3 offset:17888
    v_fma_mix_f32 v33, v70, v25, v29 op_sel:[1,0,0] op_sel_hi:[1,0,0]
    v_fma_mix_f32 v34, v71, v26, v30 op_sel:[0,0,0] op_sel_hi:[1,0,0]
    v_mfma_f32_16x16x32_bf16 v[212:215], a[232:235], v[48:51], v[212:215]
    ds_read_b64_tr_b16 a[192:193], v3 offset:36864
    v_fma_mix_f32 v35, v71, v27, v31 op_sel:[1,0,0] op_sel_hi:[1,0,0]
    v_mfma_f32_16x16x32_bf16 v[212:215], a[236:239], v[52:55], v[212:215]
    ds_read_b64_tr_b16 a[194:195], v3 offset:37376
    ds_read_b64_tr_b16 a[196:197], v3 offset:53760
    v_cvt_pk_bf16_f32 v70, v32, v33
    v_mfma_f32_16x16x32_bf16 v[244:247], a[232:235], v[56:59], v[244:247]
    s_add_u32 m0, s44, 110592
    ds_read_b64_tr_b16 a[198:199], v3 offset:54272
    v_cvt_pk_bf16_f32 v71, v34, v35
    v_mfma_f32_16x16x32_bf16 v[244:247], a[236:239], v[60:63], v[244:247]
    s_mov_b32 s45, 3145728
    s_waitcnt lgkmcnt(10)
    buffer_load_dwordx4 v6, s[24:27], s45 offen lds
    v_mfma_f32_16x16x32_bf16 v[216:219], a[240:243], v[48:51], v[216:219]
    ds_read_b64_tr_b16 a[200:201], v3 offset:36896
    v_fma_mix_f32 v36, v78, v24, v28 op_sel:[0,0,0] op_sel_hi:[1,0,0]
    v_mfma_f32_16x16x32_bf16 v[216:219], a[244:247], v[52:55], v[216:219]
    ds_read_b64_tr_b16 a[202:203], v3 offset:37408
    ds_read_b64_tr_b16 a[204:205], v3 offset:53792
    v_fma_mix_f32 v37, v78, v25, v29 op_sel:[1,0,0] op_sel_hi:[1,0,0]
    v_mfma_f32_16x16x32_bf16 v[248:251], a[240:243], v[56:59], v[248:251]
    s_add_u32 m0, s44, 111648
    ds_read_b64_tr_b16 a[206:207], v3 offset:54304
    v_fma_mix_f32 v38, v79, v26, v30 op_sel:[0,0,0] op_sel_hi:[1,0,0]
    v_mfma_f32_16x16x32_bf16 v[248:251], a[244:247], v[60:63], v[248:251]
    s_mov_b32 s45, 3153920
    s_waitcnt lgkmcnt(8)
    buffer_load_dwordx4 v6, s[24:27], s45 offen lds
    v_mfma_f32_16x16x32_bf16 v[220:223], a[248:251], v[48:51], v[220:223]
    ds_read_b64_tr_b16 a[208:209], v3 offset:36928
    v_fma_mix_f32 v39, v79, v27, v31 op_sel:[1,0,0] op_sel_hi:[1,0,0]
    v_mfma_f32_16x16x32_bf16 v[220:223], a[252:255], v[52:55], v[220:223]
    ds_read_b64_tr_b16 a[210:211], v3 offset:37440
    ds_read_b64_tr_b16 a[212:213], v3 offset:53824
    v_cvt_pk_bf16_f32 v78, v36, v37
    v_mfma_f32_16x16x32_bf16 v[252:255], a[248:251], v[56:59], v[252:255]
    s_add_u32 m0, s44, 112704
    ds_read_b64_tr_b16 a[214:215], v3 offset:54336
    v_cvt_pk_bf16_f32 v79, v38, v39
    v_mfma_f32_16x16x32_bf16 v[252:255], a[252:255], v[60:63], v[252:255]
    s_mov_b32 s45, 3162112
    s_waitcnt lgkmcnt(8)
    buffer_load_dwordx4 v6, s[24:27], s45 offen lds
    v_mfma_f32_16x16x32_bf16 v[128:131], a[192:195], v[64:67], v[128:131]
    s_waitcnt vmcnt(15)
    ds_read_b64_tr_b16 a[216:217], v3 offset:36960
    ds_read_b128 v[24:27], v9 offset:11792
    v_mfma_f32_16x16x32_bf16 v[128:131], a[196:199], v[68:71], v[128:131]
    ds_read_b64_tr_b16 a[218:219], v3 offset:37472
    ds_read_b64_tr_b16 a[220:221], v3 offset:53856
    v_fma_mix_f32 v32, v80, v16, v20 op_sel:[0,0,0] op_sel_hi:[1,0,0]
    v_mfma_f32_16x16x32_bf16 v[160:163], a[192:195], v[72:75], v[160:163]
    s_add_u32 m0, s44, 113760
    ds_read_b64_tr_b16 a[222:223], v3 offset:54368
    ds_read_b128 v[28:31], v9 offset:11824
    v_mfma_f32_16x16x32_bf16 v[160:163], a[196:199], v[76:79], v[160:163]
    s_mov_b32 s45, 3170304
    s_waitcnt lgkmcnt(10)
    buffer_load_dwordx4 v6, s[24:27], s45 offen lds
    v_mfma_f32_16x16x32_bf16 v[132:135], a[200:203], v[64:67], v[132:135]
    ds_read_b64_tr_b16 a[224:225], v3 offset:36992
    v_fma_mix_f32 v33, v80, v17, v21 op_sel:[1,0,0] op_sel_hi:[1,0,0]
    v_mfma_f32_16x16x32_bf16 v[132:135], a[204:207], v[68:71], v[132:135]
    ds_read_b64_tr_b16 a[226:227], v3 offset:37504
    ds_read_b64_tr_b16 a[228:229], v3 offset:53888
    v_fma_mix_f32 v34, v81, v18, v22 op_sel:[0,0,0] op_sel_hi:[1,0,0]
    v_mfma_f32_16x16x32_bf16 v[164:167], a[200:203], v[72:75], v[164:167]
    s_add_u32 m0, s44, 127488
    ds_read_b64_tr_b16 a[230:231], v3 offset:54400
    v_fma_mix_f32 v35, v81, v19, v23 op_sel:[1,0,0] op_sel_hi:[1,0,0]
    v_mfma_f32_16x16x32_bf16 v[164:167], a[204:207], v[76:79], v[164:167]
    s_mov_b32 s45, 3407872
    s_waitcnt lgkmcnt(10)
    buffer_load_dwordx4 v6, s[24:27], s45 offen lds
    v_mfma_f32_16x16x32_bf16 v[136:139], a[208:211], v[64:67], v[136:139]
    ds_read_b64_tr_b16 a[232:233], v3 offset:37024
    v_cvt_pk_bf16_f32 v80, v32, v33
    v_mfma_f32_16x16x32_bf16 v[136:139], a[212:215], v[68:71], v[136:139]
    ds_read_b64_tr_b16 a[234:235], v3 offset:37536
    ds_read_b64_tr_b16 a[236:237], v3 offset:53920
    v_cvt_pk_bf16_f32 v81, v34, v35
    v_mfma_f32_16x16x32_bf16 v[168:171], a[208:211], v[72:75], v[168:171]
    s_add_u32 m0, s44, 128544
    ds_read_b64_tr_b16 a[238:239], v3 offset:54432
    v_fma_mix_f32 v36, v88, v16, v20 op_sel:[0,0,0] op_sel_hi:[1,0,0]
    v_mfma_f32_16x16x32_bf16 v[168:171], a[212:215], v[76:79], v[168:171]
    s_mov_b32 s45, 3416064
    s_waitcnt lgkmcnt(9)
    buffer_load_dwordx4 v6, s[24:27], s45 offen lds
    v_fma_mix_f32 v37, v88, v17, v21 op_sel:[1,0,0] op_sel_hi:[1,0,0]
    v_mfma_f32_16x16x32_bf16 v[140:143], a[216:219], v[64:67], v[140:143]
    ds_read_b64_tr_b16 a[240:241], v3 offset:37056
    v_fma_mix_f32 v38, v89, v18, v22 op_sel:[0,0,0] op_sel_hi:[1,0,0]
    v_mfma_f32_16x16x32_bf16 v[140:143], a[220:223], v[68:71], v[140:143]
    ds_read_b64_tr_b16 a[242:243], v3 offset:37568
    ds_read_b64_tr_b16 a[244:245], v3 offset:53952
    v_fma_mix_f32 v39, v89, v19, v23 op_sel:[1,0,0] op_sel_hi:[1,0,0]
    v_mfma_f32_16x16x32_bf16 v[172:175], a[216:219], v[72:75], v[172:175]
    s_add_u32 m0, s44, 129600
    ds_read_b64_tr_b16 a[246:247], v3 offset:54464
    v_cvt_pk_bf16_f32 v88, v36, v37
    v_mfma_f32_16x16x32_bf16 v[172:175], a[220:223], v[76:79], v[172:175]
    s_mov_b32 s45, 3424256
    s_waitcnt lgkmcnt(8)
    buffer_load_dwordx4 v6, s[24:27], s45 offen lds
    v_cvt_pk_bf16_f32 v89, v38, v39
    v_mfma_f32_16x16x32_bf16 v[144:147], a[224:227], v[64:67], v[144:147]
    ds_read_b64_tr_b16 a[248:249], v3 offset:37088
    ds_read_b128 v[16:19], v9 offset:12032
    v_mfma_f32_16x16x32_bf16 v[144:147], a[228:231], v[68:71], v[144:147]
    ds_read_b64_tr_b16 a[250:251], v3 offset:37600
    ds_read_b64_tr_b16 a[252:253], v3 offset:53984
    v_mfma_f32_16x16x32_bf16 v[176:179], a[224:227], v[72:75], v[176:179]
    s_add_u32 m0, s44, 130656
    ds_read_b64_tr_b16 a[254:255], v3 offset:54496
    ds_read_b128 v[20:23], v9 offset:12064
    v_mfma_f32_16x16x32_bf16 v[176:179], a[228:231], v[76:79], v[176:179]
    s_mov_b32 s45, 3432448
    s_waitcnt lgkmcnt(10)
    buffer_load_dwordx4 v6, s[24:27], s45 offen lds
    v_mfma_f32_16x16x32_bf16 v[148:151], a[232:235], v[64:67], v[148:151]
    ds_read_b64_tr_b16 a[192:193], v3 offset:37120
    v_fma_mix_f32 v32, v82, v24, v28 op_sel:[0,0,0] op_sel_hi:[1,0,0]
    v_mfma_f32_16x16x32_bf16 v[148:151], a[236:239], v[68:71], v[148:151]
    ds_read_b64_tr_b16 a[194:195], v3 offset:37632
    v_fma_mix_f32 v33, v82, v25, v29 op_sel:[1,0,0] op_sel_hi:[1,0,0]
    v_mfma_f32_16x16x32_bf16 v[180:183], a[232:235], v[72:75], v[180:183]
    ds_read_b64_tr_b16 a[196:197], v3 offset:54016
    v_fma_mix_f32 v34, v83, v26, v30 op_sel:[0,0,0] op_sel_hi:[1,0,0]
    v_mfma_f32_16x16x32_bf16 v[180:183], a[236:239], v[76:79], v[180:183]
    s_waitcnt lgkmcnt(9)
    ds_read_b64_tr_b16 a[198:199], v3 offset:54528
    v_fma_mix_f32 v35, v83, v27, v31 op_sel:[1,0,0] op_sel_hi:[1,0,0]
    v_mfma_f32_16x16x32_bf16 v[152:155], a[240:243], v[64:67], v[152:155]
    ds_read_b64_tr_b16 a[200:201], v3 offset:37152
    v_cvt_pk_bf16_f32 v82, v32, v33
    v_mfma_f32_16x16x32_bf16 v[152:155], a[244:247], v[68:71], v[152:155]
    ds_read_b64_tr_b16 a[202:203], v3 offset:37664
    v_cvt_pk_bf16_f32 v83, v34, v35
    v_mfma_f32_16x16x32_bf16 v[184:187], a[240:243], v[72:75], v[184:187]
    ds_read_b64_tr_b16 a[204:205], v3 offset:54048
    v_fma_mix_f32 v36, v90, v24, v28 op_sel:[0,0,0] op_sel_hi:[1,0,0]
    v_mfma_f32_16x16x32_bf16 v[184:187], a[244:247], v[76:79], v[184:187]
    s_waitcnt lgkmcnt(8)
    ds_read_b64_tr_b16 a[206:207], v3 offset:54560
    v_fma_mix_f32 v37, v90, v25, v29 op_sel:[1,0,0] op_sel_hi:[1,0,0]
    v_mfma_f32_16x16x32_bf16 v[156:159], a[248:251], v[64:67], v[156:159]
    ds_read_b64_tr_b16 a[208:209], v3 offset:37184
    v_fma_mix_f32 v38, v91, v26, v30 op_sel:[0,0,0] op_sel_hi:[1,0,0]
    v_mfma_f32_16x16x32_bf16 v[156:159], a[252:255], v[68:71], v[156:159]
    ds_read_b64_tr_b16 a[210:211], v3 offset:37696
    v_fma_mix_f32 v39, v91, v27, v31 op_sel:[1,0,0] op_sel_hi:[1,0,0]
    v_mfma_f32_16x16x32_bf16 v[188:191], a[248:251], v[72:75], v[188:191]
    ds_read_b64_tr_b16 a[212:213], v3 offset:54080
    v_cvt_pk_bf16_f32 v90, v36, v37
    v_mfma_f32_16x16x32_bf16 v[188:191], a[252:255], v[76:79], v[188:191]
    s_waitcnt lgkmcnt(7)
    ds_read_b64_tr_b16 a[214:215], v3 offset:54592
    v_cvt_pk_bf16_f32 v91, v38, v39
    v_mfma_f32_16x16x32_bf16 v[192:195], a[192:195], v[64:67], v[192:195]
    ds_read_b64_tr_b16 a[216:217], v3 offset:37216
    ds_read_b128 v[24:27], v9 offset:12048
    v_mfma_f32_16x16x32_bf16 v[192:195], a[196:199], v[68:71], v[192:195]
    ds_read_b64_tr_b16 a[218:219], v3 offset:37728
    ds_read_b64_tr_b16 a[220:221], v3 offset:54112
    v_fma_mix_f32 v32, v84, v16, v20 op_sel:[0,0,0] op_sel_hi:[1,0,0]
    v_mfma_f32_16x16x32_bf16 v[224:227], a[192:195], v[72:75], v[224:227]
    s_mov_b32 s54, 14336
    ds_read_b64_tr_b16 a[222:223], v3 offset:54624
    ds_read_b128 v[28:31], v9 offset:12080
    v_mfma_f32_16x16x32_bf16 v[224:227], a[196:199], v[76:79], v[224:227]
    s_waitcnt lgkmcnt(10)
    buffer_load_dwordx4 v[112:115], v8, s[32:35], s54 offen sc1
    v_mfma_f32_16x16x32_bf16 v[196:199], a[200:203], v[64:67], v[196:199]
    ds_read_b64_tr_b16 a[224:225], v3 offset:37248
    v_fma_mix_f32 v33, v84, v17, v21 op_sel:[1,0,0] op_sel_hi:[1,0,0]
    v_mfma_f32_16x16x32_bf16 v[196:199], a[204:207], v[68:71], v[196:199]
    ds_read_b64_tr_b16 a[226:227], v3 offset:37760
    ds_read_b64_tr_b16 a[228:229], v3 offset:54144
    v_fma_mix_f32 v34, v85, v18, v22 op_sel:[0,0,0] op_sel_hi:[1,0,0]
    v_mfma_f32_16x16x32_bf16 v[228:231], a[200:203], v[72:75], v[228:231]
    s_mov_b32 s54, 15360
    ds_read_b64_tr_b16 a[230:231], v3 offset:54656
    v_fma_mix_f32 v35, v85, v19, v23 op_sel:[1,0,0] op_sel_hi:[1,0,0]
    v_mfma_f32_16x16x32_bf16 v[228:231], a[204:207], v[76:79], v[228:231]
    s_waitcnt lgkmcnt(10)
    buffer_load_dwordx4 v[116:119], v8, s[32:35], s54 offen sc1
    v_mfma_f32_16x16x32_bf16 v[200:203], a[208:211], v[64:67], v[200:203]
    ds_read_b64_tr_b16 a[232:233], v3 offset:37280
    v_cvt_pk_bf16_f32 v84, v32, v33
    v_mfma_f32_16x16x32_bf16 v[200:203], a[212:215], v[68:71], v[200:203]
    ds_read_b64_tr_b16 a[234:235], v3 offset:37792
    ds_read_b64_tr_b16 a[236:237], v3 offset:54176
    v_cvt_pk_bf16_f32 v85, v34, v35
    v_mfma_f32_16x16x32_bf16 v[232:235], a[208:211], v[72:75], v[232:235]
    s_mov_b32 s54, 32768
    ds_read_b64_tr_b16 a[238:239], v3 offset:54688
    v_fma_mix_f32 v36, v92, v16, v20 op_sel:[0,0,0] op_sel_hi:[1,0,0]
    v_mfma_f32_16x16x32_bf16 v[232:235], a[212:215], v[76:79], v[232:235]
    s_waitcnt lgkmcnt(9)
    buffer_load_dwordx4 v[120:123], v8, s[32:35], s54 offen sc1
    v_fma_mix_f32 v37, v92, v17, v21 op_sel:[1,0,0] op_sel_hi:[1,0,0]
    v_mfma_f32_16x16x32_bf16 v[204:207], a[216:219], v[64:67], v[204:207]
    ds_read_b64_tr_b16 a[240:241], v3 offset:37312
    v_fma_mix_f32 v38, v93, v18, v22 op_sel:[0,0,0] op_sel_hi:[1,0,0]
    v_mfma_f32_16x16x32_bf16 v[204:207], a[220:223], v[68:71], v[204:207]
    ds_read_b64_tr_b16 a[242:243], v3 offset:37824
    ds_read_b64_tr_b16 a[244:245], v3 offset:54208
    v_fma_mix_f32 v39, v93, v19, v23 op_sel:[1,0,0] op_sel_hi:[1,0,0]
    v_mfma_f32_16x16x32_bf16 v[236:239], a[216:219], v[72:75], v[236:239]
    s_mov_b32 s54, 33792
    ds_read_b64_tr_b16 a[246:247], v3 offset:54720
    v_cvt_pk_bf16_f32 v92, v36, v37
    v_mfma_f32_16x16x32_bf16 v[236:239], a[220:223], v[76:79], v[236:239]
    s_waitcnt lgkmcnt(8)
    buffer_load_dwordx4 v[124:127], v8, s[32:35], s54 offen sc1
    v_cvt_pk_bf16_f32 v93, v38, v39
    v_mfma_f32_16x16x32_bf16 v[208:211], a[224:227], v[64:67], v[208:211]
    ds_read_b64_tr_b16 a[248:249], v3 offset:37344
    ds_read_b128 v[16:19], v9 offset:12288
    v_mfma_f32_16x16x32_bf16 v[208:211], a[228:231], v[68:71], v[208:211]
    ds_read_b64_tr_b16 a[250:251], v3 offset:37856
    ds_read_b128 v[20:23], v9 offset:12320
    v_mfma_f32_16x16x32_bf16 v[240:243], a[224:227], v[72:75], v[240:243]
    ds_read_b64_tr_b16 a[252:253], v3 offset:54240
    v_fma_mix_f32 v32, v86, v24, v28 op_sel:[0,0,0] op_sel_hi:[1,0,0]
    v_mfma_f32_16x16x32_bf16 v[240:243], a[228:231], v[76:79], v[240:243]
    s_waitcnt vmcnt(16)
    s_barrier
    s_waitcnt lgkmcnt(9)
    ds_read_b64_tr_b16 a[254:255], v3 offset:54752
    v_fma_mix_f32 v33, v86, v25, v29 op_sel:[1,0,0] op_sel_hi:[1,0,0]
    v_fma_mix_f32 v34, v87, v26, v30 op_sel:[0,0,0] op_sel_hi:[1,0,0]
    v_mfma_f32_16x16x32_bf16 v[212:215], a[232:235], v[64:67], v[212:215]
    ds_read_b64_tr_b16 a[192:193], v4 offset:0
    v_fma_mix_f32 v35, v87, v27, v31 op_sel:[1,0,0] op_sel_hi:[1,0,0]
    v_mfma_f32_16x16x32_bf16 v[212:215], a[236:239], v[68:71], v[212:215]
    ds_read_b64_tr_b16 a[194:195], v4 offset:512
    ds_read_b64_tr_b16 a[196:197], v4 offset:16896
    v_cvt_pk_bf16_f32 v86, v32, v33
    v_mfma_f32_16x16x32_bf16 v[244:247], a[232:235], v[72:75], v[244:247]
    s_add_u32 m0, s44, 0
    ds_read_b64_tr_b16 a[198:199], v4 offset:17408
    v_cvt_pk_bf16_f32 v87, v34, v35
    v_mfma_f32_16x16x32_bf16 v[244:247], a[236:239], v[76:79], v[244:247]
    s_mov_b32 s45, 3670016
    s_waitcnt lgkmcnt(10)
    buffer_load_dwordx4 v6, s[24:27], s45 offen lds
    v_mfma_f32_16x16x32_bf16 v[216:219], a[240:243], v[64:67], v[216:219]
    ds_read_b64_tr_b16 a[200:201], v4 offset:32
    v_fma_mix_f32 v36, v94, v24, v28 op_sel:[0,0,0] op_sel_hi:[1,0,0]
    v_mfma_f32_16x16x32_bf16 v[216:219], a[244:247], v[68:71], v[216:219]
    ds_read_b64_tr_b16 a[202:203], v4 offset:544
    ds_read_b64_tr_b16 a[204:205], v4 offset:16928
    v_fma_mix_f32 v37, v94, v25, v29 op_sel:[1,0,0] op_sel_hi:[1,0,0]
    v_mfma_f32_16x16x32_bf16 v[248:251], a[240:243], v[72:75], v[248:251]
    s_add_u32 m0, s44, 1056
    ds_read_b64_tr_b16 a[206:207], v4 offset:17440
    v_fma_mix_f32 v38, v95, v26, v30 op_sel:[0,0,0] op_sel_hi:[1,0,0]
    v_mfma_f32_16x16x32_bf16 v[248:251], a[244:247], v[76:79], v[248:251]
    s_mov_b32 s45, 3678208
    s_waitcnt lgkmcnt(8)
    buffer_load_dwordx4 v6, s[24:27], s45 offen lds
    v_mfma_f32_16x16x32_bf16 v[220:223], a[248:251], v[64:67], v[220:223]
    ds_read_b64_tr_b16 a[208:209], v4 offset:64
    v_fma_mix_f32 v39, v95, v27, v31 op_sel:[1,0,0] op_sel_hi:[1,0,0]
    v_mfma_f32_16x16x32_bf16 v[220:223], a[252:255], v[68:71], v[220:223]
    ds_read_b64_tr_b16 a[210:211], v4 offset:576
    ds_read_b64_tr_b16 a[212:213], v4 offset:16960
    v_cvt_pk_bf16_f32 v94, v36, v37
    v_mfma_f32_16x16x32_bf16 v[252:255], a[248:251], v[72:75], v[252:255]
    s_add_u32 m0, s44, 2112
    ds_read_b64_tr_b16 a[214:215], v4 offset:17472
    v_cvt_pk_bf16_f32 v95, v38, v39
    v_mfma_f32_16x16x32_bf16 v[252:255], a[252:255], v[76:79], v[252:255]
    s_mov_b32 s45, 3686400
    s_waitcnt lgkmcnt(8)
    buffer_load_dwordx4 v6, s[24:27], s45 offen lds
    v_mfma_f32_16x16x32_bf16 v[128:131], a[192:195], v[80:83], v[128:131]
    s_waitcnt vmcnt(15)
    ds_read_b64_tr_b16 a[216:217], v4 offset:96
    ds_read_b128 v[24:27], v9 offset:12304
    v_mfma_f32_16x16x32_bf16 v[128:131], a[196:199], v[84:87], v[128:131]
    ds_read_b64_tr_b16 a[218:219], v4 offset:608
    ds_read_b64_tr_b16 a[220:221], v4 offset:16992
    v_fma_mix_f32 v32, v96, v16, v20 op_sel:[0,0,0] op_sel_hi:[1,0,0]
    v_mfma_f32_16x16x32_bf16 v[160:163], a[192:195], v[88:91], v[160:163]
    s_add_u32 m0, s44, 3168
    ds_read_b64_tr_b16 a[222:223], v4 offset:17504
    ds_read_b128 v[28:31], v9 offset:12336
    v_mfma_f32_16x16x32_bf16 v[160:163], a[196:199], v[92:95], v[160:163]
    s_mov_b32 s45, 3694592
    s_waitcnt lgkmcnt(10)
    buffer_load_dwordx4 v6, s[24:27], s45 offen lds
    v_mfma_f32_16x16x32_bf16 v[132:135], a[200:203], v[80:83], v[132:135]
    ds_read_b64_tr_b16 a[224:225], v4 offset:128
    v_fma_mix_f32 v33, v96, v17, v21 op_sel:[1,0,0] op_sel_hi:[1,0,0]
    v_mfma_f32_16x16x32_bf16 v[132:135], a[204:207], v[84:87], v[132:135]
    ds_read_b64_tr_b16 a[226:227], v4 offset:640
    ds_read_b64_tr_b16 a[228:229], v4 offset:17024
    v_fma_mix_f32 v34, v97, v18, v22 op_sel:[0,0,0] op_sel_hi:[1,0,0]
    v_mfma_f32_16x16x32_bf16 v[164:167], a[200:203], v[88:91], v[164:167]
    s_add_u32 m0, s44, 16896
    ds_read_b64_tr_b16 a[230:231], v4 offset:17536
    v_fma_mix_f32 v35, v97, v19, v23 op_sel:[1,0,0] op_sel_hi:[1,0,0]
    v_mfma_f32_16x16x32_bf16 v[164:167], a[204:207], v[92:95], v[164:167]
    s_mov_b32 s45, 3932160
    s_waitcnt lgkmcnt(10)
    buffer_load_dwordx4 v6, s[24:27], s45 offen lds
    v_mfma_f32_16x16x32_bf16 v[136:139], a[208:211], v[80:83], v[136:139]
    ds_read_b64_tr_b16 a[232:233], v4 offset:160
    v_cvt_pk_bf16_f32 v96, v32, v33
    v_mfma_f32_16x16x32_bf16 v[136:139], a[212:215], v[84:87], v[136:139]
    ds_read_b64_tr_b16 a[234:235], v4 offset:672
    ds_read_b64_tr_b16 a[236:237], v4 offset:17056
    v_cvt_pk_bf16_f32 v97, v34, v35
    v_mfma_f32_16x16x32_bf16 v[168:171], a[208:211], v[88:91], v[168:171]
    s_add_u32 m0, s44, 17952
    ds_read_b64_tr_b16 a[238:239], v4 offset:17568
    v_fma_mix_f32 v36, v104, v16, v20 op_sel:[0,0,0] op_sel_hi:[1,0,0]
    v_mfma_f32_16x16x32_bf16 v[168:171], a[212:215], v[92:95], v[168:171]
    s_mov_b32 s45, 3940352
    s_waitcnt lgkmcnt(9)
    buffer_load_dwordx4 v6, s[24:27], s45 offen lds
    v_fma_mix_f32 v37, v104, v17, v21 op_sel:[1,0,0] op_sel_hi:[1,0,0]
    v_mfma_f32_16x16x32_bf16 v[140:143], a[216:219], v[80:83], v[140:143]
    ds_read_b64_tr_b16 a[240:241], v4 offset:192
    v_fma_mix_f32 v38, v105, v18, v22 op_sel:[0,0,0] op_sel_hi:[1,0,0]
    v_mfma_f32_16x16x32_bf16 v[140:143], a[220:223], v[84:87], v[140:143]
    ds_read_b64_tr_b16 a[242:243], v4 offset:704
    ds_read_b64_tr_b16 a[244:245], v4 offset:17088
    v_fma_mix_f32 v39, v105, v19, v23 op_sel:[1,0,0] op_sel_hi:[1,0,0]
    v_mfma_f32_16x16x32_bf16 v[172:175], a[216:219], v[88:91], v[172:175]
    s_add_u32 m0, s44, 19008
    ds_read_b64_tr_b16 a[246:247], v4 offset:17600
    v_cvt_pk_bf16_f32 v104, v36, v37
    v_mfma_f32_16x16x32_bf16 v[172:175], a[220:223], v[92:95], v[172:175]
    s_mov_b32 s45, 3948544
    s_waitcnt lgkmcnt(8)
    buffer_load_dwordx4 v6, s[24:27], s45 offen lds
    v_cvt_pk_bf16_f32 v105, v38, v39
    v_mfma_f32_16x16x32_bf16 v[144:147], a[224:227], v[80:83], v[144:147]
    ds_read_b64_tr_b16 a[248:249], v4 offset:224
    ds_read_b128 v[16:19], v9 offset:12544
    v_mfma_f32_16x16x32_bf16 v[144:147], a[228:231], v[84:87], v[144:147]
    ds_read_b64_tr_b16 a[250:251], v4 offset:736
    ds_read_b64_tr_b16 a[252:253], v4 offset:17120
    v_mfma_f32_16x16x32_bf16 v[176:179], a[224:227], v[88:91], v[176:179]
    s_add_u32 m0, s44, 20064
    ds_read_b64_tr_b16 a[254:255], v4 offset:17632
    ds_read_b128 v[20:23], v9 offset:12576
    v_mfma_f32_16x16x32_bf16 v[176:179], a[228:231], v[92:95], v[176:179]
    s_mov_b32 s45, 3956736
    s_waitcnt lgkmcnt(10)
    buffer_load_dwordx4 v6, s[24:27], s45 offen lds
    v_mfma_f32_16x16x32_bf16 v[148:151], a[232:235], v[80:83], v[148:151]
    ds_read_b64_tr_b16 a[192:193], v4 offset:256
    v_fma_mix_f32 v32, v98, v24, v28 op_sel:[0,0,0] op_sel_hi:[1,0,0]
    v_mfma_f32_16x16x32_bf16 v[148:151], a[236:239], v[84:87], v[148:151]
    ds_read_b64_tr_b16 a[194:195], v4 offset:768
    v_fma_mix_f32 v33, v98, v25, v29 op_sel:[1,0,0] op_sel_hi:[1,0,0]
    v_mfma_f32_16x16x32_bf16 v[180:183], a[232:235], v[88:91], v[180:183]
    ds_read_b64_tr_b16 a[196:197], v4 offset:17152
    v_fma_mix_f32 v34, v99, v26, v30 op_sel:[0,0,0] op_sel_hi:[1,0,0]
    v_mfma_f32_16x16x32_bf16 v[180:183], a[236:239], v[92:95], v[180:183]
    s_waitcnt lgkmcnt(9)
    ds_read_b64_tr_b16 a[198:199], v4 offset:17664
    v_fma_mix_f32 v35, v99, v27, v31 op_sel:[1,0,0] op_sel_hi:[1,0,0]
    v_mfma_f32_16x16x32_bf16 v[152:155], a[240:243], v[80:83], v[152:155]
    ds_read_b64_tr_b16 a[200:201], v4 offset:288
    v_cvt_pk_bf16_f32 v98, v32, v33
    v_mfma_f32_16x16x32_bf16 v[152:155], a[244:247], v[84:87], v[152:155]
    ds_read_b64_tr_b16 a[202:203], v4 offset:800
    v_cvt_pk_bf16_f32 v99, v34, v35
    v_mfma_f32_16x16x32_bf16 v[184:187], a[240:243], v[88:91], v[184:187]
    ds_read_b64_tr_b16 a[204:205], v4 offset:17184
    v_fma_mix_f32 v36, v106, v24, v28 op_sel:[0,0,0] op_sel_hi:[1,0,0]
    v_mfma_f32_16x16x32_bf16 v[184:187], a[244:247], v[92:95], v[184:187]
    s_waitcnt lgkmcnt(8)
    ds_read_b64_tr_b16 a[206:207], v4 offset:17696
    v_fma_mix_f32 v37, v106, v25, v29 op_sel:[1,0,0] op_sel_hi:[1,0,0]
    v_mfma_f32_16x16x32_bf16 v[156:159], a[248:251], v[80:83], v[156:159]
    ds_read_b64_tr_b16 a[208:209], v4 offset:320
    v_fma_mix_f32 v38, v107, v26, v30 op_sel:[0,0,0] op_sel_hi:[1,0,0]
    v_mfma_f32_16x16x32_bf16 v[156:159], a[252:255], v[84:87], v[156:159]
    ds_read_b64_tr_b16 a[210:211], v4 offset:832
    v_fma_mix_f32 v39, v107, v27, v31 op_sel:[1,0,0] op_sel_hi:[1,0,0]
    v_mfma_f32_16x16x32_bf16 v[188:191], a[248:251], v[88:91], v[188:191]
    ds_read_b64_tr_b16 a[212:213], v4 offset:17216
    v_cvt_pk_bf16_f32 v106, v36, v37
    v_mfma_f32_16x16x32_bf16 v[188:191], a[252:255], v[92:95], v[188:191]
    s_waitcnt lgkmcnt(7)
    ds_read_b64_tr_b16 a[214:215], v4 offset:17728
    v_cvt_pk_bf16_f32 v107, v38, v39
    v_mfma_f32_16x16x32_bf16 v[192:195], a[192:195], v[80:83], v[192:195]
    ds_read_b64_tr_b16 a[216:217], v4 offset:352
    ds_read_b128 v[24:27], v9 offset:12560
    v_mfma_f32_16x16x32_bf16 v[192:195], a[196:199], v[84:87], v[192:195]
    ds_read_b64_tr_b16 a[218:219], v4 offset:864
    ds_read_b64_tr_b16 a[220:221], v4 offset:17248
    v_fma_mix_f32 v32, v100, v16, v20 op_sel:[0,0,0] op_sel_hi:[1,0,0]
    v_mfma_f32_16x16x32_bf16 v[224:227], a[192:195], v[88:91], v[224:227]
    s_mov_b32 s54, 16384
    ds_read_b64_tr_b16 a[222:223], v4 offset:17760
    ds_read_b128 v[28:31], v9 offset:12592
    v_mfma_f32_16x16x32_bf16 v[224:227], a[196:199], v[92:95], v[224:227]
    s_waitcnt lgkmcnt(10)
    buffer_load_dwordx4 v[48:51], v8, s[32:35], s54 offen sc1
    v_mfma_f32_16x16x32_bf16 v[196:199], a[200:203], v[80:83], v[196:199]
    ds_read_b64_tr_b16 a[224:225], v4 offset:384
    v_fma_mix_f32 v33, v100, v17, v21 op_sel:[1,0,0] op_sel_hi:[1,0,0]
    v_mfma_f32_16x16x32_bf16 v[196:199], a[204:207], v[84:87], v[196:199]
    ds_read_b64_tr_b16 a[226:227], v4 offset:896
    ds_read_b64_tr_b16 a[228:229], v4 offset:17280
    v_fma_mix_f32 v34, v101, v18, v22 op_sel:[0,0,0] op_sel_hi:[1,0,0]
    v_mfma_f32_16x16x32_bf16 v[228:231], a[200:203], v[88:91], v[228:231]
    s_mov_b32 s54, 17408
    ds_read_b64_tr_b16 a[230:231], v4 offset:17792
    v_fma_mix_f32 v35, v101, v19, v23 op_sel:[1,0,0] op_sel_hi:[1,0,0]
    v_mfma_f32_16x16x32_bf16 v[228:231], a[204:207], v[92:95], v[228:231]
    s_waitcnt lgkmcnt(10)
    buffer_load_dwordx4 v[52:55], v8, s[32:35], s54 offen sc1
    v_mfma_f32_16x16x32_bf16 v[200:203], a[208:211], v[80:83], v[200:203]
    ds_read_b64_tr_b16 a[232:233], v4 offset:416
    v_cvt_pk_bf16_f32 v100, v32, v33
    v_mfma_f32_16x16x32_bf16 v[200:203], a[212:215], v[84:87], v[200:203]
    ds_read_b64_tr_b16 a[234:235], v4 offset:928
    ds_read_b64_tr_b16 a[236:237], v4 offset:17312
    v_cvt_pk_bf16_f32 v101, v34, v35
    v_mfma_f32_16x16x32_bf16 v[232:235], a[208:211], v[88:91], v[232:235]
    s_mov_b32 s54, 34816
    ds_read_b64_tr_b16 a[238:239], v4 offset:17824
    v_fma_mix_f32 v36, v108, v16, v20 op_sel:[0,0,0] op_sel_hi:[1,0,0]
    v_mfma_f32_16x16x32_bf16 v[232:235], a[212:215], v[92:95], v[232:235]
    s_waitcnt lgkmcnt(9)
    buffer_load_dwordx4 v[56:59], v8, s[32:35], s54 offen sc1
    v_fma_mix_f32 v37, v108, v17, v21 op_sel:[1,0,0] op_sel_hi:[1,0,0]
    v_mfma_f32_16x16x32_bf16 v[204:207], a[216:219], v[80:83], v[204:207]
    ds_read_b64_tr_b16 a[240:241], v4 offset:448
    v_fma_mix_f32 v38, v109, v18, v22 op_sel:[0,0,0] op_sel_hi:[1,0,0]
    v_mfma_f32_16x16x32_bf16 v[204:207], a[220:223], v[84:87], v[204:207]
    ds_read_b64_tr_b16 a[242:243], v4 offset:960
    ds_read_b64_tr_b16 a[244:245], v4 offset:17344
    v_fma_mix_f32 v39, v109, v19, v23 op_sel:[1,0,0] op_sel_hi:[1,0,0]
    v_mfma_f32_16x16x32_bf16 v[236:239], a[216:219], v[88:91], v[236:239]
    s_mov_b32 s54, 35840
    ds_read_b64_tr_b16 a[246:247], v4 offset:17856
    v_cvt_pk_bf16_f32 v108, v36, v37
    v_mfma_f32_16x16x32_bf16 v[236:239], a[220:223], v[92:95], v[236:239]
    s_waitcnt lgkmcnt(8)
    buffer_load_dwordx4 v[60:63], v8, s[32:35], s54 offen sc1
    v_cvt_pk_bf16_f32 v109, v38, v39
    v_mfma_f32_16x16x32_bf16 v[208:211], a[224:227], v[80:83], v[208:211]
    ds_read_b64_tr_b16 a[248:249], v4 offset:480
    ds_read_b128 v[16:19], v9 offset:12800
    v_mfma_f32_16x16x32_bf16 v[208:211], a[228:231], v[84:87], v[208:211]
    ds_read_b64_tr_b16 a[250:251], v4 offset:992
    ds_read_b128 v[20:23], v9 offset:12832
    v_mfma_f32_16x16x32_bf16 v[240:243], a[224:227], v[88:91], v[240:243]
    ds_read_b64_tr_b16 a[252:253], v4 offset:17376
    v_fma_mix_f32 v32, v102, v24, v28 op_sel:[0,0,0] op_sel_hi:[1,0,0]
    v_mfma_f32_16x16x32_bf16 v[240:243], a[228:231], v[92:95], v[240:243]
    s_waitcnt vmcnt(16)
    s_barrier
    s_waitcnt lgkmcnt(9)
    ds_read_b64_tr_b16 a[254:255], v4 offset:17888
    v_fma_mix_f32 v33, v102, v25, v29 op_sel:[1,0,0] op_sel_hi:[1,0,0]
    v_fma_mix_f32 v34, v103, v26, v30 op_sel:[0,0,0] op_sel_hi:[1,0,0]
    v_mfma_f32_16x16x32_bf16 v[212:215], a[232:235], v[80:83], v[212:215]
    ds_read_b64_tr_b16 a[192:193], v4 offset:36864
    v_fma_mix_f32 v35, v103, v27, v31 op_sel:[1,0,0] op_sel_hi:[1,0,0]
    v_mfma_f32_16x16x32_bf16 v[212:215], a[236:239], v[84:87], v[212:215]
    ds_read_b64_tr_b16 a[194:195], v4 offset:37376
    ds_read_b64_tr_b16 a[196:197], v4 offset:53760
    v_cvt_pk_bf16_f32 v102, v32, v33
    v_mfma_f32_16x16x32_bf16 v[244:247], a[232:235], v[88:91], v[244:247]
    s_add_u32 m0, s44, 36864
    ds_read_b64_tr_b16 a[198:199], v4 offset:54272
    v_cvt_pk_bf16_f32 v103, v34, v35
    v_mfma_f32_16x16x32_bf16 v[244:247], a[236:239], v[92:95], v[244:247]
    s_mov_b32 s45, 4194304
    s_waitcnt lgkmcnt(10)
    buffer_load_dwordx4 v6, s[24:27], s45 offen lds
    v_mfma_f32_16x16x32_bf16 v[216:219], a[240:243], v[80:83], v[216:219]
    ds_read_b64_tr_b16 a[200:201], v4 offset:36896
    v_fma_mix_f32 v36, v110, v24, v28 op_sel:[0,0,0] op_sel_hi:[1,0,0]
    v_mfma_f32_16x16x32_bf16 v[216:219], a[244:247], v[84:87], v[216:219]
    ds_read_b64_tr_b16 a[202:203], v4 offset:37408
    ds_read_b64_tr_b16 a[204:205], v4 offset:53792
    v_fma_mix_f32 v37, v110, v25, v29 op_sel:[1,0,0] op_sel_hi:[1,0,0]
    v_mfma_f32_16x16x32_bf16 v[248:251], a[240:243], v[88:91], v[248:251]
    s_add_u32 m0, s44, 37920
    ds_read_b64_tr_b16 a[206:207], v4 offset:54304
    v_fma_mix_f32 v38, v111, v26, v30 op_sel:[0,0,0] op_sel_hi:[1,0,0]
    v_mfma_f32_16x16x32_bf16 v[248:251], a[244:247], v[92:95], v[248:251]
    s_mov_b32 s45, 4202496
    s_waitcnt lgkmcnt(8)
    buffer_load_dwordx4 v6, s[24:27], s45 offen lds
    v_mfma_f32_16x16x32_bf16 v[220:223], a[248:251], v[80:83], v[220:223]
    ds_read_b64_tr_b16 a[208:209], v4 offset:36928
    v_fma_mix_f32 v39, v111, v27, v31 op_sel:[1,0,0] op_sel_hi:[1,0,0]
    v_mfma_f32_16x16x32_bf16 v[220:223], a[252:255], v[84:87], v[220:223]
    ds_read_b64_tr_b16 a[210:211], v4 offset:37440
    ds_read_b64_tr_b16 a[212:213], v4 offset:53824
    v_cvt_pk_bf16_f32 v110, v36, v37
    v_mfma_f32_16x16x32_bf16 v[252:255], a[248:251], v[88:91], v[252:255]
    s_add_u32 m0, s44, 38976
    ds_read_b64_tr_b16 a[214:215], v4 offset:54336
    v_cvt_pk_bf16_f32 v111, v38, v39
    v_mfma_f32_16x16x32_bf16 v[252:255], a[252:255], v[92:95], v[252:255]
    s_mov_b32 s45, 4210688
    s_waitcnt lgkmcnt(8)
    buffer_load_dwordx4 v6, s[24:27], s45 offen lds
    v_mfma_f32_16x16x32_bf16 v[128:131], a[192:195], v[96:99], v[128:131]
    s_waitcnt vmcnt(15)
    ds_read_b64_tr_b16 a[216:217], v4 offset:36960
    ds_read_b128 v[24:27], v9 offset:12816
    v_mfma_f32_16x16x32_bf16 v[128:131], a[196:199], v[100:103], v[128:131]
    ds_read_b64_tr_b16 a[218:219], v4 offset:37472
    ds_read_b64_tr_b16 a[220:221], v4 offset:53856
    v_fma_mix_f32 v32, v112, v16, v20 op_sel:[0,0,0] op_sel_hi:[1,0,0]
    v_mfma_f32_16x16x32_bf16 v[160:163], a[192:195], v[104:107], v[160:163]
    s_add_u32 m0, s44, 40032
    ds_read_b64_tr_b16 a[222:223], v4 offset:54368
    ds_read_b128 v[28:31], v9 offset:12848
    v_mfma_f32_16x16x32_bf16 v[160:163], a[196:199], v[108:111], v[160:163]
    s_mov_b32 s45, 4218880
    s_waitcnt lgkmcnt(10)
    buffer_load_dwordx4 v6, s[24:27], s45 offen lds
    v_mfma_f32_16x16x32_bf16 v[132:135], a[200:203], v[96:99], v[132:135]
    ds_read_b64_tr_b16 a[224:225], v4 offset:36992
    v_fma_mix_f32 v33, v112, v17, v21 op_sel:[1,0,0] op_sel_hi:[1,0,0]
    v_mfma_f32_16x16x32_bf16 v[132:135], a[204:207], v[100:103], v[132:135]
    ds_read_b64_tr_b16 a[226:227], v4 offset:37504
    ds_read_b64_tr_b16 a[228:229], v4 offset:53888
    v_fma_mix_f32 v34, v113, v18, v22 op_sel:[0,0,0] op_sel_hi:[1,0,0]
    v_mfma_f32_16x16x32_bf16 v[164:167], a[200:203], v[104:107], v[164:167]
    s_add_u32 m0, s44, 53760
    ds_read_b64_tr_b16 a[230:231], v4 offset:54400
    v_fma_mix_f32 v35, v113, v19, v23 op_sel:[1,0,0] op_sel_hi:[1,0,0]
    v_mfma_f32_16x16x32_bf16 v[164:167], a[204:207], v[108:111], v[164:167]
    s_mov_b32 s45, 4456448
    s_waitcnt lgkmcnt(10)
    buffer_load_dwordx4 v6, s[24:27], s45 offen lds
    v_mfma_f32_16x16x32_bf16 v[136:139], a[208:211], v[96:99], v[136:139]
    ds_read_b64_tr_b16 a[232:233], v4 offset:37024
    v_cvt_pk_bf16_f32 v112, v32, v33
    v_mfma_f32_16x16x32_bf16 v[136:139], a[212:215], v[100:103], v[136:139]
    ds_read_b64_tr_b16 a[234:235], v4 offset:37536
    ds_read_b64_tr_b16 a[236:237], v4 offset:53920
    v_cvt_pk_bf16_f32 v113, v34, v35
    v_mfma_f32_16x16x32_bf16 v[168:171], a[208:211], v[104:107], v[168:171]
    s_add_u32 m0, s44, 54816
    ds_read_b64_tr_b16 a[238:239], v4 offset:54432
    v_fma_mix_f32 v36, v120, v16, v20 op_sel:[0,0,0] op_sel_hi:[1,0,0]
    v_mfma_f32_16x16x32_bf16 v[168:171], a[212:215], v[108:111], v[168:171]
    s_mov_b32 s45, 4464640
    s_waitcnt lgkmcnt(9)
    buffer_load_dwordx4 v6, s[24:27], s45 offen lds
    v_fma_mix_f32 v37, v120, v17, v21 op_sel:[1,0,0] op_sel_hi:[1,0,0]
    v_mfma_f32_16x16x32_bf16 v[140:143], a[216:219], v[96:99], v[140:143]
    ds_read_b64_tr_b16 a[240:241], v4 offset:37056
    v_fma_mix_f32 v38, v121, v18, v22 op_sel:[0,0,0] op_sel_hi:[1,0,0]
    v_mfma_f32_16x16x32_bf16 v[140:143], a[220:223], v[100:103], v[140:143]
    ds_read_b64_tr_b16 a[242:243], v4 offset:37568
    ds_read_b64_tr_b16 a[244:245], v4 offset:53952
    v_fma_mix_f32 v39, v121, v19, v23 op_sel:[1,0,0] op_sel_hi:[1,0,0]
    v_mfma_f32_16x16x32_bf16 v[172:175], a[216:219], v[104:107], v[172:175]
    s_add_u32 m0, s44, 55872
    ds_read_b64_tr_b16 a[246:247], v4 offset:54464
    v_cvt_pk_bf16_f32 v120, v36, v37
    v_mfma_f32_16x16x32_bf16 v[172:175], a[220:223], v[108:111], v[172:175]
    s_mov_b32 s45, 4472832
    s_waitcnt lgkmcnt(8)
    buffer_load_dwordx4 v6, s[24:27], s45 offen lds
    v_cvt_pk_bf16_f32 v121, v38, v39
    v_mfma_f32_16x16x32_bf16 v[144:147], a[224:227], v[96:99], v[144:147]
    ds_read_b64_tr_b16 a[248:249], v4 offset:37088
    ds_read_b128 v[16:19], v9 offset:13056
    v_mfma_f32_16x16x32_bf16 v[144:147], a[228:231], v[100:103], v[144:147]
    ds_read_b64_tr_b16 a[250:251], v4 offset:37600
    ds_read_b64_tr_b16 a[252:253], v4 offset:53984
    v_mfma_f32_16x16x32_bf16 v[176:179], a[224:227], v[104:107], v[176:179]
    s_add_u32 m0, s44, 56928
    ds_read_b64_tr_b16 a[254:255], v4 offset:54496
    ds_read_b128 v[20:23], v9 offset:13088
    v_mfma_f32_16x16x32_bf16 v[176:179], a[228:231], v[108:111], v[176:179]
    s_mov_b32 s45, 4481024
    s_waitcnt lgkmcnt(10)
    buffer_load_dwordx4 v6, s[24:27], s45 offen lds
    v_mfma_f32_16x16x32_bf16 v[148:151], a[232:235], v[96:99], v[148:151]
    ds_read_b64_tr_b16 a[192:193], v4 offset:37120
    v_fma_mix_f32 v32, v114, v24, v28 op_sel:[0,0,0] op_sel_hi:[1,0,0]
    v_mfma_f32_16x16x32_bf16 v[148:151], a[236:239], v[100:103], v[148:151]
    ds_read_b64_tr_b16 a[194:195], v4 offset:37632
    v_fma_mix_f32 v33, v114, v25, v29 op_sel:[1,0,0] op_sel_hi:[1,0,0]
    v_mfma_f32_16x16x32_bf16 v[180:183], a[232:235], v[104:107], v[180:183]
    ds_read_b64_tr_b16 a[196:197], v4 offset:54016
    v_fma_mix_f32 v34, v115, v26, v30 op_sel:[0,0,0] op_sel_hi:[1,0,0]
    v_mfma_f32_16x16x32_bf16 v[180:183], a[236:239], v[108:111], v[180:183]
    s_waitcnt lgkmcnt(9)
    ds_read_b64_tr_b16 a[198:199], v4 offset:54528
    v_fma_mix_f32 v35, v115, v27, v31 op_sel:[1,0,0] op_sel_hi:[1,0,0]
    v_mfma_f32_16x16x32_bf16 v[152:155], a[240:243], v[96:99], v[152:155]
    ds_read_b64_tr_b16 a[200:201], v4 offset:37152
    v_cvt_pk_bf16_f32 v114, v32, v33
    v_mfma_f32_16x16x32_bf16 v[152:155], a[244:247], v[100:103], v[152:155]
    ds_read_b64_tr_b16 a[202:203], v4 offset:37664
    v_cvt_pk_bf16_f32 v115, v34, v35
    v_mfma_f32_16x16x32_bf16 v[184:187], a[240:243], v[104:107], v[184:187]
    ds_read_b64_tr_b16 a[204:205], v4 offset:54048
    v_fma_mix_f32 v36, v122, v24, v28 op_sel:[0,0,0] op_sel_hi:[1,0,0]
    v_mfma_f32_16x16x32_bf16 v[184:187], a[244:247], v[108:111], v[184:187]
    s_waitcnt lgkmcnt(8)
    ds_read_b64_tr_b16 a[206:207], v4 offset:54560
    v_fma_mix_f32 v37, v122, v25, v29 op_sel:[1,0,0] op_sel_hi:[1,0,0]
    v_mfma_f32_16x16x32_bf16 v[156:159], a[248:251], v[96:99], v[156:159]
    ds_read_b64_tr_b16 a[208:209], v4 offset:37184
    v_fma_mix_f32 v38, v123, v26, v30 op_sel:[0,0,0] op_sel_hi:[1,0,0]
    v_mfma_f32_16x16x32_bf16 v[156:159], a[252:255], v[100:103], v[156:159]
    ds_read_b64_tr_b16 a[210:211], v4 offset:37696
    v_fma_mix_f32 v39, v123, v27, v31 op_sel:[1,0,0] op_sel_hi:[1,0,0]
    v_mfma_f32_16x16x32_bf16 v[188:191], a[248:251], v[104:107], v[188:191]
    ds_read_b64_tr_b16 a[212:213], v4 offset:54080
    v_cvt_pk_bf16_f32 v122, v36, v37
    v_mfma_f32_16x16x32_bf16 v[188:191], a[252:255], v[108:111], v[188:191]
    s_waitcnt lgkmcnt(7)
    ds_read_b64_tr_b16 a[214:215], v4 offset:54592
    v_cvt_pk_bf16_f32 v123, v38, v39
    v_mfma_f32_16x16x32_bf16 v[192:195], a[192:195], v[96:99], v[192:195]
    ds_read_b64_tr_b16 a[216:217], v4 offset:37216
    ds_read_b128 v[24:27], v9 offset:13072
    v_mfma_f32_16x16x32_bf16 v[192:195], a[196:199], v[100:103], v[192:195]
    ds_read_b64_tr_b16 a[218:219], v4 offset:37728
    ds_read_b128 v[28:31], v9 offset:13104
    v_mfma_f32_16x16x32_bf16 v[224:227], a[192:195], v[104:107], v[224:227]
    ds_read_b64_tr_b16 a[220:221], v4 offset:54112
    v_fma_mix_f32 v32, v116, v16, v20 op_sel:[0,0,0] op_sel_hi:[1,0,0]
    v_mfma_f32_16x16x32_bf16 v[224:227], a[196:199], v[108:111], v[224:227]
    s_waitcnt lgkmcnt(9)
    ds_read_b64_tr_b16 a[222:223], v4 offset:54624
    v_fma_mix_f32 v33, v116, v17, v21 op_sel:[1,0,0] op_sel_hi:[1,0,0]
    v_mfma_f32_16x16x32_bf16 v[196:199], a[200:203], v[96:99], v[196:199]
    ds_read_b64_tr_b16 a[224:225], v4 offset:37248
    v_fma_mix_f32 v34, v117, v18, v22 op_sel:[0,0,0] op_sel_hi:[1,0,0]
    v_mfma_f32_16x16x32_bf16 v[196:199], a[204:207], v[100:103], v[196:199]
    ds_read_b64_tr_b16 a[226:227], v4 offset:37760
    v_fma_mix_f32 v35, v117, v19, v23 op_sel:[1,0,0] op_sel_hi:[1,0,0]
    v_mfma_f32_16x16x32_bf16 v[228:231], a[200:203], v[104:107], v[228:231]
    ds_read_b64_tr_b16 a[228:229], v4 offset:54144
    v_cvt_pk_bf16_f32 v116, v32, v33
    v_mfma_f32_16x16x32_bf16 v[228:231], a[204:207], v[108:111], v[228:231]
    s_waitcnt lgkmcnt(9)
    ds_read_b64_tr_b16 a[230:231], v4 offset:54656
    v_cvt_pk_bf16_f32 v117, v34, v35
    v_mfma_f32_16x16x32_bf16 v[200:203], a[208:211], v[96:99], v[200:203]
    ds_read_b64_tr_b16 a[232:233], v4 offset:37280
    v_fma_mix_f32 v36, v124, v16, v20 op_sel:[0,0,0] op_sel_hi:[1,0,0]
    v_mfma_f32_16x16x32_bf16 v[200:203], a[212:215], v[100:103], v[200:203]
    ds_read_b64_tr_b16 a[234:235], v4 offset:37792
    v_fma_mix_f32 v37, v124, v17, v21 op_sel:[1,0,0] op_sel_hi:[1,0,0]
    v_mfma_f32_16x16x32_bf16 v[232:235], a[208:211], v[104:107], v[232:235]
    ds_read_b64_tr_b16 a[236:237], v4 offset:54176
    v_fma_mix_f32 v38, v125, v18, v22 op_sel:[0,0,0] op_sel_hi:[1,0,0]
    v_mfma_f32_16x16x32_bf16 v[232:235], a[212:215], v[108:111], v[232:235]
    s_waitcnt lgkmcnt(7)
    ds_read_b64_tr_b16 a[238:239], v4 offset:54688
    v_fma_mix_f32 v39, v125, v19, v23 op_sel:[1,0,0] op_sel_hi:[1,0,0]
    v_mfma_f32_16x16x32_bf16 v[204:207], a[216:219], v[96:99], v[204:207]
    ds_read_b64_tr_b16 a[240:241], v4 offset:37312
    v_cvt_pk_bf16_f32 v124, v36, v37
    v_mfma_f32_16x16x32_bf16 v[204:207], a[220:223], v[100:103], v[204:207]
    ds_read_b64_tr_b16 a[242:243], v4 offset:37824
    v_cvt_pk_bf16_f32 v125, v38, v39
    v_mfma_f32_16x16x32_bf16 v[236:239], a[216:219], v[104:107], v[236:239]
    ds_read_b64_tr_b16 a[244:245], v4 offset:54208
    v_mfma_f32_16x16x32_bf16 v[236:239], a[220:223], v[108:111], v[236:239]
    s_waitcnt lgkmcnt(7)
    ds_read_b64_tr_b16 a[246:247], v4 offset:54720
    v_mfma_f32_16x16x32_bf16 v[208:211], a[224:227], v[96:99], v[208:211]
    ds_read_b64_tr_b16 a[248:249], v4 offset:37344
    ds_read_b128 v[16:19], v9 offset:13312
    v_mfma_f32_16x16x32_bf16 v[208:211], a[228:231], v[100:103], v[208:211]
    ds_read_b64_tr_b16 a[250:251], v4 offset:37856
    ds_read_b128 v[20:23], v9 offset:13344
    v_mfma_f32_16x16x32_bf16 v[240:243], a[224:227], v[104:107], v[240:243]
    ds_read_b64_tr_b16 a[252:253], v4 offset:54240
    v_fma_mix_f32 v32, v118, v24, v28 op_sel:[0,0,0] op_sel_hi:[1,0,0]
    v_mfma_f32_16x16x32_bf16 v[240:243], a[228:231], v[108:111], v[240:243]
    s_waitcnt vmcnt(12)
    s_barrier
    s_waitcnt lgkmcnt(9)
    ds_read_b64_tr_b16 a[254:255], v4 offset:54752
    v_fma_mix_f32 v33, v118, v25, v29 op_sel:[1,0,0] op_sel_hi:[1,0,0]
    v_fma_mix_f32 v34, v119, v26, v30 op_sel:[0,0,0] op_sel_hi:[1,0,0]
    v_mfma_f32_16x16x32_bf16 v[212:215], a[232:235], v[96:99], v[212:215]
    ds_read_b64_tr_b16 a[192:193], v3 offset:0
    v_fma_mix_f32 v35, v119, v27, v31 op_sel:[1,0,0] op_sel_hi:[1,0,0]
    v_mfma_f32_16x16x32_bf16 v[212:215], a[236:239], v[100:103], v[212:215]
    ds_read_b64_tr_b16 a[194:195], v3 offset:512
    ds_read_b64_tr_b16 a[196:197], v3 offset:16896
    v_cvt_pk_bf16_f32 v118, v32, v33
    v_mfma_f32_16x16x32_bf16 v[244:247], a[232:235], v[104:107], v[244:247]
    s_add_u32 m0, s44, 73728
    ds_read_b64_tr_b16 a[198:199], v3 offset:17408
    v_cvt_pk_bf16_f32 v119, v34, v35
    v_mfma_f32_16x16x32_bf16 v[244:247], a[236:239], v[108:111], v[244:247]
    s_mov_b32 s46, 0
    s_waitcnt lgkmcnt(10)
    buffer_load_dwordx4 v5, s[16:19], s46 offen offset:0 lds
    v_mfma_f32_16x16x32_bf16 v[216:219], a[240:243], v[96:99], v[216:219]
    ds_read_b64_tr_b16 a[200:201], v3 offset:32
    v_fma_mix_f32 v36, v126, v24, v28 op_sel:[0,0,0] op_sel_hi:[1,0,0]
    v_mfma_f32_16x16x32_bf16 v[216:219], a[244:247], v[100:103], v[216:219]
    ds_read_b64_tr_b16 a[202:203], v3 offset:544
    ds_read_b64_tr_b16 a[204:205], v3 offset:16928
    v_fma_mix_f32 v37, v126, v25, v29 op_sel:[1,0,0] op_sel_hi:[1,0,0]
    v_mfma_f32_16x16x32_bf16 v[248:251], a[240:243], v[104:107], v[248:251]
    s_add_u32 m0, s44, 73760
    ds_read_b64_tr_b16 a[206:207], v3 offset:17440
    v_fma_mix_f32 v38, v127, v26, v30 op_sel:[0,0,0] op_sel_hi:[1,0,0]
    v_mfma_f32_16x16x32_bf16 v[248:251], a[244:247], v[108:111], v[248:251]
    s_waitcnt lgkmcnt(8)
    buffer_load_dwordx4 v5, s[16:19], s46 offen offset:1024 lds
    v_mfma_f32_16x16x32_bf16 v[220:223], a[248:251], v[96:99], v[220:223]
    ds_read_b64_tr_b16 a[208:209], v3 offset:64
    v_fma_mix_f32 v39, v127, v27, v31 op_sel:[1,0,0] op_sel_hi:[1,0,0]
    v_mfma_f32_16x16x32_bf16 v[220:223], a[252:255], v[100:103], v[220:223]
    ds_read_b64_tr_b16 a[210:211], v3 offset:576
    ds_read_b64_tr_b16 a[212:213], v3 offset:16960
    v_cvt_pk_bf16_f32 v126, v36, v37
    v_mfma_f32_16x16x32_bf16 v[252:255], a[248:251], v[104:107], v[252:255]
    s_add_u32 m0, s44, 73792
    ds_read_b64_tr_b16 a[214:215], v3 offset:17472
    v_cvt_pk_bf16_f32 v127, v38, v39
    v_mfma_f32_16x16x32_bf16 v[252:255], a[252:255], v[108:111], v[252:255]
    s_waitcnt lgkmcnt(8)
    buffer_load_dwordx4 v5, s[16:19], s46 offen offset:2048 lds
    v_mfma_f32_16x16x32_bf16 v[128:131], a[192:195], v[112:115], v[128:131]
    s_waitcnt vmcnt(11)
    ds_read_b64_tr_b16 a[216:217], v3 offset:96
    ds_read_b128 v[24:27], v9 offset:13328
    v_mfma_f32_16x16x32_bf16 v[128:131], a[196:199], v[116:119], v[128:131]
    ds_read_b64_tr_b16 a[218:219], v3 offset:608
    ds_read_b64_tr_b16 a[220:221], v3 offset:16992
    v_fma_mix_f32 v32, v48, v16, v20 op_sel:[0,0,0] op_sel_hi:[1,0,0]
    v_mfma_f32_16x16x32_bf16 v[160:163], a[192:195], v[120:123], v[160:163]
    s_add_u32 m0, s44, 73824
    ds_read_b64_tr_b16 a[222:223], v3 offset:17504
    ds_read_b128 v[28:31], v9 offset:13360
    v_mfma_f32_16x16x32_bf16 v[160:163], a[196:199], v[124:127], v[160:163]
    s_waitcnt lgkmcnt(10)
    buffer_load_dwordx4 v5, s[16:19], s46 offen offset:3072 lds
    v_mfma_f32_16x16x32_bf16 v[132:135], a[200:203], v[112:115], v[132:135]
    ds_read_b64_tr_b16 a[224:225], v3 offset:128
    v_fma_mix_f32 v33, v48, v17, v21 op_sel:[1,0,0] op_sel_hi:[1,0,0]
    v_mfma_f32_16x16x32_bf16 v[132:135], a[204:207], v[116:119], v[132:135]
    ds_read_b64_tr_b16 a[226:227], v3 offset:640
    ds_read_b64_tr_b16 a[228:229], v3 offset:17024
    v_fma_mix_f32 v34, v49, v18, v22 op_sel:[0,0,0] op_sel_hi:[1,0,0]
    v_mfma_f32_16x16x32_bf16 v[164:167], a[200:203], v[120:123], v[164:167]
    s_add_u32 m0, s44, 90624
    ds_read_b64_tr_b16 a[230:231], v3 offset:17536
    v_fma_mix_f32 v35, v49, v19, v23 op_sel:[1,0,0] op_sel_hi:[1,0,0]
    v_mfma_f32_16x16x32_bf16 v[164:167], a[204:207], v[124:127], v[164:167]
    s_waitcnt lgkmcnt(10)
    buffer_load_dwordx4 v5, s[20:23], s46 offen offset:0 lds
    v_mfma_f32_16x16x32_bf16 v[136:139], a[208:211], v[112:115], v[136:139]
    ds_read_b64_tr_b16 a[232:233], v3 offset:160
    v_cvt_pk_bf16_f32 v48, v32, v33
    v_mfma_f32_16x16x32_bf16 v[136:139], a[212:215], v[116:119], v[136:139]
    ds_read_b64_tr_b16 a[234:235], v3 offset:672
    ds_read_b64_tr_b16 a[236:237], v3 offset:17056
    v_cvt_pk_bf16_f32 v49, v34, v35
    v_mfma_f32_16x16x32_bf16 v[168:171], a[208:211], v[120:123], v[168:171]
    s_add_u32 m0, s44, 90656
    ds_read_b64_tr_b16 a[238:239], v3 offset:17568
    v_fma_mix_f32 v36, v56, v16, v20 op_sel:[0,0,0] op_sel_hi:[1,0,0]
    v_mfma_f32_16x16x32_bf16 v[168:171], a[212:215], v[124:127], v[168:171]
    s_waitcnt lgkmcnt(9)
    buffer_load_dwordx4 v5, s[20:23], s46 offen offset:1024 lds
    v_fma_mix_f32 v37, v56, v17, v21 op_sel:[1,0,0] op_sel_hi:[1,0,0]
    v_mfma_f32_16x16x32_bf16 v[140:143], a[216:219], v[112:115], v[140:143]
    ds_read_b64_tr_b16 a[240:241], v3 offset:192
    v_fma_mix_f32 v38, v57, v18, v22 op_sel:[0,0,0] op_sel_hi:[1,0,0]
    v_mfma_f32_16x16x32_bf16 v[140:143], a[220:223], v[116:119], v[140:143]
    ds_read_b64_tr_b16 a[242:243], v3 offset:704
    ds_read_b64_tr_b16 a[244:245], v3 offset:17088
    v_fma_mix_f32 v39, v57, v19, v23 op_sel:[1,0,0] op_sel_hi:[1,0,0]
    v_mfma_f32_16x16x32_bf16 v[172:175], a[216:219], v[120:123], v[172:175]
    s_add_u32 m0, s44, 90688
    ds_read_b64_tr_b16 a[246:247], v3 offset:17600
    v_cvt_pk_bf16_f32 v56, v36, v37
    v_mfma_f32_16x16x32_bf16 v[172:175], a[220:223], v[124:127], v[172:175]
    s_waitcnt lgkmcnt(8)
    buffer_load_dwordx4 v5, s[20:23], s46 offen offset:2048 lds
    v_cvt_pk_bf16_f32 v57, v38, v39
    v_mfma_f32_16x16x32_bf16 v[144:147], a[224:227], v[112:115], v[144:147]
    ds_read_b64_tr_b16 a[248:249], v3 offset:224
    ds_read_b128 v[16:19], v9 offset:13568
    v_mfma_f32_16x16x32_bf16 v[144:147], a[228:231], v[116:119], v[144:147]
    ds_read_b64_tr_b16 a[250:251], v3 offset:736
    ds_read_b64_tr_b16 a[252:253], v3 offset:17120
    v_mfma_f32_16x16x32_bf16 v[176:179], a[224:227], v[120:123], v[176:179]
    s_add_u32 m0, s44, 90720
    ds_read_b64_tr_b16 a[254:255], v3 offset:17632
    ds_read_b128 v[20:23], v9 offset:13600
    v_mfma_f32_16x16x32_bf16 v[176:179], a[228:231], v[124:127], v[176:179]
    s_waitcnt lgkmcnt(10)
    buffer_load_dwordx4 v5, s[20:23], s46 offen offset:3072 lds
    v_mfma_f32_16x16x32_bf16 v[148:151], a[232:235], v[112:115], v[148:151]
    ds_read_b64_tr_b16 a[192:193], v3 offset:256
    v_fma_mix_f32 v32, v50, v24, v28 op_sel:[0,0,0] op_sel_hi:[1,0,0]
    v_mfma_f32_16x16x32_bf16 v[148:151], a[236:239], v[116:119], v[148:151]
    ds_read_b64_tr_b16 a[194:195], v3 offset:768
    v_fma_mix_f32 v33, v50, v25, v29 op_sel:[1,0,0] op_sel_hi:[1,0,0]
    v_mfma_f32_16x16x32_bf16 v[180:183], a[232:235], v[120:123], v[180:183]
    ds_read_b64_tr_b16 a[196:197], v3 offset:17152
    v_fma_mix_f32 v34, v51, v26, v30 op_sel:[0,0,0] op_sel_hi:[1,0,0]
    v_mfma_f32_16x16x32_bf16 v[180:183], a[236:239], v[124:127], v[180:183]
    s_waitcnt lgkmcnt(9)
    ds_read_b64_tr_b16 a[198:199], v3 offset:17664
    v_fma_mix_f32 v35, v51, v27, v31 op_sel:[1,0,0] op_sel_hi:[1,0,0]
    v_mfma_f32_16x16x32_bf16 v[152:155], a[240:243], v[112:115], v[152:155]
    ds_read_b64_tr_b16 a[200:201], v3 offset:288
    v_cvt_pk_bf16_f32 v50, v32, v33
    v_mfma_f32_16x16x32_bf16 v[152:155], a[244:247], v[116:119], v[152:155]
    ds_read_b64_tr_b16 a[202:203], v3 offset:800
    v_cvt_pk_bf16_f32 v51, v34, v35
    v_mfma_f32_16x16x32_bf16 v[184:187], a[240:243], v[120:123], v[184:187]
    ds_read_b64_tr_b16 a[204:205], v3 offset:17184
    v_fma_mix_f32 v36, v58, v24, v28 op_sel:[0,0,0] op_sel_hi:[1,0,0]
    v_mfma_f32_16x16x32_bf16 v[184:187], a[244:247], v[124:127], v[184:187]
    s_waitcnt lgkmcnt(8)
    ds_read_b64_tr_b16 a[206:207], v3 offset:17696
    v_fma_mix_f32 v37, v58, v25, v29 op_sel:[1,0,0] op_sel_hi:[1,0,0]
    v_mfma_f32_16x16x32_bf16 v[156:159], a[248:251], v[112:115], v[156:159]
    ds_read_b64_tr_b16 a[208:209], v3 offset:320
    v_fma_mix_f32 v38, v59, v26, v30 op_sel:[0,0,0] op_sel_hi:[1,0,0]
    v_mfma_f32_16x16x32_bf16 v[156:159], a[252:255], v[116:119], v[156:159]
    ds_read_b64_tr_b16 a[210:211], v3 offset:832
    v_fma_mix_f32 v39, v59, v27, v31 op_sel:[1,0,0] op_sel_hi:[1,0,0]
    v_mfma_f32_16x16x32_bf16 v[188:191], a[248:251], v[120:123], v[188:191]
    ds_read_b64_tr_b16 a[212:213], v3 offset:17216
    v_cvt_pk_bf16_f32 v58, v36, v37
    v_mfma_f32_16x16x32_bf16 v[188:191], a[252:255], v[124:127], v[188:191]
    s_waitcnt lgkmcnt(7)
    ds_read_b64_tr_b16 a[214:215], v3 offset:17728
    v_cvt_pk_bf16_f32 v59, v38, v39
    v_mfma_f32_16x16x32_bf16 v[192:195], a[192:195], v[112:115], v[192:195]
    ds_read_b64_tr_b16 a[216:217], v3 offset:352
    ds_read_b128 v[24:27], v9 offset:13584
    v_mfma_f32_16x16x32_bf16 v[192:195], a[196:199], v[116:119], v[192:195]
    ds_read_b64_tr_b16 a[218:219], v3 offset:864
    ds_read_b128 v[28:31], v9 offset:13616
    v_mfma_f32_16x16x32_bf16 v[224:227], a[192:195], v[120:123], v[224:227]
    ds_read_b64_tr_b16 a[220:221], v3 offset:17248
    v_fma_mix_f32 v32, v52, v16, v20 op_sel:[0,0,0] op_sel_hi:[1,0,0]
    v_mfma_f32_16x16x32_bf16 v[224:227], a[196:199], v[124:127], v[224:227]
    s_waitcnt lgkmcnt(9)
    ds_read_b64_tr_b16 a[222:223], v3 offset:17760
    v_fma_mix_f32 v33, v52, v17, v21 op_sel:[1,0,0] op_sel_hi:[1,0,0]
    v_mfma_f32_16x16x32_bf16 v[196:199], a[200:203], v[112:115], v[196:199]
    ds_read_b64_tr_b16 a[224:225], v3 offset:384
    v_fma_mix_f32 v34, v53, v18, v22 op_sel:[0,0,0] op_sel_hi:[1,0,0]
    v_mfma_f32_16x16x32_bf16 v[196:199], a[204:207], v[116:119], v[196:199]
    ds_read_b64_tr_b16 a[226:227], v3 offset:896
    v_fma_mix_f32 v35, v53, v19, v23 op_sel:[1,0,0] op_sel_hi:[1,0,0]
    v_mfma_f32_16x16x32_bf16 v[228:231], a[200:203], v[120:123], v[228:231]
    ds_read_b64_tr_b16 a[228:229], v3 offset:17280
    v_cvt_pk_bf16_f32 v52, v32, v33
    v_mfma_f32_16x16x32_bf16 v[228:231], a[204:207], v[124:127], v[228:231]
    s_waitcnt lgkmcnt(9)
    ds_read_b64_tr_b16 a[230:231], v3 offset:17792
    v_cvt_pk_bf16_f32 v53, v34, v35
    v_mfma_f32_16x16x32_bf16 v[200:203], a[208:211], v[112:115], v[200:203]
    ds_read_b64_tr_b16 a[232:233], v3 offset:416
    v_fma_mix_f32 v36, v60, v16, v20 op_sel:[0,0,0] op_sel_hi:[1,0,0]
    v_mfma_f32_16x16x32_bf16 v[200:203], a[212:215], v[116:119], v[200:203]
    ds_read_b64_tr_b16 a[234:235], v3 offset:928
    v_fma_mix_f32 v37, v60, v17, v21 op_sel:[1,0,0] op_sel_hi:[1,0,0]
    v_mfma_f32_16x16x32_bf16 v[232:235], a[208:211], v[120:123], v[232:235]
    ds_read_b64_tr_b16 a[236:237], v3 offset:17312
    v_fma_mix_f32 v38, v61, v18, v22 op_sel:[0,0,0] op_sel_hi:[1,0,0]
    v_mfma_f32_16x16x32_bf16 v[232:235], a[212:215], v[124:127], v[232:235]
    s_waitcnt lgkmcnt(7)
    ds_read_b64_tr_b16 a[238:239], v3 offset:17824
    v_fma_mix_f32 v39, v61, v19, v23 op_sel:[1,0,0] op_sel_hi:[1,0,0]
    v_mfma_f32_16x16x32_bf16 v[204:207], a[216:219], v[112:115], v[204:207]
    ds_read_b64_tr_b16 a[240:241], v3 offset:448
    v_cvt_pk_bf16_f32 v60, v36, v37
    v_mfma_f32_16x16x32_bf16 v[204:207], a[220:223], v[116:119], v[204:207]
    ds_read_b64_tr_b16 a[242:243], v3 offset:960
    v_cvt_pk_bf16_f32 v61, v38, v39
    v_mfma_f32_16x16x32_bf16 v[236:239], a[216:219], v[120:123], v[236:239]
    ds_read_b64_tr_b16 a[244:245], v3 offset:17344
    v_mfma_f32_16x16x32_bf16 v[236:239], a[220:223], v[124:127], v[236:239]
    s_waitcnt lgkmcnt(7)
    ds_read_b64_tr_b16 a[246:247], v3 offset:17856
    v_mfma_f32_16x16x32_bf16 v[208:211], a[224:227], v[112:115], v[208:211]
    ds_read_b64_tr_b16 a[248:249], v3 offset:480
    v_fma_mix_f32 v32, v54, v24, v28 op_sel:[0,0,0] op_sel_hi:[1,0,0]
    v_mfma_f32_16x16x32_bf16 v[208:211], a[228:231], v[116:119], v[208:211]
    ds_read_b64_tr_b16 a[250:251], v3 offset:992
    v_fma_mix_f32 v33, v54, v25, v29 op_sel:[1,0,0] op_sel_hi:[1,0,0]
    v_mfma_f32_16x16x32_bf16 v[240:243], a[224:227], v[120:123], v[240:243]
    ds_read_b64_tr_b16 a[252:253], v3 offset:17376
    v_fma_mix_f32 v34, v55, v26, v30 op_sel:[0,0,0] op_sel_hi:[1,0,0]
    v_mfma_f32_16x16x32_bf16 v[240:243], a[228:231], v[124:127], v[240:243]
    s_waitcnt vmcnt(8)
    s_barrier
    s_waitcnt lgkmcnt(7)
    ds_read_b64_tr_b16 a[254:255], v3 offset:17888
    v_fma_mix_f32 v35, v55, v27, v31 op_sel:[1,0,0] op_sel_hi:[1,0,0]
    v_mfma_f32_16x16x32_bf16 v[212:215], a[232:235], v[112:115], v[212:215]
    ds_read_b64_tr_b16 a[192:193], v3 offset:36864
    v_cvt_pk_bf16_f32 v54, v32, v33
    v_mfma_f32_16x16x32_bf16 v[212:215], a[236:239], v[116:119], v[212:215]
    ds_read_b64_tr_b16 a[194:195], v3 offset:37376
    ds_read_b64_tr_b16 a[196:197], v3 offset:53760
    v_mfma_f32_16x16x32_bf16 v[244:247], a[232:235], v[120:123], v[244:247]
    s_add_u32 m0, s44, 110592
    ds_read_b64_tr_b16 a[198:199], v3 offset:54272
    v_cvt_pk_bf16_f32 v55, v34, v35
    v_mfma_f32_16x16x32_bf16 v[244:247], a[236:239], v[124:127], v[244:247]
    s_mov_b32 s46, 16384
    s_waitcnt lgkmcnt(8)
    buffer_load_dwordx4 v5, s[16:19], s46 offen offset:0 lds
    v_mfma_f32_16x16x32_bf16 v[216:219], a[240:243], v[112:115], v[216:219]
    ds_read_b64_tr_b16 a[200:201], v3 offset:36896
    v_fma_mix_f32 v36, v62, v24, v28 op_sel:[0,0,0] op_sel_hi:[1,0,0]
    v_mfma_f32_16x16x32_bf16 v[216:219], a[244:247], v[116:119], v[216:219]
    ds_read_b64_tr_b16 a[202:203], v3 offset:37408
    ds_read_b64_tr_b16 a[204:205], v3 offset:53792
    v_fma_mix_f32 v37, v62, v25, v29 op_sel:[1,0,0] op_sel_hi:[1,0,0]
    v_mfma_f32_16x16x32_bf16 v[248:251], a[240:243], v[120:123], v[248:251]
    s_add_u32 m0, s44, 110624
    ds_read_b64_tr_b16 a[206:207], v3 offset:54304
    v_fma_mix_f32 v38, v63, v26, v30 op_sel:[0,0,0] op_sel_hi:[1,0,0]
    v_mfma_f32_16x16x32_bf16 v[248:251], a[244:247], v[124:127], v[248:251]
    s_waitcnt lgkmcnt(8)
    buffer_load_dwordx4 v5, s[16:19], s46 offen offset:1024 lds
    v_mfma_f32_16x16x32_bf16 v[220:223], a[248:251], v[112:115], v[220:223]
    ds_read_b64_tr_b16 a[208:209], v3 offset:36928
    v_fma_mix_f32 v39, v63, v27, v31 op_sel:[1,0,0] op_sel_hi:[1,0,0]
    v_mfma_f32_16x16x32_bf16 v[220:223], a[252:255], v[116:119], v[220:223]
    ds_read_b64_tr_b16 a[210:211], v3 offset:37440
    ds_read_b64_tr_b16 a[212:213], v3 offset:53824
    v_cvt_pk_bf16_f32 v62, v36, v37
    v_mfma_f32_16x16x32_bf16 v[252:255], a[248:251], v[120:123], v[252:255]
    s_add_u32 m0, s44, 110656
    ds_read_b64_tr_b16 a[214:215], v3 offset:54336
    v_cvt_pk_bf16_f32 v63, v38, v39
    v_mfma_f32_16x16x32_bf16 v[252:255], a[252:255], v[124:127], v[252:255]
    s_waitcnt lgkmcnt(8)
    buffer_load_dwordx4 v5, s[16:19], s46 offen offset:2048 lds
    v_mfma_f32_16x16x32_bf16 v[128:131], a[192:195], v[48:51], v[128:131]
    ds_read_b64_tr_b16 a[216:217], v3 offset:36960
    v_mfma_f32_16x16x32_bf16 v[128:131], a[196:199], v[52:55], v[128:131]
    ds_read_b64_tr_b16 a[218:219], v3 offset:37472
    ds_read_b64_tr_b16 a[220:221], v3 offset:53856
    v_mfma_f32_16x16x32_bf16 v[160:163], a[192:195], v[56:59], v[160:163]
    s_add_u32 m0, s44, 110688
    ds_read_b64_tr_b16 a[222:223], v3 offset:54368
    v_mfma_f32_16x16x32_bf16 v[160:163], a[196:199], v[60:63], v[160:163]
    s_waitcnt lgkmcnt(8)
    buffer_load_dwordx4 v5, s[16:19], s46 offen offset:3072 lds
    v_mfma_f32_16x16x32_bf16 v[132:135], a[200:203], v[48:51], v[132:135]
    ds_read_b64_tr_b16 a[224:225], v3 offset:36992
    v_mfma_f32_16x16x32_bf16 v[132:135], a[204:207], v[52:55], v[132:135]
    ds_read_b64_tr_b16 a[226:227], v3 offset:37504
    ds_read_b64_tr_b16 a[228:229], v3 offset:53888
    v_mfma_f32_16x16x32_bf16 v[164:167], a[200:203], v[56:59], v[164:167]
    s_add_u32 m0, s44, 127488
    ds_read_b64_tr_b16 a[230:231], v3 offset:54400
    v_mfma_f32_16x16x32_bf16 v[164:167], a[204:207], v[60:63], v[164:167]
    s_waitcnt lgkmcnt(8)
    buffer_load_dwordx4 v5, s[20:23], s46 offen offset:0 lds
    v_mfma_f32_16x16x32_bf16 v[136:139], a[208:211], v[48:51], v[136:139]
    ds_read_b64_tr_b16 a[232:233], v3 offset:37024
    v_mfma_f32_16x16x32_bf16 v[136:139], a[212:215], v[52:55], v[136:139]
    ds_read_b64_tr_b16 a[234:235], v3 offset:37536
    ds_read_b64_tr_b16 a[236:237], v3 offset:53920
    v_mfma_f32_16x16x32_bf16 v[168:171], a[208:211], v[56:59], v[168:171]
    s_add_u32 m0, s44, 127520
    ds_read_b64_tr_b16 a[238:239], v3 offset:54432
    v_mfma_f32_16x16x32_bf16 v[168:171], a[212:215], v[60:63], v[168:171]
    s_waitcnt lgkmcnt(8)
    buffer_load_dwordx4 v5, s[20:23], s46 offen offset:1024 lds
    v_mfma_f32_16x16x32_bf16 v[140:143], a[216:219], v[48:51], v[140:143]
    ds_read_b64_tr_b16 a[240:241], v3 offset:37056
    v_cvt_pk_bf16_f32 v64, v128, v129
    v_mfma_f32_16x16x32_bf16 v[140:143], a[220:223], v[52:55], v[140:143]
    ds_read_b64_tr_b16 a[242:243], v3 offset:37568
    ds_read_b64_tr_b16 a[244:245], v3 offset:53952
    v_mfma_f32_16x16x32_bf16 v[172:175], a[216:219], v[56:59], v[172:175]
    s_add_u32 m0, s44, 127552
    ds_read_b64_tr_b16 a[246:247], v3 offset:54464
    v_cvt_pk_bf16_f32 v65, v130, v131
    v_mfma_f32_16x16x32_bf16 v[172:175], a[220:223], v[60:63], v[172:175]
    s_waitcnt lgkmcnt(8)
    buffer_load_dwordx4 v5, s[20:23], s46 offen offset:2048 lds
    v_mfma_f32_16x16x32_bf16 v[144:147], a[224:227], v[48:51], v[144:147]
    ds_read_b64_tr_b16 a[248:249], v3 offset:37088
    v_cvt_pk_bf16_f32 v66, v132, v133
    v_mfma_f32_16x16x32_bf16 v[144:147], a[228:231], v[52:55], v[144:147]
    ds_read_b64_tr_b16 a[250:251], v3 offset:37600
    ds_read_b64_tr_b16 a[252:253], v3 offset:53984
    v_mfma_f32_16x16x32_bf16 v[176:179], a[224:227], v[56:59], v[176:179]
    s_add_u32 m0, s44, 127584
    ds_read_b64_tr_b16 a[254:255], v3 offset:54496
    v_cvt_pk_bf16_f32 v67, v134, v135
    v_mfma_f32_16x16x32_bf16 v[176:179], a[228:231], v[60:63], v[176:179]
    s_waitcnt lgkmcnt(8)
    buffer_load_dwordx4 v5, s[20:23], s46 offen offset:3072 lds
    v_mfma_f32_16x16x32_bf16 v[148:151], a[232:235], v[48:51], v[148:151]
    ds_read_b64_tr_b16 a[192:193], v3 offset:37120
    v_cvt_pk_bf16_f32 v80, v160, v161
    v_mfma_f32_16x16x32_bf16 v[148:151], a[236:239], v[52:55], v[148:151]
    ds_read_b64_tr_b16 a[194:195], v3 offset:37632
    v_cvt_pk_bf16_f32 v81, v162, v163
    v_mfma_f32_16x16x32_bf16 v[180:183], a[232:235], v[56:59], v[180:183]
    ds_read_b64_tr_b16 a[196:197], v3 offset:54016
    v_cvt_pk_bf16_f32 v82, v164, v165
    v_mfma_f32_16x16x32_bf16 v[180:183], a[236:239], v[60:63], v[180:183]
    s_waitcnt lgkmcnt(7)
    ds_read_b64_tr_b16 a[198:199], v3 offset:54528
    v_cvt_pk_bf16_f32 v83, v166, v167
    v_mfma_f32_16x16x32_bf16 v[152:155], a[240:243], v[48:51], v[152:155]
    ds_read_b64_tr_b16 a[200:201], v3 offset:37152
    v_cvt_pk_bf16_f32 v68, v136, v137
    v_mfma_f32_16x16x32_bf16 v[152:155], a[244:247], v[52:55], v[152:155]
    ds_read_b64_tr_b16 a[202:203], v3 offset:37664
    v_cvt_pk_bf16_f32 v69, v138, v139
    v_mfma_f32_16x16x32_bf16 v[184:187], a[240:243], v[56:59], v[184:187]
    ds_read_b64_tr_b16 a[204:205], v3 offset:54048
    v_cvt_pk_bf16_f32 v70, v140, v141
    v_mfma_f32_16x16x32_bf16 v[184:187], a[244:247], v[60:63], v[184:187]
    s_waitcnt lgkmcnt(7)
    ds_read_b64_tr_b16 a[206:207], v3 offset:54560
    v_cvt_pk_bf16_f32 v71, v142, v143
    v_mfma_f32_16x16x32_bf16 v[156:159], a[248:251], v[48:51], v[156:159]
    ds_read_b64_tr_b16 a[208:209], v3 offset:37184
    v_cvt_pk_bf16_f32 v84, v168, v169
    v_mfma_f32_16x16x32_bf16 v[156:159], a[252:255], v[52:55], v[156:159]
    ds_read_b64_tr_b16 a[210:211], v3 offset:37696
    v_cvt_pk_bf16_f32 v85, v170, v171
    v_mfma_f32_16x16x32_bf16 v[188:191], a[248:251], v[56:59], v[188:191]
    ds_read_b64_tr_b16 a[212:213], v3 offset:54080
    v_cvt_pk_bf16_f32 v86, v172, v173
    v_mfma_f32_16x16x32_bf16 v[188:191], a[252:255], v[60:63], v[188:191]
    s_waitcnt lgkmcnt(7)
    ds_read_b64_tr_b16 a[214:215], v3 offset:54592
    v_cvt_pk_bf16_f32 v87, v174, v175
    v_mfma_f32_16x16x32_bf16 v[192:195], a[192:195], v[48:51], v[192:195]
    ds_read_b64_tr_b16 a[216:217], v3 offset:37216
    v_cvt_pk_bf16_f32 v72, v144, v145
    v_mfma_f32_16x16x32_bf16 v[192:195], a[196:199], v[52:55], v[192:195]
    ds_read_b64_tr_b16 a[218:219], v3 offset:37728
    v_cvt_pk_bf16_f32 v73, v146, v147
    v_mfma_f32_16x16x32_bf16 v[224:227], a[192:195], v[56:59], v[224:227]
    ds_read_b64_tr_b16 a[220:221], v3 offset:54112
    v_cvt_pk_bf16_f32 v74, v148, v149
    v_mfma_f32_16x16x32_bf16 v[224:227], a[196:199], v[60:63], v[224:227]
    s_waitcnt lgkmcnt(7)
    ds_read_b64_tr_b16 a[222:223], v3 offset:54624
    v_cvt_pk_bf16_f32 v75, v150, v151
    v_mfma_f32_16x16x32_bf16 v[196:199], a[200:203], v[48:51], v[196:199]
    ds_read_b64_tr_b16 a[224:225], v3 offset:37248
    v_cvt_pk_bf16_f32 v88, v176, v177
    v_mfma_f32_16x16x32_bf16 v[196:199], a[204:207], v[52:55], v[196:199]
    ds_read_b64_tr_b16 a[226:227], v3 offset:37760
    v_cvt_pk_bf16_f32 v89, v178, v179
    v_mfma_f32_16x16x32_bf16 v[228:231], a[200:203], v[56:59], v[228:231]
    ds_read_b64_tr_b16 a[228:229], v3 offset:54144
    v_cvt_pk_bf16_f32 v90, v180, v181
    v_mfma_f32_16x16x32_bf16 v[228:231], a[204:207], v[60:63], v[228:231]
    s_waitcnt lgkmcnt(7)
    ds_read_b64_tr_b16 a[230:231], v3 offset:54656
    v_cvt_pk_bf16_f32 v91, v182, v183
    v_mfma_f32_16x16x32_bf16 v[200:203], a[208:211], v[48:51], v[200:203]
    ds_read_b64_tr_b16 a[232:233], v3 offset:37280
    v_cvt_pk_bf16_f32 v76, v152, v153
    v_mfma_f32_16x16x32_bf16 v[200:203], a[212:215], v[52:55], v[200:203]
    ds_read_b64_tr_b16 a[234:235], v3 offset:37792
    v_cvt_pk_bf16_f32 v77, v154, v155
    v_mfma_f32_16x16x32_bf16 v[232:235], a[208:211], v[56:59], v[232:235]
    ds_read_b64_tr_b16 a[236:237], v3 offset:54176
    v_cvt_pk_bf16_f32 v78, v156, v157
    v_mfma_f32_16x16x32_bf16 v[232:235], a[212:215], v[60:63], v[232:235]
    s_waitcnt lgkmcnt(7)
    ds_read_b64_tr_b16 a[238:239], v3 offset:54688
    v_cvt_pk_bf16_f32 v79, v158, v159
    v_mfma_f32_16x16x32_bf16 v[204:207], a[216:219], v[48:51], v[204:207]
    ds_read_b64_tr_b16 a[240:241], v3 offset:37312
    v_cvt_pk_bf16_f32 v92, v184, v185
    v_mfma_f32_16x16x32_bf16 v[204:207], a[220:223], v[52:55], v[204:207]
    ds_read_b64_tr_b16 a[242:243], v3 offset:37824
    v_cvt_pk_bf16_f32 v93, v186, v187
    v_mfma_f32_16x16x32_bf16 v[236:239], a[216:219], v[56:59], v[236:239]
    ds_read_b64_tr_b16 a[244:245], v3 offset:54208
    v_cvt_pk_bf16_f32 v94, v188, v189
    v_mfma_f32_16x16x32_bf16 v[236:239], a[220:223], v[60:63], v[236:239]
    s_waitcnt lgkmcnt(7)
    ds_read_b64_tr_b16 a[246:247], v3 offset:54720
    v_cvt_pk_bf16_f32 v95, v190, v191
    v_mfma_f32_16x16x32_bf16 v[208:211], a[224:227], v[48:51], v[208:211]
    ds_read_b64_tr_b16 a[248:249], v3 offset:37344
    v_cvt_pk_bf16_f32 v96, v192, v193
    v_mfma_f32_16x16x32_bf16 v[208:211], a[228:231], v[52:55], v[208:211]
    ds_read_b64_tr_b16 a[250:251], v3 offset:37856
    v_cvt_pk_bf16_f32 v97, v194, v195
    v_mfma_f32_16x16x32_bf16 v[240:243], a[224:227], v[56:59], v[240:243]
    ds_read_b64_tr_b16 a[252:253], v3 offset:54240
    v_cvt_pk_bf16_f32 v98, v196, v197
    v_mfma_f32_16x16x32_bf16 v[240:243], a[228:231], v[60:63], v[240:243]
    s_waitcnt vmcnt(8)
    s_barrier
    s_waitcnt lgkmcnt(7)
    ds_read_b64_tr_b16 a[254:255], v3 offset:54752
    v_cvt_pk_bf16_f32 v99, v198, v199
    v_mfma_f32_16x16x32_bf16 v[212:215], a[232:235], v[48:51], v[212:215]
    ds_read_b128 a[64:67], v1 offset:0
    v_cvt_pk_bf16_f32 v112, v224, v225
    v_mfma_f32_16x16x32_bf16 v[212:215], a[236:239], v[52:55], v[212:215]
    ds_read_b128 a[68:71], v1 offset:64
    v_cvt_pk_bf16_f32 v113, v226, v227
    v_mfma_f32_16x16x32_bf16 v[244:247], a[232:235], v[56:59], v[244:247]
    s_add_u32 m0, s44, 0
    ds_read_b128 a[72:75], v1 offset:128
    v_cvt_pk_bf16_f32 v114, v228, v229
    v_mfma_f32_16x16x32_bf16 v[244:247], a[236:239], v[60:63], v[244:247]
    s_mov_b32 s46, 32768
    s_waitcnt lgkmcnt(7)
    buffer_load_dwordx4 v5, s[16:19], s46 offen offset:0 lds
    v_mfma_f32_16x16x32_bf16 v[216:219], a[240:243], v[48:51], v[216:219]
    ds_read_b128 a[76:79], v1 offset:192
    v_cvt_pk_bf16_f32 v115, v230, v231
    v_mfma_f32_16x16x32_bf16 v[216:219], a[244:247], v[52:55], v[216:219]
    ds_read_b128 a[80:83], v1 offset:256
    v_cvt_pk_bf16_f32 v100, v200, v201
    v_mfma_f32_16x16x32_bf16 v[248:251], a[240:243], v[56:59], v[248:251]
    s_add_u32 m0, s44, 32
    ds_read_b128 a[84:87], v1 offset:320
    v_cvt_pk_bf16_f32 v101, v202, v203
    v_mfma_f32_16x16x32_bf16 v[248:251], a[244:247], v[60:63], v[248:251]
    s_waitcnt lgkmcnt(6)
    buffer_load_dwordx4 v5, s[16:19], s46 offen offset:1024 lds
    v_mfma_f32_16x16x32_bf16 v[220:223], a[248:251], v[48:51], v[220:223]
    ds_read_b128 a[88:91], v1 offset:384
    v_cvt_pk_bf16_f32 v102, v204, v205
    v_mfma_f32_16x16x32_bf16 v[220:223], a[252:255], v[52:55], v[220:223]
    ds_read_b128 a[92:95], v1 offset:448
    v_cvt_pk_bf16_f32 v103, v206, v207
    v_mfma_f32_16x16x32_bf16 v[252:255], a[248:251], v[56:59], v[252:255]
    s_add_u32 m0, s44, 64
    ds_read_b128 a[96:99], v1 offset:512
    v_cvt_pk_bf16_f32 v116, v232, v233
    v_mfma_f32_16x16x32_bf16 v[252:255], a[252:255], v[60:63], v[252:255]
    buffer_load_dwordx4 v5, s[16:19], s46 offen offset:2048 lds
    v_lshlrev_b32 v14, 7, v0
    s_add_u32 m0, s44, 96
    s_nop 0
    buffer_load_dwordx4 v5, s[16:19], s46 offen offset:3072 lds
    s_add_u32 m0, s44, 16896
    s_nop 0
    buffer_load_dwordx4 v5, s[20:23], s46 offen offset:0 lds
    s_add_u32 m0, s44, 16928
    s_nop 0
    buffer_load_dwordx4 v5, s[20:23], s46 offen offset:1024 lds
    s_add_u32 m0, s44, 16960
    s_nop 0
    buffer_load_dwordx4 v5, s[20:23], s46 offen offset:2048 lds
    s_add_u32 m0, s44, 16992
    s_nop 0
    buffer_load_dwordx4 v5, s[20:23], s46 offen offset:3072 lds
    buffer_load_dword a63, v14, s[36:39], 0 offen
    ds_read_b128 a[100:103], v1 offset:576
    ds_read_b128 a[104:107], v1 offset:640
    ds_read_b128 a[108:111], v1 offset:704
    ds_read_b128 a[112:115], v1 offset:768
    ds_read_b128 a[116:119], v1 offset:832
    ds_read_b128 a[120:123], v1 offset:896
    ds_read_b128 a[124:127], v1 offset:960
    ds_read_b64_tr_b16 a[128:129], v2 offset:0
    ds_read_b64_tr_b16 a[130:131], v2 offset:256
    ds_read_b64_tr_b16 a[132:133], v2 offset:512
    ds_read_b64_tr_b16 a[134:135], v2 offset:768
    ds_read_b64_tr_b16 a[136:137], v2 offset:32
    ds_read_b64_tr_b16 a[138:139], v2 offset:288
    ds_read_b64_tr_b16 a[140:141], v2 offset:544
    ds_read_b64_tr_b16 a[142:143], v2 offset:800
    ds_read_b64_tr_b16 a[144:145], v2 offset:64
    ds_read_b64_tr_b16 a[146:147], v2 offset:320
    ds_read_b64_tr_b16 a[148:149], v2 offset:576
    ds_read_b64_tr_b16 a[150:151], v2 offset:832
    ds_read_b64_tr_b16 a[152:153], v2 offset:96
    ds_read_b64_tr_b16 a[154:155], v2 offset:352
    ds_read_b64_tr_b16 a[156:157], v2 offset:608
    ds_read_b64_tr_b16 a[158:159], v2 offset:864
    ds_read_b64_tr_b16 a[160:161], v2 offset:128
    ds_read_b64_tr_b16 a[162:163], v2 offset:384
    ds_read_b64_tr_b16 a[164:165], v2 offset:640
    ds_read_b64_tr_b16 a[166:167], v2 offset:896
    ds_read_b64_tr_b16 a[168:169], v2 offset:160
    ds_read_b64_tr_b16 a[170:171], v2 offset:416
    ds_read_b64_tr_b16 a[172:173], v2 offset:672
    ds_read_b64_tr_b16 a[174:175], v2 offset:928
    ds_read_b64_tr_b16 a[176:177], v2 offset:192
    ds_read_b64_tr_b16 a[178:179], v2 offset:448
    ds_read_b64_tr_b16 a[180:181], v2 offset:704
    ds_read_b64_tr_b16 a[182:183], v2 offset:960
    ds_read_b64_tr_b16 a[184:185], v2 offset:224
    ds_read_b64_tr_b16 a[186:187], v2 offset:480
    ds_read_b64_tr_b16 a[188:189], v2 offset:736
    ds_read_b64_tr_b16 a[190:191], v2 offset:992
    v_cvt_pk_bf16_f32 v117, v234, v235
    v_cvt_pk_bf16_f32 v118, v236, v237
    v_cvt_pk_bf16_f32 v119, v238, v239
    v_cvt_pk_bf16_f32 v104, v208, v209
    v_cvt_pk_bf16_f32 v105, v210, v211
    v_cvt_pk_bf16_f32 v106, v212, v213
    v_cvt_pk_bf16_f32 v107, v214, v215
    v_cvt_pk_bf16_f32 v120, v240, v241
    v_cvt_pk_bf16_f32 v121, v242, v243
    v_cvt_pk_bf16_f32 v122, v244, v245
    v_cvt_pk_bf16_f32 v123, v246, v247
    v_cvt_pk_bf16_f32 v108, v216, v217
    v_cvt_pk_bf16_f32 v109, v218, v219
    v_cvt_pk_bf16_f32 v110, v220, v221
    v_cvt_pk_bf16_f32 v111, v222, v223
    v_cvt_pk_bf16_f32 v124, v248, v249
    v_cvt_pk_bf16_f32 v125, v250, v251
    v_cvt_pk_bf16_f32 v126, v252, v253
    v_cvt_pk_bf16_f32 v127, v254, v255
    s_nop 0
    v_permlane32_swap_b32 v64, v66
    v_permlane32_swap_b32 v65, v67
    v_permlane32_swap_b32 v80, v82
    v_permlane32_swap_b32 v81, v83
    v_permlane32_swap_b32 v68, v70
    v_permlane32_swap_b32 v69, v71
    v_permlane32_swap_b32 v84, v86
    v_permlane32_swap_b32 v85, v87
    v_permlane32_swap_b32 v72, v74
    v_permlane32_swap_b32 v73, v75
    v_permlane32_swap_b32 v88, v90
    v_permlane32_swap_b32 v89, v91
    v_permlane32_swap_b32 v76, v78
    v_permlane32_swap_b32 v77, v79
    v_permlane32_swap_b32 v92, v94
    v_permlane32_swap_b32 v93, v95
    v_permlane32_swap_b32 v96, v98
    v_permlane32_swap_b32 v97, v99
    v_permlane32_swap_b32 v112, v114
    v_permlane32_swap_b32 v113, v115
    v_permlane32_swap_b32 v100, v102
    v_permlane32_swap_b32 v101, v103
    v_permlane32_swap_b32 v116, v118
    v_permlane32_swap_b32 v117, v119
    v_permlane32_swap_b32 v104, v106
    v_permlane32_swap_b32 v105, v107
    v_permlane32_swap_b32 v120, v122
    v_permlane32_swap_b32 v121, v123
    v_permlane32_swap_b32 v108, v110
    v_permlane32_swap_b32 v109, v111
    v_permlane32_swap_b32 v124, v126
    v_permlane32_swap_b32 v125, v127
    s_waitcnt lgkmcnt(15)
    v_mfma_f32_16x16x32_bf16 v[16:19], a[64:67], v[64:67], 0
    v_mfma_f32_16x16x32_bf16 v[16:19], a[68:71], v[68:71], v[16:19]
    v_mfma_f32_16x16x32_bf16 v[16:19], a[72:75], v[72:75], v[16:19]
    v_mfma_f32_16x16x32_bf16 v[16:19], a[76:79], v[76:79], v[16:19]
    v_mfma_f32_16x16x32_bf16 v[20:23], a[64:67], v[80:83], 0
    v_mfma_f32_16x16x32_bf16 v[20:23], a[68:71], v[84:87], v[20:23]
    v_mfma_f32_16x16x32_bf16 v[20:23], a[72:75], v[88:91], v[20:23]
    v_mfma_f32_16x16x32_bf16 v[20:23], a[76:79], v[92:95], v[20:23]
    v_mfma_f32_16x16x32_bf16 v[24:27], a[64:67], v[96:99], 0
    v_mfma_f32_16x16x32_bf16 v[24:27], a[68:71], v[100:103], v[24:27]
    v_mfma_f32_16x16x32_bf16 v[24:27], a[72:75], v[104:107], v[24:27]
    v_mfma_f32_16x16x32_bf16 v[24:27], a[76:79], v[108:111], v[24:27]
    v_mfma_f32_16x16x32_bf16 v[28:31], a[64:67], v[112:115], 0
    v_mfma_f32_16x16x32_bf16 v[28:31], a[68:71], v[116:119], v[28:31]
    v_mfma_f32_16x16x32_bf16 v[28:31], a[72:75], v[120:123], v[28:31]
    v_mfma_f32_16x16x32_bf16 v[28:31], a[76:79], v[124:127], v[28:31]
    s_nop 1
    v_max3_f32 v16, v16, v17, v18
    v_max_f32 v16, v16, v19
    v_max3_f32 v20, v20, v21, v22
    v_max_f32 v20, v20, v23
    v_max3_f32 v24, v24, v25, v26
    v_max_f32 v24, v24, v27
    v_max3_f32 v28, v28, v29, v30
    v_max_f32 v28, v28, v31
    v_mov_b32 v12, v16
    v_mov_b32 v13, v20
    v_mov_b32 v14, v24
    v_mov_b32 v15, v28
    v_permlane16_swap_b32 v12, v16
    v_permlane16_swap_b32 v13, v20
    v_permlane16_swap_b32 v14, v24
    v_permlane16_swap_b32 v15, v28
    v_max_f32 v16, v16, v12
    v_max_f32 v20, v20, v13
    v_max_f32 v24, v24, v14
    v_max_f32 v28, v28, v15
    v_mov_b32 v12, v16
    v_mov_b32 v13, v20
    v_mov_b32 v14, v24
    v_mov_b32 v15, v28
    v_permlane32_swap_b32 v12, v16
    v_permlane32_swap_b32 v13, v20
    v_permlane32_swap_b32 v14, v24
    v_permlane32_swap_b32 v15, v28
    v_max_f32 v16, v16, v12
    v_max_f32 v20, v20, v13
    v_max_f32 v24, v24, v14
    v_max_f32 v28, v28, v15
    v_sub_f32 v48, 0xc2000000, v16
    v_sub_f32 v49, 0xc2000000, v16
    v_sub_f32 v50, 0xc2000000, v16
    v_sub_f32 v51, 0xc2000000, v16
    v_sub_f32 v52, 0xc2000000, v20
    v_sub_f32 v53, 0xc2000000, v20
    v_sub_f32 v54, 0xc2000000, v20
    v_sub_f32 v55, 0xc2000000, v20
    v_sub_f32 v56, 0xc2000000, v24
    v_sub_f32 v57, 0xc2000000, v24
    v_sub_f32 v58, 0xc2000000, v24
    v_sub_f32 v59, 0xc2000000, v24
    v_sub_f32 v60, 0xc2000000, v28
    v_sub_f32 v61, 0xc2000000, v28
    v_sub_f32 v62, 0xc2000000, v28
    v_sub_f32 v63, 0xc2000000, v28
L2_entry:
    v_accvgpr_write_b32 a0, 0
    v_accvgpr_write_b32 a1, 0
    v_accvgpr_write_b32 a2, 0
    v_accvgpr_write_b32 a3, 0
    v_accvgpr_write_b32 a4, 0
    v_accvgpr_write_b32 a5, 0
    v_accvgpr_write_b32 a6, 0
    v_accvgpr_write_b32 a7, 0
    v_accvgpr_write_b32 a8, 0
    v_accvgpr_write_b32 a9, 0
    v_accvgpr_write_b32 a10, 0
    v_accvgpr_write_b32 a11, 0
    v_accvgpr_write_b32 a12, 0
    v_accvgpr_write_b32 a13, 0
    v_accvgpr_write_b32 a14, 0
    v_accvgpr_write_b32 a15, 0
    v_mov_b32 v224, 0
    v_mov_b32 v225, 0
    v_mov_b32 v226, 0
    v_mov_b32 v227, 0
    v_mov_b32 v228, 0
    v_mov_b32 v229, 0
    v_mov_b32 v230, 0
    v_mov_b32 v231, 0
    v_mov_b32 v232, 0
    v_mov_b32 v233, 0
    v_mov_b32 v234, 0
    v_mov_b32 v235, 0
    v_mov_b32 v236, 0
    v_mov_b32 v237, 0
    v_mov_b32 v238, 0
    v_mov_b32 v239, 0
    v_mov_b32 v240, 0
    v_mov_b32 v241, 0
    v_mov_b32 v242, 0
    v_mov_b32 v243, 0
    v_mov_b32 v244, 0
    v_mov_b32 v245, 0
    v_mov_b32 v246, 0
    v_mov_b32 v247, 0
    v_mov_b32 v248, 0
    v_mov_b32 v249, 0
    v_mov_b32 v250, 0
    v_mov_b32 v251, 0
    v_mov_b32 v252, 0
    v_mov_b32 v253, 0
    v_mov_b32 v254, 0
    v_mov_b32 v255, 0
    s_mov_b32 s47, s44
    s_mov_b32 s48, -73728
    s_mov_b32 s49, 12
    s_mov_b32 s46, 49152
    v_lshrrev_b32 v14, 2, v0
    s_mul_i32 s3, s51, 144
    v_add_u32 v14, s3, v14
    v_mul_u32_u24 v14, 9216, v14
    v_and_b32 v15, 3, v0
    v_lshl_add_u32 v6, v15, 4, v14
    s_lshr_b32 s3, s2, 3
    s_lshl_b32 s3, s3, 2
    s_add_u32 s3, s3, s51
    s_and_b32 s15, s2, 7
    s_lshl_b32 s14, s3, 7
    v_lshl_add_u32 v9, v0, 14, s14
    v_min_u32 v9, L2_codeend-L2_begin-8, v9
    s_mul_i32 s14, s3, 9
    s_lshr_b32 s14, s14, 1
    v_min_u32 v15, 44, v0
    v_mul_u32_u24 v12, 7282, v15
    v_lshrrev_b32 v12, 16, v12
    v_mul_u32_u24 v13, 63, v12
    v_add_u32 v12, v15, v13
    s_mul_i32 s14, s14, 72
    s_mul_i32 s56, s15, 9
    s_add_u32 s14, s14, s56
    v_add_u32 v12, s14, v12
    v_lshlrev_b32 v12, 7, v12
    s_mul_i32 s14, s3, 81
    s_lshr_b32 s14, s14, 1
    s_mul_i32 s56, s15, 5184
    s_add_u32 s14, s14, s56
    v_min_u32 v13, 40, v0
    v_add_u32 v13, s14, v13
    v_lshlrev_b32 v13, 7, v13
    s_mul_i32 s14, s3, 72
    s_andn2_b32 s56, s52, 3
    s_mul_i32 s56, s56, 2304
    s_add_u32 s14, s14, s56
    v_min_u32 v14, 35, v0
    v_add_u32 v14, s14, v14
    v_lshlrev_b32 v14, 7, v14
    v_add_u32 v15, 4608, v14
    s_waitcnt vmcnt(9) lgkmcnt(0)
    s_barrier
    v_mfma_f32_16x16x32_bf16 v[16:19], a[64:67], v[64:67], v[48:51]
    v_mfma_f32_16x16x32_bf16 v[16:19], a[68:71], v[68:71], v[16:19]
    v_mfma_f32_16x16x32_bf16 v[16:19], a[72:75], v[72:75], v[16:19]
    s_add_u32 m0, s47, 36864
    v_mfma_f32_16x16x32_bf16 v[16:19], a[76:79], v[76:79], v[16:19]
    buffer_load_dwordx4 v5, s[16:19], s46 offen offset:0 lds
    v_mfma_f32_16x16x32_bf16 v[20:23], a[80:83], v[64:67], v[48:51]
    v_mfma_f32_16x16x32_bf16 v[20:23], a[84:87], v[68:71], v[20:23]
    v_mfma_f32_16x16x32_bf16 v[20:23], a[88:91], v[72:75], v[20:23]
    s_add_u32 m0, s47, 36896
    v_mfma_f32_16x16x32_bf16 v[20:23], a[92:95], v[76:79], v[20:23]
    buffer_load_dwordx4 v5, s[16:19], s46 offen offset:1024 lds
    v_mfma_f32_16x16x32_bf16 v[24:27], a[96:99], v[64:67], v[48:51]
    s_nop 1
    v_exp_f32 v16, v16
    v_mfma_f32_16x16x32_bf16 v[24:27], a[100:103], v[68:71], v[24:27]
    v_mfma_f32_16x16x32_bf16 v[24:27], a[104:107], v[72:75], v[24:27]
    s_add_u32 m0, s47, 36928
    v_exp_f32 v17, v17
    v_mfma_f32_16x16x32_bf16 v[24:27], a[108:111], v[76:79], v[24:27]
    buffer_load_dwordx4 v5, s[16:19], s46 offen offset:2048 lds
    v_mfma_f32_16x16x32_bf16 v[28:31], a[112:115], v[64:67], v[48:51]
    v_exp_f32 v18, v18
    v_mfma_f32_16x16x32_bf16 v[28:31], a[116:119], v[68:71], v[28:31]
    v_cvt_pk_bf16_f32 v32, v16, v17
    v_mfma_f32_16x16x32_bf16 v[28:31], a[120:123], v[72:75], v[28:31]
    s_add_u32 m0, s47, 36960
    v_exp_f32 v19, v19
    v_mfma_f32_16x16x32_bf16 v[28:31], a[124:127], v[76:79], v[28:31]
    buffer_load_dwordx4 v5, s[16:19], s46 offen offset:3072 lds
    s_nop 3
    v_exp_f32 v20, v20
    s_nop 0
    ds_read_b64_tr_b16 a[192:193], v2 offset:36864
    v_cvt_pk_bf16_f32 v33, v18, v19
    s_add_u32 m0, s47, 53760
    v_exp_f32 v21, v21
    s_nop 0
    buffer_load_dwordx4 v5, s[20:23], s46 offen offset:0 lds
    v_exp_f32 v22, v22
    s_nop 0
    ds_read_b64_tr_b16 a[194:195], v2 offset:37120
    v_cvt_pk_bf16_f32 v34, v20, v21
    s_add_u32 m0, s47, 53792
    v_exp_f32 v23, v23
    s_nop 0
    buffer_load_dwordx4 v5, s[20:23], s46 offen offset:1024 lds
    v_exp_f32 v24, v24
    s_nop 0
    ds_read_b64_tr_b16 a[196:197], v2 offset:37376
    v_cvt_pk_bf16_f32 v35, v22, v23
    s_add_u32 m0, s47, 53824
    v_exp_f32 v25, v25
    s_nop 0
    buffer_load_dwordx4 v5, s[20:23], s46 offen offset:2048 lds
    v_exp_f32 v26, v26
    s_nop 0
    ds_read_b64_tr_b16 a[198:199], v2 offset:37632
    v_cvt_pk_bf16_f32 v36, v24, v25
    s_add_u32 m0, s47, 53856
    v_exp_f32 v27, v27
    s_nop 0
    buffer_load_dwordx4 v5, s[20:23], s46 offen offset:3072 lds
    ds_read_b64_tr_b16 a[200:201], v2 offset:36896
    s_nop 0
    v_mfma_f32_16x16x32_bf16 v[16:19], a[64:67], v[80:83], v[52:55]
    v_exp_f32 v28, v28
    v_mfma_f32_16x16x32_bf16 v[16:19], a[68:71], v[84:87], v[16:19]
    ds_read_b64_tr_b16 a[202:203], v2 offset:37152
    v_cvt_pk_bf16_f32 v37, v26, v27
    v_mfma_f32_16x16x32_bf16 v[16:19], a[72:75], v[88:91], v[16:19]
    v_exp_f32 v29, v29
    v_mfma_f32_16x16x32_bf16 v[16:19], a[76:79], v[92:95], v[16:19]
    ds_read_b64_tr_b16 a[204:205], v2 offset:37408
    v_mfma_f32_16x16x32_bf16 v[20:23], a[80:83], v[80:83], v[52:55]
    v_exp_f32 v30, v30
    v_mfma_f32_16x16x32_bf16 v[20:23], a[84:87], v[84:87], v[20:23]
    ds_read_b64_tr_b16 a[206:207], v2 offset:37664
    v_cvt_pk_bf16_f32 v38, v28, v29
    v_mfma_f32_16x16x32_bf16 v[20:23], a[88:91], v[88:91], v[20:23]
    v_exp_f32 v31, v31
    v_mfma_f32_16x16x32_bf16 v[20:23], a[92:95], v[92:95], v[20:23]
    ds_read_b64_tr_b16 a[208:209], v2 offset:36928
    v_mfma_f32_16x16x32_bf16 v[24:27], a[96:99], v[80:83], v[52:55]
    v_exp_f32 v16, v16
    v_mfma_f32_16x16x32_bf16 v[24:27], a[100:103], v[84:87], v[24:27]
    ds_read_b64_tr_b16 a[210:211], v2 offset:37184
    v_cvt_pk_bf16_f32 v39, v30, v31
    v_mfma_f32_16x16x32_bf16 v[24:27], a[104:107], v[88:91], v[24:27]
    v_exp_f32 v17, v17
    v_mfma_f32_16x16x32_bf16 v[24:27], a[108:111], v[92:95], v[24:27]
    ds_read_b64_tr_b16 a[212:213], v2 offset:37440
    v_mfma_f32_16x16x32_bf16 v[28:31], a[112:115], v[80:83], v[52:55]
    v_exp_f32 v18, v18
    v_mfma_f32_16x16x32_bf16 v[28:31], a[116:119], v[84:87], v[28:31]
    ds_read_b64_tr_b16 a[214:215], v2 offset:37696
    v_cvt_pk_bf16_f32 v40, v16, v17
    v_mfma_f32_16x16x32_bf16 v[28:31], a[120:123], v[88:91], v[28:31]
    v_exp_f32 v19, v19
    v_mfma_f32_16x16x32_bf16 v[28:31], a[124:127], v[92:95], v[28:31]
    ds_read_b64_tr_b16 a[216:217], v2 offset:36960
    v_mfma_f32_16x16x32_bf16 v[128:131], a[128:131], v[32:35], 0
    v_exp_f32 v20, v20
    v_mfma_f32_16x16x32_bf16 v[128:131], a[132:135], v[36:39], v[128:131]
    ds_read_b64_tr_b16 a[218:219], v2 offset:37216
    v_cvt_pk_bf16_f32 v41, v18, v19
    v_mfma_f32_16x16x32_bf16 v[132:135], a[136:139], v[32:35], 0
    v_exp_f32 v21, v21
    v_mfma_f32_16x16x32_bf16 v[132:135], a[140:143], v[36:39], v[132:135]
    ds_read_b64_tr_b16 a[220:221], v2 offset:37472
    v_mfma_f32_16x16x32_bf16 v[136:139], a[144:147], v[32:35], 0
    v_exp_f32 v22, v22
    v_mfma_f32_16x16x32_bf16 v[136:139], a[148:151], v[36:39], v[136:139]
    ds_read_b64_tr_b16 a[222:223], v2 offset:37728
    v_cvt_pk_bf16_f32 v42, v20, v21
    v_mfma_f32_16x16x32_bf16 v[140:143], a[152:155], v[32:35], 0
    v_exp_f32 v23, v23
    v_mfma_f32_16x16x32_bf16 v[140:143], a[156:159], v[36:39], v[140:143]
    ds_read_b64_tr_b16 a[224:225], v2 offset:36992
    v_mfma_f32_16x16x32_bf16 v[144:147], a[160:163], v[32:35], 0
    v_exp_f32 v24, v24
    v_mfma_f32_16x16x32_bf16 v[144:147], a[164:167], v[36:39], v[144:147]
    ds_read_b64_tr_b16 a[226:227], v2 offset:37248
    v_cvt_pk_bf16_f32 v43, v22, v23
    v_mfma_f32_16x16x32_bf16 v[148:151], a[168:171], v[32:35], 0
    v_exp_f32 v25, v25
    v_mfma_f32_16x16x32_bf16 v[148:151], a[172:175], v[36:39], v[148:151]
    ds_read_b64_tr_b16 a[228:229], v2 offset:37504
    v_mfma_f32_16x16x32_bf16 v[152:155], a[176:179], v[32:35], 0
    v_exp_f32 v26, v26
    v_mfma_f32_16x16x32_bf16 v[152:155], a[180:183], v[36:39], v[152:155]
    ds_read_b64_tr_b16 a[230:231], v2 offset:37760
    v_cvt_pk_bf16_f32 v44, v24, v25
    v_mfma_f32_16x16x32_bf16 v[156:159], a[184:187], v[32:35], 0
    v_exp_f32 v27, v27
    v_mfma_f32_16x16x32_bf16 v[156:159], a[188:191], v[36:39], v[156:159]
    ds_read_b64_tr_b16 a[232:233], v2 offset:37024
    v_smfmac_f32_16x16x64_bf16 a[0:3], a[16:19], v[32:39], v11
    ds_read_b64_tr_b16 a[234:235], v2 offset:37280
    v_mfma_f32_16x16x32_bf16 v[16:19], a[64:67], v[96:99], v[56:59]
    v_exp_f32 v28, v28
    v_mfma_f32_16x16x32_bf16 v[16:19], a[68:71], v[100:103], v[16:19]
    ds_read_b64_tr_b16 a[236:237], v2 offset:37536
    v_cvt_pk_bf16_f32 v45, v26, v27
    v_mfma_f32_16x16x32_bf16 v[16:19], a[72:75], v[104:107], v[16:19]
    v_exp_f32 v29, v29
    v_mfma_f32_16x16x32_bf16 v[16:19], a[76:79], v[108:111], v[16:19]
    ds_read_b64_tr_b16 a[238:239], v2 offset:37792
    v_mfma_f32_16x16x32_bf16 v[20:23], a[80:83], v[96:99], v[56:59]
    v_exp_f32 v30, v30
    v_mfma_f32_16x16x32_bf16 v[20:23], a[84:87], v[100:103], v[20:23]
    ds_read_b64_tr_b16 a[240:241], v2 offset:37056
    v_cvt_pk_bf16_f32 v46, v28, v29
    v_mfma_f32_16x16x32_bf16 v[20:23], a[88:91], v[104:107], v[20:23]
    v_exp_f32 v31, v31
    v_mfma_f32_16x16x32_bf16 v[20:23], a[92:95], v[108:111], v[20:23]
    ds_read_b64_tr_b16 a[242:243], v2 offset:37312
    v_mfma_f32_16x16x32_bf16 v[24:27], a[96:99], v[96:99], v[56:59]
    v_exp_f32 v16, v16
    v_mfma_f32_16x16x32_bf16 v[24:27], a[100:103], v[100:103], v[24:27]
    ds_read_b64_tr_b16 a[244:245], v2 offset:37568
    v_cvt_pk_bf16_f32 v47, v30, v31
    v_mfma_f32_16x16x32_bf16 v[24:27], a[104:107], v[104:107], v[24:27]
    v_exp_f32 v17, v17
    v_mfma_f32_16x16x32_bf16 v[24:27], a[108:111], v[108:111], v[24:27]
    ds_read_b64_tr_b16 a[246:247], v2 offset:37824
    v_mfma_f32_16x16x32_bf16 v[28:31], a[112:115], v[96:99], v[56:59]
    v_exp_f32 v18, v18
    v_mfma_f32_16x16x32_bf16 v[28:31], a[116:119], v[100:103], v[28:31]
    ds_read_b64_tr_b16 a[248:249], v2 offset:37088
    v_cvt_pk_bf16_f32 v32, v16, v17
    v_mfma_f32_16x16x32_bf16 v[28:31], a[120:123], v[104:107], v[28:31]
    v_exp_f32 v19, v19
    v_mfma_f32_16x16x32_bf16 v[28:31], a[124:127], v[108:111], v[28:31]
    ds_read_b64_tr_b16 a[250:251], v2 offset:37344
    v_mfma_f32_16x16x32_bf16 v[160:163], a[128:131], v[40:43], 0
    v_exp_f32 v20, v20
    v_mfma_f32_16x16x32_bf16 v[160:163], a[132:135], v[44:47], v[160:163]
    ds_read_b64_tr_b16 a[252:253], v2 offset:37600
    v_cvt_pk_bf16_f32 v33, v18, v19
    v_mfma_f32_16x16x32_bf16 v[164:167], a[136:139], v[40:43], 0
    v_exp_f32 v21, v21
    v_mfma_f32_16x16x32_bf16 v[164:167], a[140:143], v[44:47], v[164:167]
    ds_read_b64_tr_b16 a[254:255], v2 offset:37856
    v_mfma_f32_16x16x32_bf16 v[168:171], a[144:147], v[40:43], 0
    v_exp_f32 v22, v22
    v_mfma_f32_16x16x32_bf16 v[168:171], a[148:151], v[44:47], v[168:171]
    v_cvt_pk_bf16_f32 v34, v20, v21
    v_mfma_f32_16x16x32_bf16 v[172:175], a[152:155], v[40:43], 0
    v_exp_f32 v23, v23
    v_mfma_f32_16x16x32_bf16 v[172:175], a[156:159], v[44:47], v[172:175]
    v_mfma_f32_16x16x32_bf16 v[176:179], a[160:163], v[40:43], 0
    v_exp_f32 v24, v24
    v_mfma_f32_16x16x32_bf16 v[176:179], a[164:167], v[44:47], v[176:179]
    v_cvt_pk_bf16_f32 v35, v22, v23
    v_mfma_f32_16x16x32_bf16 v[180:183], a[168:171], v[40:43], 0
    v_exp_f32 v25, v25
    v_mfma_f32_16x16x32_bf16 v[180:183], a[172:175], v[44:47], v[180:183]
    v_mfma_f32_16x16x32_bf16 v[184:187], a[176:179], v[40:43], 0
    v_exp_f32 v26, v26
    v_mfma_f32_16x16x32_bf16 v[184:187], a[180:183], v[44:47], v[184:187]
    v_cvt_pk_bf16_f32 v36, v24, v25
    v_mfma_f32_16x16x32_bf16 v[188:191], a[184:187], v[40:43], 0
    v_exp_f32 v27, v27
    v_mfma_f32_16x16x32_bf16 v[188:191], a[188:191], v[44:47], v[188:191]
    v_smfmac_f32_16x16x64_bf16 a[4:7], a[16:19], v[40:47], v11
    v_mfma_f32_16x16x32_bf16 v[16:19], a[64:67], v[112:115], v[60:63]
    v_exp_f32 v28, v28
    v_mfma_f32_16x16x32_bf16 v[16:19], a[68:71], v[116:119], v[16:19]
    s_add_u32 s46, s46, 16384
    ds_read_b128 a[64:67], v1 offset:36864
    v_cvt_pk_bf16_f32 v37, v26, v27
    v_mfma_f32_16x16x32_bf16 v[16:19], a[72:75], v[120:123], v[16:19]
    v_exp_f32 v29, v29
    v_mfma_f32_16x16x32_bf16 v[16:19], a[76:79], v[124:127], v[16:19]
    ds_read_b128 a[68:71], v1 offset:36928
    v_mfma_f32_16x16x32_bf16 v[20:23], a[80:83], v[112:115], v[60:63]
    v_exp_f32 v30, v30
    v_mfma_f32_16x16x32_bf16 v[20:23], a[84:87], v[116:119], v[20:23]
    ds_read_b128 a[72:75], v1 offset:36992
    v_cvt_pk_bf16_f32 v38, v28, v29
    v_mfma_f32_16x16x32_bf16 v[20:23], a[88:91], v[120:123], v[20:23]
    v_exp_f32 v31, v31
    v_mfma_f32_16x16x32_bf16 v[20:23], a[92:95], v[124:127], v[20:23]
    ds_read_b128 a[76:79], v1 offset:37056
    v_mfma_f32_16x16x32_bf16 v[24:27], a[96:99], v[112:115], v[60:63]
    v_exp_f32 v16, v16
    v_mfma_f32_16x16x32_bf16 v[24:27], a[100:103], v[116:119], v[24:27]
    ds_read_b128 a[80:83], v1 offset:37120
    v_cvt_pk_bf16_f32 v39, v30, v31
    v_mfma_f32_16x16x32_bf16 v[24:27], a[104:107], v[120:123], v[24:27]
    v_exp_f32 v17, v17
    v_mfma_f32_16x16x32_bf16 v[24:27], a[108:111], v[124:127], v[24:27]
    ds_read_b128 a[84:87], v1 offset:37184
    v_mfma_f32_16x16x32_bf16 v[28:31], a[112:115], v[112:115], v[60:63]
    v_exp_f32 v18, v18
    v_mfma_f32_16x16x32_bf16 v[28:31], a[116:119], v[116:119], v[28:31]
    ds_read_b128 a[88:91], v1 offset:37248
    v_cvt_pk_bf16_f32 v40, v16, v17
    v_mfma_f32_16x16x32_bf16 v[28:31], a[120:123], v[120:123], v[28:31]
    v_exp_f32 v19, v19
    v_mfma_f32_16x16x32_bf16 v[28:31], a[124:127], v[124:127], v[28:31]
    ds_read_b128 a[92:95], v1 offset:37312
    v_mfma_f32_16x16x32_bf16 v[192:195], a[128:131], v[32:35], 0
    v_exp_f32 v20, v20
    v_mfma_f32_16x16x32_bf16 v[192:195], a[132:135], v[36:39], v[192:195]
    ds_read_b128 a[96:99], v1 offset:37376
    v_cvt_pk_bf16_f32 v41, v18, v19
    v_mfma_f32_16x16x32_bf16 v[196:199], a[136:139], v[32:35], 0
    v_exp_f32 v21, v21
    v_mfma_f32_16x16x32_bf16 v[196:199], a[140:143], v[36:39], v[196:199]
    ds_read_b128 a[100:103], v1 offset:37440
    v_mfma_f32_16x16x32_bf16 v[200:203], a[144:147], v[32:35], 0
    v_exp_f32 v22, v22
    v_mfma_f32_16x16x32_bf16 v[200:203], a[148:151], v[36:39], v[200:203]
    ds_read_b128 a[104:107], v1 offset:37504
    v_cvt_pk_bf16_f32 v42, v20, v21
    v_mfma_f32_16x16x32_bf16 v[204:207], a[152:155], v[32:35], 0
    v_exp_f32 v23, v23
    v_mfma_f32_16x16x32_bf16 v[204:207], a[156:159], v[36:39], v[204:207]
    ds_read_b128 a[108:111], v1 offset:37568
    v_mfma_f32_16x16x32_bf16 v[208:211], a[160:163], v[32:35], 0
    v_exp_f32 v24, v24
    v_mfma_f32_16x16x32_bf16 v[208:211], a[164:167], v[36:39], v[208:211]
    ds_read_b128 a[112:115], v1 offset:37632
    v_cvt_pk_bf16_f32 v43, v22, v23
    v_mfma_f32_16x16x32_bf16 v[212:215], a[168:171], v[32:35], 0
    v_exp_f32 v25, v25
    v_mfma_f32_16x16x32_bf16 v[212:215], a[172:175], v[36:39], v[212:215]
    ds_read_b128 a[116:119], v1 offset:37696
    v_mfma_f32_16x16x32_bf16 v[216:219], a[176:179], v[32:35], 0
    v_exp_f32 v26, v26
    v_mfma_f32_16x16x32_bf16 v[216:219], a[180:183], v[36:39], v[216:219]
    ds_read_b128 a[120:123], v1 offset:37760
    v_cvt_pk_bf16_f32 v44, v24, v25
    v_mfma_f32_16x16x32_bf16 v[220:223], a[184:187], v[32:35], 0
    v_exp_f32 v27, v27
    v_mfma_f32_16x16x32_bf16 v[220:223], a[188:191], v[36:39], v[220:223]
    ds_read_b128 a[124:127], v1 offset:37824
    v_smfmac_f32_16x16x64_bf16 a[8:11], a[16:19], v[32:39], v11
    s_waitcnt vmcnt(9) lgkmcnt(12)
    s_barrier
.p2align 5
L2_loop:
    v_mfma_f32_16x16x32_bf16 v[16:19], a[64:67], v[64:67], v[48:51]
    s_sub_u32 s47, s47, s48
    v_exp_f32 v28, v28
    v_mfma_f32_16x16x32_bf16 v[16:19], a[68:71], v[68:71], v[16:19]
    v_cvt_pk_bf16_f32 v45, v26, v27
    v_add_u32 v1, s48, v1
    v_mfma_f32_16x16x32_bf16 v[16:19], a[72:75], v[72:75], v[16:19]
    s_add_u32 m0, s47, 0
    v_exp_f32 v29, v29
    v_mfma_f32_16x16x32_bf16 v[16:19], a[76:79], v[76:79], v[16:19]
    s_waitcnt lgkmcnt(8)
    buffer_load_dwordx4 v5, s[16:19], s46 offen offset:0 lds
    v_mfma_f32_16x16x32_bf16 v[20:23], a[80:83], v[64:67], v[48:51]
    v_exp_f32 v30, v30
    v_mfma_f32_16x16x32_bf16 v[20:23], a[84:87], v[68:71], v[20:23]
    v_cvt_pk_bf16_f32 v46, v28, v29
    v_add_u32 v2, s48, v2
    v_mfma_f32_16x16x32_bf16 v[20:23], a[88:91], v[72:75], v[20:23]
    s_add_u32 m0, s47, 32
    v_exp_f32 v31, v31
    v_mfma_f32_16x16x32_bf16 v[20:23], a[92:95], v[76:79], v[20:23]
    s_waitcnt lgkmcnt(4)
    buffer_load_dwordx4 v5, s[16:19], s46 offen offset:1024 lds
    v_mfma_f32_16x16x32_bf16 v[24:27], a[96:99], v[64:67], v[48:51]
    s_sub_u32 s48, 0, s48
    v_exp_f32 v16, v16
    v_mfma_f32_16x16x32_bf16 v[24:27], a[100:103], v[68:71], v[24:27]
    v_cvt_pk_bf16_f32 v47, v30, v31
    v_mfma_f32_16x16x32_bf16 v[24:27], a[104:107], v[72:75], v[24:27]
    s_add_u32 m0, s47, 64
    v_exp_f32 v17, v17
    v_mfma_f32_16x16x32_bf16 v[24:27], a[108:111], v[76:79], v[24:27]
    s_waitcnt lgkmcnt(0)
    buffer_load_dwordx4 v5, s[16:19], s46 offen offset:2048 lds
    v_mfma_f32_16x16x32_bf16 v[28:31], a[112:115], v[64:67], v[48:51]
    v_exp_f32 v18, v18
    v_mfma_f32_16x16x32_bf16 v[28:31], a[116:119], v[68:71], v[28:31]
    v_cvt_pk_bf16_f32 v32, v16, v17
    v_mfma_f32_16x16x32_bf16 v[28:31], a[120:123], v[72:75], v[28:31]
    s_add_u32 m0, s47, 96
    v_exp_f32 v19, v19
    v_mfma_f32_16x16x32_bf16 v[28:31], a[124:127], v[76:79], v[28:31]
    buffer_load_dwordx4 v5, s[16:19], s46 offen offset:3072 lds
    v_mfma_f32_16x16x32_bf16 v[224:227], a[128:131], v[40:43], v[224:227]
    v_exp_f32 v20, v20
    v_mfma_f32_16x16x32_bf16 v[224:227], a[132:135], v[44:47], v[224:227]
    ds_read_b64_tr_b16 a[128:129], v2 offset:0
    v_cvt_pk_bf16_f32 v33, v18, v19
    v_mfma_f32_16x16x32_bf16 v[228:231], a[136:139], v[40:43], v[228:231]
    s_add_u32 m0, s47, 16896
    v_exp_f32 v21, v21
    v_mfma_f32_16x16x32_bf16 v[228:231], a[140:143], v[44:47], v[228:231]
    buffer_load_dwordx4 v5, s[20:23], s46 offen offset:0 lds
    v_mfma_f32_16x16x32_bf16 v[232:235], a[144:147], v[40:43], v[232:235]
    v_exp_f32 v22, v22
    v_mfma_f32_16x16x32_bf16 v[232:235], a[148:151], v[44:47], v[232:235]
    ds_read_b64_tr_b16 a[130:131], v2 offset:256
    v_cvt_pk_bf16_f32 v34, v20, v21
    v_mfma_f32_16x16x32_bf16 v[236:239], a[152:155], v[40:43], v[236:239]
    s_add_u32 m0, s47, 16928
    v_exp_f32 v23, v23
    v_mfma_f32_16x16x32_bf16 v[236:239], a[156:159], v[44:47], v[236:239]
    buffer_load_dwordx4 v5, s[20:23], s46 offen offset:1024 lds
    v_mfma_f32_16x16x32_bf16 v[240:243], a[160:163], v[40:43], v[240:243]
    v_exp_f32 v24, v24
    v_mfma_f32_16x16x32_bf16 v[240:243], a[164:167], v[44:47], v[240:243]
    ds_read_b64_tr_b16 a[132:133], v2 offset:512
    v_cvt_pk_bf16_f32 v35, v22, v23
    v_mfma_f32_16x16x32_bf16 v[244:247], a[168:171], v[40:43], v[244:247]
    s_add_u32 m0, s47, 16960
    v_exp_f32 v25, v25
    v_mfma_f32_16x16x32_bf16 v[244:247], a[172:175], v[44:47], v[244:247]
    buffer_load_dwordx4 v5, s[20:23], s46 offen offset:2048 lds
    v_mfma_f32_16x16x32_bf16 v[248:251], a[176:179], v[40:43], v[248:251]
    v_exp_f32 v26, v26
    v_mfma_f32_16x16x32_bf16 v[248:251], a[180:183], v[44:47], v[248:251]
    ds_read_b64_tr_b16 a[134:135], v2 offset:768
    v_cvt_pk_bf16_f32 v36, v24, v25
    v_mfma_f32_16x16x32_bf16 v[252:255], a[184:187], v[40:43], v[252:255]
    s_add_u32 m0, s47, 16992
    v_exp_f32 v27, v27
    v_mfma_f32_16x16x32_bf16 v[252:255], a[188:191], v[44:47], v[252:255]
    buffer_load_dwordx4 v5, s[20:23], s46 offen offset:3072 lds
    v_smfmac_f32_16x16x64_bf16 a[12:15], a[16:19], v[40:47], v11
    ds_read_b64_tr_b16 a[136:137], v2 offset:32
    v_mfma_f32_16x16x32_bf16 v[16:19], a[64:67], v[80:83], v[52:55]
    v_exp_f32 v28, v28
    v_mfma_f32_16x16x32_bf16 v[16:19], a[68:71], v[84:87], v[16:19]
    ds_read_b64_tr_b16 a[138:139], v2 offset:288
    v_cvt_pk_bf16_f32 v37, v26, v27
    v_mfma_f32_16x16x32_bf16 v[16:19], a[72:75], v[88:91], v[16:19]
    v_exp_f32 v29, v29
    v_mfma_f32_16x16x32_bf16 v[16:19], a[76:79], v[92:95], v[16:19]
    global_load_dword a63, v9, s[98:99]
    v_mfma_f32_16x16x32_bf16 v[20:23], a[80:83], v[80:83], v[52:55]
    v_exp_f32 v30, v30
    v_mfma_f32_16x16x32_bf16 v[20:23], a[84:87], v[84:87], v[20:23]
    ds_read_b64_tr_b16 a[140:141], v2 offset:544
    v_cvt_pk_bf16_f32 v38, v28, v29
    v_mfma_f32_16x16x32_bf16 v[20:23], a[88:91], v[88:91], v[20:23]
    v_exp_f32 v31, v31
    v_mfma_f32_16x16x32_bf16 v[20:23], a[92:95], v[92:95], v[20:23]
    ds_read_b64_tr_b16 a[142:143], v2 offset:800
    v_mfma_f32_16x16x32_bf16 v[24:27], a[96:99], v[80:83], v[52:55]
    v_exp_f32 v16, v16
    v_mfma_f32_16x16x32_bf16 v[24:27], a[100:103], v[84:87], v[24:27]
    ds_read_b64_tr_b16 a[144:145], v2 offset:64
    v_cvt_pk_bf16_f32 v39, v30, v31
    v_mfma_f32_16x16x32_bf16 v[24:27], a[104:107], v[88:91], v[24:27]
    v_exp_f32 v17, v17
    v_mfma_f32_16x16x32_bf16 v[24:27], a[108:111], v[92:95], v[24:27]
    ds_read_b64_tr_b16 a[146:147], v2 offset:320
    v_mfma_f32_16x16x32_bf16 v[28:31], a[112:115], v[80:83], v[52:55]
    v_exp_f32 v18, v18
    v_mfma_f32_16x16x32_bf16 v[28:31], a[116:119], v[84:87], v[28:31]
    ds_read_b64_tr_b16 a[148:149], v2 offset:576
    v_cvt_pk_bf16_f32 v40, v16, v17
    v_mfma_f32_16x16x32_bf16 v[28:31], a[120:123], v[88:91], v[28:31]
    v_exp_f32 v19, v19
    v_mfma_f32_16x16x32_bf16 v[28:31], a[124:127], v[92:95], v[28:31]
    ds_read_b64_tr_b16 a[150:151], v2 offset:832
    v_mfma_f32_16x16x32_bf16 v[128:131], a[192:195], v[32:35], v[128:131]
    v_exp_f32 v20, v20
    v_mfma_f32_16x16x32_bf16 v[128:131], a[196:199], v[36:39], v[128:131]
    ds_read_b64_tr_b16 a[152:153], v2 offset:96
    v_cvt_pk_bf16_f32 v41, v18, v19
    v_mfma_f32_16x16x32_bf16 v[132:135], a[200:203], v[32:35], v[132:135]
    v_exp_f32 v21, v21
    v_mfma_f32_16x16x32_bf16 v[132:135], a[204:207], v[36:39], v[132:135]
    ds_read_b64_tr_b16 a[154:155], v2 offset:352
    v_mfma_f32_16x16x32_bf16 v[136:139], a[208:211], v[32:35], v[136:139]
    v_exp_f32 v22, v22
    v_mfma_f32_16x16x32_bf16 v[136:139], a[212:215], v[36:39], v[136:139]
    ds_read_b64_tr_b16 a[156:157], v2 offset:608
    v_cvt_pk_bf16_f32 v42, v20, v21
    v_mfma_f32_16x16x32_bf16 v[140:143], a[216:219], v[32:35], v[140:143]
    v_exp_f32 v23, v23
    v_mfma_f32_16x16x32_bf16 v[140:143], a[220:223], v[36:39], v[140:143]
    ds_read_b64_tr_b16 a[158:159], v2 offset:864
    v_mfma_f32_16x16x32_bf16 v[144:147], a[224:227], v[32:35], v[144:147]
    v_exp_f32 v24, v24
    v_mfma_f32_16x16x32_bf16 v[144:147], a[228:231], v[36:39], v[144:147]
    ds_read_b64_tr_b16 a[160:161], v2 offset:128
    v_cvt_pk_bf16_f32 v43, v22, v23
    v_mfma_f32_16x16x32_bf16 v[148:151], a[232:235], v[32:35], v[148:151]
    v_exp_f32 v25, v25
    v_mfma_f32_16x16x32_bf16 v[148:151], a[236:239], v[36:39], v[148:151]
    ds_read_b64_tr_b16 a[162:163], v2 offset:384
    v_mfma_f32_16x16x32_bf16 v[152:155], a[240:243], v[32:35], v[152:155]
    v_exp_f32 v26, v26
    v_mfma_f32_16x16x32_bf16 v[152:155], a[244:247], v[36:39], v[152:155]
    ds_read_b64_tr_b16 a[164:165], v2 offset:640
    v_cvt_pk_bf16_f32 v44, v24, v25
    v_mfma_f32_16x16x32_bf16 v[156:159], a[248:251], v[32:35], v[156:159]
    v_exp_f32 v27, v27
    v_mfma_f32_16x16x32_bf16 v[156:159], a[252:255], v[36:39], v[156:159]
    ds_read_b64_tr_b16 a[166:167], v2 offset:896
    v_smfmac_f32_16x16x64_bf16 a[0:3], a[16:19], v[32:39], v11
    ds_read_b64_tr_b16 a[168:169], v2 offset:160
    v_mfma_f32_16x16x32_bf16 v[16:19], a[64:67], v[96:99], v[56:59]
    v_exp_f32 v28, v28
    v_mfma_f32_16x16x32_bf16 v[16:19], a[68:71], v[100:103], v[16:19]
    ds_read_b64_tr_b16 a[170:171], v2 offset:416
    v_cvt_pk_bf16_f32 v45, v26, v27
    v_mfma_f32_16x16x32_bf16 v[16:19], a[72:75], v[104:107], v[16:19]
    v_exp_f32 v29, v29
    v_mfma_f32_16x16x32_bf16 v[16:19], a[76:79], v[108:111], v[16:19]
    ds_read_b64_tr_b16 a[172:173], v2 offset:672
    v_mfma_f32_16x16x32_bf16 v[20:23], a[80:83], v[96:99], v[56:59]
    v_exp_f32 v30, v30
    v_mfma_f32_16x16x32_bf16 v[20:23], a[84:87], v[100:103], v[20:23]
    ds_read_b64_tr_b16 a[174:175], v2 offset:928
    v_cvt_pk_bf16_f32 v46, v28, v29
    v_mfma_f32_16x16x32_bf16 v[20:23], a[88:91], v[104:107], v[20:23]
    v_exp_f32 v31, v31
    v_mfma_f32_16x16x32_bf16 v[20:23], a[92:95], v[108:111], v[20:23]
    ds_read_b64_tr_b16 a[176:177], v2 offset:192
    v_mfma_f32_16x16x32_bf16 v[24:27], a[96:99], v[96:99], v[56:59]
    v_exp_f32 v16, v16
    v_mfma_f32_16x16x32_bf16 v[24:27], a[100:103], v[100:103], v[24:27]
    ds_read_b64_tr_b16 a[178:179], v2 offset:448
    v_cvt_pk_bf16_f32 v47, v30, v31
    v_mfma_f32_16x16x32_bf16 v[24:27], a[104:107], v[104:107], v[24:27]
    v_exp_f32 v17, v17
    v_mfma_f32_16x16x32_bf16 v[24:27], a[108:111], v[108:111], v[24:27]
    ds_read_b64_tr_b16 a[180:181], v2 offset:704
    v_mfma_f32_16x16x32_bf16 v[28:31], a[112:115], v[96:99], v[56:59]
    v_exp_f32 v18, v18
    v_mfma_f32_16x16x32_bf16 v[28:31], a[116:119], v[100:103], v[28:31]
    ds_read_b64_tr_b16 a[182:183], v2 offset:960
    v_cvt_pk_bf16_f32 v32, v16, v17
    v_mfma_f32_16x16x32_bf16 v[28:31], a[120:123], v[104:107], v[28:31]
    v_exp_f32 v19, v19
    v_mfma_f32_16x16x32_bf16 v[28:31], a[124:127], v[108:111], v[28:31]
    ds_read_b64_tr_b16 a[184:185], v2 offset:224
    v_mfma_f32_16x16x32_bf16 v[160:163], a[192:195], v[40:43], v[160:163]
    v_exp_f32 v20, v20
    v_mfma_f32_16x16x32_bf16 v[160:163], a[196:199], v[44:47], v[160:163]
    ds_read_b64_tr_b16 a[186:187], v2 offset:480
    v_cvt_pk_bf16_f32 v33, v18, v19
    v_mfma_f32_16x16x32_bf16 v[164:167], a[200:203], v[40:43], v[164:167]
    v_exp_f32 v21, v21
    v_mfma_f32_16x16x32_bf16 v[164:167], a[204:207], v[44:47], v[164:167]
    ds_read_b64_tr_b16 a[188:189], v2 offset:736
    v_mfma_f32_16x16x32_bf16 v[168:171], a[208:211], v[40:43], v[168:171]
    v_exp_f32 v22, v22
    v_mfma_f32_16x16x32_bf16 v[168:171], a[212:215], v[44:47], v[168:171]
    ds_read_b64_tr_b16 a[190:191], v2 offset:992
    v_cvt_pk_bf16_f32 v34, v20, v21
    v_mfma_f32_16x16x32_bf16 v[172:175], a[216:219], v[40:43], v[172:175]
    v_exp_f32 v23, v23
    v_mfma_f32_16x16x32_bf16 v[172:175], a[220:223], v[44:47], v[172:175]
    v_mfma_f32_16x16x32_bf16 v[176:179], a[224:227], v[40:43], v[176:179]
    v_exp_f32 v24, v24
    v_mfma_f32_16x16x32_bf16 v[176:179], a[228:231], v[44:47], v[176:179]
    v_cvt_pk_bf16_f32 v35, v22, v23
    v_mfma_f32_16x16x32_bf16 v[180:183], a[232:235], v[40:43], v[180:183]
    v_exp_f32 v25, v25
    v_mfma_f32_16x16x32_bf16 v[180:183], a[236:239], v[44:47], v[180:183]
    v_mfma_f32_16x16x32_bf16 v[184:187], a[240:243], v[40:43], v[184:187]
    v_exp_f32 v26, v26
    v_mfma_f32_16x16x32_bf16 v[184:187], a[244:247], v[44:47], v[184:187]
    v_cvt_pk_bf16_f32 v36, v24, v25
    v_mfma_f32_16x16x32_bf16 v[188:191], a[248:251], v[40:43], v[188:191]
    v_exp_f32 v27, v27
    v_mfma_f32_16x16x32_bf16 v[188:191], a[252:255], v[44:47], v[188:191]
    v_smfmac_f32_16x16x64_bf16 a[4:7], a[16:19], v[40:47], v11
    v_mfma_f32_16x16x32_bf16 v[16:19], a[64:67], v[112:115], v[60:63]
    v_exp_f32 v28, v28
    v_mfma_f32_16x16x32_bf16 v[16:19], a[68:71], v[116:119], v[16:19]
    s_add_u32 s46, s46, 16384
    ds_read_b128 a[64:67], v1 offset:0
    v_cvt_pk_bf16_f32 v37, v26, v27
    v_mfma_f32_16x16x32_bf16 v[16:19], a[72:75], v[120:123], v[16:19]
    v_exp_f32 v29, v29
    v_mfma_f32_16x16x32_bf16 v[16:19], a[76:79], v[124:127], v[16:19]
    ds_read_b128 a[68:71], v1 offset:64
    v_mfma_f32_16x16x32_bf16 v[20:23], a[80:83], v[112:115], v[60:63]
    v_exp_f32 v30, v30
    v_mfma_f32_16x16x32_bf16 v[20:23], a[84:87], v[116:119], v[20:23]
    ds_read_b128 a[72:75], v1 offset:128
    v_cvt_pk_bf16_f32 v38, v28, v29
    v_mfma_f32_16x16x32_bf16 v[20:23], a[88:91], v[120:123], v[20:23]
    v_exp_f32 v31, v31
    v_mfma_f32_16x16x32_bf16 v[20:23], a[92:95], v[124:127], v[20:23]
    ds_read_b128 a[76:79], v1 offset:192
    v_mfma_f32_16x16x32_bf16 v[24:27], a[96:99], v[112:115], v[60:63]
    v_exp_f32 v16, v16
    v_mfma_f32_16x16x32_bf16 v[24:27], a[100:103], v[116:119], v[24:27]
    ds_read_b128 a[80:83], v1 offset:256
    v_cvt_pk_bf16_f32 v39, v30, v31
    v_mfma_f32_16x16x32_bf16 v[24:27], a[104:107], v[120:123], v[24:27]
    v_exp_f32 v17, v17
    v_mfma_f32_16x16x32_bf16 v[24:27], a[108:111], v[124:127], v[24:27]
    ds_read_b128 a[84:87], v1 offset:320
    v_mfma_f32_16x16x32_bf16 v[28:31], a[112:115], v[112:115], v[60:63]
    v_exp_f32 v18, v18
    v_mfma_f32_16x16x32_bf16 v[28:31], a[116:119], v[116:119], v[28:31]
    ds_read_b128 a[88:91], v1 offset:384
    v_cvt_pk_bf16_f32 v40, v16, v17
    v_mfma_f32_16x16x32_bf16 v[28:31], a[120:123], v[120:123], v[28:31]
    v_exp_f32 v19, v19
    v_mfma_f32_16x16x32_bf16 v[28:31], a[124:127], v[124:127], v[28:31]
    ds_read_b128 a[92:95], v1 offset:448
    v_mfma_f32_16x16x32_bf16 v[192:195], a[192:195], v[32:35], v[192:195]
    v_exp_f32 v20, v20
    v_mfma_f32_16x16x32_bf16 v[192:195], a[196:199], v[36:39], v[192:195]
    ds_read_b128 a[96:99], v1 offset:512
    v_cvt_pk_bf16_f32 v41, v18, v19
    v_mfma_f32_16x16x32_bf16 v[196:199], a[200:203], v[32:35], v[196:199]
    v_exp_f32 v21, v21
    v_mfma_f32_16x16x32_bf16 v[196:199], a[204:207], v[36:39], v[196:199]
    ds_read_b128 a[100:103], v1 offset:576
    v_mfma_f32_16x16x32_bf16 v[200:203], a[208:211], v[32:35], v[200:203]
    v_exp_f32 v22, v22
    v_mfma_f32_16x16x32_bf16 v[200:203], a[212:215], v[36:39], v[200:203]
    ds_read_b128 a[104:107], v1 offset:640
    v_cvt_pk_bf16_f32 v42, v20, v21
    v_mfma_f32_16x16x32_bf16 v[204:207], a[216:219], v[32:35], v[204:207]
    v_exp_f32 v23, v23
    v_mfma_f32_16x16x32_bf16 v[204:207], a[220:223], v[36:39], v[204:207]
    ds_read_b128 a[108:111], v1 offset:704
    v_mfma_f32_16x16x32_bf16 v[208:211], a[224:227], v[32:35], v[208:211]
    v_exp_f32 v24, v24
    v_mfma_f32_16x16x32_bf16 v[208:211], a[228:231], v[36:39], v[208:211]
    ds_read_b128 a[112:115], v1 offset:768
    v_cvt_pk_bf16_f32 v43, v22, v23
    v_mfma_f32_16x16x32_bf16 v[212:215], a[232:235], v[32:35], v[212:215]
    v_exp_f32 v25, v25
    v_mfma_f32_16x16x32_bf16 v[212:215], a[236:239], v[36:39], v[212:215]
    ds_read_b128 a[116:119], v1 offset:832
    v_mfma_f32_16x16x32_bf16 v[216:219], a[240:243], v[32:35], v[216:219]
    v_exp_f32 v26, v26
    v_mfma_f32_16x16x32_bf16 v[216:219], a[244:247], v[36:39], v[216:219]
    ds_read_b128 a[120:123], v1 offset:896
    v_cvt_pk_bf16_f32 v44, v24, v25
    v_mfma_f32_16x16x32_bf16 v[220:223], a[248:251], v[32:35], v[220:223]
    v_exp_f32 v27, v27
    v_mfma_f32_16x16x32_bf16 v[220:223], a[252:255], v[36:39], v[220:223]
    ds_read_b128 a[124:127], v1 offset:960
    v_smfmac_f32_16x16x64_bf16 a[8:11], a[16:19], v[32:39], v11
    s_waitcnt vmcnt(9) lgkmcnt(12)
    s_barrier
    v_mfma_f32_16x16x32_bf16 v[16:19], a[64:67], v[64:67], v[48:51]
    v_exp_f32 v28, v28
    v_mfma_f32_16x16x32_bf16 v[16:19], a[68:71], v[68:71], v[16:19]
    v_cvt_pk_bf16_f32 v45, v26, v27
    v_mfma_f32_16x16x32_bf16 v[16:19], a[72:75], v[72:75], v[16:19]
    s_add_u32 m0, s47, 36864
    v_exp_f32 v29, v29
    v_mfma_f32_16x16x32_bf16 v[16:19], a[76:79], v[76:79], v[16:19]
    s_waitcnt lgkmcnt(8)
    buffer_load_dwordx4 v5, s[16:19], s46 offen offset:0 lds
    v_mfma_f32_16x16x32_bf16 v[20:23], a[80:83], v[64:67], v[48:51]
    v_exp_f32 v30, v30
    v_mfma_f32_16x16x32_bf16 v[20:23], a[84:87], v[68:71], v[20:23]
    v_cvt_pk_bf16_f32 v46, v28, v29
    v_mfma_f32_16x16x32_bf16 v[20:23], a[88:91], v[72:75], v[20:23]
    s_add_u32 m0, s47, 36896
    v_exp_f32 v31, v31
    v_mfma_f32_16x16x32_bf16 v[20:23], a[92:95], v[76:79], v[20:23]
    s_waitcnt lgkmcnt(4)
    buffer_load_dwordx4 v5, s[16:19], s46 offen offset:1024 lds
    v_mfma_f32_16x16x32_bf16 v[24:27], a[96:99], v[64:67], v[48:51]
    v_exp_f32 v16, v16
    v_mfma_f32_16x16x32_bf16 v[24:27], a[100:103], v[68:71], v[24:27]
    v_cvt_pk_bf16_f32 v47, v30, v31
    v_mfma_f32_16x16x32_bf16 v[24:27], a[104:107], v[72:75], v[24:27]
    s_add_u32 m0, s47, 36928
    v_exp_f32 v17, v17
    v_mfma_f32_16x16x32_bf16 v[24:27], a[108:111], v[76:79], v[24:27]
    s_waitcnt lgkmcnt(0)
    buffer_load_dwordx4 v5, s[16:19], s46 offen offset:2048 lds
    v_mfma_f32_16x16x32_bf16 v[28:31], a[112:115], v[64:67], v[48:51]
    v_exp_f32 v18, v18
    v_mfma_f32_16x16x32_bf16 v[28:31], a[116:119], v[68:71], v[28:31]
    v_cvt_pk_bf16_f32 v32, v16, v17
    v_mfma_f32_16x16x32_bf16 v[28:31], a[120:123], v[72:75], v[28:31]
    s_add_u32 m0, s47, 36960
    v_exp_f32 v19, v19
    v_mfma_f32_16x16x32_bf16 v[28:31], a[124:127], v[76:79], v[28:31]
    buffer_load_dwordx4 v5, s[16:19], s46 offen offset:3072 lds
    v_mfma_f32_16x16x32_bf16 v[224:227], a[192:195], v[40:43], v[224:227]
    v_exp_f32 v20, v20
    v_mfma_f32_16x16x32_bf16 v[224:227], a[196:199], v[44:47], v[224:227]
    ds_read_b64_tr_b16 a[192:193], v2 offset:36864
    v_cvt_pk_bf16_f32 v33, v18, v19
    v_mfma_f32_16x16x32_bf16 v[228:231], a[200:203], v[40:43], v[228:231]
    s_add_u32 m0, s47, 53760
    v_exp_f32 v21, v21
    v_mfma_f32_16x16x32_bf16 v[228:231], a[204:207], v[44:47], v[228:231]
    buffer_load_dwordx4 v5, s[20:23], s46 offen offset:0 lds
    v_mfma_f32_16x16x32_bf16 v[232:235], a[208:211], v[40:43], v[232:235]
    v_exp_f32 v22, v22
    v_mfma_f32_16x16x32_bf16 v[232:235], a[212:215], v[44:47], v[232:235]
    ds_read_b64_tr_b16 a[194:195], v2 offset:37120
    v_cvt_pk_bf16_f32 v34, v20, v21
    v_mfma_f32_16x16x32_bf16 v[236:239], a[216:219], v[40:43], v[236:239]
    s_add_u32 m0, s47, 53792
    v_exp_f32 v23, v23
    v_mfma_f32_16x16x32_bf16 v[236:239], a[220:223], v[44:47], v[236:239]
    buffer_load_dwordx4 v5, s[20:23], s46 offen offset:1024 lds
    v_mfma_f32_16x16x32_bf16 v[240:243], a[224:227], v[40:43], v[240:243]
    v_exp_f32 v24, v24
    v_mfma_f32_16x16x32_bf16 v[240:243], a[228:231], v[44:47], v[240:243]
    ds_read_b64_tr_b16 a[196:197], v2 offset:37376
    v_cvt_pk_bf16_f32 v35, v22, v23
    v_mfma_f32_16x16x32_bf16 v[244:247], a[232:235], v[40:43], v[244:247]
    s_add_u32 m0, s47, 53824
    v_exp_f32 v25, v25
    v_mfma_f32_16x16x32_bf16 v[244:247], a[236:239], v[44:47], v[244:247]
    buffer_load_dwordx4 v5, s[20:23], s46 offen offset:2048 lds
    v_mfma_f32_16x16x32_bf16 v[248:251], a[240:243], v[40:43], v[248:251]
    v_exp_f32 v26, v26
    v_mfma_f32_16x16x32_bf16 v[248:251], a[244:247], v[44:47], v[248:251]
    ds_read_b64_tr_b16 a[198:199], v2 offset:37632
    v_cvt_pk_bf16_f32 v36, v24, v25
    v_mfma_f32_16x16x32_bf16 v[252:255], a[248:251], v[40:43], v[252:255]
    s_add_u32 m0, s47, 53856
    v_exp_f32 v27, v27
    v_mfma_f32_16x16x32_bf16 v[252:255], a[252:255], v[44:47], v[252:255]
    buffer_load_dwordx4 v5, s[20:23], s46 offen offset:3072 lds
    v_smfmac_f32_16x16x64_bf16 a[12:15], a[16:19], v[40:47], v11
    ds_read_b64_tr_b16 a[200:201], v2 offset:36896
    v_mfma_f32_16x16x32_bf16 v[16:19], a[64:67], v[80:83], v[52:55]
    v_exp_f32 v28, v28
    v_mfma_f32_16x16x32_bf16 v[16:19], a[68:71], v[84:87], v[16:19]
    ds_read_b64_tr_b16 a[202:203], v2 offset:37152
    v_cvt_pk_bf16_f32 v37, v26, v27
    v_mfma_f32_16x16x32_bf16 v[16:19], a[72:75], v[88:91], v[16:19]
    v_exp_f32 v29, v29
    v_mfma_f32_16x16x32_bf16 v[16:19], a[76:79], v[92:95], v[16:19]
    ds_read_b64_tr_b16 a[204:205], v2 offset:37408
    v_mfma_f32_16x16x32_bf16 v[20:23], a[80:83], v[80:83], v[52:55]
    v_exp_f32 v30, v30
    v_mfma_f32_16x16x32_bf16 v[20:23], a[84:87], v[84:87], v[20:23]
    ds_read_b64_tr_b16 a[206:207], v2 offset:37664
    v_cvt_pk_bf16_f32 v38, v28, v29
    v_mfma_f32_16x16x32_bf16 v[20:23], a[88:91], v[88:91], v[20:23]
    v_exp_f32 v31, v31
    v_mfma_f32_16x16x32_bf16 v[20:23], a[92:95], v[92:95], v[20:23]
    ds_read_b64_tr_b16 a[208:209], v2 offset:36928
    v_mfma_f32_16x16x32_bf16 v[24:27], a[96:99], v[80:83], v[52:55]
    v_exp_f32 v16, v16
    v_mfma_f32_16x16x32_bf16 v[24:27], a[100:103], v[84:87], v[24:27]
    ds_read_b64_tr_b16 a[210:211], v2 offset:37184
    v_cvt_pk_bf16_f32 v39, v30, v31
    v_mfma_f32_16x16x32_bf16 v[24:27], a[104:107], v[88:91], v[24:27]
    v_exp_f32 v17, v17
    v_mfma_f32_16x16x32_bf16 v[24:27], a[108:111], v[92:95], v[24:27]
    ds_read_b64_tr_b16 a[212:213], v2 offset:37440
    v_mfma_f32_16x16x32_bf16 v[28:31], a[112:115], v[80:83], v[52:55]
    v_exp_f32 v18, v18
    v_mfma_f32_16x16x32_bf16 v[28:31], a[116:119], v[84:87], v[28:31]
    ds_read_b64_tr_b16 a[214:215], v2 offset:37696
    v_cvt_pk_bf16_f32 v40, v16, v17
    v_mfma_f32_16x16x32_bf16 v[28:31], a[120:123], v[88:91], v[28:31]
    v_exp_f32 v19, v19
    v_mfma_f32_16x16x32_bf16 v[28:31], a[124:127], v[92:95], v[28:31]
    ds_read_b64_tr_b16 a[216:217], v2 offset:36960
    v_mfma_f32_16x16x32_bf16 v[128:131], a[128:131], v[32:35], v[128:131]
    v_exp_f32 v20, v20
    v_mfma_f32_16x16x32_bf16 v[128:131], a[132:135], v[36:39], v[128:131]
    ds_read_b64_tr_b16 a[218:219], v2 offset:37216
    v_cvt_pk_bf16_f32 v41, v18, v19
    v_mfma_f32_16x16x32_bf16 v[132:135], a[136:139], v[32:35], v[132:135]
    v_exp_f32 v21, v21
    v_mfma_f32_16x16x32_bf16 v[132:135], a[140:143], v[36:39], v[132:135]
    ds_read_b64_tr_b16 a[220:221], v2 offset:37472
    v_mfma_f32_16x16x32_bf16 v[136:139], a[144:147], v[32:35], v[136:139]
    v_exp_f32 v22, v22
    v_mfma_f32_16x16x32_bf16 v[136:139], a[148:151], v[36:39], v[136:139]
    ds_read_b64_tr_b16 a[222:223], v2 offset:37728
    v_cvt_pk_bf16_f32 v42, v20, v21
    v_mfma_f32_16x16x32_bf16 v[140:143], a[152:155], v[32:35], v[140:143]
    v_exp_f32 v23, v23
    v_mfma_f32_16x16x32_bf16 v[140:143], a[156:159], v[36:39], v[140:143]
    ds_read_b64_tr_b16 a[224:225], v2 offset:36992
    v_mfma_f32_16x16x32_bf16 v[144:147], a[160:163], v[32:35], v[144:147]
    v_exp_f32 v24, v24
    v_mfma_f32_16x16x32_bf16 v[144:147], a[164:167], v[36:39], v[144:147]
    ds_read_b64_tr_b16 a[226:227], v2 offset:37248
    v_cvt_pk_bf16_f32 v43, v22, v23
    v_mfma_f32_16x16x32_bf16 v[148:151], a[168:171], v[32:35], v[148:151]
    v_exp_f32 v25, v25
    v_mfma_f32_16x16x32_bf16 v[148:151], a[172:175], v[36:39], v[148:151]
    ds_read_b64_tr_b16 a[228:229], v2 offset:37504
    v_mfma_f32_16x16x32_bf16 v[152:155], a[176:179], v[32:35], v[152:155]
    v_exp_f32 v26, v26
    v_mfma_f32_16x16x32_bf16 v[152:155], a[180:183], v[36:39], v[152:155]
    ds_read_b64_tr_b16 a[230:231], v2 offset:37760
    v_cvt_pk_bf16_f32 v44, v24, v25
    v_mfma_f32_16x16x32_bf16 v[156:159], a[184:187], v[32:35], v[156:159]
    v_exp_f32 v27, v27
    v_mfma_f32_16x16x32_bf16 v[156:159], a[188:191], v[36:39], v[156:159]
    ds_read_b64_tr_b16 a[232:233], v2 offset:37024
    v_smfmac_f32_16x16x64_bf16 a[0:3], a[16:19], v[32:39], v11
    ds_read_b64_tr_b16 a[234:235], v2 offset:37280
    v_mfma_f32_16x16x32_bf16 v[16:19], a[64:67], v[96:99], v[56:59]
    v_exp_f32 v28, v28
    v_mfma_f32_16x16x32_bf16 v[16:19], a[68:71], v[100:103], v[16:19]
    ds_read_b64_tr_b16 a[236:237], v2 offset:37536
    v_cvt_pk_bf16_f32 v45, v26, v27
    v_mfma_f32_16x16x32_bf16 v[16:19], a[72:75], v[104:107], v[16:19]
    v_exp_f32 v29, v29
    v_mfma_f32_16x16x32_bf16 v[16:19], a[76:79], v[108:111], v[16:19]
    ds_read_b64_tr_b16 a[238:239], v2 offset:37792
    v_mfma_f32_16x16x32_bf16 v[20:23], a[80:83], v[96:99], v[56:59]
    v_exp_f32 v30, v30
    v_mfma_f32_16x16x32_bf16 v[20:23], a[84:87], v[100:103], v[20:23]
    ds_read_b64_tr_b16 a[240:241], v2 offset:37056
    v_cvt_pk_bf16_f32 v46, v28, v29
    v_mfma_f32_16x16x32_bf16 v[20:23], a[88:91], v[104:107], v[20:23]
    v_exp_f32 v31, v31
    v_mfma_f32_16x16x32_bf16 v[20:23], a[92:95], v[108:111], v[20:23]
    ds_read_b64_tr_b16 a[242:243], v2 offset:37312
    v_mfma_f32_16x16x32_bf16 v[24:27], a[96:99], v[96:99], v[56:59]
    v_exp_f32 v16, v16
    v_mfma_f32_16x16x32_bf16 v[24:27], a[100:103], v[100:103], v[24:27]
    ds_read_b64_tr_b16 a[244:245], v2 offset:37568
    v_cvt_pk_bf16_f32 v47, v30, v31
    v_mfma_f32_16x16x32_bf16 v[24:27], a[104:107], v[104:107], v[24:27]
    v_exp_f32 v17, v17
    v_mfma_f32_16x16x32_bf16 v[24:27], a[108:111], v[108:111], v[24:27]
    ds_read_b64_tr_b16 a[246:247], v2 offset:37824
    v_mfma_f32_16x16x32_bf16 v[28:31], a[112:115], v[96:99], v[56:59]
    v_exp_f32 v18, v18
    v_mfma_f32_16x16x32_bf16 v[28:31], a[116:119], v[100:103], v[28:31]
    ds_read_b64_tr_b16 a[248:249], v2 offset:37088
    v_cvt_pk_bf16_f32 v32, v16, v17
    v_mfma_f32_16x16x32_bf16 v[28:31], a[120:123], v[104:107], v[28:31]
    v_exp_f32 v19, v19
    v_mfma_f32_16x16x32_bf16 v[28:31], a[124:127], v[108:111], v[28:31]
    ds_read_b64_tr_b16 a[250:251], v2 offset:37344
    v_mfma_f32_16x16x32_bf16 v[160:163], a[128:131], v[40:43], v[160:163]
    v_exp_f32 v20, v20
    v_mfma_f32_16x16x32_bf16 v[160:163], a[132:135], v[44:47], v[160:163]
    ds_read_b64_tr_b16 a[252:253], v2 offset:37600
    v_cvt_pk_bf16_f32 v33, v18, v19
    v_mfma_f32_16x16x32_bf16 v[164:167], a[136:139], v[40:43], v[164:167]
    v_exp_f32 v21, v21
    v_mfma_f32_16x16x32_bf16 v[164:167], a[140:143], v[44:47], v[164:167]
    ds_read_b64_tr_b16 a[254:255], v2 offset:37856
    v_mfma_f32_16x16x32_bf16 v[168:171], a[144:147], v[40:43], v[168:171]
    v_exp_f32 v22, v22
    v_mfma_f32_16x16x32_bf16 v[168:171], a[148:151], v[44:47], v[168:171]
    v_cvt_pk_bf16_f32 v34, v20, v21
    v_mfma_f32_16x16x32_bf16 v[172:175], a[152:155], v[40:43], v[172:175]
    v_exp_f32 v23, v23
    v_mfma_f32_16x16x32_bf16 v[172:175], a[156:159], v[44:47], v[172:175]
    v_mfma_f32_16x16x32_bf16 v[176:179], a[160:163], v[40:43], v[176:179]
    v_exp_f32 v24, v24
    v_mfma_f32_16x16x32_bf16 v[176:179], a[164:167], v[44:47], v[176:179]
    v_cvt_pk_bf16_f32 v35, v22, v23
    v_mfma_f32_16x16x32_bf16 v[180:183], a[168:171], v[40:43], v[180:183]
    v_exp_f32 v25, v25
    v_mfma_f32_16x16x32_bf16 v[180:183], a[172:175], v[44:47], v[180:183]
    v_mfma_f32_16x16x32_bf16 v[184:187], a[176:179], v[40:43], v[184:187]
    v_exp_f32 v26, v26
    v_mfma_f32_16x16x32_bf16 v[184:187], a[180:183], v[44:47], v[184:187]
    v_cvt_pk_bf16_f32 v36, v24, v25
    v_mfma_f32_16x16x32_bf16 v[188:191], a[184:187], v[40:43], v[188:191]
    v_exp_f32 v27, v27
    v_mfma_f32_16x16x32_bf16 v[188:191], a[188:191], v[44:47], v[188:191]
    v_smfmac_f32_16x16x64_bf16 a[4:7], a[16:19], v[40:47], v11
    v_mfma_f32_16x16x32_bf16 v[16:19], a[64:67], v[112:115], v[60:63]
    v_exp_f32 v28, v28
    v_mfma_f32_16x16x32_bf16 v[16:19], a[68:71], v[116:119], v[16:19]
    s_add_u32 s46, s46, 16384
    ds_read_b128 a[64:67], v1 offset:36864
    v_cvt_pk_bf16_f32 v37, v26, v27
    v_mfma_f32_16x16x32_bf16 v[16:19], a[72:75], v[120:123], v[16:19]
    v_exp_f32 v29, v29
    v_mfma_f32_16x16x32_bf16 v[16:19], a[76:79], v[124:127], v[16:19]
    ds_read_b128 a[68:71], v1 offset:36928
    v_mfma_f32_16x16x32_bf16 v[20:23], a[80:83], v[112:115], v[60:63]
    v_exp_f32 v30, v30
    v_mfma_f32_16x16x32_bf16 v[20:23], a[84:87], v[116:119], v[20:23]
    ds_read_b128 a[72:75], v1 offset:36992
    v_cvt_pk_bf16_f32 v38, v28, v29
    v_mfma_f32_16x16x32_bf16 v[20:23], a[88:91], v[120:123], v[20:23]
    v_exp_f32 v31, v31
    v_mfma_f32_16x16x32_bf16 v[20:23], a[92:95], v[124:127], v[20:23]
    ds_read_b128 a[76:79], v1 offset:37056
    v_mfma_f32_16x16x32_bf16 v[24:27], a[96:99], v[112:115], v[60:63]
    v_exp_f32 v16, v16
    v_mfma_f32_16x16x32_bf16 v[24:27], a[100:103], v[116:119], v[24:27]
    ds_read_b128 a[80:83], v1 offset:37120
    v_cvt_pk_bf16_f32 v39, v30, v31
    v_mfma_f32_16x16x32_bf16 v[24:27], a[104:107], v[120:123], v[24:27]
    v_exp_f32 v17, v17
    v_mfma_f32_16x16x32_bf16 v[24:27], a[108:111], v[124:127], v[24:27]
    ds_read_b128 a[84:87], v1 offset:37184
    v_mfma_f32_16x16x32_bf16 v[28:31], a[112:115], v[112:115], v[60:63]
    v_exp_f32 v18, v18
    v_mfma_f32_16x16x32_bf16 v[28:31], a[116:119], v[116:119], v[28:31]
    ds_read_b128 a[88:91], v1 offset:37248
    v_cvt_pk_bf16_f32 v40, v16, v17
    v_mfma_f32_16x16x32_bf16 v[28:31], a[120:123], v[120:123], v[28:31]
    v_exp_f32 v19, v19
    v_mfma_f32_16x16x32_bf16 v[28:31], a[124:127], v[124:127], v[28:31]
    ds_read_b128 a[92:95], v1 offset:37312
    v_mfma_f32_16x16x32_bf16 v[192:195], a[128:131], v[32:35], v[192:195]
    v_exp_f32 v20, v20
    v_mfma_f32_16x16x32_bf16 v[192:195], a[132:135], v[36:39], v[192:195]
    ds_read_b128 a[96:99], v1 offset:37376
    v_cvt_pk_bf16_f32 v41, v18, v19
    v_mfma_f32_16x16x32_bf16 v[196:199], a[136:139], v[32:35], v[196:199]
    v_exp_f32 v21, v21
    v_mfma_f32_16x16x32_bf16 v[196:199], a[140:143], v[36:39], v[196:199]
    ds_read_b128 a[100:103], v1 offset:37440
    v_mfma_f32_16x16x32_bf16 v[200:203], a[144:147], v[32:35], v[200:203]
    v_exp_f32 v22, v22
    v_mfma_f32_16x16x32_bf16 v[200:203], a[148:151], v[36:39], v[200:203]
    ds_read_b128 a[104:107], v1 offset:37504
    v_cvt_pk_bf16_f32 v42, v20, v21
    v_mfma_f32_16x16x32_bf16 v[204:207], a[152:155], v[32:35], v[204:207]
    v_exp_f32 v23, v23
    v_mfma_f32_16x16x32_bf16 v[204:207], a[156:159], v[36:39], v[204:207]
    ds_read_b128 a[108:111], v1 offset:37568
    v_mfma_f32_16x16x32_bf16 v[208:211], a[160:163], v[32:35], v[208:211]
    v_exp_f32 v24, v24
    v_mfma_f32_16x16x32_bf16 v[208:211], a[164:167], v[36:39], v[208:211]
    ds_read_b128 a[112:115], v1 offset:37632
    v_cvt_pk_bf16_f32 v43, v22, v23
    v_mfma_f32_16x16x32_bf16 v[212:215], a[168:171], v[32:35], v[212:215]
    v_exp_f32 v25, v25
    v_mfma_f32_16x16x32_bf16 v[212:215], a[172:175], v[36:39], v[212:215]
    ds_read_b128 a[116:119], v1 offset:37696
    v_mfma_f32_16x16x32_bf16 v[216:219], a[176:179], v[32:35], v[216:219]
    v_exp_f32 v26, v26
    v_mfma_f32_16x16x32_bf16 v[216:219], a[180:183], v[36:39], v[216:219]
    s_sub_u32 s49, s49, 1
    ds_read_b128 a[120:123], v1 offset:37760
    v_cvt_pk_bf16_f32 v44, v24, v25
    v_mfma_f32_16x16x32_bf16 v[220:223], a[184:187], v[32:35], v[220:223]
    s_cmp_lg_u32 s49, 0
    v_exp_f32 v27, v27
    v_mfma_f32_16x16x32_bf16 v[220:223], a[188:191], v[36:39], v[220:223]
    ds_read_b128 a[124:127], v1 offset:37824
    v_smfmac_f32_16x16x64_bf16 a[8:11], a[16:19], v[32:39], v11
    s_waitcnt vmcnt(9) lgkmcnt(12)
    s_barrier
    s_cbranch_scc1 L2_loop
    v_mfma_f32_16x16x32_bf16 v[16:19], a[64:67], v[64:67], v[48:51]
    s_sub_u32 s47, s47, s48
    v_exp_f32 v28, v28
    v_mfma_f32_16x16x32_bf16 v[16:19], a[68:71], v[68:71], v[16:19]
    v_cvt_pk_bf16_f32 v45, v26, v27
    v_add_u32 v1, s48, v1
    v_mfma_f32_16x16x32_bf16 v[16:19], a[72:75], v[72:75], v[16:19]
    s_add_u32 m0, s47, 0
    v_exp_f32 v29, v29
    v_mfma_f32_16x16x32_bf16 v[16:19], a[76:79], v[76:79], v[16:19]
    s_waitcnt lgkmcnt(8)
    buffer_load_dwordx4 v5, s[16:19], s46 offen offset:0 lds
    v_mfma_f32_16x16x32_bf16 v[20:23], a[80:83], v[64:67], v[48:51]
    v_exp_f32 v30, v30
    v_mfma_f32_16x16x32_bf16 v[20:23], a[84:87], v[68:71], v[20:23]
    v_cvt_pk_bf16_f32 v46, v28, v29
    v_add_u32 v2, s48, v2
    v_mfma_f32_16x16x32_bf16 v[20:23], a[88:91], v[72:75], v[20:23]
    s_add_u32 m0, s47, 32
    v_exp_f32 v31, v31
    v_mfma_f32_16x16x32_bf16 v[20:23], a[92:95], v[76:79], v[20:23]
    s_waitcnt lgkmcnt(4)
    buffer_load_dwordx4 v5, s[16:19], s46 offen offset:1024 lds
    v_mfma_f32_16x16x32_bf16 v[24:27], a[96:99], v[64:67], v[48:51]
    s_sub_u32 s48, 0, s48
    v_exp_f32 v16, v16
    v_mfma_f32_16x16x32_bf16 v[24:27], a[100:103], v[68:71], v[24:27]
    v_cvt_pk_bf16_f32 v47, v30, v31
    v_mfma_f32_16x16x32_bf16 v[24:27], a[104:107], v[72:75], v[24:27]
    s_add_u32 m0, s47, 64
    v_exp_f32 v17, v17
    v_mfma_f32_16x16x32_bf16 v[24:27], a[108:111], v[76:79], v[24:27]
    s_waitcnt lgkmcnt(0)
    buffer_load_dwordx4 v5, s[16:19], s46 offen offset:2048 lds
    v_mfma_f32_16x16x32_bf16 v[28:31], a[112:115], v[64:67], v[48:51]
    v_exp_f32 v18, v18
    v_mfma_f32_16x16x32_bf16 v[28:31], a[116:119], v[68:71], v[28:31]
    v_cvt_pk_bf16_f32 v32, v16, v17
    v_mfma_f32_16x16x32_bf16 v[28:31], a[120:123], v[72:75], v[28:31]
    s_add_u32 m0, s47, 96
    v_exp_f32 v19, v19
    v_mfma_f32_16x16x32_bf16 v[28:31], a[124:127], v[76:79], v[28:31]
    buffer_load_dwordx4 v5, s[16:19], s46 offen offset:3072 lds
    v_mfma_f32_16x16x32_bf16 v[224:227], a[128:131], v[40:43], v[224:227]
    v_exp_f32 v20, v20
    v_mfma_f32_16x16x32_bf16 v[224:227], a[132:135], v[44:47], v[224:227]
    ds_read_b64_tr_b16 a[128:129], v2 offset:0
    v_cvt_pk_bf16_f32 v33, v18, v19
    v_mfma_f32_16x16x32_bf16 v[228:231], a[136:139], v[40:43], v[228:231]
    s_add_u32 m0, s47, 16896
    v_exp_f32 v21, v21
    v_mfma_f32_16x16x32_bf16 v[228:231], a[140:143], v[44:47], v[228:231]
    buffer_load_dwordx4 v5, s[20:23], s46 offen offset:0 lds
    v_mfma_f32_16x16x32_bf16 v[232:235], a[144:147], v[40:43], v[232:235]
    v_exp_f32 v22, v22
    v_mfma_f32_16x16x32_bf16 v[232:235], a[148:151], v[44:47], v[232:235]
    ds_read_b64_tr_b16 a[130:131], v2 offset:256
    v_cvt_pk_bf16_f32 v34, v20, v21
    v_mfma_f32_16x16x32_bf16 v[236:239], a[152:155], v[40:43], v[236:239]
    s_add_u32 m0, s47, 16928
    v_exp_f32 v23, v23
    v_mfma_f32_16x16x32_bf16 v[236:239], a[156:159], v[44:47], v[236:239]
    buffer_load_dwordx4 v5, s[20:23], s46 offen offset:1024 lds
    v_mfma_f32_16x16x32_bf16 v[240:243], a[160:163], v[40:43], v[240:243]
    v_exp_f32 v24, v24
    v_mfma_f32_16x16x32_bf16 v[240:243], a[164:167], v[44:47], v[240:243]
    ds_read_b64_tr_b16 a[132:133], v2 offset:512
    v_cvt_pk_bf16_f32 v35, v22, v23
    v_mfma_f32_16x16x32_bf16 v[244:247], a[168:171], v[40:43], v[244:247]
    s_add_u32 m0, s47, 16960
    v_exp_f32 v25, v25
    v_mfma_f32_16x16x32_bf16 v[244:247], a[172:175], v[44:47], v[244:247]
    buffer_load_dwordx4 v5, s[20:23], s46 offen offset:2048 lds
    v_mfma_f32_16x16x32_bf16 v[248:251], a[176:179], v[40:43], v[248:251]
    v_exp_f32 v26, v26
    v_mfma_f32_16x16x32_bf16 v[248:251], a[180:183], v[44:47], v[248:251]
    ds_read_b64_tr_b16 a[134:135], v2 offset:768
    v_cvt_pk_bf16_f32 v36, v24, v25
    v_mfma_f32_16x16x32_bf16 v[252:255], a[184:187], v[40:43], v[252:255]
    s_add_u32 m0, s47, 16992
    v_exp_f32 v27, v27
    v_mfma_f32_16x16x32_bf16 v[252:255], a[188:191], v[44:47], v[252:255]
    buffer_load_dwordx4 v5, s[20:23], s46 offen offset:3072 lds
    v_smfmac_f32_16x16x64_bf16 a[12:15], a[16:19], v[40:47], v11
    ds_read_b64_tr_b16 a[136:137], v2 offset:32
    v_mfma_f32_16x16x32_bf16 v[16:19], a[64:67], v[80:83], v[52:55]
    v_exp_f32 v28, v28
    v_mfma_f32_16x16x32_bf16 v[16:19], a[68:71], v[84:87], v[16:19]
    ds_read_b64_tr_b16 a[138:139], v2 offset:288
    v_cvt_pk_bf16_f32 v37, v26, v27
    v_mfma_f32_16x16x32_bf16 v[16:19], a[72:75], v[88:91], v[16:19]
    v_exp_f32 v29, v29
    v_mfma_f32_16x16x32_bf16 v[16:19], a[76:79], v[92:95], v[16:19]
    global_load_dword a63, v14, s[10:11]
    v_mfma_f32_16x16x32_bf16 v[20:23], a[80:83], v[80:83], v[52:55]
    v_exp_f32 v30, v30
    v_mfma_f32_16x16x32_bf16 v[20:23], a[84:87], v[84:87], v[20:23]
    ds_read_b64_tr_b16 a[140:141], v2 offset:544
    v_cvt_pk_bf16_f32 v38, v28, v29
    v_mfma_f32_16x16x32_bf16 v[20:23], a[88:91], v[88:91], v[20:23]
    v_exp_f32 v31, v31
    v_mfma_f32_16x16x32_bf16 v[20:23], a[92:95], v[92:95], v[20:23]
    ds_read_b64_tr_b16 a[142:143], v2 offset:800
    v_mfma_f32_16x16x32_bf16 v[24:27], a[96:99], v[80:83], v[52:55]
    v_exp_f32 v16, v16
    v_mfma_f32_16x16x32_bf16 v[24:27], a[100:103], v[84:87], v[24:27]
    ds_read_b64_tr_b16 a[144:145], v2 offset:64
    v_cvt_pk_bf16_f32 v39, v30, v31
    v_mfma_f32_16x16x32_bf16 v[24:27], a[104:107], v[88:91], v[24:27]
    s_mov_b32 s54, 0
    v_exp_f32 v17, v17
    v_mfma_f32_16x16x32_bf16 v[24:27], a[108:111], v[92:95], v[24:27]
    buffer_load_dwordx4 a[20:23], v6, s[64:67], s54 offen
    v_mfma_f32_16x16x32_bf16 v[28:31], a[112:115], v[80:83], v[52:55]
    v_exp_f32 v18, v18
    v_mfma_f32_16x16x32_bf16 v[28:31], a[116:119], v[84:87], v[28:31]
    ds_read_b64_tr_b16 a[146:147], v2 offset:320
    v_cvt_pk_bf16_f32 v40, v16, v17
    v_mfma_f32_16x16x32_bf16 v[28:31], a[120:123], v[88:91], v[28:31]
    v_exp_f32 v19, v19
    v_mfma_f32_16x16x32_bf16 v[28:31], a[124:127], v[92:95], v[28:31]
    ds_read_b64_tr_b16 a[148:149], v2 offset:576
    v_mfma_f32_16x16x32_bf16 v[128:131], a[192:195], v[32:35], v[128:131]
    v_exp_f32 v20, v20
    v_mfma_f32_16x16x32_bf16 v[128:131], a[196:199], v[36:39], v[128:131]
    ds_read_b64_tr_b16 a[150:151], v2 offset:832
    v_cvt_pk_bf16_f32 v41, v18, v19
    v_mfma_f32_16x16x32_bf16 v[132:135], a[200:203], v[32:35], v[132:135]
    s_mov_b32 s54, 147456
    v_exp_f32 v21, v21
    v_mfma_f32_16x16x32_bf16 v[132:135], a[204:207], v[36:39], v[132:135]
    buffer_load_dwordx4 a[24:27], v6, s[64:67], s54 offen
    v_mfma_f32_16x16x32_bf16 v[136:139], a[208:211], v[32:35], v[136:139]
    v_exp_f32 v22, v22
    v_mfma_f32_16x16x32_bf16 v[136:139], a[212:215], v[36:39], v[136:139]
    ds_read_b64_tr_b16 a[152:153], v2 offset:96
    v_cvt_pk_bf16_f32 v42, v20, v21
    v_mfma_f32_16x16x32_bf16 v[140:143], a[216:219], v[32:35], v[140:143]
    v_exp_f32 v23, v23
    v_mfma_f32_16x16x32_bf16 v[140:143], a[220:223], v[36:39], v[140:143]
    ds_read_b64_tr_b16 a[154:155], v2 offset:352
    v_mfma_f32_16x16x32_bf16 v[144:147], a[224:227], v[32:35], v[144:147]
    v_exp_f32 v24, v24
    v_mfma_f32_16x16x32_bf16 v[144:147], a[228:231], v[36:39], v[144:147]
    ds_read_b64_tr_b16 a[156:157], v2 offset:608
    v_cvt_pk_bf16_f32 v43, v22, v23
    v_mfma_f32_16x16x32_bf16 v[148:151], a[232:235], v[32:35], v[148:151]
    s_mov_b32 s54, 294912
    v_exp_f32 v25, v25
    v_mfma_f32_16x16x32_bf16 v[148:151], a[236:239], v[36:39], v[148:151]
    buffer_load_dwordx4 a[28:31], v6, s[64:67], s54 offen
    v_mfma_f32_16x16x32_bf16 v[152:155], a[240:243], v[32:35], v[152:155]
    v_exp_f32 v26, v26
    v_mfma_f32_16x16x32_bf16 v[152:155], a[244:247], v[36:39], v[152:155]
    ds_read_b64_tr_b16 a[158:159], v2 offset:864
    v_cvt_pk_bf16_f32 v44, v24, v25
    v_mfma_f32_16x16x32_bf16 v[156:159], a[248:251], v[32:35], v[156:159]
    v_exp_f32 v27, v27
    v_mfma_f32_16x16x32_bf16 v[156:159], a[252:255], v[36:39], v[156:159]
    ds_read_b64_tr_b16 a[160:161], v2 offset:128
    v_smfmac_f32_16x16x64_bf16 a[0:3], a[16:19], v[32:39], v11
    ds_read_b64_tr_b16 a[162:163], v2 offset:384
    v_mfma_f32_16x16x32_bf16 v[16:19], a[64:67], v[96:99], v[56:59]
    v_exp_f32 v28, v28
    v_mfma_f32_16x16x32_bf16 v[16:19], a[68:71], v[100:103], v[16:19]
    ds_read_b64_tr_b16 a[164:165], v2 offset:640
    v_cvt_pk_bf16_f32 v45, v26, v27
    v_mfma_f32_16x16x32_bf16 v[16:19], a[72:75], v[104:107], v[16:19]
    v_exp_f32 v29, v29
    v_mfma_f32_16x16x32_bf16 v[16:19], a[76:79], v[108:111], v[16:19]
    ds_read_b64_tr_b16 a[166:167], v2 offset:896
    v_mfma_f32_16x16x32_bf16 v[20:23], a[80:83], v[96:99], v[56:59]
    v_exp_f32 v30, v30
    v_mfma_f32_16x16x32_bf16 v[20:23], a[84:87], v[100:103], v[20:23]
    ds_read_b64_tr_b16 a[168:169], v2 offset:160
    v_cvt_pk_bf16_f32 v46, v28, v29
    v_mfma_f32_16x16x32_bf16 v[20:23], a[88:91], v[104:107], v[20:23]
    v_exp_f32 v31, v31
    v_mfma_f32_16x16x32_bf16 v[20:23], a[92:95], v[108:111], v[20:23]
    ds_read_b64_tr_b16 a[170:171], v2 offset:416
    v_mfma_f32_16x16x32_bf16 v[24:27], a[96:99], v[96:99], v[56:59]
    v_exp_f32 v16, v16
    v_mfma_f32_16x16x32_bf16 v[24:27], a[100:103], v[100:103], v[24:27]
    ds_read_b64_tr_b16 a[172:173], v2 offset:672
    v_cvt_pk_bf16_f32 v47, v30, v31
    v_mfma_f32_16x16x32_bf16 v[24:27], a[104:107], v[104:107], v[24:27]
    v_exp_f32 v17, v17
    v_mfma_f32_16x16x32_bf16 v[24:27], a[108:111], v[108:111], v[24:27]
    ds_read_b64_tr_b16 a[174:175], v2 offset:928
    v_mfma_f32_16x16x32_bf16 v[28:31], a[112:115], v[96:99], v[56:59]
    v_exp_f32 v18, v18
    v_mfma_f32_16x16x32_bf16 v[28:31], a[116:119], v[100:103], v[28:31]
    ds_read_b64_tr_b16 a[176:177], v2 offset:192
    v_cvt_pk_bf16_f32 v32, v16, v17
    v_mfma_f32_16x16x32_bf16 v[28:31], a[120:123], v[104:107], v[28:31]
    v_exp_f32 v19, v19
    v_mfma_f32_16x16x32_bf16 v[28:31], a[124:127], v[108:111], v[28:31]
    ds_read_b64_tr_b16 a[178:179], v2 offset:448
    v_mfma_f32_16x16x32_bf16 v[160:163], a[192:195], v[40:43], v[160:163]
    v_exp_f32 v20, v20
    v_mfma_f32_16x16x32_bf16 v[160:163], a[196:199], v[44:47], v[160:163]
    ds_read_b64_tr_b16 a[180:181], v2 offset:704
    v_cvt_pk_bf16_f32 v33, v18, v19
    v_mfma_f32_16x16x32_bf16 v[164:167], a[200:203], v[40:43], v[164:167]
    v_exp_f32 v21, v21
    v_mfma_f32_16x16x32_bf16 v[164:167], a[204:207], v[44:47], v[164:167]
    ds_read_b64_tr_b16 a[182:183], v2 offset:960
    v_mfma_f32_16x16x32_bf16 v[168:171], a[208:211], v[40:43], v[168:171]
    v_exp_f32 v22, v22
    v_mfma_f32_16x16x32_bf16 v[168:171], a[212:215], v[44:47], v[168:171]
    ds_read_b64_tr_b16 a[184:185], v2 offset:224
    v_cvt_pk_bf16_f32 v34, v20, v21
    v_mfma_f32_16x16x32_bf16 v[172:175], a[216:219], v[40:43], v[172:175]
    v_exp_f32 v23, v23
    v_mfma_f32_16x16x32_bf16 v[172:175], a[220:223], v[44:47], v[172:175]
    ds_read_b64_tr_b16 a[186:187], v2 offset:480
    v_mfma_f32_16x16x32_bf16 v[176:179], a[224:227], v[40:43], v[176:179]
    v_exp_f32 v24, v24
    v_mfma_f32_16x16x32_bf16 v[176:179], a[228:231], v[44:47], v[176:179]
    ds_read_b64_tr_b16 a[188:189], v2 offset:736
    v_cvt_pk_bf16_f32 v35, v22, v23
    v_mfma_f32_16x16x32_bf16 v[180:183], a[232:235], v[40:43], v[180:183]
    v_exp_f32 v25, v25
    v_mfma_f32_16x16x32_bf16 v[180:183], a[236:239], v[44:47], v[180:183]
    ds_read_b64_tr_b16 a[190:191], v2 offset:992
    v_mfma_f32_16x16x32_bf16 v[184:187], a[240:243], v[40:43], v[184:187]
    v_exp_f32 v26, v26
    v_mfma_f32_16x16x32_bf16 v[184:187], a[244:247], v[44:47], v[184:187]
    v_cvt_pk_bf16_f32 v36, v24, v25
    v_mfma_f32_16x16x32_bf16 v[188:191], a[248:251], v[40:43], v[188:191]
    v_exp_f32 v27, v27
    v_mfma_f32_16x16x32_bf16 v[188:191], a[252:255], v[44:47], v[188:191]
    v_smfmac_f32_16x16x64_bf16 a[4:7], a[16:19], v[40:47], v11
    v_mfma_f32_16x16x32_bf16 v[16:19], a[64:67], v[112:115], v[60:63]
    v_exp_f32 v28, v28
    v_mfma_f32_16x16x32_bf16 v[16:19], a[68:71], v[116:119], v[16:19]
    s_add_u32 s46, s46, 16384
    ds_read_b128 a[64:67], v1 offset:0
    v_cvt_pk_bf16_f32 v37, v26, v27
    v_mfma_f32_16x16x32_bf16 v[16:19], a[72:75], v[120:123], v[16:19]
    v_exp_f32 v29, v29
    v_mfma_f32_16x16x32_bf16 v[16:19], a[76:79], v[124:127], v[16:19]
    ds_read_b128 a[68:71], v1 offset:64
    v_mfma_f32_16x16x32_bf16 v[20:23], a[80:83], v[112:115], v[60:63]
    v_exp_f32 v30, v30
    v_mfma_f32_16x16x32_bf16 v[20:23], a[84:87], v[116:119], v[20:23]
    ds_read_b128 a[72:75], v1 offset:128
    v_cvt_pk_bf16_f32 v38, v28, v29
    v_mfma_f32_16x16x32_bf16 v[20:23], a[88:91], v[120:123], v[20:23]
    v_exp_f32 v31, v31
    v_mfma_f32_16x16x32_bf16 v[20:23], a[92:95], v[124:127], v[20:23]
    ds_read_b128 a[76:79], v1 offset:192
    v_mfma_f32_16x16x32_bf16 v[24:27], a[96:99], v[112:115], v[60:63]
    v_exp_f32 v16, v16
    v_mfma_f32_16x16x32_bf16 v[24:27], a[100:103], v[116:119], v[24:27]
    ds_read_b128 a[80:83], v1 offset:256
    v_cvt_pk_bf16_f32 v39, v30, v31
    v_mfma_f32_16x16x32_bf16 v[24:27], a[104:107], v[120:123], v[24:27]
    v_exp_f32 v17, v17
    v_mfma_f32_16x16x32_bf16 v[24:27], a[108:111], v[124:127], v[24:27]
    ds_read_b128 a[84:87], v1 offset:320
    v_mfma_f32_16x16x32_bf16 v[28:31], a[112:115], v[112:115], v[60:63]
    v_exp_f32 v18, v18
    v_mfma_f32_16x16x32_bf16 v[28:31], a[116:119], v[116:119], v[28:31]
    ds_read_b128 a[88:91], v1 offset:384
    v_cvt_pk_bf16_f32 v40, v16, v17
    v_mfma_f32_16x16x32_bf16 v[28:31], a[120:123], v[120:123], v[28:31]
    v_exp_f32 v19, v19
    v_mfma_f32_16x16x32_bf16 v[28:31], a[124:127], v[124:127], v[28:31]
    ds_read_b128 a[92:95], v1 offset:448
    v_mfma_f32_16x16x32_bf16 v[192:195], a[192:195], v[32:35], v[192:195]
    v_exp_f32 v20, v20
    v_mfma_f32_16x16x32_bf16 v[192:195], a[196:199], v[36:39], v[192:195]
    ds_read_b128 a[96:99], v1 offset:512
    v_cvt_pk_bf16_f32 v41, v18, v19
    v_mfma_f32_16x16x32_bf16 v[196:199], a[200:203], v[32:35], v[196:199]
    v_exp_f32 v21, v21
    v_mfma_f32_16x16x32_bf16 v[196:199], a[204:207], v[36:39], v[196:199]
    ds_read_b128 a[100:103], v1 offset:576
    v_mfma_f32_16x16x32_bf16 v[200:203], a[208:211], v[32:35], v[200:203]
    v_exp_f32 v22, v22
    v_mfma_f32_16x16x32_bf16 v[200:203], a[212:215], v[36:39], v[200:203]
    ds_read_b128 a[104:107], v1 offset:640
    v_cvt_pk_bf16_f32 v42, v20, v21
    v_mfma_f32_16x16x32_bf16 v[204:207], a[216:219], v[32:35], v[204:207]
    v_exp_f32 v23, v23
    v_mfma_f32_16x16x32_bf16 v[204:207], a[220:223], v[36:39], v[204:207]
    ds_read_b128 a[108:111], v1 offset:704
    v_mfma_f32_16x16x32_bf16 v[208:211], a[224:227], v[32:35], v[208:211]
    v_exp_f32 v24, v24
    v_mfma_f32_16x16x32_bf16 v[208:211], a[228:231], v[36:39], v[208:211]
    ds_read_b128 a[112:115], v1 offset:768
    v_cvt_pk_bf16_f32 v43, v22, v23
    v_mfma_f32_16x16x32_bf16 v[212:215], a[232:235], v[32:35], v[212:215]
    v_exp_f32 v25, v25
    v_mfma_f32_16x16x32_bf16 v[212:215], a[236:239], v[36:39], v[212:215]
    ds_read_b128 a[116:119], v1 offset:832
    v_mfma_f32_16x16x32_bf16 v[216:219], a[240:243], v[32:35], v[216:219]
    v_exp_f32 v26, v26
    v_mfma_f32_16x16x32_bf16 v[216:219], a[244:247], v[36:39], v[216:219]
    ds_read_b128 a[120:123], v1 offset:896
    v_cvt_pk_bf16_f32 v44, v24, v25
    v_mfma_f32_16x16x32_bf16 v[220:223], a[248:251], v[32:35], v[220:223]
    v_exp_f32 v27, v27
    v_mfma_f32_16x16x32_bf16 v[220:223], a[252:255], v[36:39], v[220:223]
    ds_read_b128 a[124:127], v1 offset:960
    v_smfmac_f32_16x16x64_bf16 a[8:11], a[16:19], v[32:39], v11
    s_waitcnt vmcnt(12) lgkmcnt(12)
    s_barrier
    v_mfma_f32_16x16x32_bf16 v[16:19], a[64:67], v[64:67], v[48:51]
    v_exp_f32 v28, v28
    v_mfma_f32_16x16x32_bf16 v[16:19], a[68:71], v[68:71], v[16:19]
    v_cvt_pk_bf16_f32 v45, v26, v27
    v_mfma_f32_16x16x32_bf16 v[16:19], a[72:75], v[72:75], v[16:19]
    s_add_u32 m0, s47, 36864
    v_exp_f32 v29, v29
    v_mfma_f32_16x16x32_bf16 v[16:19], a[76:79], v[76:79], v[16:19]
    s_waitcnt lgkmcnt(8)
    buffer_load_dwordx4 v5, s[16:19], s46 offen offset:0 lds
    v_mfma_f32_16x16x32_bf16 v[20:23], a[80:83], v[64:67], v[48:51]
    v_exp_f32 v30, v30
    v_mfma_f32_16x16x32_bf16 v[20:23], a[84:87], v[68:71], v[20:23]
    v_cvt_pk_bf16_f32 v46, v28, v29
    v_mfma_f32_16x16x32_bf16 v[20:23], a[88:91], v[72:75], v[20:23]
    s_add_u32 m0, s47, 36896
    v_exp_f32 v31, v31
    v_mfma_f32_16x16x32_bf16 v[20:23], a[92:95], v[76:79], v[20:23]
    s_waitcnt lgkmcnt(4)
    buffer_load_dwordx4 v5, s[16:19], s46 offen offset:1024 lds
    v_mfma_f32_16x16x32_bf16 v[24:27], a[96:99], v[64:67], v[48:51]
    v_exp_f32 v16, v16
    v_mfma_f32_16x16x32_bf16 v[24:27], a[100:103], v[68:71], v[24:27]
    v_cvt_pk_bf16_f32 v47, v30, v31
    v_mfma_f32_16x16x32_bf16 v[24:27], a[104:107], v[72:75], v[24:27]
    s_add_u32 m0, s47, 36928
    v_exp_f32 v17, v17
    v_mfma_f32_16x16x32_bf16 v[24:27], a[108:111], v[76:79], v[24:27]
    s_waitcnt lgkmcnt(0)
    buffer_load_dwordx4 v5, s[16:19], s46 offen offset:2048 lds
    v_mfma_f32_16x16x32_bf16 v[28:31], a[112:115], v[64:67], v[48:51]
    v_exp_f32 v18, v18
    v_mfma_f32_16x16x32_bf16 v[28:31], a[116:119], v[68:71], v[28:31]
    v_cvt_pk_bf16_f32 v32, v16, v17
    v_mfma_f32_16x16x32_bf16 v[28:31], a[120:123], v[72:75], v[28:31]
    s_add_u32 m0, s47, 36960
    v_exp_f32 v19, v19
    v_mfma_f32_16x16x32_bf16 v[28:31], a[124:127], v[76:79], v[28:31]
    buffer_load_dwordx4 v5, s[16:19], s46 offen offset:3072 lds
    v_mfma_f32_16x16x32_bf16 v[224:227], a[192:195], v[40:43], v[224:227]
    v_exp_f32 v20, v20
    v_mfma_f32_16x16x32_bf16 v[224:227], a[196:199], v[44:47], v[224:227]
    ds_read_b64_tr_b16 a[192:193], v2 offset:36864
    v_cvt_pk_bf16_f32 v33, v18, v19
    v_mfma_f32_16x16x32_bf16 v[228:231], a[200:203], v[40:43], v[228:231]
    s_add_u32 m0, s47, 53760
    v_exp_f32 v21, v21
    v_mfma_f32_16x16x32_bf16 v[228:231], a[204:207], v[44:47], v[228:231]
    buffer_load_dwordx4 v5, s[20:23], s46 offen offset:0 lds
    v_mfma_f32_16x16x32_bf16 v[232:235], a[208:211], v[40:43], v[232:235]
    v_exp_f32 v22, v22
    v_mfma_f32_16x16x32_bf16 v[232:235], a[212:215], v[44:47], v[232:235]
    ds_read_b64_tr_b16 a[194:195], v2 offset:37120
    v_cvt_pk_bf16_f32 v34, v20, v21
    v_mfma_f32_16x16x32_bf16 v[236:239], a[216:219], v[40:43], v[236:239]
    s_add_u32 m0, s47, 53792
    v_exp_f32 v23, v23
    v_mfma_f32_16x16x32_bf16 v[236:239], a[220:223], v[44:47], v[236:239]
    buffer_load_dwordx4 v5, s[20:23], s46 offen offset:1024 lds
    v_mfma_f32_16x16x32_bf16 v[240:243], a[224:227], v[40:43], v[240:243]
    v_exp_f32 v24, v24
    v_mfma_f32_16x16x32_bf16 v[240:243], a[228:231], v[44:47], v[240:243]
    ds_read_b64_tr_b16 a[196:197], v2 offset:37376
    v_cvt_pk_bf16_f32 v35, v22, v23
    v_mfma_f32_16x16x32_bf16 v[244:247], a[232:235], v[40:43], v[244:247]
    s_add_u32 m0, s47, 53824
    v_exp_f32 v25, v25
    v_mfma_f32_16x16x32_bf16 v[244:247], a[236:239], v[44:47], v[244:247]
    buffer_load_dwordx4 v5, s[20:23], s46 offen offset:2048 lds
    v_mfma_f32_16x16x32_bf16 v[248:251], a[240:243], v[40:43], v[248:251]
    v_exp_f32 v26, v26
    v_mfma_f32_16x16x32_bf16 v[248:251], a[244:247], v[44:47], v[248:251]
    ds_read_b64_tr_b16 a[198:199], v2 offset:37632
    v_cvt_pk_bf16_f32 v36, v24, v25
    v_mfma_f32_16x16x32_bf16 v[252:255], a[248:251], v[40:43], v[252:255]
    s_add_u32 m0, s47, 53856
    v_exp_f32 v27, v27
    v_mfma_f32_16x16x32_bf16 v[252:255], a[252:255], v[44:47], v[252:255]
    buffer_load_dwordx4 v5, s[20:23], s46 offen offset:3072 lds
    v_smfmac_f32_16x16x64_bf16 a[12:15], a[16:19], v[40:47], v11
    ds_read_b64_tr_b16 a[200:201], v2 offset:36896
    v_mfma_f32_16x16x32_bf16 v[16:19], a[64:67], v[80:83], v[52:55]
    v_exp_f32 v28, v28
    v_mfma_f32_16x16x32_bf16 v[16:19], a[68:71], v[84:87], v[16:19]
    ds_read_b64_tr_b16 a[202:203], v2 offset:37152
    v_cvt_pk_bf16_f32 v37, v26, v27
    v_mfma_f32_16x16x32_bf16 v[16:19], a[72:75], v[88:91], v[16:19]
    v_exp_f32 v29, v29
    v_mfma_f32_16x16x32_bf16 v[16:19], a[76:79], v[92:95], v[16:19]
    global_load_dword a63, v15, s[10:11]
    v_mfma_f32_16x16x32_bf16 v[20:23], a[80:83], v[80:83], v[52:55]
    v_exp_f32 v30, v30
    v_mfma_f32_16x16x32_bf16 v[20:23], a[84:87], v[84:87], v[20:23]
    ds_read_b64_tr_b16 a[204:205], v2 offset:37408
    v_cvt_pk_bf16_f32 v38, v28, v29
    v_mfma_f32_16x16x32_bf16 v[20:23], a[88:91], v[88:91], v[20:23]
    v_exp_f32 v31, v31
    v_mfma_f32_16x16x32_bf16 v[20:23], a[92:95], v[92:95], v[20:23]
    ds_read_b64_tr_b16 a[206:207], v2 offset:37664
    v_mfma_f32_16x16x32_bf16 v[24:27], a[96:99], v[80:83], v[52:55]
    v_exp_f32 v16, v16
    v_mfma_f32_16x16x32_bf16 v[24:27], a[100:103], v[84:87], v[24:27]
    ds_read_b64_tr_b16 a[208:209], v2 offset:36928
    v_cvt_pk_bf16_f32 v39, v30, v31
    v_mfma_f32_16x16x32_bf16 v[24:27], a[104:107], v[88:91], v[24:27]
    s_mov_b32 s54, 442368
    v_exp_f32 v17, v17
    v_mfma_f32_16x16x32_bf16 v[24:27], a[108:111], v[92:95], v[24:27]
    buffer_load_dwordx4 a[32:35], v6, s[64:67], s54 offen
    v_mfma_f32_16x16x32_bf16 v[28:31], a[112:115], v[80:83], v[52:55]
    v_exp_f32 v18, v18
    v_mfma_f32_16x16x32_bf16 v[28:31], a[116:119], v[84:87], v[28:31]
    ds_read_b64_tr_b16 a[210:211], v2 offset:37184
    v_cvt_pk_bf16_f32 v40, v16, v17
    v_mfma_f32_16x16x32_bf16 v[28:31], a[120:123], v[88:91], v[28:31]
    v_exp_f32 v19, v19
    v_mfma_f32_16x16x32_bf16 v[28:31], a[124:127], v[92:95], v[28:31]
    ds_read_b64_tr_b16 a[212:213], v2 offset:37440
    v_mfma_f32_16x16x32_bf16 v[128:131], a[128:131], v[32:35], v[128:131]
    v_exp_f32 v20, v20
    v_mfma_f32_16x16x32_bf16 v[128:131], a[132:135], v[36:39], v[128:131]
    ds_read_b64_tr_b16 a[214:215], v2 offset:37696
    v_cvt_pk_bf16_f32 v41, v18, v19
    v_mfma_f32_16x16x32_bf16 v[132:135], a[136:139], v[32:35], v[132:135]
    s_mov_b32 s54, 589824
    v_exp_f32 v21, v21
    v_mfma_f32_16x16x32_bf16 v[132:135], a[140:143], v[36:39], v[132:135]
    buffer_load_dwordx4 a[36:39], v6, s[64:67], s54 offen
    v_mfma_f32_16x16x32_bf16 v[136:139], a[144:147], v[32:35], v[136:139]
    v_exp_f32 v22, v22
    v_mfma_f32_16x16x32_bf16 v[136:139], a[148:151], v[36:39], v[136:139]
    ds_read_b64_tr_b16 a[216:217], v2 offset:36960
    v_cvt_pk_bf16_f32 v42, v20, v21
    v_mfma_f32_16x16x32_bf16 v[140:143], a[152:155], v[32:35], v[140:143]
    v_exp_f32 v23, v23
    v_mfma_f32_16x16x32_bf16 v[140:143], a[156:159], v[36:39], v[140:143]
    ds_read_b64_tr_b16 a[218:219], v2 offset:37216
    v_mfma_f32_16x16x32_bf16 v[144:147], a[160:163], v[32:35], v[144:147]
    v_exp_f32 v24, v24
    v_mfma_f32_16x16x32_bf16 v[144:147], a[164:167], v[36:39], v[144:147]
    ds_read_b64_tr_b16 a[220:221], v2 offset:37472
    v_cvt_pk_bf16_f32 v43, v22, v23
    v_mfma_f32_16x16x32_bf16 v[148:151], a[168:171], v[32:35], v[148:151]
    s_mov_b32 s54, 737280
    v_exp_f32 v25, v25
    v_mfma_f32_16x16x32_bf16 v[148:151], a[172:175], v[36:39], v[148:151]
    buffer_load_dwordx4 a[40:43], v6, s[64:67], s54 offen
    v_mfma_f32_16x16x32_bf16 v[152:155], a[176:179], v[32:35], v[152:155]
    v_exp_f32 v26, v26
    v_mfma_f32_16x16x32_bf16 v[152:155], a[180:183], v[36:39], v[152:155]
    ds_read_b64_tr_b16 a[222:223], v2 offset:37728
    v_cvt_pk_bf16_f32 v44, v24, v25
    v_mfma_f32_16x16x32_bf16 v[156:159], a[184:187], v[32:35], v[156:159]
    v_exp_f32 v27, v27
    v_mfma_f32_16x16x32_bf16 v[156:159], a[188:191], v[36:39], v[156:159]
    ds_read_b64_tr_b16 a[224:225], v2 offset:36992
    v_smfmac_f32_16x16x64_bf16 a[0:3], a[16:19], v[32:39], v11
    ds_read_b64_tr_b16 a[226:227], v2 offset:37248
    v_mfma_f32_16x16x32_bf16 v[16:19], a[64:67], v[96:99], v[56:59]
    v_exp_f32 v28, v28
    v_mfma_f32_16x16x32_bf16 v[16:19], a[68:71], v[100:103], v[16:19]
    ds_read_b64_tr_b16 a[228:229], v2 offset:37504
    v_cvt_pk_bf16_f32 v45, v26, v27
    v_mfma_f32_16x16x32_bf16 v[16:19], a[72:75], v[104:107], v[16:19]
    v_exp_f32 v29, v29
    v_mfma_f32_16x16x32_bf16 v[16:19], a[76:79], v[108:111], v[16:19]
    ds_read_b64_tr_b16 a[230:231], v2 offset:37760
    v_mfma_f32_16x16x32_bf16 v[20:23], a[80:83], v[96:99], v[56:59]
    v_exp_f32 v30, v30
    v_mfma_f32_16x16x32_bf16 v[20:23], a[84:87], v[100:103], v[20:23]
    ds_read_b64_tr_b16 a[232:233], v2 offset:37024
    v_cvt_pk_bf16_f32 v46, v28, v29
    v_mfma_f32_16x16x32_bf16 v[20:23], a[88:91], v[104:107], v[20:23]
    v_exp_f32 v31, v31
    v_mfma_f32_16x16x32_bf16 v[20:23], a[92:95], v[108:111], v[20:23]
    ds_read_b64_tr_b16 a[234:235], v2 offset:37280
    v_mfma_f32_16x16x32_bf16 v[24:27], a[96:99], v[96:99], v[56:59]
    v_exp_f32 v16, v16
    v_mfma_f32_16x16x32_bf16 v[24:27], a[100:103], v[100:103], v[24:27]
    ds_read_b64_tr_b16 a[236:237], v2 offset:37536
    v_cvt_pk_bf16_f32 v47, v30, v31
    v_mfma_f32_16x16x32_bf16 v[24:27], a[104:107], v[104:107], v[24:27]
    v_exp_f32 v17, v17
    v_mfma_f32_16x16x32_bf16 v[24:27], a[108:111], v[108:111], v[24:27]
    ds_read_b64_tr_b16 a[238:239], v2 offset:37792
    v_mfma_f32_16x16x32_bf16 v[28:31], a[112:115], v[96:99], v[56:59]
    v_exp_f32 v18, v18
    v_mfma_f32_16x16x32_bf16 v[28:31], a[116:119], v[100:103], v[28:31]
    ds_read_b64_tr_b16 a[240:241], v2 offset:37056
    v_cvt_pk_bf16_f32 v32, v16, v17
    v_mfma_f32_16x16x32_bf16 v[28:31], a[120:123], v[104:107], v[28:31]
    v_exp_f32 v19, v19
    v_mfma_f32_16x16x32_bf16 v[28:31], a[124:127], v[108:111], v[28:31]
    ds_read_b64_tr_b16 a[242:243], v2 offset:37312
    v_mfma_f32_16x16x32_bf16 v[160:163], a[128:131], v[40:43], v[160:163]
    v_exp_f32 v20, v20
    v_mfma_f32_16x16x32_bf16 v[160:163], a[132:135], v[44:47], v[160:163]
    ds_read_b64_tr_b16 a[244:245], v2 offset:37568
    v_cvt_pk_bf16_f32 v33, v18, v19
    v_mfma_f32_16x16x32_bf16 v[164:167], a[136:139], v[40:43], v[164:167]
    v_exp_f32 v21, v21
    v_mfma_f32_16x16x32_bf16 v[164:167], a[140:143], v[44:47], v[164:167]
    ds_read_b64_tr_b16 a[246:247], v2 offset:37824
    v_mfma_f32_16x16x32_bf16 v[168:171], a[144:147], v[40:43], v[168:171]
    v_exp_f32 v22, v22
    v_mfma_f32_16x16x32_bf16 v[168:171], a[148:151], v[44:47], v[168:171]
    ds_read_b64_tr_b16 a[248:249], v2 offset:37088
    v_cvt_pk_bf16_f32 v34, v20, v21
    v_mfma_f32_16x16x32_bf16 v[172:175], a[152:155], v[40:43], v[172:175]
    v_exp_f32 v23, v23
    v_mfma_f32_16x16x32_bf16 v[172:175], a[156:159], v[44:47], v[172:175]
    ds_read_b64_tr_b16 a[250:251], v2 offset:37344
    v_mfma_f32_16x16x32_bf16 v[176:179], a[160:163], v[40:43], v[176:179]
    v_exp_f32 v24, v24
    v_mfma_f32_16x16x32_bf16 v[176:179], a[164:167], v[44:47], v[176:179]
    ds_read_b64_tr_b16 a[252:253], v2 offset:37600
    v_cvt_pk_bf16_f32 v35, v22, v23
    v_mfma_f32_16x16x32_bf16 v[180:183], a[168:171], v[40:43], v[180:183]
    v_exp_f32 v25, v25
    v_mfma_f32_16x16x32_bf16 v[180:183], a[172:175], v[44:47], v[180:183]
    ds_read_b64_tr_b16 a[254:255], v2 offset:37856
    v_mfma_f32_16x16x32_bf16 v[184:187], a[176:179], v[40:43], v[184:187]
    v_exp_f32 v26, v26
    v_mfma_f32_16x16x32_bf16 v[184:187], a[180:183], v[44:47], v[184:187]
    v_cvt_pk_bf16_f32 v36, v24, v25
    v_mfma_f32_16x16x32_bf16 v[188:191], a[184:187], v[40:43], v[188:191]
    v_exp_f32 v27, v27
    v_mfma_f32_16x16x32_bf16 v[188:191], a[188:191], v[44:47], v[188:191]
    v_smfmac_f32_16x16x64_bf16 a[4:7], a[16:19], v[40:47], v11
    v_mfma_f32_16x16x32_bf16 v[16:19], a[64:67], v[112:115], v[60:63]
    v_exp_f32 v28, v28
    v_mfma_f32_16x16x32_bf16 v[16:19], a[68:71], v[116:119], v[16:19]
    s_add_u32 s46, s46, 16384
    ds_read_b128 a[64:67], v1 offset:36864
    v_cvt_pk_bf16_f32 v37, v26, v27
    v_mfma_f32_16x16x32_bf16 v[16:19], a[72:75], v[120:123], v[16:19]
    v_exp_f32 v29, v29
    v_mfma_f32_16x16x32_bf16 v[16:19], a[76:79], v[124:127], v[16:19]
    ds_read_b128 a[68:71], v1 offset:36928
    v_mfma_f32_16x16x32_bf16 v[20:23], a[80:83], v[112:115], v[60:63]
    v_exp_f32 v30, v30
    v_mfma_f32_16x16x32_bf16 v[20:23], a[84:87], v[116:119], v[20:23]
    ds_read_b128 a[72:75], v1 offset:36992
    v_cvt_pk_bf16_f32 v38, v28, v29
    v_mfma_f32_16x16x32_bf16 v[20:23], a[88:91], v[120:123], v[20:23]
    v_exp_f32 v31, v31
    v_mfma_f32_16x16x32_bf16 v[20:23], a[92:95], v[124:127], v[20:23]
    ds_read_b128 a[76:79], v1 offset:37056
    v_mfma_f32_16x16x32_bf16 v[24:27], a[96:99], v[112:115], v[60:63]
    v_exp_f32 v16, v16
    v_mfma_f32_16x16x32_bf16 v[24:27], a[100:103], v[116:119], v[24:27]
    ds_read_b128 a[80:83], v1 offset:37120
    v_cvt_pk_bf16_f32 v39, v30, v31
    v_mfma_f32_16x16x32_bf16 v[24:27], a[104:107], v[120:123], v[24:27]
    v_exp_f32 v17, v17
    v_mfma_f32_16x16x32_bf16 v[24:27], a[108:111], v[124:127], v[24:27]
    ds_read_b128 a[84:87], v1 offset:37184
    v_mfma_f32_16x16x32_bf16 v[28:31], a[112:115], v[112:115], v[60:63]
    v_exp_f32 v18, v18
    v_mfma_f32_16x16x32_bf16 v[28:31], a[116:119], v[116:119], v[28:31]
    ds_read_b128 a[88:91], v1 offset:37248
    v_cvt_pk_bf16_f32 v40, v16, v17
    v_mfma_f32_16x16x32_bf16 v[28:31], a[120:123], v[120:123], v[28:31]
    v_exp_f32 v19, v19
    v_mfma_f32_16x16x32_bf16 v[28:31], a[124:127], v[124:127], v[28:31]
    ds_read_b128 a[92:95], v1 offset:37312
    v_mfma_f32_16x16x32_bf16 v[192:195], a[128:131], v[32:35], v[192:195]
    v_exp_f32 v20, v20
    v_mfma_f32_16x16x32_bf16 v[192:195], a[132:135], v[36:39], v[192:195]
    ds_read_b128 a[96:99], v1 offset:37376
    v_cvt_pk_bf16_f32 v41, v18, v19
    v_mfma_f32_16x16x32_bf16 v[196:199], a[136:139], v[32:35], v[196:199]
    v_exp_f32 v21, v21
    v_mfma_f32_16x16x32_bf16 v[196:199], a[140:143], v[36:39], v[196:199]
    ds_read_b128 a[100:103], v1 offset:37440
    v_mfma_f32_16x16x32_bf16 v[200:203], a[144:147], v[32:35], v[200:203]
    v_exp_f32 v22, v22
    v_mfma_f32_16x16x32_bf16 v[200:203], a[148:151], v[36:39], v[200:203]
    ds_read_b128 a[104:107], v1 offset:37504
    v_cvt_pk_bf16_f32 v42, v20, v21
    v_mfma_f32_16x16x32_bf16 v[204:207], a[152:155], v[32:35], v[204:207]
    v_exp_f32 v23, v23
    v_mfma_f32_16x16x32_bf16 v[204:207], a[156:159], v[36:39], v[204:207]
    ds_read_b128 a[108:111], v1 offset:37568
    v_mfma_f32_16x16x32_bf16 v[208:211], a[160:163], v[32:35], v[208:211]
    v_exp_f32 v24, v24
    v_mfma_f32_16x16x32_bf16 v[208:211], a[164:167], v[36:39], v[208:211]
    ds_read_b128 a[112:115], v1 offset:37632
    v_cvt_pk_bf16_f32 v43, v22, v23
    v_mfma_f32_16x16x32_bf16 v[212:215], a[168:171], v[32:35], v[212:215]
    v_exp_f32 v25, v25
    v_mfma_f32_16x16x32_bf16 v[212:215], a[172:175], v[36:39], v[212:215]
    ds_read_b128 a[116:119], v1 offset:37696
    v_mfma_f32_16x16x32_bf16 v[216:219], a[176:179], v[32:35], v[216:219]
    v_exp_f32 v26, v26
    v_mfma_f32_16x16x32_bf16 v[216:219], a[180:183], v[36:39], v[216:219]
    ds_read_b128 a[120:123], v1 offset:37760
    v_cvt_pk_bf16_f32 v44, v24, v25
    v_mfma_f32_16x16x32_bf16 v[220:223], a[184:187], v[32:35], v[220:223]
    v_exp_f32 v27, v27
    v_mfma_f32_16x16x32_bf16 v[220:223], a[188:191], v[36:39], v[220:223]
    ds_read_b128 a[124:127], v1 offset:37824
    v_smfmac_f32_16x16x64_bf16 a[8:11], a[16:19], v[32:39], v11
    s_waitcnt vmcnt(16) lgkmcnt(12)
    s_barrier
    v_mfma_f32_16x16x32_bf16 v[16:19], a[64:67], v[64:67], v[48:51]
    s_sub_u32 s47, s47, s48
    v_exp_f32 v28, v28
    v_mfma_f32_16x16x32_bf16 v[16:19], a[68:71], v[68:71], v[16:19]
    v_cvt_pk_bf16_f32 v45, v26, v27
    v_add_u32 v1, s48, v1
    v_mfma_f32_16x16x32_bf16 v[16:19], a[72:75], v[72:75], v[16:19]
    s_add_u32 m0, s47, 0
    v_exp_f32 v29, v29
    v_mfma_f32_16x16x32_bf16 v[16:19], a[76:79], v[76:79], v[16:19]
    s_waitcnt lgkmcnt(8)
    buffer_load_dwordx4 v5, s[16:19], s46 offen offset:0 lds
    v_mfma_f32_16x16x32_bf16 v[20:23], a[80:83], v[64:67], v[48:51]
    v_exp_f32 v30, v30
    v_mfma_f32_16x16x32_bf16 v[20:23], a[84:87], v[68:71], v[20:23]
    v_cvt_pk_bf16_f32 v46, v28, v29
    v_add_u32 v2, s48, v2
    v_mfma_f32_16x16x32_bf16 v[20:23], a[88:91], v[72:75], v[20:23]
    s_add_u32 m0, s47, 32
    v_exp_f32 v31, v31
    v_mfma_f32_16x16x32_bf16 v[20:23], a[92:95], v[76:79], v[20:23]
    s_waitcnt lgkmcnt(4)
    buffer_load_dwordx4 v5, s[16:19], s46 offen offset:1024 lds
    v_mfma_f32_16x16x32_bf16 v[24:27], a[96:99], v[64:67], v[48:51]
    s_sub_u32 s48, 0, s48
    v_exp_f32 v16, v16
    v_mfma_f32_16x16x32_bf16 v[24:27], a[100:103], v[68:71], v[24:27]
    v_cvt_pk_bf16_f32 v47, v30, v31
    v_mfma_f32_16x16x32_bf16 v[24:27], a[104:107], v[72:75], v[24:27]
    s_add_u32 m0, s47, 64
    v_exp_f32 v17, v17
    v_mfma_f32_16x16x32_bf16 v[24:27], a[108:111], v[76:79], v[24:27]
    s_waitcnt lgkmcnt(0)
    buffer_load_dwordx4 v5, s[16:19], s46 offen offset:2048 lds
    v_mfma_f32_16x16x32_bf16 v[28:31], a[112:115], v[64:67], v[48:51]
    v_exp_f32 v18, v18
    v_mfma_f32_16x16x32_bf16 v[28:31], a[116:119], v[68:71], v[28:31]
    v_cvt_pk_bf16_f32 v32, v16, v17
    v_mfma_f32_16x16x32_bf16 v[28:31], a[120:123], v[72:75], v[28:31]
    s_add_u32 m0, s47, 96
    v_exp_f32 v19, v19
    v_mfma_f32_16x16x32_bf16 v[28:31], a[124:127], v[76:79], v[28:31]
    buffer_load_dwordx4 v5, s[16:19], s46 offen offset:3072 lds
    v_mfma_f32_16x16x32_bf16 v[224:227], a[128:131], v[40:43], v[224:227]
    v_exp_f32 v20, v20
    v_mfma_f32_16x16x32_bf16 v[224:227], a[132:135], v[44:47], v[224:227]
    ds_read_b64_tr_b16 a[128:129], v2 offset:0
    v_cvt_pk_bf16_f32 v33, v18, v19
    v_mfma_f32_16x16x32_bf16 v[228:231], a[136:139], v[40:43], v[228:231]
    s_add_u32 m0, s47, 16896
    v_exp_f32 v21, v21
    v_mfma_f32_16x16x32_bf16 v[228:231], a[140:143], v[44:47], v[228:231]
    buffer_load_dwordx4 v5, s[20:23], s46 offen offset:0 lds
    v_mfma_f32_16x16x32_bf16 v[232:235], a[144:147], v[40:43], v[232:235]
    v_exp_f32 v22, v22
    v_mfma_f32_16x16x32_bf16 v[232:235], a[148:151], v[44:47], v[232:235]
    ds_read_b64_tr_b16 a[130:131], v2 offset:256
    v_cvt_pk_bf16_f32 v34, v20, v21
    v_mfma_f32_16x16x32_bf16 v[236:239], a[152:155], v[40:43], v[236:239]
    s_add_u32 m0, s47, 16928
    v_exp_f32 v23, v23
    v_mfma_f32_16x16x32_bf16 v[236:239], a[156:159], v[44:47], v[236:239]
    buffer_load_dwordx4 v5, s[20:23], s46 offen offset:1024 lds
    v_mfma_f32_16x16x32_bf16 v[240:243], a[160:163], v[40:43], v[240:243]
    v_exp_f32 v24, v24
    v_mfma_f32_16x16x32_bf16 v[240:243], a[164:167], v[44:47], v[240:243]
    ds_read_b64_tr_b16 a[132:133], v2 offset:512
    v_cvt_pk_bf16_f32 v35, v22, v23
    v_mfma_f32_16x16x32_bf16 v[244:247], a[168:171], v[40:43], v[244:247]
    s_add_u32 m0, s47, 16960
    v_exp_f32 v25, v25
    v_mfma_f32_16x16x32_bf16 v[244:247], a[172:175], v[44:47], v[244:247]
    buffer_load_dwordx4 v5, s[20:23], s46 offen offset:2048 lds
    v_mfma_f32_16x16x32_bf16 v[248:251], a[176:179], v[40:43], v[248:251]
    v_exp_f32 v26, v26
    v_mfma_f32_16x16x32_bf16 v[248:251], a[180:183], v[44:47], v[248:251]
    ds_read_b64_tr_b16 a[134:135], v2 offset:768
    v_cvt_pk_bf16_f32 v36, v24, v25
    v_mfma_f32_16x16x32_bf16 v[252:255], a[184:187], v[40:43], v[252:255]
    s_add_u32 m0, s47, 16992
    v_exp_f32 v27, v27
    v_mfma_f32_16x16x32_bf16 v[252:255], a[188:191], v[44:47], v[252:255]
    buffer_load_dwordx4 v5, s[20:23], s46 offen offset:3072 lds
    v_smfmac_f32_16x16x64_bf16 a[12:15], a[16:19], v[40:47], v11
    ds_read_b64_tr_b16 a[136:137], v2 offset:32
    v_mfma_f32_16x16x32_bf16 v[16:19], a[64:67], v[80:83], v[52:55]
    v_exp_f32 v28, v28
    v_mfma_f32_16x16x32_bf16 v[16:19], a[68:71], v[84:87], v[16:19]
    ds_read_b64_tr_b16 a[138:139], v2 offset:288
    v_cvt_pk_bf16_f32 v37, v26, v27
    v_mfma_f32_16x16x32_bf16 v[16:19], a[72:75], v[88:91], v[16:19]
    v_exp_f32 v29, v29
    v_mfma_f32_16x16x32_bf16 v[16:19], a[76:79], v[92:95], v[16:19]
    global_load_dword a63, v12, s[6:7]
    v_mfma_f32_16x16x32_bf16 v[20:23], a[80:83], v[80:83], v[52:55]
    v_exp_f32 v30, v30
    v_mfma_f32_16x16x32_bf16 v[20:23], a[84:87], v[84:87], v[20:23]
    ds_read_b64_tr_b16 a[140:141], v2 offset:544
    v_cvt_pk_bf16_f32 v38, v28, v29
    v_mfma_f32_16x16x32_bf16 v[20:23], a[88:91], v[88:91], v[20:23]
    v_exp_f32 v31, v31
    v_mfma_f32_16x16x32_bf16 v[20:23], a[92:95], v[92:95], v[20:23]
    ds_read_b64_tr_b16 a[142:143], v2 offset:800
    v_mfma_f32_16x16x32_bf16 v[24:27], a[96:99], v[80:83], v[52:55]
    v_exp_f32 v16, v16
    v_mfma_f32_16x16x32_bf16 v[24:27], a[100:103], v[84:87], v[24:27]
    ds_read_b64_tr_b16 a[144:145], v2 offset:64
    v_cvt_pk_bf16_f32 v39, v30, v31
    v_mfma_f32_16x16x32_bf16 v[24:27], a[104:107], v[88:91], v[24:27]
    s_mov_b32 s54, 884736
    v_exp_f32 v17, v17
    v_mfma_f32_16x16x32_bf16 v[24:27], a[108:111], v[92:95], v[24:27]
    buffer_load_dwordx4 a[44:47], v6, s[64:67], s54 offen
    v_mfma_f32_16x16x32_bf16 v[28:31], a[112:115], v[80:83], v[52:55]
    v_exp_f32 v18, v18
    v_mfma_f32_16x16x32_bf16 v[28:31], a[116:119], v[84:87], v[28:31]
    ds_read_b64_tr_b16 a[146:147], v2 offset:320
    v_cvt_pk_bf16_f32 v40, v16, v17
    v_mfma_f32_16x16x32_bf16 v[28:31], a[120:123], v[88:91], v[28:31]
    v_exp_f32 v19, v19
    v_mfma_f32_16x16x32_bf16 v[28:31], a[124:127], v[92:95], v[28:31]
    ds_read_b64_tr_b16 a[148:149], v2 offset:576
    v_mfma_f32_16x16x32_bf16 v[128:131], a[192:195], v[32:35], v[128:131]
    v_exp_f32 v20, v20
    v_mfma_f32_16x16x32_bf16 v[128:131], a[196:199], v[36:39], v[128:131]
    ds_read_b64_tr_b16 a[150:151], v2 offset:832
    v_cvt_pk_bf16_f32 v41, v18, v19
    v_mfma_f32_16x16x32_bf16 v[132:135], a[200:203], v[32:35], v[132:135]
    s_mov_b32 s54, 1032192
    v_exp_f32 v21, v21
    v_mfma_f32_16x16x32_bf16 v[132:135], a[204:207], v[36:39], v[132:135]
    buffer_load_dwordx4 a[48:51], v6, s[64:67], s54 offen
    v_mfma_f32_16x16x32_bf16 v[136:139], a[208:211], v[32:35], v[136:139]
    v_exp_f32 v22, v22
    v_mfma_f32_16x16x32_bf16 v[136:139], a[212:215], v[36:39], v[136:139]
    ds_read_b64_tr_b16 a[152:153], v2 offset:96
    v_cvt_pk_bf16_f32 v42, v20, v21
    v_mfma_f32_16x16x32_bf16 v[140:143], a[216:219], v[32:35], v[140:143]
    v_exp_f32 v23, v23
    v_mfma_f32_16x16x32_bf16 v[140:143], a[220:223], v[36:39], v[140:143]
    ds_read_b64_tr_b16 a[154:155], v2 offset:352
    v_mfma_f32_16x16x32_bf16 v[144:147], a[224:227], v[32:35], v[144:147]
    v_exp_f32 v24, v24
    v_mfma_f32_16x16x32_bf16 v[144:147], a[228:231], v[36:39], v[144:147]
    ds_read_b64_tr_b16 a[156:157], v2 offset:608
    v_cvt_pk_bf16_f32 v43, v22, v23
    v_mfma_f32_16x16x32_bf16 v[148:151], a[232:235], v[32:35], v[148:151]
    s_mov_b32 s54, 1179648
    v_exp_f32 v25, v25
    v_mfma_f32_16x16x32_bf16 v[148:151], a[236:239], v[36:39], v[148:151]
    buffer_load_dwordx4 a[52:55], v6, s[64:67], s54 offen
    v_mfma_f32_16x16x32_bf16 v[152:155], a[240:243], v[32:35], v[152:155]
    v_exp_f32 v26, v26
    v_mfma_f32_16x16x32_bf16 v[152:155], a[244:247], v[36:39], v[152:155]
    ds_read_b64_tr_b16 a[158:159], v2 offset:864
    v_cvt_pk_bf16_f32 v44, v24, v25
    v_mfma_f32_16x16x32_bf16 v[156:159], a[248:251], v[32:35], v[156:159]
    v_exp_f32 v27, v27
    v_mfma_f32_16x16x32_bf16 v[156:159], a[252:255], v[36:39], v[156:159]
    ds_read_b64_tr_b16 a[160:161], v2 offset:128
    v_smfmac_f32_16x16x64_bf16 a[0:3], a[16:19], v[32:39], v11
    ds_read_b64_tr_b16 a[162:163], v2 offset:384
    v_mfma_f32_16x16x32_bf16 v[16:19], a[64:67], v[96:99], v[56:59]
    v_exp_f32 v28, v28
    v_mfma_f32_16x16x32_bf16 v[16:19], a[68:71], v[100:103], v[16:19]
    ds_read_b64_tr_b16 a[164:165], v2 offset:640
    v_cvt_pk_bf16_f32 v45, v26, v27
    v_mfma_f32_16x16x32_bf16 v[16:19], a[72:75], v[104:107], v[16:19]
    v_exp_f32 v29, v29
    v_mfma_f32_16x16x32_bf16 v[16:19], a[76:79], v[108:111], v[16:19]
    ds_read_b64_tr_b16 a[166:167], v2 offset:896
    v_mfma_f32_16x16x32_bf16 v[20:23], a[80:83], v[96:99], v[56:59]
    v_exp_f32 v30, v30
    v_mfma_f32_16x16x32_bf16 v[20:23], a[84:87], v[100:103], v[20:23]
    ds_read_b64_tr_b16 a[168:169], v2 offset:160
    v_cvt_pk_bf16_f32 v46, v28, v29
    v_mfma_f32_16x16x32_bf16 v[20:23], a[88:91], v[104:107], v[20:23]
    v_exp_f32 v31, v31
    v_mfma_f32_16x16x32_bf16 v[20:23], a[92:95], v[108:111], v[20:23]
    ds_read_b64_tr_b16 a[170:171], v2 offset:416
    v_mfma_f32_16x16x32_bf16 v[24:27], a[96:99], v[96:99], v[56:59]
    v_exp_f32 v16, v16
    v_mfma_f32_16x16x32_bf16 v[24:27], a[100:103], v[100:103], v[24:27]
    ds_read_b64_tr_b16 a[172:173], v2 offset:672
    v_cvt_pk_bf16_f32 v47, v30, v31
    v_mfma_f32_16x16x32_bf16 v[24:27], a[104:107], v[104:107], v[24:27]
    v_exp_f32 v17, v17
    v_mfma_f32_16x16x32_bf16 v[24:27], a[108:111], v[108:111], v[24:27]
    ds_read_b64_tr_b16 a[174:175], v2 offset:928
    v_mfma_f32_16x16x32_bf16 v[28:31], a[112:115], v[96:99], v[56:59]
    v_exp_f32 v18, v18
    v_mfma_f32_16x16x32_bf16 v[28:31], a[116:119], v[100:103], v[28:31]
    ds_read_b64_tr_b16 a[176:177], v2 offset:192
    v_cvt_pk_bf16_f32 v32, v16, v17
    v_mfma_f32_16x16x32_bf16 v[28:31], a[120:123], v[104:107], v[28:31]
    v_exp_f32 v19, v19
    v_mfma_f32_16x16x32_bf16 v[28:31], a[124:127], v[108:111], v[28:31]
    ds_read_b64_tr_b16 a[178:179], v2 offset:448
    v_mfma_f32_16x16x32_bf16 v[160:163], a[192:195], v[40:43], v[160:163]
    v_exp_f32 v20, v20
    v_mfma_f32_16x16x32_bf16 v[160:163], a[196:199], v[44:47], v[160:163]
    ds_read_b64_tr_b16 a[180:181], v2 offset:704
    v_cvt_pk_bf16_f32 v33, v18, v19
    v_mfma_f32_16x16x32_bf16 v[164:167], a[200:203], v[40:43], v[164:167]
    v_exp_f32 v21, v21
    v_mfma_f32_16x16x32_bf16 v[164:167], a[204:207], v[44:47], v[164:167]
    ds_read_b64_tr_b16 a[182:183], v2 offset:960
    v_mfma_f32_16x16x32_bf16 v[168:171], a[208:211], v[40:43], v[168:171]
    v_exp_f32 v22, v22
    v_mfma_f32_16x16x32_bf16 v[168:171], a[212:215], v[44:47], v[168:171]
    ds_read_b64_tr_b16 a[184:185], v2 offset:224
    v_cvt_pk_bf16_f32 v34, v20, v21
    v_mfma_f32_16x16x32_bf16 v[172:175], a[216:219], v[40:43], v[172:175]
    v_exp_f32 v23, v23
    v_mfma_f32_16x16x32_bf16 v[172:175], a[220:223], v[44:47], v[172:175]
    ds_read_b64_tr_b16 a[186:187], v2 offset:480
    v_mfma_f32_16x16x32_bf16 v[176:179], a[224:227], v[40:43], v[176:179]
    v_exp_f32 v24, v24
    v_mfma_f32_16x16x32_bf16 v[176:179], a[228:231], v[44:47], v[176:179]
    ds_read_b64_tr_b16 a[188:189], v2 offset:736
    v_cvt_pk_bf16_f32 v35, v22, v23
    v_mfma_f32_16x16x32_bf16 v[180:183], a[232:235], v[40:43], v[180:183]
    v_exp_f32 v25, v25
    v_mfma_f32_16x16x32_bf16 v[180:183], a[236:239], v[44:47], v[180:183]
    ds_read_b64_tr_b16 a[190:191], v2 offset:992
    v_mfma_f32_16x16x32_bf16 v[184:187], a[240:243], v[40:43], v[184:187]
    v_exp_f32 v26, v26
    v_mfma_f32_16x16x32_bf16 v[184:187], a[244:247], v[44:47], v[184:187]
    v_cvt_pk_bf16_f32 v36, v24, v25
    v_mfma_f32_16x16x32_bf16 v[188:191], a[248:251], v[40:43], v[188:191]
    v_exp_f32 v27, v27
    v_mfma_f32_16x16x32_bf16 v[188:191], a[252:255], v[44:47], v[188:191]
    v_smfmac_f32_16x16x64_bf16 a[4:7], a[16:19], v[40:47], v11
    v_mfma_f32_16x16x32_bf16 v[16:19], a[64:67], v[112:115], v[60:63]
    v_exp_f32 v28, v28
    v_mfma_f32_16x16x32_bf16 v[16:19], a[68:71], v[116:119], v[16:19]
    s_add_u32 s46, s46, 16384
    ds_read_b128 a[64:67], v1 offset:0
    v_cvt_pk_bf16_f32 v37, v26, v27
    v_mfma_f32_16x16x32_bf16 v[16:19], a[72:75], v[120:123], v[16:19]
    v_exp_f32 v29, v29
    v_mfma_f32_16x16x32_bf16 v[16:19], a[76:79], v[124:127], v[16:19]
    ds_read_b128 a[68:71], v1 offset:64
    v_mfma_f32_16x16x32_bf16 v[20:23], a[80:83], v[112:115], v[60:63]
    v_exp_f32 v30, v30
    v_mfma_f32_16x16x32_bf16 v[20:23], a[84:87], v[116:119], v[20:23]
    ds_read_b128 a[72:75], v1 offset:128
    v_cvt_pk_bf16_f32 v38, v28, v29
    v_mfma_f32_16x16x32_bf16 v[20:23], a[88:91], v[120:123], v[20:23]
    v_exp_f32 v31, v31
    v_mfma_f32_16x16x32_bf16 v[20:23], a[92:95], v[124:127], v[20:23]
    ds_read_b128 a[76:79], v1 offset:192
    v_mfma_f32_16x16x32_bf16 v[24:27], a[96:99], v[112:115], v[60:63]
    v_exp_f32 v16, v16
    v_mfma_f32_16x16x32_bf16 v[24:27], a[100:103], v[116:119], v[24:27]
    ds_read_b128 a[80:83], v1 offset:256
    v_cvt_pk_bf16_f32 v39, v30, v31
    v_mfma_f32_16x16x32_bf16 v[24:27], a[104:107], v[120:123], v[24:27]
    v_exp_f32 v17, v17
    v_mfma_f32_16x16x32_bf16 v[24:27], a[108:111], v[124:127], v[24:27]
    ds_read_b128 a[84:87], v1 offset:320
    v_mfma_f32_16x16x32_bf16 v[28:31], a[112:115], v[112:115], v[60:63]
    v_exp_f32 v18, v18
    v_mfma_f32_16x16x32_bf16 v[28:31], a[116:119], v[116:119], v[28:31]
    ds_read_b128 a[88:91], v1 offset:384
    v_cvt_pk_bf16_f32 v40, v16, v17
    v_mfma_f32_16x16x32_bf16 v[28:31], a[120:123], v[120:123], v[28:31]
    v_exp_f32 v19, v19
    v_mfma_f32_16x16x32_bf16 v[28:31], a[124:127], v[124:127], v[28:31]
    ds_read_b128 a[92:95], v1 offset:448
    v_mfma_f32_16x16x32_bf16 v[192:195], a[192:195], v[32:35], v[192:195]
    v_exp_f32 v20, v20
    v_mfma_f32_16x16x32_bf16 v[192:195], a[196:199], v[36:39], v[192:195]
    ds_read_b128 a[96:99], v1 offset:512
    v_cvt_pk_bf16_f32 v41, v18, v19
    v_mfma_f32_16x16x32_bf16 v[196:199], a[200:203], v[32:35], v[196:199]
    v_exp_f32 v21, v21
    v_mfma_f32_16x16x32_bf16 v[196:199], a[204:207], v[36:39], v[196:199]
    ds_read_b128 a[100:103], v1 offset:576
    v_mfma_f32_16x16x32_bf16 v[200:203], a[208:211], v[32:35], v[200:203]
    v_exp_f32 v22, v22
    v_mfma_f32_16x16x32_bf16 v[200:203], a[212:215], v[36:39], v[200:203]
    ds_read_b128 a[104:107], v1 offset:640
    v_cvt_pk_bf16_f32 v42, v20, v21
    v_mfma_f32_16x16x32_bf16 v[204:207], a[216:219], v[32:35], v[204:207]
    v_exp_f32 v23, v23
    v_mfma_f32_16x16x32_bf16 v[204:207], a[220:223], v[36:39], v[204:207]
    ds_read_b128 a[108:111], v1 offset:704
    v_mfma_f32_16x16x32_bf16 v[208:211], a[224:227], v[32:35], v[208:211]
    v_exp_f32 v24, v24
    v_mfma_f32_16x16x32_bf16 v[208:211], a[228:231], v[36:39], v[208:211]
    ds_read_b128 a[112:115], v1 offset:768
    v_cvt_pk_bf16_f32 v43, v22, v23
    v_mfma_f32_16x16x32_bf16 v[212:215], a[232:235], v[32:35], v[212:215]
    v_exp_f32 v25, v25
    v_mfma_f32_16x16x32_bf16 v[212:215], a[236:239], v[36:39], v[212:215]
    ds_read_b128 a[116:119], v1 offset:832
    v_mfma_f32_16x16x32_bf16 v[216:219], a[240:243], v[32:35], v[216:219]
    v_exp_f32 v26, v26
    v_mfma_f32_16x16x32_bf16 v[216:219], a[244:247], v[36:39], v[216:219]
    ds_read_b128 a[120:123], v1 offset:896
    v_cvt_pk_bf16_f32 v44, v24, v25
    v_mfma_f32_16x16x32_bf16 v[220:223], a[248:251], v[32:35], v[220:223]
    v_exp_f32 v27, v27
    v_mfma_f32_16x16x32_bf16 v[220:223], a[252:255], v[36:39], v[220:223]
    ds_read_b128 a[124:127], v1 offset:960
    v_smfmac_f32_16x16x64_bf16 a[8:11], a[16:19], v[32:39], v11
    s_waitcnt vmcnt(16) lgkmcnt(12)
    s_barrier
    v_mfma_f32_16x16x32_bf16 v[16:19], a[64:67], v[64:67], v[48:51]
    v_exp_f32 v28, v28
    v_mfma_f32_16x16x32_bf16 v[16:19], a[68:71], v[68:71], v[16:19]
    v_cvt_pk_bf16_f32 v45, v26, v27
    v_mfma_f32_16x16x32_bf16 v[16:19], a[72:75], v[72:75], v[16:19]
    s_add_u32 m0, s47, 36864
    v_exp_f32 v29, v29
    v_mfma_f32_16x16x32_bf16 v[16:19], a[76:79], v[76:79], v[16:19]
    s_waitcnt lgkmcnt(8)
    buffer_load_dwordx4 v5, s[16:19], s46 offen offset:0 lds
    v_mfma_f32_16x16x32_bf16 v[20:23], a[80:83], v[64:67], v[48:51]
    v_exp_f32 v30, v30
    v_mfma_f32_16x16x32_bf16 v[20:23], a[84:87], v[68:71], v[20:23]
    v_cvt_pk_bf16_f32 v46, v28, v29
    v_mfma_f32_16x16x32_bf16 v[20:23], a[88:91], v[72:75], v[20:23]
    s_add_u32 m0, s47, 36896
    v_exp_f32 v31, v31
    v_mfma_f32_16x16x32_bf16 v[20:23], a[92:95], v[76:79], v[20:23]
    s_waitcnt lgkmcnt(4)
    buffer_load_dwordx4 v5, s[16:19], s46 offen offset:1024 lds
    v_mfma_f32_16x16x32_bf16 v[24:27], a[96:99], v[64:67], v[48:51]
    v_exp_f32 v16, v16
    v_mfma_f32_16x16x32_bf16 v[24:27], a[100:103], v[68:71], v[24:27]
    v_cvt_pk_bf16_f32 v47, v30, v31
    v_mfma_f32_16x16x32_bf16 v[24:27], a[104:107], v[72:75], v[24:27]
    s_add_u32 m0, s47, 36928
    v_exp_f32 v17, v17
    v_mfma_f32_16x16x32_bf16 v[24:27], a[108:111], v[76:79], v[24:27]
    s_waitcnt lgkmcnt(0)
    buffer_load_dwordx4 v5, s[16:19], s46 offen offset:2048 lds
    v_mfma_f32_16x16x32_bf16 v[28:31], a[112:115], v[64:67], v[48:51]
    v_exp_f32 v18, v18
    v_mfma_f32_16x16x32_bf16 v[28:31], a[116:119], v[68:71], v[28:31]
    v_cvt_pk_bf16_f32 v32, v16, v17
    v_mfma_f32_16x16x32_bf16 v[28:31], a[120:123], v[72:75], v[28:31]
    s_add_u32 m0, s47, 36960
    v_exp_f32 v19, v19
    v_mfma_f32_16x16x32_bf16 v[28:31], a[124:127], v[76:79], v[28:31]
    buffer_load_dwordx4 v5, s[16:19], s46 offen offset:3072 lds
    v_mfma_f32_16x16x32_bf16 v[224:227], a[192:195], v[40:43], v[224:227]
    v_exp_f32 v20, v20
    v_mfma_f32_16x16x32_bf16 v[224:227], a[196:199], v[44:47], v[224:227]
    ds_read_b64_tr_b16 a[192:193], v2 offset:36864
    v_cvt_pk_bf16_f32 v33, v18, v19
    v_mfma_f32_16x16x32_bf16 v[228:231], a[200:203], v[40:43], v[228:231]
    s_add_u32 m0, s47, 53760
    v_exp_f32 v21, v21
    v_mfma_f32_16x16x32_bf16 v[228:231], a[204:207], v[44:47], v[228:231]
    buffer_load_dwordx4 v5, s[20:23], s46 offen offset:0 lds
    v_mfma_f32_16x16x32_bf16 v[232:235], a[208:211], v[40:43], v[232:235]
    v_exp_f32 v22, v22
    v_mfma_f32_16x16x32_bf16 v[232:235], a[212:215], v[44:47], v[232:235]
    ds_read_b64_tr_b16 a[194:195], v2 offset:37120
    v_cvt_pk_bf16_f32 v34, v20, v21
    v_mfma_f32_16x16x32_bf16 v[236:239], a[216:219], v[40:43], v[236:239]
    s_add_u32 m0, s47, 53792
    v_exp_f32 v23, v23
    v_mfma_f32_16x16x32_bf16 v[236:239], a[220:223], v[44:47], v[236:239]
    buffer_load_dwordx4 v5, s[20:23], s46 offen offset:1024 lds
    v_mfma_f32_16x16x32_bf16 v[240:243], a[224:227], v[40:43], v[240:243]
    v_exp_f32 v24, v24
    v_mfma_f32_16x16x32_bf16 v[240:243], a[228:231], v[44:47], v[240:243]
    ds_read_b64_tr_b16 a[196:197], v2 offset:37376
    v_cvt_pk_bf16_f32 v35, v22, v23
    v_mfma_f32_16x16x32_bf16 v[244:247], a[232:235], v[40:43], v[244:247]
    s_add_u32 m0, s47, 53824
    v_exp_f32 v25, v25
    v_mfma_f32_16x16x32_bf16 v[244:247], a[236:239], v[44:47], v[244:247]
    buffer_load_dwordx4 v5, s[20:23], s46 offen offset:2048 lds
    v_mfma_f32_16x16x32_bf16 v[248:251], a[240:243], v[40:43], v[248:251]
    v_exp_f32 v26, v26
    v_mfma_f32_16x16x32_bf16 v[248:251], a[244:247], v[44:47], v[248:251]
    ds_read_b64_tr_b16 a[198:199], v2 offset:37632
    v_cvt_pk_bf16_f32 v36, v24, v25
    v_mfma_f32_16x16x32_bf16 v[252:255], a[248:251], v[40:43], v[252:255]
    s_add_u32 m0, s47, 53856
    v_exp_f32 v27, v27
    v_mfma_f32_16x16x32_bf16 v[252:255], a[252:255], v[44:47], v[252:255]
    buffer_load_dwordx4 v5, s[20:23], s46 offen offset:3072 lds
    v_smfmac_f32_16x16x64_bf16 a[12:15], a[16:19], v[40:47], v11
    ds_read_b64_tr_b16 a[200:201], v2 offset:36896
    v_mfma_f32_16x16x32_bf16 v[16:19], a[64:67], v[80:83], v[52:55]
    v_exp_f32 v28, v28
    v_mfma_f32_16x16x32_bf16 v[16:19], a[68:71], v[84:87], v[16:19]
    ds_read_b64_tr_b16 a[202:203], v2 offset:37152
    v_cvt_pk_bf16_f32 v37, v26, v27
    v_mfma_f32_16x16x32_bf16 v[16:19], a[72:75], v[88:91], v[16:19]
    v_exp_f32 v29, v29
    v_mfma_f32_16x16x32_bf16 v[16:19], a[76:79], v[92:95], v[16:19]
    global_load_dword a63, v13, s[8:9]
    v_mfma_f32_16x16x32_bf16 v[20:23], a[80:83], v[80:83], v[52:55]
    v_exp_f32 v30, v30
    v_mfma_f32_16x16x32_bf16 v[20:23], a[84:87], v[84:87], v[20:23]
    ds_read_b64_tr_b16 a[204:205], v2 offset:37408
    v_cvt_pk_bf16_f32 v38, v28, v29
    v_mfma_f32_16x16x32_bf16 v[20:23], a[88:91], v[88:91], v[20:23]
    v_exp_f32 v31, v31
    v_mfma_f32_16x16x32_bf16 v[20:23], a[92:95], v[92:95], v[20:23]
    ds_read_b64_tr_b16 a[206:207], v2 offset:37664
    v_mfma_f32_16x16x32_bf16 v[24:27], a[96:99], v[80:83], v[52:55]
    v_exp_f32 v16, v16
    v_mfma_f32_16x16x32_bf16 v[24:27], a[100:103], v[84:87], v[24:27]
    ds_read_b64_tr_b16 a[208:209], v2 offset:36928
    v_cvt_pk_bf16_f32 v39, v30, v31
    v_mfma_f32_16x16x32_bf16 v[24:27], a[104:107], v[88:91], v[24:27]
    v_exp_f32 v17, v17
    v_mfma_f32_16x16x32_bf16 v[24:27], a[108:111], v[92:95], v[24:27]
    ds_read_b64_tr_b16 a[210:211], v2 offset:37184
    v_mfma_f32_16x16x32_bf16 v[28:31], a[112:115], v[80:83], v[52:55]
    v_exp_f32 v18, v18
    v_mfma_f32_16x16x32_bf16 v[28:31], a[116:119], v[84:87], v[28:31]
    ds_read_b64_tr_b16 a[212:213], v2 offset:37440
    v_cvt_pk_bf16_f32 v40, v16, v17
    v_mfma_f32_16x16x32_bf16 v[28:31], a[120:123], v[88:91], v[28:31]
    v_exp_f32 v19, v19
    v_mfma_f32_16x16x32_bf16 v[28:31], a[124:127], v[92:95], v[28:31]
    ds_read_b64_tr_b16 a[214:215], v2 offset:37696
    v_mfma_f32_16x16x32_bf16 v[128:131], a[128:131], v[32:35], v[128:131]
    v_exp_f32 v20, v20
    v_mfma_f32_16x16x32_bf16 v[128:131], a[132:135], v[36:39], v[128:131]
    ds_read_b64_tr_b16 a[216:217], v2 offset:36960
    v_cvt_pk_bf16_f32 v41, v18, v19
    v_mfma_f32_16x16x32_bf16 v[132:135], a[136:139], v[32:35], v[132:135]
    v_exp_f32 v21, v21
    v_mfma_f32_16x16x32_bf16 v[132:135], a[140:143], v[36:39], v[132:135]
    ds_read_b64_tr_b16 a[218:219], v2 offset:37216
    v_mfma_f32_16x16x32_bf16 v[136:139], a[144:147], v[32:35], v[136:139]
    v_exp_f32 v22, v22
    v_mfma_f32_16x16x32_bf16 v[136:139], a[148:151], v[36:39], v[136:139]
    ds_read_b64_tr_b16 a[220:221], v2 offset:37472
    v_cvt_pk_bf16_f32 v42, v20, v21
    v_mfma_f32_16x16x32_bf16 v[140:143], a[152:155], v[32:35], v[140:143]
    v_exp_f32 v23, v23
    v_mfma_f32_16x16x32_bf16 v[140:143], a[156:159], v[36:39], v[140:143]
    ds_read_b64_tr_b16 a[222:223], v2 offset:37728
    v_mfma_f32_16x16x32_bf16 v[144:147], a[160:163], v[32:35], v[144:147]
    v_exp_f32 v24, v24
    v_mfma_f32_16x16x32_bf16 v[144:147], a[164:167], v[36:39], v[144:147]
    ds_read_b64_tr_b16 a[224:225], v2 offset:36992
    v_cvt_pk_bf16_f32 v43, v22, v23
    v_mfma_f32_16x16x32_bf16 v[148:151], a[168:171], v[32:35], v[148:151]
    v_exp_f32 v25, v25
    v_mfma_f32_16x16x32_bf16 v[148:151], a[172:175], v[36:39], v[148:151]
    ds_read_b64_tr_b16 a[226:227], v2 offset:37248
    v_mfma_f32_16x16x32_bf16 v[152:155], a[176:179], v[32:35], v[152:155]
    v_exp_f32 v26, v26
    v_mfma_f32_16x16x32_bf16 v[152:155], a[180:183], v[36:39], v[152:155]
    ds_read_b64_tr_b16 a[228:229], v2 offset:37504
    v_cvt_pk_bf16_f32 v44, v24, v25
    v_mfma_f32_16x16x32_bf16 v[156:159], a[184:187], v[32:35], v[156:159]
    v_exp_f32 v27, v27
    v_mfma_f32_16x16x32_bf16 v[156:159], a[188:191], v[36:39], v[156:159]
    ds_read_b64_tr_b16 a[230:231], v2 offset:37760
    v_smfmac_f32_16x16x64_bf16 a[0:3], a[16:19], v[32:39], v11
    ds_read_b64_tr_b16 a[232:233], v2 offset:37024
    v_mfma_f32_16x16x32_bf16 v[16:19], a[64:67], v[96:99], v[56:59]
    v_exp_f32 v28, v28
    v_mfma_f32_16x16x32_bf16 v[16:19], a[68:71], v[100:103], v[16:19]
    ds_read_b64_tr_b16 a[234:235], v2 offset:37280
    v_cvt_pk_bf16_f32 v45, v26, v27
    v_mfma_f32_16x16x32_bf16 v[16:19], a[72:75], v[104:107], v[16:19]
    v_exp_f32 v29, v29
    v_mfma_f32_16x16x32_bf16 v[16:19], a[76:79], v[108:111], v[16:19]
    ds_read_b64_tr_b16 a[236:237], v2 offset:37536
    v_mfma_f32_16x16x32_bf16 v[20:23], a[80:83], v[96:99], v[56:59]
    v_exp_f32 v30, v30
    v_mfma_f32_16x16x32_bf16 v[20:23], a[84:87], v[100:103], v[20:23]
    ds_read_b64_tr_b16 a[238:239], v2 offset:37792
    v_cvt_pk_bf16_f32 v46, v28, v29
    v_mfma_f32_16x16x32_bf16 v[20:23], a[88:91], v[104:107], v[20:23]
    v_exp_f32 v31, v31
    v_mfma_f32_16x16x32_bf16 v[20:23], a[92:95], v[108:111], v[20:23]
    ds_read_b64_tr_b16 a[240:241], v2 offset:37056
    v_mfma_f32_16x16x32_bf16 v[24:27], a[96:99], v[96:99], v[56:59]
    v_exp_f32 v16, v16
    v_mfma_f32_16x16x32_bf16 v[24:27], a[100:103], v[100:103], v[24:27]
    ds_read_b64_tr_b16 a[242:243], v2 offset:37312
    v_cvt_pk_bf16_f32 v47, v30, v31
    v_mfma_f32_16x16x32_bf16 v[24:27], a[104:107], v[104:107], v[24:27]
    v_exp_f32 v17, v17
    v_mfma_f32_16x16x32_bf16 v[24:27], a[108:111], v[108:111], v[24:27]
    ds_read_b64_tr_b16 a[244:245], v2 offset:37568
    v_mfma_f32_16x16x32_bf16 v[28:31], a[112:115], v[96:99], v[56:59]
    v_exp_f32 v18, v18
    v_mfma_f32_16x16x32_bf16 v[28:31], a[116:119], v[100:103], v[28:31]
    ds_read_b64_tr_b16 a[246:247], v2 offset:37824
    v_cvt_pk_bf16_f32 v32, v16, v17
    v_mfma_f32_16x16x32_bf16 v[28:31], a[120:123], v[104:107], v[28:31]
    v_exp_f32 v19, v19
    v_mfma_f32_16x16x32_bf16 v[28:31], a[124:127], v[108:111], v[28:31]
    ds_read_b64_tr_b16 a[248:249], v2 offset:37088
    v_mfma_f32_16x16x32_bf16 v[160:163], a[128:131], v[40:43], v[160:163]
    v_exp_f32 v20, v20
    v_mfma_f32_16x16x32_bf16 v[160:163], a[132:135], v[44:47], v[160:163]
    ds_read_b64_tr_b16 a[250:251], v2 offset:37344
    v_cvt_pk_bf16_f32 v33, v18, v19
    v_mfma_f32_16x16x32_bf16 v[164:167], a[136:139], v[40:43], v[164:167]
    v_exp_f32 v21, v21
    v_mfma_f32_16x16x32_bf16 v[164:167], a[140:143], v[44:47], v[164:167]
    ds_read_b64_tr_b16 a[252:253], v2 offset:37600
    v_mfma_f32_16x16x32_bf16 v[168:171], a[144:147], v[40:43], v[168:171]
    v_exp_f32 v22, v22
    v_mfma_f32_16x16x32_bf16 v[168:171], a[148:151], v[44:47], v[168:171]
    ds_read_b64_tr_b16 a[254:255], v2 offset:37856
    v_cvt_pk_bf16_f32 v34, v20, v21
    v_mfma_f32_16x16x32_bf16 v[172:175], a[152:155], v[40:43], v[172:175]
    v_exp_f32 v23, v23
    v_mfma_f32_16x16x32_bf16 v[172:175], a[156:159], v[44:47], v[172:175]
    v_mfma_f32_16x16x32_bf16 v[176:179], a[160:163], v[40:43], v[176:179]
    v_exp_f32 v24, v24
    v_mfma_f32_16x16x32_bf16 v[176:179], a[164:167], v[44:47], v[176:179]
    v_cvt_pk_bf16_f32 v35, v22, v23
    v_mfma_f32_16x16x32_bf16 v[180:183], a[168:171], v[40:43], v[180:183]
    v_exp_f32 v25, v25
    v_mfma_f32_16x16x32_bf16 v[180:183], a[172:175], v[44:47], v[180:183]
    v_mfma_f32_16x16x32_bf16 v[184:187], a[176:179], v[40:43], v[184:187]
    v_exp_f32 v26, v26
    v_mfma_f32_16x16x32_bf16 v[184:187], a[180:183], v[44:47], v[184:187]
    v_cvt_pk_bf16_f32 v36, v24, v25
    v_mfma_f32_16x16x32_bf16 v[188:191], a[184:187], v[40:43], v[188:191]
    v_exp_f32 v27, v27
    v_mfma_f32_16x16x32_bf16 v[188:191], a[188:191], v[44:47], v[188:191]
    v_smfmac_f32_16x16x64_bf16 a[4:7], a[16:19], v[40:47], v11
    v_mfma_f32_16x16x32_bf16 v[16:19], a[64:67], v[112:115], v[60:63]
    v_exp_f32 v28, v28
    v_mfma_f32_16x16x32_bf16 v[16:19], a[68:71], v[116:119], v[16:19]
    s_add_u32 s46, s46, 16384
    ds_read_b128 a[64:67], v1 offset:36864
    v_cvt_pk_bf16_f32 v37, v26, v27
    v_mfma_f32_16x16x32_bf16 v[16:19], a[72:75], v[120:123], v[16:19]
    v_exp_f32 v29, v29
    v_mfma_f32_16x16x32_bf16 v[16:19], a[76:79], v[124:127], v[16:19]
    ds_read_b128 a[68:71], v1 offset:36928
    v_mfma_f32_16x16x32_bf16 v[20:23], a[80:83], v[112:115], v[60:63]
    v_exp_f32 v30, v30
    v_mfma_f32_16x16x32_bf16 v[20:23], a[84:87], v[116:119], v[20:23]
    ds_read_b128 a[72:75], v1 offset:36992
    v_cvt_pk_bf16_f32 v38, v28, v29
    v_mfma_f32_16x16x32_bf16 v[20:23], a[88:91], v[120:123], v[20:23]
    v_exp_f32 v31, v31
    v_mfma_f32_16x16x32_bf16 v[20:23], a[92:95], v[124:127], v[20:23]
    ds_read_b128 a[76:79], v1 offset:37056
    v_mfma_f32_16x16x32_bf16 v[24:27], a[96:99], v[112:115], v[60:63]
    v_exp_f32 v16, v16
    v_mfma_f32_16x16x32_bf16 v[24:27], a[100:103], v[116:119], v[24:27]
    ds_read_b128 a[80:83], v1 offset:37120
    v_cvt_pk_bf16_f32 v39, v30, v31
    v_mfma_f32_16x16x32_bf16 v[24:27], a[104:107], v[120:123], v[24:27]
    v_exp_f32 v17, v17
    v_mfma_f32_16x16x32_bf16 v[24:27], a[108:111], v[124:127], v[24:27]
    ds_read_b128 a[84:87], v1 offset:37184
    v_mfma_f32_16x16x32_bf16 v[28:31], a[112:115], v[112:115], v[60:63]
    v_exp_f32 v18, v18
    v_mfma_f32_16x16x32_bf16 v[28:31], a[116:119], v[116:119], v[28:31]
    ds_read_b128 a[88:91], v1 offset:37248
    v_cvt_pk_bf16_f32 v40, v16, v17
    v_mfma_f32_16x16x32_bf16 v[28:31], a[120:123], v[120:123], v[28:31]
    v_exp_f32 v19, v19
    v_mfma_f32_16x16x32_bf16 v[28:31], a[124:127], v[124:127], v[28:31]
    ds_read_b128 a[92:95], v1 offset:37312
    v_mfma_f32_16x16x32_bf16 v[192:195], a[128:131], v[32:35], v[192:195]
    v_exp_f32 v20, v20
    v_mfma_f32_16x16x32_bf16 v[192:195], a[132:135], v[36:39], v[192:195]
    ds_read_b128 a[96:99], v1 offset:37376
    v_cvt_pk_bf16_f32 v41, v18, v19
    v_mfma_f32_16x16x32_bf16 v[196:199], a[136:139], v[32:35], v[196:199]
    v_exp_f32 v21, v21
    v_mfma_f32_16x16x32_bf16 v[196:199], a[140:143], v[36:39], v[196:199]
    ds_read_b128 a[100:103], v1 offset:37440
    v_mfma_f32_16x16x32_bf16 v[200:203], a[144:147], v[32:35], v[200:203]
    v_exp_f32 v22, v22
    v_mfma_f32_16x16x32_bf16 v[200:203], a[148:151], v[36:39], v[200:203]
    ds_read_b128 a[104:107], v1 offset:37504
    v_cvt_pk_bf16_f32 v42, v20, v21
    v_mfma_f32_16x16x32_bf16 v[204:207], a[152:155], v[32:35], v[204:207]
    v_exp_f32 v23, v23
    v_mfma_f32_16x16x32_bf16 v[204:207], a[156:159], v[36:39], v[204:207]
    ds_read_b128 a[108:111], v1 offset:37568
    v_mfma_f32_16x16x32_bf16 v[208:211], a[160:163], v[32:35], v[208:211]
    v_exp_f32 v24, v24
    v_mfma_f32_16x16x32_bf16 v[208:211], a[164:167], v[36:39], v[208:211]
    ds_read_b128 a[112:115], v1 offset:37632
    v_cvt_pk_bf16_f32 v43, v22, v23
    v_mfma_f32_16x16x32_bf16 v[212:215], a[168:171], v[32:35], v[212:215]
    v_exp_f32 v25, v25
    v_mfma_f32_16x16x32_bf16 v[212:215], a[172:175], v[36:39], v[212:215]
    ds_read_b128 a[116:119], v1 offset:37696
    v_mfma_f32_16x16x32_bf16 v[216:219], a[176:179], v[32:35], v[216:219]
    v_exp_f32 v26, v26
    v_mfma_f32_16x16x32_bf16 v[216:219], a[180:183], v[36:39], v[216:219]
    ds_read_b128 a[120:123], v1 offset:37760
    v_cvt_pk_bf16_f32 v44, v24, v25
    v_mfma_f32_16x16x32_bf16 v[220:223], a[184:187], v[32:35], v[220:223]
    v_exp_f32 v27, v27
    v_mfma_f32_16x16x32_bf16 v[220:223], a[188:191], v[36:39], v[220:223]
    ds_read_b128 a[124:127], v1 offset:37824
    v_smfmac_f32_16x16x64_bf16 a[8:11], a[16:19], v[32:39], v11
    s_waitcnt vmcnt(13) lgkmcnt(12)
    s_barrier
    v_mfma_f32_16x16x32_bf16 v[16:19], a[64:67], v[64:67], v[48:51]
    s_sub_u32 s47, s47, s48
    v_exp_f32 v28, v28
    v_mfma_f32_16x16x32_bf16 v[16:19], a[68:71], v[68:71], v[16:19]
    v_cvt_pk_bf16_f32 v45, v26, v27
    v_add_u32 v1, s48, v1
    v_mfma_f32_16x16x32_bf16 v[16:19], a[72:75], v[72:75], v[16:19]
    s_add_u32 m0, s44, 73728
    v_exp_f32 v29, v29
    v_mfma_f32_16x16x32_bf16 v[16:19], a[76:79], v[76:79], v[16:19]
    s_waitcnt lgkmcnt(8)
    s_mov_b32 s45, 0
    buffer_load_dwordx4 v7, s[28:31], s45 offen offset:0 lds
    v_mfma_f32_16x16x32_bf16 v[20:23], a[80:83], v[64:67], v[48:51]
    v_exp_f32 v30, v30
    v_mfma_f32_16x16x32_bf16 v[20:23], a[84:87], v[68:71], v[20:23]
    v_cvt_pk_bf16_f32 v46, v28, v29
    v_add_u32 v2, s48, v2
    v_mfma_f32_16x16x32_bf16 v[20:23], a[88:91], v[72:75], v[20:23]
    s_add_u32 m0, s44, 73632
    v_exp_f32 v31, v31
    v_mfma_f32_16x16x32_bf16 v[20:23], a[92:95], v[76:79], v[20:23]
    s_waitcnt lgkmcnt(4)
    buffer_load_dwordx4 v7, s[28:31], s45 offen offset:1152 lds
    v_mfma_f32_16x16x32_bf16 v[24:27], a[96:99], v[64:67], v[48:51]
    s_sub_u32 s48, 0, s48
    v_exp_f32 v16, v16
    v_mfma_f32_16x16x32_bf16 v[24:27], a[100:103], v[68:71], v[24:27]
    v_cvt_pk_bf16_f32 v47, v30, v31
    v_mfma_f32_16x16x32_bf16 v[24:27], a[104:107], v[72:75], v[24:27]
    s_add_u32 m0, s44, 73536
    v_exp_f32 v17, v17
    v_mfma_f32_16x16x32_bf16 v[24:27], a[108:111], v[76:79], v[24:27]
    s_waitcnt lgkmcnt(0)
    buffer_load_dwordx4 v7, s[28:31], s45 offen offset:2304 lds
    v_mfma_f32_16x16x32_bf16 v[28:31], a[112:115], v[64:67], v[48:51]
    v_exp_f32 v18, v18
    v_mfma_f32_16x16x32_bf16 v[28:31], a[116:119], v[68:71], v[28:31]
    v_cvt_pk_bf16_f32 v32, v16, v17
    v_mfma_f32_16x16x32_bf16 v[28:31], a[120:123], v[72:75], v[28:31]
    s_add_u32 m0, s44, 73440
    v_exp_f32 v19, v19
    v_mfma_f32_16x16x32_bf16 v[28:31], a[124:127], v[76:79], v[28:31]
    buffer_load_dwordx4 v7, s[28:31], s45 offen offset:3456 lds
    v_mfma_f32_16x16x32_bf16 v[224:227], a[128:131], v[40:43], v[224:227]
    v_exp_f32 v20, v20
    v_mfma_f32_16x16x32_bf16 v[224:227], a[132:135], v[44:47], v[224:227]
    ds_read_b64_tr_b16 a[128:129], v2 offset:0
    v_cvt_pk_bf16_f32 v33, v18, v19
    v_mfma_f32_16x16x32_bf16 v[228:231], a[136:139], v[40:43], v[228:231]
    s_add_u32 m0, s44, 90624
    v_exp_f32 v21, v21
    v_mfma_f32_16x16x32_bf16 v[228:231], a[140:143], v[44:47], v[228:231]
    s_mov_b32 s45, 147456
    buffer_load_dwordx4 v7, s[28:31], s45 offen offset:0 lds
    v_mfma_f32_16x16x32_bf16 v[232:235], a[144:147], v[40:43], v[232:235]
    v_exp_f32 v22, v22
    v_mfma_f32_16x16x32_bf16 v[232:235], a[148:151], v[44:47], v[232:235]
    ds_read_b64_tr_b16 a[130:131], v2 offset:256
    v_cvt_pk_bf16_f32 v34, v20, v21
    v_mfma_f32_16x16x32_bf16 v[236:239], a[152:155], v[40:43], v[236:239]
    s_add_u32 m0, s44, 90528
    v_exp_f32 v23, v23
    v_mfma_f32_16x16x32_bf16 v[236:239], a[156:159], v[44:47], v[236:239]
    buffer_load_dwordx4 v7, s[28:31], s45 offen offset:1152 lds
    v_mfma_f32_16x16x32_bf16 v[240:243], a[160:163], v[40:43], v[240:243]
    v_exp_f32 v24, v24
    v_mfma_f32_16x16x32_bf16 v[240:243], a[164:167], v[44:47], v[240:243]
    ds_read_b64_tr_b16 a[132:133], v2 offset:512
    v_cvt_pk_bf16_f32 v35, v22, v23
    v_mfma_f32_16x16x32_bf16 v[244:247], a[168:171], v[40:43], v[244:247]
    s_add_u32 m0, s44, 90432
    v_exp_f32 v25, v25
    v_mfma_f32_16x16x32_bf16 v[244:247], a[172:175], v[44:47], v[244:247]
    buffer_load_dwordx4 v7, s[28:31], s45 offen offset:2304 lds
    v_mfma_f32_16x16x32_bf16 v[248:251], a[176:179], v[40:43], v[248:251]
    v_exp_f32 v26, v26
    v_mfma_f32_16x16x32_bf16 v[248:251], a[180:183], v[44:47], v[248:251]
    ds_read_b64_tr_b16 a[134:135], v2 offset:768
    v_cvt_pk_bf16_f32 v36, v24, v25
    v_mfma_f32_16x16x32_bf16 v[252:255], a[184:187], v[40:43], v[252:255]
    s_add_u32 m0, s44, 90336
    v_exp_f32 v27, v27
    v_mfma_f32_16x16x32_bf16 v[252:255], a[188:191], v[44:47], v[252:255]
    buffer_load_dwordx4 v7, s[28:31], s45 offen offset:3456 lds
    v_smfmac_f32_16x16x64_bf16 a[12:15], a[16:19], v[40:47], v11
    ds_read_b64_tr_b16 a[136:137], v2 offset:32
    v_mfma_f32_16x16x32_bf16 v[16:19], a[64:67], v[80:83], v[52:55]
    v_exp_f32 v28, v28
    v_mfma_f32_16x16x32_bf16 v[16:19], a[68:71], v[84:87], v[16:19]
    ds_read_b64_tr_b16 a[138:139], v2 offset:288
    v_cvt_pk_bf16_f32 v37, v26, v27
    v_mfma_f32_16x16x32_bf16 v[16:19], a[72:75], v[88:91], v[16:19]
    v_exp_f32 v29, v29
    v_mfma_f32_16x16x32_bf16 v[16:19], a[76:79], v[92:95], v[16:19]
    ds_read_b64_tr_b16 a[140:141], v2 offset:544
    v_mfma_f32_16x16x32_bf16 v[20:23], a[80:83], v[80:83], v[52:55]
    v_exp_f32 v30, v30
    v_mfma_f32_16x16x32_bf16 v[20:23], a[84:87], v[84:87], v[20:23]
    ds_read_b64_tr_b16 a[142:143], v2 offset:800
    v_cvt_pk_bf16_f32 v38, v28, v29
    v_mfma_f32_16x16x32_bf16 v[20:23], a[88:91], v[88:91], v[20:23]
    v_exp_f32 v31, v31
    v_mfma_f32_16x16x32_bf16 v[20:23], a[92:95], v[92:95], v[20:23]
    ds_read_b64_tr_b16 a[144:145], v2 offset:64
    v_mfma_f32_16x16x32_bf16 v[24:27], a[96:99], v[80:83], v[52:55]
    v_exp_f32 v16, v16
    v_mfma_f32_16x16x32_bf16 v[24:27], a[100:103], v[84:87], v[24:27]
    ds_read_b64_tr_b16 a[146:147], v2 offset:320
    v_cvt_pk_bf16_f32 v39, v30, v31
    v_mfma_f32_16x16x32_bf16 v[24:27], a[104:107], v[88:91], v[24:27]
    v_exp_f32 v17, v17
    v_mfma_f32_16x16x32_bf16 v[24:27], a[108:111], v[92:95], v[24:27]
    ds_read_b64_tr_b16 a[148:149], v2 offset:576
    v_mfma_f32_16x16x32_bf16 v[28:31], a[112:115], v[80:83], v[52:55]
    v_exp_f32 v18, v18
    v_mfma_f32_16x16x32_bf16 v[28:31], a[116:119], v[84:87], v[28:31]
    ds_read_b64_tr_b16 a[150:151], v2 offset:832
    v_cvt_pk_bf16_f32 v40, v16, v17
    v_mfma_f32_16x16x32_bf16 v[28:31], a[120:123], v[88:91], v[28:31]
    v_exp_f32 v19, v19
    v_mfma_f32_16x16x32_bf16 v[28:31], a[124:127], v[92:95], v[28:31]
    ds_read_b64_tr_b16 a[152:153], v2 offset:96
    v_mfma_f32_16x16x32_bf16 v[128:131], a[192:195], v[32:35], v[128:131]
    v_exp_f32 v20, v20
    v_mfma_f32_16x16x32_bf16 v[128:131], a[196:199], v[36:39], v[128:131]
    ds_read_b64_tr_b16 a[154:155], v2 offset:352
    v_cvt_pk_bf16_f32 v41, v18, v19
    v_mfma_f32_16x16x32_bf16 v[132:135], a[200:203], v[32:35], v[132:135]
    v_exp_f32 v21, v21
    v_mfma_f32_16x16x32_bf16 v[132:135], a[204:207], v[36:39], v[132:135]
    ds_read_b64_tr_b16 a[156:157], v2 offset:608
    v_mfma_f32_16x16x32_bf16 v[136:139], a[208:211], v[32:35], v[136:139]
    v_exp_f32 v22, v22
    v_mfma_f32_16x16x32_bf16 v[136:139], a[212:215], v[36:39], v[136:139]
    ds_read_b64_tr_b16 a[158:159], v2 offset:864
    v_cvt_pk_bf16_f32 v42, v20, v21
    v_mfma_f32_16x16x32_bf16 v[140:143], a[216:219], v[32:35], v[140:143]
    v_exp_f32 v23, v23
    v_mfma_f32_16x16x32_bf16 v[140:143], a[220:223], v[36:39], v[140:143]
    ds_read_b64_tr_b16 a[160:161], v2 offset:128
    v_mfma_f32_16x16x32_bf16 v[144:147], a[224:227], v[32:35], v[144:147]
    v_exp_f32 v24, v24
    v_mfma_f32_16x16x32_bf16 v[144:147], a[228:231], v[36:39], v[144:147]
    ds_read_b64_tr_b16 a[162:163], v2 offset:384
    v_cvt_pk_bf16_f32 v43, v22, v23
    v_mfma_f32_16x16x32_bf16 v[148:151], a[232:235], v[32:35], v[148:151]
    v_exp_f32 v25, v25
    v_mfma_f32_16x16x32_bf16 v[148:151], a[236:239], v[36:39], v[148:151]
    ds_read_b64_tr_b16 a[164:165], v2 offset:640
    v_mfma_f32_16x16x32_bf16 v[152:155], a[240:243], v[32:35], v[152:155]
    v_exp_f32 v26, v26
    v_mfma_f32_16x16x32_bf16 v[152:155], a[244:247], v[36:39], v[152:155]
    ds_read_b64_tr_b16 a[166:167], v2 offset:896
    v_cvt_pk_bf16_f32 v44, v24, v25
    v_mfma_f32_16x16x32_bf16 v[156:159], a[248:251], v[32:35], v[156:159]
    v_exp_f32 v27, v27
    v_mfma_f32_16x16x32_bf16 v[156:159], a[252:255], v[36:39], v[156:159]
    ds_read_b64_tr_b16 a[168:169], v2 offset:160
    v_smfmac_f32_16x16x64_bf16 a[0:3], a[16:19], v[32:39], v11
    ds_read_b64_tr_b16 a[170:171], v2 offset:416
    v_mfma_f32_16x16x32_bf16 v[16:19], a[64:67], v[96:99], v[56:59]
    v_exp_f32 v28, v28
    v_mfma_f32_16x16x32_bf16 v[16:19], a[68:71], v[100:103], v[16:19]
    ds_read_b64_tr_b16 a[172:173], v2 offset:672
    v_cvt_pk_bf16_f32 v45, v26, v27
    v_mfma_f32_16x16x32_bf16 v[16:19], a[72:75], v[104:107], v[16:19]
    v_exp_f32 v29, v29
    v_mfma_f32_16x16x32_bf16 v[16:19], a[76:79], v[108:111], v[16:19]
    ds_read_b64_tr_b16 a[174:175], v2 offset:928
    v_mfma_f32_16x16x32_bf16 v[20:23], a[80:83], v[96:99], v[56:59]
    v_exp_f32 v30, v30
    v_mfma_f32_16x16x32_bf16 v[20:23], a[84:87], v[100:103], v[20:23]
    ds_read_b64_tr_b16 a[176:177], v2 offset:192
    v_cvt_pk_bf16_f32 v46, v28, v29
    v_mfma_f32_16x16x32_bf16 v[20:23], a[88:91], v[104:107], v[20:23]
    v_exp_f32 v31, v31
    v_mfma_f32_16x16x32_bf16 v[20:23], a[92:95], v[108:111], v[20:23]
    ds_read_b64_tr_b16 a[178:179], v2 offset:448
    v_mfma_f32_16x16x32_bf16 v[24:27], a[96:99], v[96:99], v[56:59]
    v_exp_f32 v16, v16
    v_mfma_f32_16x16x32_bf16 v[24:27], a[100:103], v[100:103], v[24:27]
    ds_read_b64_tr_b16 a[180:181], v2 offset:704
    v_cvt_pk_bf16_f32 v47, v30, v31
    v_mfma_f32_16x16x32_bf16 v[24:27], a[104:107], v[104:107], v[24:27]
    v_exp_f32 v17, v17
    v_mfma_f32_16x16x32_bf16 v[24:27], a[108:111], v[108:111], v[24:27]
    ds_read_b64_tr_b16 a[182:183], v2 offset:960
    v_mfma_f32_16x16x32_bf16 v[28:31], a[112:115], v[96:99], v[56:59]
    v_exp_f32 v18, v18
    v_mfma_f32_16x16x32_bf16 v[28:31], a[116:119], v[100:103], v[28:31]
    ds_read_b64_tr_b16 a[184:185], v2 offset:224
    v_cvt_pk_bf16_f32 v32, v16, v17
    v_mfma_f32_16x16x32_bf16 v[28:31], a[120:123], v[104:107], v[28:31]
    v_exp_f32 v19, v19
    v_mfma_f32_16x16x32_bf16 v[28:31], a[124:127], v[108:111], v[28:31]
    ds_read_b64_tr_b16 a[186:187], v2 offset:480
    v_mfma_f32_16x16x32_bf16 v[160:163], a[192:195], v[40:43], v[160:163]
    v_exp_f32 v20, v20
    v_mfma_f32_16x16x32_bf16 v[160:163], a[196:199], v[44:47], v[160:163]
    ds_read_b64_tr_b16 a[188:189], v2 offset:736
    v_cvt_pk_bf16_f32 v33, v18, v19
    v_mfma_f32_16x16x32_bf16 v[164:167], a[200:203], v[40:43], v[164:167]
    v_exp_f32 v21, v21
    v_mfma_f32_16x16x32_bf16 v[164:167], a[204:207], v[44:47], v[164:167]
    ds_read_b64_tr_b16 a[190:191], v2 offset:992
    v_mfma_f32_16x16x32_bf16 v[168:171], a[208:211], v[40:43], v[168:171]
    v_exp_f32 v22, v22
    v_mfma_f32_16x16x32_bf16 v[168:171], a[212:215], v[44:47], v[168:171]
    v_cvt_pk_bf16_f32 v34, v20, v21
    v_mfma_f32_16x16x32_bf16 v[172:175], a[216:219], v[40:43], v[172:175]
    v_exp_f32 v23, v23
    v_mfma_f32_16x16x32_bf16 v[172:175], a[220:223], v[44:47], v[172:175]
    v_mfma_f32_16x16x32_bf16 v[176:179], a[224:227], v[40:43], v[176:179]
    v_exp_f32 v24, v24
    v_mfma_f32_16x16x32_bf16 v[176:179], a[228:231], v[44:47], v[176:179]
    v_cvt_pk_bf16_f32 v35, v22, v23
    v_mfma_f32_16x16x32_bf16 v[180:183], a[232:235], v[40:43], v[180:183]
    v_exp_f32 v25, v25
    v_mfma_f32_16x16x32_bf16 v[180:183], a[236:239], v[44:47], v[180:183]
    v_mfma_f32_16x16x32_bf16 v[184:187], a[240:243], v[40:43], v[184:187]
    v_exp_f32 v26, v26
    v_mfma_f32_16x16x32_bf16 v[184:187], a[244:247], v[44:47], v[184:187]
    v_cvt_pk_bf16_f32 v36, v24, v25
    v_mfma_f32_16x16x32_bf16 v[188:191], a[248:251], v[40:43], v[188:191]
    v_exp_f32 v27, v27
    v_mfma_f32_16x16x32_bf16 v[188:191], a[252:255], v[44:47], v[188:191]
    v_smfmac_f32_16x16x64_bf16 a[4:7], a[16:19], v[40:47], v11
    v_mfma_f32_16x16x32_bf16 v[16:19], a[64:67], v[112:115], v[60:63]
    v_exp_f32 v28, v28
    v_mfma_f32_16x16x32_bf16 v[16:19], a[68:71], v[116:119], v[16:19]
    s_add_u32 s46, s46, 16384
    ds_read_b128 a[64:67], v1 offset:0
    v_cvt_pk_bf16_f32 v37, v26, v27
    v_mfma_f32_16x16x32_bf16 v[16:19], a[72:75], v[120:123], v[16:19]
    v_exp_f32 v29, v29
    v_mfma_f32_16x16x32_bf16 v[16:19], a[76:79], v[124:127], v[16:19]
    ds_read_b128 a[68:71], v1 offset:64
    v_mfma_f32_16x16x32_bf16 v[20:23], a[80:83], v[112:115], v[60:63]
    v_exp_f32 v30, v30
    v_mfma_f32_16x16x32_bf16 v[20:23], a[84:87], v[116:119], v[20:23]
    ds_read_b128 a[72:75], v1 offset:128
    v_cvt_pk_bf16_f32 v38, v28, v29
    v_mfma_f32_16x16x32_bf16 v[20:23], a[88:91], v[120:123], v[20:23]
    v_exp_f32 v31, v31
    v_mfma_f32_16x16x32_bf16 v[20:23], a[92:95], v[124:127], v[20:23]
    ds_read_b128 a[76:79], v1 offset:192
    v_mfma_f32_16x16x32_bf16 v[24:27], a[96:99], v[112:115], v[60:63]
    v_exp_f32 v16, v16
    v_mfma_f32_16x16x32_bf16 v[24:27], a[100:103], v[116:119], v[24:27]
    ds_read_b128 a[80:83], v1 offset:256
    v_cvt_pk_bf16_f32 v39, v30, v31
    v_mfma_f32_16x16x32_bf16 v[24:27], a[104:107], v[120:123], v[24:27]
    v_exp_f32 v17, v17
    v_mfma_f32_16x16x32_bf16 v[24:27], a[108:111], v[124:127], v[24:27]
    ds_read_b128 a[84:87], v1 offset:320
    v_mfma_f32_16x16x32_bf16 v[28:31], a[112:115], v[112:115], v[60:63]
    v_exp_f32 v18, v18
    v_mfma_f32_16x16x32_bf16 v[28:31], a[116:119], v[116:119], v[28:31]
    ds_read_b128 a[88:91], v1 offset:384
    v_cvt_pk_bf16_f32 v40, v16, v17
    v_mfma_f32_16x16x32_bf16 v[28:31], a[120:123], v[120:123], v[28:31]
    v_exp_f32 v19, v19
    v_mfma_f32_16x16x32_bf16 v[28:31], a[124:127], v[124:127], v[28:31]
    ds_read_b128 a[92:95], v1 offset:448
    v_mfma_f32_16x16x32_bf16 v[192:195], a[192:195], v[32:35], v[192:195]
    v_exp_f32 v20, v20
    v_mfma_f32_16x16x32_bf16 v[192:195], a[196:199], v[36:39], v[192:195]
    ds_read_b128 a[96:99], v1 offset:512
    v_cvt_pk_bf16_f32 v41, v18, v19
    v_mfma_f32_16x16x32_bf16 v[196:199], a[200:203], v[32:35], v[196:199]
    v_exp_f32 v21, v21
    v_mfma_f32_16x16x32_bf16 v[196:199], a[204:207], v[36:39], v[196:199]
    ds_read_b128 a[100:103], v1 offset:576
    v_mfma_f32_16x16x32_bf16 v[200:203], a[208:211], v[32:35], v[200:203]
    v_exp_f32 v22, v22
    v_mfma_f32_16x16x32_bf16 v[200:203], a[212:215], v[36:39], v[200:203]
    ds_read_b128 a[104:107], v1 offset:640
    v_cvt_pk_bf16_f32 v42, v20, v21
    v_mfma_f32_16x16x32_bf16 v[204:207], a[216:219], v[32:35], v[204:207]
    v_exp_f32 v23, v23
    v_mfma_f32_16x16x32_bf16 v[204:207], a[220:223], v[36:39], v[204:207]
    ds_read_b128 a[108:111], v1 offset:704
    v_mfma_f32_16x16x32_bf16 v[208:211], a[224:227], v[32:35], v[208:211]
    v_exp_f32 v24, v24
    v_mfma_f32_16x16x32_bf16 v[208:211], a[228:231], v[36:39], v[208:211]
    ds_read_b128 a[112:115], v1 offset:768
    v_cvt_pk_bf16_f32 v43, v22, v23
    v_mfma_f32_16x16x32_bf16 v[212:215], a[232:235], v[32:35], v[212:215]
    v_exp_f32 v25, v25
    v_mfma_f32_16x16x32_bf16 v[212:215], a[236:239], v[36:39], v[212:215]
    ds_read_b128 a[116:119], v1 offset:832
    v_mfma_f32_16x16x32_bf16 v[216:219], a[240:243], v[32:35], v[216:219]
    v_exp_f32 v26, v26
    v_mfma_f32_16x16x32_bf16 v[216:219], a[244:247], v[36:39], v[216:219]
    ds_read_b128 a[120:123], v1 offset:896
    v_cvt_pk_bf16_f32 v44, v24, v25
    v_mfma_f32_16x16x32_bf16 v[220:223], a[248:251], v[32:35], v[220:223]
    v_exp_f32 v27, v27
    v_mfma_f32_16x16x32_bf16 v[220:223], a[252:255], v[36:39], v[220:223]
    ds_read_b128 a[124:127], v1 offset:960
    v_smfmac_f32_16x16x64_bf16 a[8:11], a[16:19], v[32:39], v11
    s_waitcnt vmcnt(9) lgkmcnt(12)
    s_barrier
    v_mfma_f32_16x16x32_bf16 v[16:19], a[64:67], v[64:67], v[48:51]
    v_exp_f32 v28, v28
    v_mfma_f32_16x16x32_bf16 v[16:19], a[68:71], v[68:71], v[16:19]
    v_cvt_pk_bf16_f32 v45, v26, v27
    v_mfma_f32_16x16x32_bf16 v[16:19], a[72:75], v[72:75], v[16:19]
    s_add_u32 m0, s44, 110592
    v_exp_f32 v29, v29
    v_mfma_f32_16x16x32_bf16 v[16:19], a[76:79], v[76:79], v[16:19]
    s_waitcnt lgkmcnt(8)
    s_mov_b32 s45, 128
    buffer_load_dwordx4 v7, s[28:31], s45 offen offset:0 lds
    v_mfma_f32_16x16x32_bf16 v[20:23], a[80:83], v[64:67], v[48:51]
    v_exp_f32 v30, v30
    v_mfma_f32_16x16x32_bf16 v[20:23], a[84:87], v[68:71], v[20:23]
    v_cvt_pk_bf16_f32 v46, v28, v29
    v_mfma_f32_16x16x32_bf16 v[20:23], a[88:91], v[72:75], v[20:23]
    s_add_u32 m0, s44, 110496
    v_exp_f32 v31, v31
    v_mfma_f32_16x16x32_bf16 v[20:23], a[92:95], v[76:79], v[20:23]
    s_waitcnt lgkmcnt(4)
    buffer_load_dwordx4 v7, s[28:31], s45 offen offset:1152 lds
    v_mfma_f32_16x16x32_bf16 v[24:27], a[96:99], v[64:67], v[48:51]
    v_exp_f32 v16, v16
    v_mfma_f32_16x16x32_bf16 v[24:27], a[100:103], v[68:71], v[24:27]
    v_cvt_pk_bf16_f32 v47, v30, v31
    v_mfma_f32_16x16x32_bf16 v[24:27], a[104:107], v[72:75], v[24:27]
    s_add_u32 m0, s44, 110400
    v_exp_f32 v17, v17
    v_mfma_f32_16x16x32_bf16 v[24:27], a[108:111], v[76:79], v[24:27]
    s_waitcnt lgkmcnt(0)
    buffer_load_dwordx4 v7, s[28:31], s45 offen offset:2304 lds
    v_mfma_f32_16x16x32_bf16 v[28:31], a[112:115], v[64:67], v[48:51]
    v_exp_f32 v18, v18
    v_mfma_f32_16x16x32_bf16 v[28:31], a[116:119], v[68:71], v[28:31]
    v_cvt_pk_bf16_f32 v32, v16, v17
    v_mfma_f32_16x16x32_bf16 v[28:31], a[120:123], v[72:75], v[28:31]
    s_add_u32 m0, s44, 110304
    v_exp_f32 v19, v19
    v_mfma_f32_16x16x32_bf16 v[28:31], a[124:127], v[76:79], v[28:31]
    buffer_load_dwordx4 v7, s[28:31], s45 offen offset:3456 lds
    v_mfma_f32_16x16x32_bf16 v[224:227], a[192:195], v[40:43], v[224:227]
    v_exp_f32 v20, v20
    v_mfma_f32_16x16x32_bf16 v[224:227], a[196:199], v[44:47], v[224:227]
    ds_read_b64_tr_b16 a[192:193], v2 offset:36864
    v_cvt_pk_bf16_f32 v33, v18, v19
    v_mfma_f32_16x16x32_bf16 v[228:231], a[200:203], v[40:43], v[228:231]
    s_add_u32 m0, s44, 127488
    v_exp_f32 v21, v21
    v_mfma_f32_16x16x32_bf16 v[228:231], a[204:207], v[44:47], v[228:231]
    s_mov_b32 s45, 147584
    buffer_load_dwordx4 v7, s[28:31], s45 offen offset:0 lds
    v_mfma_f32_16x16x32_bf16 v[232:235], a[208:211], v[40:43], v[232:235]
    v_exp_f32 v22, v22
    v_mfma_f32_16x16x32_bf16 v[232:235], a[212:215], v[44:47], v[232:235]
    ds_read_b64_tr_b16 a[194:195], v2 offset:37120
    v_cvt_pk_bf16_f32 v34, v20, v21
    v_mfma_f32_16x16x32_bf16 v[236:239], a[216:219], v[40:43], v[236:239]
    s_add_u32 m0, s44, 127392
    v_exp_f32 v23, v23
    v_mfma_f32_16x16x32_bf16 v[236:239], a[220:223], v[44:47], v[236:239]
    buffer_load_dwordx4 v7, s[28:31], s45 offen offset:1152 lds
    v_mfma_f32_16x16x32_bf16 v[240:243], a[224:227], v[40:43], v[240:243]
    v_exp_f32 v24, v24
    v_mfma_f32_16x16x32_bf16 v[240:243], a[228:231], v[44:47], v[240:243]
    ds_read_b64_tr_b16 a[196:197], v2 offset:37376
    v_cvt_pk_bf16_f32 v35, v22, v23
    v_mfma_f32_16x16x32_bf16 v[244:247], a[232:235], v[40:43], v[244:247]
    s_add_u32 m0, s44, 127296
    v_exp_f32 v25, v25
    v_mfma_f32_16x16x32_bf16 v[244:247], a[236:239], v[44:47], v[244:247]
    buffer_load_dwordx4 v7, s[28:31], s45 offen offset:2304 lds
    v_mfma_f32_16x16x32_bf16 v[248:251], a[240:243], v[40:43], v[248:251]
    v_exp_f32 v26, v26
    v_mfma_f32_16x16x32_bf16 v[248:251], a[244:247], v[44:47], v[248:251]
    ds_read_b64_tr_b16 a[198:199], v2 offset:37632
    v_cvt_pk_bf16_f32 v36, v24, v25
    v_mfma_f32_16x16x32_bf16 v[252:255], a[248:251], v[40:43], v[252:255]
    s_add_u32 m0, s44, 127200
    v_exp_f32 v27, v27
    v_mfma_f32_16x16x32_bf16 v[252:255], a[252:255], v[44:47], v[252:255]
    buffer_load_dwordx4 v7, s[28:31], s45 offen offset:3456 lds
    v_smfmac_f32_16x16x64_bf16 a[12:15], a[16:19], v[40:47], v11
    ds_read_b64_tr_b16 a[200:201], v2 offset:36896
    v_mfma_f32_16x16x32_bf16 v[16:19], a[64:67], v[80:83], v[52:55]
    v_exp_f32 v28, v28
    v_mfma_f32_16x16x32_bf16 v[16:19], a[68:71], v[84:87], v[16:19]
    ds_read_b64_tr_b16 a[202:203], v2 offset:37152
    v_cvt_pk_bf16_f32 v37, v26, v27
    v_mfma_f32_16x16x32_bf16 v[16:19], a[72:75], v[88:91], v[16:19]
    v_exp_f32 v29, v29
    v_mfma_f32_16x16x32_bf16 v[16:19], a[76:79], v[92:95], v[16:19]
    ds_read_b64_tr_b16 a[204:205], v2 offset:37408
    v_mfma_f32_16x16x32_bf16 v[20:23], a[80:83], v[80:83], v[52:55]
    v_exp_f32 v30, v30
    v_mfma_f32_16x16x32_bf16 v[20:23], a[84:87], v[84:87], v[20:23]
    ds_read_b64_tr_b16 a[206:207], v2 offset:37664
    v_cvt_pk_bf16_f32 v38, v28, v29
    v_mfma_f32_16x16x32_bf16 v[20:23], a[88:91], v[88:91], v[20:23]
    v_exp_f32 v31, v31
    v_mfma_f32_16x16x32_bf16 v[20:23], a[92:95], v[92:95], v[20:23]
    ds_read_b64_tr_b16 a[208:209], v2 offset:36928
    v_mfma_f32_16x16x32_bf16 v[24:27], a[96:99], v[80:83], v[52:55]
    v_exp_f32 v16, v16
    v_mfma_f32_16x16x32_bf16 v[24:27], a[100:103], v[84:87], v[24:27]
    ds_read_b64_tr_b16 a[210:211], v2 offset:37184
    v_cvt_pk_bf16_f32 v39, v30, v31
    v_mfma_f32_16x16x32_bf16 v[24:27], a[104:107], v[88:91], v[24:27]
    v_exp_f32 v17, v17
    v_mfma_f32_16x16x32_bf16 v[24:27], a[108:111], v[92:95], v[24:27]
    ds_read_b64_tr_b16 a[212:213], v2 offset:37440
    v_mfma_f32_16x16x32_bf16 v[28:31], a[112:115], v[80:83], v[52:55]
    v_exp_f32 v18, v18
    v_mfma_f32_16x16x32_bf16 v[28:31], a[116:119], v[84:87], v[28:31]
    ds_read_b64_tr_b16 a[214:215], v2 offset:37696
    v_cvt_pk_bf16_f32 v40, v16, v17
    v_mfma_f32_16x16x32_bf16 v[28:31], a[120:123], v[88:91], v[28:31]
    v_exp_f32 v19, v19
    v_mfma_f32_16x16x32_bf16 v[28:31], a[124:127], v[92:95], v[28:31]
    ds_read_b64_tr_b16 a[216:217], v2 offset:36960
    v_mfma_f32_16x16x32_bf16 v[128:131], a[128:131], v[32:35], v[128:131]
    v_exp_f32 v20, v20
    v_mfma_f32_16x16x32_bf16 v[128:131], a[132:135], v[36:39], v[128:131]
    ds_read_b64_tr_b16 a[218:219], v2 offset:37216
    v_cvt_pk_bf16_f32 v41, v18, v19
    v_mfma_f32_16x16x32_bf16 v[132:135], a[136:139], v[32:35], v[132:135]
    v_exp_f32 v21, v21
    v_mfma_f32_16x16x32_bf16 v[132:135], a[140:143], v[36:39], v[132:135]
    ds_read_b64_tr_b16 a[220:221], v2 offset:37472
    v_mfma_f32_16x16x32_bf16 v[136:139], a[144:147], v[32:35], v[136:139]
    v_exp_f32 v22, v22
    v_mfma_f32_16x16x32_bf16 v[136:139], a[148:151], v[36:39], v[136:139]
    ds_read_b64_tr_b16 a[222:223], v2 offset:37728
    v_cvt_pk_bf16_f32 v42, v20, v21
    v_mfma_f32_16x16x32_bf16 v[140:143], a[152:155], v[32:35], v[140:143]
    v_exp_f32 v23, v23
    v_mfma_f32_16x16x32_bf16 v[140:143], a[156:159], v[36:39], v[140:143]
    ds_read_b64_tr_b16 a[224:225], v2 offset:36992
    v_mfma_f32_16x16x32_bf16 v[144:147], a[160:163], v[32:35], v[144:147]
    v_exp_f32 v24, v24
    v_mfma_f32_16x16x32_bf16 v[144:147], a[164:167], v[36:39], v[144:147]
    ds_read_b64_tr_b16 a[226:227], v2 offset:37248
    v_cvt_pk_bf16_f32 v43, v22, v23
    v_mfma_f32_16x16x32_bf16 v[148:151], a[168:171], v[32:35], v[148:151]
    v_exp_f32 v25, v25
    v_mfma_f32_16x16x32_bf16 v[148:151], a[172:175], v[36:39], v[148:151]
    ds_read_b64_tr_b16 a[228:229], v2 offset:37504
    v_mfma_f32_16x16x32_bf16 v[152:155], a[176:179], v[32:35], v[152:155]
    v_exp_f32 v26, v26
    v_mfma_f32_16x16x32_bf16 v[152:155], a[180:183], v[36:39], v[152:155]
    ds_read_b64_tr_b16 a[230:231], v2 offset:37760
    v_cvt_pk_bf16_f32 v44, v24, v25
    v_mfma_f32_16x16x32_bf16 v[156:159], a[184:187], v[32:35], v[156:159]
    v_exp_f32 v27, v27
    v_mfma_f32_16x16x32_bf16 v[156:159], a[188:191], v[36:39], v[156:159]
    ds_read_b64_tr_b16 a[232:233], v2 offset:37024
    v_smfmac_f32_16x16x64_bf16 a[0:3], a[16:19], v[32:39], v11
    ds_read_b64_tr_b16 a[234:235], v2 offset:37280
    v_mfma_f32_16x16x32_bf16 v[16:19], a[64:67], v[96:99], v[56:59]
    v_exp_f32 v28, v28
    v_mfma_f32_16x16x32_bf16 v[16:19], a[68:71], v[100:103], v[16:19]
    ds_read_b64_tr_b16 a[236:237], v2 offset:37536
    v_cvt_pk_bf16_f32 v45, v26, v27
    v_mfma_f32_16x16x32_bf16 v[16:19], a[72:75], v[104:107], v[16:19]
    v_exp_f32 v29, v29
    v_mfma_f32_16x16x32_bf16 v[16:19], a[76:79], v[108:111], v[16:19]
    ds_read_b64_tr_b16 a[238:239], v2 offset:37792
    v_mfma_f32_16x16x32_bf16 v[20:23], a[80:83], v[96:99], v[56:59]
    v_exp_f32 v30, v30
    v_mfma_f32_16x16x32_bf16 v[20:23], a[84:87], v[100:103], v[20:23]
    ds_read_b64_tr_b16 a[240:241], v2 offset:37056
    v_cvt_pk_bf16_f32 v46, v28, v29
    v_mfma_f32_16x16x32_bf16 v[20:23], a[88:91], v[104:107], v[20:23]
    v_exp_f32 v31, v31
    v_mfma_f32_16x16x32_bf16 v[20:23], a[92:95], v[108:111], v[20:23]
    ds_read_b64_tr_b16 a[242:243], v2 offset:37312
    v_mfma_f32_16x16x32_bf16 v[24:27], a[96:99], v[96:99], v[56:59]
    v_exp_f32 v16, v16
    v_mfma_f32_16x16x32_bf16 v[24:27], a[100:103], v[100:103], v[24:27]
    ds_read_b64_tr_b16 a[244:245], v2 offset:37568
    v_cvt_pk_bf16_f32 v47, v30, v31
    v_mfma_f32_16x16x32_bf16 v[24:27], a[104:107], v[104:107], v[24:27]
    v_exp_f32 v17, v17
    v_mfma_f32_16x16x32_bf16 v[24:27], a[108:111], v[108:111], v[24:27]
    ds_read_b64_tr_b16 a[246:247], v2 offset:37824
    v_mfma_f32_16x16x32_bf16 v[28:31], a[112:115], v[96:99], v[56:59]
    v_exp_f32 v18, v18
    v_mfma_f32_16x16x32_bf16 v[28:31], a[116:119], v[100:103], v[28:31]
    ds_read_b64_tr_b16 a[248:249], v2 offset:37088
    v_cvt_pk_bf16_f32 v32, v16, v17
    v_mfma_f32_16x16x32_bf16 v[28:31], a[120:123], v[104:107], v[28:31]
    v_exp_f32 v19, v19
    v_mfma_f32_16x16x32_bf16 v[28:31], a[124:127], v[108:111], v[28:31]
    ds_read_b64_tr_b16 a[250:251], v2 offset:37344
    v_mfma_f32_16x16x32_bf16 v[160:163], a[128:131], v[40:43], v[160:163]
    v_exp_f32 v20, v20
    v_mfma_f32_16x16x32_bf16 v[160:163], a[132:135], v[44:47], v[160:163]
    ds_read_b64_tr_b16 a[252:253], v2 offset:37600
    v_cvt_pk_bf16_f32 v33, v18, v19
    v_mfma_f32_16x16x32_bf16 v[164:167], a[136:139], v[40:43], v[164:167]
    v_exp_f32 v21, v21
    v_mfma_f32_16x16x32_bf16 v[164:167], a[140:143], v[44:47], v[164:167]
    ds_read_b64_tr_b16 a[254:255], v2 offset:37856
    v_mfma_f32_16x16x32_bf16 v[168:171], a[144:147], v[40:43], v[168:171]
    v_exp_f32 v22, v22
    v_mfma_f32_16x16x32_bf16 v[168:171], a[148:151], v[44:47], v[168:171]
    v_cvt_pk_bf16_f32 v34, v20, v21
    v_mfma_f32_16x16x32_bf16 v[172:175], a[152:155], v[40:43], v[172:175]
    v_exp_f32 v23, v23
    v_mfma_f32_16x16x32_bf16 v[172:175], a[156:159], v[44:47], v[172:175]
    v_mfma_f32_16x16x32_bf16 v[176:179], a[160:163], v[40:43], v[176:179]
    v_exp_f32 v24, v24
    v_mfma_f32_16x16x32_bf16 v[176:179], a[164:167], v[44:47], v[176:179]
    v_cvt_pk_bf16_f32 v35, v22, v23
    v_mfma_f32_16x16x32_bf16 v[180:183], a[168:171], v[40:43], v[180:183]
    v_exp_f32 v25, v25
    v_mfma_f32_16x16x32_bf16 v[180:183], a[172:175], v[44:47], v[180:183]
    v_mfma_f32_16x16x32_bf16 v[184:187], a[176:179], v[40:43], v[184:187]
    v_exp_f32 v26, v26
    v_mfma_f32_16x16x32_bf16 v[184:187], a[180:183], v[44:47], v[184:187]
    v_cvt_pk_bf16_f32 v36, v24, v25
    v_mfma_f32_16x16x32_bf16 v[188:191], a[184:187], v[40:43], v[188:191]
    v_exp_f32 v27, v27
    v_mfma_f32_16x16x32_bf16 v[188:191], a[188:191], v[44:47], v[188:191]
    v_smfmac_f32_16x16x64_bf16 a[4:7], a[16:19], v[40:47], v11
    v_mfma_f32_16x16x32_bf16 v[16:19], a[64:67], v[112:115], v[60:63]
    v_exp_f32 v28, v28
    v_mfma_f32_16x16x32_bf16 v[16:19], a[68:71], v[116:119], v[16:19]
    s_add_u32 s46, s46, 16384
    ds_read_b128 a[64:67], v1 offset:36864
    v_cvt_pk_bf16_f32 v37, v26, v27
    v_mfma_f32_16x16x32_bf16 v[16:19], a[72:75], v[120:123], v[16:19]
    v_exp_f32 v29, v29
    v_mfma_f32_16x16x32_bf16 v[16:19], a[76:79], v[124:127], v[16:19]
    ds_read_b128 a[68:71], v1 offset:36928
    v_mfma_f32_16x16x32_bf16 v[20:23], a[80:83], v[112:115], v[60:63]
    v_exp_f32 v30, v30
    v_mfma_f32_16x16x32_bf16 v[20:23], a[84:87], v[116:119], v[20:23]
    ds_read_b128 a[72:75], v1 offset:36992
    v_cvt_pk_bf16_f32 v38, v28, v29
    v_mfma_f32_16x16x32_bf16 v[20:23], a[88:91], v[120:123], v[20:23]
    v_exp_f32 v31, v31
    v_mfma_f32_16x16x32_bf16 v[20:23], a[92:95], v[124:127], v[20:23]
    ds_read_b128 a[76:79], v1 offset:37056
    v_mfma_f32_16x16x32_bf16 v[24:27], a[96:99], v[112:115], v[60:63]
    v_exp_f32 v16, v16
    v_mfma_f32_16x16x32_bf16 v[24:27], a[100:103], v[116:119], v[24:27]
    ds_read_b128 a[80:83], v1 offset:37120
    v_cvt_pk_bf16_f32 v39, v30, v31
    v_mfma_f32_16x16x32_bf16 v[24:27], a[104:107], v[120:123], v[24:27]
    v_exp_f32 v17, v17
    v_mfma_f32_16x16x32_bf16 v[24:27], a[108:111], v[124:127], v[24:27]
    ds_read_b128 a[84:87], v1 offset:37184
    v_mfma_f32_16x16x32_bf16 v[28:31], a[112:115], v[112:115], v[60:63]
    v_exp_f32 v18, v18
    v_mfma_f32_16x16x32_bf16 v[28:31], a[116:119], v[116:119], v[28:31]
    ds_read_b128 a[88:91], v1 offset:37248
    v_cvt_pk_bf16_f32 v40, v16, v17
    v_mfma_f32_16x16x32_bf16 v[28:31], a[120:123], v[120:123], v[28:31]
    v_exp_f32 v19, v19
    v_mfma_f32_16x16x32_bf16 v[28:31], a[124:127], v[124:127], v[28:31]
    ds_read_b128 a[92:95], v1 offset:37312
    v_mfma_f32_16x16x32_bf16 v[192:195], a[128:131], v[32:35], v[192:195]
    v_exp_f32 v20, v20
    v_mfma_f32_16x16x32_bf16 v[192:195], a[132:135], v[36:39], v[192:195]
    ds_read_b128 a[96:99], v1 offset:37376
    v_cvt_pk_bf16_f32 v41, v18, v19
    v_mfma_f32_16x16x32_bf16 v[196:199], a[136:139], v[32:35], v[196:199]
    v_exp_f32 v21, v21
    v_mfma_f32_16x16x32_bf16 v[196:199], a[140:143], v[36:39], v[196:199]
    ds_read_b128 a[100:103], v1 offset:37440
    v_mfma_f32_16x16x32_bf16 v[200:203], a[144:147], v[32:35], v[200:203]
    v_exp_f32 v22, v22
    v_mfma_f32_16x16x32_bf16 v[200:203], a[148:151], v[36:39], v[200:203]
    ds_read_b128 a[104:107], v1 offset:37504
    v_cvt_pk_bf16_f32 v42, v20, v21
    v_mfma_f32_16x16x32_bf16 v[204:207], a[152:155], v[32:35], v[204:207]
    v_exp_f32 v23, v23
    v_mfma_f32_16x16x32_bf16 v[204:207], a[156:159], v[36:39], v[204:207]
    ds_read_b128 a[108:111], v1 offset:37568
    v_mfma_f32_16x16x32_bf16 v[208:211], a[160:163], v[32:35], v[208:211]
    v_exp_f32 v24, v24
    v_mfma_f32_16x16x32_bf16 v[208:211], a[164:167], v[36:39], v[208:211]
    ds_read_b128 a[112:115], v1 offset:37632
    v_cvt_pk_bf16_f32 v43, v22, v23
    v_mfma_f32_16x16x32_bf16 v[212:215], a[168:171], v[32:35], v[212:215]
    v_exp_f32 v25, v25
    v_mfma_f32_16x16x32_bf16 v[212:215], a[172:175], v[36:39], v[212:215]
    ds_read_b128 a[116:119], v1 offset:37696
    v_mfma_f32_16x16x32_bf16 v[216:219], a[176:179], v[32:35], v[216:219]
    v_exp_f32 v26, v26
    v_mfma_f32_16x16x32_bf16 v[216:219], a[180:183], v[36:39], v[216:219]
    ds_read_b128 a[120:123], v1 offset:37760
    v_cvt_pk_bf16_f32 v44, v24, v25
    v_mfma_f32_16x16x32_bf16 v[220:223], a[184:187], v[32:35], v[220:223]
    v_exp_f32 v27, v27
    v_mfma_f32_16x16x32_bf16 v[220:223], a[188:191], v[36:39], v[220:223]
    ds_read_b128 a[124:127], v1 offset:37824
    v_smfmac_f32_16x16x64_bf16 a[8:11], a[16:19], v[32:39], v11
    s_waitcnt vmcnt(8) lgkmcnt(12)
    s_barrier
    v_mfma_f32_16x16x32_bf16 v[16:19], a[64:67], v[64:67], v[48:51]
    v_exp_f32 v28, v28
    v_mfma_f32_16x16x32_bf16 v[16:19], a[68:71], v[68:71], v[16:19]
    v_cvt_pk_bf16_f32 v45, v26, v27
    v_mfma_f32_16x16x32_bf16 v[16:19], a[72:75], v[72:75], v[16:19]
    s_add_u32 m0, s44, 0
    v_exp_f32 v29, v29
    v_mfma_f32_16x16x32_bf16 v[16:19], a[76:79], v[76:79], v[16:19]
    s_waitcnt lgkmcnt(8)
    s_mov_b32 s45, 256
    buffer_load_dwordx4 v7, s[28:31], s45 offen offset:0 lds
    v_mfma_f32_16x16x32_bf16 v[20:23], a[80:83], v[64:67], v[48:51]
    v_exp_f32 v30, v30
    v_mfma_f32_16x16x32_bf16 v[20:23], a[84:87], v[68:71], v[20:23]
    v_cvt_pk_bf16_f32 v46, v28, v29
    v_mfma_f32_16x16x32_bf16 v[20:23], a[88:91], v[72:75], v[20:23]
    s_add_u32 m0, s44, -96
    v_exp_f32 v31, v31
    v_mfma_f32_16x16x32_bf16 v[20:23], a[92:95], v[76:79], v[20:23]
    s_waitcnt lgkmcnt(4)
    buffer_load_dwordx4 v7, s[28:31], s45 offen offset:1152 lds
    v_mfma_f32_16x16x32_bf16 v[24:27], a[96:99], v[64:67], v[48:51]
    v_exp_f32 v16, v16
    v_mfma_f32_16x16x32_bf16 v[24:27], a[100:103], v[68:71], v[24:27]
    v_cvt_pk_bf16_f32 v47, v30, v31
    v_mfma_f32_16x16x32_bf16 v[24:27], a[104:107], v[72:75], v[24:27]
    s_add_u32 m0, s44, -192
    v_exp_f32 v17, v17
    v_mfma_f32_16x16x32_bf16 v[24:27], a[108:111], v[76:79], v[24:27]
    s_waitcnt lgkmcnt(0)
    buffer_load_dwordx4 v7, s[28:31], s45 offen offset:2304 lds
    v_mfma_f32_16x16x32_bf16 v[28:31], a[112:115], v[64:67], v[48:51]
    v_exp_f32 v18, v18
    v_mfma_f32_16x16x32_bf16 v[28:31], a[116:119], v[68:71], v[28:31]
    v_cvt_pk_bf16_f32 v32, v16, v17
    v_mfma_f32_16x16x32_bf16 v[28:31], a[120:123], v[72:75], v[28:31]
    s_add_u32 m0, s44, -288
    v_exp_f32 v19, v19
    v_mfma_f32_16x16x32_bf16 v[28:31], a[124:127], v[76:79], v[28:31]
    buffer_load_dwordx4 v7, s[28:31], s45 offen offset:3456 lds
    v_mfma_f32_16x16x32_bf16 v[224:227], a[128:131], v[40:43], v[224:227]
    v_exp_f32 v20, v20
    v_mfma_f32_16x16x32_bf16 v[224:227], a[132:135], v[44:47], v[224:227]
    v_cvt_pk_bf16_f32 v33, v18, v19
    v_mfma_f32_16x16x32_bf16 v[228:231], a[136:139], v[40:43], v[228:231]
    s_add_u32 m0, s44, 16896
    v_exp_f32 v21, v21
    v_mfma_f32_16x16x32_bf16 v[228:231], a[140:143], v[44:47], v[228:231]
    s_mov_b32 s45, 147712
    buffer_load_dwordx4 v7, s[28:31], s45 offen offset:0 lds
    v_mfma_f32_16x16x32_bf16 v[232:235], a[144:147], v[40:43], v[232:235]
    v_exp_f32 v22, v22
    v_mfma_f32_16x16x32_bf16 v[232:235], a[148:151], v[44:47], v[232:235]
    v_cvt_pk_bf16_f32 v34, v20, v21
    v_mfma_f32_16x16x32_bf16 v[236:239], a[152:155], v[40:43], v[236:239]
    s_add_u32 m0, s44, 16800
    v_exp_f32 v23, v23
    v_mfma_f32_16x16x32_bf16 v[236:239], a[156:159], v[44:47], v[236:239]
    buffer_load_dwordx4 v7, s[28:31], s45 offen offset:1152 lds
    v_mfma_f32_16x16x32_bf16 v[240:243], a[160:163], v[40:43], v[240:243]
    v_exp_f32 v24, v24
    v_mfma_f32_16x16x32_bf16 v[240:243], a[164:167], v[44:47], v[240:243]
    v_cvt_pk_bf16_f32 v35, v22, v23
    v_mfma_f32_16x16x32_bf16 v[244:247], a[168:171], v[40:43], v[244:247]
    s_add_u32 m0, s44, 16704
    v_exp_f32 v25, v25
    v_mfma_f32_16x16x32_bf16 v[244:247], a[172:175], v[44:47], v[244:247]
    buffer_load_dwordx4 v7, s[28:31], s45 offen offset:2304 lds
    v_mfma_f32_16x16x32_bf16 v[248:251], a[176:179], v[40:43], v[248:251]
    v_exp_f32 v26, v26
    v_mfma_f32_16x16x32_bf16 v[248:251], a[180:183], v[44:47], v[248:251]
    v_cvt_pk_bf16_f32 v36, v24, v25
    v_mfma_f32_16x16x32_bf16 v[252:255], a[184:187], v[40:43], v[252:255]
    s_add_u32 m0, s44, 16608
    v_exp_f32 v27, v27
    v_mfma_f32_16x16x32_bf16 v[252:255], a[188:191], v[44:47], v[252:255]
    buffer_load_dwordx4 v7, s[28:31], s45 offen offset:3456 lds
    v_smfmac_f32_16x16x64_bf16 a[12:15], a[16:19], v[40:47], v11
    v_mfma_f32_16x16x32_bf16 v[16:19], a[64:67], v[80:83], v[52:55]
    v_exp_f32 v28, v28
    v_mfma_f32_16x16x32_bf16 v[16:19], a[68:71], v[84:87], v[16:19]
    v_cvt_pk_bf16_f32 v37, v26, v27
    v_mfma_f32_16x16x32_bf16 v[16:19], a[72:75], v[88:91], v[16:19]
    s_mov_b32 s54, 0
    v_exp_f32 v29, v29
    v_mfma_f32_16x16x32_bf16 v[16:19], a[76:79], v[92:95], v[16:19]
    buffer_load_dwordx4 a[128:131], v6, s[68:71], s54 offen
    v_mfma_f32_16x16x32_bf16 v[20:23], a[80:83], v[80:83], v[52:55]
    v_exp_f32 v30, v30
    v_mfma_f32_16x16x32_bf16 v[20:23], a[84:87], v[84:87], v[20:23]
    v_cvt_pk_bf16_f32 v38, v28, v29
    v_mfma_f32_16x16x32_bf16 v[20:23], a[88:91], v[88:91], v[20:23]
    v_exp_f32 v31, v31
    v_mfma_f32_16x16x32_bf16 v[20:23], a[92:95], v[92:95], v[20:23]
    s_mov_b32 s15, 0x5d800000
    v_mfma_f32_16x16x32_bf16 v[24:27], a[96:99], v[80:83], v[52:55]
    v_exp_f32 v16, v16
    v_mfma_f32_16x16x32_bf16 v[24:27], a[100:103], v[84:87], v[24:27]
    v_cvt_pk_bf16_f32 v39, v30, v31
    v_mfma_f32_16x16x32_bf16 v[24:27], a[104:107], v[88:91], v[24:27]
    s_mov_b32 s54, 147456
    v_exp_f32 v17, v17
    v_mfma_f32_16x16x32_bf16 v[24:27], a[108:111], v[92:95], v[24:27]
    buffer_load_dwordx4 a[132:135], v6, s[68:71], s54 offen
    v_mfma_f32_16x16x32_bf16 v[28:31], a[112:115], v[80:83], v[52:55]
    v_exp_f32 v18, v18
    v_mfma_f32_16x16x32_bf16 v[28:31], a[116:119], v[84:87], v[28:31]
    v_cvt_pk_bf16_f32 v40, v16, v17
    v_mfma_f32_16x16x32_bf16 v[28:31], a[120:123], v[88:91], v[28:31]
    v_exp_f32 v19, v19
    v_mfma_f32_16x16x32_bf16 v[28:31], a[124:127], v[92:95], v[28:31]
    v_mfma_f32_16x16x32_bf16 v[128:131], a[192:195], v[32:35], v[128:131]
    v_exp_f32 v20, v20
    v_mfma_f32_16x16x32_bf16 v[128:131], a[196:199], v[36:39], v[128:131]
    v_cvt_pk_bf16_f32 v41, v18, v19
    v_mfma_f32_16x16x32_bf16 v[132:135], a[200:203], v[32:35], v[132:135]
    s_mov_b32 s54, 294912
    v_exp_f32 v21, v21
    v_mfma_f32_16x16x32_bf16 v[132:135], a[204:207], v[36:39], v[132:135]
    buffer_load_dwordx4 a[136:139], v6, s[68:71], s54 offen
    v_mfma_f32_16x16x32_bf16 v[136:139], a[208:211], v[32:35], v[136:139]
    v_exp_f32 v22, v22
    v_mfma_f32_16x16x32_bf16 v[136:139], a[212:215], v[36:39], v[136:139]
    v_cvt_pk_bf16_f32 v42, v20, v21
    v_mfma_f32_16x16x32_bf16 v[140:143], a[216:219], v[32:35], v[140:143]
    v_exp_f32 v23, v23
    v_mfma_f32_16x16x32_bf16 v[140:143], a[220:223], v[36:39], v[140:143]
    v_mfma_f32_16x16x32_bf16 v[144:147], a[224:227], v[32:35], v[144:147]
    v_exp_f32 v24, v24
    v_mfma_f32_16x16x32_bf16 v[144:147], a[228:231], v[36:39], v[144:147]
    v_cvt_pk_bf16_f32 v43, v22, v23
    v_mfma_f32_16x16x32_bf16 v[148:151], a[232:235], v[32:35], v[148:151]
    s_mov_b32 s54, 442368
    v_exp_f32 v25, v25
    v_mfma_f32_16x16x32_bf16 v[148:151], a[236:239], v[36:39], v[148:151]
    buffer_load_dwordx4 a[140:143], v6, s[68:71], s54 offen
    v_mfma_f32_16x16x32_bf16 v[152:155], a[240:243], v[32:35], v[152:155]
    v_exp_f32 v26, v26
    v_mfma_f32_16x16x32_bf16 v[152:155], a[244:247], v[36:39], v[152:155]
    v_cvt_pk_bf16_f32 v44, v24, v25
    v_mfma_f32_16x16x32_bf16 v[156:159], a[248:251], v[32:35], v[156:159]
    v_exp_f32 v27, v27
    v_mfma_f32_16x16x32_bf16 v[156:159], a[252:255], v[36:39], v[156:159]
    v_smfmac_f32_16x16x64_bf16 a[0:3], a[16:19], v[32:39], v11
    v_mfma_f32_16x16x32_bf16 v[16:19], a[64:67], v[96:99], v[56:59]
    v_exp_f32 v28, v28
    v_mfma_f32_16x16x32_bf16 v[16:19], a[68:71], v[100:103], v[16:19]
    v_cvt_pk_bf16_f32 v45, v26, v27
    v_mfma_f32_16x16x32_bf16 v[16:19], a[72:75], v[104:107], v[16:19]
    s_mov_b32 s54, 589824
    v_exp_f32 v29, v29
    v_mfma_f32_16x16x32_bf16 v[16:19], a[76:79], v[108:111], v[16:19]
    buffer_load_dwordx4 a[144:147], v6, s[68:71], s54 offen
    v_mfma_f32_16x16x32_bf16 v[20:23], a[80:83], v[96:99], v[56:59]
    v_exp_f32 v30, v30
    v_mfma_f32_16x16x32_bf16 v[20:23], a[84:87], v[100:103], v[20:23]
    v_cvt_pk_bf16_f32 v46, v28, v29
    v_accvgpr_read_b32 v12, a0
    v_mfma_f32_16x16x32_bf16 v[20:23], a[88:91], v[104:107], v[20:23]
    v_exp_f32 v31, v31
    v_mfma_f32_16x16x32_bf16 v[20:23], a[92:95], v[108:111], v[20:23]
    v_accvgpr_read_b32 v13, a1
    v_add_f32 v12, v12, v13
    v_mfma_f32_16x16x32_bf16 v[24:27], a[96:99], v[96:99], v[56:59]
    v_exp_f32 v16, v16
    v_mfma_f32_16x16x32_bf16 v[24:27], a[100:103], v[100:103], v[24:27]
    v_cvt_pk_bf16_f32 v47, v30, v31
    v_cmp_nlt_f32 s[56:57], v12, s15
    v_mfma_f32_16x16x32_bf16 v[24:27], a[104:107], v[104:107], v[24:27]
    s_mov_b32 s54, 737280
    v_exp_f32 v17, v17
    v_mfma_f32_16x16x32_bf16 v[24:27], a[108:111], v[108:111], v[24:27]
    buffer_load_dwordx4 a[148:151], v6, s[68:71], s54 offen
    v_mfma_f32_16x16x32_bf16 v[28:31], a[112:115], v[96:99], v[56:59]
    v_exp_f32 v18, v18
    v_mfma_f32_16x16x32_bf16 v[28:31], a[116:119], v[100:103], v[28:31]
    v_cvt_pk_bf16_f32 v32, v16, v17
    v_mfma_f32_16x16x32_bf16 v[28:31], a[120:123], v[104:107], v[28:31]
    v_exp_f32 v19, v19
    v_mfma_f32_16x16x32_bf16 v[28:31], a[124:127], v[108:111], v[28:31]
    v_rcp_f32 v12, v12
    v_mfma_f32_16x16x32_bf16 v[160:163], a[192:195], v[40:43], v[160:163]
    v_exp_f32 v20, v20
    v_mfma_f32_16x16x32_bf16 v[160:163], a[196:199], v[44:47], v[160:163]
    v_cvt_pk_bf16_f32 v33, v18, v19
    v_mul_f32 v128, v128, v12
    v_mfma_f32_16x16x32_bf16 v[164:167], a[200:203], v[40:43], v[164:167]
    s_mov_b32 s54, 884736
    v_exp_f32 v21, v21
    v_mfma_f32_16x16x32_bf16 v[164:167], a[204:207], v[44:47], v[164:167]
    buffer_load_dwordx4 a[152:155], v6, s[68:71], s54 offen
    v_mfma_f32_16x16x32_bf16 v[168:171], a[208:211], v[40:43], v[168:171]
    v_exp_f32 v22, v22
    v_mfma_f32_16x16x32_bf16 v[168:171], a[212:215], v[44:47], v[168:171]
    v_cvt_pk_bf16_f32 v34, v20, v21
    v_mul_f32 v129, v129, v12
    v_mfma_f32_16x16x32_bf16 v[172:175], a[216:219], v[40:43], v[172:175]
    v_exp_f32 v23, v23
    v_mfma_f32_16x16x32_bf16 v[172:175], a[220:223], v[44:47], v[172:175]
    v_mul_f32 v130, v130, v12
    v_mul_f32 v131, v131, v12
    v_mfma_f32_16x16x32_bf16 v[176:179], a[224:227], v[40:43], v[176:179]
    v_exp_f32 v24, v24
    v_mfma_f32_16x16x32_bf16 v[176:179], a[228:231], v[44:47], v[176:179]
    v_cvt_pk_bf16_f32 v35, v22, v23
    v_mul_f32 v132, v132, v12
    v_mfma_f32_16x16x32_bf16 v[180:183], a[232:235], v[40:43], v[180:183]
    s_mov_b32 s54, 1032192
    v_exp_f32 v25, v25
    v_mfma_f32_16x16x32_bf16 v[180:183], a[236:239], v[44:47], v[180:183]
    buffer_load_dwordx4 a[156:159], v6, s[68:71], s54 offen
    v_mfma_f32_16x16x32_bf16 v[184:187], a[240:243], v[40:43], v[184:187]
    v_exp_f32 v26, v26
    v_mfma_f32_16x16x32_bf16 v[184:187], a[244:247], v[44:47], v[184:187]
    v_cvt_pk_bf16_f32 v36, v24, v25
    v_mul_f32 v133, v133, v12
    v_mfma_f32_16x16x32_bf16 v[188:191], a[248:251], v[40:43], v[188:191]
    v_exp_f32 v27, v27
    v_mfma_f32_16x16x32_bf16 v[188:191], a[252:255], v[44:47], v[188:191]
    v_mul_f32 v134, v134, v12
    v_mul_f32 v135, v135, v12
    v_smfmac_f32_16x16x64_bf16 a[4:7], a[16:19], v[40:47], v11
    v_cvt_pk_bf16_f32 v128, v128, v129
    v_cvt_pk_bf16_f32 v129, v130, v131
    v_mfma_f32_16x16x32_bf16 v[16:19], a[64:67], v[112:115], v[60:63]
    v_exp_f32 v28, v28
    v_mfma_f32_16x16x32_bf16 v[16:19], a[68:71], v[116:119], v[16:19]
    v_cvt_pk_bf16_f32 v37, v26, v27
    v_cvt_pk_bf16_f32 v130, v132, v133
    v_mfma_f32_16x16x32_bf16 v[16:19], a[72:75], v[120:123], v[16:19]
    s_mov_b32 s54, 1179648
    v_exp_f32 v29, v29
    v_mfma_f32_16x16x32_bf16 v[16:19], a[76:79], v[124:127], v[16:19]
    buffer_load_dwordx4 a[160:163], v6, s[68:71], s54 offen
    v_mfma_f32_16x16x32_bf16 v[20:23], a[80:83], v[112:115], v[60:63]
    v_exp_f32 v30, v30
    v_mfma_f32_16x16x32_bf16 v[20:23], a[84:87], v[116:119], v[20:23]
    v_cvt_pk_bf16_f32 v38, v28, v29
    v_cvt_pk_bf16_f32 v131, v134, v135
    v_mfma_f32_16x16x32_bf16 v[20:23], a[88:91], v[120:123], v[20:23]
    v_exp_f32 v31, v31
    v_mfma_f32_16x16x32_bf16 v[20:23], a[92:95], v[124:127], v[20:23]
    v_mul_f32 v136, v136, v12
    v_mul_f32 v137, v137, v12
    v_mfma_f32_16x16x32_bf16 v[24:27], a[96:99], v[112:115], v[60:63]
    v_exp_f32 v16, v16
    v_mfma_f32_16x16x32_bf16 v[24:27], a[100:103], v[116:119], v[24:27]
    v_cvt_pk_bf16_f32 v39, v30, v31
    v_mul_f32 v138, v138, v12
    v_mfma_f32_16x16x32_bf16 v[24:27], a[104:107], v[120:123], v[24:27]
    v_exp_f32 v17, v17
    v_mfma_f32_16x16x32_bf16 v[24:27], a[108:111], v[124:127], v[24:27]
    v_mul_f32 v139, v139, v12
    v_mul_f32 v140, v140, v12
    v_mfma_f32_16x16x32_bf16 v[28:31], a[112:115], v[112:115], v[60:63]
    v_exp_f32 v18, v18
    v_mfma_f32_16x16x32_bf16 v[28:31], a[116:119], v[116:119], v[28:31]
    v_cvt_pk_bf16_f32 v40, v16, v17
    v_mul_f32 v141, v141, v12
    v_mfma_f32_16x16x32_bf16 v[28:31], a[120:123], v[120:123], v[28:31]
    v_exp_f32 v19, v19
    v_mfma_f32_16x16x32_bf16 v[28:31], a[124:127], v[124:127], v[28:31]
    v_mul_f32 v142, v142, v12
    v_mul_f32 v143, v143, v12
    v_mfma_f32_16x16x32_bf16 v[192:195], a[192:195], v[32:35], v[192:195]
    v_exp_f32 v20, v20
    v_mfma_f32_16x16x32_bf16 v[192:195], a[196:199], v[36:39], v[192:195]
    v_cvt_pk_bf16_f32 v41, v18, v19
    v_cvt_pk_bf16_f32 v136, v136, v137
    v_mfma_f32_16x16x32_bf16 v[196:199], a[200:203], v[32:35], v[196:199]
    v_exp_f32 v21, v21
    v_mfma_f32_16x16x32_bf16 v[196:199], a[204:207], v[36:39], v[196:199]
    v_cvt_pk_bf16_f32 v137, v138, v139
    v_cvt_pk_bf16_f32 v138, v140, v141
    v_mfma_f32_16x16x32_bf16 v[200:203], a[208:211], v[32:35], v[200:203]
    v_exp_f32 v22, v22
    v_mfma_f32_16x16x32_bf16 v[200:203], a[212:215], v[36:39], v[200:203]
    v_cvt_pk_bf16_f32 v42, v20, v21
    v_cvt_pk_bf16_f32 v139, v142, v143
    v_mfma_f32_16x16x32_bf16 v[204:207], a[216:219], v[32:35], v[204:207]
    v_exp_f32 v23, v23
    v_mfma_f32_16x16x32_bf16 v[204:207], a[220:223], v[36:39], v[204:207]
    v_mul_f32 v144, v144, v12
    v_mul_f32 v145, v145, v12
    v_mfma_f32_16x16x32_bf16 v[208:211], a[224:227], v[32:35], v[208:211]
    v_exp_f32 v24, v24
    v_mfma_f32_16x16x32_bf16 v[208:211], a[228:231], v[36:39], v[208:211]
    v_cvt_pk_bf16_f32 v43, v22, v23
    v_mul_f32 v146, v146, v12
    v_mfma_f32_16x16x32_bf16 v[212:215], a[232:235], v[32:35], v[212:215]
    v_exp_f32 v25, v25
    v_mfma_f32_16x16x32_bf16 v[212:215], a[236:239], v[36:39], v[212:215]
    v_mul_f32 v147, v147, v12
    v_mul_f32 v148, v148, v12
    v_mfma_f32_16x16x32_bf16 v[216:219], a[240:243], v[32:35], v[216:219]
    v_exp_f32 v26, v26
    v_mfma_f32_16x16x32_bf16 v[216:219], a[244:247], v[36:39], v[216:219]
    v_cvt_pk_bf16_f32 v44, v24, v25
    v_mul_f32 v149, v149, v12
    v_mfma_f32_16x16x32_bf16 v[220:223], a[248:251], v[32:35], v[220:223]
    v_exp_f32 v27, v27
    v_mfma_f32_16x16x32_bf16 v[220:223], a[252:255], v[36:39], v[220:223]
    v_mul_f32 v150, v150, v12
    v_mul_f32 v151, v151, v12
    v_smfmac_f32_16x16x64_bf16 a[8:11], a[16:19], v[32:39], v11
    v_cvt_pk_bf16_f32 v144, v144, v145
    v_cvt_pk_bf16_f32 v145, v146, v147
    v_exp_f32 v28, v28
    s_nop 0
    v_cvt_pk_bf16_f32 v45, v26, v27
    v_exp_f32 v29, v29
    s_nop 0
    v_exp_f32 v30, v30
    s_nop 0
    v_cvt_pk_bf16_f32 v46, v28, v29
    v_exp_f32 v31, v31
    s_nop 0
    v_cvt_pk_bf16_f32 v47, v30, v31
    s_nop 1
    v_mfma_f32_16x16x32_bf16 v[224:227], a[192:195], v[40:43], v[224:227]
    v_cvt_pk_bf16_f32 v146, v148, v149
    v_cvt_pk_bf16_f32 v147, v150, v151
    v_mfma_f32_16x16x32_bf16 v[224:227], a[196:199], v[44:47], v[224:227]
    ds_read_b64_tr_b16 a[64:65], v4 offset:0
    ds_read_b64_tr_b16 a[66:67], v4 offset:128
    v_mfma_f32_16x16x32_bf16 v[228:231], a[200:203], v[40:43], v[228:231]
    ds_read_b64_tr_b16 a[68:69], v4 offset:256
    ds_read_b64_tr_b16 a[70:71], v4 offset:384
    v_mfma_f32_16x16x32_bf16 v[228:231], a[204:207], v[44:47], v[228:231]
    ds_read_b64_tr_b16 a[72:73], v4 offset:512
    ds_read_b64_tr_b16 a[74:75], v4 offset:640
    v_mfma_f32_16x16x32_bf16 v[232:235], a[208:211], v[40:43], v[232:235]
    ds_read_b64_tr_b16 a[76:77], v4 offset:768
    ds_read_b64_tr_b16 a[78:79], v4 offset:896
    v_mfma_f32_16x16x32_bf16 v[232:235], a[212:215], v[44:47], v[232:235]
    ds_read_b64_tr_b16 a[80:81], v4 offset:16896
    ds_read_b64_tr_b16 a[82:83], v4 offset:17024
    v_mfma_f32_16x16x32_bf16 v[236:239], a[216:219], v[40:43], v[236:239]
    ds_read_b64_tr_b16 a[84:85], v4 offset:17152
    ds_read_b64_tr_b16 a[86:87], v4 offset:17280
    v_mfma_f32_16x16x32_bf16 v[236:239], a[220:223], v[44:47], v[236:239]
    ds_read_b64_tr_b16 a[88:89], v4 offset:17408
    ds_read_b64_tr_b16 a[90:91], v4 offset:17536
    v_mfma_f32_16x16x32_bf16 v[240:243], a[224:227], v[40:43], v[240:243]
    ds_read_b64_tr_b16 a[92:93], v4 offset:17664
    ds_read_b64_tr_b16 a[94:95], v4 offset:17792
    v_mfma_f32_16x16x32_bf16 v[240:243], a[228:231], v[44:47], v[240:243]
    v_mul_f32 v152, v152, v12
    v_mul_f32 v153, v153, v12
    v_mfma_f32_16x16x32_bf16 v[244:247], a[232:235], v[40:43], v[244:247]
    v_mul_f32 v154, v154, v12
    v_mul_f32 v155, v155, v12
    v_mfma_f32_16x16x32_bf16 v[244:247], a[236:239], v[44:47], v[244:247]
    v_mul_f32 v156, v156, v12
    v_mul_f32 v157, v157, v12
    v_mfma_f32_16x16x32_bf16 v[248:251], a[240:243], v[40:43], v[248:251]
    v_mul_f32 v158, v158, v12
    v_mul_f32 v159, v159, v12
    v_mfma_f32_16x16x32_bf16 v[248:251], a[244:247], v[44:47], v[248:251]
    v_cvt_pk_bf16_f32 v152, v152, v153
    v_cvt_pk_bf16_f32 v153, v154, v155
    v_mfma_f32_16x16x32_bf16 v[252:255], a[248:251], v[40:43], v[252:255]
    v_cvt_pk_bf16_f32 v154, v156, v157
    v_cvt_pk_bf16_f32 v155, v158, v159
    v_mfma_f32_16x16x32_bf16 v[252:255], a[252:255], v[44:47], v[252:255]
    v_accvgpr_read_b32 v14, a4
    v_accvgpr_read_b32 v15, a5
    v_smfmac_f32_16x16x64_bf16 a[12:15], a[16:19], v[40:47], v11
    v_add_f32 v14, v14, v15
    v_cmp_nlt_f32 s[58:59], v14, s15
    v_rcp_f32 v14, v14
    v_accvgpr_read_b32 v12, a8
    v_accvgpr_read_b32 v13, a9
    v_add_f32 v12, v12, v13
    v_cmp_nlt_f32 s[60:61], v12, s15
    v_rcp_f32 v12, v12
    v_pk_mul_f32 v[160:161], v[160:161], v[14:15] op_sel_hi:[1,0]
    v_pk_mul_f32 v[162:163], v[162:163], v[14:15] op_sel_hi:[1,0]
    v_pk_mul_f32 v[164:165], v[164:165], v[14:15] op_sel_hi:[1,0]
    v_pk_mul_f32 v[166:167], v[166:167], v[14:15] op_sel_hi:[1,0]
    v_cvt_pk_bf16_f32 v160, v160, v161
    v_cvt_pk_bf16_f32 v161, v162, v163
    v_cvt_pk_bf16_f32 v162, v164, v165
    v_cvt_pk_bf16_f32 v163, v166, v167
    v_pk_mul_f32 v[168:169], v[168:169], v[14:15] op_sel_hi:[1,0]
    v_pk_mul_f32 v[170:171], v[170:171], v[14:15] op_sel_hi:[1,0]
    v_pk_mul_f32 v[172:173], v[172:173], v[14:15] op_sel_hi:[1,0]
    v_pk_mul_f32 v[174:175], v[174:175], v[14:15] op_sel_hi:[1,0]
    v_cvt_pk_bf16_f32 v168, v168, v169
    v_cvt_pk_bf16_f32 v169, v170, v171
    v_cvt_pk_bf16_f32 v170, v172, v173
    v_cvt_pk_bf16_f32 v171, v174, v175
    v_pk_mul_f32 v[176:177], v[176:177], v[14:15] op_sel_hi:[1,0]
    v_pk_mul_f32 v[178:179], v[178:179], v[14:15] op_sel_hi:[1,0]
    v_pk_mul_f32 v[180:181], v[180:181], v[14:15] op_sel_hi:[1,0]
    v_pk_mul_f32 v[182:183], v[182:183], v[14:15] op_sel_hi:[1,0]
    v_cvt_pk_bf16_f32 v176, v176, v177
    v_cvt_pk_bf16_f32 v177, v178, v179
    v_cvt_pk_bf16_f32 v178, v180, v181
    v_cvt_pk_bf16_f32 v179, v182, v183
    v_pk_mul_f32 v[184:185], v[184:185], v[14:15] op_sel_hi:[1,0]
    v_pk_mul_f32 v[186:187], v[186:187], v[14:15] op_sel_hi:[1,0]
    v_pk_mul_f32 v[188:189], v[188:189], v[14:15] op_sel_hi:[1,0]
    v_pk_mul_f32 v[190:191], v[190:191], v[14:15] op_sel_hi:[1,0]
    v_cvt_pk_bf16_f32 v184, v184, v185
    v_cvt_pk_bf16_f32 v185, v186, v187
    v_cvt_pk_bf16_f32 v186, v188, v189
    v_cvt_pk_bf16_f32 v187, v190, v191
    v_accvgpr_read_b32 v14, a12
    v_accvgpr_read_b32 v15, a13
    v_add_f32 v14, v14, v15
    v_cmp_nlt_f32 s[62:63], v14, s15
    s_or_b64 s[56:57], s[56:57], s[58:59]
    v_rcp_f32 v14, v14
    s_or_b64 s[60:61], s[60:61], s[62:63]
    s_or_b64 s[56:57], s[56:57], s[60:61]
    s_cselect_b32 s3, 1, 0
    s_andn2_b32 s3, s3, s50
    s_lshl2_add_u32 s14, s51, 13824
    v_mov_b32 v56, s3
    v_mov_b32 v57, s14
    v_mov_b32 v58, 13824
    ds_write_b32 v57, v56
    v_pk_mul_f32 v[192:193], v[192:193], v[12:13] op_sel_hi:[1,0]
    v_pk_mul_f32 v[194:195], v[194:195], v[12:13] op_sel_hi:[1,0]
    v_pk_mul_f32 v[196:197], v[196:197], v[12:13] op_sel_hi:[1,0]
    v_pk_mul_f32 v[198:199], v[198:199], v[12:13] op_sel_hi:[1,0]
    v_cvt_pk_bf16_f32 v192, v192, v193
    v_cvt_pk_bf16_f32 v193, v194, v195
    v_cvt_pk_bf16_f32 v194, v196, v197
    v_cvt_pk_bf16_f32 v195, v198, v199
    v_pk_mul_f32 v[200:201], v[200:201], v[12:13] op_sel_hi:[1,0]
    v_pk_mul_f32 v[202:203], v[202:203], v[12:13] op_sel_hi:[1,0]
    v_pk_mul_f32 v[204:205], v[204:205], v[12:13] op_sel_hi:[1,0]
    v_pk_mul_f32 v[206:207], v[206:207], v[12:13] op_sel_hi:[1,0]
    v_cvt_pk_bf16_f32 v200, v200, v201
    v_cvt_pk_bf16_f32 v201, v202, v203
    v_cvt_pk_bf16_f32 v202, v204, v205
    v_cvt_pk_bf16_f32 v203, v206, v207
    v_pk_mul_f32 v[208:209], v[208:209], v[12:13] op_sel_hi:[1,0]
    v_pk_mul_f32 v[210:211], v[210:211], v[12:13] op_sel_hi:[1,0]
    v_pk_mul_f32 v[212:213], v[212:213], v[12:13] op_sel_hi:[1,0]
    v_pk_mul_f32 v[214:215], v[214:215], v[12:13] op_sel_hi:[1,0]
    v_cvt_pk_bf16_f32 v208, v208, v209
    v_cvt_pk_bf16_f32 v209, v210, v211
    v_cvt_pk_bf16_f32 v210, v212, v213
    v_cvt_pk_bf16_f32 v211, v214, v215
    v_pk_mul_f32 v[216:217], v[216:217], v[12:13] op_sel_hi:[1,0]
    v_pk_mul_f32 v[218:219], v[218:219], v[12:13] op_sel_hi:[1,0]
    v_pk_mul_f32 v[220:221], v[220:221], v[12:13] op_sel_hi:[1,0]
    v_pk_mul_f32 v[222:223], v[222:223], v[12:13] op_sel_hi:[1,0]
    v_cvt_pk_bf16_f32 v216, v216, v217
    v_cvt_pk_bf16_f32 v217, v218, v219
    v_cvt_pk_bf16_f32 v218, v220, v221
    v_cvt_pk_bf16_f32 v219, v222, v223
    v_pk_mul_f32 v[224:225], v[224:225], v[14:15] op_sel_hi:[1,0]
    v_pk_mul_f32 v[226:227], v[226:227], v[14:15] op_sel_hi:[1,0]
    v_pk_mul_f32 v[228:229], v[228:229], v[14:15] op_sel_hi:[1,0]
    v_pk_mul_f32 v[230:231], v[230:231], v[14:15] op_sel_hi:[1,0]
    v_cvt_pk_bf16_f32 v224, v224, v225
    v_cvt_pk_bf16_f32 v225, v226, v227
    v_cvt_pk_bf16_f32 v226, v228, v229
    v_cvt_pk_bf16_f32 v227, v230, v231
    v_pk_mul_f32 v[232:233], v[232:233], v[14:15] op_sel_hi:[1,0]
    v_pk_mul_f32 v[234:235], v[234:235], v[14:15] op_sel_hi:[1,0]
    v_pk_mul_f32 v[236:237], v[236:237], v[14:15] op_sel_hi:[1,0]
    v_pk_mul_f32 v[238:239], v[238:239], v[14:15] op_sel_hi:[1,0]
    v_cvt_pk_bf16_f32 v232, v232, v233
    v_cvt_pk_bf16_f32 v233, v234, v235
    v_cvt_pk_bf16_f32 v234, v236, v237
    v_cvt_pk_bf16_f32 v235, v238, v239
    v_pk_mul_f32 v[240:241], v[240:241], v[14:15] op_sel_hi:[1,0]
    v_pk_mul_f32 v[242:243], v[242:243], v[14:15] op_sel_hi:[1,0]
    v_pk_mul_f32 v[244:245], v[244:245], v[14:15] op_sel_hi:[1,0]
    v_pk_mul_f32 v[246:247], v[246:247], v[14:15] op_sel_hi:[1,0]
    v_cvt_pk_bf16_f32 v240, v240, v241
    v_cvt_pk_bf16_f32 v241, v242, v243
    v_cvt_pk_bf16_f32 v242, v244, v245
    v_cvt_pk_bf16_f32 v243, v246, v247
    v_pk_mul_f32 v[248:249], v[248:249], v[14:15] op_sel_hi:[1,0]
    v_pk_mul_f32 v[250:251], v[250:251], v[14:15] op_sel_hi:[1,0]
    v_pk_mul_f32 v[252:253], v[252:253], v[14:15] op_sel_hi:[1,0]
    v_pk_mul_f32 v[254:255], v[254:255], v[14:15] op_sel_hi:[1,0]
    v_cvt_pk_bf16_f32 v248, v248, v249
    v_cvt_pk_bf16_f32 v249, v250, v251
    v_cvt_pk_bf16_f32 v250, v252, v253
    v_cvt_pk_bf16_f32 v251, v254, v255
    s_waitcnt lgkmcnt(13)
    v_mfma_f32_16x16x32_bf16 v[16:19], a[64:67], v[128:131], 0
    s_mul_i32 s3, s51, 288
    ds_read_b64_tr_b16 a[96:97], v4 offset:32
    v_lshrrev_b32 v15, 3, v0
    v_mfma_f32_16x16x32_bf16 v[16:19], a[68:71], v[136:139], v[16:19]
    s_waitcnt lgkmcnt(10)
    ds_read_b64_tr_b16 a[98:99], v4 offset:160
    v_lshl_add_u32 v12, v15, 4, s3
    v_mfma_f32_16x16x32_bf16 v[16:19], a[72:75], v[144:147], v[16:19]
    ds_read_b64_tr_b16 a[100:101], v4 offset:288
    v_and_b32 v15, 1, v15
    v_mfma_f32_16x16x32_bf16 v[16:19], a[76:79], v[152:155], v[16:19]
    s_waitcnt lgkmcnt(8)
    ds_read_b64_tr_b16 a[102:103], v4 offset:416
    v_lshl_add_u32 v13, v15, 4, s3
    v_mfma_f32_16x16x32_bf16 v[16:19], a[80:83], v[192:195], v[16:19]
    ds_read_b64_tr_b16 a[104:105], v4 offset:544
    v_and_b32 v14, 7, v0
    v_mfma_f32_16x16x32_bf16 v[16:19], a[84:87], v[200:203], v[16:19]
    s_waitcnt lgkmcnt(6)
    ds_read_b64_tr_b16 a[106:107], v4 offset:672
    v_mul_u32_u24 v14, 1152, v14
    v_mfma_f32_16x16x32_bf16 v[16:19], a[88:91], v[208:211], v[16:19]
    ds_read_b64_tr_b16 a[108:109], v4 offset:800
    v_add_u32 v1, v14, v12
    v_mfma_f32_16x16x32_bf16 v[16:19], a[92:95], v[216:219], v[16:19]
    ds_read_b64_tr_b16 a[110:111], v4 offset:928
    v_add_u32 v2, v14, v13
    v_mfma_f32_16x16x32_bf16 v[20:23], a[64:67], v[160:163], 0
    ds_read_b64_tr_b16 a[112:113], v4 offset:16928
    v_add_u32 v2, 256, v2
    v_mfma_f32_16x16x32_bf16 v[20:23], a[68:71], v[168:171], v[20:23]
    s_mul_i32 s14, s51, 2304
    ds_read_b64_tr_b16 a[114:115], v4 offset:17056
    v_add_u32 v5, s14, v8
    v_mfma_f32_16x16x32_bf16 v[20:23], a[72:75], v[176:179], v[20:23]
    ds_read_b64_tr_b16 a[116:117], v4 offset:17184
    v_and_b32 v14, 0xf0, v8
    v_mfma_f32_16x16x32_bf16 v[20:23], a[76:79], v[184:187], v[20:23]
    ds_read_b64_tr_b16 a[118:119], v4 offset:17312
    v_add_u32 v14, s14, v14
    v_mfma_f32_16x16x32_bf16 v[20:23], a[80:83], v[224:227], v[20:23]
    ds_read_b64_tr_b16 a[120:121], v4 offset:17440
    v_mfma_f32_16x16x32_bf16 v[20:23], a[84:87], v[232:235], v[20:23]
    ds_read_b64_tr_b16 a[122:123], v4 offset:17568
    v_mfma_f32_16x16x32_bf16 v[20:23], a[88:91], v[240:243], v[20:23]
    ds_read_b64_tr_b16 a[124:125], v4 offset:17696
    v_mfma_f32_16x16x32_bf16 v[20:23], a[92:95], v[248:251], v[20:23]
    s_waitcnt lgkmcnt(11)
    ds_read_b64_tr_b16 a[126:127], v4 offset:17824
    v_mfma_f32_16x16x32_bf16 v[24:27], a[96:99], v[128:131], 0
    ds_read_b64_tr_b16 a[64:65], v4 offset:64
    v_mfma_f32_16x16x32_bf16 v[24:27], a[100:103], v[136:139], v[24:27]
    s_waitcnt lgkmcnt(9)
    ds_read_b64_tr_b16 a[66:67], v4 offset:192
    v_mfma_f32_16x16x32_bf16 v[24:27], a[104:107], v[144:147], v[24:27]
    ds_read_b64_tr_b16 a[68:69], v4 offset:320
    v_mfma_f32_16x16x32_bf16 v[24:27], a[108:111], v[152:155], v[24:27]
    s_waitcnt lgkmcnt(7)
    ds_read_b64_tr_b16 a[70:71], v4 offset:448
    v_mfma_f32_16x16x32_bf16 v[24:27], a[112:115], v[192:195], v[24:27]
    ds_read_b64_tr_b16 a[72:73], v4 offset:576
    v_mfma_f32_16x16x32_bf16 v[24:27], a[116:119], v[200:203], v[24:27]
    s_waitcnt lgkmcnt(5)
    ds_read_b64_tr_b16 a[74:75], v4 offset:704
    v_mfma_f32_16x16x32_bf16 v[24:27], a[120:123], v[208:211], v[24:27]
    ds_read_b64_tr_b16 a[76:77], v4 offset:832
    v_mfma_f32_16x16x32_bf16 v[24:27], a[124:127], v[216:219], v[24:27]
    ds_read_b64_tr_b16 a[78:79], v4 offset:960
    v_mfma_f32_16x16x32_bf16 v[28:31], a[96:99], v[160:163], 0
    ds_read_b64_tr_b16 a[80:81], v4 offset:16960
    v_mfma_f32_16x16x32_bf16 v[28:31], a[100:103], v[168:171], v[28:31]
    ds_read_b64_tr_b16 a[82:83], v4 offset:17088
    v_mfma_f32_16x16x32_bf16 v[28:31], a[104:107], v[176:179], v[28:31]
    ds_read_b64_tr_b16 a[84:85], v4 offset:17216
    v_mfma_f32_16x16x32_bf16 v[28:31], a[108:111], v[184:187], v[28:31]
    ds_read_b64_tr_b16 a[86:87], v4 offset:17344
    v_mfma_f32_16x16x32_bf16 v[28:31], a[112:115], v[224:227], v[28:31]
    ds_read_b64_tr_b16 a[88:89], v4 offset:17472
    v_mfma_f32_16x16x32_bf16 v[28:31], a[116:119], v[232:235], v[28:31]
    ds_read_b64_tr_b16 a[90:91], v4 offset:17600
    v_mfma_f32_16x16x32_bf16 v[28:31], a[120:123], v[240:243], v[28:31]
    ds_read_b64_tr_b16 a[92:93], v4 offset:17728
    v_mfma_f32_16x16x32_bf16 v[28:31], a[124:127], v[248:251], v[28:31]
    s_waitcnt lgkmcnt(11)
    ds_read_b64_tr_b16 a[94:95], v4 offset:17856
    v_mfma_f32_16x16x32_bf16 v[32:35], a[64:67], v[128:131], 0
    ds_read_b64_tr_b16 a[96:97], v4 offset:96
    v_cvt_pk_bf16_f32 v48, v16, v17
    v_mfma_f32_16x16x32_bf16 v[32:35], a[68:71], v[136:139], v[32:35]
    s_waitcnt lgkmcnt(9)
    ds_read_b64_tr_b16 a[98:99], v4 offset:224
    v_cvt_pk_bf16_f32 v49, v18, v19
    v_mfma_f32_16x16x32_bf16 v[32:35], a[72:75], v[144:147], v[32:35]
    ds_read_b64_tr_b16 a[100:101], v4 offset:352
    v_cvt_pk_bf16_f32 v50, v24, v25
    v_mfma_f32_16x16x32_bf16 v[32:35], a[76:79], v[152:155], v[32:35]
    s_waitcnt lgkmcnt(7)
    ds_read_b64_tr_b16 a[102:103], v4 offset:480
    v_cvt_pk_bf16_f32 v51, v26, v27
    v_mfma_f32_16x16x32_bf16 v[32:35], a[80:83], v[192:195], v[32:35]
    s_mov_b32 s54, 0
    ds_read_b64_tr_b16 a[104:105], v4 offset:608
    ds_read_b64_tr_b16 a[106:107], v4 offset:736
    v_mfma_f32_16x16x32_bf16 v[32:35], a[84:87], v[200:203], v[32:35]
    s_waitcnt lgkmcnt(6)
    v_permlane32_swap_b32 v48, v50
    v_mfma_f32_16x16x32_bf16 v[32:35], a[88:91], v[208:211], v[32:35]
    v_permlane32_swap_b32 v49, v51
    v_mfma_f32_16x16x32_bf16 v[32:35], a[92:95], v[216:219], v[32:35]
    ds_read_b64_tr_b16 a[108:109], v4 offset:864
    ds_read_b64_tr_b16 a[110:111], v4 offset:992
    buffer_store_dwordx4 v[48:51], v10, s[40:43], s54 offen offset:0 sc1
    v_mfma_f32_16x16x32_bf16 v[36:39], a[64:67], v[160:163], 0
    ds_read_b64_tr_b16 a[112:113], v4 offset:16992
    v_cvt_pk_bf16_f32 v52, v20, v21
    v_mfma_f32_16x16x32_bf16 v[36:39], a[68:71], v[168:171], v[36:39]
    ds_read_b64_tr_b16 a[114:115], v4 offset:17120
    v_cvt_pk_bf16_f32 v53, v22, v23
    v_mfma_f32_16x16x32_bf16 v[36:39], a[72:75], v[176:179], v[36:39]
    ds_read_b64_tr_b16 a[116:117], v4 offset:17248
    v_cvt_pk_bf16_f32 v54, v28, v29
    v_mfma_f32_16x16x32_bf16 v[36:39], a[76:79], v[184:187], v[36:39]
    ds_read_b64_tr_b16 a[118:119], v4 offset:17376
    v_cvt_pk_bf16_f32 v55, v30, v31
    v_mfma_f32_16x16x32_bf16 v[36:39], a[80:83], v[224:227], v[36:39]
    s_mov_b32 s54, 294912
    ds_read_b64_tr_b16 a[120:121], v4 offset:17504
    ds_read_b64_tr_b16 a[122:123], v4 offset:17632
    v_mfma_f32_16x16x32_bf16 v[36:39], a[84:87], v[232:235], v[36:39]
    v_permlane32_swap_b32 v52, v54
    v_mfma_f32_16x16x32_bf16 v[36:39], a[88:91], v[240:243], v[36:39]
    v_permlane32_swap_b32 v53, v55
    v_mfma_f32_16x16x32_bf16 v[36:39], a[92:95], v[248:251], v[36:39]
    s_waitcnt vmcnt(18)
    s_barrier
    s_waitcnt lgkmcnt(10)
    ds_read_b64_tr_b16 a[124:125], v4 offset:17760
    ds_read_b64_tr_b16 a[126:127], v4 offset:17888
    ds_read_b128 v[60:63], v58
    buffer_store_dwordx4 v[52:55], v10, s[40:43], s54 offen offset:0 sc1
    v_mfma_f32_16x16x32_bf16 v[40:43], a[96:99], v[128:131], 0
    s_add_u32 m0, s44, 36864
    ds_read_b64_tr_b16 a[64:65], v4 offset:36864
    ds_read_b64_tr_b16 a[66:67], v4 offset:36992
    v_mfma_f32_16x16x32_bf16 v[40:43], a[100:103], v[136:139], v[40:43]
    s_mov_b32 s45, 384
    s_waitcnt lgkmcnt(11)
    buffer_load_dwordx4 v7, s[28:31], s45 offen offset:0 lds
    v_mfma_f32_16x16x32_bf16 v[40:43], a[104:107], v[144:147], v[40:43]
    s_add_u32 m0, s44, 36768
    ds_read_b64_tr_b16 a[68:69], v4 offset:37120
    ds_read_b64_tr_b16 a[70:71], v4 offset:37248
    v_mfma_f32_16x16x32_bf16 v[40:43], a[108:111], v[152:155], v[40:43]
    s_waitcnt lgkmcnt(9)
    buffer_load_dwordx4 v7, s[28:31], s45 offen offset:1152 lds
    v_mfma_f32_16x16x32_bf16 v[40:43], a[112:115], v[192:195], v[40:43]
    s_add_u32 m0, s44, 36672
    ds_read_b64_tr_b16 a[72:73], v4 offset:37376
    ds_read_b64_tr_b16 a[74:75], v4 offset:37504
    v_mfma_f32_16x16x32_bf16 v[40:43], a[116:119], v[200:203], v[40:43]
    s_waitcnt lgkmcnt(7)
    buffer_load_dwordx4 v7, s[28:31], s45 offen offset:2304 lds
    v_mfma_f32_16x16x32_bf16 v[40:43], a[120:123], v[208:211], v[40:43]
    s_add_u32 m0, s44, 36576
    ds_read_b64_tr_b16 a[76:77], v4 offset:37632
    ds_read_b64_tr_b16 a[78:79], v4 offset:37760
    v_mfma_f32_16x16x32_bf16 v[40:43], a[124:127], v[216:219], v[40:43]
    s_waitcnt lgkmcnt(8)
    buffer_load_dwordx4 v7, s[28:31], s45 offen offset:3456 lds
    v_or3_b32 v60, v60, v61, v62
    v_or_b32 v60, v60, v63
    v_mfma_f32_16x16x32_bf16 v[44:47], a[96:99], v[160:163], 0
    s_add_u32 m0, s44, 53760
    ds_read_b64_tr_b16 a[80:81], v4 offset:53760
    ds_read_b64_tr_b16 a[82:83], v4 offset:53888
    v_mfma_f32_16x16x32_bf16 v[44:47], a[100:103], v[168:171], v[44:47]
    s_mov_b32 s45, 147840
    buffer_load_dwordx4 v7, s[28:31], s45 offen offset:0 lds
    v_mfma_f32_16x16x32_bf16 v[44:47], a[104:107], v[176:179], v[44:47]
    s_add_u32 m0, s44, 53664
    ds_read_b64_tr_b16 a[84:85], v4 offset:54016
    ds_read_b64_tr_b16 a[86:87], v4 offset:54144
    v_mfma_f32_16x16x32_bf16 v[44:47], a[108:111], v[184:187], v[44:47]
    buffer_load_dwordx4 v7, s[28:31], s45 offen offset:1152 lds
    v_mfma_f32_16x16x32_bf16 v[44:47], a[112:115], v[224:227], v[44:47]
    s_add_u32 m0, s44, 53568
    ds_read_b64_tr_b16 a[88:89], v4 offset:54272
    ds_read_b64_tr_b16 a[90:91], v4 offset:54400
    v_mfma_f32_16x16x32_bf16 v[44:47], a[116:119], v[232:235], v[44:47]
    buffer_load_dwordx4 v7, s[28:31], s45 offen offset:2304 lds
    v_mfma_f32_16x16x32_bf16 v[44:47], a[120:123], v[240:243], v[44:47]
    s_add_u32 m0, s44, 53472
    ds_read_b64_tr_b16 a[92:93], v4 offset:54528
    ds_read_b64_tr_b16 a[94:95], v4 offset:54656
    v_mfma_f32_16x16x32_bf16 v[44:47], a[124:127], v[248:251], v[44:47]
    s_waitcnt lgkmcnt(12)
    buffer_load_dwordx4 v7, s[28:31], s45 offen offset:3456 lds
    v_readfirstlane_b32 s3, v60
    v_mfma_f32_16x16x32_bf16 v[16:19], a[64:67], v[128:131], 0
    ds_read_b64_tr_b16 a[96:97], v4 offset:36896
    v_cvt_pk_bf16_f32 v48, v32, v33
    v_mfma_f32_16x16x32_bf16 v[16:19], a[68:71], v[136:139], v[16:19]
    s_waitcnt lgkmcnt(9)
    s_cmp_lg_u32 s3, 0
    ds_read_b64_tr_b16 a[98:99], v4 offset:37024
    v_cvt_pk_bf16_f32 v49, v34, v35
    v_mfma_f32_16x16x32_bf16 v[16:19], a[72:75], v[144:147], v[16:19]
    s_cbranch_scc1 L2_fallback
    ds_read_b64_tr_b16 a[100:101], v4 offset:37152
    v_cvt_pk_bf16_f32 v50, v40, v41
    v_mfma_f32_16x16x32_bf16 v[16:19], a[76:79], v[152:155], v[16:19]
    s_waitcnt lgkmcnt(7)
    ds_read_b64_tr_b16 a[102:103], v4 offset:37280
    v_cvt_pk_bf16_f32 v51, v42, v43
    v_mfma_f32_16x16x32_bf16 v[16:19], a[80:83], v[192:195], v[16:19]
    s_mov_b32 s54, 0
    ds_read_b64_tr_b16 a[104:105], v4 offset:37408
    ds_read_b64_tr_b16 a[106:107], v4 offset:37536
    v_mfma_f32_16x16x32_bf16 v[16:19], a[84:87], v[200:203], v[16:19]
    s_waitcnt lgkmcnt(6)
    v_permlane32_swap_b32 v48, v50
    v_mfma_f32_16x16x32_bf16 v[16:19], a[88:91], v[208:211], v[16:19]
    v_permlane32_swap_b32 v49, v51
    v_mfma_f32_16x16x32_bf16 v[16:19], a[92:95], v[216:219], v[16:19]
    ds_read_b64_tr_b16 a[108:109], v4 offset:37664
    ds_read_b64_tr_b16 a[110:111], v4 offset:37792
    buffer_store_dwordx4 v[48:51], v10, s[40:43], s54 offen offset:512 sc1
    v_mfma_f32_16x16x32_bf16 v[20:23], a[64:67], v[160:163], 0
    ds_read_b64_tr_b16 a[112:113], v4 offset:53792
    v_cvt_pk_bf16_f32 v52, v36, v37
    v_mfma_f32_16x16x32_bf16 v[20:23], a[68:71], v[168:171], v[20:23]
    ds_read_b64_tr_b16 a[114:115], v4 offset:53920
    v_cvt_pk_bf16_f32 v53, v38, v39
    v_mfma_f32_16x16x32_bf16 v[20:23], a[72:75], v[176:179], v[20:23]
    ds_read_b64_tr_b16 a[116:117], v4 offset:54048
    v_cvt_pk_bf16_f32 v54, v44, v45
    v_mfma_f32_16x16x32_bf16 v[20:23], a[76:79], v[184:187], v[20:23]
    ds_read_b64_tr_b16 a[118:119], v4 offset:54176
    v_cvt_pk_bf16_f32 v55, v46, v47
    v_mfma_f32_16x16x32_bf16 v[20:23], a[80:83], v[224:227], v[20:23]
    s_mov_b32 s54, 294912
    ds_read_b64_tr_b16 a[120:121], v4 offset:54304
    ds_read_b64_tr_b16 a[122:123], v4 offset:54432
    v_mfma_f32_16x16x32_bf16 v[20:23], a[84:87], v[232:235], v[20:23]
    v_permlane32_swap_b32 v52, v54
    v_mfma_f32_16x16x32_bf16 v[20:23], a[88:91], v[240:243], v[20:23]
    v_permlane32_swap_b32 v53, v55
    v_mfma_f32_16x16x32_bf16 v[20:23], a[92:95], v[248:251], v[20:23]
    s_waitcnt lgkmcnt(10)
    ds_read_b64_tr_b16 a[124:125], v4 offset:54560
    ds_read_b64_tr_b16 a[126:127], v4 offset:54688
    buffer_store_dwordx4 v[52:55], v10, s[40:43], s54 offen offset:512 sc1
    v_mfma_f32_16x16x32_bf16 v[24:27], a[96:99], v[128:131], 0
    ds_read_b64_tr_b16 a[64:65], v4 offset:36928
    ds_read_b64_tr_b16 a[66:67], v4 offset:37056
    v_mfma_f32_16x16x32_bf16 v[24:27], a[100:103], v[136:139], v[24:27]
    s_waitcnt lgkmcnt(10)
    ds_read_b64_tr_b16 a[68:69], v4 offset:37184
    ds_read_b64_tr_b16 a[70:71], v4 offset:37312
    v_mfma_f32_16x16x32_bf16 v[24:27], a[104:107], v[144:147], v[24:27]
    ds_read_b64_tr_b16 a[72:73], v4 offset:37440
    ds_read_b64_tr_b16 a[74:75], v4 offset:37568
    v_mfma_f32_16x16x32_bf16 v[24:27], a[108:111], v[152:155], v[24:27]
    s_waitcnt lgkmcnt(10)
    buffer_load_dwordx4 v[64:67], v1, s[76:79], 0 offen offset:0
    v_mfma_f32_16x16x32_bf16 v[24:27], a[112:115], v[192:195], v[24:27]
    ds_read_b64_tr_b16 a[76:77], v4 offset:37696
    ds_read_b64_tr_b16 a[78:79], v4 offset:37824
    v_mfma_f32_16x16x32_bf16 v[24:27], a[116:119], v[200:203], v[24:27]
    s_waitcnt lgkmcnt(8)
    ds_read_b64_tr_b16 a[80:81], v4 offset:53824
    v_mfma_f32_16x16x32_bf16 v[24:27], a[120:123], v[208:211], v[24:27]
    ds_read_b64_tr_b16 a[82:83], v4 offset:53952
    v_mfma_f32_16x16x32_bf16 v[24:27], a[124:127], v[216:219], v[24:27]
    buffer_load_dwordx4 v[68:71], v1, s[76:79], 0 offen offset:128
    v_mfma_f32_16x16x32_bf16 v[28:31], a[96:99], v[160:163], 0
    ds_read_b64_tr_b16 a[84:85], v4 offset:54080
    v_mfma_f32_16x16x32_bf16 v[28:31], a[100:103], v[168:171], v[28:31]
    ds_read_b64_tr_b16 a[86:87], v4 offset:54208
    v_mfma_f32_16x16x32_bf16 v[28:31], a[104:107], v[176:179], v[28:31]
    ds_read_b64_tr_b16 a[88:89], v4 offset:54336
    v_mfma_f32_16x16x32_bf16 v[28:31], a[108:111], v[184:187], v[28:31]
    buffer_load_dwordx4 v[72:75], v2, s[76:79], 0 offen offset:0
    v_mfma_f32_16x16x32_bf16 v[28:31], a[112:115], v[224:227], v[28:31]
    ds_read_b64_tr_b16 a[90:91], v4 offset:54464
    v_mfma_f32_16x16x32_bf16 v[28:31], a[116:119], v[232:235], v[28:31]
    ds_read_b64_tr_b16 a[92:93], v4 offset:54592
    v_mfma_f32_16x16x32_bf16 v[28:31], a[120:123], v[240:243], v[28:31]
    ds_read_b64_tr_b16 a[94:95], v4 offset:54720
    v_mfma_f32_16x16x32_bf16 v[28:31], a[124:127], v[248:251], v[28:31]
    s_waitcnt lgkmcnt(12)
    buffer_load_dwordx4 v[112:115], v12, s[36:39], 0 offen offset:0
    v_mfma_f32_16x16x32_bf16 v[32:35], a[64:67], v[128:131], 0
    ds_read_b64_tr_b16 a[96:97], v4 offset:36960
    v_cvt_pk_bf16_f32 v48, v16, v17
    v_mfma_f32_16x16x32_bf16 v[32:35], a[68:71], v[136:139], v[32:35]
    s_waitcnt lgkmcnt(9)
    ds_read_b64_tr_b16 a[98:99], v4 offset:37088
    v_cvt_pk_bf16_f32 v49, v18, v19
    v_mfma_f32_16x16x32_bf16 v[32:35], a[72:75], v[144:147], v[32:35]
    ds_read_b64_tr_b16 a[100:101], v4 offset:37216
    v_cvt_pk_bf16_f32 v50, v24, v25
    v_mfma_f32_16x16x32_bf16 v[32:35], a[76:79], v[152:155], v[32:35]
    s_waitcnt lgkmcnt(7)
    ds_read_b64_tr_b16 a[102:103], v4 offset:37344
    v_cvt_pk_bf16_f32 v51, v26, v27
    v_mfma_f32_16x16x32_bf16 v[32:35], a[80:83], v[192:195], v[32:35]
    s_mov_b32 s54, 1024
    ds_read_b64_tr_b16 a[104:105], v4 offset:37472
    ds_read_b64_tr_b16 a[106:107], v4 offset:37600
    v_mfma_f32_16x16x32_bf16 v[32:35], a[84:87], v[200:203], v[32:35]
    s_waitcnt lgkmcnt(6)
    v_permlane32_swap_b32 v48, v50
    v_mfma_f32_16x16x32_bf16 v[32:35], a[88:91], v[208:211], v[32:35]
    v_permlane32_swap_b32 v49, v51
    v_mfma_f32_16x16x32_bf16 v[32:35], a[92:95], v[216:219], v[32:35]
    ds_read_b64_tr_b16 a[108:109], v4 offset:37728
    ds_read_b64_tr_b16 a[110:111], v4 offset:37856
    buffer_store_dwordx4 v[48:51], v10, s[40:43], s54 offen offset:0 sc1
    v_mfma_f32_16x16x32_bf16 v[36:39], a[64:67], v[160:163], 0
    ds_read_b64_tr_b16 a[112:113], v4 offset:53856
    v_cvt_pk_bf16_f32 v52, v20, v21
    v_mfma_f32_16x16x32_bf16 v[36:39], a[68:71], v[168:171], v[36:39]
    ds_read_b64_tr_b16 a[114:115], v4 offset:53984
    v_cvt_pk_bf16_f32 v53, v22, v23
    v_mfma_f32_16x16x32_bf16 v[36:39], a[72:75], v[176:179], v[36:39]
    ds_read_b64_tr_b16 a[116:117], v4 offset:54112
    v_cvt_pk_bf16_f32 v54, v28, v29
    v_mfma_f32_16x16x32_bf16 v[36:39], a[76:79], v[184:187], v[36:39]
    ds_read_b64_tr_b16 a[118:119], v4 offset:54240
    v_cvt_pk_bf16_f32 v55, v30, v31
    v_mfma_f32_16x16x32_bf16 v[36:39], a[80:83], v[224:227], v[36:39]
    s_mov_b32 s54, 295936
    ds_read_b64_tr_b16 a[120:121], v4 offset:54368
    ds_read_b64_tr_b16 a[122:123], v4 offset:54496
    v_mfma_f32_16x16x32_bf16 v[36:39], a[84:87], v[232:235], v[36:39]
    v_permlane32_swap_b32 v52, v54
    v_mfma_f32_16x16x32_bf16 v[36:39], a[88:91], v[240:243], v[36:39]
    v_permlane32_swap_b32 v53, v55
    v_mfma_f32_16x16x32_bf16 v[36:39], a[92:95], v[248:251], v[36:39]
    s_waitcnt vmcnt(26)
    s_barrier
    s_waitcnt lgkmcnt(10)
    ds_read_b64_tr_b16 a[124:125], v4 offset:54624
    ds_read_b64_tr_b16 a[126:127], v4 offset:54752
    buffer_store_dwordx4 v[52:55], v10, s[40:43], s54 offen offset:0 sc1
    v_mfma_f32_16x16x32_bf16 v[40:43], a[96:99], v[128:131], 0
    s_add_u32 m0, s44, 73728
    ds_read_b64_tr_b16 a[64:65], v3 offset:0
    ds_read_b64_tr_b16 a[66:67], v3 offset:128
    v_mfma_f32_16x16x32_bf16 v[40:43], a[100:103], v[136:139], v[40:43]
    s_mov_b32 s45, 512
    s_waitcnt lgkmcnt(10)
    buffer_load_dwordx4 v7, s[28:31], s45 offen offset:0 lds
    v_mfma_f32_16x16x32_bf16 v[40:43], a[104:107], v[144:147], v[40:43]
    s_add_u32 m0, s44, 73632
    ds_read_b64_tr_b16 a[68:69], v3 offset:256
    ds_read_b64_tr_b16 a[70:71], v3 offset:384
    v_mfma_f32_16x16x32_bf16 v[40:43], a[108:111], v[152:155], v[40:43]
    s_waitcnt lgkmcnt(8)
    buffer_load_dwordx4 v7, s[28:31], s45 offen offset:1152 lds
    v_mfma_f32_16x16x32_bf16 v[40:43], a[112:115], v[192:195], v[40:43]
    s_add_u32 m0, s44, 73536
    ds_read_b64_tr_b16 a[72:73], v3 offset:512
    ds_read_b64_tr_b16 a[74:75], v3 offset:640
    v_mfma_f32_16x16x32_bf16 v[40:43], a[116:119], v[200:203], v[40:43]
    s_waitcnt lgkmcnt(6)
    buffer_load_dwordx4 v7, s[28:31], s45 offen offset:2304 lds
    v_mfma_f32_16x16x32_bf16 v[40:43], a[120:123], v[208:211], v[40:43]
    s_add_u32 m0, s44, 73440
    ds_read_b64_tr_b16 a[76:77], v3 offset:768
    ds_read_b64_tr_b16 a[78:79], v3 offset:896
    v_mfma_f32_16x16x32_bf16 v[40:43], a[124:127], v[216:219], v[40:43]
    buffer_load_dwordx4 v7, s[28:31], s45 offen offset:3456 lds
    v_mfma_f32_16x16x32_bf16 v[44:47], a[96:99], v[160:163], 0
    s_add_u32 m0, s44, 90624
    ds_read_b64_tr_b16 a[80:81], v3 offset:16896
    ds_read_b64_tr_b16 a[82:83], v3 offset:17024
    v_mfma_f32_16x16x32_bf16 v[44:47], a[100:103], v[168:171], v[44:47]
    s_mov_b32 s45, 147968
    buffer_load_dwordx4 v7, s[28:31], s45 offen offset:0 lds
    v_mfma_f32_16x16x32_bf16 v[44:47], a[104:107], v[176:179], v[44:47]
    s_add_u32 m0, s44, 90528
    ds_read_b64_tr_b16 a[84:85], v3 offset:17152
    ds_read_b64_tr_b16 a[86:87], v3 offset:17280
    v_mfma_f32_16x16x32_bf16 v[44:47], a[108:111], v[184:187], v[44:47]
    buffer_load_dwordx4 v7, s[28:31], s45 offen offset:1152 lds
    v_mfma_f32_16x16x32_bf16 v[44:47], a[112:115], v[224:227], v[44:47]
    s_add_u32 m0, s44, 90432
    ds_read_b64_tr_b16 a[88:89], v3 offset:17408
    ds_read_b64_tr_b16 a[90:91], v3 offset:17536
    v_mfma_f32_16x16x32_bf16 v[44:47], a[116:119], v[232:235], v[44:47]
    buffer_load_dwordx4 v7, s[28:31], s45 offen offset:2304 lds
    v_mfma_f32_16x16x32_bf16 v[44:47], a[120:123], v[240:243], v[44:47]
    s_add_u32 m0, s44, 90336
    ds_read_b64_tr_b16 a[92:93], v3 offset:17664
    ds_read_b64_tr_b16 a[94:95], v3 offset:17792
    v_mfma_f32_16x16x32_bf16 v[44:47], a[124:127], v[248:251], v[44:47]
    s_waitcnt lgkmcnt(12)
    buffer_load_dwordx4 v7, s[28:31], s45 offen offset:3456 lds
    v_mfma_f32_16x16x32_bf16 v[16:19], a[64:67], v[128:131], 0
    ds_read_b64_tr_b16 a[96:97], v3 offset:32
    v_cvt_pk_bf16_f32 v48, v32, v33
    v_mfma_f32_16x16x32_bf16 v[16:19], a[68:71], v[136:139], v[16:19]
    s_waitcnt lgkmcnt(9)
    ds_read_b64_tr_b16 a[98:99], v3 offset:160
    v_cvt_pk_bf16_f32 v49, v34, v35
    v_mfma_f32_16x16x32_bf16 v[16:19], a[72:75], v[144:147], v[16:19]
    ds_read_b64_tr_b16 a[100:101], v3 offset:288
    v_cvt_pk_bf16_f32 v50, v40, v41
    v_mfma_f32_16x16x32_bf16 v[16:19], a[76:79], v[152:155], v[16:19]
    s_waitcnt lgkmcnt(7)
    ds_read_b64_tr_b16 a[102:103], v3 offset:416
    v_cvt_pk_bf16_f32 v51, v42, v43
    v_mfma_f32_16x16x32_bf16 v[16:19], a[80:83], v[192:195], v[16:19]
    s_mov_b32 s54, 1024
    ds_read_b64_tr_b16 a[104:105], v3 offset:544
    ds_read_b64_tr_b16 a[106:107], v3 offset:672
    v_mfma_f32_16x16x32_bf16 v[16:19], a[84:87], v[200:203], v[16:19]
    s_waitcnt lgkmcnt(6)
    v_permlane32_swap_b32 v48, v50
    v_mfma_f32_16x16x32_bf16 v[16:19], a[88:91], v[208:211], v[16:19]
    v_permlane32_swap_b32 v49, v51
    v_mfma_f32_16x16x32_bf16 v[16:19], a[92:95], v[216:219], v[16:19]
    ds_read_b64_tr_b16 a[108:109], v3 offset:800
    ds_read_b64_tr_b16 a[110:111], v3 offset:928
    buffer_store_dwordx4 v[48:51], v10, s[40:43], s54 offen offset:512 sc1
    v_mfma_f32_16x16x32_bf16 v[20:23], a[64:67], v[160:163], 0
    ds_read_b64_tr_b16 a[112:113], v3 offset:16928
    v_cvt_pk_bf16_f32 v52, v36, v37
    v_mfma_f32_16x16x32_bf16 v[20:23], a[68:71], v[168:171], v[20:23]
    ds_read_b64_tr_b16 a[114:115], v3 offset:17056
    v_cvt_pk_bf16_f32 v53, v38, v39
    v_mfma_f32_16x16x32_bf16 v[20:23], a[72:75], v[176:179], v[20:23]
    ds_read_b64_tr_b16 a[116:117], v3 offset:17184
    v_cvt_pk_bf16_f32 v54, v44, v45
    v_mfma_f32_16x16x32_bf16 v[20:23], a[76:79], v[184:187], v[20:23]
    ds_read_b64_tr_b16 a[118:119], v3 offset:17312
    v_cvt_pk_bf16_f32 v55, v46, v47
    v_mfma_f32_16x16x32_bf16 v[20:23], a[80:83], v[224:227], v[20:23]
    s_mov_b32 s54, 295936
    ds_read_b64_tr_b16 a[120:121], v3 offset:17440
    ds_read_b64_tr_b16 a[122:123], v3 offset:17568
    v_mfma_f32_16x16x32_bf16 v[20:23], a[84:87], v[232:235], v[20:23]
    v_permlane32_swap_b32 v52, v54
    v_mfma_f32_16x16x32_bf16 v[20:23], a[88:91], v[240:243], v[20:23]
    v_permlane32_swap_b32 v53, v55
    v_mfma_f32_16x16x32_bf16 v[20:23], a[92:95], v[248:251], v[20:23]
    s_waitcnt lgkmcnt(10)
    ds_read_b64_tr_b16 a[124:125], v3 offset:17696
    ds_read_b64_tr_b16 a[126:127], v3 offset:17824
    buffer_store_dwordx4 v[52:55], v10, s[40:43], s54 offen offset:512 sc1
    v_mfma_f32_16x16x32_bf16 v[24:27], a[96:99], v[128:131], 0
    ds_read_b64_tr_b16 a[64:65], v3 offset:64
    ds_read_b64_tr_b16 a[66:67], v3 offset:192
    v_mfma_f32_16x16x32_bf16 v[24:27], a[100:103], v[136:139], v[24:27]
    s_waitcnt lgkmcnt(10)
    ds_read_b64_tr_b16 a[68:69], v3 offset:320
    ds_read_b64_tr_b16 a[70:71], v3 offset:448
    v_mfma_f32_16x16x32_bf16 v[24:27], a[104:107], v[144:147], v[24:27]
    ds_read_b64_tr_b16 a[72:73], v3 offset:576
    ds_read_b64_tr_b16 a[74:75], v3 offset:704
    v_mfma_f32_16x16x32_bf16 v[24:27], a[108:111], v[152:155], v[24:27]
    s_waitcnt lgkmcnt(10)
    buffer_load_dwordx4 v[116:119], v12, s[36:39], 0 offen offset:128
    v_mfma_f32_16x16x32_bf16 v[24:27], a[112:115], v[192:195], v[24:27]
    ds_read_b64_tr_b16 a[76:77], v3 offset:832
    ds_read_b64_tr_b16 a[78:79], v3 offset:960
    v_mfma_f32_16x16x32_bf16 v[24:27], a[116:119], v[200:203], v[24:27]
    s_waitcnt lgkmcnt(8)
    ds_read_b64_tr_b16 a[80:81], v3 offset:16960
    v_mfma_f32_16x16x32_bf16 v[24:27], a[120:123], v[208:211], v[24:27]
    ds_read_b64_tr_b16 a[82:83], v3 offset:17088
    v_mfma_f32_16x16x32_bf16 v[24:27], a[124:127], v[216:219], v[24:27]
    buffer_load_dwordx4 v[120:123], v13, s[36:39], 0 offen offset:256
    v_mfma_f32_16x16x32_bf16 v[28:31], a[96:99], v[160:163], 0
    ds_read_b64_tr_b16 a[84:85], v3 offset:17216
    v_mfma_f32_16x16x32_bf16 v[28:31], a[100:103], v[168:171], v[28:31]
    ds_read_b64_tr_b16 a[86:87], v3 offset:17344
    v_mfma_f32_16x16x32_bf16 v[28:31], a[104:107], v[176:179], v[28:31]
    s_movk_i32 s45, 4608
    ds_read_b64_tr_b16 a[88:89], v3 offset:17472
    v_mfma_f32_16x16x32_bf16 v[28:31], a[108:111], v[184:187], v[28:31]
    buffer_load_dwordx4 v[76:79], v5, s[84:87], s45 offen offset:0 sc1
    v_mfma_f32_16x16x32_bf16 v[28:31], a[112:115], v[224:227], v[28:31]
    ds_read_b64_tr_b16 a[90:91], v3 offset:17600
    v_mfma_f32_16x16x32_bf16 v[28:31], a[116:119], v[232:235], v[28:31]
    ds_read_b64_tr_b16 a[92:93], v3 offset:17728
    v_mfma_f32_16x16x32_bf16 v[28:31], a[120:123], v[240:243], v[28:31]
    s_movk_i32 s45, 18432
    ds_read_b64_tr_b16 a[94:95], v3 offset:17856
    v_mfma_f32_16x16x32_bf16 v[28:31], a[124:127], v[248:251], v[28:31]
    s_waitcnt lgkmcnt(12)
    buffer_load_dwordx4 v[88:91], v5, s[84:87], s45 offen offset:0 sc1
    v_mfma_f32_16x16x32_bf16 v[32:35], a[64:67], v[128:131], 0
    ds_read_b64_tr_b16 a[96:97], v3 offset:96
    v_cvt_pk_bf16_f32 v48, v16, v17
    v_mfma_f32_16x16x32_bf16 v[32:35], a[68:71], v[136:139], v[32:35]
    s_waitcnt lgkmcnt(9)
    ds_read_b64_tr_b16 a[98:99], v3 offset:224
    v_cvt_pk_bf16_f32 v49, v18, v19
    v_mfma_f32_16x16x32_bf16 v[32:35], a[72:75], v[144:147], v[32:35]
    ds_read_b64_tr_b16 a[100:101], v3 offset:352
    v_cvt_pk_bf16_f32 v50, v24, v25
    v_mfma_f32_16x16x32_bf16 v[32:35], a[76:79], v[152:155], v[32:35]
    s_waitcnt lgkmcnt(7)
    ds_read_b64_tr_b16 a[102:103], v3 offset:480
    v_cvt_pk_bf16_f32 v51, v26, v27
    v_mfma_f32_16x16x32_bf16 v[32:35], a[80:83], v[192:195], v[32:35]
    s_mov_b32 s54, 2048
    ds_read_b64_tr_b16 a[104:105], v3 offset:608
    ds_read_b64_tr_b16 a[106:107], v3 offset:736
    v_mfma_f32_16x16x32_bf16 v[32:35], a[84:87], v[200:203], v[32:35]
    s_waitcnt lgkmcnt(6)
    v_permlane32_swap_b32 v48, v50
    v_mfma_f32_16x16x32_bf16 v[32:35], a[88:91], v[208:211], v[32:35]
    v_permlane32_swap_b32 v49, v51
    v_mfma_f32_16x16x32_bf16 v[32:35], a[92:95], v[216:219], v[32:35]
    ds_read_b64_tr_b16 a[108:109], v3 offset:864
    ds_read_b64_tr_b16 a[110:111], v3 offset:992
    buffer_store_dwordx4 v[48:51], v10, s[40:43], s54 offen offset:0 sc1
    v_mfma_f32_16x16x32_bf16 v[36:39], a[64:67], v[160:163], 0
    ds_read_b64_tr_b16 a[112:113], v3 offset:16992
    v_cvt_pk_bf16_f32 v52, v20, v21
    v_mfma_f32_16x16x32_bf16 v[36:39], a[68:71], v[168:171], v[36:39]
    ds_read_b64_tr_b16 a[114:115], v3 offset:17120
    v_cvt_pk_bf16_f32 v53, v22, v23
    v_mfma_f32_16x16x32_bf16 v[36:39], a[72:75], v[176:179], v[36:39]
    ds_read_b64_tr_b16 a[116:117], v3 offset:17248
    v_cvt_pk_bf16_f32 v54, v28, v29
    v_mfma_f32_16x16x32_bf16 v[36:39], a[76:79], v[184:187], v[36:39]
    ds_read_b64_tr_b16 a[118:119], v3 offset:17376
    v_cvt_pk_bf16_f32 v55, v30, v31
    v_mfma_f32_16x16x32_bf16 v[36:39], a[80:83], v[224:227], v[36:39]
    s_mov_b32 s54, 296960
    ds_read_b64_tr_b16 a[120:121], v3 offset:17504
    ds_read_b64_tr_b16 a[122:123], v3 offset:17632
    v_mfma_f32_16x16x32_bf16 v[36:39], a[84:87], v[232:235], v[36:39]
    v_permlane32_swap_b32 v52, v54
    v_mfma_f32_16x16x32_bf16 v[36:39], a[88:91], v[240:243], v[36:39]
    v_permlane32_swap_b32 v53, v55
    v_mfma_f32_16x16x32_bf16 v[36:39], a[92:95], v[248:251], v[36:39]
    s_waitcnt vmcnt(23)
    s_barrier
    s_waitcnt lgkmcnt(10)
    ds_read_b64_tr_b16 a[124:125], v3 offset:17760
    ds_read_b64_tr_b16 a[126:127], v3 offset:17888
    buffer_store_dwordx4 v[52:55], v10, s[40:43], s54 offen offset:0 sc1
    v_mfma_f32_16x16x32_bf16 v[40:43], a[96:99], v[128:131], 0
    s_add_u32 m0, s44, 110592
    ds_read_b64_tr_b16 a[64:65], v3 offset:36864
    ds_read_b64_tr_b16 a[66:67], v3 offset:36992
    v_mfma_f32_16x16x32_bf16 v[40:43], a[100:103], v[136:139], v[40:43]
    s_mov_b32 s45, 640
    s_waitcnt lgkmcnt(10)
    buffer_load_dwordx4 v7, s[28:31], s45 offen offset:0 lds
    v_mfma_f32_16x16x32_bf16 v[40:43], a[104:107], v[144:147], v[40:43]
    s_add_u32 m0, s44, 110496
    ds_read_b64_tr_b16 a[68:69], v3 offset:37120
    ds_read_b64_tr_b16 a[70:71], v3 offset:37248
    v_mfma_f32_16x16x32_bf16 v[40:43], a[108:111], v[152:155], v[40:43]
    s_waitcnt lgkmcnt(8)
    buffer_load_dwordx4 v7, s[28:31], s45 offen offset:1152 lds
    v_mfma_f32_16x16x32_bf16 v[40:43], a[112:115], v[192:195], v[40:43]
    s_add_u32 m0, s44, 110400
    ds_read_b64_tr_b16 a[72:73], v3 offset:37376
    ds_read_b64_tr_b16 a[74:75], v3 offset:37504
    v_mfma_f32_16x16x32_bf16 v[40:43], a[116:119], v[200:203], v[40:43]
    s_waitcnt lgkmcnt(6)
    buffer_load_dwordx4 v7, s[28:31], s45 offen offset:2304 lds
    v_mfma_f32_16x16x32_bf16 v[40:43], a[120:123], v[208:211], v[40:43]
    s_add_u32 m0, s44, 110304
    ds_read_b64_tr_b16 a[76:77], v3 offset:37632
    ds_read_b64_tr_b16 a[78:79], v3 offset:37760
    v_mfma_f32_16x16x32_bf16 v[40:43], a[124:127], v[216:219], v[40:43]
    buffer_load_dwordx4 v7, s[28:31], s45 offen offset:3456 lds
    v_mfma_f32_16x16x32_bf16 v[44:47], a[96:99], v[160:163], 0
    s_add_u32 m0, s44, 127488
    ds_read_b64_tr_b16 a[80:81], v3 offset:53760
    ds_read_b64_tr_b16 a[82:83], v3 offset:53888
    v_mfma_f32_16x16x32_bf16 v[44:47], a[100:103], v[168:171], v[44:47]
    s_mov_b32 s45, 148096
    buffer_load_dwordx4 v7, s[28:31], s45 offen offset:0 lds
    v_mfma_f32_16x16x32_bf16 v[44:47], a[104:107], v[176:179], v[44:47]
    s_add_u32 m0, s44, 127392
    ds_read_b64_tr_b16 a[84:85], v3 offset:54016
    ds_read_b64_tr_b16 a[86:87], v3 offset:54144
    v_mfma_f32_16x16x32_bf16 v[44:47], a[108:111], v[184:187], v[44:47]
    buffer_load_dwordx4 v7, s[28:31], s45 offen offset:1152 lds
    v_mfma_f32_16x16x32_bf16 v[44:47], a[112:115], v[224:227], v[44:47]
    s_add_u32 m0, s44, 127296
    ds_read_b64_tr_b16 a[88:89], v3 offset:54272
    ds_read_b64_tr_b16 a[90:91], v3 offset:54400
    v_mfma_f32_16x16x32_bf16 v[44:47], a[116:119], v[232:235], v[44:47]
    buffer_load_dwordx4 v7, s[28:31], s45 offen offset:2304 lds
    v_mfma_f32_16x16x32_bf16 v[44:47], a[120:123], v[240:243], v[44:47]
    s_add_u32 m0, s44, 127200
    ds_read_b64_tr_b16 a[92:93], v3 offset:54528
    ds_read_b64_tr_b16 a[94:95], v3 offset:54656
    v_mfma_f32_16x16x32_bf16 v[44:47], a[124:127], v[248:251], v[44:47]
    s_waitcnt lgkmcnt(12)
    buffer_load_dwordx4 v7, s[28:31], s45 offen offset:3456 lds
    v_mfma_f32_16x16x32_bf16 v[16:19], a[64:67], v[128:131], 0
    ds_read_b64_tr_b16 a[96:97], v3 offset:36896
    v_cvt_pk_bf16_f32 v48, v32, v33
    v_mfma_f32_16x16x32_bf16 v[16:19], a[68:71], v[136:139], v[16:19]
    s_waitcnt lgkmcnt(9)
    ds_read_b64_tr_b16 a[98:99], v3 offset:37024
    v_cvt_pk_bf16_f32 v49, v34, v35
    v_mfma_f32_16x16x32_bf16 v[16:19], a[72:75], v[144:147], v[16:19]
    ds_read_b64_tr_b16 a[100:101], v3 offset:37152
    v_cvt_pk_bf16_f32 v50, v40, v41
    v_mfma_f32_16x16x32_bf16 v[16:19], a[76:79], v[152:155], v[16:19]
    s_waitcnt lgkmcnt(7)
    ds_read_b64_tr_b16 a[102:103], v3 offset:37280
    v_cvt_pk_bf16_f32 v51, v42, v43
    v_mfma_f32_16x16x32_bf16 v[16:19], a[80:83], v[192:195], v[16:19]
    s_mov_b32 s54, 2048
    ds_read_b64_tr_b16 a[104:105], v3 offset:37408
    ds_read_b64_tr_b16 a[106:107], v3 offset:37536
    v_mfma_f32_16x16x32_bf16 v[16:19], a[84:87], v[200:203], v[16:19]
    s_waitcnt lgkmcnt(6)
    v_permlane32_swap_b32 v48, v50
    v_mfma_f32_16x16x32_bf16 v[16:19], a[88:91], v[208:211], v[16:19]
    v_permlane32_swap_b32 v49, v51
    v_mfma_f32_16x16x32_bf16 v[16:19], a[92:95], v[216:219], v[16:19]
    ds_read_b64_tr_b16 a[108:109], v3 offset:37664
    ds_read_b64_tr_b16 a[110:111], v3 offset:37792
    buffer_store_dwordx4 v[48:51], v10, s[40:43], s54 offen offset:512 sc1
    v_mfma_f32_16x16x32_bf16 v[20:23], a[64:67], v[160:163], 0
    ds_read_b64_tr_b16 a[112:113], v3 offset:53792
    v_cvt_pk_bf16_f32 v52, v36, v37
    v_mfma_f32_16x16x32_bf16 v[20:23], a[68:71], v[168:171], v[20:23]
    ds_read_b64_tr_b16 a[114:115], v3 offset:53920
    v_cvt_pk_bf16_f32 v53, v38, v39
    v_mfma_f32_16x16x32_bf16 v[20:23], a[72:75], v[176:179], v[20:23]
    ds_read_b64_tr_b16 a[116:117], v3 offset:54048
    v_cvt_pk_bf16_f32 v54, v44, v45
    v_mfma_f32_16x16x32_bf16 v[20:23], a[76:79], v[184:187], v[20:23]
    ds_read_b64_tr_b16 a[118:119], v3 offset:54176
    v_cvt_pk_bf16_f32 v55, v46, v47
    v_mfma_f32_16x16x32_bf16 v[20:23], a[80:83], v[224:227], v[20:23]
    s_mov_b32 s54, 296960
    ds_read_b64_tr_b16 a[120:121], v3 offset:54304
    ds_read_b64_tr_b16 a[122:123], v3 offset:54432
    v_mfma_f32_16x16x32_bf16 v[20:23], a[84:87], v[232:235], v[20:23]
    v_permlane32_swap_b32 v52, v54
    v_mfma_f32_16x16x32_bf16 v[20:23], a[88:91], v[240:243], v[20:23]
    v_permlane32_swap_b32 v53, v55
    v_mfma_f32_16x16x32_bf16 v[20:23], a[92:95], v[248:251], v[20:23]
    s_waitcnt lgkmcnt(10)
    ds_read_b64_tr_b16 a[124:125], v3 offset:54560
    ds_read_b64_tr_b16 a[126:127], v3 offset:54688
    buffer_store_dwordx4 v[52:55], v10, s[40:43], s54 offen offset:512 sc1
    v_mfma_f32_16x16x32_bf16 v[24:27], a[96:99], v[128:131], 0
    ds_read_b64_tr_b16 a[64:65], v3 offset:36928
    ds_read_b64_tr_b16 a[66:67], v3 offset:37056
    v_mfma_f32_16x16x32_bf16 v[24:27], a[100:103], v[136:139], v[24:27]
    s_waitcnt lgkmcnt(10)
    ds_read_b64_tr_b16 a[68:69], v3 offset:37184
    ds_read_b64_tr_b16 a[70:71], v3 offset:37312
    v_mfma_f32_16x16x32_bf16 v[24:27], a[104:107], v[144:147], v[24:27]
    s_movk_i32 s45, 4608
    ds_read_b64_tr_b16 a[72:73], v3 offset:37440
    ds_read_b64_tr_b16 a[74:75], v3 offset:37568
    v_mfma_f32_16x16x32_bf16 v[24:27], a[108:111], v[152:155], v[24:27]
    s_waitcnt lgkmcnt(10)
    buffer_load_dwordx4 v[80:83], v5, s[84:87], s45 offen offset:1024 sc1
    v_mfma_f32_16x16x32_bf16 v[24:27], a[112:115], v[192:195], v[24:27]
    ds_read_b64_tr_b16 a[76:77], v3 offset:37696
    ds_read_b64_tr_b16 a[78:79], v3 offset:37824
    v_mfma_f32_16x16x32_bf16 v[24:27], a[116:119], v[200:203], v[24:27]
    s_waitcnt lgkmcnt(8)
    ds_read_b64_tr_b16 a[80:81], v3 offset:53824
    v_mfma_f32_16x16x32_bf16 v[24:27], a[120:123], v[208:211], v[24:27]
    s_movk_i32 s45, 18432
    ds_read_b64_tr_b16 a[82:83], v3 offset:53952
    v_mfma_f32_16x16x32_bf16 v[24:27], a[124:127], v[216:219], v[24:27]
    buffer_load_dwordx4 v[92:95], v5, s[84:87], s45 offen offset:1024 sc1
    v_mfma_f32_16x16x32_bf16 v[28:31], a[96:99], v[160:163], 0
    ds_read_b64_tr_b16 a[84:85], v3 offset:54080
    v_mfma_f32_16x16x32_bf16 v[28:31], a[100:103], v[168:171], v[28:31]
    ds_read_b64_tr_b16 a[86:87], v3 offset:54208
    v_mfma_f32_16x16x32_bf16 v[28:31], a[104:107], v[176:179], v[28:31]
    s_movk_i32 s45, 4608
    ds_read_b64_tr_b16 a[88:89], v3 offset:54336
    v_mfma_f32_16x16x32_bf16 v[28:31], a[108:111], v[184:187], v[28:31]
    buffer_load_dwordx4 v[84:87], v14, s[84:87], s45 offen offset:2048 sc1
    v_mfma_f32_16x16x32_bf16 v[28:31], a[112:115], v[224:227], v[28:31]
    ds_read_b64_tr_b16 a[90:91], v3 offset:54464
    v_mfma_f32_16x16x32_bf16 v[28:31], a[116:119], v[232:235], v[28:31]
    ds_read_b64_tr_b16 a[92:93], v3 offset:54592
    v_mfma_f32_16x16x32_bf16 v[28:31], a[120:123], v[240:243], v[28:31]
    s_movk_i32 s45, 18432
    ds_read_b64_tr_b16 a[94:95], v3 offset:54720
    v_mfma_f32_16x16x32_bf16 v[28:31], a[124:127], v[248:251], v[28:31]
    s_waitcnt lgkmcnt(12)
    buffer_load_dwordx4 v[96:99], v14, s[84:87], s45 offen offset:2048 sc1
    v_mfma_f32_16x16x32_bf16 v[32:35], a[64:67], v[128:131], 0
    ds_read_b64_tr_b16 a[96:97], v3 offset:36960
    v_cvt_pk_bf16_f32 v48, v16, v17
    v_mfma_f32_16x16x32_bf16 v[32:35], a[68:71], v[136:139], v[32:35]
    s_waitcnt lgkmcnt(9)
    ds_read_b64_tr_b16 a[98:99], v3 offset:37088
    v_cvt_pk_bf16_f32 v49, v18, v19
    v_mfma_f32_16x16x32_bf16 v[32:35], a[72:75], v[144:147], v[32:35]
    ds_read_b64_tr_b16 a[100:101], v3 offset:37216
    v_cvt_pk_bf16_f32 v50, v24, v25
    v_mfma_f32_16x16x32_bf16 v[32:35], a[76:79], v[152:155], v[32:35]
    s_waitcnt lgkmcnt(7)
    ds_read_b64_tr_b16 a[102:103], v3 offset:37344
    v_cvt_pk_bf16_f32 v51, v26, v27
    v_mfma_f32_16x16x32_bf16 v[32:35], a[80:83], v[192:195], v[32:35]
    s_mov_b32 s54, 3072
    ds_read_b64_tr_b16 a[104:105], v3 offset:37472
    ds_read_b64_tr_b16 a[106:107], v3 offset:37600
    v_mfma_f32_16x16x32_bf16 v[32:35], a[84:87], v[200:203], v[32:35]
    s_waitcnt lgkmcnt(6)
    v_permlane32_swap_b32 v48, v50
    v_mfma_f32_16x16x32_bf16 v[32:35], a[88:91], v[208:211], v[32:35]
    v_permlane32_swap_b32 v49, v51
    v_mfma_f32_16x16x32_bf16 v[32:35], a[92:95], v[216:219], v[32:35]
    ds_read_b64_tr_b16 a[108:109], v3 offset:37728
    ds_read_b64_tr_b16 a[110:111], v3 offset:37856
    buffer_store_dwordx4 v[48:51], v10, s[40:43], s54 offen offset:0 sc1
    v_mfma_f32_16x16x32_bf16 v[36:39], a[64:67], v[160:163], 0
    ds_read_b64_tr_b16 a[112:113], v3 offset:53856
    v_cvt_pk_bf16_f32 v52, v20, v21
    v_mfma_f32_16x16x32_bf16 v[36:39], a[68:71], v[168:171], v[36:39]
    ds_read_b64_tr_b16 a[114:115], v3 offset:53984
    v_cvt_pk_bf16_f32 v53, v22, v23
    v_mfma_f32_16x16x32_bf16 v[36:39], a[72:75], v[176:179], v[36:39]
    ds_read_b64_tr_b16 a[116:117], v3 offset:54112
    v_cvt_pk_bf16_f32 v54, v28, v29
    v_mfma_f32_16x16x32_bf16 v[36:39], a[76:79], v[184:187], v[36:39]
    ds_read_b64_tr_b16 a[118:119], v3 offset:54240
    v_cvt_pk_bf16_f32 v55, v30, v31
    v_mfma_f32_16x16x32_bf16 v[36:39], a[80:83], v[224:227], v[36:39]
    s_mov_b32 s54, 297984
    ds_read_b64_tr_b16 a[120:121], v3 offset:54368
    ds_read_b64_tr_b16 a[122:123], v3 offset:54496
    v_mfma_f32_16x16x32_bf16 v[36:39], a[84:87], v[232:235], v[36:39]
    v_permlane32_swap_b32 v52, v54
    v_mfma_f32_16x16x32_bf16 v[36:39], a[88:91], v[240:243], v[36:39]
    v_permlane32_swap_b32 v53, v55
    v_mfma_f32_16x16x32_bf16 v[36:39], a[92:95], v[248:251], v[36:39]
    s_waitcnt vmcnt(23)
    s_barrier
    s_waitcnt lgkmcnt(10)
    ds_read_b64_tr_b16 a[124:125], v3 offset:54624
    ds_read_b64_tr_b16 a[126:127], v3 offset:54752
    buffer_store_dwordx4 v[52:55], v10, s[40:43], s54 offen offset:0 sc1
    v_mfma_f32_16x16x32_bf16 v[40:43], a[96:99], v[128:131], 0
    s_add_u32 m0, s44, 0
    ds_read_b64_tr_b16 a[64:65], v4 offset:0
    ds_read_b64_tr_b16 a[66:67], v4 offset:128
    v_mfma_f32_16x16x32_bf16 v[40:43], a[100:103], v[136:139], v[40:43]
    s_mov_b32 s45, 768
    s_waitcnt lgkmcnt(10)
    buffer_load_dwordx4 v7, s[28:31], s45 offen offset:0 lds
    v_mfma_f32_16x16x32_bf16 v[40:43], a[104:107], v[144:147], v[40:43]
    s_add_u32 m0, s44, -96
    ds_read_b64_tr_b16 a[68:69], v4 offset:256
    ds_read_b64_tr_b16 a[70:71], v4 offset:384
    v_mfma_f32_16x16x32_bf16 v[40:43], a[108:111], v[152:155], v[40:43]
    s_waitcnt lgkmcnt(8)
    buffer_load_dwordx4 v7, s[28:31], s45 offen offset:1152 lds
    v_mfma_f32_16x16x32_bf16 v[40:43], a[112:115], v[192:195], v[40:43]
    s_add_u32 m0, s44, -192
    ds_read_b64_tr_b16 a[72:73], v4 offset:512
    ds_read_b64_tr_b16 a[74:75], v4 offset:640
    v_mfma_f32_16x16x32_bf16 v[40:43], a[116:119], v[200:203], v[40:43]
    s_waitcnt lgkmcnt(6)
    buffer_load_dwordx4 v7, s[28:31], s45 offen offset:2304 lds
    v_mfma_f32_16x16x32_bf16 v[40:43], a[120:123], v[208:211], v[40:43]
    s_add_u32 m0, s44, -288
    ds_read_b64_tr_b16 a[76:77], v4 offset:768
    ds_read_b64_tr_b16 a[78:79], v4 offset:896
    v_mfma_f32_16x16x32_bf16 v[40:43], a[124:127], v[216:219], v[40:43]
    buffer_load_dwordx4 v7, s[28:31], s45 offen offset:3456 lds
    v_mfma_f32_16x16x32_bf16 v[44:47], a[96:99], v[160:163], 0
    s_add_u32 m0, s44, 16896
    ds_read_b64_tr_b16 a[80:81], v4 offset:16896
    ds_read_b64_tr_b16 a[82:83], v4 offset:17024
    v_mfma_f32_16x16x32_bf16 v[44:47], a[100:103], v[168:171], v[44:47]
    s_mov_b32 s45, 148224
    buffer_load_dwordx4 v7, s[28:31], s45 offen offset:0 lds
    v_mfma_f32_16x16x32_bf16 v[44:47], a[104:107], v[176:179], v[44:47]
    s_add_u32 m0, s44, 16800
    ds_read_b64_tr_b16 a[84:85], v4 offset:17152
    ds_read_b64_tr_b16 a[86:87], v4 offset:17280
    v_mfma_f32_16x16x32_bf16 v[44:47], a[108:111], v[184:187], v[44:47]
    buffer_load_dwordx4 v7, s[28:31], s45 offen offset:1152 lds
    v_mfma_f32_16x16x32_bf16 v[44:47], a[112:115], v[224:227], v[44:47]
    s_add_u32 m0, s44, 16704
    ds_read_b64_tr_b16 a[88:89], v4 offset:17408
    ds_read_b64_tr_b16 a[90:91], v4 offset:17536
    v_mfma_f32_16x16x32_bf16 v[44:47], a[116:119], v[232:235], v[44:47]
    buffer_load_dwordx4 v7, s[28:31], s45 offen offset:2304 lds
    v_mfma_f32_16x16x32_bf16 v[44:47], a[120:123], v[240:243], v[44:47]
    s_add_u32 m0, s44, 16608
    ds_read_b64_tr_b16 a[92:93], v4 offset:17664
    ds_read_b64_tr_b16 a[94:95], v4 offset:17792
    v_mfma_f32_16x16x32_bf16 v[44:47], a[124:127], v[248:251], v[44:47]
    s_waitcnt lgkmcnt(12)
    buffer_load_dwordx4 v7, s[28:31], s45 offen offset:3456 lds
    v_mfma_f32_16x16x32_bf16 v[16:19], a[64:67], v[128:131], 0
    ds_read_b64_tr_b16 a[96:97], v4 offset:32
    v_cvt_pk_bf16_f32 v48, v32, v33
    v_mfma_f32_16x16x32_bf16 v[16:19], a[68:71], v[136:139], v[16:19]
    s_waitcnt lgkmcnt(9)
    ds_read_b64_tr_b16 a[98:99], v4 offset:160
    v_cvt_pk_bf16_f32 v49, v34, v35
    v_mfma_f32_16x16x32_bf16 v[16:19], a[72:75], v[144:147], v[16:19]
    ds_read_b64_tr_b16 a[100:101], v4 offset:288
    v_cvt_pk_bf16_f32 v50, v40, v41
    v_mfma_f32_16x16x32_bf16 v[16:19], a[76:79], v[152:155], v[16:19]
    s_waitcnt lgkmcnt(7)
    ds_read_b64_tr_b16 a[102:103], v4 offset:416
    v_cvt_pk_bf16_f32 v51, v42, v43
    v_mfma_f32_16x16x32_bf16 v[16:19], a[80:83], v[192:195], v[16:19]
    s_mov_b32 s54, 3072
    ds_read_b64_tr_b16 a[104:105], v4 offset:544
    ds_read_b64_tr_b16 a[106:107], v4 offset:672
    v_mfma_f32_16x16x32_bf16 v[16:19], a[84:87], v[200:203], v[16:19]
    s_waitcnt lgkmcnt(6)
    v_permlane32_swap_b32 v48, v50
    v_mfma_f32_16x16x32_bf16 v[16:19], a[88:91], v[208:211], v[16:19]
    v_permlane32_swap_b32 v49, v51
    v_mfma_f32_16x16x32_bf16 v[16:19], a[92:95], v[216:219], v[16:19]
    ds_read_b64_tr_b16 a[108:109], v4 offset:800
    ds_read_b64_tr_b16 a[110:111], v4 offset:928
    buffer_store_dwordx4 v[48:51], v10, s[40:43], s54 offen offset:512 sc1
    v_mfma_f32_16x16x32_bf16 v[20:23], a[64:67], v[160:163], 0
    ds_read_b64_tr_b16 a[112:113], v4 offset:16928
    v_cvt_pk_bf16_f32 v52, v36, v37
    v_mfma_f32_16x16x32_bf16 v[20:23], a[68:71], v[168:171], v[20:23]
    ds_read_b64_tr_b16 a[114:115], v4 offset:17056
    v_cvt_pk_bf16_f32 v53, v38, v39
    v_mfma_f32_16x16x32_bf16 v[20:23], a[72:75], v[176:179], v[20:23]
    ds_read_b64_tr_b16 a[116:117], v4 offset:17184
    v_cvt_pk_bf16_f32 v54, v44, v45
    v_mfma_f32_16x16x32_bf16 v[20:23], a[76:79], v[184:187], v[20:23]
    ds_read_b64_tr_b16 a[118:119], v4 offset:17312
    v_cvt_pk_bf16_f32 v55, v46, v47
    v_mfma_f32_16x16x32_bf16 v[20:23], a[80:83], v[224:227], v[20:23]
    s_mov_b32 s54, 297984
    ds_read_b64_tr_b16 a[120:121], v4 offset:17440
    ds_read_b64_tr_b16 a[122:123], v4 offset:17568
    v_mfma_f32_16x16x32_bf16 v[20:23], a[84:87], v[232:235], v[20:23]
    v_permlane32_swap_b32 v52, v54
    v_mfma_f32_16x16x32_bf16 v[20:23], a[88:91], v[240:243], v[20:23]
    v_permlane32_swap_b32 v53, v55
    v_mfma_f32_16x16x32_bf16 v[20:23], a[92:95], v[248:251], v[20:23]
    s_waitcnt lgkmcnt(10)
    ds_read_b64_tr_b16 a[124:125], v4 offset:17696
    ds_read_b64_tr_b16 a[126:127], v4 offset:17824
    buffer_store_dwordx4 v[52:55], v10, s[40:43], s54 offen offset:512 sc1
    v_mfma_f32_16x16x32_bf16 v[24:27], a[96:99], v[128:131], 0
    ds_read_b64_tr_b16 a[64:65], v4 offset:64
    ds_read_b64_tr_b16 a[66:67], v4 offset:192
    v_mfma_f32_16x16x32_bf16 v[24:27], a[100:103], v[136:139], v[24:27]
    s_waitcnt lgkmcnt(10)
    ds_read_b64_tr_b16 a[68:69], v4 offset:320
    ds_read_b64_tr_b16 a[70:71], v4 offset:448
    v_mfma_f32_16x16x32_bf16 v[24:27], a[104:107], v[144:147], v[24:27]
    s_add_u32 s54, s55, 0
    ds_read_b64_tr_b16 a[72:73], v4 offset:576
    ds_read_b64_tr_b16 a[74:75], v4 offset:704
    v_mfma_f32_16x16x32_bf16 v[24:27], a[108:111], v[152:155], v[24:27]
    s_waitcnt lgkmcnt(10)
    buffer_load_dwordx4 a[164:167], v8, s[72:75], s54 offen
    v_mfma_f32_16x16x32_bf16 v[24:27], a[112:115], v[192:195], v[24:27]
    ds_read_b64_tr_b16 a[76:77], v4 offset:832
    ds_read_b64_tr_b16 a[78:79], v4 offset:960
    v_mfma_f32_16x16x32_bf16 v[24:27], a[116:119], v[200:203], v[24:27]
    s_waitcnt lgkmcnt(8)
    ds_read_b64_tr_b16 a[80:81], v4 offset:16960
    v_mfma_f32_16x16x32_bf16 v[24:27], a[120:123], v[208:211], v[24:27]
    s_add_u32 s54, s55, 1024
    ds_read_b64_tr_b16 a[82:83], v4 offset:17088
    v_mfma_f32_16x16x32_bf16 v[24:27], a[124:127], v[216:219], v[24:27]
    buffer_load_dwordx4 a[168:171], v8, s[72:75], s54 offen
    v_mfma_f32_16x16x32_bf16 v[28:31], a[96:99], v[160:163], 0
    ds_read_b64_tr_b16 a[84:85], v4 offset:17216
    v_mfma_f32_16x16x32_bf16 v[28:31], a[100:103], v[168:171], v[28:31]
    ds_read_b64_tr_b16 a[86:87], v4 offset:17344
    v_mfma_f32_16x16x32_bf16 v[28:31], a[104:107], v[176:179], v[28:31]
    s_add_u32 s54, s55, 2048
    ds_read_b64_tr_b16 a[88:89], v4 offset:17472
    v_mfma_f32_16x16x32_bf16 v[28:31], a[108:111], v[184:187], v[28:31]
    buffer_load_dwordx4 a[172:175], v8, s[72:75], s54 offen
    v_mfma_f32_16x16x32_bf16 v[28:31], a[112:115], v[224:227], v[28:31]
    ds_read_b64_tr_b16 a[90:91], v4 offset:17600
    v_mfma_f32_16x16x32_bf16 v[28:31], a[116:119], v[232:235], v[28:31]
    ds_read_b64_tr_b16 a[92:93], v4 offset:17728
    v_mfma_f32_16x16x32_bf16 v[28:31], a[120:123], v[240:243], v[28:31]
    s_add_u32 s54, s55, 3072
    ds_read_b64_tr_b16 a[94:95], v4 offset:17856
    v_mfma_f32_16x16x32_bf16 v[28:31], a[124:127], v[248:251], v[28:31]
    s_waitcnt lgkmcnt(12)
    buffer_load_dwordx4 a[176:179], v8, s[72:75], s54 offen
    v_mfma_f32_16x16x32_bf16 v[32:35], a[64:67], v[128:131], 0
    ds_read_b64_tr_b16 a[96:97], v4 offset:96
    v_cvt_pk_bf16_f32 v48, v16, v17
    v_mfma_f32_16x16x32_bf16 v[32:35], a[68:71], v[136:139], v[32:35]
    s_waitcnt lgkmcnt(9)
    ds_read_b64_tr_b16 a[98:99], v4 offset:224
    v_cvt_pk_bf16_f32 v49, v18, v19
    v_mfma_f32_16x16x32_bf16 v[32:35], a[72:75], v[144:147], v[32:35]
    ds_read_b64_tr_b16 a[100:101], v4 offset:352
    v_cvt_pk_bf16_f32 v50, v24, v25
    v_mfma_f32_16x16x32_bf16 v[32:35], a[76:79], v[152:155], v[32:35]
    s_waitcnt lgkmcnt(7)
    ds_read_b64_tr_b16 a[102:103], v4 offset:480
    v_cvt_pk_bf16_f32 v51, v26, v27
    v_mfma_f32_16x16x32_bf16 v[32:35], a[80:83], v[192:195], v[32:35]
    s_mov_b32 s54, 4096
    ds_read_b64_tr_b16 a[104:105], v4 offset:608
    ds_read_b64_tr_b16 a[106:107], v4 offset:736
    v_mfma_f32_16x16x32_bf16 v[32:35], a[84:87], v[200:203], v[32:35]
    s_waitcnt lgkmcnt(6)
    v_permlane32_swap_b32 v48, v50
    v_mfma_f32_16x16x32_bf16 v[32:35], a[88:91], v[208:211], v[32:35]
    v_permlane32_swap_b32 v49, v51
    v_mfma_f32_16x16x32_bf16 v[32:35], a[92:95], v[216:219], v[32:35]
    ds_read_b64_tr_b16 a[108:109], v4 offset:864
    ds_read_b64_tr_b16 a[110:111], v4 offset:992
    buffer_store_dwordx4 v[48:51], v10, s[40:43], s54 offen offset:0 sc1
    v_mfma_f32_16x16x32_bf16 v[36:39], a[64:67], v[160:163], 0
    ds_read_b64_tr_b16 a[112:113], v4 offset:16992
    v_cvt_pk_bf16_f32 v52, v20, v21
    v_mfma_f32_16x16x32_bf16 v[36:39], a[68:71], v[168:171], v[36:39]
    ds_read_b64_tr_b16 a[114:115], v4 offset:17120
    v_cvt_pk_bf16_f32 v53, v22, v23
    v_mfma_f32_16x16x32_bf16 v[36:39], a[72:75], v[176:179], v[36:39]
    ds_read_b64_tr_b16 a[116:117], v4 offset:17248
    v_cvt_pk_bf16_f32 v54, v28, v29
    v_mfma_f32_16x16x32_bf16 v[36:39], a[76:79], v[184:187], v[36:39]
    ds_read_b64_tr_b16 a[118:119], v4 offset:17376
    v_cvt_pk_bf16_f32 v55, v30, v31
    v_mfma_f32_16x16x32_bf16 v[36:39], a[80:83], v[224:227], v[36:39]
    s_mov_b32 s54, 299008
    ds_read_b64_tr_b16 a[120:121], v4 offset:17504
    ds_read_b64_tr_b16 a[122:123], v4 offset:17632
    v_mfma_f32_16x16x32_bf16 v[36:39], a[84:87], v[232:235], v[36:39]
    v_permlane32_swap_b32 v52, v54
    v_mfma_f32_16x16x32_bf16 v[36:39], a[88:91], v[240:243], v[36:39]
    v_permlane32_swap_b32 v53, v55
    v_mfma_f32_16x16x32_bf16 v[36:39], a[92:95], v[248:251], v[36:39]
    s_waitcnt vmcnt(23)
    s_barrier
    s_waitcnt lgkmcnt(10)
    ds_read_b64_tr_b16 a[124:125], v4 offset:17760
    ds_read_b64_tr_b16 a[126:127], v4 offset:17888
    buffer_store_dwordx4 v[52:55], v10, s[40:43], s54 offen offset:0 sc1
    v_mfma_f32_16x16x32_bf16 v[40:43], a[96:99], v[128:131], 0
    s_add_u32 m0, s44, 36864
    ds_read_b64_tr_b16 a[64:65], v4 offset:36864
    ds_read_b64_tr_b16 a[66:67], v4 offset:36992
    v_mfma_f32_16x16x32_bf16 v[40:43], a[100:103], v[136:139], v[40:43]
    s_mov_b32 s45, 896
    s_waitcnt lgkmcnt(10)
    buffer_load_dwordx4 v7, s[28:31], s45 offen offset:0 lds
    v_mfma_f32_16x16x32_bf16 v[40:43], a[104:107], v[144:147], v[40:43]
    s_add_u32 m0, s44, 36768
    ds_read_b64_tr_b16 a[68:69], v4 offset:37120
    ds_read_b64_tr_b16 a[70:71], v4 offset:37248
    v_mfma_f32_16x16x32_bf16 v[40:43], a[108:111], v[152:155], v[40:43]
    s_waitcnt lgkmcnt(8)
    buffer_load_dwordx4 v7, s[28:31], s45 offen offset:1152 lds
    v_mfma_f32_16x16x32_bf16 v[40:43], a[112:115], v[192:195], v[40:43]
    s_add_u32 m0, s44, 36672
    ds_read_b64_tr_b16 a[72:73], v4 offset:37376
    ds_read_b64_tr_b16 a[74:75], v4 offset:37504
    v_mfma_f32_16x16x32_bf16 v[40:43], a[116:119], v[200:203], v[40:43]
    s_waitcnt lgkmcnt(6)
    buffer_load_dwordx4 v7, s[28:31], s45 offen offset:2304 lds
    v_mfma_f32_16x16x32_bf16 v[40:43], a[120:123], v[208:211], v[40:43]
    s_add_u32 m0, s44, 36576
    ds_read_b64_tr_b16 a[76:77], v4 offset:37632
    ds_read_b64_tr_b16 a[78:79], v4 offset:37760
    v_mfma_f32_16x16x32_bf16 v[40:43], a[124:127], v[216:219], v[40:43]
    buffer_load_dwordx4 v7, s[28:31], s45 offen offset:3456 lds
    v_mfma_f32_16x16x32_bf16 v[44:47], a[96:99], v[160:163], 0
    s_add_u32 m0, s44, 53760
    ds_read_b64_tr_b16 a[80:81], v4 offset:53760
    ds_read_b64_tr_b16 a[82:83], v4 offset:53888
    v_mfma_f32_16x16x32_bf16 v[44:47], a[100:103], v[168:171], v[44:47]
    s_mov_b32 s45, 148352
    buffer_load_dwordx4 v7, s[28:31], s45 offen offset:0 lds
    v_mfma_f32_16x16x32_bf16 v[44:47], a[104:107], v[176:179], v[44:47]
    s_add_u32 m0, s44, 53664
    ds_read_b64_tr_b16 a[84:85], v4 offset:54016
    ds_read_b64_tr_b16 a[86:87], v4 offset:54144
    v_mfma_f32_16x16x32_bf16 v[44:47], a[108:111], v[184:187], v[44:47]
    buffer_load_dwordx4 v7, s[28:31], s45 offen offset:1152 lds
    v_mfma_f32_16x16x32_bf16 v[44:47], a[112:115], v[224:227], v[44:47]
    s_add_u32 m0, s44, 53568
    ds_read_b64_tr_b16 a[88:89], v4 offset:54272
    ds_read_b64_tr_b16 a[90:91], v4 offset:54400
    v_mfma_f32_16x16x32_bf16 v[44:47], a[116:119], v[232:235], v[44:47]
    buffer_load_dwordx4 v7, s[28:31], s45 offen offset:2304 lds
    v_mfma_f32_16x16x32_bf16 v[44:47], a[120:123], v[240:243], v[44:47]
    s_add_u32 m0, s44, 53472
    ds_read_b64_tr_b16 a[92:93], v4 offset:54528
    ds_read_b64_tr_b16 a[94:95], v4 offset:54656
    v_mfma_f32_16x16x32_bf16 v[44:47], a[124:127], v[248:251], v[44:47]
    s_waitcnt lgkmcnt(12)
    buffer_load_dwordx4 v7, s[28:31], s45 offen offset:3456 lds
    v_mfma_f32_16x16x32_bf16 v[16:19], a[64:67], v[128:131], 0
    ds_read_b64_tr_b16 a[96:97], v4 offset:36896
    v_cvt_pk_bf16_f32 v48, v32, v33
    v_mfma_f32_16x16x32_bf16 v[16:19], a[68:71], v[136:139], v[16:19]
    s_waitcnt lgkmcnt(9)
    ds_read_b64_tr_b16 a[98:99], v4 offset:37024
    v_cvt_pk_bf16_f32 v49, v34, v35
    v_mfma_f32_16x16x32_bf16 v[16:19], a[72:75], v[144:147], v[16:19]
    ds_read_b64_tr_b16 a[100:101], v4 offset:37152
    v_cvt_pk_bf16_f32 v50, v40, v41
    v_mfma_f32_16x16x32_bf16 v[16:19], a[76:79], v[152:155], v[16:19]
    s_waitcnt lgkmcnt(7)
    ds_read_b64_tr_b16 a[102:103], v4 offset:37280
    v_cvt_pk_bf16_f32 v51, v42, v43
    v_mfma_f32_16x16x32_bf16 v[16:19], a[80:83], v[192:195], v[16:19]
    s_mov_b32 s54, 4096
    ds_read_b64_tr_b16 a[104:105], v4 offset:37408
    ds_read_b64_tr_b16 a[106:107], v4 offset:37536
    v_mfma_f32_16x16x32_bf16 v[16:19], a[84:87], v[200:203], v[16:19]
    s_waitcnt lgkmcnt(6)
    v_permlane32_swap_b32 v48, v50
    v_mfma_f32_16x16x32_bf16 v[16:19], a[88:91], v[208:211], v[16:19]
    v_permlane32_swap_b32 v49, v51
    v_mfma_f32_16x16x32_bf16 v[16:19], a[92:95], v[216:219], v[16:19]
    ds_read_b64_tr_b16 a[108:109], v4 offset:37664
    ds_read_b64_tr_b16 a[110:111], v4 offset:37792
    buffer_store_dwordx4 v[48:51], v10, s[40:43], s54 offen offset:512 sc1
    v_mfma_f32_16x16x32_bf16 v[20:23], a[64:67], v[160:163], 0
    ds_read_b64_tr_b16 a[112:113], v4 offset:53792
    v_cvt_pk_bf16_f32 v52, v36, v37
    v_mfma_f32_16x16x32_bf16 v[20:23], a[68:71], v[168:171], v[20:23]
    ds_read_b64_tr_b16 a[114:115], v4 offset:53920
    v_cvt_pk_bf16_f32 v53, v38, v39
    v_mfma_f32_16x16x32_bf16 v[20:23], a[72:75], v[176:179], v[20:23]
    ds_read_b64_tr_b16 a[116:117], v4 offset:54048
    v_cvt_pk_bf16_f32 v54, v44, v45
    v_mfma_f32_16x16x32_bf16 v[20:23], a[76:79], v[184:187], v[20:23]
    ds_read_b64_tr_b16 a[118:119], v4 offset:54176
    v_cvt_pk_bf16_f32 v55, v46, v47
    v_mfma_f32_16x16x32_bf16 v[20:23], a[80:83], v[224:227], v[20:23]
    s_mov_b32 s54, 299008
    ds_read_b64_tr_b16 a[120:121], v4 offset:54304
    ds_read_b64_tr_b16 a[122:123], v4 offset:54432
    v_mfma_f32_16x16x32_bf16 v[20:23], a[84:87], v[232:235], v[20:23]
    v_permlane32_swap_b32 v52, v54
    v_mfma_f32_16x16x32_bf16 v[20:23], a[88:91], v[240:243], v[20:23]
    v_permlane32_swap_b32 v53, v55
    v_mfma_f32_16x16x32_bf16 v[20:23], a[92:95], v[248:251], v[20:23]
    s_waitcnt lgkmcnt(10)
    ds_read_b64_tr_b16 a[124:125], v4 offset:54560
    ds_read_b64_tr_b16 a[126:127], v4 offset:54688
    buffer_store_dwordx4 v[52:55], v10, s[40:43], s54 offen offset:512 sc1
    v_mfma_f32_16x16x32_bf16 v[24:27], a[96:99], v[128:131], 0
    ds_read_b64_tr_b16 a[64:65], v4 offset:36928
    ds_read_b64_tr_b16 a[66:67], v4 offset:37056
    v_mfma_f32_16x16x32_bf16 v[24:27], a[100:103], v[136:139], v[24:27]
    s_waitcnt lgkmcnt(10)
    ds_read_b64_tr_b16 a[68:69], v4 offset:37184
    ds_read_b64_tr_b16 a[70:71], v4 offset:37312
    v_mfma_f32_16x16x32_bf16 v[24:27], a[104:107], v[144:147], v[24:27]
    s_add_u32 s54, s55, 4096
    ds_read_b64_tr_b16 a[72:73], v4 offset:37440
    ds_read_b64_tr_b16 a[74:75], v4 offset:37568
    v_mfma_f32_16x16x32_bf16 v[24:27], a[108:111], v[152:155], v[24:27]
    s_waitcnt lgkmcnt(10)
    buffer_load_dwordx4 a[180:183], v8, s[72:75], s54 offen
    v_mfma_f32_16x16x32_bf16 v[24:27], a[112:115], v[192:195], v[24:27]
    ds_read_b64_tr_b16 a[76:77], v4 offset:37696
    ds_read_b64_tr_b16 a[78:79], v4 offset:37824
    v_mfma_f32_16x16x32_bf16 v[24:27], a[116:119], v[200:203], v[24:27]
    s_waitcnt lgkmcnt(8)
    ds_read_b64_tr_b16 a[80:81], v4 offset:53824
    v_mfma_f32_16x16x32_bf16 v[24:27], a[120:123], v[208:211], v[24:27]
    s_add_u32 s54, s55, 5120
    ds_read_b64_tr_b16 a[82:83], v4 offset:53952
    v_mfma_f32_16x16x32_bf16 v[24:27], a[124:127], v[216:219], v[24:27]
    buffer_load_dwordx4 a[184:187], v8, s[72:75], s54 offen
    v_mfma_f32_16x16x32_bf16 v[28:31], a[96:99], v[160:163], 0
    ds_read_b64_tr_b16 a[84:85], v4 offset:54080
    v_mfma_f32_16x16x32_bf16 v[28:31], a[100:103], v[168:171], v[28:31]
    ds_read_b64_tr_b16 a[86:87], v4 offset:54208
    v_mfma_f32_16x16x32_bf16 v[28:31], a[104:107], v[176:179], v[28:31]
    s_add_u32 s54, s55, 6144
    ds_read_b64_tr_b16 a[88:89], v4 offset:54336
    v_mfma_f32_16x16x32_bf16 v[28:31], a[108:111], v[184:187], v[28:31]
    buffer_load_dwordx4 a[188:191], v8, s[72:75], s54 offen
    v_mfma_f32_16x16x32_bf16 v[28:31], a[112:115], v[224:227], v[28:31]
    ds_read_b64_tr_b16 a[90:91], v4 offset:54464
    v_mfma_f32_16x16x32_bf16 v[28:31], a[116:119], v[232:235], v[28:31]
    ds_read_b64_tr_b16 a[92:93], v4 offset:54592
    v_mfma_f32_16x16x32_bf16 v[28:31], a[120:123], v[240:243], v[28:31]
    s_add_u32 s54, s55, 7168
    ds_read_b64_tr_b16 a[94:95], v4 offset:54720
    v_mfma_f32_16x16x32_bf16 v[28:31], a[124:127], v[248:251], v[28:31]
    s_waitcnt lgkmcnt(12)
    buffer_load_dwordx4 a[192:195], v8, s[72:75], s54 offen
    v_mfma_f32_16x16x32_bf16 v[32:35], a[64:67], v[128:131], 0
    ds_read_b64_tr_b16 a[96:97], v4 offset:36960
    v_cvt_pk_bf16_f32 v48, v16, v17
    v_mfma_f32_16x16x32_bf16 v[32:35], a[68:71], v[136:139], v[32:35]
    s_waitcnt lgkmcnt(9)
    ds_read_b64_tr_b16 a[98:99], v4 offset:37088
    v_cvt_pk_bf16_f32 v49, v18, v19
    v_mfma_f32_16x16x32_bf16 v[32:35], a[72:75], v[144:147], v[32:35]
    ds_read_b64_tr_b16 a[100:101], v4 offset:37216
    v_cvt_pk_bf16_f32 v50, v24, v25
    v_mfma_f32_16x16x32_bf16 v[32:35], a[76:79], v[152:155], v[32:35]
    s_waitcnt lgkmcnt(7)
    ds_read_b64_tr_b16 a[102:103], v4 offset:37344
    v_cvt_pk_bf16_f32 v51, v26, v27
    v_mfma_f32_16x16x32_bf16 v[32:35], a[80:83], v[192:195], v[32:35]
    s_mov_b32 s54, 5120
    ds_read_b64_tr_b16 a[104:105], v4 offset:37472
    ds_read_b64_tr_b16 a[106:107], v4 offset:37600
    v_mfma_f32_16x16x32_bf16 v[32:35], a[84:87], v[200:203], v[32:35]
    s_waitcnt lgkmcnt(6)
    v_permlane32_swap_b32 v48, v50
    v_mfma_f32_16x16x32_bf16 v[32:35], a[88:91], v[208:211], v[32:35]
    v_permlane32_swap_b32 v49, v51
    v_mfma_f32_16x16x32_bf16 v[32:35], a[92:95], v[216:219], v[32:35]
    ds_read_b64_tr_b16 a[108:109], v4 offset:37728
    ds_read_b64_tr_b16 a[110:111], v4 offset:37856
    buffer_store_dwordx4 v[48:51], v10, s[40:43], s54 offen offset:0 sc1
    v_mfma_f32_16x16x32_bf16 v[36:39], a[64:67], v[160:163], 0
    ds_read_b64_tr_b16 a[112:113], v4 offset:53856
    v_cvt_pk_bf16_f32 v52, v20, v21
    v_mfma_f32_16x16x32_bf16 v[36:39], a[68:71], v[168:171], v[36:39]
    ds_read_b64_tr_b16 a[114:115], v4 offset:53984
    v_cvt_pk_bf16_f32 v53, v22, v23
    v_mfma_f32_16x16x32_bf16 v[36:39], a[72:75], v[176:179], v[36:39]
    ds_read_b64_tr_b16 a[116:117], v4 offset:54112
    v_cvt_pk_bf16_f32 v54, v28, v29
    v_mfma_f32_16x16x32_bf16 v[36:39], a[76:79], v[184:187], v[36:39]
    ds_read_b64_tr_b16 a[118:119], v4 offset:54240
    v_cvt_pk_bf16_f32 v55, v30, v31
    v_mfma_f32_16x16x32_bf16 v[36:39], a[80:83], v[224:227], v[36:39]
    s_mov_b32 s54, 300032
    ds_read_b64_tr_b16 a[120:121], v4 offset:54368
    ds_read_b64_tr_b16 a[122:123], v4 offset:54496
    v_mfma_f32_16x16x32_bf16 v[36:39], a[84:87], v[232:235], v[36:39]
    v_permlane32_swap_b32 v52, v54
    v_mfma_f32_16x16x32_bf16 v[36:39], a[88:91], v[240:243], v[36:39]
    v_permlane32_swap_b32 v53, v55
    v_mfma_f32_16x16x32_bf16 v[36:39], a[92:95], v[248:251], v[36:39]
    s_waitcnt vmcnt(23)
    s_barrier
    s_waitcnt lgkmcnt(10)
    ds_read_b64_tr_b16 a[124:125], v4 offset:54624
    ds_read_b64_tr_b16 a[126:127], v4 offset:54752
    buffer_store_dwordx4 v[52:55], v10, s[40:43], s54 offen offset:0 sc1
    v_mfma_f32_16x16x32_bf16 v[40:43], a[96:99], v[128:131], 0
    s_add_u32 m0, s44, 73728
    ds_read_b64_tr_b16 a[64:65], v3 offset:0
    ds_read_b64_tr_b16 a[66:67], v3 offset:128
    v_mfma_f32_16x16x32_bf16 v[40:43], a[100:103], v[136:139], v[40:43]
    s_mov_b32 s45, 1024
    s_waitcnt lgkmcnt(10)
    buffer_load_dwordx4 v7, s[28:31], s45 offen offset:0 lds
    v_mfma_f32_16x16x32_bf16 v[40:43], a[104:107], v[144:147], v[40:43]
    s_add_u32 m0, s44, 73632
    ds_read_b64_tr_b16 a[68:69], v3 offset:256
    ds_read_b64_tr_b16 a[70:71], v3 offset:384
    v_mfma_f32_16x16x32_bf16 v[40:43], a[108:111], v[152:155], v[40:43]
    s_waitcnt lgkmcnt(8)
    buffer_load_dwordx4 v7, s[28:31], s45 offen offset:1152 lds
    v_mfma_f32_16x16x32_bf16 v[40:43], a[112:115], v[192:195], v[40:43]
    s_add_u32 m0, s44, 73536
    ds_read_b64_tr_b16 a[72:73], v3 offset:512
    ds_read_b64_tr_b16 a[74:75], v3 offset:640
    v_mfma_f32_16x16x32_bf16 v[40:43], a[116:119], v[200:203], v[40:43]
    s_waitcnt lgkmcnt(6)
    buffer_load_dwordx4 v7, s[28:31], s45 offen offset:2304 lds
    v_mfma_f32_16x16x32_bf16 v[40:43], a[120:123], v[208:211], v[40:43]
    s_add_u32 m0, s44, 73440
    ds_read_b64_tr_b16 a[76:77], v3 offset:768
    ds_read_b64_tr_b16 a[78:79], v3 offset:896
    v_mfma_f32_16x16x32_bf16 v[40:43], a[124:127], v[216:219], v[40:43]
    buffer_load_dwordx4 v7, s[28:31], s45 offen offset:3456 lds
    v_mfma_f32_16x16x32_bf16 v[44:47], a[96:99], v[160:163], 0
    s_add_u32 m0, s44, 90624
    ds_read_b64_tr_b16 a[80:81], v3 offset:16896
    ds_read_b64_tr_b16 a[82:83], v3 offset:17024
    v_mfma_f32_16x16x32_bf16 v[44:47], a[100:103], v[168:171], v[44:47]
    s_mov_b32 s45, 148480
    buffer_load_dwordx4 v7, s[28:31], s45 offen offset:0 lds
    v_mfma_f32_16x16x32_bf16 v[44:47], a[104:107], v[176:179], v[44:47]
    s_add_u32 m0, s44, 90528
    ds_read_b64_tr_b16 a[84:85], v3 offset:17152
    ds_read_b64_tr_b16 a[86:87], v3 offset:17280
    v_mfma_f32_16x16x32_bf16 v[44:47], a[108:111], v[184:187], v[44:47]
    buffer_load_dwordx4 v7, s[28:31], s45 offen offset:1152 lds
    v_mfma_f32_16x16x32_bf16 v[44:47], a[112:115], v[224:227], v[44:47]
    s_add_u32 m0, s44, 90432
    ds_read_b64_tr_b16 a[88:89], v3 offset:17408
    ds_read_b64_tr_b16 a[90:91], v3 offset:17536
    v_mfma_f32_16x16x32_bf16 v[44:47], a[116:119], v[232:235], v[44:47]
    buffer_load_dwordx4 v7, s[28:31], s45 offen offset:2304 lds
    v_mfma_f32_16x16x32_bf16 v[44:47], a[120:123], v[240:243], v[44:47]
    s_add_u32 m0, s44, 90336
    ds_read_b64_tr_b16 a[92:93], v3 offset:17664
    ds_read_b64_tr_b16 a[94:95], v3 offset:17792
    v_mfma_f32_16x16x32_bf16 v[44:47], a[124:127], v[248:251], v[44:47]
    s_waitcnt lgkmcnt(12)
    buffer_load_dwordx4 v7, s[28:31], s45 offen offset:3456 lds
    v_mfma_f32_16x16x32_bf16 v[16:19], a[64:67], v[128:131], 0
    ds_read_b64_tr_b16 a[96:97], v3 offset:32
    v_cvt_pk_bf16_f32 v48, v32, v33
    v_mfma_f32_16x16x32_bf16 v[16:19], a[68:71], v[136:139], v[16:19]
    s_waitcnt lgkmcnt(9)
    ds_read_b64_tr_b16 a[98:99], v3 offset:160
    v_cvt_pk_bf16_f32 v49, v34, v35
    v_mfma_f32_16x16x32_bf16 v[16:19], a[72:75], v[144:147], v[16:19]
    ds_read_b64_tr_b16 a[100:101], v3 offset:288
    v_cvt_pk_bf16_f32 v50, v40, v41
    v_mfma_f32_16x16x32_bf16 v[16:19], a[76:79], v[152:155], v[16:19]
    s_waitcnt lgkmcnt(7)
    ds_read_b64_tr_b16 a[102:103], v3 offset:416
    v_cvt_pk_bf16_f32 v51, v42, v43
    v_mfma_f32_16x16x32_bf16 v[16:19], a[80:83], v[192:195], v[16:19]
    s_mov_b32 s54, 5120
    ds_read_b64_tr_b16 a[104:105], v3 offset:544
    ds_read_b64_tr_b16 a[106:107], v3 offset:672
    v_mfma_f32_16x16x32_bf16 v[16:19], a[84:87], v[200:203], v[16:19]
    s_waitcnt lgkmcnt(6)
    v_permlane32_swap_b32 v48, v50
    v_mfma_f32_16x16x32_bf16 v[16:19], a[88:91], v[208:211], v[16:19]
    v_permlane32_swap_b32 v49, v51
    v_mfma_f32_16x16x32_bf16 v[16:19], a[92:95], v[216:219], v[16:19]
    ds_read_b64_tr_b16 a[108:109], v3 offset:800
    ds_read_b64_tr_b16 a[110:111], v3 offset:928
    buffer_store_dwordx4 v[48:51], v10, s[40:43], s54 offen offset:512 sc1
    v_mfma_f32_16x16x32_bf16 v[20:23], a[64:67], v[160:163], 0
    ds_read_b64_tr_b16 a[112:113], v3 offset:16928
    v_cvt_pk_bf16_f32 v52, v36, v37
    v_mfma_f32_16x16x32_bf16 v[20:23], a[68:71], v[168:171], v[20:23]
    ds_read_b64_tr_b16 a[114:115], v3 offset:17056
    v_cvt_pk_bf16_f32 v53, v38, v39
    v_mfma_f32_16x16x32_bf16 v[20:23], a[72:75], v[176:179], v[20:23]
    ds_read_b64_tr_b16 a[116:117], v3 offset:17184
    v_cvt_pk_bf16_f32 v54, v44, v45
    v_mfma_f32_16x16x32_bf16 v[20:23], a[76:79], v[184:187], v[20:23]
    ds_read_b64_tr_b16 a[118:119], v3 offset:17312
    v_cvt_pk_bf16_f32 v55, v46, v47
    v_mfma_f32_16x16x32_bf16 v[20:23], a[80:83], v[224:227], v[20:23]
    s_mov_b32 s54, 300032
    ds_read_b64_tr_b16 a[120:121], v3 offset:17440
    ds_read_b64_tr_b16 a[122:123], v3 offset:17568
    v_mfma_f32_16x16x32_bf16 v[20:23], a[84:87], v[232:235], v[20:23]
    v_permlane32_swap_b32 v52, v54
    v_mfma_f32_16x16x32_bf16 v[20:23], a[88:91], v[240:243], v[20:23]
    v_permlane32_swap_b32 v53, v55
    v_mfma_f32_16x16x32_bf16 v[20:23], a[92:95], v[248:251], v[20:23]
    s_waitcnt lgkmcnt(10)
    ds_read_b64_tr_b16 a[124:125], v3 offset:17696
    ds_read_b64_tr_b16 a[126:127], v3 offset:17824
    buffer_store_dwordx4 v[52:55], v10, s[40:43], s54 offen offset:512 sc1
    v_mfma_f32_16x16x32_bf16 v[24:27], a[96:99], v[128:131], 0
    ds_read_b64_tr_b16 a[64:65], v3 offset:64
    ds_read_b64_tr_b16 a[66:67], v3 offset:192
    v_mfma_f32_16x16x32_bf16 v[24:27], a[100:103], v[136:139], v[24:27]
    s_waitcnt lgkmcnt(10)
    ds_read_b64_tr_b16 a[68:69], v3 offset:320
    v_mfma_f32_16x16x32_bf16 v[24:27], a[104:107], v[144:147], v[24:27]
    s_add_u32 s54, s55, 8192
    ds_read_b64_tr_b16 a[70:71], v3 offset:448
    v_mfma_f32_16x16x32_bf16 v[24:27], a[108:111], v[152:155], v[24:27]
    s_waitcnt lgkmcnt(8)
    buffer_load_dwordx4 a[196:199], v8, s[72:75], s54 offen
    v_mfma_f32_16x16x32_bf16 v[24:27], a[112:115], v[192:195], v[24:27]
    ds_read_b64_tr_b16 a[72:73], v3 offset:576
    v_mfma_f32_16x16x32_bf16 v[24:27], a[116:119], v[200:203], v[24:27]
    s_waitcnt lgkmcnt(5)
    ds_read_b64_tr_b16 a[74:75], v3 offset:704
    v_mfma_f32_16x16x32_bf16 v[24:27], a[120:123], v[208:211], v[24:27]
    ds_read_b64_tr_b16 a[76:77], v3 offset:832
    v_mfma_f32_16x16x32_bf16 v[24:27], a[124:127], v[216:219], v[24:27]
    ds_read_b64_tr_b16 a[78:79], v3 offset:960
    v_mfma_f32_16x16x32_bf16 v[28:31], a[96:99], v[160:163], 0
    ds_read_b64_tr_b16 a[80:81], v3 offset:16960
    v_mfma_f32_16x16x32_bf16 v[28:31], a[100:103], v[168:171], v[28:31]
    ds_read_b64_tr_b16 a[82:83], v3 offset:17088
    v_mfma_f32_16x16x32_bf16 v[28:31], a[104:107], v[176:179], v[28:31]
    ds_read_b64_tr_b16 a[84:85], v3 offset:17216
    v_mfma_f32_16x16x32_bf16 v[28:31], a[108:111], v[184:187], v[28:31]
    ds_read_b64_tr_b16 a[86:87], v3 offset:17344
    v_mfma_f32_16x16x32_bf16 v[28:31], a[112:115], v[224:227], v[28:31]
    ds_read_b64_tr_b16 a[88:89], v3 offset:17472
    v_mfma_f32_16x16x32_bf16 v[28:31], a[116:119], v[232:235], v[28:31]
    ds_read_b64_tr_b16 a[90:91], v3 offset:17600
    v_mfma_f32_16x16x32_bf16 v[28:31], a[120:123], v[240:243], v[28:31]
    ds_read_b64_tr_b16 a[92:93], v3 offset:17728
    v_mfma_f32_16x16x32_bf16 v[28:31], a[124:127], v[248:251], v[28:31]
    s_waitcnt lgkmcnt(11)
    ds_read_b64_tr_b16 a[94:95], v3 offset:17856
    v_mfma_f32_16x16x32_bf16 v[32:35], a[64:67], v[128:131], 0
    ds_read_b64_tr_b16 a[96:97], v3 offset:96
    v_cvt_pk_bf16_f32 v48, v16, v17
    v_mfma_f32_16x16x32_bf16 v[32:35], a[68:71], v[136:139], v[32:35]
    s_waitcnt lgkmcnt(9)
    ds_read_b64_tr_b16 a[98:99], v3 offset:224
    v_cvt_pk_bf16_f32 v49, v18, v19
    v_mfma_f32_16x16x32_bf16 v[32:35], a[72:75], v[144:147], v[32:35]
    ds_read_b64_tr_b16 a[100:101], v3 offset:352
    v_cvt_pk_bf16_f32 v50, v24, v25
    v_mfma_f32_16x16x32_bf16 v[32:35], a[76:79], v[152:155], v[32:35]
    s_waitcnt lgkmcnt(7)
    ds_read_b64_tr_b16 a[102:103], v3 offset:480
    v_cvt_pk_bf16_f32 v51, v26, v27
    v_mfma_f32_16x16x32_bf16 v[32:35], a[80:83], v[192:195], v[32:35]
    s_mov_b32 s54, 6144
    ds_read_b64_tr_b16 a[104:105], v3 offset:608
    ds_read_b64_tr_b16 a[106:107], v3 offset:736
    v_mfma_f32_16x16x32_bf16 v[32:35], a[84:87], v[200:203], v[32:35]
    s_waitcnt lgkmcnt(6)
    v_permlane32_swap_b32 v48, v50
    v_mfma_f32_16x16x32_bf16 v[32:35], a[88:91], v[208:211], v[32:35]
    v_permlane32_swap_b32 v49, v51
    v_mfma_f32_16x16x32_bf16 v[32:35], a[92:95], v[216:219], v[32:35]
    ds_read_b64_tr_b16 a[108:109], v3 offset:864
    ds_read_b64_tr_b16 a[110:111], v3 offset:992
    buffer_store_dwordx4 v[48:51], v10, s[40:43], s54 offen offset:0 sc1
    v_mfma_f32_16x16x32_bf16 v[36:39], a[64:67], v[160:163], 0
    ds_read_b64_tr_b16 a[112:113], v3 offset:16992
    v_cvt_pk_bf16_f32 v52, v20, v21
    v_mfma_f32_16x16x32_bf16 v[36:39], a[68:71], v[168:171], v[36:39]
    ds_read_b64_tr_b16 a[114:115], v3 offset:17120
    v_cvt_pk_bf16_f32 v53, v22, v23
    v_mfma_f32_16x16x32_bf16 v[36:39], a[72:75], v[176:179], v[36:39]
    ds_read_b64_tr_b16 a[116:117], v3 offset:17248
    v_cvt_pk_bf16_f32 v54, v28, v29
    v_mfma_f32_16x16x32_bf16 v[36:39], a[76:79], v[184:187], v[36:39]
    ds_read_b64_tr_b16 a[118:119], v3 offset:17376
    v_cvt_pk_bf16_f32 v55, v30, v31
    v_mfma_f32_16x16x32_bf16 v[36:39], a[80:83], v[224:227], v[36:39]
    s_mov_b32 s54, 301056
    ds_read_b64_tr_b16 a[120:121], v3 offset:17504
    ds_read_b64_tr_b16 a[122:123], v3 offset:17632
    v_mfma_f32_16x16x32_bf16 v[36:39], a[84:87], v[232:235], v[36:39]
    v_permlane32_swap_b32 v52, v54
    v_mfma_f32_16x16x32_bf16 v[36:39], a[88:91], v[240:243], v[36:39]
    v_permlane32_swap_b32 v53, v55
    v_mfma_f32_16x16x32_bf16 v[36:39], a[92:95], v[248:251], v[36:39]
    s_waitcnt vmcnt(20)
    s_barrier
    s_waitcnt lgkmcnt(10)
    ds_read_b64_tr_b16 a[124:125], v3 offset:17760
    ds_read_b64_tr_b16 a[126:127], v3 offset:17888
    buffer_store_dwordx4 v[52:55], v10, s[40:43], s54 offen offset:0 sc1
    v_mfma_f32_16x16x32_bf16 v[40:43], a[96:99], v[128:131], 0
    ds_read_b64_tr_b16 a[64:65], v3 offset:36864
    v_mfma_f32_16x16x32_bf16 v[40:43], a[100:103], v[136:139], v[40:43]
    s_waitcnt lgkmcnt(9)
    ds_read_b64_tr_b16 a[66:67], v3 offset:36992
    v_mfma_f32_16x16x32_bf16 v[40:43], a[104:107], v[144:147], v[40:43]
    ds_read_b64_tr_b16 a[68:69], v3 offset:37120
    v_mfma_f32_16x16x32_bf16 v[40:43], a[108:111], v[152:155], v[40:43]
    s_waitcnt lgkmcnt(7)
    ds_read_b64_tr_b16 a[70:71], v3 offset:37248
    v_mfma_f32_16x16x32_bf16 v[40:43], a[112:115], v[192:195], v[40:43]
    ds_read_b64_tr_b16 a[72:73], v3 offset:37376
    v_mfma_f32_16x16x32_bf16 v[40:43], a[116:119], v[200:203], v[40:43]
    s_waitcnt lgkmcnt(5)
    ds_read_b64_tr_b16 a[74:75], v3 offset:37504
    v_mfma_f32_16x16x32_bf16 v[40:43], a[120:123], v[208:211], v[40:43]
    ds_read_b64_tr_b16 a[76:77], v3 offset:37632
    v_mfma_f32_16x16x32_bf16 v[40:43], a[124:127], v[216:219], v[40:43]
    ds_read_b64_tr_b16 a[78:79], v3 offset:37760
    v_mfma_f32_16x16x32_bf16 v[44:47], a[96:99], v[160:163], 0
    ds_read_b64_tr_b16 a[80:81], v3 offset:53760
    v_mfma_f32_16x16x32_bf16 v[44:47], a[100:103], v[168:171], v[44:47]
    ds_read_b64_tr_b16 a[82:83], v3 offset:53888
    v_mfma_f32_16x16x32_bf16 v[44:47], a[104:107], v[176:179], v[44:47]
    ds_read_b64_tr_b16 a[84:85], v3 offset:54016
    v_mfma_f32_16x16x32_bf16 v[44:47], a[108:111], v[184:187], v[44:47]
    ds_read_b64_tr_b16 a[86:87], v3 offset:54144
    v_mfma_f32_16x16x32_bf16 v[44:47], a[112:115], v[224:227], v[44:47]
    ds_read_b64_tr_b16 a[88:89], v3 offset:54272
    v_mfma_f32_16x16x32_bf16 v[44:47], a[116:119], v[232:235], v[44:47]
    ds_read_b64_tr_b16 a[90:91], v3 offset:54400
    v_mfma_f32_16x16x32_bf16 v[44:47], a[120:123], v[240:243], v[44:47]
    ds_read_b64_tr_b16 a[92:93], v3 offset:54528
    v_mfma_f32_16x16x32_bf16 v[44:47], a[124:127], v[248:251], v[44:47]
    s_waitcnt lgkmcnt(11)
    ds_read_b64_tr_b16 a[94:95], v3 offset:54656
    v_mfma_f32_16x16x32_bf16 v[16:19], a[64:67], v[128:131], 0
    ds_read_b64_tr_b16 a[96:97], v3 offset:36896
    v_cvt_pk_bf16_f32 v48, v32, v33
    v_mfma_f32_16x16x32_bf16 v[16:19], a[68:71], v[136:139], v[16:19]
    s_waitcnt lgkmcnt(9)
    ds_read_b64_tr_b16 a[98:99], v3 offset:37024
    v_cvt_pk_bf16_f32 v49, v34, v35
    v_mfma_f32_16x16x32_bf16 v[16:19], a[72:75], v[144:147], v[16:19]
    ds_read_b64_tr_b16 a[100:101], v3 offset:37152
    v_cvt_pk_bf16_f32 v50, v40, v41
    v_mfma_f32_16x16x32_bf16 v[16:19], a[76:79], v[152:155], v[16:19]
    s_waitcnt lgkmcnt(7)
    ds_read_b64_tr_b16 a[102:103], v3 offset:37280
    v_cvt_pk_bf16_f32 v51, v42, v43
    v_mfma_f32_16x16x32_bf16 v[16:19], a[80:83], v[192:195], v[16:19]
    s_mov_b32 s54, 6144
    ds_read_b64_tr_b16 a[104:105], v3 offset:37408
    ds_read_b64_tr_b16 a[106:107], v3 offset:37536
    v_mfma_f32_16x16x32_bf16 v[16:19], a[84:87], v[200:203], v[16:19]
    s_waitcnt lgkmcnt(6)
    v_permlane32_swap_b32 v48, v50
    v_mfma_f32_16x16x32_bf16 v[16:19], a[88:91], v[208:211], v[16:19]
    v_permlane32_swap_b32 v49, v51
    v_mfma_f32_16x16x32_bf16 v[16:19], a[92:95], v[216:219], v[16:19]
    ds_read_b64_tr_b16 a[108:109], v3 offset:37664
    ds_read_b64_tr_b16 a[110:111], v3 offset:37792
    buffer_store_dwordx4 v[48:51], v10, s[40:43], s54 offen offset:512 sc1
    v_mfma_f32_16x16x32_bf16 v[20:23], a[64:67], v[160:163], 0
    ds_read_b64_tr_b16 a[112:113], v3 offset:53792
    v_cvt_pk_bf16_f32 v52, v36, v37
    v_mfma_f32_16x16x32_bf16 v[20:23], a[68:71], v[168:171], v[20:23]
    ds_read_b64_tr_b16 a[114:115], v3 offset:53920
    v_cvt_pk_bf16_f32 v53, v38, v39
    v_mfma_f32_16x16x32_bf16 v[20:23], a[72:75], v[176:179], v[20:23]
    ds_read_b64_tr_b16 a[116:117], v3 offset:54048
    v_cvt_pk_bf16_f32 v54, v44, v45
    v_mfma_f32_16x16x32_bf16 v[20:23], a[76:79], v[184:187], v[20:23]
    ds_read_b64_tr_b16 a[118:119], v3 offset:54176
    v_cvt_pk_bf16_f32 v55, v46, v47
    v_mfma_f32_16x16x32_bf16 v[20:23], a[80:83], v[224:227], v[20:23]
    s_mov_b32 s54, 301056
    ds_read_b64_tr_b16 a[120:121], v3 offset:54304
    ds_read_b64_tr_b16 a[122:123], v3 offset:54432
    v_mfma_f32_16x16x32_bf16 v[20:23], a[84:87], v[232:235], v[20:23]
    v_permlane32_swap_b32 v52, v54
    v_mfma_f32_16x16x32_bf16 v[20:23], a[88:91], v[240:243], v[20:23]
    v_permlane32_swap_b32 v53, v55
    v_mfma_f32_16x16x32_bf16 v[20:23], a[92:95], v[248:251], v[20:23]
    s_waitcnt lgkmcnt(10)
    ds_read_b64_tr_b16 a[124:125], v3 offset:54560
    ds_read_b64_tr_b16 a[126:127], v3 offset:54688
    buffer_store_dwordx4 v[52:55], v10, s[40:43], s54 offen offset:512 sc1
    v_mfma_f32_16x16x32_bf16 v[24:27], a[96:99], v[128:131], 0
    ds_read_b64_tr_b16 a[64:65], v3 offset:36928
    v_mfma_f32_16x16x32_bf16 v[24:27], a[100:103], v[136:139], v[24:27]
    s_waitcnt lgkmcnt(9)
    ds_read_b64_tr_b16 a[66:67], v3 offset:37056
    v_mfma_f32_16x16x32_bf16 v[24:27], a[104:107], v[144:147], v[24:27]
    ds_read_b64_tr_b16 a[68:69], v3 offset:37184
    v_mfma_f32_16x16x32_bf16 v[24:27], a[108:111], v[152:155], v[24:27]
    s_waitcnt lgkmcnt(7)
    ds_read_b64_tr_b16 a[70:71], v3 offset:37312
    v_mfma_f32_16x16x32_bf16 v[24:27], a[112:115], v[192:195], v[24:27]
    ds_read_b64_tr_b16 a[72:73], v3 offset:37440
    v_mfma_f32_16x16x32_bf16 v[24:27], a[116:119], v[200:203], v[24:27]
    s_waitcnt lgkmcnt(5)
    ds_read_b64_tr_b16 a[74:75], v3 offset:37568
    v_mfma_f32_16x16x32_bf16 v[24:27], a[120:123], v[208:211], v[24:27]
    ds_read_b64_tr_b16 a[76:77], v3 offset:37696
    v_mfma_f32_16x16x32_bf16 v[24:27], a[124:127], v[216:219], v[24:27]
    ds_read_b64_tr_b16 a[78:79], v3 offset:37824
    v_mfma_f32_16x16x32_bf16 v[28:31], a[96:99], v[160:163], 0
    ds_read_b64_tr_b16 a[80:81], v3 offset:53824
    v_mfma_f32_16x16x32_bf16 v[28:31], a[100:103], v[168:171], v[28:31]
    ds_read_b64_tr_b16 a[82:83], v3 offset:53952
    v_mfma_f32_16x16x32_bf16 v[28:31], a[104:107], v[176:179], v[28:31]
    ds_read_b64_tr_b16 a[84:85], v3 offset:54080
    v_mfma_f32_16x16x32_bf16 v[28:31], a[108:111], v[184:187], v[28:31]
    ds_read_b64_tr_b16 a[86:87], v3 offset:54208
    v_mfma_f32_16x16x32_bf16 v[28:31], a[112:115], v[224:227], v[28:31]
    ds_read_b64_tr_b16 a[88:89], v3 offset:54336
    v_mfma_f32_16x16x32_bf16 v[28:31], a[116:119], v[232:235], v[28:31]
    ds_read_b64_tr_b16 a[90:91], v3 offset:54464
    v_mfma_f32_16x16x32_bf16 v[28:31], a[120:123], v[240:243], v[28:31]
    ds_read_b64_tr_b16 a[92:93], v3 offset:54592
    v_mfma_f32_16x16x32_bf16 v[28:31], a[124:127], v[248:251], v[28:31]
    s_waitcnt lgkmcnt(11)
    ds_read_b64_tr_b16 a[94:95], v3 offset:54720
    v_mfma_f32_16x16x32_bf16 v[32:35], a[64:67], v[128:131], 0
    ds_read_b64_tr_b16 a[96:97], v3 offset:36960
    v_cvt_pk_bf16_f32 v48, v16, v17
    v_mfma_f32_16x16x32_bf16 v[32:35], a[68:71], v[136:139], v[32:35]
    s_waitcnt lgkmcnt(9)
    ds_read_b64_tr_b16 a[98:99], v3 offset:37088
    v_cvt_pk_bf16_f32 v49, v18, v19
    v_mfma_f32_16x16x32_bf16 v[32:35], a[72:75], v[144:147], v[32:35]
    ds_read_b64_tr_b16 a[100:101], v3 offset:37216
    v_cvt_pk_bf16_f32 v50, v24, v25
    v_mfma_f32_16x16x32_bf16 v[32:35], a[76:79], v[152:155], v[32:35]
    s_waitcnt lgkmcnt(7)
    ds_read_b64_tr_b16 a[102:103], v3 offset:37344
    v_cvt_pk_bf16_f32 v51, v26, v27
    v_mfma_f32_16x16x32_bf16 v[32:35], a[80:83], v[192:195], v[32:35]
    s_mov_b32 s54, 7168
    ds_read_b64_tr_b16 a[104:105], v3 offset:37472
    ds_read_b64_tr_b16 a[106:107], v3 offset:37600
    v_mfma_f32_16x16x32_bf16 v[32:35], a[84:87], v[200:203], v[32:35]
    s_waitcnt lgkmcnt(6)
    v_permlane32_swap_b32 v48, v50
    v_mfma_f32_16x16x32_bf16 v[32:35], a[88:91], v[208:211], v[32:35]
    v_permlane32_swap_b32 v49, v51
    v_mfma_f32_16x16x32_bf16 v[32:35], a[92:95], v[216:219], v[32:35]
    ds_read_b64_tr_b16 a[108:109], v3 offset:37728
    ds_read_b64_tr_b16 a[110:111], v3 offset:37856
    buffer_store_dwordx4 v[48:51], v10, s[40:43], s54 offen offset:0 sc1
    v_mfma_f32_16x16x32_bf16 v[36:39], a[64:67], v[160:163], 0
    ds_read_b64_tr_b16 a[112:113], v3 offset:53856
    v_cvt_pk_bf16_f32 v52, v20, v21
    v_mfma_f32_16x16x32_bf16 v[36:39], a[68:71], v[168:171], v[36:39]
    ds_read_b64_tr_b16 a[114:115], v3 offset:53984
    v_cvt_pk_bf16_f32 v53, v22, v23
    v_mfma_f32_16x16x32_bf16 v[36:39], a[72:75], v[176:179], v[36:39]
    ds_read_b64_tr_b16 a[116:117], v3 offset:54112
    v_cvt_pk_bf16_f32 v54, v28, v29
    v_mfma_f32_16x16x32_bf16 v[36:39], a[76:79], v[184:187], v[36:39]
    ds_read_b64_tr_b16 a[118:119], v3 offset:54240
    v_cvt_pk_bf16_f32 v55, v30, v31
    v_mfma_f32_16x16x32_bf16 v[36:39], a[80:83], v[224:227], v[36:39]
    s_mov_b32 s54, 302080
    ds_read_b64_tr_b16 a[120:121], v3 offset:54368
    ds_read_b64_tr_b16 a[122:123], v3 offset:54496
    v_mfma_f32_16x16x32_bf16 v[36:39], a[84:87], v[232:235], v[36:39]
    v_permlane32_swap_b32 v52, v54
    v_mfma_f32_16x16x32_bf16 v[36:39], a[88:91], v[240:243], v[36:39]
    v_permlane32_swap_b32 v53, v55
    v_mfma_f32_16x16x32_bf16 v[36:39], a[92:95], v[248:251], v[36:39]
    s_waitcnt vmcnt(8)
    s_barrier
    s_waitcnt lgkmcnt(10)
    ds_read_b64_tr_b16 a[124:125], v3 offset:54624
    ds_read_b64_tr_b16 a[126:127], v3 offset:54752
    buffer_store_dwordx4 v[52:55], v10, s[40:43], s54 offen offset:0 sc1
    v_mfma_f32_16x16x32_bf16 v[40:43], a[96:99], v[128:131], 0
    ds_read_b64_tr_b16 a[64:65], v4 offset:0
    v_mfma_f32_16x16x32_bf16 v[40:43], a[100:103], v[136:139], v[40:43]
    s_waitcnt lgkmcnt(9)
    ds_read_b64_tr_b16 a[66:67], v4 offset:128
    v_mfma_f32_16x16x32_bf16 v[40:43], a[104:107], v[144:147], v[40:43]
    ds_read_b64_tr_b16 a[68:69], v4 offset:256
    v_mfma_f32_16x16x32_bf16 v[40:43], a[108:111], v[152:155], v[40:43]
    s_waitcnt lgkmcnt(7)
    ds_read_b64_tr_b16 a[70:71], v4 offset:384
    v_mfma_f32_16x16x32_bf16 v[40:43], a[112:115], v[192:195], v[40:43]
    ds_read_b64_tr_b16 a[72:73], v4 offset:512
    v_mfma_f32_16x16x32_bf16 v[40:43], a[116:119], v[200:203], v[40:43]
    s_waitcnt lgkmcnt(5)
    ds_read_b64_tr_b16 a[74:75], v4 offset:640
    v_mfma_f32_16x16x32_bf16 v[40:43], a[120:123], v[208:211], v[40:43]
    ds_read_b64_tr_b16 a[76:77], v4 offset:768
    v_mfma_f32_16x16x32_bf16 v[40:43], a[124:127], v[216:219], v[40:43]
    ds_read_b64_tr_b16 a[78:79], v4 offset:896
    v_mfma_f32_16x16x32_bf16 v[44:47], a[96:99], v[160:163], 0
    ds_read_b64_tr_b16 a[80:81], v4 offset:16896
    v_mfma_f32_16x16x32_bf16 v[44:47], a[100:103], v[168:171], v[44:47]
    ds_read_b64_tr_b16 a[82:83], v4 offset:17024
    v_mfma_f32_16x16x32_bf16 v[44:47], a[104:107], v[176:179], v[44:47]
    ds_read_b64_tr_b16 a[84:85], v4 offset:17152
    v_mfma_f32_16x16x32_bf16 v[44:47], a[108:111], v[184:187], v[44:47]
    ds_read_b64_tr_b16 a[86:87], v4 offset:17280
    v_mfma_f32_16x16x32_bf16 v[44:47], a[112:115], v[224:227], v[44:47]
    ds_read_b64_tr_b16 a[88:89], v4 offset:17408
    v_mfma_f32_16x16x32_bf16 v[44:47], a[116:119], v[232:235], v[44:47]
    ds_read_b64_tr_b16 a[90:91], v4 offset:17536
    v_mfma_f32_16x16x32_bf16 v[44:47], a[120:123], v[240:243], v[44:47]
    ds_read_b64_tr_b16 a[92:93], v4 offset:17664
    v_mfma_f32_16x16x32_bf16 v[44:47], a[124:127], v[248:251], v[44:47]
    s_waitcnt lgkmcnt(11)
    ds_read_b64_tr_b16 a[94:95], v4 offset:17792
    v_mfma_f32_16x16x32_bf16 v[16:19], a[64:67], v[128:131], 0
    ds_read_b64_tr_b16 a[96:97], v4 offset:32
    v_cvt_pk_bf16_f32 v48, v32, v33
    v_mfma_f32_16x16x32_bf16 v[16:19], a[68:71], v[136:139], v[16:19]
    s_waitcnt lgkmcnt(9)
    ds_read_b64_tr_b16 a[98:99], v4 offset:160
    v_cvt_pk_bf16_f32 v49, v34, v35
    v_mfma_f32_16x16x32_bf16 v[16:19], a[72:75], v[144:147], v[16:19]
    ds_read_b64_tr_b16 a[100:101], v4 offset:288
    v_cvt_pk_bf16_f32 v50, v40, v41
    v_mfma_f32_16x16x32_bf16 v[16:19], a[76:79], v[152:155], v[16:19]
    s_waitcnt lgkmcnt(7)
    ds_read_b64_tr_b16 a[102:103], v4 offset:416
    v_cvt_pk_bf16_f32 v51, v42, v43
    v_mfma_f32_16x16x32_bf16 v[16:19], a[80:83], v[192:195], v[16:19]
    s_mov_b32 s54, 7168
    ds_read_b64_tr_b16 a[104:105], v4 offset:544
    ds_read_b64_tr_b16 a[106:107], v4 offset:672
    v_mfma_f32_16x16x32_bf16 v[16:19], a[84:87], v[200:203], v[16:19]
    s_waitcnt lgkmcnt(6)
    v_permlane32_swap_b32 v48, v50
    v_mfma_f32_16x16x32_bf16 v[16:19], a[88:91], v[208:211], v[16:19]
    v_permlane32_swap_b32 v49, v51
    v_mfma_f32_16x16x32_bf16 v[16:19], a[92:95], v[216:219], v[16:19]
    ds_read_b64_tr_b16 a[108:109], v4 offset:800
    ds_read_b64_tr_b16 a[110:111], v4 offset:928
    buffer_store_dwordx4 v[48:51], v10, s[40:43], s54 offen offset:512 sc1
    v_mfma_f32_16x16x32_bf16 v[20:23], a[64:67], v[160:163], 0
    ds_read_b64_tr_b16 a[112:113], v4 offset:16928
    v_cvt_pk_bf16_f32 v52, v36, v37
    v_mfma_f32_16x16x32_bf16 v[20:23], a[68:71], v[168:171], v[20:23]
    ds_read_b64_tr_b16 a[114:115], v4 offset:17056
    v_cvt_pk_bf16_f32 v53, v38, v39
    v_mfma_f32_16x16x32_bf16 v[20:23], a[72:75], v[176:179], v[20:23]
    ds_read_b64_tr_b16 a[116:117], v4 offset:17184
    v_cvt_pk_bf16_f32 v54, v44, v45
    v_mfma_f32_16x16x32_bf16 v[20:23], a[76:79], v[184:187], v[20:23]
    ds_read_b64_tr_b16 a[118:119], v4 offset:17312
    v_cvt_pk_bf16_f32 v55, v46, v47
    v_mfma_f32_16x16x32_bf16 v[20:23], a[80:83], v[224:227], v[20:23]
    s_mov_b32 s54, 302080
    ds_read_b64_tr_b16 a[120:121], v4 offset:17440
    ds_read_b64_tr_b16 a[122:123], v4 offset:17568
    v_mfma_f32_16x16x32_bf16 v[20:23], a[84:87], v[232:235], v[20:23]
    v_permlane32_swap_b32 v52, v54
    v_mfma_f32_16x16x32_bf16 v[20:23], a[88:91], v[240:243], v[20:23]
    v_permlane32_swap_b32 v53, v55
    v_mfma_f32_16x16x32_bf16 v[20:23], a[92:95], v[248:251], v[20:23]
    s_waitcnt lgkmcnt(10)
    ds_read_b64_tr_b16 a[124:125], v4 offset:17696
    ds_read_b64_tr_b16 a[126:127], v4 offset:17824
    buffer_store_dwordx4 v[52:55], v10, s[40:43], s54 offen offset:512 sc1
    v_mfma_f32_16x16x32_bf16 v[24:27], a[96:99], v[128:131], 0
    ds_read_b64_tr_b16 a[64:65], v4 offset:64
    v_mfma_f32_16x16x32_bf16 v[24:27], a[100:103], v[136:139], v[24:27]
    s_waitcnt lgkmcnt(9)
    ds_read_b64_tr_b16 a[66:67], v4 offset:192
    v_mfma_f32_16x16x32_bf16 v[24:27], a[104:107], v[144:147], v[24:27]
    ds_read_b64_tr_b16 a[68:69], v4 offset:320
    v_mfma_f32_16x16x32_bf16 v[24:27], a[108:111], v[152:155], v[24:27]
    s_waitcnt lgkmcnt(7)
    ds_read_b64_tr_b16 a[70:71], v4 offset:448
    v_mfma_f32_16x16x32_bf16 v[24:27], a[112:115], v[192:195], v[24:27]
    ds_read_b64_tr_b16 a[72:73], v4 offset:576
    v_mfma_f32_16x16x32_bf16 v[24:27], a[116:119], v[200:203], v[24:27]
    s_waitcnt lgkmcnt(5)
    ds_read_b64_tr_b16 a[74:75], v4 offset:704
    v_mfma_f32_16x16x32_bf16 v[24:27], a[120:123], v[208:211], v[24:27]
    ds_read_b64_tr_b16 a[76:77], v4 offset:832
    v_mfma_f32_16x16x32_bf16 v[24:27], a[124:127], v[216:219], v[24:27]
    ds_read_b64_tr_b16 a[78:79], v4 offset:960
    v_mfma_f32_16x16x32_bf16 v[28:31], a[96:99], v[160:163], 0
    ds_read_b64_tr_b16 a[80:81], v4 offset:16960
    v_mfma_f32_16x16x32_bf16 v[28:31], a[100:103], v[168:171], v[28:31]
    ds_read_b64_tr_b16 a[82:83], v4 offset:17088
    v_mfma_f32_16x16x32_bf16 v[28:31], a[104:107], v[176:179], v[28:31]
    ds_read_b64_tr_b16 a[84:85], v4 offset:17216
    v_mfma_f32_16x16x32_bf16 v[28:31], a[108:111], v[184:187], v[28:31]
    ds_read_b64_tr_b16 a[86:87], v4 offset:17344
    v_mfma_f32_16x16x32_bf16 v[28:31], a[112:115], v[224:227], v[28:31]
    ds_read_b64_tr_b16 a[88:89], v4 offset:17472
    v_mfma_f32_16x16x32_bf16 v[28:31], a[116:119], v[232:235], v[28:31]
    ds_read_b64_tr_b16 a[90:91], v4 offset:17600
    v_mfma_f32_16x16x32_bf16 v[28:31], a[120:123], v[240:243], v[28:31]
    ds_read_b64_tr_b16 a[92:93], v4 offset:17728
    v_mfma_f32_16x16x32_bf16 v[28:31], a[124:127], v[248:251], v[28:31]
    s_waitcnt lgkmcnt(11)
    ds_read_b64_tr_b16 a[94:95], v4 offset:17856
    v_mfma_f32_16x16x32_bf16 v[32:35], a[64:67], v[128:131], 0
    ds_read_b64_tr_b16 a[96:97], v4 offset:96
    v_cvt_pk_bf16_f32 v48, v16, v17
    v_mfma_f32_16x16x32_bf16 v[32:35], a[68:71], v[136:139], v[32:35]
    s_waitcnt lgkmcnt(9)
    ds_read_b64_tr_b16 a[98:99], v4 offset:224
    v_cvt_pk_bf16_f32 v49, v18, v19
    v_mfma_f32_16x16x32_bf16 v[32:35], a[72:75], v[144:147], v[32:35]
    ds_read_b64_tr_b16 a[100:101], v4 offset:352
    v_cvt_pk_bf16_f32 v50, v24, v25
    v_mfma_f32_16x16x32_bf16 v[32:35], a[76:79], v[152:155], v[32:35]
    s_waitcnt lgkmcnt(7)
    ds_read_b64_tr_b16 a[102:103], v4 offset:480
    v_cvt_pk_bf16_f32 v51, v26, v27
    v_mfma_f32_16x16x32_bf16 v[32:35], a[80:83], v[192:195], v[32:35]
    s_mov_b32 s54, 8192
    ds_read_b64_tr_b16 a[104:105], v4 offset:608
    ds_read_b64_tr_b16 a[106:107], v4 offset:736
    v_mfma_f32_16x16x32_bf16 v[32:35], a[84:87], v[200:203], v[32:35]
    s_waitcnt lgkmcnt(6)
    v_permlane32_swap_b32 v48, v50
    v_mfma_f32_16x16x32_bf16 v[32:35], a[88:91], v[208:211], v[32:35]
    v_permlane32_swap_b32 v49, v51
    v_mfma_f32_16x16x32_bf16 v[32:35], a[92:95], v[216:219], v[32:35]
    ds_read_b64_tr_b16 a[108:109], v4 offset:864
    ds_read_b64_tr_b16 a[110:111], v4 offset:992
    buffer_store_dwordx4 v[48:51], v10, s[40:43], s54 offen offset:0 sc1
    v_mfma_f32_16x16x32_bf16 v[36:39], a[64:67], v[160:163], 0
    ds_read_b64_tr_b16 a[112:113], v4 offset:16992
    v_cvt_pk_bf16_f32 v52, v20, v21
    v_mfma_f32_16x16x32_bf16 v[36:39], a[68:71], v[168:171], v[36:39]
    ds_read_b64_tr_b16 a[114:115], v4 offset:17120
    v_cvt_pk_bf16_f32 v53, v22, v23
    v_mfma_f32_16x16x32_bf16 v[36:39], a[72:75], v[176:179], v[36:39]
    ds_read_b64_tr_b16 a[116:117], v4 offset:17248
    v_cvt_pk_bf16_f32 v54, v28, v29
    v_mfma_f32_16x16x32_bf16 v[36:39], a[76:79], v[184:187], v[36:39]
    ds_read_b64_tr_b16 a[118:119], v4 offset:17376
    v_cvt_pk_bf16_f32 v55, v30, v31
    v_mfma_f32_16x16x32_bf16 v[36:39], a[80:83], v[224:227], v[36:39]
    s_mov_b32 s54, 303104
    ds_read_b64_tr_b16 a[120:121], v4 offset:17504
    ds_read_b64_tr_b16 a[122:123], v4 offset:17632
    v_mfma_f32_16x16x32_bf16 v[36:39], a[84:87], v[232:235], v[36:39]
    v_permlane32_swap_b32 v52, v54
    v_mfma_f32_16x16x32_bf16 v[36:39], a[88:91], v[240:243], v[36:39]
    v_permlane32_swap_b32 v53, v55
    v_mfma_f32_16x16x32_bf16 v[36:39], a[92:95], v[248:251], v[36:39]
    s_waitcnt lgkmcnt(10)
    ds_read_b64_tr_b16 a[124:125], v4 offset:17760
    ds_read_b64_tr_b16 a[126:127], v4 offset:17888
    buffer_store_dwordx4 v[52:55], v10, s[40:43], s54 offen offset:0 sc1
    v_mfma_f32_16x16x32_bf16 v[40:43], a[96:99], v[128:131], 0
    v_mfma_f32_16x16x32_bf16 v[40:43], a[100:103], v[136:139], v[40:43]
    s_waitcnt lgkmcnt(8)
    v_mfma_f32_16x16x32_bf16 v[40:43], a[104:107], v[144:147], v[40:43]
    v_mfma_f32_16x16x32_bf16 v[40:43], a[108:111], v[152:155], v[40:43]
    s_waitcnt lgkmcnt(4)
    v_mfma_f32_16x16x32_bf16 v[40:43], a[112:115], v[192:195], v[40:43]
    v_mfma_f32_16x16x32_bf16 v[40:43], a[116:119], v[200:203], v[40:43]
    s_waitcnt lgkmcnt(0)
    v_mfma_f32_16x16x32_bf16 v[40:43], a[120:123], v[208:211], v[40:43]
    v_mfma_f32_16x16x32_bf16 v[40:43], a[124:127], v[216:219], v[40:43]
    v_mfma_f32_16x16x32_bf16 v[44:47], a[96:99], v[160:163], 0
    v_mfma_f32_16x16x32_bf16 v[44:47], a[100:103], v[168:171], v[44:47]
    v_mfma_f32_16x16x32_bf16 v[44:47], a[104:107], v[176:179], v[44:47]
    v_mfma_f32_16x16x32_bf16 v[44:47], a[108:111], v[184:187], v[44:47]
    v_mfma_f32_16x16x32_bf16 v[44:47], a[112:115], v[224:227], v[44:47]
    v_mfma_f32_16x16x32_bf16 v[44:47], a[116:119], v[232:235], v[44:47]
    v_mfma_f32_16x16x32_bf16 v[44:47], a[120:123], v[240:243], v[44:47]
    v_mfma_f32_16x16x32_bf16 v[44:47], a[124:127], v[248:251], v[44:47]
    s_nop 7
    v_cvt_pk_bf16_f32 v48, v32, v33
    v_cvt_pk_bf16_f32 v49, v34, v35
    v_cvt_pk_bf16_f32 v50, v40, v41
    v_cvt_pk_bf16_f32 v51, v42, v43
    s_nop 1
    v_permlane32_swap_b32 v48, v50
    v_permlane32_swap_b32 v49, v51
    s_mov_b32 s54, 8192
    buffer_store_dwordx4 v[48:51], v10, s[40:43], s54 offen offset:512 sc1
    v_cvt_pk_bf16_f32 v52, v36, v37
    v_cvt_pk_bf16_f32 v53, v38, v39
    v_cvt_pk_bf16_f32 v54, v44, v45
    v_cvt_pk_bf16_f32 v55, v46, v47
    s_nop 1
    v_permlane32_swap_b32 v52, v54
    v_permlane32_swap_b32 v53, v55
    s_mov_b32 s54, 303104
    buffer_store_dwordx4 v[52:55], v10, s[40:43], s54 offen offset:512 sc1
    v_and_b32 v6, 15, v0
    v_lshlrev_b32 v6, 7, v6
    s_lshl_b32 s15, s53, 13
    s_add_u32 s15, s15, 786432
    s_and_b32 s14, s52, 12
    s_lshl_b32 s14, s14, 9
    s_add_u32 s47, s15, s14
    buffer_load_dword v9, v6, s[84:87], s47 offen sc1
    s_lshl4_add_u32 s3, s51, s52
    s_lshl_b32 s3, s3, 7
    s_add_u32 s3, s3, s15
    s_movk_i32 s48, 0x1111
    v_lshrrev_b32 v15, 4, v0
    v_mul_u32_u24 v15, 9216, v15
    v_add_u32 v7, v14, v15
    v_max_u32 v13, v76, v77
    v_max3_u32 v13, v13, v78, v79
    v_max3_u32 v13, v13, v80, v81
    v_max3_u32 v13, v13, v82, v83
    v_max3_u32 v13, v13, v84, v85
    v_max3_u32 v13, v13, v86, v87
    v_max3_u32 v13, v13, v88, v89
    v_max3_u32 v13, v13, v90, v91
    v_max3_u32 v13, v13, v92, v93
    v_max3_u32 v13, v13, v94, v95
    v_max3_u32 v13, v13, v96, v97
    v_max3_u32 v13, v13, v98, v99
    v_cmp_eq_u32 vcc, -1, v13
    s_nop 0
    s_cmp_lg_u64 vcc, 0
    s_cbranch_scc1 L2_pns
L2_pnr:
    v_pk_add_f32 v[76:77], v[76:77], v[88:89]
    v_pk_add_f32 v[78:79], v[78:79], v[90:91]
    v_pk_add_f32 v[80:81], v[80:81], v[92:93]
    v_pk_add_f32 v[82:83], v[82:83], v[94:95]
    v_pk_add_f32 v[84:85], v[84:85], v[96:97]
    v_pk_add_f32 v[86:87], v[86:87], v[98:99]
    ds_write_b128 v5, v[76:79] offset:0
    ds_write_b128 v5, v[80:83] offset:1024
    ds_write_b128 v14, v[84:87] offset:2048
    v_lshlrev_b32 v16, 16, v112
    v_and_b32 v17, 0xffff0000, v112
    v_lshlrev_b32 v18, 16, v113
    v_and_b32 v19, 0xffff0000, v113
    v_lshlrev_b32 v20, 16, v114
    v_and_b32 v21, 0xffff0000, v114
    v_lshlrev_b32 v22, 16, v115
    v_and_b32 v23, 0xffff0000, v115
    v_lshlrev_b32 v24, 16, v116
    v_and_b32 v25, 0xffff0000, v116
    v_lshlrev_b32 v26, 16, v117
    v_and_b32 v27, 0xffff0000, v117
    v_lshlrev_b32 v28, 16, v118
    v_and_b32 v29, 0xffff0000, v118
    v_lshlrev_b32 v30, 16, v119
    v_and_b32 v31, 0xffff0000, v119
    v_lshlrev_b32 v32, 16, v120
    v_and_b32 v33, 0xffff0000, v120
    v_lshlrev_b32 v34, 16, v121
    v_and_b32 v35, 0xffff0000, v121
    v_lshlrev_b32 v36, 16, v122
    v_and_b32 v37, 0xffff0000, v122
    v_lshlrev_b32 v38, 16, v123
    v_and_b32 v39, 0xffff0000, v123
    v_mov_b32 v13, 1
    s_mov_b64 exec, 1
    s_waitcnt vmcnt(1)
    buffer_store_dword v13, v6, s[84:87], s3 offen sc1
    s_mov_b64 exec, -1
    s_waitcnt vmcnt(1)
    v_cmp_ne_u32 vcc, 0, v9
    s_nop 0
    s_lshr_b32 s3, vcc_lo, 1
    s_and_b32 s3, s3, vcc_lo
    s_lshr_b32 s14, s3, 2
    s_and_b32 s3, s3, s14
    s_and_b32 s3, s3, s48
    s_cbranch_scc0 L2_g0s
L2_g0r:
    s_ff1_i32_b32 s3, s3
    s_bitset0_b32 s48, s3
    s_mul_i32 s46, s3, 9216
    buffer_load_dword v9, v6, s[84:87], s47 offen sc1
    buffer_load_dwordx4 v[112:115], v7, s[88:91], s46 offen offset:2048 sc1
    buffer_load_dwordx4 v[116:119], v5, s[88:91], s46 offen offset:0 sc1
    buffer_load_dwordx4 v[120:123], v5, s[88:91], s46 offen offset:1024 sc1
    s_add_u32 s46, s46, 9216
    buffer_load_dwordx4 v[124:127], v5, s[88:91], s46 offen offset:0 sc1
    buffer_load_dwordx4 v[128:131], v5, s[88:91], s46 offen offset:1024 sc1
    s_add_u32 s46, s46, 9216
    buffer_load_dwordx4 v[132:135], v5, s[88:91], s46 offen offset:0 sc1
    buffer_load_dwordx4 v[136:139], v5, s[88:91], s46 offen offset:1024 sc1
    s_add_u32 s46, s46, 9216
    buffer_load_dwordx4 v[140:143], v5, s[88:91], s46 offen offset:0 sc1
    buffer_load_dwordx4 v[144:147], v5, s[88:91], s46 offen offset:1024 sc1
    s_waitcnt lgkmcnt(0)
    s_barrier
    s_add_u32 s14, s55, 16384
    v_add_u32 v105, s14, v8
    v_add_u32 v106, 73728, v105
    s_mul_i32 s14, s51, 576
    v_lshrrev_b32 v14, 3, v0
    v_lshlrev_b32 v3, 5, v14
    v_add_u32 v3, s14, v3
    v_and_b32 v14, 1, v14
    v_lshlrev_b32 v4, 5, v14
    v_add_u32 v4, s14, v4
    ds_read_b128 v[76:79], v3 offset:4608
    ds_read_b128 v[80:83], v3 offset:4624
    ds_read_b128 v[84:87], v3 offset:4864
    ds_read_b128 v[88:91], v3 offset:4880
    ds_read_b128 v[92:95], v4 offset:5120
    ds_read_b128 v[96:99], v4 offset:5136
    ds_read_b128 v[40:43], v3 offset:2304
    ds_read_b128 v[44:47], v3 offset:2320
    ds_read_b128 v[48:51], v3 offset:2560
    ds_read_b128 v[52:55], v3 offset:2576
    ds_read_b128 v[56:59], v4 offset:2816
    ds_read_b128 v[60:63], v4 offset:2832
    s_waitcnt lgkmcnt(6)
    v_mul_f32 v76, v76, v16
    v_mul_f32 v77, v77, v17
    v_mul_f32 v78, v78, v18
    v_mul_f32 v79, v79, v19
    v_mul_f32 v80, v80, v20
    v_mul_f32 v81, v81, v21
    v_mul_f32 v82, v82, v22
    v_mul_f32 v83, v83, v23
    v_mul_f32 v84, v84, v24
    v_mul_f32 v85, v85, v25
    v_mul_f32 v86, v86, v26
    v_mul_f32 v87, v87, v27
    v_mul_f32 v88, v88, v28
    v_mul_f32 v89, v89, v29
    v_mul_f32 v90, v90, v30
    v_mul_f32 v91, v91, v31
    v_mul_f32 v92, v92, v32
    v_mul_f32 v93, v93, v33
    v_mul_f32 v94, v94, v34
    v_mul_f32 v95, v95, v35
    v_mul_f32 v96, v96, v36
    v_mul_f32 v97, v97, v37
    v_mul_f32 v98, v98, v38
    v_mul_f32 v99, v99, v39
    s_waitcnt lgkmcnt(0)
    v_add_f32 v100, v76, v77
    v_add_f32 v100, v100, v78
    v_add_f32 v100, v100, v79
    v_add_f32 v100, v100, v80
    v_add_f32 v100, v100, v81
    v_add_f32 v100, v100, v82
    v_add_f32 v100, v100, v83
    v_add_f32 v100, v100, v84
    v_add_f32 v100, v100, v85
    v_add_f32 v100, v100, v86
    v_add_f32 v100, v100, v87
    v_add_f32 v100, v100, v88
    v_add_f32 v100, v100, v89
    v_add_f32 v100, v100, v90
    v_add_f32 v100, v100, v91
    v_add_f32 v102, v92, v93
    v_add_f32 v102, v102, v94
    v_add_f32 v102, v102, v95
    v_add_f32 v102, v102, v96
    v_add_f32 v102, v102, v97
    v_add_f32 v102, v102, v98
    v_add_f32 v102, v102, v99
    v_fmac_f32 v100, 0x3e800000, v102
    v_mul_f32 v101, v40, v16
    v_fmac_f32 v101, v41, v17
    v_fmac_f32 v101, v42, v18
    v_fmac_f32 v101, v43, v19
    v_fmac_f32 v101, v44, v20
    v_fmac_f32 v101, v45, v21
    v_fmac_f32 v101, v46, v22
    v_fmac_f32 v101, v47, v23
    v_fmac_f32 v101, v48, v24
    v_fmac_f32 v101, v49, v25
    v_fmac_f32 v101, v50, v26
    v_fmac_f32 v101, v51, v27
    v_fmac_f32 v101, v52, v28
    v_fmac_f32 v101, v53, v29
    v_fmac_f32 v101, v54, v30
    v_fmac_f32 v101, v55, v31
    v_mul_f32 v102, v56, v32
    v_fmac_f32 v102, v57, v33
    v_fmac_f32 v102, v58, v34
    v_fmac_f32 v102, v59, v35
    v_fmac_f32 v102, v60, v36
    v_fmac_f32 v102, v61, v37
    v_fmac_f32 v102, v62, v38
    v_fmac_f32 v102, v63, v39
    v_fmac_f32 v101, 0x3e800000, v102
    ds_read_b128 v[40:43], v3 offset:0
    ds_read_b128 v[44:47], v3 offset:16
    ds_read_b128 v[48:51], v3 offset:256
    ds_read_b128 v[52:55], v3 offset:272
    ds_read_b128 v[56:59], v4 offset:512
    ds_read_b128 v[60:63], v4 offset:528
    s_waitcnt vmcnt(9)
    v_cmp_ne_u32 vcc, 0, v9
    s_nop 0
    s_lshr_b32 s3, vcc_lo, 1
    s_and_b32 s3, s3, vcc_lo
    s_lshr_b32 s14, s3, 2
    s_and_b32 s3, s3, s14
    s_and_b32 s3, s3, s48
    s_cbranch_scc0 L2_g1s
L2_g1r:
    s_ff1_i32_b32 s3, s3
    s_bitset0_b32 s48, s3
    s_mul_i32 s46, s3, 9216
    buffer_load_dword v9, v6, s[84:87], s47 offen sc1
    buffer_load_dwordx4 v[148:151], v7, s[88:91], s46 offen offset:2048 sc1
    ds_write_b128 v106, a[20:23] offset:36864
    buffer_load_dwordx4 v[152:155], v5, s[88:91], s46 offen offset:0 sc1
    ds_write_b128 v106, a[24:27] offset:37888
    s_waitcnt vmcnt(11)
    buffer_load_dwordx4 v[156:159], v5, s[88:91], s46 offen offset:1024 sc1
    ds_write_b128 v106, a[28:31] offset:38912
    s_waitcnt vmcnt(11)
    s_add_u32 s46, s46, 9216
    buffer_load_dwordx4 v[160:163], v5, s[88:91], s46 offen offset:0 sc1
    ds_write_b128 v106, a[32:35] offset:39936
    s_nop 1
    v_add_f32_dpp v100, v100, v100 row_ror:8 row_mask:0xf bank_mask:0xf
    v_add_f32_dpp v101, v101, v101 row_ror:8 row_mask:0xf bank_mask:0xf
    v_mov_b32 v102, v100
    v_mov_b32 v103, v101
    s_nop 0
    v_permlane16_swap_b32 v102, v100
    v_permlane16_swap_b32 v103, v101
    v_add_f32 v100, v100, v102
    v_add_f32 v101, v101, v103
    v_mov_b32 v102, v100
    v_mov_b32 v103, v101
    s_nop 0
    v_permlane32_swap_b32 v102, v100
    v_permlane32_swap_b32 v103, v101
    v_add_f32 v100, v100, v102
    v_add_f32 v101, v101, v103
    v_and_b32 v14, 7, v0
    v_lshlrev_b32 v11, 4, v14
    v_add_u32 v11, 14080, v11
    s_lshl_b32 s3, s51, 2
    v_add_u32 v10, s3, v11
    ds_write_b32 v10, v100 offset:384
    ds_write_b32 v10, v101 offset:512
    v_lshl_add_u32 v1, v14, 4, v1
    v_lshl_add_u32 v2, v14, 4, v2
    v_add_u32 v1, 90112, v1
    v_add_u32 v2, 90112, v2
    s_and_b32 s3, s51, 1
    s_mul_i32 s3, s3, 288
    v_add_u32 v14, s3, v0
    s_lshl_b32 s45, s3, 4
    s_lshr_b32 s14, s51, 1
    s_mul_i32 s14, s14, 9344
    s_add_u32 s14, s14, 90112
    v_add_u32 v15, 0, v14
    v_mul_u32_u24 v12, 911, v15
    v_lshrrev_b32 v12, 16, v12
    v_add_u32 v15, v15, v12
    v_lshl_add_u32 v107, v15, 4, s14
    v_add_u32 v15, 64, v14
    v_mul_u32_u24 v12, 911, v15
    v_lshrrev_b32 v12, 16, v12
    v_add_u32 v15, v15, v12
    v_lshl_add_u32 v108, v15, 4, s14
    v_add_u32 v15, 128, v14
    v_mul_u32_u24 v12, 911, v15
    v_lshrrev_b32 v12, 16, v12
    v_add_u32 v15, v15, v12
    v_lshl_add_u32 v109, v15, 4, s14
    v_add_u32 v15, 192, v14
    v_mul_u32_u24 v12, 911, v15
    v_lshrrev_b32 v12, 16, v12
    v_add_u32 v15, v15, v12
    v_lshl_add_u32 v110, v15, 4, s14
    v_add_u32 v15, 256, v14
    v_mul_u32_u24 v12, 911, v15
    v_lshrrev_b32 v12, 16, v12
    v_add_u32 v15, v15, v12
    v_lshl_add_u32 v111, v15, 4, s14
    s_mul_i32 s3, s96, 9216
    s_add_u32 s14, s3, 4194304
    s_cmp_lt_u32 s51, 2
    s_cselect_b32 s3, s3, s14
    s_cselect_b64 s[24:25], s[80:81], s[84:85]
    s_add_u32 s24, s24, s3
    s_addc_u32 s25, s25, 0
    s_mov_b32 s26, 9216
    s_mov_b32 s27, 0x20000
    s_waitcnt vmcnt(11)
    buffer_load_dwordx4 v[164:167], v5, s[88:91], s46 offen offset:1024 sc1
    ds_write_b128 v106, a[36:39] offset:40960
    v_lshlrev_b32 v32, 16, v112
    v_and_b32 v33, 0xffff0000, v112
    v_lshlrev_b32 v34, 16, v113
    v_and_b32 v35, 0xffff0000, v113
    v_lshlrev_b32 v36, 16, v114
    v_and_b32 v37, 0xffff0000, v114
    v_lshlrev_b32 v38, 16, v115
    v_and_b32 v39, 0xffff0000, v115
    s_waitcnt vmcnt(11)
    s_add_u32 s46, s46, 9216
    buffer_load_dwordx4 v[168:171], v5, s[88:91], s46 offen offset:0 sc1
    ds_write_b128 v106, a[40:43] offset:41984
    v_lshlrev_b32 v16, 16, v116
    v_and_b32 v17, 0xffff0000, v116
    v_lshlrev_b32 v18, 16, v117
    v_and_b32 v19, 0xffff0000, v117
    v_lshlrev_b32 v20, 16, v118
    v_and_b32 v21, 0xffff0000, v118
    v_lshlrev_b32 v22, 16, v119
    v_and_b32 v23, 0xffff0000, v119
    s_waitcnt vmcnt(11)
    buffer_load_dwordx4 v[172:175], v5, s[88:91], s46 offen offset:1024 sc1
    ds_write_b128 v106, a[44:47] offset:43008
    v_lshlrev_b32 v24, 16, v120
    v_and_b32 v25, 0xffff0000, v120
    v_lshlrev_b32 v26, 16, v121
    v_and_b32 v27, 0xffff0000, v121
    v_lshlrev_b32 v28, 16, v122
    v_and_b32 v29, 0xffff0000, v122
    v_lshlrev_b32 v30, 16, v123
    v_and_b32 v31, 0xffff0000, v123
    s_waitcnt vmcnt(11)
    s_add_u32 s46, s46, 9216
    buffer_load_dwordx4 v[176:179], v5, s[88:91], s46 offen offset:0 sc1
    ds_write_b128 v106, a[48:51] offset:44032
    v_lshlrev_b32 v12, 16, v124
    v_and_b32 v13, 0xffff0000, v124
    v_pk_add_f32 v[16:17], v[16:17], v[12:13]
    v_lshlrev_b32 v14, 16, v125
    v_and_b32 v15, 0xffff0000, v125
    v_pk_add_f32 v[18:19], v[18:19], v[14:15]
    v_lshlrev_b32 v12, 16, v126
    v_and_b32 v13, 0xffff0000, v126
    v_pk_add_f32 v[20:21], v[20:21], v[12:13]
    v_lshlrev_b32 v14, 16, v127
    v_and_b32 v15, 0xffff0000, v127
    v_pk_add_f32 v[22:23], v[22:23], v[14:15]
    s_waitcnt vmcnt(11)
    buffer_load_dwordx4 v[180:183], v5, s[88:91], s46 offen offset:1024 sc1
    ds_write_b128 v106, a[52:55] offset:45056
    v_lshlrev_b32 v12, 16, v128
    v_and_b32 v13, 0xffff0000, v128
    v_pk_add_f32 v[24:25], v[24:25], v[12:13]
    v_lshlrev_b32 v14, 16, v129
    v_and_b32 v15, 0xffff0000, v129
    v_pk_add_f32 v[26:27], v[26:27], v[14:15]
    v_lshlrev_b32 v12, 16, v130
    v_and_b32 v13, 0xffff0000, v130
    v_pk_add_f32 v[28:29], v[28:29], v[12:13]
    v_lshlrev_b32 v14, 16, v131
    v_and_b32 v15, 0xffff0000, v131
    v_pk_add_f32 v[30:31], v[30:31], v[14:15]
    s_waitcnt vmcnt(11)
    s_waitcnt vmcnt(9)
    v_cmp_ne_u32 vcc, 0, v9
    s_nop 0
    s_lshr_b32 s3, vcc_lo, 1
    s_and_b32 s3, s3, vcc_lo
    s_lshr_b32 s14, s3, 2
    s_and_b32 s3, s3, s14
    s_and_b32 s3, s3, s48
    s_cbranch_scc0 L2_g2s
L2_g2r:
    s_ff1_i32_b32 s3, s3
    s_bitset0_b32 s48, s3
    s_mul_i32 s46, s3, 9216
    buffer_load_dword v9, v6, s[84:87], s47 offen sc1
    buffer_load_dwordx4 v[184:187], v7, s[88:91], s46 offen offset:2048 sc1
    ds_write_b128 v105, a[128:131] offset:0
    v_lshlrev_b32 v12, 16, v132
    v_and_b32 v13, 0xffff0000, v132
    v_pk_add_f32 v[16:17], v[16:17], v[12:13]
    v_lshlrev_b32 v14, 16, v133
    v_and_b32 v15, 0xffff0000, v133
    v_pk_add_f32 v[18:19], v[18:19], v[14:15]
    v_lshlrev_b32 v12, 16, v134
    v_and_b32 v13, 0xffff0000, v134
    v_pk_add_f32 v[20:21], v[20:21], v[12:13]
    v_lshlrev_b32 v14, 16, v135
    v_and_b32 v15, 0xffff0000, v135
    v_pk_add_f32 v[22:23], v[22:23], v[14:15]
    buffer_load_dwordx4 v[188:191], v5, s[88:91], s46 offen offset:0 sc1
    ds_write_b128 v105, a[132:135] offset:1024
    v_lshlrev_b32 v12, 16, v136
    v_and_b32 v13, 0xffff0000, v136
    v_pk_add_f32 v[24:25], v[24:25], v[12:13]
    v_lshlrev_b32 v14, 16, v137
    v_and_b32 v15, 0xffff0000, v137
    v_pk_add_f32 v[26:27], v[26:27], v[14:15]
    v_lshlrev_b32 v12, 16, v138
    v_and_b32 v13, 0xffff0000, v138
    v_pk_add_f32 v[28:29], v[28:29], v[12:13]
    v_lshlrev_b32 v14, 16, v139
    v_and_b32 v15, 0xffff0000, v139
    v_pk_add_f32 v[30:31], v[30:31], v[14:15]
    s_waitcnt vmcnt(11)
    buffer_load_dwordx4 v[192:195], v5, s[88:91], s46 offen offset:1024 sc1
    ds_write_b128 v105, a[136:139] offset:2048
    v_lshlrev_b32 v12, 16, v140
    v_and_b32 v13, 0xffff0000, v140
    v_pk_add_f32 v[16:17], v[16:17], v[12:13]
    v_lshlrev_b32 v14, 16, v141
    v_and_b32 v15, 0xffff0000, v141
    v_pk_add_f32 v[18:19], v[18:19], v[14:15]
    v_lshlrev_b32 v12, 16, v142
    v_and_b32 v13, 0xffff0000, v142
    v_pk_add_f32 v[20:21], v[20:21], v[12:13]
    v_lshlrev_b32 v14, 16, v143
    v_and_b32 v15, 0xffff0000, v143
    v_pk_add_f32 v[22:23], v[22:23], v[14:15]
    s_waitcnt vmcnt(11)
    s_add_u32 s46, s46, 9216
    buffer_load_dwordx4 v[196:199], v5, s[88:91], s46 offen offset:0 sc1
    ds_write_b128 v105, a[140:143] offset:3072
    v_lshlrev_b32 v12, 16, v144
    v_and_b32 v13, 0xffff0000, v144
    v_pk_add_f32 v[24:25], v[24:25], v[12:13]
    v_lshlrev_b32 v14, 16, v145
    v_and_b32 v15, 0xffff0000, v145
    v_pk_add_f32 v[26:27], v[26:27], v[14:15]
    v_lshlrev_b32 v12, 16, v146
    v_and_b32 v13, 0xffff0000, v146
    v_pk_add_f32 v[28:29], v[28:29], v[12:13]
    v_lshlrev_b32 v14, 16, v147
    v_and_b32 v15, 0xffff0000, v147
    v_pk_add_f32 v[30:31], v[30:31], v[14:15]
    s_waitcnt vmcnt(11)
    buffer_load_dwordx4 v[200:203], v5, s[88:91], s46 offen offset:1024 sc1
    ds_write_b128 v105, a[144:147] offset:4096
    v_lshlrev_b32 v12, 16, v148
    v_and_b32 v13, 0xffff0000, v148
    v_pk_add_f32 v[32:33], v[32:33], v[12:13]
    v_lshlrev_b32 v14, 16, v149
    v_and_b32 v15, 0xffff0000, v149
    v_pk_add_f32 v[34:35], v[34:35], v[14:15]
    v_lshlrev_b32 v12, 16, v150
    v_and_b32 v13, 0xffff0000, v150
    v_pk_add_f32 v[36:37], v[36:37], v[12:13]
    v_lshlrev_b32 v14, 16, v151
    v_and_b32 v15, 0xffff0000, v151
    v_pk_add_f32 v[38:39], v[38:39], v[14:15]
    s_waitcnt vmcnt(11)
    s_add_u32 s46, s46, 9216
    buffer_load_dwordx4 v[204:207], v5, s[88:91], s46 offen offset:0 sc1
    ds_write_b128 v105, a[148:151] offset:5120
    v_lshlrev_b32 v12, 16, v152
    v_and_b32 v13, 0xffff0000, v152
    v_pk_add_f32 v[16:17], v[16:17], v[12:13]
    v_lshlrev_b32 v14, 16, v153
    v_and_b32 v15, 0xffff0000, v153
    v_pk_add_f32 v[18:19], v[18:19], v[14:15]
    v_lshlrev_b32 v12, 16, v154
    v_and_b32 v13, 0xffff0000, v154
    v_pk_add_f32 v[20:21], v[20:21], v[12:13]
    v_lshlrev_b32 v14, 16, v155
    v_and_b32 v15, 0xffff0000, v155
    v_pk_add_f32 v[22:23], v[22:23], v[14:15]
    s_waitcnt vmcnt(11)
    buffer_load_dwordx4 v[208:211], v5, s[88:91], s46 offen offset:1024 sc1
    ds_write_b128 v105, a[152:155] offset:6144
    v_lshlrev_b32 v12, 16, v156
    v_and_b32 v13, 0xffff0000, v156
    v_pk_add_f32 v[24:25], v[24:25], v[12:13]
    v_lshlrev_b32 v14, 16, v157
    v_and_b32 v15, 0xffff0000, v157
    v_pk_add_f32 v[26:27], v[26:27], v[14:15]
    v_lshlrev_b32 v12, 16, v158
    v_and_b32 v13, 0xffff0000, v158
    v_pk_add_f32 v[28:29], v[28:29], v[12:13]
    v_lshlrev_b32 v14, 16, v159
    v_and_b32 v15, 0xffff0000, v159
    v_pk_add_f32 v[30:31], v[30:31], v[14:15]
    s_waitcnt vmcnt(11)
    s_add_u32 s46, s46, 9216
    buffer_load_dwordx4 v[212:215], v5, s[88:91], s46 offen offset:0 sc1
    ds_write_b128 v105, a[156:159] offset:7168
    v_lshlrev_b32 v12, 16, v160
    v_and_b32 v13, 0xffff0000, v160
    v_pk_add_f32 v[16:17], v[16:17], v[12:13]
    v_lshlrev_b32 v14, 16, v161
    v_and_b32 v15, 0xffff0000, v161
    v_pk_add_f32 v[18:19], v[18:19], v[14:15]
    v_lshlrev_b32 v12, 16, v162
    v_and_b32 v13, 0xffff0000, v162
    v_pk_add_f32 v[20:21], v[20:21], v[12:13]
    v_lshlrev_b32 v14, 16, v163
    v_and_b32 v15, 0xffff0000, v163
    v_pk_add_f32 v[22:23], v[22:23], v[14:15]
    s_waitcnt vmcnt(11)
    buffer_load_dwordx4 v[216:219], v5, s[88:91], s46 offen offset:1024 sc1
    ds_write_b128 v105, a[160:163] offset:8192
    v_lshlrev_b32 v12, 16, v164
    v_and_b32 v13, 0xffff0000, v164
    v_pk_add_f32 v[24:25], v[24:25], v[12:13]
    v_lshlrev_b32 v14, 16, v165
    v_and_b32 v15, 0xffff0000, v165
    v_pk_add_f32 v[26:27], v[26:27], v[14:15]
    v_lshlrev_b32 v12, 16, v166
    v_and_b32 v13, 0xffff0000, v166
    v_pk_add_f32 v[28:29], v[28:29], v[12:13]
    v_lshlrev_b32 v14, 16, v167
    v_and_b32 v15, 0xffff0000, v167
    v_pk_add_f32 v[30:31], v[30:31], v[14:15]
    s_waitcnt vmcnt(11)
    s_waitcnt vmcnt(9)
    v_cmp_ne_u32 vcc, 0, v9
    s_nop 0
    s_lshr_b32 s3, vcc_lo, 1
    s_and_b32 s3, s3, vcc_lo
    s_lshr_b32 s14, s3, 2
    s_and_b32 s3, s3, s14
    s_and_b32 s3, s3, s48
    s_cbranch_scc0 L2_g3s
L2_g3r:
    s_ff1_i32_b32 s3, s3
    s_bitset0_b32 s48, s3
    s_mul_i32 s46, s3, 9216
    buffer_load_dwordx4 v[220:223], v7, s[88:91], s46 offen offset:2048 sc1
    ds_write_b128 v105, a[164:167] offset:36864
    v_lshlrev_b32 v12, 16, v168
    v_and_b32 v13, 0xffff0000, v168
    v_pk_add_f32 v[16:17], v[16:17], v[12:13]
    v_lshlrev_b32 v14, 16, v169
    v_and_b32 v15, 0xffff0000, v169
    v_pk_add_f32 v[18:19], v[18:19], v[14:15]
    v_lshlrev_b32 v12, 16, v170
    v_and_b32 v13, 0xffff0000, v170
    v_pk_add_f32 v[20:21], v[20:21], v[12:13]
    v_lshlrev_b32 v14, 16, v171
    v_and_b32 v15, 0xffff0000, v171
    v_pk_add_f32 v[22:23], v[22:23], v[14:15]
    buffer_load_dwordx4 v[224:227], v5, s[88:91], s46 offen offset:0 sc1
    ds_write_b128 v105, a[168:171] offset:37888
    v_lshlrev_b32 v12, 16, v172
    v_and_b32 v13, 0xffff0000, v172
    v_pk_add_f32 v[24:25], v[24:25], v[12:13]
    v_lshlrev_b32 v14, 16, v173
    v_and_b32 v15, 0xffff0000, v173
    v_pk_add_f32 v[26:27], v[26:27], v[14:15]
    v_lshlrev_b32 v12, 16, v174
    v_and_b32 v13, 0xffff0000, v174
    v_pk_add_f32 v[28:29], v[28:29], v[12:13]
    v_lshlrev_b32 v14, 16, v175
    v_and_b32 v15, 0xffff0000, v175
    v_pk_add_f32 v[30:31], v[30:31], v[14:15]
    buffer_load_dwordx4 v[228:231], v5, s[88:91], s46 offen offset:1024 sc1
    ds_write_b128 v105, a[172:175] offset:38912
    v_lshlrev_b32 v12, 16, v176
    v_and_b32 v13, 0xffff0000, v176
    v_pk_add_f32 v[16:17], v[16:17], v[12:13]
    v_lshlrev_b32 v14, 16, v177
    v_and_b32 v15, 0xffff0000, v177
    v_pk_add_f32 v[18:19], v[18:19], v[14:15]
    v_lshlrev_b32 v12, 16, v178
    v_and_b32 v13, 0xffff0000, v178
    v_pk_add_f32 v[20:21], v[20:21], v[12:13]
    v_lshlrev_b32 v14, 16, v179
    v_and_b32 v15, 0xffff0000, v179
    v_pk_add_f32 v[22:23], v[22:23], v[14:15]
    s_waitcnt vmcnt(11)
    s_add_u32 s46, s46, 9216
    buffer_load_dwordx4 v[232:235], v5, s[88:91], s46 offen offset:0 sc1
    ds_write_b128 v105, a[176:179] offset:39936
    v_lshlrev_b32 v12, 16, v180
    v_and_b32 v13, 0xffff0000, v180
    v_pk_add_f32 v[24:25], v[24:25], v[12:13]
    v_lshlrev_b32 v14, 16, v181
    v_and_b32 v15, 0xffff0000, v181
    v_pk_add_f32 v[26:27], v[26:27], v[14:15]
    v_lshlrev_b32 v12, 16, v182
    v_and_b32 v13, 0xffff0000, v182
    v_pk_add_f32 v[28:29], v[28:29], v[12:13]
    v_lshlrev_b32 v14, 16, v183
    v_and_b32 v15, 0xffff0000, v183
    v_pk_add_f32 v[30:31], v[30:31], v[14:15]
    s_waitcnt vmcnt(11)
    buffer_load_dwordx4 v[236:239], v5, s[88:91], s46 offen offset:1024 sc1
    ds_write_b128 v105, a[180:183] offset:40960
    v_lshlrev_b32 v12, 16, v184
    v_and_b32 v13, 0xffff0000, v184
    v_pk_add_f32 v[32:33], v[32:33], v[12:13]
    v_lshlrev_b32 v14, 16, v185
    v_and_b32 v15, 0xffff0000, v185
    v_pk_add_f32 v[34:35], v[34:35], v[14:15]
    v_lshlrev_b32 v12, 16, v186
    v_and_b32 v13, 0xffff0000, v186
    v_pk_add_f32 v[36:37], v[36:37], v[12:13]
    v_lshlrev_b32 v14, 16, v187
    v_and_b32 v15, 0xffff0000, v187
    v_pk_add_f32 v[38:39], v[38:39], v[14:15]
    ds_read_b128 v[112:115], v3 offset:4608
    ds_read_b128 v[116:119], v3 offset:4624
    ds_read_b128 v[120:123], v3 offset:4864
    ds_read_b128 v[124:127], v3 offset:4880
    ds_read_b128 v[128:131], v4 offset:5120
    ds_read_b128 v[132:135], v4 offset:5136
    ds_read_b128 v[136:139], v3 offset:2304
    ds_read_b128 v[140:143], v3 offset:2320
    ds_read_b128 v[144:147], v3 offset:2560
    ds_read_b128 v[148:151], v3 offset:2576
    ds_read_b128 v[152:155], v4 offset:2816
    ds_read_b128 v[156:159], v4 offset:2832
    ds_read_b128 v[160:163], v3 offset:6912
    ds_read_b128 v[164:167], v3 offset:6928
    ds_read_b128 v[168:171], v3 offset:7168
    ds_read_b128 v[172:175], v3 offset:7184
    ds_read_b128 v[176:179], v4 offset:7424
    ds_read_b128 v[180:183], v4 offset:7440
    s_waitcnt vmcnt(11)
    s_add_u32 s46, s46, 9216
    buffer_load_dwordx4 v[240:243], v5, s[88:91], s46 offen offset:0 sc1
    ds_write_b128 v105, a[184:187] offset:41984
    v_lshlrev_b32 v12, 16, v188
    v_and_b32 v13, 0xffff0000, v188
    v_pk_add_f32 v[16:17], v[16:17], v[12:13]
    v_lshlrev_b32 v14, 16, v189
    v_and_b32 v15, 0xffff0000, v189
    v_pk_add_f32 v[18:19], v[18:19], v[14:15]
    v_lshlrev_b32 v12, 16, v190
    v_and_b32 v13, 0xffff0000, v190
    v_pk_add_f32 v[20:21], v[20:21], v[12:13]
    v_lshlrev_b32 v14, 16, v191
    v_and_b32 v15, 0xffff0000, v191
    v_pk_add_f32 v[22:23], v[22:23], v[14:15]
    s_waitcnt vmcnt(11)
    buffer_load_dwordx4 v[244:247], v5, s[88:91], s46 offen offset:1024 sc1
    ds_write_b128 v105, a[188:191] offset:43008
    v_lshlrev_b32 v12, 16, v192
    v_and_b32 v13, 0xffff0000, v192
    v_pk_add_f32 v[24:25], v[24:25], v[12:13]
    v_lshlrev_b32 v14, 16, v193
    v_and_b32 v15, 0xffff0000, v193
    v_pk_add_f32 v[26:27], v[26:27], v[14:15]
    v_lshlrev_b32 v12, 16, v194
    v_and_b32 v13, 0xffff0000, v194
    v_pk_add_f32 v[28:29], v[28:29], v[12:13]
    v_lshlrev_b32 v14, 16, v195
    v_and_b32 v15, 0xffff0000, v195
    v_pk_add_f32 v[30:31], v[30:31], v[14:15]
    s_waitcnt vmcnt(11)
    s_add_u32 s46, s46, 9216
    buffer_load_dwordx4 v[248:251], v5, s[88:91], s46 offen offset:0 sc1
    ds_write_b128 v105, a[192:195] offset:44032
    v_lshlrev_b32 v12, 16, v196
    v_and_b32 v13, 0xffff0000, v196
    v_pk_add_f32 v[16:17], v[16:17], v[12:13]
    v_lshlrev_b32 v14, 16, v197
    v_and_b32 v15, 0xffff0000, v197
    v_pk_add_f32 v[18:19], v[18:19], v[14:15]
    v_lshlrev_b32 v12, 16, v198
    v_and_b32 v13, 0xffff0000, v198
    v_pk_add_f32 v[20:21], v[20:21], v[12:13]
    v_lshlrev_b32 v14, 16, v199
    v_and_b32 v15, 0xffff0000, v199
    v_pk_add_f32 v[22:23], v[22:23], v[14:15]
    s_waitcnt vmcnt(11)
    buffer_load_dwordx4 v[252:255], v5, s[88:91], s46 offen offset:1024 sc1
    ds_write_b128 v105, a[196:199] offset:45056
    v_lshlrev_b32 v12, 16, v200
    v_and_b32 v13, 0xffff0000, v200
    v_pk_add_f32 v[24:25], v[24:25], v[12:13]
    v_lshlrev_b32 v14, 16, v201
    v_and_b32 v15, 0xffff0000, v201
    v_pk_add_f32 v[26:27], v[26:27], v[14:15]
    v_lshlrev_b32 v12, 16, v202
    v_and_b32 v13, 0xffff0000, v202
    v_pk_add_f32 v[28:29], v[28:29], v[12:13]
    v_lshlrev_b32 v14, 16, v203
    v_and_b32 v15, 0xffff0000, v203
    v_pk_add_f32 v[30:31], v[30:31], v[14:15]
    v_lshlrev_b32 v12, 16, v204
    v_and_b32 v13, 0xffff0000, v204
    v_pk_add_f32 v[16:17], v[16:17], v[12:13]
    v_lshlrev_b32 v14, 16, v205
    v_and_b32 v15, 0xffff0000, v205
    v_pk_add_f32 v[18:19], v[18:19], v[14:15]
    v_lshlrev_b32 v12, 16, v206
    v_and_b32 v13, 0xffff0000, v206
    v_pk_add_f32 v[20:21], v[20:21], v[12:13]
    v_lshlrev_b32 v14, 16, v207
    v_and_b32 v15, 0xffff0000, v207
    v_pk_add_f32 v[22:23], v[22:23], v[14:15]
    s_waitcnt vmcnt(11)
    v_lshlrev_b32 v12, 16, v208
    v_and_b32 v13, 0xffff0000, v208
    v_pk_add_f32 v[24:25], v[24:25], v[12:13]
    v_lshlrev_b32 v14, 16, v209
    v_and_b32 v15, 0xffff0000, v209
    v_pk_add_f32 v[26:27], v[26:27], v[14:15]
    v_lshlrev_b32 v12, 16, v210
    v_and_b32 v13, 0xffff0000, v210
    v_pk_add_f32 v[28:29], v[28:29], v[12:13]
    v_lshlrev_b32 v14, 16, v211
    v_and_b32 v15, 0xffff0000, v211
    v_pk_add_f32 v[30:31], v[30:31], v[14:15]
    s_waitcnt vmcnt(10)
    v_lshlrev_b32 v12, 16, v212
    v_and_b32 v13, 0xffff0000, v212
    v_pk_add_f32 v[16:17], v[16:17], v[12:13]
    v_lshlrev_b32 v14, 16, v213
    v_and_b32 v15, 0xffff0000, v213
    v_pk_add_f32 v[18:19], v[18:19], v[14:15]
    v_lshlrev_b32 v12, 16, v214
    v_and_b32 v13, 0xffff0000, v214
    v_pk_add_f32 v[20:21], v[20:21], v[12:13]
    v_lshlrev_b32 v14, 16, v215
    v_and_b32 v15, 0xffff0000, v215
    v_pk_add_f32 v[22:23], v[22:23], v[14:15]
    s_waitcnt vmcnt(9)
    v_lshlrev_b32 v12, 16, v216
    v_and_b32 v13, 0xffff0000, v216
    v_pk_add_f32 v[24:25], v[24:25], v[12:13]
    v_lshlrev_b32 v14, 16, v217
    v_and_b32 v15, 0xffff0000, v217
    v_pk_add_f32 v[26:27], v[26:27], v[14:15]
    v_lshlrev_b32 v12, 16, v218
    v_and_b32 v13, 0xffff0000, v218
    v_pk_add_f32 v[28:29], v[28:29], v[12:13]
    v_lshlrev_b32 v14, 16, v219
    v_and_b32 v15, 0xffff0000, v219
    v_pk_add_f32 v[30:31], v[30:31], v[14:15]
    s_waitcnt vmcnt(8)
    v_lshlrev_b32 v12, 16, v220
    v_and_b32 v13, 0xffff0000, v220
    v_pk_add_f32 v[32:33], v[32:33], v[12:13]
    v_lshlrev_b32 v14, 16, v221
    v_and_b32 v15, 0xffff0000, v221
    v_pk_add_f32 v[34:35], v[34:35], v[14:15]
    v_lshlrev_b32 v12, 16, v222
    v_and_b32 v13, 0xffff0000, v222
    v_pk_add_f32 v[36:37], v[36:37], v[12:13]
    v_lshlrev_b32 v14, 16, v223
    v_and_b32 v15, 0xffff0000, v223
    v_pk_add_f32 v[38:39], v[38:39], v[14:15]
    v_mov_b32 v184, v32
    v_mov_b32 v185, v33
    v_mov_b32 v186, v34
    v_mov_b32 v187, v35
    v_mov_b32 v188, v36
    v_mov_b32 v189, v37
    v_mov_b32 v190, v38
    v_mov_b32 v191, v39
    v_permlane16_swap_b32 v184, v32
    v_permlane16_swap_b32 v185, v33
    v_permlane16_swap_b32 v186, v34
    v_permlane16_swap_b32 v187, v35
    v_permlane16_swap_b32 v188, v36
    v_permlane16_swap_b32 v189, v37
    v_permlane16_swap_b32 v190, v38
    v_permlane16_swap_b32 v191, v39
    v_add_f32 v32, v32, v184
    v_add_f32 v33, v33, v185
    v_add_f32 v34, v34, v186
    v_add_f32 v35, v35, v187
    v_add_f32 v36, v36, v188
    v_add_f32 v37, v37, v189
    v_add_f32 v38, v38, v190
    v_add_f32 v39, v39, v191
    v_mov_b32 v184, v32
    v_mov_b32 v185, v33
    v_mov_b32 v186, v34
    v_mov_b32 v187, v35
    v_mov_b32 v188, v36
    v_mov_b32 v189, v37
    v_mov_b32 v190, v38
    v_mov_b32 v191, v39
    v_permlane32_swap_b32 v184, v32
    v_permlane32_swap_b32 v185, v33
    v_permlane32_swap_b32 v186, v34
    v_permlane32_swap_b32 v187, v35
    v_permlane32_swap_b32 v188, v36
    v_permlane32_swap_b32 v189, v37
    v_permlane32_swap_b32 v190, v38
    v_permlane32_swap_b32 v191, v39
    v_add_f32 v32, v32, v184
    v_add_f32 v33, v33, v185
    v_add_f32 v34, v34, v186
    v_add_f32 v35, v35, v187
    v_add_f32 v36, v36, v188
    v_add_f32 v37, v37, v189
    v_add_f32 v38, v38, v190
    v_add_f32 v39, v39, v191
    s_waitcnt vmcnt(7)
    v_lshlrev_b32 v12, 16, v224
    v_and_b32 v13, 0xffff0000, v224
    v_pk_add_f32 v[16:17], v[16:17], v[12:13]
    v_lshlrev_b32 v14, 16, v225
    v_and_b32 v15, 0xffff0000, v225
    v_pk_add_f32 v[18:19], v[18:19], v[14:15]
    v_lshlrev_b32 v12, 16, v226
    v_and_b32 v13, 0xffff0000, v226
    v_pk_add_f32 v[20:21], v[20:21], v[12:13]
    v_lshlrev_b32 v14, 16, v227
    v_and_b32 v15, 0xffff0000, v227
    v_pk_add_f32 v[22:23], v[22:23], v[14:15]
    s_waitcnt vmcnt(6)
    v_lshlrev_b32 v12, 16, v228
    v_and_b32 v13, 0xffff0000, v228
    v_pk_add_f32 v[24:25], v[24:25], v[12:13]
    v_lshlrev_b32 v14, 16, v229
    v_and_b32 v15, 0xffff0000, v229
    v_pk_add_f32 v[26:27], v[26:27], v[14:15]
    v_lshlrev_b32 v12, 16, v230
    v_and_b32 v13, 0xffff0000, v230
    v_pk_add_f32 v[28:29], v[28:29], v[12:13]
    v_lshlrev_b32 v14, 16, v231
    v_and_b32 v15, 0xffff0000, v231
    v_pk_add_f32 v[30:31], v[30:31], v[14:15]
    s_waitcnt vmcnt(5)
    v_lshlrev_b32 v12, 16, v232
    v_and_b32 v13, 0xffff0000, v232
    v_pk_add_f32 v[16:17], v[16:17], v[12:13]
    v_lshlrev_b32 v14, 16, v233
    v_and_b32 v15, 0xffff0000, v233
    v_pk_add_f32 v[18:19], v[18:19], v[14:15]
    v_lshlrev_b32 v12, 16, v234
    v_and_b32 v13, 0xffff0000, v234
    v_pk_add_f32 v[20:21], v[20:21], v[12:13]
    v_lshlrev_b32 v14, 16, v235
    v_and_b32 v15, 0xffff0000, v235
    v_pk_add_f32 v[22:23], v[22:23], v[14:15]
    s_waitcnt vmcnt(4)
    v_lshlrev_b32 v12, 16, v236
    v_and_b32 v13, 0xffff0000, v236
    v_pk_add_f32 v[24:25], v[24:25], v[12:13]
    v_lshlrev_b32 v14, 16, v237
    v_and_b32 v15, 0xffff0000, v237
    v_pk_add_f32 v[26:27], v[26:27], v[14:15]
    v_lshlrev_b32 v12, 16, v238
    v_and_b32 v13, 0xffff0000, v238
    v_pk_add_f32 v[28:29], v[28:29], v[12:13]
    v_lshlrev_b32 v14, 16, v239
    v_and_b32 v15, 0xffff0000, v239
    v_pk_add_f32 v[30:31], v[30:31], v[14:15]
    s_waitcnt vmcnt(3)
    v_lshlrev_b32 v12, 16, v240
    v_and_b32 v13, 0xffff0000, v240
    v_pk_add_f32 v[16:17], v[16:17], v[12:13]
    v_lshlrev_b32 v14, 16, v241
    v_and_b32 v15, 0xffff0000, v241
    v_pk_add_f32 v[18:19], v[18:19], v[14:15]
    v_lshlrev_b32 v12, 16, v242
    v_and_b32 v13, 0xffff0000, v242
    v_pk_add_f32 v[20:21], v[20:21], v[12:13]
    v_lshlrev_b32 v14, 16, v243
    v_and_b32 v15, 0xffff0000, v243
    v_pk_add_f32 v[22:23], v[22:23], v[14:15]
    s_waitcnt vmcnt(2)
    v_lshlrev_b32 v12, 16, v244
    v_and_b32 v13, 0xffff0000, v244
    v_pk_add_f32 v[24:25], v[24:25], v[12:13]
    v_lshlrev_b32 v14, 16, v245
    v_and_b32 v15, 0xffff0000, v245
    v_pk_add_f32 v[26:27], v[26:27], v[14:15]
    v_lshlrev_b32 v12, 16, v246
    v_and_b32 v13, 0xffff0000, v246
    v_pk_add_f32 v[28:29], v[28:29], v[12:13]
    v_lshlrev_b32 v14, 16, v247
    v_and_b32 v15, 0xffff0000, v247
    v_pk_add_f32 v[30:31], v[30:31], v[14:15]
    s_waitcnt vmcnt(1)
    v_lshlrev_b32 v12, 16, v248
    v_and_b32 v13, 0xffff0000, v248
    v_pk_add_f32 v[16:17], v[16:17], v[12:13]
    v_lshlrev_b32 v14, 16, v249
    v_and_b32 v15, 0xffff0000, v249
    v_pk_add_f32 v[18:19], v[18:19], v[14:15]
    v_lshlrev_b32 v12, 16, v250
    v_and_b32 v13, 0xffff0000, v250
    v_pk_add_f32 v[20:21], v[20:21], v[12:13]
    v_lshlrev_b32 v14, 16, v251
    v_and_b32 v15, 0xffff0000, v251
    v_pk_add_f32 v[22:23], v[22:23], v[14:15]
    s_waitcnt vmcnt(0)
    v_lshlrev_b32 v12, 16, v252
    v_and_b32 v13, 0xffff0000, v252
    v_pk_add_f32 v[24:25], v[24:25], v[12:13]
    v_lshlrev_b32 v14, 16, v253
    v_and_b32 v15, 0xffff0000, v253
    v_pk_add_f32 v[26:27], v[26:27], v[14:15]
    v_lshlrev_b32 v12, 16, v254
    v_and_b32 v13, 0xffff0000, v254
    v_pk_add_f32 v[28:29], v[28:29], v[12:13]
    v_lshlrev_b32 v14, 16, v255
    v_and_b32 v15, 0xffff0000, v255
    v_pk_add_f32 v[30:31], v[30:31], v[14:15]
    s_waitcnt lgkmcnt(15)
    v_lshlrev_b32 v12, 16, v64
    v_and_b32 v13, 0xffff0000, v64
    v_pk_fma_f32 v[16:17], v[16:17], v[40:41], v[12:13]
    v_lshlrev_b32 v12, 16, v65
    v_and_b32 v13, 0xffff0000, v65
    v_pk_fma_f32 v[18:19], v[18:19], v[42:43], v[12:13]
    v_lshlrev_b32 v12, 16, v66
    v_and_b32 v13, 0xffff0000, v66
    v_pk_fma_f32 v[20:21], v[20:21], v[44:45], v[12:13]
    v_lshlrev_b32 v12, 16, v67
    v_and_b32 v13, 0xffff0000, v67
    v_pk_fma_f32 v[22:23], v[22:23], v[46:47], v[12:13]
    v_lshlrev_b32 v12, 16, v68
    v_and_b32 v13, 0xffff0000, v68
    v_pk_fma_f32 v[24:25], v[24:25], v[48:49], v[12:13]
    v_lshlrev_b32 v12, 16, v69
    v_and_b32 v13, 0xffff0000, v69
    v_pk_fma_f32 v[26:27], v[26:27], v[50:51], v[12:13]
    v_lshlrev_b32 v12, 16, v70
    v_and_b32 v13, 0xffff0000, v70
    v_pk_fma_f32 v[28:29], v[28:29], v[52:53], v[12:13]
    v_lshlrev_b32 v12, 16, v71
    v_and_b32 v13, 0xffff0000, v71
    v_pk_fma_f32 v[30:31], v[30:31], v[54:55], v[12:13]
    v_lshlrev_b32 v12, 16, v72
    v_and_b32 v13, 0xffff0000, v72
    v_pk_fma_f32 v[32:33], v[32:33], v[56:57], v[12:13]
    v_lshlrev_b32 v12, 16, v73
    v_and_b32 v13, 0xffff0000, v73
    v_pk_fma_f32 v[34:35], v[34:35], v[58:59], v[12:13]
    v_lshlrev_b32 v12, 16, v74
    v_and_b32 v13, 0xffff0000, v74
    v_pk_fma_f32 v[36:37], v[36:37], v[60:61], v[12:13]
    v_lshlrev_b32 v12, 16, v75
    v_and_b32 v13, 0xffff0000, v75
    v_pk_fma_f32 v[38:39], v[38:39], v[62:63], v[12:13]
    v_add_f32 v100, v16, v17
    v_add_f32 v100, v100, v18
    v_add_f32 v100, v100, v19
    v_add_f32 v100, v100, v20
    v_add_f32 v100, v100, v21
    v_add_f32 v100, v100, v22
    v_add_f32 v100, v100, v23
    v_add_f32 v100, v100, v24
    v_add_f32 v100, v100, v25
    v_add_f32 v100, v100, v26
    v_add_f32 v100, v100, v27
    v_add_f32 v100, v100, v28
    v_add_f32 v100, v100, v29
    v_add_f32 v100, v100, v30
    v_add_f32 v100, v100, v31
    v_add_f32 v103, v32, v33
    v_add_f32 v103, v103, v34
    v_add_f32 v103, v103, v35
    v_add_f32 v103, v103, v36
    v_add_f32 v103, v103, v37
    v_add_f32 v103, v103, v38
    v_add_f32 v103, v103, v39
    v_fmac_f32 v100, 0x3e800000, v103
    s_nop 1
    v_add_f32_dpp v100, v100, v100 row_ror:8 row_mask:0xf bank_mask:0xf
    v_mov_b32 v103, v100
    s_nop 1
    v_permlane16_swap_b32 v103, v100
    v_add_f32 v100, v100, v103
    v_mov_b32 v103, v100
    s_nop 1
    v_permlane32_swap_b32 v103, v100
    v_add_f32 v100, v100, v103
    v_mul_f32 v100, 0x3be38e39, v100
    v_sub_f32 v184, v16, v100
    v_sub_f32 v185, v17, v100
    v_sub_f32 v186, v18, v100
    v_sub_f32 v187, v19, v100
    v_sub_f32 v188, v20, v100
    v_sub_f32 v189, v21, v100
    v_sub_f32 v190, v22, v100
    v_sub_f32 v191, v23, v100
    v_sub_f32 v192, v24, v100
    v_sub_f32 v193, v25, v100
    v_sub_f32 v194, v26, v100
    v_sub_f32 v195, v27, v100
    v_sub_f32 v196, v28, v100
    v_sub_f32 v197, v29, v100
    v_sub_f32 v198, v30, v100
    v_sub_f32 v199, v31, v100
    v_sub_f32 v200, v32, v100
    v_sub_f32 v201, v33, v100
    v_sub_f32 v202, v34, v100
    v_sub_f32 v203, v35, v100
    v_sub_f32 v204, v36, v100
    v_sub_f32 v205, v37, v100
    v_sub_f32 v206, v38, v100
    v_sub_f32 v207, v39, v100
    v_mul_f32 v101, v184, v184
    v_fmac_f32 v101, v185, v185
    v_fmac_f32 v101, v186, v186
    v_fmac_f32 v101, v187, v187
    v_fmac_f32 v101, v188, v188
    v_fmac_f32 v101, v189, v189
    v_fmac_f32 v101, v190, v190
    v_fmac_f32 v101, v191, v191
    v_fmac_f32 v101, v192, v192
    v_fmac_f32 v101, v193, v193
    v_fmac_f32 v101, v194, v194
    v_fmac_f32 v101, v195, v195
    v_fmac_f32 v101, v196, v196
    v_fmac_f32 v101, v197, v197
    v_fmac_f32 v101, v198, v198
    v_fmac_f32 v101, v199, v199
    v_mul_f32 v103, v200, v200
    v_fmac_f32 v103, v201, v201
    v_fmac_f32 v103, v202, v202
    v_fmac_f32 v103, v203, v203
    v_fmac_f32 v103, v204, v204
    v_fmac_f32 v103, v205, v205
    v_fmac_f32 v103, v206, v206
    v_fmac_f32 v103, v207, v207
    v_fmac_f32 v101, 0x3e800000, v103
    v_mul_f32 v102, v184, v76
    v_fmac_f32 v102, v185, v77
    v_fmac_f32 v102, v186, v78
    v_fmac_f32 v102, v187, v79
    v_fmac_f32 v102, v188, v80
    v_fmac_f32 v102, v189, v81
    v_fmac_f32 v102, v190, v82
    v_fmac_f32 v102, v191, v83
    v_fmac_f32 v102, v192, v84
    v_fmac_f32 v102, v193, v85
    v_fmac_f32 v102, v194, v86
    v_fmac_f32 v102, v195, v87
    v_fmac_f32 v102, v196, v88
    v_fmac_f32 v102, v197, v89
    v_fmac_f32 v102, v198, v90
    v_fmac_f32 v102, v199, v91
    v_mul_f32 v103, v200, v92
    v_fmac_f32 v103, v201, v93
    v_fmac_f32 v103, v202, v94
    v_fmac_f32 v103, v203, v95
    v_fmac_f32 v103, v204, v96
    v_fmac_f32 v103, v205, v97
    v_fmac_f32 v103, v206, v98
    v_fmac_f32 v103, v207, v99
    v_fmac_f32 v102, 0x3e800000, v103
    s_nop 1
    v_add_f32_dpp v101, v101, v101 row_ror:8 row_mask:0xf bank_mask:0xf
    v_add_f32_dpp v102, v102, v102 row_ror:8 row_mask:0xf bank_mask:0xf
    v_mov_b32 v103, v101
    v_mov_b32 v104, v102
    s_nop 0
    v_permlane16_swap_b32 v103, v101
    v_permlane16_swap_b32 v104, v102
    v_add_f32 v101, v101, v103
    v_add_f32 v102, v102, v104
    v_mov_b32 v103, v101
    v_mov_b32 v104, v102
    s_nop 0
    v_permlane32_swap_b32 v103, v101
    v_permlane32_swap_b32 v104, v102
    v_add_f32 v101, v101, v103
    v_add_f32 v102, v102, v104
    ds_write_b32 v10, v100 offset:0
    ds_write_b32 v10, v101 offset:128
    ds_write_b32 v10, v102 offset:256
    s_waitcnt lgkmcnt(0)
    s_barrier
    ds_read_b128 v[40:43], v11 offset:0
    ds_read_b128 v[44:47], v11 offset:128
    ds_read_b128 v[48:51], v11 offset:256
    ds_read_b128 v[52:55], v11 offset:384
    ds_read_b128 v[56:59], v11 offset:512
    s_waitcnt lgkmcnt(4)
    v_add_f32 v12, v40, v41
    v_add_f32 v13, v42, v43
    v_add_f32 v12, v12, v13
    v_mul_f32 v12, 0x3e800000, v12
    v_sub_f32 v40, v40, v12
    v_sub_f32 v41, v41, v12
    v_sub_f32 v42, v42, v12
    v_sub_f32 v43, v43, v12
    v_sub_f32 v100, v100, v12
    v_mul_f32 v13, v40, v40
    v_fmac_f32 v13, v41, v41
    v_fmac_f32 v13, v42, v42
    v_fmac_f32 v13, v43, v43
    s_waitcnt lgkmcnt(3)
    v_add_f32 v14, v44, v45
    v_add_f32 v15, v46, v47
    v_add_f32 v14, v14, v15
    v_fmac_f32 v14, 0x43100000, v13
    v_mov_b32 v13, 0x3727c5ac
    v_fmac_f32 v13, 0x3ae38e39, v14
    v_rsq_f32 v13, v13
    s_waitcnt lgkmcnt(0)
    v_mul_f32 v100, v100, v13
    v_fma_f32 v184, v184, v13, v100
    v_fma_f32 v185, v185, v13, v100
    v_fma_f32 v186, v186, v13, v100
    v_fma_f32 v187, v187, v13, v100
    v_fma_f32 v188, v188, v13, v100
    v_fma_f32 v189, v189, v13, v100
    v_fma_f32 v190, v190, v13, v100
    v_fma_f32 v191, v191, v13, v100
    v_fma_f32 v192, v192, v13, v100
    v_fma_f32 v193, v193, v13, v100
    v_fma_f32 v194, v194, v13, v100
    v_fma_f32 v195, v195, v13, v100
    v_fma_f32 v196, v196, v13, v100
    v_fma_f32 v197, v197, v13, v100
    v_fma_f32 v198, v198, v13, v100
    v_fma_f32 v199, v199, v13, v100
    v_fma_f32 v200, v200, v13, v100
    v_fma_f32 v201, v201, v13, v100
    v_fma_f32 v202, v202, v13, v100
    v_fma_f32 v203, v203, v13, v100
    v_fma_f32 v204, v204, v13, v100
    v_fma_f32 v205, v205, v13, v100
    v_fma_f32 v206, v206, v13, v100
    v_fma_f32 v207, v207, v13, v100
    v_pk_fma_f32 v[184:185], v[184:185], v[112:113], v[136:137]
    v_pk_fma_f32 v[186:187], v[186:187], v[114:115], v[138:139]
    v_pk_fma_f32 v[188:189], v[188:189], v[116:117], v[140:141]
    v_pk_fma_f32 v[190:191], v[190:191], v[118:119], v[142:143]
    v_pk_fma_f32 v[192:193], v[192:193], v[120:121], v[144:145]
    v_pk_fma_f32 v[194:195], v[194:195], v[122:123], v[146:147]
    v_pk_fma_f32 v[196:197], v[196:197], v[124:125], v[148:149]
    v_pk_fma_f32 v[198:199], v[198:199], v[126:127], v[150:151]
    v_pk_fma_f32 v[200:201], v[200:201], v[128:129], v[152:153]
    v_pk_fma_f32 v[202:203], v[202:203], v[130:131], v[154:155]
    v_pk_fma_f32 v[204:205], v[204:205], v[132:133], v[156:157]
    v_pk_fma_f32 v[206:207], v[206:207], v[134:135], v[158:159]
    v_pk_fma_f32 v[16:17], v[184:185], v[160:161], v[16:17]
    v_pk_fma_f32 v[18:19], v[186:187], v[162:163], v[18:19]
    v_pk_fma_f32 v[20:21], v[188:189], v[164:165], v[20:21]
    v_pk_fma_f32 v[22:23], v[190:191], v[166:167], v[22:23]
    v_pk_fma_f32 v[24:25], v[192:193], v[168:169], v[24:25]
    v_pk_fma_f32 v[26:27], v[194:195], v[170:171], v[26:27]
    v_pk_fma_f32 v[28:29], v[196:197], v[172:173], v[28:29]
    v_pk_fma_f32 v[30:31], v[198:199], v[174:175], v[30:31]
    v_pk_fma_f32 v[32:33], v[200:201], v[176:177], v[32:33]
    v_pk_fma_f32 v[34:35], v[202:203], v[178:179], v[34:35]
    v_pk_fma_f32 v[36:37], v[204:205], v[180:181], v[36:37]
    v_pk_fma_f32 v[38:39], v[206:207], v[182:183], v[38:39]
    v_cvt_pk_bf16_f32 v112, v16, v17
    v_cvt_pk_bf16_f32 v113, v18, v19
    v_cvt_pk_bf16_f32 v114, v20, v21
    v_cvt_pk_bf16_f32 v115, v22, v23
    ds_write_b128 v1, v[112:115] offset:0
    v_cvt_pk_bf16_f32 v116, v24, v25
    v_cvt_pk_bf16_f32 v117, v26, v27
    v_cvt_pk_bf16_f32 v118, v28, v29
    v_cvt_pk_bf16_f32 v119, v30, v31
    ds_write_b128 v1, v[116:119] offset:128
    v_cvt_pk_bf16_f32 v120, v32, v33
    v_cvt_pk_bf16_f32 v121, v34, v35
    v_cvt_pk_bf16_f32 v122, v36, v37
    v_cvt_pk_bf16_f32 v123, v38, v39
    ds_write_b128 v2, v[120:123] offset:0
    v_cvt_pk_bf16_f32 v124, v184, v185
    v_cvt_pk_bf16_f32 v125, v186, v187
    v_cvt_pk_bf16_f32 v126, v188, v189
    v_cvt_pk_bf16_f32 v127, v190, v191
    ds_write_b128 v1, v[124:127] offset:9344
    v_cvt_pk_bf16_f32 v128, v192, v193
    v_cvt_pk_bf16_f32 v129, v194, v195
    v_cvt_pk_bf16_f32 v130, v196, v197
    v_cvt_pk_bf16_f32 v131, v198, v199
    ds_write_b128 v1, v[128:131] offset:9472
    v_cvt_pk_bf16_f32 v132, v200, v201
    v_cvt_pk_bf16_f32 v133, v202, v203
    v_cvt_pk_bf16_f32 v134, v204, v205
    v_cvt_pk_bf16_f32 v135, v206, v207
    ds_write_b128 v2, v[132:135] offset:9344
    v_fmac_f32 v48, v40, v52
    v_fmac_f32 v49, v41, v53
    v_fmac_f32 v50, v42, v54
    v_fmac_f32 v51, v43, v55
    v_add_f32 v14, v48, v49
    v_add_f32 v15, v50, v51
    v_add_f32 v14, v14, v15
    v_add_f32 v15, v56, v57
    v_add_f32 v12, v58, v59
    v_add_f32 v15, v15, v12
    v_fmac_f32 v15, v14, v13
    s_waitcnt lgkmcnt(0)
    s_barrier
    ds_read_b128 v[160:163], v107
    ds_read_b128 v[164:167], v108
    ds_read_b128 v[168:171], v109
    ds_read_b128 v[172:175], v110
    ds_read_b128 v[176:179], v111
    s_lshl_b32 s3, s96, 3
    s_sub_u32 s3, 0xfff, s3
    v_and_b32 v14, 7, v0
    v_sub_u32 v14, s3, v14
    v_ashrrev_i32 v12, 31, v15
    v_or_b32 v12, 0x80000000, v12
    v_xor_b32 v12, v12, v15
    v_and_b32 v12, 0xfffff000, v12
    v_or_b32 v100, v12, v14
    v_mov_b32 v101, 0
    s_waitcnt lgkmcnt(4)
    buffer_store_dwordx4 v[160:163], v8, s[24:27], s45 offen offset:0 sc1
    s_waitcnt lgkmcnt(3)
    buffer_store_dwordx4 v[164:167], v8, s[24:27], s45 offen offset:1024 sc1
    s_waitcnt lgkmcnt(2)
    buffer_store_dwordx4 v[168:171], v8, s[24:27], s45 offen offset:2048 sc1
    s_waitcnt lgkmcnt(1)
    buffer_store_dwordx4 v[172:175], v8, s[24:27], s45 offen offset:3072 sc1
    s_waitcnt lgkmcnt(0)
    s_mov_b32 exec_hi, 0
    s_add_u32 s45, s45, 4096
    buffer_store_dwordx4 v[176:179], v8, s[24:27], s45 offen offset:0 sc1
    s_mov_b64 exec, -1
    s_nop 1
    v_mov_b32_dpp v12, v100 row_ror:1 row_mask:0xf bank_mask:0xf
    v_mov_b32_dpp v13, v101 row_ror:1 row_mask:0xf bank_mask:0xf
    v_max_u32 v101, v101, v13
    v_med3_u32 v101, v100, v12, v101
    v_max_u32 v100, v100, v12
    s_nop 1
    v_mov_b32_dpp v12, v100 row_ror:2 row_mask:0xf bank_mask:0xf
    v_mov_b32_dpp v13, v101 row_ror:2 row_mask:0xf bank_mask:0xf
    v_max_u32 v101, v101, v13
    v_med3_u32 v101, v100, v12, v101
    v_max_u32 v100, v100, v12
    s_nop 1
    v_mov_b32_dpp v12, v100 row_ror:4 row_mask:0xf bank_mask:0xf
    v_mov_b32_dpp v13, v101 row_ror:4 row_mask:0xf bank_mask:0xf
    v_max_u32 v101, v101, v13
    v_med3_u32 v101, v100, v12, v101
    v_max_u32 v100, v100, v12
    s_lshl_b32 s3, s96, 7
    s_add_u32 s3, s3, 32776
    v_lshlrev_b32 v14, 7, v0
    s_lshl_b32 s15, s51, 13
    s_add_u32 s15, s15, 32776
    s_waitcnt vmcnt(0)
    s_barrier
    s_cmp_lg_u32 s51, 0
    s_cbranch_scc1 L2_nokey
    s_mov_b64 exec, 1
    buffer_store_dwordx2 v[100:101], v14, s[84:87], s3 offen sc1
    s_mov_b64 exec, -1
L2_nokey:
    s_cmp_ge_u32 s2, 180
    s_cbranch_scc1 L2_fin
    s_cmp_ge_u32 s2, 144
    s_cbranch_scc1 L2_gather
    v_lshrrev_b32 v21, 4, v0
    v_bfe_u32 v20, v0, 2, 2
    v_lshl_add_u32 v20, v21, 3, v20
    v_and_b32 v21, 3, v0
    v_lshlrev_b32 v22, 6, v20
    v_lshl_add_u32 v22, v21, 3, v22
    s_cmp_lt_u32 s51, 2
    s_cselect_b32 s3, 126976, 0
    s_cselect_b32 s14, 0, 16384
    s_add_u32 s3, s3, s14
    s_and_b32 s14, s51, 1
    s_lshl_b32 s14, s14, 5
    s_add_u32 s3, s3, s14
    v_add_u32 v22, s3, v22
    v_mul_u32_u24 v23, 1152, v20
    v_lshl_add_u32 v23, v21, 3, v23
    s_mul_i32 s3, s51, 288
    s_add_u32 s3, s3, 53248
    v_add_u32 v23, s3, v23
    ds_read_b64_tr_b16 a[64:65], v22 offset:0
    ds_read_b64_tr_b16 a[66:67], v22 offset:256
    ds_read_b64_tr_b16 a[68:69], v22 offset:2048
    ds_read_b64_tr_b16 a[70:71], v22 offset:2304
    ds_read_b64_tr_b16 a[72:73], v22 offset:4096
    ds_read_b64_tr_b16 a[74:75], v22 offset:4352
    ds_read_b64_tr_b16 a[76:77], v22 offset:6144
    ds_read_b64_tr_b16 a[78:79], v22 offset:6400
    ds_read_b64_tr_b16 a[80:81], v22 offset:8192
    ds_read_b64_tr_b16 a[82:83], v22 offset:8448
    ds_read_b64_tr_b16 a[84:85], v22 offset:10240
    ds_read_b64_tr_b16 a[86:87], v22 offset:10496
    ds_read_b64_tr_b16 a[88:89], v22 offset:12288
    ds_read_b64_tr_b16 a[90:91], v22 offset:12544
    ds_read_b64_tr_b16 a[92:93], v22 offset:14336
    ds_read_b64_tr_b16 a[94:95], v22 offset:14592
    ds_read_b64_tr_b16 a[96:97], v22 offset:16384
    ds_read_b64_tr_b16 a[98:99], v22 offset:16640
    ds_read_b64_tr_b16 a[100:101], v22 offset:18432
    ds_read_b64_tr_b16 a[102:103], v22 offset:18688
    ds_read_b64_tr_b16 a[104:105], v22 offset:20480
    ds_read_b64_tr_b16 a[106:107], v22 offset:20736
    ds_read_b64_tr_b16 a[108:109], v22 offset:22528
    ds_read_b64_tr_b16 a[110:111], v22 offset:22784
    ds_read_b64_tr_b16 a[112:113], v22 offset:24576
    ds_read_b64_tr_b16 a[114:115], v22 offset:24832
    ds_read_b64_tr_b16 a[116:117], v22 offset:26624
    ds_read_b64_tr_b16 a[118:119], v22 offset:26880
    ds_read_b64_tr_b16 a[120:121], v22 offset:28672
    ds_read_b64_tr_b16 a[122:123], v22 offset:28928
    ds_read_b64_tr_b16 a[124:125], v22 offset:30720
    ds_read_b64_tr_b16 a[126:127], v22 offset:30976
    ds_read_b64_tr_b16 a[128:129], v22 offset:32768
    ds_read_b64_tr_b16 a[130:131], v22 offset:33024
    ds_read_b64_tr_b16 a[132:133], v22 offset:34816
    ds_read_b64_tr_b16 a[134:135], v22 offset:35072
    ds_read_b64_tr_b16 a[136:137], v23 offset:0
    ds_read_b64_tr_b16 a[138:139], v23 offset:4608
    ds_read_b64_tr_b16 a[140:141], v23 offset:32
    ds_read_b64_tr_b16 a[142:143], v23 offset:4640
    ds_read_b64_tr_b16 a[144:145], v23 offset:64
    ds_read_b64_tr_b16 a[146:147], v23 offset:4672
    ds_read_b64_tr_b16 a[148:149], v23 offset:96
    ds_read_b64_tr_b16 a[150:151], v23 offset:4704
    ds_read_b64_tr_b16 a[152:153], v23 offset:128
    ds_read_b64_tr_b16 a[154:155], v23 offset:4736
    ds_read_b64_tr_b16 a[156:157], v23 offset:160
    ds_read_b64_tr_b16 a[158:159], v23 offset:4768
    ds_read_b64_tr_b16 a[160:161], v23 offset:192
    ds_read_b64_tr_b16 a[162:163], v23 offset:4800
    ds_read_b64_tr_b16 a[164:165], v23 offset:224
    ds_read_b64_tr_b16 a[166:167], v23 offset:4832
    ds_read_b64_tr_b16 a[168:169], v23 offset:256
    ds_read_b64_tr_b16 a[170:171], v23 offset:4864
L2_gather:
    s_mov_b32 s97, 0x20000
L2_p2:
    buffer_load_dwordx2 v[16:17], v14, s[84:87], s15 offen sc1
    s_waitcnt vmcnt(0)
    v_min_u32 v12, v16, v17
    v_cmp_eq_u32 vcc, 0, v12
    s_sub_u32 s97, s97, 1
    s_cselect_b64 vcc, 0, vcc
    s_cmp_eq_u64 vcc, 0
    s_cbranch_scc1 L2_p2_ok
    s_mov_b64 exec, vcc
    s_sleep 1
    s_branch L2_p2
L2_p2_ok:
    s_mov_b64 exec, -1
    s_nop 1
    v_mov_b32_dpp v12, v16 row_ror:1 row_mask:0xf bank_mask:0xf
    v_mov_b32_dpp v13, v17 row_ror:1 row_mask:0xf bank_mask:0xf
    v_max_u32 v17, v17, v13
    v_med3_u32 v17, v16, v12, v17
    v_max_u32 v16, v16, v12
    s_nop 1
    v_mov_b32_dpp v12, v16 row_ror:2 row_mask:0xf bank_mask:0xf
    v_mov_b32_dpp v13, v17 row_ror:2 row_mask:0xf bank_mask:0xf
    v_max_u32 v17, v17, v13
    v_med3_u32 v17, v16, v12, v17
    v_max_u32 v16, v16, v12
    s_nop 1
    v_mov_b32_dpp v12, v16 row_ror:4 row_mask:0xf bank_mask:0xf
    v_mov_b32_dpp v13, v17 row_ror:4 row_mask:0xf bank_mask:0xf
    v_max_u32 v17, v17, v13
    v_med3_u32 v17, v16, v12, v17
    v_max_u32 v16, v16, v12
    s_nop 1
    v_mov_b32_dpp v12, v16 row_ror:8 row_mask:0xf bank_mask:0xf
    v_mov_b32_dpp v13, v17 row_ror:8 row_mask:0xf bank_mask:0xf
    v_max_u32 v17, v17, v13
    v_med3_u32 v17, v16, v12, v17
    v_max_u32 v16, v16, v12
    v_mov_b32 v12, v16
    v_mov_b32 v13, v17
    s_nop 0
    v_permlane16_swap_b32 v12, v16
    v_permlane16_swap_b32 v13, v17
    v_max_u32 v17, v17, v13
    v_med3_u32 v17, v16, v12, v17
    v_max_u32 v16, v16, v12
    v_mov_b32 v12, v16
    v_mov_b32 v13, v17
    s_nop 0
    v_permlane32_swap_b32 v12, v16
    v_permlane32_swap_b32 v13, v17
    v_max_u32 v17, v17, v13
    v_med3_u32 v17, v16, v12, v17
    v_max_u32 v16, v16, v12
    s_lshl_b32 s3, s51, 3
    s_add_u32 s3, s3, 15616
    v_mov_b32 v12, s3
    v_mov_b32 v13, 15616
    ds_write_b64 v12, v[16:17]
    s_waitcnt lgkmcnt(0)
    s_barrier
    ds_read_b128 v[16:19], v13
    ds_read_b128 v[20:23], v13 offset:16
    v_and_b32 v6, 1, v0
    v_lshrrev_b32 v7, 4, v0
    s_waitcnt lgkmcnt(0)
    v_max_u32 v17, v17, v19
    v_med3_u32 v17, v16, v18, v17
    v_max_u32 v16, v16, v18
    v_max_u32 v21, v21, v23
    v_med3_u32 v21, v20, v22, v21
    v_max_u32 v20, v20, v22
    v_max_u32 v17, v17, v21
    v_med3_u32 v17, v16, v20, v17
    v_max_u32 v16, v16, v20
    s_cmp_ge_u32 s2, 144
    s_cbranch_scc1 L2_red
    v_cmp_eq_u32 vcc, 0, v6
    s_nop 1
    v_cndmask_b32 v4, v17, v16, vcc
    v_and_b32 v4, 0x7ff, v4
    v_sub_u32 v4, 2047, v4
    v_mul_u32_u24 v5, 1152, v4
    v_lshl_add_u32 v5, v7, 4, v5
    s_mov_b32 s3, 4194304
    s_mov_b32 exec_lo, 0x30003
    s_mov_b32 exec_hi, 0x30003
    buffer_load_dwordx4 v[128:131], v5, s[84:87], s3 offen offset:0 sc1
    buffer_load_dwordx4 v[132:135], v5, s[84:87], s3 offen offset:64 sc1
    buffer_load_dwordx4 v[136:139], v5, s[84:87], s3 offen offset:128 sc1
    buffer_load_dwordx4 v[140:143], v5, s[84:87], s3 offen offset:192 sc1
    buffer_load_dwordx4 v[144:147], v5, s[84:87], s3 offen offset:256 sc1
    buffer_load_dwordx4 v[148:151], v5, s[84:87], s3 offen offset:320 sc1
    buffer_load_dwordx4 v[152:155], v5, s[84:87], s3 offen offset:384 sc1
    buffer_load_dwordx4 v[156:159], v5, s[84:87], s3 offen offset:448 sc1
    buffer_load_dwordx4 v[160:163], v5, s[84:87], s3 offen offset:512 sc1
    buffer_load_dwordx4 v[164:167], v5, s[84:87], s3 offen offset:576 sc1
    buffer_load_dwordx4 v[168:171], v5, s[84:87], s3 offen offset:640 sc1
    buffer_load_dwordx4 v[172:175], v5, s[84:87], s3 offen offset:704 sc1
    buffer_load_dwordx4 v[176:179], v5, s[84:87], s3 offen offset:768 sc1
    buffer_load_dwordx4 v[180:183], v5, s[84:87], s3 offen offset:832 sc1
    buffer_load_dwordx4 v[184:187], v5, s[84:87], s3 offen offset:896 sc1
    buffer_load_dwordx4 v[188:191], v5, s[84:87], s3 offen offset:960 sc1
    buffer_load_dwordx4 v[192:195], v5, s[84:87], s3 offen offset:1024 sc1
    buffer_load_dwordx4 v[196:199], v5, s[84:87], s3 offen offset:1088 sc1
    s_mov_b64 exec, -1
    v_lshlrev_b32 v11, 7, v6
    v_lshl_add_u32 v13, v7, 5, v11
    v_add_u32 v13, 14848, v13
    v_lshl_add_u32 v11, v7, 4, v11
    s_lshr_b32 s3, s51, 1
    s_lshl_b32 s3, s3, 8
    s_and_b32 s14, s51, 1
    s_lshl_b32 s14, s14, 6
    s_add_u32 s3, s3, s14
    s_add_u32 s3, s3, 14848
    v_add_u32 v11, s3, v11
    s_mul_i32 s14, s51, 1152
    s_add_u32 s3, s14, 110592
    v_mul_u32_u24 v9, 576, v6
    v_lshl_add_u32 v9, v7, 4, v9
    v_add_u32 v9, s3, v9
    v_add_u32 v10, s3, v8
    s_mul_i32 s15, s2, 4608
    s_add_u32 s15, s15, s14
    s_add_u32 s15, s15, 98304
    s_waitcnt vmcnt(17)
    v_mfma_f32_16x16x32_bf16 v[88:91], a[64:67], v[128:131], 0
    s_waitcnt vmcnt(16)
    v_mfma_f32_16x16x32_bf16 v[88:91], a[68:71], v[132:135], v[88:91]
    s_waitcnt vmcnt(15)
    v_mfma_f32_16x16x32_bf16 v[88:91], a[72:75], v[136:139], v[88:91]
    s_waitcnt vmcnt(14)
    v_mfma_f32_16x16x32_bf16 v[88:91], a[76:79], v[140:143], v[88:91]
    s_waitcnt vmcnt(13)
    v_mfma_f32_16x16x32_bf16 v[88:91], a[80:83], v[144:147], v[88:91]
    s_waitcnt vmcnt(12)
    v_mfma_f32_16x16x32_bf16 v[88:91], a[84:87], v[148:151], v[88:91]
    s_waitcnt vmcnt(11)
    v_mfma_f32_16x16x32_bf16 v[88:91], a[88:91], v[152:155], v[88:91]
    s_waitcnt vmcnt(10)
    v_mfma_f32_16x16x32_bf16 v[88:91], a[92:95], v[156:159], v[88:91]
    s_waitcnt vmcnt(9)
    v_mfma_f32_16x16x32_bf16 v[88:91], a[96:99], v[160:163], v[88:91]
    s_waitcnt vmcnt(8)
    v_mfma_f32_16x16x32_bf16 v[88:91], a[100:103], v[164:167], v[88:91]
    s_waitcnt vmcnt(7)
    v_mfma_f32_16x16x32_bf16 v[88:91], a[104:107], v[168:171], v[88:91]
    s_waitcnt vmcnt(6)
    v_mfma_f32_16x16x32_bf16 v[88:91], a[108:111], v[172:175], v[88:91]
    s_waitcnt vmcnt(5)
    v_mfma_f32_16x16x32_bf16 v[88:91], a[112:115], v[176:179], v[88:91]
    s_waitcnt vmcnt(4)
    v_mfma_f32_16x16x32_bf16 v[88:91], a[116:119], v[180:183], v[88:91]
    s_waitcnt vmcnt(3)
    v_mfma_f32_16x16x32_bf16 v[88:91], a[120:123], v[184:187], v[88:91]
    s_waitcnt vmcnt(2)
    v_mfma_f32_16x16x32_bf16 v[88:91], a[124:127], v[188:191], v[88:91]
    s_waitcnt vmcnt(1)
    v_mfma_f32_16x16x32_bf16 v[88:91], a[128:131], v[192:195], v[88:91]
    s_waitcnt vmcnt(0)
    v_mfma_f32_16x16x32_bf16 v[88:91], a[132:135], v[196:199], v[88:91]
    s_nop 5
    s_mov_b32 exec_lo, 0x30003
    s_mov_b32 exec_hi, 0x30003
    ds_write_b128 v11, v[88:91]
    s_mov_b64 exec, -1
    s_waitcnt lgkmcnt(0)
    s_barrier
    ds_read_b128 v[16:19], v13 offset:0
    ds_read_b128 v[20:23], v13 offset:16
    ds_read_b128 v[24:27], v13 offset:256
    ds_read_b128 v[28:31], v13 offset:272
    s_waitcnt lgkmcnt(2)
    v_mul_f32 v32, 0xbfb8aa3b, v16
    v_mul_f32 v33, 0xbfb8aa3b, v17
    v_mul_f32 v34, 0xbfb8aa3b, v18
    v_mul_f32 v35, 0xbfb8aa3b, v19
    v_mul_f32 v36, 0xbfb8aa3b, v20
    v_mul_f32 v37, 0xbfb8aa3b, v21
    v_mul_f32 v38, 0xbfb8aa3b, v22
    v_mul_f32 v39, 0xbfb8aa3b, v23
    v_exp_f32 v32, v32
    v_exp_f32 v33, v33
    v_exp_f32 v34, v34
    v_exp_f32 v35, v35
    v_exp_f32 v36, v36
    v_exp_f32 v37, v37
    v_exp_f32 v38, v38
    v_exp_f32 v39, v39
    v_add_f32 v32, 1.0, v32
    v_add_f32 v33, 1.0, v33
    v_add_f32 v34, 1.0, v34
    v_add_f32 v35, 1.0, v35
    v_add_f32 v36, 1.0, v36
    v_add_f32 v37, 1.0, v37
    v_add_f32 v38, 1.0, v38
    v_add_f32 v39, 1.0, v39
    v_rcp_f32 v32, v32
    v_rcp_f32 v33, v33
    v_rcp_f32 v34, v34
    v_rcp_f32 v35, v35
    v_rcp_f32 v36, v36
    v_rcp_f32 v37, v37
    v_rcp_f32 v38, v38
    v_rcp_f32 v39, v39
    s_waitcnt lgkmcnt(0)
    v_mul_f32 v16, v16, v32
    v_mul_f32 v17, v17, v33
    v_mul_f32 v18, v18, v34
    v_mul_f32 v19, v19, v35
    v_mul_f32 v20, v20, v36
    v_mul_f32 v21, v21, v37
    v_mul_f32 v22, v22, v38
    v_mul_f32 v23, v23, v39
    v_mul_f32 v16, v16, v24
    v_mul_f32 v17, v17, v25
    v_mul_f32 v18, v18, v26
    v_mul_f32 v19, v19, v27
    v_mul_f32 v20, v20, v28
    v_mul_f32 v21, v21, v29
    v_mul_f32 v22, v22, v30
    v_mul_f32 v23, v23, v31
    v_cvt_pk_bf16_f32 v40, v16, v17
    v_cvt_pk_bf16_f32 v41, v18, v19
    v_cvt_pk_bf16_f32 v42, v20, v21
    v_cvt_pk_bf16_f32 v43, v22, v23
    s_nop 1
    v_mfma_f32_16x16x32_bf16 v[48:51], a[136:139], v[40:43], 0
    v_mfma_f32_16x16x32_bf16 v[52:55], a[140:143], v[40:43], 0
    v_mfma_f32_16x16x32_bf16 v[56:59], a[144:147], v[40:43], 0
    v_mfma_f32_16x16x32_bf16 v[60:63], a[148:151], v[40:43], 0
    v_mfma_f32_16x16x32_bf16 v[64:67], a[152:155], v[40:43], 0
    v_mfma_f32_16x16x32_bf16 v[68:71], a[156:159], v[40:43], 0
    v_mfma_f32_16x16x32_bf16 v[72:75], a[160:163], v[40:43], 0
    v_mfma_f32_16x16x32_bf16 v[76:79], a[164:167], v[40:43], 0
    v_mfma_f32_16x16x32_bf16 v[80:83], a[168:171], v[40:43], 0
    s_mov_b32 exec_lo, 0x30003
    s_mov_b32 exec_hi, 0x30003
    ds_write_b128 v9, v[48:51] offset:0
    ds_write_b128 v9, v[52:55] offset:64
    ds_write_b128 v9, v[56:59] offset:128
    ds_write_b128 v9, v[60:63] offset:192
    ds_write_b128 v9, v[64:67] offset:256
    ds_write_b128 v9, v[68:71] offset:320
    ds_write_b128 v9, v[72:75] offset:384
    ds_write_b128 v9, v[76:79] offset:448
    ds_write_b128 v9, v[80:83] offset:512
    s_mov_b64 exec, -1
    ds_read_b128 v[16:19], v10
    ds_read_b128 v[20:23], v10 offset:1024
    s_waitcnt lgkmcnt(0)
    v_min_u32 v16, -2, v16
    v_min_u32 v17, -2, v17
    v_min_u32 v18, -2, v18
    v_min_u32 v19, -2, v19
    v_min_u32 v20, -2, v20
    v_min_u32 v21, -2, v21
    v_min_u32 v22, -2, v22
    v_min_u32 v23, -2, v23
    buffer_store_dwordx4 v[16:19], v8, s[84:87], s15 offen sc1
    s_mov_b64 exec, 0xff
    buffer_store_dwordx4 v[20:23], v8, s[84:87], s15 offen offset:1024 sc1
    s_branch L2_fin
L2_red:
    s_mov_b32 s3, 98304
    s_add_u32 s32, s84, s3
    s_addc_u32 s33, s85, 0
    s_mov_b32 s34, 663552
    s_mov_b32 s35, 0x20000
    s_sub_u32 s3, s2, 144
    s_mul_i32 s14, s3, 7282
    s_lshr_b32 s14, s14, 16
    s_mul_i32 s15, s14, 9
    s_sub_u32 s15, s3, s15
    s_lshl_b32 s15, s15, 5
    s_mul_i32 s14, s14, 144
    v_and_b32 v6, 7, v0
    v_lshl_add_u32 v7, v6, 2, s15
    v_cmp_gt_u32 vcc, 144, v7
    v_subrev_u32 v9, 144, v7
    v_lshrrev_b32 v10, 3, v0
    v_cndmask_b32 v7, v9, v7, vcc
    v_cndmask_b32 v16, v17, v16, vcc
    v_add_u32 v7, s14, v7
    v_and_b32 v9, 0x7ff, v16
    v_sub_u32 v9, 2047, v9
    v_mul_u32_u24 v9, 1152, v9
    v_lshl_add_u32 v9, v7, 1, v9
    v_lshlrev_b32 v7, 2, v7
    buffer_load_dwordx2 v[18:19], v9, s[80:83], 0 offen sc1
    ds_read_b128 v[20:23], v7 offset:6912
    s_lshl_b32 s14, s51, 3
    v_add_u32 v10, s14, v10
    v_mul_u32_u24 v10, 4608, v10
    v_lshl_add_u32 v10, v6, 4, v10
    s_lshl_b32 s3, s3, 7
    v_add_u32 v24, s3, v10
    v_add_u32 v25, 147456, v24
    v_add_u32 v26, 294912, v24
    v_add_u32 v27, 442368, v24
    v_add_u32 v28, 589824, v24
    v_and_b32 v16, 0xfffff800, v16
    v_not_b32 v12, v16
    v_ashrrev_i32 v12, 31, v12
    v_or_b32 v12, 0x80000000, v12
    v_xor_b32 v16, v16, v12
    v_mul_f32 v16, 0xbfb8aa3b, v16
    v_exp_f32 v16, v16
    s_nop 0
    v_add_f32 v16, 1.0, v16
    v_rcp_f32 v16, v16
    s_waitcnt lgkmcnt(0)
    v_mul_f32 v20, v20, v16
    v_mul_f32 v21, v21, v16
    v_mul_f32 v22, v22, v16
    v_mul_f32 v23, v23, v16
    v_lshlrev_b32 v11, 4, v6
    v_add_u32 v11, 15872, v11
    s_lshl_b32 s14, s51, 7
    v_add_u32 v10, s14, v11
    s_mov_b32 s97, 0x20000
L2_p3:
    buffer_load_dwordx4 v[32:35], v24, s[32:35], 0 offen sc1
    buffer_load_dwordx4 v[36:39], v25, s[32:35], 0 offen sc1
    buffer_load_dwordx4 v[40:43], v26, s[32:35], 0 offen sc1
    buffer_load_dwordx4 v[44:47], v27, s[32:35], 0 offen sc1
    buffer_load_dwordx4 v[48:51], v28, s[32:35], 0 offen sc1
    s_waitcnt vmcnt(0)
    v_max3_u32 v12, v32, v33, v34
    v_max3_u32 v12, v12, v35, v36
    v_max3_u32 v12, v12, v37, v38
    v_max3_u32 v12, v12, v39, v40
    v_max3_u32 v12, v12, v41, v42
    v_max3_u32 v12, v12, v43, v44
    v_max3_u32 v12, v12, v45, v46
    v_max3_u32 v12, v12, v47, v48
    v_max3_u32 v12, v12, v49, v50
    v_max_u32 v12, v12, v51
    v_cmp_eq_u32 vcc, -1, v12
    s_sub_u32 s97, s97, 1
    s_cselect_b64 vcc, 0, vcc
    s_cmp_eq_u64 vcc, 0
    s_cbranch_scc1 L2_p3_ok
    s_sleep 1
    s_branch L2_p3
L2_p3_ok:
    v_pk_add_f32 v[32:33], v[32:33], v[36:37]
    v_pk_add_f32 v[40:41], v[40:41], v[44:45]
    v_pk_add_f32 v[32:33], v[32:33], v[48:49]
    v_pk_add_f32 v[32:33], v[32:33], v[40:41]
    v_pk_add_f32 v[34:35], v[34:35], v[38:39]
    v_pk_add_f32 v[42:43], v[42:43], v[46:47]
    v_pk_add_f32 v[34:35], v[34:35], v[50:51]
    v_pk_add_f32 v[34:35], v[34:35], v[42:43]
    s_nop 1
    v_add_f32_dpp v32, v32, v32 row_ror:8 row_mask:0xf bank_mask:0xf
    v_add_f32_dpp v33, v33, v33 row_ror:8 row_mask:0xf bank_mask:0xf
    v_add_f32_dpp v34, v34, v34 row_ror:8 row_mask:0xf bank_mask:0xf
    v_add_f32_dpp v35, v35, v35 row_ror:8 row_mask:0xf bank_mask:0xf
    v_mov_b32 v12, v32
    v_mov_b32 v13, v33
    v_mov_b32 v14, v34
    v_mov_b32 v15, v35
    v_permlane16_swap_b32 v12, v32
    v_permlane16_swap_b32 v13, v33
    v_permlane16_swap_b32 v14, v34
    v_permlane16_swap_b32 v15, v35
    v_add_f32 v32, v32, v12
    v_add_f32 v33, v33, v13
    v_add_f32 v34, v34, v14
    v_add_f32 v35, v35, v15
    v_mov_b32 v12, v32
    v_mov_b32 v13, v33
    v_mov_b32 v14, v34
    v_mov_b32 v15, v35
    v_permlane32_swap_b32 v12, v32
    v_permlane32_swap_b32 v13, v33
    v_permlane32_swap_b32 v14, v34
    v_permlane32_swap_b32 v15, v35
    v_add_f32 v32, v32, v12
    v_add_f32 v33, v33, v13
    v_add_f32 v34, v34, v14
    v_add_f32 v35, v35, v15
    ds_write_b128 v10, v[32:35]
    s_waitcnt lgkmcnt(0)
    s_barrier
    ds_read_b128 v[32:35], v11 offset:0
    ds_read_b128 v[36:39], v11 offset:128
    ds_read_b128 v[40:43], v11 offset:256
    ds_read_b128 v[44:47], v11 offset:384
    v_lshlrev_b32 v12, 16, v18
    v_and_b32 v13, 0xffff0000, v18
    v_lshlrev_b32 v14, 16, v19
    v_and_b32 v15, 0xffff0000, v19
    s_waitcnt lgkmcnt(0)
    v_pk_add_f32 v[32:33], v[32:33], v[36:37]
    v_pk_add_f32 v[40:41], v[40:41], v[44:45]
    v_pk_add_f32 v[32:33], v[32:33], v[40:41]
    v_pk_fma_f32 v[12:13], v[32:33], v[20:21], v[12:13]
    v_pk_add_f32 v[34:35], v[34:35], v[38:39]
    v_pk_add_f32 v[42:43], v[42:43], v[46:47]
    v_pk_add_f32 v[34:35], v[34:35], v[42:43]
    v_pk_fma_f32 v[14:15], v[34:35], v[22:23], v[14:15]
    v_cvt_pk_bf16_f32 v12, v12, v13
    v_cvt_pk_bf16_f32 v13, v14, v15
    s_cmp_lg_u32 s51, 0
    s_cbranch_scc1 L2_fin
    s_mov_b64 exec, 0xff
    buffer_store_dwordx2 v[12:13], v9, s[80:83], 0 offen sc1
L2_fin:
L2_end:
    s_endpgm
L2_p0s:
    s_mov_b32 s97, 0x20000
L2_p0:
    buffer_load_dword v51, v156, s[60:63], 0 offen sc1
    s_waitcnt vmcnt(0)
    v_cmp_eq_u32 vcc, 0, v51
    s_sub_u32 s97, s97, 1
    s_cselect_b64 vcc, 0, vcc
    s_cmp_eq_u64 vcc, 0
    s_cbranch_scc1 L2_p0_ok
    s_sleep 1
    s_branch L2_p0
L2_p0_ok:
    s_branch L2_p0r
L2_pms:
    s_mov_b32 s97, 0x20000
L2_pm:
    buffer_load_dwordx4 v[168:171], v166, s[84:87], 0 offen sc1
    buffer_load_dwordx4 v[176:179], v166, s[84:87], s14 offen sc1
    s_mov_b64 exec, 0xff
    buffer_load_dwordx4 v[172:175], v166, s[84:87], 0 offen offset:1024 sc1
    buffer_load_dwordx4 v[180:183], v166, s[84:87], s14 offen offset:1024 sc1
    s_mov_b64 exec, -1
    s_waitcnt vmcnt(0)
    v_max_u32 v13, v168, v169
    v_max3_u32 v13, v13, v170, v171
    v_max3_u32 v13, v13, v172, v173
    v_max3_u32 v13, v13, v174, v175
    v_max3_u32 v13, v13, v176, v177
    v_max3_u32 v13, v13, v178, v179
    v_max3_u32 v13, v13, v180, v181
    v_max3_u32 v13, v13, v182, v183
    v_cmp_eq_u32 vcc, -1, v13
    s_sub_u32 s97, s97, 1
    s_cselect_b64 vcc, 0, vcc
    s_cmp_eq_u64 vcc, 0
    s_cbranch_scc1 L2_pm_ok
    s_sleep 1
    s_branch L2_pm
L2_pm_ok:
    s_branch L2_pmr
L2_pns:
    s_mov_b32 s97, 0x20000
L2_pn:
    s_movk_i32 s45, 4608
    buffer_load_dwordx4 v[76:79], v5, s[84:87], s45 offen offset:0 sc1
    s_movk_i32 s45, 18432
    buffer_load_dwordx4 v[88:91], v5, s[84:87], s45 offen offset:0 sc1
    s_movk_i32 s45, 4608
    buffer_load_dwordx4 v[80:83], v5, s[84:87], s45 offen offset:1024 sc1
    s_movk_i32 s45, 18432
    buffer_load_dwordx4 v[92:95], v5, s[84:87], s45 offen offset:1024 sc1
    s_movk_i32 s45, 4608
    buffer_load_dwordx4 v[84:87], v14, s[84:87], s45 offen offset:2048 sc1
    s_movk_i32 s45, 18432
    buffer_load_dwordx4 v[96:99], v14, s[84:87], s45 offen offset:2048 sc1
    s_waitcnt vmcnt(0)
    v_max_u32 v13, v76, v77
    v_max3_u32 v13, v13, v78, v79
    v_max3_u32 v13, v13, v80, v81
    v_max3_u32 v13, v13, v82, v83
    v_max3_u32 v13, v13, v84, v85
    v_max3_u32 v13, v13, v86, v87
    v_max3_u32 v13, v13, v88, v89
    v_max3_u32 v13, v13, v90, v91
    v_max3_u32 v13, v13, v92, v93
    v_max3_u32 v13, v13, v94, v95
    v_max3_u32 v13, v13, v96, v97
    v_max3_u32 v13, v13, v98, v99
    v_cmp_eq_u32 vcc, -1, v13
    s_sub_u32 s97, s97, 1
    s_cselect_b64 vcc, 0, vcc
    s_cmp_eq_u64 vcc, 0
    s_cbranch_scc1 L2_pn_ok
    s_sleep 1
    s_branch L2_pn
L2_pn_ok:
    s_branch L2_pnr
L2_g0s:
    s_mov_b32 s97, 0x20000
L2_g0:
    buffer_load_dword v9, v6, s[84:87], s47 offen sc1
    s_waitcnt vmcnt(0)
    v_cmp_ne_u32 vcc, 0, v9
    s_nop 0
    s_lshr_b32 s3, vcc_lo, 1
    s_and_b32 s3, s3, vcc_lo
    s_lshr_b32 s14, s3, 2
    s_and_b32 s3, s3, s14
    s_and_b32 s3, s3, s48
    s_cselect_b64 vcc, 0, -1
    s_sub_u32 s97, s97, 1
    s_cselect_b64 vcc, 0, vcc
    s_cmp_eq_u64 vcc, 0
    s_cbranch_scc1 L2_g0_ok
    s_sleep 1
    s_branch L2_g0
L2_g0_ok:
    s_cmp_eq_u32 s3, 0
    s_cselect_b32 s3, s48, s3
    s_branch L2_g0r
L2_g1s:
    s_mov_b32 s97, 0x20000
L2_g1:
    buffer_load_dword v9, v6, s[84:87], s47 offen sc1
    s_waitcnt vmcnt(0)
    v_cmp_ne_u32 vcc, 0, v9
    s_nop 0
    s_lshr_b32 s3, vcc_lo, 1
    s_and_b32 s3, s3, vcc_lo
    s_lshr_b32 s14, s3, 2
    s_and_b32 s3, s3, s14
    s_and_b32 s3, s3, s48
    s_cselect_b64 vcc, 0, -1
    s_sub_u32 s97, s97, 1
    s_cselect_b64 vcc, 0, vcc
    s_cmp_eq_u64 vcc, 0
    s_cbranch_scc1 L2_g1_ok
    s_sleep 1
    s_branch L2_g1
L2_g1_ok:
    s_cmp_eq_u32 s3, 0
    s_cselect_b32 s3, s48, s3
    s_branch L2_g1r
L2_g2s:
    s_mov_b32 s97, 0x20000
L2_g2:
    buffer_load_dword v9, v6, s[84:87], s47 offen sc1
    s_waitcnt vmcnt(0)
    v_cmp_ne_u32 vcc, 0, v9
    s_nop 0
    s_lshr_b32 s3, vcc_lo, 1
    s_and_b32 s3, s3, vcc_lo
    s_lshr_b32 s14, s3, 2
    s_and_b32 s3, s3, s14
    s_and_b32 s3, s3, s48
    s_cselect_b64 vcc, 0, -1
    s_sub_u32 s97, s97, 1
    s_cselect_b64 vcc, 0, vcc
    s_cmp_eq_u64 vcc, 0
    s_cbranch_scc1 L2_g2_ok
    s_sleep 1
    s_branch L2_g2
L2_g2_ok:
    s_cmp_eq_u32 s3, 0
    s_cselect_b32 s3, s48, s3
    s_branch L2_g2r
L2_g3s:
    s_mov_b32 s97, 0x20000
L2_g3:
    buffer_load_dword v9, v6, s[84:87], s47 offen sc1
    s_waitcnt vmcnt(0)
    v_cmp_ne_u32 vcc, 0, v9
    s_nop 0
    s_lshr_b32 s3, vcc_lo, 1
    s_and_b32 s3, s3, vcc_lo
    s_lshr_b32 s14, s3, 2
    s_and_b32 s3, s3, s14
    s_and_b32 s3, s3, s48
    s_cselect_b64 vcc, 0, -1
    s_sub_u32 s97, s97, 1
    s_cselect_b64 vcc, 0, vcc
    s_cmp_eq_u64 vcc, 0
    s_cbranch_scc1 L2_g3_ok
    s_sleep 1
    s_branch L2_g3
L2_g3_ok:
    s_cmp_eq_u32 s3, 0
    s_cselect_b32 s3, s48, s3
    s_branch L2_g3r
L2_fallback:
    s_waitcnt vmcnt(0) lgkmcnt(0)
    s_nop 7
    s_barrier
    s_lshl_b32 s3, s51, 12
    v_add_u32 v5, s3, v8
    v_lshrrev_b32 v14, 2, v0
    v_mul_u32_u24 v14, 1056, v14
    v_and_b32 v15, 3, v0
    v_lshl_add_u32 v14, v15, 3, v14
    v_add_u32 v2, 107008, v14
    v_and_b32 v14, 15, v0
    v_mul_u32_u24 v14, 1056, v14
    v_lshrrev_b32 v15, 4, v0
    v_lshl_add_u32 v14, v15, 4, v14
    v_add_u32 v1, 90112, v14
    v_mov_b32 v32, 0xff800000
    v_mov_b32 v33, 0xff800000
    v_mov_b32 v34, 0xff800000
    v_mov_b32 v35, 0xff800000
    s_mov_b32 s50, 1
    s_mov_b32 s46, 0
L2_fb_loop:
    s_add_u32 m0, s44, 73728
    s_nop 0
    buffer_load_dwordx4 v5, s[16:19], s46 offen offset:0 lds
    s_add_u32 m0, s44, 73760
    s_nop 0
    buffer_load_dwordx4 v5, s[16:19], s46 offen offset:1024 lds
    s_add_u32 m0, s44, 73792
    s_nop 0
    buffer_load_dwordx4 v5, s[16:19], s46 offen offset:2048 lds
    s_add_u32 m0, s44, 73824
    s_nop 0
    buffer_load_dwordx4 v5, s[16:19], s46 offen offset:3072 lds
    s_waitcnt vmcnt(0) lgkmcnt(0)
    s_barrier
    ds_read_b128 a[64:67], v1 offset:0
    ds_read_b128 a[68:71], v1 offset:64
    ds_read_b128 a[72:75], v1 offset:128
    ds_read_b128 a[76:79], v1 offset:192
    ds_read_b128 a[80:83], v1 offset:256
    ds_read_b128 a[84:87], v1 offset:320
    ds_read_b128 a[88:91], v1 offset:384
    ds_read_b128 a[92:95], v1 offset:448
    ds_read_b128 a[96:99], v1 offset:512
    ds_read_b128 a[100:103], v1 offset:576
    ds_read_b128 a[104:107], v1 offset:640
    ds_read_b128 a[108:111], v1 offset:704
    ds_read_b128 a[112:115], v1 offset:768
    ds_read_b128 a[116:119], v1 offset:832
    ds_read_b128 a[120:123], v1 offset:896
    ds_read_b128 a[124:127], v1 offset:960
    s_waitcnt vmcnt(0) lgkmcnt(0)
    s_barrier
    v_mfma_f32_16x16x32_bf16 v[16:19], a[64:67], v[64:67], 0
    v_mfma_f32_16x16x32_bf16 v[16:19], a[68:71], v[68:71], v[16:19]
    v_mfma_f32_16x16x32_bf16 v[16:19], a[72:75], v[72:75], v[16:19]
    v_mfma_f32_16x16x32_bf16 v[16:19], a[76:79], v[76:79], v[16:19]
    v_mfma_f32_16x16x32_bf16 v[20:23], a[80:83], v[64:67], 0
    v_mfma_f32_16x16x32_bf16 v[20:23], a[84:87], v[68:71], v[20:23]
    v_mfma_f32_16x16x32_bf16 v[20:23], a[88:91], v[72:75], v[20:23]
    v_mfma_f32_16x16x32_bf16 v[20:23], a[92:95], v[76:79], v[20:23]
    v_mfma_f32_16x16x32_bf16 v[24:27], a[96:99], v[64:67], 0
    v_mfma_f32_16x16x32_bf16 v[24:27], a[100:103], v[68:71], v[24:27]
    v_mfma_f32_16x16x32_bf16 v[24:27], a[104:107], v[72:75], v[24:27]
    v_mfma_f32_16x16x32_bf16 v[24:27], a[108:111], v[76:79], v[24:27]
    v_mfma_f32_16x16x32_bf16 v[28:31], a[112:115], v[64:67], 0
    v_mfma_f32_16x16x32_bf16 v[28:31], a[116:119], v[68:71], v[28:31]
    v_mfma_f32_16x16x32_bf16 v[28:31], a[120:123], v[72:75], v[28:31]
    v_mfma_f32_16x16x32_bf16 v[28:31], a[124:127], v[76:79], v[28:31]
    s_nop 7
    v_max3_f32 v32, v32, v16, v17
    v_max3_f32 v32, v32, v18, v19
    v_max3_f32 v32, v32, v20, v21
    v_max3_f32 v32, v32, v22, v23
    v_max3_f32 v32, v32, v24, v25
    v_max3_f32 v32, v32, v26, v27
    v_max3_f32 v32, v32, v28, v29
    v_max3_f32 v32, v32, v30, v31
    v_mfma_f32_16x16x32_bf16 v[16:19], a[64:67], v[80:83], 0
    v_mfma_f32_16x16x32_bf16 v[16:19], a[68:71], v[84:87], v[16:19]
    v_mfma_f32_16x16x32_bf16 v[16:19], a[72:75], v[88:91], v[16:19]
    v_mfma_f32_16x16x32_bf16 v[16:19], a[76:79], v[92:95], v[16:19]
    v_mfma_f32_16x16x32_bf16 v[20:23], a[80:83], v[80:83], 0
    v_mfma_f32_16x16x32_bf16 v[20:23], a[84:87], v[84:87], v[20:23]
    v_mfma_f32_16x16x32_bf16 v[20:23], a[88:91], v[88:91], v[20:23]
    v_mfma_f32_16x16x32_bf16 v[20:23], a[92:95], v[92:95], v[20:23]
    v_mfma_f32_16x16x32_bf16 v[24:27], a[96:99], v[80:83], 0
    v_mfma_f32_16x16x32_bf16 v[24:27], a[100:103], v[84:87], v[24:27]
    v_mfma_f32_16x16x32_bf16 v[24:27], a[104:107], v[88:91], v[24:27]
    v_mfma_f32_16x16x32_bf16 v[24:27], a[108:111], v[92:95], v[24:27]
    v_mfma_f32_16x16x32_bf16 v[28:31], a[112:115], v[80:83], 0
    v_mfma_f32_16x16x32_bf16 v[28:31], a[116:119], v[84:87], v[28:31]
    v_mfma_f32_16x16x32_bf16 v[28:31], a[120:123], v[88:91], v[28:31]
    v_mfma_f32_16x16x32_bf16 v[28:31], a[124:127], v[92:95], v[28:31]
    s_nop 7
    v_max3_f32 v33, v33, v16, v17
    v_max3_f32 v33, v33, v18, v19
    v_max3_f32 v33, v33, v20, v21
    v_max3_f32 v33, v33, v22, v23
    v_max3_f32 v33, v33, v24, v25
    v_max3_f32 v33, v33, v26, v27
    v_max3_f32 v33, v33, v28, v29
    v_max3_f32 v33, v33, v30, v31
    v_mfma_f32_16x16x32_bf16 v[16:19], a[64:67], v[96:99], 0
    v_mfma_f32_16x16x32_bf16 v[16:19], a[68:71], v[100:103], v[16:19]
    v_mfma_f32_16x16x32_bf16 v[16:19], a[72:75], v[104:107], v[16:19]
    v_mfma_f32_16x16x32_bf16 v[16:19], a[76:79], v[108:111], v[16:19]
    v_mfma_f32_16x16x32_bf16 v[20:23], a[80:83], v[96:99], 0
    v_mfma_f32_16x16x32_bf16 v[20:23], a[84:87], v[100:103], v[20:23]
    v_mfma_f32_16x16x32_bf16 v[20:23], a[88:91], v[104:107], v[20:23]
    v_mfma_f32_16x16x32_bf16 v[20:23], a[92:95], v[108:111], v[20:23]
    v_mfma_f32_16x16x32_bf16 v[24:27], a[96:99], v[96:99], 0
    v_mfma_f32_16x16x32_bf16 v[24:27], a[100:103], v[100:103], v[24:27]
    v_mfma_f32_16x16x32_bf16 v[24:27], a[104:107], v[104:107], v[24:27]
    v_mfma_f32_16x16x32_bf16 v[24:27], a[108:111], v[108:111], v[24:27]
    v_mfma_f32_16x16x32_bf16 v[28:31], a[112:115], v[96:99], 0
    v_mfma_f32_16x16x32_bf16 v[28:31], a[116:119], v[100:103], v[28:31]
    v_mfma_f32_16x16x32_bf16 v[28:31], a[120:123], v[104:107], v[28:31]
    v_mfma_f32_16x16x32_bf16 v[28:31], a[124:127], v[108:111], v[28:31]
    s_nop 7
    v_max3_f32 v34, v34, v16, v17
    v_max3_f32 v34, v34, v18, v19
    v_max3_f32 v34, v34, v20, v21
    v_max3_f32 v34, v34, v22, v23
    v_max3_f32 v34, v34, v24, v25
    v_max3_f32 v34, v34, v26, v27
    v_max3_f32 v34, v34, v28, v29
    v_max3_f32 v34, v34, v30, v31
    v_mfma_f32_16x16x32_bf16 v[16:19], a[64:67], v[112:115], 0
    v_mfma_f32_16x16x32_bf16 v[16:19], a[68:71], v[116:119], v[16:19]
    v_mfma_f32_16x16x32_bf16 v[16:19], a[72:75], v[120:123], v[16:19]
    v_mfma_f32_16x16x32_bf16 v[16:19], a[76:79], v[124:127], v[16:19]
    v_mfma_f32_16x16x32_bf16 v[20:23], a[80:83], v[112:115], 0
    v_mfma_f32_16x16x32_bf16 v[20:23], a[84:87], v[116:119], v[20:23]
    v_mfma_f32_16x16x32_bf16 v[20:23], a[88:91], v[120:123], v[20:23]
    v_mfma_f32_16x16x32_bf16 v[20:23], a[92:95], v[124:127], v[20:23]
    v_mfma_f32_16x16x32_bf16 v[24:27], a[96:99], v[112:115], 0
    v_mfma_f32_16x16x32_bf16 v[24:27], a[100:103], v[116:119], v[24:27]
    v_mfma_f32_16x16x32_bf16 v[24:27], a[104:107], v[120:123], v[24:27]
    v_mfma_f32_16x16x32_bf16 v[24:27], a[108:111], v[124:127], v[24:27]
    v_mfma_f32_16x16x32_bf16 v[28:31], a[112:115], v[112:115], 0
    v_mfma_f32_16x16x32_bf16 v[28:31], a[116:119], v[116:119], v[28:31]
    v_mfma_f32_16x16x32_bf16 v[28:31], a[120:123], v[120:123], v[28:31]
    v_mfma_f32_16x16x32_bf16 v[28:31], a[124:127], v[124:127], v[28:31]
    s_nop 7
    v_max3_f32 v35, v35, v16, v17
    v_max3_f32 v35, v35, v18, v19
    v_max3_f32 v35, v35, v20, v21
    v_max3_f32 v35, v35, v22, v23
    v_max3_f32 v35, v35, v24, v25
    v_max3_f32 v35, v35, v26, v27
    v_max3_f32 v35, v35, v28, v29
    v_max3_f32 v35, v35, v30, v31
    s_add_u32 s46, s46, 16384
    s_cmp_lt_u32 s46, 524288
    s_cbranch_scc1 L2_fb_loop
    v_mov_b32 v12, v32
    v_mov_b32 v13, v33
    v_mov_b32 v14, v34
    v_mov_b32 v15, v35
    v_permlane16_swap_b32 v12, v32
    v_permlane16_swap_b32 v13, v33
    v_permlane16_swap_b32 v14, v34
    v_permlane16_swap_b32 v15, v35
    v_max_f32 v32, v32, v12
    v_max_f32 v33, v33, v13
    v_max_f32 v34, v34, v14
    v_max_f32 v35, v35, v15
    v_mov_b32 v12, v32
    v_mov_b32 v13, v33
    v_mov_b32 v14, v34
    v_mov_b32 v15, v35
    v_permlane32_swap_b32 v12, v32
    v_permlane32_swap_b32 v13, v33
    v_permlane32_swap_b32 v14, v34
    v_permlane32_swap_b32 v15, v35
    v_max_f32 v32, v32, v12
    v_max_f32 v33, v33, v13
    v_max_f32 v34, v34, v14
    v_max_f32 v35, v35, v15
    v_sub_f32 v48, 0x80000000, v32
    v_sub_f32 v49, 0x80000000, v32
    v_sub_f32 v50, 0x80000000, v32
    v_sub_f32 v51, 0x80000000, v32
    v_sub_f32 v52, 0x80000000, v33
    v_sub_f32 v53, 0x80000000, v33
    v_sub_f32 v54, 0x80000000, v33
    v_sub_f32 v55, 0x80000000, v33
    v_sub_f32 v56, 0x80000000, v34
    v_sub_f32 v57, 0x80000000, v34
    v_sub_f32 v58, 0x80000000, v34
    v_sub_f32 v59, 0x80000000, v34
    v_sub_f32 v60, 0x80000000, v35
    v_sub_f32 v61, 0x80000000, v35
    v_sub_f32 v62, 0x80000000, v35
    v_sub_f32 v63, 0x80000000, v35
    s_add_u32 m0, s44, 73728
    s_mov_b32 s46, 0
    buffer_load_dwordx4 v5, s[16:19], s46 offen offset:0 lds
    s_add_u32 m0, s44, 73760
    s_nop 0
    buffer_load_dwordx4 v5, s[16:19], s46 offen offset:1024 lds
    s_add_u32 m0, s44, 73792
    s_nop 0
    buffer_load_dwordx4 v5, s[16:19], s46 offen offset:2048 lds
    s_add_u32 m0, s44, 73824
    s_nop 0
    buffer_load_dwordx4 v5, s[16:19], s46 offen offset:3072 lds
    s_add_u32 m0, s44, 90624
    s_nop 0
    buffer_load_dwordx4 v5, s[20:23], s46 offen offset:0 lds
    s_add_u32 m0, s44, 90656
    s_nop 0
    buffer_load_dwordx4 v5, s[20:23], s46 offen offset:1024 lds
    s_add_u32 m0, s44, 90688
    s_nop 0
    buffer_load_dwordx4 v5, s[20:23], s46 offen offset:2048 lds
    s_add_u32 m0, s44, 90720
    s_nop 0
    buffer_load_dwordx4 v5, s[20:23], s46 offen offset:3072 lds
    s_add_u32 m0, s44, 110592
    s_mov_b32 s46, 16384
    buffer_load_dwordx4 v5, s[16:19], s46 offen offset:0 lds
    s_add_u32 m0, s44, 110624
    s_nop 0
    buffer_load_dwordx4 v5, s[16:19], s46 offen offset:1024 lds
    s_add_u32 m0, s44, 110656
    s_nop 0
    buffer_load_dwordx4 v5, s[16:19], s46 offen offset:2048 lds
    s_add_u32 m0, s44, 110688
    s_nop 0
    buffer_load_dwordx4 v5, s[16:19], s46 offen offset:3072 lds
    s_add_u32 m0, s44, 127488
    s_nop 0
    buffer_load_dwordx4 v5, s[20:23], s46 offen offset:0 lds
    s_add_u32 m0, s44, 127520
    s_nop 0
    buffer_load_dwordx4 v5, s[20:23], s46 offen offset:1024 lds
    s_add_u32 m0, s44, 127552
    s_nop 0
    buffer_load_dwordx4 v5, s[20:23], s46 offen offset:2048 lds
    s_add_u32 m0, s44, 127584
    s_nop 0
    buffer_load_dwordx4 v5, s[20:23], s46 offen offset:3072 lds
    s_add_u32 m0, s44, 0
    s_mov_b32 s46, 32768
    buffer_load_dwordx4 v5, s[16:19], s46 offen offset:0 lds
    s_add_u32 m0, s44, 32
    s_nop 0
    buffer_load_dwordx4 v5, s[16:19], s46 offen offset:1024 lds
    s_add_u32 m0, s44, 64
    s_nop 0
    buffer_load_dwordx4 v5, s[16:19], s46 offen offset:2048 lds
    s_add_u32 m0, s44, 96
    s_nop 0
    buffer_load_dwordx4 v5, s[16:19], s46 offen offset:3072 lds
    s_add_u32 m0, s44, 16896
    s_nop 0
    buffer_load_dwordx4 v5, s[20:23], s46 offen offset:0 lds
    s_add_u32 m0, s44, 16928
    s_nop 0
    buffer_load_dwordx4 v5, s[20:23], s46 offen offset:1024 lds
    s_add_u32 m0, s44, 16960
    s_nop 0
    buffer_load_dwordx4 v5, s[20:23], s46 offen offset:2048 lds
    s_add_u32 m0, s44, 16992
    s_nop 0
    buffer_load_dwordx4 v5, s[20:23], s46 offen offset:3072 lds
    s_waitcnt vmcnt(0) lgkmcnt(0)
    s_barrier
    ds_read_b128 a[64:67], v1 offset:0
    ds_read_b128 a[68:71], v1 offset:64
    ds_read_b128 a[72:75], v1 offset:128
    ds_read_b128 a[76:79], v1 offset:192
    ds_read_b128 a[80:83], v1 offset:256
    ds_read_b128 a[84:87], v1 offset:320
    ds_read_b128 a[88:91], v1 offset:384
    ds_read_b128 a[92:95], v1 offset:448
    ds_read_b128 a[96:99], v1 offset:512
    ds_read_b128 a[100:103], v1 offset:576
    ds_read_b128 a[104:107], v1 offset:640
    ds_read_b128 a[108:111], v1 offset:704
    ds_read_b128 a[112:115], v1 offset:768
    ds_read_b128 a[116:119], v1 offset:832
    ds_read_b128 a[120:123], v1 offset:896
    ds_read_b128 a[124:127], v1 offset:960
    ds_read_b64_tr_b16 a[128:129], v2 offset:0
    ds_read_b64_tr_b16 a[130:131], v2 offset:256
    ds_read_b64_tr_b16 a[132:133], v2 offset:512
    ds_read_b64_tr_b16 a[134:135], v2 offset:768
    ds_read_b64_tr_b16 a[136:137], v2 offset:32
    ds_read_b64_tr_b16 a[138:139], v2 offset:288
    ds_read_b64_tr_b16 a[140:141], v2 offset:544
    ds_read_b64_tr_b16 a[142:143], v2 offset:800
    ds_read_b64_tr_b16 a[144:145], v2 offset:64
    ds_read_b64_tr_b16 a[146:147], v2 offset:320
    ds_read_b64_tr_b16 a[148:149], v2 offset:576
    ds_read_b64_tr_b16 a[150:151], v2 offset:832
    ds_read_b64_tr_b16 a[152:153], v2 offset:96
    ds_read_b64_tr_b16 a[154:155], v2 offset:352
    ds_read_b64_tr_b16 a[156:157], v2 offset:608
    ds_read_b64_tr_b16 a[158:159], v2 offset:864
    ds_read_b64_tr_b16 a[160:161], v2 offset:128
    ds_read_b64_tr_b16 a[162:163], v2 offset:384
    ds_read_b64_tr_b16 a[164:165], v2 offset:640
    ds_read_b64_tr_b16 a[166:167], v2 offset:896
    ds_read_b64_tr_b16 a[168:169], v2 offset:160
    ds_read_b64_tr_b16 a[170:171], v2 offset:416
    ds_read_b64_tr_b16 a[172:173], v2 offset:672
    ds_read_b64_tr_b16 a[174:175], v2 offset:928
    ds_read_b64_tr_b16 a[176:177], v2 offset:192
    ds_read_b64_tr_b16 a[178:179], v2 offset:448
    ds_read_b64_tr_b16 a[180:181], v2 offset:704
    ds_read_b64_tr_b16 a[182:183], v2 offset:960
    ds_read_b64_tr_b16 a[184:185], v2 offset:224
    ds_read_b64_tr_b16 a[186:187], v2 offset:480
    ds_read_b64_tr_b16 a[188:189], v2 offset:736
    ds_read_b64_tr_b16 a[190:191], v2 offset:992
    s_waitcnt vmcnt(0) lgkmcnt(0)
    s_branch L2_entry
L2_codeend:

.section .rodata,"a"
.p2align 6
.amdhsa_kernel adaLN_cond__gqa_block_cached__moe_arch_mod__prompt_kernel
  .amdhsa_next_free_vgpr 512
  .amdhsa_next_free_sgpr 102
  .amdhsa_accum_offset 256
  .amdhsa_group_segment_fixed_size 0
  .amdhsa_kernarg_size 120
  .amdhsa_user_sgpr_count 2
  .amdhsa_user_sgpr_kernarg_segment_ptr 1
  .amdhsa_system_sgpr_workgroup_id_x 1
  .amdhsa_float_denorm_mode_32 3
.end_amdhsa_kernel
```

```asm
; @launch grid=(256,1,1) block=(256,1,1) lds=163840
.amdgcn_target "amdgcn-amd-amdhsa--gfx950"
.text
.globl adaLN_cond__gqa_block_cached__moe_arch_mod__prompt_kernel
.p2align 8
.type adaLN_cond__gqa_block_cached__moe_arch_mod__prompt_kernel,@function
adaLN_cond__gqa_block_cached__moe_arch_mod__prompt_kernel:
L2_begin:
    s_getpc_b64 s[98:99]
    s_cmp_ge_u32 s2, 256
    s_cbranch_scc1 L2_end
    s_load_dwordx2 s[76:77], s[0:1], 0
    s_load_dwordx2 s[16:17], s[0:1], 80
    s_load_dwordx2 s[88:89], s[0:1], 88
    s_load_dwordx2 s[12:13], s[0:1], 112
    s_load_dwordx2 s[60:61], s[0:1], 104
    s_and_b32 s3, s2, 7
    s_lshr_b32 s14, s2, 3
    v_mov_b32 v155, v0
    v_lshrrev_b32 v10, 6, v0
    v_and_b32 v0, 63, v0
    s_lshl_b32 s15, s14, 9
    v_lshl_add_u32 v13, v10, 7, s15
    v_lshl_add_u32 v13, v0, 14, v13
    v_min_u32 v13, L2_codeend-L2_begin-8, v13
    s_mov_b64 exec, 31
    global_load_dword a63, v13, s[98:99]
    s_mov_b64 exec, -1
    v_readfirstlane_b32 s51, v10
    s_and_b32 s52, s3, 3
    s_and_b32 s15, s14, 3
    s_lshl2_add_u32 s52, s52, s15
    s_lshr_b32 s53, s3, 2
    s_lshr_b32 s15, s14, 2
    s_lshl3_add_u32 s53, s53, s15
    s_lshl4_add_u32 s96, s53, s52
    s_mul_i32 s49, s3, 27
    s_max_u32 s14, s14, 5
    s_add_u32 s49, s49, s14
    s_sub_u32 s49, s49, 5
    s_lshr_b32 s55, s3, 2
    s_mul_i32 s15, s55, 108
    s_sub_u32 s50, s49, s15
    s_mul_i32 s3, s51, 288
    v_lshrrev_b32 v14, 3, v0
    v_lshl_add_u32 v12, v14, 4, s3
    v_and_b32 v14, 1, v14
    v_lshl_add_u32 v13, v14, 4, s3
    v_and_b32 v14, 7, v0
    v_mul_u32_u24 v14, 1152, v14
    v_add_u32 v1, v14, v12
    v_add_u32 v2, v14, v13
    v_add_u32 v2, 256, v2
    v_and_b32 v4, 0xfc, v155
    v_and_b32 v7, 3, v0
    v_mul_u32_u24 v3, 6912, v4
    v_lshl_add_u32 v153, v7, 4, v3
    s_mul_i32 s3, s96, 9216
    s_movk_i32 s78, 9216
    s_mov_b32 s79, 0x20000
    s_mov_b32 s91, s79
    v_lshlrev_b32 v8, 4, v0
    s_mov_b32 s86, 6553600
    s_mov_b32 s87, s79
    s_movk_i32 s62, 256
    s_mov_b32 s63, s79
    s_lshl_b32 s14, s50, 6
    s_sub_u32 s90, 1990656, s14
    s_cmp_ge_u32 s2, 40
    s_cselect_b32 s90, s90, 0
    s_mul_i32 s15, s55, 1990656
    s_add_u32 s14, s14, s15
    s_waitcnt lgkmcnt(0)
    s_add_u32 s76, s76, s3
    s_addc_u32 s77, s77, 0
    buffer_load_dwordx4 v[64:67], v1, s[76:79], 0 offen offset:0
    buffer_load_dwordx4 v[68:71], v1, s[76:79], 0 offen offset:128
    buffer_load_dwordx4 v[72:75], v2, s[76:79], 0 offen offset:0
    s_add_u32 s88, s88, s14
    s_addc_u32 s89, s89, 0
    s_mov_b64 s[84:85], s[12:13]
    s_cmp_ge_u32 s2, 8
    s_cbranch_scc1 L2_noclr
    s_cmp_lt_u32 s2, 4
    s_cselect_b32 s3, -1, 0
    v_mov_b32 v52, s3
    v_mov_b32 v53, s3
    v_mov_b32 v54, s3
    v_mov_b32 v55, s3
    s_lshl2_add_u32 s3, s2, s51
    s_mul_i32 s3, s3, 2048
    buffer_store_dwordx4 v[52:55], v8, s[84:87], s3 offen offset:0 sc1
    buffer_store_dwordx4 v[52:55], v8, s[84:87], s3 offen offset:1024 sc1
L2_noclr:
    buffer_load_dwordx4 v[128:131], v153, s[88:91], 0 offen
    s_movk_i32 s3, 6912
    buffer_load_dwordx4 v[132:135], v153, s[88:91], s3 offen
    s_movk_i32 s3, 13824
    buffer_load_dwordx4 v[136:139], v153, s[88:91], s3 offen
    s_movk_i32 s3, 20736
    buffer_load_dwordx4 v[140:143], v153, s[88:91], s3 offen
    v_lshrrev_b32 v3, 2, v3
    v_lshl_add_u32 v3, v7, 4, v3
    v_add_u32 v154, 1769472, v3
    v_lshrrev_b32 v3, 1, v4
    v_lshlrev_b32 v4, 1, v4
    s_mul_i32 s3, s55, 576
    s_add_u32 s16, s16, s3
    s_addc_u32 s17, s17, 0
    s_mov_b32 s18, 576
    s_mov_b32 s19, 0x20000
    buffer_load_dwordx2 v[148:149], v4, s[16:19], 0 offen
    v_mov_b32 v144, 0
    v_mov_b32 v145, 0
    v_mov_b32 v146, 0
    v_mov_b32 v147, 0
    v_mov_b32 v150, 0
    s_cmp_ge_u32 s51, 2
    s_cbranch_scc1 L2_w23
    buffer_load_dwordx4 v[144:147], v154, s[88:91], 0 offen
    buffer_load_ushort v150, v3, s[16:19], 0 offen offset:512
L2_w23:
    s_load_dwordx8 s[4:11], s[0:1], 8
    s_load_dwordx2 s[64:65], s[0:1], 56
    s_load_dwordx2 s[68:69], s[0:1], 64
    s_load_dwordx2 s[72:73], s[0:1], 72
    s_load_dwordx2 s[80:81], s[0:1], 96
    s_load_dwordx2 s[36:37], s[0:1], 48
    s_cmp_eq_u32 s51, 0
    s_cselect_b32 s3, 0, 0x40000000
    v_mul_u32_u24 v156, 32, v0
    v_or_b32 v156, s3, v156
    s_mul_i32 s44, s51, 4224
    s_add_u32 s44, s44, 16384
    v_lshl_add_u32 v5, v10, 12, v8
    v_lshrrev_b32 v13, 5, v0
    v_lshl_add_u32 v13, v10, 1, v13
    v_lshlrev_b32 v13, 15, v13
    v_and_b32 v14, 31, v0
    v_lshl_add_u32 v6, v14, 4, v13
    v_mov_b32 v56, 0
    v_mov_b32 v60, -1
    v_mov_b32 v57, 0
    v_mov_b32 v61, -1
    v_mov_b32 v58, 0
    v_mov_b32 v62, -1
    v_mov_b32 v59, 0
    v_mov_b32 v63, -1
    s_and_b32 s14, s53, 7
    s_lshl2_add_u32 s14, s14, s51
    v_lshrrev_b32 v13, 2, v0
    v_lshl_add_u32 v13, v13, 5, s14
    v_lshlrev_b32 v13, 13, v13
    v_lshl_add_u32 v13, v7, 7, v13
    s_waitcnt lgkmcnt(0)
    s_lshl_b32 s3, s52, 9
    s_add_u32 s24, s8, s3
    s_addc_u32 s25, s9, 0
    s_mov_b32 s26, 0
    s_mov_b32 s27, 0x20000
    s_sub_u32 s26, 4718592, s3
    s_mov_b64 exec, 0xffff
    buffer_load_dword a63, v13, s[24:27], 0 offen
    s_mov_b64 exec, -1
    s_mov_b32 s38, 1152
    s_mov_b32 s39, 0x20000
    v_and_b32 v14, 7, v0
    v_lshlrev_b32 v157, 4, v14
    v_add_u32 v157, 14080, v157
    v_lshl_add_u32 v158, v10, 2, v157
    s_mul_i32 s3, s51, 4608
    v_lshl_add_u32 v14, v14, 4, s3
    v_lshrrev_b32 v15, 3, v0
    v_lshl_add_u32 v159, v15, 8, v14
    s_lshr_b32 s3, s96, 1
    s_mul_i32 s3, s3, 18432
    s_and_b32 s14, s96, 1
    s_lshl_b32 s14, s14, 7
    s_add_u32 s3, s3, s14
    s_add_u32 s58, s3, 1048576
    s_lshl_b32 s3, s53, 2
    s_add_u32 s3, s3, s51
    s_lshl_b32 s14, s3, 4
    s_add_u32 s14, s14, s52
    s_lshl_b32 s14, s14, 7
    s_add_u32 s56, s14, 786432
    s_lshl_b32 s14, s3, 9
    s_add_u32 s59, s14, 32768
    v_and_b32 v14, 3, v0
    v_lshlrev_b32 v163, 7, v14
    s_mul_i32 s14, s3, 36864
    s_add_u32 s14, s14, 1048576
    s_add_u32 s32, s12, s14
    s_addc_u32 s33, s13, 0
    s_mov_b32 s34, 36864
    s_mov_b32 s35, 0x20000
    s_mul_i32 s15, s2, 4608
    s_mul_i32 s14, s51, 1152
    s_add_u32 s15, s15, s14
    s_add_u32 s57, s15, 98304
    s_cmp_ge_u32 s2, 144
    s_cselect_b32 s14, 0x40000000, 0
    v_or_b32 v160, s14, v8
    v_lshrrev_b32 v12, 4, v155
    v_lshlrev_b32 v12, 7, v12
    v_lshl_add_u32 v161, v7, 5, v12
    v_lshlrev_b32 v162, 2, v0
    s_mul_i32 s3, s50, 3641
    s_lshr_b32 s3, s3, 16
    s_mov_b32 s47, 1.0
    s_mov_b32 s48, 0
    s_cmp_lt_u32 s3, 2
    s_cselect_b32 s47, 0x3e0293ee, s47
    s_cmp_eq_u32 s3, 1
    s_cselect_b32 s48, 0x3e0293ee, s48
    s_cmp_eq_u32 s3, 4
    s_cselect_b32 s48, 1.0, s48
    s_cmp_eq_u32 s55, 0
    s_cselect_b32 s48, s48, 0
    s_lshl_b32 s100, s49, 7
    s_lshl_b32 s14, s96, 7
    s_add_u32 s101, s14, 32768
    s_mul_i32 s3, s51, 1152
    v_add_u32 v166, s3, v8
    s_and_b32 s3, s51, 1
    s_mul_i32 s3, s3, 2304
    s_cmp_lt_u32 s51, 2
    s_cselect_b32 s14, 32, 0
    s_add_u32 s3, s3, s14
    s_add_u32 s3, s3, 9216
    v_lshrrev_b32 v14, 1, v0
    v_lshl_add_u32 v14, v14, 6, s3
    v_and_b32 v15, 1, v0
    v_lshl_add_u32 v167, v15, 4, v14
    s_cmp_eq_u32 s51, 1
    s_cselect_b32 s3, 40, 256
    s_cmp_ge_u32 s2, s3
    s_cselect_b32 s3, 0, 0x40000000
    v_or_b32 v164, s3, v162
    v_mov_b32 v172, 0
    v_mov_b32 v180, 0
    v_mov_b32 v173, 0
    v_mov_b32 v181, 0
    v_mov_b32 v174, 0
    v_mov_b32 v182, 0
    v_mov_b32 v175, 0
    v_mov_b32 v183, 0
    s_lshl_b32 s3, s53, 2
    s_add_u32 s3, s3, s51
    v_mov_b32 v12, v10
    s_mul_i32 s14, s3, 589824
    s_mul_i32 s15, s52, 9216
    s_add_u32 s14, s14, s15
    s_add_u32 s14, s14, 8388608
    s_add_u32 s40, s12, s14
    s_addc_u32 s41, s13, 0
    s_mov_b32 s42, 0
    s_mov_b32 s43, 0x20000
    s_sub_u32 s42, 589824, s15
    s_lshl_b32 s3, s52, 19
    s_add_u32 s16, s4, s3
    s_addc_u32 s17, s5, 0
    s_mov_b32 s18, 524288
    s_mov_b32 s19, 0x20000
    s_add_u32 s20, s6, s3
    s_addc_u32 s21, s7, 0
    s_mov_b32 s22, 524288
    s_mov_b32 s23, 0x20000
    s_mul_i32 s3, s52, 294912
    s_add_u32 s28, s10, s3
    s_addc_u32 s29, s11, 0
    s_mov_b32 s30, 294912
    s_mov_b32 s31, 0x20000
    s_mov_b64 s[4:5], s[64:65]
    s_mov_b64 s[6:7], s[68:69]
    s_mov_b64 s[8:9], s[72:73]
    s_mov_b32 s50, 0
    s_mul_i32 s55, s51, 9216
    s_min_u32 s15, s2, 143
    s_and_b32 s3, s15, 7
    s_mul_i32 s3, s3, 18
    s_lshr_b32 s15, s15, 3
    s_add_u32 s15, s15, s3
    s_lshl_b32 s3, s15, 6
    s_add_u32 s64, s64, s3
    s_addc_u32 s65, s65, 0
    s_mov_b32 s66, 0
    s_mov_b32 s67, 0x20000
    s_add_u32 s68, s68, s3
    s_addc_u32 s69, s69, 0
    s_mov_b32 s70, 0
    s_mov_b32 s71, 0x20000
    s_sub_u32 s14, 5308416, s3
    s_mul_i32 s3, s15, 36864
    s_add_u32 s72, s72, s3
    s_addc_u32 s73, s73, 0
    s_mov_b32 s74, 0
    s_mov_b32 s75, 0x20000
    s_cmp_lt_u32 s2, 144
    s_cselect_b32 s66, s14, 0
    s_cselect_b32 s70, s14, 0
    s_cselect_b32 s74, 36864, 0
    s_mov_b32 s82, 2359296
    s_mov_b32 s83, 0x20000
    v_lshrrev_b32 v13, 4, v0
    v_lshlrev_b32 v9, 6, v13
    v_lshrrev_b32 v14, 2, v0
    v_mul_u32_u24 v14, 1056, v14
    v_add_u32 v14, 16384, v14
    v_and_b32 v15, 1, v0
    v_lshlrev_b32 v15, 4, v15
    v_add_u32 v3, v14, v15
    v_and_b32 v15, 2, v0
    v_lshl_add_u32 v3, v15, 2, v3
    v_add_u32 v4, 73728, v3
    v_lshrrev_b32 v14, 3, v0
    v_lshlrev_b32 v14, 2, v14
    v_add_u32 v14, v14, v12
    v_mul_u32_u24 v14, 4608, v14
    v_and_b32 v15, 7, v0
    v_lshl_add_u32 v7, v15, 4, v14
    v_lshlrev_b32 v10, 4, v15
    v_lshl_add_u32 v10, v13, 7, v10
    v_bfe_u32 v14, v0, 3, 1
    v_mul_u32_u24 v14, 147456, v14
    v_add_u32 v10, v10, v14
    v_lshrrev_b32 v14, 2, v0
    v_mul_u32_u24 v14, 1056, v14
    v_and_b32 v15, 3, v0
    v_lshl_add_u32 v14, v15, 3, v14
    v_add_u32 v2, 107008, v14
    v_and_b32 v14, 15, v0
    v_mul_u32_u24 v14, 1056, v14
    v_lshrrev_b32 v15, 4, v0
    v_lshl_add_u32 v14, v15, 4, v14
    v_add_u32 v1, 90112, v14
    v_and_b32 v14, 1, v0
    v_cmp_eq_u32 vcc, 0, v14
    v_mov_b32 v11, 0xeeeeeeee
    v_mov_b32 v15, 0x44444444
    v_cndmask_b32 v11, v11, v15, vcc
    v_and_b32 v14, 2, v0
    v_cmp_eq_u32 vcc, 0, v14
    v_mov_b32 v15, 0x3f803f80
    s_nop 0
    v_cndmask_b32 v15, 0, v15, vcc
    v_accvgpr_write_b32 a16, v15
    v_accvgpr_write_b32 a17, v15
    v_accvgpr_write_b32 a18, v15
    v_accvgpr_write_b32 a19, v15
    s_cmp_ge_u32 s2, 8
    s_cbranch_scc1 L2_noclr2
    s_mul_i32 s14, s2, 32
    s_mov_b64 exec, 1
    s_waitcnt vmcnt(6)
    s_barrier
    buffer_store_dword v60, v156, s[60:63], s14 offen sc1
    s_mov_b64 exec, -1
L2_noclr2:
    s_waitcnt vmcnt(6)
    v_lshlrev_b32 v24, 16, v64
    v_and_b32 v25, 0xffff0000, v64
    v_lshlrev_b32 v26, 16, v65
    v_and_b32 v27, 0xffff0000, v65
    v_lshlrev_b32 v28, 16, v66
    v_and_b32 v29, 0xffff0000, v66
    v_lshlrev_b32 v30, 16, v67
    v_and_b32 v31, 0xffff0000, v67
    v_lshlrev_b32 v32, 16, v68
    v_and_b32 v33, 0xffff0000, v68
    v_lshlrev_b32 v34, 16, v69
    v_and_b32 v35, 0xffff0000, v69
    v_lshlrev_b32 v36, 16, v70
    v_and_b32 v37, 0xffff0000, v70
    v_lshlrev_b32 v38, 16, v71
    v_and_b32 v39, 0xffff0000, v71
    v_lshlrev_b32 v40, 16, v72
    v_and_b32 v41, 0xffff0000, v72
    v_lshlrev_b32 v42, 16, v73
    v_and_b32 v43, 0xffff0000, v73
    v_lshlrev_b32 v44, 16, v74
    v_and_b32 v45, 0xffff0000, v74
    v_lshlrev_b32 v46, 16, v75
    v_and_b32 v47, 0xffff0000, v75
    v_add_f32 v48, v24, v25
    v_add_f32 v48, v48, v26
    v_add_f32 v48, v48, v27
    v_add_f32 v48, v48, v28
    v_add_f32 v48, v48, v29
    v_add_f32 v48, v48, v30
    v_add_f32 v48, v48, v31
    v_add_f32 v48, v48, v32
    v_add_f32 v48, v48, v33
    v_add_f32 v48, v48, v34
    v_add_f32 v48, v48, v35
    v_add_f32 v48, v48, v36
    v_add_f32 v48, v48, v37
    v_add_f32 v48, v48, v38
    v_add_f32 v48, v48, v39
    v_add_f32 v50, v40, v41
    v_add_f32 v50, v50, v42
    v_add_f32 v50, v50, v43
    v_add_f32 v50, v50, v44
    v_add_f32 v50, v50, v45
    v_add_f32 v50, v50, v46
    v_add_f32 v50, v50, v47
    v_fmac_f32 v48, 0x3e800000, v50
    s_nop 1
    v_add_f32_dpp v48, v48, v48 row_ror:8 row_mask:0xf bank_mask:0xf
    v_mov_b32 v50, v48
    s_nop 1
    v_permlane16_swap_b32 v50, v48
    v_add_f32 v48, v48, v50
    v_mov_b32 v50, v48
    s_nop 1
    v_permlane32_swap_b32 v50, v48
    v_add_f32 v48, v48, v50
    v_mul_f32 v48, 0x3be38e39, v48
    v_pk_add_f32 v[24:25], v[24:25], v[48:49] op_sel_hi:[1,0] neg_lo:[0,1] neg_hi:[0,1]
    v_pk_add_f32 v[26:27], v[26:27], v[48:49] op_sel_hi:[1,0] neg_lo:[0,1] neg_hi:[0,1]
    v_pk_add_f32 v[28:29], v[28:29], v[48:49] op_sel_hi:[1,0] neg_lo:[0,1] neg_hi:[0,1]
    v_pk_add_f32 v[30:31], v[30:31], v[48:49] op_sel_hi:[1,0] neg_lo:[0,1] neg_hi:[0,1]
    v_pk_add_f32 v[32:33], v[32:33], v[48:49] op_sel_hi:[1,0] neg_lo:[0,1] neg_hi:[0,1]
    v_pk_add_f32 v[34:35], v[34:35], v[48:49] op_sel_hi:[1,0] neg_lo:[0,1] neg_hi:[0,1]
    v_pk_add_f32 v[36:37], v[36:37], v[48:49] op_sel_hi:[1,0] neg_lo:[0,1] neg_hi:[0,1]
    v_pk_add_f32 v[38:39], v[38:39], v[48:49] op_sel_hi:[1,0] neg_lo:[0,1] neg_hi:[0,1]
    v_pk_add_f32 v[40:41], v[40:41], v[48:49] op_sel_hi:[1,0] neg_lo:[0,1] neg_hi:[0,1]
    v_pk_add_f32 v[42:43], v[42:43], v[48:49] op_sel_hi:[1,0] neg_lo:[0,1] neg_hi:[0,1]
    v_pk_add_f32 v[44:45], v[44:45], v[48:49] op_sel_hi:[1,0] neg_lo:[0,1] neg_hi:[0,1]
    v_pk_add_f32 v[46:47], v[46:47], v[48:49] op_sel_hi:[1,0] neg_lo:[0,1] neg_hi:[0,1]
    v_mul_f32 v49, v24, v24
    v_fmac_f32 v49, v25, v25
    v_fmac_f32 v49, v26, v26
    v_fmac_f32 v49, v27, v27
    v_fmac_f32 v49, v28, v28
    v_fmac_f32 v49, v29, v29
    v_fmac_f32 v49, v30, v30
    v_fmac_f32 v49, v31, v31
    v_fmac_f32 v49, v32, v32
    v_fmac_f32 v49, v33, v33
    v_fmac_f32 v49, v34, v34
    v_fmac_f32 v49, v35, v35
    v_fmac_f32 v49, v36, v36
    v_fmac_f32 v49, v37, v37
    v_fmac_f32 v49, v38, v38
    v_fmac_f32 v49, v39, v39
    v_mul_f32 v50, v40, v40
    v_fmac_f32 v50, v41, v41
    v_fmac_f32 v50, v42, v42
    v_fmac_f32 v50, v43, v43
    v_fmac_f32 v50, v44, v44
    v_fmac_f32 v50, v45, v45
    v_fmac_f32 v50, v46, v46
    v_fmac_f32 v50, v47, v47
    v_fmac_f32 v49, 0x3e800000, v50
    s_nop 1
    v_add_f32_dpp v49, v49, v49 row_ror:8 row_mask:0xf bank_mask:0xf
    v_mov_b32 v50, v49
    s_nop 1
    v_permlane16_swap_b32 v50, v49
    v_add_f32 v49, v49, v50
    v_mov_b32 v50, v49
    s_nop 1
    v_permlane32_swap_b32 v50, v49
    v_add_f32 v49, v49, v50
    ds_write_b32 v158, v48
    ds_write_b32 v158, v49 offset:128
    s_waitcnt lgkmcnt(0)
    s_barrier
    ds_read_b128 v[16:19], v157
    ds_read_b128 v[20:23], v157 offset:128
    s_add_u32 s14, s58, 4096
    s_waitcnt lgkmcnt(1)
    v_add_f32 v12, v16, v17
    v_add_f32 v13, v18, v19
    v_add_f32 v12, v12, v13
    v_mul_f32 v12, 0x3e800000, v12
    v_sub_f32 v16, v16, v12
    v_sub_f32 v17, v17, v12
    v_sub_f32 v18, v18, v12
    v_sub_f32 v19, v19, v12
    v_sub_f32 v48, v48, v12
    v_mul_f32 v13, v16, v16
    v_fmac_f32 v13, v17, v17
    v_fmac_f32 v13, v18, v18
    v_fmac_f32 v13, v19, v19
    s_waitcnt lgkmcnt(0)
    v_add_f32 v14, v20, v21
    v_add_f32 v15, v22, v23
    v_add_f32 v14, v14, v15
    v_fmac_f32 v14, 0x43100000, v13
    v_mov_b32 v12, 0x3727c5ac
    v_fmac_f32 v12, 0x3ae38e39, v14
    v_rsq_f32 v12, v12
    s_nop 0
    v_mul_f32 v48, v48, v12
    v_pk_fma_f32 v[24:25], v[24:25], v[12:13], v[48:49] op_sel_hi:[1,0,0]
    v_pk_fma_f32 v[26:27], v[26:27], v[12:13], v[48:49] op_sel_hi:[1,0,0]
    v_pk_fma_f32 v[28:29], v[28:29], v[12:13], v[48:49] op_sel_hi:[1,0,0]
    v_pk_fma_f32 v[30:31], v[30:31], v[12:13], v[48:49] op_sel_hi:[1,0,0]
    v_cvt_pk_f16_f32 v64, v24, v25
    v_cvt_pk_f16_f32 v65, v26, v27
    v_cvt_pk_f16_f32 v66, v28, v29
    v_cvt_pk_f16_f32 v67, v30, v31
    buffer_store_dwordx4 v[64:67], v159, s[84:87], s58 offen offset:0 sc1
    v_pk_fma_f32 v[32:33], v[32:33], v[12:13], v[48:49] op_sel_hi:[1,0,0]
    v_pk_fma_f32 v[34:35], v[34:35], v[12:13], v[48:49] op_sel_hi:[1,0,0]
    v_pk_fma_f32 v[36:37], v[36:37], v[12:13], v[48:49] op_sel_hi:[1,0,0]
    v_pk_fma_f32 v[38:39], v[38:39], v[12:13], v[48:49] op_sel_hi:[1,0,0]
    v_cvt_pk_f16_f32 v68, v32, v33
    v_cvt_pk_f16_f32 v69, v34, v35
    v_cvt_pk_f16_f32 v70, v36, v37
    v_cvt_pk_f16_f32 v71, v38, v39
    buffer_store_dwordx4 v[68:71], v159, s[84:87], s58 offen offset:2048 sc1
    v_pk_fma_f32 v[40:41], v[40:41], v[12:13], v[48:49] op_sel_hi:[1,0,0]
    v_pk_fma_f32 v[42:43], v[42:43], v[12:13], v[48:49] op_sel_hi:[1,0,0]
    v_pk_fma_f32 v[44:45], v[44:45], v[12:13], v[48:49] op_sel_hi:[1,0,0]
    v_pk_fma_f32 v[46:47], v[46:47], v[12:13], v[48:49] op_sel_hi:[1,0,0]
    v_cvt_pk_f16_f32 v72, v40, v41
    v_cvt_pk_f16_f32 v73, v42, v43
    v_cvt_pk_f16_f32 v74, v44, v45
    v_cvt_pk_f16_f32 v75, v46, v47
    s_mov_b64 exec, 0xffff
    buffer_store_dwordx4 v[72:75], v159, s[84:87], s14 offen offset:0 sc1
    s_mov_b64 exec, 0xff
    buffer_store_dwordx4 v[56:59], v8, s[84:87], s56 offen sc1
    buffer_store_dwordx4 v[60:63], v160, s[84:87], s57 offen offset:1024 sc1
    s_mov_b64 exec, -1
    buffer_store_dwordx4 v[60:63], v160, s[84:87], s57 offen sc1
    s_mov_b64 exec, 255
    buffer_load_dword v51, v156, s[60:63], 0 offen sc1
    s_mov_b64 exec, -1
    s_mul_i32 s3, s96, 147456
    s_add_u32 s3, s3, 8388608
    s_add_u32 s88, s12, s3
    s_addc_u32 s89, s13, 0
    s_mov_b32 s90, 147456
    s_mov_b32 s91, 0x20000
    s_waitcnt vmcnt(7)
    v_lshlrev_b32 v40, 16, v148
    v_and_b32 v41, 0xffff0000, v148
    v_lshlrev_b32 v42, 16, v149
    v_and_b32 v43, 0xffff0000, v149
    v_lshlrev_b32 v44, 16, v150
    v_mul_f32 v16, 0xbfb8aa3b, v40
    v_mul_f32 v17, 0xbfb8aa3b, v41
    v_mul_f32 v18, 0xbfb8aa3b, v42
    v_mul_f32 v19, 0xbfb8aa3b, v43
    v_mul_f32 v20, 0xbfb8aa3b, v44
    v_exp_f32 v16, v16
    v_exp_f32 v17, v17
    v_exp_f32 v18, v18
    v_exp_f32 v19, v19
    v_exp_f32 v20, v20
    v_add_f32 v16, 1.0, v16
    v_add_f32 v17, 1.0, v17
    v_add_f32 v18, 1.0, v18
    v_add_f32 v19, 1.0, v19
    v_add_f32 v20, 1.0, v20
    v_rcp_f32 v16, v16
    v_rcp_f32 v17, v17
    v_rcp_f32 v18, v18
    v_rcp_f32 v19, v19
    v_rcp_f32 v20, v20
    v_mul_f32 v24, v40, v16
    v_mul_f32 v26, v41, v17
    v_mul_f32 v28, v42, v18
    v_mul_f32 v30, v43, v19
    v_mul_f32 v32, v44, v20
    v_lshlrev_b32 v12, 16, v128
    v_and_b32 v13, 0xffff0000, v128
    v_pk_mul_f32 v[16:17], v[12:13], v[24:25] op_sel_hi:[1,0]
    v_lshlrev_b32 v14, 16, v129
    v_and_b32 v15, 0xffff0000, v129
    v_pk_mul_f32 v[18:19], v[14:15], v[24:25] op_sel_hi:[1,0]
    v_lshlrev_b32 v12, 16, v130
    v_and_b32 v13, 0xffff0000, v130
    v_pk_mul_f32 v[20:21], v[12:13], v[24:25] op_sel_hi:[1,0]
    v_lshlrev_b32 v14, 16, v131
    v_and_b32 v15, 0xffff0000, v131
    v_pk_mul_f32 v[22:23], v[14:15], v[24:25] op_sel_hi:[1,0]
    v_lshlrev_b32 v12, 16, v132
    v_and_b32 v13, 0xffff0000, v132
    v_pk_fma_f32 v[16:17], v[12:13], v[26:27], v[16:17] op_sel_hi:[1,0,1]
    v_lshlrev_b32 v14, 16, v133
    v_and_b32 v15, 0xffff0000, v133
    v_pk_fma_f32 v[18:19], v[14:15], v[26:27], v[18:19] op_sel_hi:[1,0,1]
    v_lshlrev_b32 v12, 16, v134
    v_and_b32 v13, 0xffff0000, v134
    v_pk_fma_f32 v[20:21], v[12:13], v[26:27], v[20:21] op_sel_hi:[1,0,1]
    v_lshlrev_b32 v14, 16, v135
    v_and_b32 v15, 0xffff0000, v135
    v_pk_fma_f32 v[22:23], v[14:15], v[26:27], v[22:23] op_sel_hi:[1,0,1]
    v_lshlrev_b32 v12, 16, v136
    v_and_b32 v13, 0xffff0000, v136
    v_pk_fma_f32 v[16:17], v[12:13], v[28:29], v[16:17] op_sel_hi:[1,0,1]
    v_lshlrev_b32 v14, 16, v137
    v_and_b32 v15, 0xffff0000, v137
    v_pk_fma_f32 v[18:19], v[14:15], v[28:29], v[18:19] op_sel_hi:[1,0,1]
    v_lshlrev_b32 v12, 16, v138
    v_and_b32 v13, 0xffff0000, v138
    v_pk_fma_f32 v[20:21], v[12:13], v[28:29], v[20:21] op_sel_hi:[1,0,1]
    v_lshlrev_b32 v14, 16, v139
    v_and_b32 v15, 0xffff0000, v139
    v_pk_fma_f32 v[22:23], v[14:15], v[28:29], v[22:23] op_sel_hi:[1,0,1]
    v_lshlrev_b32 v12, 16, v140
    v_and_b32 v13, 0xffff0000, v140
    v_pk_fma_f32 v[16:17], v[12:13], v[30:31], v[16:17] op_sel_hi:[1,0,1]
    v_lshlrev_b32 v14, 16, v141
    v_and_b32 v15, 0xffff0000, v141
    v_pk_fma_f32 v[18:19], v[14:15], v[30:31], v[18:19] op_sel_hi:[1,0,1]
    v_lshlrev_b32 v12, 16, v142
    v_and_b32 v13, 0xffff0000, v142
    v_pk_fma_f32 v[20:21], v[12:13], v[30:31], v[20:21] op_sel_hi:[1,0,1]
    v_lshlrev_b32 v14, 16, v143
    v_and_b32 v15, 0xffff0000, v143
    v_pk_fma_f32 v[22:23], v[14:15], v[30:31], v[22:23] op_sel_hi:[1,0,1]
    v_lshlrev_b32 v12, 16, v144
    v_and_b32 v13, 0xffff0000, v144
    v_pk_fma_f32 v[16:17], v[12:13], v[32:33], v[16:17] op_sel_hi:[1,0,1]
    v_lshlrev_b32 v14, 16, v145
    v_and_b32 v15, 0xffff0000, v145
    v_pk_fma_f32 v[18:19], v[14:15], v[32:33], v[18:19] op_sel_hi:[1,0,1]
    v_lshlrev_b32 v12, 16, v146
    v_and_b32 v13, 0xffff0000, v146
    v_pk_fma_f32 v[20:21], v[12:13], v[32:33], v[20:21] op_sel_hi:[1,0,1]
    v_lshlrev_b32 v14, 16, v147
    v_and_b32 v15, 0xffff0000, v147
    v_pk_fma_f32 v[22:23], v[14:15], v[32:33], v[22:23] op_sel_hi:[1,0,1]
    v_add_f32_dpp v16, v16, v16 row_ror:4 row_mask:0xf bank_mask:0xf
    v_add_f32_dpp v17, v17, v17 row_ror:4 row_mask:0xf bank_mask:0xf
    v_add_f32_dpp v18, v18, v18 row_ror:4 row_mask:0xf bank_mask:0xf
    v_add_f32_dpp v19, v19, v19 row_ror:4 row_mask:0xf bank_mask:0xf
    v_add_f32_dpp v20, v20, v20 row_ror:4 row_mask:0xf bank_mask:0xf
    v_add_f32_dpp v21, v21, v21 row_ror:4 row_mask:0xf bank_mask:0xf
    v_add_f32_dpp v22, v22, v22 row_ror:4 row_mask:0xf bank_mask:0xf
    v_add_f32_dpp v23, v23, v23 row_ror:4 row_mask:0xf bank_mask:0xf
    v_add_f32_dpp v16, v16, v16 row_ror:8 row_mask:0xf bank_mask:0xf
    v_add_f32_dpp v17, v17, v17 row_ror:8 row_mask:0xf bank_mask:0xf
    v_add_f32_dpp v18, v18, v18 row_ror:8 row_mask:0xf bank_mask:0xf
    v_add_f32_dpp v19, v19, v19 row_ror:8 row_mask:0xf bank_mask:0xf
    v_add_f32_dpp v20, v20, v20 row_ror:8 row_mask:0xf bank_mask:0xf
    v_add_f32_dpp v21, v21, v21 row_ror:8 row_mask:0xf bank_mask:0xf
    v_add_f32_dpp v22, v22, v22 row_ror:8 row_mask:0xf bank_mask:0xf
    v_add_f32_dpp v23, v23, v23 row_ror:8 row_mask:0xf bank_mask:0xf
    s_mov_b32 exec_lo, 0xf000f
    s_mov_b32 exec_hi, 0xf000f
    ds_write_b128 v161, v[16:19] offset:16384
    ds_write_b128 v161, v[20:23] offset:16400
    s_mov_b64 exec, 255
    s_waitcnt vmcnt(0)
    v_cmp_eq_u32 vcc, s51, v51
    s_nop 0
    s_cmp_lg_u64 vcc, 0
    s_cbranch_scc1 L2_p0s
L2_p0r:
    s_mov_b64 exec, 1
    s_waitcnt lgkmcnt(0)
    s_barrier
    buffer_store_dword v60, v156, s[84:87], s101 offen sc1
    s_mov_b64 exec, -1
    ds_read_b32 v24, v162 offset:16384
    ds_read_b32 v25, v162 offset:16640
    ds_read_b32 v26, v162 offset:16896
    ds_read_b32 v27, v162 offset:17152
    ds_read_b32 v28, v162 offset:17408
    ds_read_b32 v29, v162 offset:17664
    ds_read_b32 v30, v162 offset:17920
    ds_read_b32 v31, v162 offset:18176
    s_waitcnt lgkmcnt(0)
    v_pk_add_f32 v[24:25], v[24:25], v[26:27]
    v_pk_add_f32 v[28:29], v[28:29], v[30:31]
    v_pk_add_f32 v[24:25], v[24:25], v[28:29]
    v_add_f32 v52, v24, v25
    v_mov_b32 v53, v52
    v_mov_b32 v54, s48
    s_nop 0
    v_permlane32_swap_b32 v53, v52
    v_add_f32 v52, v52, v53
    v_fma_f32 v52, v52, s47, v54
    v_min_u32 v52, -2, v52
    s_mov_b32 exec_hi, 0
    buffer_store_dword v52, v164, s[84:87], s100 offen sc1
    s_mov_b64 exec, -1
    s_add_u32 m0, s44, 36864
    s_mov_b32 s45, 0
    buffer_load_dwordx4 v6, s[24:27], s45 offen lds
    s_add_u32 m0, s44, 37920
    s_mov_b32 s45, 8192
    buffer_load_dwordx4 v6, s[24:27], s45 offen lds
    s_add_u32 m0, s44, 38976
    s_mov_b32 s45, 16384
    buffer_load_dwordx4 v6, s[24:27], s45 offen lds
    s_add_u32 m0, s44, 40032
    s_mov_b32 s45, 24576
    buffer_load_dwordx4 v6, s[24:27], s45 offen lds
    s_add_u32 m0, s44, 53760
    s_mov_b32 s45, 262144
    buffer_load_dwordx4 v6, s[24:27], s45 offen lds
    s_add_u32 m0, s44, 54816
    s_mov_b32 s45, 270336
    buffer_load_dwordx4 v6, s[24:27], s45 offen lds
    s_add_u32 m0, s44, 55872
    s_mov_b32 s45, 278528
    buffer_load_dwordx4 v6, s[24:27], s45 offen lds
    s_add_u32 m0, s44, 56928
    s_mov_b32 s45, 286720
    buffer_load_dwordx4 v6, s[24:27], s45 offen lds
    s_add_u32 m0, s44, 73728
    s_mov_b32 s45, 524288
    buffer_load_dwordx4 v6, s[24:27], s45 offen lds
    s_add_u32 m0, s44, 74784
    s_mov_b32 s45, 532480
    buffer_load_dwordx4 v6, s[24:27], s45 offen lds
    s_add_u32 m0, s44, 75840
    s_mov_b32 s45, 540672
    buffer_load_dwordx4 v6, s[24:27], s45 offen lds
    s_add_u32 m0, s44, 76896
    s_mov_b32 s45, 548864
    buffer_load_dwordx4 v6, s[24:27], s45 offen lds
    s_add_u32 m0, s44, 90624
    s_mov_b32 s45, 786432
    buffer_load_dwordx4 v6, s[24:27], s45 offen lds
    s_add_u32 m0, s44, 91680
    s_mov_b32 s45, 794624
    buffer_load_dwordx4 v6, s[24:27], s45 offen lds
    s_add_u32 m0, s44, 92736
    s_mov_b32 s45, 802816
    buffer_load_dwordx4 v6, s[24:27], s45 offen lds
    s_add_u32 m0, s44, 93792
    s_mov_b32 s45, 811008
    buffer_load_dwordx4 v6, s[24:27], s45 offen lds
    s_mov_b64 exec, 0
    s_cmp_eq_u32 s51, 0
    s_cbranch_scc1 L2_pad0
    s_cmp_eq_u32 s51, 1
    s_cbranch_scc1 L2_pad1
    s_cmp_eq_u32 s51, 2
    s_cbranch_scc1 L2_pad2
    s_branch L2_pad3
.p2align 12
L2_walkret:
    s_mov_b64 exec, 15
    s_mov_b32 s97, 0x20000
L2_px:
    buffer_load_dword v13, v163, s[84:87], s59 offen sc1
    s_waitcnt vmcnt(0)
    v_cmp_eq_u32 vcc, 0, v13
    s_sub_u32 s97, s97, 1
    s_cselect_b64 vcc, 0, vcc
    s_cmp_eq_u64 vcc, 0
    s_cbranch_scc1 L2_px_ok
    s_sleep 1
    s_branch L2_px
L2_px_ok:
    s_mov_b64 exec, -1
    s_movk_i32 s14, 13824
    buffer_load_dwordx4 v[168:171], v166, s[84:87], 0 offen sc1
    buffer_load_dwordx4 v[176:179], v166, s[84:87], s14 offen sc1
    s_mov_b64 exec, 0xff
    buffer_load_dwordx4 v[172:175], v166, s[84:87], 0 offen offset:1024 sc1
    buffer_load_dwordx4 v[180:183], v166, s[84:87], s14 offen offset:1024 sc1
    s_mov_b64 exec, -1
    s_mov_b32 s54, 0
    buffer_load_dwordx4 v[80:83], v8, s[32:35], s54 offen sc1
    s_mov_b32 s54, 1024
    buffer_load_dwordx4 v[84:87], v8, s[32:35], s54 offen sc1
    s_mov_b32 s54, 18432
    buffer_load_dwordx4 v[88:91], v8, s[32:35], s54 offen sc1
    s_mov_b32 s54, 19456
    buffer_load_dwordx4 v[92:95], v8, s[32:35], s54 offen sc1
    s_mov_b32 s54, 2048
    buffer_load_dwordx4 v[96:99], v8, s[32:35], s54 offen sc1
    s_mov_b32 s54, 3072
    buffer_load_dwordx4 v[100:103], v8, s[32:35], s54 offen sc1
    s_mov_b32 s54, 20480
    buffer_load_dwordx4 v[104:107], v8, s[32:35], s54 offen sc1
    s_mov_b32 s54, 21504
    buffer_load_dwordx4 v[108:111], v8, s[32:35], s54 offen sc1
    s_waitcnt vmcnt(8)
    v_max_u32 v13, v168, v169
    v_max3_u32 v13, v13, v170, v171
    v_max3_u32 v13, v13, v172, v173
    v_max3_u32 v13, v13, v174, v175
    v_max3_u32 v13, v13, v176, v177
    v_max3_u32 v13, v13, v178, v179
    v_max3_u32 v13, v13, v180, v181
    v_max3_u32 v13, v13, v182, v183
    v_cmp_eq_u32 vcc, -1, v13
    s_nop 0
    s_cmp_lg_u64 vcc, 0
    s_cbranch_scc1 L2_pms
L2_pmr:
    v_pk_add_f32 v[168:169], v[168:169], v[176:177]
    v_pk_add_f32 v[170:171], v[170:171], v[178:179]
    v_pk_add_f32 v[172:173], v[172:173], v[180:181]
    v_pk_add_f32 v[174:175], v[174:175], v[182:183]
    ds_write_b128 v167, v[168:171]
    s_mov_b64 exec, 0xff
    ds_write_b128 v167, v[172:175] offset:2048
    s_mov_b64 exec, -1
    s_mov_b32 s54, 4096
    buffer_load_dwordx4 v[112:115], v8, s[32:35], s54 offen sc1
    s_mov_b32 s54, 5120
    buffer_load_dwordx4 v[116:119], v8, s[32:35], s54 offen sc1
    s_mov_b32 s54, 22528
    buffer_load_dwordx4 v[120:123], v8, s[32:35], s54 offen sc1
    s_mov_b32 s54, 23552
    buffer_load_dwordx4 v[124:127], v8, s[32:35], s54 offen sc1
    s_waitcnt lgkmcnt(0)
    s_barrier
    ds_read_b128 v[16:19], v9 offset:9216
    ds_read_b128 v[20:23], v9 offset:9248
    ds_read_b128 v[24:27], v9 offset:9232
    ds_read_b128 v[28:31], v9 offset:9264
    s_waitcnt vmcnt(8)
    s_waitcnt lgkmcnt(2)
    v_fma_mix_f32 v32, v80, v16, v20 op_sel:[0,0,0] op_sel_hi:[1,0,0]
    v_fma_mix_f32 v33, v80, v17, v21 op_sel:[1,0,0] op_sel_hi:[1,0,0]
    v_fma_mix_f32 v34, v81, v18, v22 op_sel:[0,0,0] op_sel_hi:[1,0,0]
    v_fma_mix_f32 v35, v81, v19, v23 op_sel:[1,0,0] op_sel_hi:[1,0,0]
    v_cvt_pk_bf16_f32 v80, v32, v33
    v_cvt_pk_bf16_f32 v81, v34, v35
    v_fma_mix_f32 v36, v88, v16, v20 op_sel:[0,0,0] op_sel_hi:[1,0,0]
    v_fma_mix_f32 v37, v88, v17, v21 op_sel:[1,0,0] op_sel_hi:[1,0,0]
    v_fma_mix_f32 v38, v89, v18, v22 op_sel:[0,0,0] op_sel_hi:[1,0,0]
    v_fma_mix_f32 v39, v89, v19, v23 op_sel:[1,0,0] op_sel_hi:[1,0,0]
    v_cvt_pk_bf16_f32 v88, v36, v37
    v_cvt_pk_bf16_f32 v89, v38, v39
    ds_read_b128 v[16:19], v9 offset:9472
    ds_read_b128 v[20:23], v9 offset:9504
    s_waitcnt lgkmcnt(2)
    v_fma_mix_f32 v32, v82, v24, v28 op_sel:[0,0,0] op_sel_hi:[1,0,0]
    v_fma_mix_f32 v33, v82, v25, v29 op_sel:[1,0,0] op_sel_hi:[1,0,0]
    v_fma_mix_f32 v34, v83, v26, v30 op_sel:[0,0,0] op_sel_hi:[1,0,0]
    v_fma_mix_f32 v35, v83, v27, v31 op_sel:[1,0,0] op_sel_hi:[1,0,0]
    v_cvt_pk_bf16_f32 v82, v32, v33
    v_cvt_pk_bf16_f32 v83, v34, v35
    v_fma_mix_f32 v36, v90, v24, v28 op_sel:[0,0,0] op_sel_hi:[1,0,0]
    v_fma_mix_f32 v37, v90, v25, v29 op_sel:[1,0,0] op_sel_hi:[1,0,0]
    v_fma_mix_f32 v38, v91, v26, v30 op_sel:[0,0,0] op_sel_hi:[1,0,0]
    v_fma_mix_f32 v39, v91, v27, v31 op_sel:[1,0,0] op_sel_hi:[1,0,0]
    v_cvt_pk_bf16_f32 v90, v36, v37
    v_cvt_pk_bf16_f32 v91, v38, v39
    ds_read_b128 v[24:27], v9 offset:9488
    ds_read_b128 v[28:31], v9 offset:9520
    s_waitcnt lgkmcnt(2)
    v_fma_mix_f32 v32, v84, v16, v20 op_sel:[0,0,0] op_sel_hi:[1,0,0]
    v_fma_mix_f32 v33, v84, v17, v21 op_sel:[1,0,0] op_sel_hi:[1,0,0]
    v_fma_mix_f32 v34, v85, v18, v22 op_sel:[0,0,0] op_sel_hi:[1,0,0]
    v_fma_mix_f32 v35, v85, v19, v23 op_sel:[1,0,0] op_sel_hi:[1,0,0]
    v_cvt_pk_bf16_f32 v84, v32, v33
    v_cvt_pk_bf16_f32 v85, v34, v35
    v_fma_mix_f32 v36, v92, v16, v20 op_sel:[0,0,0] op_sel_hi:[1,0,0]
    v_fma_mix_f32 v37, v92, v17, v21 op_sel:[1,0,0] op_sel_hi:[1,0,0]
    v_fma_mix_f32 v38, v93, v18, v22 op_sel:[0,0,0] op_sel_hi:[1,0,0]
    v_fma_mix_f32 v39, v93, v19, v23 op_sel:[1,0,0] op_sel_hi:[1,0,0]
    v_cvt_pk_bf16_f32 v92, v36, v37
    v_cvt_pk_bf16_f32 v93, v38, v39
    ds_read_b128 v[16:19], v9 offset:9728
    ds_read_b128 v[20:23], v9 offset:9760
    ds_read_b64_tr_b16 a[192:193], v3 offset:36864
    ds_read_b64_tr_b16 a[194:195], v3 offset:37376
    ds_read_b64_tr_b16 a[196:197], v3 offset:53760
    ds_read_b64_tr_b16 a[198:199], v3 offset:54272
    ds_read_b64_tr_b16 a[200:201], v3 offset:36896
    ds_read_b64_tr_b16 a[202:203], v3 offset:37408
    ds_read_b64_tr_b16 a[204:205], v3 offset:53792
    ds_read_b64_tr_b16 a[206:207], v3 offset:54304
    ds_read_b64_tr_b16 a[208:209], v3 offset:36928
    ds_read_b64_tr_b16 a[210:211], v3 offset:37440
    ds_read_b64_tr_b16 a[212:213], v3 offset:53824
    ds_read_b64_tr_b16 a[214:215], v3 offset:54336
    s_waitcnt lgkmcnt(14)
    v_fma_mix_f32 v32, v86, v24, v28 op_sel:[0,0,0] op_sel_hi:[1,0,0]
    v_fma_mix_f32 v33, v86, v25, v29 op_sel:[1,0,0] op_sel_hi:[1,0,0]
    v_fma_mix_f32 v34, v87, v26, v30 op_sel:[0,0,0] op_sel_hi:[1,0,0]
    v_fma_mix_f32 v35, v87, v27, v31 op_sel:[1,0,0] op_sel_hi:[1,0,0]
    v_cvt_pk_bf16_f32 v86, v32, v33
    v_cvt_pk_bf16_f32 v87, v34, v35
    v_fma_mix_f32 v36, v94, v24, v28 op_sel:[0,0,0] op_sel_hi:[1,0,0]
    v_fma_mix_f32 v37, v94, v25, v29 op_sel:[1,0,0] op_sel_hi:[1,0,0]
    v_fma_mix_f32 v38, v95, v26, v30 op_sel:[0,0,0] op_sel_hi:[1,0,0]
    v_fma_mix_f32 v39, v95, v27, v31 op_sel:[1,0,0] op_sel_hi:[1,0,0]
    v_cvt_pk_bf16_f32 v94, v36, v37
    v_cvt_pk_bf16_f32 v95, v38, v39
    s_waitcnt lgkmcnt(8)
    v_mfma_f32_16x16x32_bf16 v[128:131], a[192:195], v[80:83], 0
    s_waitcnt vmcnt(4)
    ds_read_b64_tr_b16 a[216:217], v3 offset:36960
    ds_read_b128 v[24:27], v9 offset:9744
    v_mfma_f32_16x16x32_bf16 v[128:131], a[196:199], v[84:87], v[128:131]
    ds_read_b64_tr_b16 a[218:219], v3 offset:37472
    ds_read_b64_tr_b16 a[220:221], v3 offset:53856
    v_fma_mix_f32 v32, v96, v16, v20 op_sel:[0,0,0] op_sel_hi:[1,0,0]
    v_mfma_f32_16x16x32_bf16 v[160:163], a[192:195], v[88:91], 0
    s_add_u32 m0, s44, 110592
    ds_read_b64_tr_b16 a[222:223], v3 offset:54368
    ds_read_b128 v[28:31], v9 offset:9776
    v_mfma_f32_16x16x32_bf16 v[160:163], a[196:199], v[92:95], v[160:163]
    s_mov_b32 s45, 1048576
    s_waitcnt lgkmcnt(10)
    buffer_load_dwordx4 v6, s[24:27], s45 offen lds
    v_mfma_f32_16x16x32_bf16 v[132:135], a[200:203], v[80:83], 0
    ds_read_b64_tr_b16 a[224:225], v3 offset:36992
    v_fma_mix_f32 v33, v96, v17, v21 op_sel:[1,0,0] op_sel_hi:[1,0,0]
    v_mfma_f32_16x16x32_bf16 v[132:135], a[204:207], v[84:87], v[132:135]
    ds_read_b64_tr_b16 a[226:227], v3 offset:37504
    ds_read_b64_tr_b16 a[228:229], v3 offset:53888
    v_fma_mix_f32 v34, v97, v18, v22 op_sel:[0,0,0] op_sel_hi:[1,0,0]
    v_mfma_f32_16x16x32_bf16 v[164:167], a[200:203], v[88:91], 0
    s_add_u32 m0, s44, 111648
    ds_read_b64_tr_b16 a[230:231], v3 offset:54400
    v_fma_mix_f32 v35, v97, v19, v23 op_sel:[1,0,0] op_sel_hi:[1,0,0]
    v_mfma_f32_16x16x32_bf16 v[164:167], a[204:207], v[92:95], v[164:167]
    s_mov_b32 s45, 1056768
    s_waitcnt lgkmcnt(10)
    buffer_load_dwordx4 v6, s[24:27], s45 offen lds
    v_mfma_f32_16x16x32_bf16 v[136:139], a[208:211], v[80:83], 0
    ds_read_b64_tr_b16 a[232:233], v3 offset:37024
    v_cvt_pk_bf16_f32 v96, v32, v33
    v_mfma_f32_16x16x32_bf16 v[136:139], a[212:215], v[84:87], v[136:139]
    ds_read_b64_tr_b16 a[234:235], v3 offset:37536
    ds_read_b64_tr_b16 a[236:237], v3 offset:53920
    v_cvt_pk_bf16_f32 v97, v34, v35
    v_mfma_f32_16x16x32_bf16 v[168:171], a[208:211], v[88:91], 0
    s_add_u32 m0, s44, 112704
    ds_read_b64_tr_b16 a[238:239], v3 offset:54432
    v_fma_mix_f32 v36, v104, v16, v20 op_sel:[0,0,0] op_sel_hi:[1,0,0]
    v_mfma_f32_16x16x32_bf16 v[168:171], a[212:215], v[92:95], v[168:171]
    s_mov_b32 s45, 1064960
    s_waitcnt lgkmcnt(9)
    buffer_load_dwordx4 v6, s[24:27], s45 offen lds
    v_fma_mix_f32 v37, v104, v17, v21 op_sel:[1,0,0] op_sel_hi:[1,0,0]
    v_mfma_f32_16x16x32_bf16 v[140:143], a[216:219], v[80:83], 0
    ds_read_b64_tr_b16 a[240:241], v3 offset:37056
    v_fma_mix_f32 v38, v105, v18, v22 op_sel:[0,0,0] op_sel_hi:[1,0,0]
    v_mfma_f32_16x16x32_bf16 v[140:143], a[220:223], v[84:87], v[140:143]
    ds_read_b64_tr_b16 a[242:243], v3 offset:37568
    ds_read_b64_tr_b16 a[244:245], v3 offset:53952
    v_fma_mix_f32 v39, v105, v19, v23 op_sel:[1,0,0] op_sel_hi:[1,0,0]
    v_mfma_f32_16x16x32_bf16 v[172:175], a[216:219], v[88:91], 0
    s_add_u32 m0, s44, 113760
    ds_read_b64_tr_b16 a[246:247], v3 offset:54464
    v_cvt_pk_bf16_f32 v104, v36, v37
    v_mfma_f32_16x16x32_bf16 v[172:175], a[220:223], v[92:95], v[172:175]
    s_mov_b32 s45, 1073152
    s_waitcnt lgkmcnt(8)
    buffer_load_dwordx4 v6, s[24:27], s45 offen lds
    v_cvt_pk_bf16_f32 v105, v38, v39
    v_mfma_f32_16x16x32_bf16 v[144:147], a[224:227], v[80:83], 0
    ds_read_b64_tr_b16 a[248:249], v3 offset:37088
    ds_read_b128 v[16:19], v9 offset:9984
    v_mfma_f32_16x16x32_bf16 v[144:147], a[228:231], v[84:87], v[144:147]
    ds_read_b64_tr_b16 a[250:251], v3 offset:37600
    ds_read_b64_tr_b16 a[252:253], v3 offset:53984
    v_fma_mix_f32 v32, v98, v24, v28 op_sel:[0,0,0] op_sel_hi:[1,0,0]
    v_mfma_f32_16x16x32_bf16 v[176:179], a[224:227], v[88:91], 0
    s_add_u32 m0, s44, 127488
    ds_read_b64_tr_b16 a[254:255], v3 offset:54496
    ds_read_b128 v[20:23], v9 offset:10016
    v_mfma_f32_16x16x32_bf16 v[176:179], a[228:231], v[92:95], v[176:179]
    s_mov_b32 s45, 1310720
    s_waitcnt lgkmcnt(10)
    buffer_load_dwordx4 v6, s[24:27], s45 offen lds
    v_mfma_f32_16x16x32_bf16 v[148:151], a[232:235], v[80:83], 0
    ds_read_b64_tr_b16 a[192:193], v3 offset:37120
    v_fma_mix_f32 v33, v98, v25, v29 op_sel:[1,0,0] op_sel_hi:[1,0,0]
    v_mfma_f32_16x16x32_bf16 v[148:151], a[236:239], v[84:87], v[148:151]
    ds_read_b64_tr_b16 a[194:195], v3 offset:37632
    ds_read_b64_tr_b16 a[196:197], v3 offset:54016
    v_fma_mix_f32 v34, v99, v26, v30 op_sel:[0,0,0] op_sel_hi:[1,0,0]
    v_mfma_f32_16x16x32_bf16 v[180:183], a[232:235], v[88:91], 0
    s_add_u32 m0, s44, 128544
    ds_read_b64_tr_b16 a[198:199], v3 offset:54528
    v_fma_mix_f32 v35, v99, v27, v31 op_sel:[1,0,0] op_sel_hi:[1,0,0]
    v_mfma_f32_16x16x32_bf16 v[180:183], a[236:239], v[92:95], v[180:183]
    s_mov_b32 s45, 1318912
    s_waitcnt lgkmcnt(10)
    buffer_load_dwordx4 v6, s[24:27], s45 offen lds
    v_mfma_f32_16x16x32_bf16 v[152:155], a[240:243], v[80:83], 0
    ds_read_b64_tr_b16 a[200:201], v3 offset:37152
    v_cvt_pk_bf16_f32 v98, v32, v33
    v_mfma_f32_16x16x32_bf16 v[152:155], a[244:247], v[84:87], v[152:155]
    ds_read_b64_tr_b16 a[202:203], v3 offset:37664
    ds_read_b64_tr_b16 a[204:205], v3 offset:54048
    v_cvt_pk_bf16_f32 v99, v34, v35
    v_mfma_f32_16x16x32_bf16 v[184:187], a[240:243], v[88:91], 0
    s_add_u32 m0, s44, 129600
    ds_read_b64_tr_b16 a[206:207], v3 offset:54560
    v_fma_mix_f32 v36, v106, v24, v28 op_sel:[0,0,0] op_sel_hi:[1,0,0]
    v_mfma_f32_16x16x32_bf16 v[184:187], a[244:247], v[92:95], v[184:187]
    s_mov_b32 s45, 1327104
    s_waitcnt lgkmcnt(9)
    buffer_load_dwordx4 v6, s[24:27], s45 offen lds
    v_fma_mix_f32 v37, v106, v25, v29 op_sel:[1,0,0] op_sel_hi:[1,0,0]
    v_mfma_f32_16x16x32_bf16 v[156:159], a[248:251], v[80:83], 0
    ds_read_b64_tr_b16 a[208:209], v3 offset:37184
    v_fma_mix_f32 v38, v107, v26, v30 op_sel:[0,0,0] op_sel_hi:[1,0,0]
    v_mfma_f32_16x16x32_bf16 v[156:159], a[252:255], v[84:87], v[156:159]
    ds_read_b64_tr_b16 a[210:211], v3 offset:37696
    ds_read_b64_tr_b16 a[212:213], v3 offset:54080
    v_fma_mix_f32 v39, v107, v27, v31 op_sel:[1,0,0] op_sel_hi:[1,0,0]
    v_mfma_f32_16x16x32_bf16 v[188:191], a[248:251], v[88:91], 0
    s_add_u32 m0, s44, 130656
    ds_read_b64_tr_b16 a[214:215], v3 offset:54592
    v_cvt_pk_bf16_f32 v106, v36, v37
    v_mfma_f32_16x16x32_bf16 v[188:191], a[252:255], v[92:95], v[188:191]
    s_mov_b32 s45, 1335296
    s_waitcnt lgkmcnt(8)
    buffer_load_dwordx4 v6, s[24:27], s45 offen lds
    v_cvt_pk_bf16_f32 v107, v38, v39
    v_mfma_f32_16x16x32_bf16 v[192:195], a[192:195], v[80:83], 0
    ds_read_b64_tr_b16 a[216:217], v3 offset:37216
    ds_read_b128 v[24:27], v9 offset:10000
    v_mfma_f32_16x16x32_bf16 v[192:195], a[196:199], v[84:87], v[192:195]
    ds_read_b64_tr_b16 a[218:219], v3 offset:37728
    ds_read_b64_tr_b16 a[220:221], v3 offset:54112
    v_fma_mix_f32 v32, v100, v16, v20 op_sel:[0,0,0] op_sel_hi:[1,0,0]
    v_mfma_f32_16x16x32_bf16 v[224:227], a[192:195], v[88:91], 0
    s_mov_b32 s54, 6144
    ds_read_b64_tr_b16 a[222:223], v3 offset:54624
    ds_read_b128 v[28:31], v9 offset:10032
    v_mfma_f32_16x16x32_bf16 v[224:227], a[196:199], v[92:95], v[224:227]
    s_waitcnt lgkmcnt(10)
    buffer_load_dwordx4 v[48:51], v8, s[32:35], s54 offen sc1
    v_mfma_f32_16x16x32_bf16 v[196:199], a[200:203], v[80:83], 0
    ds_read_b64_tr_b16 a[224:225], v3 offset:37248
    v_fma_mix_f32 v33, v100, v17, v21 op_sel:[1,0,0] op_sel_hi:[1,0,0]
    v_mfma_f32_16x16x32_bf16 v[196:199], a[204:207], v[84:87], v[196:199]
    ds_read_b64_tr_b16 a[226:227], v3 offset:37760
    ds_read_b64_tr_b16 a[228:229], v3 offset:54144
    v_fma_mix_f32 v34, v101, v18, v22 op_sel:[0,0,0] op_sel_hi:[1,0,0]
    v_mfma_f32_16x16x32_bf16 v[228:231], a[200:203], v[88:91], 0
    s_mov_b32 s54, 7168
    ds_read_b64_tr_b16 a[230:231], v3 offset:54656
    v_fma_mix_f32 v35, v101, v19, v23 op_sel:[1,0,0] op_sel_hi:[1,0,0]
    v_mfma_f32_16x16x32_bf16 v[228:231], a[204:207], v[92:95], v[228:231]
    s_waitcnt lgkmcnt(10)
    buffer_load_dwordx4 v[52:55], v8, s[32:35], s54 offen sc1
    v_mfma_f32_16x16x32_bf16 v[200:203], a[208:211], v[80:83], 0
    ds_read_b64_tr_b16 a[232:233], v3 offset:37280
    v_cvt_pk_bf16_f32 v100, v32, v33
    v_mfma_f32_16x16x32_bf16 v[200:203], a[212:215], v[84:87], v[200:203]
    ds_read_b64_tr_b16 a[234:235], v3 offset:37792
    ds_read_b64_tr_b16 a[236:237], v3 offset:54176
    v_cvt_pk_bf16_f32 v101, v34, v35
    v_mfma_f32_16x16x32_bf16 v[232:235], a[208:211], v[88:91], 0
    s_mov_b32 s54, 24576
    ds_read_b64_tr_b16 a[238:239], v3 offset:54688
    v_fma_mix_f32 v36, v108, v16, v20 op_sel:[0,0,0] op_sel_hi:[1,0,0]
    v_mfma_f32_16x16x32_bf16 v[232:235], a[212:215], v[92:95], v[232:235]
    s_waitcnt lgkmcnt(9)
    buffer_load_dwordx4 v[56:59], v8, s[32:35], s54 offen sc1
    v_fma_mix_f32 v37, v108, v17, v21 op_sel:[1,0,0] op_sel_hi:[1,0,0]
    v_mfma_f32_16x16x32_bf16 v[204:207], a[216:219], v[80:83], 0
    ds_read_b64_tr_b16 a[240:241], v3 offset:37312
    v_fma_mix_f32 v38, v109, v18, v22 op_sel:[0,0,0] op_sel_hi:[1,0,0]
    v_mfma_f32_16x16x32_bf16 v[204:207], a[220:223], v[84:87], v[204:207]
    ds_read_b64_tr_b16 a[242:243], v3 offset:37824
    ds_read_b64_tr_b16 a[244:245], v3 offset:54208
    v_fma_mix_f32 v39, v109, v19, v23 op_sel:[1,0,0] op_sel_hi:[1,0,0]
    v_mfma_f32_16x16x32_bf16 v[236:239], a[216:219], v[88:91], 0
    s_mov_b32 s54, 25600
    ds_read_b64_tr_b16 a[246:247], v3 offset:54720
    v_cvt_pk_bf16_f32 v108, v36, v37
    v_mfma_f32_16x16x32_bf16 v[236:239], a[220:223], v[92:95], v[236:239]
    s_waitcnt lgkmcnt(8)
    buffer_load_dwordx4 v[60:63], v8, s[32:35], s54 offen sc1
    v_cvt_pk_bf16_f32 v109, v38, v39
    v_mfma_f32_16x16x32_bf16 v[208:211], a[224:227], v[80:83], 0
    ds_read_b64_tr_b16 a[248:249], v3 offset:37344
    ds_read_b128 v[16:19], v9 offset:10240
    v_mfma_f32_16x16x32_bf16 v[208:211], a[228:231], v[84:87], v[208:211]
    ds_read_b64_tr_b16 a[250:251], v3 offset:37856
    ds_read_b128 v[20:23], v9 offset:10272
    v_mfma_f32_16x16x32_bf16 v[240:243], a[224:227], v[88:91], 0
    ds_read_b64_tr_b16 a[252:253], v3 offset:54240
    v_fma_mix_f32 v32, v102, v24, v28 op_sel:[0,0,0] op_sel_hi:[1,0,0]
    v_mfma_f32_16x16x32_bf16 v[240:243], a[228:231], v[92:95], v[240:243]
    s_barrier
    s_waitcnt lgkmcnt(9)
    ds_read_b64_tr_b16 a[254:255], v3 offset:54752
    v_fma_mix_f32 v33, v102, v25, v29 op_sel:[1,0,0] op_sel_hi:[1,0,0]
    v_fma_mix_f32 v34, v103, v26, v30 op_sel:[0,0,0] op_sel_hi:[1,0,0]
    v_mfma_f32_16x16x32_bf16 v[212:215], a[232:235], v[80:83], 0
    ds_read_b64_tr_b16 a[192:193], v4 offset:0
    v_fma_mix_f32 v35, v103, v27, v31 op_sel:[1,0,0] op_sel_hi:[1,0,0]
    v_mfma_f32_16x16x32_bf16 v[212:215], a[236:239], v[84:87], v[212:215]
    ds_read_b64_tr_b16 a[194:195], v4 offset:512
    ds_read_b64_tr_b16 a[196:197], v4 offset:16896
    v_cvt_pk_bf16_f32 v102, v32, v33
    v_mfma_f32_16x16x32_bf16 v[244:247], a[232:235], v[88:91], 0
    s_add_u32 m0, s44, 0
    ds_read_b64_tr_b16 a[198:199], v4 offset:17408
    v_cvt_pk_bf16_f32 v103, v34, v35
    v_mfma_f32_16x16x32_bf16 v[244:247], a[236:239], v[92:95], v[244:247]
    s_mov_b32 s45, 1572864
    s_waitcnt lgkmcnt(10)
    buffer_load_dwordx4 v6, s[24:27], s45 offen lds
    v_mfma_f32_16x16x32_bf16 v[216:219], a[240:243], v[80:83], 0
    ds_read_b64_tr_b16 a[200:201], v4 offset:32
    v_fma_mix_f32 v36, v110, v24, v28 op_sel:[0,0,0] op_sel_hi:[1,0,0]
    v_mfma_f32_16x16x32_bf16 v[216:219], a[244:247], v[84:87], v[216:219]
    ds_read_b64_tr_b16 a[202:203], v4 offset:544
    ds_read_b64_tr_b16 a[204:205], v4 offset:16928
    v_fma_mix_f32 v37, v110, v25, v29 op_sel:[1,0,0] op_sel_hi:[1,0,0]
    v_mfma_f32_16x16x32_bf16 v[248:251], a[240:243], v[88:91], 0
    s_add_u32 m0, s44, 1056
    ds_read_b64_tr_b16 a[206:207], v4 offset:17440
    v_fma_mix_f32 v38, v111, v26, v30 op_sel:[0,0,0] op_sel_hi:[1,0,0]
    v_mfma_f32_16x16x32_bf16 v[248:251], a[244:247], v[92:95], v[248:251]
    s_mov_b32 s45, 1581056
    s_waitcnt lgkmcnt(8)
    buffer_load_dwordx4 v6, s[24:27], s45 offen lds
    v_mfma_f32_16x16x32_bf16 v[220:223], a[248:251], v[80:83], 0
    ds_read_b64_tr_b16 a[208:209], v4 offset:64
    v_fma_mix_f32 v39, v111, v27, v31 op_sel:[1,0,0] op_sel_hi:[1,0,0]
    v_mfma_f32_16x16x32_bf16 v[220:223], a[252:255], v[84:87], v[220:223]
    ds_read_b64_tr_b16 a[210:211], v4 offset:576
    ds_read_b64_tr_b16 a[212:213], v4 offset:16960
    v_cvt_pk_bf16_f32 v110, v36, v37
    v_mfma_f32_16x16x32_bf16 v[252:255], a[248:251], v[88:91], 0
    s_add_u32 m0, s44, 2112
    ds_read_b64_tr_b16 a[214:215], v4 offset:17472
    v_cvt_pk_bf16_f32 v111, v38, v39
    v_mfma_f32_16x16x32_bf16 v[252:255], a[252:255], v[92:95], v[252:255]
    s_mov_b32 s45, 1589248
    s_waitcnt lgkmcnt(8)
    buffer_load_dwordx4 v6, s[24:27], s45 offen lds
    v_mfma_f32_16x16x32_bf16 v[128:131], a[192:195], v[96:99], v[128:131]
    s_waitcnt vmcnt(15)
    ds_read_b64_tr_b16 a[216:217], v4 offset:96
    ds_read_b128 v[24:27], v9 offset:10256
    v_mfma_f32_16x16x32_bf16 v[128:131], a[196:199], v[100:103], v[128:131]
    ds_read_b64_tr_b16 a[218:219], v4 offset:608
    ds_read_b64_tr_b16 a[220:221], v4 offset:16992
    v_fma_mix_f32 v32, v112, v16, v20 op_sel:[0,0,0] op_sel_hi:[1,0,0]
    v_mfma_f32_16x16x32_bf16 v[160:163], a[192:195], v[104:107], v[160:163]
    s_add_u32 m0, s44, 3168
    ds_read_b64_tr_b16 a[222:223], v4 offset:17504
    ds_read_b128 v[28:31], v9 offset:10288
    v_mfma_f32_16x16x32_bf16 v[160:163], a[196:199], v[108:111], v[160:163]
    s_mov_b32 s45, 1597440
    s_waitcnt lgkmcnt(10)
    buffer_load_dwordx4 v6, s[24:27], s45 offen lds
    v_mfma_f32_16x16x32_bf16 v[132:135], a[200:203], v[96:99], v[132:135]
    ds_read_b64_tr_b16 a[224:225], v4 offset:128
    v_fma_mix_f32 v33, v112, v17, v21 op_sel:[1,0,0] op_sel_hi:[1,0,0]
    v_mfma_f32_16x16x32_bf16 v[132:135], a[204:207], v[100:103], v[132:135]
    ds_read_b64_tr_b16 a[226:227], v4 offset:640
    ds_read_b64_tr_b16 a[228:229], v4 offset:17024
    v_fma_mix_f32 v34, v113, v18, v22 op_sel:[0,0,0] op_sel_hi:[1,0,0]
    v_mfma_f32_16x16x32_bf16 v[164:167], a[200:203], v[104:107], v[164:167]
    s_add_u32 m0, s44, 16896
    ds_read_b64_tr_b16 a[230:231], v4 offset:17536
    v_fma_mix_f32 v35, v113, v19, v23 op_sel:[1,0,0] op_sel_hi:[1,0,0]
    v_mfma_f32_16x16x32_bf16 v[164:167], a[204:207], v[108:111], v[164:167]
    s_mov_b32 s45, 1835008
    s_waitcnt lgkmcnt(10)
    buffer_load_dwordx4 v6, s[24:27], s45 offen lds
    v_mfma_f32_16x16x32_bf16 v[136:139], a[208:211], v[96:99], v[136:139]
    ds_read_b64_tr_b16 a[232:233], v4 offset:160
    v_cvt_pk_bf16_f32 v112, v32, v33
    v_mfma_f32_16x16x32_bf16 v[136:139], a[212:215], v[100:103], v[136:139]
    ds_read_b64_tr_b16 a[234:235], v4 offset:672
    ds_read_b64_tr_b16 a[236:237], v4 offset:17056
    v_cvt_pk_bf16_f32 v113, v34, v35
    v_mfma_f32_16x16x32_bf16 v[168:171], a[208:211], v[104:107], v[168:171]
    s_add_u32 m0, s44, 17952
    ds_read_b64_tr_b16 a[238:239], v4 offset:17568
    v_fma_mix_f32 v36, v120, v16, v20 op_sel:[0,0,0] op_sel_hi:[1,0,0]
    v_mfma_f32_16x16x32_bf16 v[168:171], a[212:215], v[108:111], v[168:171]
    s_mov_b32 s45, 1843200
    s_waitcnt lgkmcnt(9)
    buffer_load_dwordx4 v6, s[24:27], s45 offen lds
    v_fma_mix_f32 v37, v120, v17, v21 op_sel:[1,0,0] op_sel_hi:[1,0,0]
    v_mfma_f32_16x16x32_bf16 v[140:143], a[216:219], v[96:99], v[140:143]
    ds_read_b64_tr_b16 a[240:241], v4 offset:192
    v_fma_mix_f32 v38, v121, v18, v22 op_sel:[0,0,0] op_sel_hi:[1,0,0]
    v_mfma_f32_16x16x32_bf16 v[140:143], a[220:223], v[100:103], v[140:143]
    ds_read_b64_tr_b16 a[242:243], v4 offset:704
    ds_read_b64_tr_b16 a[244:245], v4 offset:17088
    v_fma_mix_f32 v39, v121, v19, v23 op_sel:[1,0,0] op_sel_hi:[1,0,0]
    v_mfma_f32_16x16x32_bf16 v[172:175], a[216:219], v[104:107], v[172:175]
    s_add_u32 m0, s44, 19008
    ds_read_b64_tr_b16 a[246:247], v4 offset:17600
    v_cvt_pk_bf16_f32 v120, v36, v37
    v_mfma_f32_16x16x32_bf16 v[172:175], a[220:223], v[108:111], v[172:175]
    s_mov_b32 s45, 1851392
    s_waitcnt lgkmcnt(8)
    buffer_load_dwordx4 v6, s[24:27], s45 offen lds
    v_cvt_pk_bf16_f32 v121, v38, v39
    v_mfma_f32_16x16x32_bf16 v[144:147], a[224:227], v[96:99], v[144:147]
    ds_read_b64_tr_b16 a[248:249], v4 offset:224
    ds_read_b128 v[16:19], v9 offset:10496
    v_mfma_f32_16x16x32_bf16 v[144:147], a[228:231], v[100:103], v[144:147]
    ds_read_b64_tr_b16 a[250:251], v4 offset:736
    ds_read_b64_tr_b16 a[252:253], v4 offset:17120
    v_mfma_f32_16x16x32_bf16 v[176:179], a[224:227], v[104:107], v[176:179]
    s_add_u32 m0, s44, 20064
    ds_read_b64_tr_b16 a[254:255], v4 offset:17632
    ds_read_b128 v[20:23], v9 offset:10528
    v_mfma_f32_16x16x32_bf16 v[176:179], a[228:231], v[108:111], v[176:179]
    s_mov_b32 s45, 1859584
    s_waitcnt lgkmcnt(10)
    buffer_load_dwordx4 v6, s[24:27], s45 offen lds
    v_mfma_f32_16x16x32_bf16 v[148:151], a[232:235], v[96:99], v[148:151]
    ds_read_b64_tr_b16 a[192:193], v4 offset:256
    v_fma_mix_f32 v32, v114, v24, v28 op_sel:[0,0,0] op_sel_hi:[1,0,0]
    v_mfma_f32_16x16x32_bf16 v[148:151], a[236:239], v[100:103], v[148:151]
    ds_read_b64_tr_b16 a[194:195], v4 offset:768
    v_fma_mix_f32 v33, v114, v25, v29 op_sel:[1,0,0] op_sel_hi:[1,0,0]
    v_mfma_f32_16x16x32_bf16 v[180:183], a[232:235], v[104:107], v[180:183]
    ds_read_b64_tr_b16 a[196:197], v4 offset:17152
    v_fma_mix_f32 v34, v115, v26, v30 op_sel:[0,0,0] op_sel_hi:[1,0,0]
    v_mfma_f32_16x16x32_bf16 v[180:183], a[236:239], v[108:111], v[180:183]
    s_waitcnt lgkmcnt(9)
    ds_read_b64_tr_b16 a[198:199], v4 offset:17664
    v_fma_mix_f32 v35, v115, v27, v31 op_sel:[1,0,0] op_sel_hi:[1,0,0]
    v_mfma_f32_16x16x32_bf16 v[152:155], a[240:243], v[96:99], v[152:155]
    ds_read_b64_tr_b16 a[200:201], v4 offset:288
    v_cvt_pk_bf16_f32 v114, v32, v33
    v_mfma_f32_16x16x32_bf16 v[152:155], a[244:247], v[100:103], v[152:155]
    ds_read_b64_tr_b16 a[202:203], v4 offset:800
    v_cvt_pk_bf16_f32 v115, v34, v35
    v_mfma_f32_16x16x32_bf16 v[184:187], a[240:243], v[104:107], v[184:187]
    ds_read_b64_tr_b16 a[204:205], v4 offset:17184
    v_fma_mix_f32 v36, v122, v24, v28 op_sel:[0,0,0] op_sel_hi:[1,0,0]
    v_mfma_f32_16x16x32_bf16 v[184:187], a[244:247], v[108:111], v[184:187]
    s_waitcnt lgkmcnt(8)
    ds_read_b64_tr_b16 a[206:207], v4 offset:17696
    v_fma_mix_f32 v37, v122, v25, v29 op_sel:[1,0,0] op_sel_hi:[1,0,0]
    v_mfma_f32_16x16x32_bf16 v[156:159], a[248:251], v[96:99], v[156:159]
    ds_read_b64_tr_b16 a[208:209], v4 offset:320
    v_fma_mix_f32 v38, v123, v26, v30 op_sel:[0,0,0] op_sel_hi:[1,0,0]
    v_mfma_f32_16x16x32_bf16 v[156:159], a[252:255], v[100:103], v[156:159]
    ds_read_b64_tr_b16 a[210:211], v4 offset:832
    v_fma_mix_f32 v39, v123, v27, v31 op_sel:[1,0,0] op_sel_hi:[1,0,0]
    v_mfma_f32_16x16x32_bf16 v[188:191], a[248:251], v[104:107], v[188:191]
    ds_read_b64_tr_b16 a[212:213], v4 offset:17216
    v_cvt_pk_bf16_f32 v122, v36, v37
    v_mfma_f32_16x16x32_bf16 v[188:191], a[252:255], v[108:111], v[188:191]
    s_waitcnt lgkmcnt(7)
    ds_read_b64_tr_b16 a[214:215], v4 offset:17728
    v_cvt_pk_bf16_f32 v123, v38, v39
    v_mfma_f32_16x16x32_bf16 v[192:195], a[192:195], v[96:99], v[192:195]
    ds_read_b64_tr_b16 a[216:217], v4 offset:352
    ds_read_b128 v[24:27], v9 offset:10512
    v_mfma_f32_16x16x32_bf16 v[192:195], a[196:199], v[100:103], v[192:195]
    ds_read_b64_tr_b16 a[218:219], v4 offset:864
    ds_read_b64_tr_b16 a[220:221], v4 offset:17248
    v_fma_mix_f32 v32, v116, v16, v20 op_sel:[0,0,0] op_sel_hi:[1,0,0]
    v_mfma_f32_16x16x32_bf16 v[224:227], a[192:195], v[104:107], v[224:227]
    s_mov_b32 s54, 8192
    ds_read_b64_tr_b16 a[222:223], v4 offset:17760
    ds_read_b128 v[28:31], v9 offset:10544
    v_mfma_f32_16x16x32_bf16 v[224:227], a[196:199], v[108:111], v[224:227]
    s_waitcnt lgkmcnt(10)
    buffer_load_dwordx4 v[64:67], v8, s[32:35], s54 offen sc1
    v_mfma_f32_16x16x32_bf16 v[196:199], a[200:203], v[96:99], v[196:199]
    ds_read_b64_tr_b16 a[224:225], v4 offset:384
    v_fma_mix_f32 v33, v116, v17, v21 op_sel:[1,0,0] op_sel_hi:[1,0,0]
    v_mfma_f32_16x16x32_bf16 v[196:199], a[204:207], v[100:103], v[196:199]
    ds_read_b64_tr_b16 a[226:227], v4 offset:896
    ds_read_b64_tr_b16 a[228:229], v4 offset:17280
    v_fma_mix_f32 v34, v117, v18, v22 op_sel:[0,0,0] op_sel_hi:[1,0,0]
    v_mfma_f32_16x16x32_bf16 v[228:231], a[200:203], v[104:107], v[228:231]
    s_mov_b32 s54, 9216
    ds_read_b64_tr_b16 a[230:231], v4 offset:17792
    v_fma_mix_f32 v35, v117, v19, v23 op_sel:[1,0,0] op_sel_hi:[1,0,0]
    v_mfma_f32_16x16x32_bf16 v[228:231], a[204:207], v[108:111], v[228:231]
    s_waitcnt lgkmcnt(10)
    buffer_load_dwordx4 v[68:71], v8, s[32:35], s54 offen sc1
    v_mfma_f32_16x16x32_bf16 v[200:203], a[208:211], v[96:99], v[200:203]
    ds_read_b64_tr_b16 a[232:233], v4 offset:416
    v_cvt_pk_bf16_f32 v116, v32, v33
    v_mfma_f32_16x16x32_bf16 v[200:203], a[212:215], v[100:103], v[200:203]
    ds_read_b64_tr_b16 a[234:235], v4 offset:928
    ds_read_b64_tr_b16 a[236:237], v4 offset:17312
    v_cvt_pk_bf16_f32 v117, v34, v35
    v_mfma_f32_16x16x32_bf16 v[232:235], a[208:211], v[104:107], v[232:235]
    s_mov_b32 s54, 26624
    ds_read_b64_tr_b16 a[238:239], v4 offset:17824
    v_fma_mix_f32 v36, v124, v16, v20 op_sel:[0,0,0] op_sel_hi:[1,0,0]
    v_mfma_f32_16x16x32_bf16 v[232:235], a[212:215], v[108:111], v[232:235]
    s_waitcnt lgkmcnt(9)
    buffer_load_dwordx4 v[72:75], v8, s[32:35], s54 offen sc1
    v_fma_mix_f32 v37, v124, v17, v21 op_sel:[1,0,0] op_sel_hi:[1,0,0]
    v_mfma_f32_16x16x32_bf16 v[204:207], a[216:219], v[96:99], v[204:207]
L2_pad0:
    s_cbranch_execz L2_pad4
    ds_read_b64_tr_b16 a[240:241], v4 offset:448
    v_fma_mix_f32 v38, v125, v18, v22 op_sel:[0,0,0] op_sel_hi:[1,0,0]
    v_mfma_f32_16x16x32_bf16 v[204:207], a[220:223], v[100:103], v[204:207]
    ds_read_b64_tr_b16 a[242:243], v4 offset:960
    ds_read_b64_tr_b16 a[244:245], v4 offset:17344
    v_fma_mix_f32 v39, v125, v19, v23 op_sel:[1,0,0] op_sel_hi:[1,0,0]
    v_mfma_f32_16x16x32_bf16 v[236:239], a[216:219], v[104:107], v[236:239]
    s_mov_b32 s54, 27648
    ds_read_b64_tr_b16 a[246:247], v4 offset:17856
    v_cvt_pk_bf16_f32 v124, v36, v37
    v_mfma_f32_16x16x32_bf16 v[236:239], a[220:223], v[108:111], v[236:239]
    s_waitcnt lgkmcnt(8)
    buffer_load_dwordx4 v[76:79], v8, s[32:35], s54 offen sc1
    v_cvt_pk_bf16_f32 v125, v38, v39
    v_mfma_f32_16x16x32_bf16 v[208:211], a[224:227], v[96:99], v[208:211]
    ds_read_b64_tr_b16 a[248:249], v4 offset:480
    ds_read_b128 v[16:19], v9 offset:10752
    v_mfma_f32_16x16x32_bf16 v[208:211], a[228:231], v[100:103], v[208:211]
    ds_read_b64_tr_b16 a[250:251], v4 offset:992
    ds_read_b128 v[20:23], v9 offset:10784
    v_mfma_f32_16x16x32_bf16 v[240:243], a[224:227], v[104:107], v[240:243]
    ds_read_b64_tr_b16 a[252:253], v4 offset:17376
    v_fma_mix_f32 v32, v118, v24, v28 op_sel:[0,0,0] op_sel_hi:[1,0,0]
    v_mfma_f32_16x16x32_bf16 v[240:243], a[228:231], v[108:111], v[240:243]
    s_waitcnt vmcnt(16)
    s_barrier
    s_waitcnt lgkmcnt(9)
    ds_read_b64_tr_b16 a[254:255], v4 offset:17888
    v_fma_mix_f32 v33, v118, v25, v29 op_sel:[1,0,0] op_sel_hi:[1,0,0]
    v_fma_mix_f32 v34, v119, v26, v30 op_sel:[0,0,0] op_sel_hi:[1,0,0]
    v_mfma_f32_16x16x32_bf16 v[212:215], a[232:235], v[96:99], v[212:215]
    ds_read_b64_tr_b16 a[192:193], v4 offset:36864
    v_fma_mix_f32 v35, v119, v27, v31 op_sel:[1,0,0] op_sel_hi:[1,0,0]
    v_mfma_f32_16x16x32_bf16 v[212:215], a[236:239], v[100:103], v[212:215]
    ds_read_b64_tr_b16 a[194:195], v4 offset:37376
    ds_read_b64_tr_b16 a[196:197], v4 offset:53760
    v_cvt_pk_bf16_f32 v118, v32, v33
    v_mfma_f32_16x16x32_bf16 v[244:247], a[232:235], v[104:107], v[244:247]
    s_add_u32 m0, s44, 36864
    ds_read_b64_tr_b16 a[198:199], v4 offset:54272
    v_cvt_pk_bf16_f32 v119, v34, v35
    v_mfma_f32_16x16x32_bf16 v[244:247], a[236:239], v[108:111], v[244:247]
    s_mov_b32 s45, 2097152
    s_waitcnt lgkmcnt(10)
    buffer_load_dwordx4 v6, s[24:27], s45 offen lds
    v_mfma_f32_16x16x32_bf16 v[216:219], a[240:243], v[96:99], v[216:219]
    ds_read_b64_tr_b16 a[200:201], v4 offset:36896
    v_fma_mix_f32 v36, v126, v24, v28 op_sel:[0,0,0] op_sel_hi:[1,0,0]
    v_mfma_f32_16x16x32_bf16 v[216:219], a[244:247], v[100:103], v[216:219]
    ds_read_b64_tr_b16 a[202:203], v4 offset:37408
    ds_read_b64_tr_b16 a[204:205], v4 offset:53792
    v_fma_mix_f32 v37, v126, v25, v29 op_sel:[1,0,0] op_sel_hi:[1,0,0]
    v_mfma_f32_16x16x32_bf16 v[248:251], a[240:243], v[104:107], v[248:251]
    s_add_u32 m0, s44, 37920
    ds_read_b64_tr_b16 a[206:207], v4 offset:54304
    v_fma_mix_f32 v38, v127, v26, v30 op_sel:[0,0,0] op_sel_hi:[1,0,0]
    v_mfma_f32_16x16x32_bf16 v[248:251], a[244:247], v[108:111], v[248:251]
    s_mov_b32 s45, 2105344
    s_waitcnt lgkmcnt(8)
    buffer_load_dwordx4 v6, s[24:27], s45 offen lds
    v_mfma_f32_16x16x32_bf16 v[220:223], a[248:251], v[96:99], v[220:223]
    ds_read_b64_tr_b16 a[208:209], v4 offset:36928
    v_fma_mix_f32 v39, v127, v27, v31 op_sel:[1,0,0] op_sel_hi:[1,0,0]
    v_mfma_f32_16x16x32_bf16 v[220:223], a[252:255], v[100:103], v[220:223]
    ds_read_b64_tr_b16 a[210:211], v4 offset:37440
    ds_read_b64_tr_b16 a[212:213], v4 offset:53824
    v_cvt_pk_bf16_f32 v126, v36, v37
    v_mfma_f32_16x16x32_bf16 v[252:255], a[248:251], v[104:107], v[252:255]
    s_add_u32 m0, s44, 38976
    ds_read_b64_tr_b16 a[214:215], v4 offset:54336
    v_cvt_pk_bf16_f32 v127, v38, v39
    v_mfma_f32_16x16x32_bf16 v[252:255], a[252:255], v[108:111], v[252:255]
    s_mov_b32 s45, 2113536
    s_waitcnt lgkmcnt(8)
    buffer_load_dwordx4 v6, s[24:27], s45 offen lds
    v_mfma_f32_16x16x32_bf16 v[128:131], a[192:195], v[112:115], v[128:131]
    s_waitcnt vmcnt(15)
    ds_read_b64_tr_b16 a[216:217], v4 offset:36960
    ds_read_b128 v[24:27], v9 offset:10768
    v_mfma_f32_16x16x32_bf16 v[128:131], a[196:199], v[116:119], v[128:131]
    ds_read_b64_tr_b16 a[218:219], v4 offset:37472
    ds_read_b64_tr_b16 a[220:221], v4 offset:53856
    v_fma_mix_f32 v32, v48, v16, v20 op_sel:[0,0,0] op_sel_hi:[1,0,0]
    v_mfma_f32_16x16x32_bf16 v[160:163], a[192:195], v[120:123], v[160:163]
    s_add_u32 m0, s44, 40032
    ds_read_b64_tr_b16 a[222:223], v4 offset:54368
    ds_read_b128 v[28:31], v9 offset:10800
    v_mfma_f32_16x16x32_bf16 v[160:163], a[196:199], v[124:127], v[160:163]
    s_mov_b32 s45, 2121728
    s_waitcnt lgkmcnt(10)
    buffer_load_dwordx4 v6, s[24:27], s45 offen lds
    v_mfma_f32_16x16x32_bf16 v[132:135], a[200:203], v[112:115], v[132:135]
    ds_read_b64_tr_b16 a[224:225], v4 offset:36992
    v_fma_mix_f32 v33, v48, v17, v21 op_sel:[1,0,0] op_sel_hi:[1,0,0]
    v_mfma_f32_16x16x32_bf16 v[132:135], a[204:207], v[116:119], v[132:135]
    ds_read_b64_tr_b16 a[226:227], v4 offset:37504
    ds_read_b64_tr_b16 a[228:229], v4 offset:53888
    v_fma_mix_f32 v34, v49, v18, v22 op_sel:[0,0,0] op_sel_hi:[1,0,0]
    v_mfma_f32_16x16x32_bf16 v[164:167], a[200:203], v[120:123], v[164:167]
    s_add_u32 m0, s44, 53760
    ds_read_b64_tr_b16 a[230:231], v4 offset:54400
    v_fma_mix_f32 v35, v49, v19, v23 op_sel:[1,0,0] op_sel_hi:[1,0,0]
    v_mfma_f32_16x16x32_bf16 v[164:167], a[204:207], v[124:127], v[164:167]
    s_mov_b32 s45, 2359296
    s_waitcnt lgkmcnt(10)
    buffer_load_dwordx4 v6, s[24:27], s45 offen lds
    v_mfma_f32_16x16x32_bf16 v[136:139], a[208:211], v[112:115], v[136:139]
    ds_read_b64_tr_b16 a[232:233], v4 offset:37024
    v_cvt_pk_bf16_f32 v48, v32, v33
    v_mfma_f32_16x16x32_bf16 v[136:139], a[212:215], v[116:119], v[136:139]
    ds_read_b64_tr_b16 a[234:235], v4 offset:37536
    ds_read_b64_tr_b16 a[236:237], v4 offset:53920
    v_cvt_pk_bf16_f32 v49, v34, v35
    v_mfma_f32_16x16x32_bf16 v[168:171], a[208:211], v[120:123], v[168:171]
    s_add_u32 m0, s44, 54816
    ds_read_b64_tr_b16 a[238:239], v4 offset:54432
    v_fma_mix_f32 v36, v56, v16, v20 op_sel:[0,0,0] op_sel_hi:[1,0,0]
    v_mfma_f32_16x16x32_bf16 v[168:171], a[212:215], v[124:127], v[168:171]
    s_mov_b32 s45, 2367488
    s_waitcnt lgkmcnt(9)
    buffer_load_dwordx4 v6, s[24:27], s45 offen lds
    v_fma_mix_f32 v37, v56, v17, v21 op_sel:[1,0,0] op_sel_hi:[1,0,0]
    v_mfma_f32_16x16x32_bf16 v[140:143], a[216:219], v[112:115], v[140:143]
    ds_read_b64_tr_b16 a[240:241], v4 offset:37056
    v_fma_mix_f32 v38, v57, v18, v22 op_sel:[0,0,0] op_sel_hi:[1,0,0]
    v_mfma_f32_16x16x32_bf16 v[140:143], a[220:223], v[116:119], v[140:143]
    ds_read_b64_tr_b16 a[242:243], v4 offset:37568
    ds_read_b64_tr_b16 a[244:245], v4 offset:53952
    v_fma_mix_f32 v39, v57, v19, v23 op_sel:[1,0,0] op_sel_hi:[1,0,0]
    v_mfma_f32_16x16x32_bf16 v[172:175], a[216:219], v[120:123], v[172:175]
    s_add_u32 m0, s44, 55872
    ds_read_b64_tr_b16 a[246:247], v4 offset:54464
    v_cvt_pk_bf16_f32 v56, v36, v37
    v_mfma_f32_16x16x32_bf16 v[172:175], a[220:223], v[124:127], v[172:175]
    s_mov_b32 s45, 2375680
    s_waitcnt lgkmcnt(8)
    buffer_load_dwordx4 v6, s[24:27], s45 offen lds
    v_cvt_pk_bf16_f32 v57, v38, v39
    v_mfma_f32_16x16x32_bf16 v[144:147], a[224:227], v[112:115], v[144:147]
    ds_read_b64_tr_b16 a[248:249], v4 offset:37088
    ds_read_b128 v[16:19], v9 offset:11008
    v_mfma_f32_16x16x32_bf16 v[144:147], a[228:231], v[116:119], v[144:147]
    ds_read_b64_tr_b16 a[250:251], v4 offset:37600
    ds_read_b64_tr_b16 a[252:253], v4 offset:53984
    v_mfma_f32_16x16x32_bf16 v[176:179], a[224:227], v[120:123], v[176:179]
    s_add_u32 m0, s44, 56928
    ds_read_b64_tr_b16 a[254:255], v4 offset:54496
    ds_read_b128 v[20:23], v9 offset:11040
    v_mfma_f32_16x16x32_bf16 v[176:179], a[228:231], v[124:127], v[176:179]
    s_mov_b32 s45, 2383872
    s_waitcnt lgkmcnt(10)
    buffer_load_dwordx4 v6, s[24:27], s45 offen lds
    v_mfma_f32_16x16x32_bf16 v[148:151], a[232:235], v[112:115], v[148:151]
    ds_read_b64_tr_b16 a[192:193], v4 offset:37120
    v_fma_mix_f32 v32, v50, v24, v28 op_sel:[0,0,0] op_sel_hi:[1,0,0]
    v_mfma_f32_16x16x32_bf16 v[148:151], a[236:239], v[116:119], v[148:151]
    ds_read_b64_tr_b16 a[194:195], v4 offset:37632
    v_fma_mix_f32 v33, v50, v25, v29 op_sel:[1,0,0] op_sel_hi:[1,0,0]
    v_mfma_f32_16x16x32_bf16 v[180:183], a[232:235], v[120:123], v[180:183]
    ds_read_b64_tr_b16 a[196:197], v4 offset:54016
    v_fma_mix_f32 v34, v51, v26, v30 op_sel:[0,0,0] op_sel_hi:[1,0,0]
    v_mfma_f32_16x16x32_bf16 v[180:183], a[236:239], v[124:127], v[180:183]
    s_waitcnt lgkmcnt(9)
    ds_read_b64_tr_b16 a[198:199], v4 offset:54528
    v_fma_mix_f32 v35, v51, v27, v31 op_sel:[1,0,0] op_sel_hi:[1,0,0]
    v_mfma_f32_16x16x32_bf16 v[152:155], a[240:243], v[112:115], v[152:155]
    ds_read_b64_tr_b16 a[200:201], v4 offset:37152
    v_cvt_pk_bf16_f32 v50, v32, v33
    v_mfma_f32_16x16x32_bf16 v[152:155], a[244:247], v[116:119], v[152:155]
    ds_read_b64_tr_b16 a[202:203], v4 offset:37664
    v_cvt_pk_bf16_f32 v51, v34, v35
    v_mfma_f32_16x16x32_bf16 v[184:187], a[240:243], v[120:123], v[184:187]
    ds_read_b64_tr_b16 a[204:205], v4 offset:54048
    v_fma_mix_f32 v36, v58, v24, v28 op_sel:[0,0,0] op_sel_hi:[1,0,0]
    v_mfma_f32_16x16x32_bf16 v[184:187], a[244:247], v[124:127], v[184:187]
    s_waitcnt lgkmcnt(8)
    ds_read_b64_tr_b16 a[206:207], v4 offset:54560
    v_fma_mix_f32 v37, v58, v25, v29 op_sel:[1,0,0] op_sel_hi:[1,0,0]
    v_mfma_f32_16x16x32_bf16 v[156:159], a[248:251], v[112:115], v[156:159]
    ds_read_b64_tr_b16 a[208:209], v4 offset:37184
    v_fma_mix_f32 v38, v59, v26, v30 op_sel:[0,0,0] op_sel_hi:[1,0,0]
    v_mfma_f32_16x16x32_bf16 v[156:159], a[252:255], v[116:119], v[156:159]
    ds_read_b64_tr_b16 a[210:211], v4 offset:37696
    v_fma_mix_f32 v39, v59, v27, v31 op_sel:[1,0,0] op_sel_hi:[1,0,0]
    v_mfma_f32_16x16x32_bf16 v[188:191], a[248:251], v[120:123], v[188:191]
    ds_read_b64_tr_b16 a[212:213], v4 offset:54080
    v_cvt_pk_bf16_f32 v58, v36, v37
    v_mfma_f32_16x16x32_bf16 v[188:191], a[252:255], v[124:127], v[188:191]
    s_waitcnt lgkmcnt(7)
    ds_read_b64_tr_b16 a[214:215], v4 offset:54592
    v_cvt_pk_bf16_f32 v59, v38, v39
    v_mfma_f32_16x16x32_bf16 v[192:195], a[192:195], v[112:115], v[192:195]
    ds_read_b64_tr_b16 a[216:217], v4 offset:37216
    ds_read_b128 v[24:27], v9 offset:11024
    v_mfma_f32_16x16x32_bf16 v[192:195], a[196:199], v[116:119], v[192:195]
    ds_read_b64_tr_b16 a[218:219], v4 offset:37728
    ds_read_b64_tr_b16 a[220:221], v4 offset:54112
    v_fma_mix_f32 v32, v52, v16, v20 op_sel:[0,0,0] op_sel_hi:[1,0,0]
    v_mfma_f32_16x16x32_bf16 v[224:227], a[192:195], v[120:123], v[224:227]
    s_mov_b32 s54, 10240
    ds_read_b64_tr_b16 a[222:223], v4 offset:54624
    ds_read_b128 v[28:31], v9 offset:11056
    v_mfma_f32_16x16x32_bf16 v[224:227], a[196:199], v[124:127], v[224:227]
    s_waitcnt lgkmcnt(10)
    buffer_load_dwordx4 v[80:83], v8, s[32:35], s54 offen sc1
    v_mfma_f32_16x16x32_bf16 v[196:199], a[200:203], v[112:115], v[196:199]
    ds_read_b64_tr_b16 a[224:225], v4 offset:37248
    v_fma_mix_f32 v33, v52, v17, v21 op_sel:[1,0,0] op_sel_hi:[1,0,0]
    v_mfma_f32_16x16x32_bf16 v[196:199], a[204:207], v[116:119], v[196:199]
    ds_read_b64_tr_b16 a[226:227], v4 offset:37760
    ds_read_b64_tr_b16 a[228:229], v4 offset:54144
    v_fma_mix_f32 v34, v53, v18, v22 op_sel:[0,0,0] op_sel_hi:[1,0,0]
    v_mfma_f32_16x16x32_bf16 v[228:231], a[200:203], v[120:123], v[228:231]
    s_mov_b32 s54, 11264
    ds_read_b64_tr_b16 a[230:231], v4 offset:54656
    v_fma_mix_f32 v35, v53, v19, v23 op_sel:[1,0,0] op_sel_hi:[1,0,0]
    v_mfma_f32_16x16x32_bf16 v[228:231], a[204:207], v[124:127], v[228:231]
    s_waitcnt lgkmcnt(10)
    buffer_load_dwordx4 v[84:87], v8, s[32:35], s54 offen sc1
    v_mfma_f32_16x16x32_bf16 v[200:203], a[208:211], v[112:115], v[200:203]
    ds_read_b64_tr_b16 a[232:233], v4 offset:37280
    v_cvt_pk_bf16_f32 v52, v32, v33
    v_mfma_f32_16x16x32_bf16 v[200:203], a[212:215], v[116:119], v[200:203]
    ds_read_b64_tr_b16 a[234:235], v4 offset:37792
    ds_read_b64_tr_b16 a[236:237], v4 offset:54176
    v_cvt_pk_bf16_f32 v53, v34, v35
    v_mfma_f32_16x16x32_bf16 v[232:235], a[208:211], v[120:123], v[232:235]
    s_mov_b32 s54, 28672
    ds_read_b64_tr_b16 a[238:239], v4 offset:54688
    v_fma_mix_f32 v36, v60, v16, v20 op_sel:[0,0,0] op_sel_hi:[1,0,0]
    v_mfma_f32_16x16x32_bf16 v[232:235], a[212:215], v[124:127], v[232:235]
    s_waitcnt lgkmcnt(9)
    buffer_load_dwordx4 v[88:91], v8, s[32:35], s54 offen sc1
    v_fma_mix_f32 v37, v60, v17, v21 op_sel:[1,0,0] op_sel_hi:[1,0,0]
    v_mfma_f32_16x16x32_bf16 v[204:207], a[216:219], v[112:115], v[204:207]
    ds_read_b64_tr_b16 a[240:241], v4 offset:37312
    v_fma_mix_f32 v38, v61, v18, v22 op_sel:[0,0,0] op_sel_hi:[1,0,0]
    v_mfma_f32_16x16x32_bf16 v[204:207], a[220:223], v[116:119], v[204:207]
    ds_read_b64_tr_b16 a[242:243], v4 offset:37824
    ds_read_b64_tr_b16 a[244:245], v4 offset:54208
    v_fma_mix_f32 v39, v61, v19, v23 op_sel:[1,0,0] op_sel_hi:[1,0,0]
    v_mfma_f32_16x16x32_bf16 v[236:239], a[216:219], v[120:123], v[236:239]
    s_mov_b32 s54, 29696
    ds_read_b64_tr_b16 a[246:247], v4 offset:54720
    v_cvt_pk_bf16_f32 v60, v36, v37
    v_mfma_f32_16x16x32_bf16 v[236:239], a[220:223], v[124:127], v[236:239]
    s_waitcnt lgkmcnt(8)
    buffer_load_dwordx4 v[92:95], v8, s[32:35], s54 offen sc1
    v_cvt_pk_bf16_f32 v61, v38, v39
    v_mfma_f32_16x16x32_bf16 v[208:211], a[224:227], v[112:115], v[208:211]
    ds_read_b64_tr_b16 a[248:249], v4 offset:37344
    ds_read_b128 v[16:19], v9 offset:11264
    v_mfma_f32_16x16x32_bf16 v[208:211], a[228:231], v[116:119], v[208:211]
    ds_read_b64_tr_b16 a[250:251], v4 offset:37856
    ds_read_b128 v[20:23], v9 offset:11296
    v_mfma_f32_16x16x32_bf16 v[240:243], a[224:227], v[120:123], v[240:243]
    ds_read_b64_tr_b16 a[252:253], v4 offset:54240
    v_fma_mix_f32 v32, v54, v24, v28 op_sel:[0,0,0] op_sel_hi:[1,0,0]
    v_mfma_f32_16x16x32_bf16 v[240:243], a[228:231], v[124:127], v[240:243]
    s_waitcnt vmcnt(16)
    s_barrier
    s_waitcnt lgkmcnt(9)
    ds_read_b64_tr_b16 a[254:255], v4 offset:54752
    v_fma_mix_f32 v33, v54, v25, v29 op_sel:[1,0,0] op_sel_hi:[1,0,0]
    v_fma_mix_f32 v34, v55, v26, v30 op_sel:[0,0,0] op_sel_hi:[1,0,0]
    v_mfma_f32_16x16x32_bf16 v[212:215], a[232:235], v[112:115], v[212:215]
    ds_read_b64_tr_b16 a[192:193], v3 offset:0
    v_fma_mix_f32 v35, v55, v27, v31 op_sel:[1,0,0] op_sel_hi:[1,0,0]
    v_mfma_f32_16x16x32_bf16 v[212:215], a[236:239], v[116:119], v[212:215]
    ds_read_b64_tr_b16 a[194:195], v3 offset:512
    ds_read_b64_tr_b16 a[196:197], v3 offset:16896
    v_cvt_pk_bf16_f32 v54, v32, v33
    v_mfma_f32_16x16x32_bf16 v[244:247], a[232:235], v[120:123], v[244:247]
    s_add_u32 m0, s44, 73728
    ds_read_b64_tr_b16 a[198:199], v3 offset:17408
    v_cvt_pk_bf16_f32 v55, v34, v35
    v_mfma_f32_16x16x32_bf16 v[244:247], a[236:239], v[124:127], v[244:247]
    s_mov_b32 s45, 2621440
    s_waitcnt lgkmcnt(10)
    buffer_load_dwordx4 v6, s[24:27], s45 offen lds
    v_mfma_f32_16x16x32_bf16 v[216:219], a[240:243], v[112:115], v[216:219]
    ds_read_b64_tr_b16 a[200:201], v3 offset:32
    v_fma_mix_f32 v36, v62, v24, v28 op_sel:[0,0,0] op_sel_hi:[1,0,0]
    v_mfma_f32_16x16x32_bf16 v[216:219], a[244:247], v[116:119], v[216:219]
    ds_read_b64_tr_b16 a[202:203], v3 offset:544
    ds_read_b64_tr_b16 a[204:205], v3 offset:16928
    v_fma_mix_f32 v37, v62, v25, v29 op_sel:[1,0,0] op_sel_hi:[1,0,0]
    v_mfma_f32_16x16x32_bf16 v[248:251], a[240:243], v[120:123], v[248:251]
    s_add_u32 m0, s44, 74784
    ds_read_b64_tr_b16 a[206:207], v3 offset:17440
    v_fma_mix_f32 v38, v63, v26, v30 op_sel:[0,0,0] op_sel_hi:[1,0,0]
    v_mfma_f32_16x16x32_bf16 v[248:251], a[244:247], v[124:127], v[248:251]
    s_mov_b32 s45, 2629632
    s_waitcnt lgkmcnt(8)
    buffer_load_dwordx4 v6, s[24:27], s45 offen lds
    v_mfma_f32_16x16x32_bf16 v[220:223], a[248:251], v[112:115], v[220:223]
    ds_read_b64_tr_b16 a[208:209], v3 offset:64
    v_fma_mix_f32 v39, v63, v27, v31 op_sel:[1,0,0] op_sel_hi:[1,0,0]
    v_mfma_f32_16x16x32_bf16 v[220:223], a[252:255], v[116:119], v[220:223]
    ds_read_b64_tr_b16 a[210:211], v3 offset:576
    ds_read_b64_tr_b16 a[212:213], v3 offset:16960
    v_cvt_pk_bf16_f32 v62, v36, v37
    v_mfma_f32_16x16x32_bf16 v[252:255], a[248:251], v[120:123], v[252:255]
    s_add_u32 m0, s44, 75840
    ds_read_b64_tr_b16 a[214:215], v3 offset:17472
    v_cvt_pk_bf16_f32 v63, v38, v39
    v_mfma_f32_16x16x32_bf16 v[252:255], a[252:255], v[124:127], v[252:255]
    s_mov_b32 s45, 2637824
    s_waitcnt lgkmcnt(8)
    buffer_load_dwordx4 v6, s[24:27], s45 offen lds
    v_mfma_f32_16x16x32_bf16 v[128:131], a[192:195], v[48:51], v[128:131]
    s_waitcnt vmcnt(15)
    ds_read_b64_tr_b16 a[216:217], v3 offset:96
    ds_read_b128 v[24:27], v9 offset:11280
    v_mfma_f32_16x16x32_bf16 v[128:131], a[196:199], v[52:55], v[128:131]
    ds_read_b64_tr_b16 a[218:219], v3 offset:608
    ds_read_b64_tr_b16 a[220:221], v3 offset:16992
    v_fma_mix_f32 v32, v64, v16, v20 op_sel:[0,0,0] op_sel_hi:[1,0,0]
    v_mfma_f32_16x16x32_bf16 v[160:163], a[192:195], v[56:59], v[160:163]
    s_add_u32 m0, s44, 76896
    ds_read_b64_tr_b16 a[222:223], v3 offset:17504
    ds_read_b128 v[28:31], v9 offset:11312
    v_mfma_f32_16x16x32_bf16 v[160:163], a[196:199], v[60:63], v[160:163]
    s_mov_b32 s45, 2646016
    s_waitcnt lgkmcnt(10)
    buffer_load_dwordx4 v6, s[24:27], s45 offen lds
    v_mfma_f32_16x16x32_bf16 v[132:135], a[200:203], v[48:51], v[132:135]
    ds_read_b64_tr_b16 a[224:225], v3 offset:128
    v_fma_mix_f32 v33, v64, v17, v21 op_sel:[1,0,0] op_sel_hi:[1,0,0]
    v_mfma_f32_16x16x32_bf16 v[132:135], a[204:207], v[52:55], v[132:135]
    ds_read_b64_tr_b16 a[226:227], v3 offset:640
    ds_read_b64_tr_b16 a[228:229], v3 offset:17024
    v_fma_mix_f32 v34, v65, v18, v22 op_sel:[0,0,0] op_sel_hi:[1,0,0]
    v_mfma_f32_16x16x32_bf16 v[164:167], a[200:203], v[56:59], v[164:167]
    s_add_u32 m0, s44, 90624
    ds_read_b64_tr_b16 a[230:231], v3 offset:17536
    v_fma_mix_f32 v35, v65, v19, v23 op_sel:[1,0,0] op_sel_hi:[1,0,0]
    v_mfma_f32_16x16x32_bf16 v[164:167], a[204:207], v[60:63], v[164:167]
    s_mov_b32 s45, 2883584
    s_waitcnt lgkmcnt(10)
    buffer_load_dwordx4 v6, s[24:27], s45 offen lds
    v_mfma_f32_16x16x32_bf16 v[136:139], a[208:211], v[48:51], v[136:139]
    ds_read_b64_tr_b16 a[232:233], v3 offset:160
    v_cvt_pk_bf16_f32 v64, v32, v33
    v_mfma_f32_16x16x32_bf16 v[136:139], a[212:215], v[52:55], v[136:139]
    ds_read_b64_tr_b16 a[234:235], v3 offset:672
    ds_read_b64_tr_b16 a[236:237], v3 offset:17056
    v_cvt_pk_bf16_f32 v65, v34, v35
    v_mfma_f32_16x16x32_bf16 v[168:171], a[208:211], v[56:59], v[168:171]
    s_add_u32 m0, s44, 91680
    ds_read_b64_tr_b16 a[238:239], v3 offset:17568
    v_fma_mix_f32 v36, v72, v16, v20 op_sel:[0,0,0] op_sel_hi:[1,0,0]
    v_mfma_f32_16x16x32_bf16 v[168:171], a[212:215], v[60:63], v[168:171]
    s_mov_b32 s45, 2891776
    s_waitcnt lgkmcnt(9)
    buffer_load_dwordx4 v6, s[24:27], s45 offen lds
    v_fma_mix_f32 v37, v72, v17, v21 op_sel:[1,0,0] op_sel_hi:[1,0,0]
    v_mfma_f32_16x16x32_bf16 v[140:143], a[216:219], v[48:51], v[140:143]
    ds_read_b64_tr_b16 a[240:241], v3 offset:192
    v_fma_mix_f32 v38, v73, v18, v22 op_sel:[0,0,0] op_sel_hi:[1,0,0]
    v_mfma_f32_16x16x32_bf16 v[140:143], a[220:223], v[52:55], v[140:143]
    ds_read_b64_tr_b16 a[242:243], v3 offset:704
    ds_read_b64_tr_b16 a[244:245], v3 offset:17088
    v_fma_mix_f32 v39, v73, v19, v23 op_sel:[1,0,0] op_sel_hi:[1,0,0]
    v_mfma_f32_16x16x32_bf16 v[172:175], a[216:219], v[56:59], v[172:175]
    s_add_u32 m0, s44, 92736
    ds_read_b64_tr_b16 a[246:247], v3 offset:17600
    v_cvt_pk_bf16_f32 v72, v36, v37
    v_mfma_f32_16x16x32_bf16 v[172:175], a[220:223], v[60:63], v[172:175]
    s_mov_b32 s45, 2899968
    s_waitcnt lgkmcnt(8)
    buffer_load_dwordx4 v6, s[24:27], s45 offen lds
    v_cvt_pk_bf16_f32 v73, v38, v39
    v_mfma_f32_16x16x32_bf16 v[144:147], a[224:227], v[48:51], v[144:147]
    ds_read_b64_tr_b16 a[248:249], v3 offset:224
    ds_read_b128 v[16:19], v9 offset:11520
    v_mfma_f32_16x16x32_bf16 v[144:147], a[228:231], v[52:55], v[144:147]
    ds_read_b64_tr_b16 a[250:251], v3 offset:736
    ds_read_b64_tr_b16 a[252:253], v3 offset:17120
    v_mfma_f32_16x16x32_bf16 v[176:179], a[224:227], v[56:59], v[176:179]
    s_add_u32 m0, s44, 93792
    ds_read_b64_tr_b16 a[254:255], v3 offset:17632
    ds_read_b128 v[20:23], v9 offset:11552
    v_mfma_f32_16x16x32_bf16 v[176:179], a[228:231], v[60:63], v[176:179]
    s_mov_b32 s45, 2908160
    s_waitcnt lgkmcnt(10)
    buffer_load_dwordx4 v6, s[24:27], s45 offen lds
    v_mfma_f32_16x16x32_bf16 v[148:151], a[232:235], v[48:51], v[148:151]
    ds_read_b64_tr_b16 a[192:193], v3 offset:256
    v_fma_mix_f32 v32, v66, v24, v28 op_sel:[0,0,0] op_sel_hi:[1,0,0]
    v_mfma_f32_16x16x32_bf16 v[148:151], a[236:239], v[52:55], v[148:151]
    ds_read_b64_tr_b16 a[194:195], v3 offset:768
    v_fma_mix_f32 v33, v66, v25, v29 op_sel:[1,0,0] op_sel_hi:[1,0,0]
    v_mfma_f32_16x16x32_bf16 v[180:183], a[232:235], v[56:59], v[180:183]
    ds_read_b64_tr_b16 a[196:197], v3 offset:17152
    v_fma_mix_f32 v34, v67, v26, v30 op_sel:[0,0,0] op_sel_hi:[1,0,0]
    v_mfma_f32_16x16x32_bf16 v[180:183], a[236:239], v[60:63], v[180:183]
    s_waitcnt lgkmcnt(9)
    ds_read_b64_tr_b16 a[198:199], v3 offset:17664
    v_fma_mix_f32 v35, v67, v27, v31 op_sel:[1,0,0] op_sel_hi:[1,0,0]
    v_mfma_f32_16x16x32_bf16 v[152:155], a[240:243], v[48:51], v[152:155]
    ds_read_b64_tr_b16 a[200:201], v3 offset:288
    v_cvt_pk_bf16_f32 v66, v32, v33
    v_mfma_f32_16x16x32_bf16 v[152:155], a[244:247], v[52:55], v[152:155]
    ds_read_b64_tr_b16 a[202:203], v3 offset:800
    v_cvt_pk_bf16_f32 v67, v34, v35
    v_mfma_f32_16x16x32_bf16 v[184:187], a[240:243], v[56:59], v[184:187]
    ds_read_b64_tr_b16 a[204:205], v3 offset:17184
    v_fma_mix_f32 v36, v74, v24, v28 op_sel:[0,0,0] op_sel_hi:[1,0,0]
    v_mfma_f32_16x16x32_bf16 v[184:187], a[244:247], v[60:63], v[184:187]
    s_waitcnt lgkmcnt(8)
    ds_read_b64_tr_b16 a[206:207], v3 offset:17696
    v_fma_mix_f32 v37, v74, v25, v29 op_sel:[1,0,0] op_sel_hi:[1,0,0]
    v_mfma_f32_16x16x32_bf16 v[156:159], a[248:251], v[48:51], v[156:159]
    ds_read_b64_tr_b16 a[208:209], v3 offset:320
    v_fma_mix_f32 v38, v75, v26, v30 op_sel:[0,0,0] op_sel_hi:[1,0,0]
    v_mfma_f32_16x16x32_bf16 v[156:159], a[252:255], v[52:55], v[156:159]
    ds_read_b64_tr_b16 a[210:211], v3 offset:832
    v_fma_mix_f32 v39, v75, v27, v31 op_sel:[1,0,0] op_sel_hi:[1,0,0]
    v_mfma_f32_16x16x32_bf16 v[188:191], a[248:251], v[56:59], v[188:191]
    ds_read_b64_tr_b16 a[212:213], v3 offset:17216
    v_cvt_pk_bf16_f32 v74, v36, v37
    v_mfma_f32_16x16x32_bf16 v[188:191], a[252:255], v[60:63], v[188:191]
    s_waitcnt lgkmcnt(7)
    ds_read_b64_tr_b16 a[214:215], v3 offset:17728
    v_cvt_pk_bf16_f32 v75, v38, v39
    v_mfma_f32_16x16x32_bf16 v[192:195], a[192:195], v[48:51], v[192:195]
    ds_read_b64_tr_b16 a[216:217], v3 offset:352
    ds_read_b128 v[24:27], v9 offset:11536
    v_mfma_f32_16x16x32_bf16 v[192:195], a[196:199], v[52:55], v[192:195]
    ds_read_b64_tr_b16 a[218:219], v3 offset:864
    ds_read_b64_tr_b16 a[220:221], v3 offset:17248
    v_fma_mix_f32 v32, v68, v16, v20 op_sel:[0,0,0] op_sel_hi:[1,0,0]
    v_mfma_f32_16x16x32_bf16 v[224:227], a[192:195], v[56:59], v[224:227]
    s_mov_b32 s54, 12288
    ds_read_b64_tr_b16 a[222:223], v3 offset:17760
    ds_read_b128 v[28:31], v9 offset:11568
    v_mfma_f32_16x16x32_bf16 v[224:227], a[196:199], v[60:63], v[224:227]
    s_waitcnt lgkmcnt(10)
    buffer_load_dwordx4 v[96:99], v8, s[32:35], s54 offen sc1
    v_mfma_f32_16x16x32_bf16 v[196:199], a[200:203], v[48:51], v[196:199]
    ds_read_b64_tr_b16 a[224:225], v3 offset:384
    v_fma_mix_f32 v33, v68, v17, v21 op_sel:[1,0,0] op_sel_hi:[1,0,0]
    v_mfma_f32_16x16x32_bf16 v[196:199], a[204:207], v[52:55], v[196:199]
    ds_read_b64_tr_b16 a[226:227], v3 offset:896
    ds_read_b64_tr_b16 a[228:229], v3 offset:17280
    v_fma_mix_f32 v34, v69, v18, v22 op_sel:[0,0,0] op_sel_hi:[1,0,0]
    v_mfma_f32_16x16x32_bf16 v[228:231], a[200:203], v[56:59], v[228:231]
    s_mov_b32 s54, 13312
    ds_read_b64_tr_b16 a[230:231], v3 offset:17792
    v_fma_mix_f32 v35, v69, v19, v23 op_sel:[1,0,0] op_sel_hi:[1,0,0]
    v_mfma_f32_16x16x32_bf16 v[228:231], a[204:207], v[60:63], v[228:231]
    s_waitcnt lgkmcnt(10)
    buffer_load_dwordx4 v[100:103], v8, s[32:35], s54 offen sc1
    v_mfma_f32_16x16x32_bf16 v[200:203], a[208:211], v[48:51], v[200:203]
    ds_read_b64_tr_b16 a[232:233], v3 offset:416
    v_cvt_pk_bf16_f32 v68, v32, v33
    v_mfma_f32_16x16x32_bf16 v[200:203], a[212:215], v[52:55], v[200:203]
    ds_read_b64_tr_b16 a[234:235], v3 offset:928
    ds_read_b64_tr_b16 a[236:237], v3 offset:17312
    v_cvt_pk_bf16_f32 v69, v34, v35
    v_mfma_f32_16x16x32_bf16 v[232:235], a[208:211], v[56:59], v[232:235]
    s_mov_b32 s54, 30720
    ds_read_b64_tr_b16 a[238:239], v3 offset:17824
    v_fma_mix_f32 v36, v76, v16, v20 op_sel:[0,0,0] op_sel_hi:[1,0,0]
    v_mfma_f32_16x16x32_bf16 v[232:235], a[212:215], v[60:63], v[232:235]
    s_waitcnt lgkmcnt(9)
    buffer_load_dwordx4 v[104:107], v8, s[32:35], s54 offen sc1
    v_fma_mix_f32 v37, v76, v17, v21 op_sel:[1,0,0] op_sel_hi:[1,0,0]
    v_mfma_f32_16x16x32_bf16 v[204:207], a[216:219], v[48:51], v[204:207]
    ds_read_b64_tr_b16 a[240:241], v3 offset:448
    v_fma_mix_f32 v38, v77, v18, v22 op_sel:[0,0,0] op_sel_hi:[1,0,0]
    v_mfma_f32_16x16x32_bf16 v[204:207], a[220:223], v[52:55], v[204:207]
    ds_read_b64_tr_b16 a[242:243], v3 offset:960
    ds_read_b64_tr_b16 a[244:245], v3 offset:17344
    v_fma_mix_f32 v39, v77, v19, v23 op_sel:[1,0,0] op_sel_hi:[1,0,0]
    v_mfma_f32_16x16x32_bf16 v[236:239], a[216:219], v[56:59], v[236:239]
    s_mov_b32 s54, 31744
    ds_read_b64_tr_b16 a[246:247], v3 offset:17856
    v_cvt_pk_bf16_f32 v76, v36, v37
    v_mfma_f32_16x16x32_bf16 v[236:239], a[220:223], v[60:63], v[236:239]
    s_waitcnt lgkmcnt(8)
    buffer_load_dwordx4 v[108:111], v8, s[32:35], s54 offen sc1
    v_cvt_pk_bf16_f32 v77, v38, v39
    v_mfma_f32_16x16x32_bf16 v[208:211], a[224:227], v[48:51], v[208:211]
    ds_read_b64_tr_b16 a[248:249], v3 offset:480
    ds_read_b128 v[16:19], v9 offset:11776
    v_mfma_f32_16x16x32_bf16 v[208:211], a[228:231], v[52:55], v[208:211]
    ds_read_b64_tr_b16 a[250:251], v3 offset:992
    ds_read_b128 v[20:23], v9 offset:11808
    v_mfma_f32_16x16x32_bf16 v[240:243], a[224:227], v[56:59], v[240:243]
    ds_read_b64_tr_b16 a[252:253], v3 offset:17376
    v_fma_mix_f32 v32, v70, v24, v28 op_sel:[0,0,0] op_sel_hi:[1,0,0]
    v_mfma_f32_16x16x32_bf16 v[240:243], a[228:231], v[60:63], v[240:243]
    s_waitcnt vmcnt(16)
    s_barrier
    s_waitcnt lgkmcnt(9)
    ds_read_b64_tr_b16 a[254:255], v3 offset:17888
    v_fma_mix_f32 v33, v70, v25, v29 op_sel:[1,0,0] op_sel_hi:[1,0,0]
    v_fma_mix_f32 v34, v71, v26, v30 op_sel:[0,0,0] op_sel_hi:[1,0,0]
    v_mfma_f32_16x16x32_bf16 v[212:215], a[232:235], v[48:51], v[212:215]
    ds_read_b64_tr_b16 a[192:193], v3 offset:36864
    v_fma_mix_f32 v35, v71, v27, v31 op_sel:[1,0,0] op_sel_hi:[1,0,0]
    v_mfma_f32_16x16x32_bf16 v[212:215], a[236:239], v[52:55], v[212:215]
    ds_read_b64_tr_b16 a[194:195], v3 offset:37376
    ds_read_b64_tr_b16 a[196:197], v3 offset:53760
    v_cvt_pk_bf16_f32 v70, v32, v33
    v_mfma_f32_16x16x32_bf16 v[244:247], a[232:235], v[56:59], v[244:247]
    s_add_u32 m0, s44, 110592
    ds_read_b64_tr_b16 a[198:199], v3 offset:54272
    v_cvt_pk_bf16_f32 v71, v34, v35
    v_mfma_f32_16x16x32_bf16 v[244:247], a[236:239], v[60:63], v[244:247]
    s_mov_b32 s45, 3145728
    s_waitcnt lgkmcnt(10)
    buffer_load_dwordx4 v6, s[24:27], s45 offen lds
    v_mfma_f32_16x16x32_bf16 v[216:219], a[240:243], v[48:51], v[216:219]
    ds_read_b64_tr_b16 a[200:201], v3 offset:36896
    v_fma_mix_f32 v36, v78, v24, v28 op_sel:[0,0,0] op_sel_hi:[1,0,0]
    v_mfma_f32_16x16x32_bf16 v[216:219], a[244:247], v[52:55], v[216:219]
    ds_read_b64_tr_b16 a[202:203], v3 offset:37408
    ds_read_b64_tr_b16 a[204:205], v3 offset:53792
    v_fma_mix_f32 v37, v78, v25, v29 op_sel:[1,0,0] op_sel_hi:[1,0,0]
    v_mfma_f32_16x16x32_bf16 v[248:251], a[240:243], v[56:59], v[248:251]
    s_add_u32 m0, s44, 111648
    ds_read_b64_tr_b16 a[206:207], v3 offset:54304
    v_fma_mix_f32 v38, v79, v26, v30 op_sel:[0,0,0] op_sel_hi:[1,0,0]
    v_mfma_f32_16x16x32_bf16 v[248:251], a[244:247], v[60:63], v[248:251]
    s_mov_b32 s45, 3153920
    s_waitcnt lgkmcnt(8)
    buffer_load_dwordx4 v6, s[24:27], s45 offen lds
    v_mfma_f32_16x16x32_bf16 v[220:223], a[248:251], v[48:51], v[220:223]
L2_pad1:
    s_cbranch_execz L2_pad5
    ds_read_b64_tr_b16 a[208:209], v3 offset:36928
    v_fma_mix_f32 v39, v79, v27, v31 op_sel:[1,0,0] op_sel_hi:[1,0,0]
    v_mfma_f32_16x16x32_bf16 v[220:223], a[252:255], v[52:55], v[220:223]
    ds_read_b64_tr_b16 a[210:211], v3 offset:37440
    ds_read_b64_tr_b16 a[212:213], v3 offset:53824
    v_cvt_pk_bf16_f32 v78, v36, v37
    v_mfma_f32_16x16x32_bf16 v[252:255], a[248:251], v[56:59], v[252:255]
    s_add_u32 m0, s44, 112704
    ds_read_b64_tr_b16 a[214:215], v3 offset:54336
    v_cvt_pk_bf16_f32 v79, v38, v39
    v_mfma_f32_16x16x32_bf16 v[252:255], a[252:255], v[60:63], v[252:255]
    s_mov_b32 s45, 3162112
    s_waitcnt lgkmcnt(8)
    buffer_load_dwordx4 v6, s[24:27], s45 offen lds
    v_mfma_f32_16x16x32_bf16 v[128:131], a[192:195], v[64:67], v[128:131]
    s_waitcnt vmcnt(15)
    ds_read_b64_tr_b16 a[216:217], v3 offset:36960
    ds_read_b128 v[24:27], v9 offset:11792
    v_mfma_f32_16x16x32_bf16 v[128:131], a[196:199], v[68:71], v[128:131]
    ds_read_b64_tr_b16 a[218:219], v3 offset:37472
    ds_read_b64_tr_b16 a[220:221], v3 offset:53856
    v_fma_mix_f32 v32, v80, v16, v20 op_sel:[0,0,0] op_sel_hi:[1,0,0]
    v_mfma_f32_16x16x32_bf16 v[160:163], a[192:195], v[72:75], v[160:163]
    s_add_u32 m0, s44, 113760
    ds_read_b64_tr_b16 a[222:223], v3 offset:54368
    ds_read_b128 v[28:31], v9 offset:11824
    v_mfma_f32_16x16x32_bf16 v[160:163], a[196:199], v[76:79], v[160:163]
    s_mov_b32 s45, 3170304
    s_waitcnt lgkmcnt(10)
    buffer_load_dwordx4 v6, s[24:27], s45 offen lds
    v_mfma_f32_16x16x32_bf16 v[132:135], a[200:203], v[64:67], v[132:135]
    ds_read_b64_tr_b16 a[224:225], v3 offset:36992
    v_fma_mix_f32 v33, v80, v17, v21 op_sel:[1,0,0] op_sel_hi:[1,0,0]
    v_mfma_f32_16x16x32_bf16 v[132:135], a[204:207], v[68:71], v[132:135]
    ds_read_b64_tr_b16 a[226:227], v3 offset:37504
    ds_read_b64_tr_b16 a[228:229], v3 offset:53888
    v_fma_mix_f32 v34, v81, v18, v22 op_sel:[0,0,0] op_sel_hi:[1,0,0]
    v_mfma_f32_16x16x32_bf16 v[164:167], a[200:203], v[72:75], v[164:167]
    s_add_u32 m0, s44, 127488
    ds_read_b64_tr_b16 a[230:231], v3 offset:54400
    v_fma_mix_f32 v35, v81, v19, v23 op_sel:[1,0,0] op_sel_hi:[1,0,0]
    v_mfma_f32_16x16x32_bf16 v[164:167], a[204:207], v[76:79], v[164:167]
    s_mov_b32 s45, 3407872
    s_waitcnt lgkmcnt(10)
    buffer_load_dwordx4 v6, s[24:27], s45 offen lds
    v_mfma_f32_16x16x32_bf16 v[136:139], a[208:211], v[64:67], v[136:139]
    ds_read_b64_tr_b16 a[232:233], v3 offset:37024
    v_cvt_pk_bf16_f32 v80, v32, v33
    v_mfma_f32_16x16x32_bf16 v[136:139], a[212:215], v[68:71], v[136:139]
    ds_read_b64_tr_b16 a[234:235], v3 offset:37536
    ds_read_b64_tr_b16 a[236:237], v3 offset:53920
    v_cvt_pk_bf16_f32 v81, v34, v35
    v_mfma_f32_16x16x32_bf16 v[168:171], a[208:211], v[72:75], v[168:171]
    s_add_u32 m0, s44, 128544
    ds_read_b64_tr_b16 a[238:239], v3 offset:54432
    v_fma_mix_f32 v36, v88, v16, v20 op_sel:[0,0,0] op_sel_hi:[1,0,0]
    v_mfma_f32_16x16x32_bf16 v[168:171], a[212:215], v[76:79], v[168:171]
    s_mov_b32 s45, 3416064
    s_waitcnt lgkmcnt(9)
    buffer_load_dwordx4 v6, s[24:27], s45 offen lds
    v_fma_mix_f32 v37, v88, v17, v21 op_sel:[1,0,0] op_sel_hi:[1,0,0]
    v_mfma_f32_16x16x32_bf16 v[140:143], a[216:219], v[64:67], v[140:143]
    ds_read_b64_tr_b16 a[240:241], v3 offset:37056
    v_fma_mix_f32 v38, v89, v18, v22 op_sel:[0,0,0] op_sel_hi:[1,0,0]
    v_mfma_f32_16x16x32_bf16 v[140:143], a[220:223], v[68:71], v[140:143]
    ds_read_b64_tr_b16 a[242:243], v3 offset:37568
    ds_read_b64_tr_b16 a[244:245], v3 offset:53952
    v_fma_mix_f32 v39, v89, v19, v23 op_sel:[1,0,0] op_sel_hi:[1,0,0]
    v_mfma_f32_16x16x32_bf16 v[172:175], a[216:219], v[72:75], v[172:175]
    s_add_u32 m0, s44, 129600
    ds_read_b64_tr_b16 a[246:247], v3 offset:54464
    v_cvt_pk_bf16_f32 v88, v36, v37
    v_mfma_f32_16x16x32_bf16 v[172:175], a[220:223], v[76:79], v[172:175]
    s_mov_b32 s45, 3424256
    s_waitcnt lgkmcnt(8)
    buffer_load_dwordx4 v6, s[24:27], s45 offen lds
    v_cvt_pk_bf16_f32 v89, v38, v39
    v_mfma_f32_16x16x32_bf16 v[144:147], a[224:227], v[64:67], v[144:147]
    ds_read_b64_tr_b16 a[248:249], v3 offset:37088
    ds_read_b128 v[16:19], v9 offset:12032
    v_mfma_f32_16x16x32_bf16 v[144:147], a[228:231], v[68:71], v[144:147]
    ds_read_b64_tr_b16 a[250:251], v3 offset:37600
    ds_read_b64_tr_b16 a[252:253], v3 offset:53984
    v_mfma_f32_16x16x32_bf16 v[176:179], a[224:227], v[72:75], v[176:179]
    s_add_u32 m0, s44, 130656
    ds_read_b64_tr_b16 a[254:255], v3 offset:54496
    ds_read_b128 v[20:23], v9 offset:12064
    v_mfma_f32_16x16x32_bf16 v[176:179], a[228:231], v[76:79], v[176:179]
    s_mov_b32 s45, 3432448
    s_waitcnt lgkmcnt(10)
    buffer_load_dwordx4 v6, s[24:27], s45 offen lds
    v_mfma_f32_16x16x32_bf16 v[148:151], a[232:235], v[64:67], v[148:151]
    ds_read_b64_tr_b16 a[192:193], v3 offset:37120
    v_fma_mix_f32 v32, v82, v24, v28 op_sel:[0,0,0] op_sel_hi:[1,0,0]
    v_mfma_f32_16x16x32_bf16 v[148:151], a[236:239], v[68:71], v[148:151]
    ds_read_b64_tr_b16 a[194:195], v3 offset:37632
    v_fma_mix_f32 v33, v82, v25, v29 op_sel:[1,0,0] op_sel_hi:[1,0,0]
    v_mfma_f32_16x16x32_bf16 v[180:183], a[232:235], v[72:75], v[180:183]
    ds_read_b64_tr_b16 a[196:197], v3 offset:54016
    v_fma_mix_f32 v34, v83, v26, v30 op_sel:[0,0,0] op_sel_hi:[1,0,0]
    v_mfma_f32_16x16x32_bf16 v[180:183], a[236:239], v[76:79], v[180:183]
    s_waitcnt lgkmcnt(9)
    ds_read_b64_tr_b16 a[198:199], v3 offset:54528
    v_fma_mix_f32 v35, v83, v27, v31 op_sel:[1,0,0] op_sel_hi:[1,0,0]
    v_mfma_f32_16x16x32_bf16 v[152:155], a[240:243], v[64:67], v[152:155]
    ds_read_b64_tr_b16 a[200:201], v3 offset:37152
    v_cvt_pk_bf16_f32 v82, v32, v33
    v_mfma_f32_16x16x32_bf16 v[152:155], a[244:247], v[68:71], v[152:155]
    ds_read_b64_tr_b16 a[202:203], v3 offset:37664
    v_cvt_pk_bf16_f32 v83, v34, v35
    v_mfma_f32_16x16x32_bf16 v[184:187], a[240:243], v[72:75], v[184:187]
    ds_read_b64_tr_b16 a[204:205], v3 offset:54048
    v_fma_mix_f32 v36, v90, v24, v28 op_sel:[0,0,0] op_sel_hi:[1,0,0]
    v_mfma_f32_16x16x32_bf16 v[184:187], a[244:247], v[76:79], v[184:187]
    s_waitcnt lgkmcnt(8)
    ds_read_b64_tr_b16 a[206:207], v3 offset:54560
    v_fma_mix_f32 v37, v90, v25, v29 op_sel:[1,0,0] op_sel_hi:[1,0,0]
    v_mfma_f32_16x16x32_bf16 v[156:159], a[248:251], v[64:67], v[156:159]
    ds_read_b64_tr_b16 a[208:209], v3 offset:37184
    v_fma_mix_f32 v38, v91, v26, v30 op_sel:[0,0,0] op_sel_hi:[1,0,0]
    v_mfma_f32_16x16x32_bf16 v[156:159], a[252:255], v[68:71], v[156:159]
    ds_read_b64_tr_b16 a[210:211], v3 offset:37696
    v_fma_mix_f32 v39, v91, v27, v31 op_sel:[1,0,0] op_sel_hi:[1,0,0]
    v_mfma_f32_16x16x32_bf16 v[188:191], a[248:251], v[72:75], v[188:191]
    ds_read_b64_tr_b16 a[212:213], v3 offset:54080
    v_cvt_pk_bf16_f32 v90, v36, v37
    v_mfma_f32_16x16x32_bf16 v[188:191], a[252:255], v[76:79], v[188:191]
    s_waitcnt lgkmcnt(7)
    ds_read_b64_tr_b16 a[214:215], v3 offset:54592
    v_cvt_pk_bf16_f32 v91, v38, v39
    v_mfma_f32_16x16x32_bf16 v[192:195], a[192:195], v[64:67], v[192:195]
    ds_read_b64_tr_b16 a[216:217], v3 offset:37216
    ds_read_b128 v[24:27], v9 offset:12048
    v_mfma_f32_16x16x32_bf16 v[192:195], a[196:199], v[68:71], v[192:195]
    ds_read_b64_tr_b16 a[218:219], v3 offset:37728
    ds_read_b64_tr_b16 a[220:221], v3 offset:54112
    v_fma_mix_f32 v32, v84, v16, v20 op_sel:[0,0,0] op_sel_hi:[1,0,0]
    v_mfma_f32_16x16x32_bf16 v[224:227], a[192:195], v[72:75], v[224:227]
    s_mov_b32 s54, 14336
    ds_read_b64_tr_b16 a[222:223], v3 offset:54624
    ds_read_b128 v[28:31], v9 offset:12080
    v_mfma_f32_16x16x32_bf16 v[224:227], a[196:199], v[76:79], v[224:227]
    s_waitcnt lgkmcnt(10)
    buffer_load_dwordx4 v[112:115], v8, s[32:35], s54 offen sc1
    v_mfma_f32_16x16x32_bf16 v[196:199], a[200:203], v[64:67], v[196:199]
    ds_read_b64_tr_b16 a[224:225], v3 offset:37248
    v_fma_mix_f32 v33, v84, v17, v21 op_sel:[1,0,0] op_sel_hi:[1,0,0]
    v_mfma_f32_16x16x32_bf16 v[196:199], a[204:207], v[68:71], v[196:199]
    ds_read_b64_tr_b16 a[226:227], v3 offset:37760
    ds_read_b64_tr_b16 a[228:229], v3 offset:54144
    v_fma_mix_f32 v34, v85, v18, v22 op_sel:[0,0,0] op_sel_hi:[1,0,0]
    v_mfma_f32_16x16x32_bf16 v[228:231], a[200:203], v[72:75], v[228:231]
    s_mov_b32 s54, 15360
    ds_read_b64_tr_b16 a[230:231], v3 offset:54656
    v_fma_mix_f32 v35, v85, v19, v23 op_sel:[1,0,0] op_sel_hi:[1,0,0]
    v_mfma_f32_16x16x32_bf16 v[228:231], a[204:207], v[76:79], v[228:231]
    s_waitcnt lgkmcnt(10)
    buffer_load_dwordx4 v[116:119], v8, s[32:35], s54 offen sc1
    v_mfma_f32_16x16x32_bf16 v[200:203], a[208:211], v[64:67], v[200:203]
    ds_read_b64_tr_b16 a[232:233], v3 offset:37280
    v_cvt_pk_bf16_f32 v84, v32, v33
    v_mfma_f32_16x16x32_bf16 v[200:203], a[212:215], v[68:71], v[200:203]
    ds_read_b64_tr_b16 a[234:235], v3 offset:37792
    ds_read_b64_tr_b16 a[236:237], v3 offset:54176
    v_cvt_pk_bf16_f32 v85, v34, v35
    v_mfma_f32_16x16x32_bf16 v[232:235], a[208:211], v[72:75], v[232:235]
    s_mov_b32 s54, 32768
    ds_read_b64_tr_b16 a[238:239], v3 offset:54688
    v_fma_mix_f32 v36, v92, v16, v20 op_sel:[0,0,0] op_sel_hi:[1,0,0]
    v_mfma_f32_16x16x32_bf16 v[232:235], a[212:215], v[76:79], v[232:235]
    s_waitcnt lgkmcnt(9)
    buffer_load_dwordx4 v[120:123], v8, s[32:35], s54 offen sc1
    v_fma_mix_f32 v37, v92, v17, v21 op_sel:[1,0,0] op_sel_hi:[1,0,0]
    v_mfma_f32_16x16x32_bf16 v[204:207], a[216:219], v[64:67], v[204:207]
    ds_read_b64_tr_b16 a[240:241], v3 offset:37312
    v_fma_mix_f32 v38, v93, v18, v22 op_sel:[0,0,0] op_sel_hi:[1,0,0]
    v_mfma_f32_16x16x32_bf16 v[204:207], a[220:223], v[68:71], v[204:207]
    ds_read_b64_tr_b16 a[242:243], v3 offset:37824
    ds_read_b64_tr_b16 a[244:245], v3 offset:54208
    v_fma_mix_f32 v39, v93, v19, v23 op_sel:[1,0,0] op_sel_hi:[1,0,0]
    v_mfma_f32_16x16x32_bf16 v[236:239], a[216:219], v[72:75], v[236:239]
    s_mov_b32 s54, 33792
    ds_read_b64_tr_b16 a[246:247], v3 offset:54720
    v_cvt_pk_bf16_f32 v92, v36, v37
    v_mfma_f32_16x16x32_bf16 v[236:239], a[220:223], v[76:79], v[236:239]
    s_waitcnt lgkmcnt(8)
    buffer_load_dwordx4 v[124:127], v8, s[32:35], s54 offen sc1
    v_cvt_pk_bf16_f32 v93, v38, v39
    v_mfma_f32_16x16x32_bf16 v[208:211], a[224:227], v[64:67], v[208:211]
    ds_read_b64_tr_b16 a[248:249], v3 offset:37344
    ds_read_b128 v[16:19], v9 offset:12288
    v_mfma_f32_16x16x32_bf16 v[208:211], a[228:231], v[68:71], v[208:211]
    ds_read_b64_tr_b16 a[250:251], v3 offset:37856
    ds_read_b128 v[20:23], v9 offset:12320
    v_mfma_f32_16x16x32_bf16 v[240:243], a[224:227], v[72:75], v[240:243]
    ds_read_b64_tr_b16 a[252:253], v3 offset:54240
    v_fma_mix_f32 v32, v86, v24, v28 op_sel:[0,0,0] op_sel_hi:[1,0,0]
    v_mfma_f32_16x16x32_bf16 v[240:243], a[228:231], v[76:79], v[240:243]
    s_waitcnt vmcnt(16)
    s_barrier
    s_waitcnt lgkmcnt(9)
    ds_read_b64_tr_b16 a[254:255], v3 offset:54752
    v_fma_mix_f32 v33, v86, v25, v29 op_sel:[1,0,0] op_sel_hi:[1,0,0]
    v_fma_mix_f32 v34, v87, v26, v30 op_sel:[0,0,0] op_sel_hi:[1,0,0]
    v_mfma_f32_16x16x32_bf16 v[212:215], a[232:235], v[64:67], v[212:215]
    ds_read_b64_tr_b16 a[192:193], v4 offset:0
    v_fma_mix_f32 v35, v87, v27, v31 op_sel:[1,0,0] op_sel_hi:[1,0,0]
    v_mfma_f32_16x16x32_bf16 v[212:215], a[236:239], v[68:71], v[212:215]
    ds_read_b64_tr_b16 a[194:195], v4 offset:512
    ds_read_b64_tr_b16 a[196:197], v4 offset:16896
    v_cvt_pk_bf16_f32 v86, v32, v33
    v_mfma_f32_16x16x32_bf16 v[244:247], a[232:235], v[72:75], v[244:247]
    s_add_u32 m0, s44, 0
    ds_read_b64_tr_b16 a[198:199], v4 offset:17408
    v_cvt_pk_bf16_f32 v87, v34, v35
    v_mfma_f32_16x16x32_bf16 v[244:247], a[236:239], v[76:79], v[244:247]
    s_mov_b32 s45, 3670016
    s_waitcnt lgkmcnt(10)
    buffer_load_dwordx4 v6, s[24:27], s45 offen lds
    v_mfma_f32_16x16x32_bf16 v[216:219], a[240:243], v[64:67], v[216:219]
    ds_read_b64_tr_b16 a[200:201], v4 offset:32
    v_fma_mix_f32 v36, v94, v24, v28 op_sel:[0,0,0] op_sel_hi:[1,0,0]
    v_mfma_f32_16x16x32_bf16 v[216:219], a[244:247], v[68:71], v[216:219]
    ds_read_b64_tr_b16 a[202:203], v4 offset:544
    ds_read_b64_tr_b16 a[204:205], v4 offset:16928
    v_fma_mix_f32 v37, v94, v25, v29 op_sel:[1,0,0] op_sel_hi:[1,0,0]
    v_mfma_f32_16x16x32_bf16 v[248:251], a[240:243], v[72:75], v[248:251]
    s_add_u32 m0, s44, 1056
    ds_read_b64_tr_b16 a[206:207], v4 offset:17440
    v_fma_mix_f32 v38, v95, v26, v30 op_sel:[0,0,0] op_sel_hi:[1,0,0]
    v_mfma_f32_16x16x32_bf16 v[248:251], a[244:247], v[76:79], v[248:251]
    s_mov_b32 s45, 3678208
    s_waitcnt lgkmcnt(8)
    buffer_load_dwordx4 v6, s[24:27], s45 offen lds
    v_mfma_f32_16x16x32_bf16 v[220:223], a[248:251], v[64:67], v[220:223]
    ds_read_b64_tr_b16 a[208:209], v4 offset:64
    v_fma_mix_f32 v39, v95, v27, v31 op_sel:[1,0,0] op_sel_hi:[1,0,0]
    v_mfma_f32_16x16x32_bf16 v[220:223], a[252:255], v[68:71], v[220:223]
    ds_read_b64_tr_b16 a[210:211], v4 offset:576
    ds_read_b64_tr_b16 a[212:213], v4 offset:16960
    v_cvt_pk_bf16_f32 v94, v36, v37
    v_mfma_f32_16x16x32_bf16 v[252:255], a[248:251], v[72:75], v[252:255]
    s_add_u32 m0, s44, 2112
    ds_read_b64_tr_b16 a[214:215], v4 offset:17472
    v_cvt_pk_bf16_f32 v95, v38, v39
    v_mfma_f32_16x16x32_bf16 v[252:255], a[252:255], v[76:79], v[252:255]
    s_mov_b32 s45, 3686400
    s_waitcnt lgkmcnt(8)
    buffer_load_dwordx4 v6, s[24:27], s45 offen lds
    v_mfma_f32_16x16x32_bf16 v[128:131], a[192:195], v[80:83], v[128:131]
    s_waitcnt vmcnt(15)
    ds_read_b64_tr_b16 a[216:217], v4 offset:96
    ds_read_b128 v[24:27], v9 offset:12304
    v_mfma_f32_16x16x32_bf16 v[128:131], a[196:199], v[84:87], v[128:131]
    ds_read_b64_tr_b16 a[218:219], v4 offset:608
    ds_read_b64_tr_b16 a[220:221], v4 offset:16992
    v_fma_mix_f32 v32, v96, v16, v20 op_sel:[0,0,0] op_sel_hi:[1,0,0]
    v_mfma_f32_16x16x32_bf16 v[160:163], a[192:195], v[88:91], v[160:163]
    s_add_u32 m0, s44, 3168
    ds_read_b64_tr_b16 a[222:223], v4 offset:17504
    ds_read_b128 v[28:31], v9 offset:12336
    v_mfma_f32_16x16x32_bf16 v[160:163], a[196:199], v[92:95], v[160:163]
    s_mov_b32 s45, 3694592
    s_waitcnt lgkmcnt(10)
    buffer_load_dwordx4 v6, s[24:27], s45 offen lds
    v_mfma_f32_16x16x32_bf16 v[132:135], a[200:203], v[80:83], v[132:135]
    ds_read_b64_tr_b16 a[224:225], v4 offset:128
    v_fma_mix_f32 v33, v96, v17, v21 op_sel:[1,0,0] op_sel_hi:[1,0,0]
    v_mfma_f32_16x16x32_bf16 v[132:135], a[204:207], v[84:87], v[132:135]
    ds_read_b64_tr_b16 a[226:227], v4 offset:640
    ds_read_b64_tr_b16 a[228:229], v4 offset:17024
    v_fma_mix_f32 v34, v97, v18, v22 op_sel:[0,0,0] op_sel_hi:[1,0,0]
    v_mfma_f32_16x16x32_bf16 v[164:167], a[200:203], v[88:91], v[164:167]
    s_add_u32 m0, s44, 16896
    ds_read_b64_tr_b16 a[230:231], v4 offset:17536
    v_fma_mix_f32 v35, v97, v19, v23 op_sel:[1,0,0] op_sel_hi:[1,0,0]
    v_mfma_f32_16x16x32_bf16 v[164:167], a[204:207], v[92:95], v[164:167]
    s_mov_b32 s45, 3932160
    s_waitcnt lgkmcnt(10)
    buffer_load_dwordx4 v6, s[24:27], s45 offen lds
    v_mfma_f32_16x16x32_bf16 v[136:139], a[208:211], v[80:83], v[136:139]
    ds_read_b64_tr_b16 a[232:233], v4 offset:160
    v_cvt_pk_bf16_f32 v96, v32, v33
    v_mfma_f32_16x16x32_bf16 v[136:139], a[212:215], v[84:87], v[136:139]
    ds_read_b64_tr_b16 a[234:235], v4 offset:672
    ds_read_b64_tr_b16 a[236:237], v4 offset:17056
    v_cvt_pk_bf16_f32 v97, v34, v35
    v_mfma_f32_16x16x32_bf16 v[168:171], a[208:211], v[88:91], v[168:171]
    s_add_u32 m0, s44, 17952
    ds_read_b64_tr_b16 a[238:239], v4 offset:17568
    v_fma_mix_f32 v36, v104, v16, v20 op_sel:[0,0,0] op_sel_hi:[1,0,0]
    v_mfma_f32_16x16x32_bf16 v[168:171], a[212:215], v[92:95], v[168:171]
    s_mov_b32 s45, 3940352
    s_waitcnt lgkmcnt(9)
    buffer_load_dwordx4 v6, s[24:27], s45 offen lds
    v_fma_mix_f32 v37, v104, v17, v21 op_sel:[1,0,0] op_sel_hi:[1,0,0]
    v_mfma_f32_16x16x32_bf16 v[140:143], a[216:219], v[80:83], v[140:143]
    ds_read_b64_tr_b16 a[240:241], v4 offset:192
    v_fma_mix_f32 v38, v105, v18, v22 op_sel:[0,0,0] op_sel_hi:[1,0,0]
    v_mfma_f32_16x16x32_bf16 v[140:143], a[220:223], v[84:87], v[140:143]
    ds_read_b64_tr_b16 a[242:243], v4 offset:704
    ds_read_b64_tr_b16 a[244:245], v4 offset:17088
    v_fma_mix_f32 v39, v105, v19, v23 op_sel:[1,0,0] op_sel_hi:[1,0,0]
    v_mfma_f32_16x16x32_bf16 v[172:175], a[216:219], v[88:91], v[172:175]
    s_add_u32 m0, s44, 19008
    ds_read_b64_tr_b16 a[246:247], v4 offset:17600
    v_cvt_pk_bf16_f32 v104, v36, v37
    v_mfma_f32_16x16x32_bf16 v[172:175], a[220:223], v[92:95], v[172:175]
    s_mov_b32 s45, 3948544
    s_waitcnt lgkmcnt(8)
    buffer_load_dwordx4 v6, s[24:27], s45 offen lds
    v_cvt_pk_bf16_f32 v105, v38, v39
    v_mfma_f32_16x16x32_bf16 v[144:147], a[224:227], v[80:83], v[144:147]
    ds_read_b64_tr_b16 a[248:249], v4 offset:224
    ds_read_b128 v[16:19], v9 offset:12544
    v_mfma_f32_16x16x32_bf16 v[144:147], a[228:231], v[84:87], v[144:147]
    ds_read_b64_tr_b16 a[250:251], v4 offset:736
    ds_read_b64_tr_b16 a[252:253], v4 offset:17120
    v_mfma_f32_16x16x32_bf16 v[176:179], a[224:227], v[88:91], v[176:179]
    s_add_u32 m0, s44, 20064
    ds_read_b64_tr_b16 a[254:255], v4 offset:17632
    ds_read_b128 v[20:23], v9 offset:12576
    v_mfma_f32_16x16x32_bf16 v[176:179], a[228:231], v[92:95], v[176:179]
    s_mov_b32 s45, 3956736
    s_waitcnt lgkmcnt(10)
    buffer_load_dwordx4 v6, s[24:27], s45 offen lds
    v_mfma_f32_16x16x32_bf16 v[148:151], a[232:235], v[80:83], v[148:151]
    ds_read_b64_tr_b16 a[192:193], v4 offset:256
    v_fma_mix_f32 v32, v98, v24, v28 op_sel:[0,0,0] op_sel_hi:[1,0,0]
    v_mfma_f32_16x16x32_bf16 v[148:151], a[236:239], v[84:87], v[148:151]
    ds_read_b64_tr_b16 a[194:195], v4 offset:768
    v_fma_mix_f32 v33, v98, v25, v29 op_sel:[1,0,0] op_sel_hi:[1,0,0]
    v_mfma_f32_16x16x32_bf16 v[180:183], a[232:235], v[88:91], v[180:183]
    ds_read_b64_tr_b16 a[196:197], v4 offset:17152
    v_fma_mix_f32 v34, v99, v26, v30 op_sel:[0,0,0] op_sel_hi:[1,0,0]
    v_mfma_f32_16x16x32_bf16 v[180:183], a[236:239], v[92:95], v[180:183]
    s_waitcnt lgkmcnt(9)
    ds_read_b64_tr_b16 a[198:199], v4 offset:17664
    v_fma_mix_f32 v35, v99, v27, v31 op_sel:[1,0,0] op_sel_hi:[1,0,0]
    v_mfma_f32_16x16x32_bf16 v[152:155], a[240:243], v[80:83], v[152:155]
    ds_read_b64_tr_b16 a[200:201], v4 offset:288
    v_cvt_pk_bf16_f32 v98, v32, v33
    v_mfma_f32_16x16x32_bf16 v[152:155], a[244:247], v[84:87], v[152:155]
    ds_read_b64_tr_b16 a[202:203], v4 offset:800
    v_cvt_pk_bf16_f32 v99, v34, v35
    v_mfma_f32_16x16x32_bf16 v[184:187], a[240:243], v[88:91], v[184:187]
    ds_read_b64_tr_b16 a[204:205], v4 offset:17184
    v_fma_mix_f32 v36, v106, v24, v28 op_sel:[0,0,0] op_sel_hi:[1,0,0]
    v_mfma_f32_16x16x32_bf16 v[184:187], a[244:247], v[92:95], v[184:187]
    s_waitcnt lgkmcnt(8)
    ds_read_b64_tr_b16 a[206:207], v4 offset:17696
    v_fma_mix_f32 v37, v106, v25, v29 op_sel:[1,0,0] op_sel_hi:[1,0,0]
    v_mfma_f32_16x16x32_bf16 v[156:159], a[248:251], v[80:83], v[156:159]
    ds_read_b64_tr_b16 a[208:209], v4 offset:320
    v_fma_mix_f32 v38, v107, v26, v30 op_sel:[0,0,0] op_sel_hi:[1,0,0]
    v_mfma_f32_16x16x32_bf16 v[156:159], a[252:255], v[84:87], v[156:159]
    ds_read_b64_tr_b16 a[210:211], v4 offset:832
    v_fma_mix_f32 v39, v107, v27, v31 op_sel:[1,0,0] op_sel_hi:[1,0,0]
    v_mfma_f32_16x16x32_bf16 v[188:191], a[248:251], v[88:91], v[188:191]
    ds_read_b64_tr_b16 a[212:213], v4 offset:17216
    v_cvt_pk_bf16_f32 v106, v36, v37
    v_mfma_f32_16x16x32_bf16 v[188:191], a[252:255], v[92:95], v[188:191]
    s_waitcnt lgkmcnt(7)
    ds_read_b64_tr_b16 a[214:215], v4 offset:17728
    v_cvt_pk_bf16_f32 v107, v38, v39
    v_mfma_f32_16x16x32_bf16 v[192:195], a[192:195], v[80:83], v[192:195]
    ds_read_b64_tr_b16 a[216:217], v4 offset:352
    ds_read_b128 v[24:27], v9 offset:12560
    v_mfma_f32_16x16x32_bf16 v[192:195], a[196:199], v[84:87], v[192:195]
    ds_read_b64_tr_b16 a[218:219], v4 offset:864
    ds_read_b64_tr_b16 a[220:221], v4 offset:17248
    v_fma_mix_f32 v32, v100, v16, v20 op_sel:[0,0,0] op_sel_hi:[1,0,0]
    v_mfma_f32_16x16x32_bf16 v[224:227], a[192:195], v[88:91], v[224:227]
    s_mov_b32 s54, 16384
    ds_read_b64_tr_b16 a[222:223], v4 offset:17760
    ds_read_b128 v[28:31], v9 offset:12592
    v_mfma_f32_16x16x32_bf16 v[224:227], a[196:199], v[92:95], v[224:227]
    s_waitcnt lgkmcnt(10)
    buffer_load_dwordx4 v[48:51], v8, s[32:35], s54 offen sc1
    v_mfma_f32_16x16x32_bf16 v[196:199], a[200:203], v[80:83], v[196:199]
    ds_read_b64_tr_b16 a[224:225], v4 offset:384
    v_fma_mix_f32 v33, v100, v17, v21 op_sel:[1,0,0] op_sel_hi:[1,0,0]
    v_mfma_f32_16x16x32_bf16 v[196:199], a[204:207], v[84:87], v[196:199]
    ds_read_b64_tr_b16 a[226:227], v4 offset:896
    ds_read_b64_tr_b16 a[228:229], v4 offset:17280
    v_fma_mix_f32 v34, v101, v18, v22 op_sel:[0,0,0] op_sel_hi:[1,0,0]
    v_mfma_f32_16x16x32_bf16 v[228:231], a[200:203], v[88:91], v[228:231]
    s_mov_b32 s54, 17408
    ds_read_b64_tr_b16 a[230:231], v4 offset:17792
    v_fma_mix_f32 v35, v101, v19, v23 op_sel:[1,0,0] op_sel_hi:[1,0,0]
    v_mfma_f32_16x16x32_bf16 v[228:231], a[204:207], v[92:95], v[228:231]
    s_waitcnt lgkmcnt(10)
    buffer_load_dwordx4 v[52:55], v8, s[32:35], s54 offen sc1
    v_mfma_f32_16x16x32_bf16 v[200:203], a[208:211], v[80:83], v[200:203]
    ds_read_b64_tr_b16 a[232:233], v4 offset:416
    v_cvt_pk_bf16_f32 v100, v32, v33
    v_mfma_f32_16x16x32_bf16 v[200:203], a[212:215], v[84:87], v[200:203]
    ds_read_b64_tr_b16 a[234:235], v4 offset:928
    ds_read_b64_tr_b16 a[236:237], v4 offset:17312
    v_cvt_pk_bf16_f32 v101, v34, v35
    v_mfma_f32_16x16x32_bf16 v[232:235], a[208:211], v[88:91], v[232:235]
    s_mov_b32 s54, 34816
    ds_read_b64_tr_b16 a[238:239], v4 offset:17824
    v_fma_mix_f32 v36, v108, v16, v20 op_sel:[0,0,0] op_sel_hi:[1,0,0]
    v_mfma_f32_16x16x32_bf16 v[232:235], a[212:215], v[92:95], v[232:235]
    s_waitcnt lgkmcnt(9)
    buffer_load_dwordx4 v[56:59], v8, s[32:35], s54 offen sc1
    v_fma_mix_f32 v37, v108, v17, v21 op_sel:[1,0,0] op_sel_hi:[1,0,0]
    v_mfma_f32_16x16x32_bf16 v[204:207], a[216:219], v[80:83], v[204:207]
    ds_read_b64_tr_b16 a[240:241], v4 offset:448
    v_fma_mix_f32 v38, v109, v18, v22 op_sel:[0,0,0] op_sel_hi:[1,0,0]
    v_mfma_f32_16x16x32_bf16 v[204:207], a[220:223], v[84:87], v[204:207]
    ds_read_b64_tr_b16 a[242:243], v4 offset:960
    ds_read_b64_tr_b16 a[244:245], v4 offset:17344
    v_fma_mix_f32 v39, v109, v19, v23 op_sel:[1,0,0] op_sel_hi:[1,0,0]
    v_mfma_f32_16x16x32_bf16 v[236:239], a[216:219], v[88:91], v[236:239]
    s_mov_b32 s54, 35840
    ds_read_b64_tr_b16 a[246:247], v4 offset:17856
    v_cvt_pk_bf16_f32 v108, v36, v37
    v_mfma_f32_16x16x32_bf16 v[236:239], a[220:223], v[92:95], v[236:239]
    s_waitcnt lgkmcnt(8)
    buffer_load_dwordx4 v[60:63], v8, s[32:35], s54 offen sc1
    v_cvt_pk_bf16_f32 v109, v38, v39
    v_mfma_f32_16x16x32_bf16 v[208:211], a[224:227], v[80:83], v[208:211]
    ds_read_b64_tr_b16 a[248:249], v4 offset:480
    ds_read_b128 v[16:19], v9 offset:12800
    v_mfma_f32_16x16x32_bf16 v[208:211], a[228:231], v[84:87], v[208:211]
    ds_read_b64_tr_b16 a[250:251], v4 offset:992
    ds_read_b128 v[20:23], v9 offset:12832
    v_mfma_f32_16x16x32_bf16 v[240:243], a[224:227], v[88:91], v[240:243]
    ds_read_b64_tr_b16 a[252:253], v4 offset:17376
    v_fma_mix_f32 v32, v102, v24, v28 op_sel:[0,0,0] op_sel_hi:[1,0,0]
    v_mfma_f32_16x16x32_bf16 v[240:243], a[228:231], v[92:95], v[240:243]
    s_waitcnt vmcnt(16)
    s_barrier
    s_waitcnt lgkmcnt(9)
    ds_read_b64_tr_b16 a[254:255], v4 offset:17888
    v_fma_mix_f32 v33, v102, v25, v29 op_sel:[1,0,0] op_sel_hi:[1,0,0]
    v_fma_mix_f32 v34, v103, v26, v30 op_sel:[0,0,0] op_sel_hi:[1,0,0]
    v_mfma_f32_16x16x32_bf16 v[212:215], a[232:235], v[80:83], v[212:215]
    ds_read_b64_tr_b16 a[192:193], v4 offset:36864
    v_fma_mix_f32 v35, v103, v27, v31 op_sel:[1,0,0] op_sel_hi:[1,0,0]
    v_mfma_f32_16x16x32_bf16 v[212:215], a[236:239], v[84:87], v[212:215]
    ds_read_b64_tr_b16 a[194:195], v4 offset:37376
    ds_read_b64_tr_b16 a[196:197], v4 offset:53760
    v_cvt_pk_bf16_f32 v102, v32, v33
    v_mfma_f32_16x16x32_bf16 v[244:247], a[232:235], v[88:91], v[244:247]
    s_add_u32 m0, s44, 36864
    ds_read_b64_tr_b16 a[198:199], v4 offset:54272
    v_cvt_pk_bf16_f32 v103, v34, v35
    v_mfma_f32_16x16x32_bf16 v[244:247], a[236:239], v[92:95], v[244:247]
    s_mov_b32 s45, 4194304
    s_waitcnt lgkmcnt(10)
    buffer_load_dwordx4 v6, s[24:27], s45 offen lds
    v_mfma_f32_16x16x32_bf16 v[216:219], a[240:243], v[80:83], v[216:219]
    ds_read_b64_tr_b16 a[200:201], v4 offset:36896
    v_fma_mix_f32 v36, v110, v24, v28 op_sel:[0,0,0] op_sel_hi:[1,0,0]
    v_mfma_f32_16x16x32_bf16 v[216:219], a[244:247], v[84:87], v[216:219]
    ds_read_b64_tr_b16 a[202:203], v4 offset:37408
    ds_read_b64_tr_b16 a[204:205], v4 offset:53792
    v_fma_mix_f32 v37, v110, v25, v29 op_sel:[1,0,0] op_sel_hi:[1,0,0]
    v_mfma_f32_16x16x32_bf16 v[248:251], a[240:243], v[88:91], v[248:251]
    s_add_u32 m0, s44, 37920
    ds_read_b64_tr_b16 a[206:207], v4 offset:54304
    v_fma_mix_f32 v38, v111, v26, v30 op_sel:[0,0,0] op_sel_hi:[1,0,0]
    v_mfma_f32_16x16x32_bf16 v[248:251], a[244:247], v[92:95], v[248:251]
    s_mov_b32 s45, 4202496
    s_waitcnt lgkmcnt(8)
    buffer_load_dwordx4 v6, s[24:27], s45 offen lds
    v_mfma_f32_16x16x32_bf16 v[220:223], a[248:251], v[80:83], v[220:223]
    ds_read_b64_tr_b16 a[208:209], v4 offset:36928
    v_fma_mix_f32 v39, v111, v27, v31 op_sel:[1,0,0] op_sel_hi:[1,0,0]
    v_mfma_f32_16x16x32_bf16 v[220:223], a[252:255], v[84:87], v[220:223]
    ds_read_b64_tr_b16 a[210:211], v4 offset:37440
    ds_read_b64_tr_b16 a[212:213], v4 offset:53824
    v_cvt_pk_bf16_f32 v110, v36, v37
    v_mfma_f32_16x16x32_bf16 v[252:255], a[248:251], v[88:91], v[252:255]
    s_add_u32 m0, s44, 38976
    ds_read_b64_tr_b16 a[214:215], v4 offset:54336
    v_cvt_pk_bf16_f32 v111, v38, v39
    v_mfma_f32_16x16x32_bf16 v[252:255], a[252:255], v[92:95], v[252:255]
    s_mov_b32 s45, 4210688
    s_waitcnt lgkmcnt(8)
    buffer_load_dwordx4 v6, s[24:27], s45 offen lds
    v_mfma_f32_16x16x32_bf16 v[128:131], a[192:195], v[96:99], v[128:131]
    s_waitcnt vmcnt(15)
    ds_read_b64_tr_b16 a[216:217], v4 offset:36960
    ds_read_b128 v[24:27], v9 offset:12816
    v_mfma_f32_16x16x32_bf16 v[128:131], a[196:199], v[100:103], v[128:131]
    ds_read_b64_tr_b16 a[218:219], v4 offset:37472
    ds_read_b64_tr_b16 a[220:221], v4 offset:53856
    v_fma_mix_f32 v32, v112, v16, v20 op_sel:[0,0,0] op_sel_hi:[1,0,0]
    v_mfma_f32_16x16x32_bf16 v[160:163], a[192:195], v[104:107], v[160:163]
    s_add_u32 m0, s44, 40032
    ds_read_b64_tr_b16 a[222:223], v4 offset:54368
    ds_read_b128 v[28:31], v9 offset:12848
    v_mfma_f32_16x16x32_bf16 v[160:163], a[196:199], v[108:111], v[160:163]
    s_mov_b32 s45, 4218880
    s_waitcnt lgkmcnt(10)
    buffer_load_dwordx4 v6, s[24:27], s45 offen lds
    v_mfma_f32_16x16x32_bf16 v[132:135], a[200:203], v[96:99], v[132:135]
    ds_read_b64_tr_b16 a[224:225], v4 offset:36992
    v_fma_mix_f32 v33, v112, v17, v21 op_sel:[1,0,0] op_sel_hi:[1,0,0]
    v_mfma_f32_16x16x32_bf16 v[132:135], a[204:207], v[100:103], v[132:135]
    ds_read_b64_tr_b16 a[226:227], v4 offset:37504
    ds_read_b64_tr_b16 a[228:229], v4 offset:53888
    v_fma_mix_f32 v34, v113, v18, v22 op_sel:[0,0,0] op_sel_hi:[1,0,0]
    v_mfma_f32_16x16x32_bf16 v[164:167], a[200:203], v[104:107], v[164:167]
    s_add_u32 m0, s44, 53760
    ds_read_b64_tr_b16 a[230:231], v4 offset:54400
    v_fma_mix_f32 v35, v113, v19, v23 op_sel:[1,0,0] op_sel_hi:[1,0,0]
    v_mfma_f32_16x16x32_bf16 v[164:167], a[204:207], v[108:111], v[164:167]
    s_mov_b32 s45, 4456448
    s_waitcnt lgkmcnt(10)
    buffer_load_dwordx4 v6, s[24:27], s45 offen lds
    v_mfma_f32_16x16x32_bf16 v[136:139], a[208:211], v[96:99], v[136:139]
    ds_read_b64_tr_b16 a[232:233], v4 offset:37024
    v_cvt_pk_bf16_f32 v112, v32, v33
    v_mfma_f32_16x16x32_bf16 v[136:139], a[212:215], v[100:103], v[136:139]
    ds_read_b64_tr_b16 a[234:235], v4 offset:37536
    ds_read_b64_tr_b16 a[236:237], v4 offset:53920
    v_cvt_pk_bf16_f32 v113, v34, v35
    v_mfma_f32_16x16x32_bf16 v[168:171], a[208:211], v[104:107], v[168:171]
    s_add_u32 m0, s44, 54816
    ds_read_b64_tr_b16 a[238:239], v4 offset:54432
    v_fma_mix_f32 v36, v120, v16, v20 op_sel:[0,0,0] op_sel_hi:[1,0,0]
    v_mfma_f32_16x16x32_bf16 v[168:171], a[212:215], v[108:111], v[168:171]
    s_mov_b32 s45, 4464640
    s_waitcnt lgkmcnt(9)
    buffer_load_dwordx4 v6, s[24:27], s45 offen lds
    v_fma_mix_f32 v37, v120, v17, v21 op_sel:[1,0,0] op_sel_hi:[1,0,0]
    v_mfma_f32_16x16x32_bf16 v[140:143], a[216:219], v[96:99], v[140:143]
    ds_read_b64_tr_b16 a[240:241], v4 offset:37056
    v_fma_mix_f32 v38, v121, v18, v22 op_sel:[0,0,0] op_sel_hi:[1,0,0]
    v_mfma_f32_16x16x32_bf16 v[140:143], a[220:223], v[100:103], v[140:143]
L2_pad2:
    s_cbranch_execz L2_pad6
    ds_read_b64_tr_b16 a[242:243], v4 offset:37568
    ds_read_b64_tr_b16 a[244:245], v4 offset:53952
    v_fma_mix_f32 v39, v121, v19, v23 op_sel:[1,0,0] op_sel_hi:[1,0,0]
    v_mfma_f32_16x16x32_bf16 v[172:175], a[216:219], v[104:107], v[172:175]
    s_add_u32 m0, s44, 55872
    ds_read_b64_tr_b16 a[246:247], v4 offset:54464
    v_cvt_pk_bf16_f32 v120, v36, v37
    v_mfma_f32_16x16x32_bf16 v[172:175], a[220:223], v[108:111], v[172:175]
    s_mov_b32 s45, 4472832
    s_waitcnt lgkmcnt(8)
    buffer_load_dwordx4 v6, s[24:27], s45 offen lds
    v_cvt_pk_bf16_f32 v121, v38, v39
    v_mfma_f32_16x16x32_bf16 v[144:147], a[224:227], v[96:99], v[144:147]
    ds_read_b64_tr_b16 a[248:249], v4 offset:37088
    ds_read_b128 v[16:19], v9 offset:13056
    v_mfma_f32_16x16x32_bf16 v[144:147], a[228:231], v[100:103], v[144:147]
    ds_read_b64_tr_b16 a[250:251], v4 offset:37600
    ds_read_b64_tr_b16 a[252:253], v4 offset:53984
    v_mfma_f32_16x16x32_bf16 v[176:179], a[224:227], v[104:107], v[176:179]
    s_add_u32 m0, s44, 56928
    ds_read_b64_tr_b16 a[254:255], v4 offset:54496
    ds_read_b128 v[20:23], v9 offset:13088
    v_mfma_f32_16x16x32_bf16 v[176:179], a[228:231], v[108:111], v[176:179]
    s_mov_b32 s45, 4481024
    s_waitcnt lgkmcnt(10)
    buffer_load_dwordx4 v6, s[24:27], s45 offen lds
    v_mfma_f32_16x16x32_bf16 v[148:151], a[232:235], v[96:99], v[148:151]
    ds_read_b64_tr_b16 a[192:193], v4 offset:37120
    v_fma_mix_f32 v32, v114, v24, v28 op_sel:[0,0,0] op_sel_hi:[1,0,0]
    v_mfma_f32_16x16x32_bf16 v[148:151], a[236:239], v[100:103], v[148:151]
    ds_read_b64_tr_b16 a[194:195], v4 offset:37632
    v_fma_mix_f32 v33, v114, v25, v29 op_sel:[1,0,0] op_sel_hi:[1,0,0]
    v_mfma_f32_16x16x32_bf16 v[180:183], a[232:235], v[104:107], v[180:183]
    ds_read_b64_tr_b16 a[196:197], v4 offset:54016
    v_fma_mix_f32 v34, v115, v26, v30 op_sel:[0,0,0] op_sel_hi:[1,0,0]
    v_mfma_f32_16x16x32_bf16 v[180:183], a[236:239], v[108:111], v[180:183]
    s_waitcnt lgkmcnt(9)
    ds_read_b64_tr_b16 a[198:199], v4 offset:54528
    v_fma_mix_f32 v35, v115, v27, v31 op_sel:[1,0,0] op_sel_hi:[1,0,0]
    v_mfma_f32_16x16x32_bf16 v[152:155], a[240:243], v[96:99], v[152:155]
    ds_read_b64_tr_b16 a[200:201], v4 offset:37152
    v_cvt_pk_bf16_f32 v114, v32, v33
    v_mfma_f32_16x16x32_bf16 v[152:155], a[244:247], v[100:103], v[152:155]
    ds_read_b64_tr_b16 a[202:203], v4 offset:37664
    v_cvt_pk_bf16_f32 v115, v34, v35
    v_mfma_f32_16x16x32_bf16 v[184:187], a[240:243], v[104:107], v[184:187]
    ds_read_b64_tr_b16 a[204:205], v4 offset:54048
    v_fma_mix_f32 v36, v122, v24, v28 op_sel:[0,0,0] op_sel_hi:[1,0,0]
    v_mfma_f32_16x16x32_bf16 v[184:187], a[244:247], v[108:111], v[184:187]
    s_waitcnt lgkmcnt(8)
    ds_read_b64_tr_b16 a[206:207], v4 offset:54560
    v_fma_mix_f32 v37, v122, v25, v29 op_sel:[1,0,0] op_sel_hi:[1,0,0]
    v_mfma_f32_16x16x32_bf16 v[156:159], a[248:251], v[96:99], v[156:159]
    ds_read_b64_tr_b16 a[208:209], v4 offset:37184
    v_fma_mix_f32 v38, v123, v26, v30 op_sel:[0,0,0] op_sel_hi:[1,0,0]
    v_mfma_f32_16x16x32_bf16 v[156:159], a[252:255], v[100:103], v[156:159]
    ds_read_b64_tr_b16 a[210:211], v4 offset:37696
    v_fma_mix_f32 v39, v123, v27, v31 op_sel:[1,0,0] op_sel_hi:[1,0,0]
    v_mfma_f32_16x16x32_bf16 v[188:191], a[248:251], v[104:107], v[188:191]
    ds_read_b64_tr_b16 a[212:213], v4 offset:54080
    v_cvt_pk_bf16_f32 v122, v36, v37
    v_mfma_f32_16x16x32_bf16 v[188:191], a[252:255], v[108:111], v[188:191]
    s_waitcnt lgkmcnt(7)
    ds_read_b64_tr_b16 a[214:215], v4 offset:54592
    v_cvt_pk_bf16_f32 v123, v38, v39
    v_mfma_f32_16x16x32_bf16 v[192:195], a[192:195], v[96:99], v[192:195]
    ds_read_b64_tr_b16 a[216:217], v4 offset:37216
    ds_read_b128 v[24:27], v9 offset:13072
    v_mfma_f32_16x16x32_bf16 v[192:195], a[196:199], v[100:103], v[192:195]
    ds_read_b64_tr_b16 a[218:219], v4 offset:37728
    ds_read_b128 v[28:31], v9 offset:13104
    v_mfma_f32_16x16x32_bf16 v[224:227], a[192:195], v[104:107], v[224:227]
    ds_read_b64_tr_b16 a[220:221], v4 offset:54112
    v_fma_mix_f32 v32, v116, v16, v20 op_sel:[0,0,0] op_sel_hi:[1,0,0]
    v_mfma_f32_16x16x32_bf16 v[224:227], a[196:199], v[108:111], v[224:227]
    s_waitcnt lgkmcnt(9)
    ds_read_b64_tr_b16 a[222:223], v4 offset:54624
    v_fma_mix_f32 v33, v116, v17, v21 op_sel:[1,0,0] op_sel_hi:[1,0,0]
    v_mfma_f32_16x16x32_bf16 v[196:199], a[200:203], v[96:99], v[196:199]
    ds_read_b64_tr_b16 a[224:225], v4 offset:37248
    v_fma_mix_f32 v34, v117, v18, v22 op_sel:[0,0,0] op_sel_hi:[1,0,0]
    v_mfma_f32_16x16x32_bf16 v[196:199], a[204:207], v[100:103], v[196:199]
    ds_read_b64_tr_b16 a[226:227], v4 offset:37760
    v_fma_mix_f32 v35, v117, v19, v23 op_sel:[1,0,0] op_sel_hi:[1,0,0]
    v_mfma_f32_16x16x32_bf16 v[228:231], a[200:203], v[104:107], v[228:231]
    ds_read_b64_tr_b16 a[228:229], v4 offset:54144
    v_cvt_pk_bf16_f32 v116, v32, v33
    v_mfma_f32_16x16x32_bf16 v[228:231], a[204:207], v[108:111], v[228:231]
    s_waitcnt lgkmcnt(9)
    ds_read_b64_tr_b16 a[230:231], v4 offset:54656
    v_cvt_pk_bf16_f32 v117, v34, v35
    v_mfma_f32_16x16x32_bf16 v[200:203], a[208:211], v[96:99], v[200:203]
    ds_read_b64_tr_b16 a[232:233], v4 offset:37280
    v_fma_mix_f32 v36, v124, v16, v20 op_sel:[0,0,0] op_sel_hi:[1,0,0]
    v_mfma_f32_16x16x32_bf16 v[200:203], a[212:215], v[100:103], v[200:203]
    ds_read_b64_tr_b16 a[234:235], v4 offset:37792
    v_fma_mix_f32 v37, v124, v17, v21 op_sel:[1,0,0] op_sel_hi:[1,0,0]
    v_mfma_f32_16x16x32_bf16 v[232:235], a[208:211], v[104:107], v[232:235]
    ds_read_b64_tr_b16 a[236:237], v4 offset:54176
    v_fma_mix_f32 v38, v125, v18, v22 op_sel:[0,0,0] op_sel_hi:[1,0,0]
    v_mfma_f32_16x16x32_bf16 v[232:235], a[212:215], v[108:111], v[232:235]
    s_waitcnt lgkmcnt(7)
    ds_read_b64_tr_b16 a[238:239], v4 offset:54688
    v_fma_mix_f32 v39, v125, v19, v23 op_sel:[1,0,0] op_sel_hi:[1,0,0]
    v_mfma_f32_16x16x32_bf16 v[204:207], a[216:219], v[96:99], v[204:207]
    ds_read_b64_tr_b16 a[240:241], v4 offset:37312
    v_cvt_pk_bf16_f32 v124, v36, v37
    v_mfma_f32_16x16x32_bf16 v[204:207], a[220:223], v[100:103], v[204:207]
    ds_read_b64_tr_b16 a[242:243], v4 offset:37824
    v_cvt_pk_bf16_f32 v125, v38, v39
    v_mfma_f32_16x16x32_bf16 v[236:239], a[216:219], v[104:107], v[236:239]
    ds_read_b64_tr_b16 a[244:245], v4 offset:54208
    v_mfma_f32_16x16x32_bf16 v[236:239], a[220:223], v[108:111], v[236:239]
    s_waitcnt lgkmcnt(7)
    ds_read_b64_tr_b16 a[246:247], v4 offset:54720
    v_mfma_f32_16x16x32_bf16 v[208:211], a[224:227], v[96:99], v[208:211]
    ds_read_b64_tr_b16 a[248:249], v4 offset:37344
    ds_read_b128 v[16:19], v9 offset:13312
    v_mfma_f32_16x16x32_bf16 v[208:211], a[228:231], v[100:103], v[208:211]
    ds_read_b64_tr_b16 a[250:251], v4 offset:37856
    ds_read_b128 v[20:23], v9 offset:13344
    v_mfma_f32_16x16x32_bf16 v[240:243], a[224:227], v[104:107], v[240:243]
    ds_read_b64_tr_b16 a[252:253], v4 offset:54240
    v_fma_mix_f32 v32, v118, v24, v28 op_sel:[0,0,0] op_sel_hi:[1,0,0]
    v_mfma_f32_16x16x32_bf16 v[240:243], a[228:231], v[108:111], v[240:243]
    s_waitcnt vmcnt(12)
    s_barrier
    s_waitcnt lgkmcnt(9)
    ds_read_b64_tr_b16 a[254:255], v4 offset:54752
    v_fma_mix_f32 v33, v118, v25, v29 op_sel:[1,0,0] op_sel_hi:[1,0,0]
    v_fma_mix_f32 v34, v119, v26, v30 op_sel:[0,0,0] op_sel_hi:[1,0,0]
    v_mfma_f32_16x16x32_bf16 v[212:215], a[232:235], v[96:99], v[212:215]
    ds_read_b64_tr_b16 a[192:193], v3 offset:0
    v_fma_mix_f32 v35, v119, v27, v31 op_sel:[1,0,0] op_sel_hi:[1,0,0]
    v_mfma_f32_16x16x32_bf16 v[212:215], a[236:239], v[100:103], v[212:215]
    ds_read_b64_tr_b16 a[194:195], v3 offset:512
    ds_read_b64_tr_b16 a[196:197], v3 offset:16896
    v_cvt_pk_bf16_f32 v118, v32, v33
    v_mfma_f32_16x16x32_bf16 v[244:247], a[232:235], v[104:107], v[244:247]
    s_add_u32 m0, s44, 73728
    ds_read_b64_tr_b16 a[198:199], v3 offset:17408
    v_cvt_pk_bf16_f32 v119, v34, v35
    v_mfma_f32_16x16x32_bf16 v[244:247], a[236:239], v[108:111], v[244:247]
    s_mov_b32 s46, 0
    s_waitcnt lgkmcnt(10)
    buffer_load_dwordx4 v5, s[16:19], s46 offen offset:0 lds
    v_mfma_f32_16x16x32_bf16 v[216:219], a[240:243], v[96:99], v[216:219]
    ds_read_b64_tr_b16 a[200:201], v3 offset:32
    v_fma_mix_f32 v36, v126, v24, v28 op_sel:[0,0,0] op_sel_hi:[1,0,0]
    v_mfma_f32_16x16x32_bf16 v[216:219], a[244:247], v[100:103], v[216:219]
    ds_read_b64_tr_b16 a[202:203], v3 offset:544
    ds_read_b64_tr_b16 a[204:205], v3 offset:16928
    v_fma_mix_f32 v37, v126, v25, v29 op_sel:[1,0,0] op_sel_hi:[1,0,0]
    v_mfma_f32_16x16x32_bf16 v[248:251], a[240:243], v[104:107], v[248:251]
    s_add_u32 m0, s44, 73760
    ds_read_b64_tr_b16 a[206:207], v3 offset:17440
    v_fma_mix_f32 v38, v127, v26, v30 op_sel:[0,0,0] op_sel_hi:[1,0,0]
    v_mfma_f32_16x16x32_bf16 v[248:251], a[244:247], v[108:111], v[248:251]
    s_waitcnt lgkmcnt(8)
    buffer_load_dwordx4 v5, s[16:19], s46 offen offset:1024 lds
    v_mfma_f32_16x16x32_bf16 v[220:223], a[248:251], v[96:99], v[220:223]
    ds_read_b64_tr_b16 a[208:209], v3 offset:64
    v_fma_mix_f32 v39, v127, v27, v31 op_sel:[1,0,0] op_sel_hi:[1,0,0]
    v_mfma_f32_16x16x32_bf16 v[220:223], a[252:255], v[100:103], v[220:223]
    ds_read_b64_tr_b16 a[210:211], v3 offset:576
    ds_read_b64_tr_b16 a[212:213], v3 offset:16960
    v_cvt_pk_bf16_f32 v126, v36, v37
    v_mfma_f32_16x16x32_bf16 v[252:255], a[248:251], v[104:107], v[252:255]
    s_add_u32 m0, s44, 73792
    ds_read_b64_tr_b16 a[214:215], v3 offset:17472
    v_cvt_pk_bf16_f32 v127, v38, v39
    v_mfma_f32_16x16x32_bf16 v[252:255], a[252:255], v[108:111], v[252:255]
    s_waitcnt lgkmcnt(8)
    buffer_load_dwordx4 v5, s[16:19], s46 offen offset:2048 lds
    v_mfma_f32_16x16x32_bf16 v[128:131], a[192:195], v[112:115], v[128:131]
    s_waitcnt vmcnt(11)
    ds_read_b64_tr_b16 a[216:217], v3 offset:96
    ds_read_b128 v[24:27], v9 offset:13328
    v_mfma_f32_16x16x32_bf16 v[128:131], a[196:199], v[116:119], v[128:131]
    ds_read_b64_tr_b16 a[218:219], v3 offset:608
    ds_read_b64_tr_b16 a[220:221], v3 offset:16992
    v_fma_mix_f32 v32, v48, v16, v20 op_sel:[0,0,0] op_sel_hi:[1,0,0]
    v_mfma_f32_16x16x32_bf16 v[160:163], a[192:195], v[120:123], v[160:163]
    s_add_u32 m0, s44, 73824
    ds_read_b64_tr_b16 a[222:223], v3 offset:17504
    ds_read_b128 v[28:31], v9 offset:13360
    v_mfma_f32_16x16x32_bf16 v[160:163], a[196:199], v[124:127], v[160:163]
    s_waitcnt lgkmcnt(10)
    buffer_load_dwordx4 v5, s[16:19], s46 offen offset:3072 lds
    v_mfma_f32_16x16x32_bf16 v[132:135], a[200:203], v[112:115], v[132:135]
    ds_read_b64_tr_b16 a[224:225], v3 offset:128
    v_fma_mix_f32 v33, v48, v17, v21 op_sel:[1,0,0] op_sel_hi:[1,0,0]
    v_mfma_f32_16x16x32_bf16 v[132:135], a[204:207], v[116:119], v[132:135]
    ds_read_b64_tr_b16 a[226:227], v3 offset:640
    ds_read_b64_tr_b16 a[228:229], v3 offset:17024
    v_fma_mix_f32 v34, v49, v18, v22 op_sel:[0,0,0] op_sel_hi:[1,0,0]
    v_mfma_f32_16x16x32_bf16 v[164:167], a[200:203], v[120:123], v[164:167]
    s_add_u32 m0, s44, 90624
    ds_read_b64_tr_b16 a[230:231], v3 offset:17536
    v_fma_mix_f32 v35, v49, v19, v23 op_sel:[1,0,0] op_sel_hi:[1,0,0]
    v_mfma_f32_16x16x32_bf16 v[164:167], a[204:207], v[124:127], v[164:167]
    s_waitcnt lgkmcnt(10)
    buffer_load_dwordx4 v5, s[20:23], s46 offen offset:0 lds
    v_mfma_f32_16x16x32_bf16 v[136:139], a[208:211], v[112:115], v[136:139]
    ds_read_b64_tr_b16 a[232:233], v3 offset:160
    v_cvt_pk_bf16_f32 v48, v32, v33
    v_mfma_f32_16x16x32_bf16 v[136:139], a[212:215], v[116:119], v[136:139]
    ds_read_b64_tr_b16 a[234:235], v3 offset:672
    ds_read_b64_tr_b16 a[236:237], v3 offset:17056
    v_cvt_pk_bf16_f32 v49, v34, v35
    v_mfma_f32_16x16x32_bf16 v[168:171], a[208:211], v[120:123], v[168:171]
    s_add_u32 m0, s44, 90656
    ds_read_b64_tr_b16 a[238:239], v3 offset:17568
    v_fma_mix_f32 v36, v56, v16, v20 op_sel:[0,0,0] op_sel_hi:[1,0,0]
    v_mfma_f32_16x16x32_bf16 v[168:171], a[212:215], v[124:127], v[168:171]
    s_waitcnt lgkmcnt(9)
    buffer_load_dwordx4 v5, s[20:23], s46 offen offset:1024 lds
    v_fma_mix_f32 v37, v56, v17, v21 op_sel:[1,0,0] op_sel_hi:[1,0,0]
    v_mfma_f32_16x16x32_bf16 v[140:143], a[216:219], v[112:115], v[140:143]
    ds_read_b64_tr_b16 a[240:241], v3 offset:192
    v_fma_mix_f32 v38, v57, v18, v22 op_sel:[0,0,0] op_sel_hi:[1,0,0]
    v_mfma_f32_16x16x32_bf16 v[140:143], a[220:223], v[116:119], v[140:143]
    ds_read_b64_tr_b16 a[242:243], v3 offset:704
    ds_read_b64_tr_b16 a[244:245], v3 offset:17088
    v_fma_mix_f32 v39, v57, v19, v23 op_sel:[1,0,0] op_sel_hi:[1,0,0]
    v_mfma_f32_16x16x32_bf16 v[172:175], a[216:219], v[120:123], v[172:175]
    s_add_u32 m0, s44, 90688
    ds_read_b64_tr_b16 a[246:247], v3 offset:17600
    v_cvt_pk_bf16_f32 v56, v36, v37
    v_mfma_f32_16x16x32_bf16 v[172:175], a[220:223], v[124:127], v[172:175]
    s_waitcnt lgkmcnt(8)
    buffer_load_dwordx4 v5, s[20:23], s46 offen offset:2048 lds
    v_cvt_pk_bf16_f32 v57, v38, v39
    v_mfma_f32_16x16x32_bf16 v[144:147], a[224:227], v[112:115], v[144:147]
    ds_read_b64_tr_b16 a[248:249], v3 offset:224
    ds_read_b128 v[16:19], v9 offset:13568
    v_mfma_f32_16x16x32_bf16 v[144:147], a[228:231], v[116:119], v[144:147]
    ds_read_b64_tr_b16 a[250:251], v3 offset:736
    ds_read_b64_tr_b16 a[252:253], v3 offset:17120
    v_mfma_f32_16x16x32_bf16 v[176:179], a[224:227], v[120:123], v[176:179]
    s_add_u32 m0, s44, 90720
    ds_read_b64_tr_b16 a[254:255], v3 offset:17632
    ds_read_b128 v[20:23], v9 offset:13600
    v_mfma_f32_16x16x32_bf16 v[176:179], a[228:231], v[124:127], v[176:179]
    s_waitcnt lgkmcnt(10)
    buffer_load_dwordx4 v5, s[20:23], s46 offen offset:3072 lds
    v_mfma_f32_16x16x32_bf16 v[148:151], a[232:235], v[112:115], v[148:151]
    ds_read_b64_tr_b16 a[192:193], v3 offset:256
    v_fma_mix_f32 v32, v50, v24, v28 op_sel:[0,0,0] op_sel_hi:[1,0,0]
    v_mfma_f32_16x16x32_bf16 v[148:151], a[236:239], v[116:119], v[148:151]
    ds_read_b64_tr_b16 a[194:195], v3 offset:768
    v_fma_mix_f32 v33, v50, v25, v29 op_sel:[1,0,0] op_sel_hi:[1,0,0]
    v_mfma_f32_16x16x32_bf16 v[180:183], a[232:235], v[120:123], v[180:183]
    ds_read_b64_tr_b16 a[196:197], v3 offset:17152
    v_fma_mix_f32 v34, v51, v26, v30 op_sel:[0,0,0] op_sel_hi:[1,0,0]
    v_mfma_f32_16x16x32_bf16 v[180:183], a[236:239], v[124:127], v[180:183]
    s_waitcnt lgkmcnt(9)
    ds_read_b64_tr_b16 a[198:199], v3 offset:17664
    v_fma_mix_f32 v35, v51, v27, v31 op_sel:[1,0,0] op_sel_hi:[1,0,0]
    v_mfma_f32_16x16x32_bf16 v[152:155], a[240:243], v[112:115], v[152:155]
    ds_read_b64_tr_b16 a[200:201], v3 offset:288
    v_cvt_pk_bf16_f32 v50, v32, v33
    v_mfma_f32_16x16x32_bf16 v[152:155], a[244:247], v[116:119], v[152:155]
    ds_read_b64_tr_b16 a[202:203], v3 offset:800
    v_cvt_pk_bf16_f32 v51, v34, v35
    v_mfma_f32_16x16x32_bf16 v[184:187], a[240:243], v[120:123], v[184:187]
    ds_read_b64_tr_b16 a[204:205], v3 offset:17184
    v_fma_mix_f32 v36, v58, v24, v28 op_sel:[0,0,0] op_sel_hi:[1,0,0]
    v_mfma_f32_16x16x32_bf16 v[184:187], a[244:247], v[124:127], v[184:187]
    s_waitcnt lgkmcnt(8)
    ds_read_b64_tr_b16 a[206:207], v3 offset:17696
    v_fma_mix_f32 v37, v58, v25, v29 op_sel:[1,0,0] op_sel_hi:[1,0,0]
    v_mfma_f32_16x16x32_bf16 v[156:159], a[248:251], v[112:115], v[156:159]
    ds_read_b64_tr_b16 a[208:209], v3 offset:320
    v_fma_mix_f32 v38, v59, v26, v30 op_sel:[0,0,0] op_sel_hi:[1,0,0]
    v_mfma_f32_16x16x32_bf16 v[156:159], a[252:255], v[116:119], v[156:159]
    ds_read_b64_tr_b16 a[210:211], v3 offset:832
    v_fma_mix_f32 v39, v59, v27, v31 op_sel:[1,0,0] op_sel_hi:[1,0,0]
    v_mfma_f32_16x16x32_bf16 v[188:191], a[248:251], v[120:123], v[188:191]
    ds_read_b64_tr_b16 a[212:213], v3 offset:17216
    v_cvt_pk_bf16_f32 v58, v36, v37
    v_mfma_f32_16x16x32_bf16 v[188:191], a[252:255], v[124:127], v[188:191]
    s_waitcnt lgkmcnt(7)
    ds_read_b64_tr_b16 a[214:215], v3 offset:17728
    v_cvt_pk_bf16_f32 v59, v38, v39
    v_mfma_f32_16x16x32_bf16 v[192:195], a[192:195], v[112:115], v[192:195]
    ds_read_b64_tr_b16 a[216:217], v3 offset:352
    ds_read_b128 v[24:27], v9 offset:13584
    v_mfma_f32_16x16x32_bf16 v[192:195], a[196:199], v[116:119], v[192:195]
    ds_read_b64_tr_b16 a[218:219], v3 offset:864
    ds_read_b128 v[28:31], v9 offset:13616
    v_mfma_f32_16x16x32_bf16 v[224:227], a[192:195], v[120:123], v[224:227]
    ds_read_b64_tr_b16 a[220:221], v3 offset:17248
    v_fma_mix_f32 v32, v52, v16, v20 op_sel:[0,0,0] op_sel_hi:[1,0,0]
    v_mfma_f32_16x16x32_bf16 v[224:227], a[196:199], v[124:127], v[224:227]
    s_waitcnt lgkmcnt(9)
    ds_read_b64_tr_b16 a[222:223], v3 offset:17760
    v_fma_mix_f32 v33, v52, v17, v21 op_sel:[1,0,0] op_sel_hi:[1,0,0]
    v_mfma_f32_16x16x32_bf16 v[196:199], a[200:203], v[112:115], v[196:199]
    ds_read_b64_tr_b16 a[224:225], v3 offset:384
    v_fma_mix_f32 v34, v53, v18, v22 op_sel:[0,0,0] op_sel_hi:[1,0,0]
    v_mfma_f32_16x16x32_bf16 v[196:199], a[204:207], v[116:119], v[196:199]
    ds_read_b64_tr_b16 a[226:227], v3 offset:896
    v_fma_mix_f32 v35, v53, v19, v23 op_sel:[1,0,0] op_sel_hi:[1,0,0]
    v_mfma_f32_16x16x32_bf16 v[228:231], a[200:203], v[120:123], v[228:231]
    ds_read_b64_tr_b16 a[228:229], v3 offset:17280
    v_cvt_pk_bf16_f32 v52, v32, v33
    v_mfma_f32_16x16x32_bf16 v[228:231], a[204:207], v[124:127], v[228:231]
    s_waitcnt lgkmcnt(9)
    ds_read_b64_tr_b16 a[230:231], v3 offset:17792
    v_cvt_pk_bf16_f32 v53, v34, v35
    v_mfma_f32_16x16x32_bf16 v[200:203], a[208:211], v[112:115], v[200:203]
    ds_read_b64_tr_b16 a[232:233], v3 offset:416
    v_fma_mix_f32 v36, v60, v16, v20 op_sel:[0,0,0] op_sel_hi:[1,0,0]
    v_mfma_f32_16x16x32_bf16 v[200:203], a[212:215], v[116:119], v[200:203]
    ds_read_b64_tr_b16 a[234:235], v3 offset:928
    v_fma_mix_f32 v37, v60, v17, v21 op_sel:[1,0,0] op_sel_hi:[1,0,0]
    v_mfma_f32_16x16x32_bf16 v[232:235], a[208:211], v[120:123], v[232:235]
    ds_read_b64_tr_b16 a[236:237], v3 offset:17312
    v_fma_mix_f32 v38, v61, v18, v22 op_sel:[0,0,0] op_sel_hi:[1,0,0]
    v_mfma_f32_16x16x32_bf16 v[232:235], a[212:215], v[124:127], v[232:235]
    s_waitcnt lgkmcnt(7)
    ds_read_b64_tr_b16 a[238:239], v3 offset:17824
    v_fma_mix_f32 v39, v61, v19, v23 op_sel:[1,0,0] op_sel_hi:[1,0,0]
    v_mfma_f32_16x16x32_bf16 v[204:207], a[216:219], v[112:115], v[204:207]
    ds_read_b64_tr_b16 a[240:241], v3 offset:448
    v_cvt_pk_bf16_f32 v60, v36, v37
    v_mfma_f32_16x16x32_bf16 v[204:207], a[220:223], v[116:119], v[204:207]
    ds_read_b64_tr_b16 a[242:243], v3 offset:960
    v_cvt_pk_bf16_f32 v61, v38, v39
    v_mfma_f32_16x16x32_bf16 v[236:239], a[216:219], v[120:123], v[236:239]
    ds_read_b64_tr_b16 a[244:245], v3 offset:17344
    v_mfma_f32_16x16x32_bf16 v[236:239], a[220:223], v[124:127], v[236:239]
    s_waitcnt lgkmcnt(7)
    ds_read_b64_tr_b16 a[246:247], v3 offset:17856
    v_mfma_f32_16x16x32_bf16 v[208:211], a[224:227], v[112:115], v[208:211]
    ds_read_b64_tr_b16 a[248:249], v3 offset:480
    v_fma_mix_f32 v32, v54, v24, v28 op_sel:[0,0,0] op_sel_hi:[1,0,0]
    v_mfma_f32_16x16x32_bf16 v[208:211], a[228:231], v[116:119], v[208:211]
    ds_read_b64_tr_b16 a[250:251], v3 offset:992
    v_fma_mix_f32 v33, v54, v25, v29 op_sel:[1,0,0] op_sel_hi:[1,0,0]
    v_mfma_f32_16x16x32_bf16 v[240:243], a[224:227], v[120:123], v[240:243]
    ds_read_b64_tr_b16 a[252:253], v3 offset:17376
    v_fma_mix_f32 v34, v55, v26, v30 op_sel:[0,0,0] op_sel_hi:[1,0,0]
    v_mfma_f32_16x16x32_bf16 v[240:243], a[228:231], v[124:127], v[240:243]
    s_waitcnt vmcnt(8)
    s_barrier
    s_waitcnt lgkmcnt(7)
    ds_read_b64_tr_b16 a[254:255], v3 offset:17888
    v_fma_mix_f32 v35, v55, v27, v31 op_sel:[1,0,0] op_sel_hi:[1,0,0]
    v_mfma_f32_16x16x32_bf16 v[212:215], a[232:235], v[112:115], v[212:215]
    ds_read_b64_tr_b16 a[192:193], v3 offset:36864
    v_cvt_pk_bf16_f32 v54, v32, v33
    v_mfma_f32_16x16x32_bf16 v[212:215], a[236:239], v[116:119], v[212:215]
    ds_read_b64_tr_b16 a[194:195], v3 offset:37376
    ds_read_b64_tr_b16 a[196:197], v3 offset:53760
    v_mfma_f32_16x16x32_bf16 v[244:247], a[232:235], v[120:123], v[244:247]
    s_add_u32 m0, s44, 110592
    ds_read_b64_tr_b16 a[198:199], v3 offset:54272
    v_cvt_pk_bf16_f32 v55, v34, v35
    v_mfma_f32_16x16x32_bf16 v[244:247], a[236:239], v[124:127], v[244:247]
    s_mov_b32 s46, 16384
    s_waitcnt lgkmcnt(8)
    buffer_load_dwordx4 v5, s[16:19], s46 offen offset:0 lds
    v_mfma_f32_16x16x32_bf16 v[216:219], a[240:243], v[112:115], v[216:219]
    ds_read_b64_tr_b16 a[200:201], v3 offset:36896
    v_fma_mix_f32 v36, v62, v24, v28 op_sel:[0,0,0] op_sel_hi:[1,0,0]
    v_mfma_f32_16x16x32_bf16 v[216:219], a[244:247], v[116:119], v[216:219]
    ds_read_b64_tr_b16 a[202:203], v3 offset:37408
    ds_read_b64_tr_b16 a[204:205], v3 offset:53792
    v_fma_mix_f32 v37, v62, v25, v29 op_sel:[1,0,0] op_sel_hi:[1,0,0]
    v_mfma_f32_16x16x32_bf16 v[248:251], a[240:243], v[120:123], v[248:251]
    s_add_u32 m0, s44, 110624
    ds_read_b64_tr_b16 a[206:207], v3 offset:54304
    v_fma_mix_f32 v38, v63, v26, v30 op_sel:[0,0,0] op_sel_hi:[1,0,0]
    v_mfma_f32_16x16x32_bf16 v[248:251], a[244:247], v[124:127], v[248:251]
    s_waitcnt lgkmcnt(8)
    buffer_load_dwordx4 v5, s[16:19], s46 offen offset:1024 lds
    v_mfma_f32_16x16x32_bf16 v[220:223], a[248:251], v[112:115], v[220:223]
    ds_read_b64_tr_b16 a[208:209], v3 offset:36928
    v_fma_mix_f32 v39, v63, v27, v31 op_sel:[1,0,0] op_sel_hi:[1,0,0]
    v_mfma_f32_16x16x32_bf16 v[220:223], a[252:255], v[116:119], v[220:223]
    ds_read_b64_tr_b16 a[210:211], v3 offset:37440
    ds_read_b64_tr_b16 a[212:213], v3 offset:53824
    v_cvt_pk_bf16_f32 v62, v36, v37
    v_mfma_f32_16x16x32_bf16 v[252:255], a[248:251], v[120:123], v[252:255]
    s_add_u32 m0, s44, 110656
    ds_read_b64_tr_b16 a[214:215], v3 offset:54336
    v_cvt_pk_bf16_f32 v63, v38, v39
    v_mfma_f32_16x16x32_bf16 v[252:255], a[252:255], v[124:127], v[252:255]
    s_waitcnt lgkmcnt(8)
    buffer_load_dwordx4 v5, s[16:19], s46 offen offset:2048 lds
    v_mfma_f32_16x16x32_bf16 v[128:131], a[192:195], v[48:51], v[128:131]
    ds_read_b64_tr_b16 a[216:217], v3 offset:36960
    v_mfma_f32_16x16x32_bf16 v[128:131], a[196:199], v[52:55], v[128:131]
    ds_read_b64_tr_b16 a[218:219], v3 offset:37472
    ds_read_b64_tr_b16 a[220:221], v3 offset:53856
    v_mfma_f32_16x16x32_bf16 v[160:163], a[192:195], v[56:59], v[160:163]
    s_add_u32 m0, s44, 110688
    ds_read_b64_tr_b16 a[222:223], v3 offset:54368
    v_mfma_f32_16x16x32_bf16 v[160:163], a[196:199], v[60:63], v[160:163]
    s_waitcnt lgkmcnt(8)
    buffer_load_dwordx4 v5, s[16:19], s46 offen offset:3072 lds
    v_mfma_f32_16x16x32_bf16 v[132:135], a[200:203], v[48:51], v[132:135]
    ds_read_b64_tr_b16 a[224:225], v3 offset:36992
    v_mfma_f32_16x16x32_bf16 v[132:135], a[204:207], v[52:55], v[132:135]
    ds_read_b64_tr_b16 a[226:227], v3 offset:37504
    ds_read_b64_tr_b16 a[228:229], v3 offset:53888
    v_mfma_f32_16x16x32_bf16 v[164:167], a[200:203], v[56:59], v[164:167]
    s_add_u32 m0, s44, 127488
    ds_read_b64_tr_b16 a[230:231], v3 offset:54400
    v_mfma_f32_16x16x32_bf16 v[164:167], a[204:207], v[60:63], v[164:167]
    s_waitcnt lgkmcnt(8)
    buffer_load_dwordx4 v5, s[20:23], s46 offen offset:0 lds
    v_mfma_f32_16x16x32_bf16 v[136:139], a[208:211], v[48:51], v[136:139]
    ds_read_b64_tr_b16 a[232:233], v3 offset:37024
    v_mfma_f32_16x16x32_bf16 v[136:139], a[212:215], v[52:55], v[136:139]
    ds_read_b64_tr_b16 a[234:235], v3 offset:37536
    ds_read_b64_tr_b16 a[236:237], v3 offset:53920
    v_mfma_f32_16x16x32_bf16 v[168:171], a[208:211], v[56:59], v[168:171]
    s_add_u32 m0, s44, 127520
    ds_read_b64_tr_b16 a[238:239], v3 offset:54432
    v_mfma_f32_16x16x32_bf16 v[168:171], a[212:215], v[60:63], v[168:171]
    s_waitcnt lgkmcnt(8)
    buffer_load_dwordx4 v5, s[20:23], s46 offen offset:1024 lds
    v_mfma_f32_16x16x32_bf16 v[140:143], a[216:219], v[48:51], v[140:143]
    ds_read_b64_tr_b16 a[240:241], v3 offset:37056
    v_cvt_pk_bf16_f32 v64, v128, v129
    v_mfma_f32_16x16x32_bf16 v[140:143], a[220:223], v[52:55], v[140:143]
    ds_read_b64_tr_b16 a[242:243], v3 offset:37568
    ds_read_b64_tr_b16 a[244:245], v3 offset:53952
    v_mfma_f32_16x16x32_bf16 v[172:175], a[216:219], v[56:59], v[172:175]
    s_add_u32 m0, s44, 127552
    ds_read_b64_tr_b16 a[246:247], v3 offset:54464
    v_cvt_pk_bf16_f32 v65, v130, v131
    v_mfma_f32_16x16x32_bf16 v[172:175], a[220:223], v[60:63], v[172:175]
    s_waitcnt lgkmcnt(8)
    buffer_load_dwordx4 v5, s[20:23], s46 offen offset:2048 lds
    v_mfma_f32_16x16x32_bf16 v[144:147], a[224:227], v[48:51], v[144:147]
    ds_read_b64_tr_b16 a[248:249], v3 offset:37088
    v_cvt_pk_bf16_f32 v66, v132, v133
    v_mfma_f32_16x16x32_bf16 v[144:147], a[228:231], v[52:55], v[144:147]
    ds_read_b64_tr_b16 a[250:251], v3 offset:37600
    ds_read_b64_tr_b16 a[252:253], v3 offset:53984
    v_mfma_f32_16x16x32_bf16 v[176:179], a[224:227], v[56:59], v[176:179]
    s_add_u32 m0, s44, 127584
    ds_read_b64_tr_b16 a[254:255], v3 offset:54496
    v_cvt_pk_bf16_f32 v67, v134, v135
    v_mfma_f32_16x16x32_bf16 v[176:179], a[228:231], v[60:63], v[176:179]
    s_waitcnt lgkmcnt(8)
    buffer_load_dwordx4 v5, s[20:23], s46 offen offset:3072 lds
    v_mfma_f32_16x16x32_bf16 v[148:151], a[232:235], v[48:51], v[148:151]
    ds_read_b64_tr_b16 a[192:193], v3 offset:37120
    v_cvt_pk_bf16_f32 v80, v160, v161
    v_mfma_f32_16x16x32_bf16 v[148:151], a[236:239], v[52:55], v[148:151]
    ds_read_b64_tr_b16 a[194:195], v3 offset:37632
    v_cvt_pk_bf16_f32 v81, v162, v163
    v_mfma_f32_16x16x32_bf16 v[180:183], a[232:235], v[56:59], v[180:183]
    ds_read_b64_tr_b16 a[196:197], v3 offset:54016
    v_cvt_pk_bf16_f32 v82, v164, v165
    v_mfma_f32_16x16x32_bf16 v[180:183], a[236:239], v[60:63], v[180:183]
    s_waitcnt lgkmcnt(7)
    ds_read_b64_tr_b16 a[198:199], v3 offset:54528
    v_cvt_pk_bf16_f32 v83, v166, v167
    v_mfma_f32_16x16x32_bf16 v[152:155], a[240:243], v[48:51], v[152:155]
    ds_read_b64_tr_b16 a[200:201], v3 offset:37152
    v_cvt_pk_bf16_f32 v68, v136, v137
    v_mfma_f32_16x16x32_bf16 v[152:155], a[244:247], v[52:55], v[152:155]
    ds_read_b64_tr_b16 a[202:203], v3 offset:37664
    v_cvt_pk_bf16_f32 v69, v138, v139
    v_mfma_f32_16x16x32_bf16 v[184:187], a[240:243], v[56:59], v[184:187]
    ds_read_b64_tr_b16 a[204:205], v3 offset:54048
    v_cvt_pk_bf16_f32 v70, v140, v141
    v_mfma_f32_16x16x32_bf16 v[184:187], a[244:247], v[60:63], v[184:187]
    s_waitcnt lgkmcnt(7)
    ds_read_b64_tr_b16 a[206:207], v3 offset:54560
    v_cvt_pk_bf16_f32 v71, v142, v143
    v_mfma_f32_16x16x32_bf16 v[156:159], a[248:251], v[48:51], v[156:159]
    ds_read_b64_tr_b16 a[208:209], v3 offset:37184
    v_cvt_pk_bf16_f32 v84, v168, v169
    v_mfma_f32_16x16x32_bf16 v[156:159], a[252:255], v[52:55], v[156:159]
    ds_read_b64_tr_b16 a[210:211], v3 offset:37696
    v_cvt_pk_bf16_f32 v85, v170, v171
    v_mfma_f32_16x16x32_bf16 v[188:191], a[248:251], v[56:59], v[188:191]
    ds_read_b64_tr_b16 a[212:213], v3 offset:54080
    v_cvt_pk_bf16_f32 v86, v172, v173
    v_mfma_f32_16x16x32_bf16 v[188:191], a[252:255], v[60:63], v[188:191]
    s_waitcnt lgkmcnt(7)
    ds_read_b64_tr_b16 a[214:215], v3 offset:54592
    v_cvt_pk_bf16_f32 v87, v174, v175
    v_mfma_f32_16x16x32_bf16 v[192:195], a[192:195], v[48:51], v[192:195]
    ds_read_b64_tr_b16 a[216:217], v3 offset:37216
    v_cvt_pk_bf16_f32 v72, v144, v145
    v_mfma_f32_16x16x32_bf16 v[192:195], a[196:199], v[52:55], v[192:195]
    ds_read_b64_tr_b16 a[218:219], v3 offset:37728
    v_cvt_pk_bf16_f32 v73, v146, v147
    v_mfma_f32_16x16x32_bf16 v[224:227], a[192:195], v[56:59], v[224:227]
    ds_read_b64_tr_b16 a[220:221], v3 offset:54112
    v_cvt_pk_bf16_f32 v74, v148, v149
    v_mfma_f32_16x16x32_bf16 v[224:227], a[196:199], v[60:63], v[224:227]
    s_waitcnt lgkmcnt(7)
    ds_read_b64_tr_b16 a[222:223], v3 offset:54624
    v_cvt_pk_bf16_f32 v75, v150, v151
    v_mfma_f32_16x16x32_bf16 v[196:199], a[200:203], v[48:51], v[196:199]
    ds_read_b64_tr_b16 a[224:225], v3 offset:37248
    v_cvt_pk_bf16_f32 v88, v176, v177
    v_mfma_f32_16x16x32_bf16 v[196:199], a[204:207], v[52:55], v[196:199]
    ds_read_b64_tr_b16 a[226:227], v3 offset:37760
    v_cvt_pk_bf16_f32 v89, v178, v179
    v_mfma_f32_16x16x32_bf16 v[228:231], a[200:203], v[56:59], v[228:231]
    ds_read_b64_tr_b16 a[228:229], v3 offset:54144
    v_cvt_pk_bf16_f32 v90, v180, v181
    v_mfma_f32_16x16x32_bf16 v[228:231], a[204:207], v[60:63], v[228:231]
    s_waitcnt lgkmcnt(7)
    ds_read_b64_tr_b16 a[230:231], v3 offset:54656
    v_cvt_pk_bf16_f32 v91, v182, v183
    v_mfma_f32_16x16x32_bf16 v[200:203], a[208:211], v[48:51], v[200:203]
    ds_read_b64_tr_b16 a[232:233], v3 offset:37280
    v_cvt_pk_bf16_f32 v76, v152, v153
    v_mfma_f32_16x16x32_bf16 v[200:203], a[212:215], v[52:55], v[200:203]
    ds_read_b64_tr_b16 a[234:235], v3 offset:37792
    v_cvt_pk_bf16_f32 v77, v154, v155
    v_mfma_f32_16x16x32_bf16 v[232:235], a[208:211], v[56:59], v[232:235]
    ds_read_b64_tr_b16 a[236:237], v3 offset:54176
    v_cvt_pk_bf16_f32 v78, v156, v157
    v_mfma_f32_16x16x32_bf16 v[232:235], a[212:215], v[60:63], v[232:235]
    s_waitcnt lgkmcnt(7)
    ds_read_b64_tr_b16 a[238:239], v3 offset:54688
    v_cvt_pk_bf16_f32 v79, v158, v159
    v_mfma_f32_16x16x32_bf16 v[204:207], a[216:219], v[48:51], v[204:207]
    ds_read_b64_tr_b16 a[240:241], v3 offset:37312
    v_cvt_pk_bf16_f32 v92, v184, v185
    v_mfma_f32_16x16x32_bf16 v[204:207], a[220:223], v[52:55], v[204:207]
L2_pad3:
    s_cbranch_execz L2_pad7
    ds_read_b64_tr_b16 a[242:243], v3 offset:37824
    v_cvt_pk_bf16_f32 v93, v186, v187
    v_mfma_f32_16x16x32_bf16 v[236:239], a[216:219], v[56:59], v[236:239]
    ds_read_b64_tr_b16 a[244:245], v3 offset:54208
    v_cvt_pk_bf16_f32 v94, v188, v189
    v_mfma_f32_16x16x32_bf16 v[236:239], a[220:223], v[60:63], v[236:239]
    s_waitcnt lgkmcnt(7)
    ds_read_b64_tr_b16 a[246:247], v3 offset:54720
    v_cvt_pk_bf16_f32 v95, v190, v191
    v_mfma_f32_16x16x32_bf16 v[208:211], a[224:227], v[48:51], v[208:211]
    ds_read_b64_tr_b16 a[248:249], v3 offset:37344
    v_cvt_pk_bf16_f32 v96, v192, v193
    v_mfma_f32_16x16x32_bf16 v[208:211], a[228:231], v[52:55], v[208:211]
    ds_read_b64_tr_b16 a[250:251], v3 offset:37856
    v_cvt_pk_bf16_f32 v97, v194, v195
    v_mfma_f32_16x16x32_bf16 v[240:243], a[224:227], v[56:59], v[240:243]
    ds_read_b64_tr_b16 a[252:253], v3 offset:54240
    v_cvt_pk_bf16_f32 v98, v196, v197
    v_mfma_f32_16x16x32_bf16 v[240:243], a[228:231], v[60:63], v[240:243]
    s_waitcnt vmcnt(8)
    s_barrier
    s_waitcnt lgkmcnt(7)
    ds_read_b64_tr_b16 a[254:255], v3 offset:54752
    v_cvt_pk_bf16_f32 v99, v198, v199
    v_mfma_f32_16x16x32_bf16 v[212:215], a[232:235], v[48:51], v[212:215]
    ds_read_b128 a[64:67], v1 offset:0
    v_cvt_pk_bf16_f32 v112, v224, v225
    v_mfma_f32_16x16x32_bf16 v[212:215], a[236:239], v[52:55], v[212:215]
    ds_read_b128 a[68:71], v1 offset:64
    v_cvt_pk_bf16_f32 v113, v226, v227
    v_mfma_f32_16x16x32_bf16 v[244:247], a[232:235], v[56:59], v[244:247]
    s_add_u32 m0, s44, 0
    ds_read_b128 a[72:75], v1 offset:128
    v_cvt_pk_bf16_f32 v114, v228, v229
    v_mfma_f32_16x16x32_bf16 v[244:247], a[236:239], v[60:63], v[244:247]
    s_mov_b32 s46, 32768
    s_waitcnt lgkmcnt(7)
    buffer_load_dwordx4 v5, s[16:19], s46 offen offset:0 lds
    v_mfma_f32_16x16x32_bf16 v[216:219], a[240:243], v[48:51], v[216:219]
    ds_read_b128 a[76:79], v1 offset:192
    v_cvt_pk_bf16_f32 v115, v230, v231
    v_mfma_f32_16x16x32_bf16 v[216:219], a[244:247], v[52:55], v[216:219]
    ds_read_b128 a[80:83], v1 offset:256
    v_cvt_pk_bf16_f32 v100, v200, v201
    v_mfma_f32_16x16x32_bf16 v[248:251], a[240:243], v[56:59], v[248:251]
    s_add_u32 m0, s44, 32
    ds_read_b128 a[84:87], v1 offset:320
    v_cvt_pk_bf16_f32 v101, v202, v203
    v_mfma_f32_16x16x32_bf16 v[248:251], a[244:247], v[60:63], v[248:251]
    s_waitcnt lgkmcnt(6)
    buffer_load_dwordx4 v5, s[16:19], s46 offen offset:1024 lds
    v_mfma_f32_16x16x32_bf16 v[220:223], a[248:251], v[48:51], v[220:223]
    ds_read_b128 a[88:91], v1 offset:384
    v_cvt_pk_bf16_f32 v102, v204, v205
    v_mfma_f32_16x16x32_bf16 v[220:223], a[252:255], v[52:55], v[220:223]
    ds_read_b128 a[92:95], v1 offset:448
    v_cvt_pk_bf16_f32 v103, v206, v207
    v_mfma_f32_16x16x32_bf16 v[252:255], a[248:251], v[56:59], v[252:255]
    s_add_u32 m0, s44, 64
    ds_read_b128 a[96:99], v1 offset:512
    v_cvt_pk_bf16_f32 v116, v232, v233
    v_mfma_f32_16x16x32_bf16 v[252:255], a[252:255], v[60:63], v[252:255]
    buffer_load_dwordx4 v5, s[16:19], s46 offen offset:2048 lds
    v_lshlrev_b32 v14, 7, v0
    s_add_u32 m0, s44, 96
    s_nop 0
    buffer_load_dwordx4 v5, s[16:19], s46 offen offset:3072 lds
    s_add_u32 m0, s44, 16896
    s_nop 0
    buffer_load_dwordx4 v5, s[20:23], s46 offen offset:0 lds
    s_add_u32 m0, s44, 16928
    s_nop 0
    buffer_load_dwordx4 v5, s[20:23], s46 offen offset:1024 lds
    s_add_u32 m0, s44, 16960
    s_nop 0
    buffer_load_dwordx4 v5, s[20:23], s46 offen offset:2048 lds
    s_add_u32 m0, s44, 16992
    s_nop 0
    buffer_load_dwordx4 v5, s[20:23], s46 offen offset:3072 lds
    buffer_load_dword a63, v14, s[36:39], 0 offen
    ds_read_b128 a[100:103], v1 offset:576
    ds_read_b128 a[104:107], v1 offset:640
    ds_read_b128 a[108:111], v1 offset:704
    ds_read_b128 a[112:115], v1 offset:768
    ds_read_b128 a[116:119], v1 offset:832
    ds_read_b128 a[120:123], v1 offset:896
    ds_read_b128 a[124:127], v1 offset:960
    ds_read_b64_tr_b16 a[128:129], v2 offset:0
    ds_read_b64_tr_b16 a[130:131], v2 offset:256
    ds_read_b64_tr_b16 a[132:133], v2 offset:512
    ds_read_b64_tr_b16 a[134:135], v2 offset:768
    ds_read_b64_tr_b16 a[136:137], v2 offset:32
    ds_read_b64_tr_b16 a[138:139], v2 offset:288
    ds_read_b64_tr_b16 a[140:141], v2 offset:544
    ds_read_b64_tr_b16 a[142:143], v2 offset:800
    ds_read_b64_tr_b16 a[144:145], v2 offset:64
    ds_read_b64_tr_b16 a[146:147], v2 offset:320
    ds_read_b64_tr_b16 a[148:149], v2 offset:576
    ds_read_b64_tr_b16 a[150:151], v2 offset:832
    ds_read_b64_tr_b16 a[152:153], v2 offset:96
    ds_read_b64_tr_b16 a[154:155], v2 offset:352
    ds_read_b64_tr_b16 a[156:157], v2 offset:608
    ds_read_b64_tr_b16 a[158:159], v2 offset:864
    ds_read_b64_tr_b16 a[160:161], v2 offset:128
    ds_read_b64_tr_b16 a[162:163], v2 offset:384
    ds_read_b64_tr_b16 a[164:165], v2 offset:640
    ds_read_b64_tr_b16 a[166:167], v2 offset:896
    ds_read_b64_tr_b16 a[168:169], v2 offset:160
    ds_read_b64_tr_b16 a[170:171], v2 offset:416
    ds_read_b64_tr_b16 a[172:173], v2 offset:672
    ds_read_b64_tr_b16 a[174:175], v2 offset:928
    ds_read_b64_tr_b16 a[176:177], v2 offset:192
    ds_read_b64_tr_b16 a[178:179], v2 offset:448
    ds_read_b64_tr_b16 a[180:181], v2 offset:704
    ds_read_b64_tr_b16 a[182:183], v2 offset:960
    ds_read_b64_tr_b16 a[184:185], v2 offset:224
    ds_read_b64_tr_b16 a[186:187], v2 offset:480
    ds_read_b64_tr_b16 a[188:189], v2 offset:736
    ds_read_b64_tr_b16 a[190:191], v2 offset:992
    v_cvt_pk_bf16_f32 v117, v234, v235
    v_cvt_pk_bf16_f32 v118, v236, v237
    v_cvt_pk_bf16_f32 v119, v238, v239
    v_cvt_pk_bf16_f32 v104, v208, v209
    v_cvt_pk_bf16_f32 v105, v210, v211
    v_cvt_pk_bf16_f32 v106, v212, v213
    v_cvt_pk_bf16_f32 v107, v214, v215
    v_cvt_pk_bf16_f32 v120, v240, v241
    v_cvt_pk_bf16_f32 v121, v242, v243
    v_cvt_pk_bf16_f32 v122, v244, v245
    v_cvt_pk_bf16_f32 v123, v246, v247
    v_cvt_pk_bf16_f32 v108, v216, v217
    v_cvt_pk_bf16_f32 v109, v218, v219
    v_cvt_pk_bf16_f32 v110, v220, v221
    v_cvt_pk_bf16_f32 v111, v222, v223
    v_cvt_pk_bf16_f32 v124, v248, v249
    v_cvt_pk_bf16_f32 v125, v250, v251
    v_cvt_pk_bf16_f32 v126, v252, v253
    v_cvt_pk_bf16_f32 v127, v254, v255
    s_nop 0
    v_permlane32_swap_b32 v64, v66
    v_permlane32_swap_b32 v65, v67
    v_permlane32_swap_b32 v80, v82
    v_permlane32_swap_b32 v81, v83
    v_permlane32_swap_b32 v68, v70
    v_permlane32_swap_b32 v69, v71
    v_permlane32_swap_b32 v84, v86
    v_permlane32_swap_b32 v85, v87
    v_permlane32_swap_b32 v72, v74
    v_permlane32_swap_b32 v73, v75
    v_permlane32_swap_b32 v88, v90
    v_permlane32_swap_b32 v89, v91
    v_permlane32_swap_b32 v76, v78
    v_permlane32_swap_b32 v77, v79
    v_permlane32_swap_b32 v92, v94
    v_permlane32_swap_b32 v93, v95
    v_permlane32_swap_b32 v96, v98
    v_permlane32_swap_b32 v97, v99
    v_permlane32_swap_b32 v112, v114
    v_permlane32_swap_b32 v113, v115
    v_permlane32_swap_b32 v100, v102
    v_permlane32_swap_b32 v101, v103
    v_permlane32_swap_b32 v116, v118
    v_permlane32_swap_b32 v117, v119
    v_permlane32_swap_b32 v104, v106
    v_permlane32_swap_b32 v105, v107
    v_permlane32_swap_b32 v120, v122
    v_permlane32_swap_b32 v121, v123
    v_permlane32_swap_b32 v108, v110
    v_permlane32_swap_b32 v109, v111
    v_permlane32_swap_b32 v124, v126
    v_permlane32_swap_b32 v125, v127
    s_waitcnt lgkmcnt(15)
    v_mfma_f32_16x16x32_bf16 v[16:19], a[64:67], v[64:67], 0
    v_mfma_f32_16x16x32_bf16 v[16:19], a[68:71], v[68:71], v[16:19]
    v_mfma_f32_16x16x32_bf16 v[16:19], a[72:75], v[72:75], v[16:19]
    v_mfma_f32_16x16x32_bf16 v[16:19], a[76:79], v[76:79], v[16:19]
    v_mfma_f32_16x16x32_bf16 v[20:23], a[64:67], v[80:83], 0
    v_mfma_f32_16x16x32_bf16 v[20:23], a[68:71], v[84:87], v[20:23]
    v_mfma_f32_16x16x32_bf16 v[20:23], a[72:75], v[88:91], v[20:23]
    v_mfma_f32_16x16x32_bf16 v[20:23], a[76:79], v[92:95], v[20:23]
    v_mfma_f32_16x16x32_bf16 v[24:27], a[64:67], v[96:99], 0
    v_mfma_f32_16x16x32_bf16 v[24:27], a[68:71], v[100:103], v[24:27]
    v_mfma_f32_16x16x32_bf16 v[24:27], a[72:75], v[104:107], v[24:27]
    v_mfma_f32_16x16x32_bf16 v[24:27], a[76:79], v[108:111], v[24:27]
    v_mfma_f32_16x16x32_bf16 v[28:31], a[64:67], v[112:115], 0
    v_mfma_f32_16x16x32_bf16 v[28:31], a[68:71], v[116:119], v[28:31]
    v_mfma_f32_16x16x32_bf16 v[28:31], a[72:75], v[120:123], v[28:31]
    v_mfma_f32_16x16x32_bf16 v[28:31], a[76:79], v[124:127], v[28:31]
    s_nop 1
    v_max3_f32 v16, v16, v17, v18
    v_max_f32 v16, v16, v19
    v_max3_f32 v20, v20, v21, v22
    v_max_f32 v20, v20, v23
    v_max3_f32 v24, v24, v25, v26
    v_max_f32 v24, v24, v27
    v_max3_f32 v28, v28, v29, v30
    v_max_f32 v28, v28, v31
    v_mov_b32 v12, v16
    v_mov_b32 v13, v20
    v_mov_b32 v14, v24
    v_mov_b32 v15, v28
    v_permlane16_swap_b32 v12, v16
    v_permlane16_swap_b32 v13, v20
    v_permlane16_swap_b32 v14, v24
    v_permlane16_swap_b32 v15, v28
    v_max_f32 v16, v16, v12
    v_max_f32 v20, v20, v13
    v_max_f32 v24, v24, v14
    v_max_f32 v28, v28, v15
    v_mov_b32 v12, v16
    v_mov_b32 v13, v20
    v_mov_b32 v14, v24
    v_mov_b32 v15, v28
    v_permlane32_swap_b32 v12, v16
    v_permlane32_swap_b32 v13, v20
    v_permlane32_swap_b32 v14, v24
    v_permlane32_swap_b32 v15, v28
    v_max_f32 v16, v16, v12
    v_max_f32 v20, v20, v13
    v_max_f32 v24, v24, v14
    v_max_f32 v28, v28, v15
    v_sub_f32 v48, 0xc2000000, v16
    v_sub_f32 v49, 0xc2000000, v16
    v_sub_f32 v50, 0xc2000000, v16
    v_sub_f32 v51, 0xc2000000, v16
    v_sub_f32 v52, 0xc2000000, v20
    v_sub_f32 v53, 0xc2000000, v20
    v_sub_f32 v54, 0xc2000000, v20
    v_sub_f32 v55, 0xc2000000, v20
    v_sub_f32 v56, 0xc2000000, v24
    v_sub_f32 v57, 0xc2000000, v24
    v_sub_f32 v58, 0xc2000000, v24
    v_sub_f32 v59, 0xc2000000, v24
    v_sub_f32 v60, 0xc2000000, v28
    v_sub_f32 v61, 0xc2000000, v28
    v_sub_f32 v62, 0xc2000000, v28
    v_sub_f32 v63, 0xc2000000, v28
L2_entry:
    v_accvgpr_write_b32 a0, 0
    v_accvgpr_write_b32 a1, 0
    v_accvgpr_write_b32 a2, 0
    v_accvgpr_write_b32 a3, 0
    v_accvgpr_write_b32 a4, 0
    v_accvgpr_write_b32 a5, 0
    v_accvgpr_write_b32 a6, 0
    v_accvgpr_write_b32 a7, 0
    v_accvgpr_write_b32 a8, 0
    v_accvgpr_write_b32 a9, 0
    v_accvgpr_write_b32 a10, 0
    v_accvgpr_write_b32 a11, 0
    v_accvgpr_write_b32 a12, 0
    v_accvgpr_write_b32 a13, 0
    v_accvgpr_write_b32 a14, 0
    v_accvgpr_write_b32 a15, 0
    v_mov_b32 v224, 0
    v_mov_b32 v225, 0
    v_mov_b32 v226, 0
    v_mov_b32 v227, 0
    v_mov_b32 v228, 0
    v_mov_b32 v229, 0
    v_mov_b32 v230, 0
    v_mov_b32 v231, 0
    v_mov_b32 v232, 0
    v_mov_b32 v233, 0
    v_mov_b32 v234, 0
    v_mov_b32 v235, 0
    v_mov_b32 v236, 0
    v_mov_b32 v237, 0
    v_mov_b32 v238, 0
    v_mov_b32 v239, 0
    v_mov_b32 v240, 0
    v_mov_b32 v241, 0
    v_mov_b32 v242, 0
    v_mov_b32 v243, 0
    v_mov_b32 v244, 0
    v_mov_b32 v245, 0
    v_mov_b32 v246, 0
    v_mov_b32 v247, 0
    v_mov_b32 v248, 0
    v_mov_b32 v249, 0
    v_mov_b32 v250, 0
    v_mov_b32 v251, 0
    v_mov_b32 v252, 0
    v_mov_b32 v253, 0
    v_mov_b32 v254, 0
    v_mov_b32 v255, 0
    s_mov_b32 s47, s44
    s_mov_b32 s48, -73728
    s_mov_b32 s49, 12
    s_mov_b32 s46, 49152
    v_lshrrev_b32 v14, 2, v0
    s_mul_i32 s3, s51, 144
    v_add_u32 v14, s3, v14
    v_mul_u32_u24 v14, 9216, v14
    v_and_b32 v15, 3, v0
    v_lshl_add_u32 v6, v15, 4, v14
    s_lshr_b32 s3, s2, 3
    s_lshl_b32 s3, s3, 2
    s_add_u32 s3, s3, s51
    s_and_b32 s15, s2, 7
    s_lshl_b32 s14, s3, 7
    v_lshl_add_u32 v9, v0, 14, s14
    v_min_u32 v9, L2_codeend-L2_begin-8, v9
    s_mul_i32 s14, s3, 9
    s_lshr_b32 s14, s14, 1
    v_min_u32 v15, 44, v0
    v_mul_u32_u24 v12, 7282, v15
    v_lshrrev_b32 v12, 16, v12
    v_mul_u32_u24 v13, 63, v12
    v_add_u32 v12, v15, v13
    s_mul_i32 s14, s14, 72
    s_mul_i32 s56, s15, 9
    s_add_u32 s14, s14, s56
    v_add_u32 v12, s14, v12
    v_lshlrev_b32 v12, 7, v12
    s_mul_i32 s14, s3, 81
    s_lshr_b32 s14, s14, 1
    s_mul_i32 s56, s15, 5184
    s_add_u32 s14, s14, s56
    v_min_u32 v13, 40, v0
    v_add_u32 v13, s14, v13
    v_lshlrev_b32 v13, 7, v13
    s_mul_i32 s14, s3, 72
    s_andn2_b32 s56, s52, 3
    s_mul_i32 s56, s56, 2304
    s_add_u32 s14, s14, s56
    v_min_u32 v14, 35, v0
    v_add_u32 v14, s14, v14
    v_lshlrev_b32 v14, 7, v14
    v_add_u32 v15, 4608, v14
    s_waitcnt vmcnt(9) lgkmcnt(0)
    s_barrier
    v_mfma_f32_16x16x32_bf16 v[16:19], a[64:67], v[64:67], v[48:51]
    v_mfma_f32_16x16x32_bf16 v[16:19], a[68:71], v[68:71], v[16:19]
    v_mfma_f32_16x16x32_bf16 v[16:19], a[72:75], v[72:75], v[16:19]
    s_add_u32 m0, s47, 36864
    v_mfma_f32_16x16x32_bf16 v[16:19], a[76:79], v[76:79], v[16:19]
    buffer_load_dwordx4 v5, s[16:19], s46 offen offset:0 lds
    v_mfma_f32_16x16x32_bf16 v[20:23], a[80:83], v[64:67], v[48:51]
    v_mfma_f32_16x16x32_bf16 v[20:23], a[84:87], v[68:71], v[20:23]
    v_mfma_f32_16x16x32_bf16 v[20:23], a[88:91], v[72:75], v[20:23]
    s_add_u32 m0, s47, 36896
    v_mfma_f32_16x16x32_bf16 v[20:23], a[92:95], v[76:79], v[20:23]
    buffer_load_dwordx4 v5, s[16:19], s46 offen offset:1024 lds
    v_mfma_f32_16x16x32_bf16 v[24:27], a[96:99], v[64:67], v[48:51]
    s_nop 1
    v_exp_f32 v16, v16
    v_mfma_f32_16x16x32_bf16 v[24:27], a[100:103], v[68:71], v[24:27]
    v_mfma_f32_16x16x32_bf16 v[24:27], a[104:107], v[72:75], v[24:27]
    s_add_u32 m0, s47, 36928
    v_exp_f32 v17, v17
    v_mfma_f32_16x16x32_bf16 v[24:27], a[108:111], v[76:79], v[24:27]
    buffer_load_dwordx4 v5, s[16:19], s46 offen offset:2048 lds
    v_mfma_f32_16x16x32_bf16 v[28:31], a[112:115], v[64:67], v[48:51]
    v_exp_f32 v18, v18
    v_mfma_f32_16x16x32_bf16 v[28:31], a[116:119], v[68:71], v[28:31]
    v_cvt_pk_bf16_f32 v32, v16, v17
    v_mfma_f32_16x16x32_bf16 v[28:31], a[120:123], v[72:75], v[28:31]
    s_add_u32 m0, s47, 36960
    v_exp_f32 v19, v19
    v_mfma_f32_16x16x32_bf16 v[28:31], a[124:127], v[76:79], v[28:31]
    buffer_load_dwordx4 v5, s[16:19], s46 offen offset:3072 lds
    s_nop 3
    v_exp_f32 v20, v20
    s_nop 0
    ds_read_b64_tr_b16 a[192:193], v2 offset:36864
    v_cvt_pk_bf16_f32 v33, v18, v19
    s_add_u32 m0, s47, 53760
    v_exp_f32 v21, v21
    s_nop 0
    buffer_load_dwordx4 v5, s[20:23], s46 offen offset:0 lds
    v_exp_f32 v22, v22
    s_nop 0
    ds_read_b64_tr_b16 a[194:195], v2 offset:37120
    v_cvt_pk_bf16_f32 v34, v20, v21
    s_add_u32 m0, s47, 53792
    v_exp_f32 v23, v23
    s_nop 0
    buffer_load_dwordx4 v5, s[20:23], s46 offen offset:1024 lds
    v_exp_f32 v24, v24
    s_nop 0
    ds_read_b64_tr_b16 a[196:197], v2 offset:37376
    v_cvt_pk_bf16_f32 v35, v22, v23
    s_add_u32 m0, s47, 53824
    v_exp_f32 v25, v25
    s_nop 0
    buffer_load_dwordx4 v5, s[20:23], s46 offen offset:2048 lds
    v_exp_f32 v26, v26
    s_nop 0
    ds_read_b64_tr_b16 a[198:199], v2 offset:37632
    v_cvt_pk_bf16_f32 v36, v24, v25
    s_add_u32 m0, s47, 53856
    v_exp_f32 v27, v27
    s_nop 0
    buffer_load_dwordx4 v5, s[20:23], s46 offen offset:3072 lds
    ds_read_b64_tr_b16 a[200:201], v2 offset:36896
    s_nop 0
    v_mfma_f32_16x16x32_bf16 v[16:19], a[64:67], v[80:83], v[52:55]
    v_exp_f32 v28, v28
    v_mfma_f32_16x16x32_bf16 v[16:19], a[68:71], v[84:87], v[16:19]
    ds_read_b64_tr_b16 a[202:203], v2 offset:37152
    v_cvt_pk_bf16_f32 v37, v26, v27
    v_mfma_f32_16x16x32_bf16 v[16:19], a[72:75], v[88:91], v[16:19]
    v_exp_f32 v29, v29
    v_mfma_f32_16x16x32_bf16 v[16:19], a[76:79], v[92:95], v[16:19]
    ds_read_b64_tr_b16 a[204:205], v2 offset:37408
    v_mfma_f32_16x16x32_bf16 v[20:23], a[80:83], v[80:83], v[52:55]
    v_exp_f32 v30, v30
    v_mfma_f32_16x16x32_bf16 v[20:23], a[84:87], v[84:87], v[20:23]
    ds_read_b64_tr_b16 a[206:207], v2 offset:37664
    v_cvt_pk_bf16_f32 v38, v28, v29
    v_mfma_f32_16x16x32_bf16 v[20:23], a[88:91], v[88:91], v[20:23]
    v_exp_f32 v31, v31
    v_mfma_f32_16x16x32_bf16 v[20:23], a[92:95], v[92:95], v[20:23]
    ds_read_b64_tr_b16 a[208:209], v2 offset:36928
    v_mfma_f32_16x16x32_bf16 v[24:27], a[96:99], v[80:83], v[52:55]
    v_exp_f32 v16, v16
    v_mfma_f32_16x16x32_bf16 v[24:27], a[100:103], v[84:87], v[24:27]
    ds_read_b64_tr_b16 a[210:211], v2 offset:37184
    v_cvt_pk_bf16_f32 v39, v30, v31
    v_mfma_f32_16x16x32_bf16 v[24:27], a[104:107], v[88:91], v[24:27]
    v_exp_f32 v17, v17
    v_mfma_f32_16x16x32_bf16 v[24:27], a[108:111], v[92:95], v[24:27]
    ds_read_b64_tr_b16 a[212:213], v2 offset:37440
    v_mfma_f32_16x16x32_bf16 v[28:31], a[112:115], v[80:83], v[52:55]
    v_exp_f32 v18, v18
    v_mfma_f32_16x16x32_bf16 v[28:31], a[116:119], v[84:87], v[28:31]
    ds_read_b64_tr_b16 a[214:215], v2 offset:37696
    v_cvt_pk_bf16_f32 v40, v16, v17
    v_mfma_f32_16x16x32_bf16 v[28:31], a[120:123], v[88:91], v[28:31]
    v_exp_f32 v19, v19
    v_mfma_f32_16x16x32_bf16 v[28:31], a[124:127], v[92:95], v[28:31]
    ds_read_b64_tr_b16 a[216:217], v2 offset:36960
    v_mfma_f32_16x16x32_bf16 v[128:131], a[128:131], v[32:35], 0
    v_exp_f32 v20, v20
    v_mfma_f32_16x16x32_bf16 v[128:131], a[132:135], v[36:39], v[128:131]
    ds_read_b64_tr_b16 a[218:219], v2 offset:37216
    v_cvt_pk_bf16_f32 v41, v18, v19
    v_mfma_f32_16x16x32_bf16 v[132:135], a[136:139], v[32:35], 0
    v_exp_f32 v21, v21
    v_mfma_f32_16x16x32_bf16 v[132:135], a[140:143], v[36:39], v[132:135]
    ds_read_b64_tr_b16 a[220:221], v2 offset:37472
    v_mfma_f32_16x16x32_bf16 v[136:139], a[144:147], v[32:35], 0
    v_exp_f32 v22, v22
    v_mfma_f32_16x16x32_bf16 v[136:139], a[148:151], v[36:39], v[136:139]
    ds_read_b64_tr_b16 a[222:223], v2 offset:37728
    v_cvt_pk_bf16_f32 v42, v20, v21
    v_mfma_f32_16x16x32_bf16 v[140:143], a[152:155], v[32:35], 0
    v_exp_f32 v23, v23
    v_mfma_f32_16x16x32_bf16 v[140:143], a[156:159], v[36:39], v[140:143]
    ds_read_b64_tr_b16 a[224:225], v2 offset:36992
    v_mfma_f32_16x16x32_bf16 v[144:147], a[160:163], v[32:35], 0
    v_exp_f32 v24, v24
    v_mfma_f32_16x16x32_bf16 v[144:147], a[164:167], v[36:39], v[144:147]
    ds_read_b64_tr_b16 a[226:227], v2 offset:37248
    v_cvt_pk_bf16_f32 v43, v22, v23
    v_mfma_f32_16x16x32_bf16 v[148:151], a[168:171], v[32:35], 0
    v_exp_f32 v25, v25
    v_mfma_f32_16x16x32_bf16 v[148:151], a[172:175], v[36:39], v[148:151]
    ds_read_b64_tr_b16 a[228:229], v2 offset:37504
    v_mfma_f32_16x16x32_bf16 v[152:155], a[176:179], v[32:35], 0
    v_exp_f32 v26, v26
    v_mfma_f32_16x16x32_bf16 v[152:155], a[180:183], v[36:39], v[152:155]
    ds_read_b64_tr_b16 a[230:231], v2 offset:37760
    v_cvt_pk_bf16_f32 v44, v24, v25
    v_mfma_f32_16x16x32_bf16 v[156:159], a[184:187], v[32:35], 0
    v_exp_f32 v27, v27
    v_mfma_f32_16x16x32_bf16 v[156:159], a[188:191], v[36:39], v[156:159]
    ds_read_b64_tr_b16 a[232:233], v2 offset:37024
    v_smfmac_f32_16x16x64_bf16 a[0:3], a[16:19], v[32:39], v11
    ds_read_b64_tr_b16 a[234:235], v2 offset:37280
    v_mfma_f32_16x16x32_bf16 v[16:19], a[64:67], v[96:99], v[56:59]
    v_exp_f32 v28, v28
    v_mfma_f32_16x16x32_bf16 v[16:19], a[68:71], v[100:103], v[16:19]
    ds_read_b64_tr_b16 a[236:237], v2 offset:37536
    v_cvt_pk_bf16_f32 v45, v26, v27
    v_mfma_f32_16x16x32_bf16 v[16:19], a[72:75], v[104:107], v[16:19]
    v_exp_f32 v29, v29
    v_mfma_f32_16x16x32_bf16 v[16:19], a[76:79], v[108:111], v[16:19]
    ds_read_b64_tr_b16 a[238:239], v2 offset:37792
    v_mfma_f32_16x16x32_bf16 v[20:23], a[80:83], v[96:99], v[56:59]
    v_exp_f32 v30, v30
    v_mfma_f32_16x16x32_bf16 v[20:23], a[84:87], v[100:103], v[20:23]
    ds_read_b64_tr_b16 a[240:241], v2 offset:37056
    v_cvt_pk_bf16_f32 v46, v28, v29
    v_mfma_f32_16x16x32_bf16 v[20:23], a[88:91], v[104:107], v[20:23]
    v_exp_f32 v31, v31
    v_mfma_f32_16x16x32_bf16 v[20:23], a[92:95], v[108:111], v[20:23]
    ds_read_b64_tr_b16 a[242:243], v2 offset:37312
    v_mfma_f32_16x16x32_bf16 v[24:27], a[96:99], v[96:99], v[56:59]
    v_exp_f32 v16, v16
    v_mfma_f32_16x16x32_bf16 v[24:27], a[100:103], v[100:103], v[24:27]
    ds_read_b64_tr_b16 a[244:245], v2 offset:37568
    v_cvt_pk_bf16_f32 v47, v30, v31
    v_mfma_f32_16x16x32_bf16 v[24:27], a[104:107], v[104:107], v[24:27]
    v_exp_f32 v17, v17
    v_mfma_f32_16x16x32_bf16 v[24:27], a[108:111], v[108:111], v[24:27]
    ds_read_b64_tr_b16 a[246:247], v2 offset:37824
    v_mfma_f32_16x16x32_bf16 v[28:31], a[112:115], v[96:99], v[56:59]
    v_exp_f32 v18, v18
    v_mfma_f32_16x16x32_bf16 v[28:31], a[116:119], v[100:103], v[28:31]
    ds_read_b64_tr_b16 a[248:249], v2 offset:37088
    v_cvt_pk_bf16_f32 v32, v16, v17
    v_mfma_f32_16x16x32_bf16 v[28:31], a[120:123], v[104:107], v[28:31]
    v_exp_f32 v19, v19
    v_mfma_f32_16x16x32_bf16 v[28:31], a[124:127], v[108:111], v[28:31]
    ds_read_b64_tr_b16 a[250:251], v2 offset:37344
    v_mfma_f32_16x16x32_bf16 v[160:163], a[128:131], v[40:43], 0
    v_exp_f32 v20, v20
    v_mfma_f32_16x16x32_bf16 v[160:163], a[132:135], v[44:47], v[160:163]
    ds_read_b64_tr_b16 a[252:253], v2 offset:37600
    v_cvt_pk_bf16_f32 v33, v18, v19
    v_mfma_f32_16x16x32_bf16 v[164:167], a[136:139], v[40:43], 0
    v_exp_f32 v21, v21
    v_mfma_f32_16x16x32_bf16 v[164:167], a[140:143], v[44:47], v[164:167]
    ds_read_b64_tr_b16 a[254:255], v2 offset:37856
    v_mfma_f32_16x16x32_bf16 v[168:171], a[144:147], v[40:43], 0
    v_exp_f32 v22, v22
    v_mfma_f32_16x16x32_bf16 v[168:171], a[148:151], v[44:47], v[168:171]
    v_cvt_pk_bf16_f32 v34, v20, v21
    v_mfma_f32_16x16x32_bf16 v[172:175], a[152:155], v[40:43], 0
    v_exp_f32 v23, v23
    v_mfma_f32_16x16x32_bf16 v[172:175], a[156:159], v[44:47], v[172:175]
    v_mfma_f32_16x16x32_bf16 v[176:179], a[160:163], v[40:43], 0
    v_exp_f32 v24, v24
    v_mfma_f32_16x16x32_bf16 v[176:179], a[164:167], v[44:47], v[176:179]
    v_cvt_pk_bf16_f32 v35, v22, v23
    v_mfma_f32_16x16x32_bf16 v[180:183], a[168:171], v[40:43], 0
    v_exp_f32 v25, v25
    v_mfma_f32_16x16x32_bf16 v[180:183], a[172:175], v[44:47], v[180:183]
    v_mfma_f32_16x16x32_bf16 v[184:187], a[176:179], v[40:43], 0
    v_exp_f32 v26, v26
    v_mfma_f32_16x16x32_bf16 v[184:187], a[180:183], v[44:47], v[184:187]
    v_cvt_pk_bf16_f32 v36, v24, v25
    v_mfma_f32_16x16x32_bf16 v[188:191], a[184:187], v[40:43], 0
    v_exp_f32 v27, v27
    v_mfma_f32_16x16x32_bf16 v[188:191], a[188:191], v[44:47], v[188:191]
    v_smfmac_f32_16x16x64_bf16 a[4:7], a[16:19], v[40:47], v11
    v_mfma_f32_16x16x32_bf16 v[16:19], a[64:67], v[112:115], v[60:63]
    v_exp_f32 v28, v28
    v_mfma_f32_16x16x32_bf16 v[16:19], a[68:71], v[116:119], v[16:19]
    s_add_u32 s46, s46, 16384
    ds_read_b128 a[64:67], v1 offset:36864
    v_cvt_pk_bf16_f32 v37, v26, v27
    v_mfma_f32_16x16x32_bf16 v[16:19], a[72:75], v[120:123], v[16:19]
    v_exp_f32 v29, v29
    v_mfma_f32_16x16x32_bf16 v[16:19], a[76:79], v[124:127], v[16:19]
    ds_read_b128 a[68:71], v1 offset:36928
    v_mfma_f32_16x16x32_bf16 v[20:23], a[80:83], v[112:115], v[60:63]
    v_exp_f32 v30, v30
    v_mfma_f32_16x16x32_bf16 v[20:23], a[84:87], v[116:119], v[20:23]
    ds_read_b128 a[72:75], v1 offset:36992
    v_cvt_pk_bf16_f32 v38, v28, v29
    v_mfma_f32_16x16x32_bf16 v[20:23], a[88:91], v[120:123], v[20:23]
    v_exp_f32 v31, v31
    v_mfma_f32_16x16x32_bf16 v[20:23], a[92:95], v[124:127], v[20:23]
    ds_read_b128 a[76:79], v1 offset:37056
    v_mfma_f32_16x16x32_bf16 v[24:27], a[96:99], v[112:115], v[60:63]
    v_exp_f32 v16, v16
    v_mfma_f32_16x16x32_bf16 v[24:27], a[100:103], v[116:119], v[24:27]
    ds_read_b128 a[80:83], v1 offset:37120
    v_cvt_pk_bf16_f32 v39, v30, v31
    v_mfma_f32_16x16x32_bf16 v[24:27], a[104:107], v[120:123], v[24:27]
    v_exp_f32 v17, v17
    v_mfma_f32_16x16x32_bf16 v[24:27], a[108:111], v[124:127], v[24:27]
    ds_read_b128 a[84:87], v1 offset:37184
    v_mfma_f32_16x16x32_bf16 v[28:31], a[112:115], v[112:115], v[60:63]
    v_exp_f32 v18, v18
    v_mfma_f32_16x16x32_bf16 v[28:31], a[116:119], v[116:119], v[28:31]
    ds_read_b128 a[88:91], v1 offset:37248
    v_cvt_pk_bf16_f32 v40, v16, v17
    v_mfma_f32_16x16x32_bf16 v[28:31], a[120:123], v[120:123], v[28:31]
    v_exp_f32 v19, v19
    v_mfma_f32_16x16x32_bf16 v[28:31], a[124:127], v[124:127], v[28:31]
    ds_read_b128 a[92:95], v1 offset:37312
    v_mfma_f32_16x16x32_bf16 v[192:195], a[128:131], v[32:35], 0
    v_exp_f32 v20, v20
    v_mfma_f32_16x16x32_bf16 v[192:195], a[132:135], v[36:39], v[192:195]
    ds_read_b128 a[96:99], v1 offset:37376
    v_cvt_pk_bf16_f32 v41, v18, v19
    v_mfma_f32_16x16x32_bf16 v[196:199], a[136:139], v[32:35], 0
    v_exp_f32 v21, v21
    v_mfma_f32_16x16x32_bf16 v[196:199], a[140:143], v[36:39], v[196:199]
    ds_read_b128 a[100:103], v1 offset:37440
    v_mfma_f32_16x16x32_bf16 v[200:203], a[144:147], v[32:35], 0
    v_exp_f32 v22, v22
    v_mfma_f32_16x16x32_bf16 v[200:203], a[148:151], v[36:39], v[200:203]
    ds_read_b128 a[104:107], v1 offset:37504
    v_cvt_pk_bf16_f32 v42, v20, v21
    v_mfma_f32_16x16x32_bf16 v[204:207], a[152:155], v[32:35], 0
    v_exp_f32 v23, v23
    v_mfma_f32_16x16x32_bf16 v[204:207], a[156:159], v[36:39], v[204:207]
    ds_read_b128 a[108:111], v1 offset:37568
    v_mfma_f32_16x16x32_bf16 v[208:211], a[160:163], v[32:35], 0
    v_exp_f32 v24, v24
    v_mfma_f32_16x16x32_bf16 v[208:211], a[164:167], v[36:39], v[208:211]
    ds_read_b128 a[112:115], v1 offset:37632
    v_cvt_pk_bf16_f32 v43, v22, v23
    v_mfma_f32_16x16x32_bf16 v[212:215], a[168:171], v[32:35], 0
    v_exp_f32 v25, v25
    v_mfma_f32_16x16x32_bf16 v[212:215], a[172:175], v[36:39], v[212:215]
    ds_read_b128 a[116:119], v1 offset:37696
    v_mfma_f32_16x16x32_bf16 v[216:219], a[176:179], v[32:35], 0
    v_exp_f32 v26, v26
    v_mfma_f32_16x16x32_bf16 v[216:219], a[180:183], v[36:39], v[216:219]
    ds_read_b128 a[120:123], v1 offset:37760
    v_cvt_pk_bf16_f32 v44, v24, v25
    v_mfma_f32_16x16x32_bf16 v[220:223], a[184:187], v[32:35], 0
    v_exp_f32 v27, v27
    v_mfma_f32_16x16x32_bf16 v[220:223], a[188:191], v[36:39], v[220:223]
    ds_read_b128 a[124:127], v1 offset:37824
    v_smfmac_f32_16x16x64_bf16 a[8:11], a[16:19], v[32:39], v11
    s_waitcnt vmcnt(9) lgkmcnt(12)
    s_barrier
.p2align 5
L2_loop:
    v_mfma_f32_16x16x32_bf16 v[16:19], a[64:67], v[64:67], v[48:51]
    s_sub_u32 s47, s47, s48
    v_exp_f32 v28, v28
    v_mfma_f32_16x16x32_bf16 v[16:19], a[68:71], v[68:71], v[16:19]
    v_cvt_pk_bf16_f32 v45, v26, v27
    v_add_u32 v1, s48, v1
    v_mfma_f32_16x16x32_bf16 v[16:19], a[72:75], v[72:75], v[16:19]
    s_add_u32 m0, s47, 0
    v_exp_f32 v29, v29
    v_mfma_f32_16x16x32_bf16 v[16:19], a[76:79], v[76:79], v[16:19]
    s_waitcnt lgkmcnt(8)
    buffer_load_dwordx4 v5, s[16:19], s46 offen offset:0 lds
    v_mfma_f32_16x16x32_bf16 v[20:23], a[80:83], v[64:67], v[48:51]
L2_pad4:
    s_cbranch_execz L2_pad8
    v_exp_f32 v30, v30
    v_mfma_f32_16x16x32_bf16 v[20:23], a[84:87], v[68:71], v[20:23]
    v_cvt_pk_bf16_f32 v46, v28, v29
    v_add_u32 v2, s48, v2
    v_mfma_f32_16x16x32_bf16 v[20:23], a[88:91], v[72:75], v[20:23]
    s_add_u32 m0, s47, 32
    v_exp_f32 v31, v31
    v_mfma_f32_16x16x32_bf16 v[20:23], a[92:95], v[76:79], v[20:23]
    s_waitcnt lgkmcnt(4)
    buffer_load_dwordx4 v5, s[16:19], s46 offen offset:1024 lds
    v_mfma_f32_16x16x32_bf16 v[24:27], a[96:99], v[64:67], v[48:51]
    s_sub_u32 s48, 0, s48
    v_exp_f32 v16, v16
    v_mfma_f32_16x16x32_bf16 v[24:27], a[100:103], v[68:71], v[24:27]
    v_cvt_pk_bf16_f32 v47, v30, v31
    v_mfma_f32_16x16x32_bf16 v[24:27], a[104:107], v[72:75], v[24:27]
    s_add_u32 m0, s47, 64
    v_exp_f32 v17, v17
    v_mfma_f32_16x16x32_bf16 v[24:27], a[108:111], v[76:79], v[24:27]
    s_waitcnt lgkmcnt(0)
    buffer_load_dwordx4 v5, s[16:19], s46 offen offset:2048 lds
    v_mfma_f32_16x16x32_bf16 v[28:31], a[112:115], v[64:67], v[48:51]
    v_exp_f32 v18, v18
    v_mfma_f32_16x16x32_bf16 v[28:31], a[116:119], v[68:71], v[28:31]
    v_cvt_pk_bf16_f32 v32, v16, v17
    v_mfma_f32_16x16x32_bf16 v[28:31], a[120:123], v[72:75], v[28:31]
    s_add_u32 m0, s47, 96
    v_exp_f32 v19, v19
    v_mfma_f32_16x16x32_bf16 v[28:31], a[124:127], v[76:79], v[28:31]
    buffer_load_dwordx4 v5, s[16:19], s46 offen offset:3072 lds
    v_mfma_f32_16x16x32_bf16 v[224:227], a[128:131], v[40:43], v[224:227]
    v_exp_f32 v20, v20
    v_mfma_f32_16x16x32_bf16 v[224:227], a[132:135], v[44:47], v[224:227]
    ds_read_b64_tr_b16 a[128:129], v2 offset:0
    v_cvt_pk_bf16_f32 v33, v18, v19
    v_mfma_f32_16x16x32_bf16 v[228:231], a[136:139], v[40:43], v[228:231]
    s_add_u32 m0, s47, 16896
    v_exp_f32 v21, v21
    v_mfma_f32_16x16x32_bf16 v[228:231], a[140:143], v[44:47], v[228:231]
    buffer_load_dwordx4 v5, s[20:23], s46 offen offset:0 lds
    v_mfma_f32_16x16x32_bf16 v[232:235], a[144:147], v[40:43], v[232:235]
    v_exp_f32 v22, v22
    v_mfma_f32_16x16x32_bf16 v[232:235], a[148:151], v[44:47], v[232:235]
    ds_read_b64_tr_b16 a[130:131], v2 offset:256
    v_cvt_pk_bf16_f32 v34, v20, v21
    v_mfma_f32_16x16x32_bf16 v[236:239], a[152:155], v[40:43], v[236:239]
    s_add_u32 m0, s47, 16928
    v_exp_f32 v23, v23
    v_mfma_f32_16x16x32_bf16 v[236:239], a[156:159], v[44:47], v[236:239]
    buffer_load_dwordx4 v5, s[20:23], s46 offen offset:1024 lds
    v_mfma_f32_16x16x32_bf16 v[240:243], a[160:163], v[40:43], v[240:243]
    v_exp_f32 v24, v24
    v_mfma_f32_16x16x32_bf16 v[240:243], a[164:167], v[44:47], v[240:243]
    ds_read_b64_tr_b16 a[132:133], v2 offset:512
    v_cvt_pk_bf16_f32 v35, v22, v23
    v_mfma_f32_16x16x32_bf16 v[244:247], a[168:171], v[40:43], v[244:247]
    s_add_u32 m0, s47, 16960
    v_exp_f32 v25, v25
    v_mfma_f32_16x16x32_bf16 v[244:247], a[172:175], v[44:47], v[244:247]
    buffer_load_dwordx4 v5, s[20:23], s46 offen offset:2048 lds
    v_mfma_f32_16x16x32_bf16 v[248:251], a[176:179], v[40:43], v[248:251]
    v_exp_f32 v26, v26
    v_mfma_f32_16x16x32_bf16 v[248:251], a[180:183], v[44:47], v[248:251]
    ds_read_b64_tr_b16 a[134:135], v2 offset:768
    v_cvt_pk_bf16_f32 v36, v24, v25
    v_mfma_f32_16x16x32_bf16 v[252:255], a[184:187], v[40:43], v[252:255]
    s_add_u32 m0, s47, 16992
    v_exp_f32 v27, v27
    v_mfma_f32_16x16x32_bf16 v[252:255], a[188:191], v[44:47], v[252:255]
    buffer_load_dwordx4 v5, s[20:23], s46 offen offset:3072 lds
    v_smfmac_f32_16x16x64_bf16 a[12:15], a[16:19], v[40:47], v11
    ds_read_b64_tr_b16 a[136:137], v2 offset:32
    v_mfma_f32_16x16x32_bf16 v[16:19], a[64:67], v[80:83], v[52:55]
    v_exp_f32 v28, v28
    v_mfma_f32_16x16x32_bf16 v[16:19], a[68:71], v[84:87], v[16:19]
    ds_read_b64_tr_b16 a[138:139], v2 offset:288
    v_cvt_pk_bf16_f32 v37, v26, v27
    v_mfma_f32_16x16x32_bf16 v[16:19], a[72:75], v[88:91], v[16:19]
    v_exp_f32 v29, v29
    v_mfma_f32_16x16x32_bf16 v[16:19], a[76:79], v[92:95], v[16:19]
    global_load_dword a63, v9, s[98:99]
    v_mfma_f32_16x16x32_bf16 v[20:23], a[80:83], v[80:83], v[52:55]
    v_exp_f32 v30, v30
    v_mfma_f32_16x16x32_bf16 v[20:23], a[84:87], v[84:87], v[20:23]
    ds_read_b64_tr_b16 a[140:141], v2 offset:544
    v_cvt_pk_bf16_f32 v38, v28, v29
    v_mfma_f32_16x16x32_bf16 v[20:23], a[88:91], v[88:91], v[20:23]
    v_exp_f32 v31, v31
    v_mfma_f32_16x16x32_bf16 v[20:23], a[92:95], v[92:95], v[20:23]
    ds_read_b64_tr_b16 a[142:143], v2 offset:800
    v_mfma_f32_16x16x32_bf16 v[24:27], a[96:99], v[80:83], v[52:55]
    v_exp_f32 v16, v16
    v_mfma_f32_16x16x32_bf16 v[24:27], a[100:103], v[84:87], v[24:27]
    ds_read_b64_tr_b16 a[144:145], v2 offset:64
    v_cvt_pk_bf16_f32 v39, v30, v31
    v_mfma_f32_16x16x32_bf16 v[24:27], a[104:107], v[88:91], v[24:27]
    v_exp_f32 v17, v17
    v_mfma_f32_16x16x32_bf16 v[24:27], a[108:111], v[92:95], v[24:27]
    ds_read_b64_tr_b16 a[146:147], v2 offset:320
    v_mfma_f32_16x16x32_bf16 v[28:31], a[112:115], v[80:83], v[52:55]
    v_exp_f32 v18, v18
    v_mfma_f32_16x16x32_bf16 v[28:31], a[116:119], v[84:87], v[28:31]
    ds_read_b64_tr_b16 a[148:149], v2 offset:576
    v_cvt_pk_bf16_f32 v40, v16, v17
    v_mfma_f32_16x16x32_bf16 v[28:31], a[120:123], v[88:91], v[28:31]
    v_exp_f32 v19, v19
    v_mfma_f32_16x16x32_bf16 v[28:31], a[124:127], v[92:95], v[28:31]
    ds_read_b64_tr_b16 a[150:151], v2 offset:832
    v_mfma_f32_16x16x32_bf16 v[128:131], a[192:195], v[32:35], v[128:131]
    v_exp_f32 v20, v20
    v_mfma_f32_16x16x32_bf16 v[128:131], a[196:199], v[36:39], v[128:131]
    ds_read_b64_tr_b16 a[152:153], v2 offset:96
    v_cvt_pk_bf16_f32 v41, v18, v19
    v_mfma_f32_16x16x32_bf16 v[132:135], a[200:203], v[32:35], v[132:135]
    v_exp_f32 v21, v21
    v_mfma_f32_16x16x32_bf16 v[132:135], a[204:207], v[36:39], v[132:135]
    ds_read_b64_tr_b16 a[154:155], v2 offset:352
    v_mfma_f32_16x16x32_bf16 v[136:139], a[208:211], v[32:35], v[136:139]
    v_exp_f32 v22, v22
    v_mfma_f32_16x16x32_bf16 v[136:139], a[212:215], v[36:39], v[136:139]
    ds_read_b64_tr_b16 a[156:157], v2 offset:608
    v_cvt_pk_bf16_f32 v42, v20, v21
    v_mfma_f32_16x16x32_bf16 v[140:143], a[216:219], v[32:35], v[140:143]
    v_exp_f32 v23, v23
    v_mfma_f32_16x16x32_bf16 v[140:143], a[220:223], v[36:39], v[140:143]
    ds_read_b64_tr_b16 a[158:159], v2 offset:864
    v_mfma_f32_16x16x32_bf16 v[144:147], a[224:227], v[32:35], v[144:147]
    v_exp_f32 v24, v24
    v_mfma_f32_16x16x32_bf16 v[144:147], a[228:231], v[36:39], v[144:147]
    ds_read_b64_tr_b16 a[160:161], v2 offset:128
    v_cvt_pk_bf16_f32 v43, v22, v23
    v_mfma_f32_16x16x32_bf16 v[148:151], a[232:235], v[32:35], v[148:151]
    v_exp_f32 v25, v25
    v_mfma_f32_16x16x32_bf16 v[148:151], a[236:239], v[36:39], v[148:151]
    ds_read_b64_tr_b16 a[162:163], v2 offset:384
    v_mfma_f32_16x16x32_bf16 v[152:155], a[240:243], v[32:35], v[152:155]
    v_exp_f32 v26, v26
    v_mfma_f32_16x16x32_bf16 v[152:155], a[244:247], v[36:39], v[152:155]
    ds_read_b64_tr_b16 a[164:165], v2 offset:640
    v_cvt_pk_bf16_f32 v44, v24, v25
    v_mfma_f32_16x16x32_bf16 v[156:159], a[248:251], v[32:35], v[156:159]
    v_exp_f32 v27, v27
    v_mfma_f32_16x16x32_bf16 v[156:159], a[252:255], v[36:39], v[156:159]
    ds_read_b64_tr_b16 a[166:167], v2 offset:896
    v_smfmac_f32_16x16x64_bf16 a[0:3], a[16:19], v[32:39], v11
    ds_read_b64_tr_b16 a[168:169], v2 offset:160
    v_mfma_f32_16x16x32_bf16 v[16:19], a[64:67], v[96:99], v[56:59]
    v_exp_f32 v28, v28
    v_mfma_f32_16x16x32_bf16 v[16:19], a[68:71], v[100:103], v[16:19]
    ds_read_b64_tr_b16 a[170:171], v2 offset:416
    v_cvt_pk_bf16_f32 v45, v26, v27
    v_mfma_f32_16x16x32_bf16 v[16:19], a[72:75], v[104:107], v[16:19]
    v_exp_f32 v29, v29
    v_mfma_f32_16x16x32_bf16 v[16:19], a[76:79], v[108:111], v[16:19]
    ds_read_b64_tr_b16 a[172:173], v2 offset:672
    v_mfma_f32_16x16x32_bf16 v[20:23], a[80:83], v[96:99], v[56:59]
    v_exp_f32 v30, v30
    v_mfma_f32_16x16x32_bf16 v[20:23], a[84:87], v[100:103], v[20:23]
    ds_read_b64_tr_b16 a[174:175], v2 offset:928
    v_cvt_pk_bf16_f32 v46, v28, v29
    v_mfma_f32_16x16x32_bf16 v[20:23], a[88:91], v[104:107], v[20:23]
    v_exp_f32 v31, v31
    v_mfma_f32_16x16x32_bf16 v[20:23], a[92:95], v[108:111], v[20:23]
    ds_read_b64_tr_b16 a[176:177], v2 offset:192
    v_mfma_f32_16x16x32_bf16 v[24:27], a[96:99], v[96:99], v[56:59]
    v_exp_f32 v16, v16
    v_mfma_f32_16x16x32_bf16 v[24:27], a[100:103], v[100:103], v[24:27]
    ds_read_b64_tr_b16 a[178:179], v2 offset:448
    v_cvt_pk_bf16_f32 v47, v30, v31
    v_mfma_f32_16x16x32_bf16 v[24:27], a[104:107], v[104:107], v[24:27]
    v_exp_f32 v17, v17
    v_mfma_f32_16x16x32_bf16 v[24:27], a[108:111], v[108:111], v[24:27]
    ds_read_b64_tr_b16 a[180:181], v2 offset:704
    v_mfma_f32_16x16x32_bf16 v[28:31], a[112:115], v[96:99], v[56:59]
    v_exp_f32 v18, v18
    v_mfma_f32_16x16x32_bf16 v[28:31], a[116:119], v[100:103], v[28:31]
    ds_read_b64_tr_b16 a[182:183], v2 offset:960
    v_cvt_pk_bf16_f32 v32, v16, v17
    v_mfma_f32_16x16x32_bf16 v[28:31], a[120:123], v[104:107], v[28:31]
    v_exp_f32 v19, v19
    v_mfma_f32_16x16x32_bf16 v[28:31], a[124:127], v[108:111], v[28:31]
    ds_read_b64_tr_b16 a[184:185], v2 offset:224
    v_mfma_f32_16x16x32_bf16 v[160:163], a[192:195], v[40:43], v[160:163]
    v_exp_f32 v20, v20
    v_mfma_f32_16x16x32_bf16 v[160:163], a[196:199], v[44:47], v[160:163]
    ds_read_b64_tr_b16 a[186:187], v2 offset:480
    v_cvt_pk_bf16_f32 v33, v18, v19
    v_mfma_f32_16x16x32_bf16 v[164:167], a[200:203], v[40:43], v[164:167]
    v_exp_f32 v21, v21
    v_mfma_f32_16x16x32_bf16 v[164:167], a[204:207], v[44:47], v[164:167]
    ds_read_b64_tr_b16 a[188:189], v2 offset:736
    v_mfma_f32_16x16x32_bf16 v[168:171], a[208:211], v[40:43], v[168:171]
    v_exp_f32 v22, v22
    v_mfma_f32_16x16x32_bf16 v[168:171], a[212:215], v[44:47], v[168:171]
    ds_read_b64_tr_b16 a[190:191], v2 offset:992
    v_cvt_pk_bf16_f32 v34, v20, v21
    v_mfma_f32_16x16x32_bf16 v[172:175], a[216:219], v[40:43], v[172:175]
    v_exp_f32 v23, v23
    v_mfma_f32_16x16x32_bf16 v[172:175], a[220:223], v[44:47], v[172:175]
    v_mfma_f32_16x16x32_bf16 v[176:179], a[224:227], v[40:43], v[176:179]
    v_exp_f32 v24, v24
    v_mfma_f32_16x16x32_bf16 v[176:179], a[228:231], v[44:47], v[176:179]
    v_cvt_pk_bf16_f32 v35, v22, v23
    v_mfma_f32_16x16x32_bf16 v[180:183], a[232:235], v[40:43], v[180:183]
    v_exp_f32 v25, v25
    v_mfma_f32_16x16x32_bf16 v[180:183], a[236:239], v[44:47], v[180:183]
    v_mfma_f32_16x16x32_bf16 v[184:187], a[240:243], v[40:43], v[184:187]
    v_exp_f32 v26, v26
    v_mfma_f32_16x16x32_bf16 v[184:187], a[244:247], v[44:47], v[184:187]
    v_cvt_pk_bf16_f32 v36, v24, v25
    v_mfma_f32_16x16x32_bf16 v[188:191], a[248:251], v[40:43], v[188:191]
    v_exp_f32 v27, v27
    v_mfma_f32_16x16x32_bf16 v[188:191], a[252:255], v[44:47], v[188:191]
    v_smfmac_f32_16x16x64_bf16 a[4:7], a[16:19], v[40:47], v11
    v_mfma_f32_16x16x32_bf16 v[16:19], a[64:67], v[112:115], v[60:63]
    v_exp_f32 v28, v28
    v_mfma_f32_16x16x32_bf16 v[16:19], a[68:71], v[116:119], v[16:19]
    s_add_u32 s46, s46, 16384
    ds_read_b128 a[64:67], v1 offset:0
    v_cvt_pk_bf16_f32 v37, v26, v27
    v_mfma_f32_16x16x32_bf16 v[16:19], a[72:75], v[120:123], v[16:19]
    v_exp_f32 v29, v29
    v_mfma_f32_16x16x32_bf16 v[16:19], a[76:79], v[124:127], v[16:19]
    ds_read_b128 a[68:71], v1 offset:64
    v_mfma_f32_16x16x32_bf16 v[20:23], a[80:83], v[112:115], v[60:63]
    v_exp_f32 v30, v30
    v_mfma_f32_16x16x32_bf16 v[20:23], a[84:87], v[116:119], v[20:23]
    ds_read_b128 a[72:75], v1 offset:128
    v_cvt_pk_bf16_f32 v38, v28, v29
    v_mfma_f32_16x16x32_bf16 v[20:23], a[88:91], v[120:123], v[20:23]
    v_exp_f32 v31, v31
    v_mfma_f32_16x16x32_bf16 v[20:23], a[92:95], v[124:127], v[20:23]
    ds_read_b128 a[76:79], v1 offset:192
    v_mfma_f32_16x16x32_bf16 v[24:27], a[96:99], v[112:115], v[60:63]
    v_exp_f32 v16, v16
    v_mfma_f32_16x16x32_bf16 v[24:27], a[100:103], v[116:119], v[24:27]
    ds_read_b128 a[80:83], v1 offset:256
    v_cvt_pk_bf16_f32 v39, v30, v31
    v_mfma_f32_16x16x32_bf16 v[24:27], a[104:107], v[120:123], v[24:27]
    v_exp_f32 v17, v17
    v_mfma_f32_16x16x32_bf16 v[24:27], a[108:111], v[124:127], v[24:27]
    ds_read_b128 a[84:87], v1 offset:320
    v_mfma_f32_16x16x32_bf16 v[28:31], a[112:115], v[112:115], v[60:63]
    v_exp_f32 v18, v18
    v_mfma_f32_16x16x32_bf16 v[28:31], a[116:119], v[116:119], v[28:31]
    ds_read_b128 a[88:91], v1 offset:384
    v_cvt_pk_bf16_f32 v40, v16, v17
    v_mfma_f32_16x16x32_bf16 v[28:31], a[120:123], v[120:123], v[28:31]
    v_exp_f32 v19, v19
    v_mfma_f32_16x16x32_bf16 v[28:31], a[124:127], v[124:127], v[28:31]
    ds_read_b128 a[92:95], v1 offset:448
    v_mfma_f32_16x16x32_bf16 v[192:195], a[192:195], v[32:35], v[192:195]
    v_exp_f32 v20, v20
    v_mfma_f32_16x16x32_bf16 v[192:195], a[196:199], v[36:39], v[192:195]
    ds_read_b128 a[96:99], v1 offset:512
    v_cvt_pk_bf16_f32 v41, v18, v19
    v_mfma_f32_16x16x32_bf16 v[196:199], a[200:203], v[32:35], v[196:199]
    v_exp_f32 v21, v21
    v_mfma_f32_16x16x32_bf16 v[196:199], a[204:207], v[36:39], v[196:199]
    ds_read_b128 a[100:103], v1 offset:576
    v_mfma_f32_16x16x32_bf16 v[200:203], a[208:211], v[32:35], v[200:203]
    v_exp_f32 v22, v22
    v_mfma_f32_16x16x32_bf16 v[200:203], a[212:215], v[36:39], v[200:203]
    ds_read_b128 a[104:107], v1 offset:640
    v_cvt_pk_bf16_f32 v42, v20, v21
    v_mfma_f32_16x16x32_bf16 v[204:207], a[216:219], v[32:35], v[204:207]
    v_exp_f32 v23, v23
    v_mfma_f32_16x16x32_bf16 v[204:207], a[220:223], v[36:39], v[204:207]
    ds_read_b128 a[108:111], v1 offset:704
    v_mfma_f32_16x16x32_bf16 v[208:211], a[224:227], v[32:35], v[208:211]
    v_exp_f32 v24, v24
    v_mfma_f32_16x16x32_bf16 v[208:211], a[228:231], v[36:39], v[208:211]
    ds_read_b128 a[112:115], v1 offset:768
    v_cvt_pk_bf16_f32 v43, v22, v23
    v_mfma_f32_16x16x32_bf16 v[212:215], a[232:235], v[32:35], v[212:215]
    v_exp_f32 v25, v25
    v_mfma_f32_16x16x32_bf16 v[212:215], a[236:239], v[36:39], v[212:215]
    ds_read_b128 a[116:119], v1 offset:832
    v_mfma_f32_16x16x32_bf16 v[216:219], a[240:243], v[32:35], v[216:219]
    v_exp_f32 v26, v26
    v_mfma_f32_16x16x32_bf16 v[216:219], a[244:247], v[36:39], v[216:219]
    ds_read_b128 a[120:123], v1 offset:896
    v_cvt_pk_bf16_f32 v44, v24, v25
    v_mfma_f32_16x16x32_bf16 v[220:223], a[248:251], v[32:35], v[220:223]
    v_exp_f32 v27, v27
    v_mfma_f32_16x16x32_bf16 v[220:223], a[252:255], v[36:39], v[220:223]
    ds_read_b128 a[124:127], v1 offset:960
    v_smfmac_f32_16x16x64_bf16 a[8:11], a[16:19], v[32:39], v11
    s_waitcnt vmcnt(9) lgkmcnt(12)
    s_barrier
    v_mfma_f32_16x16x32_bf16 v[16:19], a[64:67], v[64:67], v[48:51]
    v_exp_f32 v28, v28
    v_mfma_f32_16x16x32_bf16 v[16:19], a[68:71], v[68:71], v[16:19]
    v_cvt_pk_bf16_f32 v45, v26, v27
    v_mfma_f32_16x16x32_bf16 v[16:19], a[72:75], v[72:75], v[16:19]
    s_add_u32 m0, s47, 36864
    v_exp_f32 v29, v29
    v_mfma_f32_16x16x32_bf16 v[16:19], a[76:79], v[76:79], v[16:19]
    s_waitcnt lgkmcnt(8)
    buffer_load_dwordx4 v5, s[16:19], s46 offen offset:0 lds
    v_mfma_f32_16x16x32_bf16 v[20:23], a[80:83], v[64:67], v[48:51]
    v_exp_f32 v30, v30
    v_mfma_f32_16x16x32_bf16 v[20:23], a[84:87], v[68:71], v[20:23]
    v_cvt_pk_bf16_f32 v46, v28, v29
    v_mfma_f32_16x16x32_bf16 v[20:23], a[88:91], v[72:75], v[20:23]
    s_add_u32 m0, s47, 36896
    v_exp_f32 v31, v31
    v_mfma_f32_16x16x32_bf16 v[20:23], a[92:95], v[76:79], v[20:23]
    s_waitcnt lgkmcnt(4)
    buffer_load_dwordx4 v5, s[16:19], s46 offen offset:1024 lds
    v_mfma_f32_16x16x32_bf16 v[24:27], a[96:99], v[64:67], v[48:51]
    v_exp_f32 v16, v16
    v_mfma_f32_16x16x32_bf16 v[24:27], a[100:103], v[68:71], v[24:27]
    v_cvt_pk_bf16_f32 v47, v30, v31
    v_mfma_f32_16x16x32_bf16 v[24:27], a[104:107], v[72:75], v[24:27]
    s_add_u32 m0, s47, 36928
    v_exp_f32 v17, v17
    v_mfma_f32_16x16x32_bf16 v[24:27], a[108:111], v[76:79], v[24:27]
    s_waitcnt lgkmcnt(0)
    buffer_load_dwordx4 v5, s[16:19], s46 offen offset:2048 lds
    v_mfma_f32_16x16x32_bf16 v[28:31], a[112:115], v[64:67], v[48:51]
    v_exp_f32 v18, v18
    v_mfma_f32_16x16x32_bf16 v[28:31], a[116:119], v[68:71], v[28:31]
    v_cvt_pk_bf16_f32 v32, v16, v17
    v_mfma_f32_16x16x32_bf16 v[28:31], a[120:123], v[72:75], v[28:31]
    s_add_u32 m0, s47, 36960
    v_exp_f32 v19, v19
    v_mfma_f32_16x16x32_bf16 v[28:31], a[124:127], v[76:79], v[28:31]
    buffer_load_dwordx4 v5, s[16:19], s46 offen offset:3072 lds
    v_mfma_f32_16x16x32_bf16 v[224:227], a[192:195], v[40:43], v[224:227]
    v_exp_f32 v20, v20
    v_mfma_f32_16x16x32_bf16 v[224:227], a[196:199], v[44:47], v[224:227]
    ds_read_b64_tr_b16 a[192:193], v2 offset:36864
    v_cvt_pk_bf16_f32 v33, v18, v19
    v_mfma_f32_16x16x32_bf16 v[228:231], a[200:203], v[40:43], v[228:231]
    s_add_u32 m0, s47, 53760
    v_exp_f32 v21, v21
    v_mfma_f32_16x16x32_bf16 v[228:231], a[204:207], v[44:47], v[228:231]
    buffer_load_dwordx4 v5, s[20:23], s46 offen offset:0 lds
    v_mfma_f32_16x16x32_bf16 v[232:235], a[208:211], v[40:43], v[232:235]
    v_exp_f32 v22, v22
    v_mfma_f32_16x16x32_bf16 v[232:235], a[212:215], v[44:47], v[232:235]
    ds_read_b64_tr_b16 a[194:195], v2 offset:37120
    v_cvt_pk_bf16_f32 v34, v20, v21
    v_mfma_f32_16x16x32_bf16 v[236:239], a[216:219], v[40:43], v[236:239]
    s_add_u32 m0, s47, 53792
    v_exp_f32 v23, v23
    v_mfma_f32_16x16x32_bf16 v[236:239], a[220:223], v[44:47], v[236:239]
    buffer_load_dwordx4 v5, s[20:23], s46 offen offset:1024 lds
    v_mfma_f32_16x16x32_bf16 v[240:243], a[224:227], v[40:43], v[240:243]
    v_exp_f32 v24, v24
    v_mfma_f32_16x16x32_bf16 v[240:243], a[228:231], v[44:47], v[240:243]
    ds_read_b64_tr_b16 a[196:197], v2 offset:37376
    v_cvt_pk_bf16_f32 v35, v22, v23
    v_mfma_f32_16x16x32_bf16 v[244:247], a[232:235], v[40:43], v[244:247]
    s_add_u32 m0, s47, 53824
    v_exp_f32 v25, v25
    v_mfma_f32_16x16x32_bf16 v[244:247], a[236:239], v[44:47], v[244:247]
    buffer_load_dwordx4 v5, s[20:23], s46 offen offset:2048 lds
    v_mfma_f32_16x16x32_bf16 v[248:251], a[240:243], v[40:43], v[248:251]
    v_exp_f32 v26, v26
    v_mfma_f32_16x16x32_bf16 v[248:251], a[244:247], v[44:47], v[248:251]
    ds_read_b64_tr_b16 a[198:199], v2 offset:37632
    v_cvt_pk_bf16_f32 v36, v24, v25
    v_mfma_f32_16x16x32_bf16 v[252:255], a[248:251], v[40:43], v[252:255]
    s_add_u32 m0, s47, 53856
    v_exp_f32 v27, v27
    v_mfma_f32_16x16x32_bf16 v[252:255], a[252:255], v[44:47], v[252:255]
    buffer_load_dwordx4 v5, s[20:23], s46 offen offset:3072 lds
    v_smfmac_f32_16x16x64_bf16 a[12:15], a[16:19], v[40:47], v11
    ds_read_b64_tr_b16 a[200:201], v2 offset:36896
    v_mfma_f32_16x16x32_bf16 v[16:19], a[64:67], v[80:83], v[52:55]
    v_exp_f32 v28, v28
    v_mfma_f32_16x16x32_bf16 v[16:19], a[68:71], v[84:87], v[16:19]
    ds_read_b64_tr_b16 a[202:203], v2 offset:37152
    v_cvt_pk_bf16_f32 v37, v26, v27
    v_mfma_f32_16x16x32_bf16 v[16:19], a[72:75], v[88:91], v[16:19]
    v_exp_f32 v29, v29
    v_mfma_f32_16x16x32_bf16 v[16:19], a[76:79], v[92:95], v[16:19]
    ds_read_b64_tr_b16 a[204:205], v2 offset:37408
    v_mfma_f32_16x16x32_bf16 v[20:23], a[80:83], v[80:83], v[52:55]
    v_exp_f32 v30, v30
    v_mfma_f32_16x16x32_bf16 v[20:23], a[84:87], v[84:87], v[20:23]
    ds_read_b64_tr_b16 a[206:207], v2 offset:37664
    v_cvt_pk_bf16_f32 v38, v28, v29
    v_mfma_f32_16x16x32_bf16 v[20:23], a[88:91], v[88:91], v[20:23]
    v_exp_f32 v31, v31
    v_mfma_f32_16x16x32_bf16 v[20:23], a[92:95], v[92:95], v[20:23]
    ds_read_b64_tr_b16 a[208:209], v2 offset:36928
    v_mfma_f32_16x16x32_bf16 v[24:27], a[96:99], v[80:83], v[52:55]
    v_exp_f32 v16, v16
    v_mfma_f32_16x16x32_bf16 v[24:27], a[100:103], v[84:87], v[24:27]
    ds_read_b64_tr_b16 a[210:211], v2 offset:37184
    v_cvt_pk_bf16_f32 v39, v30, v31
    v_mfma_f32_16x16x32_bf16 v[24:27], a[104:107], v[88:91], v[24:27]
    v_exp_f32 v17, v17
    v_mfma_f32_16x16x32_bf16 v[24:27], a[108:111], v[92:95], v[24:27]
    ds_read_b64_tr_b16 a[212:213], v2 offset:37440
    v_mfma_f32_16x16x32_bf16 v[28:31], a[112:115], v[80:83], v[52:55]
    v_exp_f32 v18, v18
    v_mfma_f32_16x16x32_bf16 v[28:31], a[116:119], v[84:87], v[28:31]
    ds_read_b64_tr_b16 a[214:215], v2 offset:37696
    v_cvt_pk_bf16_f32 v40, v16, v17
    v_mfma_f32_16x16x32_bf16 v[28:31], a[120:123], v[88:91], v[28:31]
    v_exp_f32 v19, v19
    v_mfma_f32_16x16x32_bf16 v[28:31], a[124:127], v[92:95], v[28:31]
    ds_read_b64_tr_b16 a[216:217], v2 offset:36960
    v_mfma_f32_16x16x32_bf16 v[128:131], a[128:131], v[32:35], v[128:131]
    v_exp_f32 v20, v20
    v_mfma_f32_16x16x32_bf16 v[128:131], a[132:135], v[36:39], v[128:131]
    ds_read_b64_tr_b16 a[218:219], v2 offset:37216
    v_cvt_pk_bf16_f32 v41, v18, v19
    v_mfma_f32_16x16x32_bf16 v[132:135], a[136:139], v[32:35], v[132:135]
    v_exp_f32 v21, v21
    v_mfma_f32_16x16x32_bf16 v[132:135], a[140:143], v[36:39], v[132:135]
    ds_read_b64_tr_b16 a[220:221], v2 offset:37472
    v_mfma_f32_16x16x32_bf16 v[136:139], a[144:147], v[32:35], v[136:139]
    v_exp_f32 v22, v22
    v_mfma_f32_16x16x32_bf16 v[136:139], a[148:151], v[36:39], v[136:139]
    ds_read_b64_tr_b16 a[222:223], v2 offset:37728
    v_cvt_pk_bf16_f32 v42, v20, v21
    v_mfma_f32_16x16x32_bf16 v[140:143], a[152:155], v[32:35], v[140:143]
    v_exp_f32 v23, v23
    v_mfma_f32_16x16x32_bf16 v[140:143], a[156:159], v[36:39], v[140:143]
    ds_read_b64_tr_b16 a[224:225], v2 offset:36992
    v_mfma_f32_16x16x32_bf16 v[144:147], a[160:163], v[32:35], v[144:147]
    v_exp_f32 v24, v24
    v_mfma_f32_16x16x32_bf16 v[144:147], a[164:167], v[36:39], v[144:147]
    ds_read_b64_tr_b16 a[226:227], v2 offset:37248
    v_cvt_pk_bf16_f32 v43, v22, v23
    v_mfma_f32_16x16x32_bf16 v[148:151], a[168:171], v[32:35], v[148:151]
    v_exp_f32 v25, v25
    v_mfma_f32_16x16x32_bf16 v[148:151], a[172:175], v[36:39], v[148:151]
    ds_read_b64_tr_b16 a[228:229], v2 offset:37504
    v_mfma_f32_16x16x32_bf16 v[152:155], a[176:179], v[32:35], v[152:155]
    v_exp_f32 v26, v26
    v_mfma_f32_16x16x32_bf16 v[152:155], a[180:183], v[36:39], v[152:155]
    ds_read_b64_tr_b16 a[230:231], v2 offset:37760
    v_cvt_pk_bf16_f32 v44, v24, v25
    v_mfma_f32_16x16x32_bf16 v[156:159], a[184:187], v[32:35], v[156:159]
    v_exp_f32 v27, v27
    v_mfma_f32_16x16x32_bf16 v[156:159], a[188:191], v[36:39], v[156:159]
    ds_read_b64_tr_b16 a[232:233], v2 offset:37024
    v_smfmac_f32_16x16x64_bf16 a[0:3], a[16:19], v[32:39], v11
    ds_read_b64_tr_b16 a[234:235], v2 offset:37280
    v_mfma_f32_16x16x32_bf16 v[16:19], a[64:67], v[96:99], v[56:59]
    v_exp_f32 v28, v28
    v_mfma_f32_16x16x32_bf16 v[16:19], a[68:71], v[100:103], v[16:19]
    ds_read_b64_tr_b16 a[236:237], v2 offset:37536
    v_cvt_pk_bf16_f32 v45, v26, v27
    v_mfma_f32_16x16x32_bf16 v[16:19], a[72:75], v[104:107], v[16:19]
    v_exp_f32 v29, v29
    v_mfma_f32_16x16x32_bf16 v[16:19], a[76:79], v[108:111], v[16:19]
    ds_read_b64_tr_b16 a[238:239], v2 offset:37792
    v_mfma_f32_16x16x32_bf16 v[20:23], a[80:83], v[96:99], v[56:59]
    v_exp_f32 v30, v30
    v_mfma_f32_16x16x32_bf16 v[20:23], a[84:87], v[100:103], v[20:23]
    ds_read_b64_tr_b16 a[240:241], v2 offset:37056
    v_cvt_pk_bf16_f32 v46, v28, v29
    v_mfma_f32_16x16x32_bf16 v[20:23], a[88:91], v[104:107], v[20:23]
    v_exp_f32 v31, v31
    v_mfma_f32_16x16x32_bf16 v[20:23], a[92:95], v[108:111], v[20:23]
    ds_read_b64_tr_b16 a[242:243], v2 offset:37312
    v_mfma_f32_16x16x32_bf16 v[24:27], a[96:99], v[96:99], v[56:59]
    v_exp_f32 v16, v16
    v_mfma_f32_16x16x32_bf16 v[24:27], a[100:103], v[100:103], v[24:27]
    ds_read_b64_tr_b16 a[244:245], v2 offset:37568
    v_cvt_pk_bf16_f32 v47, v30, v31
    v_mfma_f32_16x16x32_bf16 v[24:27], a[104:107], v[104:107], v[24:27]
    v_exp_f32 v17, v17
    v_mfma_f32_16x16x32_bf16 v[24:27], a[108:111], v[108:111], v[24:27]
    ds_read_b64_tr_b16 a[246:247], v2 offset:37824
    v_mfma_f32_16x16x32_bf16 v[28:31], a[112:115], v[96:99], v[56:59]
    v_exp_f32 v18, v18
    v_mfma_f32_16x16x32_bf16 v[28:31], a[116:119], v[100:103], v[28:31]
    ds_read_b64_tr_b16 a[248:249], v2 offset:37088
    v_cvt_pk_bf16_f32 v32, v16, v17
    v_mfma_f32_16x16x32_bf16 v[28:31], a[120:123], v[104:107], v[28:31]
    v_exp_f32 v19, v19
    v_mfma_f32_16x16x32_bf16 v[28:31], a[124:127], v[108:111], v[28:31]
    ds_read_b64_tr_b16 a[250:251], v2 offset:37344
    v_mfma_f32_16x16x32_bf16 v[160:163], a[128:131], v[40:43], v[160:163]
    v_exp_f32 v20, v20
    v_mfma_f32_16x16x32_bf16 v[160:163], a[132:135], v[44:47], v[160:163]
    ds_read_b64_tr_b16 a[252:253], v2 offset:37600
    v_cvt_pk_bf16_f32 v33, v18, v19
    v_mfma_f32_16x16x32_bf16 v[164:167], a[136:139], v[40:43], v[164:167]
    v_exp_f32 v21, v21
    v_mfma_f32_16x16x32_bf16 v[164:167], a[140:143], v[44:47], v[164:167]
    ds_read_b64_tr_b16 a[254:255], v2 offset:37856
    v_mfma_f32_16x16x32_bf16 v[168:171], a[144:147], v[40:43], v[168:171]
    v_exp_f32 v22, v22
    v_mfma_f32_16x16x32_bf16 v[168:171], a[148:151], v[44:47], v[168:171]
    v_cvt_pk_bf16_f32 v34, v20, v21
    v_mfma_f32_16x16x32_bf16 v[172:175], a[152:155], v[40:43], v[172:175]
    v_exp_f32 v23, v23
    v_mfma_f32_16x16x32_bf16 v[172:175], a[156:159], v[44:47], v[172:175]
    v_mfma_f32_16x16x32_bf16 v[176:179], a[160:163], v[40:43], v[176:179]
    v_exp_f32 v24, v24
    v_mfma_f32_16x16x32_bf16 v[176:179], a[164:167], v[44:47], v[176:179]
    v_cvt_pk_bf16_f32 v35, v22, v23
    v_mfma_f32_16x16x32_bf16 v[180:183], a[168:171], v[40:43], v[180:183]
    v_exp_f32 v25, v25
    v_mfma_f32_16x16x32_bf16 v[180:183], a[172:175], v[44:47], v[180:183]
    v_mfma_f32_16x16x32_bf16 v[184:187], a[176:179], v[40:43], v[184:187]
    v_exp_f32 v26, v26
    v_mfma_f32_16x16x32_bf16 v[184:187], a[180:183], v[44:47], v[184:187]
    v_cvt_pk_bf16_f32 v36, v24, v25
    v_mfma_f32_16x16x32_bf16 v[188:191], a[184:187], v[40:43], v[188:191]
    v_exp_f32 v27, v27
    v_mfma_f32_16x16x32_bf16 v[188:191], a[188:191], v[44:47], v[188:191]
    v_smfmac_f32_16x16x64_bf16 a[4:7], a[16:19], v[40:47], v11
    v_mfma_f32_16x16x32_bf16 v[16:19], a[64:67], v[112:115], v[60:63]
    v_exp_f32 v28, v28
    v_mfma_f32_16x16x32_bf16 v[16:19], a[68:71], v[116:119], v[16:19]
    s_add_u32 s46, s46, 16384
    ds_read_b128 a[64:67], v1 offset:36864
    v_cvt_pk_bf16_f32 v37, v26, v27
    v_mfma_f32_16x16x32_bf16 v[16:19], a[72:75], v[120:123], v[16:19]
    v_exp_f32 v29, v29
    v_mfma_f32_16x16x32_bf16 v[16:19], a[76:79], v[124:127], v[16:19]
    ds_read_b128 a[68:71], v1 offset:36928
    v_mfma_f32_16x16x32_bf16 v[20:23], a[80:83], v[112:115], v[60:63]
    v_exp_f32 v30, v30
    v_mfma_f32_16x16x32_bf16 v[20:23], a[84:87], v[116:119], v[20:23]
    ds_read_b128 a[72:75], v1 offset:36992
    v_cvt_pk_bf16_f32 v38, v28, v29
    v_mfma_f32_16x16x32_bf16 v[20:23], a[88:91], v[120:123], v[20:23]
    v_exp_f32 v31, v31
    v_mfma_f32_16x16x32_bf16 v[20:23], a[92:95], v[124:127], v[20:23]
    ds_read_b128 a[76:79], v1 offset:37056
    v_mfma_f32_16x16x32_bf16 v[24:27], a[96:99], v[112:115], v[60:63]
    v_exp_f32 v16, v16
    v_mfma_f32_16x16x32_bf16 v[24:27], a[100:103], v[116:119], v[24:27]
    ds_read_b128 a[80:83], v1 offset:37120
    v_cvt_pk_bf16_f32 v39, v30, v31
    v_mfma_f32_16x16x32_bf16 v[24:27], a[104:107], v[120:123], v[24:27]
    v_exp_f32 v17, v17
    v_mfma_f32_16x16x32_bf16 v[24:27], a[108:111], v[124:127], v[24:27]
    ds_read_b128 a[84:87], v1 offset:37184
    v_mfma_f32_16x16x32_bf16 v[28:31], a[112:115], v[112:115], v[60:63]
    v_exp_f32 v18, v18
    v_mfma_f32_16x16x32_bf16 v[28:31], a[116:119], v[116:119], v[28:31]
    ds_read_b128 a[88:91], v1 offset:37248
    v_cvt_pk_bf16_f32 v40, v16, v17
    v_mfma_f32_16x16x32_bf16 v[28:31], a[120:123], v[120:123], v[28:31]
    v_exp_f32 v19, v19
    v_mfma_f32_16x16x32_bf16 v[28:31], a[124:127], v[124:127], v[28:31]
    ds_read_b128 a[92:95], v1 offset:37312
    v_mfma_f32_16x16x32_bf16 v[192:195], a[128:131], v[32:35], v[192:195]
    v_exp_f32 v20, v20
    v_mfma_f32_16x16x32_bf16 v[192:195], a[132:135], v[36:39], v[192:195]
    ds_read_b128 a[96:99], v1 offset:37376
    v_cvt_pk_bf16_f32 v41, v18, v19
    v_mfma_f32_16x16x32_bf16 v[196:199], a[136:139], v[32:35], v[196:199]
    v_exp_f32 v21, v21
    v_mfma_f32_16x16x32_bf16 v[196:199], a[140:143], v[36:39], v[196:199]
    ds_read_b128 a[100:103], v1 offset:37440
    v_mfma_f32_16x16x32_bf16 v[200:203], a[144:147], v[32:35], v[200:203]
    v_exp_f32 v22, v22
    v_mfma_f32_16x16x32_bf16 v[200:203], a[148:151], v[36:39], v[200:203]
    ds_read_b128 a[104:107], v1 offset:37504
    v_cvt_pk_bf16_f32 v42, v20, v21
    v_mfma_f32_16x16x32_bf16 v[204:207], a[152:155], v[32:35], v[204:207]
    v_exp_f32 v23, v23
    v_mfma_f32_16x16x32_bf16 v[204:207], a[156:159], v[36:39], v[204:207]
    ds_read_b128 a[108:111], v1 offset:37568
    v_mfma_f32_16x16x32_bf16 v[208:211], a[160:163], v[32:35], v[208:211]
    v_exp_f32 v24, v24
    v_mfma_f32_16x16x32_bf16 v[208:211], a[164:167], v[36:39], v[208:211]
    ds_read_b128 a[112:115], v1 offset:37632
    v_cvt_pk_bf16_f32 v43, v22, v23
    v_mfma_f32_16x16x32_bf16 v[212:215], a[168:171], v[32:35], v[212:215]
L2_pad5:
    s_cbranch_execz L2_pad9
    v_exp_f32 v25, v25
    v_mfma_f32_16x16x32_bf16 v[212:215], a[172:175], v[36:39], v[212:215]
    ds_read_b128 a[116:119], v1 offset:37696
    v_mfma_f32_16x16x32_bf16 v[216:219], a[176:179], v[32:35], v[216:219]
    v_exp_f32 v26, v26
    v_mfma_f32_16x16x32_bf16 v[216:219], a[180:183], v[36:39], v[216:219]
    s_sub_u32 s49, s49, 1
    ds_read_b128 a[120:123], v1 offset:37760
    v_cvt_pk_bf16_f32 v44, v24, v25
    v_mfma_f32_16x16x32_bf16 v[220:223], a[184:187], v[32:35], v[220:223]
    s_cmp_lg_u32 s49, 0
    v_exp_f32 v27, v27
    v_mfma_f32_16x16x32_bf16 v[220:223], a[188:191], v[36:39], v[220:223]
    ds_read_b128 a[124:127], v1 offset:37824
    v_smfmac_f32_16x16x64_bf16 a[8:11], a[16:19], v[32:39], v11
    s_waitcnt vmcnt(9) lgkmcnt(12)
    s_barrier
    s_cbranch_scc1 L2_loop
    v_mfma_f32_16x16x32_bf16 v[16:19], a[64:67], v[64:67], v[48:51]
    s_sub_u32 s47, s47, s48
    v_exp_f32 v28, v28
    v_mfma_f32_16x16x32_bf16 v[16:19], a[68:71], v[68:71], v[16:19]
    v_cvt_pk_bf16_f32 v45, v26, v27
    v_add_u32 v1, s48, v1
    v_mfma_f32_16x16x32_bf16 v[16:19], a[72:75], v[72:75], v[16:19]
    s_add_u32 m0, s47, 0
    v_exp_f32 v29, v29
    v_mfma_f32_16x16x32_bf16 v[16:19], a[76:79], v[76:79], v[16:19]
    s_waitcnt lgkmcnt(8)
    buffer_load_dwordx4 v5, s[16:19], s46 offen offset:0 lds
    v_mfma_f32_16x16x32_bf16 v[20:23], a[80:83], v[64:67], v[48:51]
    v_exp_f32 v30, v30
    v_mfma_f32_16x16x32_bf16 v[20:23], a[84:87], v[68:71], v[20:23]
    v_cvt_pk_bf16_f32 v46, v28, v29
    v_add_u32 v2, s48, v2
    v_mfma_f32_16x16x32_bf16 v[20:23], a[88:91], v[72:75], v[20:23]
    s_add_u32 m0, s47, 32
    v_exp_f32 v31, v31
    v_mfma_f32_16x16x32_bf16 v[20:23], a[92:95], v[76:79], v[20:23]
    s_waitcnt lgkmcnt(4)
    buffer_load_dwordx4 v5, s[16:19], s46 offen offset:1024 lds
    v_mfma_f32_16x16x32_bf16 v[24:27], a[96:99], v[64:67], v[48:51]
    s_sub_u32 s48, 0, s48
    v_exp_f32 v16, v16
    v_mfma_f32_16x16x32_bf16 v[24:27], a[100:103], v[68:71], v[24:27]
    v_cvt_pk_bf16_f32 v47, v30, v31
    v_mfma_f32_16x16x32_bf16 v[24:27], a[104:107], v[72:75], v[24:27]
    s_add_u32 m0, s47, 64
    v_exp_f32 v17, v17
    v_mfma_f32_16x16x32_bf16 v[24:27], a[108:111], v[76:79], v[24:27]
    s_waitcnt lgkmcnt(0)
    buffer_load_dwordx4 v5, s[16:19], s46 offen offset:2048 lds
    v_mfma_f32_16x16x32_bf16 v[28:31], a[112:115], v[64:67], v[48:51]
    v_exp_f32 v18, v18
    v_mfma_f32_16x16x32_bf16 v[28:31], a[116:119], v[68:71], v[28:31]
    v_cvt_pk_bf16_f32 v32, v16, v17
    v_mfma_f32_16x16x32_bf16 v[28:31], a[120:123], v[72:75], v[28:31]
    s_add_u32 m0, s47, 96
    v_exp_f32 v19, v19
    v_mfma_f32_16x16x32_bf16 v[28:31], a[124:127], v[76:79], v[28:31]
    buffer_load_dwordx4 v5, s[16:19], s46 offen offset:3072 lds
    v_mfma_f32_16x16x32_bf16 v[224:227], a[128:131], v[40:43], v[224:227]
    v_exp_f32 v20, v20
    v_mfma_f32_16x16x32_bf16 v[224:227], a[132:135], v[44:47], v[224:227]
    ds_read_b64_tr_b16 a[128:129], v2 offset:0
    v_cvt_pk_bf16_f32 v33, v18, v19
    v_mfma_f32_16x16x32_bf16 v[228:231], a[136:139], v[40:43], v[228:231]
    s_add_u32 m0, s47, 16896
    v_exp_f32 v21, v21
    v_mfma_f32_16x16x32_bf16 v[228:231], a[140:143], v[44:47], v[228:231]
    buffer_load_dwordx4 v5, s[20:23], s46 offen offset:0 lds
    v_mfma_f32_16x16x32_bf16 v[232:235], a[144:147], v[40:43], v[232:235]
    v_exp_f32 v22, v22
    v_mfma_f32_16x16x32_bf16 v[232:235], a[148:151], v[44:47], v[232:235]
    ds_read_b64_tr_b16 a[130:131], v2 offset:256
    v_cvt_pk_bf16_f32 v34, v20, v21
    v_mfma_f32_16x16x32_bf16 v[236:239], a[152:155], v[40:43], v[236:239]
    s_add_u32 m0, s47, 16928
    v_exp_f32 v23, v23
    v_mfma_f32_16x16x32_bf16 v[236:239], a[156:159], v[44:47], v[236:239]
    buffer_load_dwordx4 v5, s[20:23], s46 offen offset:1024 lds
    v_mfma_f32_16x16x32_bf16 v[240:243], a[160:163], v[40:43], v[240:243]
    v_exp_f32 v24, v24
    v_mfma_f32_16x16x32_bf16 v[240:243], a[164:167], v[44:47], v[240:243]
    ds_read_b64_tr_b16 a[132:133], v2 offset:512
    v_cvt_pk_bf16_f32 v35, v22, v23
    v_mfma_f32_16x16x32_bf16 v[244:247], a[168:171], v[40:43], v[244:247]
    s_add_u32 m0, s47, 16960
    v_exp_f32 v25, v25
    v_mfma_f32_16x16x32_bf16 v[244:247], a[172:175], v[44:47], v[244:247]
    buffer_load_dwordx4 v5, s[20:23], s46 offen offset:2048 lds
    v_mfma_f32_16x16x32_bf16 v[248:251], a[176:179], v[40:43], v[248:251]
    v_exp_f32 v26, v26
    v_mfma_f32_16x16x32_bf16 v[248:251], a[180:183], v[44:47], v[248:251]
    ds_read_b64_tr_b16 a[134:135], v2 offset:768
    v_cvt_pk_bf16_f32 v36, v24, v25
    v_mfma_f32_16x16x32_bf16 v[252:255], a[184:187], v[40:43], v[252:255]
    s_add_u32 m0, s47, 16992
    v_exp_f32 v27, v27
    v_mfma_f32_16x16x32_bf16 v[252:255], a[188:191], v[44:47], v[252:255]
    buffer_load_dwordx4 v5, s[20:23], s46 offen offset:3072 lds
    v_smfmac_f32_16x16x64_bf16 a[12:15], a[16:19], v[40:47], v11
    ds_read_b64_tr_b16 a[136:137], v2 offset:32
    v_mfma_f32_16x16x32_bf16 v[16:19], a[64:67], v[80:83], v[52:55]
    v_exp_f32 v28, v28
    v_mfma_f32_16x16x32_bf16 v[16:19], a[68:71], v[84:87], v[16:19]
    ds_read_b64_tr_b16 a[138:139], v2 offset:288
    v_cvt_pk_bf16_f32 v37, v26, v27
    v_mfma_f32_16x16x32_bf16 v[16:19], a[72:75], v[88:91], v[16:19]
    v_exp_f32 v29, v29
    v_mfma_f32_16x16x32_bf16 v[16:19], a[76:79], v[92:95], v[16:19]
    global_load_dword a63, v14, s[10:11]
    v_mfma_f32_16x16x32_bf16 v[20:23], a[80:83], v[80:83], v[52:55]
    v_exp_f32 v30, v30
    v_mfma_f32_16x16x32_bf16 v[20:23], a[84:87], v[84:87], v[20:23]
    ds_read_b64_tr_b16 a[140:141], v2 offset:544
    v_cvt_pk_bf16_f32 v38, v28, v29
    v_mfma_f32_16x16x32_bf16 v[20:23], a[88:91], v[88:91], v[20:23]
    v_exp_f32 v31, v31
    v_mfma_f32_16x16x32_bf16 v[20:23], a[92:95], v[92:95], v[20:23]
    ds_read_b64_tr_b16 a[142:143], v2 offset:800
    v_mfma_f32_16x16x32_bf16 v[24:27], a[96:99], v[80:83], v[52:55]
    v_exp_f32 v16, v16
    v_mfma_f32_16x16x32_bf16 v[24:27], a[100:103], v[84:87], v[24:27]
    ds_read_b64_tr_b16 a[144:145], v2 offset:64
    v_cvt_pk_bf16_f32 v39, v30, v31
    v_mfma_f32_16x16x32_bf16 v[24:27], a[104:107], v[88:91], v[24:27]
    s_mov_b32 s54, 0
    v_exp_f32 v17, v17
    v_mfma_f32_16x16x32_bf16 v[24:27], a[108:111], v[92:95], v[24:27]
    buffer_load_dwordx4 a[20:23], v6, s[64:67], s54 offen
    v_mfma_f32_16x16x32_bf16 v[28:31], a[112:115], v[80:83], v[52:55]
    v_exp_f32 v18, v18
    v_mfma_f32_16x16x32_bf16 v[28:31], a[116:119], v[84:87], v[28:31]
    ds_read_b64_tr_b16 a[146:147], v2 offset:320
    v_cvt_pk_bf16_f32 v40, v16, v17
    v_mfma_f32_16x16x32_bf16 v[28:31], a[120:123], v[88:91], v[28:31]
    v_exp_f32 v19, v19
    v_mfma_f32_16x16x32_bf16 v[28:31], a[124:127], v[92:95], v[28:31]
    ds_read_b64_tr_b16 a[148:149], v2 offset:576
    v_mfma_f32_16x16x32_bf16 v[128:131], a[192:195], v[32:35], v[128:131]
    v_exp_f32 v20, v20
    v_mfma_f32_16x16x32_bf16 v[128:131], a[196:199], v[36:39], v[128:131]
    ds_read_b64_tr_b16 a[150:151], v2 offset:832
    v_cvt_pk_bf16_f32 v41, v18, v19
    v_mfma_f32_16x16x32_bf16 v[132:135], a[200:203], v[32:35], v[132:135]
    s_mov_b32 s54, 147456
    v_exp_f32 v21, v21
    v_mfma_f32_16x16x32_bf16 v[132:135], a[204:207], v[36:39], v[132:135]
    buffer_load_dwordx4 a[24:27], v6, s[64:67], s54 offen
    v_mfma_f32_16x16x32_bf16 v[136:139], a[208:211], v[32:35], v[136:139]
    v_exp_f32 v22, v22
    v_mfma_f32_16x16x32_bf16 v[136:139], a[212:215], v[36:39], v[136:139]
    ds_read_b64_tr_b16 a[152:153], v2 offset:96
    v_cvt_pk_bf16_f32 v42, v20, v21
    v_mfma_f32_16x16x32_bf16 v[140:143], a[216:219], v[32:35], v[140:143]
    v_exp_f32 v23, v23
    v_mfma_f32_16x16x32_bf16 v[140:143], a[220:223], v[36:39], v[140:143]
    ds_read_b64_tr_b16 a[154:155], v2 offset:352
    v_mfma_f32_16x16x32_bf16 v[144:147], a[224:227], v[32:35], v[144:147]
    v_exp_f32 v24, v24
    v_mfma_f32_16x16x32_bf16 v[144:147], a[228:231], v[36:39], v[144:147]
    ds_read_b64_tr_b16 a[156:157], v2 offset:608
    v_cvt_pk_bf16_f32 v43, v22, v23
    v_mfma_f32_16x16x32_bf16 v[148:151], a[232:235], v[32:35], v[148:151]
    s_mov_b32 s54, 294912
    v_exp_f32 v25, v25
    v_mfma_f32_16x16x32_bf16 v[148:151], a[236:239], v[36:39], v[148:151]
    buffer_load_dwordx4 a[28:31], v6, s[64:67], s54 offen
    v_mfma_f32_16x16x32_bf16 v[152:155], a[240:243], v[32:35], v[152:155]
    v_exp_f32 v26, v26
    v_mfma_f32_16x16x32_bf16 v[152:155], a[244:247], v[36:39], v[152:155]
    ds_read_b64_tr_b16 a[158:159], v2 offset:864
    v_cvt_pk_bf16_f32 v44, v24, v25
    v_mfma_f32_16x16x32_bf16 v[156:159], a[248:251], v[32:35], v[156:159]
    v_exp_f32 v27, v27
    v_mfma_f32_16x16x32_bf16 v[156:159], a[252:255], v[36:39], v[156:159]
    ds_read_b64_tr_b16 a[160:161], v2 offset:128
    v_smfmac_f32_16x16x64_bf16 a[0:3], a[16:19], v[32:39], v11
    ds_read_b64_tr_b16 a[162:163], v2 offset:384
    v_mfma_f32_16x16x32_bf16 v[16:19], a[64:67], v[96:99], v[56:59]
    v_exp_f32 v28, v28
    v_mfma_f32_16x16x32_bf16 v[16:19], a[68:71], v[100:103], v[16:19]
    ds_read_b64_tr_b16 a[164:165], v2 offset:640
    v_cvt_pk_bf16_f32 v45, v26, v27
    v_mfma_f32_16x16x32_bf16 v[16:19], a[72:75], v[104:107], v[16:19]
    v_exp_f32 v29, v29
    v_mfma_f32_16x16x32_bf16 v[16:19], a[76:79], v[108:111], v[16:19]
    ds_read_b64_tr_b16 a[166:167], v2 offset:896
    v_mfma_f32_16x16x32_bf16 v[20:23], a[80:83], v[96:99], v[56:59]
    v_exp_f32 v30, v30
    v_mfma_f32_16x16x32_bf16 v[20:23], a[84:87], v[100:103], v[20:23]
    ds_read_b64_tr_b16 a[168:169], v2 offset:160
    v_cvt_pk_bf16_f32 v46, v28, v29
    v_mfma_f32_16x16x32_bf16 v[20:23], a[88:91], v[104:107], v[20:23]
    v_exp_f32 v31, v31
    v_mfma_f32_16x16x32_bf16 v[20:23], a[92:95], v[108:111], v[20:23]
    ds_read_b64_tr_b16 a[170:171], v2 offset:416
    v_mfma_f32_16x16x32_bf16 v[24:27], a[96:99], v[96:99], v[56:59]
    v_exp_f32 v16, v16
    v_mfma_f32_16x16x32_bf16 v[24:27], a[100:103], v[100:103], v[24:27]
    ds_read_b64_tr_b16 a[172:173], v2 offset:672
    v_cvt_pk_bf16_f32 v47, v30, v31
    v_mfma_f32_16x16x32_bf16 v[24:27], a[104:107], v[104:107], v[24:27]
    v_exp_f32 v17, v17
    v_mfma_f32_16x16x32_bf16 v[24:27], a[108:111], v[108:111], v[24:27]
    ds_read_b64_tr_b16 a[174:175], v2 offset:928
    v_mfma_f32_16x16x32_bf16 v[28:31], a[112:115], v[96:99], v[56:59]
    v_exp_f32 v18, v18
    v_mfma_f32_16x16x32_bf16 v[28:31], a[116:119], v[100:103], v[28:31]
    ds_read_b64_tr_b16 a[176:177], v2 offset:192
    v_cvt_pk_bf16_f32 v32, v16, v17
    v_mfma_f32_16x16x32_bf16 v[28:31], a[120:123], v[104:107], v[28:31]
    v_exp_f32 v19, v19
    v_mfma_f32_16x16x32_bf16 v[28:31], a[124:127], v[108:111], v[28:31]
    ds_read_b64_tr_b16 a[178:179], v2 offset:448
    v_mfma_f32_16x16x32_bf16 v[160:163], a[192:195], v[40:43], v[160:163]
    v_exp_f32 v20, v20
    v_mfma_f32_16x16x32_bf16 v[160:163], a[196:199], v[44:47], v[160:163]
    ds_read_b64_tr_b16 a[180:181], v2 offset:704
    v_cvt_pk_bf16_f32 v33, v18, v19
    v_mfma_f32_16x16x32_bf16 v[164:167], a[200:203], v[40:43], v[164:167]
    v_exp_f32 v21, v21
    v_mfma_f32_16x16x32_bf16 v[164:167], a[204:207], v[44:47], v[164:167]
    ds_read_b64_tr_b16 a[182:183], v2 offset:960
    v_mfma_f32_16x16x32_bf16 v[168:171], a[208:211], v[40:43], v[168:171]
    v_exp_f32 v22, v22
    v_mfma_f32_16x16x32_bf16 v[168:171], a[212:215], v[44:47], v[168:171]
    ds_read_b64_tr_b16 a[184:185], v2 offset:224
    v_cvt_pk_bf16_f32 v34, v20, v21
    v_mfma_f32_16x16x32_bf16 v[172:175], a[216:219], v[40:43], v[172:175]
    v_exp_f32 v23, v23
    v_mfma_f32_16x16x32_bf16 v[172:175], a[220:223], v[44:47], v[172:175]
    ds_read_b64_tr_b16 a[186:187], v2 offset:480
    v_mfma_f32_16x16x32_bf16 v[176:179], a[224:227], v[40:43], v[176:179]
    v_exp_f32 v24, v24
    v_mfma_f32_16x16x32_bf16 v[176:179], a[228:231], v[44:47], v[176:179]
    ds_read_b64_tr_b16 a[188:189], v2 offset:736
    v_cvt_pk_bf16_f32 v35, v22, v23
    v_mfma_f32_16x16x32_bf16 v[180:183], a[232:235], v[40:43], v[180:183]
    v_exp_f32 v25, v25
    v_mfma_f32_16x16x32_bf16 v[180:183], a[236:239], v[44:47], v[180:183]
    ds_read_b64_tr_b16 a[190:191], v2 offset:992
    v_mfma_f32_16x16x32_bf16 v[184:187], a[240:243], v[40:43], v[184:187]
    v_exp_f32 v26, v26
    v_mfma_f32_16x16x32_bf16 v[184:187], a[244:247], v[44:47], v[184:187]
    v_cvt_pk_bf16_f32 v36, v24, v25
    v_mfma_f32_16x16x32_bf16 v[188:191], a[248:251], v[40:43], v[188:191]
    v_exp_f32 v27, v27
    v_mfma_f32_16x16x32_bf16 v[188:191], a[252:255], v[44:47], v[188:191]
    v_smfmac_f32_16x16x64_bf16 a[4:7], a[16:19], v[40:47], v11
    v_mfma_f32_16x16x32_bf16 v[16:19], a[64:67], v[112:115], v[60:63]
    v_exp_f32 v28, v28
    v_mfma_f32_16x16x32_bf16 v[16:19], a[68:71], v[116:119], v[16:19]
    s_add_u32 s46, s46, 16384
    ds_read_b128 a[64:67], v1 offset:0
    v_cvt_pk_bf16_f32 v37, v26, v27
    v_mfma_f32_16x16x32_bf16 v[16:19], a[72:75], v[120:123], v[16:19]
    v_exp_f32 v29, v29
    v_mfma_f32_16x16x32_bf16 v[16:19], a[76:79], v[124:127], v[16:19]
    ds_read_b128 a[68:71], v1 offset:64
    v_mfma_f32_16x16x32_bf16 v[20:23], a[80:83], v[112:115], v[60:63]
    v_exp_f32 v30, v30
    v_mfma_f32_16x16x32_bf16 v[20:23], a[84:87], v[116:119], v[20:23]
    ds_read_b128 a[72:75], v1 offset:128
    v_cvt_pk_bf16_f32 v38, v28, v29
    v_mfma_f32_16x16x32_bf16 v[20:23], a[88:91], v[120:123], v[20:23]
    v_exp_f32 v31, v31
    v_mfma_f32_16x16x32_bf16 v[20:23], a[92:95], v[124:127], v[20:23]
    ds_read_b128 a[76:79], v1 offset:192
    v_mfma_f32_16x16x32_bf16 v[24:27], a[96:99], v[112:115], v[60:63]
    v_exp_f32 v16, v16
    v_mfma_f32_16x16x32_bf16 v[24:27], a[100:103], v[116:119], v[24:27]
    ds_read_b128 a[80:83], v1 offset:256
    v_cvt_pk_bf16_f32 v39, v30, v31
    v_mfma_f32_16x16x32_bf16 v[24:27], a[104:107], v[120:123], v[24:27]
    v_exp_f32 v17, v17
    v_mfma_f32_16x16x32_bf16 v[24:27], a[108:111], v[124:127], v[24:27]
    ds_read_b128 a[84:87], v1 offset:320
    v_mfma_f32_16x16x32_bf16 v[28:31], a[112:115], v[112:115], v[60:63]
    v_exp_f32 v18, v18
    v_mfma_f32_16x16x32_bf16 v[28:31], a[116:119], v[116:119], v[28:31]
    ds_read_b128 a[88:91], v1 offset:384
    v_cvt_pk_bf16_f32 v40, v16, v17
    v_mfma_f32_16x16x32_bf16 v[28:31], a[120:123], v[120:123], v[28:31]
    v_exp_f32 v19, v19
    v_mfma_f32_16x16x32_bf16 v[28:31], a[124:127], v[124:127], v[28:31]
    ds_read_b128 a[92:95], v1 offset:448
    v_mfma_f32_16x16x32_bf16 v[192:195], a[192:195], v[32:35], v[192:195]
    v_exp_f32 v20, v20
    v_mfma_f32_16x16x32_bf16 v[192:195], a[196:199], v[36:39], v[192:195]
    ds_read_b128 a[96:99], v1 offset:512
    v_cvt_pk_bf16_f32 v41, v18, v19
    v_mfma_f32_16x16x32_bf16 v[196:199], a[200:203], v[32:35], v[196:199]
    v_exp_f32 v21, v21
    v_mfma_f32_16x16x32_bf16 v[196:199], a[204:207], v[36:39], v[196:199]
    ds_read_b128 a[100:103], v1 offset:576
    v_mfma_f32_16x16x32_bf16 v[200:203], a[208:211], v[32:35], v[200:203]
    v_exp_f32 v22, v22
    v_mfma_f32_16x16x32_bf16 v[200:203], a[212:215], v[36:39], v[200:203]
    ds_read_b128 a[104:107], v1 offset:640
    v_cvt_pk_bf16_f32 v42, v20, v21
    v_mfma_f32_16x16x32_bf16 v[204:207], a[216:219], v[32:35], v[204:207]
    v_exp_f32 v23, v23
    v_mfma_f32_16x16x32_bf16 v[204:207], a[220:223], v[36:39], v[204:207]
    ds_read_b128 a[108:111], v1 offset:704
    v_mfma_f32_16x16x32_bf16 v[208:211], a[224:227], v[32:35], v[208:211]
    v_exp_f32 v24, v24
    v_mfma_f32_16x16x32_bf16 v[208:211], a[228:231], v[36:39], v[208:211]
    ds_read_b128 a[112:115], v1 offset:768
    v_cvt_pk_bf16_f32 v43, v22, v23
    v_mfma_f32_16x16x32_bf16 v[212:215], a[232:235], v[32:35], v[212:215]
    v_exp_f32 v25, v25
    v_mfma_f32_16x16x32_bf16 v[212:215], a[236:239], v[36:39], v[212:215]
    ds_read_b128 a[116:119], v1 offset:832
    v_mfma_f32_16x16x32_bf16 v[216:219], a[240:243], v[32:35], v[216:219]
    v_exp_f32 v26, v26
    v_mfma_f32_16x16x32_bf16 v[216:219], a[244:247], v[36:39], v[216:219]
    ds_read_b128 a[120:123], v1 offset:896
    v_cvt_pk_bf16_f32 v44, v24, v25
    v_mfma_f32_16x16x32_bf16 v[220:223], a[248:251], v[32:35], v[220:223]
    v_exp_f32 v27, v27
    v_mfma_f32_16x16x32_bf16 v[220:223], a[252:255], v[36:39], v[220:223]
    ds_read_b128 a[124:127], v1 offset:960
    v_smfmac_f32_16x16x64_bf16 a[8:11], a[16:19], v[32:39], v11
    s_waitcnt vmcnt(12) lgkmcnt(12)
    s_barrier
    v_mfma_f32_16x16x32_bf16 v[16:19], a[64:67], v[64:67], v[48:51]
    v_exp_f32 v28, v28
    v_mfma_f32_16x16x32_bf16 v[16:19], a[68:71], v[68:71], v[16:19]
    v_cvt_pk_bf16_f32 v45, v26, v27
    v_mfma_f32_16x16x32_bf16 v[16:19], a[72:75], v[72:75], v[16:19]
    s_add_u32 m0, s47, 36864
    v_exp_f32 v29, v29
    v_mfma_f32_16x16x32_bf16 v[16:19], a[76:79], v[76:79], v[16:19]
    s_waitcnt lgkmcnt(8)
    buffer_load_dwordx4 v5, s[16:19], s46 offen offset:0 lds
    v_mfma_f32_16x16x32_bf16 v[20:23], a[80:83], v[64:67], v[48:51]
    v_exp_f32 v30, v30
    v_mfma_f32_16x16x32_bf16 v[20:23], a[84:87], v[68:71], v[20:23]
    v_cvt_pk_bf16_f32 v46, v28, v29
    v_mfma_f32_16x16x32_bf16 v[20:23], a[88:91], v[72:75], v[20:23]
    s_add_u32 m0, s47, 36896
    v_exp_f32 v31, v31
    v_mfma_f32_16x16x32_bf16 v[20:23], a[92:95], v[76:79], v[20:23]
    s_waitcnt lgkmcnt(4)
    buffer_load_dwordx4 v5, s[16:19], s46 offen offset:1024 lds
    v_mfma_f32_16x16x32_bf16 v[24:27], a[96:99], v[64:67], v[48:51]
    v_exp_f32 v16, v16
    v_mfma_f32_16x16x32_bf16 v[24:27], a[100:103], v[68:71], v[24:27]
    v_cvt_pk_bf16_f32 v47, v30, v31
    v_mfma_f32_16x16x32_bf16 v[24:27], a[104:107], v[72:75], v[24:27]
    s_add_u32 m0, s47, 36928
    v_exp_f32 v17, v17
    v_mfma_f32_16x16x32_bf16 v[24:27], a[108:111], v[76:79], v[24:27]
    s_waitcnt lgkmcnt(0)
    buffer_load_dwordx4 v5, s[16:19], s46 offen offset:2048 lds
    v_mfma_f32_16x16x32_bf16 v[28:31], a[112:115], v[64:67], v[48:51]
    v_exp_f32 v18, v18
    v_mfma_f32_16x16x32_bf16 v[28:31], a[116:119], v[68:71], v[28:31]
    v_cvt_pk_bf16_f32 v32, v16, v17
    v_mfma_f32_16x16x32_bf16 v[28:31], a[120:123], v[72:75], v[28:31]
    s_add_u32 m0, s47, 36960
    v_exp_f32 v19, v19
    v_mfma_f32_16x16x32_bf16 v[28:31], a[124:127], v[76:79], v[28:31]
    buffer_load_dwordx4 v5, s[16:19], s46 offen offset:3072 lds
    v_mfma_f32_16x16x32_bf16 v[224:227], a[192:195], v[40:43], v[224:227]
    v_exp_f32 v20, v20
    v_mfma_f32_16x16x32_bf16 v[224:227], a[196:199], v[44:47], v[224:227]
    ds_read_b64_tr_b16 a[192:193], v2 offset:36864
    v_cvt_pk_bf16_f32 v33, v18, v19
    v_mfma_f32_16x16x32_bf16 v[228:231], a[200:203], v[40:43], v[228:231]
    s_add_u32 m0, s47, 53760
    v_exp_f32 v21, v21
    v_mfma_f32_16x16x32_bf16 v[228:231], a[204:207], v[44:47], v[228:231]
    buffer_load_dwordx4 v5, s[20:23], s46 offen offset:0 lds
    v_mfma_f32_16x16x32_bf16 v[232:235], a[208:211], v[40:43], v[232:235]
    v_exp_f32 v22, v22
    v_mfma_f32_16x16x32_bf16 v[232:235], a[212:215], v[44:47], v[232:235]
    ds_read_b64_tr_b16 a[194:195], v2 offset:37120
    v_cvt_pk_bf16_f32 v34, v20, v21
    v_mfma_f32_16x16x32_bf16 v[236:239], a[216:219], v[40:43], v[236:239]
    s_add_u32 m0, s47, 53792
    v_exp_f32 v23, v23
    v_mfma_f32_16x16x32_bf16 v[236:239], a[220:223], v[44:47], v[236:239]
    buffer_load_dwordx4 v5, s[20:23], s46 offen offset:1024 lds
    v_mfma_f32_16x16x32_bf16 v[240:243], a[224:227], v[40:43], v[240:243]
    v_exp_f32 v24, v24
    v_mfma_f32_16x16x32_bf16 v[240:243], a[228:231], v[44:47], v[240:243]
    ds_read_b64_tr_b16 a[196:197], v2 offset:37376
    v_cvt_pk_bf16_f32 v35, v22, v23
    v_mfma_f32_16x16x32_bf16 v[244:247], a[232:235], v[40:43], v[244:247]
    s_add_u32 m0, s47, 53824
    v_exp_f32 v25, v25
    v_mfma_f32_16x16x32_bf16 v[244:247], a[236:239], v[44:47], v[244:247]
    buffer_load_dwordx4 v5, s[20:23], s46 offen offset:2048 lds
    v_mfma_f32_16x16x32_bf16 v[248:251], a[240:243], v[40:43], v[248:251]
    v_exp_f32 v26, v26
    v_mfma_f32_16x16x32_bf16 v[248:251], a[244:247], v[44:47], v[248:251]
    ds_read_b64_tr_b16 a[198:199], v2 offset:37632
    v_cvt_pk_bf16_f32 v36, v24, v25
    v_mfma_f32_16x16x32_bf16 v[252:255], a[248:251], v[40:43], v[252:255]
    s_add_u32 m0, s47, 53856
    v_exp_f32 v27, v27
    v_mfma_f32_16x16x32_bf16 v[252:255], a[252:255], v[44:47], v[252:255]
    buffer_load_dwordx4 v5, s[20:23], s46 offen offset:3072 lds
    v_smfmac_f32_16x16x64_bf16 a[12:15], a[16:19], v[40:47], v11
    ds_read_b64_tr_b16 a[200:201], v2 offset:36896
    v_mfma_f32_16x16x32_bf16 v[16:19], a[64:67], v[80:83], v[52:55]
    v_exp_f32 v28, v28
    v_mfma_f32_16x16x32_bf16 v[16:19], a[68:71], v[84:87], v[16:19]
    ds_read_b64_tr_b16 a[202:203], v2 offset:37152
    v_cvt_pk_bf16_f32 v37, v26, v27
    v_mfma_f32_16x16x32_bf16 v[16:19], a[72:75], v[88:91], v[16:19]
    v_exp_f32 v29, v29
    v_mfma_f32_16x16x32_bf16 v[16:19], a[76:79], v[92:95], v[16:19]
    global_load_dword a63, v15, s[10:11]
    v_mfma_f32_16x16x32_bf16 v[20:23], a[80:83], v[80:83], v[52:55]
    v_exp_f32 v30, v30
    v_mfma_f32_16x16x32_bf16 v[20:23], a[84:87], v[84:87], v[20:23]
    ds_read_b64_tr_b16 a[204:205], v2 offset:37408
    v_cvt_pk_bf16_f32 v38, v28, v29
    v_mfma_f32_16x16x32_bf16 v[20:23], a[88:91], v[88:91], v[20:23]
    v_exp_f32 v31, v31
    v_mfma_f32_16x16x32_bf16 v[20:23], a[92:95], v[92:95], v[20:23]
    ds_read_b64_tr_b16 a[206:207], v2 offset:37664
    v_mfma_f32_16x16x32_bf16 v[24:27], a[96:99], v[80:83], v[52:55]
    v_exp_f32 v16, v16
    v_mfma_f32_16x16x32_bf16 v[24:27], a[100:103], v[84:87], v[24:27]
    ds_read_b64_tr_b16 a[208:209], v2 offset:36928
    v_cvt_pk_bf16_f32 v39, v30, v31
    v_mfma_f32_16x16x32_bf16 v[24:27], a[104:107], v[88:91], v[24:27]
    s_mov_b32 s54, 442368
    v_exp_f32 v17, v17
    v_mfma_f32_16x16x32_bf16 v[24:27], a[108:111], v[92:95], v[24:27]
    buffer_load_dwordx4 a[32:35], v6, s[64:67], s54 offen
    v_mfma_f32_16x16x32_bf16 v[28:31], a[112:115], v[80:83], v[52:55]
    v_exp_f32 v18, v18
    v_mfma_f32_16x16x32_bf16 v[28:31], a[116:119], v[84:87], v[28:31]
    ds_read_b64_tr_b16 a[210:211], v2 offset:37184
    v_cvt_pk_bf16_f32 v40, v16, v17
    v_mfma_f32_16x16x32_bf16 v[28:31], a[120:123], v[88:91], v[28:31]
    v_exp_f32 v19, v19
    v_mfma_f32_16x16x32_bf16 v[28:31], a[124:127], v[92:95], v[28:31]
    ds_read_b64_tr_b16 a[212:213], v2 offset:37440
    v_mfma_f32_16x16x32_bf16 v[128:131], a[128:131], v[32:35], v[128:131]
    v_exp_f32 v20, v20
    v_mfma_f32_16x16x32_bf16 v[128:131], a[132:135], v[36:39], v[128:131]
    ds_read_b64_tr_b16 a[214:215], v2 offset:37696
    v_cvt_pk_bf16_f32 v41, v18, v19
    v_mfma_f32_16x16x32_bf16 v[132:135], a[136:139], v[32:35], v[132:135]
    s_mov_b32 s54, 589824
    v_exp_f32 v21, v21
    v_mfma_f32_16x16x32_bf16 v[132:135], a[140:143], v[36:39], v[132:135]
    buffer_load_dwordx4 a[36:39], v6, s[64:67], s54 offen
    v_mfma_f32_16x16x32_bf16 v[136:139], a[144:147], v[32:35], v[136:139]
    v_exp_f32 v22, v22
    v_mfma_f32_16x16x32_bf16 v[136:139], a[148:151], v[36:39], v[136:139]
    ds_read_b64_tr_b16 a[216:217], v2 offset:36960
    v_cvt_pk_bf16_f32 v42, v20, v21
    v_mfma_f32_16x16x32_bf16 v[140:143], a[152:155], v[32:35], v[140:143]
    v_exp_f32 v23, v23
    v_mfma_f32_16x16x32_bf16 v[140:143], a[156:159], v[36:39], v[140:143]
    ds_read_b64_tr_b16 a[218:219], v2 offset:37216
    v_mfma_f32_16x16x32_bf16 v[144:147], a[160:163], v[32:35], v[144:147]
    v_exp_f32 v24, v24
    v_mfma_f32_16x16x32_bf16 v[144:147], a[164:167], v[36:39], v[144:147]
    ds_read_b64_tr_b16 a[220:221], v2 offset:37472
    v_cvt_pk_bf16_f32 v43, v22, v23
    v_mfma_f32_16x16x32_bf16 v[148:151], a[168:171], v[32:35], v[148:151]
    s_mov_b32 s54, 737280
    v_exp_f32 v25, v25
    v_mfma_f32_16x16x32_bf16 v[148:151], a[172:175], v[36:39], v[148:151]
    buffer_load_dwordx4 a[40:43], v6, s[64:67], s54 offen
    v_mfma_f32_16x16x32_bf16 v[152:155], a[176:179], v[32:35], v[152:155]
    v_exp_f32 v26, v26
    v_mfma_f32_16x16x32_bf16 v[152:155], a[180:183], v[36:39], v[152:155]
    ds_read_b64_tr_b16 a[222:223], v2 offset:37728
    v_cvt_pk_bf16_f32 v44, v24, v25
    v_mfma_f32_16x16x32_bf16 v[156:159], a[184:187], v[32:35], v[156:159]
    v_exp_f32 v27, v27
    v_mfma_f32_16x16x32_bf16 v[156:159], a[188:191], v[36:39], v[156:159]
    ds_read_b64_tr_b16 a[224:225], v2 offset:36992
    v_smfmac_f32_16x16x64_bf16 a[0:3], a[16:19], v[32:39], v11
    ds_read_b64_tr_b16 a[226:227], v2 offset:37248
    v_mfma_f32_16x16x32_bf16 v[16:19], a[64:67], v[96:99], v[56:59]
    v_exp_f32 v28, v28
    v_mfma_f32_16x16x32_bf16 v[16:19], a[68:71], v[100:103], v[16:19]
    ds_read_b64_tr_b16 a[228:229], v2 offset:37504
    v_cvt_pk_bf16_f32 v45, v26, v27
    v_mfma_f32_16x16x32_bf16 v[16:19], a[72:75], v[104:107], v[16:19]
    v_exp_f32 v29, v29
    v_mfma_f32_16x16x32_bf16 v[16:19], a[76:79], v[108:111], v[16:19]
    ds_read_b64_tr_b16 a[230:231], v2 offset:37760
    v_mfma_f32_16x16x32_bf16 v[20:23], a[80:83], v[96:99], v[56:59]
    v_exp_f32 v30, v30
    v_mfma_f32_16x16x32_bf16 v[20:23], a[84:87], v[100:103], v[20:23]
    ds_read_b64_tr_b16 a[232:233], v2 offset:37024
    v_cvt_pk_bf16_f32 v46, v28, v29
    v_mfma_f32_16x16x32_bf16 v[20:23], a[88:91], v[104:107], v[20:23]
    v_exp_f32 v31, v31
    v_mfma_f32_16x16x32_bf16 v[20:23], a[92:95], v[108:111], v[20:23]
    ds_read_b64_tr_b16 a[234:235], v2 offset:37280
    v_mfma_f32_16x16x32_bf16 v[24:27], a[96:99], v[96:99], v[56:59]
    v_exp_f32 v16, v16
    v_mfma_f32_16x16x32_bf16 v[24:27], a[100:103], v[100:103], v[24:27]
    ds_read_b64_tr_b16 a[236:237], v2 offset:37536
    v_cvt_pk_bf16_f32 v47, v30, v31
    v_mfma_f32_16x16x32_bf16 v[24:27], a[104:107], v[104:107], v[24:27]
    v_exp_f32 v17, v17
    v_mfma_f32_16x16x32_bf16 v[24:27], a[108:111], v[108:111], v[24:27]
    ds_read_b64_tr_b16 a[238:239], v2 offset:37792
    v_mfma_f32_16x16x32_bf16 v[28:31], a[112:115], v[96:99], v[56:59]
    v_exp_f32 v18, v18
    v_mfma_f32_16x16x32_bf16 v[28:31], a[116:119], v[100:103], v[28:31]
    ds_read_b64_tr_b16 a[240:241], v2 offset:37056
    v_cvt_pk_bf16_f32 v32, v16, v17
    v_mfma_f32_16x16x32_bf16 v[28:31], a[120:123], v[104:107], v[28:31]
    v_exp_f32 v19, v19
    v_mfma_f32_16x16x32_bf16 v[28:31], a[124:127], v[108:111], v[28:31]
    ds_read_b64_tr_b16 a[242:243], v2 offset:37312
    v_mfma_f32_16x16x32_bf16 v[160:163], a[128:131], v[40:43], v[160:163]
    v_exp_f32 v20, v20
    v_mfma_f32_16x16x32_bf16 v[160:163], a[132:135], v[44:47], v[160:163]
    ds_read_b64_tr_b16 a[244:245], v2 offset:37568
    v_cvt_pk_bf16_f32 v33, v18, v19
    v_mfma_f32_16x16x32_bf16 v[164:167], a[136:139], v[40:43], v[164:167]
    v_exp_f32 v21, v21
    v_mfma_f32_16x16x32_bf16 v[164:167], a[140:143], v[44:47], v[164:167]
    ds_read_b64_tr_b16 a[246:247], v2 offset:37824
    v_mfma_f32_16x16x32_bf16 v[168:171], a[144:147], v[40:43], v[168:171]
    v_exp_f32 v22, v22
    v_mfma_f32_16x16x32_bf16 v[168:171], a[148:151], v[44:47], v[168:171]
    ds_read_b64_tr_b16 a[248:249], v2 offset:37088
    v_cvt_pk_bf16_f32 v34, v20, v21
    v_mfma_f32_16x16x32_bf16 v[172:175], a[152:155], v[40:43], v[172:175]
    v_exp_f32 v23, v23
    v_mfma_f32_16x16x32_bf16 v[172:175], a[156:159], v[44:47], v[172:175]
    ds_read_b64_tr_b16 a[250:251], v2 offset:37344
    v_mfma_f32_16x16x32_bf16 v[176:179], a[160:163], v[40:43], v[176:179]
    v_exp_f32 v24, v24
    v_mfma_f32_16x16x32_bf16 v[176:179], a[164:167], v[44:47], v[176:179]
    ds_read_b64_tr_b16 a[252:253], v2 offset:37600
    v_cvt_pk_bf16_f32 v35, v22, v23
    v_mfma_f32_16x16x32_bf16 v[180:183], a[168:171], v[40:43], v[180:183]
    v_exp_f32 v25, v25
    v_mfma_f32_16x16x32_bf16 v[180:183], a[172:175], v[44:47], v[180:183]
    ds_read_b64_tr_b16 a[254:255], v2 offset:37856
    v_mfma_f32_16x16x32_bf16 v[184:187], a[176:179], v[40:43], v[184:187]
    v_exp_f32 v26, v26
    v_mfma_f32_16x16x32_bf16 v[184:187], a[180:183], v[44:47], v[184:187]
    v_cvt_pk_bf16_f32 v36, v24, v25
    v_mfma_f32_16x16x32_bf16 v[188:191], a[184:187], v[40:43], v[188:191]
    v_exp_f32 v27, v27
    v_mfma_f32_16x16x32_bf16 v[188:191], a[188:191], v[44:47], v[188:191]
    v_smfmac_f32_16x16x64_bf16 a[4:7], a[16:19], v[40:47], v11
    v_mfma_f32_16x16x32_bf16 v[16:19], a[64:67], v[112:115], v[60:63]
    v_exp_f32 v28, v28
    v_mfma_f32_16x16x32_bf16 v[16:19], a[68:71], v[116:119], v[16:19]
    s_add_u32 s46, s46, 16384
    ds_read_b128 a[64:67], v1 offset:36864
    v_cvt_pk_bf16_f32 v37, v26, v27
    v_mfma_f32_16x16x32_bf16 v[16:19], a[72:75], v[120:123], v[16:19]
    v_exp_f32 v29, v29
    v_mfma_f32_16x16x32_bf16 v[16:19], a[76:79], v[124:127], v[16:19]
    ds_read_b128 a[68:71], v1 offset:36928
    v_mfma_f32_16x16x32_bf16 v[20:23], a[80:83], v[112:115], v[60:63]
    v_exp_f32 v30, v30
    v_mfma_f32_16x16x32_bf16 v[20:23], a[84:87], v[116:119], v[20:23]
    ds_read_b128 a[72:75], v1 offset:36992
    v_cvt_pk_bf16_f32 v38, v28, v29
    v_mfma_f32_16x16x32_bf16 v[20:23], a[88:91], v[120:123], v[20:23]
    v_exp_f32 v31, v31
    v_mfma_f32_16x16x32_bf16 v[20:23], a[92:95], v[124:127], v[20:23]
    ds_read_b128 a[76:79], v1 offset:37056
    v_mfma_f32_16x16x32_bf16 v[24:27], a[96:99], v[112:115], v[60:63]
    v_exp_f32 v16, v16
    v_mfma_f32_16x16x32_bf16 v[24:27], a[100:103], v[116:119], v[24:27]
    ds_read_b128 a[80:83], v1 offset:37120
    v_cvt_pk_bf16_f32 v39, v30, v31
    v_mfma_f32_16x16x32_bf16 v[24:27], a[104:107], v[120:123], v[24:27]
    v_exp_f32 v17, v17
    v_mfma_f32_16x16x32_bf16 v[24:27], a[108:111], v[124:127], v[24:27]
L2_pad6:
    s_cbranch_execz L2_pad10
    ds_read_b128 a[84:87], v1 offset:37184
    v_mfma_f32_16x16x32_bf16 v[28:31], a[112:115], v[112:115], v[60:63]
    v_exp_f32 v18, v18
    v_mfma_f32_16x16x32_bf16 v[28:31], a[116:119], v[116:119], v[28:31]
    ds_read_b128 a[88:91], v1 offset:37248
    v_cvt_pk_bf16_f32 v40, v16, v17
    v_mfma_f32_16x16x32_bf16 v[28:31], a[120:123], v[120:123], v[28:31]
    v_exp_f32 v19, v19
    v_mfma_f32_16x16x32_bf16 v[28:31], a[124:127], v[124:127], v[28:31]
    ds_read_b128 a[92:95], v1 offset:37312
    v_mfma_f32_16x16x32_bf16 v[192:195], a[128:131], v[32:35], v[192:195]
    v_exp_f32 v20, v20
    v_mfma_f32_16x16x32_bf16 v[192:195], a[132:135], v[36:39], v[192:195]
    ds_read_b128 a[96:99], v1 offset:37376
    v_cvt_pk_bf16_f32 v41, v18, v19
    v_mfma_f32_16x16x32_bf16 v[196:199], a[136:139], v[32:35], v[196:199]
    v_exp_f32 v21, v21
    v_mfma_f32_16x16x32_bf16 v[196:199], a[140:143], v[36:39], v[196:199]
    ds_read_b128 a[100:103], v1 offset:37440
    v_mfma_f32_16x16x32_bf16 v[200:203], a[144:147], v[32:35], v[200:203]
    v_exp_f32 v22, v22
    v_mfma_f32_16x16x32_bf16 v[200:203], a[148:151], v[36:39], v[200:203]
    ds_read_b128 a[104:107], v1 offset:37504
    v_cvt_pk_bf16_f32 v42, v20, v21
    v_mfma_f32_16x16x32_bf16 v[204:207], a[152:155], v[32:35], v[204:207]
    v_exp_f32 v23, v23
    v_mfma_f32_16x16x32_bf16 v[204:207], a[156:159], v[36:39], v[204:207]
    ds_read_b128 a[108:111], v1 offset:37568
    v_mfma_f32_16x16x32_bf16 v[208:211], a[160:163], v[32:35], v[208:211]
    v_exp_f32 v24, v24
    v_mfma_f32_16x16x32_bf16 v[208:211], a[164:167], v[36:39], v[208:211]
    ds_read_b128 a[112:115], v1 offset:37632
    v_cvt_pk_bf16_f32 v43, v22, v23
    v_mfma_f32_16x16x32_bf16 v[212:215], a[168:171], v[32:35], v[212:215]
    v_exp_f32 v25, v25
    v_mfma_f32_16x16x32_bf16 v[212:215], a[172:175], v[36:39], v[212:215]
    ds_read_b128 a[116:119], v1 offset:37696
    v_mfma_f32_16x16x32_bf16 v[216:219], a[176:179], v[32:35], v[216:219]
    v_exp_f32 v26, v26
    v_mfma_f32_16x16x32_bf16 v[216:219], a[180:183], v[36:39], v[216:219]
    ds_read_b128 a[120:123], v1 offset:37760
    v_cvt_pk_bf16_f32 v44, v24, v25
    v_mfma_f32_16x16x32_bf16 v[220:223], a[184:187], v[32:35], v[220:223]
    v_exp_f32 v27, v27
    v_mfma_f32_16x16x32_bf16 v[220:223], a[188:191], v[36:39], v[220:223]
    ds_read_b128 a[124:127], v1 offset:37824
    v_smfmac_f32_16x16x64_bf16 a[8:11], a[16:19], v[32:39], v11
    s_waitcnt vmcnt(16) lgkmcnt(12)
    s_barrier
    v_mfma_f32_16x16x32_bf16 v[16:19], a[64:67], v[64:67], v[48:51]
    s_sub_u32 s47, s47, s48
    v_exp_f32 v28, v28
    v_mfma_f32_16x16x32_bf16 v[16:19], a[68:71], v[68:71], v[16:19]
    v_cvt_pk_bf16_f32 v45, v26, v27
    v_add_u32 v1, s48, v1
    v_mfma_f32_16x16x32_bf16 v[16:19], a[72:75], v[72:75], v[16:19]
    s_add_u32 m0, s47, 0
    v_exp_f32 v29, v29
    v_mfma_f32_16x16x32_bf16 v[16:19], a[76:79], v[76:79], v[16:19]
    s_waitcnt lgkmcnt(8)
    buffer_load_dwordx4 v5, s[16:19], s46 offen offset:0 lds
    v_mfma_f32_16x16x32_bf16 v[20:23], a[80:83], v[64:67], v[48:51]
    v_exp_f32 v30, v30
    v_mfma_f32_16x16x32_bf16 v[20:23], a[84:87], v[68:71], v[20:23]
    v_cvt_pk_bf16_f32 v46, v28, v29
    v_add_u32 v2, s48, v2
    v_mfma_f32_16x16x32_bf16 v[20:23], a[88:91], v[72:75], v[20:23]
    s_add_u32 m0, s47, 32
    v_exp_f32 v31, v31
    v_mfma_f32_16x16x32_bf16 v[20:23], a[92:95], v[76:79], v[20:23]
    s_waitcnt lgkmcnt(4)
    buffer_load_dwordx4 v5, s[16:19], s46 offen offset:1024 lds
    v_mfma_f32_16x16x32_bf16 v[24:27], a[96:99], v[64:67], v[48:51]
    s_sub_u32 s48, 0, s48
    v_exp_f32 v16, v16
    v_mfma_f32_16x16x32_bf16 v[24:27], a[100:103], v[68:71], v[24:27]
    v_cvt_pk_bf16_f32 v47, v30, v31
    v_mfma_f32_16x16x32_bf16 v[24:27], a[104:107], v[72:75], v[24:27]
    s_add_u32 m0, s47, 64
    v_exp_f32 v17, v17
    v_mfma_f32_16x16x32_bf16 v[24:27], a[108:111], v[76:79], v[24:27]
    s_waitcnt lgkmcnt(0)
    buffer_load_dwordx4 v5, s[16:19], s46 offen offset:2048 lds
    v_mfma_f32_16x16x32_bf16 v[28:31], a[112:115], v[64:67], v[48:51]
    v_exp_f32 v18, v18
    v_mfma_f32_16x16x32_bf16 v[28:31], a[116:119], v[68:71], v[28:31]
    v_cvt_pk_bf16_f32 v32, v16, v17
    v_mfma_f32_16x16x32_bf16 v[28:31], a[120:123], v[72:75], v[28:31]
    s_add_u32 m0, s47, 96
    v_exp_f32 v19, v19
    v_mfma_f32_16x16x32_bf16 v[28:31], a[124:127], v[76:79], v[28:31]
    buffer_load_dwordx4 v5, s[16:19], s46 offen offset:3072 lds
    v_mfma_f32_16x16x32_bf16 v[224:227], a[128:131], v[40:43], v[224:227]
    v_exp_f32 v20, v20
    v_mfma_f32_16x16x32_bf16 v[224:227], a[132:135], v[44:47], v[224:227]
    ds_read_b64_tr_b16 a[128:129], v2 offset:0
    v_cvt_pk_bf16_f32 v33, v18, v19
    v_mfma_f32_16x16x32_bf16 v[228:231], a[136:139], v[40:43], v[228:231]
    s_add_u32 m0, s47, 16896
    v_exp_f32 v21, v21
    v_mfma_f32_16x16x32_bf16 v[228:231], a[140:143], v[44:47], v[228:231]
    buffer_load_dwordx4 v5, s[20:23], s46 offen offset:0 lds
    v_mfma_f32_16x16x32_bf16 v[232:235], a[144:147], v[40:43], v[232:235]
    v_exp_f32 v22, v22
    v_mfma_f32_16x16x32_bf16 v[232:235], a[148:151], v[44:47], v[232:235]
    ds_read_b64_tr_b16 a[130:131], v2 offset:256
    v_cvt_pk_bf16_f32 v34, v20, v21
    v_mfma_f32_16x16x32_bf16 v[236:239], a[152:155], v[40:43], v[236:239]
    s_add_u32 m0, s47, 16928
    v_exp_f32 v23, v23
    v_mfma_f32_16x16x32_bf16 v[236:239], a[156:159], v[44:47], v[236:239]
    buffer_load_dwordx4 v5, s[20:23], s46 offen offset:1024 lds
    v_mfma_f32_16x16x32_bf16 v[240:243], a[160:163], v[40:43], v[240:243]
    v_exp_f32 v24, v24
    v_mfma_f32_16x16x32_bf16 v[240:243], a[164:167], v[44:47], v[240:243]
    ds_read_b64_tr_b16 a[132:133], v2 offset:512
    v_cvt_pk_bf16_f32 v35, v22, v23
    v_mfma_f32_16x16x32_bf16 v[244:247], a[168:171], v[40:43], v[244:247]
    s_add_u32 m0, s47, 16960
    v_exp_f32 v25, v25
    v_mfma_f32_16x16x32_bf16 v[244:247], a[172:175], v[44:47], v[244:247]
    buffer_load_dwordx4 v5, s[20:23], s46 offen offset:2048 lds
    v_mfma_f32_16x16x32_bf16 v[248:251], a[176:179], v[40:43], v[248:251]
    v_exp_f32 v26, v26
    v_mfma_f32_16x16x32_bf16 v[248:251], a[180:183], v[44:47], v[248:251]
    ds_read_b64_tr_b16 a[134:135], v2 offset:768
    v_cvt_pk_bf16_f32 v36, v24, v25
    v_mfma_f32_16x16x32_bf16 v[252:255], a[184:187], v[40:43], v[252:255]
    s_add_u32 m0, s47, 16992
    v_exp_f32 v27, v27
    v_mfma_f32_16x16x32_bf16 v[252:255], a[188:191], v[44:47], v[252:255]
    buffer_load_dwordx4 v5, s[20:23], s46 offen offset:3072 lds
    v_smfmac_f32_16x16x64_bf16 a[12:15], a[16:19], v[40:47], v11
    ds_read_b64_tr_b16 a[136:137], v2 offset:32
    v_mfma_f32_16x16x32_bf16 v[16:19], a[64:67], v[80:83], v[52:55]
    v_exp_f32 v28, v28
    v_mfma_f32_16x16x32_bf16 v[16:19], a[68:71], v[84:87], v[16:19]
    ds_read_b64_tr_b16 a[138:139], v2 offset:288
    v_cvt_pk_bf16_f32 v37, v26, v27
    v_mfma_f32_16x16x32_bf16 v[16:19], a[72:75], v[88:91], v[16:19]
    v_exp_f32 v29, v29
    v_mfma_f32_16x16x32_bf16 v[16:19], a[76:79], v[92:95], v[16:19]
    global_load_dword a63, v12, s[6:7]
    v_mfma_f32_16x16x32_bf16 v[20:23], a[80:83], v[80:83], v[52:55]
    v_exp_f32 v30, v30
    v_mfma_f32_16x16x32_bf16 v[20:23], a[84:87], v[84:87], v[20:23]
    ds_read_b64_tr_b16 a[140:141], v2 offset:544
    v_cvt_pk_bf16_f32 v38, v28, v29
    v_mfma_f32_16x16x32_bf16 v[20:23], a[88:91], v[88:91], v[20:23]
    v_exp_f32 v31, v31
    v_mfma_f32_16x16x32_bf16 v[20:23], a[92:95], v[92:95], v[20:23]
    ds_read_b64_tr_b16 a[142:143], v2 offset:800
    v_mfma_f32_16x16x32_bf16 v[24:27], a[96:99], v[80:83], v[52:55]
    v_exp_f32 v16, v16
    v_mfma_f32_16x16x32_bf16 v[24:27], a[100:103], v[84:87], v[24:27]
    ds_read_b64_tr_b16 a[144:145], v2 offset:64
    v_cvt_pk_bf16_f32 v39, v30, v31
    v_mfma_f32_16x16x32_bf16 v[24:27], a[104:107], v[88:91], v[24:27]
    s_mov_b32 s54, 884736
    v_exp_f32 v17, v17
    v_mfma_f32_16x16x32_bf16 v[24:27], a[108:111], v[92:95], v[24:27]
    buffer_load_dwordx4 a[44:47], v6, s[64:67], s54 offen
    v_mfma_f32_16x16x32_bf16 v[28:31], a[112:115], v[80:83], v[52:55]
    v_exp_f32 v18, v18
    v_mfma_f32_16x16x32_bf16 v[28:31], a[116:119], v[84:87], v[28:31]
    ds_read_b64_tr_b16 a[146:147], v2 offset:320
    v_cvt_pk_bf16_f32 v40, v16, v17
    v_mfma_f32_16x16x32_bf16 v[28:31], a[120:123], v[88:91], v[28:31]
    v_exp_f32 v19, v19
    v_mfma_f32_16x16x32_bf16 v[28:31], a[124:127], v[92:95], v[28:31]
    ds_read_b64_tr_b16 a[148:149], v2 offset:576
    v_mfma_f32_16x16x32_bf16 v[128:131], a[192:195], v[32:35], v[128:131]
    v_exp_f32 v20, v20
    v_mfma_f32_16x16x32_bf16 v[128:131], a[196:199], v[36:39], v[128:131]
    ds_read_b64_tr_b16 a[150:151], v2 offset:832
    v_cvt_pk_bf16_f32 v41, v18, v19
    v_mfma_f32_16x16x32_bf16 v[132:135], a[200:203], v[32:35], v[132:135]
    s_mov_b32 s54, 1032192
    v_exp_f32 v21, v21
    v_mfma_f32_16x16x32_bf16 v[132:135], a[204:207], v[36:39], v[132:135]
    buffer_load_dwordx4 a[48:51], v6, s[64:67], s54 offen
    v_mfma_f32_16x16x32_bf16 v[136:139], a[208:211], v[32:35], v[136:139]
    v_exp_f32 v22, v22
    v_mfma_f32_16x16x32_bf16 v[136:139], a[212:215], v[36:39], v[136:139]
    ds_read_b64_tr_b16 a[152:153], v2 offset:96
    v_cvt_pk_bf16_f32 v42, v20, v21
    v_mfma_f32_16x16x32_bf16 v[140:143], a[216:219], v[32:35], v[140:143]
    v_exp_f32 v23, v23
    v_mfma_f32_16x16x32_bf16 v[140:143], a[220:223], v[36:39], v[140:143]
    ds_read_b64_tr_b16 a[154:155], v2 offset:352
    v_mfma_f32_16x16x32_bf16 v[144:147], a[224:227], v[32:35], v[144:147]
    v_exp_f32 v24, v24
    v_mfma_f32_16x16x32_bf16 v[144:147], a[228:231], v[36:39], v[144:147]
    ds_read_b64_tr_b16 a[156:157], v2 offset:608
    v_cvt_pk_bf16_f32 v43, v22, v23
    v_mfma_f32_16x16x32_bf16 v[148:151], a[232:235], v[32:35], v[148:151]
    s_mov_b32 s54, 1179648
    v_exp_f32 v25, v25
    v_mfma_f32_16x16x32_bf16 v[148:151], a[236:239], v[36:39], v[148:151]
    buffer_load_dwordx4 a[52:55], v6, s[64:67], s54 offen
    v_mfma_f32_16x16x32_bf16 v[152:155], a[240:243], v[32:35], v[152:155]
    v_exp_f32 v26, v26
    v_mfma_f32_16x16x32_bf16 v[152:155], a[244:247], v[36:39], v[152:155]
    ds_read_b64_tr_b16 a[158:159], v2 offset:864
    v_cvt_pk_bf16_f32 v44, v24, v25
    v_mfma_f32_16x16x32_bf16 v[156:159], a[248:251], v[32:35], v[156:159]
    v_exp_f32 v27, v27
    v_mfma_f32_16x16x32_bf16 v[156:159], a[252:255], v[36:39], v[156:159]
    ds_read_b64_tr_b16 a[160:161], v2 offset:128
    v_smfmac_f32_16x16x64_bf16 a[0:3], a[16:19], v[32:39], v11
    ds_read_b64_tr_b16 a[162:163], v2 offset:384
    v_mfma_f32_16x16x32_bf16 v[16:19], a[64:67], v[96:99], v[56:59]
    v_exp_f32 v28, v28
    v_mfma_f32_16x16x32_bf16 v[16:19], a[68:71], v[100:103], v[16:19]
    ds_read_b64_tr_b16 a[164:165], v2 offset:640
    v_cvt_pk_bf16_f32 v45, v26, v27
    v_mfma_f32_16x16x32_bf16 v[16:19], a[72:75], v[104:107], v[16:19]
    v_exp_f32 v29, v29
    v_mfma_f32_16x16x32_bf16 v[16:19], a[76:79], v[108:111], v[16:19]
    ds_read_b64_tr_b16 a[166:167], v2 offset:896
    v_mfma_f32_16x16x32_bf16 v[20:23], a[80:83], v[96:99], v[56:59]
    v_exp_f32 v30, v30
    v_mfma_f32_16x16x32_bf16 v[20:23], a[84:87], v[100:103], v[20:23]
    ds_read_b64_tr_b16 a[168:169], v2 offset:160
    v_cvt_pk_bf16_f32 v46, v28, v29
    v_mfma_f32_16x16x32_bf16 v[20:23], a[88:91], v[104:107], v[20:23]
    v_exp_f32 v31, v31
    v_mfma_f32_16x16x32_bf16 v[20:23], a[92:95], v[108:111], v[20:23]
    ds_read_b64_tr_b16 a[170:171], v2 offset:416
    v_mfma_f32_16x16x32_bf16 v[24:27], a[96:99], v[96:99], v[56:59]
    v_exp_f32 v16, v16
    v_mfma_f32_16x16x32_bf16 v[24:27], a[100:103], v[100:103], v[24:27]
    ds_read_b64_tr_b16 a[172:173], v2 offset:672
    v_cvt_pk_bf16_f32 v47, v30, v31
    v_mfma_f32_16x16x32_bf16 v[24:27], a[104:107], v[104:107], v[24:27]
    v_exp_f32 v17, v17
    v_mfma_f32_16x16x32_bf16 v[24:27], a[108:111], v[108:111], v[24:27]
    ds_read_b64_tr_b16 a[174:175], v2 offset:928
    v_mfma_f32_16x16x32_bf16 v[28:31], a[112:115], v[96:99], v[56:59]
    v_exp_f32 v18, v18
    v_mfma_f32_16x16x32_bf16 v[28:31], a[116:119], v[100:103], v[28:31]
    ds_read_b64_tr_b16 a[176:177], v2 offset:192
    v_cvt_pk_bf16_f32 v32, v16, v17
    v_mfma_f32_16x16x32_bf16 v[28:31], a[120:123], v[104:107], v[28:31]
    v_exp_f32 v19, v19
    v_mfma_f32_16x16x32_bf16 v[28:31], a[124:127], v[108:111], v[28:31]
    ds_read_b64_tr_b16 a[178:179], v2 offset:448
    v_mfma_f32_16x16x32_bf16 v[160:163], a[192:195], v[40:43], v[160:163]
    v_exp_f32 v20, v20
    v_mfma_f32_16x16x32_bf16 v[160:163], a[196:199], v[44:47], v[160:163]
    ds_read_b64_tr_b16 a[180:181], v2 offset:704
    v_cvt_pk_bf16_f32 v33, v18, v19
    v_mfma_f32_16x16x32_bf16 v[164:167], a[200:203], v[40:43], v[164:167]
    v_exp_f32 v21, v21
    v_mfma_f32_16x16x32_bf16 v[164:167], a[204:207], v[44:47], v[164:167]
    ds_read_b64_tr_b16 a[182:183], v2 offset:960
    v_mfma_f32_16x16x32_bf16 v[168:171], a[208:211], v[40:43], v[168:171]
    v_exp_f32 v22, v22
    v_mfma_f32_16x16x32_bf16 v[168:171], a[212:215], v[44:47], v[168:171]
    ds_read_b64_tr_b16 a[184:185], v2 offset:224
    v_cvt_pk_bf16_f32 v34, v20, v21
    v_mfma_f32_16x16x32_bf16 v[172:175], a[216:219], v[40:43], v[172:175]
    v_exp_f32 v23, v23
    v_mfma_f32_16x16x32_bf16 v[172:175], a[220:223], v[44:47], v[172:175]
    ds_read_b64_tr_b16 a[186:187], v2 offset:480
    v_mfma_f32_16x16x32_bf16 v[176:179], a[224:227], v[40:43], v[176:179]
    v_exp_f32 v24, v24
    v_mfma_f32_16x16x32_bf16 v[176:179], a[228:231], v[44:47], v[176:179]
    ds_read_b64_tr_b16 a[188:189], v2 offset:736
    v_cvt_pk_bf16_f32 v35, v22, v23
    v_mfma_f32_16x16x32_bf16 v[180:183], a[232:235], v[40:43], v[180:183]
    v_exp_f32 v25, v25
    v_mfma_f32_16x16x32_bf16 v[180:183], a[236:239], v[44:47], v[180:183]
    ds_read_b64_tr_b16 a[190:191], v2 offset:992
    v_mfma_f32_16x16x32_bf16 v[184:187], a[240:243], v[40:43], v[184:187]
    v_exp_f32 v26, v26
    v_mfma_f32_16x16x32_bf16 v[184:187], a[244:247], v[44:47], v[184:187]
    v_cvt_pk_bf16_f32 v36, v24, v25
    v_mfma_f32_16x16x32_bf16 v[188:191], a[248:251], v[40:43], v[188:191]
    v_exp_f32 v27, v27
    v_mfma_f32_16x16x32_bf16 v[188:191], a[252:255], v[44:47], v[188:191]
    v_smfmac_f32_16x16x64_bf16 a[4:7], a[16:19], v[40:47], v11
    v_mfma_f32_16x16x32_bf16 v[16:19], a[64:67], v[112:115], v[60:63]
    v_exp_f32 v28, v28
    v_mfma_f32_16x16x32_bf16 v[16:19], a[68:71], v[116:119], v[16:19]
    s_add_u32 s46, s46, 16384
    ds_read_b128 a[64:67], v1 offset:0
    v_cvt_pk_bf16_f32 v37, v26, v27
    v_mfma_f32_16x16x32_bf16 v[16:19], a[72:75], v[120:123], v[16:19]
    v_exp_f32 v29, v29
    v_mfma_f32_16x16x32_bf16 v[16:19], a[76:79], v[124:127], v[16:19]
    ds_read_b128 a[68:71], v1 offset:64
    v_mfma_f32_16x16x32_bf16 v[20:23], a[80:83], v[112:115], v[60:63]
    v_exp_f32 v30, v30
    v_mfma_f32_16x16x32_bf16 v[20:23], a[84:87], v[116:119], v[20:23]
    ds_read_b128 a[72:75], v1 offset:128
    v_cvt_pk_bf16_f32 v38, v28, v29
    v_mfma_f32_16x16x32_bf16 v[20:23], a[88:91], v[120:123], v[20:23]
    v_exp_f32 v31, v31
    v_mfma_f32_16x16x32_bf16 v[20:23], a[92:95], v[124:127], v[20:23]
    ds_read_b128 a[76:79], v1 offset:192
    v_mfma_f32_16x16x32_bf16 v[24:27], a[96:99], v[112:115], v[60:63]
    v_exp_f32 v16, v16
    v_mfma_f32_16x16x32_bf16 v[24:27], a[100:103], v[116:119], v[24:27]
    ds_read_b128 a[80:83], v1 offset:256
    v_cvt_pk_bf16_f32 v39, v30, v31
    v_mfma_f32_16x16x32_bf16 v[24:27], a[104:107], v[120:123], v[24:27]
    v_exp_f32 v17, v17
    v_mfma_f32_16x16x32_bf16 v[24:27], a[108:111], v[124:127], v[24:27]
    ds_read_b128 a[84:87], v1 offset:320
    v_mfma_f32_16x16x32_bf16 v[28:31], a[112:115], v[112:115], v[60:63]
    v_exp_f32 v18, v18
    v_mfma_f32_16x16x32_bf16 v[28:31], a[116:119], v[116:119], v[28:31]
    ds_read_b128 a[88:91], v1 offset:384
    v_cvt_pk_bf16_f32 v40, v16, v17
    v_mfma_f32_16x16x32_bf16 v[28:31], a[120:123], v[120:123], v[28:31]
    v_exp_f32 v19, v19
    v_mfma_f32_16x16x32_bf16 v[28:31], a[124:127], v[124:127], v[28:31]
    ds_read_b128 a[92:95], v1 offset:448
    v_mfma_f32_16x16x32_bf16 v[192:195], a[192:195], v[32:35], v[192:195]
    v_exp_f32 v20, v20
    v_mfma_f32_16x16x32_bf16 v[192:195], a[196:199], v[36:39], v[192:195]
    ds_read_b128 a[96:99], v1 offset:512
    v_cvt_pk_bf16_f32 v41, v18, v19
    v_mfma_f32_16x16x32_bf16 v[196:199], a[200:203], v[32:35], v[196:199]
    v_exp_f32 v21, v21
    v_mfma_f32_16x16x32_bf16 v[196:199], a[204:207], v[36:39], v[196:199]
    ds_read_b128 a[100:103], v1 offset:576
    v_mfma_f32_16x16x32_bf16 v[200:203], a[208:211], v[32:35], v[200:203]
    v_exp_f32 v22, v22
    v_mfma_f32_16x16x32_bf16 v[200:203], a[212:215], v[36:39], v[200:203]
    ds_read_b128 a[104:107], v1 offset:640
    v_cvt_pk_bf16_f32 v42, v20, v21
    v_mfma_f32_16x16x32_bf16 v[204:207], a[216:219], v[32:35], v[204:207]
    v_exp_f32 v23, v23
    v_mfma_f32_16x16x32_bf16 v[204:207], a[220:223], v[36:39], v[204:207]
    ds_read_b128 a[108:111], v1 offset:704
    v_mfma_f32_16x16x32_bf16 v[208:211], a[224:227], v[32:35], v[208:211]
    v_exp_f32 v24, v24
    v_mfma_f32_16x16x32_bf16 v[208:211], a[228:231], v[36:39], v[208:211]
    ds_read_b128 a[112:115], v1 offset:768
    v_cvt_pk_bf16_f32 v43, v22, v23
    v_mfma_f32_16x16x32_bf16 v[212:215], a[232:235], v[32:35], v[212:215]
    v_exp_f32 v25, v25
    v_mfma_f32_16x16x32_bf16 v[212:215], a[236:239], v[36:39], v[212:215]
    ds_read_b128 a[116:119], v1 offset:832
    v_mfma_f32_16x16x32_bf16 v[216:219], a[240:243], v[32:35], v[216:219]
    v_exp_f32 v26, v26
    v_mfma_f32_16x16x32_bf16 v[216:219], a[244:247], v[36:39], v[216:219]
    ds_read_b128 a[120:123], v1 offset:896
    v_cvt_pk_bf16_f32 v44, v24, v25
    v_mfma_f32_16x16x32_bf16 v[220:223], a[248:251], v[32:35], v[220:223]
    v_exp_f32 v27, v27
    v_mfma_f32_16x16x32_bf16 v[220:223], a[252:255], v[36:39], v[220:223]
    ds_read_b128 a[124:127], v1 offset:960
    v_smfmac_f32_16x16x64_bf16 a[8:11], a[16:19], v[32:39], v11
    s_waitcnt vmcnt(16) lgkmcnt(12)
    s_barrier
    v_mfma_f32_16x16x32_bf16 v[16:19], a[64:67], v[64:67], v[48:51]
    v_exp_f32 v28, v28
    v_mfma_f32_16x16x32_bf16 v[16:19], a[68:71], v[68:71], v[16:19]
    v_cvt_pk_bf16_f32 v45, v26, v27
    v_mfma_f32_16x16x32_bf16 v[16:19], a[72:75], v[72:75], v[16:19]
    s_add_u32 m0, s47, 36864
    v_exp_f32 v29, v29
    v_mfma_f32_16x16x32_bf16 v[16:19], a[76:79], v[76:79], v[16:19]
    s_waitcnt lgkmcnt(8)
    buffer_load_dwordx4 v5, s[16:19], s46 offen offset:0 lds
    v_mfma_f32_16x16x32_bf16 v[20:23], a[80:83], v[64:67], v[48:51]
    v_exp_f32 v30, v30
    v_mfma_f32_16x16x32_bf16 v[20:23], a[84:87], v[68:71], v[20:23]
    v_cvt_pk_bf16_f32 v46, v28, v29
    v_mfma_f32_16x16x32_bf16 v[20:23], a[88:91], v[72:75], v[20:23]
    s_add_u32 m0, s47, 36896
    v_exp_f32 v31, v31
    v_mfma_f32_16x16x32_bf16 v[20:23], a[92:95], v[76:79], v[20:23]
    s_waitcnt lgkmcnt(4)
    buffer_load_dwordx4 v5, s[16:19], s46 offen offset:1024 lds
    v_mfma_f32_16x16x32_bf16 v[24:27], a[96:99], v[64:67], v[48:51]
    v_exp_f32 v16, v16
    v_mfma_f32_16x16x32_bf16 v[24:27], a[100:103], v[68:71], v[24:27]
    v_cvt_pk_bf16_f32 v47, v30, v31
    v_mfma_f32_16x16x32_bf16 v[24:27], a[104:107], v[72:75], v[24:27]
    s_add_u32 m0, s47, 36928
    v_exp_f32 v17, v17
    v_mfma_f32_16x16x32_bf16 v[24:27], a[108:111], v[76:79], v[24:27]
    s_waitcnt lgkmcnt(0)
    buffer_load_dwordx4 v5, s[16:19], s46 offen offset:2048 lds
    v_mfma_f32_16x16x32_bf16 v[28:31], a[112:115], v[64:67], v[48:51]
    v_exp_f32 v18, v18
    v_mfma_f32_16x16x32_bf16 v[28:31], a[116:119], v[68:71], v[28:31]
    v_cvt_pk_bf16_f32 v32, v16, v17
    v_mfma_f32_16x16x32_bf16 v[28:31], a[120:123], v[72:75], v[28:31]
    s_add_u32 m0, s47, 36960
    v_exp_f32 v19, v19
    v_mfma_f32_16x16x32_bf16 v[28:31], a[124:127], v[76:79], v[28:31]
    buffer_load_dwordx4 v5, s[16:19], s46 offen offset:3072 lds
    v_mfma_f32_16x16x32_bf16 v[224:227], a[192:195], v[40:43], v[224:227]
    v_exp_f32 v20, v20
    v_mfma_f32_16x16x32_bf16 v[224:227], a[196:199], v[44:47], v[224:227]
    ds_read_b64_tr_b16 a[192:193], v2 offset:36864
    v_cvt_pk_bf16_f32 v33, v18, v19
    v_mfma_f32_16x16x32_bf16 v[228:231], a[200:203], v[40:43], v[228:231]
    s_add_u32 m0, s47, 53760
    v_exp_f32 v21, v21
    v_mfma_f32_16x16x32_bf16 v[228:231], a[204:207], v[44:47], v[228:231]
    buffer_load_dwordx4 v5, s[20:23], s46 offen offset:0 lds
    v_mfma_f32_16x16x32_bf16 v[232:235], a[208:211], v[40:43], v[232:235]
    v_exp_f32 v22, v22
    v_mfma_f32_16x16x32_bf16 v[232:235], a[212:215], v[44:47], v[232:235]
    ds_read_b64_tr_b16 a[194:195], v2 offset:37120
    v_cvt_pk_bf16_f32 v34, v20, v21
    v_mfma_f32_16x16x32_bf16 v[236:239], a[216:219], v[40:43], v[236:239]
    s_add_u32 m0, s47, 53792
    v_exp_f32 v23, v23
    v_mfma_f32_16x16x32_bf16 v[236:239], a[220:223], v[44:47], v[236:239]
    buffer_load_dwordx4 v5, s[20:23], s46 offen offset:1024 lds
    v_mfma_f32_16x16x32_bf16 v[240:243], a[224:227], v[40:43], v[240:243]
    v_exp_f32 v24, v24
    v_mfma_f32_16x16x32_bf16 v[240:243], a[228:231], v[44:47], v[240:243]
    ds_read_b64_tr_b16 a[196:197], v2 offset:37376
    v_cvt_pk_bf16_f32 v35, v22, v23
    v_mfma_f32_16x16x32_bf16 v[244:247], a[232:235], v[40:43], v[244:247]
    s_add_u32 m0, s47, 53824
    v_exp_f32 v25, v25
    v_mfma_f32_16x16x32_bf16 v[244:247], a[236:239], v[44:47], v[244:247]
    buffer_load_dwordx4 v5, s[20:23], s46 offen offset:2048 lds
    v_mfma_f32_16x16x32_bf16 v[248:251], a[240:243], v[40:43], v[248:251]
    v_exp_f32 v26, v26
    v_mfma_f32_16x16x32_bf16 v[248:251], a[244:247], v[44:47], v[248:251]
    ds_read_b64_tr_b16 a[198:199], v2 offset:37632
    v_cvt_pk_bf16_f32 v36, v24, v25
    v_mfma_f32_16x16x32_bf16 v[252:255], a[248:251], v[40:43], v[252:255]
    s_add_u32 m0, s47, 53856
    v_exp_f32 v27, v27
    v_mfma_f32_16x16x32_bf16 v[252:255], a[252:255], v[44:47], v[252:255]
    buffer_load_dwordx4 v5, s[20:23], s46 offen offset:3072 lds
    v_smfmac_f32_16x16x64_bf16 a[12:15], a[16:19], v[40:47], v11
    ds_read_b64_tr_b16 a[200:201], v2 offset:36896
    v_mfma_f32_16x16x32_bf16 v[16:19], a[64:67], v[80:83], v[52:55]
    v_exp_f32 v28, v28
    v_mfma_f32_16x16x32_bf16 v[16:19], a[68:71], v[84:87], v[16:19]
    ds_read_b64_tr_b16 a[202:203], v2 offset:37152
    v_cvt_pk_bf16_f32 v37, v26, v27
    v_mfma_f32_16x16x32_bf16 v[16:19], a[72:75], v[88:91], v[16:19]
    v_exp_f32 v29, v29
    v_mfma_f32_16x16x32_bf16 v[16:19], a[76:79], v[92:95], v[16:19]
    global_load_dword a63, v13, s[8:9]
    v_mfma_f32_16x16x32_bf16 v[20:23], a[80:83], v[80:83], v[52:55]
    v_exp_f32 v30, v30
    v_mfma_f32_16x16x32_bf16 v[20:23], a[84:87], v[84:87], v[20:23]
    ds_read_b64_tr_b16 a[204:205], v2 offset:37408
    v_cvt_pk_bf16_f32 v38, v28, v29
    v_mfma_f32_16x16x32_bf16 v[20:23], a[88:91], v[88:91], v[20:23]
    v_exp_f32 v31, v31
    v_mfma_f32_16x16x32_bf16 v[20:23], a[92:95], v[92:95], v[20:23]
    ds_read_b64_tr_b16 a[206:207], v2 offset:37664
    v_mfma_f32_16x16x32_bf16 v[24:27], a[96:99], v[80:83], v[52:55]
    v_exp_f32 v16, v16
    v_mfma_f32_16x16x32_bf16 v[24:27], a[100:103], v[84:87], v[24:27]
    ds_read_b64_tr_b16 a[208:209], v2 offset:36928
    v_cvt_pk_bf16_f32 v39, v30, v31
    v_mfma_f32_16x16x32_bf16 v[24:27], a[104:107], v[88:91], v[24:27]
    v_exp_f32 v17, v17
    v_mfma_f32_16x16x32_bf16 v[24:27], a[108:111], v[92:95], v[24:27]
    ds_read_b64_tr_b16 a[210:211], v2 offset:37184
    v_mfma_f32_16x16x32_bf16 v[28:31], a[112:115], v[80:83], v[52:55]
    v_exp_f32 v18, v18
    v_mfma_f32_16x16x32_bf16 v[28:31], a[116:119], v[84:87], v[28:31]
    ds_read_b64_tr_b16 a[212:213], v2 offset:37440
    v_cvt_pk_bf16_f32 v40, v16, v17
    v_mfma_f32_16x16x32_bf16 v[28:31], a[120:123], v[88:91], v[28:31]
    v_exp_f32 v19, v19
    v_mfma_f32_16x16x32_bf16 v[28:31], a[124:127], v[92:95], v[28:31]
    ds_read_b64_tr_b16 a[214:215], v2 offset:37696
    v_mfma_f32_16x16x32_bf16 v[128:131], a[128:131], v[32:35], v[128:131]
    v_exp_f32 v20, v20
    v_mfma_f32_16x16x32_bf16 v[128:131], a[132:135], v[36:39], v[128:131]
    ds_read_b64_tr_b16 a[216:217], v2 offset:36960
    v_cvt_pk_bf16_f32 v41, v18, v19
    v_mfma_f32_16x16x32_bf16 v[132:135], a[136:139], v[32:35], v[132:135]
    v_exp_f32 v21, v21
    v_mfma_f32_16x16x32_bf16 v[132:135], a[140:143], v[36:39], v[132:135]
    ds_read_b64_tr_b16 a[218:219], v2 offset:37216
    v_mfma_f32_16x16x32_bf16 v[136:139], a[144:147], v[32:35], v[136:139]
    v_exp_f32 v22, v22
    v_mfma_f32_16x16x32_bf16 v[136:139], a[148:151], v[36:39], v[136:139]
    ds_read_b64_tr_b16 a[220:221], v2 offset:37472
    v_cvt_pk_bf16_f32 v42, v20, v21
    v_mfma_f32_16x16x32_bf16 v[140:143], a[152:155], v[32:35], v[140:143]
    v_exp_f32 v23, v23
    v_mfma_f32_16x16x32_bf16 v[140:143], a[156:159], v[36:39], v[140:143]
    ds_read_b64_tr_b16 a[222:223], v2 offset:37728
    v_mfma_f32_16x16x32_bf16 v[144:147], a[160:163], v[32:35], v[144:147]
    v_exp_f32 v24, v24
    v_mfma_f32_16x16x32_bf16 v[144:147], a[164:167], v[36:39], v[144:147]
    ds_read_b64_tr_b16 a[224:225], v2 offset:36992
    v_cvt_pk_bf16_f32 v43, v22, v23
    v_mfma_f32_16x16x32_bf16 v[148:151], a[168:171], v[32:35], v[148:151]
    v_exp_f32 v25, v25
    v_mfma_f32_16x16x32_bf16 v[148:151], a[172:175], v[36:39], v[148:151]
    ds_read_b64_tr_b16 a[226:227], v2 offset:37248
    v_mfma_f32_16x16x32_bf16 v[152:155], a[176:179], v[32:35], v[152:155]
    v_exp_f32 v26, v26
    v_mfma_f32_16x16x32_bf16 v[152:155], a[180:183], v[36:39], v[152:155]
    ds_read_b64_tr_b16 a[228:229], v2 offset:37504
    v_cvt_pk_bf16_f32 v44, v24, v25
    v_mfma_f32_16x16x32_bf16 v[156:159], a[184:187], v[32:35], v[156:159]
    v_exp_f32 v27, v27
    v_mfma_f32_16x16x32_bf16 v[156:159], a[188:191], v[36:39], v[156:159]
    ds_read_b64_tr_b16 a[230:231], v2 offset:37760
    v_smfmac_f32_16x16x64_bf16 a[0:3], a[16:19], v[32:39], v11
    ds_read_b64_tr_b16 a[232:233], v2 offset:37024
    v_mfma_f32_16x16x32_bf16 v[16:19], a[64:67], v[96:99], v[56:59]
    v_exp_f32 v28, v28
    v_mfma_f32_16x16x32_bf16 v[16:19], a[68:71], v[100:103], v[16:19]
    ds_read_b64_tr_b16 a[234:235], v2 offset:37280
    v_cvt_pk_bf16_f32 v45, v26, v27
    v_mfma_f32_16x16x32_bf16 v[16:19], a[72:75], v[104:107], v[16:19]
    v_exp_f32 v29, v29
    v_mfma_f32_16x16x32_bf16 v[16:19], a[76:79], v[108:111], v[16:19]
    ds_read_b64_tr_b16 a[236:237], v2 offset:37536
    v_mfma_f32_16x16x32_bf16 v[20:23], a[80:83], v[96:99], v[56:59]
    v_exp_f32 v30, v30
    v_mfma_f32_16x16x32_bf16 v[20:23], a[84:87], v[100:103], v[20:23]
    ds_read_b64_tr_b16 a[238:239], v2 offset:37792
    v_cvt_pk_bf16_f32 v46, v28, v29
    v_mfma_f32_16x16x32_bf16 v[20:23], a[88:91], v[104:107], v[20:23]
    v_exp_f32 v31, v31
    v_mfma_f32_16x16x32_bf16 v[20:23], a[92:95], v[108:111], v[20:23]
    ds_read_b64_tr_b16 a[240:241], v2 offset:37056
    v_mfma_f32_16x16x32_bf16 v[24:27], a[96:99], v[96:99], v[56:59]
    v_exp_f32 v16, v16
    v_mfma_f32_16x16x32_bf16 v[24:27], a[100:103], v[100:103], v[24:27]
    ds_read_b64_tr_b16 a[242:243], v2 offset:37312
    v_cvt_pk_bf16_f32 v47, v30, v31
    v_mfma_f32_16x16x32_bf16 v[24:27], a[104:107], v[104:107], v[24:27]
    v_exp_f32 v17, v17
    v_mfma_f32_16x16x32_bf16 v[24:27], a[108:111], v[108:111], v[24:27]
    ds_read_b64_tr_b16 a[244:245], v2 offset:37568
    v_mfma_f32_16x16x32_bf16 v[28:31], a[112:115], v[96:99], v[56:59]
    v_exp_f32 v18, v18
    v_mfma_f32_16x16x32_bf16 v[28:31], a[116:119], v[100:103], v[28:31]
    ds_read_b64_tr_b16 a[246:247], v2 offset:37824
    v_cvt_pk_bf16_f32 v32, v16, v17
    v_mfma_f32_16x16x32_bf16 v[28:31], a[120:123], v[104:107], v[28:31]
    v_exp_f32 v19, v19
    v_mfma_f32_16x16x32_bf16 v[28:31], a[124:127], v[108:111], v[28:31]
    ds_read_b64_tr_b16 a[248:249], v2 offset:37088
    v_mfma_f32_16x16x32_bf16 v[160:163], a[128:131], v[40:43], v[160:163]
    v_exp_f32 v20, v20
    v_mfma_f32_16x16x32_bf16 v[160:163], a[132:135], v[44:47], v[160:163]
    ds_read_b64_tr_b16 a[250:251], v2 offset:37344
    v_cvt_pk_bf16_f32 v33, v18, v19
    v_mfma_f32_16x16x32_bf16 v[164:167], a[136:139], v[40:43], v[164:167]
    v_exp_f32 v21, v21
    v_mfma_f32_16x16x32_bf16 v[164:167], a[140:143], v[44:47], v[164:167]
    ds_read_b64_tr_b16 a[252:253], v2 offset:37600
    v_mfma_f32_16x16x32_bf16 v[168:171], a[144:147], v[40:43], v[168:171]
    v_exp_f32 v22, v22
    v_mfma_f32_16x16x32_bf16 v[168:171], a[148:151], v[44:47], v[168:171]
    ds_read_b64_tr_b16 a[254:255], v2 offset:37856
    v_cvt_pk_bf16_f32 v34, v20, v21
    v_mfma_f32_16x16x32_bf16 v[172:175], a[152:155], v[40:43], v[172:175]
    v_exp_f32 v23, v23
    v_mfma_f32_16x16x32_bf16 v[172:175], a[156:159], v[44:47], v[172:175]
    v_mfma_f32_16x16x32_bf16 v[176:179], a[160:163], v[40:43], v[176:179]
    v_exp_f32 v24, v24
    v_mfma_f32_16x16x32_bf16 v[176:179], a[164:167], v[44:47], v[176:179]
    v_cvt_pk_bf16_f32 v35, v22, v23
    v_mfma_f32_16x16x32_bf16 v[180:183], a[168:171], v[40:43], v[180:183]
    v_exp_f32 v25, v25
    v_mfma_f32_16x16x32_bf16 v[180:183], a[172:175], v[44:47], v[180:183]
    v_mfma_f32_16x16x32_bf16 v[184:187], a[176:179], v[40:43], v[184:187]
    v_exp_f32 v26, v26
    v_mfma_f32_16x16x32_bf16 v[184:187], a[180:183], v[44:47], v[184:187]
    v_cvt_pk_bf16_f32 v36, v24, v25
    v_mfma_f32_16x16x32_bf16 v[188:191], a[184:187], v[40:43], v[188:191]
    v_exp_f32 v27, v27
    v_mfma_f32_16x16x32_bf16 v[188:191], a[188:191], v[44:47], v[188:191]
L2_pad7:
    s_cbranch_execz L2_pad11
    v_smfmac_f32_16x16x64_bf16 a[4:7], a[16:19], v[40:47], v11
    v_mfma_f32_16x16x32_bf16 v[16:19], a[64:67], v[112:115], v[60:63]
    v_exp_f32 v28, v28
    v_mfma_f32_16x16x32_bf16 v[16:19], a[68:71], v[116:119], v[16:19]
    s_add_u32 s46, s46, 16384
    ds_read_b128 a[64:67], v1 offset:36864
    v_cvt_pk_bf16_f32 v37, v26, v27
    v_mfma_f32_16x16x32_bf16 v[16:19], a[72:75], v[120:123], v[16:19]
    v_exp_f32 v29, v29
    v_mfma_f32_16x16x32_bf16 v[16:19], a[76:79], v[124:127], v[16:19]
    ds_read_b128 a[68:71], v1 offset:36928
    v_mfma_f32_16x16x32_bf16 v[20:23], a[80:83], v[112:115], v[60:63]
    v_exp_f32 v30, v30
    v_mfma_f32_16x16x32_bf16 v[20:23], a[84:87], v[116:119], v[20:23]
    ds_read_b128 a[72:75], v1 offset:36992
    v_cvt_pk_bf16_f32 v38, v28, v29
    v_mfma_f32_16x16x32_bf16 v[20:23], a[88:91], v[120:123], v[20:23]
    v_exp_f32 v31, v31
    v_mfma_f32_16x16x32_bf16 v[20:23], a[92:95], v[124:127], v[20:23]
    ds_read_b128 a[76:79], v1 offset:37056
    v_mfma_f32_16x16x32_bf16 v[24:27], a[96:99], v[112:115], v[60:63]
    v_exp_f32 v16, v16
    v_mfma_f32_16x16x32_bf16 v[24:27], a[100:103], v[116:119], v[24:27]
    ds_read_b128 a[80:83], v1 offset:37120
    v_cvt_pk_bf16_f32 v39, v30, v31
    v_mfma_f32_16x16x32_bf16 v[24:27], a[104:107], v[120:123], v[24:27]
    v_exp_f32 v17, v17
    v_mfma_f32_16x16x32_bf16 v[24:27], a[108:111], v[124:127], v[24:27]
    ds_read_b128 a[84:87], v1 offset:37184
    v_mfma_f32_16x16x32_bf16 v[28:31], a[112:115], v[112:115], v[60:63]
    v_exp_f32 v18, v18
    v_mfma_f32_16x16x32_bf16 v[28:31], a[116:119], v[116:119], v[28:31]
    ds_read_b128 a[88:91], v1 offset:37248
    v_cvt_pk_bf16_f32 v40, v16, v17
    v_mfma_f32_16x16x32_bf16 v[28:31], a[120:123], v[120:123], v[28:31]
    v_exp_f32 v19, v19
    v_mfma_f32_16x16x32_bf16 v[28:31], a[124:127], v[124:127], v[28:31]
    ds_read_b128 a[92:95], v1 offset:37312
    v_mfma_f32_16x16x32_bf16 v[192:195], a[128:131], v[32:35], v[192:195]
    v_exp_f32 v20, v20
    v_mfma_f32_16x16x32_bf16 v[192:195], a[132:135], v[36:39], v[192:195]
    ds_read_b128 a[96:99], v1 offset:37376
    v_cvt_pk_bf16_f32 v41, v18, v19
    v_mfma_f32_16x16x32_bf16 v[196:199], a[136:139], v[32:35], v[196:199]
    v_exp_f32 v21, v21
    v_mfma_f32_16x16x32_bf16 v[196:199], a[140:143], v[36:39], v[196:199]
    ds_read_b128 a[100:103], v1 offset:37440
    v_mfma_f32_16x16x32_bf16 v[200:203], a[144:147], v[32:35], v[200:203]
    v_exp_f32 v22, v22
    v_mfma_f32_16x16x32_bf16 v[200:203], a[148:151], v[36:39], v[200:203]
    ds_read_b128 a[104:107], v1 offset:37504
    v_cvt_pk_bf16_f32 v42, v20, v21
    v_mfma_f32_16x16x32_bf16 v[204:207], a[152:155], v[32:35], v[204:207]
    v_exp_f32 v23, v23
    v_mfma_f32_16x16x32_bf16 v[204:207], a[156:159], v[36:39], v[204:207]
    ds_read_b128 a[108:111], v1 offset:37568
    v_mfma_f32_16x16x32_bf16 v[208:211], a[160:163], v[32:35], v[208:211]
    v_exp_f32 v24, v24
    v_mfma_f32_16x16x32_bf16 v[208:211], a[164:167], v[36:39], v[208:211]
    ds_read_b128 a[112:115], v1 offset:37632
    v_cvt_pk_bf16_f32 v43, v22, v23
    v_mfma_f32_16x16x32_bf16 v[212:215], a[168:171], v[32:35], v[212:215]
    v_exp_f32 v25, v25
    v_mfma_f32_16x16x32_bf16 v[212:215], a[172:175], v[36:39], v[212:215]
    ds_read_b128 a[116:119], v1 offset:37696
    v_mfma_f32_16x16x32_bf16 v[216:219], a[176:179], v[32:35], v[216:219]
    v_exp_f32 v26, v26
    v_mfma_f32_16x16x32_bf16 v[216:219], a[180:183], v[36:39], v[216:219]
    ds_read_b128 a[120:123], v1 offset:37760
    v_cvt_pk_bf16_f32 v44, v24, v25
    v_mfma_f32_16x16x32_bf16 v[220:223], a[184:187], v[32:35], v[220:223]
    v_exp_f32 v27, v27
    v_mfma_f32_16x16x32_bf16 v[220:223], a[188:191], v[36:39], v[220:223]
    ds_read_b128 a[124:127], v1 offset:37824
    v_smfmac_f32_16x16x64_bf16 a[8:11], a[16:19], v[32:39], v11
    s_waitcnt vmcnt(13) lgkmcnt(12)
    s_barrier
    v_mfma_f32_16x16x32_bf16 v[16:19], a[64:67], v[64:67], v[48:51]
    s_sub_u32 s47, s47, s48
    v_exp_f32 v28, v28
    v_mfma_f32_16x16x32_bf16 v[16:19], a[68:71], v[68:71], v[16:19]
    v_cvt_pk_bf16_f32 v45, v26, v27
    v_add_u32 v1, s48, v1
    v_mfma_f32_16x16x32_bf16 v[16:19], a[72:75], v[72:75], v[16:19]
    s_add_u32 m0, s44, 73728
    v_exp_f32 v29, v29
    v_mfma_f32_16x16x32_bf16 v[16:19], a[76:79], v[76:79], v[16:19]
    s_waitcnt lgkmcnt(8)
    s_mov_b32 s45, 0
    buffer_load_dwordx4 v7, s[28:31], s45 offen offset:0 lds
    v_mfma_f32_16x16x32_bf16 v[20:23], a[80:83], v[64:67], v[48:51]
    v_exp_f32 v30, v30
    v_mfma_f32_16x16x32_bf16 v[20:23], a[84:87], v[68:71], v[20:23]
    v_cvt_pk_bf16_f32 v46, v28, v29
    v_add_u32 v2, s48, v2
    v_mfma_f32_16x16x32_bf16 v[20:23], a[88:91], v[72:75], v[20:23]
    s_add_u32 m0, s44, 73632
    v_exp_f32 v31, v31
    v_mfma_f32_16x16x32_bf16 v[20:23], a[92:95], v[76:79], v[20:23]
    s_waitcnt lgkmcnt(4)
    buffer_load_dwordx4 v7, s[28:31], s45 offen offset:1152 lds
    v_mfma_f32_16x16x32_bf16 v[24:27], a[96:99], v[64:67], v[48:51]
    s_sub_u32 s48, 0, s48
    v_exp_f32 v16, v16
    v_mfma_f32_16x16x32_bf16 v[24:27], a[100:103], v[68:71], v[24:27]
    v_cvt_pk_bf16_f32 v47, v30, v31
    v_mfma_f32_16x16x32_bf16 v[24:27], a[104:107], v[72:75], v[24:27]
    s_add_u32 m0, s44, 73536
    v_exp_f32 v17, v17
    v_mfma_f32_16x16x32_bf16 v[24:27], a[108:111], v[76:79], v[24:27]
    s_waitcnt lgkmcnt(0)
    buffer_load_dwordx4 v7, s[28:31], s45 offen offset:2304 lds
    v_mfma_f32_16x16x32_bf16 v[28:31], a[112:115], v[64:67], v[48:51]
    v_exp_f32 v18, v18
    v_mfma_f32_16x16x32_bf16 v[28:31], a[116:119], v[68:71], v[28:31]
    v_cvt_pk_bf16_f32 v32, v16, v17
    v_mfma_f32_16x16x32_bf16 v[28:31], a[120:123], v[72:75], v[28:31]
    s_add_u32 m0, s44, 73440
    v_exp_f32 v19, v19
    v_mfma_f32_16x16x32_bf16 v[28:31], a[124:127], v[76:79], v[28:31]
    buffer_load_dwordx4 v7, s[28:31], s45 offen offset:3456 lds
    v_mfma_f32_16x16x32_bf16 v[224:227], a[128:131], v[40:43], v[224:227]
    v_exp_f32 v20, v20
    v_mfma_f32_16x16x32_bf16 v[224:227], a[132:135], v[44:47], v[224:227]
    ds_read_b64_tr_b16 a[128:129], v2 offset:0
    v_cvt_pk_bf16_f32 v33, v18, v19
    v_mfma_f32_16x16x32_bf16 v[228:231], a[136:139], v[40:43], v[228:231]
    s_add_u32 m0, s44, 90624
    v_exp_f32 v21, v21
    v_mfma_f32_16x16x32_bf16 v[228:231], a[140:143], v[44:47], v[228:231]
    s_mov_b32 s45, 147456
    buffer_load_dwordx4 v7, s[28:31], s45 offen offset:0 lds
    v_mfma_f32_16x16x32_bf16 v[232:235], a[144:147], v[40:43], v[232:235]
    v_exp_f32 v22, v22
    v_mfma_f32_16x16x32_bf16 v[232:235], a[148:151], v[44:47], v[232:235]
    ds_read_b64_tr_b16 a[130:131], v2 offset:256
    v_cvt_pk_bf16_f32 v34, v20, v21
    v_mfma_f32_16x16x32_bf16 v[236:239], a[152:155], v[40:43], v[236:239]
    s_add_u32 m0, s44, 90528
    v_exp_f32 v23, v23
    v_mfma_f32_16x16x32_bf16 v[236:239], a[156:159], v[44:47], v[236:239]
    buffer_load_dwordx4 v7, s[28:31], s45 offen offset:1152 lds
    v_mfma_f32_16x16x32_bf16 v[240:243], a[160:163], v[40:43], v[240:243]
    v_exp_f32 v24, v24
    v_mfma_f32_16x16x32_bf16 v[240:243], a[164:167], v[44:47], v[240:243]
    ds_read_b64_tr_b16 a[132:133], v2 offset:512
    v_cvt_pk_bf16_f32 v35, v22, v23
    v_mfma_f32_16x16x32_bf16 v[244:247], a[168:171], v[40:43], v[244:247]
    s_add_u32 m0, s44, 90432
    v_exp_f32 v25, v25
    v_mfma_f32_16x16x32_bf16 v[244:247], a[172:175], v[44:47], v[244:247]
    buffer_load_dwordx4 v7, s[28:31], s45 offen offset:2304 lds
    v_mfma_f32_16x16x32_bf16 v[248:251], a[176:179], v[40:43], v[248:251]
    v_exp_f32 v26, v26
    v_mfma_f32_16x16x32_bf16 v[248:251], a[180:183], v[44:47], v[248:251]
    ds_read_b64_tr_b16 a[134:135], v2 offset:768
    v_cvt_pk_bf16_f32 v36, v24, v25
    v_mfma_f32_16x16x32_bf16 v[252:255], a[184:187], v[40:43], v[252:255]
    s_add_u32 m0, s44, 90336
    v_exp_f32 v27, v27
    v_mfma_f32_16x16x32_bf16 v[252:255], a[188:191], v[44:47], v[252:255]
    buffer_load_dwordx4 v7, s[28:31], s45 offen offset:3456 lds
    v_smfmac_f32_16x16x64_bf16 a[12:15], a[16:19], v[40:47], v11
    ds_read_b64_tr_b16 a[136:137], v2 offset:32
    v_mfma_f32_16x16x32_bf16 v[16:19], a[64:67], v[80:83], v[52:55]
    v_exp_f32 v28, v28
    v_mfma_f32_16x16x32_bf16 v[16:19], a[68:71], v[84:87], v[16:19]
    ds_read_b64_tr_b16 a[138:139], v2 offset:288
    v_cvt_pk_bf16_f32 v37, v26, v27
    v_mfma_f32_16x16x32_bf16 v[16:19], a[72:75], v[88:91], v[16:19]
    v_exp_f32 v29, v29
    v_mfma_f32_16x16x32_bf16 v[16:19], a[76:79], v[92:95], v[16:19]
    ds_read_b64_tr_b16 a[140:141], v2 offset:544
    v_mfma_f32_16x16x32_bf16 v[20:23], a[80:83], v[80:83], v[52:55]
    v_exp_f32 v30, v30
    v_mfma_f32_16x16x32_bf16 v[20:23], a[84:87], v[84:87], v[20:23]
    ds_read_b64_tr_b16 a[142:143], v2 offset:800
    v_cvt_pk_bf16_f32 v38, v28, v29
    v_mfma_f32_16x16x32_bf16 v[20:23], a[88:91], v[88:91], v[20:23]
    v_exp_f32 v31, v31
    v_mfma_f32_16x16x32_bf16 v[20:23], a[92:95], v[92:95], v[20:23]
    ds_read_b64_tr_b16 a[144:145], v2 offset:64
    v_mfma_f32_16x16x32_bf16 v[24:27], a[96:99], v[80:83], v[52:55]
    v_exp_f32 v16, v16
    v_mfma_f32_16x16x32_bf16 v[24:27], a[100:103], v[84:87], v[24:27]
    ds_read_b64_tr_b16 a[146:147], v2 offset:320
    v_cvt_pk_bf16_f32 v39, v30, v31
    v_mfma_f32_16x16x32_bf16 v[24:27], a[104:107], v[88:91], v[24:27]
    v_exp_f32 v17, v17
    v_mfma_f32_16x16x32_bf16 v[24:27], a[108:111], v[92:95], v[24:27]
    ds_read_b64_tr_b16 a[148:149], v2 offset:576
    v_mfma_f32_16x16x32_bf16 v[28:31], a[112:115], v[80:83], v[52:55]
    v_exp_f32 v18, v18
    v_mfma_f32_16x16x32_bf16 v[28:31], a[116:119], v[84:87], v[28:31]
    ds_read_b64_tr_b16 a[150:151], v2 offset:832
    v_cvt_pk_bf16_f32 v40, v16, v17
    v_mfma_f32_16x16x32_bf16 v[28:31], a[120:123], v[88:91], v[28:31]
    v_exp_f32 v19, v19
    v_mfma_f32_16x16x32_bf16 v[28:31], a[124:127], v[92:95], v[28:31]
    ds_read_b64_tr_b16 a[152:153], v2 offset:96
    v_mfma_f32_16x16x32_bf16 v[128:131], a[192:195], v[32:35], v[128:131]
    v_exp_f32 v20, v20
    v_mfma_f32_16x16x32_bf16 v[128:131], a[196:199], v[36:39], v[128:131]
    ds_read_b64_tr_b16 a[154:155], v2 offset:352
    v_cvt_pk_bf16_f32 v41, v18, v19
    v_mfma_f32_16x16x32_bf16 v[132:135], a[200:203], v[32:35], v[132:135]
    v_exp_f32 v21, v21
    v_mfma_f32_16x16x32_bf16 v[132:135], a[204:207], v[36:39], v[132:135]
    ds_read_b64_tr_b16 a[156:157], v2 offset:608
    v_mfma_f32_16x16x32_bf16 v[136:139], a[208:211], v[32:35], v[136:139]
    v_exp_f32 v22, v22
    v_mfma_f32_16x16x32_bf16 v[136:139], a[212:215], v[36:39], v[136:139]
    ds_read_b64_tr_b16 a[158:159], v2 offset:864
    v_cvt_pk_bf16_f32 v42, v20, v21
    v_mfma_f32_16x16x32_bf16 v[140:143], a[216:219], v[32:35], v[140:143]
    v_exp_f32 v23, v23
    v_mfma_f32_16x16x32_bf16 v[140:143], a[220:223], v[36:39], v[140:143]
    ds_read_b64_tr_b16 a[160:161], v2 offset:128
    v_mfma_f32_16x16x32_bf16 v[144:147], a[224:227], v[32:35], v[144:147]
    v_exp_f32 v24, v24
    v_mfma_f32_16x16x32_bf16 v[144:147], a[228:231], v[36:39], v[144:147]
    ds_read_b64_tr_b16 a[162:163], v2 offset:384
    v_cvt_pk_bf16_f32 v43, v22, v23
    v_mfma_f32_16x16x32_bf16 v[148:151], a[232:235], v[32:35], v[148:151]
    v_exp_f32 v25, v25
    v_mfma_f32_16x16x32_bf16 v[148:151], a[236:239], v[36:39], v[148:151]
    ds_read_b64_tr_b16 a[164:165], v2 offset:640
    v_mfma_f32_16x16x32_bf16 v[152:155], a[240:243], v[32:35], v[152:155]
    v_exp_f32 v26, v26
    v_mfma_f32_16x16x32_bf16 v[152:155], a[244:247], v[36:39], v[152:155]
    ds_read_b64_tr_b16 a[166:167], v2 offset:896
    v_cvt_pk_bf16_f32 v44, v24, v25
    v_mfma_f32_16x16x32_bf16 v[156:159], a[248:251], v[32:35], v[156:159]
    v_exp_f32 v27, v27
    v_mfma_f32_16x16x32_bf16 v[156:159], a[252:255], v[36:39], v[156:159]
    ds_read_b64_tr_b16 a[168:169], v2 offset:160
    v_smfmac_f32_16x16x64_bf16 a[0:3], a[16:19], v[32:39], v11
    ds_read_b64_tr_b16 a[170:171], v2 offset:416
    v_mfma_f32_16x16x32_bf16 v[16:19], a[64:67], v[96:99], v[56:59]
    v_exp_f32 v28, v28
    v_mfma_f32_16x16x32_bf16 v[16:19], a[68:71], v[100:103], v[16:19]
    ds_read_b64_tr_b16 a[172:173], v2 offset:672
    v_cvt_pk_bf16_f32 v45, v26, v27
    v_mfma_f32_16x16x32_bf16 v[16:19], a[72:75], v[104:107], v[16:19]
    v_exp_f32 v29, v29
    v_mfma_f32_16x16x32_bf16 v[16:19], a[76:79], v[108:111], v[16:19]
    ds_read_b64_tr_b16 a[174:175], v2 offset:928
    v_mfma_f32_16x16x32_bf16 v[20:23], a[80:83], v[96:99], v[56:59]
    v_exp_f32 v30, v30
    v_mfma_f32_16x16x32_bf16 v[20:23], a[84:87], v[100:103], v[20:23]
    ds_read_b64_tr_b16 a[176:177], v2 offset:192
    v_cvt_pk_bf16_f32 v46, v28, v29
    v_mfma_f32_16x16x32_bf16 v[20:23], a[88:91], v[104:107], v[20:23]
    v_exp_f32 v31, v31
    v_mfma_f32_16x16x32_bf16 v[20:23], a[92:95], v[108:111], v[20:23]
    ds_read_b64_tr_b16 a[178:179], v2 offset:448
    v_mfma_f32_16x16x32_bf16 v[24:27], a[96:99], v[96:99], v[56:59]
    v_exp_f32 v16, v16
    v_mfma_f32_16x16x32_bf16 v[24:27], a[100:103], v[100:103], v[24:27]
    ds_read_b64_tr_b16 a[180:181], v2 offset:704
    v_cvt_pk_bf16_f32 v47, v30, v31
    v_mfma_f32_16x16x32_bf16 v[24:27], a[104:107], v[104:107], v[24:27]
    v_exp_f32 v17, v17
    v_mfma_f32_16x16x32_bf16 v[24:27], a[108:111], v[108:111], v[24:27]
    ds_read_b64_tr_b16 a[182:183], v2 offset:960
    v_mfma_f32_16x16x32_bf16 v[28:31], a[112:115], v[96:99], v[56:59]
    v_exp_f32 v18, v18
    v_mfma_f32_16x16x32_bf16 v[28:31], a[116:119], v[100:103], v[28:31]
    ds_read_b64_tr_b16 a[184:185], v2 offset:224
    v_cvt_pk_bf16_f32 v32, v16, v17
    v_mfma_f32_16x16x32_bf16 v[28:31], a[120:123], v[104:107], v[28:31]
    v_exp_f32 v19, v19
    v_mfma_f32_16x16x32_bf16 v[28:31], a[124:127], v[108:111], v[28:31]
    ds_read_b64_tr_b16 a[186:187], v2 offset:480
    v_mfma_f32_16x16x32_bf16 v[160:163], a[192:195], v[40:43], v[160:163]
    v_exp_f32 v20, v20
    v_mfma_f32_16x16x32_bf16 v[160:163], a[196:199], v[44:47], v[160:163]
    ds_read_b64_tr_b16 a[188:189], v2 offset:736
    v_cvt_pk_bf16_f32 v33, v18, v19
    v_mfma_f32_16x16x32_bf16 v[164:167], a[200:203], v[40:43], v[164:167]
    v_exp_f32 v21, v21
    v_mfma_f32_16x16x32_bf16 v[164:167], a[204:207], v[44:47], v[164:167]
    ds_read_b64_tr_b16 a[190:191], v2 offset:992
    v_mfma_f32_16x16x32_bf16 v[168:171], a[208:211], v[40:43], v[168:171]
    v_exp_f32 v22, v22
    v_mfma_f32_16x16x32_bf16 v[168:171], a[212:215], v[44:47], v[168:171]
    v_cvt_pk_bf16_f32 v34, v20, v21
    v_mfma_f32_16x16x32_bf16 v[172:175], a[216:219], v[40:43], v[172:175]
    v_exp_f32 v23, v23
    v_mfma_f32_16x16x32_bf16 v[172:175], a[220:223], v[44:47], v[172:175]
    v_mfma_f32_16x16x32_bf16 v[176:179], a[224:227], v[40:43], v[176:179]
    v_exp_f32 v24, v24
    v_mfma_f32_16x16x32_bf16 v[176:179], a[228:231], v[44:47], v[176:179]
    v_cvt_pk_bf16_f32 v35, v22, v23
    v_mfma_f32_16x16x32_bf16 v[180:183], a[232:235], v[40:43], v[180:183]
    v_exp_f32 v25, v25
    v_mfma_f32_16x16x32_bf16 v[180:183], a[236:239], v[44:47], v[180:183]
    v_mfma_f32_16x16x32_bf16 v[184:187], a[240:243], v[40:43], v[184:187]
    v_exp_f32 v26, v26
    v_mfma_f32_16x16x32_bf16 v[184:187], a[244:247], v[44:47], v[184:187]
    v_cvt_pk_bf16_f32 v36, v24, v25
    v_mfma_f32_16x16x32_bf16 v[188:191], a[248:251], v[40:43], v[188:191]
    v_exp_f32 v27, v27
    v_mfma_f32_16x16x32_bf16 v[188:191], a[252:255], v[44:47], v[188:191]
    v_smfmac_f32_16x16x64_bf16 a[4:7], a[16:19], v[40:47], v11
    v_mfma_f32_16x16x32_bf16 v[16:19], a[64:67], v[112:115], v[60:63]
    v_exp_f32 v28, v28
    v_mfma_f32_16x16x32_bf16 v[16:19], a[68:71], v[116:119], v[16:19]
    s_add_u32 s46, s46, 16384
    ds_read_b128 a[64:67], v1 offset:0
    v_cvt_pk_bf16_f32 v37, v26, v27
    v_mfma_f32_16x16x32_bf16 v[16:19], a[72:75], v[120:123], v[16:19]
    v_exp_f32 v29, v29
    v_mfma_f32_16x16x32_bf16 v[16:19], a[76:79], v[124:127], v[16:19]
    ds_read_b128 a[68:71], v1 offset:64
    v_mfma_f32_16x16x32_bf16 v[20:23], a[80:83], v[112:115], v[60:63]
    v_exp_f32 v30, v30
    v_mfma_f32_16x16x32_bf16 v[20:23], a[84:87], v[116:119], v[20:23]
    ds_read_b128 a[72:75], v1 offset:128
    v_cvt_pk_bf16_f32 v38, v28, v29
    v_mfma_f32_16x16x32_bf16 v[20:23], a[88:91], v[120:123], v[20:23]
    v_exp_f32 v31, v31
    v_mfma_f32_16x16x32_bf16 v[20:23], a[92:95], v[124:127], v[20:23]
    ds_read_b128 a[76:79], v1 offset:192
    v_mfma_f32_16x16x32_bf16 v[24:27], a[96:99], v[112:115], v[60:63]
    v_exp_f32 v16, v16
    v_mfma_f32_16x16x32_bf16 v[24:27], a[100:103], v[116:119], v[24:27]
    ds_read_b128 a[80:83], v1 offset:256
    v_cvt_pk_bf16_f32 v39, v30, v31
    v_mfma_f32_16x16x32_bf16 v[24:27], a[104:107], v[120:123], v[24:27]
    v_exp_f32 v17, v17
    v_mfma_f32_16x16x32_bf16 v[24:27], a[108:111], v[124:127], v[24:27]
    ds_read_b128 a[84:87], v1 offset:320
    v_mfma_f32_16x16x32_bf16 v[28:31], a[112:115], v[112:115], v[60:63]
    v_exp_f32 v18, v18
    v_mfma_f32_16x16x32_bf16 v[28:31], a[116:119], v[116:119], v[28:31]
    ds_read_b128 a[88:91], v1 offset:384
    v_cvt_pk_bf16_f32 v40, v16, v17
    v_mfma_f32_16x16x32_bf16 v[28:31], a[120:123], v[120:123], v[28:31]
    v_exp_f32 v19, v19
    v_mfma_f32_16x16x32_bf16 v[28:31], a[124:127], v[124:127], v[28:31]
    ds_read_b128 a[92:95], v1 offset:448
    v_mfma_f32_16x16x32_bf16 v[192:195], a[192:195], v[32:35], v[192:195]
    v_exp_f32 v20, v20
    v_mfma_f32_16x16x32_bf16 v[192:195], a[196:199], v[36:39], v[192:195]
    ds_read_b128 a[96:99], v1 offset:512
    v_cvt_pk_bf16_f32 v41, v18, v19
    v_mfma_f32_16x16x32_bf16 v[196:199], a[200:203], v[32:35], v[196:199]
    v_exp_f32 v21, v21
    v_mfma_f32_16x16x32_bf16 v[196:199], a[204:207], v[36:39], v[196:199]
    ds_read_b128 a[100:103], v1 offset:576
    v_mfma_f32_16x16x32_bf16 v[200:203], a[208:211], v[32:35], v[200:203]
    v_exp_f32 v22, v22
    v_mfma_f32_16x16x32_bf16 v[200:203], a[212:215], v[36:39], v[200:203]
    ds_read_b128 a[104:107], v1 offset:640
    v_cvt_pk_bf16_f32 v42, v20, v21
    v_mfma_f32_16x16x32_bf16 v[204:207], a[216:219], v[32:35], v[204:207]
    v_exp_f32 v23, v23
    v_mfma_f32_16x16x32_bf16 v[204:207], a[220:223], v[36:39], v[204:207]
    ds_read_b128 a[108:111], v1 offset:704
    v_mfma_f32_16x16x32_bf16 v[208:211], a[224:227], v[32:35], v[208:211]
    v_exp_f32 v24, v24
    v_mfma_f32_16x16x32_bf16 v[208:211], a[228:231], v[36:39], v[208:211]
    ds_read_b128 a[112:115], v1 offset:768
    v_cvt_pk_bf16_f32 v43, v22, v23
    v_mfma_f32_16x16x32_bf16 v[212:215], a[232:235], v[32:35], v[212:215]
    v_exp_f32 v25, v25
    v_mfma_f32_16x16x32_bf16 v[212:215], a[236:239], v[36:39], v[212:215]
    ds_read_b128 a[116:119], v1 offset:832
    v_mfma_f32_16x16x32_bf16 v[216:219], a[240:243], v[32:35], v[216:219]
    v_exp_f32 v26, v26
    v_mfma_f32_16x16x32_bf16 v[216:219], a[244:247], v[36:39], v[216:219]
    ds_read_b128 a[120:123], v1 offset:896
    v_cvt_pk_bf16_f32 v44, v24, v25
    v_mfma_f32_16x16x32_bf16 v[220:223], a[248:251], v[32:35], v[220:223]
    v_exp_f32 v27, v27
    v_mfma_f32_16x16x32_bf16 v[220:223], a[252:255], v[36:39], v[220:223]
    ds_read_b128 a[124:127], v1 offset:960
    v_smfmac_f32_16x16x64_bf16 a[8:11], a[16:19], v[32:39], v11
    s_waitcnt vmcnt(9) lgkmcnt(12)
    s_barrier
    v_mfma_f32_16x16x32_bf16 v[16:19], a[64:67], v[64:67], v[48:51]
    v_exp_f32 v28, v28
    v_mfma_f32_16x16x32_bf16 v[16:19], a[68:71], v[68:71], v[16:19]
    v_cvt_pk_bf16_f32 v45, v26, v27
    v_mfma_f32_16x16x32_bf16 v[16:19], a[72:75], v[72:75], v[16:19]
    s_add_u32 m0, s44, 110592
    v_exp_f32 v29, v29
    v_mfma_f32_16x16x32_bf16 v[16:19], a[76:79], v[76:79], v[16:19]
    s_waitcnt lgkmcnt(8)
    s_mov_b32 s45, 128
    buffer_load_dwordx4 v7, s[28:31], s45 offen offset:0 lds
    v_mfma_f32_16x16x32_bf16 v[20:23], a[80:83], v[64:67], v[48:51]
    v_exp_f32 v30, v30
    v_mfma_f32_16x16x32_bf16 v[20:23], a[84:87], v[68:71], v[20:23]
    v_cvt_pk_bf16_f32 v46, v28, v29
    v_mfma_f32_16x16x32_bf16 v[20:23], a[88:91], v[72:75], v[20:23]
    s_add_u32 m0, s44, 110496
    v_exp_f32 v31, v31
    v_mfma_f32_16x16x32_bf16 v[20:23], a[92:95], v[76:79], v[20:23]
    s_waitcnt lgkmcnt(4)
    buffer_load_dwordx4 v7, s[28:31], s45 offen offset:1152 lds
    v_mfma_f32_16x16x32_bf16 v[24:27], a[96:99], v[64:67], v[48:51]
    v_exp_f32 v16, v16
    v_mfma_f32_16x16x32_bf16 v[24:27], a[100:103], v[68:71], v[24:27]
    v_cvt_pk_bf16_f32 v47, v30, v31
    v_mfma_f32_16x16x32_bf16 v[24:27], a[104:107], v[72:75], v[24:27]
    s_add_u32 m0, s44, 110400
    v_exp_f32 v17, v17
    v_mfma_f32_16x16x32_bf16 v[24:27], a[108:111], v[76:79], v[24:27]
    s_waitcnt lgkmcnt(0)
    buffer_load_dwordx4 v7, s[28:31], s45 offen offset:2304 lds
    v_mfma_f32_16x16x32_bf16 v[28:31], a[112:115], v[64:67], v[48:51]
    v_exp_f32 v18, v18
    v_mfma_f32_16x16x32_bf16 v[28:31], a[116:119], v[68:71], v[28:31]
    v_cvt_pk_bf16_f32 v32, v16, v17
    v_mfma_f32_16x16x32_bf16 v[28:31], a[120:123], v[72:75], v[28:31]
    s_add_u32 m0, s44, 110304
    v_exp_f32 v19, v19
    v_mfma_f32_16x16x32_bf16 v[28:31], a[124:127], v[76:79], v[28:31]
    buffer_load_dwordx4 v7, s[28:31], s45 offen offset:3456 lds
    v_mfma_f32_16x16x32_bf16 v[224:227], a[192:195], v[40:43], v[224:227]
    v_exp_f32 v20, v20
    v_mfma_f32_16x16x32_bf16 v[224:227], a[196:199], v[44:47], v[224:227]
    ds_read_b64_tr_b16 a[192:193], v2 offset:36864
    v_cvt_pk_bf16_f32 v33, v18, v19
    v_mfma_f32_16x16x32_bf16 v[228:231], a[200:203], v[40:43], v[228:231]
    s_add_u32 m0, s44, 127488
    v_exp_f32 v21, v21
    v_mfma_f32_16x16x32_bf16 v[228:231], a[204:207], v[44:47], v[228:231]
    s_mov_b32 s45, 147584
    buffer_load_dwordx4 v7, s[28:31], s45 offen offset:0 lds
    v_mfma_f32_16x16x32_bf16 v[232:235], a[208:211], v[40:43], v[232:235]
    v_exp_f32 v22, v22
    v_mfma_f32_16x16x32_bf16 v[232:235], a[212:215], v[44:47], v[232:235]
    ds_read_b64_tr_b16 a[194:195], v2 offset:37120
    v_cvt_pk_bf16_f32 v34, v20, v21
    v_mfma_f32_16x16x32_bf16 v[236:239], a[216:219], v[40:43], v[236:239]
    s_add_u32 m0, s44, 127392
    v_exp_f32 v23, v23
    v_mfma_f32_16x16x32_bf16 v[236:239], a[220:223], v[44:47], v[236:239]
    buffer_load_dwordx4 v7, s[28:31], s45 offen offset:1152 lds
    v_mfma_f32_16x16x32_bf16 v[240:243], a[224:227], v[40:43], v[240:243]
    v_exp_f32 v24, v24
    v_mfma_f32_16x16x32_bf16 v[240:243], a[228:231], v[44:47], v[240:243]
    ds_read_b64_tr_b16 a[196:197], v2 offset:37376
    v_cvt_pk_bf16_f32 v35, v22, v23
    v_mfma_f32_16x16x32_bf16 v[244:247], a[232:235], v[40:43], v[244:247]
    s_add_u32 m0, s44, 127296
    v_exp_f32 v25, v25
    v_mfma_f32_16x16x32_bf16 v[244:247], a[236:239], v[44:47], v[244:247]
    buffer_load_dwordx4 v7, s[28:31], s45 offen offset:2304 lds
    v_mfma_f32_16x16x32_bf16 v[248:251], a[240:243], v[40:43], v[248:251]
    v_exp_f32 v26, v26
    v_mfma_f32_16x16x32_bf16 v[248:251], a[244:247], v[44:47], v[248:251]
    ds_read_b64_tr_b16 a[198:199], v2 offset:37632
    v_cvt_pk_bf16_f32 v36, v24, v25
    v_mfma_f32_16x16x32_bf16 v[252:255], a[248:251], v[40:43], v[252:255]
    s_add_u32 m0, s44, 127200
    v_exp_f32 v27, v27
    v_mfma_f32_16x16x32_bf16 v[252:255], a[252:255], v[44:47], v[252:255]
    buffer_load_dwordx4 v7, s[28:31], s45 offen offset:3456 lds
    v_smfmac_f32_16x16x64_bf16 a[12:15], a[16:19], v[40:47], v11
    ds_read_b64_tr_b16 a[200:201], v2 offset:36896
    v_mfma_f32_16x16x32_bf16 v[16:19], a[64:67], v[80:83], v[52:55]
    v_exp_f32 v28, v28
    v_mfma_f32_16x16x32_bf16 v[16:19], a[68:71], v[84:87], v[16:19]
    ds_read_b64_tr_b16 a[202:203], v2 offset:37152
    v_cvt_pk_bf16_f32 v37, v26, v27
    v_mfma_f32_16x16x32_bf16 v[16:19], a[72:75], v[88:91], v[16:19]
    v_exp_f32 v29, v29
    v_mfma_f32_16x16x32_bf16 v[16:19], a[76:79], v[92:95], v[16:19]
    ds_read_b64_tr_b16 a[204:205], v2 offset:37408
    v_mfma_f32_16x16x32_bf16 v[20:23], a[80:83], v[80:83], v[52:55]
    v_exp_f32 v30, v30
    v_mfma_f32_16x16x32_bf16 v[20:23], a[84:87], v[84:87], v[20:23]
    ds_read_b64_tr_b16 a[206:207], v2 offset:37664
    v_cvt_pk_bf16_f32 v38, v28, v29
    v_mfma_f32_16x16x32_bf16 v[20:23], a[88:91], v[88:91], v[20:23]
    v_exp_f32 v31, v31
    v_mfma_f32_16x16x32_bf16 v[20:23], a[92:95], v[92:95], v[20:23]
    ds_read_b64_tr_b16 a[208:209], v2 offset:36928
    v_mfma_f32_16x16x32_bf16 v[24:27], a[96:99], v[80:83], v[52:55]
    v_exp_f32 v16, v16
    v_mfma_f32_16x16x32_bf16 v[24:27], a[100:103], v[84:87], v[24:27]
    ds_read_b64_tr_b16 a[210:211], v2 offset:37184
    v_cvt_pk_bf16_f32 v39, v30, v31
    v_mfma_f32_16x16x32_bf16 v[24:27], a[104:107], v[88:91], v[24:27]
    v_exp_f32 v17, v17
    v_mfma_f32_16x16x32_bf16 v[24:27], a[108:111], v[92:95], v[24:27]
    ds_read_b64_tr_b16 a[212:213], v2 offset:37440
    v_mfma_f32_16x16x32_bf16 v[28:31], a[112:115], v[80:83], v[52:55]
    v_exp_f32 v18, v18
    v_mfma_f32_16x16x32_bf16 v[28:31], a[116:119], v[84:87], v[28:31]
    ds_read_b64_tr_b16 a[214:215], v2 offset:37696
    v_cvt_pk_bf16_f32 v40, v16, v17
    v_mfma_f32_16x16x32_bf16 v[28:31], a[120:123], v[88:91], v[28:31]
    v_exp_f32 v19, v19
    v_mfma_f32_16x16x32_bf16 v[28:31], a[124:127], v[92:95], v[28:31]
    ds_read_b64_tr_b16 a[216:217], v2 offset:36960
    v_mfma_f32_16x16x32_bf16 v[128:131], a[128:131], v[32:35], v[128:131]
    v_exp_f32 v20, v20
    v_mfma_f32_16x16x32_bf16 v[128:131], a[132:135], v[36:39], v[128:131]
    ds_read_b64_tr_b16 a[218:219], v2 offset:37216
    v_cvt_pk_bf16_f32 v41, v18, v19
    v_mfma_f32_16x16x32_bf16 v[132:135], a[136:139], v[32:35], v[132:135]
    v_exp_f32 v21, v21
    v_mfma_f32_16x16x32_bf16 v[132:135], a[140:143], v[36:39], v[132:135]
    ds_read_b64_tr_b16 a[220:221], v2 offset:37472
    v_mfma_f32_16x16x32_bf16 v[136:139], a[144:147], v[32:35], v[136:139]
    v_exp_f32 v22, v22
    v_mfma_f32_16x16x32_bf16 v[136:139], a[148:151], v[36:39], v[136:139]
    ds_read_b64_tr_b16 a[222:223], v2 offset:37728
    v_cvt_pk_bf16_f32 v42, v20, v21
    v_mfma_f32_16x16x32_bf16 v[140:143], a[152:155], v[32:35], v[140:143]
    v_exp_f32 v23, v23
    v_mfma_f32_16x16x32_bf16 v[140:143], a[156:159], v[36:39], v[140:143]
    ds_read_b64_tr_b16 a[224:225], v2 offset:36992
    v_mfma_f32_16x16x32_bf16 v[144:147], a[160:163], v[32:35], v[144:147]
    v_exp_f32 v24, v24
    v_mfma_f32_16x16x32_bf16 v[144:147], a[164:167], v[36:39], v[144:147]
    ds_read_b64_tr_b16 a[226:227], v2 offset:37248
    v_cvt_pk_bf16_f32 v43, v22, v23
    v_mfma_f32_16x16x32_bf16 v[148:151], a[168:171], v[32:35], v[148:151]
    v_exp_f32 v25, v25
    v_mfma_f32_16x16x32_bf16 v[148:151], a[172:175], v[36:39], v[148:151]
    ds_read_b64_tr_b16 a[228:229], v2 offset:37504
    v_mfma_f32_16x16x32_bf16 v[152:155], a[176:179], v[32:35], v[152:155]
    v_exp_f32 v26, v26
    v_mfma_f32_16x16x32_bf16 v[152:155], a[180:183], v[36:39], v[152:155]
    ds_read_b64_tr_b16 a[230:231], v2 offset:37760
    v_cvt_pk_bf16_f32 v44, v24, v25
    v_mfma_f32_16x16x32_bf16 v[156:159], a[184:187], v[32:35], v[156:159]
    v_exp_f32 v27, v27
    v_mfma_f32_16x16x32_bf16 v[156:159], a[188:191], v[36:39], v[156:159]
    ds_read_b64_tr_b16 a[232:233], v2 offset:37024
    v_smfmac_f32_16x16x64_bf16 a[0:3], a[16:19], v[32:39], v11
    ds_read_b64_tr_b16 a[234:235], v2 offset:37280
    v_mfma_f32_16x16x32_bf16 v[16:19], a[64:67], v[96:99], v[56:59]
    v_exp_f32 v28, v28
    v_mfma_f32_16x16x32_bf16 v[16:19], a[68:71], v[100:103], v[16:19]
    ds_read_b64_tr_b16 a[236:237], v2 offset:37536
    v_cvt_pk_bf16_f32 v45, v26, v27
    v_mfma_f32_16x16x32_bf16 v[16:19], a[72:75], v[104:107], v[16:19]
    v_exp_f32 v29, v29
    v_mfma_f32_16x16x32_bf16 v[16:19], a[76:79], v[108:111], v[16:19]
    ds_read_b64_tr_b16 a[238:239], v2 offset:37792
    v_mfma_f32_16x16x32_bf16 v[20:23], a[80:83], v[96:99], v[56:59]
    v_exp_f32 v30, v30
    v_mfma_f32_16x16x32_bf16 v[20:23], a[84:87], v[100:103], v[20:23]
    ds_read_b64_tr_b16 a[240:241], v2 offset:37056
    v_cvt_pk_bf16_f32 v46, v28, v29
    v_mfma_f32_16x16x32_bf16 v[20:23], a[88:91], v[104:107], v[20:23]
    v_exp_f32 v31, v31
    v_mfma_f32_16x16x32_bf16 v[20:23], a[92:95], v[108:111], v[20:23]
    ds_read_b64_tr_b16 a[242:243], v2 offset:37312
    v_mfma_f32_16x16x32_bf16 v[24:27], a[96:99], v[96:99], v[56:59]
    v_exp_f32 v16, v16
    v_mfma_f32_16x16x32_bf16 v[24:27], a[100:103], v[100:103], v[24:27]
    ds_read_b64_tr_b16 a[244:245], v2 offset:37568
    v_cvt_pk_bf16_f32 v47, v30, v31
    v_mfma_f32_16x16x32_bf16 v[24:27], a[104:107], v[104:107], v[24:27]
    v_exp_f32 v17, v17
    v_mfma_f32_16x16x32_bf16 v[24:27], a[108:111], v[108:111], v[24:27]
    ds_read_b64_tr_b16 a[246:247], v2 offset:37824
    v_mfma_f32_16x16x32_bf16 v[28:31], a[112:115], v[96:99], v[56:59]
    v_exp_f32 v18, v18
    v_mfma_f32_16x16x32_bf16 v[28:31], a[116:119], v[100:103], v[28:31]
    ds_read_b64_tr_b16 a[248:249], v2 offset:37088
    v_cvt_pk_bf16_f32 v32, v16, v17
    v_mfma_f32_16x16x32_bf16 v[28:31], a[120:123], v[104:107], v[28:31]
    v_exp_f32 v19, v19
    v_mfma_f32_16x16x32_bf16 v[28:31], a[124:127], v[108:111], v[28:31]
    ds_read_b64_tr_b16 a[250:251], v2 offset:37344
    v_mfma_f32_16x16x32_bf16 v[160:163], a[128:131], v[40:43], v[160:163]
    v_exp_f32 v20, v20
    v_mfma_f32_16x16x32_bf16 v[160:163], a[132:135], v[44:47], v[160:163]
    ds_read_b64_tr_b16 a[252:253], v2 offset:37600
    v_cvt_pk_bf16_f32 v33, v18, v19
    v_mfma_f32_16x16x32_bf16 v[164:167], a[136:139], v[40:43], v[164:167]
L2_pad8:
    s_cbranch_execz L2_pad12
    v_exp_f32 v21, v21
    v_mfma_f32_16x16x32_bf16 v[164:167], a[140:143], v[44:47], v[164:167]
    ds_read_b64_tr_b16 a[254:255], v2 offset:37856
    v_mfma_f32_16x16x32_bf16 v[168:171], a[144:147], v[40:43], v[168:171]
    v_exp_f32 v22, v22
    v_mfma_f32_16x16x32_bf16 v[168:171], a[148:151], v[44:47], v[168:171]
    v_cvt_pk_bf16_f32 v34, v20, v21
    v_mfma_f32_16x16x32_bf16 v[172:175], a[152:155], v[40:43], v[172:175]
    v_exp_f32 v23, v23
    v_mfma_f32_16x16x32_bf16 v[172:175], a[156:159], v[44:47], v[172:175]
    v_mfma_f32_16x16x32_bf16 v[176:179], a[160:163], v[40:43], v[176:179]
    v_exp_f32 v24, v24
    v_mfma_f32_16x16x32_bf16 v[176:179], a[164:167], v[44:47], v[176:179]
    v_cvt_pk_bf16_f32 v35, v22, v23
    v_mfma_f32_16x16x32_bf16 v[180:183], a[168:171], v[40:43], v[180:183]
    v_exp_f32 v25, v25
    v_mfma_f32_16x16x32_bf16 v[180:183], a[172:175], v[44:47], v[180:183]
    v_mfma_f32_16x16x32_bf16 v[184:187], a[176:179], v[40:43], v[184:187]
    v_exp_f32 v26, v26
    v_mfma_f32_16x16x32_bf16 v[184:187], a[180:183], v[44:47], v[184:187]
    v_cvt_pk_bf16_f32 v36, v24, v25
    v_mfma_f32_16x16x32_bf16 v[188:191], a[184:187], v[40:43], v[188:191]
    v_exp_f32 v27, v27
    v_mfma_f32_16x16x32_bf16 v[188:191], a[188:191], v[44:47], v[188:191]
    v_smfmac_f32_16x16x64_bf16 a[4:7], a[16:19], v[40:47], v11
    v_mfma_f32_16x16x32_bf16 v[16:19], a[64:67], v[112:115], v[60:63]
    v_exp_f32 v28, v28
    v_mfma_f32_16x16x32_bf16 v[16:19], a[68:71], v[116:119], v[16:19]
    s_add_u32 s46, s46, 16384
    ds_read_b128 a[64:67], v1 offset:36864
    v_cvt_pk_bf16_f32 v37, v26, v27
    v_mfma_f32_16x16x32_bf16 v[16:19], a[72:75], v[120:123], v[16:19]
    v_exp_f32 v29, v29
    v_mfma_f32_16x16x32_bf16 v[16:19], a[76:79], v[124:127], v[16:19]
    ds_read_b128 a[68:71], v1 offset:36928
    v_mfma_f32_16x16x32_bf16 v[20:23], a[80:83], v[112:115], v[60:63]
    v_exp_f32 v30, v30
    v_mfma_f32_16x16x32_bf16 v[20:23], a[84:87], v[116:119], v[20:23]
    ds_read_b128 a[72:75], v1 offset:36992
    v_cvt_pk_bf16_f32 v38, v28, v29
    v_mfma_f32_16x16x32_bf16 v[20:23], a[88:91], v[120:123], v[20:23]
    v_exp_f32 v31, v31
    v_mfma_f32_16x16x32_bf16 v[20:23], a[92:95], v[124:127], v[20:23]
    ds_read_b128 a[76:79], v1 offset:37056
    v_mfma_f32_16x16x32_bf16 v[24:27], a[96:99], v[112:115], v[60:63]
    v_exp_f32 v16, v16
    v_mfma_f32_16x16x32_bf16 v[24:27], a[100:103], v[116:119], v[24:27]
    ds_read_b128 a[80:83], v1 offset:37120
    v_cvt_pk_bf16_f32 v39, v30, v31
    v_mfma_f32_16x16x32_bf16 v[24:27], a[104:107], v[120:123], v[24:27]
    v_exp_f32 v17, v17
    v_mfma_f32_16x16x32_bf16 v[24:27], a[108:111], v[124:127], v[24:27]
    ds_read_b128 a[84:87], v1 offset:37184
    v_mfma_f32_16x16x32_bf16 v[28:31], a[112:115], v[112:115], v[60:63]
    v_exp_f32 v18, v18
    v_mfma_f32_16x16x32_bf16 v[28:31], a[116:119], v[116:119], v[28:31]
    ds_read_b128 a[88:91], v1 offset:37248
    v_cvt_pk_bf16_f32 v40, v16, v17
    v_mfma_f32_16x16x32_bf16 v[28:31], a[120:123], v[120:123], v[28:31]
    v_exp_f32 v19, v19
    v_mfma_f32_16x16x32_bf16 v[28:31], a[124:127], v[124:127], v[28:31]
    ds_read_b128 a[92:95], v1 offset:37312
    v_mfma_f32_16x16x32_bf16 v[192:195], a[128:131], v[32:35], v[192:195]
    v_exp_f32 v20, v20
    v_mfma_f32_16x16x32_bf16 v[192:195], a[132:135], v[36:39], v[192:195]
    ds_read_b128 a[96:99], v1 offset:37376
    v_cvt_pk_bf16_f32 v41, v18, v19
    v_mfma_f32_16x16x32_bf16 v[196:199], a[136:139], v[32:35], v[196:199]
    v_exp_f32 v21, v21
    v_mfma_f32_16x16x32_bf16 v[196:199], a[140:143], v[36:39], v[196:199]
    ds_read_b128 a[100:103], v1 offset:37440
    v_mfma_f32_16x16x32_bf16 v[200:203], a[144:147], v[32:35], v[200:203]
    v_exp_f32 v22, v22
    v_mfma_f32_16x16x32_bf16 v[200:203], a[148:151], v[36:39], v[200:203]
    ds_read_b128 a[104:107], v1 offset:37504
    v_cvt_pk_bf16_f32 v42, v20, v21
    v_mfma_f32_16x16x32_bf16 v[204:207], a[152:155], v[32:35], v[204:207]
    v_exp_f32 v23, v23
    v_mfma_f32_16x16x32_bf16 v[204:207], a[156:159], v[36:39], v[204:207]
    ds_read_b128 a[108:111], v1 offset:37568
    v_mfma_f32_16x16x32_bf16 v[208:211], a[160:163], v[32:35], v[208:211]
    v_exp_f32 v24, v24
    v_mfma_f32_16x16x32_bf16 v[208:211], a[164:167], v[36:39], v[208:211]
    ds_read_b128 a[112:115], v1 offset:37632
    v_cvt_pk_bf16_f32 v43, v22, v23
    v_mfma_f32_16x16x32_bf16 v[212:215], a[168:171], v[32:35], v[212:215]
    v_exp_f32 v25, v25
    v_mfma_f32_16x16x32_bf16 v[212:215], a[172:175], v[36:39], v[212:215]
    ds_read_b128 a[116:119], v1 offset:37696
    v_mfma_f32_16x16x32_bf16 v[216:219], a[176:179], v[32:35], v[216:219]
    v_exp_f32 v26, v26
    v_mfma_f32_16x16x32_bf16 v[216:219], a[180:183], v[36:39], v[216:219]
    ds_read_b128 a[120:123], v1 offset:37760
    v_cvt_pk_bf16_f32 v44, v24, v25
    v_mfma_f32_16x16x32_bf16 v[220:223], a[184:187], v[32:35], v[220:223]
    v_exp_f32 v27, v27
    v_mfma_f32_16x16x32_bf16 v[220:223], a[188:191], v[36:39], v[220:223]
    ds_read_b128 a[124:127], v1 offset:37824
    v_smfmac_f32_16x16x64_bf16 a[8:11], a[16:19], v[32:39], v11
    s_waitcnt vmcnt(8) lgkmcnt(12)
    s_barrier
    v_mfma_f32_16x16x32_bf16 v[16:19], a[64:67], v[64:67], v[48:51]
    v_exp_f32 v28, v28
    v_mfma_f32_16x16x32_bf16 v[16:19], a[68:71], v[68:71], v[16:19]
    v_cvt_pk_bf16_f32 v45, v26, v27
    v_mfma_f32_16x16x32_bf16 v[16:19], a[72:75], v[72:75], v[16:19]
    s_add_u32 m0, s44, 0
    v_exp_f32 v29, v29
    v_mfma_f32_16x16x32_bf16 v[16:19], a[76:79], v[76:79], v[16:19]
    s_waitcnt lgkmcnt(8)
    s_mov_b32 s45, 256
    buffer_load_dwordx4 v7, s[28:31], s45 offen offset:0 lds
    v_mfma_f32_16x16x32_bf16 v[20:23], a[80:83], v[64:67], v[48:51]
    v_exp_f32 v30, v30
    v_mfma_f32_16x16x32_bf16 v[20:23], a[84:87], v[68:71], v[20:23]
    v_cvt_pk_bf16_f32 v46, v28, v29
    v_mfma_f32_16x16x32_bf16 v[20:23], a[88:91], v[72:75], v[20:23]
    s_add_u32 m0, s44, -96
    v_exp_f32 v31, v31
    v_mfma_f32_16x16x32_bf16 v[20:23], a[92:95], v[76:79], v[20:23]
    s_waitcnt lgkmcnt(4)
    buffer_load_dwordx4 v7, s[28:31], s45 offen offset:1152 lds
    v_mfma_f32_16x16x32_bf16 v[24:27], a[96:99], v[64:67], v[48:51]
    v_exp_f32 v16, v16
    v_mfma_f32_16x16x32_bf16 v[24:27], a[100:103], v[68:71], v[24:27]
    v_cvt_pk_bf16_f32 v47, v30, v31
    v_mfma_f32_16x16x32_bf16 v[24:27], a[104:107], v[72:75], v[24:27]
    s_add_u32 m0, s44, -192
    v_exp_f32 v17, v17
    v_mfma_f32_16x16x32_bf16 v[24:27], a[108:111], v[76:79], v[24:27]
    s_waitcnt lgkmcnt(0)
    buffer_load_dwordx4 v7, s[28:31], s45 offen offset:2304 lds
    v_mfma_f32_16x16x32_bf16 v[28:31], a[112:115], v[64:67], v[48:51]
    v_exp_f32 v18, v18
    v_mfma_f32_16x16x32_bf16 v[28:31], a[116:119], v[68:71], v[28:31]
    v_cvt_pk_bf16_f32 v32, v16, v17
    v_mfma_f32_16x16x32_bf16 v[28:31], a[120:123], v[72:75], v[28:31]
    s_add_u32 m0, s44, -288
    v_exp_f32 v19, v19
    v_mfma_f32_16x16x32_bf16 v[28:31], a[124:127], v[76:79], v[28:31]
    buffer_load_dwordx4 v7, s[28:31], s45 offen offset:3456 lds
    v_mfma_f32_16x16x32_bf16 v[224:227], a[128:131], v[40:43], v[224:227]
    v_exp_f32 v20, v20
    v_mfma_f32_16x16x32_bf16 v[224:227], a[132:135], v[44:47], v[224:227]
    v_cvt_pk_bf16_f32 v33, v18, v19
    v_mfma_f32_16x16x32_bf16 v[228:231], a[136:139], v[40:43], v[228:231]
    s_add_u32 m0, s44, 16896
    v_exp_f32 v21, v21
    v_mfma_f32_16x16x32_bf16 v[228:231], a[140:143], v[44:47], v[228:231]
    s_mov_b32 s45, 147712
    buffer_load_dwordx4 v7, s[28:31], s45 offen offset:0 lds
    v_mfma_f32_16x16x32_bf16 v[232:235], a[144:147], v[40:43], v[232:235]
    v_exp_f32 v22, v22
    v_mfma_f32_16x16x32_bf16 v[232:235], a[148:151], v[44:47], v[232:235]
    v_cvt_pk_bf16_f32 v34, v20, v21
    v_mfma_f32_16x16x32_bf16 v[236:239], a[152:155], v[40:43], v[236:239]
    s_add_u32 m0, s44, 16800
    v_exp_f32 v23, v23
    v_mfma_f32_16x16x32_bf16 v[236:239], a[156:159], v[44:47], v[236:239]
    buffer_load_dwordx4 v7, s[28:31], s45 offen offset:1152 lds
    v_mfma_f32_16x16x32_bf16 v[240:243], a[160:163], v[40:43], v[240:243]
    v_exp_f32 v24, v24
    v_mfma_f32_16x16x32_bf16 v[240:243], a[164:167], v[44:47], v[240:243]
    v_cvt_pk_bf16_f32 v35, v22, v23
    v_mfma_f32_16x16x32_bf16 v[244:247], a[168:171], v[40:43], v[244:247]
    s_add_u32 m0, s44, 16704
    v_exp_f32 v25, v25
    v_mfma_f32_16x16x32_bf16 v[244:247], a[172:175], v[44:47], v[244:247]
    buffer_load_dwordx4 v7, s[28:31], s45 offen offset:2304 lds
    v_mfma_f32_16x16x32_bf16 v[248:251], a[176:179], v[40:43], v[248:251]
    v_exp_f32 v26, v26
    v_mfma_f32_16x16x32_bf16 v[248:251], a[180:183], v[44:47], v[248:251]
    v_cvt_pk_bf16_f32 v36, v24, v25
    v_mfma_f32_16x16x32_bf16 v[252:255], a[184:187], v[40:43], v[252:255]
    s_add_u32 m0, s44, 16608
    v_exp_f32 v27, v27
    v_mfma_f32_16x16x32_bf16 v[252:255], a[188:191], v[44:47], v[252:255]
    buffer_load_dwordx4 v7, s[28:31], s45 offen offset:3456 lds
    v_smfmac_f32_16x16x64_bf16 a[12:15], a[16:19], v[40:47], v11
    v_mfma_f32_16x16x32_bf16 v[16:19], a[64:67], v[80:83], v[52:55]
    v_exp_f32 v28, v28
    v_mfma_f32_16x16x32_bf16 v[16:19], a[68:71], v[84:87], v[16:19]
    v_cvt_pk_bf16_f32 v37, v26, v27
    v_mfma_f32_16x16x32_bf16 v[16:19], a[72:75], v[88:91], v[16:19]
    s_mov_b32 s54, 0
    v_exp_f32 v29, v29
    v_mfma_f32_16x16x32_bf16 v[16:19], a[76:79], v[92:95], v[16:19]
    buffer_load_dwordx4 a[128:131], v6, s[68:71], s54 offen
    v_mfma_f32_16x16x32_bf16 v[20:23], a[80:83], v[80:83], v[52:55]
    v_exp_f32 v30, v30
    v_mfma_f32_16x16x32_bf16 v[20:23], a[84:87], v[84:87], v[20:23]
    v_cvt_pk_bf16_f32 v38, v28, v29
    v_mfma_f32_16x16x32_bf16 v[20:23], a[88:91], v[88:91], v[20:23]
    s_add_u32 s54, s55, 0
    v_exp_f32 v31, v31
    v_mfma_f32_16x16x32_bf16 v[20:23], a[92:95], v[92:95], v[20:23]
    s_mov_b32 s15, 0x5d800000
    buffer_load_dwordx4 a[164:167], v8, s[72:75], s54 offen
    v_mfma_f32_16x16x32_bf16 v[24:27], a[96:99], v[80:83], v[52:55]
    v_exp_f32 v16, v16
    v_mfma_f32_16x16x32_bf16 v[24:27], a[100:103], v[84:87], v[24:27]
    v_cvt_pk_bf16_f32 v39, v30, v31
    v_mfma_f32_16x16x32_bf16 v[24:27], a[104:107], v[88:91], v[24:27]
    s_mov_b32 s54, 147456
    v_exp_f32 v17, v17
    v_mfma_f32_16x16x32_bf16 v[24:27], a[108:111], v[92:95], v[24:27]
    buffer_load_dwordx4 a[132:135], v6, s[68:71], s54 offen
    v_mfma_f32_16x16x32_bf16 v[28:31], a[112:115], v[80:83], v[52:55]
    v_exp_f32 v18, v18
    v_mfma_f32_16x16x32_bf16 v[28:31], a[116:119], v[84:87], v[28:31]
    v_cvt_pk_bf16_f32 v40, v16, v17
    v_mfma_f32_16x16x32_bf16 v[28:31], a[120:123], v[88:91], v[28:31]
    s_add_u32 s54, s55, 1024
    v_exp_f32 v19, v19
    v_mfma_f32_16x16x32_bf16 v[28:31], a[124:127], v[92:95], v[28:31]
    buffer_load_dwordx4 a[168:171], v8, s[72:75], s54 offen
    v_mfma_f32_16x16x32_bf16 v[128:131], a[192:195], v[32:35], v[128:131]
    v_exp_f32 v20, v20
    v_mfma_f32_16x16x32_bf16 v[128:131], a[196:199], v[36:39], v[128:131]
    v_cvt_pk_bf16_f32 v41, v18, v19
    v_mfma_f32_16x16x32_bf16 v[132:135], a[200:203], v[32:35], v[132:135]
    s_mov_b32 s54, 294912
    v_exp_f32 v21, v21
    v_mfma_f32_16x16x32_bf16 v[132:135], a[204:207], v[36:39], v[132:135]
    buffer_load_dwordx4 a[136:139], v6, s[68:71], s54 offen
    v_mfma_f32_16x16x32_bf16 v[136:139], a[208:211], v[32:35], v[136:139]
    v_exp_f32 v22, v22
    v_mfma_f32_16x16x32_bf16 v[136:139], a[212:215], v[36:39], v[136:139]
    v_cvt_pk_bf16_f32 v42, v20, v21
    v_mfma_f32_16x16x32_bf16 v[140:143], a[216:219], v[32:35], v[140:143]
    s_add_u32 s54, s55, 2048
    v_exp_f32 v23, v23
    v_mfma_f32_16x16x32_bf16 v[140:143], a[220:223], v[36:39], v[140:143]
    buffer_load_dwordx4 a[172:175], v8, s[72:75], s54 offen
    v_mfma_f32_16x16x32_bf16 v[144:147], a[224:227], v[32:35], v[144:147]
    v_exp_f32 v24, v24
    v_mfma_f32_16x16x32_bf16 v[144:147], a[228:231], v[36:39], v[144:147]
    v_cvt_pk_bf16_f32 v43, v22, v23
    v_mfma_f32_16x16x32_bf16 v[148:151], a[232:235], v[32:35], v[148:151]
    s_mov_b32 s54, 442368
    v_exp_f32 v25, v25
    v_mfma_f32_16x16x32_bf16 v[148:151], a[236:239], v[36:39], v[148:151]
    buffer_load_dwordx4 a[140:143], v6, s[68:71], s54 offen
    v_mfma_f32_16x16x32_bf16 v[152:155], a[240:243], v[32:35], v[152:155]
    v_exp_f32 v26, v26
    v_mfma_f32_16x16x32_bf16 v[152:155], a[244:247], v[36:39], v[152:155]
    v_cvt_pk_bf16_f32 v44, v24, v25
    v_mfma_f32_16x16x32_bf16 v[156:159], a[248:251], v[32:35], v[156:159]
    s_add_u32 s54, s55, 3072
    v_exp_f32 v27, v27
    v_mfma_f32_16x16x32_bf16 v[156:159], a[252:255], v[36:39], v[156:159]
    buffer_load_dwordx4 a[176:179], v8, s[72:75], s54 offen
    v_smfmac_f32_16x16x64_bf16 a[0:3], a[16:19], v[32:39], v11
    v_mfma_f32_16x16x32_bf16 v[16:19], a[64:67], v[96:99], v[56:59]
    v_exp_f32 v28, v28
    v_mfma_f32_16x16x32_bf16 v[16:19], a[68:71], v[100:103], v[16:19]
    v_cvt_pk_bf16_f32 v45, v26, v27
    v_mfma_f32_16x16x32_bf16 v[16:19], a[72:75], v[104:107], v[16:19]
    s_mov_b32 s54, 589824
    v_exp_f32 v29, v29
    v_mfma_f32_16x16x32_bf16 v[16:19], a[76:79], v[108:111], v[16:19]
    buffer_load_dwordx4 a[144:147], v6, s[68:71], s54 offen
    v_mfma_f32_16x16x32_bf16 v[20:23], a[80:83], v[96:99], v[56:59]
    v_exp_f32 v30, v30
    v_mfma_f32_16x16x32_bf16 v[20:23], a[84:87], v[100:103], v[20:23]
    v_cvt_pk_bf16_f32 v46, v28, v29
    v_accvgpr_read_b32 v12, a0
    v_mfma_f32_16x16x32_bf16 v[20:23], a[88:91], v[104:107], v[20:23]
    s_add_u32 s54, s55, 4096
    v_exp_f32 v31, v31
    v_mfma_f32_16x16x32_bf16 v[20:23], a[92:95], v[108:111], v[20:23]
    buffer_load_dwordx4 a[180:183], v8, s[72:75], s54 offen
    v_mfma_f32_16x16x32_bf16 v[24:27], a[96:99], v[96:99], v[56:59]
    v_exp_f32 v16, v16
    v_mfma_f32_16x16x32_bf16 v[24:27], a[100:103], v[100:103], v[24:27]
    v_cvt_pk_bf16_f32 v47, v30, v31
    v_accvgpr_read_b32 v13, a1
    v_mfma_f32_16x16x32_bf16 v[24:27], a[104:107], v[104:107], v[24:27]
    s_mov_b32 s54, 737280
    v_exp_f32 v17, v17
    v_mfma_f32_16x16x32_bf16 v[24:27], a[108:111], v[108:111], v[24:27]
    buffer_load_dwordx4 a[148:151], v6, s[68:71], s54 offen
    v_mfma_f32_16x16x32_bf16 v[28:31], a[112:115], v[96:99], v[56:59]
    v_exp_f32 v18, v18
    v_mfma_f32_16x16x32_bf16 v[28:31], a[116:119], v[100:103], v[28:31]
    v_cvt_pk_bf16_f32 v32, v16, v17
    v_add_f32 v12, v12, v13
    v_mfma_f32_16x16x32_bf16 v[28:31], a[120:123], v[104:107], v[28:31]
    s_add_u32 s54, s55, 5120
    v_exp_f32 v19, v19
    v_mfma_f32_16x16x32_bf16 v[28:31], a[124:127], v[108:111], v[28:31]
    buffer_load_dwordx4 a[184:187], v8, s[72:75], s54 offen
    v_mfma_f32_16x16x32_bf16 v[160:163], a[192:195], v[40:43], v[160:163]
    v_exp_f32 v20, v20
    v_mfma_f32_16x16x32_bf16 v[160:163], a[196:199], v[44:47], v[160:163]
    v_cvt_pk_bf16_f32 v33, v18, v19
    v_cmp_nlt_f32 s[56:57], v12, s15
    v_mfma_f32_16x16x32_bf16 v[164:167], a[200:203], v[40:43], v[164:167]
    s_mov_b32 s54, 884736
    v_exp_f32 v21, v21
    v_mfma_f32_16x16x32_bf16 v[164:167], a[204:207], v[44:47], v[164:167]
    buffer_load_dwordx4 a[152:155], v6, s[68:71], s54 offen
    v_mfma_f32_16x16x32_bf16 v[168:171], a[208:211], v[40:43], v[168:171]
    v_exp_f32 v22, v22
    v_mfma_f32_16x16x32_bf16 v[168:171], a[212:215], v[44:47], v[168:171]
    v_cvt_pk_bf16_f32 v34, v20, v21
    v_mfma_f32_16x16x32_bf16 v[172:175], a[216:219], v[40:43], v[172:175]
    s_add_u32 s54, s55, 6144
    v_exp_f32 v23, v23
    v_mfma_f32_16x16x32_bf16 v[172:175], a[220:223], v[44:47], v[172:175]
    buffer_load_dwordx4 a[188:191], v8, s[72:75], s54 offen
    v_mfma_f32_16x16x32_bf16 v[176:179], a[224:227], v[40:43], v[176:179]
    v_exp_f32 v24, v24
    v_mfma_f32_16x16x32_bf16 v[176:179], a[228:231], v[44:47], v[176:179]
    v_cvt_pk_bf16_f32 v35, v22, v23
    v_mfma_f32_16x16x32_bf16 v[180:183], a[232:235], v[40:43], v[180:183]
    s_mov_b32 s54, 1032192
    v_exp_f32 v25, v25
    v_mfma_f32_16x16x32_bf16 v[180:183], a[236:239], v[44:47], v[180:183]
    buffer_load_dwordx4 a[156:159], v6, s[68:71], s54 offen
    v_mfma_f32_16x16x32_bf16 v[184:187], a[240:243], v[40:43], v[184:187]
    v_exp_f32 v26, v26
    v_mfma_f32_16x16x32_bf16 v[184:187], a[244:247], v[44:47], v[184:187]
    v_cvt_pk_bf16_f32 v36, v24, v25
    v_mfma_f32_16x16x32_bf16 v[188:191], a[248:251], v[40:43], v[188:191]
    s_mov_b32 s54, 1179648
    v_exp_f32 v27, v27
    v_mfma_f32_16x16x32_bf16 v[188:191], a[252:255], v[44:47], v[188:191]
    buffer_load_dwordx4 a[160:163], v6, s[68:71], s54 offen
    v_smfmac_f32_16x16x64_bf16 a[4:7], a[16:19], v[40:47], v11
    v_rcp_f32 v12, v12
    v_mfma_f32_16x16x32_bf16 v[16:19], a[64:67], v[112:115], v[60:63]
    v_exp_f32 v28, v28
    v_mfma_f32_16x16x32_bf16 v[16:19], a[68:71], v[116:119], v[16:19]
    v_cvt_pk_bf16_f32 v37, v26, v27
    v_mul_f32 v128, v128, v12
    v_mfma_f32_16x16x32_bf16 v[16:19], a[72:75], v[120:123], v[16:19]
    v_exp_f32 v29, v29
    v_mfma_f32_16x16x32_bf16 v[16:19], a[76:79], v[124:127], v[16:19]
    v_mul_f32 v129, v129, v12
    v_mul_f32 v130, v130, v12
    v_mfma_f32_16x16x32_bf16 v[20:23], a[80:83], v[112:115], v[60:63]
    v_exp_f32 v30, v30
    v_mfma_f32_16x16x32_bf16 v[20:23], a[84:87], v[116:119], v[20:23]
    v_cvt_pk_bf16_f32 v38, v28, v29
    v_mul_f32 v131, v131, v12
    v_mfma_f32_16x16x32_bf16 v[20:23], a[88:91], v[120:123], v[20:23]
    v_exp_f32 v31, v31
    v_mfma_f32_16x16x32_bf16 v[20:23], a[92:95], v[124:127], v[20:23]
    v_mul_f32 v132, v132, v12
    v_mul_f32 v133, v133, v12
    v_mfma_f32_16x16x32_bf16 v[24:27], a[96:99], v[112:115], v[60:63]
    v_exp_f32 v16, v16
    v_mfma_f32_16x16x32_bf16 v[24:27], a[100:103], v[116:119], v[24:27]
    v_cvt_pk_bf16_f32 v39, v30, v31
    v_mul_f32 v134, v134, v12
    v_mfma_f32_16x16x32_bf16 v[24:27], a[104:107], v[120:123], v[24:27]
    v_exp_f32 v17, v17
    v_mfma_f32_16x16x32_bf16 v[24:27], a[108:111], v[124:127], v[24:27]
    v_mul_f32 v135, v135, v12
    v_cvt_pk_bf16_f32 v128, v128, v129
    v_mfma_f32_16x16x32_bf16 v[28:31], a[112:115], v[112:115], v[60:63]
    v_exp_f32 v18, v18
    v_mfma_f32_16x16x32_bf16 v[28:31], a[116:119], v[116:119], v[28:31]
    v_cvt_pk_bf16_f32 v40, v16, v17
    v_cvt_pk_bf16_f32 v129, v130, v131
    v_mfma_f32_16x16x32_bf16 v[28:31], a[120:123], v[120:123], v[28:31]
    v_exp_f32 v19, v19
    v_mfma_f32_16x16x32_bf16 v[28:31], a[124:127], v[124:127], v[28:31]
    v_cvt_pk_bf16_f32 v130, v132, v133
    v_cvt_pk_bf16_f32 v131, v134, v135
    v_mfma_f32_16x16x32_bf16 v[192:195], a[192:195], v[32:35], v[192:195]
    v_exp_f32 v20, v20
    v_mfma_f32_16x16x32_bf16 v[192:195], a[196:199], v[36:39], v[192:195]
    v_cvt_pk_bf16_f32 v41, v18, v19
    v_mul_f32 v136, v136, v12
    v_mfma_f32_16x16x32_bf16 v[196:199], a[200:203], v[32:35], v[196:199]
    v_exp_f32 v21, v21
    v_mfma_f32_16x16x32_bf16 v[196:199], a[204:207], v[36:39], v[196:199]
    v_mul_f32 v137, v137, v12
    v_mul_f32 v138, v138, v12
    v_mfma_f32_16x16x32_bf16 v[200:203], a[208:211], v[32:35], v[200:203]
    v_exp_f32 v22, v22
    v_mfma_f32_16x16x32_bf16 v[200:203], a[212:215], v[36:39], v[200:203]
    v_cvt_pk_bf16_f32 v42, v20, v21
    v_mul_f32 v139, v139, v12
    v_mfma_f32_16x16x32_bf16 v[204:207], a[216:219], v[32:35], v[204:207]
    v_exp_f32 v23, v23
    v_mfma_f32_16x16x32_bf16 v[204:207], a[220:223], v[36:39], v[204:207]
    v_mul_f32 v140, v140, v12
    v_mul_f32 v141, v141, v12
    v_mfma_f32_16x16x32_bf16 v[208:211], a[224:227], v[32:35], v[208:211]
    v_exp_f32 v24, v24
    v_mfma_f32_16x16x32_bf16 v[208:211], a[228:231], v[36:39], v[208:211]
    v_cvt_pk_bf16_f32 v43, v22, v23
    v_mul_f32 v142, v142, v12
    v_mfma_f32_16x16x32_bf16 v[212:215], a[232:235], v[32:35], v[212:215]
    v_exp_f32 v25, v25
    v_mfma_f32_16x16x32_bf16 v[212:215], a[236:239], v[36:39], v[212:215]
    v_mul_f32 v143, v143, v12
    v_cvt_pk_bf16_f32 v136, v136, v137
    v_mfma_f32_16x16x32_bf16 v[216:219], a[240:243], v[32:35], v[216:219]
    v_exp_f32 v26, v26
    v_mfma_f32_16x16x32_bf16 v[216:219], a[244:247], v[36:39], v[216:219]
    v_cvt_pk_bf16_f32 v44, v24, v25
    v_cvt_pk_bf16_f32 v137, v138, v139
    v_mfma_f32_16x16x32_bf16 v[220:223], a[248:251], v[32:35], v[220:223]
    v_exp_f32 v27, v27
    v_mfma_f32_16x16x32_bf16 v[220:223], a[252:255], v[36:39], v[220:223]
    v_cvt_pk_bf16_f32 v138, v140, v141
    v_cvt_pk_bf16_f32 v139, v142, v143
    v_smfmac_f32_16x16x64_bf16 a[8:11], a[16:19], v[32:39], v11
    v_mul_f32 v144, v144, v12
    v_mul_f32 v145, v145, v12
    v_exp_f32 v28, v28
    s_nop 0
    v_cvt_pk_bf16_f32 v45, v26, v27
    v_exp_f32 v29, v29
    s_nop 0
    v_exp_f32 v30, v30
    s_nop 0
    v_cvt_pk_bf16_f32 v46, v28, v29
    v_exp_f32 v31, v31
    s_nop 0
    v_cvt_pk_bf16_f32 v47, v30, v31
    s_nop 1
    v_mfma_f32_16x16x32_bf16 v[224:227], a[192:195], v[40:43], v[224:227]
    v_mul_f32 v146, v146, v12
    v_mul_f32 v147, v147, v12
    v_mfma_f32_16x16x32_bf16 v[224:227], a[196:199], v[44:47], v[224:227]
    ds_read_b64_tr_b16 a[64:65], v4 offset:0
    ds_read_b64_tr_b16 a[66:67], v4 offset:128
    v_mfma_f32_16x16x32_bf16 v[228:231], a[200:203], v[40:43], v[228:231]
    ds_read_b64_tr_b16 a[68:69], v4 offset:256
    ds_read_b64_tr_b16 a[70:71], v4 offset:384
    v_mfma_f32_16x16x32_bf16 v[228:231], a[204:207], v[44:47], v[228:231]
    ds_read_b64_tr_b16 a[72:73], v4 offset:512
    ds_read_b64_tr_b16 a[74:75], v4 offset:640
    v_mfma_f32_16x16x32_bf16 v[232:235], a[208:211], v[40:43], v[232:235]
    ds_read_b64_tr_b16 a[76:77], v4 offset:768
    ds_read_b64_tr_b16 a[78:79], v4 offset:896
    v_mfma_f32_16x16x32_bf16 v[232:235], a[212:215], v[44:47], v[232:235]
    ds_read_b64_tr_b16 a[80:81], v4 offset:16896
    ds_read_b64_tr_b16 a[82:83], v4 offset:17024
    v_mfma_f32_16x16x32_bf16 v[236:239], a[216:219], v[40:43], v[236:239]
    ds_read_b64_tr_b16 a[84:85], v4 offset:17152
    ds_read_b64_tr_b16 a[86:87], v4 offset:17280
    v_mfma_f32_16x16x32_bf16 v[236:239], a[220:223], v[44:47], v[236:239]
    ds_read_b64_tr_b16 a[88:89], v4 offset:17408
    ds_read_b64_tr_b16 a[90:91], v4 offset:17536
    v_mfma_f32_16x16x32_bf16 v[240:243], a[224:227], v[40:43], v[240:243]
    ds_read_b64_tr_b16 a[92:93], v4 offset:17664
    ds_read_b64_tr_b16 a[94:95], v4 offset:17792
    v_mfma_f32_16x16x32_bf16 v[240:243], a[228:231], v[44:47], v[240:243]
    v_mul_f32 v148, v148, v12
    v_mul_f32 v149, v149, v12
    v_mfma_f32_16x16x32_bf16 v[244:247], a[232:235], v[40:43], v[244:247]
    v_mul_f32 v150, v150, v12
    v_mul_f32 v151, v151, v12
    v_mfma_f32_16x16x32_bf16 v[244:247], a[236:239], v[44:47], v[244:247]
    v_cvt_pk_bf16_f32 v144, v144, v145
    v_cvt_pk_bf16_f32 v145, v146, v147
    v_mfma_f32_16x16x32_bf16 v[248:251], a[240:243], v[40:43], v[248:251]
    v_cvt_pk_bf16_f32 v146, v148, v149
    v_cvt_pk_bf16_f32 v147, v150, v151
    v_mfma_f32_16x16x32_bf16 v[248:251], a[244:247], v[44:47], v[248:251]
    v_mul_f32 v152, v152, v12
    v_mul_f32 v153, v153, v12
    v_mfma_f32_16x16x32_bf16 v[252:255], a[248:251], v[40:43], v[252:255]
    v_mul_f32 v154, v154, v12
    v_mul_f32 v155, v155, v12
    v_mfma_f32_16x16x32_bf16 v[252:255], a[252:255], v[44:47], v[252:255]
    v_mul_f32 v156, v156, v12
    v_mul_f32 v157, v157, v12
    v_smfmac_f32_16x16x64_bf16 a[12:15], a[16:19], v[40:47], v11
    v_mul_f32 v158, v158, v12
    v_mul_f32 v159, v159, v12
    v_cvt_pk_bf16_f32 v152, v152, v153
    v_cvt_pk_bf16_f32 v153, v154, v155
    v_cvt_pk_bf16_f32 v154, v156, v157
    v_cvt_pk_bf16_f32 v155, v158, v159
    v_accvgpr_read_b32 v14, a4
    v_accvgpr_read_b32 v15, a5
    v_add_f32 v14, v14, v15
    v_cmp_nlt_f32 s[58:59], v14, s15
    v_rcp_f32 v14, v14
    v_accvgpr_read_b32 v12, a8
    v_accvgpr_read_b32 v13, a9
    v_add_f32 v12, v12, v13
    v_cmp_nlt_f32 s[60:61], v12, s15
    v_rcp_f32 v12, v12
    v_pk_mul_f32 v[160:161], v[160:161], v[14:15] op_sel_hi:[1,0]
    v_pk_mul_f32 v[162:163], v[162:163], v[14:15] op_sel_hi:[1,0]
    v_pk_mul_f32 v[164:165], v[164:165], v[14:15] op_sel_hi:[1,0]
    v_pk_mul_f32 v[166:167], v[166:167], v[14:15] op_sel_hi:[1,0]
    v_cvt_pk_bf16_f32 v160, v160, v161
    v_cvt_pk_bf16_f32 v161, v162, v163
    v_cvt_pk_bf16_f32 v162, v164, v165
    v_cvt_pk_bf16_f32 v163, v166, v167
    v_pk_mul_f32 v[168:169], v[168:169], v[14:15] op_sel_hi:[1,0]
    v_pk_mul_f32 v[170:171], v[170:171], v[14:15] op_sel_hi:[1,0]
    v_pk_mul_f32 v[172:173], v[172:173], v[14:15] op_sel_hi:[1,0]
    v_pk_mul_f32 v[174:175], v[174:175], v[14:15] op_sel_hi:[1,0]
    v_cvt_pk_bf16_f32 v168, v168, v169
    v_cvt_pk_bf16_f32 v169, v170, v171
    v_cvt_pk_bf16_f32 v170, v172, v173
    v_cvt_pk_bf16_f32 v171, v174, v175
    v_pk_mul_f32 v[176:177], v[176:177], v[14:15] op_sel_hi:[1,0]
    v_pk_mul_f32 v[178:179], v[178:179], v[14:15] op_sel_hi:[1,0]
    v_pk_mul_f32 v[180:181], v[180:181], v[14:15] op_sel_hi:[1,0]
    v_pk_mul_f32 v[182:183], v[182:183], v[14:15] op_sel_hi:[1,0]
    v_cvt_pk_bf16_f32 v176, v176, v177
    v_cvt_pk_bf16_f32 v177, v178, v179
    v_cvt_pk_bf16_f32 v178, v180, v181
    v_cvt_pk_bf16_f32 v179, v182, v183
    v_pk_mul_f32 v[184:185], v[184:185], v[14:15] op_sel_hi:[1,0]
    v_pk_mul_f32 v[186:187], v[186:187], v[14:15] op_sel_hi:[1,0]
    v_pk_mul_f32 v[188:189], v[188:189], v[14:15] op_sel_hi:[1,0]
    v_pk_mul_f32 v[190:191], v[190:191], v[14:15] op_sel_hi:[1,0]
    v_cvt_pk_bf16_f32 v184, v184, v185
    v_cvt_pk_bf16_f32 v185, v186, v187
    v_cvt_pk_bf16_f32 v186, v188, v189
    v_cvt_pk_bf16_f32 v187, v190, v191
    v_accvgpr_read_b32 v14, a12
    v_accvgpr_read_b32 v15, a13
    v_add_f32 v14, v14, v15
    v_cmp_nlt_f32 s[62:63], v14, s15
    s_or_b64 s[56:57], s[56:57], s[58:59]
    v_rcp_f32 v14, v14
    s_or_b64 s[60:61], s[60:61], s[62:63]
    s_or_b64 s[56:57], s[56:57], s[60:61]
    s_cselect_b32 s3, 1, 0
    s_andn2_b32 s3, s3, s50
    s_lshl2_add_u32 s14, s51, 13824
    v_mov_b32 v56, s3
    v_mov_b32 v57, s14
    v_mov_b32 v58, 13824
    ds_write_b32 v57, v56
    v_pk_mul_f32 v[192:193], v[192:193], v[12:13] op_sel_hi:[1,0]
    v_pk_mul_f32 v[194:195], v[194:195], v[12:13] op_sel_hi:[1,0]
    v_pk_mul_f32 v[196:197], v[196:197], v[12:13] op_sel_hi:[1,0]
    v_pk_mul_f32 v[198:199], v[198:199], v[12:13] op_sel_hi:[1,0]
    v_cvt_pk_bf16_f32 v192, v192, v193
    v_cvt_pk_bf16_f32 v193, v194, v195
    v_cvt_pk_bf16_f32 v194, v196, v197
    v_cvt_pk_bf16_f32 v195, v198, v199
    v_pk_mul_f32 v[200:201], v[200:201], v[12:13] op_sel_hi:[1,0]
    v_pk_mul_f32 v[202:203], v[202:203], v[12:13] op_sel_hi:[1,0]
    v_pk_mul_f32 v[204:205], v[204:205], v[12:13] op_sel_hi:[1,0]
    v_pk_mul_f32 v[206:207], v[206:207], v[12:13] op_sel_hi:[1,0]
    v_cvt_pk_bf16_f32 v200, v200, v201
    v_cvt_pk_bf16_f32 v201, v202, v203
    v_cvt_pk_bf16_f32 v202, v204, v205
    v_cvt_pk_bf16_f32 v203, v206, v207
    v_pk_mul_f32 v[208:209], v[208:209], v[12:13] op_sel_hi:[1,0]
    v_pk_mul_f32 v[210:211], v[210:211], v[12:13] op_sel_hi:[1,0]
    v_pk_mul_f32 v[212:213], v[212:213], v[12:13] op_sel_hi:[1,0]
    v_pk_mul_f32 v[214:215], v[214:215], v[12:13] op_sel_hi:[1,0]
    v_cvt_pk_bf16_f32 v208, v208, v209
    v_cvt_pk_bf16_f32 v209, v210, v211
    v_cvt_pk_bf16_f32 v210, v212, v213
    v_cvt_pk_bf16_f32 v211, v214, v215
    v_pk_mul_f32 v[216:217], v[216:217], v[12:13] op_sel_hi:[1,0]
    v_pk_mul_f32 v[218:219], v[218:219], v[12:13] op_sel_hi:[1,0]
    v_pk_mul_f32 v[220:221], v[220:221], v[12:13] op_sel_hi:[1,0]
    v_pk_mul_f32 v[222:223], v[222:223], v[12:13] op_sel_hi:[1,0]
    v_cvt_pk_bf16_f32 v216, v216, v217
    v_cvt_pk_bf16_f32 v217, v218, v219
    v_cvt_pk_bf16_f32 v218, v220, v221
    v_cvt_pk_bf16_f32 v219, v222, v223
    v_pk_mul_f32 v[224:225], v[224:225], v[14:15] op_sel_hi:[1,0]
    v_pk_mul_f32 v[226:227], v[226:227], v[14:15] op_sel_hi:[1,0]
    v_pk_mul_f32 v[228:229], v[228:229], v[14:15] op_sel_hi:[1,0]
    v_pk_mul_f32 v[230:231], v[230:231], v[14:15] op_sel_hi:[1,0]
    v_cvt_pk_bf16_f32 v224, v224, v225
    v_cvt_pk_bf16_f32 v225, v226, v227
    v_cvt_pk_bf16_f32 v226, v228, v229
    v_cvt_pk_bf16_f32 v227, v230, v231
    v_pk_mul_f32 v[232:233], v[232:233], v[14:15] op_sel_hi:[1,0]
    v_pk_mul_f32 v[234:235], v[234:235], v[14:15] op_sel_hi:[1,0]
    v_pk_mul_f32 v[236:237], v[236:237], v[14:15] op_sel_hi:[1,0]
    v_pk_mul_f32 v[238:239], v[238:239], v[14:15] op_sel_hi:[1,0]
    v_cvt_pk_bf16_f32 v232, v232, v233
    v_cvt_pk_bf16_f32 v233, v234, v235
    v_cvt_pk_bf16_f32 v234, v236, v237
    v_cvt_pk_bf16_f32 v235, v238, v239
    v_pk_mul_f32 v[240:241], v[240:241], v[14:15] op_sel_hi:[1,0]
    v_pk_mul_f32 v[242:243], v[242:243], v[14:15] op_sel_hi:[1,0]
    v_pk_mul_f32 v[244:245], v[244:245], v[14:15] op_sel_hi:[1,0]
    v_pk_mul_f32 v[246:247], v[246:247], v[14:15] op_sel_hi:[1,0]
    v_cvt_pk_bf16_f32 v240, v240, v241
    v_cvt_pk_bf16_f32 v241, v242, v243
    v_cvt_pk_bf16_f32 v242, v244, v245
L2_pad9:
    s_cbranch_execz L2_pad13
    v_cvt_pk_bf16_f32 v243, v246, v247
    v_pk_mul_f32 v[248:249], v[248:249], v[14:15] op_sel_hi:[1,0]
    v_pk_mul_f32 v[250:251], v[250:251], v[14:15] op_sel_hi:[1,0]
    v_pk_mul_f32 v[252:253], v[252:253], v[14:15] op_sel_hi:[1,0]
    v_pk_mul_f32 v[254:255], v[254:255], v[14:15] op_sel_hi:[1,0]
    v_cvt_pk_bf16_f32 v248, v248, v249
    v_cvt_pk_bf16_f32 v249, v250, v251
    v_cvt_pk_bf16_f32 v250, v252, v253
    v_cvt_pk_bf16_f32 v251, v254, v255
    s_waitcnt lgkmcnt(13)
    v_mfma_f32_16x16x32_bf16 v[16:19], a[64:67], v[128:131], 0
    ds_read_b64_tr_b16 a[96:97], v4 offset:32
    ds_read_b64_tr_b16 a[98:99], v4 offset:160
    v_mfma_f32_16x16x32_bf16 v[16:19], a[68:71], v[136:139], v[16:19]
    s_waitcnt lgkmcnt(11)
    ds_read_b64_tr_b16 a[100:101], v4 offset:288
    ds_read_b64_tr_b16 a[102:103], v4 offset:416
    v_mfma_f32_16x16x32_bf16 v[16:19], a[72:75], v[144:147], v[16:19]
    s_add_u32 s54, s55, 7168
    ds_read_b64_tr_b16 a[104:105], v4 offset:544
    v_mfma_f32_16x16x32_bf16 v[16:19], a[76:79], v[152:155], v[16:19]
    s_waitcnt lgkmcnt(10)
    buffer_load_dwordx4 a[192:195], v8, s[72:75], s54 offen
    v_mfma_f32_16x16x32_bf16 v[16:19], a[80:83], v[192:195], v[16:19]
    ds_read_b64_tr_b16 a[106:107], v4 offset:672
    v_mfma_f32_16x16x32_bf16 v[16:19], a[84:87], v[200:203], v[16:19]
    s_waitcnt lgkmcnt(7)
    ds_read_b64_tr_b16 a[108:109], v4 offset:800
    v_mfma_f32_16x16x32_bf16 v[16:19], a[88:91], v[208:211], v[16:19]
    s_add_u32 s54, s55, 8192
    ds_read_b64_tr_b16 a[110:111], v4 offset:928
    v_mfma_f32_16x16x32_bf16 v[16:19], a[92:95], v[216:219], v[16:19]
    buffer_load_dwordx4 a[196:199], v8, s[72:75], s54 offen
    v_mfma_f32_16x16x32_bf16 v[20:23], a[64:67], v[160:163], 0
    ds_read_b64_tr_b16 a[112:113], v4 offset:16928
    v_mfma_f32_16x16x32_bf16 v[20:23], a[68:71], v[168:171], v[20:23]
    ds_read_b64_tr_b16 a[114:115], v4 offset:17056
    v_mfma_f32_16x16x32_bf16 v[20:23], a[72:75], v[176:179], v[20:23]
    ds_read_b64_tr_b16 a[116:117], v4 offset:17184
    v_mfma_f32_16x16x32_bf16 v[20:23], a[76:79], v[184:187], v[20:23]
    ds_read_b64_tr_b16 a[118:119], v4 offset:17312
    v_mfma_f32_16x16x32_bf16 v[20:23], a[80:83], v[224:227], v[20:23]
    ds_read_b64_tr_b16 a[120:121], v4 offset:17440
    v_mfma_f32_16x16x32_bf16 v[20:23], a[84:87], v[232:235], v[20:23]
    ds_read_b64_tr_b16 a[122:123], v4 offset:17568
    v_mfma_f32_16x16x32_bf16 v[20:23], a[88:91], v[240:243], v[20:23]
    ds_read_b64_tr_b16 a[124:125], v4 offset:17696
    v_mfma_f32_16x16x32_bf16 v[20:23], a[92:95], v[248:251], v[20:23]
    s_waitcnt lgkmcnt(11)
    ds_read_b64_tr_b16 a[126:127], v4 offset:17824
    v_mfma_f32_16x16x32_bf16 v[24:27], a[96:99], v[128:131], 0
    ds_read_b64_tr_b16 a[64:65], v4 offset:64
    v_mfma_f32_16x16x32_bf16 v[24:27], a[100:103], v[136:139], v[24:27]
    s_waitcnt lgkmcnt(9)
    ds_read_b64_tr_b16 a[66:67], v4 offset:192
    v_mfma_f32_16x16x32_bf16 v[24:27], a[104:107], v[144:147], v[24:27]
    ds_read_b64_tr_b16 a[68:69], v4 offset:320
    v_mfma_f32_16x16x32_bf16 v[24:27], a[108:111], v[152:155], v[24:27]
    s_waitcnt lgkmcnt(7)
    ds_read_b64_tr_b16 a[70:71], v4 offset:448
    v_mfma_f32_16x16x32_bf16 v[24:27], a[112:115], v[192:195], v[24:27]
    ds_read_b64_tr_b16 a[72:73], v4 offset:576
    v_mfma_f32_16x16x32_bf16 v[24:27], a[116:119], v[200:203], v[24:27]
    s_waitcnt lgkmcnt(5)
    ds_read_b64_tr_b16 a[74:75], v4 offset:704
    v_mfma_f32_16x16x32_bf16 v[24:27], a[120:123], v[208:211], v[24:27]
    ds_read_b64_tr_b16 a[76:77], v4 offset:832
    v_mfma_f32_16x16x32_bf16 v[24:27], a[124:127], v[216:219], v[24:27]
    ds_read_b64_tr_b16 a[78:79], v4 offset:960
    v_mfma_f32_16x16x32_bf16 v[28:31], a[96:99], v[160:163], 0
    ds_read_b64_tr_b16 a[80:81], v4 offset:16960
    v_mfma_f32_16x16x32_bf16 v[28:31], a[100:103], v[168:171], v[28:31]
    ds_read_b64_tr_b16 a[82:83], v4 offset:17088
    v_mfma_f32_16x16x32_bf16 v[28:31], a[104:107], v[176:179], v[28:31]
    ds_read_b64_tr_b16 a[84:85], v4 offset:17216
    v_mfma_f32_16x16x32_bf16 v[28:31], a[108:111], v[184:187], v[28:31]
    ds_read_b64_tr_b16 a[86:87], v4 offset:17344
    v_mfma_f32_16x16x32_bf16 v[28:31], a[112:115], v[224:227], v[28:31]
    ds_read_b64_tr_b16 a[88:89], v4 offset:17472
    v_mfma_f32_16x16x32_bf16 v[28:31], a[116:119], v[232:235], v[28:31]
    ds_read_b64_tr_b16 a[90:91], v4 offset:17600
    v_mfma_f32_16x16x32_bf16 v[28:31], a[120:123], v[240:243], v[28:31]
    ds_read_b64_tr_b16 a[92:93], v4 offset:17728
    v_mfma_f32_16x16x32_bf16 v[28:31], a[124:127], v[248:251], v[28:31]
    s_waitcnt lgkmcnt(11)
    ds_read_b64_tr_b16 a[94:95], v4 offset:17856
    v_mfma_f32_16x16x32_bf16 v[32:35], a[64:67], v[128:131], 0
    ds_read_b64_tr_b16 a[96:97], v4 offset:96
    v_cvt_pk_bf16_f32 v48, v16, v17
    v_mfma_f32_16x16x32_bf16 v[32:35], a[68:71], v[136:139], v[32:35]
    s_waitcnt lgkmcnt(9)
    ds_read_b64_tr_b16 a[98:99], v4 offset:224
    v_cvt_pk_bf16_f32 v49, v18, v19
    v_mfma_f32_16x16x32_bf16 v[32:35], a[72:75], v[144:147], v[32:35]
    ds_read_b64_tr_b16 a[100:101], v4 offset:352
    v_cvt_pk_bf16_f32 v50, v24, v25
    v_mfma_f32_16x16x32_bf16 v[32:35], a[76:79], v[152:155], v[32:35]
    s_waitcnt lgkmcnt(7)
    ds_read_b64_tr_b16 a[102:103], v4 offset:480
    v_cvt_pk_bf16_f32 v51, v26, v27
    v_mfma_f32_16x16x32_bf16 v[32:35], a[80:83], v[192:195], v[32:35]
    s_mov_b32 s54, 0
    ds_read_b64_tr_b16 a[104:105], v4 offset:608
    ds_read_b64_tr_b16 a[106:107], v4 offset:736
    v_mfma_f32_16x16x32_bf16 v[32:35], a[84:87], v[200:203], v[32:35]
    s_waitcnt lgkmcnt(6)
    v_permlane32_swap_b32 v48, v50
    v_mfma_f32_16x16x32_bf16 v[32:35], a[88:91], v[208:211], v[32:35]
    v_permlane32_swap_b32 v49, v51
    v_mfma_f32_16x16x32_bf16 v[32:35], a[92:95], v[216:219], v[32:35]
    ds_read_b64_tr_b16 a[108:109], v4 offset:864
    ds_read_b64_tr_b16 a[110:111], v4 offset:992
    buffer_store_dwordx4 v[48:51], v10, s[40:43], s54 offen offset:0 sc1
    v_mfma_f32_16x16x32_bf16 v[36:39], a[64:67], v[160:163], 0
    ds_read_b64_tr_b16 a[112:113], v4 offset:16992
    v_cvt_pk_bf16_f32 v52, v20, v21
    v_mfma_f32_16x16x32_bf16 v[36:39], a[68:71], v[168:171], v[36:39]
    ds_read_b64_tr_b16 a[114:115], v4 offset:17120
    v_cvt_pk_bf16_f32 v53, v22, v23
    v_mfma_f32_16x16x32_bf16 v[36:39], a[72:75], v[176:179], v[36:39]
    ds_read_b64_tr_b16 a[116:117], v4 offset:17248
    v_cvt_pk_bf16_f32 v54, v28, v29
    v_mfma_f32_16x16x32_bf16 v[36:39], a[76:79], v[184:187], v[36:39]
    ds_read_b64_tr_b16 a[118:119], v4 offset:17376
    v_cvt_pk_bf16_f32 v55, v30, v31
    v_mfma_f32_16x16x32_bf16 v[36:39], a[80:83], v[224:227], v[36:39]
    s_mov_b32 s54, 294912
    ds_read_b64_tr_b16 a[120:121], v4 offset:17504
    ds_read_b64_tr_b16 a[122:123], v4 offset:17632
    v_mfma_f32_16x16x32_bf16 v[36:39], a[84:87], v[232:235], v[36:39]
    v_permlane32_swap_b32 v52, v54
    v_mfma_f32_16x16x32_bf16 v[36:39], a[88:91], v[240:243], v[36:39]
    v_permlane32_swap_b32 v53, v55
    v_mfma_f32_16x16x32_bf16 v[36:39], a[92:95], v[248:251], v[36:39]
    s_waitcnt vmcnt(27)
    s_barrier
    s_waitcnt lgkmcnt(10)
    ds_read_b64_tr_b16 a[124:125], v4 offset:17760
    ds_read_b64_tr_b16 a[126:127], v4 offset:17888
    ds_read_b128 v[60:63], v58
    buffer_store_dwordx4 v[52:55], v10, s[40:43], s54 offen offset:0 sc1
    v_mfma_f32_16x16x32_bf16 v[40:43], a[96:99], v[128:131], 0
    s_add_u32 m0, s44, 36864
    ds_read_b64_tr_b16 a[64:65], v4 offset:36864
    ds_read_b64_tr_b16 a[66:67], v4 offset:36992
    v_mfma_f32_16x16x32_bf16 v[40:43], a[100:103], v[136:139], v[40:43]
    s_mov_b32 s45, 384
    s_waitcnt lgkmcnt(11)
    buffer_load_dwordx4 v7, s[28:31], s45 offen offset:0 lds
    v_mfma_f32_16x16x32_bf16 v[40:43], a[104:107], v[144:147], v[40:43]
    s_add_u32 m0, s44, 36768
    ds_read_b64_tr_b16 a[68:69], v4 offset:37120
    ds_read_b64_tr_b16 a[70:71], v4 offset:37248
    v_mfma_f32_16x16x32_bf16 v[40:43], a[108:111], v[152:155], v[40:43]
    s_waitcnt lgkmcnt(9)
    buffer_load_dwordx4 v7, s[28:31], s45 offen offset:1152 lds
    v_mfma_f32_16x16x32_bf16 v[40:43], a[112:115], v[192:195], v[40:43]
    s_add_u32 m0, s44, 36672
    ds_read_b64_tr_b16 a[72:73], v4 offset:37376
    ds_read_b64_tr_b16 a[74:75], v4 offset:37504
    v_mfma_f32_16x16x32_bf16 v[40:43], a[116:119], v[200:203], v[40:43]
    s_waitcnt lgkmcnt(7)
    buffer_load_dwordx4 v7, s[28:31], s45 offen offset:2304 lds
    v_mfma_f32_16x16x32_bf16 v[40:43], a[120:123], v[208:211], v[40:43]
    s_add_u32 m0, s44, 36576
    ds_read_b64_tr_b16 a[76:77], v4 offset:37632
    ds_read_b64_tr_b16 a[78:79], v4 offset:37760
    v_mfma_f32_16x16x32_bf16 v[40:43], a[124:127], v[216:219], v[40:43]
    s_waitcnt lgkmcnt(8)
    buffer_load_dwordx4 v7, s[28:31], s45 offen offset:3456 lds
    v_or3_b32 v60, v60, v61, v62
    v_or_b32 v60, v60, v63
    v_mfma_f32_16x16x32_bf16 v[44:47], a[96:99], v[160:163], 0
    s_add_u32 m0, s44, 53760
    ds_read_b64_tr_b16 a[80:81], v4 offset:53760
    ds_read_b64_tr_b16 a[82:83], v4 offset:53888
    v_mfma_f32_16x16x32_bf16 v[44:47], a[100:103], v[168:171], v[44:47]
    s_mov_b32 s45, 147840
    buffer_load_dwordx4 v7, s[28:31], s45 offen offset:0 lds
    v_mfma_f32_16x16x32_bf16 v[44:47], a[104:107], v[176:179], v[44:47]
    s_add_u32 m0, s44, 53664
    ds_read_b64_tr_b16 a[84:85], v4 offset:54016
    ds_read_b64_tr_b16 a[86:87], v4 offset:54144
    v_mfma_f32_16x16x32_bf16 v[44:47], a[108:111], v[184:187], v[44:47]
    buffer_load_dwordx4 v7, s[28:31], s45 offen offset:1152 lds
    v_mfma_f32_16x16x32_bf16 v[44:47], a[112:115], v[224:227], v[44:47]
    s_add_u32 m0, s44, 53568
    ds_read_b64_tr_b16 a[88:89], v4 offset:54272
    ds_read_b64_tr_b16 a[90:91], v4 offset:54400
    v_mfma_f32_16x16x32_bf16 v[44:47], a[116:119], v[232:235], v[44:47]
    buffer_load_dwordx4 v7, s[28:31], s45 offen offset:2304 lds
    v_mfma_f32_16x16x32_bf16 v[44:47], a[120:123], v[240:243], v[44:47]
    s_add_u32 m0, s44, 53472
    ds_read_b64_tr_b16 a[92:93], v4 offset:54528
    ds_read_b64_tr_b16 a[94:95], v4 offset:54656
    v_mfma_f32_16x16x32_bf16 v[44:47], a[124:127], v[248:251], v[44:47]
    s_waitcnt lgkmcnt(12)
    buffer_load_dwordx4 v7, s[28:31], s45 offen offset:3456 lds
    v_readfirstlane_b32 s3, v60
    v_mfma_f32_16x16x32_bf16 v[16:19], a[64:67], v[128:131], 0
    ds_read_b64_tr_b16 a[96:97], v4 offset:36896
    v_cvt_pk_bf16_f32 v48, v32, v33
    v_mfma_f32_16x16x32_bf16 v[16:19], a[68:71], v[136:139], v[16:19]
    s_waitcnt lgkmcnt(9)
    s_cmp_lg_u32 s3, 0
    ds_read_b64_tr_b16 a[98:99], v4 offset:37024
    v_cvt_pk_bf16_f32 v49, v34, v35
    v_mfma_f32_16x16x32_bf16 v[16:19], a[72:75], v[144:147], v[16:19]
    s_cbranch_scc1 L2_fallback
    ds_read_b64_tr_b16 a[100:101], v4 offset:37152
    v_cvt_pk_bf16_f32 v50, v40, v41
    v_mfma_f32_16x16x32_bf16 v[16:19], a[76:79], v[152:155], v[16:19]
    s_waitcnt lgkmcnt(7)
    ds_read_b64_tr_b16 a[102:103], v4 offset:37280
    v_cvt_pk_bf16_f32 v51, v42, v43
    v_mfma_f32_16x16x32_bf16 v[16:19], a[80:83], v[192:195], v[16:19]
    s_mov_b32 s54, 0
    ds_read_b64_tr_b16 a[104:105], v4 offset:37408
    ds_read_b64_tr_b16 a[106:107], v4 offset:37536
    v_mfma_f32_16x16x32_bf16 v[16:19], a[84:87], v[200:203], v[16:19]
    s_waitcnt lgkmcnt(6)
    v_permlane32_swap_b32 v48, v50
    v_mfma_f32_16x16x32_bf16 v[16:19], a[88:91], v[208:211], v[16:19]
    v_permlane32_swap_b32 v49, v51
    v_mfma_f32_16x16x32_bf16 v[16:19], a[92:95], v[216:219], v[16:19]
    ds_read_b64_tr_b16 a[108:109], v4 offset:37664
    ds_read_b64_tr_b16 a[110:111], v4 offset:37792
    buffer_store_dwordx4 v[48:51], v10, s[40:43], s54 offen offset:512 sc1
    v_mfma_f32_16x16x32_bf16 v[20:23], a[64:67], v[160:163], 0
    ds_read_b64_tr_b16 a[112:113], v4 offset:53792
    v_cvt_pk_bf16_f32 v52, v36, v37
    v_mfma_f32_16x16x32_bf16 v[20:23], a[68:71], v[168:171], v[20:23]
    ds_read_b64_tr_b16 a[114:115], v4 offset:53920
    v_cvt_pk_bf16_f32 v53, v38, v39
    v_mfma_f32_16x16x32_bf16 v[20:23], a[72:75], v[176:179], v[20:23]
    ds_read_b64_tr_b16 a[116:117], v4 offset:54048
    v_cvt_pk_bf16_f32 v54, v44, v45
    v_mfma_f32_16x16x32_bf16 v[20:23], a[76:79], v[184:187], v[20:23]
    ds_read_b64_tr_b16 a[118:119], v4 offset:54176
    v_cvt_pk_bf16_f32 v55, v46, v47
    v_mfma_f32_16x16x32_bf16 v[20:23], a[80:83], v[224:227], v[20:23]
    s_mov_b32 s54, 294912
    ds_read_b64_tr_b16 a[120:121], v4 offset:54304
    ds_read_b64_tr_b16 a[122:123], v4 offset:54432
    v_mfma_f32_16x16x32_bf16 v[20:23], a[84:87], v[232:235], v[20:23]
    v_permlane32_swap_b32 v52, v54
    v_mfma_f32_16x16x32_bf16 v[20:23], a[88:91], v[240:243], v[20:23]
    v_permlane32_swap_b32 v53, v55
    v_mfma_f32_16x16x32_bf16 v[20:23], a[92:95], v[248:251], v[20:23]
    s_waitcnt lgkmcnt(10)
    ds_read_b64_tr_b16 a[124:125], v4 offset:54560
    ds_read_b64_tr_b16 a[126:127], v4 offset:54688
    buffer_store_dwordx4 v[52:55], v10, s[40:43], s54 offen offset:512 sc1
    v_mfma_f32_16x16x32_bf16 v[24:27], a[96:99], v[128:131], 0
    s_mul_i32 s3, s51, 288
    ds_read_b64_tr_b16 a[64:65], v4 offset:36928
    v_lshrrev_b32 v14, 3, v0
    v_mfma_f32_16x16x32_bf16 v[24:27], a[100:103], v[136:139], v[24:27]
    s_waitcnt lgkmcnt(9)
    ds_read_b64_tr_b16 a[66:67], v4 offset:37056
    v_lshl_add_u32 v12, v14, 4, s3
    v_mfma_f32_16x16x32_bf16 v[24:27], a[104:107], v[144:147], v[24:27]
    ds_read_b64_tr_b16 a[68:69], v4 offset:37184
    v_and_b32 v14, 1, v14
    v_mfma_f32_16x16x32_bf16 v[24:27], a[108:111], v[152:155], v[24:27]
    s_waitcnt lgkmcnt(7)
    ds_read_b64_tr_b16 a[70:71], v4 offset:37312
    v_lshl_add_u32 v13, v14, 4, s3
    v_mfma_f32_16x16x32_bf16 v[24:27], a[112:115], v[192:195], v[24:27]
    ds_read_b64_tr_b16 a[72:73], v4 offset:37440
    v_and_b32 v14, 7, v0
    v_mfma_f32_16x16x32_bf16 v[24:27], a[116:119], v[200:203], v[24:27]
    s_waitcnt lgkmcnt(5)
    ds_read_b64_tr_b16 a[74:75], v4 offset:37568
    v_mul_u32_u24 v14, 1152, v14
    v_mfma_f32_16x16x32_bf16 v[24:27], a[120:123], v[208:211], v[24:27]
    ds_read_b64_tr_b16 a[76:77], v4 offset:37696
    v_add_u32 v1, v14, v12
    v_mfma_f32_16x16x32_bf16 v[24:27], a[124:127], v[216:219], v[24:27]
    ds_read_b64_tr_b16 a[78:79], v4 offset:37824
    v_add_u32 v2, v14, v13
    v_mfma_f32_16x16x32_bf16 v[28:31], a[96:99], v[160:163], 0
    ds_read_b64_tr_b16 a[80:81], v4 offset:53824
    v_add_u32 v2, 256, v2
    v_mfma_f32_16x16x32_bf16 v[28:31], a[100:103], v[168:171], v[28:31]
    s_mul_i32 s14, s51, 2304
    ds_read_b64_tr_b16 a[82:83], v4 offset:53952
    v_add_u32 v5, s14, v8
    v_mfma_f32_16x16x32_bf16 v[28:31], a[104:107], v[176:179], v[28:31]
    ds_read_b64_tr_b16 a[84:85], v4 offset:54080
    v_and_b32 v59, 0xf0, v8
    v_mfma_f32_16x16x32_bf16 v[28:31], a[108:111], v[184:187], v[28:31]
    ds_read_b64_tr_b16 a[86:87], v4 offset:54208
    v_add_u32 v59, s14, v59
    v_mfma_f32_16x16x32_bf16 v[28:31], a[112:115], v[224:227], v[28:31]
    ds_read_b64_tr_b16 a[88:89], v4 offset:54336
    v_mfma_f32_16x16x32_bf16 v[28:31], a[116:119], v[232:235], v[28:31]
    ds_read_b64_tr_b16 a[90:91], v4 offset:54464
    v_mfma_f32_16x16x32_bf16 v[28:31], a[120:123], v[240:243], v[28:31]
    ds_read_b64_tr_b16 a[92:93], v4 offset:54592
    v_mfma_f32_16x16x32_bf16 v[28:31], a[124:127], v[248:251], v[28:31]
    s_waitcnt lgkmcnt(11)
    ds_read_b64_tr_b16 a[94:95], v4 offset:54720
    v_mfma_f32_16x16x32_bf16 v[32:35], a[64:67], v[128:131], 0
    ds_read_b64_tr_b16 a[96:97], v4 offset:36960
    v_cvt_pk_bf16_f32 v48, v16, v17
    v_mfma_f32_16x16x32_bf16 v[32:35], a[68:71], v[136:139], v[32:35]
    s_waitcnt lgkmcnt(9)
    ds_read_b64_tr_b16 a[98:99], v4 offset:37088
    v_cvt_pk_bf16_f32 v49, v18, v19
    v_mfma_f32_16x16x32_bf16 v[32:35], a[72:75], v[144:147], v[32:35]
    ds_read_b64_tr_b16 a[100:101], v4 offset:37216
    v_cvt_pk_bf16_f32 v50, v24, v25
    v_mfma_f32_16x16x32_bf16 v[32:35], a[76:79], v[152:155], v[32:35]
    s_waitcnt lgkmcnt(7)
    ds_read_b64_tr_b16 a[102:103], v4 offset:37344
    v_cvt_pk_bf16_f32 v51, v26, v27
    v_mfma_f32_16x16x32_bf16 v[32:35], a[80:83], v[192:195], v[32:35]
    s_mov_b32 s54, 1024
    ds_read_b64_tr_b16 a[104:105], v4 offset:37472
    ds_read_b64_tr_b16 a[106:107], v4 offset:37600
    v_mfma_f32_16x16x32_bf16 v[32:35], a[84:87], v[200:203], v[32:35]
    s_waitcnt lgkmcnt(6)
    v_permlane32_swap_b32 v48, v50
    v_mfma_f32_16x16x32_bf16 v[32:35], a[88:91], v[208:211], v[32:35]
    v_permlane32_swap_b32 v49, v51
    v_mfma_f32_16x16x32_bf16 v[32:35], a[92:95], v[216:219], v[32:35]
    ds_read_b64_tr_b16 a[108:109], v4 offset:37728
    ds_read_b64_tr_b16 a[110:111], v4 offset:37856
    buffer_store_dwordx4 v[48:51], v10, s[40:43], s54 offen offset:0 sc1
    v_mfma_f32_16x16x32_bf16 v[36:39], a[64:67], v[160:163], 0
    ds_read_b64_tr_b16 a[112:113], v4 offset:53856
    v_cvt_pk_bf16_f32 v52, v20, v21
    v_mfma_f32_16x16x32_bf16 v[36:39], a[68:71], v[168:171], v[36:39]
    ds_read_b64_tr_b16 a[114:115], v4 offset:53984
    v_cvt_pk_bf16_f32 v53, v22, v23
    v_mfma_f32_16x16x32_bf16 v[36:39], a[72:75], v[176:179], v[36:39]
    ds_read_b64_tr_b16 a[116:117], v4 offset:54112
    v_cvt_pk_bf16_f32 v54, v28, v29
    v_mfma_f32_16x16x32_bf16 v[36:39], a[76:79], v[184:187], v[36:39]
    ds_read_b64_tr_b16 a[118:119], v4 offset:54240
    v_cvt_pk_bf16_f32 v55, v30, v31
    v_mfma_f32_16x16x32_bf16 v[36:39], a[80:83], v[224:227], v[36:39]
    s_mov_b32 s54, 295936
    ds_read_b64_tr_b16 a[120:121], v4 offset:54368
    ds_read_b64_tr_b16 a[122:123], v4 offset:54496
    v_mfma_f32_16x16x32_bf16 v[36:39], a[84:87], v[232:235], v[36:39]
    v_permlane32_swap_b32 v52, v54
    v_mfma_f32_16x16x32_bf16 v[36:39], a[88:91], v[240:243], v[36:39]
    v_permlane32_swap_b32 v53, v55
    v_mfma_f32_16x16x32_bf16 v[36:39], a[92:95], v[248:251], v[36:39]
    s_waitcnt vmcnt(31)
    s_barrier
    s_waitcnt lgkmcnt(10)
    ds_read_b64_tr_b16 a[124:125], v4 offset:54624
    ds_read_b64_tr_b16 a[126:127], v4 offset:54752
    buffer_store_dwordx4 v[52:55], v10, s[40:43], s54 offen offset:0 sc1
    v_mfma_f32_16x16x32_bf16 v[40:43], a[96:99], v[128:131], 0
    s_add_u32 m0, s44, 73728
    ds_read_b64_tr_b16 a[64:65], v3 offset:0
    ds_read_b64_tr_b16 a[66:67], v3 offset:128
    v_mfma_f32_16x16x32_bf16 v[40:43], a[100:103], v[136:139], v[40:43]
    s_mov_b32 s45, 512
    s_waitcnt lgkmcnt(10)
    buffer_load_dwordx4 v7, s[28:31], s45 offen offset:0 lds
    v_mfma_f32_16x16x32_bf16 v[40:43], a[104:107], v[144:147], v[40:43]
    s_add_u32 m0, s44, 73632
    ds_read_b64_tr_b16 a[68:69], v3 offset:256
    ds_read_b64_tr_b16 a[70:71], v3 offset:384
    v_mfma_f32_16x16x32_bf16 v[40:43], a[108:111], v[152:155], v[40:43]
    s_waitcnt lgkmcnt(8)
    buffer_load_dwordx4 v7, s[28:31], s45 offen offset:1152 lds
    v_mfma_f32_16x16x32_bf16 v[40:43], a[112:115], v[192:195], v[40:43]
    s_add_u32 m0, s44, 73536
    ds_read_b64_tr_b16 a[72:73], v3 offset:512
    ds_read_b64_tr_b16 a[74:75], v3 offset:640
    v_mfma_f32_16x16x32_bf16 v[40:43], a[116:119], v[200:203], v[40:43]
    s_waitcnt lgkmcnt(6)
    buffer_load_dwordx4 v7, s[28:31], s45 offen offset:2304 lds
    v_mfma_f32_16x16x32_bf16 v[40:43], a[120:123], v[208:211], v[40:43]
    s_add_u32 m0, s44, 73440
    ds_read_b64_tr_b16 a[76:77], v3 offset:768
    ds_read_b64_tr_b16 a[78:79], v3 offset:896
    v_mfma_f32_16x16x32_bf16 v[40:43], a[124:127], v[216:219], v[40:43]
    buffer_load_dwordx4 v7, s[28:31], s45 offen offset:3456 lds
    v_mfma_f32_16x16x32_bf16 v[44:47], a[96:99], v[160:163], 0
    s_add_u32 m0, s44, 90624
    ds_read_b64_tr_b16 a[80:81], v3 offset:16896
    ds_read_b64_tr_b16 a[82:83], v3 offset:17024
    v_mfma_f32_16x16x32_bf16 v[44:47], a[100:103], v[168:171], v[44:47]
    s_mov_b32 s45, 147968
    buffer_load_dwordx4 v7, s[28:31], s45 offen offset:0 lds
    v_mfma_f32_16x16x32_bf16 v[44:47], a[104:107], v[176:179], v[44:47]
    s_add_u32 m0, s44, 90528
    ds_read_b64_tr_b16 a[84:85], v3 offset:17152
    ds_read_b64_tr_b16 a[86:87], v3 offset:17280
    v_mfma_f32_16x16x32_bf16 v[44:47], a[108:111], v[184:187], v[44:47]
    buffer_load_dwordx4 v7, s[28:31], s45 offen offset:1152 lds
    v_mfma_f32_16x16x32_bf16 v[44:47], a[112:115], v[224:227], v[44:47]
    s_add_u32 m0, s44, 90432
    ds_read_b64_tr_b16 a[88:89], v3 offset:17408
    ds_read_b64_tr_b16 a[90:91], v3 offset:17536
    v_mfma_f32_16x16x32_bf16 v[44:47], a[116:119], v[232:235], v[44:47]
    buffer_load_dwordx4 v7, s[28:31], s45 offen offset:2304 lds
    v_mfma_f32_16x16x32_bf16 v[44:47], a[120:123], v[240:243], v[44:47]
    s_add_u32 m0, s44, 90336
    ds_read_b64_tr_b16 a[92:93], v3 offset:17664
    ds_read_b64_tr_b16 a[94:95], v3 offset:17792
    v_mfma_f32_16x16x32_bf16 v[44:47], a[124:127], v[248:251], v[44:47]
    s_waitcnt lgkmcnt(12)
    buffer_load_dwordx4 v7, s[28:31], s45 offen offset:3456 lds
    v_mfma_f32_16x16x32_bf16 v[16:19], a[64:67], v[128:131], 0
    ds_read_b64_tr_b16 a[96:97], v3 offset:32
    v_cvt_pk_bf16_f32 v48, v32, v33
    v_mfma_f32_16x16x32_bf16 v[16:19], a[68:71], v[136:139], v[16:19]
    s_waitcnt lgkmcnt(9)
    ds_read_b64_tr_b16 a[98:99], v3 offset:160
    v_cvt_pk_bf16_f32 v49, v34, v35
    v_mfma_f32_16x16x32_bf16 v[16:19], a[72:75], v[144:147], v[16:19]
    ds_read_b64_tr_b16 a[100:101], v3 offset:288
    v_cvt_pk_bf16_f32 v50, v40, v41
    v_mfma_f32_16x16x32_bf16 v[16:19], a[76:79], v[152:155], v[16:19]
    s_waitcnt lgkmcnt(7)
    ds_read_b64_tr_b16 a[102:103], v3 offset:416
    v_cvt_pk_bf16_f32 v51, v42, v43
    v_mfma_f32_16x16x32_bf16 v[16:19], a[80:83], v[192:195], v[16:19]
    s_mov_b32 s54, 1024
    ds_read_b64_tr_b16 a[104:105], v3 offset:544
    ds_read_b64_tr_b16 a[106:107], v3 offset:672
    v_mfma_f32_16x16x32_bf16 v[16:19], a[84:87], v[200:203], v[16:19]
    s_waitcnt lgkmcnt(6)
    v_permlane32_swap_b32 v48, v50
    v_mfma_f32_16x16x32_bf16 v[16:19], a[88:91], v[208:211], v[16:19]
    v_permlane32_swap_b32 v49, v51
    v_mfma_f32_16x16x32_bf16 v[16:19], a[92:95], v[216:219], v[16:19]
    ds_read_b64_tr_b16 a[108:109], v3 offset:800
    ds_read_b64_tr_b16 a[110:111], v3 offset:928
    buffer_store_dwordx4 v[48:51], v10, s[40:43], s54 offen offset:512 sc1
    v_mfma_f32_16x16x32_bf16 v[20:23], a[64:67], v[160:163], 0
    ds_read_b64_tr_b16 a[112:113], v3 offset:16928
    v_cvt_pk_bf16_f32 v52, v36, v37
    v_mfma_f32_16x16x32_bf16 v[20:23], a[68:71], v[168:171], v[20:23]
    ds_read_b64_tr_b16 a[114:115], v3 offset:17056
    v_cvt_pk_bf16_f32 v53, v38, v39
    v_mfma_f32_16x16x32_bf16 v[20:23], a[72:75], v[176:179], v[20:23]
    ds_read_b64_tr_b16 a[116:117], v3 offset:17184
    v_cvt_pk_bf16_f32 v54, v44, v45
    v_mfma_f32_16x16x32_bf16 v[20:23], a[76:79], v[184:187], v[20:23]
    ds_read_b64_tr_b16 a[118:119], v3 offset:17312
    v_cvt_pk_bf16_f32 v55, v46, v47
    v_mfma_f32_16x16x32_bf16 v[20:23], a[80:83], v[224:227], v[20:23]
    s_mov_b32 s54, 295936
    ds_read_b64_tr_b16 a[120:121], v3 offset:17440
    ds_read_b64_tr_b16 a[122:123], v3 offset:17568
    v_mfma_f32_16x16x32_bf16 v[20:23], a[84:87], v[232:235], v[20:23]
    v_permlane32_swap_b32 v52, v54
    v_mfma_f32_16x16x32_bf16 v[20:23], a[88:91], v[240:243], v[20:23]
    v_permlane32_swap_b32 v53, v55
    v_mfma_f32_16x16x32_bf16 v[20:23], a[92:95], v[248:251], v[20:23]
    s_waitcnt lgkmcnt(10)
    ds_read_b64_tr_b16 a[124:125], v3 offset:17696
    ds_read_b64_tr_b16 a[126:127], v3 offset:17824
    buffer_store_dwordx4 v[52:55], v10, s[40:43], s54 offen offset:512 sc1
    v_mfma_f32_16x16x32_bf16 v[24:27], a[96:99], v[128:131], 0
    ds_read_b64_tr_b16 a[64:65], v3 offset:64
    v_mfma_f32_16x16x32_bf16 v[24:27], a[100:103], v[136:139], v[24:27]
    s_waitcnt lgkmcnt(9)
    ds_read_b64_tr_b16 a[66:67], v3 offset:192
    v_mfma_f32_16x16x32_bf16 v[24:27], a[104:107], v[144:147], v[24:27]
    ds_read_b64_tr_b16 a[68:69], v3 offset:320
    v_mfma_f32_16x16x32_bf16 v[24:27], a[108:111], v[152:155], v[24:27]
    s_waitcnt lgkmcnt(7)
    ds_read_b64_tr_b16 a[70:71], v3 offset:448
    v_mfma_f32_16x16x32_bf16 v[24:27], a[112:115], v[192:195], v[24:27]
    ds_read_b64_tr_b16 a[72:73], v3 offset:576
    v_mfma_f32_16x16x32_bf16 v[24:27], a[116:119], v[200:203], v[24:27]
    s_waitcnt lgkmcnt(5)
    ds_read_b64_tr_b16 a[74:75], v3 offset:704
    v_mfma_f32_16x16x32_bf16 v[24:27], a[120:123], v[208:211], v[24:27]
    ds_read_b64_tr_b16 a[76:77], v3 offset:832
    v_mfma_f32_16x16x32_bf16 v[24:27], a[124:127], v[216:219], v[24:27]
    ds_read_b64_tr_b16 a[78:79], v3 offset:960
    v_mfma_f32_16x16x32_bf16 v[28:31], a[96:99], v[160:163], 0
    ds_read_b64_tr_b16 a[80:81], v3 offset:16960
    v_mfma_f32_16x16x32_bf16 v[28:31], a[100:103], v[168:171], v[28:31]
    ds_read_b64_tr_b16 a[82:83], v3 offset:17088
    v_mfma_f32_16x16x32_bf16 v[28:31], a[104:107], v[176:179], v[28:31]
    ds_read_b64_tr_b16 a[84:85], v3 offset:17216
    v_mfma_f32_16x16x32_bf16 v[28:31], a[108:111], v[184:187], v[28:31]
    ds_read_b64_tr_b16 a[86:87], v3 offset:17344
    v_mfma_f32_16x16x32_bf16 v[28:31], a[112:115], v[224:227], v[28:31]
    ds_read_b64_tr_b16 a[88:89], v3 offset:17472
    v_mfma_f32_16x16x32_bf16 v[28:31], a[116:119], v[232:235], v[28:31]
    ds_read_b64_tr_b16 a[90:91], v3 offset:17600
    v_mfma_f32_16x16x32_bf16 v[28:31], a[120:123], v[240:243], v[28:31]
    ds_read_b64_tr_b16 a[92:93], v3 offset:17728
    v_mfma_f32_16x16x32_bf16 v[28:31], a[124:127], v[248:251], v[28:31]
    s_waitcnt lgkmcnt(11)
    ds_read_b64_tr_b16 a[94:95], v3 offset:17856
    v_mfma_f32_16x16x32_bf16 v[32:35], a[64:67], v[128:131], 0
    ds_read_b64_tr_b16 a[96:97], v3 offset:96
    v_cvt_pk_bf16_f32 v48, v16, v17
    v_mfma_f32_16x16x32_bf16 v[32:35], a[68:71], v[136:139], v[32:35]
    s_waitcnt lgkmcnt(9)
    ds_read_b64_tr_b16 a[98:99], v3 offset:224
    v_cvt_pk_bf16_f32 v49, v18, v19
    v_mfma_f32_16x16x32_bf16 v[32:35], a[72:75], v[144:147], v[32:35]
    ds_read_b64_tr_b16 a[100:101], v3 offset:352
    v_cvt_pk_bf16_f32 v50, v24, v25
    v_mfma_f32_16x16x32_bf16 v[32:35], a[76:79], v[152:155], v[32:35]
    s_waitcnt lgkmcnt(7)
    ds_read_b64_tr_b16 a[102:103], v3 offset:480
    v_cvt_pk_bf16_f32 v51, v26, v27
    v_mfma_f32_16x16x32_bf16 v[32:35], a[80:83], v[192:195], v[32:35]
    s_mov_b32 s54, 2048
    ds_read_b64_tr_b16 a[104:105], v3 offset:608
    ds_read_b64_tr_b16 a[106:107], v3 offset:736
    v_mfma_f32_16x16x32_bf16 v[32:35], a[84:87], v[200:203], v[32:35]
    s_waitcnt lgkmcnt(6)
    v_permlane32_swap_b32 v48, v50
    v_mfma_f32_16x16x32_bf16 v[32:35], a[88:91], v[208:211], v[32:35]
    v_permlane32_swap_b32 v49, v51
    v_mfma_f32_16x16x32_bf16 v[32:35], a[92:95], v[216:219], v[32:35]
    ds_read_b64_tr_b16 a[108:109], v3 offset:864
    ds_read_b64_tr_b16 a[110:111], v3 offset:992
    buffer_store_dwordx4 v[48:51], v10, s[40:43], s54 offen offset:0 sc1
    v_mfma_f32_16x16x32_bf16 v[36:39], a[64:67], v[160:163], 0
    ds_read_b64_tr_b16 a[112:113], v3 offset:16992
    v_cvt_pk_bf16_f32 v52, v20, v21
    v_mfma_f32_16x16x32_bf16 v[36:39], a[68:71], v[168:171], v[36:39]
    ds_read_b64_tr_b16 a[114:115], v3 offset:17120
    v_cvt_pk_bf16_f32 v53, v22, v23
    v_mfma_f32_16x16x32_bf16 v[36:39], a[72:75], v[176:179], v[36:39]
    ds_read_b64_tr_b16 a[116:117], v3 offset:17248
    v_cvt_pk_bf16_f32 v54, v28, v29
    v_mfma_f32_16x16x32_bf16 v[36:39], a[76:79], v[184:187], v[36:39]
    ds_read_b64_tr_b16 a[118:119], v3 offset:17376
    v_cvt_pk_bf16_f32 v55, v30, v31
    v_mfma_f32_16x16x32_bf16 v[36:39], a[80:83], v[224:227], v[36:39]
    s_mov_b32 s54, 296960
    ds_read_b64_tr_b16 a[120:121], v3 offset:17504
    ds_read_b64_tr_b16 a[122:123], v3 offset:17632
    v_mfma_f32_16x16x32_bf16 v[36:39], a[84:87], v[232:235], v[36:39]
    v_permlane32_swap_b32 v52, v54
    v_mfma_f32_16x16x32_bf16 v[36:39], a[88:91], v[240:243], v[36:39]
    v_permlane32_swap_b32 v53, v55
    v_mfma_f32_16x16x32_bf16 v[36:39], a[92:95], v[248:251], v[36:39]
    s_waitcnt vmcnt(15)
    s_barrier
    s_waitcnt lgkmcnt(10)
    ds_read_b64_tr_b16 a[124:125], v3 offset:17760
    ds_read_b64_tr_b16 a[126:127], v3 offset:17888
    buffer_store_dwordx4 v[52:55], v10, s[40:43], s54 offen offset:0 sc1
    v_mfma_f32_16x16x32_bf16 v[40:43], a[96:99], v[128:131], 0
L2_pad10:
    s_cbranch_execz L2_pad14
    s_add_u32 m0, s44, 110592
    ds_read_b64_tr_b16 a[64:65], v3 offset:36864
    ds_read_b64_tr_b16 a[66:67], v3 offset:36992
    v_mfma_f32_16x16x32_bf16 v[40:43], a[100:103], v[136:139], v[40:43]
    s_mov_b32 s45, 640
    s_waitcnt lgkmcnt(10)
    buffer_load_dwordx4 v7, s[28:31], s45 offen offset:0 lds
    v_mfma_f32_16x16x32_bf16 v[40:43], a[104:107], v[144:147], v[40:43]
    s_add_u32 m0, s44, 110496
    ds_read_b64_tr_b16 a[68:69], v3 offset:37120
    ds_read_b64_tr_b16 a[70:71], v3 offset:37248
    v_mfma_f32_16x16x32_bf16 v[40:43], a[108:111], v[152:155], v[40:43]
    s_waitcnt lgkmcnt(8)
    buffer_load_dwordx4 v7, s[28:31], s45 offen offset:1152 lds
    v_mfma_f32_16x16x32_bf16 v[40:43], a[112:115], v[192:195], v[40:43]
    s_add_u32 m0, s44, 110400
    ds_read_b64_tr_b16 a[72:73], v3 offset:37376
    ds_read_b64_tr_b16 a[74:75], v3 offset:37504
    v_mfma_f32_16x16x32_bf16 v[40:43], a[116:119], v[200:203], v[40:43]
    s_waitcnt lgkmcnt(6)
    buffer_load_dwordx4 v7, s[28:31], s45 offen offset:2304 lds
    v_mfma_f32_16x16x32_bf16 v[40:43], a[120:123], v[208:211], v[40:43]
    s_add_u32 m0, s44, 110304
    ds_read_b64_tr_b16 a[76:77], v3 offset:37632
    ds_read_b64_tr_b16 a[78:79], v3 offset:37760
    v_mfma_f32_16x16x32_bf16 v[40:43], a[124:127], v[216:219], v[40:43]
    buffer_load_dwordx4 v7, s[28:31], s45 offen offset:3456 lds
    v_mfma_f32_16x16x32_bf16 v[44:47], a[96:99], v[160:163], 0
    s_add_u32 m0, s44, 127488
    ds_read_b64_tr_b16 a[80:81], v3 offset:53760
    ds_read_b64_tr_b16 a[82:83], v3 offset:53888
    v_mfma_f32_16x16x32_bf16 v[44:47], a[100:103], v[168:171], v[44:47]
    s_mov_b32 s45, 148096
    buffer_load_dwordx4 v7, s[28:31], s45 offen offset:0 lds
    v_mfma_f32_16x16x32_bf16 v[44:47], a[104:107], v[176:179], v[44:47]
    s_add_u32 m0, s44, 127392
    ds_read_b64_tr_b16 a[84:85], v3 offset:54016
    ds_read_b64_tr_b16 a[86:87], v3 offset:54144
    v_mfma_f32_16x16x32_bf16 v[44:47], a[108:111], v[184:187], v[44:47]
    buffer_load_dwordx4 v7, s[28:31], s45 offen offset:1152 lds
    v_mfma_f32_16x16x32_bf16 v[44:47], a[112:115], v[224:227], v[44:47]
    s_add_u32 m0, s44, 127296
    ds_read_b64_tr_b16 a[88:89], v3 offset:54272
    ds_read_b64_tr_b16 a[90:91], v3 offset:54400
    v_mfma_f32_16x16x32_bf16 v[44:47], a[116:119], v[232:235], v[44:47]
    buffer_load_dwordx4 v7, s[28:31], s45 offen offset:2304 lds
    v_mfma_f32_16x16x32_bf16 v[44:47], a[120:123], v[240:243], v[44:47]
    s_add_u32 m0, s44, 127200
    ds_read_b64_tr_b16 a[92:93], v3 offset:54528
    ds_read_b64_tr_b16 a[94:95], v3 offset:54656
    v_mfma_f32_16x16x32_bf16 v[44:47], a[124:127], v[248:251], v[44:47]
    s_waitcnt lgkmcnt(12)
    buffer_load_dwordx4 v7, s[28:31], s45 offen offset:3456 lds
    v_mfma_f32_16x16x32_bf16 v[16:19], a[64:67], v[128:131], 0
    ds_read_b64_tr_b16 a[96:97], v3 offset:36896
    v_cvt_pk_bf16_f32 v48, v32, v33
    v_mfma_f32_16x16x32_bf16 v[16:19], a[68:71], v[136:139], v[16:19]
    s_waitcnt lgkmcnt(9)
    ds_read_b64_tr_b16 a[98:99], v3 offset:37024
    v_cvt_pk_bf16_f32 v49, v34, v35
    v_mfma_f32_16x16x32_bf16 v[16:19], a[72:75], v[144:147], v[16:19]
    ds_read_b64_tr_b16 a[100:101], v3 offset:37152
    v_cvt_pk_bf16_f32 v50, v40, v41
    v_mfma_f32_16x16x32_bf16 v[16:19], a[76:79], v[152:155], v[16:19]
    s_waitcnt lgkmcnt(7)
    ds_read_b64_tr_b16 a[102:103], v3 offset:37280
    v_cvt_pk_bf16_f32 v51, v42, v43
    v_mfma_f32_16x16x32_bf16 v[16:19], a[80:83], v[192:195], v[16:19]
    s_mov_b32 s54, 2048
    ds_read_b64_tr_b16 a[104:105], v3 offset:37408
    ds_read_b64_tr_b16 a[106:107], v3 offset:37536
    v_mfma_f32_16x16x32_bf16 v[16:19], a[84:87], v[200:203], v[16:19]
    s_waitcnt lgkmcnt(6)
    v_permlane32_swap_b32 v48, v50
    v_mfma_f32_16x16x32_bf16 v[16:19], a[88:91], v[208:211], v[16:19]
    v_permlane32_swap_b32 v49, v51
    v_mfma_f32_16x16x32_bf16 v[16:19], a[92:95], v[216:219], v[16:19]
    ds_read_b64_tr_b16 a[108:109], v3 offset:37664
    ds_read_b64_tr_b16 a[110:111], v3 offset:37792
    buffer_store_dwordx4 v[48:51], v10, s[40:43], s54 offen offset:512 sc1
    v_mfma_f32_16x16x32_bf16 v[20:23], a[64:67], v[160:163], 0
    ds_read_b64_tr_b16 a[112:113], v3 offset:53792
    v_cvt_pk_bf16_f32 v52, v36, v37
    v_mfma_f32_16x16x32_bf16 v[20:23], a[68:71], v[168:171], v[20:23]
    ds_read_b64_tr_b16 a[114:115], v3 offset:53920
    v_cvt_pk_bf16_f32 v53, v38, v39
    v_mfma_f32_16x16x32_bf16 v[20:23], a[72:75], v[176:179], v[20:23]
    ds_read_b64_tr_b16 a[116:117], v3 offset:54048
    v_cvt_pk_bf16_f32 v54, v44, v45
    v_mfma_f32_16x16x32_bf16 v[20:23], a[76:79], v[184:187], v[20:23]
    ds_read_b64_tr_b16 a[118:119], v3 offset:54176
    v_cvt_pk_bf16_f32 v55, v46, v47
    v_mfma_f32_16x16x32_bf16 v[20:23], a[80:83], v[224:227], v[20:23]
    s_mov_b32 s54, 296960
    ds_read_b64_tr_b16 a[120:121], v3 offset:54304
    ds_read_b64_tr_b16 a[122:123], v3 offset:54432
    v_mfma_f32_16x16x32_bf16 v[20:23], a[84:87], v[232:235], v[20:23]
    v_permlane32_swap_b32 v52, v54
    v_mfma_f32_16x16x32_bf16 v[20:23], a[88:91], v[240:243], v[20:23]
    v_permlane32_swap_b32 v53, v55
    v_mfma_f32_16x16x32_bf16 v[20:23], a[92:95], v[248:251], v[20:23]
    s_waitcnt lgkmcnt(10)
    ds_read_b64_tr_b16 a[124:125], v3 offset:54560
    ds_read_b64_tr_b16 a[126:127], v3 offset:54688
    buffer_store_dwordx4 v[52:55], v10, s[40:43], s54 offen offset:512 sc1
    v_mfma_f32_16x16x32_bf16 v[24:27], a[96:99], v[128:131], 0
    ds_read_b64_tr_b16 a[64:65], v3 offset:36928
    v_mfma_f32_16x16x32_bf16 v[24:27], a[100:103], v[136:139], v[24:27]
    s_waitcnt lgkmcnt(9)
    ds_read_b64_tr_b16 a[66:67], v3 offset:37056
    v_mfma_f32_16x16x32_bf16 v[24:27], a[104:107], v[144:147], v[24:27]
    ds_read_b64_tr_b16 a[68:69], v3 offset:37184
    v_mfma_f32_16x16x32_bf16 v[24:27], a[108:111], v[152:155], v[24:27]
    s_waitcnt lgkmcnt(7)
    ds_read_b64_tr_b16 a[70:71], v3 offset:37312
    v_mfma_f32_16x16x32_bf16 v[24:27], a[112:115], v[192:195], v[24:27]
    ds_read_b64_tr_b16 a[72:73], v3 offset:37440
    v_mfma_f32_16x16x32_bf16 v[24:27], a[116:119], v[200:203], v[24:27]
    s_waitcnt lgkmcnt(5)
    ds_read_b64_tr_b16 a[74:75], v3 offset:37568
    v_mfma_f32_16x16x32_bf16 v[24:27], a[120:123], v[208:211], v[24:27]
    ds_read_b64_tr_b16 a[76:77], v3 offset:37696
    v_mfma_f32_16x16x32_bf16 v[24:27], a[124:127], v[216:219], v[24:27]
    ds_read_b64_tr_b16 a[78:79], v3 offset:37824
    v_mfma_f32_16x16x32_bf16 v[28:31], a[96:99], v[160:163], 0
    ds_read_b64_tr_b16 a[80:81], v3 offset:53824
    v_mfma_f32_16x16x32_bf16 v[28:31], a[100:103], v[168:171], v[28:31]
    ds_read_b64_tr_b16 a[82:83], v3 offset:53952
    v_mfma_f32_16x16x32_bf16 v[28:31], a[104:107], v[176:179], v[28:31]
    ds_read_b64_tr_b16 a[84:85], v3 offset:54080
    v_mfma_f32_16x16x32_bf16 v[28:31], a[108:111], v[184:187], v[28:31]
    ds_read_b64_tr_b16 a[86:87], v3 offset:54208
    v_mfma_f32_16x16x32_bf16 v[28:31], a[112:115], v[224:227], v[28:31]
    ds_read_b64_tr_b16 a[88:89], v3 offset:54336
    v_mfma_f32_16x16x32_bf16 v[28:31], a[116:119], v[232:235], v[28:31]
    ds_read_b64_tr_b16 a[90:91], v3 offset:54464
    v_mfma_f32_16x16x32_bf16 v[28:31], a[120:123], v[240:243], v[28:31]
    ds_read_b64_tr_b16 a[92:93], v3 offset:54592
    v_mfma_f32_16x16x32_bf16 v[28:31], a[124:127], v[248:251], v[28:31]
    s_waitcnt lgkmcnt(11)
    ds_read_b64_tr_b16 a[94:95], v3 offset:54720
    v_mfma_f32_16x16x32_bf16 v[32:35], a[64:67], v[128:131], 0
    ds_read_b64_tr_b16 a[96:97], v3 offset:36960
    v_cvt_pk_bf16_f32 v48, v16, v17
    v_mfma_f32_16x16x32_bf16 v[32:35], a[68:71], v[136:139], v[32:35]
    s_waitcnt lgkmcnt(9)
    ds_read_b64_tr_b16 a[98:99], v3 offset:37088
    v_cvt_pk_bf16_f32 v49, v18, v19
    v_mfma_f32_16x16x32_bf16 v[32:35], a[72:75], v[144:147], v[32:35]
    ds_read_b64_tr_b16 a[100:101], v3 offset:37216
    v_cvt_pk_bf16_f32 v50, v24, v25
    v_mfma_f32_16x16x32_bf16 v[32:35], a[76:79], v[152:155], v[32:35]
    s_waitcnt lgkmcnt(7)
    ds_read_b64_tr_b16 a[102:103], v3 offset:37344
    v_cvt_pk_bf16_f32 v51, v26, v27
    v_mfma_f32_16x16x32_bf16 v[32:35], a[80:83], v[192:195], v[32:35]
    s_mov_b32 s54, 3072
    ds_read_b64_tr_b16 a[104:105], v3 offset:37472
    ds_read_b64_tr_b16 a[106:107], v3 offset:37600
    v_mfma_f32_16x16x32_bf16 v[32:35], a[84:87], v[200:203], v[32:35]
    s_waitcnt lgkmcnt(6)
    v_permlane32_swap_b32 v48, v50
    v_mfma_f32_16x16x32_bf16 v[32:35], a[88:91], v[208:211], v[32:35]
    v_permlane32_swap_b32 v49, v51
    v_mfma_f32_16x16x32_bf16 v[32:35], a[92:95], v[216:219], v[32:35]
    ds_read_b64_tr_b16 a[108:109], v3 offset:37728
    ds_read_b64_tr_b16 a[110:111], v3 offset:37856
    buffer_store_dwordx4 v[48:51], v10, s[40:43], s54 offen offset:0 sc1
    v_mfma_f32_16x16x32_bf16 v[36:39], a[64:67], v[160:163], 0
    ds_read_b64_tr_b16 a[112:113], v3 offset:53856
    v_cvt_pk_bf16_f32 v52, v20, v21
    v_mfma_f32_16x16x32_bf16 v[36:39], a[68:71], v[168:171], v[36:39]
    ds_read_b64_tr_b16 a[114:115], v3 offset:53984
    v_cvt_pk_bf16_f32 v53, v22, v23
    v_mfma_f32_16x16x32_bf16 v[36:39], a[72:75], v[176:179], v[36:39]
    ds_read_b64_tr_b16 a[116:117], v3 offset:54112
    v_cvt_pk_bf16_f32 v54, v28, v29
    v_mfma_f32_16x16x32_bf16 v[36:39], a[76:79], v[184:187], v[36:39]
    ds_read_b64_tr_b16 a[118:119], v3 offset:54240
    v_cvt_pk_bf16_f32 v55, v30, v31
    v_mfma_f32_16x16x32_bf16 v[36:39], a[80:83], v[224:227], v[36:39]
    s_mov_b32 s54, 297984
    ds_read_b64_tr_b16 a[120:121], v3 offset:54368
    ds_read_b64_tr_b16 a[122:123], v3 offset:54496
    v_mfma_f32_16x16x32_bf16 v[36:39], a[84:87], v[232:235], v[36:39]
    v_permlane32_swap_b32 v52, v54
    v_mfma_f32_16x16x32_bf16 v[36:39], a[88:91], v[240:243], v[36:39]
    v_permlane32_swap_b32 v53, v55
    v_mfma_f32_16x16x32_bf16 v[36:39], a[92:95], v[248:251], v[36:39]
    s_waitcnt vmcnt(15)
    s_barrier
    s_waitcnt lgkmcnt(10)
    ds_read_b64_tr_b16 a[124:125], v3 offset:54624
    ds_read_b64_tr_b16 a[126:127], v3 offset:54752
    buffer_store_dwordx4 v[52:55], v10, s[40:43], s54 offen offset:0 sc1
    v_mfma_f32_16x16x32_bf16 v[40:43], a[96:99], v[128:131], 0
    s_add_u32 m0, s44, 0
    ds_read_b64_tr_b16 a[64:65], v4 offset:0
    ds_read_b64_tr_b16 a[66:67], v4 offset:128
    v_mfma_f32_16x16x32_bf16 v[40:43], a[100:103], v[136:139], v[40:43]
    s_mov_b32 s45, 768
    s_waitcnt lgkmcnt(10)
    buffer_load_dwordx4 v7, s[28:31], s45 offen offset:0 lds
    v_mfma_f32_16x16x32_bf16 v[40:43], a[104:107], v[144:147], v[40:43]
    s_add_u32 m0, s44, -96
    ds_read_b64_tr_b16 a[68:69], v4 offset:256
    ds_read_b64_tr_b16 a[70:71], v4 offset:384
    v_mfma_f32_16x16x32_bf16 v[40:43], a[108:111], v[152:155], v[40:43]
    s_waitcnt lgkmcnt(8)
    buffer_load_dwordx4 v7, s[28:31], s45 offen offset:1152 lds
    v_mfma_f32_16x16x32_bf16 v[40:43], a[112:115], v[192:195], v[40:43]
    s_add_u32 m0, s44, -192
    ds_read_b64_tr_b16 a[72:73], v4 offset:512
    ds_read_b64_tr_b16 a[74:75], v4 offset:640
    v_mfma_f32_16x16x32_bf16 v[40:43], a[116:119], v[200:203], v[40:43]
    s_waitcnt lgkmcnt(6)
    buffer_load_dwordx4 v7, s[28:31], s45 offen offset:2304 lds
    v_mfma_f32_16x16x32_bf16 v[40:43], a[120:123], v[208:211], v[40:43]
    s_add_u32 m0, s44, -288
    ds_read_b64_tr_b16 a[76:77], v4 offset:768
    ds_read_b64_tr_b16 a[78:79], v4 offset:896
    v_mfma_f32_16x16x32_bf16 v[40:43], a[124:127], v[216:219], v[40:43]
    buffer_load_dwordx4 v7, s[28:31], s45 offen offset:3456 lds
    v_mfma_f32_16x16x32_bf16 v[44:47], a[96:99], v[160:163], 0
    s_add_u32 m0, s44, 16896
    ds_read_b64_tr_b16 a[80:81], v4 offset:16896
    ds_read_b64_tr_b16 a[82:83], v4 offset:17024
    v_mfma_f32_16x16x32_bf16 v[44:47], a[100:103], v[168:171], v[44:47]
    s_mov_b32 s45, 148224
    buffer_load_dwordx4 v7, s[28:31], s45 offen offset:0 lds
    v_mfma_f32_16x16x32_bf16 v[44:47], a[104:107], v[176:179], v[44:47]
    s_add_u32 m0, s44, 16800
    ds_read_b64_tr_b16 a[84:85], v4 offset:17152
    ds_read_b64_tr_b16 a[86:87], v4 offset:17280
    v_mfma_f32_16x16x32_bf16 v[44:47], a[108:111], v[184:187], v[44:47]
    buffer_load_dwordx4 v7, s[28:31], s45 offen offset:1152 lds
    v_mfma_f32_16x16x32_bf16 v[44:47], a[112:115], v[224:227], v[44:47]
    s_add_u32 m0, s44, 16704
    ds_read_b64_tr_b16 a[88:89], v4 offset:17408
    ds_read_b64_tr_b16 a[90:91], v4 offset:17536
    v_mfma_f32_16x16x32_bf16 v[44:47], a[116:119], v[232:235], v[44:47]
    buffer_load_dwordx4 v7, s[28:31], s45 offen offset:2304 lds
    v_mfma_f32_16x16x32_bf16 v[44:47], a[120:123], v[240:243], v[44:47]
    s_add_u32 m0, s44, 16608
    ds_read_b64_tr_b16 a[92:93], v4 offset:17664
    ds_read_b64_tr_b16 a[94:95], v4 offset:17792
    v_mfma_f32_16x16x32_bf16 v[44:47], a[124:127], v[248:251], v[44:47]
    s_waitcnt lgkmcnt(12)
    buffer_load_dwordx4 v7, s[28:31], s45 offen offset:3456 lds
    v_mfma_f32_16x16x32_bf16 v[16:19], a[64:67], v[128:131], 0
    ds_read_b64_tr_b16 a[96:97], v4 offset:32
    v_cvt_pk_bf16_f32 v48, v32, v33
    v_mfma_f32_16x16x32_bf16 v[16:19], a[68:71], v[136:139], v[16:19]
    s_waitcnt lgkmcnt(9)
    ds_read_b64_tr_b16 a[98:99], v4 offset:160
    v_cvt_pk_bf16_f32 v49, v34, v35
    v_mfma_f32_16x16x32_bf16 v[16:19], a[72:75], v[144:147], v[16:19]
    ds_read_b64_tr_b16 a[100:101], v4 offset:288
    v_cvt_pk_bf16_f32 v50, v40, v41
    v_mfma_f32_16x16x32_bf16 v[16:19], a[76:79], v[152:155], v[16:19]
    s_waitcnt lgkmcnt(7)
    ds_read_b64_tr_b16 a[102:103], v4 offset:416
    v_cvt_pk_bf16_f32 v51, v42, v43
    v_mfma_f32_16x16x32_bf16 v[16:19], a[80:83], v[192:195], v[16:19]
    s_mov_b32 s54, 3072
    ds_read_b64_tr_b16 a[104:105], v4 offset:544
    ds_read_b64_tr_b16 a[106:107], v4 offset:672
    v_mfma_f32_16x16x32_bf16 v[16:19], a[84:87], v[200:203], v[16:19]
    s_waitcnt lgkmcnt(6)
    v_permlane32_swap_b32 v48, v50
    v_mfma_f32_16x16x32_bf16 v[16:19], a[88:91], v[208:211], v[16:19]
    v_permlane32_swap_b32 v49, v51
    v_mfma_f32_16x16x32_bf16 v[16:19], a[92:95], v[216:219], v[16:19]
    ds_read_b64_tr_b16 a[108:109], v4 offset:800
    ds_read_b64_tr_b16 a[110:111], v4 offset:928
    buffer_store_dwordx4 v[48:51], v10, s[40:43], s54 offen offset:512 sc1
    v_mfma_f32_16x16x32_bf16 v[20:23], a[64:67], v[160:163], 0
    ds_read_b64_tr_b16 a[112:113], v4 offset:16928
    v_cvt_pk_bf16_f32 v52, v36, v37
    v_mfma_f32_16x16x32_bf16 v[20:23], a[68:71], v[168:171], v[20:23]
    ds_read_b64_tr_b16 a[114:115], v4 offset:17056
    v_cvt_pk_bf16_f32 v53, v38, v39
    v_mfma_f32_16x16x32_bf16 v[20:23], a[72:75], v[176:179], v[20:23]
    ds_read_b64_tr_b16 a[116:117], v4 offset:17184
    v_cvt_pk_bf16_f32 v54, v44, v45
    v_mfma_f32_16x16x32_bf16 v[20:23], a[76:79], v[184:187], v[20:23]
    ds_read_b64_tr_b16 a[118:119], v4 offset:17312
    v_cvt_pk_bf16_f32 v55, v46, v47
    v_mfma_f32_16x16x32_bf16 v[20:23], a[80:83], v[224:227], v[20:23]
    s_mov_b32 s54, 297984
    ds_read_b64_tr_b16 a[120:121], v4 offset:17440
    ds_read_b64_tr_b16 a[122:123], v4 offset:17568
    v_mfma_f32_16x16x32_bf16 v[20:23], a[84:87], v[232:235], v[20:23]
    v_permlane32_swap_b32 v52, v54
    v_mfma_f32_16x16x32_bf16 v[20:23], a[88:91], v[240:243], v[20:23]
    v_permlane32_swap_b32 v53, v55
    v_mfma_f32_16x16x32_bf16 v[20:23], a[92:95], v[248:251], v[20:23]
    s_waitcnt lgkmcnt(10)
    ds_read_b64_tr_b16 a[124:125], v4 offset:17696
    ds_read_b64_tr_b16 a[126:127], v4 offset:17824
    buffer_store_dwordx4 v[52:55], v10, s[40:43], s54 offen offset:512 sc1
    v_mfma_f32_16x16x32_bf16 v[24:27], a[96:99], v[128:131], 0
    ds_read_b64_tr_b16 a[64:65], v4 offset:64
    v_mfma_f32_16x16x32_bf16 v[24:27], a[100:103], v[136:139], v[24:27]
    s_waitcnt lgkmcnt(9)
    ds_read_b64_tr_b16 a[66:67], v4 offset:192
    v_mfma_f32_16x16x32_bf16 v[24:27], a[104:107], v[144:147], v[24:27]
    ds_read_b64_tr_b16 a[68:69], v4 offset:320
    v_mfma_f32_16x16x32_bf16 v[24:27], a[108:111], v[152:155], v[24:27]
    s_waitcnt lgkmcnt(7)
    ds_read_b64_tr_b16 a[70:71], v4 offset:448
    v_mfma_f32_16x16x32_bf16 v[24:27], a[112:115], v[192:195], v[24:27]
    ds_read_b64_tr_b16 a[72:73], v4 offset:576
    v_mfma_f32_16x16x32_bf16 v[24:27], a[116:119], v[200:203], v[24:27]
    s_waitcnt lgkmcnt(5)
    ds_read_b64_tr_b16 a[74:75], v4 offset:704
    v_mfma_f32_16x16x32_bf16 v[24:27], a[120:123], v[208:211], v[24:27]
    ds_read_b64_tr_b16 a[76:77], v4 offset:832
    v_mfma_f32_16x16x32_bf16 v[24:27], a[124:127], v[216:219], v[24:27]
    ds_read_b64_tr_b16 a[78:79], v4 offset:960
    v_mfma_f32_16x16x32_bf16 v[28:31], a[96:99], v[160:163], 0
    ds_read_b64_tr_b16 a[80:81], v4 offset:16960
    v_mfma_f32_16x16x32_bf16 v[28:31], a[100:103], v[168:171], v[28:31]
    ds_read_b64_tr_b16 a[82:83], v4 offset:17088
    v_mfma_f32_16x16x32_bf16 v[28:31], a[104:107], v[176:179], v[28:31]
    ds_read_b64_tr_b16 a[84:85], v4 offset:17216
    v_mfma_f32_16x16x32_bf16 v[28:31], a[108:111], v[184:187], v[28:31]
    ds_read_b64_tr_b16 a[86:87], v4 offset:17344
    v_mfma_f32_16x16x32_bf16 v[28:31], a[112:115], v[224:227], v[28:31]
    ds_read_b64_tr_b16 a[88:89], v4 offset:17472
    v_mfma_f32_16x16x32_bf16 v[28:31], a[116:119], v[232:235], v[28:31]
    ds_read_b64_tr_b16 a[90:91], v4 offset:17600
    v_mfma_f32_16x16x32_bf16 v[28:31], a[120:123], v[240:243], v[28:31]
    ds_read_b64_tr_b16 a[92:93], v4 offset:17728
    v_mfma_f32_16x16x32_bf16 v[28:31], a[124:127], v[248:251], v[28:31]
    s_waitcnt lgkmcnt(11)
    ds_read_b64_tr_b16 a[94:95], v4 offset:17856
    v_mfma_f32_16x16x32_bf16 v[32:35], a[64:67], v[128:131], 0
    ds_read_b64_tr_b16 a[96:97], v4 offset:96
    v_cvt_pk_bf16_f32 v48, v16, v17
    v_mfma_f32_16x16x32_bf16 v[32:35], a[68:71], v[136:139], v[32:35]
    s_waitcnt lgkmcnt(9)
    ds_read_b64_tr_b16 a[98:99], v4 offset:224
    v_cvt_pk_bf16_f32 v49, v18, v19
    v_mfma_f32_16x16x32_bf16 v[32:35], a[72:75], v[144:147], v[32:35]
    ds_read_b64_tr_b16 a[100:101], v4 offset:352
    v_cvt_pk_bf16_f32 v50, v24, v25
    v_mfma_f32_16x16x32_bf16 v[32:35], a[76:79], v[152:155], v[32:35]
    s_waitcnt lgkmcnt(7)
    ds_read_b64_tr_b16 a[102:103], v4 offset:480
    v_cvt_pk_bf16_f32 v51, v26, v27
    v_mfma_f32_16x16x32_bf16 v[32:35], a[80:83], v[192:195], v[32:35]
    s_mov_b32 s54, 4096
    ds_read_b64_tr_b16 a[104:105], v4 offset:608
    ds_read_b64_tr_b16 a[106:107], v4 offset:736
    v_mfma_f32_16x16x32_bf16 v[32:35], a[84:87], v[200:203], v[32:35]
    s_waitcnt lgkmcnt(6)
    v_permlane32_swap_b32 v48, v50
    v_mfma_f32_16x16x32_bf16 v[32:35], a[88:91], v[208:211], v[32:35]
    v_permlane32_swap_b32 v49, v51
    v_mfma_f32_16x16x32_bf16 v[32:35], a[92:95], v[216:219], v[32:35]
    ds_read_b64_tr_b16 a[108:109], v4 offset:864
    ds_read_b64_tr_b16 a[110:111], v4 offset:992
    buffer_store_dwordx4 v[48:51], v10, s[40:43], s54 offen offset:0 sc1
    v_mfma_f32_16x16x32_bf16 v[36:39], a[64:67], v[160:163], 0
    ds_read_b64_tr_b16 a[112:113], v4 offset:16992
    v_cvt_pk_bf16_f32 v52, v20, v21
    v_mfma_f32_16x16x32_bf16 v[36:39], a[68:71], v[168:171], v[36:39]
    ds_read_b64_tr_b16 a[114:115], v4 offset:17120
    v_cvt_pk_bf16_f32 v53, v22, v23
    v_mfma_f32_16x16x32_bf16 v[36:39], a[72:75], v[176:179], v[36:39]
    ds_read_b64_tr_b16 a[116:117], v4 offset:17248
    v_cvt_pk_bf16_f32 v54, v28, v29
    v_mfma_f32_16x16x32_bf16 v[36:39], a[76:79], v[184:187], v[36:39]
    ds_read_b64_tr_b16 a[118:119], v4 offset:17376
    v_cvt_pk_bf16_f32 v55, v30, v31
    v_mfma_f32_16x16x32_bf16 v[36:39], a[80:83], v[224:227], v[36:39]
    s_mov_b32 s54, 299008
    ds_read_b64_tr_b16 a[120:121], v4 offset:17504
    ds_read_b64_tr_b16 a[122:123], v4 offset:17632
    v_mfma_f32_16x16x32_bf16 v[36:39], a[84:87], v[232:235], v[36:39]
    v_permlane32_swap_b32 v52, v54
    v_mfma_f32_16x16x32_bf16 v[36:39], a[88:91], v[240:243], v[36:39]
    v_permlane32_swap_b32 v53, v55
    v_mfma_f32_16x16x32_bf16 v[36:39], a[92:95], v[248:251], v[36:39]
    s_waitcnt vmcnt(15)
    s_barrier
    s_waitcnt lgkmcnt(10)
    ds_read_b64_tr_b16 a[124:125], v4 offset:17760
    ds_read_b64_tr_b16 a[126:127], v4 offset:17888
    buffer_store_dwordx4 v[52:55], v10, s[40:43], s54 offen offset:0 sc1
    v_mfma_f32_16x16x32_bf16 v[40:43], a[96:99], v[128:131], 0
    s_add_u32 m0, s44, 36864
    ds_read_b64_tr_b16 a[64:65], v4 offset:36864
    ds_read_b64_tr_b16 a[66:67], v4 offset:36992
    v_mfma_f32_16x16x32_bf16 v[40:43], a[100:103], v[136:139], v[40:43]
    s_mov_b32 s45, 896
    s_waitcnt lgkmcnt(10)
    buffer_load_dwordx4 v7, s[28:31], s45 offen offset:0 lds
    v_mfma_f32_16x16x32_bf16 v[40:43], a[104:107], v[144:147], v[40:43]
    s_add_u32 m0, s44, 36768
    ds_read_b64_tr_b16 a[68:69], v4 offset:37120
    ds_read_b64_tr_b16 a[70:71], v4 offset:37248
    v_mfma_f32_16x16x32_bf16 v[40:43], a[108:111], v[152:155], v[40:43]
    s_waitcnt lgkmcnt(8)
    buffer_load_dwordx4 v7, s[28:31], s45 offen offset:1152 lds
    v_mfma_f32_16x16x32_bf16 v[40:43], a[112:115], v[192:195], v[40:43]
    s_add_u32 m0, s44, 36672
    ds_read_b64_tr_b16 a[72:73], v4 offset:37376
    ds_read_b64_tr_b16 a[74:75], v4 offset:37504
    v_mfma_f32_16x16x32_bf16 v[40:43], a[116:119], v[200:203], v[40:43]
    s_waitcnt lgkmcnt(6)
    buffer_load_dwordx4 v7, s[28:31], s45 offen offset:2304 lds
    v_mfma_f32_16x16x32_bf16 v[40:43], a[120:123], v[208:211], v[40:43]
    s_add_u32 m0, s44, 36576
    ds_read_b64_tr_b16 a[76:77], v4 offset:37632
    ds_read_b64_tr_b16 a[78:79], v4 offset:37760
    v_mfma_f32_16x16x32_bf16 v[40:43], a[124:127], v[216:219], v[40:43]
    buffer_load_dwordx4 v7, s[28:31], s45 offen offset:3456 lds
    v_mfma_f32_16x16x32_bf16 v[44:47], a[96:99], v[160:163], 0
    s_add_u32 m0, s44, 53760
    ds_read_b64_tr_b16 a[80:81], v4 offset:53760
    ds_read_b64_tr_b16 a[82:83], v4 offset:53888
    v_mfma_f32_16x16x32_bf16 v[44:47], a[100:103], v[168:171], v[44:47]
    s_mov_b32 s45, 148352
    buffer_load_dwordx4 v7, s[28:31], s45 offen offset:0 lds
    v_mfma_f32_16x16x32_bf16 v[44:47], a[104:107], v[176:179], v[44:47]
    s_add_u32 m0, s44, 53664
    ds_read_b64_tr_b16 a[84:85], v4 offset:54016
    ds_read_b64_tr_b16 a[86:87], v4 offset:54144
    v_mfma_f32_16x16x32_bf16 v[44:47], a[108:111], v[184:187], v[44:47]
    buffer_load_dwordx4 v7, s[28:31], s45 offen offset:1152 lds
    v_mfma_f32_16x16x32_bf16 v[44:47], a[112:115], v[224:227], v[44:47]
    s_add_u32 m0, s44, 53568
    ds_read_b64_tr_b16 a[88:89], v4 offset:54272
    ds_read_b64_tr_b16 a[90:91], v4 offset:54400
    v_mfma_f32_16x16x32_bf16 v[44:47], a[116:119], v[232:235], v[44:47]
    buffer_load_dwordx4 v7, s[28:31], s45 offen offset:2304 lds
    v_mfma_f32_16x16x32_bf16 v[44:47], a[120:123], v[240:243], v[44:47]
    s_add_u32 m0, s44, 53472
    ds_read_b64_tr_b16 a[92:93], v4 offset:54528
    ds_read_b64_tr_b16 a[94:95], v4 offset:54656
    v_mfma_f32_16x16x32_bf16 v[44:47], a[124:127], v[248:251], v[44:47]
    s_waitcnt lgkmcnt(12)
    buffer_load_dwordx4 v7, s[28:31], s45 offen offset:3456 lds
    v_mfma_f32_16x16x32_bf16 v[16:19], a[64:67], v[128:131], 0
    ds_read_b64_tr_b16 a[96:97], v4 offset:36896
    v_cvt_pk_bf16_f32 v48, v32, v33
    v_mfma_f32_16x16x32_bf16 v[16:19], a[68:71], v[136:139], v[16:19]
    s_waitcnt lgkmcnt(9)
    ds_read_b64_tr_b16 a[98:99], v4 offset:37024
    v_cvt_pk_bf16_f32 v49, v34, v35
    v_mfma_f32_16x16x32_bf16 v[16:19], a[72:75], v[144:147], v[16:19]
    ds_read_b64_tr_b16 a[100:101], v4 offset:37152
    v_cvt_pk_bf16_f32 v50, v40, v41
    v_mfma_f32_16x16x32_bf16 v[16:19], a[76:79], v[152:155], v[16:19]
    s_waitcnt lgkmcnt(7)
    ds_read_b64_tr_b16 a[102:103], v4 offset:37280
    v_cvt_pk_bf16_f32 v51, v42, v43
    v_mfma_f32_16x16x32_bf16 v[16:19], a[80:83], v[192:195], v[16:19]
    s_mov_b32 s54, 4096
    ds_read_b64_tr_b16 a[104:105], v4 offset:37408
    ds_read_b64_tr_b16 a[106:107], v4 offset:37536
    v_mfma_f32_16x16x32_bf16 v[16:19], a[84:87], v[200:203], v[16:19]
    s_waitcnt lgkmcnt(6)
    v_permlane32_swap_b32 v48, v50
    v_mfma_f32_16x16x32_bf16 v[16:19], a[88:91], v[208:211], v[16:19]
    v_permlane32_swap_b32 v49, v51
    v_mfma_f32_16x16x32_bf16 v[16:19], a[92:95], v[216:219], v[16:19]
    ds_read_b64_tr_b16 a[108:109], v4 offset:37664
    ds_read_b64_tr_b16 a[110:111], v4 offset:37792
    buffer_store_dwordx4 v[48:51], v10, s[40:43], s54 offen offset:512 sc1
    v_mfma_f32_16x16x32_bf16 v[20:23], a[64:67], v[160:163], 0
    ds_read_b64_tr_b16 a[112:113], v4 offset:53792
    v_cvt_pk_bf16_f32 v52, v36, v37
    v_mfma_f32_16x16x32_bf16 v[20:23], a[68:71], v[168:171], v[20:23]
    ds_read_b64_tr_b16 a[114:115], v4 offset:53920
    v_cvt_pk_bf16_f32 v53, v38, v39
    v_mfma_f32_16x16x32_bf16 v[20:23], a[72:75], v[176:179], v[20:23]
    ds_read_b64_tr_b16 a[116:117], v4 offset:54048
    v_cvt_pk_bf16_f32 v54, v44, v45
    v_mfma_f32_16x16x32_bf16 v[20:23], a[76:79], v[184:187], v[20:23]
    ds_read_b64_tr_b16 a[118:119], v4 offset:54176
    v_cvt_pk_bf16_f32 v55, v46, v47
    v_mfma_f32_16x16x32_bf16 v[20:23], a[80:83], v[224:227], v[20:23]
    s_mov_b32 s54, 299008
    ds_read_b64_tr_b16 a[120:121], v4 offset:54304
    ds_read_b64_tr_b16 a[122:123], v4 offset:54432
    v_mfma_f32_16x16x32_bf16 v[20:23], a[84:87], v[232:235], v[20:23]
    v_permlane32_swap_b32 v52, v54
    v_mfma_f32_16x16x32_bf16 v[20:23], a[88:91], v[240:243], v[20:23]
    v_permlane32_swap_b32 v53, v55
    v_mfma_f32_16x16x32_bf16 v[20:23], a[92:95], v[248:251], v[20:23]
    s_waitcnt lgkmcnt(10)
    ds_read_b64_tr_b16 a[124:125], v4 offset:54560
    ds_read_b64_tr_b16 a[126:127], v4 offset:54688
    buffer_store_dwordx4 v[52:55], v10, s[40:43], s54 offen offset:512 sc1
    v_mfma_f32_16x16x32_bf16 v[24:27], a[96:99], v[128:131], 0
    ds_read_b64_tr_b16 a[64:65], v4 offset:36928
    v_mfma_f32_16x16x32_bf16 v[24:27], a[100:103], v[136:139], v[24:27]
    s_waitcnt lgkmcnt(9)
    ds_read_b64_tr_b16 a[66:67], v4 offset:37056
    v_mfma_f32_16x16x32_bf16 v[24:27], a[104:107], v[144:147], v[24:27]
    ds_read_b64_tr_b16 a[68:69], v4 offset:37184
    v_mfma_f32_16x16x32_bf16 v[24:27], a[108:111], v[152:155], v[24:27]
    s_waitcnt lgkmcnt(7)
    ds_read_b64_tr_b16 a[70:71], v4 offset:37312
    v_mfma_f32_16x16x32_bf16 v[24:27], a[112:115], v[192:195], v[24:27]
    ds_read_b64_tr_b16 a[72:73], v4 offset:37440
    v_mfma_f32_16x16x32_bf16 v[24:27], a[116:119], v[200:203], v[24:27]
    s_waitcnt lgkmcnt(5)
    ds_read_b64_tr_b16 a[74:75], v4 offset:37568
    v_mfma_f32_16x16x32_bf16 v[24:27], a[120:123], v[208:211], v[24:27]
    ds_read_b64_tr_b16 a[76:77], v4 offset:37696
    v_mfma_f32_16x16x32_bf16 v[24:27], a[124:127], v[216:219], v[24:27]
    ds_read_b64_tr_b16 a[78:79], v4 offset:37824
    v_mfma_f32_16x16x32_bf16 v[28:31], a[96:99], v[160:163], 0
    ds_read_b64_tr_b16 a[80:81], v4 offset:53824
    v_mfma_f32_16x16x32_bf16 v[28:31], a[100:103], v[168:171], v[28:31]
    ds_read_b64_tr_b16 a[82:83], v4 offset:53952
    v_mfma_f32_16x16x32_bf16 v[28:31], a[104:107], v[176:179], v[28:31]
    ds_read_b64_tr_b16 a[84:85], v4 offset:54080
    v_mfma_f32_16x16x32_bf16 v[28:31], a[108:111], v[184:187], v[28:31]
    ds_read_b64_tr_b16 a[86:87], v4 offset:54208
    v_mfma_f32_16x16x32_bf16 v[28:31], a[112:115], v[224:227], v[28:31]
    ds_read_b64_tr_b16 a[88:89], v4 offset:54336
    v_mfma_f32_16x16x32_bf16 v[28:31], a[116:119], v[232:235], v[28:31]
    ds_read_b64_tr_b16 a[90:91], v4 offset:54464
    v_mfma_f32_16x16x32_bf16 v[28:31], a[120:123], v[240:243], v[28:31]
    ds_read_b64_tr_b16 a[92:93], v4 offset:54592
    v_mfma_f32_16x16x32_bf16 v[28:31], a[124:127], v[248:251], v[28:31]
    s_waitcnt lgkmcnt(11)
    ds_read_b64_tr_b16 a[94:95], v4 offset:54720
    v_mfma_f32_16x16x32_bf16 v[32:35], a[64:67], v[128:131], 0
    ds_read_b64_tr_b16 a[96:97], v4 offset:36960
    v_cvt_pk_bf16_f32 v48, v16, v17
    v_mfma_f32_16x16x32_bf16 v[32:35], a[68:71], v[136:139], v[32:35]
    s_waitcnt lgkmcnt(9)
    ds_read_b64_tr_b16 a[98:99], v4 offset:37088
    v_cvt_pk_bf16_f32 v49, v18, v19
    v_mfma_f32_16x16x32_bf16 v[32:35], a[72:75], v[144:147], v[32:35]
L2_pad11:
    s_cbranch_execz L2_walkret
    ds_read_b64_tr_b16 a[100:101], v4 offset:37216
    v_cvt_pk_bf16_f32 v50, v24, v25
    v_mfma_f32_16x16x32_bf16 v[32:35], a[76:79], v[152:155], v[32:35]
    s_waitcnt lgkmcnt(7)
    ds_read_b64_tr_b16 a[102:103], v4 offset:37344
    v_cvt_pk_bf16_f32 v51, v26, v27
    v_mfma_f32_16x16x32_bf16 v[32:35], a[80:83], v[192:195], v[32:35]
    s_mov_b32 s54, 5120
    ds_read_b64_tr_b16 a[104:105], v4 offset:37472
    ds_read_b64_tr_b16 a[106:107], v4 offset:37600
    v_mfma_f32_16x16x32_bf16 v[32:35], a[84:87], v[200:203], v[32:35]
    s_waitcnt lgkmcnt(6)
    v_permlane32_swap_b32 v48, v50
    v_mfma_f32_16x16x32_bf16 v[32:35], a[88:91], v[208:211], v[32:35]
    v_permlane32_swap_b32 v49, v51
    v_mfma_f32_16x16x32_bf16 v[32:35], a[92:95], v[216:219], v[32:35]
    ds_read_b64_tr_b16 a[108:109], v4 offset:37728
    ds_read_b64_tr_b16 a[110:111], v4 offset:37856
    buffer_store_dwordx4 v[48:51], v10, s[40:43], s54 offen offset:0 sc1
    v_mfma_f32_16x16x32_bf16 v[36:39], a[64:67], v[160:163], 0
    ds_read_b64_tr_b16 a[112:113], v4 offset:53856
    v_cvt_pk_bf16_f32 v52, v20, v21
    v_mfma_f32_16x16x32_bf16 v[36:39], a[68:71], v[168:171], v[36:39]
    ds_read_b64_tr_b16 a[114:115], v4 offset:53984
    v_cvt_pk_bf16_f32 v53, v22, v23
    v_mfma_f32_16x16x32_bf16 v[36:39], a[72:75], v[176:179], v[36:39]
    ds_read_b64_tr_b16 a[116:117], v4 offset:54112
    v_cvt_pk_bf16_f32 v54, v28, v29
    v_mfma_f32_16x16x32_bf16 v[36:39], a[76:79], v[184:187], v[36:39]
    ds_read_b64_tr_b16 a[118:119], v4 offset:54240
    v_cvt_pk_bf16_f32 v55, v30, v31
    v_mfma_f32_16x16x32_bf16 v[36:39], a[80:83], v[224:227], v[36:39]
    s_mov_b32 s54, 300032
    ds_read_b64_tr_b16 a[120:121], v4 offset:54368
    ds_read_b64_tr_b16 a[122:123], v4 offset:54496
    v_mfma_f32_16x16x32_bf16 v[36:39], a[84:87], v[232:235], v[36:39]
    v_permlane32_swap_b32 v52, v54
    v_mfma_f32_16x16x32_bf16 v[36:39], a[88:91], v[240:243], v[36:39]
    v_permlane32_swap_b32 v53, v55
    v_mfma_f32_16x16x32_bf16 v[36:39], a[92:95], v[248:251], v[36:39]
    s_waitcnt vmcnt(15)
    s_barrier
    s_waitcnt lgkmcnt(10)
    ds_read_b64_tr_b16 a[124:125], v4 offset:54624
    ds_read_b64_tr_b16 a[126:127], v4 offset:54752
    buffer_store_dwordx4 v[52:55], v10, s[40:43], s54 offen offset:0 sc1
    v_mfma_f32_16x16x32_bf16 v[40:43], a[96:99], v[128:131], 0
    s_add_u32 m0, s44, 73728
    ds_read_b64_tr_b16 a[64:65], v3 offset:0
    ds_read_b64_tr_b16 a[66:67], v3 offset:128
    v_mfma_f32_16x16x32_bf16 v[40:43], a[100:103], v[136:139], v[40:43]
    s_mov_b32 s45, 1024
    s_waitcnt lgkmcnt(10)
    buffer_load_dwordx4 v7, s[28:31], s45 offen offset:0 lds
    v_mfma_f32_16x16x32_bf16 v[40:43], a[104:107], v[144:147], v[40:43]
    s_add_u32 m0, s44, 73632
    ds_read_b64_tr_b16 a[68:69], v3 offset:256
    ds_read_b64_tr_b16 a[70:71], v3 offset:384
    v_mfma_f32_16x16x32_bf16 v[40:43], a[108:111], v[152:155], v[40:43]
    s_waitcnt lgkmcnt(8)
    buffer_load_dwordx4 v7, s[28:31], s45 offen offset:1152 lds
    v_mfma_f32_16x16x32_bf16 v[40:43], a[112:115], v[192:195], v[40:43]
    s_add_u32 m0, s44, 73536
    ds_read_b64_tr_b16 a[72:73], v3 offset:512
    ds_read_b64_tr_b16 a[74:75], v3 offset:640
    v_mfma_f32_16x16x32_bf16 v[40:43], a[116:119], v[200:203], v[40:43]
    s_waitcnt lgkmcnt(6)
    buffer_load_dwordx4 v7, s[28:31], s45 offen offset:2304 lds
    v_mfma_f32_16x16x32_bf16 v[40:43], a[120:123], v[208:211], v[40:43]
    s_add_u32 m0, s44, 73440
    ds_read_b64_tr_b16 a[76:77], v3 offset:768
    ds_read_b64_tr_b16 a[78:79], v3 offset:896
    v_mfma_f32_16x16x32_bf16 v[40:43], a[124:127], v[216:219], v[40:43]
    buffer_load_dwordx4 v7, s[28:31], s45 offen offset:3456 lds
    v_mfma_f32_16x16x32_bf16 v[44:47], a[96:99], v[160:163], 0
    s_add_u32 m0, s44, 90624
    ds_read_b64_tr_b16 a[80:81], v3 offset:16896
    ds_read_b64_tr_b16 a[82:83], v3 offset:17024
    v_mfma_f32_16x16x32_bf16 v[44:47], a[100:103], v[168:171], v[44:47]
    s_mov_b32 s45, 148480
    buffer_load_dwordx4 v7, s[28:31], s45 offen offset:0 lds
    v_mfma_f32_16x16x32_bf16 v[44:47], a[104:107], v[176:179], v[44:47]
    s_add_u32 m0, s44, 90528
    ds_read_b64_tr_b16 a[84:85], v3 offset:17152
    ds_read_b64_tr_b16 a[86:87], v3 offset:17280
    v_mfma_f32_16x16x32_bf16 v[44:47], a[108:111], v[184:187], v[44:47]
    buffer_load_dwordx4 v7, s[28:31], s45 offen offset:1152 lds
    v_mfma_f32_16x16x32_bf16 v[44:47], a[112:115], v[224:227], v[44:47]
    s_add_u32 m0, s44, 90432
    ds_read_b64_tr_b16 a[88:89], v3 offset:17408
    ds_read_b64_tr_b16 a[90:91], v3 offset:17536
    v_mfma_f32_16x16x32_bf16 v[44:47], a[116:119], v[232:235], v[44:47]
    buffer_load_dwordx4 v7, s[28:31], s45 offen offset:2304 lds
    v_mfma_f32_16x16x32_bf16 v[44:47], a[120:123], v[240:243], v[44:47]
    s_add_u32 m0, s44, 90336
    ds_read_b64_tr_b16 a[92:93], v3 offset:17664
    ds_read_b64_tr_b16 a[94:95], v3 offset:17792
    v_mfma_f32_16x16x32_bf16 v[44:47], a[124:127], v[248:251], v[44:47]
    s_waitcnt lgkmcnt(12)
    buffer_load_dwordx4 v7, s[28:31], s45 offen offset:3456 lds
    v_mfma_f32_16x16x32_bf16 v[16:19], a[64:67], v[128:131], 0
    ds_read_b64_tr_b16 a[96:97], v3 offset:32
    v_cvt_pk_bf16_f32 v48, v32, v33
    v_mfma_f32_16x16x32_bf16 v[16:19], a[68:71], v[136:139], v[16:19]
    s_waitcnt lgkmcnt(9)
    ds_read_b64_tr_b16 a[98:99], v3 offset:160
    v_cvt_pk_bf16_f32 v49, v34, v35
    v_mfma_f32_16x16x32_bf16 v[16:19], a[72:75], v[144:147], v[16:19]
    ds_read_b64_tr_b16 a[100:101], v3 offset:288
    v_cvt_pk_bf16_f32 v50, v40, v41
    v_mfma_f32_16x16x32_bf16 v[16:19], a[76:79], v[152:155], v[16:19]
    s_waitcnt lgkmcnt(7)
    ds_read_b64_tr_b16 a[102:103], v3 offset:416
    v_cvt_pk_bf16_f32 v51, v42, v43
    v_mfma_f32_16x16x32_bf16 v[16:19], a[80:83], v[192:195], v[16:19]
    s_mov_b32 s54, 5120
    ds_read_b64_tr_b16 a[104:105], v3 offset:544
    ds_read_b64_tr_b16 a[106:107], v3 offset:672
    v_mfma_f32_16x16x32_bf16 v[16:19], a[84:87], v[200:203], v[16:19]
    s_waitcnt lgkmcnt(6)
    v_permlane32_swap_b32 v48, v50
    v_mfma_f32_16x16x32_bf16 v[16:19], a[88:91], v[208:211], v[16:19]
    v_permlane32_swap_b32 v49, v51
    v_mfma_f32_16x16x32_bf16 v[16:19], a[92:95], v[216:219], v[16:19]
    ds_read_b64_tr_b16 a[108:109], v3 offset:800
    ds_read_b64_tr_b16 a[110:111], v3 offset:928
    buffer_store_dwordx4 v[48:51], v10, s[40:43], s54 offen offset:512 sc1
    v_mfma_f32_16x16x32_bf16 v[20:23], a[64:67], v[160:163], 0
    ds_read_b64_tr_b16 a[112:113], v3 offset:16928
    v_cvt_pk_bf16_f32 v52, v36, v37
    v_mfma_f32_16x16x32_bf16 v[20:23], a[68:71], v[168:171], v[20:23]
    ds_read_b64_tr_b16 a[114:115], v3 offset:17056
    v_cvt_pk_bf16_f32 v53, v38, v39
    v_mfma_f32_16x16x32_bf16 v[20:23], a[72:75], v[176:179], v[20:23]
    ds_read_b64_tr_b16 a[116:117], v3 offset:17184
    v_cvt_pk_bf16_f32 v54, v44, v45
    v_mfma_f32_16x16x32_bf16 v[20:23], a[76:79], v[184:187], v[20:23]
    ds_read_b64_tr_b16 a[118:119], v3 offset:17312
    v_cvt_pk_bf16_f32 v55, v46, v47
    v_mfma_f32_16x16x32_bf16 v[20:23], a[80:83], v[224:227], v[20:23]
    s_mov_b32 s54, 300032
    ds_read_b64_tr_b16 a[120:121], v3 offset:17440
    ds_read_b64_tr_b16 a[122:123], v3 offset:17568
    v_mfma_f32_16x16x32_bf16 v[20:23], a[84:87], v[232:235], v[20:23]
    v_permlane32_swap_b32 v52, v54
    v_mfma_f32_16x16x32_bf16 v[20:23], a[88:91], v[240:243], v[20:23]
    v_permlane32_swap_b32 v53, v55
    v_mfma_f32_16x16x32_bf16 v[20:23], a[92:95], v[248:251], v[20:23]
    s_waitcnt lgkmcnt(10)
    ds_read_b64_tr_b16 a[124:125], v3 offset:17696
    ds_read_b64_tr_b16 a[126:127], v3 offset:17824
    buffer_store_dwordx4 v[52:55], v10, s[40:43], s54 offen offset:512 sc1
    v_mfma_f32_16x16x32_bf16 v[24:27], a[96:99], v[128:131], 0
    ds_read_b64_tr_b16 a[64:65], v3 offset:64
    v_mfma_f32_16x16x32_bf16 v[24:27], a[100:103], v[136:139], v[24:27]
    s_waitcnt lgkmcnt(9)
    ds_read_b64_tr_b16 a[66:67], v3 offset:192
    v_mfma_f32_16x16x32_bf16 v[24:27], a[104:107], v[144:147], v[24:27]
    ds_read_b64_tr_b16 a[68:69], v3 offset:320
    v_mfma_f32_16x16x32_bf16 v[24:27], a[108:111], v[152:155], v[24:27]
    s_waitcnt lgkmcnt(7)
    ds_read_b64_tr_b16 a[70:71], v3 offset:448
    v_mfma_f32_16x16x32_bf16 v[24:27], a[112:115], v[192:195], v[24:27]
    ds_read_b64_tr_b16 a[72:73], v3 offset:576
    v_mfma_f32_16x16x32_bf16 v[24:27], a[116:119], v[200:203], v[24:27]
    s_waitcnt lgkmcnt(5)
    ds_read_b64_tr_b16 a[74:75], v3 offset:704
    v_mfma_f32_16x16x32_bf16 v[24:27], a[120:123], v[208:211], v[24:27]
    ds_read_b64_tr_b16 a[76:77], v3 offset:832
    v_mfma_f32_16x16x32_bf16 v[24:27], a[124:127], v[216:219], v[24:27]
    ds_read_b64_tr_b16 a[78:79], v3 offset:960
    v_mfma_f32_16x16x32_bf16 v[28:31], a[96:99], v[160:163], 0
    ds_read_b64_tr_b16 a[80:81], v3 offset:16960
    v_mfma_f32_16x16x32_bf16 v[28:31], a[100:103], v[168:171], v[28:31]
    ds_read_b64_tr_b16 a[82:83], v3 offset:17088
    v_mfma_f32_16x16x32_bf16 v[28:31], a[104:107], v[176:179], v[28:31]
    ds_read_b64_tr_b16 a[84:85], v3 offset:17216
    v_mfma_f32_16x16x32_bf16 v[28:31], a[108:111], v[184:187], v[28:31]
    ds_read_b64_tr_b16 a[86:87], v3 offset:17344
    v_mfma_f32_16x16x32_bf16 v[28:31], a[112:115], v[224:227], v[28:31]
    ds_read_b64_tr_b16 a[88:89], v3 offset:17472
    v_mfma_f32_16x16x32_bf16 v[28:31], a[116:119], v[232:235], v[28:31]
    ds_read_b64_tr_b16 a[90:91], v3 offset:17600
    v_mfma_f32_16x16x32_bf16 v[28:31], a[120:123], v[240:243], v[28:31]
    ds_read_b64_tr_b16 a[92:93], v3 offset:17728
    v_mfma_f32_16x16x32_bf16 v[28:31], a[124:127], v[248:251], v[28:31]
    s_waitcnt lgkmcnt(11)
    ds_read_b64_tr_b16 a[94:95], v3 offset:17856
    v_mfma_f32_16x16x32_bf16 v[32:35], a[64:67], v[128:131], 0
    ds_read_b64_tr_b16 a[96:97], v3 offset:96
    v_cvt_pk_bf16_f32 v48, v16, v17
    v_mfma_f32_16x16x32_bf16 v[32:35], a[68:71], v[136:139], v[32:35]
    s_waitcnt lgkmcnt(9)
    ds_read_b64_tr_b16 a[98:99], v3 offset:224
    v_cvt_pk_bf16_f32 v49, v18, v19
    v_mfma_f32_16x16x32_bf16 v[32:35], a[72:75], v[144:147], v[32:35]
    ds_read_b64_tr_b16 a[100:101], v3 offset:352
    v_cvt_pk_bf16_f32 v50, v24, v25
    v_mfma_f32_16x16x32_bf16 v[32:35], a[76:79], v[152:155], v[32:35]
    s_waitcnt lgkmcnt(7)
    ds_read_b64_tr_b16 a[102:103], v3 offset:480
    v_cvt_pk_bf16_f32 v51, v26, v27
    v_mfma_f32_16x16x32_bf16 v[32:35], a[80:83], v[192:195], v[32:35]
    s_mov_b32 s54, 6144
    ds_read_b64_tr_b16 a[104:105], v3 offset:608
    ds_read_b64_tr_b16 a[106:107], v3 offset:736
    v_mfma_f32_16x16x32_bf16 v[32:35], a[84:87], v[200:203], v[32:35]
    s_waitcnt lgkmcnt(6)
    v_permlane32_swap_b32 v48, v50
    v_mfma_f32_16x16x32_bf16 v[32:35], a[88:91], v[208:211], v[32:35]
    v_permlane32_swap_b32 v49, v51
    v_mfma_f32_16x16x32_bf16 v[32:35], a[92:95], v[216:219], v[32:35]
    ds_read_b64_tr_b16 a[108:109], v3 offset:864
    ds_read_b64_tr_b16 a[110:111], v3 offset:992
    buffer_store_dwordx4 v[48:51], v10, s[40:43], s54 offen offset:0 sc1
    v_mfma_f32_16x16x32_bf16 v[36:39], a[64:67], v[160:163], 0
    ds_read_b64_tr_b16 a[112:113], v3 offset:16992
    v_cvt_pk_bf16_f32 v52, v20, v21
    v_mfma_f32_16x16x32_bf16 v[36:39], a[68:71], v[168:171], v[36:39]
    ds_read_b64_tr_b16 a[114:115], v3 offset:17120
    v_cvt_pk_bf16_f32 v53, v22, v23
    v_mfma_f32_16x16x32_bf16 v[36:39], a[72:75], v[176:179], v[36:39]
    ds_read_b64_tr_b16 a[116:117], v3 offset:17248
    v_cvt_pk_bf16_f32 v54, v28, v29
    v_mfma_f32_16x16x32_bf16 v[36:39], a[76:79], v[184:187], v[36:39]
    ds_read_b64_tr_b16 a[118:119], v3 offset:17376
    v_cvt_pk_bf16_f32 v55, v30, v31
    v_mfma_f32_16x16x32_bf16 v[36:39], a[80:83], v[224:227], v[36:39]
    s_mov_b32 s54, 301056
    ds_read_b64_tr_b16 a[120:121], v3 offset:17504
    ds_read_b64_tr_b16 a[122:123], v3 offset:17632
    v_mfma_f32_16x16x32_bf16 v[36:39], a[84:87], v[232:235], v[36:39]
    v_permlane32_swap_b32 v52, v54
    v_mfma_f32_16x16x32_bf16 v[36:39], a[88:91], v[240:243], v[36:39]
    v_permlane32_swap_b32 v53, v55
    v_mfma_f32_16x16x32_bf16 v[36:39], a[92:95], v[248:251], v[36:39]
    s_waitcnt vmcnt(15)
    s_barrier
    s_waitcnt lgkmcnt(10)
    ds_read_b64_tr_b16 a[124:125], v3 offset:17760
    ds_read_b64_tr_b16 a[126:127], v3 offset:17888
    buffer_store_dwordx4 v[52:55], v10, s[40:43], s54 offen offset:0 sc1
    v_mfma_f32_16x16x32_bf16 v[40:43], a[96:99], v[128:131], 0
    ds_read_b64_tr_b16 a[64:65], v3 offset:36864
    v_mfma_f32_16x16x32_bf16 v[40:43], a[100:103], v[136:139], v[40:43]
    s_waitcnt lgkmcnt(9)
    ds_read_b64_tr_b16 a[66:67], v3 offset:36992
    v_mfma_f32_16x16x32_bf16 v[40:43], a[104:107], v[144:147], v[40:43]
    ds_read_b64_tr_b16 a[68:69], v3 offset:37120
    v_mfma_f32_16x16x32_bf16 v[40:43], a[108:111], v[152:155], v[40:43]
    s_waitcnt lgkmcnt(7)
    ds_read_b64_tr_b16 a[70:71], v3 offset:37248
    v_mfma_f32_16x16x32_bf16 v[40:43], a[112:115], v[192:195], v[40:43]
    ds_read_b64_tr_b16 a[72:73], v3 offset:37376
    v_mfma_f32_16x16x32_bf16 v[40:43], a[116:119], v[200:203], v[40:43]
    s_waitcnt lgkmcnt(5)
    ds_read_b64_tr_b16 a[74:75], v3 offset:37504
    v_mfma_f32_16x16x32_bf16 v[40:43], a[120:123], v[208:211], v[40:43]
    ds_read_b64_tr_b16 a[76:77], v3 offset:37632
    v_mfma_f32_16x16x32_bf16 v[40:43], a[124:127], v[216:219], v[40:43]
    ds_read_b64_tr_b16 a[78:79], v3 offset:37760
    v_mfma_f32_16x16x32_bf16 v[44:47], a[96:99], v[160:163], 0
    ds_read_b64_tr_b16 a[80:81], v3 offset:53760
    v_mfma_f32_16x16x32_bf16 v[44:47], a[100:103], v[168:171], v[44:47]
    ds_read_b64_tr_b16 a[82:83], v3 offset:53888
    v_mfma_f32_16x16x32_bf16 v[44:47], a[104:107], v[176:179], v[44:47]
    ds_read_b64_tr_b16 a[84:85], v3 offset:54016
    v_mfma_f32_16x16x32_bf16 v[44:47], a[108:111], v[184:187], v[44:47]
    ds_read_b64_tr_b16 a[86:87], v3 offset:54144
    v_mfma_f32_16x16x32_bf16 v[44:47], a[112:115], v[224:227], v[44:47]
    ds_read_b64_tr_b16 a[88:89], v3 offset:54272
    v_mfma_f32_16x16x32_bf16 v[44:47], a[116:119], v[232:235], v[44:47]
    ds_read_b64_tr_b16 a[90:91], v3 offset:54400
    v_mfma_f32_16x16x32_bf16 v[44:47], a[120:123], v[240:243], v[44:47]
    ds_read_b64_tr_b16 a[92:93], v3 offset:54528
    v_mfma_f32_16x16x32_bf16 v[44:47], a[124:127], v[248:251], v[44:47]
    s_waitcnt lgkmcnt(11)
    ds_read_b64_tr_b16 a[94:95], v3 offset:54656
    v_mfma_f32_16x16x32_bf16 v[16:19], a[64:67], v[128:131], 0
    ds_read_b64_tr_b16 a[96:97], v3 offset:36896
    v_cvt_pk_bf16_f32 v48, v32, v33
    v_mfma_f32_16x16x32_bf16 v[16:19], a[68:71], v[136:139], v[16:19]
    s_waitcnt lgkmcnt(9)
    ds_read_b64_tr_b16 a[98:99], v3 offset:37024
    v_cvt_pk_bf16_f32 v49, v34, v35
    v_mfma_f32_16x16x32_bf16 v[16:19], a[72:75], v[144:147], v[16:19]
    ds_read_b64_tr_b16 a[100:101], v3 offset:37152
    v_cvt_pk_bf16_f32 v50, v40, v41
    v_mfma_f32_16x16x32_bf16 v[16:19], a[76:79], v[152:155], v[16:19]
    s_waitcnt lgkmcnt(7)
    ds_read_b64_tr_b16 a[102:103], v3 offset:37280
    v_cvt_pk_bf16_f32 v51, v42, v43
    v_mfma_f32_16x16x32_bf16 v[16:19], a[80:83], v[192:195], v[16:19]
    s_mov_b32 s54, 6144
    ds_read_b64_tr_b16 a[104:105], v3 offset:37408
    ds_read_b64_tr_b16 a[106:107], v3 offset:37536
    v_mfma_f32_16x16x32_bf16 v[16:19], a[84:87], v[200:203], v[16:19]
    s_waitcnt lgkmcnt(6)
    v_permlane32_swap_b32 v48, v50
    v_mfma_f32_16x16x32_bf16 v[16:19], a[88:91], v[208:211], v[16:19]
    v_permlane32_swap_b32 v49, v51
    v_mfma_f32_16x16x32_bf16 v[16:19], a[92:95], v[216:219], v[16:19]
    ds_read_b64_tr_b16 a[108:109], v3 offset:37664
    ds_read_b64_tr_b16 a[110:111], v3 offset:37792
    buffer_store_dwordx4 v[48:51], v10, s[40:43], s54 offen offset:512 sc1
    v_mfma_f32_16x16x32_bf16 v[20:23], a[64:67], v[160:163], 0
    ds_read_b64_tr_b16 a[112:113], v3 offset:53792
    v_cvt_pk_bf16_f32 v52, v36, v37
    v_mfma_f32_16x16x32_bf16 v[20:23], a[68:71], v[168:171], v[20:23]
    ds_read_b64_tr_b16 a[114:115], v3 offset:53920
    v_cvt_pk_bf16_f32 v53, v38, v39
    v_mfma_f32_16x16x32_bf16 v[20:23], a[72:75], v[176:179], v[20:23]
    ds_read_b64_tr_b16 a[116:117], v3 offset:54048
    v_cvt_pk_bf16_f32 v54, v44, v45
    v_mfma_f32_16x16x32_bf16 v[20:23], a[76:79], v[184:187], v[20:23]
    ds_read_b64_tr_b16 a[118:119], v3 offset:54176
    v_cvt_pk_bf16_f32 v55, v46, v47
    v_mfma_f32_16x16x32_bf16 v[20:23], a[80:83], v[224:227], v[20:23]
    s_mov_b32 s54, 301056
    ds_read_b64_tr_b16 a[120:121], v3 offset:54304
    ds_read_b64_tr_b16 a[122:123], v3 offset:54432
    v_mfma_f32_16x16x32_bf16 v[20:23], a[84:87], v[232:235], v[20:23]
    v_permlane32_swap_b32 v52, v54
    v_mfma_f32_16x16x32_bf16 v[20:23], a[88:91], v[240:243], v[20:23]
    v_permlane32_swap_b32 v53, v55
    v_mfma_f32_16x16x32_bf16 v[20:23], a[92:95], v[248:251], v[20:23]
    s_waitcnt lgkmcnt(10)
    ds_read_b64_tr_b16 a[124:125], v3 offset:54560
    ds_read_b64_tr_b16 a[126:127], v3 offset:54688
    buffer_store_dwordx4 v[52:55], v10, s[40:43], s54 offen offset:512 sc1
    v_mfma_f32_16x16x32_bf16 v[24:27], a[96:99], v[128:131], 0
    ds_read_b64_tr_b16 a[64:65], v3 offset:36928
    v_mfma_f32_16x16x32_bf16 v[24:27], a[100:103], v[136:139], v[24:27]
    s_waitcnt lgkmcnt(9)
    ds_read_b64_tr_b16 a[66:67], v3 offset:37056
    v_mfma_f32_16x16x32_bf16 v[24:27], a[104:107], v[144:147], v[24:27]
    ds_read_b64_tr_b16 a[68:69], v3 offset:37184
    v_mfma_f32_16x16x32_bf16 v[24:27], a[108:111], v[152:155], v[24:27]
    s_waitcnt lgkmcnt(7)
    ds_read_b64_tr_b16 a[70:71], v3 offset:37312
    v_mfma_f32_16x16x32_bf16 v[24:27], a[112:115], v[192:195], v[24:27]
    ds_read_b64_tr_b16 a[72:73], v3 offset:37440
    v_mfma_f32_16x16x32_bf16 v[24:27], a[116:119], v[200:203], v[24:27]
    s_waitcnt lgkmcnt(5)
    ds_read_b64_tr_b16 a[74:75], v3 offset:37568
    v_mfma_f32_16x16x32_bf16 v[24:27], a[120:123], v[208:211], v[24:27]
    ds_read_b64_tr_b16 a[76:77], v3 offset:37696
    v_mfma_f32_16x16x32_bf16 v[24:27], a[124:127], v[216:219], v[24:27]
    ds_read_b64_tr_b16 a[78:79], v3 offset:37824
    v_mfma_f32_16x16x32_bf16 v[28:31], a[96:99], v[160:163], 0
    ds_read_b64_tr_b16 a[80:81], v3 offset:53824
    v_mfma_f32_16x16x32_bf16 v[28:31], a[100:103], v[168:171], v[28:31]
    ds_read_b64_tr_b16 a[82:83], v3 offset:53952
    v_mfma_f32_16x16x32_bf16 v[28:31], a[104:107], v[176:179], v[28:31]
    ds_read_b64_tr_b16 a[84:85], v3 offset:54080
    v_mfma_f32_16x16x32_bf16 v[28:31], a[108:111], v[184:187], v[28:31]
    ds_read_b64_tr_b16 a[86:87], v3 offset:54208
    v_mfma_f32_16x16x32_bf16 v[28:31], a[112:115], v[224:227], v[28:31]
    ds_read_b64_tr_b16 a[88:89], v3 offset:54336
    v_mfma_f32_16x16x32_bf16 v[28:31], a[116:119], v[232:235], v[28:31]
    ds_read_b64_tr_b16 a[90:91], v3 offset:54464
    v_mfma_f32_16x16x32_bf16 v[28:31], a[120:123], v[240:243], v[28:31]
    ds_read_b64_tr_b16 a[92:93], v3 offset:54592
    v_mfma_f32_16x16x32_bf16 v[28:31], a[124:127], v[248:251], v[28:31]
    s_waitcnt lgkmcnt(11)
    ds_read_b64_tr_b16 a[94:95], v3 offset:54720
    v_mfma_f32_16x16x32_bf16 v[32:35], a[64:67], v[128:131], 0
    ds_read_b64_tr_b16 a[96:97], v3 offset:36960
    v_cvt_pk_bf16_f32 v48, v16, v17
    v_mfma_f32_16x16x32_bf16 v[32:35], a[68:71], v[136:139], v[32:35]
    s_waitcnt lgkmcnt(9)
    ds_read_b64_tr_b16 a[98:99], v3 offset:37088
    v_cvt_pk_bf16_f32 v49, v18, v19
    v_mfma_f32_16x16x32_bf16 v[32:35], a[72:75], v[144:147], v[32:35]
    ds_read_b64_tr_b16 a[100:101], v3 offset:37216
    v_cvt_pk_bf16_f32 v50, v24, v25
    v_mfma_f32_16x16x32_bf16 v[32:35], a[76:79], v[152:155], v[32:35]
    s_waitcnt lgkmcnt(7)
    ds_read_b64_tr_b16 a[102:103], v3 offset:37344
    v_cvt_pk_bf16_f32 v51, v26, v27
    v_mfma_f32_16x16x32_bf16 v[32:35], a[80:83], v[192:195], v[32:35]
    s_mov_b32 s54, 7168
    ds_read_b64_tr_b16 a[104:105], v3 offset:37472
    ds_read_b64_tr_b16 a[106:107], v3 offset:37600
    v_mfma_f32_16x16x32_bf16 v[32:35], a[84:87], v[200:203], v[32:35]
    s_waitcnt lgkmcnt(6)
    v_permlane32_swap_b32 v48, v50
    v_mfma_f32_16x16x32_bf16 v[32:35], a[88:91], v[208:211], v[32:35]
    v_permlane32_swap_b32 v49, v51
    v_mfma_f32_16x16x32_bf16 v[32:35], a[92:95], v[216:219], v[32:35]
    ds_read_b64_tr_b16 a[108:109], v3 offset:37728
    ds_read_b64_tr_b16 a[110:111], v3 offset:37856
    buffer_store_dwordx4 v[48:51], v10, s[40:43], s54 offen offset:0 sc1
    v_mfma_f32_16x16x32_bf16 v[36:39], a[64:67], v[160:163], 0
    ds_read_b64_tr_b16 a[112:113], v3 offset:53856
    v_cvt_pk_bf16_f32 v52, v20, v21
    v_mfma_f32_16x16x32_bf16 v[36:39], a[68:71], v[168:171], v[36:39]
    ds_read_b64_tr_b16 a[114:115], v3 offset:53984
    v_cvt_pk_bf16_f32 v53, v22, v23
    v_mfma_f32_16x16x32_bf16 v[36:39], a[72:75], v[176:179], v[36:39]
    ds_read_b64_tr_b16 a[116:117], v3 offset:54112
    v_cvt_pk_bf16_f32 v54, v28, v29
    v_mfma_f32_16x16x32_bf16 v[36:39], a[76:79], v[184:187], v[36:39]
    ds_read_b64_tr_b16 a[118:119], v3 offset:54240
    v_cvt_pk_bf16_f32 v55, v30, v31
    v_mfma_f32_16x16x32_bf16 v[36:39], a[80:83], v[224:227], v[36:39]
    s_mov_b32 s54, 302080
    ds_read_b64_tr_b16 a[120:121], v3 offset:54368
    ds_read_b64_tr_b16 a[122:123], v3 offset:54496
    v_mfma_f32_16x16x32_bf16 v[36:39], a[84:87], v[232:235], v[36:39]
    v_permlane32_swap_b32 v52, v54
    v_mfma_f32_16x16x32_bf16 v[36:39], a[88:91], v[240:243], v[36:39]
    v_permlane32_swap_b32 v53, v55
    v_mfma_f32_16x16x32_bf16 v[36:39], a[92:95], v[248:251], v[36:39]
    s_waitcnt vmcnt(7)
    s_barrier
    s_waitcnt lgkmcnt(10)
    ds_read_b64_tr_b16 a[124:125], v3 offset:54624
    ds_read_b64_tr_b16 a[126:127], v3 offset:54752
    buffer_store_dwordx4 v[52:55], v10, s[40:43], s54 offen offset:0 sc1
    v_mfma_f32_16x16x32_bf16 v[40:43], a[96:99], v[128:131], 0
    ds_read_b64_tr_b16 a[64:65], v4 offset:0
    v_mfma_f32_16x16x32_bf16 v[40:43], a[100:103], v[136:139], v[40:43]
    s_waitcnt lgkmcnt(9)
    ds_read_b64_tr_b16 a[66:67], v4 offset:128
    v_mfma_f32_16x16x32_bf16 v[40:43], a[104:107], v[144:147], v[40:43]
    ds_read_b64_tr_b16 a[68:69], v4 offset:256
    v_mfma_f32_16x16x32_bf16 v[40:43], a[108:111], v[152:155], v[40:43]
    s_waitcnt lgkmcnt(7)
    ds_read_b64_tr_b16 a[70:71], v4 offset:384
    v_mfma_f32_16x16x32_bf16 v[40:43], a[112:115], v[192:195], v[40:43]
    ds_read_b64_tr_b16 a[72:73], v4 offset:512
    v_mfma_f32_16x16x32_bf16 v[40:43], a[116:119], v[200:203], v[40:43]
    s_waitcnt lgkmcnt(5)
    ds_read_b64_tr_b16 a[74:75], v4 offset:640
    v_mfma_f32_16x16x32_bf16 v[40:43], a[120:123], v[208:211], v[40:43]
    ds_read_b64_tr_b16 a[76:77], v4 offset:768
    v_mfma_f32_16x16x32_bf16 v[40:43], a[124:127], v[216:219], v[40:43]
    ds_read_b64_tr_b16 a[78:79], v4 offset:896
    v_mfma_f32_16x16x32_bf16 v[44:47], a[96:99], v[160:163], 0
    ds_read_b64_tr_b16 a[80:81], v4 offset:16896
    v_mfma_f32_16x16x32_bf16 v[44:47], a[100:103], v[168:171], v[44:47]
    ds_read_b64_tr_b16 a[82:83], v4 offset:17024
    v_mfma_f32_16x16x32_bf16 v[44:47], a[104:107], v[176:179], v[44:47]
    ds_read_b64_tr_b16 a[84:85], v4 offset:17152
    v_mfma_f32_16x16x32_bf16 v[44:47], a[108:111], v[184:187], v[44:47]
    ds_read_b64_tr_b16 a[86:87], v4 offset:17280
    v_mfma_f32_16x16x32_bf16 v[44:47], a[112:115], v[224:227], v[44:47]
    ds_read_b64_tr_b16 a[88:89], v4 offset:17408
    v_mfma_f32_16x16x32_bf16 v[44:47], a[116:119], v[232:235], v[44:47]
    ds_read_b64_tr_b16 a[90:91], v4 offset:17536
    v_mfma_f32_16x16x32_bf16 v[44:47], a[120:123], v[240:243], v[44:47]
    ds_read_b64_tr_b16 a[92:93], v4 offset:17664
    v_mfma_f32_16x16x32_bf16 v[44:47], a[124:127], v[248:251], v[44:47]
    s_waitcnt lgkmcnt(11)
    ds_read_b64_tr_b16 a[94:95], v4 offset:17792
    v_mfma_f32_16x16x32_bf16 v[16:19], a[64:67], v[128:131], 0
    ds_read_b64_tr_b16 a[96:97], v4 offset:32
    v_cvt_pk_bf16_f32 v48, v32, v33
    v_mfma_f32_16x16x32_bf16 v[16:19], a[68:71], v[136:139], v[16:19]
    s_waitcnt lgkmcnt(9)
    ds_read_b64_tr_b16 a[98:99], v4 offset:160
    v_cvt_pk_bf16_f32 v49, v34, v35
    v_mfma_f32_16x16x32_bf16 v[16:19], a[72:75], v[144:147], v[16:19]
    ds_read_b64_tr_b16 a[100:101], v4 offset:288
    v_cvt_pk_bf16_f32 v50, v40, v41
    v_mfma_f32_16x16x32_bf16 v[16:19], a[76:79], v[152:155], v[16:19]
    s_waitcnt lgkmcnt(7)
    ds_read_b64_tr_b16 a[102:103], v4 offset:416
    v_cvt_pk_bf16_f32 v51, v42, v43
    v_mfma_f32_16x16x32_bf16 v[16:19], a[80:83], v[192:195], v[16:19]
    s_mov_b32 s54, 7168
    ds_read_b64_tr_b16 a[104:105], v4 offset:544
    ds_read_b64_tr_b16 a[106:107], v4 offset:672
    v_mfma_f32_16x16x32_bf16 v[16:19], a[84:87], v[200:203], v[16:19]
    s_waitcnt lgkmcnt(6)
    v_permlane32_swap_b32 v48, v50
    v_mfma_f32_16x16x32_bf16 v[16:19], a[88:91], v[208:211], v[16:19]
    v_permlane32_swap_b32 v49, v51
    v_mfma_f32_16x16x32_bf16 v[16:19], a[92:95], v[216:219], v[16:19]
    ds_read_b64_tr_b16 a[108:109], v4 offset:800
    ds_read_b64_tr_b16 a[110:111], v4 offset:928
    buffer_store_dwordx4 v[48:51], v10, s[40:43], s54 offen offset:512 sc1
    v_mfma_f32_16x16x32_bf16 v[20:23], a[64:67], v[160:163], 0
    ds_read_b64_tr_b16 a[112:113], v4 offset:16928
    v_cvt_pk_bf16_f32 v52, v36, v37
    v_mfma_f32_16x16x32_bf16 v[20:23], a[68:71], v[168:171], v[20:23]
    ds_read_b64_tr_b16 a[114:115], v4 offset:17056
    v_cvt_pk_bf16_f32 v53, v38, v39
    v_mfma_f32_16x16x32_bf16 v[20:23], a[72:75], v[176:179], v[20:23]
    ds_read_b64_tr_b16 a[116:117], v4 offset:17184
    v_cvt_pk_bf16_f32 v54, v44, v45
    v_mfma_f32_16x16x32_bf16 v[20:23], a[76:79], v[184:187], v[20:23]
    ds_read_b64_tr_b16 a[118:119], v4 offset:17312
    v_cvt_pk_bf16_f32 v55, v46, v47
    v_mfma_f32_16x16x32_bf16 v[20:23], a[80:83], v[224:227], v[20:23]
    s_mov_b32 s54, 302080
    ds_read_b64_tr_b16 a[120:121], v4 offset:17440
    ds_read_b64_tr_b16 a[122:123], v4 offset:17568
    v_mfma_f32_16x16x32_bf16 v[20:23], a[84:87], v[232:235], v[20:23]
    v_permlane32_swap_b32 v52, v54
    v_mfma_f32_16x16x32_bf16 v[20:23], a[88:91], v[240:243], v[20:23]
    v_permlane32_swap_b32 v53, v55
    v_mfma_f32_16x16x32_bf16 v[20:23], a[92:95], v[248:251], v[20:23]
    s_waitcnt lgkmcnt(10)
    ds_read_b64_tr_b16 a[124:125], v4 offset:17696
    ds_read_b64_tr_b16 a[126:127], v4 offset:17824
    buffer_store_dwordx4 v[52:55], v10, s[40:43], s54 offen offset:512 sc1
    v_mfma_f32_16x16x32_bf16 v[24:27], a[96:99], v[128:131], 0
    ds_read_b64_tr_b16 a[64:65], v4 offset:64
    v_mfma_f32_16x16x32_bf16 v[24:27], a[100:103], v[136:139], v[24:27]
    s_waitcnt lgkmcnt(9)
    ds_read_b64_tr_b16 a[66:67], v4 offset:192
    v_mfma_f32_16x16x32_bf16 v[24:27], a[104:107], v[144:147], v[24:27]
    ds_read_b64_tr_b16 a[68:69], v4 offset:320
    v_mfma_f32_16x16x32_bf16 v[24:27], a[108:111], v[152:155], v[24:27]
    s_waitcnt lgkmcnt(7)
    ds_read_b64_tr_b16 a[70:71], v4 offset:448
    v_mfma_f32_16x16x32_bf16 v[24:27], a[112:115], v[192:195], v[24:27]
    ds_read_b64_tr_b16 a[72:73], v4 offset:576
    v_mfma_f32_16x16x32_bf16 v[24:27], a[116:119], v[200:203], v[24:27]
    s_waitcnt lgkmcnt(5)
    ds_read_b64_tr_b16 a[74:75], v4 offset:704
    v_mfma_f32_16x16x32_bf16 v[24:27], a[120:123], v[208:211], v[24:27]
    ds_read_b64_tr_b16 a[76:77], v4 offset:832
    v_mfma_f32_16x16x32_bf16 v[24:27], a[124:127], v[216:219], v[24:27]
    ds_read_b64_tr_b16 a[78:79], v4 offset:960
    v_mfma_f32_16x16x32_bf16 v[28:31], a[96:99], v[160:163], 0
    ds_read_b64_tr_b16 a[80:81], v4 offset:16960
    v_mfma_f32_16x16x32_bf16 v[28:31], a[100:103], v[168:171], v[28:31]
    ds_read_b64_tr_b16 a[82:83], v4 offset:17088
    v_mfma_f32_16x16x32_bf16 v[28:31], a[104:107], v[176:179], v[28:31]
    ds_read_b64_tr_b16 a[84:85], v4 offset:17216
    v_mfma_f32_16x16x32_bf16 v[28:31], a[108:111], v[184:187], v[28:31]
    ds_read_b64_tr_b16 a[86:87], v4 offset:17344
    v_mfma_f32_16x16x32_bf16 v[28:31], a[112:115], v[224:227], v[28:31]
    ds_read_b64_tr_b16 a[88:89], v4 offset:17472
    v_mfma_f32_16x16x32_bf16 v[28:31], a[116:119], v[232:235], v[28:31]
    ds_read_b64_tr_b16 a[90:91], v4 offset:17600
    v_mfma_f32_16x16x32_bf16 v[28:31], a[120:123], v[240:243], v[28:31]
    ds_read_b64_tr_b16 a[92:93], v4 offset:17728
    v_mfma_f32_16x16x32_bf16 v[28:31], a[124:127], v[248:251], v[28:31]
    s_waitcnt lgkmcnt(11)
    ds_read_b64_tr_b16 a[94:95], v4 offset:17856
    v_mfma_f32_16x16x32_bf16 v[32:35], a[64:67], v[128:131], 0
    ds_read_b64_tr_b16 a[96:97], v4 offset:96
    v_cvt_pk_bf16_f32 v48, v16, v17
    v_mfma_f32_16x16x32_bf16 v[32:35], a[68:71], v[136:139], v[32:35]
    s_waitcnt lgkmcnt(9)
    ds_read_b64_tr_b16 a[98:99], v4 offset:224
    v_cvt_pk_bf16_f32 v49, v18, v19
    v_mfma_f32_16x16x32_bf16 v[32:35], a[72:75], v[144:147], v[32:35]
L2_pad12:
    s_cbranch_execz L2_walkret
    ds_read_b64_tr_b16 a[100:101], v4 offset:352
    v_cvt_pk_bf16_f32 v50, v24, v25
    v_mfma_f32_16x16x32_bf16 v[32:35], a[76:79], v[152:155], v[32:35]
    s_waitcnt lgkmcnt(7)
    ds_read_b64_tr_b16 a[102:103], v4 offset:480
    v_cvt_pk_bf16_f32 v51, v26, v27
    v_mfma_f32_16x16x32_bf16 v[32:35], a[80:83], v[192:195], v[32:35]
    s_mov_b32 s54, 8192
    ds_read_b64_tr_b16 a[104:105], v4 offset:608
    ds_read_b64_tr_b16 a[106:107], v4 offset:736
    v_mfma_f32_16x16x32_bf16 v[32:35], a[84:87], v[200:203], v[32:35]
    s_waitcnt lgkmcnt(6)
    v_permlane32_swap_b32 v48, v50
    v_mfma_f32_16x16x32_bf16 v[32:35], a[88:91], v[208:211], v[32:35]
    v_permlane32_swap_b32 v49, v51
    v_mfma_f32_16x16x32_bf16 v[32:35], a[92:95], v[216:219], v[32:35]
    ds_read_b64_tr_b16 a[108:109], v4 offset:864
    ds_read_b64_tr_b16 a[110:111], v4 offset:992
    buffer_store_dwordx4 v[48:51], v10, s[40:43], s54 offen offset:0 sc1
    v_mfma_f32_16x16x32_bf16 v[36:39], a[64:67], v[160:163], 0
    ds_read_b64_tr_b16 a[112:113], v4 offset:16992
    v_cvt_pk_bf16_f32 v52, v20, v21
    v_mfma_f32_16x16x32_bf16 v[36:39], a[68:71], v[168:171], v[36:39]
    ds_read_b64_tr_b16 a[114:115], v4 offset:17120
    v_cvt_pk_bf16_f32 v53, v22, v23
    v_mfma_f32_16x16x32_bf16 v[36:39], a[72:75], v[176:179], v[36:39]
    ds_read_b64_tr_b16 a[116:117], v4 offset:17248
    v_cvt_pk_bf16_f32 v54, v28, v29
    v_mfma_f32_16x16x32_bf16 v[36:39], a[76:79], v[184:187], v[36:39]
    ds_read_b64_tr_b16 a[118:119], v4 offset:17376
    v_cvt_pk_bf16_f32 v55, v30, v31
    v_mfma_f32_16x16x32_bf16 v[36:39], a[80:83], v[224:227], v[36:39]
    s_mov_b32 s54, 303104
    ds_read_b64_tr_b16 a[120:121], v4 offset:17504
    ds_read_b64_tr_b16 a[122:123], v4 offset:17632
    v_mfma_f32_16x16x32_bf16 v[36:39], a[84:87], v[232:235], v[36:39]
    v_permlane32_swap_b32 v52, v54
    v_mfma_f32_16x16x32_bf16 v[36:39], a[88:91], v[240:243], v[36:39]
    v_permlane32_swap_b32 v53, v55
    v_mfma_f32_16x16x32_bf16 v[36:39], a[92:95], v[248:251], v[36:39]
    s_waitcnt lgkmcnt(10)
    ds_read_b64_tr_b16 a[124:125], v4 offset:17760
    ds_read_b64_tr_b16 a[126:127], v4 offset:17888
    buffer_store_dwordx4 v[52:55], v10, s[40:43], s54 offen offset:0 sc1
    v_mfma_f32_16x16x32_bf16 v[40:43], a[96:99], v[128:131], 0
    v_mfma_f32_16x16x32_bf16 v[40:43], a[100:103], v[136:139], v[40:43]
    s_waitcnt lgkmcnt(8)
    v_mfma_f32_16x16x32_bf16 v[40:43], a[104:107], v[144:147], v[40:43]
    v_mfma_f32_16x16x32_bf16 v[40:43], a[108:111], v[152:155], v[40:43]
    s_waitcnt lgkmcnt(4)
    v_mfma_f32_16x16x32_bf16 v[40:43], a[112:115], v[192:195], v[40:43]
    v_mfma_f32_16x16x32_bf16 v[40:43], a[116:119], v[200:203], v[40:43]
    s_waitcnt lgkmcnt(0)
    v_mfma_f32_16x16x32_bf16 v[40:43], a[120:123], v[208:211], v[40:43]
    v_mfma_f32_16x16x32_bf16 v[40:43], a[124:127], v[216:219], v[40:43]
    v_mfma_f32_16x16x32_bf16 v[44:47], a[96:99], v[160:163], 0
    v_mfma_f32_16x16x32_bf16 v[44:47], a[100:103], v[168:171], v[44:47]
    v_mfma_f32_16x16x32_bf16 v[44:47], a[104:107], v[176:179], v[44:47]
    v_mfma_f32_16x16x32_bf16 v[44:47], a[108:111], v[184:187], v[44:47]
    v_mfma_f32_16x16x32_bf16 v[44:47], a[112:115], v[224:227], v[44:47]
    v_mfma_f32_16x16x32_bf16 v[44:47], a[116:119], v[232:235], v[44:47]
    v_mfma_f32_16x16x32_bf16 v[44:47], a[120:123], v[240:243], v[44:47]
    v_mfma_f32_16x16x32_bf16 v[44:47], a[124:127], v[248:251], v[44:47]
    s_nop 7
    v_cvt_pk_bf16_f32 v48, v32, v33
    v_cvt_pk_bf16_f32 v49, v34, v35
    v_cvt_pk_bf16_f32 v50, v40, v41
    v_cvt_pk_bf16_f32 v51, v42, v43
    s_nop 1
    v_permlane32_swap_b32 v48, v50
    v_permlane32_swap_b32 v49, v51
    s_mov_b32 s54, 8192
    buffer_store_dwordx4 v[48:51], v10, s[40:43], s54 offen offset:512 sc1
    v_cvt_pk_bf16_f32 v52, v36, v37
    v_cvt_pk_bf16_f32 v53, v38, v39
    v_cvt_pk_bf16_f32 v54, v44, v45
    v_cvt_pk_bf16_f32 v55, v46, v47
    s_nop 1
    v_permlane32_swap_b32 v52, v54
    v_permlane32_swap_b32 v53, v55
    s_mov_b32 s54, 303104
    buffer_store_dwordx4 v[52:55], v10, s[40:43], s54 offen offset:512 sc1
    v_and_b32 v6, 15, v0
    v_lshlrev_b32 v6, 7, v6
    s_lshl_b32 s15, s53, 13
    s_add_u32 s15, s15, 786432
    s_and_b32 s14, s52, 12
    s_lshl_b32 s14, s14, 9
    s_add_u32 s47, s15, s14
    buffer_load_dword v9, v6, s[84:87], s47 offen sc1
    s_lshl4_add_u32 s3, s51, s52
    s_lshl_b32 s3, s3, 7
    s_add_u32 s3, s3, s15
    s_movk_i32 s48, 0x1111
    v_lshrrev_b32 v15, 4, v0
    v_mul_u32_u24 v15, 9216, v15
    v_add_u32 v7, v59, v15
    s_movk_i32 s45, 4608
    buffer_load_dwordx4 v[76:79], v5, s[84:87], s45 offen offset:0 sc1
    s_movk_i32 s45, 18432
    buffer_load_dwordx4 v[88:91], v5, s[84:87], s45 offen offset:0 sc1
    s_movk_i32 s45, 4608
    buffer_load_dwordx4 v[80:83], v5, s[84:87], s45 offen offset:1024 sc1
    s_movk_i32 s45, 18432
    buffer_load_dwordx4 v[92:95], v5, s[84:87], s45 offen offset:1024 sc1
    s_movk_i32 s45, 4608
    buffer_load_dwordx4 v[84:87], v59, s[84:87], s45 offen offset:2048 sc1
    s_movk_i32 s45, 18432
    buffer_load_dwordx4 v[96:99], v59, s[84:87], s45 offen offset:2048 sc1
    buffer_load_dwordx4 v[100:103], v12, s[36:39], 0 offen offset:0
    buffer_load_dwordx4 v[104:107], v12, s[36:39], 0 offen offset:128
    buffer_load_dwordx4 v[108:111], v13, s[36:39], 0 offen offset:256
    buffer_load_dwordx4 v[64:67], v1, s[76:79], 0 offen offset:0
    buffer_load_dwordx4 v[68:71], v1, s[76:79], 0 offen offset:128
    buffer_load_dwordx4 v[72:75], v2, s[76:79], 0 offen offset:0
    v_mov_b32 v13, 1
    s_mov_b64 exec, 1
    s_waitcnt vmcnt(13)
    buffer_store_dword v13, v6, s[84:87], s3 offen sc1
    s_mov_b64 exec, -1
    s_waitcnt vmcnt(13)
    v_cmp_ne_u32 vcc, 0, v9
    s_nop 0
    s_lshr_b32 s3, vcc_lo, 1
    s_and_b32 s3, s3, vcc_lo
    s_lshr_b32 s14, s3, 2
    s_and_b32 s3, s3, s14
    s_and_b32 s3, s3, s48
    s_cbranch_scc0 L2_g0s
L2_g0r:
    s_ff1_i32_b32 s3, s3
    s_bitset0_b32 s48, s3
    s_mul_i32 s46, s3, 9216
    buffer_load_dword v9, v6, s[84:87], s47 offen sc1
    buffer_load_dwordx4 v[112:115], v7, s[88:91], s46 offen offset:2048 sc1
    buffer_load_dwordx4 v[116:119], v5, s[88:91], s46 offen offset:0 sc1
    buffer_load_dwordx4 v[120:123], v5, s[88:91], s46 offen offset:1024 sc1
    s_add_u32 s46, s46, 9216
    buffer_load_dwordx4 v[124:127], v5, s[88:91], s46 offen offset:0 sc1
    buffer_load_dwordx4 v[128:131], v5, s[88:91], s46 offen offset:1024 sc1
    s_add_u32 s46, s46, 9216
    buffer_load_dwordx4 v[132:135], v5, s[88:91], s46 offen offset:0 sc1
    buffer_load_dwordx4 v[136:139], v5, s[88:91], s46 offen offset:1024 sc1
    s_add_u32 s46, s46, 9216
    buffer_load_dwordx4 v[140:143], v5, s[88:91], s46 offen offset:0 sc1
    buffer_load_dwordx4 v[144:147], v5, s[88:91], s46 offen offset:1024 sc1
    s_waitcnt vmcnt(11)
    v_max_u32 v13, v76, v77
    v_max3_u32 v13, v13, v78, v79
    v_max3_u32 v13, v13, v88, v89
    v_max3_u32 v13, v13, v90, v91
    v_max3_u32 v13, v13, v80, v81
    v_max3_u32 v13, v13, v82, v83
    v_max3_u32 v13, v13, v92, v93
    v_max3_u32 v13, v13, v94, v95
    v_max3_u32 v13, v13, v84, v85
    v_max3_u32 v13, v13, v86, v87
    v_max3_u32 v13, v13, v96, v97
    v_max3_u32 v13, v13, v98, v99
    v_cmp_eq_u32 vcc, -1, v13
    s_nop 0
    s_cmp_lg_u64 vcc, 0
    s_cbranch_scc1 L2_pns
L2_pnr:
    v_pk_add_f32 v[76:77], v[76:77], v[88:89]
    v_pk_add_f32 v[78:79], v[78:79], v[90:91]
    ds_write_b128 v5, v[76:79] offset:0
    v_pk_add_f32 v[80:81], v[80:81], v[92:93]
    v_pk_add_f32 v[82:83], v[82:83], v[94:95]
    ds_write_b128 v5, v[80:83] offset:1024
    v_pk_add_f32 v[84:85], v[84:85], v[96:97]
    v_pk_add_f32 v[86:87], v[86:87], v[98:99]
    ds_write_b128 v59, v[84:87] offset:2048
    v_lshlrev_b32 v16, 16, v100
    v_and_b32 v17, 0xffff0000, v100
    v_lshlrev_b32 v18, 16, v101
    v_and_b32 v19, 0xffff0000, v101
    v_lshlrev_b32 v20, 16, v102
    v_and_b32 v21, 0xffff0000, v102
    v_lshlrev_b32 v22, 16, v103
    v_and_b32 v23, 0xffff0000, v103
    v_lshlrev_b32 v24, 16, v104
    v_and_b32 v25, 0xffff0000, v104
    v_lshlrev_b32 v26, 16, v105
    v_and_b32 v27, 0xffff0000, v105
    v_lshlrev_b32 v28, 16, v106
    v_and_b32 v29, 0xffff0000, v106
    v_lshlrev_b32 v30, 16, v107
    v_and_b32 v31, 0xffff0000, v107
    v_lshlrev_b32 v32, 16, v108
    v_and_b32 v33, 0xffff0000, v108
    v_lshlrev_b32 v34, 16, v109
    v_and_b32 v35, 0xffff0000, v109
    v_lshlrev_b32 v36, 16, v110
    v_and_b32 v37, 0xffff0000, v110
    v_lshlrev_b32 v38, 16, v111
    v_and_b32 v39, 0xffff0000, v111
    s_waitcnt lgkmcnt(0)
    s_barrier
    s_add_u32 s14, s55, 16384
    v_add_u32 v105, s14, v8
    v_add_u32 v106, 73728, v105
    s_mul_i32 s14, s51, 576
    v_lshrrev_b32 v14, 3, v0
    v_lshlrev_b32 v3, 5, v14
    v_add_u32 v3, s14, v3
    v_and_b32 v14, 1, v14
    v_lshlrev_b32 v4, 5, v14
    v_add_u32 v4, s14, v4
    ds_read_b128 v[76:79], v3 offset:4608
    ds_read_b128 v[80:83], v3 offset:4624
    ds_read_b128 v[84:87], v3 offset:4864
    ds_read_b128 v[88:91], v3 offset:4880
    ds_read_b128 v[92:95], v4 offset:5120
    ds_read_b128 v[96:99], v4 offset:5136
    ds_read_b128 v[40:43], v3 offset:2304
    ds_read_b128 v[44:47], v3 offset:2320
    ds_read_b128 v[48:51], v3 offset:2560
    ds_read_b128 v[52:55], v3 offset:2576
    ds_read_b128 v[56:59], v4 offset:2816
    ds_read_b128 v[60:63], v4 offset:2832
    s_waitcnt lgkmcnt(6)
    v_mul_f32 v76, v76, v16
    v_mul_f32 v77, v77, v17
    v_mul_f32 v78, v78, v18
    v_mul_f32 v79, v79, v19
    v_mul_f32 v80, v80, v20
    v_mul_f32 v81, v81, v21
    v_mul_f32 v82, v82, v22
    v_mul_f32 v83, v83, v23
    v_mul_f32 v84, v84, v24
    v_mul_f32 v85, v85, v25
    v_mul_f32 v86, v86, v26
    v_mul_f32 v87, v87, v27
    v_mul_f32 v88, v88, v28
    v_mul_f32 v89, v89, v29
    v_mul_f32 v90, v90, v30
    v_mul_f32 v91, v91, v31
    v_mul_f32 v92, v92, v32
    v_mul_f32 v93, v93, v33
    v_mul_f32 v94, v94, v34
    v_mul_f32 v95, v95, v35
    v_mul_f32 v96, v96, v36
    v_mul_f32 v97, v97, v37
    v_mul_f32 v98, v98, v38
    v_mul_f32 v99, v99, v39
    s_waitcnt lgkmcnt(0)
    s_waitcnt vmcnt(3)
    v_cmp_ne_u32 vcc, 0, v9
    s_nop 0
    s_lshr_b32 s3, vcc_lo, 1
    s_and_b32 s3, s3, vcc_lo
    s_lshr_b32 s14, s3, 2
    s_and_b32 s3, s3, s14
    s_and_b32 s3, s3, s48
    s_cbranch_scc0 L2_g1s
L2_g1r:
    s_ff1_i32_b32 s3, s3
    s_bitset0_b32 s48, s3
    s_mul_i32 s46, s3, 9216
    buffer_load_dword v9, v6, s[84:87], s47 offen sc1
    buffer_load_dwordx4 v[148:151], v7, s[88:91], s46 offen offset:2048 sc1
    ds_write_b128 v106, a[20:23] offset:36864
    v_add_f32 v100, v76, v77
    v_add_f32 v100, v100, v78
    v_add_f32 v100, v100, v79
    v_add_f32 v100, v100, v80
    v_add_f32 v100, v100, v81
    v_add_f32 v100, v100, v82
    v_add_f32 v100, v100, v83
    v_add_f32 v100, v100, v84
    v_add_f32 v100, v100, v85
    v_add_f32 v100, v100, v86
    v_add_f32 v100, v100, v87
    v_add_f32 v100, v100, v88
    v_add_f32 v100, v100, v89
    v_add_f32 v100, v100, v90
    v_add_f32 v100, v100, v91
    v_add_f32 v102, v92, v93
    v_add_f32 v102, v102, v94
    v_add_f32 v102, v102, v95
    v_add_f32 v102, v102, v96
    v_add_f32 v102, v102, v97
    v_add_f32 v102, v102, v98
    v_add_f32 v102, v102, v99
    v_fmac_f32 v100, 0x3e800000, v102
    s_waitcnt vmcnt(3)
    buffer_load_dwordx4 v[152:155], v5, s[88:91], s46 offen offset:0 sc1
    ds_write_b128 v106, a[24:27] offset:37888
    v_mul_f32 v101, v40, v16
    v_fmac_f32 v101, v41, v17
    v_fmac_f32 v101, v42, v18
    v_fmac_f32 v101, v43, v19
    v_fmac_f32 v101, v44, v20
    v_fmac_f32 v101, v45, v21
    v_fmac_f32 v101, v46, v22
    v_fmac_f32 v101, v47, v23
    v_fmac_f32 v101, v48, v24
    v_fmac_f32 v101, v49, v25
    v_fmac_f32 v101, v50, v26
    v_fmac_f32 v101, v51, v27
    v_fmac_f32 v101, v52, v28
    v_fmac_f32 v101, v53, v29
    v_fmac_f32 v101, v54, v30
    v_fmac_f32 v101, v55, v31
    v_mul_f32 v102, v56, v32
    v_fmac_f32 v102, v57, v33
    v_fmac_f32 v102, v58, v34
    v_fmac_f32 v102, v59, v35
    v_fmac_f32 v102, v60, v36
    v_fmac_f32 v102, v61, v37
    v_fmac_f32 v102, v62, v38
    v_fmac_f32 v102, v63, v39
    v_fmac_f32 v101, 0x3e800000, v102
    ds_read_b128 v[40:43], v3 offset:0
    ds_read_b128 v[44:47], v3 offset:16
    ds_read_b128 v[48:51], v3 offset:256
    ds_read_b128 v[52:55], v3 offset:272
    ds_read_b128 v[56:59], v4 offset:512
    ds_read_b128 v[60:63], v4 offset:528
    s_waitcnt vmcnt(3)
    buffer_load_dwordx4 v[156:159], v5, s[88:91], s46 offen offset:1024 sc1
    ds_write_b128 v106, a[28:31] offset:38912
    s_nop 1
    v_add_f32_dpp v100, v100, v100 row_ror:8 row_mask:0xf bank_mask:0xf
    v_add_f32_dpp v101, v101, v101 row_ror:8 row_mask:0xf bank_mask:0xf
    v_mov_b32 v102, v100
    v_mov_b32 v103, v101
    s_nop 0
    v_permlane16_swap_b32 v102, v100
    v_permlane16_swap_b32 v103, v101
    v_add_f32 v100, v100, v102
    v_add_f32 v101, v101, v103
    v_mov_b32 v102, v100
    v_mov_b32 v103, v101
    s_nop 0
    v_permlane32_swap_b32 v102, v100
    v_permlane32_swap_b32 v103, v101
    v_add_f32 v100, v100, v102
    v_add_f32 v101, v101, v103
    s_waitcnt vmcnt(3)
    s_add_u32 s46, s46, 9216
    buffer_load_dwordx4 v[160:163], v5, s[88:91], s46 offen offset:0 sc1
    ds_write_b128 v106, a[32:35] offset:39936
    v_and_b32 v14, 7, v0
    v_lshlrev_b32 v11, 4, v14
    v_add_u32 v11, 14080, v11
    s_lshl_b32 s3, s51, 2
    v_add_u32 v10, s3, v11
    ds_write_b32 v10, v100 offset:384
    ds_write_b32 v10, v101 offset:512
    v_lshl_add_u32 v1, v14, 4, v1
    v_lshl_add_u32 v2, v14, 4, v2
    v_add_u32 v1, 90112, v1
    v_add_u32 v2, 90112, v2
    s_and_b32 s3, s51, 1
    s_mul_i32 s3, s3, 288
    v_add_u32 v14, s3, v0
    s_lshl_b32 s45, s3, 4
    s_lshr_b32 s14, s51, 1
    s_mul_i32 s14, s14, 9344
    s_add_u32 s14, s14, 90112
    v_add_u32 v15, 0, v14
    v_mul_u32_u24 v12, 911, v15
    v_lshrrev_b32 v12, 16, v12
    v_add_u32 v15, v15, v12
    v_lshl_add_u32 v107, v15, 4, s14
    v_add_u32 v15, 64, v14
    v_mul_u32_u24 v12, 911, v15
    v_lshrrev_b32 v12, 16, v12
    v_add_u32 v15, v15, v12
    v_lshl_add_u32 v108, v15, 4, s14
    v_add_u32 v15, 128, v14
    v_mul_u32_u24 v12, 911, v15
    v_lshrrev_b32 v12, 16, v12
    v_add_u32 v15, v15, v12
    v_lshl_add_u32 v109, v15, 4, s14
    v_add_u32 v15, 192, v14
    v_mul_u32_u24 v12, 911, v15
    v_lshrrev_b32 v12, 16, v12
    v_add_u32 v15, v15, v12
    v_lshl_add_u32 v110, v15, 4, s14
    v_add_u32 v15, 256, v14
    v_mul_u32_u24 v12, 911, v15
    v_lshrrev_b32 v12, 16, v12
    v_add_u32 v15, v15, v12
    v_lshl_add_u32 v111, v15, 4, s14
    s_mul_i32 s3, s96, 9216
    s_add_u32 s14, s3, 4194304
    s_cmp_lt_u32 s51, 2
    s_cselect_b32 s3, s3, s14
    s_cselect_b64 s[24:25], s[80:81], s[84:85]
    s_add_u32 s24, s24, s3
    s_addc_u32 s25, s25, 0
    s_mov_b32 s26, 9216
    s_mov_b32 s27, 0x20000
    s_waitcnt vmcnt(3)
    buffer_load_dwordx4 v[164:167], v5, s[88:91], s46 offen offset:1024 sc1
    ds_write_b128 v106, a[36:39] offset:40960
    s_waitcnt vmcnt(3)
    s_add_u32 s46, s46, 9216
    buffer_load_dwordx4 v[168:171], v5, s[88:91], s46 offen offset:0 sc1
    ds_write_b128 v106, a[40:43] offset:41984
    v_lshlrev_b32 v32, 16, v112
    v_and_b32 v33, 0xffff0000, v112
    v_lshlrev_b32 v34, 16, v113
    v_and_b32 v35, 0xffff0000, v113
    v_lshlrev_b32 v36, 16, v114
    v_and_b32 v37, 0xffff0000, v114
    v_lshlrev_b32 v38, 16, v115
    v_and_b32 v39, 0xffff0000, v115
    s_waitcnt vmcnt(3)
    buffer_load_dwordx4 v[172:175], v5, s[88:91], s46 offen offset:1024 sc1
    ds_write_b128 v106, a[44:47] offset:43008
    v_lshlrev_b32 v16, 16, v116
    v_and_b32 v17, 0xffff0000, v116
    v_lshlrev_b32 v18, 16, v117
    v_and_b32 v19, 0xffff0000, v117
    v_lshlrev_b32 v20, 16, v118
    v_and_b32 v21, 0xffff0000, v118
    v_lshlrev_b32 v22, 16, v119
    v_and_b32 v23, 0xffff0000, v119
    s_waitcnt vmcnt(3)
    s_add_u32 s46, s46, 9216
    buffer_load_dwordx4 v[176:179], v5, s[88:91], s46 offen offset:0 sc1
    ds_write_b128 v106, a[48:51] offset:44032
    v_lshlrev_b32 v24, 16, v120
    v_and_b32 v25, 0xffff0000, v120
    v_lshlrev_b32 v26, 16, v121
    v_and_b32 v27, 0xffff0000, v121
    v_lshlrev_b32 v28, 16, v122
    v_and_b32 v29, 0xffff0000, v122
    v_lshlrev_b32 v30, 16, v123
    v_and_b32 v31, 0xffff0000, v123
    s_waitcnt vmcnt(3)
    buffer_load_dwordx4 v[180:183], v5, s[88:91], s46 offen offset:1024 sc1
    ds_write_b128 v106, a[52:55] offset:45056
    v_lshlrev_b32 v12, 16, v124
    v_and_b32 v13, 0xffff0000, v124
    v_pk_add_f32 v[16:17], v[16:17], v[12:13]
    v_lshlrev_b32 v14, 16, v125
    v_and_b32 v15, 0xffff0000, v125
    v_pk_add_f32 v[18:19], v[18:19], v[14:15]
    v_lshlrev_b32 v12, 16, v126
    v_and_b32 v13, 0xffff0000, v126
    v_pk_add_f32 v[20:21], v[20:21], v[12:13]
    v_lshlrev_b32 v14, 16, v127
    v_and_b32 v15, 0xffff0000, v127
    v_pk_add_f32 v[22:23], v[22:23], v[14:15]
    s_waitcnt vmcnt(3)
    v_cmp_ne_u32 vcc, 0, v9
    s_nop 0
    s_lshr_b32 s3, vcc_lo, 1
    s_and_b32 s3, s3, vcc_lo
    s_lshr_b32 s14, s3, 2
    s_and_b32 s3, s3, s14
    s_and_b32 s3, s3, s48
    s_cbranch_scc0 L2_g2s
L2_g2r:
    s_ff1_i32_b32 s3, s3
    s_bitset0_b32 s48, s3
    s_mul_i32 s46, s3, 9216
    buffer_load_dword v9, v6, s[84:87], s47 offen sc1
    buffer_load_dwordx4 v[184:187], v7, s[88:91], s46 offen offset:2048 sc1
    ds_write_b128 v105, a[128:131] offset:0
    v_lshlrev_b32 v12, 16, v128
    v_and_b32 v13, 0xffff0000, v128
    v_pk_add_f32 v[24:25], v[24:25], v[12:13]
    v_lshlrev_b32 v14, 16, v129
    v_and_b32 v15, 0xffff0000, v129
    v_pk_add_f32 v[26:27], v[26:27], v[14:15]
    v_lshlrev_b32 v12, 16, v130
    v_and_b32 v13, 0xffff0000, v130
    v_pk_add_f32 v[28:29], v[28:29], v[12:13]
    v_lshlrev_b32 v14, 16, v131
    v_and_b32 v15, 0xffff0000, v131
    v_pk_add_f32 v[30:31], v[30:31], v[14:15]
    s_waitcnt vmcnt(3)
    buffer_load_dwordx4 v[188:191], v5, s[88:91], s46 offen offset:0 sc1
    ds_write_b128 v105, a[132:135] offset:1024
    v_lshlrev_b32 v12, 16, v132
    v_and_b32 v13, 0xffff0000, v132
    v_pk_add_f32 v[16:17], v[16:17], v[12:13]
    v_lshlrev_b32 v14, 16, v133
    v_and_b32 v15, 0xffff0000, v133
    v_pk_add_f32 v[18:19], v[18:19], v[14:15]
    v_lshlrev_b32 v12, 16, v134
    v_and_b32 v13, 0xffff0000, v134
    v_pk_add_f32 v[20:21], v[20:21], v[12:13]
    v_lshlrev_b32 v14, 16, v135
    v_and_b32 v15, 0xffff0000, v135
    v_pk_add_f32 v[22:23], v[22:23], v[14:15]
    s_waitcnt vmcnt(3)
    buffer_load_dwordx4 v[192:195], v5, s[88:91], s46 offen offset:1024 sc1
    ds_write_b128 v105, a[136:139] offset:2048
    v_lshlrev_b32 v12, 16, v136
    v_and_b32 v13, 0xffff0000, v136
    v_pk_add_f32 v[24:25], v[24:25], v[12:13]
    v_lshlrev_b32 v14, 16, v137
    v_and_b32 v15, 0xffff0000, v137
    v_pk_add_f32 v[26:27], v[26:27], v[14:15]
    v_lshlrev_b32 v12, 16, v138
    v_and_b32 v13, 0xffff0000, v138
    v_pk_add_f32 v[28:29], v[28:29], v[12:13]
    v_lshlrev_b32 v14, 16, v139
    v_and_b32 v15, 0xffff0000, v139
    v_pk_add_f32 v[30:31], v[30:31], v[14:15]
    s_waitcnt vmcnt(3)
    s_add_u32 s46, s46, 9216
    buffer_load_dwordx4 v[196:199], v5, s[88:91], s46 offen offset:0 sc1
    ds_write_b128 v105, a[140:143] offset:3072
    v_lshlrev_b32 v12, 16, v140
    v_and_b32 v13, 0xffff0000, v140
    v_pk_add_f32 v[16:17], v[16:17], v[12:13]
    v_lshlrev_b32 v14, 16, v141
    v_and_b32 v15, 0xffff0000, v141
    v_pk_add_f32 v[18:19], v[18:19], v[14:15]
    v_lshlrev_b32 v12, 16, v142
    v_and_b32 v13, 0xffff0000, v142
    v_pk_add_f32 v[20:21], v[20:21], v[12:13]
    v_lshlrev_b32 v14, 16, v143
    v_and_b32 v15, 0xffff0000, v143
    v_pk_add_f32 v[22:23], v[22:23], v[14:15]
    s_waitcnt vmcnt(3)
    buffer_load_dwordx4 v[200:203], v5, s[88:91], s46 offen offset:1024 sc1
    ds_write_b128 v105, a[144:147] offset:4096
    v_lshlrev_b32 v12, 16, v144
    v_and_b32 v13, 0xffff0000, v144
    v_pk_add_f32 v[24:25], v[24:25], v[12:13]
    v_lshlrev_b32 v14, 16, v145
    v_and_b32 v15, 0xffff0000, v145
    v_pk_add_f32 v[26:27], v[26:27], v[14:15]
    v_lshlrev_b32 v12, 16, v146
    v_and_b32 v13, 0xffff0000, v146
    v_pk_add_f32 v[28:29], v[28:29], v[12:13]
    v_lshlrev_b32 v14, 16, v147
    v_and_b32 v15, 0xffff0000, v147
    v_pk_add_f32 v[30:31], v[30:31], v[14:15]
    s_waitcnt vmcnt(3)
    s_add_u32 s46, s46, 9216
    buffer_load_dwordx4 v[204:207], v5, s[88:91], s46 offen offset:0 sc1
    ds_write_b128 v105, a[148:151] offset:5120
    v_lshlrev_b32 v12, 16, v148
    v_and_b32 v13, 0xffff0000, v148
    v_pk_add_f32 v[32:33], v[32:33], v[12:13]
    v_lshlrev_b32 v14, 16, v149
    v_and_b32 v15, 0xffff0000, v149
    v_pk_add_f32 v[34:35], v[34:35], v[14:15]
    v_lshlrev_b32 v12, 16, v150
    v_and_b32 v13, 0xffff0000, v150
    v_pk_add_f32 v[36:37], v[36:37], v[12:13]
    v_lshlrev_b32 v14, 16, v151
    v_and_b32 v15, 0xffff0000, v151
    v_pk_add_f32 v[38:39], v[38:39], v[14:15]
    s_waitcnt vmcnt(3)
    buffer_load_dwordx4 v[208:211], v5, s[88:91], s46 offen offset:1024 sc1
    ds_write_b128 v105, a[152:155] offset:6144
    v_lshlrev_b32 v12, 16, v152
    v_and_b32 v13, 0xffff0000, v152
    v_pk_add_f32 v[16:17], v[16:17], v[12:13]
    v_lshlrev_b32 v14, 16, v153
    v_and_b32 v15, 0xffff0000, v153
    v_pk_add_f32 v[18:19], v[18:19], v[14:15]
    v_lshlrev_b32 v12, 16, v154
    v_and_b32 v13, 0xffff0000, v154
    v_pk_add_f32 v[20:21], v[20:21], v[12:13]
    v_lshlrev_b32 v14, 16, v155
    v_and_b32 v15, 0xffff0000, v155
    v_pk_add_f32 v[22:23], v[22:23], v[14:15]
    s_waitcnt vmcnt(3)
    s_add_u32 s46, s46, 9216
    buffer_load_dwordx4 v[212:215], v5, s[88:91], s46 offen offset:0 sc1
    ds_write_b128 v105, a[156:159] offset:7168
    v_lshlrev_b32 v12, 16, v156
    v_and_b32 v13, 0xffff0000, v156
    v_pk_add_f32 v[24:25], v[24:25], v[12:13]
    v_lshlrev_b32 v14, 16, v157
    v_and_b32 v15, 0xffff0000, v157
    v_pk_add_f32 v[26:27], v[26:27], v[14:15]
    v_lshlrev_b32 v12, 16, v158
    v_and_b32 v13, 0xffff0000, v158
    v_pk_add_f32 v[28:29], v[28:29], v[12:13]
    v_lshlrev_b32 v14, 16, v159
    v_and_b32 v15, 0xffff0000, v159
    v_pk_add_f32 v[30:31], v[30:31], v[14:15]
    s_waitcnt vmcnt(3)
    buffer_load_dwordx4 v[216:219], v5, s[88:91], s46 offen offset:1024 sc1
    ds_write_b128 v105, a[160:163] offset:8192
    v_lshlrev_b32 v12, 16, v160
    v_and_b32 v13, 0xffff0000, v160
    v_pk_add_f32 v[16:17], v[16:17], v[12:13]
    v_lshlrev_b32 v14, 16, v161
    v_and_b32 v15, 0xffff0000, v161
    v_pk_add_f32 v[18:19], v[18:19], v[14:15]
    v_lshlrev_b32 v12, 16, v162
    v_and_b32 v13, 0xffff0000, v162
    v_pk_add_f32 v[20:21], v[20:21], v[12:13]
    v_lshlrev_b32 v14, 16, v163
    v_and_b32 v15, 0xffff0000, v163
    v_pk_add_f32 v[22:23], v[22:23], v[14:15]
    s_waitcnt vmcnt(3)
    v_cmp_ne_u32 vcc, 0, v9
    s_nop 0
    s_lshr_b32 s3, vcc_lo, 1
    s_and_b32 s3, s3, vcc_lo
    s_lshr_b32 s14, s3, 2
    s_and_b32 s3, s3, s14
    s_and_b32 s3, s3, s48
    s_cbranch_scc0 L2_g3s
L2_g3r:
    s_ff1_i32_b32 s3, s3
    s_bitset0_b32 s48, s3
    s_mul_i32 s46, s3, 9216
    buffer_load_dwordx4 v[220:223], v7, s[88:91], s46 offen offset:2048 sc1
    ds_write_b128 v105, a[164:167] offset:36864
    v_lshlrev_b32 v12, 16, v164
    v_and_b32 v13, 0xffff0000, v164
    v_pk_add_f32 v[24:25], v[24:25], v[12:13]
    v_lshlrev_b32 v14, 16, v165
    v_and_b32 v15, 0xffff0000, v165
    v_pk_add_f32 v[26:27], v[26:27], v[14:15]
    v_lshlrev_b32 v12, 16, v166
    v_and_b32 v13, 0xffff0000, v166
    v_pk_add_f32 v[28:29], v[28:29], v[12:13]
    v_lshlrev_b32 v14, 16, v167
    v_and_b32 v15, 0xffff0000, v167
    v_pk_add_f32 v[30:31], v[30:31], v[14:15]
    s_waitcnt vmcnt(3)
    buffer_load_dwordx4 v[224:227], v5, s[88:91], s46 offen offset:0 sc1
    ds_write_b128 v105, a[168:171] offset:37888
    v_lshlrev_b32 v12, 16, v168
    v_and_b32 v13, 0xffff0000, v168
    v_pk_add_f32 v[16:17], v[16:17], v[12:13]
    v_lshlrev_b32 v14, 16, v169
    v_and_b32 v15, 0xffff0000, v169
    v_pk_add_f32 v[18:19], v[18:19], v[14:15]
    v_lshlrev_b32 v12, 16, v170
    v_and_b32 v13, 0xffff0000, v170
    v_pk_add_f32 v[20:21], v[20:21], v[12:13]
    v_lshlrev_b32 v14, 16, v171
    v_and_b32 v15, 0xffff0000, v171
    v_pk_add_f32 v[22:23], v[22:23], v[14:15]
    s_waitcnt vmcnt(3)
    buffer_load_dwordx4 v[228:231], v5, s[88:91], s46 offen offset:1024 sc1
    ds_write_b128 v105, a[172:175] offset:38912
    v_lshlrev_b32 v12, 16, v172
    v_and_b32 v13, 0xffff0000, v172
    v_pk_add_f32 v[24:25], v[24:25], v[12:13]
    v_lshlrev_b32 v14, 16, v173
    v_and_b32 v15, 0xffff0000, v173
    v_pk_add_f32 v[26:27], v[26:27], v[14:15]
    v_lshlrev_b32 v12, 16, v174
    v_and_b32 v13, 0xffff0000, v174
    v_pk_add_f32 v[28:29], v[28:29], v[12:13]
    v_lshlrev_b32 v14, 16, v175
    v_and_b32 v15, 0xffff0000, v175
    v_pk_add_f32 v[30:31], v[30:31], v[14:15]
    s_waitcnt vmcnt(3)
    s_add_u32 s46, s46, 9216
    buffer_load_dwordx4 v[232:235], v5, s[88:91], s46 offen offset:0 sc1
    ds_write_b128 v105, a[176:179] offset:39936
    v_lshlrev_b32 v12, 16, v176
    v_and_b32 v13, 0xffff0000, v176
    v_pk_add_f32 v[16:17], v[16:17], v[12:13]
    v_lshlrev_b32 v14, 16, v177
    v_and_b32 v15, 0xffff0000, v177
    v_pk_add_f32 v[18:19], v[18:19], v[14:15]
    v_lshlrev_b32 v12, 16, v178
    v_and_b32 v13, 0xffff0000, v178
    v_pk_add_f32 v[20:21], v[20:21], v[12:13]
    v_lshlrev_b32 v14, 16, v179
    v_and_b32 v15, 0xffff0000, v179
    v_pk_add_f32 v[22:23], v[22:23], v[14:15]
    s_waitcnt vmcnt(3)
    buffer_load_dwordx4 v[236:239], v5, s[88:91], s46 offen offset:1024 sc1
    ds_write_b128 v105, a[180:183] offset:40960
L2_pad13:
    s_cbranch_execz L2_walkret
    v_lshlrev_b32 v12, 16, v180
    v_and_b32 v13, 0xffff0000, v180
    v_pk_add_f32 v[24:25], v[24:25], v[12:13]
    v_lshlrev_b32 v14, 16, v181
    v_and_b32 v15, 0xffff0000, v181
    v_pk_add_f32 v[26:27], v[26:27], v[14:15]
    v_lshlrev_b32 v12, 16, v182
    v_and_b32 v13, 0xffff0000, v182
    v_pk_add_f32 v[28:29], v[28:29], v[12:13]
    v_lshlrev_b32 v14, 16, v183
    v_and_b32 v15, 0xffff0000, v183
    v_pk_add_f32 v[30:31], v[30:31], v[14:15]
    s_waitcnt vmcnt(3)
    s_add_u32 s46, s46, 9216
    buffer_load_dwordx4 v[240:243], v5, s[88:91], s46 offen offset:0 sc1
    ds_write_b128 v105, a[184:187] offset:41984
    v_lshlrev_b32 v12, 16, v184
    v_and_b32 v13, 0xffff0000, v184
    v_pk_add_f32 v[32:33], v[32:33], v[12:13]
    v_lshlrev_b32 v14, 16, v185
    v_and_b32 v15, 0xffff0000, v185
    v_pk_add_f32 v[34:35], v[34:35], v[14:15]
    v_lshlrev_b32 v12, 16, v186
    v_and_b32 v13, 0xffff0000, v186
    v_pk_add_f32 v[36:37], v[36:37], v[12:13]
    v_lshlrev_b32 v14, 16, v187
    v_and_b32 v15, 0xffff0000, v187
    v_pk_add_f32 v[38:39], v[38:39], v[14:15]
    ds_read_b128 v[112:115], v3 offset:4608
    ds_read_b128 v[116:119], v3 offset:4624
    ds_read_b128 v[120:123], v3 offset:4864
    ds_read_b128 v[124:127], v3 offset:4880
    ds_read_b128 v[128:131], v4 offset:5120
    ds_read_b128 v[132:135], v4 offset:5136
    ds_read_b128 v[136:139], v3 offset:2304
    ds_read_b128 v[140:143], v3 offset:2320
    ds_read_b128 v[144:147], v3 offset:2560
    ds_read_b128 v[148:151], v3 offset:2576
    ds_read_b128 v[152:155], v4 offset:2816
    ds_read_b128 v[156:159], v4 offset:2832
    ds_read_b128 v[160:163], v3 offset:6912
    ds_read_b128 v[164:167], v3 offset:6928
    ds_read_b128 v[168:171], v3 offset:7168
    ds_read_b128 v[172:175], v3 offset:7184
    ds_read_b128 v[176:179], v4 offset:7424
    ds_read_b128 v[180:183], v4 offset:7440
    s_waitcnt vmcnt(3)
    buffer_load_dwordx4 v[244:247], v5, s[88:91], s46 offen offset:1024 sc1
    ds_write_b128 v105, a[188:191] offset:43008
    v_lshlrev_b32 v12, 16, v188
    v_and_b32 v13, 0xffff0000, v188
    v_pk_add_f32 v[16:17], v[16:17], v[12:13]
    v_lshlrev_b32 v14, 16, v189
    v_and_b32 v15, 0xffff0000, v189
    v_pk_add_f32 v[18:19], v[18:19], v[14:15]
    v_lshlrev_b32 v12, 16, v190
    v_and_b32 v13, 0xffff0000, v190
    v_pk_add_f32 v[20:21], v[20:21], v[12:13]
    v_lshlrev_b32 v14, 16, v191
    v_and_b32 v15, 0xffff0000, v191
    v_pk_add_f32 v[22:23], v[22:23], v[14:15]
    s_waitcnt vmcnt(3)
    s_add_u32 s46, s46, 9216
    buffer_load_dwordx4 v[248:251], v5, s[88:91], s46 offen offset:0 sc1
    ds_write_b128 v105, a[192:195] offset:44032
    v_lshlrev_b32 v12, 16, v192
    v_and_b32 v13, 0xffff0000, v192
    v_pk_add_f32 v[24:25], v[24:25], v[12:13]
    v_lshlrev_b32 v14, 16, v193
    v_and_b32 v15, 0xffff0000, v193
    v_pk_add_f32 v[26:27], v[26:27], v[14:15]
    v_lshlrev_b32 v12, 16, v194
    v_and_b32 v13, 0xffff0000, v194
    v_pk_add_f32 v[28:29], v[28:29], v[12:13]
    v_lshlrev_b32 v14, 16, v195
    v_and_b32 v15, 0xffff0000, v195
    v_pk_add_f32 v[30:31], v[30:31], v[14:15]
    s_waitcnt vmcnt(3)
    buffer_load_dwordx4 v[252:255], v5, s[88:91], s46 offen offset:1024 sc1
    ds_write_b128 v105, a[196:199] offset:45056
    v_lshlrev_b32 v12, 16, v196
    v_and_b32 v13, 0xffff0000, v196
    v_pk_add_f32 v[16:17], v[16:17], v[12:13]
    v_lshlrev_b32 v14, 16, v197
    v_and_b32 v15, 0xffff0000, v197
    v_pk_add_f32 v[18:19], v[18:19], v[14:15]
    v_lshlrev_b32 v12, 16, v198
    v_and_b32 v13, 0xffff0000, v198
    v_pk_add_f32 v[20:21], v[20:21], v[12:13]
    v_lshlrev_b32 v14, 16, v199
    v_and_b32 v15, 0xffff0000, v199
    v_pk_add_f32 v[22:23], v[22:23], v[14:15]
    v_lshlrev_b32 v12, 16, v200
    v_and_b32 v13, 0xffff0000, v200
    v_pk_add_f32 v[24:25], v[24:25], v[12:13]
    v_lshlrev_b32 v14, 16, v201
    v_and_b32 v15, 0xffff0000, v201
    v_pk_add_f32 v[26:27], v[26:27], v[14:15]
    v_lshlrev_b32 v12, 16, v202
    v_and_b32 v13, 0xffff0000, v202
    v_pk_add_f32 v[28:29], v[28:29], v[12:13]
    v_lshlrev_b32 v14, 16, v203
    v_and_b32 v15, 0xffff0000, v203
    v_pk_add_f32 v[30:31], v[30:31], v[14:15]
    v_lshlrev_b32 v12, 16, v204
    v_and_b32 v13, 0xffff0000, v204
    v_pk_add_f32 v[16:17], v[16:17], v[12:13]
    v_lshlrev_b32 v14, 16, v205
    v_and_b32 v15, 0xffff0000, v205
    v_pk_add_f32 v[18:19], v[18:19], v[14:15]
    v_lshlrev_b32 v12, 16, v206
    v_and_b32 v13, 0xffff0000, v206
    v_pk_add_f32 v[20:21], v[20:21], v[12:13]
    v_lshlrev_b32 v14, 16, v207
    v_and_b32 v15, 0xffff0000, v207
    v_pk_add_f32 v[22:23], v[22:23], v[14:15]
    v_lshlrev_b32 v12, 16, v208
    v_and_b32 v13, 0xffff0000, v208
    v_pk_add_f32 v[24:25], v[24:25], v[12:13]
    v_lshlrev_b32 v14, 16, v209
    v_and_b32 v15, 0xffff0000, v209
    v_pk_add_f32 v[26:27], v[26:27], v[14:15]
    v_lshlrev_b32 v12, 16, v210
    v_and_b32 v13, 0xffff0000, v210
    v_pk_add_f32 v[28:29], v[28:29], v[12:13]
    v_lshlrev_b32 v14, 16, v211
    v_and_b32 v15, 0xffff0000, v211
    v_pk_add_f32 v[30:31], v[30:31], v[14:15]
    v_lshlrev_b32 v12, 16, v212
    v_and_b32 v13, 0xffff0000, v212
    v_pk_add_f32 v[16:17], v[16:17], v[12:13]
    v_lshlrev_b32 v14, 16, v213
    v_and_b32 v15, 0xffff0000, v213
    v_pk_add_f32 v[18:19], v[18:19], v[14:15]
    v_lshlrev_b32 v12, 16, v214
    v_and_b32 v13, 0xffff0000, v214
    v_pk_add_f32 v[20:21], v[20:21], v[12:13]
    v_lshlrev_b32 v14, 16, v215
    v_and_b32 v15, 0xffff0000, v215
    v_pk_add_f32 v[22:23], v[22:23], v[14:15]
    v_lshlrev_b32 v12, 16, v216
    v_and_b32 v13, 0xffff0000, v216
    v_pk_add_f32 v[24:25], v[24:25], v[12:13]
    v_lshlrev_b32 v14, 16, v217
    v_and_b32 v15, 0xffff0000, v217
    v_pk_add_f32 v[26:27], v[26:27], v[14:15]
    v_lshlrev_b32 v12, 16, v218
    v_and_b32 v13, 0xffff0000, v218
    v_pk_add_f32 v[28:29], v[28:29], v[12:13]
    v_lshlrev_b32 v14, 16, v219
    v_and_b32 v15, 0xffff0000, v219
    v_pk_add_f32 v[30:31], v[30:31], v[14:15]
    v_lshlrev_b32 v12, 16, v220
    v_and_b32 v13, 0xffff0000, v220
    v_pk_add_f32 v[32:33], v[32:33], v[12:13]
    v_lshlrev_b32 v14, 16, v221
    v_and_b32 v15, 0xffff0000, v221
    v_pk_add_f32 v[34:35], v[34:35], v[14:15]
    v_lshlrev_b32 v12, 16, v222
    v_and_b32 v13, 0xffff0000, v222
    v_pk_add_f32 v[36:37], v[36:37], v[12:13]
    v_lshlrev_b32 v14, 16, v223
    v_and_b32 v15, 0xffff0000, v223
    v_pk_add_f32 v[38:39], v[38:39], v[14:15]
    v_mov_b32 v184, v32
    v_mov_b32 v185, v33
    v_mov_b32 v186, v34
    v_mov_b32 v187, v35
    v_mov_b32 v188, v36
    v_mov_b32 v189, v37
    v_mov_b32 v190, v38
    v_mov_b32 v191, v39
    v_permlane16_swap_b32 v184, v32
    v_permlane16_swap_b32 v185, v33
    v_permlane16_swap_b32 v186, v34
    v_permlane16_swap_b32 v187, v35
    v_permlane16_swap_b32 v188, v36
    v_permlane16_swap_b32 v189, v37
    v_permlane16_swap_b32 v190, v38
    v_permlane16_swap_b32 v191, v39
    v_add_f32 v32, v32, v184
    v_add_f32 v33, v33, v185
    v_add_f32 v34, v34, v186
    v_add_f32 v35, v35, v187
    v_add_f32 v36, v36, v188
    v_add_f32 v37, v37, v189
    v_add_f32 v38, v38, v190
    v_add_f32 v39, v39, v191
    v_mov_b32 v184, v32
    v_mov_b32 v185, v33
    v_mov_b32 v186, v34
    v_mov_b32 v187, v35
    v_mov_b32 v188, v36
    v_mov_b32 v189, v37
    v_mov_b32 v190, v38
    v_mov_b32 v191, v39
    v_permlane32_swap_b32 v184, v32
    v_permlane32_swap_b32 v185, v33
    v_permlane32_swap_b32 v186, v34
    v_permlane32_swap_b32 v187, v35
    v_permlane32_swap_b32 v188, v36
    v_permlane32_swap_b32 v189, v37
    v_permlane32_swap_b32 v190, v38
    v_permlane32_swap_b32 v191, v39
    v_add_f32 v32, v32, v184
    v_add_f32 v33, v33, v185
    v_add_f32 v34, v34, v186
    v_add_f32 v35, v35, v187
    v_add_f32 v36, v36, v188
    v_add_f32 v37, v37, v189
    v_add_f32 v38, v38, v190
    v_add_f32 v39, v39, v191
    v_lshlrev_b32 v12, 16, v224
    v_and_b32 v13, 0xffff0000, v224
    v_pk_add_f32 v[16:17], v[16:17], v[12:13]
    v_lshlrev_b32 v14, 16, v225
    v_and_b32 v15, 0xffff0000, v225
    v_pk_add_f32 v[18:19], v[18:19], v[14:15]
    v_lshlrev_b32 v12, 16, v226
    v_and_b32 v13, 0xffff0000, v226
    v_pk_add_f32 v[20:21], v[20:21], v[12:13]
    v_lshlrev_b32 v14, 16, v227
    v_and_b32 v15, 0xffff0000, v227
    v_pk_add_f32 v[22:23], v[22:23], v[14:15]
    v_lshlrev_b32 v12, 16, v228
    v_and_b32 v13, 0xffff0000, v228
    v_pk_add_f32 v[24:25], v[24:25], v[12:13]
    v_lshlrev_b32 v14, 16, v229
    v_and_b32 v15, 0xffff0000, v229
    v_pk_add_f32 v[26:27], v[26:27], v[14:15]
    v_lshlrev_b32 v12, 16, v230
    v_and_b32 v13, 0xffff0000, v230
    v_pk_add_f32 v[28:29], v[28:29], v[12:13]
    v_lshlrev_b32 v14, 16, v231
    v_and_b32 v15, 0xffff0000, v231
    v_pk_add_f32 v[30:31], v[30:31], v[14:15]
    v_lshlrev_b32 v12, 16, v232
    v_and_b32 v13, 0xffff0000, v232
    v_pk_add_f32 v[16:17], v[16:17], v[12:13]
    v_lshlrev_b32 v14, 16, v233
    v_and_b32 v15, 0xffff0000, v233
    v_pk_add_f32 v[18:19], v[18:19], v[14:15]
    v_lshlrev_b32 v12, 16, v234
    v_and_b32 v13, 0xffff0000, v234
    v_pk_add_f32 v[20:21], v[20:21], v[12:13]
    v_lshlrev_b32 v14, 16, v235
    v_and_b32 v15, 0xffff0000, v235
    v_pk_add_f32 v[22:23], v[22:23], v[14:15]
    v_lshlrev_b32 v12, 16, v236
    v_and_b32 v13, 0xffff0000, v236
    v_pk_add_f32 v[24:25], v[24:25], v[12:13]
    v_lshlrev_b32 v14, 16, v237
    v_and_b32 v15, 0xffff0000, v237
    v_pk_add_f32 v[26:27], v[26:27], v[14:15]
    v_lshlrev_b32 v12, 16, v238
    v_and_b32 v13, 0xffff0000, v238
    v_pk_add_f32 v[28:29], v[28:29], v[12:13]
    v_lshlrev_b32 v14, 16, v239
    v_and_b32 v15, 0xffff0000, v239
    v_pk_add_f32 v[30:31], v[30:31], v[14:15]
    s_waitcnt vmcnt(3)
    v_lshlrev_b32 v12, 16, v240
    v_and_b32 v13, 0xffff0000, v240
    v_pk_add_f32 v[16:17], v[16:17], v[12:13]
    v_lshlrev_b32 v14, 16, v241
    v_and_b32 v15, 0xffff0000, v241
    v_pk_add_f32 v[18:19], v[18:19], v[14:15]
    v_lshlrev_b32 v12, 16, v242
    v_and_b32 v13, 0xffff0000, v242
    v_pk_add_f32 v[20:21], v[20:21], v[12:13]
    v_lshlrev_b32 v14, 16, v243
    v_and_b32 v15, 0xffff0000, v243
    v_pk_add_f32 v[22:23], v[22:23], v[14:15]
    s_waitcnt vmcnt(2)
    v_lshlrev_b32 v12, 16, v244
    v_and_b32 v13, 0xffff0000, v244
    v_pk_add_f32 v[24:25], v[24:25], v[12:13]
    v_lshlrev_b32 v14, 16, v245
    v_and_b32 v15, 0xffff0000, v245
    v_pk_add_f32 v[26:27], v[26:27], v[14:15]
    v_lshlrev_b32 v12, 16, v246
    v_and_b32 v13, 0xffff0000, v246
    v_pk_add_f32 v[28:29], v[28:29], v[12:13]
    v_lshlrev_b32 v14, 16, v247
    v_and_b32 v15, 0xffff0000, v247
    v_pk_add_f32 v[30:31], v[30:31], v[14:15]
    s_waitcnt vmcnt(1)
    v_lshlrev_b32 v12, 16, v248
    v_and_b32 v13, 0xffff0000, v248
    v_pk_add_f32 v[16:17], v[16:17], v[12:13]
    v_lshlrev_b32 v14, 16, v249
    v_and_b32 v15, 0xffff0000, v249
    v_pk_add_f32 v[18:19], v[18:19], v[14:15]
    v_lshlrev_b32 v12, 16, v250
    v_and_b32 v13, 0xffff0000, v250
    v_pk_add_f32 v[20:21], v[20:21], v[12:13]
    v_lshlrev_b32 v14, 16, v251
    v_and_b32 v15, 0xffff0000, v251
    v_pk_add_f32 v[22:23], v[22:23], v[14:15]
    s_waitcnt vmcnt(0)
    v_lshlrev_b32 v12, 16, v252
    v_and_b32 v13, 0xffff0000, v252
    v_pk_add_f32 v[24:25], v[24:25], v[12:13]
    v_lshlrev_b32 v14, 16, v253
    v_and_b32 v15, 0xffff0000, v253
    v_pk_add_f32 v[26:27], v[26:27], v[14:15]
    v_lshlrev_b32 v12, 16, v254
    v_and_b32 v13, 0xffff0000, v254
    v_pk_add_f32 v[28:29], v[28:29], v[12:13]
    v_lshlrev_b32 v14, 16, v255
    v_and_b32 v15, 0xffff0000, v255
    v_pk_add_f32 v[30:31], v[30:31], v[14:15]
    s_waitcnt lgkmcnt(15)
    v_lshlrev_b32 v12, 16, v64
    v_and_b32 v13, 0xffff0000, v64
    v_pk_fma_f32 v[16:17], v[16:17], v[40:41], v[12:13]
    v_lshlrev_b32 v12, 16, v65
    v_and_b32 v13, 0xffff0000, v65
    v_pk_fma_f32 v[18:19], v[18:19], v[42:43], v[12:13]
    v_lshlrev_b32 v12, 16, v66
    v_and_b32 v13, 0xffff0000, v66
    v_pk_fma_f32 v[20:21], v[20:21], v[44:45], v[12:13]
    v_lshlrev_b32 v12, 16, v67
    v_and_b32 v13, 0xffff0000, v67
    v_pk_fma_f32 v[22:23], v[22:23], v[46:47], v[12:13]
    v_lshlrev_b32 v12, 16, v68
    v_and_b32 v13, 0xffff0000, v68
    v_pk_fma_f32 v[24:25], v[24:25], v[48:49], v[12:13]
    v_lshlrev_b32 v12, 16, v69
    v_and_b32 v13, 0xffff0000, v69
    v_pk_fma_f32 v[26:27], v[26:27], v[50:51], v[12:13]
    v_lshlrev_b32 v12, 16, v70
    v_and_b32 v13, 0xffff0000, v70
    v_pk_fma_f32 v[28:29], v[28:29], v[52:53], v[12:13]
    v_lshlrev_b32 v12, 16, v71
    v_and_b32 v13, 0xffff0000, v71
    v_pk_fma_f32 v[30:31], v[30:31], v[54:55], v[12:13]
    v_lshlrev_b32 v12, 16, v72
    v_and_b32 v13, 0xffff0000, v72
    v_pk_fma_f32 v[32:33], v[32:33], v[56:57], v[12:13]
    v_lshlrev_b32 v12, 16, v73
    v_and_b32 v13, 0xffff0000, v73
    v_pk_fma_f32 v[34:35], v[34:35], v[58:59], v[12:13]
    v_lshlrev_b32 v12, 16, v74
    v_and_b32 v13, 0xffff0000, v74
    v_pk_fma_f32 v[36:37], v[36:37], v[60:61], v[12:13]
    v_lshlrev_b32 v12, 16, v75
    v_and_b32 v13, 0xffff0000, v75
    v_pk_fma_f32 v[38:39], v[38:39], v[62:63], v[12:13]
    v_add_f32 v100, v16, v17
    v_add_f32 v100, v100, v18
    v_add_f32 v100, v100, v19
    v_add_f32 v100, v100, v20
    v_add_f32 v100, v100, v21
    v_add_f32 v100, v100, v22
    v_add_f32 v100, v100, v23
    v_add_f32 v100, v100, v24
    v_add_f32 v100, v100, v25
    v_add_f32 v100, v100, v26
    v_add_f32 v100, v100, v27
    v_add_f32 v100, v100, v28
    v_add_f32 v100, v100, v29
    v_add_f32 v100, v100, v30
    v_add_f32 v100, v100, v31
    v_add_f32 v103, v32, v33
    v_add_f32 v103, v103, v34
    v_add_f32 v103, v103, v35
    v_add_f32 v103, v103, v36
    v_add_f32 v103, v103, v37
    v_add_f32 v103, v103, v38
    v_add_f32 v103, v103, v39
    v_fmac_f32 v100, 0x3e800000, v103
    s_nop 1
    v_add_f32_dpp v100, v100, v100 row_ror:8 row_mask:0xf bank_mask:0xf
    v_mov_b32 v103, v100
    s_nop 1
    v_permlane16_swap_b32 v103, v100
    v_add_f32 v100, v100, v103
    v_mov_b32 v103, v100
    s_nop 1
    v_permlane32_swap_b32 v103, v100
    v_add_f32 v100, v100, v103
    v_mul_f32 v100, 0x3be38e39, v100
    v_sub_f32 v184, v16, v100
    v_sub_f32 v185, v17, v100
    v_sub_f32 v186, v18, v100
    v_sub_f32 v187, v19, v100
    v_sub_f32 v188, v20, v100
    v_sub_f32 v189, v21, v100
    v_sub_f32 v190, v22, v100
    v_sub_f32 v191, v23, v100
    v_sub_f32 v192, v24, v100
    v_sub_f32 v193, v25, v100
    v_sub_f32 v194, v26, v100
    v_sub_f32 v195, v27, v100
    v_sub_f32 v196, v28, v100
    v_sub_f32 v197, v29, v100
    v_sub_f32 v198, v30, v100
    v_sub_f32 v199, v31, v100
    v_sub_f32 v200, v32, v100
    v_sub_f32 v201, v33, v100
    v_sub_f32 v202, v34, v100
    v_sub_f32 v203, v35, v100
    v_sub_f32 v204, v36, v100
    v_sub_f32 v205, v37, v100
    v_sub_f32 v206, v38, v100
    v_sub_f32 v207, v39, v100
    v_mul_f32 v101, v184, v184
    v_fmac_f32 v101, v185, v185
    v_fmac_f32 v101, v186, v186
    v_fmac_f32 v101, v187, v187
    v_fmac_f32 v101, v188, v188
    v_fmac_f32 v101, v189, v189
    v_fmac_f32 v101, v190, v190
    v_fmac_f32 v101, v191, v191
    v_fmac_f32 v101, v192, v192
    v_fmac_f32 v101, v193, v193
    v_fmac_f32 v101, v194, v194
    v_fmac_f32 v101, v195, v195
    v_fmac_f32 v101, v196, v196
    v_fmac_f32 v101, v197, v197
    v_fmac_f32 v101, v198, v198
    v_fmac_f32 v101, v199, v199
    v_mul_f32 v103, v200, v200
    v_fmac_f32 v103, v201, v201
    v_fmac_f32 v103, v202, v202
    v_fmac_f32 v103, v203, v203
    v_fmac_f32 v103, v204, v204
    v_fmac_f32 v103, v205, v205
    v_fmac_f32 v103, v206, v206
    v_fmac_f32 v103, v207, v207
    v_fmac_f32 v101, 0x3e800000, v103
    v_mul_f32 v102, v184, v76
    v_fmac_f32 v102, v185, v77
    v_fmac_f32 v102, v186, v78
    v_fmac_f32 v102, v187, v79
    v_fmac_f32 v102, v188, v80
    v_fmac_f32 v102, v189, v81
    v_fmac_f32 v102, v190, v82
    v_fmac_f32 v102, v191, v83
    v_fmac_f32 v102, v192, v84
    v_fmac_f32 v102, v193, v85
    v_fmac_f32 v102, v194, v86
    v_fmac_f32 v102, v195, v87
    v_fmac_f32 v102, v196, v88
    v_fmac_f32 v102, v197, v89
    v_fmac_f32 v102, v198, v90
    v_fmac_f32 v102, v199, v91
    v_mul_f32 v103, v200, v92
    v_fmac_f32 v103, v201, v93
    v_fmac_f32 v103, v202, v94
    v_fmac_f32 v103, v203, v95
    v_fmac_f32 v103, v204, v96
    v_fmac_f32 v103, v205, v97
    v_fmac_f32 v103, v206, v98
    v_fmac_f32 v103, v207, v99
    v_fmac_f32 v102, 0x3e800000, v103
    s_nop 1
    v_add_f32_dpp v101, v101, v101 row_ror:8 row_mask:0xf bank_mask:0xf
    v_add_f32_dpp v102, v102, v102 row_ror:8 row_mask:0xf bank_mask:0xf
    v_mov_b32 v103, v101
    v_mov_b32 v104, v102
    s_nop 0
    v_permlane16_swap_b32 v103, v101
    v_permlane16_swap_b32 v104, v102
    v_add_f32 v101, v101, v103
    v_add_f32 v102, v102, v104
    v_mov_b32 v103, v101
    v_mov_b32 v104, v102
    s_nop 0
    v_permlane32_swap_b32 v103, v101
    v_permlane32_swap_b32 v104, v102
    v_add_f32 v101, v101, v103
    v_add_f32 v102, v102, v104
    ds_write_b32 v10, v100 offset:0
    ds_write_b32 v10, v101 offset:128
    ds_write_b32 v10, v102 offset:256
    s_waitcnt lgkmcnt(0)
    s_barrier
    ds_read_b128 v[40:43], v11 offset:0
    ds_read_b128 v[44:47], v11 offset:128
    ds_read_b128 v[48:51], v11 offset:256
    ds_read_b128 v[52:55], v11 offset:384
    ds_read_b128 v[56:59], v11 offset:512
    s_waitcnt lgkmcnt(4)
    v_add_f32 v12, v40, v41
    v_add_f32 v13, v42, v43
    v_add_f32 v12, v12, v13
    v_mul_f32 v12, 0x3e800000, v12
    v_sub_f32 v40, v40, v12
    v_sub_f32 v41, v41, v12
    v_sub_f32 v42, v42, v12
    v_sub_f32 v43, v43, v12
    v_sub_f32 v100, v100, v12
    v_mul_f32 v13, v40, v40
    v_fmac_f32 v13, v41, v41
    v_fmac_f32 v13, v42, v42
    v_fmac_f32 v13, v43, v43
    s_waitcnt lgkmcnt(3)
    v_add_f32 v14, v44, v45
    v_add_f32 v15, v46, v47
    v_add_f32 v14, v14, v15
    v_fmac_f32 v14, 0x43100000, v13
    v_mov_b32 v13, 0x3727c5ac
    v_fmac_f32 v13, 0x3ae38e39, v14
    v_rsq_f32 v13, v13
    s_waitcnt lgkmcnt(0)
    v_mul_f32 v100, v100, v13
    v_fma_f32 v184, v184, v13, v100
    v_fma_f32 v185, v185, v13, v100
    v_fma_f32 v186, v186, v13, v100
    v_fma_f32 v187, v187, v13, v100
    v_fma_f32 v188, v188, v13, v100
    v_fma_f32 v189, v189, v13, v100
    v_fma_f32 v190, v190, v13, v100
    v_fma_f32 v191, v191, v13, v100
    v_fma_f32 v192, v192, v13, v100
    v_fma_f32 v193, v193, v13, v100
    v_fma_f32 v194, v194, v13, v100
    v_fma_f32 v195, v195, v13, v100
    v_fma_f32 v196, v196, v13, v100
    v_fma_f32 v197, v197, v13, v100
    v_fma_f32 v198, v198, v13, v100
    v_fma_f32 v199, v199, v13, v100
    v_fma_f32 v200, v200, v13, v100
    v_fma_f32 v201, v201, v13, v100
    v_fma_f32 v202, v202, v13, v100
    v_fma_f32 v203, v203, v13, v100
    v_fma_f32 v204, v204, v13, v100
    v_fma_f32 v205, v205, v13, v100
    v_fma_f32 v206, v206, v13, v100
    v_fma_f32 v207, v207, v13, v100
    v_pk_fma_f32 v[184:185], v[184:185], v[112:113], v[136:137]
    v_pk_fma_f32 v[186:187], v[186:187], v[114:115], v[138:139]
    v_pk_fma_f32 v[188:189], v[188:189], v[116:117], v[140:141]
    v_pk_fma_f32 v[190:191], v[190:191], v[118:119], v[142:143]
    v_pk_fma_f32 v[192:193], v[192:193], v[120:121], v[144:145]
    v_pk_fma_f32 v[194:195], v[194:195], v[122:123], v[146:147]
    v_pk_fma_f32 v[196:197], v[196:197], v[124:125], v[148:149]
    v_pk_fma_f32 v[198:199], v[198:199], v[126:127], v[150:151]
    v_pk_fma_f32 v[200:201], v[200:201], v[128:129], v[152:153]
    v_pk_fma_f32 v[202:203], v[202:203], v[130:131], v[154:155]
    v_pk_fma_f32 v[204:205], v[204:205], v[132:133], v[156:157]
    v_pk_fma_f32 v[206:207], v[206:207], v[134:135], v[158:159]
    v_pk_fma_f32 v[16:17], v[184:185], v[160:161], v[16:17]
    v_pk_fma_f32 v[18:19], v[186:187], v[162:163], v[18:19]
    v_pk_fma_f32 v[20:21], v[188:189], v[164:165], v[20:21]
    v_pk_fma_f32 v[22:23], v[190:191], v[166:167], v[22:23]
    v_pk_fma_f32 v[24:25], v[192:193], v[168:169], v[24:25]
    v_pk_fma_f32 v[26:27], v[194:195], v[170:171], v[26:27]
    v_pk_fma_f32 v[28:29], v[196:197], v[172:173], v[28:29]
    v_pk_fma_f32 v[30:31], v[198:199], v[174:175], v[30:31]
    v_pk_fma_f32 v[32:33], v[200:201], v[176:177], v[32:33]
    v_pk_fma_f32 v[34:35], v[202:203], v[178:179], v[34:35]
    v_pk_fma_f32 v[36:37], v[204:205], v[180:181], v[36:37]
    v_pk_fma_f32 v[38:39], v[206:207], v[182:183], v[38:39]
    v_cvt_pk_bf16_f32 v112, v16, v17
    v_cvt_pk_bf16_f32 v113, v18, v19
    v_cvt_pk_bf16_f32 v114, v20, v21
    v_cvt_pk_bf16_f32 v115, v22, v23
    ds_write_b128 v1, v[112:115] offset:0
    v_cvt_pk_bf16_f32 v116, v24, v25
    v_cvt_pk_bf16_f32 v117, v26, v27
    v_cvt_pk_bf16_f32 v118, v28, v29
    v_cvt_pk_bf16_f32 v119, v30, v31
    ds_write_b128 v1, v[116:119] offset:128
    v_cvt_pk_bf16_f32 v120, v32, v33
    v_cvt_pk_bf16_f32 v121, v34, v35
    v_cvt_pk_bf16_f32 v122, v36, v37
    v_cvt_pk_bf16_f32 v123, v38, v39
    ds_write_b128 v2, v[120:123] offset:0
    v_cvt_pk_bf16_f32 v124, v184, v185
    v_cvt_pk_bf16_f32 v125, v186, v187
    v_cvt_pk_bf16_f32 v126, v188, v189
    v_cvt_pk_bf16_f32 v127, v190, v191
    ds_write_b128 v1, v[124:127] offset:9344
    v_cvt_pk_bf16_f32 v128, v192, v193
    v_cvt_pk_bf16_f32 v129, v194, v195
    v_cvt_pk_bf16_f32 v130, v196, v197
    v_cvt_pk_bf16_f32 v131, v198, v199
    ds_write_b128 v1, v[128:131] offset:9472
    v_cvt_pk_bf16_f32 v132, v200, v201
    v_cvt_pk_bf16_f32 v133, v202, v203
    v_cvt_pk_bf16_f32 v134, v204, v205
    v_cvt_pk_bf16_f32 v135, v206, v207
    ds_write_b128 v2, v[132:135] offset:9344
    v_fmac_f32 v48, v40, v52
    v_fmac_f32 v49, v41, v53
    v_fmac_f32 v50, v42, v54
    v_fmac_f32 v51, v43, v55
    v_add_f32 v14, v48, v49
    v_add_f32 v15, v50, v51
    v_add_f32 v14, v14, v15
    v_add_f32 v15, v56, v57
    v_add_f32 v12, v58, v59
    v_add_f32 v15, v15, v12
    v_fmac_f32 v15, v14, v13
    s_waitcnt lgkmcnt(0)
    s_barrier
    ds_read_b128 v[160:163], v107
    ds_read_b128 v[164:167], v108
    ds_read_b128 v[168:171], v109
    ds_read_b128 v[172:175], v110
    ds_read_b128 v[176:179], v111
    s_lshl_b32 s3, s96, 3
    s_sub_u32 s3, 0xfff, s3
    v_and_b32 v14, 7, v0
    v_sub_u32 v14, s3, v14
    v_ashrrev_i32 v12, 31, v15
    v_or_b32 v12, 0x80000000, v12
    v_xor_b32 v12, v12, v15
    v_and_b32 v12, 0xfffff000, v12
    v_or_b32 v100, v12, v14
    v_mov_b32 v101, 0
    s_waitcnt lgkmcnt(4)
    buffer_store_dwordx4 v[160:163], v8, s[24:27], s45 offen offset:0 sc1
    s_waitcnt lgkmcnt(3)
    buffer_store_dwordx4 v[164:167], v8, s[24:27], s45 offen offset:1024 sc1
    s_waitcnt lgkmcnt(2)
    buffer_store_dwordx4 v[168:171], v8, s[24:27], s45 offen offset:2048 sc1
    s_waitcnt lgkmcnt(1)
    buffer_store_dwordx4 v[172:175], v8, s[24:27], s45 offen offset:3072 sc1
    s_waitcnt lgkmcnt(0)
    s_mov_b32 exec_hi, 0
    s_add_u32 s45, s45, 4096
    buffer_store_dwordx4 v[176:179], v8, s[24:27], s45 offen offset:0 sc1
    s_mov_b64 exec, -1
    s_nop 1
    v_mov_b32_dpp v12, v100 row_ror:1 row_mask:0xf bank_mask:0xf
    v_mov_b32_dpp v13, v101 row_ror:1 row_mask:0xf bank_mask:0xf
    v_max_u32 v101, v101, v13
    v_med3_u32 v101, v100, v12, v101
    v_max_u32 v100, v100, v12
    s_nop 1
    v_mov_b32_dpp v12, v100 row_ror:2 row_mask:0xf bank_mask:0xf
    v_mov_b32_dpp v13, v101 row_ror:2 row_mask:0xf bank_mask:0xf
    v_max_u32 v101, v101, v13
    v_med3_u32 v101, v100, v12, v101
    v_max_u32 v100, v100, v12
    s_nop 1
    v_mov_b32_dpp v12, v100 row_ror:4 row_mask:0xf bank_mask:0xf
    v_mov_b32_dpp v13, v101 row_ror:4 row_mask:0xf bank_mask:0xf
    v_max_u32 v101, v101, v13
    v_med3_u32 v101, v100, v12, v101
    v_max_u32 v100, v100, v12
    s_lshl_b32 s3, s96, 7
    s_add_u32 s3, s3, 32776
    v_lshlrev_b32 v14, 7, v0
    s_lshl_b32 s15, s51, 13
    s_add_u32 s15, s15, 32776
    s_waitcnt vmcnt(0)
    s_barrier
    s_cmp_lg_u32 s51, 0
    s_cbranch_scc1 L2_nokey
    s_mov_b64 exec, 1
    buffer_store_dwordx2 v[100:101], v14, s[84:87], s3 offen sc1
    s_mov_b64 exec, -1
L2_nokey:
    s_cmp_ge_u32 s2, 180
    s_cbranch_scc1 L2_fin
    s_cmp_ge_u32 s2, 144
    s_cbranch_scc1 L2_gather
    v_lshrrev_b32 v21, 4, v0
    v_bfe_u32 v20, v0, 2, 2
    v_lshl_add_u32 v20, v21, 3, v20
    v_and_b32 v21, 3, v0
    v_lshlrev_b32 v22, 6, v20
    v_lshl_add_u32 v22, v21, 3, v22
    s_cmp_lt_u32 s51, 2
    s_cselect_b32 s3, 126976, 0
    s_cselect_b32 s14, 0, 16384
    s_add_u32 s3, s3, s14
    s_and_b32 s14, s51, 1
    s_lshl_b32 s14, s14, 5
    s_add_u32 s3, s3, s14
    v_add_u32 v22, s3, v22
    v_mul_u32_u24 v23, 1152, v20
    v_lshl_add_u32 v23, v21, 3, v23
    s_mul_i32 s3, s51, 288
    s_add_u32 s3, s3, 53248
    v_add_u32 v23, s3, v23
    ds_read_b64_tr_b16 a[64:65], v22 offset:0
    ds_read_b64_tr_b16 a[66:67], v22 offset:256
L2_pad14:
    s_cbranch_execz L2_walkret
    ds_read_b64_tr_b16 a[68:69], v22 offset:2048
    ds_read_b64_tr_b16 a[70:71], v22 offset:2304
    ds_read_b64_tr_b16 a[72:73], v22 offset:4096
    ds_read_b64_tr_b16 a[74:75], v22 offset:4352
    ds_read_b64_tr_b16 a[76:77], v22 offset:6144
    ds_read_b64_tr_b16 a[78:79], v22 offset:6400
    ds_read_b64_tr_b16 a[80:81], v22 offset:8192
    ds_read_b64_tr_b16 a[82:83], v22 offset:8448
    ds_read_b64_tr_b16 a[84:85], v22 offset:10240
    ds_read_b64_tr_b16 a[86:87], v22 offset:10496
    ds_read_b64_tr_b16 a[88:89], v22 offset:12288
    ds_read_b64_tr_b16 a[90:91], v22 offset:12544
    ds_read_b64_tr_b16 a[92:93], v22 offset:14336
    ds_read_b64_tr_b16 a[94:95], v22 offset:14592
    ds_read_b64_tr_b16 a[96:97], v22 offset:16384
    ds_read_b64_tr_b16 a[98:99], v22 offset:16640
    ds_read_b64_tr_b16 a[100:101], v22 offset:18432
    ds_read_b64_tr_b16 a[102:103], v22 offset:18688
    ds_read_b64_tr_b16 a[104:105], v22 offset:20480
    ds_read_b64_tr_b16 a[106:107], v22 offset:20736
    ds_read_b64_tr_b16 a[108:109], v22 offset:22528
    ds_read_b64_tr_b16 a[110:111], v22 offset:22784
    ds_read_b64_tr_b16 a[112:113], v22 offset:24576
    ds_read_b64_tr_b16 a[114:115], v22 offset:24832
    ds_read_b64_tr_b16 a[116:117], v22 offset:26624
    ds_read_b64_tr_b16 a[118:119], v22 offset:26880
    ds_read_b64_tr_b16 a[120:121], v22 offset:28672
    ds_read_b64_tr_b16 a[122:123], v22 offset:28928
    ds_read_b64_tr_b16 a[124:125], v22 offset:30720
    ds_read_b64_tr_b16 a[126:127], v22 offset:30976
    ds_read_b64_tr_b16 a[128:129], v22 offset:32768
    ds_read_b64_tr_b16 a[130:131], v22 offset:33024
    ds_read_b64_tr_b16 a[132:133], v22 offset:34816
    ds_read_b64_tr_b16 a[134:135], v22 offset:35072
    ds_read_b64_tr_b16 a[136:137], v23 offset:0
    ds_read_b64_tr_b16 a[138:139], v23 offset:4608
    ds_read_b64_tr_b16 a[140:141], v23 offset:32
    ds_read_b64_tr_b16 a[142:143], v23 offset:4640
    ds_read_b64_tr_b16 a[144:145], v23 offset:64
    ds_read_b64_tr_b16 a[146:147], v23 offset:4672
    ds_read_b64_tr_b16 a[148:149], v23 offset:96
    ds_read_b64_tr_b16 a[150:151], v23 offset:4704
    ds_read_b64_tr_b16 a[152:153], v23 offset:128
    ds_read_b64_tr_b16 a[154:155], v23 offset:4736
    ds_read_b64_tr_b16 a[156:157], v23 offset:160
    ds_read_b64_tr_b16 a[158:159], v23 offset:4768
    ds_read_b64_tr_b16 a[160:161], v23 offset:192
    ds_read_b64_tr_b16 a[162:163], v23 offset:4800
    ds_read_b64_tr_b16 a[164:165], v23 offset:224
    ds_read_b64_tr_b16 a[166:167], v23 offset:4832
    ds_read_b64_tr_b16 a[168:169], v23 offset:256
    ds_read_b64_tr_b16 a[170:171], v23 offset:4864
L2_gather:
    s_mov_b32 s97, 0x20000
L2_p2:
    buffer_load_dwordx2 v[16:17], v14, s[84:87], s15 offen sc1
    s_waitcnt vmcnt(0)
    v_min_u32 v12, v16, v17
    v_cmp_eq_u32 vcc, 0, v12
    s_sub_u32 s97, s97, 1
    s_cselect_b64 vcc, 0, vcc
    s_cmp_eq_u64 vcc, 0
    s_cbranch_scc1 L2_p2_ok
    s_mov_b64 exec, vcc
    s_sleep 1
    s_branch L2_p2
L2_p2_ok:
    s_mov_b64 exec, -1
    s_nop 1
    v_mov_b32_dpp v12, v16 row_ror:1 row_mask:0xf bank_mask:0xf
    v_mov_b32_dpp v13, v17 row_ror:1 row_mask:0xf bank_mask:0xf
    v_max_u32 v17, v17, v13
    v_med3_u32 v17, v16, v12, v17
    v_max_u32 v16, v16, v12
    s_nop 1
    v_mov_b32_dpp v12, v16 row_ror:2 row_mask:0xf bank_mask:0xf
    v_mov_b32_dpp v13, v17 row_ror:2 row_mask:0xf bank_mask:0xf
    v_max_u32 v17, v17, v13
    v_med3_u32 v17, v16, v12, v17
    v_max_u32 v16, v16, v12
    s_nop 1
    v_mov_b32_dpp v12, v16 row_ror:4 row_mask:0xf bank_mask:0xf
    v_mov_b32_dpp v13, v17 row_ror:4 row_mask:0xf bank_mask:0xf
    v_max_u32 v17, v17, v13
    v_med3_u32 v17, v16, v12, v17
    v_max_u32 v16, v16, v12
    s_nop 1
    v_mov_b32_dpp v12, v16 row_ror:8 row_mask:0xf bank_mask:0xf
    v_mov_b32_dpp v13, v17 row_ror:8 row_mask:0xf bank_mask:0xf
    v_max_u32 v17, v17, v13
    v_med3_u32 v17, v16, v12, v17
    v_max_u32 v16, v16, v12
    v_mov_b32 v12, v16
    v_mov_b32 v13, v17
    s_nop 0
    v_permlane16_swap_b32 v12, v16
    v_permlane16_swap_b32 v13, v17
    v_max_u32 v17, v17, v13
    v_med3_u32 v17, v16, v12, v17
    v_max_u32 v16, v16, v12
    v_mov_b32 v12, v16
    v_mov_b32 v13, v17
    s_nop 0
    v_permlane32_swap_b32 v12, v16
    v_permlane32_swap_b32 v13, v17
    v_max_u32 v17, v17, v13
    v_med3_u32 v17, v16, v12, v17
    v_max_u32 v16, v16, v12
    s_lshl_b32 s3, s51, 3
    s_add_u32 s3, s3, 15616
    v_mov_b32 v12, s3
    v_mov_b32 v13, 15616
    ds_write_b64 v12, v[16:17]
    s_waitcnt lgkmcnt(0)
    s_barrier
    ds_read_b128 v[16:19], v13
    ds_read_b128 v[20:23], v13 offset:16
    v_and_b32 v6, 1, v0
    v_lshrrev_b32 v7, 4, v0
    s_waitcnt lgkmcnt(0)
    v_max_u32 v17, v17, v19
    v_med3_u32 v17, v16, v18, v17
    v_max_u32 v16, v16, v18
    v_max_u32 v21, v21, v23
    v_med3_u32 v21, v20, v22, v21
    v_max_u32 v20, v20, v22
    v_max_u32 v17, v17, v21
    v_med3_u32 v17, v16, v20, v17
    v_max_u32 v16, v16, v20
    s_cmp_ge_u32 s2, 144
    s_cbranch_scc1 L2_red
    v_cmp_eq_u32 vcc, 0, v6
    s_nop 1
    v_cndmask_b32 v4, v17, v16, vcc
    v_and_b32 v4, 0x7ff, v4
    v_sub_u32 v4, 2047, v4
    v_mul_u32_u24 v5, 1152, v4
    v_lshl_add_u32 v5, v7, 4, v5
    s_mov_b32 s3, 4194304
    s_mov_b32 exec_lo, 0x30003
    s_mov_b32 exec_hi, 0x30003
    buffer_load_dwordx4 v[128:131], v5, s[84:87], s3 offen offset:0 sc1
    buffer_load_dwordx4 v[132:135], v5, s[84:87], s3 offen offset:64 sc1
    buffer_load_dwordx4 v[136:139], v5, s[84:87], s3 offen offset:128 sc1
    buffer_load_dwordx4 v[140:143], v5, s[84:87], s3 offen offset:192 sc1
    buffer_load_dwordx4 v[144:147], v5, s[84:87], s3 offen offset:256 sc1
    buffer_load_dwordx4 v[148:151], v5, s[84:87], s3 offen offset:320 sc1
    buffer_load_dwordx4 v[152:155], v5, s[84:87], s3 offen offset:384 sc1
    buffer_load_dwordx4 v[156:159], v5, s[84:87], s3 offen offset:448 sc1
    buffer_load_dwordx4 v[160:163], v5, s[84:87], s3 offen offset:512 sc1
    buffer_load_dwordx4 v[164:167], v5, s[84:87], s3 offen offset:576 sc1
    buffer_load_dwordx4 v[168:171], v5, s[84:87], s3 offen offset:640 sc1
    buffer_load_dwordx4 v[172:175], v5, s[84:87], s3 offen offset:704 sc1
    buffer_load_dwordx4 v[176:179], v5, s[84:87], s3 offen offset:768 sc1
    buffer_load_dwordx4 v[180:183], v5, s[84:87], s3 offen offset:832 sc1
    buffer_load_dwordx4 v[184:187], v5, s[84:87], s3 offen offset:896 sc1
    buffer_load_dwordx4 v[188:191], v5, s[84:87], s3 offen offset:960 sc1
    buffer_load_dwordx4 v[192:195], v5, s[84:87], s3 offen offset:1024 sc1
    buffer_load_dwordx4 v[196:199], v5, s[84:87], s3 offen offset:1088 sc1
    s_mov_b64 exec, -1
    v_lshlrev_b32 v11, 7, v6
    v_lshl_add_u32 v13, v7, 5, v11
    v_add_u32 v13, 14848, v13
    v_lshl_add_u32 v11, v7, 4, v11
    s_lshr_b32 s3, s51, 1
    s_lshl_b32 s3, s3, 8
    s_and_b32 s14, s51, 1
    s_lshl_b32 s14, s14, 6
    s_add_u32 s3, s3, s14
    s_add_u32 s3, s3, 14848
    v_add_u32 v11, s3, v11
    s_mul_i32 s14, s51, 1152
    s_add_u32 s3, s14, 110592
    v_mul_u32_u24 v9, 576, v6
    v_lshl_add_u32 v9, v7, 4, v9
    v_add_u32 v9, s3, v9
    v_add_u32 v10, s3, v8
    s_mul_i32 s15, s2, 4608
    s_add_u32 s15, s15, s14
    s_add_u32 s15, s15, 98304
    s_waitcnt vmcnt(17)
    v_mfma_f32_16x16x32_bf16 v[88:91], a[64:67], v[128:131], 0
    s_waitcnt vmcnt(16)
    v_mfma_f32_16x16x32_bf16 v[88:91], a[68:71], v[132:135], v[88:91]
    s_waitcnt vmcnt(15)
    v_mfma_f32_16x16x32_bf16 v[88:91], a[72:75], v[136:139], v[88:91]
    s_waitcnt vmcnt(14)
    v_mfma_f32_16x16x32_bf16 v[88:91], a[76:79], v[140:143], v[88:91]
    s_waitcnt vmcnt(13)
    v_mfma_f32_16x16x32_bf16 v[88:91], a[80:83], v[144:147], v[88:91]
    s_waitcnt vmcnt(12)
    v_mfma_f32_16x16x32_bf16 v[88:91], a[84:87], v[148:151], v[88:91]
    s_waitcnt vmcnt(11)
    v_mfma_f32_16x16x32_bf16 v[88:91], a[88:91], v[152:155], v[88:91]
    s_waitcnt vmcnt(10)
    v_mfma_f32_16x16x32_bf16 v[88:91], a[92:95], v[156:159], v[88:91]
    s_waitcnt vmcnt(9)
    v_mfma_f32_16x16x32_bf16 v[88:91], a[96:99], v[160:163], v[88:91]
    s_waitcnt vmcnt(8)
    v_mfma_f32_16x16x32_bf16 v[88:91], a[100:103], v[164:167], v[88:91]
    s_waitcnt vmcnt(7)
    v_mfma_f32_16x16x32_bf16 v[88:91], a[104:107], v[168:171], v[88:91]
    s_waitcnt vmcnt(6)
    v_mfma_f32_16x16x32_bf16 v[88:91], a[108:111], v[172:175], v[88:91]
    s_waitcnt vmcnt(5)
    v_mfma_f32_16x16x32_bf16 v[88:91], a[112:115], v[176:179], v[88:91]
    s_waitcnt vmcnt(4)
    v_mfma_f32_16x16x32_bf16 v[88:91], a[116:119], v[180:183], v[88:91]
    s_waitcnt vmcnt(3)
    v_mfma_f32_16x16x32_bf16 v[88:91], a[120:123], v[184:187], v[88:91]
    s_waitcnt vmcnt(2)
    v_mfma_f32_16x16x32_bf16 v[88:91], a[124:127], v[188:191], v[88:91]
    s_waitcnt vmcnt(1)
    v_mfma_f32_16x16x32_bf16 v[88:91], a[128:131], v[192:195], v[88:91]
    s_waitcnt vmcnt(0)
    v_mfma_f32_16x16x32_bf16 v[88:91], a[132:135], v[196:199], v[88:91]
    s_nop 5
    s_mov_b32 exec_lo, 0x30003
    s_mov_b32 exec_hi, 0x30003
    ds_write_b128 v11, v[88:91]
    s_mov_b64 exec, -1
    s_waitcnt lgkmcnt(0)
    s_barrier
    ds_read_b128 v[16:19], v13 offset:0
    ds_read_b128 v[20:23], v13 offset:16
    ds_read_b128 v[24:27], v13 offset:256
    ds_read_b128 v[28:31], v13 offset:272
    s_waitcnt lgkmcnt(2)
    v_mul_f32 v32, 0xbfb8aa3b, v16
    v_mul_f32 v33, 0xbfb8aa3b, v17
    v_mul_f32 v34, 0xbfb8aa3b, v18
    v_mul_f32 v35, 0xbfb8aa3b, v19
    v_mul_f32 v36, 0xbfb8aa3b, v20
    v_mul_f32 v37, 0xbfb8aa3b, v21
    v_mul_f32 v38, 0xbfb8aa3b, v22
    v_mul_f32 v39, 0xbfb8aa3b, v23
    v_exp_f32 v32, v32
    v_exp_f32 v33, v33
    v_exp_f32 v34, v34
    v_exp_f32 v35, v35
    v_exp_f32 v36, v36
    v_exp_f32 v37, v37
    v_exp_f32 v38, v38
    v_exp_f32 v39, v39
    v_add_f32 v32, 1.0, v32
    v_add_f32 v33, 1.0, v33
    v_add_f32 v34, 1.0, v34
    v_add_f32 v35, 1.0, v35
    v_add_f32 v36, 1.0, v36
    v_add_f32 v37, 1.0, v37
    v_add_f32 v38, 1.0, v38
    v_add_f32 v39, 1.0, v39
    v_rcp_f32 v32, v32
    v_rcp_f32 v33, v33
    v_rcp_f32 v34, v34
    v_rcp_f32 v35, v35
    v_rcp_f32 v36, v36
    v_rcp_f32 v37, v37
    v_rcp_f32 v38, v38
    v_rcp_f32 v39, v39
    s_waitcnt lgkmcnt(0)
    v_mul_f32 v16, v16, v32
    v_mul_f32 v17, v17, v33
    v_mul_f32 v18, v18, v34
    v_mul_f32 v19, v19, v35
    v_mul_f32 v20, v20, v36
    v_mul_f32 v21, v21, v37
    v_mul_f32 v22, v22, v38
    v_mul_f32 v23, v23, v39
    v_mul_f32 v16, v16, v24
    v_mul_f32 v17, v17, v25
    v_mul_f32 v18, v18, v26
    v_mul_f32 v19, v19, v27
    v_mul_f32 v20, v20, v28
    v_mul_f32 v21, v21, v29
    v_mul_f32 v22, v22, v30
    v_mul_f32 v23, v23, v31
    v_cvt_pk_bf16_f32 v40, v16, v17
    v_cvt_pk_bf16_f32 v41, v18, v19
    v_cvt_pk_bf16_f32 v42, v20, v21
    v_cvt_pk_bf16_f32 v43, v22, v23
    s_nop 1
    v_mfma_f32_16x16x32_bf16 v[48:51], a[136:139], v[40:43], 0
    v_mfma_f32_16x16x32_bf16 v[52:55], a[140:143], v[40:43], 0
    v_mfma_f32_16x16x32_bf16 v[56:59], a[144:147], v[40:43], 0
    v_mfma_f32_16x16x32_bf16 v[60:63], a[148:151], v[40:43], 0
    v_mfma_f32_16x16x32_bf16 v[64:67], a[152:155], v[40:43], 0
    v_mfma_f32_16x16x32_bf16 v[68:71], a[156:159], v[40:43], 0
    v_mfma_f32_16x16x32_bf16 v[72:75], a[160:163], v[40:43], 0
    v_mfma_f32_16x16x32_bf16 v[76:79], a[164:167], v[40:43], 0
    v_mfma_f32_16x16x32_bf16 v[80:83], a[168:171], v[40:43], 0
    s_mov_b32 exec_lo, 0x30003
    s_mov_b32 exec_hi, 0x30003
    ds_write_b128 v9, v[48:51] offset:0
    ds_write_b128 v9, v[52:55] offset:64
    ds_write_b128 v9, v[56:59] offset:128
    ds_write_b128 v9, v[60:63] offset:192
    ds_write_b128 v9, v[64:67] offset:256
    ds_write_b128 v9, v[68:71] offset:320
    ds_write_b128 v9, v[72:75] offset:384
    ds_write_b128 v9, v[76:79] offset:448
    ds_write_b128 v9, v[80:83] offset:512
    s_mov_b64 exec, -1
    ds_read_b128 v[16:19], v10
    ds_read_b128 v[20:23], v10 offset:1024
    s_waitcnt lgkmcnt(0)
    v_min_u32 v16, -2, v16
    v_min_u32 v17, -2, v17
    v_min_u32 v18, -2, v18
    v_min_u32 v19, -2, v19
    v_min_u32 v20, -2, v20
    v_min_u32 v21, -2, v21
    v_min_u32 v22, -2, v22
    v_min_u32 v23, -2, v23
    buffer_store_dwordx4 v[16:19], v8, s[84:87], s15 offen sc1
    s_mov_b64 exec, 0xff
    buffer_store_dwordx4 v[20:23], v8, s[84:87], s15 offen offset:1024 sc1
    s_branch L2_fin
L2_red:
    s_mov_b32 s3, 98304
    s_add_u32 s32, s84, s3
    s_addc_u32 s33, s85, 0
    s_mov_b32 s34, 663552
    s_mov_b32 s35, 0x20000
    s_sub_u32 s3, s2, 144
    s_mul_i32 s14, s3, 7282
    s_lshr_b32 s14, s14, 16
    s_mul_i32 s15, s14, 9
    s_sub_u32 s15, s3, s15
    s_lshl_b32 s15, s15, 5
    s_mul_i32 s14, s14, 144
    v_and_b32 v6, 7, v0
    v_lshl_add_u32 v7, v6, 2, s15
    v_cmp_gt_u32 vcc, 144, v7
    v_subrev_u32 v9, 144, v7
    v_lshrrev_b32 v10, 3, v0
    v_cndmask_b32 v7, v9, v7, vcc
    v_cndmask_b32 v16, v17, v16, vcc
    v_add_u32 v7, s14, v7
    v_and_b32 v9, 0x7ff, v16
    v_sub_u32 v9, 2047, v9
    v_mul_u32_u24 v9, 1152, v9
    v_lshl_add_u32 v9, v7, 1, v9
    v_lshlrev_b32 v7, 2, v7
    buffer_load_dwordx2 v[18:19], v9, s[80:83], 0 offen sc1
    ds_read_b128 v[20:23], v7 offset:6912
    s_lshl_b32 s14, s51, 3
    v_add_u32 v10, s14, v10
    v_mul_u32_u24 v10, 4608, v10
    v_lshl_add_u32 v10, v6, 4, v10
    s_lshl_b32 s3, s3, 7
    v_add_u32 v24, s3, v10
    v_add_u32 v25, 147456, v24
    v_add_u32 v26, 294912, v24
    v_add_u32 v27, 442368, v24
    v_add_u32 v28, 589824, v24
    v_and_b32 v16, 0xfffff800, v16
    v_not_b32 v12, v16
    v_ashrrev_i32 v12, 31, v12
    v_or_b32 v12, 0x80000000, v12
    v_xor_b32 v16, v16, v12
    v_mul_f32 v16, 0xbfb8aa3b, v16
    v_exp_f32 v16, v16
    s_nop 0
    v_add_f32 v16, 1.0, v16
    v_rcp_f32 v16, v16
    s_waitcnt lgkmcnt(0)
    v_mul_f32 v20, v20, v16
    v_mul_f32 v21, v21, v16
    v_mul_f32 v22, v22, v16
    v_mul_f32 v23, v23, v16
    v_lshlrev_b32 v11, 4, v6
    v_add_u32 v11, 15872, v11
    s_lshl_b32 s14, s51, 7
    v_add_u32 v10, s14, v11
    s_mov_b32 s97, 0x20000
L2_p3:
    buffer_load_dwordx4 v[32:35], v24, s[32:35], 0 offen sc1
    buffer_load_dwordx4 v[36:39], v25, s[32:35], 0 offen sc1
    buffer_load_dwordx4 v[40:43], v26, s[32:35], 0 offen sc1
    buffer_load_dwordx4 v[44:47], v27, s[32:35], 0 offen sc1
    buffer_load_dwordx4 v[48:51], v28, s[32:35], 0 offen sc1
    s_waitcnt vmcnt(0)
    v_max3_u32 v12, v32, v33, v34
    v_max3_u32 v12, v12, v35, v36
    v_max3_u32 v12, v12, v37, v38
    v_max3_u32 v12, v12, v39, v40
    v_max3_u32 v12, v12, v41, v42
    v_max3_u32 v12, v12, v43, v44
    v_max3_u32 v12, v12, v45, v46
    v_max3_u32 v12, v12, v47, v48
    v_max3_u32 v12, v12, v49, v50
    v_max_u32 v12, v12, v51
    v_cmp_eq_u32 vcc, -1, v12
    s_sub_u32 s97, s97, 1
    s_cselect_b64 vcc, 0, vcc
    s_cmp_eq_u64 vcc, 0
    s_cbranch_scc1 L2_p3_ok
    s_sleep 1
    s_branch L2_p3
L2_p3_ok:
    v_pk_add_f32 v[32:33], v[32:33], v[36:37]
    v_pk_add_f32 v[40:41], v[40:41], v[44:45]
    v_pk_add_f32 v[32:33], v[32:33], v[48:49]
    v_pk_add_f32 v[32:33], v[32:33], v[40:41]
    v_pk_add_f32 v[34:35], v[34:35], v[38:39]
    v_pk_add_f32 v[42:43], v[42:43], v[46:47]
    v_pk_add_f32 v[34:35], v[34:35], v[50:51]
    v_pk_add_f32 v[34:35], v[34:35], v[42:43]
    s_nop 1
    v_add_f32_dpp v32, v32, v32 row_ror:8 row_mask:0xf bank_mask:0xf
    v_add_f32_dpp v33, v33, v33 row_ror:8 row_mask:0xf bank_mask:0xf
    v_add_f32_dpp v34, v34, v34 row_ror:8 row_mask:0xf bank_mask:0xf
    v_add_f32_dpp v35, v35, v35 row_ror:8 row_mask:0xf bank_mask:0xf
    v_mov_b32 v12, v32
    v_mov_b32 v13, v33
    v_mov_b32 v14, v34
    v_mov_b32 v15, v35
    v_permlane16_swap_b32 v12, v32
    v_permlane16_swap_b32 v13, v33
    v_permlane16_swap_b32 v14, v34
    v_permlane16_swap_b32 v15, v35
    v_add_f32 v32, v32, v12
    v_add_f32 v33, v33, v13
    v_add_f32 v34, v34, v14
    v_add_f32 v35, v35, v15
    v_mov_b32 v12, v32
    v_mov_b32 v13, v33
    v_mov_b32 v14, v34
    v_mov_b32 v15, v35
    v_permlane32_swap_b32 v12, v32
    v_permlane32_swap_b32 v13, v33
    v_permlane32_swap_b32 v14, v34
    v_permlane32_swap_b32 v15, v35
    v_add_f32 v32, v32, v12
    v_add_f32 v33, v33, v13
    v_add_f32 v34, v34, v14
    v_add_f32 v35, v35, v15
    ds_write_b128 v10, v[32:35]
    s_waitcnt lgkmcnt(0)
    s_barrier
    ds_read_b128 v[32:35], v11 offset:0
    ds_read_b128 v[36:39], v11 offset:128
    ds_read_b128 v[40:43], v11 offset:256
    ds_read_b128 v[44:47], v11 offset:384
    v_lshlrev_b32 v12, 16, v18
    v_and_b32 v13, 0xffff0000, v18
    v_lshlrev_b32 v14, 16, v19
    v_and_b32 v15, 0xffff0000, v19
    s_waitcnt lgkmcnt(0)
    v_pk_add_f32 v[32:33], v[32:33], v[36:37]
    v_pk_add_f32 v[40:41], v[40:41], v[44:45]
    v_pk_add_f32 v[32:33], v[32:33], v[40:41]
    v_pk_fma_f32 v[12:13], v[32:33], v[20:21], v[12:13]
    v_pk_add_f32 v[34:35], v[34:35], v[38:39]
    v_pk_add_f32 v[42:43], v[42:43], v[46:47]
    v_pk_add_f32 v[34:35], v[34:35], v[42:43]
    v_pk_fma_f32 v[14:15], v[34:35], v[22:23], v[14:15]
    v_cvt_pk_bf16_f32 v12, v12, v13
    v_cvt_pk_bf16_f32 v13, v14, v15
    s_cmp_lg_u32 s51, 0
    s_cbranch_scc1 L2_fin
    s_mov_b64 exec, 0xff
    buffer_store_dwordx2 v[12:13], v9, s[80:83], 0 offen sc1
L2_fin:
L2_end:
    s_endpgm
L2_p0s:
    s_mov_b32 s97, 0x20000
L2_p0:
    buffer_load_dword v51, v156, s[60:63], 0 offen sc1
    s_waitcnt vmcnt(0)
    v_cmp_eq_u32 vcc, 0, v51
    s_sub_u32 s97, s97, 1
    s_cselect_b64 vcc, 0, vcc
    s_cmp_eq_u64 vcc, 0
    s_cbranch_scc1 L2_p0_ok
    s_sleep 1
    s_branch L2_p0
L2_p0_ok:
    s_branch L2_p0r
L2_pms:
    s_mov_b32 s97, 0x20000
L2_pm:
    buffer_load_dwordx4 v[168:171], v166, s[84:87], 0 offen sc1
    buffer_load_dwordx4 v[176:179], v166, s[84:87], s14 offen sc1
    s_mov_b64 exec, 0xff
    buffer_load_dwordx4 v[172:175], v166, s[84:87], 0 offen offset:1024 sc1
    buffer_load_dwordx4 v[180:183], v166, s[84:87], s14 offen offset:1024 sc1
    s_mov_b64 exec, -1
    s_waitcnt vmcnt(0)
    v_max_u32 v13, v168, v169
    v_max3_u32 v13, v13, v170, v171
    v_max3_u32 v13, v13, v172, v173
    v_max3_u32 v13, v13, v174, v175
    v_max3_u32 v13, v13, v176, v177
    v_max3_u32 v13, v13, v178, v179
    v_max3_u32 v13, v13, v180, v181
    v_max3_u32 v13, v13, v182, v183
    v_cmp_eq_u32 vcc, -1, v13
    s_sub_u32 s97, s97, 1
    s_cselect_b64 vcc, 0, vcc
    s_cmp_eq_u64 vcc, 0
    s_cbranch_scc1 L2_pm_ok
    s_sleep 1
    s_branch L2_pm
L2_pm_ok:
    s_branch L2_pmr
L2_g0s:
    s_mov_b32 s97, 0x20000
L2_g0:
    buffer_load_dword v9, v6, s[84:87], s47 offen sc1
    s_waitcnt vmcnt(0)
    v_cmp_ne_u32 vcc, 0, v9
    s_nop 0
    s_lshr_b32 s3, vcc_lo, 1
    s_and_b32 s3, s3, vcc_lo
    s_lshr_b32 s14, s3, 2
    s_and_b32 s3, s3, s14
    s_and_b32 s3, s3, s48
    s_cselect_b64 vcc, 0, -1
    s_sub_u32 s97, s97, 1
    s_cselect_b64 vcc, 0, vcc
    s_cmp_eq_u64 vcc, 0
    s_cbranch_scc1 L2_g0_ok
    s_sleep 1
    s_branch L2_g0
L2_g0_ok:
    s_cmp_eq_u32 s3, 0
    s_cselect_b32 s3, s48, s3
    s_branch L2_g0r
L2_pns:
    s_mov_b32 s97, 0x20000
L2_pn:
    s_movk_i32 s45, 4608
    buffer_load_dwordx4 v[76:79], v5, s[84:87], s45 offen offset:0 sc1
    s_movk_i32 s45, 18432
    buffer_load_dwordx4 v[88:91], v5, s[84:87], s45 offen offset:0 sc1
    s_movk_i32 s45, 4608
    buffer_load_dwordx4 v[80:83], v5, s[84:87], s45 offen offset:1024 sc1
    s_movk_i32 s45, 18432
    buffer_load_dwordx4 v[92:95], v5, s[84:87], s45 offen offset:1024 sc1
    s_movk_i32 s45, 4608
    buffer_load_dwordx4 v[84:87], v59, s[84:87], s45 offen offset:2048 sc1
    s_movk_i32 s45, 18432
    buffer_load_dwordx4 v[96:99], v59, s[84:87], s45 offen offset:2048 sc1
    s_waitcnt vmcnt(0)
    v_max_u32 v13, v76, v77
    v_max3_u32 v13, v13, v78, v79
    v_max3_u32 v13, v13, v88, v89
    v_max3_u32 v13, v13, v90, v91
    v_max3_u32 v13, v13, v80, v81
    v_max3_u32 v13, v13, v82, v83
    v_max3_u32 v13, v13, v92, v93
    v_max3_u32 v13, v13, v94, v95
    v_max3_u32 v13, v13, v84, v85
    v_max3_u32 v13, v13, v86, v87
    v_max3_u32 v13, v13, v96, v97
    v_max3_u32 v13, v13, v98, v99
    v_cmp_eq_u32 vcc, -1, v13
    s_sub_u32 s97, s97, 1
    s_cselect_b64 vcc, 0, vcc
    s_cmp_eq_u64 vcc, 0
    s_cbranch_scc1 L2_pn_ok
    s_sleep 1
    s_branch L2_pn
L2_pn_ok:
    s_branch L2_pnr
L2_g1s:
    s_mov_b32 s97, 0x20000
L2_g1:
    buffer_load_dword v9, v6, s[84:87], s47 offen sc1
    s_waitcnt vmcnt(0)
    v_cmp_ne_u32 vcc, 0, v9
    s_nop 0
    s_lshr_b32 s3, vcc_lo, 1
    s_and_b32 s3, s3, vcc_lo
    s_lshr_b32 s14, s3, 2
    s_and_b32 s3, s3, s14
    s_and_b32 s3, s3, s48
    s_cselect_b64 vcc, 0, -1
    s_sub_u32 s97, s97, 1
    s_cselect_b64 vcc, 0, vcc
    s_cmp_eq_u64 vcc, 0
    s_cbranch_scc1 L2_g1_ok
    s_sleep 1
    s_branch L2_g1
L2_g1_ok:
    s_cmp_eq_u32 s3, 0
    s_cselect_b32 s3, s48, s3
    s_branch L2_g1r
L2_g2s:
    s_mov_b32 s97, 0x20000
L2_g2:
    buffer_load_dword v9, v6, s[84:87], s47 offen sc1
    s_waitcnt vmcnt(0)
    v_cmp_ne_u32 vcc, 0, v9
    s_nop 0
    s_lshr_b32 s3, vcc_lo, 1
    s_and_b32 s3, s3, vcc_lo
    s_lshr_b32 s14, s3, 2
    s_and_b32 s3, s3, s14
    s_and_b32 s3, s3, s48
    s_cselect_b64 vcc, 0, -1
    s_sub_u32 s97, s97, 1
    s_cselect_b64 vcc, 0, vcc
    s_cmp_eq_u64 vcc, 0
    s_cbranch_scc1 L2_g2_ok
    s_sleep 1
    s_branch L2_g2
L2_g2_ok:
    s_cmp_eq_u32 s3, 0
    s_cselect_b32 s3, s48, s3
    s_branch L2_g2r
L2_g3s:
    s_mov_b32 s97, 0x20000
L2_g3:
    buffer_load_dword v9, v6, s[84:87], s47 offen sc1
    s_waitcnt vmcnt(0)
    v_cmp_ne_u32 vcc, 0, v9
    s_nop 0
    s_lshr_b32 s3, vcc_lo, 1
    s_and_b32 s3, s3, vcc_lo
    s_lshr_b32 s14, s3, 2
    s_and_b32 s3, s3, s14
    s_and_b32 s3, s3, s48
    s_cselect_b64 vcc, 0, -1
    s_sub_u32 s97, s97, 1
    s_cselect_b64 vcc, 0, vcc
    s_cmp_eq_u64 vcc, 0
    s_cbranch_scc1 L2_g3_ok
    s_sleep 1
    s_branch L2_g3
L2_g3_ok:
    s_cmp_eq_u32 s3, 0
    s_cselect_b32 s3, s48, s3
    s_branch L2_g3r
L2_fallback:
    s_waitcnt vmcnt(0) lgkmcnt(0)
    s_nop 7
    s_barrier
    s_lshl_b32 s3, s51, 12
    v_add_u32 v5, s3, v8
    v_lshrrev_b32 v14, 2, v0
    v_mul_u32_u24 v14, 1056, v14
    v_and_b32 v15, 3, v0
    v_lshl_add_u32 v14, v15, 3, v14
    v_add_u32 v2, 107008, v14
    v_and_b32 v14, 15, v0
    v_mul_u32_u24 v14, 1056, v14
    v_lshrrev_b32 v15, 4, v0
    v_lshl_add_u32 v14, v15, 4, v14
    v_add_u32 v1, 90112, v14
    v_mov_b32 v32, 0xff800000
    v_mov_b32 v33, 0xff800000
    v_mov_b32 v34, 0xff800000
    v_mov_b32 v35, 0xff800000
    s_mov_b32 s50, 1
    s_mov_b32 s46, 0
L2_fb_loop:
    s_add_u32 m0, s44, 73728
    s_nop 0
    buffer_load_dwordx4 v5, s[16:19], s46 offen offset:0 lds
    s_add_u32 m0, s44, 73760
    s_nop 0
    buffer_load_dwordx4 v5, s[16:19], s46 offen offset:1024 lds
    s_add_u32 m0, s44, 73792
    s_nop 0
    buffer_load_dwordx4 v5, s[16:19], s46 offen offset:2048 lds
    s_add_u32 m0, s44, 73824
    s_nop 0
    buffer_load_dwordx4 v5, s[16:19], s46 offen offset:3072 lds
    s_waitcnt vmcnt(0) lgkmcnt(0)
    s_barrier
    ds_read_b128 a[64:67], v1 offset:0
    ds_read_b128 a[68:71], v1 offset:64
    ds_read_b128 a[72:75], v1 offset:128
    ds_read_b128 a[76:79], v1 offset:192
    ds_read_b128 a[80:83], v1 offset:256
    ds_read_b128 a[84:87], v1 offset:320
    ds_read_b128 a[88:91], v1 offset:384
    ds_read_b128 a[92:95], v1 offset:448
    ds_read_b128 a[96:99], v1 offset:512
    ds_read_b128 a[100:103], v1 offset:576
    ds_read_b128 a[104:107], v1 offset:640
    ds_read_b128 a[108:111], v1 offset:704
    ds_read_b128 a[112:115], v1 offset:768
    ds_read_b128 a[116:119], v1 offset:832
    ds_read_b128 a[120:123], v1 offset:896
    ds_read_b128 a[124:127], v1 offset:960
    s_waitcnt vmcnt(0) lgkmcnt(0)
    s_barrier
    v_mfma_f32_16x16x32_bf16 v[16:19], a[64:67], v[64:67], 0
    v_mfma_f32_16x16x32_bf16 v[16:19], a[68:71], v[68:71], v[16:19]
    v_mfma_f32_16x16x32_bf16 v[16:19], a[72:75], v[72:75], v[16:19]
    v_mfma_f32_16x16x32_bf16 v[16:19], a[76:79], v[76:79], v[16:19]
    v_mfma_f32_16x16x32_bf16 v[20:23], a[80:83], v[64:67], 0
    v_mfma_f32_16x16x32_bf16 v[20:23], a[84:87], v[68:71], v[20:23]
    v_mfma_f32_16x16x32_bf16 v[20:23], a[88:91], v[72:75], v[20:23]
    v_mfma_f32_16x16x32_bf16 v[20:23], a[92:95], v[76:79], v[20:23]
    v_mfma_f32_16x16x32_bf16 v[24:27], a[96:99], v[64:67], 0
    v_mfma_f32_16x16x32_bf16 v[24:27], a[100:103], v[68:71], v[24:27]
    v_mfma_f32_16x16x32_bf16 v[24:27], a[104:107], v[72:75], v[24:27]
    v_mfma_f32_16x16x32_bf16 v[24:27], a[108:111], v[76:79], v[24:27]
    v_mfma_f32_16x16x32_bf16 v[28:31], a[112:115], v[64:67], 0
    v_mfma_f32_16x16x32_bf16 v[28:31], a[116:119], v[68:71], v[28:31]
    v_mfma_f32_16x16x32_bf16 v[28:31], a[120:123], v[72:75], v[28:31]
    v_mfma_f32_16x16x32_bf16 v[28:31], a[124:127], v[76:79], v[28:31]
    s_nop 7
    v_max3_f32 v32, v32, v16, v17
    v_max3_f32 v32, v32, v18, v19
    v_max3_f32 v32, v32, v20, v21
    v_max3_f32 v32, v32, v22, v23
    v_max3_f32 v32, v32, v24, v25
    v_max3_f32 v32, v32, v26, v27
    v_max3_f32 v32, v32, v28, v29
    v_max3_f32 v32, v32, v30, v31
    v_mfma_f32_16x16x32_bf16 v[16:19], a[64:67], v[80:83], 0
    v_mfma_f32_16x16x32_bf16 v[16:19], a[68:71], v[84:87], v[16:19]
    v_mfma_f32_16x16x32_bf16 v[16:19], a[72:75], v[88:91], v[16:19]
    v_mfma_f32_16x16x32_bf16 v[16:19], a[76:79], v[92:95], v[16:19]
    v_mfma_f32_16x16x32_bf16 v[20:23], a[80:83], v[80:83], 0
    v_mfma_f32_16x16x32_bf16 v[20:23], a[84:87], v[84:87], v[20:23]
    v_mfma_f32_16x16x32_bf16 v[20:23], a[88:91], v[88:91], v[20:23]
    v_mfma_f32_16x16x32_bf16 v[20:23], a[92:95], v[92:95], v[20:23]
    v_mfma_f32_16x16x32_bf16 v[24:27], a[96:99], v[80:83], 0
    v_mfma_f32_16x16x32_bf16 v[24:27], a[100:103], v[84:87], v[24:27]
    v_mfma_f32_16x16x32_bf16 v[24:27], a[104:107], v[88:91], v[24:27]
    v_mfma_f32_16x16x32_bf16 v[24:27], a[108:111], v[92:95], v[24:27]
    v_mfma_f32_16x16x32_bf16 v[28:31], a[112:115], v[80:83], 0
    v_mfma_f32_16x16x32_bf16 v[28:31], a[116:119], v[84:87], v[28:31]
    v_mfma_f32_16x16x32_bf16 v[28:31], a[120:123], v[88:91], v[28:31]
    v_mfma_f32_16x16x32_bf16 v[28:31], a[124:127], v[92:95], v[28:31]
    s_nop 7
    v_max3_f32 v33, v33, v16, v17
    v_max3_f32 v33, v33, v18, v19
    v_max3_f32 v33, v33, v20, v21
    v_max3_f32 v33, v33, v22, v23
    v_max3_f32 v33, v33, v24, v25
    v_max3_f32 v33, v33, v26, v27
    v_max3_f32 v33, v33, v28, v29
    v_max3_f32 v33, v33, v30, v31
    v_mfma_f32_16x16x32_bf16 v[16:19], a[64:67], v[96:99], 0
    v_mfma_f32_16x16x32_bf16 v[16:19], a[68:71], v[100:103], v[16:19]
    v_mfma_f32_16x16x32_bf16 v[16:19], a[72:75], v[104:107], v[16:19]
    v_mfma_f32_16x16x32_bf16 v[16:19], a[76:79], v[108:111], v[16:19]
    v_mfma_f32_16x16x32_bf16 v[20:23], a[80:83], v[96:99], 0
    v_mfma_f32_16x16x32_bf16 v[20:23], a[84:87], v[100:103], v[20:23]
    v_mfma_f32_16x16x32_bf16 v[20:23], a[88:91], v[104:107], v[20:23]
    v_mfma_f32_16x16x32_bf16 v[20:23], a[92:95], v[108:111], v[20:23]
    v_mfma_f32_16x16x32_bf16 v[24:27], a[96:99], v[96:99], 0
    v_mfma_f32_16x16x32_bf16 v[24:27], a[100:103], v[100:103], v[24:27]
    v_mfma_f32_16x16x32_bf16 v[24:27], a[104:107], v[104:107], v[24:27]
    v_mfma_f32_16x16x32_bf16 v[24:27], a[108:111], v[108:111], v[24:27]
    v_mfma_f32_16x16x32_bf16 v[28:31], a[112:115], v[96:99], 0
    v_mfma_f32_16x16x32_bf16 v[28:31], a[116:119], v[100:103], v[28:31]
    v_mfma_f32_16x16x32_bf16 v[28:31], a[120:123], v[104:107], v[28:31]
    v_mfma_f32_16x16x32_bf16 v[28:31], a[124:127], v[108:111], v[28:31]
    s_nop 7
    v_max3_f32 v34, v34, v16, v17
    v_max3_f32 v34, v34, v18, v19
    v_max3_f32 v34, v34, v20, v21
    v_max3_f32 v34, v34, v22, v23
    v_max3_f32 v34, v34, v24, v25
    v_max3_f32 v34, v34, v26, v27
    v_max3_f32 v34, v34, v28, v29
    v_max3_f32 v34, v34, v30, v31
    v_mfma_f32_16x16x32_bf16 v[16:19], a[64:67], v[112:115], 0
    v_mfma_f32_16x16x32_bf16 v[16:19], a[68:71], v[116:119], v[16:19]
    v_mfma_f32_16x16x32_bf16 v[16:19], a[72:75], v[120:123], v[16:19]
    v_mfma_f32_16x16x32_bf16 v[16:19], a[76:79], v[124:127], v[16:19]
    v_mfma_f32_16x16x32_bf16 v[20:23], a[80:83], v[112:115], 0
    v_mfma_f32_16x16x32_bf16 v[20:23], a[84:87], v[116:119], v[20:23]
    v_mfma_f32_16x16x32_bf16 v[20:23], a[88:91], v[120:123], v[20:23]
    v_mfma_f32_16x16x32_bf16 v[20:23], a[92:95], v[124:127], v[20:23]
    v_mfma_f32_16x16x32_bf16 v[24:27], a[96:99], v[112:115], 0
    v_mfma_f32_16x16x32_bf16 v[24:27], a[100:103], v[116:119], v[24:27]
    v_mfma_f32_16x16x32_bf16 v[24:27], a[104:107], v[120:123], v[24:27]
    v_mfma_f32_16x16x32_bf16 v[24:27], a[108:111], v[124:127], v[24:27]
    v_mfma_f32_16x16x32_bf16 v[28:31], a[112:115], v[112:115], 0
    v_mfma_f32_16x16x32_bf16 v[28:31], a[116:119], v[116:119], v[28:31]
    v_mfma_f32_16x16x32_bf16 v[28:31], a[120:123], v[120:123], v[28:31]
    v_mfma_f32_16x16x32_bf16 v[28:31], a[124:127], v[124:127], v[28:31]
    s_nop 7
    v_max3_f32 v35, v35, v16, v17
    v_max3_f32 v35, v35, v18, v19
    v_max3_f32 v35, v35, v20, v21
    v_max3_f32 v35, v35, v22, v23
    v_max3_f32 v35, v35, v24, v25
    v_max3_f32 v35, v35, v26, v27
    v_max3_f32 v35, v35, v28, v29
    v_max3_f32 v35, v35, v30, v31
    s_add_u32 s46, s46, 16384
    s_cmp_lt_u32 s46, 524288
    s_cbranch_scc1 L2_fb_loop
    v_mov_b32 v12, v32
    v_mov_b32 v13, v33
    v_mov_b32 v14, v34
    v_mov_b32 v15, v35
    v_permlane16_swap_b32 v12, v32
    v_permlane16_swap_b32 v13, v33
    v_permlane16_swap_b32 v14, v34
    v_permlane16_swap_b32 v15, v35
    v_max_f32 v32, v32, v12
    v_max_f32 v33, v33, v13
    v_max_f32 v34, v34, v14
    v_max_f32 v35, v35, v15
    v_mov_b32 v12, v32
    v_mov_b32 v13, v33
    v_mov_b32 v14, v34
    v_mov_b32 v15, v35
    v_permlane32_swap_b32 v12, v32
    v_permlane32_swap_b32 v13, v33
    v_permlane32_swap_b32 v14, v34
    v_permlane32_swap_b32 v15, v35
    v_max_f32 v32, v32, v12
    v_max_f32 v33, v33, v13
    v_max_f32 v34, v34, v14
    v_max_f32 v35, v35, v15
    v_sub_f32 v48, 0x80000000, v32
    v_sub_f32 v49, 0x80000000, v32
    v_sub_f32 v50, 0x80000000, v32
    v_sub_f32 v51, 0x80000000, v32
    v_sub_f32 v52, 0x80000000, v33
    v_sub_f32 v53, 0x80000000, v33
    v_sub_f32 v54, 0x80000000, v33
    v_sub_f32 v55, 0x80000000, v33
    v_sub_f32 v56, 0x80000000, v34
    v_sub_f32 v57, 0x80000000, v34
    v_sub_f32 v58, 0x80000000, v34
    v_sub_f32 v59, 0x80000000, v34
    v_sub_f32 v60, 0x80000000, v35
    v_sub_f32 v61, 0x80000000, v35
    v_sub_f32 v62, 0x80000000, v35
    v_sub_f32 v63, 0x80000000, v35
    s_add_u32 m0, s44, 73728
    s_mov_b32 s46, 0
    buffer_load_dwordx4 v5, s[16:19], s46 offen offset:0 lds
    s_add_u32 m0, s44, 73760
    s_nop 0
    buffer_load_dwordx4 v5, s[16:19], s46 offen offset:1024 lds
    s_add_u32 m0, s44, 73792
    s_nop 0
    buffer_load_dwordx4 v5, s[16:19], s46 offen offset:2048 lds
    s_add_u32 m0, s44, 73824
    s_nop 0
    buffer_load_dwordx4 v5, s[16:19], s46 offen offset:3072 lds
    s_add_u32 m0, s44, 90624
    s_nop 0
    buffer_load_dwordx4 v5, s[20:23], s46 offen offset:0 lds
    s_add_u32 m0, s44, 90656
    s_nop 0
    buffer_load_dwordx4 v5, s[20:23], s46 offen offset:1024 lds
    s_add_u32 m0, s44, 90688
    s_nop 0
    buffer_load_dwordx4 v5, s[20:23], s46 offen offset:2048 lds
    s_add_u32 m0, s44, 90720
    s_nop 0
    buffer_load_dwordx4 v5, s[20:23], s46 offen offset:3072 lds
    s_add_u32 m0, s44, 110592
    s_mov_b32 s46, 16384
    buffer_load_dwordx4 v5, s[16:19], s46 offen offset:0 lds
    s_add_u32 m0, s44, 110624
    s_nop 0
    buffer_load_dwordx4 v5, s[16:19], s46 offen offset:1024 lds
    s_add_u32 m0, s44, 110656
    s_nop 0
    buffer_load_dwordx4 v5, s[16:19], s46 offen offset:2048 lds
    s_add_u32 m0, s44, 110688
    s_nop 0
    buffer_load_dwordx4 v5, s[16:19], s46 offen offset:3072 lds
    s_add_u32 m0, s44, 127488
    s_nop 0
    buffer_load_dwordx4 v5, s[20:23], s46 offen offset:0 lds
    s_add_u32 m0, s44, 127520
    s_nop 0
    buffer_load_dwordx4 v5, s[20:23], s46 offen offset:1024 lds
    s_add_u32 m0, s44, 127552
    s_nop 0
    buffer_load_dwordx4 v5, s[20:23], s46 offen offset:2048 lds
    s_add_u32 m0, s44, 127584
    s_nop 0
    buffer_load_dwordx4 v5, s[20:23], s46 offen offset:3072 lds
    s_add_u32 m0, s44, 0
    s_mov_b32 s46, 32768
    buffer_load_dwordx4 v5, s[16:19], s46 offen offset:0 lds
    s_add_u32 m0, s44, 32
    s_nop 0
    buffer_load_dwordx4 v5, s[16:19], s46 offen offset:1024 lds
    s_add_u32 m0, s44, 64
    s_nop 0
    buffer_load_dwordx4 v5, s[16:19], s46 offen offset:2048 lds
    s_add_u32 m0, s44, 96
    s_nop 0
    buffer_load_dwordx4 v5, s[16:19], s46 offen offset:3072 lds
    s_add_u32 m0, s44, 16896
    s_nop 0
    buffer_load_dwordx4 v5, s[20:23], s46 offen offset:0 lds
    s_add_u32 m0, s44, 16928
    s_nop 0
    buffer_load_dwordx4 v5, s[20:23], s46 offen offset:1024 lds
    s_add_u32 m0, s44, 16960
    s_nop 0
    buffer_load_dwordx4 v5, s[20:23], s46 offen offset:2048 lds
    s_add_u32 m0, s44, 16992
    s_nop 0
    buffer_load_dwordx4 v5, s[20:23], s46 offen offset:3072 lds
    s_waitcnt vmcnt(0) lgkmcnt(0)
    s_barrier
    ds_read_b128 a[64:67], v1 offset:0
    ds_read_b128 a[68:71], v1 offset:64
    ds_read_b128 a[72:75], v1 offset:128
    ds_read_b128 a[76:79], v1 offset:192
    ds_read_b128 a[80:83], v1 offset:256
    ds_read_b128 a[84:87], v1 offset:320
    ds_read_b128 a[88:91], v1 offset:384
    ds_read_b128 a[92:95], v1 offset:448
    ds_read_b128 a[96:99], v1 offset:512
    ds_read_b128 a[100:103], v1 offset:576
    ds_read_b128 a[104:107], v1 offset:640
    ds_read_b128 a[108:111], v1 offset:704
    ds_read_b128 a[112:115], v1 offset:768
    ds_read_b128 a[116:119], v1 offset:832
    ds_read_b128 a[120:123], v1 offset:896
    ds_read_b128 a[124:127], v1 offset:960
    ds_read_b64_tr_b16 a[128:129], v2 offset:0
    ds_read_b64_tr_b16 a[130:131], v2 offset:256
    ds_read_b64_tr_b16 a[132:133], v2 offset:512
    ds_read_b64_tr_b16 a[134:135], v2 offset:768
    ds_read_b64_tr_b16 a[136:137], v2 offset:32
    ds_read_b64_tr_b16 a[138:139], v2 offset:288
    ds_read_b64_tr_b16 a[140:141], v2 offset:544
    ds_read_b64_tr_b16 a[142:143], v2 offset:800
    ds_read_b64_tr_b16 a[144:145], v2 offset:64
    ds_read_b64_tr_b16 a[146:147], v2 offset:320
    ds_read_b64_tr_b16 a[148:149], v2 offset:576
    ds_read_b64_tr_b16 a[150:151], v2 offset:832
    ds_read_b64_tr_b16 a[152:153], v2 offset:96
    ds_read_b64_tr_b16 a[154:155], v2 offset:352
    ds_read_b64_tr_b16 a[156:157], v2 offset:608
    ds_read_b64_tr_b16 a[158:159], v2 offset:864
    ds_read_b64_tr_b16 a[160:161], v2 offset:128
    ds_read_b64_tr_b16 a[162:163], v2 offset:384
    ds_read_b64_tr_b16 a[164:165], v2 offset:640
    ds_read_b64_tr_b16 a[166:167], v2 offset:896
    ds_read_b64_tr_b16 a[168:169], v2 offset:160
    ds_read_b64_tr_b16 a[170:171], v2 offset:416
    ds_read_b64_tr_b16 a[172:173], v2 offset:672
    ds_read_b64_tr_b16 a[174:175], v2 offset:928
    ds_read_b64_tr_b16 a[176:177], v2 offset:192
    ds_read_b64_tr_b16 a[178:179], v2 offset:448
    ds_read_b64_tr_b16 a[180:181], v2 offset:704
    ds_read_b64_tr_b16 a[182:183], v2 offset:960
    ds_read_b64_tr_b16 a[184:185], v2 offset:224
    ds_read_b64_tr_b16 a[186:187], v2 offset:480
    ds_read_b64_tr_b16 a[188:189], v2 offset:736
    ds_read_b64_tr_b16 a[190:191], v2 offset:992
    s_waitcnt vmcnt(0) lgkmcnt(0)
    s_branch L2_entry
L2_codeend:

.section .rodata,"a"
.p2align 6
.amdhsa_kernel adaLN_cond__gqa_block_cached__moe_arch_mod__prompt_kernel
  .amdhsa_next_free_vgpr 512
  .amdhsa_next_free_sgpr 102
  .amdhsa_accum_offset 256
  .amdhsa_group_segment_fixed_size 0
  .amdhsa_kernarg_size 120
  .amdhsa_user_sgpr_count 2
  .amdhsa_user_sgpr_kernarg_segment_ptr 1
  .amdhsa_system_sgpr_workgroup_id_x 1
  .amdhsa_float_denorm_mode_32 3
.end_amdhsa_kernel
```

```asm
; @launch grid=(256,1,1) block=(256,1,1) lds=163840
.amdgcn_target "amdgcn-amd-amdhsa--gfx950"
.text
.globl adaLN_cond__gqa_block_cached__moe_arch_mod__prompt_kernel
.p2align 8
.type adaLN_cond__gqa_block_cached__moe_arch_mod__prompt_kernel,@function
adaLN_cond__gqa_block_cached__moe_arch_mod__prompt_kernel:
L2_begin:
    s_getpc_b64 s[98:99]
    s_cmp_ge_u32 s2, 256
    s_cbranch_scc1 L2_end
    s_load_dwordx2 s[76:77], s[0:1], 0
    s_load_dwordx2 s[16:17], s[0:1], 80
    s_load_dwordx2 s[88:89], s[0:1], 88
    s_load_dwordx2 s[12:13], s[0:1], 112
    s_load_dwordx2 s[60:61], s[0:1], 104
    s_and_b32 s3, s2, 7
    s_lshr_b32 s14, s2, 3
    v_mov_b32 v155, v0
    v_lshrrev_b32 v10, 6, v0
    v_and_b32 v0, 63, v0
    s_lshl_b32 s15, s14, 9
    v_lshl_add_u32 v13, v10, 7, s15
    v_lshl_add_u32 v13, v0, 14, v13
    v_min_u32 v13, L2_codeend-L2_begin-8, v13
    s_mov_b64 exec, 31
    global_load_dword a63, v13, s[98:99]
    s_mov_b64 exec, -1
    v_readfirstlane_b32 s51, v10
    s_and_b32 s52, s3, 3
    s_and_b32 s15, s14, 3
    s_lshl2_add_u32 s52, s52, s15
    s_lshr_b32 s53, s3, 2
    s_lshr_b32 s15, s14, 2
    s_lshl3_add_u32 s53, s53, s15
    s_lshl4_add_u32 s96, s53, s52
    s_mul_i32 s49, s3, 27
    s_max_u32 s14, s14, 5
    s_add_u32 s49, s49, s14
    s_sub_u32 s49, s49, 5
    s_lshr_b32 s55, s3, 2
    s_mul_i32 s15, s55, 108
    s_sub_u32 s50, s49, s15
    s_mul_i32 s3, s51, 288
    v_lshrrev_b32 v14, 3, v0
    v_lshl_add_u32 v12, v14, 4, s3
    v_and_b32 v14, 1, v14
    v_lshl_add_u32 v13, v14, 4, s3
    v_and_b32 v14, 7, v0
    v_mul_u32_u24 v14, 1152, v14
    v_add_u32 v1, v14, v12
    v_add_u32 v2, v14, v13
    v_add_u32 v2, 256, v2
    v_and_b32 v4, 0xfc, v155
    v_and_b32 v7, 3, v0
    v_mul_u32_u24 v3, 6912, v4
    v_lshl_add_u32 v153, v7, 4, v3
    s_mul_i32 s3, s96, 9216
    s_movk_i32 s78, 9216
    s_mov_b32 s79, 0x20000
    s_mov_b32 s91, s79
    v_lshlrev_b32 v8, 4, v0
    s_mov_b32 s86, 6553600
    s_mov_b32 s87, s79
    s_movk_i32 s62, 256
    s_mov_b32 s63, s79
    s_lshl_b32 s14, s50, 6
    s_sub_u32 s90, 1990656, s14
    s_cmp_ge_u32 s2, 40
    s_cselect_b32 s90, s90, 0
    s_mul_i32 s15, s55, 1990656
    s_add_u32 s14, s14, s15
    s_waitcnt lgkmcnt(0)
    s_add_u32 s76, s76, s3
    s_addc_u32 s77, s77, 0
    buffer_load_dwordx4 v[64:67], v1, s[76:79], 0 offen offset:0
    buffer_load_dwordx4 v[68:71], v1, s[76:79], 0 offen offset:128
    buffer_load_dwordx4 v[72:75], v2, s[76:79], 0 offen offset:0
    s_add_u32 s88, s88, s14
    s_addc_u32 s89, s89, 0
    s_mov_b64 s[84:85], s[12:13]
    s_cmp_ge_u32 s2, 8
    s_cbranch_scc1 L2_noclr
    s_cmp_lt_u32 s2, 4
    s_cselect_b32 s3, -1, 0
    v_mov_b32 v52, s3
    v_mov_b32 v53, s3
    v_mov_b32 v54, s3
    v_mov_b32 v55, s3
    s_lshl2_add_u32 s3, s2, s51
    s_mul_i32 s3, s3, 2048
    buffer_store_dwordx4 v[52:55], v8, s[84:87], s3 offen offset:0 sc1
    buffer_store_dwordx4 v[52:55], v8, s[84:87], s3 offen offset:1024 sc1
L2_noclr:
    buffer_load_dwordx4 v[128:131], v153, s[88:91], 0 offen
    s_movk_i32 s3, 6912
    buffer_load_dwordx4 v[132:135], v153, s[88:91], s3 offen
    s_movk_i32 s3, 13824
    buffer_load_dwordx4 v[136:139], v153, s[88:91], s3 offen
    s_movk_i32 s3, 20736
    buffer_load_dwordx4 v[140:143], v153, s[88:91], s3 offen
    v_lshrrev_b32 v3, 2, v3
    v_lshl_add_u32 v3, v7, 4, v3
    v_add_u32 v154, 1769472, v3
    v_lshrrev_b32 v3, 1, v4
    v_lshlrev_b32 v4, 1, v4
    s_mul_i32 s3, s55, 576
    s_add_u32 s16, s16, s3
    s_addc_u32 s17, s17, 0
    s_mov_b32 s18, 576
    s_mov_b32 s19, 0x20000
    buffer_load_dwordx2 v[148:149], v4, s[16:19], 0 offen
    v_mov_b32 v144, 0
    v_mov_b32 v145, 0
    v_mov_b32 v146, 0
    v_mov_b32 v147, 0
    v_mov_b32 v150, 0
    s_cmp_ge_u32 s51, 2
    s_cbranch_scc1 L2_w23
    buffer_load_dwordx4 v[144:147], v154, s[88:91], 0 offen
    buffer_load_ushort v150, v3, s[16:19], 0 offen offset:512
L2_w23:
    s_load_dwordx8 s[4:11], s[0:1], 8
    s_load_dwordx2 s[64:65], s[0:1], 56
    s_load_dwordx2 s[68:69], s[0:1], 64
    s_load_dwordx2 s[72:73], s[0:1], 72
    s_load_dwordx2 s[80:81], s[0:1], 96
    s_load_dwordx2 s[36:37], s[0:1], 48
    s_getreg_b32 s3, hwreg(HW_REG_XCC_ID, 0, 4)
    s_add_u32 s3, s3, 1
    v_mov_b32 v165, s3
    s_cmp_eq_u32 s51, 0
    s_cselect_b32 s3, 0, 0x40000000
    v_mul_u32_u24 v156, 32, v0
    v_or_b32 v156, s3, v156
    s_mul_i32 s44, s51, 4224
    s_add_u32 s44, s44, 16384
    v_lshl_add_u32 v5, v10, 12, v8
    v_lshrrev_b32 v13, 5, v0
    v_lshl_add_u32 v13, v10, 1, v13
    v_lshlrev_b32 v13, 15, v13
    v_and_b32 v14, 31, v0
    v_lshl_add_u32 v6, v14, 4, v13
    v_mov_b32 v56, 0
    v_mov_b32 v60, -1
    v_mov_b32 v57, 0
    v_mov_b32 v61, -1
    v_mov_b32 v58, 0
    v_mov_b32 v62, -1
    v_mov_b32 v59, 0
    v_mov_b32 v63, -1
    s_and_b32 s14, s53, 7
    s_lshl2_add_u32 s14, s14, s51
    v_lshrrev_b32 v13, 2, v0
    v_lshl_add_u32 v13, v13, 5, s14
    v_lshlrev_b32 v13, 13, v13
    v_lshl_add_u32 v13, v7, 7, v13
    s_waitcnt lgkmcnt(0)
    s_lshl_b32 s3, s52, 9
    s_add_u32 s24, s8, s3
    s_addc_u32 s25, s9, 0
    s_mov_b32 s26, 0
    s_mov_b32 s27, 0x20000
    s_sub_u32 s26, 4718592, s3
    s_mov_b64 exec, 0xffff
    buffer_load_dword a63, v13, s[24:27], 0 offen
    s_mov_b64 exec, -1
    s_mov_b32 s38, 1152
    s_mov_b32 s39, 0x20000
    v_and_b32 v14, 7, v0
    v_lshlrev_b32 v157, 4, v14
    v_add_u32 v157, 14080, v157
    v_lshl_add_u32 v158, v10, 2, v157
    s_mul_i32 s3, s51, 4608
    v_lshl_add_u32 v14, v14, 4, s3
    v_lshrrev_b32 v15, 3, v0
    v_lshl_add_u32 v159, v15, 8, v14
    s_lshr_b32 s3, s96, 1
    s_mul_i32 s3, s3, 18432
    s_and_b32 s14, s96, 1
    s_lshl_b32 s14, s14, 7
    s_add_u32 s3, s3, s14
    s_add_u32 s58, s3, 1048576
    s_lshl_b32 s3, s53, 2
    s_add_u32 s3, s3, s51
    s_lshl_b32 s14, s3, 4
    s_add_u32 s14, s14, s52
    s_lshl_b32 s14, s14, 8
    s_add_u32 s56, s14, 786432
    s_lshl_b32 s14, s3, 9
    s_add_u32 s59, s14, 32768
    v_and_b32 v14, 3, v0
    v_lshlrev_b32 v163, 7, v14
    s_mul_i32 s14, s3, 36864
    s_add_u32 s14, s14, 1048576
    s_add_u32 s32, s12, s14
    s_addc_u32 s33, s13, 0
    s_mov_b32 s34, 36864
    s_mov_b32 s35, 0x20000
    s_mul_i32 s15, s2, 4608
    s_mul_i32 s14, s51, 1152
    s_add_u32 s15, s15, s14
    s_add_u32 s57, s15, 98304
    s_cmp_ge_u32 s2, 144
    s_cselect_b32 s14, 0x40000000, 0
    v_or_b32 v160, s14, v8
    v_lshrrev_b32 v12, 4, v155
    v_lshlrev_b32 v12, 7, v12
    v_lshl_add_u32 v161, v7, 5, v12
    v_lshlrev_b32 v162, 2, v0
    s_mul_i32 s3, s50, 3641
    s_lshr_b32 s3, s3, 16
    s_mov_b32 s47, 1.0
    s_mov_b32 s48, 0
    s_cmp_lt_u32 s3, 2
    s_cselect_b32 s47, 0x3e0293ee, s47
    s_cmp_eq_u32 s3, 1
    s_cselect_b32 s48, 0x3e0293ee, s48
    s_cmp_eq_u32 s3, 4
    s_cselect_b32 s48, 1.0, s48
    s_cmp_eq_u32 s55, 0
    s_cselect_b32 s48, s48, 0
    s_lshl_b32 s100, s49, 7
    s_lshl_b32 s14, s96, 7
    s_add_u32 s101, s14, 32768
    s_mul_i32 s3, s51, 1152
    v_add_u32 v166, s3, v8
    s_and_b32 s3, s51, 1
    s_mul_i32 s3, s3, 2304
    s_cmp_lt_u32 s51, 2
    s_cselect_b32 s14, 32, 0
    s_add_u32 s3, s3, s14
    s_add_u32 s3, s3, 9216
    v_lshrrev_b32 v14, 1, v0
    v_lshl_add_u32 v14, v14, 6, s3
    v_and_b32 v15, 1, v0
    v_lshl_add_u32 v167, v15, 4, v14
    s_cmp_eq_u32 s51, 1
    s_cselect_b32 s3, 40, 256
    s_cmp_ge_u32 s2, s3
    s_cselect_b32 s3, 0, 0x40000000
    v_or_b32 v164, s3, v162
    v_mov_b32 v172, 0
    v_mov_b32 v180, 0
    v_mov_b32 v173, 0
    v_mov_b32 v181, 0
    v_mov_b32 v174, 0
    v_mov_b32 v182, 0
    v_mov_b32 v175, 0
    v_mov_b32 v183, 0
    s_lshl_b32 s3, s53, 2
    s_add_u32 s3, s3, s51
    v_mov_b32 v12, v10
    s_mul_i32 s14, s3, 589824
    s_mul_i32 s15, s52, 9216
    s_add_u32 s14, s14, s15
    s_add_u32 s14, s14, 8388608
    s_add_u32 s40, s12, s14
    s_addc_u32 s41, s13, 0
    s_mov_b32 s42, 0
    s_mov_b32 s43, 0x20000
    s_sub_u32 s42, 589824, s15
    s_lshl_b32 s3, s52, 19
    s_add_u32 s16, s4, s3
    s_addc_u32 s17, s5, 0
    s_mov_b32 s18, 524288
    s_mov_b32 s19, 0x20000
    s_add_u32 s20, s6, s3
    s_addc_u32 s21, s7, 0
    s_mov_b32 s22, 524288
    s_mov_b32 s23, 0x20000
    s_mul_i32 s3, s52, 294912
    s_add_u32 s28, s10, s3
    s_addc_u32 s29, s11, 0
    s_mov_b32 s30, 294912
    s_mov_b32 s31, 0x20000
    s_mov_b64 s[4:5], s[64:65]
    s_mov_b64 s[6:7], s[68:69]
    s_mov_b64 s[8:9], s[72:73]
    s_mov_b32 s50, 0
    s_mul_i32 s55, s51, 9216
    s_min_u32 s15, s2, 143
    s_and_b32 s3, s15, 7
    s_mul_i32 s3, s3, 18
    s_lshr_b32 s15, s15, 3
    s_add_u32 s15, s15, s3
    s_lshl_b32 s3, s15, 6
    s_add_u32 s64, s64, s3
    s_addc_u32 s65, s65, 0
    s_mov_b32 s66, 0
    s_mov_b32 s67, 0x20000
    s_add_u32 s68, s68, s3
    s_addc_u32 s69, s69, 0
    s_mov_b32 s70, 0
    s_mov_b32 s71, 0x20000
    s_sub_u32 s14, 5308416, s3
    s_mul_i32 s3, s15, 36864
    s_add_u32 s72, s72, s3
    s_addc_u32 s73, s73, 0
    s_mov_b32 s74, 0
    s_mov_b32 s75, 0x20000
    s_cmp_lt_u32 s2, 144
    s_cselect_b32 s66, s14, 0
    s_cselect_b32 s70, s14, 0
    s_cselect_b32 s74, 36864, 0
    s_mov_b32 s82, 2359296
    s_mov_b32 s83, 0x20000
    v_lshrrev_b32 v13, 4, v0
    v_lshlrev_b32 v9, 6, v13
    v_lshrrev_b32 v14, 2, v0
    v_mul_u32_u24 v14, 1056, v14
    v_add_u32 v14, 16384, v14
    v_and_b32 v15, 1, v0
    v_lshlrev_b32 v15, 4, v15
    v_add_u32 v3, v14, v15
    v_and_b32 v15, 2, v0
    v_lshl_add_u32 v3, v15, 2, v3
    v_add_u32 v4, 73728, v3
    v_lshrrev_b32 v14, 3, v0
    v_lshlrev_b32 v14, 2, v14
    v_add_u32 v14, v14, v12
    v_mul_u32_u24 v14, 4608, v14
    v_and_b32 v15, 7, v0
    v_lshl_add_u32 v7, v15, 4, v14
    v_lshlrev_b32 v10, 4, v15
    v_lshl_add_u32 v10, v13, 7, v10
    v_bfe_u32 v14, v0, 3, 1
    v_mul_u32_u24 v14, 147456, v14
    v_add_u32 v10, v10, v14
    v_lshrrev_b32 v14, 2, v0
    v_mul_u32_u24 v14, 1056, v14
    v_and_b32 v15, 3, v0
    v_lshl_add_u32 v14, v15, 3, v14
    v_add_u32 v2, 107008, v14
    v_and_b32 v14, 15, v0
    v_mul_u32_u24 v14, 1056, v14
    v_lshrrev_b32 v15, 4, v0
    v_lshl_add_u32 v14, v15, 4, v14
    v_add_u32 v1, 90112, v14
    v_and_b32 v14, 1, v0
    v_cmp_eq_u32 vcc, 0, v14
    v_mov_b32 v11, 0xeeeeeeee
    v_mov_b32 v15, 0x44444444
    v_cndmask_b32 v11, v11, v15, vcc
    v_and_b32 v14, 2, v0
    v_cmp_eq_u32 vcc, 0, v14
    v_mov_b32 v15, 0x3f803f80
    s_nop 0
    v_cndmask_b32 v15, 0, v15, vcc
    v_accvgpr_write_b32 a16, v15
    v_accvgpr_write_b32 a17, v15
    v_accvgpr_write_b32 a18, v15
    v_accvgpr_write_b32 a19, v15
    s_cmp_ge_u32 s2, 8
    s_cbranch_scc1 L2_noclr2
    s_mul_i32 s14, s2, 32
    s_mov_b64 exec, 1
    s_waitcnt vmcnt(6)
    s_barrier
    buffer_store_dword v60, v156, s[60:63], s14 offen sc1
    s_mov_b64 exec, -1
L2_noclr2:
    s_waitcnt vmcnt(6)
    v_lshlrev_b32 v24, 16, v64
    v_and_b32 v25, 0xffff0000, v64
    v_lshlrev_b32 v26, 16, v65
    v_and_b32 v27, 0xffff0000, v65
    v_lshlrev_b32 v28, 16, v66
    v_and_b32 v29, 0xffff0000, v66
    v_lshlrev_b32 v30, 16, v67
    v_and_b32 v31, 0xffff0000, v67
    v_lshlrev_b32 v32, 16, v68
    v_and_b32 v33, 0xffff0000, v68
    v_lshlrev_b32 v34, 16, v69
    v_and_b32 v35, 0xffff0000, v69
    v_lshlrev_b32 v36, 16, v70
    v_and_b32 v37, 0xffff0000, v70
    v_lshlrev_b32 v38, 16, v71
    v_and_b32 v39, 0xffff0000, v71
    v_lshlrev_b32 v40, 16, v72
    v_and_b32 v41, 0xffff0000, v72
    v_lshlrev_b32 v42, 16, v73
    v_and_b32 v43, 0xffff0000, v73
    v_lshlrev_b32 v44, 16, v74
    v_and_b32 v45, 0xffff0000, v74
    v_lshlrev_b32 v46, 16, v75
    v_and_b32 v47, 0xffff0000, v75
    v_pk_add_f32 v[12:13], v[24:25], v[26:27]
    v_pk_add_f32 v[12:13], v[12:13], v[28:29]
    v_pk_add_f32 v[12:13], v[12:13], v[30:31]
    v_pk_add_f32 v[12:13], v[12:13], v[32:33]
    v_pk_add_f32 v[12:13], v[12:13], v[34:35]
    v_pk_add_f32 v[12:13], v[12:13], v[36:37]
    v_pk_add_f32 v[12:13], v[12:13], v[38:39]
    v_pk_add_f32 v[14:15], v[40:41], v[42:43]
    v_pk_add_f32 v[14:15], v[14:15], v[44:45]
    v_pk_add_f32 v[14:15], v[14:15], v[46:47]
    v_add_f32 v48, v12, v13
    v_add_f32 v14, v14, v15
    v_fmac_f32 v48, 0x3e800000, v14
    s_nop 1
    v_add_f32_dpp v48, v48, v48 row_ror:8 row_mask:0xf bank_mask:0xf
    v_mov_b32 v50, v48
    s_nop 1
    v_permlane16_swap_b32 v50, v48
    v_add_f32 v48, v48, v50
    v_mov_b32 v50, v48
    s_nop 1
    v_permlane32_swap_b32 v50, v48
    v_add_f32 v48, v48, v50
    v_mul_f32 v48, 0x3be38e39, v48
    v_pk_add_f32 v[24:25], v[24:25], v[48:49] op_sel_hi:[1,0] neg_lo:[0,1] neg_hi:[0,1]
    v_pk_add_f32 v[26:27], v[26:27], v[48:49] op_sel_hi:[1,0] neg_lo:[0,1] neg_hi:[0,1]
    v_pk_add_f32 v[28:29], v[28:29], v[48:49] op_sel_hi:[1,0] neg_lo:[0,1] neg_hi:[0,1]
    v_pk_add_f32 v[30:31], v[30:31], v[48:49] op_sel_hi:[1,0] neg_lo:[0,1] neg_hi:[0,1]
    v_pk_add_f32 v[32:33], v[32:33], v[48:49] op_sel_hi:[1,0] neg_lo:[0,1] neg_hi:[0,1]
    v_pk_add_f32 v[34:35], v[34:35], v[48:49] op_sel_hi:[1,0] neg_lo:[0,1] neg_hi:[0,1]
    v_pk_add_f32 v[36:37], v[36:37], v[48:49] op_sel_hi:[1,0] neg_lo:[0,1] neg_hi:[0,1]
    v_pk_add_f32 v[38:39], v[38:39], v[48:49] op_sel_hi:[1,0] neg_lo:[0,1] neg_hi:[0,1]
    v_pk_add_f32 v[40:41], v[40:41], v[48:49] op_sel_hi:[1,0] neg_lo:[0,1] neg_hi:[0,1]
    v_pk_add_f32 v[42:43], v[42:43], v[48:49] op_sel_hi:[1,0] neg_lo:[0,1] neg_hi:[0,1]
    v_pk_add_f32 v[44:45], v[44:45], v[48:49] op_sel_hi:[1,0] neg_lo:[0,1] neg_hi:[0,1]
    v_pk_add_f32 v[46:47], v[46:47], v[48:49] op_sel_hi:[1,0] neg_lo:[0,1] neg_hi:[0,1]
    v_pk_mul_f32 v[12:13], v[24:25], v[24:25]
    v_pk_fma_f32 v[12:13], v[26:27], v[26:27], v[12:13]
    v_pk_fma_f32 v[12:13], v[28:29], v[28:29], v[12:13]
    v_pk_fma_f32 v[12:13], v[30:31], v[30:31], v[12:13]
    v_pk_fma_f32 v[12:13], v[32:33], v[32:33], v[12:13]
    v_pk_fma_f32 v[12:13], v[34:35], v[34:35], v[12:13]
    v_pk_fma_f32 v[12:13], v[36:37], v[36:37], v[12:13]
    v_pk_fma_f32 v[12:13], v[38:39], v[38:39], v[12:13]
    v_pk_mul_f32 v[14:15], v[40:41], v[40:41]
    v_pk_fma_f32 v[14:15], v[42:43], v[42:43], v[14:15]
    v_pk_fma_f32 v[14:15], v[44:45], v[44:45], v[14:15]
    v_pk_fma_f32 v[14:15], v[46:47], v[46:47], v[14:15]
    v_add_f32 v49, v12, v13
    v_add_f32 v14, v14, v15
    v_fmac_f32 v49, 0x3e800000, v14
    s_nop 1
    v_add_f32_dpp v49, v49, v49 row_ror:8 row_mask:0xf bank_mask:0xf
    v_mov_b32 v50, v49
    s_nop 1
    v_permlane16_swap_b32 v50, v49
    v_add_f32 v49, v49, v50
    v_mov_b32 v50, v49
    s_nop 1
    v_permlane32_swap_b32 v50, v49
    v_add_f32 v49, v49, v50
    ds_write_b32 v158, v48
    ds_write_b32 v158, v49 offset:128
    s_waitcnt lgkmcnt(0)
    s_barrier
    ds_read_b128 v[16:19], v157
    ds_read_b128 v[20:23], v157 offset:128
    s_add_u32 s14, s58, 4096
    s_waitcnt lgkmcnt(1)
    v_add_f32 v12, v16, v17
    v_add_f32 v13, v18, v19
    v_add_f32 v12, v12, v13
    v_mul_f32 v12, 0x3e800000, v12
    v_sub_f32 v16, v16, v12
    v_sub_f32 v17, v17, v12
    v_sub_f32 v18, v18, v12
    v_sub_f32 v19, v19, v12
    v_sub_f32 v48, v48, v12
    v_mul_f32 v13, v16, v16
    v_fmac_f32 v13, v17, v17
    v_fmac_f32 v13, v18, v18
    v_fmac_f32 v13, v19, v19
    s_waitcnt lgkmcnt(0)
    v_add_f32 v14, v20, v21
    v_add_f32 v15, v22, v23
    v_add_f32 v14, v14, v15
    v_fmac_f32 v14, 0x43100000, v13
    v_mov_b32 v12, 0x3727c5ac
    v_fmac_f32 v12, 0x3ae38e39, v14
    v_rsq_f32 v12, v12
    s_nop 0
    v_mul_f32 v48, v48, v12
    v_pk_fma_f32 v[24:25], v[24:25], v[12:13], v[48:49] op_sel_hi:[1,0,0]
    v_pk_fma_f32 v[26:27], v[26:27], v[12:13], v[48:49] op_sel_hi:[1,0,0]
    v_pk_fma_f32 v[28:29], v[28:29], v[12:13], v[48:49] op_sel_hi:[1,0,0]
    v_pk_fma_f32 v[30:31], v[30:31], v[12:13], v[48:49] op_sel_hi:[1,0,0]
    v_cvt_pk_f16_f32 v64, v24, v25
    v_cvt_pk_f16_f32 v65, v26, v27
    v_cvt_pk_f16_f32 v66, v28, v29
    v_cvt_pk_f16_f32 v67, v30, v31
    buffer_store_dwordx4 v[64:67], v159, s[84:87], s58 offen offset:0 sc1
    v_pk_fma_f32 v[32:33], v[32:33], v[12:13], v[48:49] op_sel_hi:[1,0,0]
    v_pk_fma_f32 v[34:35], v[34:35], v[12:13], v[48:49] op_sel_hi:[1,0,0]
    v_pk_fma_f32 v[36:37], v[36:37], v[12:13], v[48:49] op_sel_hi:[1,0,0]
    v_pk_fma_f32 v[38:39], v[38:39], v[12:13], v[48:49] op_sel_hi:[1,0,0]
    v_cvt_pk_f16_f32 v68, v32, v33
    v_cvt_pk_f16_f32 v69, v34, v35
    v_cvt_pk_f16_f32 v70, v36, v37
    v_cvt_pk_f16_f32 v71, v38, v39
    buffer_store_dwordx4 v[68:71], v159, s[84:87], s58 offen offset:2048 sc1
    v_pk_fma_f32 v[40:41], v[40:41], v[12:13], v[48:49] op_sel_hi:[1,0,0]
    v_pk_fma_f32 v[42:43], v[42:43], v[12:13], v[48:49] op_sel_hi:[1,0,0]
    v_pk_fma_f32 v[44:45], v[44:45], v[12:13], v[48:49] op_sel_hi:[1,0,0]
    v_pk_fma_f32 v[46:47], v[46:47], v[12:13], v[48:49] op_sel_hi:[1,0,0]
    v_cvt_pk_f16_f32 v72, v40, v41
    v_cvt_pk_f16_f32 v73, v42, v43
    v_cvt_pk_f16_f32 v74, v44, v45
    v_cvt_pk_f16_f32 v75, v46, v47
    s_mov_b64 exec, 0xffff
    buffer_store_dwordx4 v[72:75], v159, s[84:87], s14 offen offset:0 sc1
    buffer_store_dwordx4 v[56:59], v8, s[84:87], s56 offen sc1
    s_mov_b64 exec, 0xff
    buffer_store_dwordx4 v[60:63], v160, s[84:87], s57 offen offset:1024 sc1
    s_mov_b64 exec, -1
    buffer_store_dwordx4 v[60:63], v160, s[84:87], s57 offen sc1
    s_mov_b64 exec, 255
    buffer_load_dword v51, v156, s[60:63], 0 offen sc1
    s_mov_b64 exec, -1
    s_mul_i32 s3, s96, 147456
    s_add_u32 s3, s3, 8392704
    s_add_u32 s88, s12, s3
    s_addc_u32 s89, s13, 0
    s_mov_b32 s90, 143360
    s_mov_b32 s91, 0x20000
    s_waitcnt vmcnt(7)
    v_lshlrev_b32 v40, 16, v148
    v_and_b32 v41, 0xffff0000, v148
    v_lshlrev_b32 v42, 16, v149
    v_and_b32 v43, 0xffff0000, v149
    v_lshlrev_b32 v44, 16, v150
    v_mul_f32 v16, 0xbfb8aa3b, v40
    v_mul_f32 v17, 0xbfb8aa3b, v41
    v_mul_f32 v18, 0xbfb8aa3b, v42
    v_mul_f32 v19, 0xbfb8aa3b, v43
    v_mul_f32 v20, 0xbfb8aa3b, v44
    v_exp_f32 v16, v16
    v_exp_f32 v17, v17
    v_exp_f32 v18, v18
    v_exp_f32 v19, v19
    v_exp_f32 v20, v20
    v_add_f32 v16, 1.0, v16
    v_add_f32 v17, 1.0, v17
    v_add_f32 v18, 1.0, v18
    v_add_f32 v19, 1.0, v19
    v_add_f32 v20, 1.0, v20
    v_rcp_f32 v16, v16
    v_rcp_f32 v17, v17
    v_rcp_f32 v18, v18
    v_rcp_f32 v19, v19
    v_rcp_f32 v20, v20
    v_mul_f32 v24, v40, v16
    v_mul_f32 v26, v41, v17
    v_mul_f32 v28, v42, v18
    v_mul_f32 v30, v43, v19
    v_mul_f32 v32, v44, v20
    v_lshlrev_b32 v12, 16, v128
    v_and_b32 v13, 0xffff0000, v128
    v_pk_mul_f32 v[16:17], v[12:13], v[24:25] op_sel_hi:[1,0]
    v_lshlrev_b32 v14, 16, v129
    v_and_b32 v15, 0xffff0000, v129
    v_pk_mul_f32 v[18:19], v[14:15], v[24:25] op_sel_hi:[1,0]
    v_lshlrev_b32 v12, 16, v130
    v_and_b32 v13, 0xffff0000, v130
    v_pk_mul_f32 v[20:21], v[12:13], v[24:25] op_sel_hi:[1,0]
    v_lshlrev_b32 v14, 16, v131
    v_and_b32 v15, 0xffff0000, v131
    v_pk_mul_f32 v[22:23], v[14:15], v[24:25] op_sel_hi:[1,0]
    v_lshlrev_b32 v12, 16, v132
    v_and_b32 v13, 0xffff0000, v132
    v_pk_fma_f32 v[16:17], v[12:13], v[26:27], v[16:17] op_sel_hi:[1,0,1]
    v_lshlrev_b32 v14, 16, v133
    v_and_b32 v15, 0xffff0000, v133
    v_pk_fma_f32 v[18:19], v[14:15], v[26:27], v[18:19] op_sel_hi:[1,0,1]
    v_lshlrev_b32 v12, 16, v134
    v_and_b32 v13, 0xffff0000, v134
    v_pk_fma_f32 v[20:21], v[12:13], v[26:27], v[20:21] op_sel_hi:[1,0,1]
    v_lshlrev_b32 v14, 16, v135
    v_and_b32 v15, 0xffff0000, v135
    v_pk_fma_f32 v[22:23], v[14:15], v[26:27], v[22:23] op_sel_hi:[1,0,1]
    v_lshlrev_b32 v12, 16, v136
    v_and_b32 v13, 0xffff0000, v136
    v_pk_fma_f32 v[16:17], v[12:13], v[28:29], v[16:17] op_sel_hi:[1,0,1]
    v_lshlrev_b32 v14, 16, v137
    v_and_b32 v15, 0xffff0000, v137
    v_pk_fma_f32 v[18:19], v[14:15], v[28:29], v[18:19] op_sel_hi:[1,0,1]
    v_lshlrev_b32 v12, 16, v138
    v_and_b32 v13, 0xffff0000, v138
    v_pk_fma_f32 v[20:21], v[12:13], v[28:29], v[20:21] op_sel_hi:[1,0,1]
    v_lshlrev_b32 v14, 16, v139
    v_and_b32 v15, 0xffff0000, v139
    v_pk_fma_f32 v[22:23], v[14:15], v[28:29], v[22:23] op_sel_hi:[1,0,1]
    v_lshlrev_b32 v12, 16, v140
    v_and_b32 v13, 0xffff0000, v140
    v_pk_fma_f32 v[16:17], v[12:13], v[30:31], v[16:17] op_sel_hi:[1,0,1]
    v_lshlrev_b32 v14, 16, v141
    v_and_b32 v15, 0xffff0000, v141
    v_pk_fma_f32 v[18:19], v[14:15], v[30:31], v[18:19] op_sel_hi:[1,0,1]
    v_lshlrev_b32 v12, 16, v142
    v_and_b32 v13, 0xffff0000, v142
    v_pk_fma_f32 v[20:21], v[12:13], v[30:31], v[20:21] op_sel_hi:[1,0,1]
    v_lshlrev_b32 v14, 16, v143
    v_and_b32 v15, 0xffff0000, v143
    v_pk_fma_f32 v[22:23], v[14:15], v[30:31], v[22:23] op_sel_hi:[1,0,1]
    v_lshlrev_b32 v12, 16, v144
    v_and_b32 v13, 0xffff0000, v144
    v_pk_fma_f32 v[16:17], v[12:13], v[32:33], v[16:17] op_sel_hi:[1,0,1]
    v_lshlrev_b32 v14, 16, v145
    v_and_b32 v15, 0xffff0000, v145
    v_pk_fma_f32 v[18:19], v[14:15], v[32:33], v[18:19] op_sel_hi:[1,0,1]
    v_lshlrev_b32 v12, 16, v146
    v_and_b32 v13, 0xffff0000, v146
    v_pk_fma_f32 v[20:21], v[12:13], v[32:33], v[20:21] op_sel_hi:[1,0,1]
    v_lshlrev_b32 v14, 16, v147
    v_and_b32 v15, 0xffff0000, v147
    v_pk_fma_f32 v[22:23], v[14:15], v[32:33], v[22:23] op_sel_hi:[1,0,1]
    v_add_f32_dpp v16, v16, v16 row_ror:4 row_mask:0xf bank_mask:0xf
    v_add_f32_dpp v17, v17, v17 row_ror:4 row_mask:0xf bank_mask:0xf
    v_add_f32_dpp v18, v18, v18 row_ror:4 row_mask:0xf bank_mask:0xf
    v_add_f32_dpp v19, v19, v19 row_ror:4 row_mask:0xf bank_mask:0xf
    v_add_f32_dpp v20, v20, v20 row_ror:4 row_mask:0xf bank_mask:0xf
    v_add_f32_dpp v21, v21, v21 row_ror:4 row_mask:0xf bank_mask:0xf
    v_add_f32_dpp v22, v22, v22 row_ror:4 row_mask:0xf bank_mask:0xf
    v_add_f32_dpp v23, v23, v23 row_ror:4 row_mask:0xf bank_mask:0xf
    v_add_f32_dpp v16, v16, v16 row_ror:8 row_mask:0xf bank_mask:0xf
    v_add_f32_dpp v17, v17, v17 row_ror:8 row_mask:0xf bank_mask:0xf
    v_add_f32_dpp v18, v18, v18 row_ror:8 row_mask:0xf bank_mask:0xf
    v_add_f32_dpp v19, v19, v19 row_ror:8 row_mask:0xf bank_mask:0xf
    v_add_f32_dpp v20, v20, v20 row_ror:8 row_mask:0xf bank_mask:0xf
    v_add_f32_dpp v21, v21, v21 row_ror:8 row_mask:0xf bank_mask:0xf
    v_add_f32_dpp v22, v22, v22 row_ror:8 row_mask:0xf bank_mask:0xf
    v_add_f32_dpp v23, v23, v23 row_ror:8 row_mask:0xf bank_mask:0xf
    s_mov_b32 exec_lo, 0xf000f
    s_mov_b32 exec_hi, 0xf000f
    ds_write_b128 v161, v[16:19] offset:16384
    ds_write_b128 v161, v[20:23] offset:16400
    s_mov_b64 exec, 255
    s_waitcnt vmcnt(0)
    v_cmp_eq_u32 vcc, s51, v51
    s_nop 0
    s_cmp_lg_u64 vcc, 0
    s_cbranch_scc1 L2_p0s
L2_p0r:
    s_mov_b64 exec, 1
    s_waitcnt lgkmcnt(0)
    s_barrier
    buffer_store_dword v165, v156, s[84:87], s101 offen sc1
    s_mov_b64 exec, -1
    ds_read_b32 v24, v162 offset:16384
    ds_read_b32 v25, v162 offset:16640
    ds_read_b32 v26, v162 offset:16896
    ds_read_b32 v27, v162 offset:17152
    ds_read_b32 v28, v162 offset:17408
    ds_read_b32 v29, v162 offset:17664
    ds_read_b32 v30, v162 offset:17920
    ds_read_b32 v31, v162 offset:18176
    s_waitcnt lgkmcnt(0)
    v_pk_add_f32 v[24:25], v[24:25], v[26:27]
    v_pk_add_f32 v[28:29], v[28:29], v[30:31]
    v_pk_add_f32 v[24:25], v[24:25], v[28:29]
    v_add_f32 v52, v24, v25
    v_mov_b32 v53, v52
    v_mov_b32 v54, s48
    s_nop 0
    v_permlane32_swap_b32 v53, v52
    v_add_f32 v52, v52, v53
    v_fma_f32 v52, v52, s47, v54
    v_min_u32 v52, -2, v52
    s_mov_b32 exec_hi, 0
    buffer_store_dword v52, v164, s[84:87], s100 offen sc1
    s_mov_b64 exec, -1
    s_add_u32 m0, s44, 36864
    s_mov_b32 s45, 0
    buffer_load_dwordx4 v6, s[24:27], s45 offen lds
    s_add_u32 m0, s44, 37920
    s_mov_b32 s45, 8192
    buffer_load_dwordx4 v6, s[24:27], s45 offen lds
    s_add_u32 m0, s44, 38976
    s_mov_b32 s45, 16384
    buffer_load_dwordx4 v6, s[24:27], s45 offen lds
    s_add_u32 m0, s44, 40032
    s_mov_b32 s45, 24576
    buffer_load_dwordx4 v6, s[24:27], s45 offen lds
    s_add_u32 m0, s44, 53760
    s_mov_b32 s45, 262144
    buffer_load_dwordx4 v6, s[24:27], s45 offen lds
    s_add_u32 m0, s44, 54816
    s_mov_b32 s45, 270336
    buffer_load_dwordx4 v6, s[24:27], s45 offen lds
    s_add_u32 m0, s44, 55872
    s_mov_b32 s45, 278528
    buffer_load_dwordx4 v6, s[24:27], s45 offen lds
    s_add_u32 m0, s44, 56928
    s_mov_b32 s45, 286720
    buffer_load_dwordx4 v6, s[24:27], s45 offen lds
    s_add_u32 m0, s44, 73728
    s_mov_b32 s45, 524288
    buffer_load_dwordx4 v6, s[24:27], s45 offen lds
    s_add_u32 m0, s44, 74784
    s_mov_b32 s45, 532480
    buffer_load_dwordx4 v6, s[24:27], s45 offen lds
    s_add_u32 m0, s44, 75840
    s_mov_b32 s45, 540672
    buffer_load_dwordx4 v6, s[24:27], s45 offen lds
    s_add_u32 m0, s44, 76896
    s_mov_b32 s45, 548864
    buffer_load_dwordx4 v6, s[24:27], s45 offen lds
    s_add_u32 m0, s44, 90624
    s_mov_b32 s45, 786432
    buffer_load_dwordx4 v6, s[24:27], s45 offen lds
    s_add_u32 m0, s44, 91680
    s_mov_b32 s45, 794624
    buffer_load_dwordx4 v6, s[24:27], s45 offen lds
    s_add_u32 m0, s44, 92736
    s_mov_b32 s45, 802816
    buffer_load_dwordx4 v6, s[24:27], s45 offen lds
    s_add_u32 m0, s44, 93792
    s_mov_b32 s45, 811008
    buffer_load_dwordx4 v6, s[24:27], s45 offen lds
    s_mov_b64 exec, 0
    s_cmp_eq_u32 s51, 0
    s_cbranch_scc1 L2_pad0
    s_cmp_eq_u32 s51, 1
    s_cbranch_scc1 L2_pad1
    s_cmp_eq_u32 s51, 2
    s_cbranch_scc1 L2_pad2
    s_branch L2_pad3
.p2align 12
L2_walkret:
    s_mov_b64 exec, 15
    s_mov_b32 s97, 0x20000
L2_px:
    buffer_load_dword v13, v163, s[84:87], s59 offen sc1
    s_waitcnt vmcnt(0)
    v_cmp_eq_u32 vcc, 0, v13
    s_sub_u32 s97, s97, 1
    s_cselect_b64 vcc, 0, vcc
    s_cmp_eq_u64 vcc, 0
    s_cbranch_scc1 L2_px_ok
    s_sleep 1
    s_branch L2_px
L2_px_ok:
    v_cmp_ne_u32 vcc, v13, v165
    s_mov_b64 exec, -1
    s_cmp_lg_u64 vcc, 0
    s_cselect_b64 s[100:101], -1, 0
    s_movk_i32 s14, 13824
    buffer_load_dwordx4 v[168:171], v166, s[84:87], 0 offen sc1
    buffer_load_dwordx4 v[176:179], v166, s[84:87], s14 offen sc1
    s_mov_b64 exec, 0xff
    buffer_load_dwordx4 v[172:175], v166, s[84:87], 0 offen offset:1024 sc1
    buffer_load_dwordx4 v[180:183], v166, s[84:87], s14 offen offset:1024 sc1
    s_mov_b64 exec, -1
    s_mov_b32 s54, 0
    buffer_load_dwordx4 v[80:83], v8, s[32:35], s54 offen sc1
    s_mov_b32 s54, 1024
    buffer_load_dwordx4 v[84:87], v8, s[32:35], s54 offen sc1
    s_mov_b32 s54, 18432
    buffer_load_dwordx4 v[88:91], v8, s[32:35], s54 offen sc1
    s_mov_b32 s54, 19456
    buffer_load_dwordx4 v[92:95], v8, s[32:35], s54 offen sc1
    s_mov_b32 s54, 2048
    buffer_load_dwordx4 v[96:99], v8, s[32:35], s54 offen sc1
    s_mov_b32 s54, 3072
    buffer_load_dwordx4 v[100:103], v8, s[32:35], s54 offen sc1
    s_mov_b32 s54, 20480
    buffer_load_dwordx4 v[104:107], v8, s[32:35], s54 offen sc1
    s_mov_b32 s54, 21504
    buffer_load_dwordx4 v[108:111], v8, s[32:35], s54 offen sc1
    s_waitcnt vmcnt(8)
    v_max_u32 v13, v168, v169
    v_max3_u32 v13, v13, v170, v171
    v_max3_u32 v13, v13, v172, v173
    v_max3_u32 v13, v13, v174, v175
    v_max3_u32 v13, v13, v176, v177
    v_max3_u32 v13, v13, v178, v179
    v_max3_u32 v13, v13, v180, v181
    v_max3_u32 v13, v13, v182, v183
    v_cmp_eq_u32 vcc, -1, v13
    s_nop 0
    s_cmp_lg_u64 vcc, 0
    s_cbranch_scc1 L2_pms
L2_pmr:
    v_pk_add_f32 v[168:169], v[168:169], v[176:177]
    v_pk_add_f32 v[170:171], v[170:171], v[178:179]
    v_pk_add_f32 v[172:173], v[172:173], v[180:181]
    v_pk_add_f32 v[174:175], v[174:175], v[182:183]
    ds_write_b128 v167, v[168:171]
    s_mov_b64 exec, 0xff
    ds_write_b128 v167, v[172:175] offset:2048
    s_mov_b64 exec, -1
    s_mov_b32 s54, 4096
    buffer_load_dwordx4 v[112:115], v8, s[32:35], s54 offen sc1
    s_mov_b32 s54, 5120
    buffer_load_dwordx4 v[116:119], v8, s[32:35], s54 offen sc1
    s_mov_b32 s54, 22528
    buffer_load_dwordx4 v[120:123], v8, s[32:35], s54 offen sc1
    s_mov_b32 s54, 23552
    buffer_load_dwordx4 v[124:127], v8, s[32:35], s54 offen sc1
    s_waitcnt lgkmcnt(0)
    s_barrier
    ds_read_b128 v[16:19], v9 offset:9216
    ds_read_b128 v[20:23], v9 offset:9248
    ds_read_b128 v[24:27], v9 offset:9232
    ds_read_b128 v[28:31], v9 offset:9264
    s_waitcnt vmcnt(8)
    s_waitcnt lgkmcnt(2)
    v_fma_mix_f32 v32, v80, v16, v20 op_sel:[0,0,0] op_sel_hi:[1,0,0]
    v_fma_mix_f32 v33, v80, v17, v21 op_sel:[1,0,0] op_sel_hi:[1,0,0]
    v_fma_mix_f32 v34, v81, v18, v22 op_sel:[0,0,0] op_sel_hi:[1,0,0]
    v_fma_mix_f32 v35, v81, v19, v23 op_sel:[1,0,0] op_sel_hi:[1,0,0]
    v_cvt_pk_bf16_f32 v80, v32, v33
    v_cvt_pk_bf16_f32 v81, v34, v35
    v_fma_mix_f32 v36, v88, v16, v20 op_sel:[0,0,0] op_sel_hi:[1,0,0]
    v_fma_mix_f32 v37, v88, v17, v21 op_sel:[1,0,0] op_sel_hi:[1,0,0]
    v_fma_mix_f32 v38, v89, v18, v22 op_sel:[0,0,0] op_sel_hi:[1,0,0]
    v_fma_mix_f32 v39, v89, v19, v23 op_sel:[1,0,0] op_sel_hi:[1,0,0]
    v_cvt_pk_bf16_f32 v88, v36, v37
    v_cvt_pk_bf16_f32 v89, v38, v39
    ds_read_b128 v[16:19], v9 offset:9472
    ds_read_b128 v[20:23], v9 offset:9504
    s_waitcnt lgkmcnt(2)
    v_fma_mix_f32 v32, v82, v24, v28 op_sel:[0,0,0] op_sel_hi:[1,0,0]
    v_fma_mix_f32 v33, v82, v25, v29 op_sel:[1,0,0] op_sel_hi:[1,0,0]
    v_fma_mix_f32 v34, v83, v26, v30 op_sel:[0,0,0] op_sel_hi:[1,0,0]
    v_fma_mix_f32 v35, v83, v27, v31 op_sel:[1,0,0] op_sel_hi:[1,0,0]
    v_cvt_pk_bf16_f32 v82, v32, v33
    v_cvt_pk_bf16_f32 v83, v34, v35
    v_fma_mix_f32 v36, v90, v24, v28 op_sel:[0,0,0] op_sel_hi:[1,0,0]
    v_fma_mix_f32 v37, v90, v25, v29 op_sel:[1,0,0] op_sel_hi:[1,0,0]
    v_fma_mix_f32 v38, v91, v26, v30 op_sel:[0,0,0] op_sel_hi:[1,0,0]
    v_fma_mix_f32 v39, v91, v27, v31 op_sel:[1,0,0] op_sel_hi:[1,0,0]
    v_cvt_pk_bf16_f32 v90, v36, v37
    v_cvt_pk_bf16_f32 v91, v38, v39
    ds_read_b128 v[24:27], v9 offset:9488
    ds_read_b128 v[28:31], v9 offset:9520
    s_waitcnt lgkmcnt(2)
    v_fma_mix_f32 v32, v84, v16, v20 op_sel:[0,0,0] op_sel_hi:[1,0,0]
    v_fma_mix_f32 v33, v84, v17, v21 op_sel:[1,0,0] op_sel_hi:[1,0,0]
    v_fma_mix_f32 v34, v85, v18, v22 op_sel:[0,0,0] op_sel_hi:[1,0,0]
    v_fma_mix_f32 v35, v85, v19, v23 op_sel:[1,0,0] op_sel_hi:[1,0,0]
    v_cvt_pk_bf16_f32 v84, v32, v33
    v_cvt_pk_bf16_f32 v85, v34, v35
    v_fma_mix_f32 v36, v92, v16, v20 op_sel:[0,0,0] op_sel_hi:[1,0,0]
    v_fma_mix_f32 v37, v92, v17, v21 op_sel:[1,0,0] op_sel_hi:[1,0,0]
    v_fma_mix_f32 v38, v93, v18, v22 op_sel:[0,0,0] op_sel_hi:[1,0,0]
    v_fma_mix_f32 v39, v93, v19, v23 op_sel:[1,0,0] op_sel_hi:[1,0,0]
    v_cvt_pk_bf16_f32 v92, v36, v37
    v_cvt_pk_bf16_f32 v93, v38, v39
    ds_read_b128 v[16:19], v9 offset:9728
    ds_read_b128 v[20:23], v9 offset:9760
    ds_read_b64_tr_b16 a[192:193], v3 offset:36864
    ds_read_b64_tr_b16 a[194:195], v3 offset:37376
    ds_read_b64_tr_b16 a[196:197], v3 offset:53760
    ds_read_b64_tr_b16 a[198:199], v3 offset:54272
    ds_read_b64_tr_b16 a[200:201], v3 offset:36896
    ds_read_b64_tr_b16 a[202:203], v3 offset:37408
    ds_read_b64_tr_b16 a[204:205], v3 offset:53792
    ds_read_b64_tr_b16 a[206:207], v3 offset:54304
    ds_read_b64_tr_b16 a[208:209], v3 offset:36928
    ds_read_b64_tr_b16 a[210:211], v3 offset:37440
    ds_read_b64_tr_b16 a[212:213], v3 offset:53824
    ds_read_b64_tr_b16 a[214:215], v3 offset:54336
    s_waitcnt lgkmcnt(14)
    v_fma_mix_f32 v32, v86, v24, v28 op_sel:[0,0,0] op_sel_hi:[1,0,0]
    v_fma_mix_f32 v33, v86, v25, v29 op_sel:[1,0,0] op_sel_hi:[1,0,0]
    v_fma_mix_f32 v34, v87, v26, v30 op_sel:[0,0,0] op_sel_hi:[1,0,0]
    v_fma_mix_f32 v35, v87, v27, v31 op_sel:[1,0,0] op_sel_hi:[1,0,0]
    v_cvt_pk_bf16_f32 v86, v32, v33
    v_cvt_pk_bf16_f32 v87, v34, v35
    v_fma_mix_f32 v36, v94, v24, v28 op_sel:[0,0,0] op_sel_hi:[1,0,0]
    v_fma_mix_f32 v37, v94, v25, v29 op_sel:[1,0,0] op_sel_hi:[1,0,0]
    v_fma_mix_f32 v38, v95, v26, v30 op_sel:[0,0,0] op_sel_hi:[1,0,0]
    v_fma_mix_f32 v39, v95, v27, v31 op_sel:[1,0,0] op_sel_hi:[1,0,0]
    v_cvt_pk_bf16_f32 v94, v36, v37
    v_cvt_pk_bf16_f32 v95, v38, v39
    s_waitcnt lgkmcnt(8)
    v_mfma_f32_16x16x32_bf16 v[128:131], a[192:195], v[80:83], 0
    s_waitcnt vmcnt(4)
    ds_read_b64_tr_b16 a[216:217], v3 offset:36960
    ds_read_b128 v[24:27], v9 offset:9744
    v_mfma_f32_16x16x32_bf16 v[128:131], a[196:199], v[84:87], v[128:131]
    ds_read_b64_tr_b16 a[218:219], v3 offset:37472
    ds_read_b64_tr_b16 a[220:221], v3 offset:53856
    v_fma_mix_f32 v32, v96, v16, v20 op_sel:[0,0,0] op_sel_hi:[1,0,0]
    v_mfma_f32_16x16x32_bf16 v[160:163], a[192:195], v[88:91], 0
    s_add_u32 m0, s44, 110592
    ds_read_b64_tr_b16 a[222:223], v3 offset:54368
    ds_read_b128 v[28:31], v9 offset:9776
    v_mfma_f32_16x16x32_bf16 v[160:163], a[196:199], v[92:95], v[160:163]
    s_mov_b32 s45, 1048576
    s_waitcnt lgkmcnt(10)
    buffer_load_dwordx4 v6, s[24:27], s45 offen lds
    v_mfma_f32_16x16x32_bf16 v[132:135], a[200:203], v[80:83], 0
    ds_read_b64_tr_b16 a[224:225], v3 offset:36992
    v_fma_mix_f32 v33, v96, v17, v21 op_sel:[1,0,0] op_sel_hi:[1,0,0]
    v_mfma_f32_16x16x32_bf16 v[132:135], a[204:207], v[84:87], v[132:135]
    ds_read_b64_tr_b16 a[226:227], v3 offset:37504
    ds_read_b64_tr_b16 a[228:229], v3 offset:53888
    v_fma_mix_f32 v34, v97, v18, v22 op_sel:[0,0,0] op_sel_hi:[1,0,0]
    v_mfma_f32_16x16x32_bf16 v[164:167], a[200:203], v[88:91], 0
    s_add_u32 m0, s44, 111648
    ds_read_b64_tr_b16 a[230:231], v3 offset:54400
    v_fma_mix_f32 v35, v97, v19, v23 op_sel:[1,0,0] op_sel_hi:[1,0,0]
    v_mfma_f32_16x16x32_bf16 v[164:167], a[204:207], v[92:95], v[164:167]
    s_mov_b32 s45, 1056768
    s_waitcnt lgkmcnt(10)
    buffer_load_dwordx4 v6, s[24:27], s45 offen lds
    v_mfma_f32_16x16x32_bf16 v[136:139], a[208:211], v[80:83], 0
    ds_read_b64_tr_b16 a[232:233], v3 offset:37024
    v_cvt_pk_bf16_f32 v96, v32, v33
    v_mfma_f32_16x16x32_bf16 v[136:139], a[212:215], v[84:87], v[136:139]
    ds_read_b64_tr_b16 a[234:235], v3 offset:37536
    ds_read_b64_tr_b16 a[236:237], v3 offset:53920
    v_cvt_pk_bf16_f32 v97, v34, v35
    v_mfma_f32_16x16x32_bf16 v[168:171], a[208:211], v[88:91], 0
    s_add_u32 m0, s44, 112704
    ds_read_b64_tr_b16 a[238:239], v3 offset:54432
    v_fma_mix_f32 v36, v104, v16, v20 op_sel:[0,0,0] op_sel_hi:[1,0,0]
    v_mfma_f32_16x16x32_bf16 v[168:171], a[212:215], v[92:95], v[168:171]
    s_mov_b32 s45, 1064960
    s_waitcnt lgkmcnt(9)
    buffer_load_dwordx4 v6, s[24:27], s45 offen lds
    v_fma_mix_f32 v37, v104, v17, v21 op_sel:[1,0,0] op_sel_hi:[1,0,0]
    v_mfma_f32_16x16x32_bf16 v[140:143], a[216:219], v[80:83], 0
    ds_read_b64_tr_b16 a[240:241], v3 offset:37056
    v_fma_mix_f32 v38, v105, v18, v22 op_sel:[0,0,0] op_sel_hi:[1,0,0]
    v_mfma_f32_16x16x32_bf16 v[140:143], a[220:223], v[84:87], v[140:143]
    ds_read_b64_tr_b16 a[242:243], v3 offset:37568
    ds_read_b64_tr_b16 a[244:245], v3 offset:53952
    v_fma_mix_f32 v39, v105, v19, v23 op_sel:[1,0,0] op_sel_hi:[1,0,0]
    v_mfma_f32_16x16x32_bf16 v[172:175], a[216:219], v[88:91], 0
    s_add_u32 m0, s44, 113760
    ds_read_b64_tr_b16 a[246:247], v3 offset:54464
    v_cvt_pk_bf16_f32 v104, v36, v37
    v_mfma_f32_16x16x32_bf16 v[172:175], a[220:223], v[92:95], v[172:175]
    s_mov_b32 s45, 1073152
    s_waitcnt lgkmcnt(8)
    buffer_load_dwordx4 v6, s[24:27], s45 offen lds
    v_cvt_pk_bf16_f32 v105, v38, v39
    v_mfma_f32_16x16x32_bf16 v[144:147], a[224:227], v[80:83], 0
    ds_read_b64_tr_b16 a[248:249], v3 offset:37088
    ds_read_b128 v[16:19], v9 offset:9984
    v_mfma_f32_16x16x32_bf16 v[144:147], a[228:231], v[84:87], v[144:147]
    ds_read_b64_tr_b16 a[250:251], v3 offset:37600
    ds_read_b64_tr_b16 a[252:253], v3 offset:53984
    v_fma_mix_f32 v32, v98, v24, v28 op_sel:[0,0,0] op_sel_hi:[1,0,0]
    v_mfma_f32_16x16x32_bf16 v[176:179], a[224:227], v[88:91], 0
    s_add_u32 m0, s44, 127488
    ds_read_b64_tr_b16 a[254:255], v3 offset:54496
    ds_read_b128 v[20:23], v9 offset:10016
    v_mfma_f32_16x16x32_bf16 v[176:179], a[228:231], v[92:95], v[176:179]
    s_mov_b32 s45, 1310720
    s_waitcnt lgkmcnt(10)
    buffer_load_dwordx4 v6, s[24:27], s45 offen lds
    v_mfma_f32_16x16x32_bf16 v[148:151], a[232:235], v[80:83], 0
    ds_read_b64_tr_b16 a[192:193], v3 offset:37120
    v_fma_mix_f32 v33, v98, v25, v29 op_sel:[1,0,0] op_sel_hi:[1,0,0]
    v_mfma_f32_16x16x32_bf16 v[148:151], a[236:239], v[84:87], v[148:151]
    ds_read_b64_tr_b16 a[194:195], v3 offset:37632
    ds_read_b64_tr_b16 a[196:197], v3 offset:54016
    v_fma_mix_f32 v34, v99, v26, v30 op_sel:[0,0,0] op_sel_hi:[1,0,0]
    v_mfma_f32_16x16x32_bf16 v[180:183], a[232:235], v[88:91], 0
    s_add_u32 m0, s44, 128544
    ds_read_b64_tr_b16 a[198:199], v3 offset:54528
    v_fma_mix_f32 v35, v99, v27, v31 op_sel:[1,0,0] op_sel_hi:[1,0,0]
    v_mfma_f32_16x16x32_bf16 v[180:183], a[236:239], v[92:95], v[180:183]
    s_mov_b32 s45, 1318912
    s_waitcnt lgkmcnt(10)
    buffer_load_dwordx4 v6, s[24:27], s45 offen lds
    v_mfma_f32_16x16x32_bf16 v[152:155], a[240:243], v[80:83], 0
    ds_read_b64_tr_b16 a[200:201], v3 offset:37152
    v_cvt_pk_bf16_f32 v98, v32, v33
    v_mfma_f32_16x16x32_bf16 v[152:155], a[244:247], v[84:87], v[152:155]
    ds_read_b64_tr_b16 a[202:203], v3 offset:37664
    ds_read_b64_tr_b16 a[204:205], v3 offset:54048
    v_cvt_pk_bf16_f32 v99, v34, v35
    v_mfma_f32_16x16x32_bf16 v[184:187], a[240:243], v[88:91], 0
    s_add_u32 m0, s44, 129600
    ds_read_b64_tr_b16 a[206:207], v3 offset:54560
    v_fma_mix_f32 v36, v106, v24, v28 op_sel:[0,0,0] op_sel_hi:[1,0,0]
    v_mfma_f32_16x16x32_bf16 v[184:187], a[244:247], v[92:95], v[184:187]
    s_mov_b32 s45, 1327104
    s_waitcnt lgkmcnt(9)
    buffer_load_dwordx4 v6, s[24:27], s45 offen lds
    v_fma_mix_f32 v37, v106, v25, v29 op_sel:[1,0,0] op_sel_hi:[1,0,0]
    v_mfma_f32_16x16x32_bf16 v[156:159], a[248:251], v[80:83], 0
    ds_read_b64_tr_b16 a[208:209], v3 offset:37184
    v_fma_mix_f32 v38, v107, v26, v30 op_sel:[0,0,0] op_sel_hi:[1,0,0]
    v_mfma_f32_16x16x32_bf16 v[156:159], a[252:255], v[84:87], v[156:159]
    ds_read_b64_tr_b16 a[210:211], v3 offset:37696
    ds_read_b64_tr_b16 a[212:213], v3 offset:54080
    v_fma_mix_f32 v39, v107, v27, v31 op_sel:[1,0,0] op_sel_hi:[1,0,0]
    v_mfma_f32_16x16x32_bf16 v[188:191], a[248:251], v[88:91], 0
    s_add_u32 m0, s44, 130656
    ds_read_b64_tr_b16 a[214:215], v3 offset:54592
    v_cvt_pk_bf16_f32 v106, v36, v37
    v_mfma_f32_16x16x32_bf16 v[188:191], a[252:255], v[92:95], v[188:191]
    s_mov_b32 s45, 1335296
    s_waitcnt lgkmcnt(8)
    buffer_load_dwordx4 v6, s[24:27], s45 offen lds
    v_cvt_pk_bf16_f32 v107, v38, v39
    v_mfma_f32_16x16x32_bf16 v[192:195], a[192:195], v[80:83], 0
    ds_read_b64_tr_b16 a[216:217], v3 offset:37216
    ds_read_b128 v[24:27], v9 offset:10000
    v_mfma_f32_16x16x32_bf16 v[192:195], a[196:199], v[84:87], v[192:195]
    ds_read_b64_tr_b16 a[218:219], v3 offset:37728
    ds_read_b64_tr_b16 a[220:221], v3 offset:54112
    v_fma_mix_f32 v32, v100, v16, v20 op_sel:[0,0,0] op_sel_hi:[1,0,0]
    v_mfma_f32_16x16x32_bf16 v[224:227], a[192:195], v[88:91], 0
    s_mov_b32 s54, 6144
    ds_read_b64_tr_b16 a[222:223], v3 offset:54624
    ds_read_b128 v[28:31], v9 offset:10032
    v_mfma_f32_16x16x32_bf16 v[224:227], a[196:199], v[92:95], v[224:227]
    s_waitcnt lgkmcnt(10)
    buffer_load_dwordx4 v[48:51], v8, s[32:35], s54 offen sc1
    v_mfma_f32_16x16x32_bf16 v[196:199], a[200:203], v[80:83], 0
    ds_read_b64_tr_b16 a[224:225], v3 offset:37248
    v_fma_mix_f32 v33, v100, v17, v21 op_sel:[1,0,0] op_sel_hi:[1,0,0]
    v_mfma_f32_16x16x32_bf16 v[196:199], a[204:207], v[84:87], v[196:199]
    ds_read_b64_tr_b16 a[226:227], v3 offset:37760
    ds_read_b64_tr_b16 a[228:229], v3 offset:54144
    v_fma_mix_f32 v34, v101, v18, v22 op_sel:[0,0,0] op_sel_hi:[1,0,0]
    v_mfma_f32_16x16x32_bf16 v[228:231], a[200:203], v[88:91], 0
    s_mov_b32 s54, 7168
    ds_read_b64_tr_b16 a[230:231], v3 offset:54656
    v_fma_mix_f32 v35, v101, v19, v23 op_sel:[1,0,0] op_sel_hi:[1,0,0]
    v_mfma_f32_16x16x32_bf16 v[228:231], a[204:207], v[92:95], v[228:231]
    s_waitcnt lgkmcnt(10)
    buffer_load_dwordx4 v[52:55], v8, s[32:35], s54 offen sc1
    v_mfma_f32_16x16x32_bf16 v[200:203], a[208:211], v[80:83], 0
    ds_read_b64_tr_b16 a[232:233], v3 offset:37280
    v_cvt_pk_bf16_f32 v100, v32, v33
    v_mfma_f32_16x16x32_bf16 v[200:203], a[212:215], v[84:87], v[200:203]
    ds_read_b64_tr_b16 a[234:235], v3 offset:37792
    ds_read_b64_tr_b16 a[236:237], v3 offset:54176
    v_cvt_pk_bf16_f32 v101, v34, v35
    v_mfma_f32_16x16x32_bf16 v[232:235], a[208:211], v[88:91], 0
    s_mov_b32 s54, 24576
    ds_read_b64_tr_b16 a[238:239], v3 offset:54688
    v_fma_mix_f32 v36, v108, v16, v20 op_sel:[0,0,0] op_sel_hi:[1,0,0]
    v_mfma_f32_16x16x32_bf16 v[232:235], a[212:215], v[92:95], v[232:235]
    s_waitcnt lgkmcnt(9)
    buffer_load_dwordx4 v[56:59], v8, s[32:35], s54 offen sc1
    v_fma_mix_f32 v37, v108, v17, v21 op_sel:[1,0,0] op_sel_hi:[1,0,0]
    v_mfma_f32_16x16x32_bf16 v[204:207], a[216:219], v[80:83], 0
    ds_read_b64_tr_b16 a[240:241], v3 offset:37312
    v_fma_mix_f32 v38, v109, v18, v22 op_sel:[0,0,0] op_sel_hi:[1,0,0]
    v_mfma_f32_16x16x32_bf16 v[204:207], a[220:223], v[84:87], v[204:207]
    ds_read_b64_tr_b16 a[242:243], v3 offset:37824
    ds_read_b64_tr_b16 a[244:245], v3 offset:54208
    v_fma_mix_f32 v39, v109, v19, v23 op_sel:[1,0,0] op_sel_hi:[1,0,0]
    v_mfma_f32_16x16x32_bf16 v[236:239], a[216:219], v[88:91], 0
    s_mov_b32 s54, 25600
    ds_read_b64_tr_b16 a[246:247], v3 offset:54720
    v_cvt_pk_bf16_f32 v108, v36, v37
    v_mfma_f32_16x16x32_bf16 v[236:239], a[220:223], v[92:95], v[236:239]
    s_waitcnt lgkmcnt(8)
    buffer_load_dwordx4 v[60:63], v8, s[32:35], s54 offen sc1
    v_cvt_pk_bf16_f32 v109, v38, v39
    v_mfma_f32_16x16x32_bf16 v[208:211], a[224:227], v[80:83], 0
    ds_read_b64_tr_b16 a[248:249], v3 offset:37344
    ds_read_b128 v[16:19], v9 offset:10240
    v_mfma_f32_16x16x32_bf16 v[208:211], a[228:231], v[84:87], v[208:211]
    ds_read_b64_tr_b16 a[250:251], v3 offset:37856
    ds_read_b128 v[20:23], v9 offset:10272
    v_mfma_f32_16x16x32_bf16 v[240:243], a[224:227], v[88:91], 0
    ds_read_b64_tr_b16 a[252:253], v3 offset:54240
    v_fma_mix_f32 v32, v102, v24, v28 op_sel:[0,0,0] op_sel_hi:[1,0,0]
    v_mfma_f32_16x16x32_bf16 v[240:243], a[228:231], v[92:95], v[240:243]
    s_barrier
    s_waitcnt lgkmcnt(9)
    ds_read_b64_tr_b16 a[254:255], v3 offset:54752
    v_fma_mix_f32 v33, v102, v25, v29 op_sel:[1,0,0] op_sel_hi:[1,0,0]
    v_fma_mix_f32 v34, v103, v26, v30 op_sel:[0,0,0] op_sel_hi:[1,0,0]
    v_mfma_f32_16x16x32_bf16 v[212:215], a[232:235], v[80:83], 0
    ds_read_b64_tr_b16 a[192:193], v4 offset:0
    v_fma_mix_f32 v35, v103, v27, v31 op_sel:[1,0,0] op_sel_hi:[1,0,0]
    v_mfma_f32_16x16x32_bf16 v[212:215], a[236:239], v[84:87], v[212:215]
    ds_read_b64_tr_b16 a[194:195], v4 offset:512
    ds_read_b64_tr_b16 a[196:197], v4 offset:16896
    v_cvt_pk_bf16_f32 v102, v32, v33
    v_mfma_f32_16x16x32_bf16 v[244:247], a[232:235], v[88:91], 0
    s_add_u32 m0, s44, 0
    ds_read_b64_tr_b16 a[198:199], v4 offset:17408
    v_cvt_pk_bf16_f32 v103, v34, v35
    v_mfma_f32_16x16x32_bf16 v[244:247], a[236:239], v[92:95], v[244:247]
    s_mov_b32 s45, 1572864
    s_waitcnt lgkmcnt(10)
    buffer_load_dwordx4 v6, s[24:27], s45 offen lds
    v_mfma_f32_16x16x32_bf16 v[216:219], a[240:243], v[80:83], 0
    ds_read_b64_tr_b16 a[200:201], v4 offset:32
    v_fma_mix_f32 v36, v110, v24, v28 op_sel:[0,0,0] op_sel_hi:[1,0,0]
    v_mfma_f32_16x16x32_bf16 v[216:219], a[244:247], v[84:87], v[216:219]
    ds_read_b64_tr_b16 a[202:203], v4 offset:544
    ds_read_b64_tr_b16 a[204:205], v4 offset:16928
    v_fma_mix_f32 v37, v110, v25, v29 op_sel:[1,0,0] op_sel_hi:[1,0,0]
    v_mfma_f32_16x16x32_bf16 v[248:251], a[240:243], v[88:91], 0
    s_add_u32 m0, s44, 1056
    ds_read_b64_tr_b16 a[206:207], v4 offset:17440
    v_fma_mix_f32 v38, v111, v26, v30 op_sel:[0,0,0] op_sel_hi:[1,0,0]
    v_mfma_f32_16x16x32_bf16 v[248:251], a[244:247], v[92:95], v[248:251]
    s_mov_b32 s45, 1581056
    s_waitcnt lgkmcnt(8)
    buffer_load_dwordx4 v6, s[24:27], s45 offen lds
    v_mfma_f32_16x16x32_bf16 v[220:223], a[248:251], v[80:83], 0
    ds_read_b64_tr_b16 a[208:209], v4 offset:64
    v_fma_mix_f32 v39, v111, v27, v31 op_sel:[1,0,0] op_sel_hi:[1,0,0]
    v_mfma_f32_16x16x32_bf16 v[220:223], a[252:255], v[84:87], v[220:223]
    ds_read_b64_tr_b16 a[210:211], v4 offset:576
    ds_read_b64_tr_b16 a[212:213], v4 offset:16960
    v_cvt_pk_bf16_f32 v110, v36, v37
    v_mfma_f32_16x16x32_bf16 v[252:255], a[248:251], v[88:91], 0
    s_add_u32 m0, s44, 2112
    ds_read_b64_tr_b16 a[214:215], v4 offset:17472
    v_cvt_pk_bf16_f32 v111, v38, v39
    v_mfma_f32_16x16x32_bf16 v[252:255], a[252:255], v[92:95], v[252:255]
    s_mov_b32 s45, 1589248
    s_waitcnt lgkmcnt(8)
    buffer_load_dwordx4 v6, s[24:27], s45 offen lds
    v_mfma_f32_16x16x32_bf16 v[128:131], a[192:195], v[96:99], v[128:131]
    s_waitcnt vmcnt(15)
    ds_read_b64_tr_b16 a[216:217], v4 offset:96
    ds_read_b128 v[24:27], v9 offset:10256
    v_mfma_f32_16x16x32_bf16 v[128:131], a[196:199], v[100:103], v[128:131]
    ds_read_b64_tr_b16 a[218:219], v4 offset:608
    ds_read_b64_tr_b16 a[220:221], v4 offset:16992
    v_fma_mix_f32 v32, v112, v16, v20 op_sel:[0,0,0] op_sel_hi:[1,0,0]
    v_mfma_f32_16x16x32_bf16 v[160:163], a[192:195], v[104:107], v[160:163]
    s_add_u32 m0, s44, 3168
    ds_read_b64_tr_b16 a[222:223], v4 offset:17504
    ds_read_b128 v[28:31], v9 offset:10288
    v_mfma_f32_16x16x32_bf16 v[160:163], a[196:199], v[108:111], v[160:163]
    s_mov_b32 s45, 1597440
    s_waitcnt lgkmcnt(10)
    buffer_load_dwordx4 v6, s[24:27], s45 offen lds
    v_mfma_f32_16x16x32_bf16 v[132:135], a[200:203], v[96:99], v[132:135]
    ds_read_b64_tr_b16 a[224:225], v4 offset:128
    v_fma_mix_f32 v33, v112, v17, v21 op_sel:[1,0,0] op_sel_hi:[1,0,0]
    v_mfma_f32_16x16x32_bf16 v[132:135], a[204:207], v[100:103], v[132:135]
    ds_read_b64_tr_b16 a[226:227], v4 offset:640
    ds_read_b64_tr_b16 a[228:229], v4 offset:17024
    v_fma_mix_f32 v34, v113, v18, v22 op_sel:[0,0,0] op_sel_hi:[1,0,0]
    v_mfma_f32_16x16x32_bf16 v[164:167], a[200:203], v[104:107], v[164:167]
    s_add_u32 m0, s44, 16896
    ds_read_b64_tr_b16 a[230:231], v4 offset:17536
    v_fma_mix_f32 v35, v113, v19, v23 op_sel:[1,0,0] op_sel_hi:[1,0,0]
    v_mfma_f32_16x16x32_bf16 v[164:167], a[204:207], v[108:111], v[164:167]
    s_mov_b32 s45, 1835008
    s_waitcnt lgkmcnt(10)
    buffer_load_dwordx4 v6, s[24:27], s45 offen lds
    v_mfma_f32_16x16x32_bf16 v[136:139], a[208:211], v[96:99], v[136:139]
    ds_read_b64_tr_b16 a[232:233], v4 offset:160
    v_cvt_pk_bf16_f32 v112, v32, v33
    v_mfma_f32_16x16x32_bf16 v[136:139], a[212:215], v[100:103], v[136:139]
    ds_read_b64_tr_b16 a[234:235], v4 offset:672
    ds_read_b64_tr_b16 a[236:237], v4 offset:17056
    v_cvt_pk_bf16_f32 v113, v34, v35
    v_mfma_f32_16x16x32_bf16 v[168:171], a[208:211], v[104:107], v[168:171]
    s_add_u32 m0, s44, 17952
    ds_read_b64_tr_b16 a[238:239], v4 offset:17568
    v_fma_mix_f32 v36, v120, v16, v20 op_sel:[0,0,0] op_sel_hi:[1,0,0]
    v_mfma_f32_16x16x32_bf16 v[168:171], a[212:215], v[108:111], v[168:171]
    s_mov_b32 s45, 1843200
    s_waitcnt lgkmcnt(9)
    buffer_load_dwordx4 v6, s[24:27], s45 offen lds
    v_fma_mix_f32 v37, v120, v17, v21 op_sel:[1,0,0] op_sel_hi:[1,0,0]
    v_mfma_f32_16x16x32_bf16 v[140:143], a[216:219], v[96:99], v[140:143]
    ds_read_b64_tr_b16 a[240:241], v4 offset:192
    v_fma_mix_f32 v38, v121, v18, v22 op_sel:[0,0,0] op_sel_hi:[1,0,0]
    v_mfma_f32_16x16x32_bf16 v[140:143], a[220:223], v[100:103], v[140:143]
    ds_read_b64_tr_b16 a[242:243], v4 offset:704
    ds_read_b64_tr_b16 a[244:245], v4 offset:17088
    v_fma_mix_f32 v39, v121, v19, v23 op_sel:[1,0,0] op_sel_hi:[1,0,0]
    v_mfma_f32_16x16x32_bf16 v[172:175], a[216:219], v[104:107], v[172:175]
    s_add_u32 m0, s44, 19008
    ds_read_b64_tr_b16 a[246:247], v4 offset:17600
    v_cvt_pk_bf16_f32 v120, v36, v37
    v_mfma_f32_16x16x32_bf16 v[172:175], a[220:223], v[108:111], v[172:175]
    s_mov_b32 s45, 1851392
    s_waitcnt lgkmcnt(8)
    buffer_load_dwordx4 v6, s[24:27], s45 offen lds
    v_cvt_pk_bf16_f32 v121, v38, v39
    v_mfma_f32_16x16x32_bf16 v[144:147], a[224:227], v[96:99], v[144:147]
    ds_read_b64_tr_b16 a[248:249], v4 offset:224
    ds_read_b128 v[16:19], v9 offset:10496
    v_mfma_f32_16x16x32_bf16 v[144:147], a[228:231], v[100:103], v[144:147]
    ds_read_b64_tr_b16 a[250:251], v4 offset:736
    ds_read_b64_tr_b16 a[252:253], v4 offset:17120
    v_mfma_f32_16x16x32_bf16 v[176:179], a[224:227], v[104:107], v[176:179]
    s_add_u32 m0, s44, 20064
    ds_read_b64_tr_b16 a[254:255], v4 offset:17632
    ds_read_b128 v[20:23], v9 offset:10528
    v_mfma_f32_16x16x32_bf16 v[176:179], a[228:231], v[108:111], v[176:179]
    s_mov_b32 s45, 1859584
    s_waitcnt lgkmcnt(10)
    buffer_load_dwordx4 v6, s[24:27], s45 offen lds
    v_mfma_f32_16x16x32_bf16 v[148:151], a[232:235], v[96:99], v[148:151]
    ds_read_b64_tr_b16 a[192:193], v4 offset:256
    v_fma_mix_f32 v32, v114, v24, v28 op_sel:[0,0,0] op_sel_hi:[1,0,0]
    v_mfma_f32_16x16x32_bf16 v[148:151], a[236:239], v[100:103], v[148:151]
    ds_read_b64_tr_b16 a[194:195], v4 offset:768
    v_fma_mix_f32 v33, v114, v25, v29 op_sel:[1,0,0] op_sel_hi:[1,0,0]
    v_mfma_f32_16x16x32_bf16 v[180:183], a[232:235], v[104:107], v[180:183]
    ds_read_b64_tr_b16 a[196:197], v4 offset:17152
    v_fma_mix_f32 v34, v115, v26, v30 op_sel:[0,0,0] op_sel_hi:[1,0,0]
    v_mfma_f32_16x16x32_bf16 v[180:183], a[236:239], v[108:111], v[180:183]
    s_waitcnt lgkmcnt(9)
    ds_read_b64_tr_b16 a[198:199], v4 offset:17664
    v_fma_mix_f32 v35, v115, v27, v31 op_sel:[1,0,0] op_sel_hi:[1,0,0]
    v_mfma_f32_16x16x32_bf16 v[152:155], a[240:243], v[96:99], v[152:155]
    ds_read_b64_tr_b16 a[200:201], v4 offset:288
    v_cvt_pk_bf16_f32 v114, v32, v33
    v_mfma_f32_16x16x32_bf16 v[152:155], a[244:247], v[100:103], v[152:155]
    ds_read_b64_tr_b16 a[202:203], v4 offset:800
    v_cvt_pk_bf16_f32 v115, v34, v35
    v_mfma_f32_16x16x32_bf16 v[184:187], a[240:243], v[104:107], v[184:187]
    ds_read_b64_tr_b16 a[204:205], v4 offset:17184
    v_fma_mix_f32 v36, v122, v24, v28 op_sel:[0,0,0] op_sel_hi:[1,0,0]
    v_mfma_f32_16x16x32_bf16 v[184:187], a[244:247], v[108:111], v[184:187]
    s_waitcnt lgkmcnt(8)
    ds_read_b64_tr_b16 a[206:207], v4 offset:17696
    v_fma_mix_f32 v37, v122, v25, v29 op_sel:[1,0,0] op_sel_hi:[1,0,0]
    v_mfma_f32_16x16x32_bf16 v[156:159], a[248:251], v[96:99], v[156:159]
    ds_read_b64_tr_b16 a[208:209], v4 offset:320
    v_fma_mix_f32 v38, v123, v26, v30 op_sel:[0,0,0] op_sel_hi:[1,0,0]
    v_mfma_f32_16x16x32_bf16 v[156:159], a[252:255], v[100:103], v[156:159]
    ds_read_b64_tr_b16 a[210:211], v4 offset:832
    v_fma_mix_f32 v39, v123, v27, v31 op_sel:[1,0,0] op_sel_hi:[1,0,0]
    v_mfma_f32_16x16x32_bf16 v[188:191], a[248:251], v[104:107], v[188:191]
    ds_read_b64_tr_b16 a[212:213], v4 offset:17216
    v_cvt_pk_bf16_f32 v122, v36, v37
    v_mfma_f32_16x16x32_bf16 v[188:191], a[252:255], v[108:111], v[188:191]
    s_waitcnt lgkmcnt(7)
    ds_read_b64_tr_b16 a[214:215], v4 offset:17728
    v_cvt_pk_bf16_f32 v123, v38, v39
    v_mfma_f32_16x16x32_bf16 v[192:195], a[192:195], v[96:99], v[192:195]
    ds_read_b64_tr_b16 a[216:217], v4 offset:352
    ds_read_b128 v[24:27], v9 offset:10512
    v_mfma_f32_16x16x32_bf16 v[192:195], a[196:199], v[100:103], v[192:195]
    ds_read_b64_tr_b16 a[218:219], v4 offset:864
    ds_read_b64_tr_b16 a[220:221], v4 offset:17248
    v_fma_mix_f32 v32, v116, v16, v20 op_sel:[0,0,0] op_sel_hi:[1,0,0]
    v_mfma_f32_16x16x32_bf16 v[224:227], a[192:195], v[104:107], v[224:227]
    s_mov_b32 s54, 8192
    ds_read_b64_tr_b16 a[222:223], v4 offset:17760
    ds_read_b128 v[28:31], v9 offset:10544
    v_mfma_f32_16x16x32_bf16 v[224:227], a[196:199], v[108:111], v[224:227]
    s_waitcnt lgkmcnt(10)
    buffer_load_dwordx4 v[64:67], v8, s[32:35], s54 offen sc1
    v_mfma_f32_16x16x32_bf16 v[196:199], a[200:203], v[96:99], v[196:199]
    ds_read_b64_tr_b16 a[224:225], v4 offset:384
    v_fma_mix_f32 v33, v116, v17, v21 op_sel:[1,0,0] op_sel_hi:[1,0,0]
    v_mfma_f32_16x16x32_bf16 v[196:199], a[204:207], v[100:103], v[196:199]
    ds_read_b64_tr_b16 a[226:227], v4 offset:896
    ds_read_b64_tr_b16 a[228:229], v4 offset:17280
    v_fma_mix_f32 v34, v117, v18, v22 op_sel:[0,0,0] op_sel_hi:[1,0,0]
    v_mfma_f32_16x16x32_bf16 v[228:231], a[200:203], v[104:107], v[228:231]
    s_mov_b32 s54, 9216
    ds_read_b64_tr_b16 a[230:231], v4 offset:17792
    v_fma_mix_f32 v35, v117, v19, v23 op_sel:[1,0,0] op_sel_hi:[1,0,0]
    v_mfma_f32_16x16x32_bf16 v[228:231], a[204:207], v[108:111], v[228:231]
    s_waitcnt lgkmcnt(10)
    buffer_load_dwordx4 v[68:71], v8, s[32:35], s54 offen sc1
    v_mfma_f32_16x16x32_bf16 v[200:203], a[208:211], v[96:99], v[200:203]
    ds_read_b64_tr_b16 a[232:233], v4 offset:416
    v_cvt_pk_bf16_f32 v116, v32, v33
    v_mfma_f32_16x16x32_bf16 v[200:203], a[212:215], v[100:103], v[200:203]
    ds_read_b64_tr_b16 a[234:235], v4 offset:928
    ds_read_b64_tr_b16 a[236:237], v4 offset:17312
    v_cvt_pk_bf16_f32 v117, v34, v35
    v_mfma_f32_16x16x32_bf16 v[232:235], a[208:211], v[104:107], v[232:235]
    s_mov_b32 s54, 26624
    ds_read_b64_tr_b16 a[238:239], v4 offset:17824
    v_fma_mix_f32 v36, v124, v16, v20 op_sel:[0,0,0] op_sel_hi:[1,0,0]
    v_mfma_f32_16x16x32_bf16 v[232:235], a[212:215], v[108:111], v[232:235]
    s_waitcnt lgkmcnt(9)
    buffer_load_dwordx4 v[72:75], v8, s[32:35], s54 offen sc1
    v_fma_mix_f32 v37, v124, v17, v21 op_sel:[1,0,0] op_sel_hi:[1,0,0]
    v_mfma_f32_16x16x32_bf16 v[204:207], a[216:219], v[96:99], v[204:207]
L2_pad0:
    s_cbranch_execz L2_pad4
    ds_read_b64_tr_b16 a[240:241], v4 offset:448
    v_fma_mix_f32 v38, v125, v18, v22 op_sel:[0,0,0] op_sel_hi:[1,0,0]
    v_mfma_f32_16x16x32_bf16 v[204:207], a[220:223], v[100:103], v[204:207]
    ds_read_b64_tr_b16 a[242:243], v4 offset:960
    ds_read_b64_tr_b16 a[244:245], v4 offset:17344
    v_fma_mix_f32 v39, v125, v19, v23 op_sel:[1,0,0] op_sel_hi:[1,0,0]
    v_mfma_f32_16x16x32_bf16 v[236:239], a[216:219], v[104:107], v[236:239]
    s_mov_b32 s54, 27648
    ds_read_b64_tr_b16 a[246:247], v4 offset:17856
    v_cvt_pk_bf16_f32 v124, v36, v37
    v_mfma_f32_16x16x32_bf16 v[236:239], a[220:223], v[108:111], v[236:239]
    s_waitcnt lgkmcnt(8)
    buffer_load_dwordx4 v[76:79], v8, s[32:35], s54 offen sc1
    v_cvt_pk_bf16_f32 v125, v38, v39
    v_mfma_f32_16x16x32_bf16 v[208:211], a[224:227], v[96:99], v[208:211]
    ds_read_b64_tr_b16 a[248:249], v4 offset:480
    ds_read_b128 v[16:19], v9 offset:10752
    v_mfma_f32_16x16x32_bf16 v[208:211], a[228:231], v[100:103], v[208:211]
    ds_read_b64_tr_b16 a[250:251], v4 offset:992
    ds_read_b128 v[20:23], v9 offset:10784
    v_mfma_f32_16x16x32_bf16 v[240:243], a[224:227], v[104:107], v[240:243]
    ds_read_b64_tr_b16 a[252:253], v4 offset:17376
    v_fma_mix_f32 v32, v118, v24, v28 op_sel:[0,0,0] op_sel_hi:[1,0,0]
    v_mfma_f32_16x16x32_bf16 v[240:243], a[228:231], v[108:111], v[240:243]
    s_waitcnt vmcnt(16)
    s_barrier
    s_waitcnt lgkmcnt(9)
    ds_read_b64_tr_b16 a[254:255], v4 offset:17888
    v_fma_mix_f32 v33, v118, v25, v29 op_sel:[1,0,0] op_sel_hi:[1,0,0]
    v_fma_mix_f32 v34, v119, v26, v30 op_sel:[0,0,0] op_sel_hi:[1,0,0]
    v_mfma_f32_16x16x32_bf16 v[212:215], a[232:235], v[96:99], v[212:215]
    ds_read_b64_tr_b16 a[192:193], v4 offset:36864
    v_fma_mix_f32 v35, v119, v27, v31 op_sel:[1,0,0] op_sel_hi:[1,0,0]
    v_mfma_f32_16x16x32_bf16 v[212:215], a[236:239], v[100:103], v[212:215]
    ds_read_b64_tr_b16 a[194:195], v4 offset:37376
    ds_read_b64_tr_b16 a[196:197], v4 offset:53760
    v_cvt_pk_bf16_f32 v118, v32, v33
    v_mfma_f32_16x16x32_bf16 v[244:247], a[232:235], v[104:107], v[244:247]
    s_add_u32 m0, s44, 36864
    ds_read_b64_tr_b16 a[198:199], v4 offset:54272
    v_cvt_pk_bf16_f32 v119, v34, v35
    v_mfma_f32_16x16x32_bf16 v[244:247], a[236:239], v[108:111], v[244:247]
    s_mov_b32 s45, 2097152
    s_waitcnt lgkmcnt(10)
    buffer_load_dwordx4 v6, s[24:27], s45 offen lds
    v_mfma_f32_16x16x32_bf16 v[216:219], a[240:243], v[96:99], v[216:219]
    ds_read_b64_tr_b16 a[200:201], v4 offset:36896
    v_fma_mix_f32 v36, v126, v24, v28 op_sel:[0,0,0] op_sel_hi:[1,0,0]
    v_mfma_f32_16x16x32_bf16 v[216:219], a[244:247], v[100:103], v[216:219]
    ds_read_b64_tr_b16 a[202:203], v4 offset:37408
    ds_read_b64_tr_b16 a[204:205], v4 offset:53792
    v_fma_mix_f32 v37, v126, v25, v29 op_sel:[1,0,0] op_sel_hi:[1,0,0]
    v_mfma_f32_16x16x32_bf16 v[248:251], a[240:243], v[104:107], v[248:251]
    s_add_u32 m0, s44, 37920
    ds_read_b64_tr_b16 a[206:207], v4 offset:54304
    v_fma_mix_f32 v38, v127, v26, v30 op_sel:[0,0,0] op_sel_hi:[1,0,0]
    v_mfma_f32_16x16x32_bf16 v[248:251], a[244:247], v[108:111], v[248:251]
    s_mov_b32 s45, 2105344
    s_waitcnt lgkmcnt(8)
    buffer_load_dwordx4 v6, s[24:27], s45 offen lds
    v_mfma_f32_16x16x32_bf16 v[220:223], a[248:251], v[96:99], v[220:223]
    ds_read_b64_tr_b16 a[208:209], v4 offset:36928
    v_fma_mix_f32 v39, v127, v27, v31 op_sel:[1,0,0] op_sel_hi:[1,0,0]
    v_mfma_f32_16x16x32_bf16 v[220:223], a[252:255], v[100:103], v[220:223]
    ds_read_b64_tr_b16 a[210:211], v4 offset:37440
    ds_read_b64_tr_b16 a[212:213], v4 offset:53824
    v_cvt_pk_bf16_f32 v126, v36, v37
    v_mfma_f32_16x16x32_bf16 v[252:255], a[248:251], v[104:107], v[252:255]
    s_add_u32 m0, s44, 38976
    ds_read_b64_tr_b16 a[214:215], v4 offset:54336
    v_cvt_pk_bf16_f32 v127, v38, v39
    v_mfma_f32_16x16x32_bf16 v[252:255], a[252:255], v[108:111], v[252:255]
    s_mov_b32 s45, 2113536
    s_waitcnt lgkmcnt(8)
    buffer_load_dwordx4 v6, s[24:27], s45 offen lds
    v_mfma_f32_16x16x32_bf16 v[128:131], a[192:195], v[112:115], v[128:131]
    s_waitcnt vmcnt(15)
    ds_read_b64_tr_b16 a[216:217], v4 offset:36960
    ds_read_b128 v[24:27], v9 offset:10768
    v_mfma_f32_16x16x32_bf16 v[128:131], a[196:199], v[116:119], v[128:131]
    ds_read_b64_tr_b16 a[218:219], v4 offset:37472
    ds_read_b64_tr_b16 a[220:221], v4 offset:53856
    v_fma_mix_f32 v32, v48, v16, v20 op_sel:[0,0,0] op_sel_hi:[1,0,0]
    v_mfma_f32_16x16x32_bf16 v[160:163], a[192:195], v[120:123], v[160:163]
    s_add_u32 m0, s44, 40032
    ds_read_b64_tr_b16 a[222:223], v4 offset:54368
    ds_read_b128 v[28:31], v9 offset:10800
    v_mfma_f32_16x16x32_bf16 v[160:163], a[196:199], v[124:127], v[160:163]
    s_mov_b32 s45, 2121728
    s_waitcnt lgkmcnt(10)
    buffer_load_dwordx4 v6, s[24:27], s45 offen lds
    v_mfma_f32_16x16x32_bf16 v[132:135], a[200:203], v[112:115], v[132:135]
    ds_read_b64_tr_b16 a[224:225], v4 offset:36992
    v_fma_mix_f32 v33, v48, v17, v21 op_sel:[1,0,0] op_sel_hi:[1,0,0]
    v_mfma_f32_16x16x32_bf16 v[132:135], a[204:207], v[116:119], v[132:135]
    ds_read_b64_tr_b16 a[226:227], v4 offset:37504
    ds_read_b64_tr_b16 a[228:229], v4 offset:53888
    v_fma_mix_f32 v34, v49, v18, v22 op_sel:[0,0,0] op_sel_hi:[1,0,0]
    v_mfma_f32_16x16x32_bf16 v[164:167], a[200:203], v[120:123], v[164:167]
    s_add_u32 m0, s44, 53760
    ds_read_b64_tr_b16 a[230:231], v4 offset:54400
    v_fma_mix_f32 v35, v49, v19, v23 op_sel:[1,0,0] op_sel_hi:[1,0,0]
    v_mfma_f32_16x16x32_bf16 v[164:167], a[204:207], v[124:127], v[164:167]
    s_mov_b32 s45, 2359296
    s_waitcnt lgkmcnt(10)
    buffer_load_dwordx4 v6, s[24:27], s45 offen lds
    v_mfma_f32_16x16x32_bf16 v[136:139], a[208:211], v[112:115], v[136:139]
    ds_read_b64_tr_b16 a[232:233], v4 offset:37024
    v_cvt_pk_bf16_f32 v48, v32, v33
    v_mfma_f32_16x16x32_bf16 v[136:139], a[212:215], v[116:119], v[136:139]
    ds_read_b64_tr_b16 a[234:235], v4 offset:37536
    ds_read_b64_tr_b16 a[236:237], v4 offset:53920
    v_cvt_pk_bf16_f32 v49, v34, v35
    v_mfma_f32_16x16x32_bf16 v[168:171], a[208:211], v[120:123], v[168:171]
    s_add_u32 m0, s44, 54816
    ds_read_b64_tr_b16 a[238:239], v4 offset:54432
    v_fma_mix_f32 v36, v56, v16, v20 op_sel:[0,0,0] op_sel_hi:[1,0,0]
    v_mfma_f32_16x16x32_bf16 v[168:171], a[212:215], v[124:127], v[168:171]
    s_mov_b32 s45, 2367488
    s_waitcnt lgkmcnt(9)
    buffer_load_dwordx4 v6, s[24:27], s45 offen lds
    v_fma_mix_f32 v37, v56, v17, v21 op_sel:[1,0,0] op_sel_hi:[1,0,0]
    v_mfma_f32_16x16x32_bf16 v[140:143], a[216:219], v[112:115], v[140:143]
    ds_read_b64_tr_b16 a[240:241], v4 offset:37056
    v_fma_mix_f32 v38, v57, v18, v22 op_sel:[0,0,0] op_sel_hi:[1,0,0]
    v_mfma_f32_16x16x32_bf16 v[140:143], a[220:223], v[116:119], v[140:143]
    ds_read_b64_tr_b16 a[242:243], v4 offset:37568
    ds_read_b64_tr_b16 a[244:245], v4 offset:53952
    v_fma_mix_f32 v39, v57, v19, v23 op_sel:[1,0,0] op_sel_hi:[1,0,0]
    v_mfma_f32_16x16x32_bf16 v[172:175], a[216:219], v[120:123], v[172:175]
    s_add_u32 m0, s44, 55872
    ds_read_b64_tr_b16 a[246:247], v4 offset:54464
    v_cvt_pk_bf16_f32 v56, v36, v37
    v_mfma_f32_16x16x32_bf16 v[172:175], a[220:223], v[124:127], v[172:175]
    s_mov_b32 s45, 2375680
    s_waitcnt lgkmcnt(8)
    buffer_load_dwordx4 v6, s[24:27], s45 offen lds
    v_cvt_pk_bf16_f32 v57, v38, v39
    v_mfma_f32_16x16x32_bf16 v[144:147], a[224:227], v[112:115], v[144:147]
    ds_read_b64_tr_b16 a[248:249], v4 offset:37088
    ds_read_b128 v[16:19], v9 offset:11008
    v_mfma_f32_16x16x32_bf16 v[144:147], a[228:231], v[116:119], v[144:147]
    ds_read_b64_tr_b16 a[250:251], v4 offset:37600
    ds_read_b64_tr_b16 a[252:253], v4 offset:53984
    v_mfma_f32_16x16x32_bf16 v[176:179], a[224:227], v[120:123], v[176:179]
    s_add_u32 m0, s44, 56928
    ds_read_b64_tr_b16 a[254:255], v4 offset:54496
    ds_read_b128 v[20:23], v9 offset:11040
    v_mfma_f32_16x16x32_bf16 v[176:179], a[228:231], v[124:127], v[176:179]
    s_mov_b32 s45, 2383872
    s_waitcnt lgkmcnt(10)
    buffer_load_dwordx4 v6, s[24:27], s45 offen lds
    v_mfma_f32_16x16x32_bf16 v[148:151], a[232:235], v[112:115], v[148:151]
    ds_read_b64_tr_b16 a[192:193], v4 offset:37120
    v_fma_mix_f32 v32, v50, v24, v28 op_sel:[0,0,0] op_sel_hi:[1,0,0]
    v_mfma_f32_16x16x32_bf16 v[148:151], a[236:239], v[116:119], v[148:151]
    ds_read_b64_tr_b16 a[194:195], v4 offset:37632
    v_fma_mix_f32 v33, v50, v25, v29 op_sel:[1,0,0] op_sel_hi:[1,0,0]
    v_mfma_f32_16x16x32_bf16 v[180:183], a[232:235], v[120:123], v[180:183]
    ds_read_b64_tr_b16 a[196:197], v4 offset:54016
    v_fma_mix_f32 v34, v51, v26, v30 op_sel:[0,0,0] op_sel_hi:[1,0,0]
    v_mfma_f32_16x16x32_bf16 v[180:183], a[236:239], v[124:127], v[180:183]
    s_waitcnt lgkmcnt(9)
    ds_read_b64_tr_b16 a[198:199], v4 offset:54528
    v_fma_mix_f32 v35, v51, v27, v31 op_sel:[1,0,0] op_sel_hi:[1,0,0]
    v_mfma_f32_16x16x32_bf16 v[152:155], a[240:243], v[112:115], v[152:155]
    ds_read_b64_tr_b16 a[200:201], v4 offset:37152
    v_cvt_pk_bf16_f32 v50, v32, v33
    v_mfma_f32_16x16x32_bf16 v[152:155], a[244:247], v[116:119], v[152:155]
    ds_read_b64_tr_b16 a[202:203], v4 offset:37664
    v_cvt_pk_bf16_f32 v51, v34, v35
    v_mfma_f32_16x16x32_bf16 v[184:187], a[240:243], v[120:123], v[184:187]
    ds_read_b64_tr_b16 a[204:205], v4 offset:54048
    v_fma_mix_f32 v36, v58, v24, v28 op_sel:[0,0,0] op_sel_hi:[1,0,0]
    v_mfma_f32_16x16x32_bf16 v[184:187], a[244:247], v[124:127], v[184:187]
    s_waitcnt lgkmcnt(8)
    ds_read_b64_tr_b16 a[206:207], v4 offset:54560
    v_fma_mix_f32 v37, v58, v25, v29 op_sel:[1,0,0] op_sel_hi:[1,0,0]
    v_mfma_f32_16x16x32_bf16 v[156:159], a[248:251], v[112:115], v[156:159]
    ds_read_b64_tr_b16 a[208:209], v4 offset:37184
    v_fma_mix_f32 v38, v59, v26, v30 op_sel:[0,0,0] op_sel_hi:[1,0,0]
    v_mfma_f32_16x16x32_bf16 v[156:159], a[252:255], v[116:119], v[156:159]
    ds_read_b64_tr_b16 a[210:211], v4 offset:37696
    v_fma_mix_f32 v39, v59, v27, v31 op_sel:[1,0,0] op_sel_hi:[1,0,0]
    v_mfma_f32_16x16x32_bf16 v[188:191], a[248:251], v[120:123], v[188:191]
    ds_read_b64_tr_b16 a[212:213], v4 offset:54080
    v_cvt_pk_bf16_f32 v58, v36, v37
    v_mfma_f32_16x16x32_bf16 v[188:191], a[252:255], v[124:127], v[188:191]
    s_waitcnt lgkmcnt(7)
    ds_read_b64_tr_b16 a[214:215], v4 offset:54592
    v_cvt_pk_bf16_f32 v59, v38, v39
    v_mfma_f32_16x16x32_bf16 v[192:195], a[192:195], v[112:115], v[192:195]
    ds_read_b64_tr_b16 a[216:217], v4 offset:37216
    ds_read_b128 v[24:27], v9 offset:11024
    v_mfma_f32_16x16x32_bf16 v[192:195], a[196:199], v[116:119], v[192:195]
    ds_read_b64_tr_b16 a[218:219], v4 offset:37728
    ds_read_b64_tr_b16 a[220:221], v4 offset:54112
    v_fma_mix_f32 v32, v52, v16, v20 op_sel:[0,0,0] op_sel_hi:[1,0,0]
    v_mfma_f32_16x16x32_bf16 v[224:227], a[192:195], v[120:123], v[224:227]
    s_mov_b32 s54, 10240
    ds_read_b64_tr_b16 a[222:223], v4 offset:54624
    ds_read_b128 v[28:31], v9 offset:11056
    v_mfma_f32_16x16x32_bf16 v[224:227], a[196:199], v[124:127], v[224:227]
    s_waitcnt lgkmcnt(10)
    buffer_load_dwordx4 v[80:83], v8, s[32:35], s54 offen sc1
    v_mfma_f32_16x16x32_bf16 v[196:199], a[200:203], v[112:115], v[196:199]
    ds_read_b64_tr_b16 a[224:225], v4 offset:37248
    v_fma_mix_f32 v33, v52, v17, v21 op_sel:[1,0,0] op_sel_hi:[1,0,0]
    v_mfma_f32_16x16x32_bf16 v[196:199], a[204:207], v[116:119], v[196:199]
    ds_read_b64_tr_b16 a[226:227], v4 offset:37760
    ds_read_b64_tr_b16 a[228:229], v4 offset:54144
    v_fma_mix_f32 v34, v53, v18, v22 op_sel:[0,0,0] op_sel_hi:[1,0,0]
    v_mfma_f32_16x16x32_bf16 v[228:231], a[200:203], v[120:123], v[228:231]
    s_mov_b32 s54, 11264
    ds_read_b64_tr_b16 a[230:231], v4 offset:54656
    v_fma_mix_f32 v35, v53, v19, v23 op_sel:[1,0,0] op_sel_hi:[1,0,0]
    v_mfma_f32_16x16x32_bf16 v[228:231], a[204:207], v[124:127], v[228:231]
    s_waitcnt lgkmcnt(10)
    buffer_load_dwordx4 v[84:87], v8, s[32:35], s54 offen sc1
    v_mfma_f32_16x16x32_bf16 v[200:203], a[208:211], v[112:115], v[200:203]
    ds_read_b64_tr_b16 a[232:233], v4 offset:37280
    v_cvt_pk_bf16_f32 v52, v32, v33
    v_mfma_f32_16x16x32_bf16 v[200:203], a[212:215], v[116:119], v[200:203]
    ds_read_b64_tr_b16 a[234:235], v4 offset:37792
    ds_read_b64_tr_b16 a[236:237], v4 offset:54176
    v_cvt_pk_bf16_f32 v53, v34, v35
    v_mfma_f32_16x16x32_bf16 v[232:235], a[208:211], v[120:123], v[232:235]
    s_mov_b32 s54, 28672
    ds_read_b64_tr_b16 a[238:239], v4 offset:54688
    v_fma_mix_f32 v36, v60, v16, v20 op_sel:[0,0,0] op_sel_hi:[1,0,0]
    v_mfma_f32_16x16x32_bf16 v[232:235], a[212:215], v[124:127], v[232:235]
    s_waitcnt lgkmcnt(9)
    buffer_load_dwordx4 v[88:91], v8, s[32:35], s54 offen sc1
    v_fma_mix_f32 v37, v60, v17, v21 op_sel:[1,0,0] op_sel_hi:[1,0,0]
    v_mfma_f32_16x16x32_bf16 v[204:207], a[216:219], v[112:115], v[204:207]
    ds_read_b64_tr_b16 a[240:241], v4 offset:37312
    v_fma_mix_f32 v38, v61, v18, v22 op_sel:[0,0,0] op_sel_hi:[1,0,0]
    v_mfma_f32_16x16x32_bf16 v[204:207], a[220:223], v[116:119], v[204:207]
    ds_read_b64_tr_b16 a[242:243], v4 offset:37824
    ds_read_b64_tr_b16 a[244:245], v4 offset:54208
    v_fma_mix_f32 v39, v61, v19, v23 op_sel:[1,0,0] op_sel_hi:[1,0,0]
    v_mfma_f32_16x16x32_bf16 v[236:239], a[216:219], v[120:123], v[236:239]
    s_mov_b32 s54, 29696
    ds_read_b64_tr_b16 a[246:247], v4 offset:54720
    v_cvt_pk_bf16_f32 v60, v36, v37
    v_mfma_f32_16x16x32_bf16 v[236:239], a[220:223], v[124:127], v[236:239]
    s_waitcnt lgkmcnt(8)
    buffer_load_dwordx4 v[92:95], v8, s[32:35], s54 offen sc1
    v_cvt_pk_bf16_f32 v61, v38, v39
    v_mfma_f32_16x16x32_bf16 v[208:211], a[224:227], v[112:115], v[208:211]
    ds_read_b64_tr_b16 a[248:249], v4 offset:37344
    ds_read_b128 v[16:19], v9 offset:11264
    v_mfma_f32_16x16x32_bf16 v[208:211], a[228:231], v[116:119], v[208:211]
    ds_read_b64_tr_b16 a[250:251], v4 offset:37856
    ds_read_b128 v[20:23], v9 offset:11296
    v_mfma_f32_16x16x32_bf16 v[240:243], a[224:227], v[120:123], v[240:243]
    ds_read_b64_tr_b16 a[252:253], v4 offset:54240
    v_fma_mix_f32 v32, v54, v24, v28 op_sel:[0,0,0] op_sel_hi:[1,0,0]
    v_mfma_f32_16x16x32_bf16 v[240:243], a[228:231], v[124:127], v[240:243]
    s_waitcnt vmcnt(16)
    s_barrier
    s_waitcnt lgkmcnt(9)
    ds_read_b64_tr_b16 a[254:255], v4 offset:54752
    v_fma_mix_f32 v33, v54, v25, v29 op_sel:[1,0,0] op_sel_hi:[1,0,0]
    v_fma_mix_f32 v34, v55, v26, v30 op_sel:[0,0,0] op_sel_hi:[1,0,0]
    v_mfma_f32_16x16x32_bf16 v[212:215], a[232:235], v[112:115], v[212:215]
    ds_read_b64_tr_b16 a[192:193], v3 offset:0
    v_fma_mix_f32 v35, v55, v27, v31 op_sel:[1,0,0] op_sel_hi:[1,0,0]
    v_mfma_f32_16x16x32_bf16 v[212:215], a[236:239], v[116:119], v[212:215]
    ds_read_b64_tr_b16 a[194:195], v3 offset:512
    ds_read_b64_tr_b16 a[196:197], v3 offset:16896
    v_cvt_pk_bf16_f32 v54, v32, v33
    v_mfma_f32_16x16x32_bf16 v[244:247], a[232:235], v[120:123], v[244:247]
    s_add_u32 m0, s44, 73728
    ds_read_b64_tr_b16 a[198:199], v3 offset:17408
    v_cvt_pk_bf16_f32 v55, v34, v35
    v_mfma_f32_16x16x32_bf16 v[244:247], a[236:239], v[124:127], v[244:247]
    s_mov_b32 s45, 2621440
    s_waitcnt lgkmcnt(10)
    buffer_load_dwordx4 v6, s[24:27], s45 offen lds
    v_mfma_f32_16x16x32_bf16 v[216:219], a[240:243], v[112:115], v[216:219]
    ds_read_b64_tr_b16 a[200:201], v3 offset:32
    v_fma_mix_f32 v36, v62, v24, v28 op_sel:[0,0,0] op_sel_hi:[1,0,0]
    v_mfma_f32_16x16x32_bf16 v[216:219], a[244:247], v[116:119], v[216:219]
    ds_read_b64_tr_b16 a[202:203], v3 offset:544
    ds_read_b64_tr_b16 a[204:205], v3 offset:16928
    v_fma_mix_f32 v37, v62, v25, v29 op_sel:[1,0,0] op_sel_hi:[1,0,0]
    v_mfma_f32_16x16x32_bf16 v[248:251], a[240:243], v[120:123], v[248:251]
    s_add_u32 m0, s44, 74784
    ds_read_b64_tr_b16 a[206:207], v3 offset:17440
    v_fma_mix_f32 v38, v63, v26, v30 op_sel:[0,0,0] op_sel_hi:[1,0,0]
    v_mfma_f32_16x16x32_bf16 v[248:251], a[244:247], v[124:127], v[248:251]
    s_mov_b32 s45, 2629632
    s_waitcnt lgkmcnt(8)
    buffer_load_dwordx4 v6, s[24:27], s45 offen lds
    v_mfma_f32_16x16x32_bf16 v[220:223], a[248:251], v[112:115], v[220:223]
    ds_read_b64_tr_b16 a[208:209], v3 offset:64
    v_fma_mix_f32 v39, v63, v27, v31 op_sel:[1,0,0] op_sel_hi:[1,0,0]
    v_mfma_f32_16x16x32_bf16 v[220:223], a[252:255], v[116:119], v[220:223]
    ds_read_b64_tr_b16 a[210:211], v3 offset:576
    ds_read_b64_tr_b16 a[212:213], v3 offset:16960
    v_cvt_pk_bf16_f32 v62, v36, v37
    v_mfma_f32_16x16x32_bf16 v[252:255], a[248:251], v[120:123], v[252:255]
    s_add_u32 m0, s44, 75840
    ds_read_b64_tr_b16 a[214:215], v3 offset:17472
    v_cvt_pk_bf16_f32 v63, v38, v39
    v_mfma_f32_16x16x32_bf16 v[252:255], a[252:255], v[124:127], v[252:255]
    s_mov_b32 s45, 2637824
    s_waitcnt lgkmcnt(8)
    buffer_load_dwordx4 v6, s[24:27], s45 offen lds
    v_mfma_f32_16x16x32_bf16 v[128:131], a[192:195], v[48:51], v[128:131]
    s_waitcnt vmcnt(15)
    ds_read_b64_tr_b16 a[216:217], v3 offset:96
    ds_read_b128 v[24:27], v9 offset:11280
    v_mfma_f32_16x16x32_bf16 v[128:131], a[196:199], v[52:55], v[128:131]
    ds_read_b64_tr_b16 a[218:219], v3 offset:608
    ds_read_b64_tr_b16 a[220:221], v3 offset:16992
    v_fma_mix_f32 v32, v64, v16, v20 op_sel:[0,0,0] op_sel_hi:[1,0,0]
    v_mfma_f32_16x16x32_bf16 v[160:163], a[192:195], v[56:59], v[160:163]
    s_add_u32 m0, s44, 76896
    ds_read_b64_tr_b16 a[222:223], v3 offset:17504
    ds_read_b128 v[28:31], v9 offset:11312
    v_mfma_f32_16x16x32_bf16 v[160:163], a[196:199], v[60:63], v[160:163]
    s_mov_b32 s45, 2646016
    s_waitcnt lgkmcnt(10)
    buffer_load_dwordx4 v6, s[24:27], s45 offen lds
    v_mfma_f32_16x16x32_bf16 v[132:135], a[200:203], v[48:51], v[132:135]
    ds_read_b64_tr_b16 a[224:225], v3 offset:128
    v_fma_mix_f32 v33, v64, v17, v21 op_sel:[1,0,0] op_sel_hi:[1,0,0]
    v_mfma_f32_16x16x32_bf16 v[132:135], a[204:207], v[52:55], v[132:135]
    ds_read_b64_tr_b16 a[226:227], v3 offset:640
    ds_read_b64_tr_b16 a[228:229], v3 offset:17024
    v_fma_mix_f32 v34, v65, v18, v22 op_sel:[0,0,0] op_sel_hi:[1,0,0]
    v_mfma_f32_16x16x32_bf16 v[164:167], a[200:203], v[56:59], v[164:167]
    s_add_u32 m0, s44, 90624
    ds_read_b64_tr_b16 a[230:231], v3 offset:17536
    v_fma_mix_f32 v35, v65, v19, v23 op_sel:[1,0,0] op_sel_hi:[1,0,0]
    v_mfma_f32_16x16x32_bf16 v[164:167], a[204:207], v[60:63], v[164:167]
    s_mov_b32 s45, 2883584
    s_waitcnt lgkmcnt(10)
    buffer_load_dwordx4 v6, s[24:27], s45 offen lds
    v_mfma_f32_16x16x32_bf16 v[136:139], a[208:211], v[48:51], v[136:139]
    ds_read_b64_tr_b16 a[232:233], v3 offset:160
    v_cvt_pk_bf16_f32 v64, v32, v33
    v_mfma_f32_16x16x32_bf16 v[136:139], a[212:215], v[52:55], v[136:139]
    ds_read_b64_tr_b16 a[234:235], v3 offset:672
    ds_read_b64_tr_b16 a[236:237], v3 offset:17056
    v_cvt_pk_bf16_f32 v65, v34, v35
    v_mfma_f32_16x16x32_bf16 v[168:171], a[208:211], v[56:59], v[168:171]
    s_add_u32 m0, s44, 91680
    ds_read_b64_tr_b16 a[238:239], v3 offset:17568
    v_fma_mix_f32 v36, v72, v16, v20 op_sel:[0,0,0] op_sel_hi:[1,0,0]
    v_mfma_f32_16x16x32_bf16 v[168:171], a[212:215], v[60:63], v[168:171]
    s_mov_b32 s45, 2891776
    s_waitcnt lgkmcnt(9)
    buffer_load_dwordx4 v6, s[24:27], s45 offen lds
    v_fma_mix_f32 v37, v72, v17, v21 op_sel:[1,0,0] op_sel_hi:[1,0,0]
    v_mfma_f32_16x16x32_bf16 v[140:143], a[216:219], v[48:51], v[140:143]
    ds_read_b64_tr_b16 a[240:241], v3 offset:192
    v_fma_mix_f32 v38, v73, v18, v22 op_sel:[0,0,0] op_sel_hi:[1,0,0]
    v_mfma_f32_16x16x32_bf16 v[140:143], a[220:223], v[52:55], v[140:143]
    ds_read_b64_tr_b16 a[242:243], v3 offset:704
    ds_read_b64_tr_b16 a[244:245], v3 offset:17088
    v_fma_mix_f32 v39, v73, v19, v23 op_sel:[1,0,0] op_sel_hi:[1,0,0]
    v_mfma_f32_16x16x32_bf16 v[172:175], a[216:219], v[56:59], v[172:175]
    s_add_u32 m0, s44, 92736
    ds_read_b64_tr_b16 a[246:247], v3 offset:17600
    v_cvt_pk_bf16_f32 v72, v36, v37
    v_mfma_f32_16x16x32_bf16 v[172:175], a[220:223], v[60:63], v[172:175]
    s_mov_b32 s45, 2899968
    s_waitcnt lgkmcnt(8)
    buffer_load_dwordx4 v6, s[24:27], s45 offen lds
    v_cvt_pk_bf16_f32 v73, v38, v39
    v_mfma_f32_16x16x32_bf16 v[144:147], a[224:227], v[48:51], v[144:147]
    ds_read_b64_tr_b16 a[248:249], v3 offset:224
    ds_read_b128 v[16:19], v9 offset:11520
    v_mfma_f32_16x16x32_bf16 v[144:147], a[228:231], v[52:55], v[144:147]
    ds_read_b64_tr_b16 a[250:251], v3 offset:736
    ds_read_b64_tr_b16 a[252:253], v3 offset:17120
    v_mfma_f32_16x16x32_bf16 v[176:179], a[224:227], v[56:59], v[176:179]
    s_add_u32 m0, s44, 93792
    ds_read_b64_tr_b16 a[254:255], v3 offset:17632
    ds_read_b128 v[20:23], v9 offset:11552
    v_mfma_f32_16x16x32_bf16 v[176:179], a[228:231], v[60:63], v[176:179]
    s_mov_b32 s45, 2908160
    s_waitcnt lgkmcnt(10)
    buffer_load_dwordx4 v6, s[24:27], s45 offen lds
    v_mfma_f32_16x16x32_bf16 v[148:151], a[232:235], v[48:51], v[148:151]
    ds_read_b64_tr_b16 a[192:193], v3 offset:256
    v_fma_mix_f32 v32, v66, v24, v28 op_sel:[0,0,0] op_sel_hi:[1,0,0]
    v_mfma_f32_16x16x32_bf16 v[148:151], a[236:239], v[52:55], v[148:151]
    ds_read_b64_tr_b16 a[194:195], v3 offset:768
    v_fma_mix_f32 v33, v66, v25, v29 op_sel:[1,0,0] op_sel_hi:[1,0,0]
    v_mfma_f32_16x16x32_bf16 v[180:183], a[232:235], v[56:59], v[180:183]
    ds_read_b64_tr_b16 a[196:197], v3 offset:17152
    v_fma_mix_f32 v34, v67, v26, v30 op_sel:[0,0,0] op_sel_hi:[1,0,0]
    v_mfma_f32_16x16x32_bf16 v[180:183], a[236:239], v[60:63], v[180:183]
    s_waitcnt lgkmcnt(9)
    ds_read_b64_tr_b16 a[198:199], v3 offset:17664
    v_fma_mix_f32 v35, v67, v27, v31 op_sel:[1,0,0] op_sel_hi:[1,0,0]
    v_mfma_f32_16x16x32_bf16 v[152:155], a[240:243], v[48:51], v[152:155]
    ds_read_b64_tr_b16 a[200:201], v3 offset:288
    v_cvt_pk_bf16_f32 v66, v32, v33
    v_mfma_f32_16x16x32_bf16 v[152:155], a[244:247], v[52:55], v[152:155]
    ds_read_b64_tr_b16 a[202:203], v3 offset:800
    v_cvt_pk_bf16_f32 v67, v34, v35
    v_mfma_f32_16x16x32_bf16 v[184:187], a[240:243], v[56:59], v[184:187]
    ds_read_b64_tr_b16 a[204:205], v3 offset:17184
    v_fma_mix_f32 v36, v74, v24, v28 op_sel:[0,0,0] op_sel_hi:[1,0,0]
    v_mfma_f32_16x16x32_bf16 v[184:187], a[244:247], v[60:63], v[184:187]
    s_waitcnt lgkmcnt(8)
    ds_read_b64_tr_b16 a[206:207], v3 offset:17696
    v_fma_mix_f32 v37, v74, v25, v29 op_sel:[1,0,0] op_sel_hi:[1,0,0]
    v_mfma_f32_16x16x32_bf16 v[156:159], a[248:251], v[48:51], v[156:159]
    ds_read_b64_tr_b16 a[208:209], v3 offset:320
    v_fma_mix_f32 v38, v75, v26, v30 op_sel:[0,0,0] op_sel_hi:[1,0,0]
    v_mfma_f32_16x16x32_bf16 v[156:159], a[252:255], v[52:55], v[156:159]
    ds_read_b64_tr_b16 a[210:211], v3 offset:832
    v_fma_mix_f32 v39, v75, v27, v31 op_sel:[1,0,0] op_sel_hi:[1,0,0]
    v_mfma_f32_16x16x32_bf16 v[188:191], a[248:251], v[56:59], v[188:191]
    ds_read_b64_tr_b16 a[212:213], v3 offset:17216
    v_cvt_pk_bf16_f32 v74, v36, v37
    v_mfma_f32_16x16x32_bf16 v[188:191], a[252:255], v[60:63], v[188:191]
    s_waitcnt lgkmcnt(7)
    ds_read_b64_tr_b16 a[214:215], v3 offset:17728
    v_cvt_pk_bf16_f32 v75, v38, v39
    v_mfma_f32_16x16x32_bf16 v[192:195], a[192:195], v[48:51], v[192:195]
    ds_read_b64_tr_b16 a[216:217], v3 offset:352
    ds_read_b128 v[24:27], v9 offset:11536
    v_mfma_f32_16x16x32_bf16 v[192:195], a[196:199], v[52:55], v[192:195]
    ds_read_b64_tr_b16 a[218:219], v3 offset:864
    ds_read_b64_tr_b16 a[220:221], v3 offset:17248
    v_fma_mix_f32 v32, v68, v16, v20 op_sel:[0,0,0] op_sel_hi:[1,0,0]
    v_mfma_f32_16x16x32_bf16 v[224:227], a[192:195], v[56:59], v[224:227]
    s_mov_b32 s54, 12288
    ds_read_b64_tr_b16 a[222:223], v3 offset:17760
    ds_read_b128 v[28:31], v9 offset:11568
    v_mfma_f32_16x16x32_bf16 v[224:227], a[196:199], v[60:63], v[224:227]
    s_waitcnt lgkmcnt(10)
    buffer_load_dwordx4 v[96:99], v8, s[32:35], s54 offen sc1
    v_mfma_f32_16x16x32_bf16 v[196:199], a[200:203], v[48:51], v[196:199]
    ds_read_b64_tr_b16 a[224:225], v3 offset:384
    v_fma_mix_f32 v33, v68, v17, v21 op_sel:[1,0,0] op_sel_hi:[1,0,0]
    v_mfma_f32_16x16x32_bf16 v[196:199], a[204:207], v[52:55], v[196:199]
    ds_read_b64_tr_b16 a[226:227], v3 offset:896
    ds_read_b64_tr_b16 a[228:229], v3 offset:17280
    v_fma_mix_f32 v34, v69, v18, v22 op_sel:[0,0,0] op_sel_hi:[1,0,0]
    v_mfma_f32_16x16x32_bf16 v[228:231], a[200:203], v[56:59], v[228:231]
    s_mov_b32 s54, 13312
    ds_read_b64_tr_b16 a[230:231], v3 offset:17792
    v_fma_mix_f32 v35, v69, v19, v23 op_sel:[1,0,0] op_sel_hi:[1,0,0]
    v_mfma_f32_16x16x32_bf16 v[228:231], a[204:207], v[60:63], v[228:231]
    s_waitcnt lgkmcnt(10)
    buffer_load_dwordx4 v[100:103], v8, s[32:35], s54 offen sc1
    v_mfma_f32_16x16x32_bf16 v[200:203], a[208:211], v[48:51], v[200:203]
    ds_read_b64_tr_b16 a[232:233], v3 offset:416
    v_cvt_pk_bf16_f32 v68, v32, v33
    v_mfma_f32_16x16x32_bf16 v[200:203], a[212:215], v[52:55], v[200:203]
    ds_read_b64_tr_b16 a[234:235], v3 offset:928
    ds_read_b64_tr_b16 a[236:237], v3 offset:17312
    v_cvt_pk_bf16_f32 v69, v34, v35
    v_mfma_f32_16x16x32_bf16 v[232:235], a[208:211], v[56:59], v[232:235]
    s_mov_b32 s54, 30720
    ds_read_b64_tr_b16 a[238:239], v3 offset:17824
    v_fma_mix_f32 v36, v76, v16, v20 op_sel:[0,0,0] op_sel_hi:[1,0,0]
    v_mfma_f32_16x16x32_bf16 v[232:235], a[212:215], v[60:63], v[232:235]
    s_waitcnt lgkmcnt(9)
    buffer_load_dwordx4 v[104:107], v8, s[32:35], s54 offen sc1
    v_fma_mix_f32 v37, v76, v17, v21 op_sel:[1,0,0] op_sel_hi:[1,0,0]
    v_mfma_f32_16x16x32_bf16 v[204:207], a[216:219], v[48:51], v[204:207]
    ds_read_b64_tr_b16 a[240:241], v3 offset:448
    v_fma_mix_f32 v38, v77, v18, v22 op_sel:[0,0,0] op_sel_hi:[1,0,0]
    v_mfma_f32_16x16x32_bf16 v[204:207], a[220:223], v[52:55], v[204:207]
    ds_read_b64_tr_b16 a[242:243], v3 offset:960
    ds_read_b64_tr_b16 a[244:245], v3 offset:17344
    v_fma_mix_f32 v39, v77, v19, v23 op_sel:[1,0,0] op_sel_hi:[1,0,0]
    v_mfma_f32_16x16x32_bf16 v[236:239], a[216:219], v[56:59], v[236:239]
    s_mov_b32 s54, 31744
    ds_read_b64_tr_b16 a[246:247], v3 offset:17856
    v_cvt_pk_bf16_f32 v76, v36, v37
    v_mfma_f32_16x16x32_bf16 v[236:239], a[220:223], v[60:63], v[236:239]
    s_waitcnt lgkmcnt(8)
    buffer_load_dwordx4 v[108:111], v8, s[32:35], s54 offen sc1
    v_cvt_pk_bf16_f32 v77, v38, v39
    v_mfma_f32_16x16x32_bf16 v[208:211], a[224:227], v[48:51], v[208:211]
    ds_read_b64_tr_b16 a[248:249], v3 offset:480
    ds_read_b128 v[16:19], v9 offset:11776
    v_mfma_f32_16x16x32_bf16 v[208:211], a[228:231], v[52:55], v[208:211]
    ds_read_b64_tr_b16 a[250:251], v3 offset:992
    ds_read_b128 v[20:23], v9 offset:11808
    v_mfma_f32_16x16x32_bf16 v[240:243], a[224:227], v[56:59], v[240:243]
    ds_read_b64_tr_b16 a[252:253], v3 offset:17376
    v_fma_mix_f32 v32, v70, v24, v28 op_sel:[0,0,0] op_sel_hi:[1,0,0]
    v_mfma_f32_16x16x32_bf16 v[240:243], a[228:231], v[60:63], v[240:243]
    s_waitcnt vmcnt(16)
    s_barrier
    s_waitcnt lgkmcnt(9)
    ds_read_b64_tr_b16 a[254:255], v3 offset:17888
    v_fma_mix_f32 v33, v70, v25, v29 op_sel:[1,0,0] op_sel_hi:[1,0,0]
    v_fma_mix_f32 v34, v71, v26, v30 op_sel:[0,0,0] op_sel_hi:[1,0,0]
    v_mfma_f32_16x16x32_bf16 v[212:215], a[232:235], v[48:51], v[212:215]
    ds_read_b64_tr_b16 a[192:193], v3 offset:36864
    v_fma_mix_f32 v35, v71, v27, v31 op_sel:[1,0,0] op_sel_hi:[1,0,0]
    v_mfma_f32_16x16x32_bf16 v[212:215], a[236:239], v[52:55], v[212:215]
    ds_read_b64_tr_b16 a[194:195], v3 offset:37376
    ds_read_b64_tr_b16 a[196:197], v3 offset:53760
    v_cvt_pk_bf16_f32 v70, v32, v33
    v_mfma_f32_16x16x32_bf16 v[244:247], a[232:235], v[56:59], v[244:247]
    s_add_u32 m0, s44, 110592
    ds_read_b64_tr_b16 a[198:199], v3 offset:54272
    v_cvt_pk_bf16_f32 v71, v34, v35
    v_mfma_f32_16x16x32_bf16 v[244:247], a[236:239], v[60:63], v[244:247]
    s_mov_b32 s45, 3145728
    s_waitcnt lgkmcnt(10)
    buffer_load_dwordx4 v6, s[24:27], s45 offen lds
    v_mfma_f32_16x16x32_bf16 v[216:219], a[240:243], v[48:51], v[216:219]
    ds_read_b64_tr_b16 a[200:201], v3 offset:36896
    v_fma_mix_f32 v36, v78, v24, v28 op_sel:[0,0,0] op_sel_hi:[1,0,0]
    v_mfma_f32_16x16x32_bf16 v[216:219], a[244:247], v[52:55], v[216:219]
    ds_read_b64_tr_b16 a[202:203], v3 offset:37408
    ds_read_b64_tr_b16 a[204:205], v3 offset:53792
    v_fma_mix_f32 v37, v78, v25, v29 op_sel:[1,0,0] op_sel_hi:[1,0,0]
    v_mfma_f32_16x16x32_bf16 v[248:251], a[240:243], v[56:59], v[248:251]
    s_add_u32 m0, s44, 111648
    ds_read_b64_tr_b16 a[206:207], v3 offset:54304
    v_fma_mix_f32 v38, v79, v26, v30 op_sel:[0,0,0] op_sel_hi:[1,0,0]
    v_mfma_f32_16x16x32_bf16 v[248:251], a[244:247], v[60:63], v[248:251]
    s_mov_b32 s45, 3153920
    s_waitcnt lgkmcnt(8)
    buffer_load_dwordx4 v6, s[24:27], s45 offen lds
    v_mfma_f32_16x16x32_bf16 v[220:223], a[248:251], v[48:51], v[220:223]
L2_pad1:
    s_cbranch_execz L2_pad5
    ds_read_b64_tr_b16 a[208:209], v3 offset:36928
    v_fma_mix_f32 v39, v79, v27, v31 op_sel:[1,0,0] op_sel_hi:[1,0,0]
    v_mfma_f32_16x16x32_bf16 v[220:223], a[252:255], v[52:55], v[220:223]
    ds_read_b64_tr_b16 a[210:211], v3 offset:37440
    ds_read_b64_tr_b16 a[212:213], v3 offset:53824
    v_cvt_pk_bf16_f32 v78, v36, v37
    v_mfma_f32_16x16x32_bf16 v[252:255], a[248:251], v[56:59], v[252:255]
    s_add_u32 m0, s44, 112704
    ds_read_b64_tr_b16 a[214:215], v3 offset:54336
    v_cvt_pk_bf16_f32 v79, v38, v39
    v_mfma_f32_16x16x32_bf16 v[252:255], a[252:255], v[60:63], v[252:255]
    s_mov_b32 s45, 3162112
    s_waitcnt lgkmcnt(8)
    buffer_load_dwordx4 v6, s[24:27], s45 offen lds
    v_mfma_f32_16x16x32_bf16 v[128:131], a[192:195], v[64:67], v[128:131]
    s_waitcnt vmcnt(15)
    ds_read_b64_tr_b16 a[216:217], v3 offset:36960
    ds_read_b128 v[24:27], v9 offset:11792
    v_mfma_f32_16x16x32_bf16 v[128:131], a[196:199], v[68:71], v[128:131]
    ds_read_b64_tr_b16 a[218:219], v3 offset:37472
    ds_read_b64_tr_b16 a[220:221], v3 offset:53856
    v_fma_mix_f32 v32, v80, v16, v20 op_sel:[0,0,0] op_sel_hi:[1,0,0]
    v_mfma_f32_16x16x32_bf16 v[160:163], a[192:195], v[72:75], v[160:163]
    s_add_u32 m0, s44, 113760
    ds_read_b64_tr_b16 a[222:223], v3 offset:54368
    ds_read_b128 v[28:31], v9 offset:11824
    v_mfma_f32_16x16x32_bf16 v[160:163], a[196:199], v[76:79], v[160:163]
    s_mov_b32 s45, 3170304
    s_waitcnt lgkmcnt(10)
    buffer_load_dwordx4 v6, s[24:27], s45 offen lds
    v_mfma_f32_16x16x32_bf16 v[132:135], a[200:203], v[64:67], v[132:135]
    ds_read_b64_tr_b16 a[224:225], v3 offset:36992
    v_fma_mix_f32 v33, v80, v17, v21 op_sel:[1,0,0] op_sel_hi:[1,0,0]
    v_mfma_f32_16x16x32_bf16 v[132:135], a[204:207], v[68:71], v[132:135]
    ds_read_b64_tr_b16 a[226:227], v3 offset:37504
    ds_read_b64_tr_b16 a[228:229], v3 offset:53888
    v_fma_mix_f32 v34, v81, v18, v22 op_sel:[0,0,0] op_sel_hi:[1,0,0]
    v_mfma_f32_16x16x32_bf16 v[164:167], a[200:203], v[72:75], v[164:167]
    s_add_u32 m0, s44, 127488
    ds_read_b64_tr_b16 a[230:231], v3 offset:54400
    v_fma_mix_f32 v35, v81, v19, v23 op_sel:[1,0,0] op_sel_hi:[1,0,0]
    v_mfma_f32_16x16x32_bf16 v[164:167], a[204:207], v[76:79], v[164:167]
    s_mov_b32 s45, 3407872
    s_waitcnt lgkmcnt(10)
    buffer_load_dwordx4 v6, s[24:27], s45 offen lds
    v_mfma_f32_16x16x32_bf16 v[136:139], a[208:211], v[64:67], v[136:139]
    ds_read_b64_tr_b16 a[232:233], v3 offset:37024
    v_cvt_pk_bf16_f32 v80, v32, v33
    v_mfma_f32_16x16x32_bf16 v[136:139], a[212:215], v[68:71], v[136:139]
    ds_read_b64_tr_b16 a[234:235], v3 offset:37536
    ds_read_b64_tr_b16 a[236:237], v3 offset:53920
    v_cvt_pk_bf16_f32 v81, v34, v35
    v_mfma_f32_16x16x32_bf16 v[168:171], a[208:211], v[72:75], v[168:171]
    s_add_u32 m0, s44, 128544
    ds_read_b64_tr_b16 a[238:239], v3 offset:54432
    v_fma_mix_f32 v36, v88, v16, v20 op_sel:[0,0,0] op_sel_hi:[1,0,0]
    v_mfma_f32_16x16x32_bf16 v[168:171], a[212:215], v[76:79], v[168:171]
    s_mov_b32 s45, 3416064
    s_waitcnt lgkmcnt(9)
    buffer_load_dwordx4 v6, s[24:27], s45 offen lds
    v_fma_mix_f32 v37, v88, v17, v21 op_sel:[1,0,0] op_sel_hi:[1,0,0]
    v_mfma_f32_16x16x32_bf16 v[140:143], a[216:219], v[64:67], v[140:143]
    ds_read_b64_tr_b16 a[240:241], v3 offset:37056
    v_fma_mix_f32 v38, v89, v18, v22 op_sel:[0,0,0] op_sel_hi:[1,0,0]
    v_mfma_f32_16x16x32_bf16 v[140:143], a[220:223], v[68:71], v[140:143]
    ds_read_b64_tr_b16 a[242:243], v3 offset:37568
    ds_read_b64_tr_b16 a[244:245], v3 offset:53952
    v_fma_mix_f32 v39, v89, v19, v23 op_sel:[1,0,0] op_sel_hi:[1,0,0]
    v_mfma_f32_16x16x32_bf16 v[172:175], a[216:219], v[72:75], v[172:175]
    s_add_u32 m0, s44, 129600
    ds_read_b64_tr_b16 a[246:247], v3 offset:54464
    v_cvt_pk_bf16_f32 v88, v36, v37
    v_mfma_f32_16x16x32_bf16 v[172:175], a[220:223], v[76:79], v[172:175]
    s_mov_b32 s45, 3424256
    s_waitcnt lgkmcnt(8)
    buffer_load_dwordx4 v6, s[24:27], s45 offen lds
    v_cvt_pk_bf16_f32 v89, v38, v39
    v_mfma_f32_16x16x32_bf16 v[144:147], a[224:227], v[64:67], v[144:147]
    ds_read_b64_tr_b16 a[248:249], v3 offset:37088
    ds_read_b128 v[16:19], v9 offset:12032
    v_mfma_f32_16x16x32_bf16 v[144:147], a[228:231], v[68:71], v[144:147]
    ds_read_b64_tr_b16 a[250:251], v3 offset:37600
    ds_read_b64_tr_b16 a[252:253], v3 offset:53984
    v_mfma_f32_16x16x32_bf16 v[176:179], a[224:227], v[72:75], v[176:179]
    s_add_u32 m0, s44, 130656
    ds_read_b64_tr_b16 a[254:255], v3 offset:54496
    ds_read_b128 v[20:23], v9 offset:12064
    v_mfma_f32_16x16x32_bf16 v[176:179], a[228:231], v[76:79], v[176:179]
    s_mov_b32 s45, 3432448
    s_waitcnt lgkmcnt(10)
    buffer_load_dwordx4 v6, s[24:27], s45 offen lds
    v_mfma_f32_16x16x32_bf16 v[148:151], a[232:235], v[64:67], v[148:151]
    ds_read_b64_tr_b16 a[192:193], v3 offset:37120
    v_fma_mix_f32 v32, v82, v24, v28 op_sel:[0,0,0] op_sel_hi:[1,0,0]
    v_mfma_f32_16x16x32_bf16 v[148:151], a[236:239], v[68:71], v[148:151]
    ds_read_b64_tr_b16 a[194:195], v3 offset:37632
    v_fma_mix_f32 v33, v82, v25, v29 op_sel:[1,0,0] op_sel_hi:[1,0,0]
    v_mfma_f32_16x16x32_bf16 v[180:183], a[232:235], v[72:75], v[180:183]
    ds_read_b64_tr_b16 a[196:197], v3 offset:54016
    v_fma_mix_f32 v34, v83, v26, v30 op_sel:[0,0,0] op_sel_hi:[1,0,0]
    v_mfma_f32_16x16x32_bf16 v[180:183], a[236:239], v[76:79], v[180:183]
    s_waitcnt lgkmcnt(9)
    ds_read_b64_tr_b16 a[198:199], v3 offset:54528
    v_fma_mix_f32 v35, v83, v27, v31 op_sel:[1,0,0] op_sel_hi:[1,0,0]
    v_mfma_f32_16x16x32_bf16 v[152:155], a[240:243], v[64:67], v[152:155]
    ds_read_b64_tr_b16 a[200:201], v3 offset:37152
    v_cvt_pk_bf16_f32 v82, v32, v33
    v_mfma_f32_16x16x32_bf16 v[152:155], a[244:247], v[68:71], v[152:155]
    ds_read_b64_tr_b16 a[202:203], v3 offset:37664
    v_cvt_pk_bf16_f32 v83, v34, v35
    v_mfma_f32_16x16x32_bf16 v[184:187], a[240:243], v[72:75], v[184:187]
    ds_read_b64_tr_b16 a[204:205], v3 offset:54048
    v_fma_mix_f32 v36, v90, v24, v28 op_sel:[0,0,0] op_sel_hi:[1,0,0]
    v_mfma_f32_16x16x32_bf16 v[184:187], a[244:247], v[76:79], v[184:187]
    s_waitcnt lgkmcnt(8)
    ds_read_b64_tr_b16 a[206:207], v3 offset:54560
    v_fma_mix_f32 v37, v90, v25, v29 op_sel:[1,0,0] op_sel_hi:[1,0,0]
    v_mfma_f32_16x16x32_bf16 v[156:159], a[248:251], v[64:67], v[156:159]
    ds_read_b64_tr_b16 a[208:209], v3 offset:37184
    v_fma_mix_f32 v38, v91, v26, v30 op_sel:[0,0,0] op_sel_hi:[1,0,0]
    v_mfma_f32_16x16x32_bf16 v[156:159], a[252:255], v[68:71], v[156:159]
    ds_read_b64_tr_b16 a[210:211], v3 offset:37696
    v_fma_mix_f32 v39, v91, v27, v31 op_sel:[1,0,0] op_sel_hi:[1,0,0]
    v_mfma_f32_16x16x32_bf16 v[188:191], a[248:251], v[72:75], v[188:191]
    ds_read_b64_tr_b16 a[212:213], v3 offset:54080
    v_cvt_pk_bf16_f32 v90, v36, v37
    v_mfma_f32_16x16x32_bf16 v[188:191], a[252:255], v[76:79], v[188:191]
    s_waitcnt lgkmcnt(7)
    ds_read_b64_tr_b16 a[214:215], v3 offset:54592
    v_cvt_pk_bf16_f32 v91, v38, v39
    v_mfma_f32_16x16x32_bf16 v[192:195], a[192:195], v[64:67], v[192:195]
    ds_read_b64_tr_b16 a[216:217], v3 offset:37216
    ds_read_b128 v[24:27], v9 offset:12048
    v_mfma_f32_16x16x32_bf16 v[192:195], a[196:199], v[68:71], v[192:195]
    ds_read_b64_tr_b16 a[218:219], v3 offset:37728
    ds_read_b64_tr_b16 a[220:221], v3 offset:54112
    v_fma_mix_f32 v32, v84, v16, v20 op_sel:[0,0,0] op_sel_hi:[1,0,0]
    v_mfma_f32_16x16x32_bf16 v[224:227], a[192:195], v[72:75], v[224:227]
    s_mov_b32 s54, 14336
    ds_read_b64_tr_b16 a[222:223], v3 offset:54624
    ds_read_b128 v[28:31], v9 offset:12080
    v_mfma_f32_16x16x32_bf16 v[224:227], a[196:199], v[76:79], v[224:227]
    s_waitcnt lgkmcnt(10)
    buffer_load_dwordx4 v[112:115], v8, s[32:35], s54 offen sc1
    v_mfma_f32_16x16x32_bf16 v[196:199], a[200:203], v[64:67], v[196:199]
    ds_read_b64_tr_b16 a[224:225], v3 offset:37248
    v_fma_mix_f32 v33, v84, v17, v21 op_sel:[1,0,0] op_sel_hi:[1,0,0]
    v_mfma_f32_16x16x32_bf16 v[196:199], a[204:207], v[68:71], v[196:199]
    ds_read_b64_tr_b16 a[226:227], v3 offset:37760
    ds_read_b64_tr_b16 a[228:229], v3 offset:54144
    v_fma_mix_f32 v34, v85, v18, v22 op_sel:[0,0,0] op_sel_hi:[1,0,0]
    v_mfma_f32_16x16x32_bf16 v[228:231], a[200:203], v[72:75], v[228:231]
    s_mov_b32 s54, 15360
    ds_read_b64_tr_b16 a[230:231], v3 offset:54656
    v_fma_mix_f32 v35, v85, v19, v23 op_sel:[1,0,0] op_sel_hi:[1,0,0]
    v_mfma_f32_16x16x32_bf16 v[228:231], a[204:207], v[76:79], v[228:231]
    s_waitcnt lgkmcnt(10)
    buffer_load_dwordx4 v[116:119], v8, s[32:35], s54 offen sc1
    v_mfma_f32_16x16x32_bf16 v[200:203], a[208:211], v[64:67], v[200:203]
    ds_read_b64_tr_b16 a[232:233], v3 offset:37280
    v_cvt_pk_bf16_f32 v84, v32, v33
    v_mfma_f32_16x16x32_bf16 v[200:203], a[212:215], v[68:71], v[200:203]
    ds_read_b64_tr_b16 a[234:235], v3 offset:37792
    ds_read_b64_tr_b16 a[236:237], v3 offset:54176
    v_cvt_pk_bf16_f32 v85, v34, v35
    v_mfma_f32_16x16x32_bf16 v[232:235], a[208:211], v[72:75], v[232:235]
    s_mov_b32 s54, 32768
    ds_read_b64_tr_b16 a[238:239], v3 offset:54688
    v_fma_mix_f32 v36, v92, v16, v20 op_sel:[0,0,0] op_sel_hi:[1,0,0]
    v_mfma_f32_16x16x32_bf16 v[232:235], a[212:215], v[76:79], v[232:235]
    s_waitcnt lgkmcnt(9)
    buffer_load_dwordx4 v[120:123], v8, s[32:35], s54 offen sc1
    v_fma_mix_f32 v37, v92, v17, v21 op_sel:[1,0,0] op_sel_hi:[1,0,0]
    v_mfma_f32_16x16x32_bf16 v[204:207], a[216:219], v[64:67], v[204:207]
    ds_read_b64_tr_b16 a[240:241], v3 offset:37312
    v_fma_mix_f32 v38, v93, v18, v22 op_sel:[0,0,0] op_sel_hi:[1,0,0]
    v_mfma_f32_16x16x32_bf16 v[204:207], a[220:223], v[68:71], v[204:207]
    ds_read_b64_tr_b16 a[242:243], v3 offset:37824
    ds_read_b64_tr_b16 a[244:245], v3 offset:54208
    v_fma_mix_f32 v39, v93, v19, v23 op_sel:[1,0,0] op_sel_hi:[1,0,0]
    v_mfma_f32_16x16x32_bf16 v[236:239], a[216:219], v[72:75], v[236:239]
    s_mov_b32 s54, 33792
    ds_read_b64_tr_b16 a[246:247], v3 offset:54720
    v_cvt_pk_bf16_f32 v92, v36, v37
    v_mfma_f32_16x16x32_bf16 v[236:239], a[220:223], v[76:79], v[236:239]
    s_waitcnt lgkmcnt(8)
    buffer_load_dwordx4 v[124:127], v8, s[32:35], s54 offen sc1
    v_cvt_pk_bf16_f32 v93, v38, v39
    v_mfma_f32_16x16x32_bf16 v[208:211], a[224:227], v[64:67], v[208:211]
    ds_read_b64_tr_b16 a[248:249], v3 offset:37344
    ds_read_b128 v[16:19], v9 offset:12288
    v_mfma_f32_16x16x32_bf16 v[208:211], a[228:231], v[68:71], v[208:211]
    ds_read_b64_tr_b16 a[250:251], v3 offset:37856
    ds_read_b128 v[20:23], v9 offset:12320
    v_mfma_f32_16x16x32_bf16 v[240:243], a[224:227], v[72:75], v[240:243]
    ds_read_b64_tr_b16 a[252:253], v3 offset:54240
    v_fma_mix_f32 v32, v86, v24, v28 op_sel:[0,0,0] op_sel_hi:[1,0,0]
    v_mfma_f32_16x16x32_bf16 v[240:243], a[228:231], v[76:79], v[240:243]
    s_waitcnt vmcnt(16)
    s_barrier
    s_waitcnt lgkmcnt(9)
    ds_read_b64_tr_b16 a[254:255], v3 offset:54752
    v_fma_mix_f32 v33, v86, v25, v29 op_sel:[1,0,0] op_sel_hi:[1,0,0]
    v_fma_mix_f32 v34, v87, v26, v30 op_sel:[0,0,0] op_sel_hi:[1,0,0]
    v_mfma_f32_16x16x32_bf16 v[212:215], a[232:235], v[64:67], v[212:215]
    ds_read_b64_tr_b16 a[192:193], v4 offset:0
    v_fma_mix_f32 v35, v87, v27, v31 op_sel:[1,0,0] op_sel_hi:[1,0,0]
    v_mfma_f32_16x16x32_bf16 v[212:215], a[236:239], v[68:71], v[212:215]
    ds_read_b64_tr_b16 a[194:195], v4 offset:512
    ds_read_b64_tr_b16 a[196:197], v4 offset:16896
    v_cvt_pk_bf16_f32 v86, v32, v33
    v_mfma_f32_16x16x32_bf16 v[244:247], a[232:235], v[72:75], v[244:247]
    s_add_u32 m0, s44, 0
    ds_read_b64_tr_b16 a[198:199], v4 offset:17408
    v_cvt_pk_bf16_f32 v87, v34, v35
    v_mfma_f32_16x16x32_bf16 v[244:247], a[236:239], v[76:79], v[244:247]
    s_mov_b32 s45, 3670016
    s_waitcnt lgkmcnt(10)
    buffer_load_dwordx4 v6, s[24:27], s45 offen lds
    v_mfma_f32_16x16x32_bf16 v[216:219], a[240:243], v[64:67], v[216:219]
    ds_read_b64_tr_b16 a[200:201], v4 offset:32
    v_fma_mix_f32 v36, v94, v24, v28 op_sel:[0,0,0] op_sel_hi:[1,0,0]
    v_mfma_f32_16x16x32_bf16 v[216:219], a[244:247], v[68:71], v[216:219]
    ds_read_b64_tr_b16 a[202:203], v4 offset:544
    ds_read_b64_tr_b16 a[204:205], v4 offset:16928
    v_fma_mix_f32 v37, v94, v25, v29 op_sel:[1,0,0] op_sel_hi:[1,0,0]
    v_mfma_f32_16x16x32_bf16 v[248:251], a[240:243], v[72:75], v[248:251]
    s_add_u32 m0, s44, 1056
    ds_read_b64_tr_b16 a[206:207], v4 offset:17440
    v_fma_mix_f32 v38, v95, v26, v30 op_sel:[0,0,0] op_sel_hi:[1,0,0]
    v_mfma_f32_16x16x32_bf16 v[248:251], a[244:247], v[76:79], v[248:251]
    s_mov_b32 s45, 3678208
    s_waitcnt lgkmcnt(8)
    buffer_load_dwordx4 v6, s[24:27], s45 offen lds
    v_mfma_f32_16x16x32_bf16 v[220:223], a[248:251], v[64:67], v[220:223]
    ds_read_b64_tr_b16 a[208:209], v4 offset:64
    v_fma_mix_f32 v39, v95, v27, v31 op_sel:[1,0,0] op_sel_hi:[1,0,0]
    v_mfma_f32_16x16x32_bf16 v[220:223], a[252:255], v[68:71], v[220:223]
    ds_read_b64_tr_b16 a[210:211], v4 offset:576
    ds_read_b64_tr_b16 a[212:213], v4 offset:16960
    v_cvt_pk_bf16_f32 v94, v36, v37
    v_mfma_f32_16x16x32_bf16 v[252:255], a[248:251], v[72:75], v[252:255]
    s_add_u32 m0, s44, 2112
    ds_read_b64_tr_b16 a[214:215], v4 offset:17472
    v_cvt_pk_bf16_f32 v95, v38, v39
    v_mfma_f32_16x16x32_bf16 v[252:255], a[252:255], v[76:79], v[252:255]
    s_mov_b32 s45, 3686400
    s_waitcnt lgkmcnt(8)
    buffer_load_dwordx4 v6, s[24:27], s45 offen lds
    v_mfma_f32_16x16x32_bf16 v[128:131], a[192:195], v[80:83], v[128:131]
    s_waitcnt vmcnt(15)
    ds_read_b64_tr_b16 a[216:217], v4 offset:96
    ds_read_b128 v[24:27], v9 offset:12304
    v_mfma_f32_16x16x32_bf16 v[128:131], a[196:199], v[84:87], v[128:131]
    ds_read_b64_tr_b16 a[218:219], v4 offset:608
    ds_read_b64_tr_b16 a[220:221], v4 offset:16992
    v_fma_mix_f32 v32, v96, v16, v20 op_sel:[0,0,0] op_sel_hi:[1,0,0]
    v_mfma_f32_16x16x32_bf16 v[160:163], a[192:195], v[88:91], v[160:163]
    s_add_u32 m0, s44, 3168
    ds_read_b64_tr_b16 a[222:223], v4 offset:17504
    ds_read_b128 v[28:31], v9 offset:12336
    v_mfma_f32_16x16x32_bf16 v[160:163], a[196:199], v[92:95], v[160:163]
    s_mov_b32 s45, 3694592
    s_waitcnt lgkmcnt(10)
    buffer_load_dwordx4 v6, s[24:27], s45 offen lds
    v_mfma_f32_16x16x32_bf16 v[132:135], a[200:203], v[80:83], v[132:135]
    ds_read_b64_tr_b16 a[224:225], v4 offset:128
    v_fma_mix_f32 v33, v96, v17, v21 op_sel:[1,0,0] op_sel_hi:[1,0,0]
    v_mfma_f32_16x16x32_bf16 v[132:135], a[204:207], v[84:87], v[132:135]
    ds_read_b64_tr_b16 a[226:227], v4 offset:640
    ds_read_b64_tr_b16 a[228:229], v4 offset:17024
    v_fma_mix_f32 v34, v97, v18, v22 op_sel:[0,0,0] op_sel_hi:[1,0,0]
    v_mfma_f32_16x16x32_bf16 v[164:167], a[200:203], v[88:91], v[164:167]
    s_add_u32 m0, s44, 16896
    ds_read_b64_tr_b16 a[230:231], v4 offset:17536
    v_fma_mix_f32 v35, v97, v19, v23 op_sel:[1,0,0] op_sel_hi:[1,0,0]
    v_mfma_f32_16x16x32_bf16 v[164:167], a[204:207], v[92:95], v[164:167]
    s_mov_b32 s45, 3932160
    s_waitcnt lgkmcnt(10)
    buffer_load_dwordx4 v6, s[24:27], s45 offen lds
    v_mfma_f32_16x16x32_bf16 v[136:139], a[208:211], v[80:83], v[136:139]
    ds_read_b64_tr_b16 a[232:233], v4 offset:160
    v_cvt_pk_bf16_f32 v96, v32, v33
    v_mfma_f32_16x16x32_bf16 v[136:139], a[212:215], v[84:87], v[136:139]
    ds_read_b64_tr_b16 a[234:235], v4 offset:672
    ds_read_b64_tr_b16 a[236:237], v4 offset:17056
    v_cvt_pk_bf16_f32 v97, v34, v35
    v_mfma_f32_16x16x32_bf16 v[168:171], a[208:211], v[88:91], v[168:171]
    s_add_u32 m0, s44, 17952
    ds_read_b64_tr_b16 a[238:239], v4 offset:17568
    v_fma_mix_f32 v36, v104, v16, v20 op_sel:[0,0,0] op_sel_hi:[1,0,0]
    v_mfma_f32_16x16x32_bf16 v[168:171], a[212:215], v[92:95], v[168:171]
    s_mov_b32 s45, 3940352
    s_waitcnt lgkmcnt(9)
    buffer_load_dwordx4 v6, s[24:27], s45 offen lds
    v_fma_mix_f32 v37, v104, v17, v21 op_sel:[1,0,0] op_sel_hi:[1,0,0]
    v_mfma_f32_16x16x32_bf16 v[140:143], a[216:219], v[80:83], v[140:143]
    ds_read_b64_tr_b16 a[240:241], v4 offset:192
    v_fma_mix_f32 v38, v105, v18, v22 op_sel:[0,0,0] op_sel_hi:[1,0,0]
    v_mfma_f32_16x16x32_bf16 v[140:143], a[220:223], v[84:87], v[140:143]
    ds_read_b64_tr_b16 a[242:243], v4 offset:704
    ds_read_b64_tr_b16 a[244:245], v4 offset:17088
    v_fma_mix_f32 v39, v105, v19, v23 op_sel:[1,0,0] op_sel_hi:[1,0,0]
    v_mfma_f32_16x16x32_bf16 v[172:175], a[216:219], v[88:91], v[172:175]
    s_add_u32 m0, s44, 19008
    ds_read_b64_tr_b16 a[246:247], v4 offset:17600
    v_cvt_pk_bf16_f32 v104, v36, v37
    v_mfma_f32_16x16x32_bf16 v[172:175], a[220:223], v[92:95], v[172:175]
    s_mov_b32 s45, 3948544
    s_waitcnt lgkmcnt(8)
    buffer_load_dwordx4 v6, s[24:27], s45 offen lds
    v_cvt_pk_bf16_f32 v105, v38, v39
    v_mfma_f32_16x16x32_bf16 v[144:147], a[224:227], v[80:83], v[144:147]
    ds_read_b64_tr_b16 a[248:249], v4 offset:224
    ds_read_b128 v[16:19], v9 offset:12544
    v_mfma_f32_16x16x32_bf16 v[144:147], a[228:231], v[84:87], v[144:147]
    ds_read_b64_tr_b16 a[250:251], v4 offset:736
    ds_read_b64_tr_b16 a[252:253], v4 offset:17120
    v_mfma_f32_16x16x32_bf16 v[176:179], a[224:227], v[88:91], v[176:179]
    s_add_u32 m0, s44, 20064
    ds_read_b64_tr_b16 a[254:255], v4 offset:17632
    ds_read_b128 v[20:23], v9 offset:12576
    v_mfma_f32_16x16x32_bf16 v[176:179], a[228:231], v[92:95], v[176:179]
    s_mov_b32 s45, 3956736
    s_waitcnt lgkmcnt(10)
    buffer_load_dwordx4 v6, s[24:27], s45 offen lds
    v_mfma_f32_16x16x32_bf16 v[148:151], a[232:235], v[80:83], v[148:151]
    ds_read_b64_tr_b16 a[192:193], v4 offset:256
    v_fma_mix_f32 v32, v98, v24, v28 op_sel:[0,0,0] op_sel_hi:[1,0,0]
    v_mfma_f32_16x16x32_bf16 v[148:151], a[236:239], v[84:87], v[148:151]
    ds_read_b64_tr_b16 a[194:195], v4 offset:768
    v_fma_mix_f32 v33, v98, v25, v29 op_sel:[1,0,0] op_sel_hi:[1,0,0]
    v_mfma_f32_16x16x32_bf16 v[180:183], a[232:235], v[88:91], v[180:183]
    ds_read_b64_tr_b16 a[196:197], v4 offset:17152
    v_fma_mix_f32 v34, v99, v26, v30 op_sel:[0,0,0] op_sel_hi:[1,0,0]
    v_mfma_f32_16x16x32_bf16 v[180:183], a[236:239], v[92:95], v[180:183]
    s_waitcnt lgkmcnt(9)
    ds_read_b64_tr_b16 a[198:199], v4 offset:17664
    v_fma_mix_f32 v35, v99, v27, v31 op_sel:[1,0,0] op_sel_hi:[1,0,0]
    v_mfma_f32_16x16x32_bf16 v[152:155], a[240:243], v[80:83], v[152:155]
    ds_read_b64_tr_b16 a[200:201], v4 offset:288
    v_cvt_pk_bf16_f32 v98, v32, v33
    v_mfma_f32_16x16x32_bf16 v[152:155], a[244:247], v[84:87], v[152:155]
    ds_read_b64_tr_b16 a[202:203], v4 offset:800
    v_cvt_pk_bf16_f32 v99, v34, v35
    v_mfma_f32_16x16x32_bf16 v[184:187], a[240:243], v[88:91], v[184:187]
    ds_read_b64_tr_b16 a[204:205], v4 offset:17184
    v_fma_mix_f32 v36, v106, v24, v28 op_sel:[0,0,0] op_sel_hi:[1,0,0]
    v_mfma_f32_16x16x32_bf16 v[184:187], a[244:247], v[92:95], v[184:187]
    s_waitcnt lgkmcnt(8)
    ds_read_b64_tr_b16 a[206:207], v4 offset:17696
    v_fma_mix_f32 v37, v106, v25, v29 op_sel:[1,0,0] op_sel_hi:[1,0,0]
    v_mfma_f32_16x16x32_bf16 v[156:159], a[248:251], v[80:83], v[156:159]
    ds_read_b64_tr_b16 a[208:209], v4 offset:320
    v_fma_mix_f32 v38, v107, v26, v30 op_sel:[0,0,0] op_sel_hi:[1,0,0]
    v_mfma_f32_16x16x32_bf16 v[156:159], a[252:255], v[84:87], v[156:159]
    ds_read_b64_tr_b16 a[210:211], v4 offset:832
    v_fma_mix_f32 v39, v107, v27, v31 op_sel:[1,0,0] op_sel_hi:[1,0,0]
    v_mfma_f32_16x16x32_bf16 v[188:191], a[248:251], v[88:91], v[188:191]
    ds_read_b64_tr_b16 a[212:213], v4 offset:17216
    v_cvt_pk_bf16_f32 v106, v36, v37
    v_mfma_f32_16x16x32_bf16 v[188:191], a[252:255], v[92:95], v[188:191]
    s_waitcnt lgkmcnt(7)
    ds_read_b64_tr_b16 a[214:215], v4 offset:17728
    v_cvt_pk_bf16_f32 v107, v38, v39
    v_mfma_f32_16x16x32_bf16 v[192:195], a[192:195], v[80:83], v[192:195]
    ds_read_b64_tr_b16 a[216:217], v4 offset:352
    ds_read_b128 v[24:27], v9 offset:12560
    v_mfma_f32_16x16x32_bf16 v[192:195], a[196:199], v[84:87], v[192:195]
    ds_read_b64_tr_b16 a[218:219], v4 offset:864
    ds_read_b64_tr_b16 a[220:221], v4 offset:17248
    v_fma_mix_f32 v32, v100, v16, v20 op_sel:[0,0,0] op_sel_hi:[1,0,0]
    v_mfma_f32_16x16x32_bf16 v[224:227], a[192:195], v[88:91], v[224:227]
    s_mov_b32 s54, 16384
    ds_read_b64_tr_b16 a[222:223], v4 offset:17760
    ds_read_b128 v[28:31], v9 offset:12592
    v_mfma_f32_16x16x32_bf16 v[224:227], a[196:199], v[92:95], v[224:227]
    s_waitcnt lgkmcnt(10)
    buffer_load_dwordx4 v[48:51], v8, s[32:35], s54 offen sc1
    v_mfma_f32_16x16x32_bf16 v[196:199], a[200:203], v[80:83], v[196:199]
    ds_read_b64_tr_b16 a[224:225], v4 offset:384
    v_fma_mix_f32 v33, v100, v17, v21 op_sel:[1,0,0] op_sel_hi:[1,0,0]
    v_mfma_f32_16x16x32_bf16 v[196:199], a[204:207], v[84:87], v[196:199]
    ds_read_b64_tr_b16 a[226:227], v4 offset:896
    ds_read_b64_tr_b16 a[228:229], v4 offset:17280
    v_fma_mix_f32 v34, v101, v18, v22 op_sel:[0,0,0] op_sel_hi:[1,0,0]
    v_mfma_f32_16x16x32_bf16 v[228:231], a[200:203], v[88:91], v[228:231]
    s_mov_b32 s54, 17408
    ds_read_b64_tr_b16 a[230:231], v4 offset:17792
    v_fma_mix_f32 v35, v101, v19, v23 op_sel:[1,0,0] op_sel_hi:[1,0,0]
    v_mfma_f32_16x16x32_bf16 v[228:231], a[204:207], v[92:95], v[228:231]
    s_waitcnt lgkmcnt(10)
    buffer_load_dwordx4 v[52:55], v8, s[32:35], s54 offen sc1
    v_mfma_f32_16x16x32_bf16 v[200:203], a[208:211], v[80:83], v[200:203]
    ds_read_b64_tr_b16 a[232:233], v4 offset:416
    v_cvt_pk_bf16_f32 v100, v32, v33
    v_mfma_f32_16x16x32_bf16 v[200:203], a[212:215], v[84:87], v[200:203]
    ds_read_b64_tr_b16 a[234:235], v4 offset:928
    ds_read_b64_tr_b16 a[236:237], v4 offset:17312
    v_cvt_pk_bf16_f32 v101, v34, v35
    v_mfma_f32_16x16x32_bf16 v[232:235], a[208:211], v[88:91], v[232:235]
    s_mov_b32 s54, 34816
    ds_read_b64_tr_b16 a[238:239], v4 offset:17824
    v_fma_mix_f32 v36, v108, v16, v20 op_sel:[0,0,0] op_sel_hi:[1,0,0]
    v_mfma_f32_16x16x32_bf16 v[232:235], a[212:215], v[92:95], v[232:235]
    s_waitcnt lgkmcnt(9)
    buffer_load_dwordx4 v[56:59], v8, s[32:35], s54 offen sc1
    v_fma_mix_f32 v37, v108, v17, v21 op_sel:[1,0,0] op_sel_hi:[1,0,0]
    v_mfma_f32_16x16x32_bf16 v[204:207], a[216:219], v[80:83], v[204:207]
    ds_read_b64_tr_b16 a[240:241], v4 offset:448
    v_fma_mix_f32 v38, v109, v18, v22 op_sel:[0,0,0] op_sel_hi:[1,0,0]
    v_mfma_f32_16x16x32_bf16 v[204:207], a[220:223], v[84:87], v[204:207]
    ds_read_b64_tr_b16 a[242:243], v4 offset:960
    ds_read_b64_tr_b16 a[244:245], v4 offset:17344
    v_fma_mix_f32 v39, v109, v19, v23 op_sel:[1,0,0] op_sel_hi:[1,0,0]
    v_mfma_f32_16x16x32_bf16 v[236:239], a[216:219], v[88:91], v[236:239]
    s_mov_b32 s54, 35840
    ds_read_b64_tr_b16 a[246:247], v4 offset:17856
    v_cvt_pk_bf16_f32 v108, v36, v37
    v_mfma_f32_16x16x32_bf16 v[236:239], a[220:223], v[92:95], v[236:239]
    s_waitcnt lgkmcnt(8)
    buffer_load_dwordx4 v[60:63], v8, s[32:35], s54 offen sc1
    v_cvt_pk_bf16_f32 v109, v38, v39
    v_mfma_f32_16x16x32_bf16 v[208:211], a[224:227], v[80:83], v[208:211]
    ds_read_b64_tr_b16 a[248:249], v4 offset:480
    ds_read_b128 v[16:19], v9 offset:12800
    v_mfma_f32_16x16x32_bf16 v[208:211], a[228:231], v[84:87], v[208:211]
    ds_read_b64_tr_b16 a[250:251], v4 offset:992
    ds_read_b128 v[20:23], v9 offset:12832
    v_mfma_f32_16x16x32_bf16 v[240:243], a[224:227], v[88:91], v[240:243]
    ds_read_b64_tr_b16 a[252:253], v4 offset:17376
    v_fma_mix_f32 v32, v102, v24, v28 op_sel:[0,0,0] op_sel_hi:[1,0,0]
    v_mfma_f32_16x16x32_bf16 v[240:243], a[228:231], v[92:95], v[240:243]
    s_waitcnt vmcnt(16)
    s_barrier
    s_waitcnt lgkmcnt(9)
    ds_read_b64_tr_b16 a[254:255], v4 offset:17888
    v_fma_mix_f32 v33, v102, v25, v29 op_sel:[1,0,0] op_sel_hi:[1,0,0]
    v_fma_mix_f32 v34, v103, v26, v30 op_sel:[0,0,0] op_sel_hi:[1,0,0]
    v_mfma_f32_16x16x32_bf16 v[212:215], a[232:235], v[80:83], v[212:215]
    ds_read_b64_tr_b16 a[192:193], v4 offset:36864
    v_fma_mix_f32 v35, v103, v27, v31 op_sel:[1,0,0] op_sel_hi:[1,0,0]
    v_mfma_f32_16x16x32_bf16 v[212:215], a[236:239], v[84:87], v[212:215]
    ds_read_b64_tr_b16 a[194:195], v4 offset:37376
    ds_read_b64_tr_b16 a[196:197], v4 offset:53760
    v_cvt_pk_bf16_f32 v102, v32, v33
    v_mfma_f32_16x16x32_bf16 v[244:247], a[232:235], v[88:91], v[244:247]
    s_add_u32 m0, s44, 36864
    ds_read_b64_tr_b16 a[198:199], v4 offset:54272
    v_cvt_pk_bf16_f32 v103, v34, v35
    v_mfma_f32_16x16x32_bf16 v[244:247], a[236:239], v[92:95], v[244:247]
    s_mov_b32 s45, 4194304
    s_waitcnt lgkmcnt(10)
    buffer_load_dwordx4 v6, s[24:27], s45 offen lds
    v_mfma_f32_16x16x32_bf16 v[216:219], a[240:243], v[80:83], v[216:219]
    ds_read_b64_tr_b16 a[200:201], v4 offset:36896
    v_fma_mix_f32 v36, v110, v24, v28 op_sel:[0,0,0] op_sel_hi:[1,0,0]
    v_mfma_f32_16x16x32_bf16 v[216:219], a[244:247], v[84:87], v[216:219]
    ds_read_b64_tr_b16 a[202:203], v4 offset:37408
    ds_read_b64_tr_b16 a[204:205], v4 offset:53792
    v_fma_mix_f32 v37, v110, v25, v29 op_sel:[1,0,0] op_sel_hi:[1,0,0]
    v_mfma_f32_16x16x32_bf16 v[248:251], a[240:243], v[88:91], v[248:251]
    s_add_u32 m0, s44, 37920
    ds_read_b64_tr_b16 a[206:207], v4 offset:54304
    v_fma_mix_f32 v38, v111, v26, v30 op_sel:[0,0,0] op_sel_hi:[1,0,0]
    v_mfma_f32_16x16x32_bf16 v[248:251], a[244:247], v[92:95], v[248:251]
    s_mov_b32 s45, 4202496
    s_waitcnt lgkmcnt(8)
    buffer_load_dwordx4 v6, s[24:27], s45 offen lds
    v_mfma_f32_16x16x32_bf16 v[220:223], a[248:251], v[80:83], v[220:223]
    ds_read_b64_tr_b16 a[208:209], v4 offset:36928
    v_fma_mix_f32 v39, v111, v27, v31 op_sel:[1,0,0] op_sel_hi:[1,0,0]
    v_mfma_f32_16x16x32_bf16 v[220:223], a[252:255], v[84:87], v[220:223]
    ds_read_b64_tr_b16 a[210:211], v4 offset:37440
    ds_read_b64_tr_b16 a[212:213], v4 offset:53824
    v_cvt_pk_bf16_f32 v110, v36, v37
    v_mfma_f32_16x16x32_bf16 v[252:255], a[248:251], v[88:91], v[252:255]
    s_add_u32 m0, s44, 38976
    ds_read_b64_tr_b16 a[214:215], v4 offset:54336
    v_cvt_pk_bf16_f32 v111, v38, v39
    v_mfma_f32_16x16x32_bf16 v[252:255], a[252:255], v[92:95], v[252:255]
    s_mov_b32 s45, 4210688
    s_waitcnt lgkmcnt(8)
    buffer_load_dwordx4 v6, s[24:27], s45 offen lds
    v_mfma_f32_16x16x32_bf16 v[128:131], a[192:195], v[96:99], v[128:131]
    s_waitcnt vmcnt(15)
    ds_read_b64_tr_b16 a[216:217], v4 offset:36960
    ds_read_b128 v[24:27], v9 offset:12816
    v_mfma_f32_16x16x32_bf16 v[128:131], a[196:199], v[100:103], v[128:131]
    ds_read_b64_tr_b16 a[218:219], v4 offset:37472
    ds_read_b64_tr_b16 a[220:221], v4 offset:53856
    v_fma_mix_f32 v32, v112, v16, v20 op_sel:[0,0,0] op_sel_hi:[1,0,0]
    v_mfma_f32_16x16x32_bf16 v[160:163], a[192:195], v[104:107], v[160:163]
    s_add_u32 m0, s44, 40032
    ds_read_b64_tr_b16 a[222:223], v4 offset:54368
    ds_read_b128 v[28:31], v9 offset:12848
    v_mfma_f32_16x16x32_bf16 v[160:163], a[196:199], v[108:111], v[160:163]
    s_mov_b32 s45, 4218880
    s_waitcnt lgkmcnt(10)
    buffer_load_dwordx4 v6, s[24:27], s45 offen lds
    v_mfma_f32_16x16x32_bf16 v[132:135], a[200:203], v[96:99], v[132:135]
    ds_read_b64_tr_b16 a[224:225], v4 offset:36992
    v_fma_mix_f32 v33, v112, v17, v21 op_sel:[1,0,0] op_sel_hi:[1,0,0]
    v_mfma_f32_16x16x32_bf16 v[132:135], a[204:207], v[100:103], v[132:135]
    ds_read_b64_tr_b16 a[226:227], v4 offset:37504
    ds_read_b64_tr_b16 a[228:229], v4 offset:53888
    v_fma_mix_f32 v34, v113, v18, v22 op_sel:[0,0,0] op_sel_hi:[1,0,0]
    v_mfma_f32_16x16x32_bf16 v[164:167], a[200:203], v[104:107], v[164:167]
    s_add_u32 m0, s44, 53760
    ds_read_b64_tr_b16 a[230:231], v4 offset:54400
    v_fma_mix_f32 v35, v113, v19, v23 op_sel:[1,0,0] op_sel_hi:[1,0,0]
    v_mfma_f32_16x16x32_bf16 v[164:167], a[204:207], v[108:111], v[164:167]
    s_mov_b32 s45, 4456448
    s_waitcnt lgkmcnt(10)
    buffer_load_dwordx4 v6, s[24:27], s45 offen lds
    v_mfma_f32_16x16x32_bf16 v[136:139], a[208:211], v[96:99], v[136:139]
    ds_read_b64_tr_b16 a[232:233], v4 offset:37024
    v_cvt_pk_bf16_f32 v112, v32, v33
    v_mfma_f32_16x16x32_bf16 v[136:139], a[212:215], v[100:103], v[136:139]
    ds_read_b64_tr_b16 a[234:235], v4 offset:37536
    ds_read_b64_tr_b16 a[236:237], v4 offset:53920
    v_cvt_pk_bf16_f32 v113, v34, v35
    v_mfma_f32_16x16x32_bf16 v[168:171], a[208:211], v[104:107], v[168:171]
    s_add_u32 m0, s44, 54816
    ds_read_b64_tr_b16 a[238:239], v4 offset:54432
    v_fma_mix_f32 v36, v120, v16, v20 op_sel:[0,0,0] op_sel_hi:[1,0,0]
    v_mfma_f32_16x16x32_bf16 v[168:171], a[212:215], v[108:111], v[168:171]
    s_mov_b32 s45, 4464640
    s_waitcnt lgkmcnt(9)
    buffer_load_dwordx4 v6, s[24:27], s45 offen lds
    v_fma_mix_f32 v37, v120, v17, v21 op_sel:[1,0,0] op_sel_hi:[1,0,0]
    v_mfma_f32_16x16x32_bf16 v[140:143], a[216:219], v[96:99], v[140:143]
L2_pad2:
    s_cbranch_execz L2_pad6
    ds_read_b64_tr_b16 a[240:241], v4 offset:37056
    v_fma_mix_f32 v38, v121, v18, v22 op_sel:[0,0,0] op_sel_hi:[1,0,0]
    v_mfma_f32_16x16x32_bf16 v[140:143], a[220:223], v[100:103], v[140:143]
    ds_read_b64_tr_b16 a[242:243], v4 offset:37568
    ds_read_b64_tr_b16 a[244:245], v4 offset:53952
    v_fma_mix_f32 v39, v121, v19, v23 op_sel:[1,0,0] op_sel_hi:[1,0,0]
    v_mfma_f32_16x16x32_bf16 v[172:175], a[216:219], v[104:107], v[172:175]
    s_add_u32 m0, s44, 55872
    ds_read_b64_tr_b16 a[246:247], v4 offset:54464
    v_cvt_pk_bf16_f32 v120, v36, v37
    v_mfma_f32_16x16x32_bf16 v[172:175], a[220:223], v[108:111], v[172:175]
    s_mov_b32 s45, 4472832
    s_waitcnt lgkmcnt(8)
    buffer_load_dwordx4 v6, s[24:27], s45 offen lds
    v_cvt_pk_bf16_f32 v121, v38, v39
    v_mfma_f32_16x16x32_bf16 v[144:147], a[224:227], v[96:99], v[144:147]
    ds_read_b64_tr_b16 a[248:249], v4 offset:37088
    ds_read_b128 v[16:19], v9 offset:13056
    v_mfma_f32_16x16x32_bf16 v[144:147], a[228:231], v[100:103], v[144:147]
    ds_read_b64_tr_b16 a[250:251], v4 offset:37600
    ds_read_b64_tr_b16 a[252:253], v4 offset:53984
    v_mfma_f32_16x16x32_bf16 v[176:179], a[224:227], v[104:107], v[176:179]
    s_add_u32 m0, s44, 56928
    ds_read_b64_tr_b16 a[254:255], v4 offset:54496
    ds_read_b128 v[20:23], v9 offset:13088
    v_mfma_f32_16x16x32_bf16 v[176:179], a[228:231], v[108:111], v[176:179]
    s_mov_b32 s45, 4481024
    s_waitcnt lgkmcnt(10)
    buffer_load_dwordx4 v6, s[24:27], s45 offen lds
    v_mfma_f32_16x16x32_bf16 v[148:151], a[232:235], v[96:99], v[148:151]
    ds_read_b64_tr_b16 a[192:193], v4 offset:37120
    v_fma_mix_f32 v32, v114, v24, v28 op_sel:[0,0,0] op_sel_hi:[1,0,0]
    v_mfma_f32_16x16x32_bf16 v[148:151], a[236:239], v[100:103], v[148:151]
    ds_read_b64_tr_b16 a[194:195], v4 offset:37632
    v_fma_mix_f32 v33, v114, v25, v29 op_sel:[1,0,0] op_sel_hi:[1,0,0]
    v_mfma_f32_16x16x32_bf16 v[180:183], a[232:235], v[104:107], v[180:183]
    ds_read_b64_tr_b16 a[196:197], v4 offset:54016
    v_fma_mix_f32 v34, v115, v26, v30 op_sel:[0,0,0] op_sel_hi:[1,0,0]
    v_mfma_f32_16x16x32_bf16 v[180:183], a[236:239], v[108:111], v[180:183]
    s_waitcnt lgkmcnt(9)
    ds_read_b64_tr_b16 a[198:199], v4 offset:54528
    v_fma_mix_f32 v35, v115, v27, v31 op_sel:[1,0,0] op_sel_hi:[1,0,0]
    v_mfma_f32_16x16x32_bf16 v[152:155], a[240:243], v[96:99], v[152:155]
    ds_read_b64_tr_b16 a[200:201], v4 offset:37152
    v_cvt_pk_bf16_f32 v114, v32, v33
    v_mfma_f32_16x16x32_bf16 v[152:155], a[244:247], v[100:103], v[152:155]
    ds_read_b64_tr_b16 a[202:203], v4 offset:37664
    v_cvt_pk_bf16_f32 v115, v34, v35
    v_mfma_f32_16x16x32_bf16 v[184:187], a[240:243], v[104:107], v[184:187]
    ds_read_b64_tr_b16 a[204:205], v4 offset:54048
    v_fma_mix_f32 v36, v122, v24, v28 op_sel:[0,0,0] op_sel_hi:[1,0,0]
    v_mfma_f32_16x16x32_bf16 v[184:187], a[244:247], v[108:111], v[184:187]
    s_waitcnt lgkmcnt(8)
    ds_read_b64_tr_b16 a[206:207], v4 offset:54560
    v_fma_mix_f32 v37, v122, v25, v29 op_sel:[1,0,0] op_sel_hi:[1,0,0]
    v_mfma_f32_16x16x32_bf16 v[156:159], a[248:251], v[96:99], v[156:159]
    ds_read_b64_tr_b16 a[208:209], v4 offset:37184
    v_fma_mix_f32 v38, v123, v26, v30 op_sel:[0,0,0] op_sel_hi:[1,0,0]
    v_mfma_f32_16x16x32_bf16 v[156:159], a[252:255], v[100:103], v[156:159]
    ds_read_b64_tr_b16 a[210:211], v4 offset:37696
    v_fma_mix_f32 v39, v123, v27, v31 op_sel:[1,0,0] op_sel_hi:[1,0,0]
    v_mfma_f32_16x16x32_bf16 v[188:191], a[248:251], v[104:107], v[188:191]
    ds_read_b64_tr_b16 a[212:213], v4 offset:54080
    v_cvt_pk_bf16_f32 v122, v36, v37
    v_mfma_f32_16x16x32_bf16 v[188:191], a[252:255], v[108:111], v[188:191]
    s_waitcnt lgkmcnt(7)
    ds_read_b64_tr_b16 a[214:215], v4 offset:54592
    v_cvt_pk_bf16_f32 v123, v38, v39
    v_mfma_f32_16x16x32_bf16 v[192:195], a[192:195], v[96:99], v[192:195]
    ds_read_b64_tr_b16 a[216:217], v4 offset:37216
    ds_read_b128 v[24:27], v9 offset:13072
    v_mfma_f32_16x16x32_bf16 v[192:195], a[196:199], v[100:103], v[192:195]
    ds_read_b64_tr_b16 a[218:219], v4 offset:37728
    ds_read_b128 v[28:31], v9 offset:13104
    v_mfma_f32_16x16x32_bf16 v[224:227], a[192:195], v[104:107], v[224:227]
    ds_read_b64_tr_b16 a[220:221], v4 offset:54112
    v_fma_mix_f32 v32, v116, v16, v20 op_sel:[0,0,0] op_sel_hi:[1,0,0]
    v_mfma_f32_16x16x32_bf16 v[224:227], a[196:199], v[108:111], v[224:227]
    s_waitcnt lgkmcnt(9)
    ds_read_b64_tr_b16 a[222:223], v4 offset:54624
    v_fma_mix_f32 v33, v116, v17, v21 op_sel:[1,0,0] op_sel_hi:[1,0,0]
    v_mfma_f32_16x16x32_bf16 v[196:199], a[200:203], v[96:99], v[196:199]
    ds_read_b64_tr_b16 a[224:225], v4 offset:37248
    v_fma_mix_f32 v34, v117, v18, v22 op_sel:[0,0,0] op_sel_hi:[1,0,0]
    v_mfma_f32_16x16x32_bf16 v[196:199], a[204:207], v[100:103], v[196:199]
    ds_read_b64_tr_b16 a[226:227], v4 offset:37760
    v_fma_mix_f32 v35, v117, v19, v23 op_sel:[1,0,0] op_sel_hi:[1,0,0]
    v_mfma_f32_16x16x32_bf16 v[228:231], a[200:203], v[104:107], v[228:231]
    ds_read_b64_tr_b16 a[228:229], v4 offset:54144
    v_cvt_pk_bf16_f32 v116, v32, v33
    v_mfma_f32_16x16x32_bf16 v[228:231], a[204:207], v[108:111], v[228:231]
    s_waitcnt lgkmcnt(9)
    ds_read_b64_tr_b16 a[230:231], v4 offset:54656
    v_cvt_pk_bf16_f32 v117, v34, v35
    v_mfma_f32_16x16x32_bf16 v[200:203], a[208:211], v[96:99], v[200:203]
    ds_read_b64_tr_b16 a[232:233], v4 offset:37280
    v_fma_mix_f32 v36, v124, v16, v20 op_sel:[0,0,0] op_sel_hi:[1,0,0]
    v_mfma_f32_16x16x32_bf16 v[200:203], a[212:215], v[100:103], v[200:203]
    ds_read_b64_tr_b16 a[234:235], v4 offset:37792
    v_fma_mix_f32 v37, v124, v17, v21 op_sel:[1,0,0] op_sel_hi:[1,0,0]
    v_mfma_f32_16x16x32_bf16 v[232:235], a[208:211], v[104:107], v[232:235]
    ds_read_b64_tr_b16 a[236:237], v4 offset:54176
    v_fma_mix_f32 v38, v125, v18, v22 op_sel:[0,0,0] op_sel_hi:[1,0,0]
    v_mfma_f32_16x16x32_bf16 v[232:235], a[212:215], v[108:111], v[232:235]
    s_waitcnt lgkmcnt(7)
    ds_read_b64_tr_b16 a[238:239], v4 offset:54688
    v_fma_mix_f32 v39, v125, v19, v23 op_sel:[1,0,0] op_sel_hi:[1,0,0]
    v_mfma_f32_16x16x32_bf16 v[204:207], a[216:219], v[96:99], v[204:207]
    ds_read_b64_tr_b16 a[240:241], v4 offset:37312
    v_cvt_pk_bf16_f32 v124, v36, v37
    v_mfma_f32_16x16x32_bf16 v[204:207], a[220:223], v[100:103], v[204:207]
    ds_read_b64_tr_b16 a[242:243], v4 offset:37824
    v_cvt_pk_bf16_f32 v125, v38, v39
    v_mfma_f32_16x16x32_bf16 v[236:239], a[216:219], v[104:107], v[236:239]
    ds_read_b64_tr_b16 a[244:245], v4 offset:54208
    v_mfma_f32_16x16x32_bf16 v[236:239], a[220:223], v[108:111], v[236:239]
    s_waitcnt lgkmcnt(7)
    ds_read_b64_tr_b16 a[246:247], v4 offset:54720
    v_mfma_f32_16x16x32_bf16 v[208:211], a[224:227], v[96:99], v[208:211]
    ds_read_b64_tr_b16 a[248:249], v4 offset:37344
    ds_read_b128 v[16:19], v9 offset:13312
    v_mfma_f32_16x16x32_bf16 v[208:211], a[228:231], v[100:103], v[208:211]
    ds_read_b64_tr_b16 a[250:251], v4 offset:37856
    ds_read_b128 v[20:23], v9 offset:13344
    v_mfma_f32_16x16x32_bf16 v[240:243], a[224:227], v[104:107], v[240:243]
    ds_read_b64_tr_b16 a[252:253], v4 offset:54240
    v_fma_mix_f32 v32, v118, v24, v28 op_sel:[0,0,0] op_sel_hi:[1,0,0]
    v_mfma_f32_16x16x32_bf16 v[240:243], a[228:231], v[108:111], v[240:243]
    s_waitcnt vmcnt(12)
    s_barrier
    s_waitcnt lgkmcnt(9)
    ds_read_b64_tr_b16 a[254:255], v4 offset:54752
    v_fma_mix_f32 v33, v118, v25, v29 op_sel:[1,0,0] op_sel_hi:[1,0,0]
    v_fma_mix_f32 v34, v119, v26, v30 op_sel:[0,0,0] op_sel_hi:[1,0,0]
    v_mfma_f32_16x16x32_bf16 v[212:215], a[232:235], v[96:99], v[212:215]
    ds_read_b64_tr_b16 a[192:193], v3 offset:0
    v_fma_mix_f32 v35, v119, v27, v31 op_sel:[1,0,0] op_sel_hi:[1,0,0]
    v_mfma_f32_16x16x32_bf16 v[212:215], a[236:239], v[100:103], v[212:215]
    ds_read_b64_tr_b16 a[194:195], v3 offset:512
    ds_read_b64_tr_b16 a[196:197], v3 offset:16896
    v_cvt_pk_bf16_f32 v118, v32, v33
    v_mfma_f32_16x16x32_bf16 v[244:247], a[232:235], v[104:107], v[244:247]
    s_add_u32 m0, s44, 73728
    ds_read_b64_tr_b16 a[198:199], v3 offset:17408
    v_cvt_pk_bf16_f32 v119, v34, v35
    v_mfma_f32_16x16x32_bf16 v[244:247], a[236:239], v[108:111], v[244:247]
    s_mov_b32 s46, 0
    s_waitcnt lgkmcnt(10)
    buffer_load_dwordx4 v5, s[16:19], s46 offen offset:0 lds
    v_mfma_f32_16x16x32_bf16 v[216:219], a[240:243], v[96:99], v[216:219]
    ds_read_b64_tr_b16 a[200:201], v3 offset:32
    v_fma_mix_f32 v36, v126, v24, v28 op_sel:[0,0,0] op_sel_hi:[1,0,0]
    v_mfma_f32_16x16x32_bf16 v[216:219], a[244:247], v[100:103], v[216:219]
    ds_read_b64_tr_b16 a[202:203], v3 offset:544
    ds_read_b64_tr_b16 a[204:205], v3 offset:16928
    v_fma_mix_f32 v37, v126, v25, v29 op_sel:[1,0,0] op_sel_hi:[1,0,0]
    v_mfma_f32_16x16x32_bf16 v[248:251], a[240:243], v[104:107], v[248:251]
    s_add_u32 m0, s44, 73760
    ds_read_b64_tr_b16 a[206:207], v3 offset:17440
    v_fma_mix_f32 v38, v127, v26, v30 op_sel:[0,0,0] op_sel_hi:[1,0,0]
    v_mfma_f32_16x16x32_bf16 v[248:251], a[244:247], v[108:111], v[248:251]
    s_waitcnt lgkmcnt(8)
    buffer_load_dwordx4 v5, s[16:19], s46 offen offset:1024 lds
    v_mfma_f32_16x16x32_bf16 v[220:223], a[248:251], v[96:99], v[220:223]
    ds_read_b64_tr_b16 a[208:209], v3 offset:64
    v_fma_mix_f32 v39, v127, v27, v31 op_sel:[1,0,0] op_sel_hi:[1,0,0]
    v_mfma_f32_16x16x32_bf16 v[220:223], a[252:255], v[100:103], v[220:223]
    ds_read_b64_tr_b16 a[210:211], v3 offset:576
    ds_read_b64_tr_b16 a[212:213], v3 offset:16960
    v_cvt_pk_bf16_f32 v126, v36, v37
    v_mfma_f32_16x16x32_bf16 v[252:255], a[248:251], v[104:107], v[252:255]
    s_add_u32 m0, s44, 73792
    ds_read_b64_tr_b16 a[214:215], v3 offset:17472
    v_cvt_pk_bf16_f32 v127, v38, v39
    v_mfma_f32_16x16x32_bf16 v[252:255], a[252:255], v[108:111], v[252:255]
    s_waitcnt lgkmcnt(8)
    buffer_load_dwordx4 v5, s[16:19], s46 offen offset:2048 lds
    v_mfma_f32_16x16x32_bf16 v[128:131], a[192:195], v[112:115], v[128:131]
    s_waitcnt vmcnt(11)
    ds_read_b64_tr_b16 a[216:217], v3 offset:96
    ds_read_b128 v[24:27], v9 offset:13328
    v_mfma_f32_16x16x32_bf16 v[128:131], a[196:199], v[116:119], v[128:131]
    ds_read_b64_tr_b16 a[218:219], v3 offset:608
    ds_read_b64_tr_b16 a[220:221], v3 offset:16992
    v_fma_mix_f32 v32, v48, v16, v20 op_sel:[0,0,0] op_sel_hi:[1,0,0]
    v_mfma_f32_16x16x32_bf16 v[160:163], a[192:195], v[120:123], v[160:163]
    s_add_u32 m0, s44, 73824
    ds_read_b64_tr_b16 a[222:223], v3 offset:17504
    ds_read_b128 v[28:31], v9 offset:13360
    v_mfma_f32_16x16x32_bf16 v[160:163], a[196:199], v[124:127], v[160:163]
    s_waitcnt lgkmcnt(10)
    buffer_load_dwordx4 v5, s[16:19], s46 offen offset:3072 lds
    v_mfma_f32_16x16x32_bf16 v[132:135], a[200:203], v[112:115], v[132:135]
    ds_read_b64_tr_b16 a[224:225], v3 offset:128
    v_fma_mix_f32 v33, v48, v17, v21 op_sel:[1,0,0] op_sel_hi:[1,0,0]
    v_mfma_f32_16x16x32_bf16 v[132:135], a[204:207], v[116:119], v[132:135]
    ds_read_b64_tr_b16 a[226:227], v3 offset:640
    ds_read_b64_tr_b16 a[228:229], v3 offset:17024
    v_fma_mix_f32 v34, v49, v18, v22 op_sel:[0,0,0] op_sel_hi:[1,0,0]
    v_mfma_f32_16x16x32_bf16 v[164:167], a[200:203], v[120:123], v[164:167]
    s_add_u32 m0, s44, 90624
    ds_read_b64_tr_b16 a[230:231], v3 offset:17536
    v_fma_mix_f32 v35, v49, v19, v23 op_sel:[1,0,0] op_sel_hi:[1,0,0]
    v_mfma_f32_16x16x32_bf16 v[164:167], a[204:207], v[124:127], v[164:167]
    s_waitcnt lgkmcnt(10)
    buffer_load_dwordx4 v5, s[20:23], s46 offen offset:0 lds
    v_mfma_f32_16x16x32_bf16 v[136:139], a[208:211], v[112:115], v[136:139]
    ds_read_b64_tr_b16 a[232:233], v3 offset:160
    v_cvt_pk_bf16_f32 v48, v32, v33
    v_mfma_f32_16x16x32_bf16 v[136:139], a[212:215], v[116:119], v[136:139]
    ds_read_b64_tr_b16 a[234:235], v3 offset:672
    ds_read_b64_tr_b16 a[236:237], v3 offset:17056
    v_cvt_pk_bf16_f32 v49, v34, v35
    v_mfma_f32_16x16x32_bf16 v[168:171], a[208:211], v[120:123], v[168:171]
    s_add_u32 m0, s44, 90656
    ds_read_b64_tr_b16 a[238:239], v3 offset:17568
    v_fma_mix_f32 v36, v56, v16, v20 op_sel:[0,0,0] op_sel_hi:[1,0,0]
    v_mfma_f32_16x16x32_bf16 v[168:171], a[212:215], v[124:127], v[168:171]
    s_waitcnt lgkmcnt(9)
    buffer_load_dwordx4 v5, s[20:23], s46 offen offset:1024 lds
    v_fma_mix_f32 v37, v56, v17, v21 op_sel:[1,0,0] op_sel_hi:[1,0,0]
    v_mfma_f32_16x16x32_bf16 v[140:143], a[216:219], v[112:115], v[140:143]
    ds_read_b64_tr_b16 a[240:241], v3 offset:192
    v_fma_mix_f32 v38, v57, v18, v22 op_sel:[0,0,0] op_sel_hi:[1,0,0]
    v_mfma_f32_16x16x32_bf16 v[140:143], a[220:223], v[116:119], v[140:143]
    ds_read_b64_tr_b16 a[242:243], v3 offset:704
    ds_read_b64_tr_b16 a[244:245], v3 offset:17088
    v_fma_mix_f32 v39, v57, v19, v23 op_sel:[1,0,0] op_sel_hi:[1,0,0]
    v_mfma_f32_16x16x32_bf16 v[172:175], a[216:219], v[120:123], v[172:175]
    s_add_u32 m0, s44, 90688
    ds_read_b64_tr_b16 a[246:247], v3 offset:17600
    v_cvt_pk_bf16_f32 v56, v36, v37
    v_mfma_f32_16x16x32_bf16 v[172:175], a[220:223], v[124:127], v[172:175]
    s_waitcnt lgkmcnt(8)
    buffer_load_dwordx4 v5, s[20:23], s46 offen offset:2048 lds
    v_cvt_pk_bf16_f32 v57, v38, v39
    v_mfma_f32_16x16x32_bf16 v[144:147], a[224:227], v[112:115], v[144:147]
    ds_read_b64_tr_b16 a[248:249], v3 offset:224
    ds_read_b128 v[16:19], v9 offset:13568
    v_mfma_f32_16x16x32_bf16 v[144:147], a[228:231], v[116:119], v[144:147]
    ds_read_b64_tr_b16 a[250:251], v3 offset:736
    ds_read_b64_tr_b16 a[252:253], v3 offset:17120
    v_mfma_f32_16x16x32_bf16 v[176:179], a[224:227], v[120:123], v[176:179]
    s_add_u32 m0, s44, 90720
    ds_read_b64_tr_b16 a[254:255], v3 offset:17632
    ds_read_b128 v[20:23], v9 offset:13600
    v_mfma_f32_16x16x32_bf16 v[176:179], a[228:231], v[124:127], v[176:179]
    s_waitcnt lgkmcnt(10)
    buffer_load_dwordx4 v5, s[20:23], s46 offen offset:3072 lds
    v_mfma_f32_16x16x32_bf16 v[148:151], a[232:235], v[112:115], v[148:151]
    ds_read_b64_tr_b16 a[192:193], v3 offset:256
    v_fma_mix_f32 v32, v50, v24, v28 op_sel:[0,0,0] op_sel_hi:[1,0,0]
    v_mfma_f32_16x16x32_bf16 v[148:151], a[236:239], v[116:119], v[148:151]
    ds_read_b64_tr_b16 a[194:195], v3 offset:768
    v_fma_mix_f32 v33, v50, v25, v29 op_sel:[1,0,0] op_sel_hi:[1,0,0]
    v_mfma_f32_16x16x32_bf16 v[180:183], a[232:235], v[120:123], v[180:183]
    ds_read_b64_tr_b16 a[196:197], v3 offset:17152
    v_fma_mix_f32 v34, v51, v26, v30 op_sel:[0,0,0] op_sel_hi:[1,0,0]
    v_mfma_f32_16x16x32_bf16 v[180:183], a[236:239], v[124:127], v[180:183]
    s_waitcnt lgkmcnt(9)
    ds_read_b64_tr_b16 a[198:199], v3 offset:17664
    v_fma_mix_f32 v35, v51, v27, v31 op_sel:[1,0,0] op_sel_hi:[1,0,0]
    v_mfma_f32_16x16x32_bf16 v[152:155], a[240:243], v[112:115], v[152:155]
    ds_read_b64_tr_b16 a[200:201], v3 offset:288
    v_cvt_pk_bf16_f32 v50, v32, v33
    v_mfma_f32_16x16x32_bf16 v[152:155], a[244:247], v[116:119], v[152:155]
    ds_read_b64_tr_b16 a[202:203], v3 offset:800
    v_cvt_pk_bf16_f32 v51, v34, v35
    v_mfma_f32_16x16x32_bf16 v[184:187], a[240:243], v[120:123], v[184:187]
    ds_read_b64_tr_b16 a[204:205], v3 offset:17184
    v_fma_mix_f32 v36, v58, v24, v28 op_sel:[0,0,0] op_sel_hi:[1,0,0]
    v_mfma_f32_16x16x32_bf16 v[184:187], a[244:247], v[124:127], v[184:187]
    s_waitcnt lgkmcnt(8)
    ds_read_b64_tr_b16 a[206:207], v3 offset:17696
    v_fma_mix_f32 v37, v58, v25, v29 op_sel:[1,0,0] op_sel_hi:[1,0,0]
    v_mfma_f32_16x16x32_bf16 v[156:159], a[248:251], v[112:115], v[156:159]
    ds_read_b64_tr_b16 a[208:209], v3 offset:320
    v_fma_mix_f32 v38, v59, v26, v30 op_sel:[0,0,0] op_sel_hi:[1,0,0]
    v_mfma_f32_16x16x32_bf16 v[156:159], a[252:255], v[116:119], v[156:159]
    ds_read_b64_tr_b16 a[210:211], v3 offset:832
    v_fma_mix_f32 v39, v59, v27, v31 op_sel:[1,0,0] op_sel_hi:[1,0,0]
    v_mfma_f32_16x16x32_bf16 v[188:191], a[248:251], v[120:123], v[188:191]
    ds_read_b64_tr_b16 a[212:213], v3 offset:17216
    v_cvt_pk_bf16_f32 v58, v36, v37
    v_mfma_f32_16x16x32_bf16 v[188:191], a[252:255], v[124:127], v[188:191]
    s_waitcnt lgkmcnt(7)
    ds_read_b64_tr_b16 a[214:215], v3 offset:17728
    v_cvt_pk_bf16_f32 v59, v38, v39
    v_mfma_f32_16x16x32_bf16 v[192:195], a[192:195], v[112:115], v[192:195]
    ds_read_b64_tr_b16 a[216:217], v3 offset:352
    ds_read_b128 v[24:27], v9 offset:13584
    v_mfma_f32_16x16x32_bf16 v[192:195], a[196:199], v[116:119], v[192:195]
    ds_read_b64_tr_b16 a[218:219], v3 offset:864
    ds_read_b128 v[28:31], v9 offset:13616
    v_mfma_f32_16x16x32_bf16 v[224:227], a[192:195], v[120:123], v[224:227]
    ds_read_b64_tr_b16 a[220:221], v3 offset:17248
    v_fma_mix_f32 v32, v52, v16, v20 op_sel:[0,0,0] op_sel_hi:[1,0,0]
    v_mfma_f32_16x16x32_bf16 v[224:227], a[196:199], v[124:127], v[224:227]
    s_waitcnt lgkmcnt(9)
    ds_read_b64_tr_b16 a[222:223], v3 offset:17760
    v_fma_mix_f32 v33, v52, v17, v21 op_sel:[1,0,0] op_sel_hi:[1,0,0]
    v_mfma_f32_16x16x32_bf16 v[196:199], a[200:203], v[112:115], v[196:199]
    ds_read_b64_tr_b16 a[224:225], v3 offset:384
    v_fma_mix_f32 v34, v53, v18, v22 op_sel:[0,0,0] op_sel_hi:[1,0,0]
    v_mfma_f32_16x16x32_bf16 v[196:199], a[204:207], v[116:119], v[196:199]
    ds_read_b64_tr_b16 a[226:227], v3 offset:896
    v_fma_mix_f32 v35, v53, v19, v23 op_sel:[1,0,0] op_sel_hi:[1,0,0]
    v_mfma_f32_16x16x32_bf16 v[228:231], a[200:203], v[120:123], v[228:231]
    ds_read_b64_tr_b16 a[228:229], v3 offset:17280
    v_cvt_pk_bf16_f32 v52, v32, v33
    v_mfma_f32_16x16x32_bf16 v[228:231], a[204:207], v[124:127], v[228:231]
    s_waitcnt lgkmcnt(9)
    ds_read_b64_tr_b16 a[230:231], v3 offset:17792
    v_cvt_pk_bf16_f32 v53, v34, v35
    v_mfma_f32_16x16x32_bf16 v[200:203], a[208:211], v[112:115], v[200:203]
    ds_read_b64_tr_b16 a[232:233], v3 offset:416
    v_fma_mix_f32 v36, v60, v16, v20 op_sel:[0,0,0] op_sel_hi:[1,0,0]
    v_mfma_f32_16x16x32_bf16 v[200:203], a[212:215], v[116:119], v[200:203]
    ds_read_b64_tr_b16 a[234:235], v3 offset:928
    v_fma_mix_f32 v37, v60, v17, v21 op_sel:[1,0,0] op_sel_hi:[1,0,0]
    v_mfma_f32_16x16x32_bf16 v[232:235], a[208:211], v[120:123], v[232:235]
    ds_read_b64_tr_b16 a[236:237], v3 offset:17312
    v_fma_mix_f32 v38, v61, v18, v22 op_sel:[0,0,0] op_sel_hi:[1,0,0]
    v_mfma_f32_16x16x32_bf16 v[232:235], a[212:215], v[124:127], v[232:235]
    s_waitcnt lgkmcnt(7)
    ds_read_b64_tr_b16 a[238:239], v3 offset:17824
    v_fma_mix_f32 v39, v61, v19, v23 op_sel:[1,0,0] op_sel_hi:[1,0,0]
    v_mfma_f32_16x16x32_bf16 v[204:207], a[216:219], v[112:115], v[204:207]
    ds_read_b64_tr_b16 a[240:241], v3 offset:448
    v_cvt_pk_bf16_f32 v60, v36, v37
    v_mfma_f32_16x16x32_bf16 v[204:207], a[220:223], v[116:119], v[204:207]
    ds_read_b64_tr_b16 a[242:243], v3 offset:960
    v_cvt_pk_bf16_f32 v61, v38, v39
    v_mfma_f32_16x16x32_bf16 v[236:239], a[216:219], v[120:123], v[236:239]
    ds_read_b64_tr_b16 a[244:245], v3 offset:17344
    v_mfma_f32_16x16x32_bf16 v[236:239], a[220:223], v[124:127], v[236:239]
    s_waitcnt lgkmcnt(7)
    ds_read_b64_tr_b16 a[246:247], v3 offset:17856
    v_mfma_f32_16x16x32_bf16 v[208:211], a[224:227], v[112:115], v[208:211]
    ds_read_b64_tr_b16 a[248:249], v3 offset:480
    v_fma_mix_f32 v32, v54, v24, v28 op_sel:[0,0,0] op_sel_hi:[1,0,0]
    v_mfma_f32_16x16x32_bf16 v[208:211], a[228:231], v[116:119], v[208:211]
    ds_read_b64_tr_b16 a[250:251], v3 offset:992
    v_fma_mix_f32 v33, v54, v25, v29 op_sel:[1,0,0] op_sel_hi:[1,0,0]
    v_mfma_f32_16x16x32_bf16 v[240:243], a[224:227], v[120:123], v[240:243]
    ds_read_b64_tr_b16 a[252:253], v3 offset:17376
    v_fma_mix_f32 v34, v55, v26, v30 op_sel:[0,0,0] op_sel_hi:[1,0,0]
    v_mfma_f32_16x16x32_bf16 v[240:243], a[228:231], v[124:127], v[240:243]
    s_waitcnt vmcnt(8)
    s_barrier
    s_waitcnt lgkmcnt(7)
    ds_read_b64_tr_b16 a[254:255], v3 offset:17888
    v_fma_mix_f32 v35, v55, v27, v31 op_sel:[1,0,0] op_sel_hi:[1,0,0]
    v_mfma_f32_16x16x32_bf16 v[212:215], a[232:235], v[112:115], v[212:215]
    ds_read_b64_tr_b16 a[192:193], v3 offset:36864
    v_cvt_pk_bf16_f32 v54, v32, v33
    v_mfma_f32_16x16x32_bf16 v[212:215], a[236:239], v[116:119], v[212:215]
    ds_read_b64_tr_b16 a[194:195], v3 offset:37376
    ds_read_b64_tr_b16 a[196:197], v3 offset:53760
    v_mfma_f32_16x16x32_bf16 v[244:247], a[232:235], v[120:123], v[244:247]
    s_add_u32 m0, s44, 110592
    ds_read_b64_tr_b16 a[198:199], v3 offset:54272
    v_cvt_pk_bf16_f32 v55, v34, v35
    v_mfma_f32_16x16x32_bf16 v[244:247], a[236:239], v[124:127], v[244:247]
    s_mov_b32 s46, 16384
    s_waitcnt lgkmcnt(8)
    buffer_load_dwordx4 v5, s[16:19], s46 offen offset:0 lds
    v_mfma_f32_16x16x32_bf16 v[216:219], a[240:243], v[112:115], v[216:219]
    ds_read_b64_tr_b16 a[200:201], v3 offset:36896
    v_fma_mix_f32 v36, v62, v24, v28 op_sel:[0,0,0] op_sel_hi:[1,0,0]
    v_mfma_f32_16x16x32_bf16 v[216:219], a[244:247], v[116:119], v[216:219]
    ds_read_b64_tr_b16 a[202:203], v3 offset:37408
    ds_read_b64_tr_b16 a[204:205], v3 offset:53792
    v_fma_mix_f32 v37, v62, v25, v29 op_sel:[1,0,0] op_sel_hi:[1,0,0]
    v_mfma_f32_16x16x32_bf16 v[248:251], a[240:243], v[120:123], v[248:251]
    s_add_u32 m0, s44, 110624
    ds_read_b64_tr_b16 a[206:207], v3 offset:54304
    v_fma_mix_f32 v38, v63, v26, v30 op_sel:[0,0,0] op_sel_hi:[1,0,0]
    v_mfma_f32_16x16x32_bf16 v[248:251], a[244:247], v[124:127], v[248:251]
    s_waitcnt lgkmcnt(8)
    buffer_load_dwordx4 v5, s[16:19], s46 offen offset:1024 lds
    v_mfma_f32_16x16x32_bf16 v[220:223], a[248:251], v[112:115], v[220:223]
    ds_read_b64_tr_b16 a[208:209], v3 offset:36928
    v_fma_mix_f32 v39, v63, v27, v31 op_sel:[1,0,0] op_sel_hi:[1,0,0]
    v_mfma_f32_16x16x32_bf16 v[220:223], a[252:255], v[116:119], v[220:223]
    ds_read_b64_tr_b16 a[210:211], v3 offset:37440
    ds_read_b64_tr_b16 a[212:213], v3 offset:53824
    v_cvt_pk_bf16_f32 v62, v36, v37
    v_mfma_f32_16x16x32_bf16 v[252:255], a[248:251], v[120:123], v[252:255]
    s_add_u32 m0, s44, 110656
    ds_read_b64_tr_b16 a[214:215], v3 offset:54336
    v_cvt_pk_bf16_f32 v63, v38, v39
    v_mfma_f32_16x16x32_bf16 v[252:255], a[252:255], v[124:127], v[252:255]
    s_waitcnt lgkmcnt(8)
    buffer_load_dwordx4 v5, s[16:19], s46 offen offset:2048 lds
    v_mfma_f32_16x16x32_bf16 v[128:131], a[192:195], v[48:51], v[128:131]
    ds_read_b64_tr_b16 a[216:217], v3 offset:36960
    v_mfma_f32_16x16x32_bf16 v[128:131], a[196:199], v[52:55], v[128:131]
    ds_read_b64_tr_b16 a[218:219], v3 offset:37472
    ds_read_b64_tr_b16 a[220:221], v3 offset:53856
    v_mfma_f32_16x16x32_bf16 v[160:163], a[192:195], v[56:59], v[160:163]
    s_add_u32 m0, s44, 110688
    ds_read_b64_tr_b16 a[222:223], v3 offset:54368
    v_mfma_f32_16x16x32_bf16 v[160:163], a[196:199], v[60:63], v[160:163]
    s_waitcnt lgkmcnt(8)
    buffer_load_dwordx4 v5, s[16:19], s46 offen offset:3072 lds
    v_mfma_f32_16x16x32_bf16 v[132:135], a[200:203], v[48:51], v[132:135]
    ds_read_b64_tr_b16 a[224:225], v3 offset:36992
    v_mfma_f32_16x16x32_bf16 v[132:135], a[204:207], v[52:55], v[132:135]
    ds_read_b64_tr_b16 a[226:227], v3 offset:37504
    ds_read_b64_tr_b16 a[228:229], v3 offset:53888
    v_mfma_f32_16x16x32_bf16 v[164:167], a[200:203], v[56:59], v[164:167]
    s_add_u32 m0, s44, 127488
    ds_read_b64_tr_b16 a[230:231], v3 offset:54400
    v_mfma_f32_16x16x32_bf16 v[164:167], a[204:207], v[60:63], v[164:167]
    s_waitcnt lgkmcnt(8)
    buffer_load_dwordx4 v5, s[20:23], s46 offen offset:0 lds
    v_mfma_f32_16x16x32_bf16 v[136:139], a[208:211], v[48:51], v[136:139]
    ds_read_b64_tr_b16 a[232:233], v3 offset:37024
    v_mfma_f32_16x16x32_bf16 v[136:139], a[212:215], v[52:55], v[136:139]
    ds_read_b64_tr_b16 a[234:235], v3 offset:37536
    ds_read_b64_tr_b16 a[236:237], v3 offset:53920
    v_mfma_f32_16x16x32_bf16 v[168:171], a[208:211], v[56:59], v[168:171]
    s_add_u32 m0, s44, 127520
    ds_read_b64_tr_b16 a[238:239], v3 offset:54432
    v_mfma_f32_16x16x32_bf16 v[168:171], a[212:215], v[60:63], v[168:171]
    s_waitcnt lgkmcnt(8)
    buffer_load_dwordx4 v5, s[20:23], s46 offen offset:1024 lds
    v_mfma_f32_16x16x32_bf16 v[140:143], a[216:219], v[48:51], v[140:143]
    ds_read_b64_tr_b16 a[240:241], v3 offset:37056
    v_cvt_pk_bf16_f32 v64, v128, v129
    v_mfma_f32_16x16x32_bf16 v[140:143], a[220:223], v[52:55], v[140:143]
    ds_read_b64_tr_b16 a[242:243], v3 offset:37568
    ds_read_b64_tr_b16 a[244:245], v3 offset:53952
    v_mfma_f32_16x16x32_bf16 v[172:175], a[216:219], v[56:59], v[172:175]
    s_add_u32 m0, s44, 127552
    ds_read_b64_tr_b16 a[246:247], v3 offset:54464
    v_cvt_pk_bf16_f32 v65, v130, v131
    v_mfma_f32_16x16x32_bf16 v[172:175], a[220:223], v[60:63], v[172:175]
    s_waitcnt lgkmcnt(8)
    buffer_load_dwordx4 v5, s[20:23], s46 offen offset:2048 lds
    v_mfma_f32_16x16x32_bf16 v[144:147], a[224:227], v[48:51], v[144:147]
    ds_read_b64_tr_b16 a[248:249], v3 offset:37088
    v_cvt_pk_bf16_f32 v66, v132, v133
    v_mfma_f32_16x16x32_bf16 v[144:147], a[228:231], v[52:55], v[144:147]
    ds_read_b64_tr_b16 a[250:251], v3 offset:37600
    ds_read_b64_tr_b16 a[252:253], v3 offset:53984
    v_mfma_f32_16x16x32_bf16 v[176:179], a[224:227], v[56:59], v[176:179]
    s_add_u32 m0, s44, 127584
    ds_read_b64_tr_b16 a[254:255], v3 offset:54496
    v_cvt_pk_bf16_f32 v67, v134, v135
    v_mfma_f32_16x16x32_bf16 v[176:179], a[228:231], v[60:63], v[176:179]
    s_waitcnt lgkmcnt(8)
    buffer_load_dwordx4 v5, s[20:23], s46 offen offset:3072 lds
    v_mfma_f32_16x16x32_bf16 v[148:151], a[232:235], v[48:51], v[148:151]
    ds_read_b64_tr_b16 a[192:193], v3 offset:37120
    v_cvt_pk_bf16_f32 v80, v160, v161
    v_mfma_f32_16x16x32_bf16 v[148:151], a[236:239], v[52:55], v[148:151]
    ds_read_b64_tr_b16 a[194:195], v3 offset:37632
    v_cvt_pk_bf16_f32 v81, v162, v163
    v_mfma_f32_16x16x32_bf16 v[180:183], a[232:235], v[56:59], v[180:183]
    ds_read_b64_tr_b16 a[196:197], v3 offset:54016
    v_cvt_pk_bf16_f32 v82, v164, v165
    v_mfma_f32_16x16x32_bf16 v[180:183], a[236:239], v[60:63], v[180:183]
    s_waitcnt lgkmcnt(7)
    ds_read_b64_tr_b16 a[198:199], v3 offset:54528
    v_cvt_pk_bf16_f32 v83, v166, v167
    v_mfma_f32_16x16x32_bf16 v[152:155], a[240:243], v[48:51], v[152:155]
    ds_read_b64_tr_b16 a[200:201], v3 offset:37152
    v_cvt_pk_bf16_f32 v68, v136, v137
    v_mfma_f32_16x16x32_bf16 v[152:155], a[244:247], v[52:55], v[152:155]
    ds_read_b64_tr_b16 a[202:203], v3 offset:37664
    v_cvt_pk_bf16_f32 v69, v138, v139
    v_mfma_f32_16x16x32_bf16 v[184:187], a[240:243], v[56:59], v[184:187]
    ds_read_b64_tr_b16 a[204:205], v3 offset:54048
    v_cvt_pk_bf16_f32 v70, v140, v141
    v_mfma_f32_16x16x32_bf16 v[184:187], a[244:247], v[60:63], v[184:187]
    s_waitcnt lgkmcnt(7)
    ds_read_b64_tr_b16 a[206:207], v3 offset:54560
    v_cvt_pk_bf16_f32 v71, v142, v143
    v_mfma_f32_16x16x32_bf16 v[156:159], a[248:251], v[48:51], v[156:159]
    ds_read_b64_tr_b16 a[208:209], v3 offset:37184
    v_cvt_pk_bf16_f32 v84, v168, v169
    v_mfma_f32_16x16x32_bf16 v[156:159], a[252:255], v[52:55], v[156:159]
    ds_read_b64_tr_b16 a[210:211], v3 offset:37696
    v_cvt_pk_bf16_f32 v85, v170, v171
    v_mfma_f32_16x16x32_bf16 v[188:191], a[248:251], v[56:59], v[188:191]
    ds_read_b64_tr_b16 a[212:213], v3 offset:54080
    v_cvt_pk_bf16_f32 v86, v172, v173
    v_mfma_f32_16x16x32_bf16 v[188:191], a[252:255], v[60:63], v[188:191]
    s_waitcnt lgkmcnt(7)
    ds_read_b64_tr_b16 a[214:215], v3 offset:54592
    v_cvt_pk_bf16_f32 v87, v174, v175
    v_mfma_f32_16x16x32_bf16 v[192:195], a[192:195], v[48:51], v[192:195]
    ds_read_b64_tr_b16 a[216:217], v3 offset:37216
    v_cvt_pk_bf16_f32 v72, v144, v145
    v_mfma_f32_16x16x32_bf16 v[192:195], a[196:199], v[52:55], v[192:195]
    ds_read_b64_tr_b16 a[218:219], v3 offset:37728
    v_cvt_pk_bf16_f32 v73, v146, v147
    v_mfma_f32_16x16x32_bf16 v[224:227], a[192:195], v[56:59], v[224:227]
    ds_read_b64_tr_b16 a[220:221], v3 offset:54112
    v_cvt_pk_bf16_f32 v74, v148, v149
    v_mfma_f32_16x16x32_bf16 v[224:227], a[196:199], v[60:63], v[224:227]
    s_waitcnt lgkmcnt(7)
    ds_read_b64_tr_b16 a[222:223], v3 offset:54624
    v_cvt_pk_bf16_f32 v75, v150, v151
    v_mfma_f32_16x16x32_bf16 v[196:199], a[200:203], v[48:51], v[196:199]
    ds_read_b64_tr_b16 a[224:225], v3 offset:37248
    v_cvt_pk_bf16_f32 v88, v176, v177
    v_mfma_f32_16x16x32_bf16 v[196:199], a[204:207], v[52:55], v[196:199]
    ds_read_b64_tr_b16 a[226:227], v3 offset:37760
    v_cvt_pk_bf16_f32 v89, v178, v179
    v_mfma_f32_16x16x32_bf16 v[228:231], a[200:203], v[56:59], v[228:231]
    ds_read_b64_tr_b16 a[228:229], v3 offset:54144
    v_cvt_pk_bf16_f32 v90, v180, v181
    v_mfma_f32_16x16x32_bf16 v[228:231], a[204:207], v[60:63], v[228:231]
    s_waitcnt lgkmcnt(7)
    ds_read_b64_tr_b16 a[230:231], v3 offset:54656
    v_cvt_pk_bf16_f32 v91, v182, v183
    v_mfma_f32_16x16x32_bf16 v[200:203], a[208:211], v[48:51], v[200:203]
    ds_read_b64_tr_b16 a[232:233], v3 offset:37280
    v_cvt_pk_bf16_f32 v76, v152, v153
    v_mfma_f32_16x16x32_bf16 v[200:203], a[212:215], v[52:55], v[200:203]
    ds_read_b64_tr_b16 a[234:235], v3 offset:37792
    v_cvt_pk_bf16_f32 v77, v154, v155
    v_mfma_f32_16x16x32_bf16 v[232:235], a[208:211], v[56:59], v[232:235]
    ds_read_b64_tr_b16 a[236:237], v3 offset:54176
    v_cvt_pk_bf16_f32 v78, v156, v157
    v_mfma_f32_16x16x32_bf16 v[232:235], a[212:215], v[60:63], v[232:235]
    s_waitcnt lgkmcnt(7)
    ds_read_b64_tr_b16 a[238:239], v3 offset:54688
    v_cvt_pk_bf16_f32 v79, v158, v159
    v_mfma_f32_16x16x32_bf16 v[204:207], a[216:219], v[48:51], v[204:207]
    ds_read_b64_tr_b16 a[240:241], v3 offset:37312
    v_cvt_pk_bf16_f32 v92, v184, v185
    v_mfma_f32_16x16x32_bf16 v[204:207], a[220:223], v[52:55], v[204:207]
L2_pad3:
    s_cbranch_execz L2_pad7
    ds_read_b64_tr_b16 a[242:243], v3 offset:37824
    v_cvt_pk_bf16_f32 v93, v186, v187
    v_mfma_f32_16x16x32_bf16 v[236:239], a[216:219], v[56:59], v[236:239]
    ds_read_b64_tr_b16 a[244:245], v3 offset:54208
    v_cvt_pk_bf16_f32 v94, v188, v189
    v_mfma_f32_16x16x32_bf16 v[236:239], a[220:223], v[60:63], v[236:239]
    s_waitcnt lgkmcnt(7)
    ds_read_b64_tr_b16 a[246:247], v3 offset:54720
    v_cvt_pk_bf16_f32 v95, v190, v191
    v_mfma_f32_16x16x32_bf16 v[208:211], a[224:227], v[48:51], v[208:211]
    ds_read_b64_tr_b16 a[248:249], v3 offset:37344
    v_cvt_pk_bf16_f32 v96, v192, v193
    v_mfma_f32_16x16x32_bf16 v[208:211], a[228:231], v[52:55], v[208:211]
    ds_read_b64_tr_b16 a[250:251], v3 offset:37856
    v_cvt_pk_bf16_f32 v97, v194, v195
    v_mfma_f32_16x16x32_bf16 v[240:243], a[224:227], v[56:59], v[240:243]
    ds_read_b64_tr_b16 a[252:253], v3 offset:54240
    v_cvt_pk_bf16_f32 v98, v196, v197
    v_mfma_f32_16x16x32_bf16 v[240:243], a[228:231], v[60:63], v[240:243]
    s_waitcnt vmcnt(8)
    s_barrier
    s_waitcnt lgkmcnt(7)
    ds_read_b64_tr_b16 a[254:255], v3 offset:54752
    v_cvt_pk_bf16_f32 v99, v198, v199
    v_mfma_f32_16x16x32_bf16 v[212:215], a[232:235], v[48:51], v[212:215]
    ds_read_b128 a[64:67], v1 offset:0
    v_cvt_pk_bf16_f32 v112, v224, v225
    v_mfma_f32_16x16x32_bf16 v[212:215], a[236:239], v[52:55], v[212:215]
    ds_read_b128 a[68:71], v1 offset:64
    v_cvt_pk_bf16_f32 v113, v226, v227
    v_mfma_f32_16x16x32_bf16 v[244:247], a[232:235], v[56:59], v[244:247]
    s_add_u32 m0, s44, 0
    ds_read_b128 a[72:75], v1 offset:128
    v_cvt_pk_bf16_f32 v114, v228, v229
    v_mfma_f32_16x16x32_bf16 v[244:247], a[236:239], v[60:63], v[244:247]
    s_mov_b32 s46, 32768
    s_waitcnt lgkmcnt(7)
    buffer_load_dwordx4 v5, s[16:19], s46 offen offset:0 lds
    v_mfma_f32_16x16x32_bf16 v[216:219], a[240:243], v[48:51], v[216:219]
    ds_read_b128 a[76:79], v1 offset:192
    v_cvt_pk_bf16_f32 v115, v230, v231
    v_mfma_f32_16x16x32_bf16 v[216:219], a[244:247], v[52:55], v[216:219]
    ds_read_b128 a[80:83], v1 offset:256
    v_cvt_pk_bf16_f32 v100, v200, v201
    v_mfma_f32_16x16x32_bf16 v[248:251], a[240:243], v[56:59], v[248:251]
    s_add_u32 m0, s44, 32
    ds_read_b128 a[84:87], v1 offset:320
    v_cvt_pk_bf16_f32 v101, v202, v203
    v_mfma_f32_16x16x32_bf16 v[248:251], a[244:247], v[60:63], v[248:251]
    s_waitcnt lgkmcnt(6)
    buffer_load_dwordx4 v5, s[16:19], s46 offen offset:1024 lds
    v_mfma_f32_16x16x32_bf16 v[220:223], a[248:251], v[48:51], v[220:223]
    ds_read_b128 a[88:91], v1 offset:384
    v_cvt_pk_bf16_f32 v102, v204, v205
    v_mfma_f32_16x16x32_bf16 v[220:223], a[252:255], v[52:55], v[220:223]
    ds_read_b128 a[92:95], v1 offset:448
    v_cvt_pk_bf16_f32 v103, v206, v207
    v_mfma_f32_16x16x32_bf16 v[252:255], a[248:251], v[56:59], v[252:255]
    s_add_u32 m0, s44, 64
    ds_read_b128 a[96:99], v1 offset:512
    v_cvt_pk_bf16_f32 v116, v232, v233
    v_mfma_f32_16x16x32_bf16 v[252:255], a[252:255], v[60:63], v[252:255]
    buffer_load_dwordx4 v5, s[16:19], s46 offen offset:2048 lds
    s_mov_b64 s[32:33], s[40:41]
    s_andn2_b32 s34, s42, s100
    s_and_b32 s42, s42, s100
    v_lshlrev_b32 v14, 7, v0
    s_add_u32 m0, s44, 96
    s_nop 0
    buffer_load_dwordx4 v5, s[16:19], s46 offen offset:3072 lds
    s_add_u32 m0, s44, 16896
    s_nop 0
    buffer_load_dwordx4 v5, s[20:23], s46 offen offset:0 lds
    s_add_u32 m0, s44, 16928
    s_nop 0
    buffer_load_dwordx4 v5, s[20:23], s46 offen offset:1024 lds
    s_add_u32 m0, s44, 16960
    s_nop 0
    buffer_load_dwordx4 v5, s[20:23], s46 offen offset:2048 lds
    s_add_u32 m0, s44, 16992
    s_nop 0
    buffer_load_dwordx4 v5, s[20:23], s46 offen offset:3072 lds
    buffer_load_dword a63, v14, s[36:39], 0 offen
    ds_read_b128 a[100:103], v1 offset:576
    ds_read_b128 a[104:107], v1 offset:640
    ds_read_b128 a[108:111], v1 offset:704
    ds_read_b128 a[112:115], v1 offset:768
    ds_read_b128 a[116:119], v1 offset:832
    ds_read_b128 a[120:123], v1 offset:896
    ds_read_b128 a[124:127], v1 offset:960
    ds_read_b64_tr_b16 a[128:129], v2 offset:0
    ds_read_b64_tr_b16 a[130:131], v2 offset:256
    ds_read_b64_tr_b16 a[132:133], v2 offset:512
    ds_read_b64_tr_b16 a[134:135], v2 offset:768
    ds_read_b64_tr_b16 a[136:137], v2 offset:32
    ds_read_b64_tr_b16 a[138:139], v2 offset:288
    ds_read_b64_tr_b16 a[140:141], v2 offset:544
    ds_read_b64_tr_b16 a[142:143], v2 offset:800
    ds_read_b64_tr_b16 a[144:145], v2 offset:64
    ds_read_b64_tr_b16 a[146:147], v2 offset:320
    ds_read_b64_tr_b16 a[148:149], v2 offset:576
    ds_read_b64_tr_b16 a[150:151], v2 offset:832
    ds_read_b64_tr_b16 a[152:153], v2 offset:96
    ds_read_b64_tr_b16 a[154:155], v2 offset:352
    ds_read_b64_tr_b16 a[156:157], v2 offset:608
    ds_read_b64_tr_b16 a[158:159], v2 offset:864
    ds_read_b64_tr_b16 a[160:161], v2 offset:128
    ds_read_b64_tr_b16 a[162:163], v2 offset:384
    ds_read_b64_tr_b16 a[164:165], v2 offset:640
    ds_read_b64_tr_b16 a[166:167], v2 offset:896
    ds_read_b64_tr_b16 a[168:169], v2 offset:160
    ds_read_b64_tr_b16 a[170:171], v2 offset:416
    ds_read_b64_tr_b16 a[172:173], v2 offset:672
    ds_read_b64_tr_b16 a[174:175], v2 offset:928
    ds_read_b64_tr_b16 a[176:177], v2 offset:192
    ds_read_b64_tr_b16 a[178:179], v2 offset:448
    ds_read_b64_tr_b16 a[180:181], v2 offset:704
    ds_read_b64_tr_b16 a[182:183], v2 offset:960
    ds_read_b64_tr_b16 a[184:185], v2 offset:224
    ds_read_b64_tr_b16 a[186:187], v2 offset:480
    ds_read_b64_tr_b16 a[188:189], v2 offset:736
    ds_read_b64_tr_b16 a[190:191], v2 offset:992
    v_cvt_pk_bf16_f32 v117, v234, v235
    v_cvt_pk_bf16_f32 v118, v236, v237
    v_cvt_pk_bf16_f32 v119, v238, v239
    v_cvt_pk_bf16_f32 v104, v208, v209
    v_cvt_pk_bf16_f32 v105, v210, v211
    v_cvt_pk_bf16_f32 v106, v212, v213
    v_cvt_pk_bf16_f32 v107, v214, v215
    v_cvt_pk_bf16_f32 v120, v240, v241
    v_cvt_pk_bf16_f32 v121, v242, v243
    v_cvt_pk_bf16_f32 v122, v244, v245
    v_cvt_pk_bf16_f32 v123, v246, v247
    v_cvt_pk_bf16_f32 v108, v216, v217
    v_cvt_pk_bf16_f32 v109, v218, v219
    v_cvt_pk_bf16_f32 v110, v220, v221
    v_cvt_pk_bf16_f32 v111, v222, v223
    v_cvt_pk_bf16_f32 v124, v248, v249
    v_cvt_pk_bf16_f32 v125, v250, v251
    v_cvt_pk_bf16_f32 v126, v252, v253
    v_cvt_pk_bf16_f32 v127, v254, v255
    s_nop 0
    v_permlane32_swap_b32 v64, v66
    v_permlane32_swap_b32 v65, v67
    v_permlane32_swap_b32 v80, v82
    v_permlane32_swap_b32 v81, v83
    v_permlane32_swap_b32 v68, v70
    v_permlane32_swap_b32 v69, v71
    v_permlane32_swap_b32 v84, v86
    v_permlane32_swap_b32 v85, v87
    v_permlane32_swap_b32 v72, v74
    v_permlane32_swap_b32 v73, v75
    v_permlane32_swap_b32 v88, v90
    v_permlane32_swap_b32 v89, v91
    v_permlane32_swap_b32 v76, v78
    v_permlane32_swap_b32 v77, v79
    v_permlane32_swap_b32 v92, v94
    v_permlane32_swap_b32 v93, v95
    v_permlane32_swap_b32 v96, v98
    v_permlane32_swap_b32 v97, v99
    v_permlane32_swap_b32 v112, v114
    v_permlane32_swap_b32 v113, v115
    v_permlane32_swap_b32 v100, v102
    v_permlane32_swap_b32 v101, v103
    v_permlane32_swap_b32 v116, v118
    v_permlane32_swap_b32 v117, v119
    v_permlane32_swap_b32 v104, v106
    v_permlane32_swap_b32 v105, v107
    v_permlane32_swap_b32 v120, v122
    v_permlane32_swap_b32 v121, v123
    v_permlane32_swap_b32 v108, v110
    v_permlane32_swap_b32 v109, v111
    v_permlane32_swap_b32 v124, v126
    v_permlane32_swap_b32 v125, v127
    s_waitcnt lgkmcnt(15)
    v_mfma_f32_16x16x32_bf16 v[16:19], a[64:67], v[64:67], 0
    v_mfma_f32_16x16x32_bf16 v[16:19], a[68:71], v[68:71], v[16:19]
    v_mfma_f32_16x16x32_bf16 v[16:19], a[72:75], v[72:75], v[16:19]
    v_mfma_f32_16x16x32_bf16 v[16:19], a[76:79], v[76:79], v[16:19]
    v_mfma_f32_16x16x32_bf16 v[20:23], a[64:67], v[80:83], 0
    v_mfma_f32_16x16x32_bf16 v[20:23], a[68:71], v[84:87], v[20:23]
    v_mfma_f32_16x16x32_bf16 v[20:23], a[72:75], v[88:91], v[20:23]
    v_mfma_f32_16x16x32_bf16 v[20:23], a[76:79], v[92:95], v[20:23]
    v_mfma_f32_16x16x32_bf16 v[24:27], a[64:67], v[96:99], 0
    v_mfma_f32_16x16x32_bf16 v[24:27], a[68:71], v[100:103], v[24:27]
    v_mfma_f32_16x16x32_bf16 v[24:27], a[72:75], v[104:107], v[24:27]
    v_mfma_f32_16x16x32_bf16 v[24:27], a[76:79], v[108:111], v[24:27]
    v_mfma_f32_16x16x32_bf16 v[28:31], a[64:67], v[112:115], 0
    v_mfma_f32_16x16x32_bf16 v[28:31], a[68:71], v[116:119], v[28:31]
    v_mfma_f32_16x16x32_bf16 v[28:31], a[72:75], v[120:123], v[28:31]
    v_mfma_f32_16x16x32_bf16 v[28:31], a[76:79], v[124:127], v[28:31]
    s_nop 1
    v_max3_f32 v16, v16, v17, v18
    v_max_f32 v16, v16, v19
    v_max3_f32 v20, v20, v21, v22
    v_max_f32 v20, v20, v23
    v_max3_f32 v24, v24, v25, v26
    v_max_f32 v24, v24, v27
    v_max3_f32 v28, v28, v29, v30
    v_max_f32 v28, v28, v31
    v_mov_b32 v12, v16
    v_mov_b32 v13, v20
    v_mov_b32 v14, v24
    v_mov_b32 v15, v28
    v_permlane16_swap_b32 v12, v16
    v_permlane16_swap_b32 v13, v20
    v_permlane16_swap_b32 v14, v24
    v_permlane16_swap_b32 v15, v28
    v_max_f32 v16, v16, v12
    v_max_f32 v20, v20, v13
    v_max_f32 v24, v24, v14
    v_max_f32 v28, v28, v15
    v_mov_b32 v12, v16
    v_mov_b32 v13, v20
    v_mov_b32 v14, v24
    v_mov_b32 v15, v28
    v_permlane32_swap_b32 v12, v16
    v_permlane32_swap_b32 v13, v20
    v_permlane32_swap_b32 v14, v24
    v_permlane32_swap_b32 v15, v28
    v_max_f32 v16, v16, v12
    v_max_f32 v20, v20, v13
    v_max_f32 v24, v24, v14
    v_max_f32 v28, v28, v15
    v_sub_f32 v48, 0xc2000000, v16
    v_sub_f32 v49, 0xc2000000, v16
    v_sub_f32 v50, 0xc2000000, v16
    v_sub_f32 v51, 0xc2000000, v16
    v_sub_f32 v52, 0xc2000000, v20
    v_sub_f32 v53, 0xc2000000, v20
    v_sub_f32 v54, 0xc2000000, v20
    v_sub_f32 v55, 0xc2000000, v20
    v_sub_f32 v56, 0xc2000000, v24
    v_sub_f32 v57, 0xc2000000, v24
    v_sub_f32 v58, 0xc2000000, v24
    v_sub_f32 v59, 0xc2000000, v24
    v_sub_f32 v60, 0xc2000000, v28
    v_sub_f32 v61, 0xc2000000, v28
    v_sub_f32 v62, 0xc2000000, v28
    v_sub_f32 v63, 0xc2000000, v28
L2_entry:
    v_accvgpr_write_b32 a0, 0
    v_accvgpr_write_b32 a1, 0
    v_accvgpr_write_b32 a2, 0
    v_accvgpr_write_b32 a3, 0
    v_accvgpr_write_b32 a4, 0
    v_accvgpr_write_b32 a5, 0
    v_accvgpr_write_b32 a6, 0
    v_accvgpr_write_b32 a7, 0
    v_accvgpr_write_b32 a8, 0
    v_accvgpr_write_b32 a9, 0
    v_accvgpr_write_b32 a10, 0
    v_accvgpr_write_b32 a11, 0
    v_accvgpr_write_b32 a12, 0
    v_accvgpr_write_b32 a13, 0
    v_accvgpr_write_b32 a14, 0
    v_accvgpr_write_b32 a15, 0
    v_mov_b32 v224, 0
    v_mov_b32 v225, 0
    v_mov_b32 v226, 0
    v_mov_b32 v227, 0
    v_mov_b32 v228, 0
    v_mov_b32 v229, 0
    v_mov_b32 v230, 0
    v_mov_b32 v231, 0
    v_mov_b32 v232, 0
    v_mov_b32 v233, 0
    v_mov_b32 v234, 0
    v_mov_b32 v235, 0
    v_mov_b32 v236, 0
    v_mov_b32 v237, 0
    v_mov_b32 v238, 0
    v_mov_b32 v239, 0
    v_mov_b32 v240, 0
    v_mov_b32 v241, 0
    v_mov_b32 v242, 0
    v_mov_b32 v243, 0
    v_mov_b32 v244, 0
    v_mov_b32 v245, 0
    v_mov_b32 v246, 0
    v_mov_b32 v247, 0
    v_mov_b32 v248, 0
    v_mov_b32 v249, 0
    v_mov_b32 v250, 0
    v_mov_b32 v251, 0
    v_mov_b32 v252, 0
    v_mov_b32 v253, 0
    v_mov_b32 v254, 0
    v_mov_b32 v255, 0
    s_mov_b32 s47, s44
    s_mov_b32 s48, -73728
    s_mov_b32 s49, 12
    s_mov_b32 s46, 49152
    v_lshrrev_b32 v14, 2, v0
    s_mul_i32 s3, s51, 144
    v_add_u32 v14, s3, v14
    v_mul_u32_u24 v14, 9216, v14
    v_and_b32 v15, 3, v0
    v_lshl_add_u32 v6, v15, 4, v14
    s_lshr_b32 s3, s2, 3
    s_lshl_b32 s3, s3, 2
    s_add_u32 s3, s3, s51
    s_and_b32 s15, s2, 7
    s_lshl_b32 s14, s3, 7
    v_lshl_add_u32 v9, v0, 14, s14
    v_min_u32 v9, L2_codeend-L2_begin-8, v9
    s_mul_i32 s14, s3, 9
    s_lshr_b32 s14, s14, 1
    v_min_u32 v15, 44, v0
    v_mul_u32_u24 v12, 7282, v15
    v_lshrrev_b32 v12, 16, v12
    v_mul_u32_u24 v13, 63, v12
    v_add_u32 v12, v15, v13
    s_mul_i32 s14, s14, 72
    s_mul_i32 s56, s15, 9
    s_add_u32 s14, s14, s56
    v_add_u32 v12, s14, v12
    v_lshlrev_b32 v12, 7, v12
    s_mul_i32 s14, s3, 81
    s_lshr_b32 s14, s14, 1
    s_mul_i32 s56, s15, 5184
    s_add_u32 s14, s14, s56
    v_min_u32 v13, 40, v0
    v_add_u32 v13, s14, v13
    v_lshlrev_b32 v13, 7, v13
    s_mul_i32 s14, s3, 72
    s_andn2_b32 s56, s52, 3
    s_mul_i32 s56, s56, 2304
    s_add_u32 s14, s14, s56
    v_min_u32 v14, 35, v0
    v_add_u32 v14, s14, v14
    v_lshlrev_b32 v14, 7, v14
    v_add_u32 v15, 4608, v14
    s_waitcnt vmcnt(9) lgkmcnt(0)
    s_barrier
    v_mfma_f32_16x16x32_bf16 v[16:19], a[64:67], v[64:67], v[48:51]
    v_mfma_f32_16x16x32_bf16 v[16:19], a[68:71], v[68:71], v[16:19]
    v_mfma_f32_16x16x32_bf16 v[16:19], a[72:75], v[72:75], v[16:19]
    s_add_u32 m0, s47, 36864
    v_mfma_f32_16x16x32_bf16 v[16:19], a[76:79], v[76:79], v[16:19]
    buffer_load_dwordx4 v5, s[16:19], s46 offen offset:0 lds
    v_mfma_f32_16x16x32_bf16 v[20:23], a[80:83], v[64:67], v[48:51]
    v_mfma_f32_16x16x32_bf16 v[20:23], a[84:87], v[68:71], v[20:23]
    v_mfma_f32_16x16x32_bf16 v[20:23], a[88:91], v[72:75], v[20:23]
    s_add_u32 m0, s47, 36896
    v_mfma_f32_16x16x32_bf16 v[20:23], a[92:95], v[76:79], v[20:23]
    buffer_load_dwordx4 v5, s[16:19], s46 offen offset:1024 lds
    v_mfma_f32_16x16x32_bf16 v[24:27], a[96:99], v[64:67], v[48:51]
    s_nop 1
    v_exp_f32 v16, v16
    v_mfma_f32_16x16x32_bf16 v[24:27], a[100:103], v[68:71], v[24:27]
    v_mfma_f32_16x16x32_bf16 v[24:27], a[104:107], v[72:75], v[24:27]
    s_add_u32 m0, s47, 36928
    v_exp_f32 v17, v17
    v_mfma_f32_16x16x32_bf16 v[24:27], a[108:111], v[76:79], v[24:27]
    buffer_load_dwordx4 v5, s[16:19], s46 offen offset:2048 lds
    v_mfma_f32_16x16x32_bf16 v[28:31], a[112:115], v[64:67], v[48:51]
    v_exp_f32 v18, v18
    v_mfma_f32_16x16x32_bf16 v[28:31], a[116:119], v[68:71], v[28:31]
    v_cvt_pk_bf16_f32 v32, v16, v17
    v_mfma_f32_16x16x32_bf16 v[28:31], a[120:123], v[72:75], v[28:31]
    s_add_u32 m0, s47, 36960
    v_exp_f32 v19, v19
    v_mfma_f32_16x16x32_bf16 v[28:31], a[124:127], v[76:79], v[28:31]
    buffer_load_dwordx4 v5, s[16:19], s46 offen offset:3072 lds
    s_nop 3
    v_exp_f32 v20, v20
    s_nop 0
    ds_read_b64_tr_b16 a[192:193], v2 offset:36864
    v_cvt_pk_bf16_f32 v33, v18, v19
    s_add_u32 m0, s47, 53760
    v_exp_f32 v21, v21
    s_nop 0
    buffer_load_dwordx4 v5, s[20:23], s46 offen offset:0 lds
    v_exp_f32 v22, v22
    s_nop 0
    ds_read_b64_tr_b16 a[194:195], v2 offset:37120
    v_cvt_pk_bf16_f32 v34, v20, v21
    s_add_u32 m0, s47, 53792
    v_exp_f32 v23, v23
    s_nop 0
    buffer_load_dwordx4 v5, s[20:23], s46 offen offset:1024 lds
    v_exp_f32 v24, v24
    s_nop 0
    ds_read_b64_tr_b16 a[196:197], v2 offset:37376
    v_cvt_pk_bf16_f32 v35, v22, v23
    s_add_u32 m0, s47, 53824
    v_exp_f32 v25, v25
    s_nop 0
    buffer_load_dwordx4 v5, s[20:23], s46 offen offset:2048 lds
    v_exp_f32 v26, v26
    s_nop 0
    ds_read_b64_tr_b16 a[198:199], v2 offset:37632
    v_cvt_pk_bf16_f32 v36, v24, v25
    s_add_u32 m0, s47, 53856
    v_exp_f32 v27, v27
    s_nop 0
    buffer_load_dwordx4 v5, s[20:23], s46 offen offset:3072 lds
    ds_read_b64_tr_b16 a[200:201], v2 offset:36896
    s_nop 0
    v_mfma_f32_16x16x32_bf16 v[16:19], a[64:67], v[80:83], v[52:55]
    v_exp_f32 v28, v28
    v_mfma_f32_16x16x32_bf16 v[16:19], a[68:71], v[84:87], v[16:19]
    ds_read_b64_tr_b16 a[202:203], v2 offset:37152
    v_cvt_pk_bf16_f32 v37, v26, v27
    v_mfma_f32_16x16x32_bf16 v[16:19], a[72:75], v[88:91], v[16:19]
    v_exp_f32 v29, v29
    v_mfma_f32_16x16x32_bf16 v[16:19], a[76:79], v[92:95], v[16:19]
    ds_read_b64_tr_b16 a[204:205], v2 offset:37408
    v_mfma_f32_16x16x32_bf16 v[20:23], a[80:83], v[80:83], v[52:55]
    v_exp_f32 v30, v30
    v_mfma_f32_16x16x32_bf16 v[20:23], a[84:87], v[84:87], v[20:23]
    ds_read_b64_tr_b16 a[206:207], v2 offset:37664
    v_cvt_pk_bf16_f32 v38, v28, v29
    v_mfma_f32_16x16x32_bf16 v[20:23], a[88:91], v[88:91], v[20:23]
    v_exp_f32 v31, v31
    v_mfma_f32_16x16x32_bf16 v[20:23], a[92:95], v[92:95], v[20:23]
    ds_read_b64_tr_b16 a[208:209], v2 offset:36928
    v_mfma_f32_16x16x32_bf16 v[24:27], a[96:99], v[80:83], v[52:55]
    v_exp_f32 v16, v16
    v_mfma_f32_16x16x32_bf16 v[24:27], a[100:103], v[84:87], v[24:27]
    ds_read_b64_tr_b16 a[210:211], v2 offset:37184
    v_cvt_pk_bf16_f32 v39, v30, v31
    v_mfma_f32_16x16x32_bf16 v[24:27], a[104:107], v[88:91], v[24:27]
    v_exp_f32 v17, v17
    v_mfma_f32_16x16x32_bf16 v[24:27], a[108:111], v[92:95], v[24:27]
    ds_read_b64_tr_b16 a[212:213], v2 offset:37440
    v_mfma_f32_16x16x32_bf16 v[28:31], a[112:115], v[80:83], v[52:55]
    v_exp_f32 v18, v18
    v_mfma_f32_16x16x32_bf16 v[28:31], a[116:119], v[84:87], v[28:31]
    ds_read_b64_tr_b16 a[214:215], v2 offset:37696
    v_cvt_pk_bf16_f32 v40, v16, v17
    v_mfma_f32_16x16x32_bf16 v[28:31], a[120:123], v[88:91], v[28:31]
    v_exp_f32 v19, v19
    v_mfma_f32_16x16x32_bf16 v[28:31], a[124:127], v[92:95], v[28:31]
    ds_read_b64_tr_b16 a[216:217], v2 offset:36960
    v_mfma_f32_16x16x32_bf16 v[128:131], a[128:131], v[32:35], 0
    v_exp_f32 v20, v20
    v_mfma_f32_16x16x32_bf16 v[128:131], a[132:135], v[36:39], v[128:131]
    ds_read_b64_tr_b16 a[218:219], v2 offset:37216
    v_cvt_pk_bf16_f32 v41, v18, v19
    v_mfma_f32_16x16x32_bf16 v[132:135], a[136:139], v[32:35], 0
    v_exp_f32 v21, v21
    v_mfma_f32_16x16x32_bf16 v[132:135], a[140:143], v[36:39], v[132:135]
    ds_read_b64_tr_b16 a[220:221], v2 offset:37472
    v_mfma_f32_16x16x32_bf16 v[136:139], a[144:147], v[32:35], 0
    v_exp_f32 v22, v22
    v_mfma_f32_16x16x32_bf16 v[136:139], a[148:151], v[36:39], v[136:139]
    ds_read_b64_tr_b16 a[222:223], v2 offset:37728
    v_cvt_pk_bf16_f32 v42, v20, v21
    v_mfma_f32_16x16x32_bf16 v[140:143], a[152:155], v[32:35], 0
    v_exp_f32 v23, v23
    v_mfma_f32_16x16x32_bf16 v[140:143], a[156:159], v[36:39], v[140:143]
    ds_read_b64_tr_b16 a[224:225], v2 offset:36992
    v_mfma_f32_16x16x32_bf16 v[144:147], a[160:163], v[32:35], 0
    v_exp_f32 v24, v24
    v_mfma_f32_16x16x32_bf16 v[144:147], a[164:167], v[36:39], v[144:147]
    ds_read_b64_tr_b16 a[226:227], v2 offset:37248
    v_cvt_pk_bf16_f32 v43, v22, v23
    v_mfma_f32_16x16x32_bf16 v[148:151], a[168:171], v[32:35], 0
    v_exp_f32 v25, v25
    v_mfma_f32_16x16x32_bf16 v[148:151], a[172:175], v[36:39], v[148:151]
    ds_read_b64_tr_b16 a[228:229], v2 offset:37504
    v_mfma_f32_16x16x32_bf16 v[152:155], a[176:179], v[32:35], 0
    v_exp_f32 v26, v26
    v_mfma_f32_16x16x32_bf16 v[152:155], a[180:183], v[36:39], v[152:155]
    ds_read_b64_tr_b16 a[230:231], v2 offset:37760
    v_cvt_pk_bf16_f32 v44, v24, v25
    v_mfma_f32_16x16x32_bf16 v[156:159], a[184:187], v[32:35], 0
    v_exp_f32 v27, v27
    v_mfma_f32_16x16x32_bf16 v[156:159], a[188:191], v[36:39], v[156:159]
    ds_read_b64_tr_b16 a[232:233], v2 offset:37024
    v_smfmac_f32_16x16x64_bf16 a[0:3], a[16:19], v[32:39], v11
    ds_read_b64_tr_b16 a[234:235], v2 offset:37280
    v_mfma_f32_16x16x32_bf16 v[16:19], a[64:67], v[96:99], v[56:59]
    v_exp_f32 v28, v28
    v_mfma_f32_16x16x32_bf16 v[16:19], a[68:71], v[100:103], v[16:19]
    ds_read_b64_tr_b16 a[236:237], v2 offset:37536
    v_cvt_pk_bf16_f32 v45, v26, v27
    v_mfma_f32_16x16x32_bf16 v[16:19], a[72:75], v[104:107], v[16:19]
    v_exp_f32 v29, v29
    v_mfma_f32_16x16x32_bf16 v[16:19], a[76:79], v[108:111], v[16:19]
    ds_read_b64_tr_b16 a[238:239], v2 offset:37792
    v_mfma_f32_16x16x32_bf16 v[20:23], a[80:83], v[96:99], v[56:59]
    v_exp_f32 v30, v30
    v_mfma_f32_16x16x32_bf16 v[20:23], a[84:87], v[100:103], v[20:23]
    ds_read_b64_tr_b16 a[240:241], v2 offset:37056
    v_cvt_pk_bf16_f32 v46, v28, v29
    v_mfma_f32_16x16x32_bf16 v[20:23], a[88:91], v[104:107], v[20:23]
    v_exp_f32 v31, v31
    v_mfma_f32_16x16x32_bf16 v[20:23], a[92:95], v[108:111], v[20:23]
    ds_read_b64_tr_b16 a[242:243], v2 offset:37312
    v_mfma_f32_16x16x32_bf16 v[24:27], a[96:99], v[96:99], v[56:59]
    v_exp_f32 v16, v16
    v_mfma_f32_16x16x32_bf16 v[24:27], a[100:103], v[100:103], v[24:27]
    ds_read_b64_tr_b16 a[244:245], v2 offset:37568
    v_cvt_pk_bf16_f32 v47, v30, v31
    v_mfma_f32_16x16x32_bf16 v[24:27], a[104:107], v[104:107], v[24:27]
    v_exp_f32 v17, v17
    v_mfma_f32_16x16x32_bf16 v[24:27], a[108:111], v[108:111], v[24:27]
    ds_read_b64_tr_b16 a[246:247], v2 offset:37824
    v_mfma_f32_16x16x32_bf16 v[28:31], a[112:115], v[96:99], v[56:59]
    v_exp_f32 v18, v18
    v_mfma_f32_16x16x32_bf16 v[28:31], a[116:119], v[100:103], v[28:31]
    ds_read_b64_tr_b16 a[248:249], v2 offset:37088
    v_cvt_pk_bf16_f32 v32, v16, v17
    v_mfma_f32_16x16x32_bf16 v[28:31], a[120:123], v[104:107], v[28:31]
    v_exp_f32 v19, v19
    v_mfma_f32_16x16x32_bf16 v[28:31], a[124:127], v[108:111], v[28:31]
    ds_read_b64_tr_b16 a[250:251], v2 offset:37344
    v_mfma_f32_16x16x32_bf16 v[160:163], a[128:131], v[40:43], 0
    v_exp_f32 v20, v20
    v_mfma_f32_16x16x32_bf16 v[160:163], a[132:135], v[44:47], v[160:163]
    ds_read_b64_tr_b16 a[252:253], v2 offset:37600
    v_cvt_pk_bf16_f32 v33, v18, v19
    v_mfma_f32_16x16x32_bf16 v[164:167], a[136:139], v[40:43], 0
    v_exp_f32 v21, v21
    v_mfma_f32_16x16x32_bf16 v[164:167], a[140:143], v[44:47], v[164:167]
    ds_read_b64_tr_b16 a[254:255], v2 offset:37856
    v_mfma_f32_16x16x32_bf16 v[168:171], a[144:147], v[40:43], 0
    v_exp_f32 v22, v22
    v_mfma_f32_16x16x32_bf16 v[168:171], a[148:151], v[44:47], v[168:171]
    v_cvt_pk_bf16_f32 v34, v20, v21
    v_mfma_f32_16x16x32_bf16 v[172:175], a[152:155], v[40:43], 0
    v_exp_f32 v23, v23
    v_mfma_f32_16x16x32_bf16 v[172:175], a[156:159], v[44:47], v[172:175]
    v_mfma_f32_16x16x32_bf16 v[176:179], a[160:163], v[40:43], 0
    v_exp_f32 v24, v24
    v_mfma_f32_16x16x32_bf16 v[176:179], a[164:167], v[44:47], v[176:179]
    v_cvt_pk_bf16_f32 v35, v22, v23
    v_mfma_f32_16x16x32_bf16 v[180:183], a[168:171], v[40:43], 0
    v_exp_f32 v25, v25
    v_mfma_f32_16x16x32_bf16 v[180:183], a[172:175], v[44:47], v[180:183]
    v_mfma_f32_16x16x32_bf16 v[184:187], a[176:179], v[40:43], 0
    v_exp_f32 v26, v26
    v_mfma_f32_16x16x32_bf16 v[184:187], a[180:183], v[44:47], v[184:187]
    v_cvt_pk_bf16_f32 v36, v24, v25
    v_mfma_f32_16x16x32_bf16 v[188:191], a[184:187], v[40:43], 0
    v_exp_f32 v27, v27
    v_mfma_f32_16x16x32_bf16 v[188:191], a[188:191], v[44:47], v[188:191]
    v_smfmac_f32_16x16x64_bf16 a[4:7], a[16:19], v[40:47], v11
    v_mfma_f32_16x16x32_bf16 v[16:19], a[64:67], v[112:115], v[60:63]
    v_exp_f32 v28, v28
    v_mfma_f32_16x16x32_bf16 v[16:19], a[68:71], v[116:119], v[16:19]
    s_add_u32 s46, s46, 16384
    ds_read_b128 a[64:67], v1 offset:36864
    v_cvt_pk_bf16_f32 v37, v26, v27
    v_mfma_f32_16x16x32_bf16 v[16:19], a[72:75], v[120:123], v[16:19]
    v_exp_f32 v29, v29
    v_mfma_f32_16x16x32_bf16 v[16:19], a[76:79], v[124:127], v[16:19]
    ds_read_b128 a[68:71], v1 offset:36928
    v_mfma_f32_16x16x32_bf16 v[20:23], a[80:83], v[112:115], v[60:63]
    v_exp_f32 v30, v30
    v_mfma_f32_16x16x32_bf16 v[20:23], a[84:87], v[116:119], v[20:23]
    ds_read_b128 a[72:75], v1 offset:36992
    v_cvt_pk_bf16_f32 v38, v28, v29
    v_mfma_f32_16x16x32_bf16 v[20:23], a[88:91], v[120:123], v[20:23]
    v_exp_f32 v31, v31
    v_mfma_f32_16x16x32_bf16 v[20:23], a[92:95], v[124:127], v[20:23]
    ds_read_b128 a[76:79], v1 offset:37056
    v_mfma_f32_16x16x32_bf16 v[24:27], a[96:99], v[112:115], v[60:63]
    v_exp_f32 v16, v16
    v_mfma_f32_16x16x32_bf16 v[24:27], a[100:103], v[116:119], v[24:27]
    ds_read_b128 a[80:83], v1 offset:37120
    v_cvt_pk_bf16_f32 v39, v30, v31
    v_mfma_f32_16x16x32_bf16 v[24:27], a[104:107], v[120:123], v[24:27]
    v_exp_f32 v17, v17
    v_mfma_f32_16x16x32_bf16 v[24:27], a[108:111], v[124:127], v[24:27]
    ds_read_b128 a[84:87], v1 offset:37184
    v_mfma_f32_16x16x32_bf16 v[28:31], a[112:115], v[112:115], v[60:63]
    v_exp_f32 v18, v18
    v_mfma_f32_16x16x32_bf16 v[28:31], a[116:119], v[116:119], v[28:31]
    ds_read_b128 a[88:91], v1 offset:37248
    v_cvt_pk_bf16_f32 v40, v16, v17
    v_mfma_f32_16x16x32_bf16 v[28:31], a[120:123], v[120:123], v[28:31]
    v_exp_f32 v19, v19
    v_mfma_f32_16x16x32_bf16 v[28:31], a[124:127], v[124:127], v[28:31]
    ds_read_b128 a[92:95], v1 offset:37312
    v_mfma_f32_16x16x32_bf16 v[192:195], a[128:131], v[32:35], 0
    v_exp_f32 v20, v20
    v_mfma_f32_16x16x32_bf16 v[192:195], a[132:135], v[36:39], v[192:195]
    ds_read_b128 a[96:99], v1 offset:37376
    v_cvt_pk_bf16_f32 v41, v18, v19
    v_mfma_f32_16x16x32_bf16 v[196:199], a[136:139], v[32:35], 0
    v_exp_f32 v21, v21
    v_mfma_f32_16x16x32_bf16 v[196:199], a[140:143], v[36:39], v[196:199]
    ds_read_b128 a[100:103], v1 offset:37440
    v_mfma_f32_16x16x32_bf16 v[200:203], a[144:147], v[32:35], 0
    v_exp_f32 v22, v22
    v_mfma_f32_16x16x32_bf16 v[200:203], a[148:151], v[36:39], v[200:203]
    ds_read_b128 a[104:107], v1 offset:37504
    v_cvt_pk_bf16_f32 v42, v20, v21
    v_mfma_f32_16x16x32_bf16 v[204:207], a[152:155], v[32:35], 0
    v_exp_f32 v23, v23
    v_mfma_f32_16x16x32_bf16 v[204:207], a[156:159], v[36:39], v[204:207]
    ds_read_b128 a[108:111], v1 offset:37568
    v_mfma_f32_16x16x32_bf16 v[208:211], a[160:163], v[32:35], 0
    v_exp_f32 v24, v24
    v_mfma_f32_16x16x32_bf16 v[208:211], a[164:167], v[36:39], v[208:211]
    ds_read_b128 a[112:115], v1 offset:37632
    v_cvt_pk_bf16_f32 v43, v22, v23
    v_mfma_f32_16x16x32_bf16 v[212:215], a[168:171], v[32:35], 0
    v_exp_f32 v25, v25
    v_mfma_f32_16x16x32_bf16 v[212:215], a[172:175], v[36:39], v[212:215]
    ds_read_b128 a[116:119], v1 offset:37696
    v_mfma_f32_16x16x32_bf16 v[216:219], a[176:179], v[32:35], 0
    v_exp_f32 v26, v26
    v_mfma_f32_16x16x32_bf16 v[216:219], a[180:183], v[36:39], v[216:219]
    ds_read_b128 a[120:123], v1 offset:37760
    v_cvt_pk_bf16_f32 v44, v24, v25
    v_mfma_f32_16x16x32_bf16 v[220:223], a[184:187], v[32:35], 0
    v_exp_f32 v27, v27
    v_mfma_f32_16x16x32_bf16 v[220:223], a[188:191], v[36:39], v[220:223]
    ds_read_b128 a[124:127], v1 offset:37824
    v_smfmac_f32_16x16x64_bf16 a[8:11], a[16:19], v[32:39], v11
    s_waitcnt vmcnt(9) lgkmcnt(12)
    s_barrier
.p2align 5
L2_loop:
    v_mfma_f32_16x16x32_bf16 v[16:19], a[64:67], v[64:67], v[48:51]
    s_sub_u32 s47, s47, s48
    v_exp_f32 v28, v28
    v_mfma_f32_16x16x32_bf16 v[16:19], a[68:71], v[68:71], v[16:19]
L2_pad4:
    s_cbranch_execz L2_pad8
    v_cvt_pk_bf16_f32 v45, v26, v27
    v_add_u32 v1, s48, v1
    v_mfma_f32_16x16x32_bf16 v[16:19], a[72:75], v[72:75], v[16:19]
    s_add_u32 m0, s47, 0
    v_exp_f32 v29, v29
    v_mfma_f32_16x16x32_bf16 v[16:19], a[76:79], v[76:79], v[16:19]
    s_waitcnt lgkmcnt(8)
    buffer_load_dwordx4 v5, s[16:19], s46 offen offset:0 lds
    v_mfma_f32_16x16x32_bf16 v[20:23], a[80:83], v[64:67], v[48:51]
    v_exp_f32 v30, v30
    v_mfma_f32_16x16x32_bf16 v[20:23], a[84:87], v[68:71], v[20:23]
    v_cvt_pk_bf16_f32 v46, v28, v29
    v_add_u32 v2, s48, v2
    v_mfma_f32_16x16x32_bf16 v[20:23], a[88:91], v[72:75], v[20:23]
    s_add_u32 m0, s47, 32
    v_exp_f32 v31, v31
    v_mfma_f32_16x16x32_bf16 v[20:23], a[92:95], v[76:79], v[20:23]
    s_waitcnt lgkmcnt(4)
    buffer_load_dwordx4 v5, s[16:19], s46 offen offset:1024 lds
    v_mfma_f32_16x16x32_bf16 v[24:27], a[96:99], v[64:67], v[48:51]
    s_sub_u32 s48, 0, s48
    v_exp_f32 v16, v16
    v_mfma_f32_16x16x32_bf16 v[24:27], a[100:103], v[68:71], v[24:27]
    v_cvt_pk_bf16_f32 v47, v30, v31
    v_mfma_f32_16x16x32_bf16 v[24:27], a[104:107], v[72:75], v[24:27]
    s_add_u32 m0, s47, 64
    v_exp_f32 v17, v17
    v_mfma_f32_16x16x32_bf16 v[24:27], a[108:111], v[76:79], v[24:27]
    s_waitcnt lgkmcnt(0)
    buffer_load_dwordx4 v5, s[16:19], s46 offen offset:2048 lds
    v_mfma_f32_16x16x32_bf16 v[28:31], a[112:115], v[64:67], v[48:51]
    v_exp_f32 v18, v18
    v_mfma_f32_16x16x32_bf16 v[28:31], a[116:119], v[68:71], v[28:31]
    v_cvt_pk_bf16_f32 v32, v16, v17
    v_mfma_f32_16x16x32_bf16 v[28:31], a[120:123], v[72:75], v[28:31]
    s_add_u32 m0, s47, 96
    v_exp_f32 v19, v19
    v_mfma_f32_16x16x32_bf16 v[28:31], a[124:127], v[76:79], v[28:31]
    buffer_load_dwordx4 v5, s[16:19], s46 offen offset:3072 lds
    v_mfma_f32_16x16x32_bf16 v[224:227], a[128:131], v[40:43], v[224:227]
    v_exp_f32 v20, v20
    v_mfma_f32_16x16x32_bf16 v[224:227], a[132:135], v[44:47], v[224:227]
    ds_read_b64_tr_b16 a[128:129], v2 offset:0
    v_cvt_pk_bf16_f32 v33, v18, v19
    v_mfma_f32_16x16x32_bf16 v[228:231], a[136:139], v[40:43], v[228:231]
    s_add_u32 m0, s47, 16896
    v_exp_f32 v21, v21
    v_mfma_f32_16x16x32_bf16 v[228:231], a[140:143], v[44:47], v[228:231]
    buffer_load_dwordx4 v5, s[20:23], s46 offen offset:0 lds
    v_mfma_f32_16x16x32_bf16 v[232:235], a[144:147], v[40:43], v[232:235]
    v_exp_f32 v22, v22
    v_mfma_f32_16x16x32_bf16 v[232:235], a[148:151], v[44:47], v[232:235]
    ds_read_b64_tr_b16 a[130:131], v2 offset:256
    v_cvt_pk_bf16_f32 v34, v20, v21
    v_mfma_f32_16x16x32_bf16 v[236:239], a[152:155], v[40:43], v[236:239]
    s_add_u32 m0, s47, 16928
    v_exp_f32 v23, v23
    v_mfma_f32_16x16x32_bf16 v[236:239], a[156:159], v[44:47], v[236:239]
    buffer_load_dwordx4 v5, s[20:23], s46 offen offset:1024 lds
    v_mfma_f32_16x16x32_bf16 v[240:243], a[160:163], v[40:43], v[240:243]
    v_exp_f32 v24, v24
    v_mfma_f32_16x16x32_bf16 v[240:243], a[164:167], v[44:47], v[240:243]
    ds_read_b64_tr_b16 a[132:133], v2 offset:512
    v_cvt_pk_bf16_f32 v35, v22, v23
    v_mfma_f32_16x16x32_bf16 v[244:247], a[168:171], v[40:43], v[244:247]
    s_add_u32 m0, s47, 16960
    v_exp_f32 v25, v25
    v_mfma_f32_16x16x32_bf16 v[244:247], a[172:175], v[44:47], v[244:247]
    buffer_load_dwordx4 v5, s[20:23], s46 offen offset:2048 lds
    v_mfma_f32_16x16x32_bf16 v[248:251], a[176:179], v[40:43], v[248:251]
    v_exp_f32 v26, v26
    v_mfma_f32_16x16x32_bf16 v[248:251], a[180:183], v[44:47], v[248:251]
    ds_read_b64_tr_b16 a[134:135], v2 offset:768
    v_cvt_pk_bf16_f32 v36, v24, v25
    v_mfma_f32_16x16x32_bf16 v[252:255], a[184:187], v[40:43], v[252:255]
    s_add_u32 m0, s47, 16992
    v_exp_f32 v27, v27
    v_mfma_f32_16x16x32_bf16 v[252:255], a[188:191], v[44:47], v[252:255]
    buffer_load_dwordx4 v5, s[20:23], s46 offen offset:3072 lds
    v_smfmac_f32_16x16x64_bf16 a[12:15], a[16:19], v[40:47], v11
    ds_read_b64_tr_b16 a[136:137], v2 offset:32
    v_mfma_f32_16x16x32_bf16 v[16:19], a[64:67], v[80:83], v[52:55]
    v_exp_f32 v28, v28
    v_mfma_f32_16x16x32_bf16 v[16:19], a[68:71], v[84:87], v[16:19]
    ds_read_b64_tr_b16 a[138:139], v2 offset:288
    v_cvt_pk_bf16_f32 v37, v26, v27
    v_mfma_f32_16x16x32_bf16 v[16:19], a[72:75], v[88:91], v[16:19]
    v_exp_f32 v29, v29
    v_mfma_f32_16x16x32_bf16 v[16:19], a[76:79], v[92:95], v[16:19]
    global_load_dword a63, v9, s[98:99]
    v_mfma_f32_16x16x32_bf16 v[20:23], a[80:83], v[80:83], v[52:55]
    v_exp_f32 v30, v30
    v_mfma_f32_16x16x32_bf16 v[20:23], a[84:87], v[84:87], v[20:23]
    ds_read_b64_tr_b16 a[140:141], v2 offset:544
    v_cvt_pk_bf16_f32 v38, v28, v29
    v_mfma_f32_16x16x32_bf16 v[20:23], a[88:91], v[88:91], v[20:23]
    v_exp_f32 v31, v31
    v_mfma_f32_16x16x32_bf16 v[20:23], a[92:95], v[92:95], v[20:23]
    ds_read_b64_tr_b16 a[142:143], v2 offset:800
    v_mfma_f32_16x16x32_bf16 v[24:27], a[96:99], v[80:83], v[52:55]
    v_exp_f32 v16, v16
    v_mfma_f32_16x16x32_bf16 v[24:27], a[100:103], v[84:87], v[24:27]
    ds_read_b64_tr_b16 a[144:145], v2 offset:64
    v_cvt_pk_bf16_f32 v39, v30, v31
    v_mfma_f32_16x16x32_bf16 v[24:27], a[104:107], v[88:91], v[24:27]
    v_exp_f32 v17, v17
    v_mfma_f32_16x16x32_bf16 v[24:27], a[108:111], v[92:95], v[24:27]
    ds_read_b64_tr_b16 a[146:147], v2 offset:320
    v_mfma_f32_16x16x32_bf16 v[28:31], a[112:115], v[80:83], v[52:55]
    v_exp_f32 v18, v18
    v_mfma_f32_16x16x32_bf16 v[28:31], a[116:119], v[84:87], v[28:31]
    ds_read_b64_tr_b16 a[148:149], v2 offset:576
    v_cvt_pk_bf16_f32 v40, v16, v17
    v_mfma_f32_16x16x32_bf16 v[28:31], a[120:123], v[88:91], v[28:31]
    v_exp_f32 v19, v19
    v_mfma_f32_16x16x32_bf16 v[28:31], a[124:127], v[92:95], v[28:31]
    ds_read_b64_tr_b16 a[150:151], v2 offset:832
    v_mfma_f32_16x16x32_bf16 v[128:131], a[192:195], v[32:35], v[128:131]
    v_exp_f32 v20, v20
    v_mfma_f32_16x16x32_bf16 v[128:131], a[196:199], v[36:39], v[128:131]
    ds_read_b64_tr_b16 a[152:153], v2 offset:96
    v_cvt_pk_bf16_f32 v41, v18, v19
    v_mfma_f32_16x16x32_bf16 v[132:135], a[200:203], v[32:35], v[132:135]
    v_exp_f32 v21, v21
    v_mfma_f32_16x16x32_bf16 v[132:135], a[204:207], v[36:39], v[132:135]
    ds_read_b64_tr_b16 a[154:155], v2 offset:352
    v_mfma_f32_16x16x32_bf16 v[136:139], a[208:211], v[32:35], v[136:139]
    v_exp_f32 v22, v22
    v_mfma_f32_16x16x32_bf16 v[136:139], a[212:215], v[36:39], v[136:139]
    ds_read_b64_tr_b16 a[156:157], v2 offset:608
    v_cvt_pk_bf16_f32 v42, v20, v21
    v_mfma_f32_16x16x32_bf16 v[140:143], a[216:219], v[32:35], v[140:143]
    v_exp_f32 v23, v23
    v_mfma_f32_16x16x32_bf16 v[140:143], a[220:223], v[36:39], v[140:143]
    ds_read_b64_tr_b16 a[158:159], v2 offset:864
    v_mfma_f32_16x16x32_bf16 v[144:147], a[224:227], v[32:35], v[144:147]
    v_exp_f32 v24, v24
    v_mfma_f32_16x16x32_bf16 v[144:147], a[228:231], v[36:39], v[144:147]
    ds_read_b64_tr_b16 a[160:161], v2 offset:128
    v_cvt_pk_bf16_f32 v43, v22, v23
    v_mfma_f32_16x16x32_bf16 v[148:151], a[232:235], v[32:35], v[148:151]
    v_exp_f32 v25, v25
    v_mfma_f32_16x16x32_bf16 v[148:151], a[236:239], v[36:39], v[148:151]
    ds_read_b64_tr_b16 a[162:163], v2 offset:384
    v_mfma_f32_16x16x32_bf16 v[152:155], a[240:243], v[32:35], v[152:155]
    v_exp_f32 v26, v26
    v_mfma_f32_16x16x32_bf16 v[152:155], a[244:247], v[36:39], v[152:155]
    ds_read_b64_tr_b16 a[164:165], v2 offset:640
    v_cvt_pk_bf16_f32 v44, v24, v25
    v_mfma_f32_16x16x32_bf16 v[156:159], a[248:251], v[32:35], v[156:159]
    v_exp_f32 v27, v27
    v_mfma_f32_16x16x32_bf16 v[156:159], a[252:255], v[36:39], v[156:159]
    ds_read_b64_tr_b16 a[166:167], v2 offset:896
    v_smfmac_f32_16x16x64_bf16 a[0:3], a[16:19], v[32:39], v11
    ds_read_b64_tr_b16 a[168:169], v2 offset:160
    v_mfma_f32_16x16x32_bf16 v[16:19], a[64:67], v[96:99], v[56:59]
    v_exp_f32 v28, v28
    v_mfma_f32_16x16x32_bf16 v[16:19], a[68:71], v[100:103], v[16:19]
    ds_read_b64_tr_b16 a[170:171], v2 offset:416
    v_cvt_pk_bf16_f32 v45, v26, v27
    v_mfma_f32_16x16x32_bf16 v[16:19], a[72:75], v[104:107], v[16:19]
    v_exp_f32 v29, v29
    v_mfma_f32_16x16x32_bf16 v[16:19], a[76:79], v[108:111], v[16:19]
    ds_read_b64_tr_b16 a[172:173], v2 offset:672
    v_mfma_f32_16x16x32_bf16 v[20:23], a[80:83], v[96:99], v[56:59]
    v_exp_f32 v30, v30
    v_mfma_f32_16x16x32_bf16 v[20:23], a[84:87], v[100:103], v[20:23]
    ds_read_b64_tr_b16 a[174:175], v2 offset:928
    v_cvt_pk_bf16_f32 v46, v28, v29
    v_mfma_f32_16x16x32_bf16 v[20:23], a[88:91], v[104:107], v[20:23]
    v_exp_f32 v31, v31
    v_mfma_f32_16x16x32_bf16 v[20:23], a[92:95], v[108:111], v[20:23]
    ds_read_b64_tr_b16 a[176:177], v2 offset:192
    v_mfma_f32_16x16x32_bf16 v[24:27], a[96:99], v[96:99], v[56:59]
    v_exp_f32 v16, v16
    v_mfma_f32_16x16x32_bf16 v[24:27], a[100:103], v[100:103], v[24:27]
    ds_read_b64_tr_b16 a[178:179], v2 offset:448
    v_cvt_pk_bf16_f32 v47, v30, v31
    v_mfma_f32_16x16x32_bf16 v[24:27], a[104:107], v[104:107], v[24:27]
    v_exp_f32 v17, v17
    v_mfma_f32_16x16x32_bf16 v[24:27], a[108:111], v[108:111], v[24:27]
    ds_read_b64_tr_b16 a[180:181], v2 offset:704
    v_mfma_f32_16x16x32_bf16 v[28:31], a[112:115], v[96:99], v[56:59]
    v_exp_f32 v18, v18
    v_mfma_f32_16x16x32_bf16 v[28:31], a[116:119], v[100:103], v[28:31]
    ds_read_b64_tr_b16 a[182:183], v2 offset:960
    v_cvt_pk_bf16_f32 v32, v16, v17
    v_mfma_f32_16x16x32_bf16 v[28:31], a[120:123], v[104:107], v[28:31]
    v_exp_f32 v19, v19
    v_mfma_f32_16x16x32_bf16 v[28:31], a[124:127], v[108:111], v[28:31]
    ds_read_b64_tr_b16 a[184:185], v2 offset:224
    v_mfma_f32_16x16x32_bf16 v[160:163], a[192:195], v[40:43], v[160:163]
    v_exp_f32 v20, v20
    v_mfma_f32_16x16x32_bf16 v[160:163], a[196:199], v[44:47], v[160:163]
    ds_read_b64_tr_b16 a[186:187], v2 offset:480
    v_cvt_pk_bf16_f32 v33, v18, v19
    v_mfma_f32_16x16x32_bf16 v[164:167], a[200:203], v[40:43], v[164:167]
    v_exp_f32 v21, v21
    v_mfma_f32_16x16x32_bf16 v[164:167], a[204:207], v[44:47], v[164:167]
    ds_read_b64_tr_b16 a[188:189], v2 offset:736
    v_mfma_f32_16x16x32_bf16 v[168:171], a[208:211], v[40:43], v[168:171]
    v_exp_f32 v22, v22
    v_mfma_f32_16x16x32_bf16 v[168:171], a[212:215], v[44:47], v[168:171]
    ds_read_b64_tr_b16 a[190:191], v2 offset:992
    v_cvt_pk_bf16_f32 v34, v20, v21
    v_mfma_f32_16x16x32_bf16 v[172:175], a[216:219], v[40:43], v[172:175]
    v_exp_f32 v23, v23
    v_mfma_f32_16x16x32_bf16 v[172:175], a[220:223], v[44:47], v[172:175]
    v_mfma_f32_16x16x32_bf16 v[176:179], a[224:227], v[40:43], v[176:179]
    v_exp_f32 v24, v24
    v_mfma_f32_16x16x32_bf16 v[176:179], a[228:231], v[44:47], v[176:179]
    v_cvt_pk_bf16_f32 v35, v22, v23
    v_mfma_f32_16x16x32_bf16 v[180:183], a[232:235], v[40:43], v[180:183]
    v_exp_f32 v25, v25
    v_mfma_f32_16x16x32_bf16 v[180:183], a[236:239], v[44:47], v[180:183]
    v_mfma_f32_16x16x32_bf16 v[184:187], a[240:243], v[40:43], v[184:187]
    v_exp_f32 v26, v26
    v_mfma_f32_16x16x32_bf16 v[184:187], a[244:247], v[44:47], v[184:187]
    v_cvt_pk_bf16_f32 v36, v24, v25
    v_mfma_f32_16x16x32_bf16 v[188:191], a[248:251], v[40:43], v[188:191]
    v_exp_f32 v27, v27
    v_mfma_f32_16x16x32_bf16 v[188:191], a[252:255], v[44:47], v[188:191]
    v_smfmac_f32_16x16x64_bf16 a[4:7], a[16:19], v[40:47], v11
    v_mfma_f32_16x16x32_bf16 v[16:19], a[64:67], v[112:115], v[60:63]
    v_exp_f32 v28, v28
    v_mfma_f32_16x16x32_bf16 v[16:19], a[68:71], v[116:119], v[16:19]
    s_add_u32 s46, s46, 16384
    ds_read_b128 a[64:67], v1 offset:0
    v_cvt_pk_bf16_f32 v37, v26, v27
    v_mfma_f32_16x16x32_bf16 v[16:19], a[72:75], v[120:123], v[16:19]
    v_exp_f32 v29, v29
    v_mfma_f32_16x16x32_bf16 v[16:19], a[76:79], v[124:127], v[16:19]
    ds_read_b128 a[68:71], v1 offset:64
    v_mfma_f32_16x16x32_bf16 v[20:23], a[80:83], v[112:115], v[60:63]
    v_exp_f32 v30, v30
    v_mfma_f32_16x16x32_bf16 v[20:23], a[84:87], v[116:119], v[20:23]
    ds_read_b128 a[72:75], v1 offset:128
    v_cvt_pk_bf16_f32 v38, v28, v29
    v_mfma_f32_16x16x32_bf16 v[20:23], a[88:91], v[120:123], v[20:23]
    v_exp_f32 v31, v31
    v_mfma_f32_16x16x32_bf16 v[20:23], a[92:95], v[124:127], v[20:23]
    ds_read_b128 a[76:79], v1 offset:192
    v_mfma_f32_16x16x32_bf16 v[24:27], a[96:99], v[112:115], v[60:63]
    v_exp_f32 v16, v16
    v_mfma_f32_16x16x32_bf16 v[24:27], a[100:103], v[116:119], v[24:27]
    ds_read_b128 a[80:83], v1 offset:256
    v_cvt_pk_bf16_f32 v39, v30, v31
    v_mfma_f32_16x16x32_bf16 v[24:27], a[104:107], v[120:123], v[24:27]
    v_exp_f32 v17, v17
    v_mfma_f32_16x16x32_bf16 v[24:27], a[108:111], v[124:127], v[24:27]
    ds_read_b128 a[84:87], v1 offset:320
    v_mfma_f32_16x16x32_bf16 v[28:31], a[112:115], v[112:115], v[60:63]
    v_exp_f32 v18, v18
    v_mfma_f32_16x16x32_bf16 v[28:31], a[116:119], v[116:119], v[28:31]
    ds_read_b128 a[88:91], v1 offset:384
    v_cvt_pk_bf16_f32 v40, v16, v17
    v_mfma_f32_16x16x32_bf16 v[28:31], a[120:123], v[120:123], v[28:31]
    v_exp_f32 v19, v19
    v_mfma_f32_16x16x32_bf16 v[28:31], a[124:127], v[124:127], v[28:31]
    ds_read_b128 a[92:95], v1 offset:448
    v_mfma_f32_16x16x32_bf16 v[192:195], a[192:195], v[32:35], v[192:195]
    v_exp_f32 v20, v20
    v_mfma_f32_16x16x32_bf16 v[192:195], a[196:199], v[36:39], v[192:195]
    ds_read_b128 a[96:99], v1 offset:512
    v_cvt_pk_bf16_f32 v41, v18, v19
    v_mfma_f32_16x16x32_bf16 v[196:199], a[200:203], v[32:35], v[196:199]
    v_exp_f32 v21, v21
    v_mfma_f32_16x16x32_bf16 v[196:199], a[204:207], v[36:39], v[196:199]
    ds_read_b128 a[100:103], v1 offset:576
    v_mfma_f32_16x16x32_bf16 v[200:203], a[208:211], v[32:35], v[200:203]
    v_exp_f32 v22, v22
    v_mfma_f32_16x16x32_bf16 v[200:203], a[212:215], v[36:39], v[200:203]
    ds_read_b128 a[104:107], v1 offset:640
    v_cvt_pk_bf16_f32 v42, v20, v21
    v_mfma_f32_16x16x32_bf16 v[204:207], a[216:219], v[32:35], v[204:207]
    v_exp_f32 v23, v23
    v_mfma_f32_16x16x32_bf16 v[204:207], a[220:223], v[36:39], v[204:207]
    ds_read_b128 a[108:111], v1 offset:704
    v_mfma_f32_16x16x32_bf16 v[208:211], a[224:227], v[32:35], v[208:211]
    v_exp_f32 v24, v24
    v_mfma_f32_16x16x32_bf16 v[208:211], a[228:231], v[36:39], v[208:211]
    ds_read_b128 a[112:115], v1 offset:768
    v_cvt_pk_bf16_f32 v43, v22, v23
    v_mfma_f32_16x16x32_bf16 v[212:215], a[232:235], v[32:35], v[212:215]
    v_exp_f32 v25, v25
    v_mfma_f32_16x16x32_bf16 v[212:215], a[236:239], v[36:39], v[212:215]
    ds_read_b128 a[116:119], v1 offset:832
    v_mfma_f32_16x16x32_bf16 v[216:219], a[240:243], v[32:35], v[216:219]
    v_exp_f32 v26, v26
    v_mfma_f32_16x16x32_bf16 v[216:219], a[244:247], v[36:39], v[216:219]
    ds_read_b128 a[120:123], v1 offset:896
    v_cvt_pk_bf16_f32 v44, v24, v25
    v_mfma_f32_16x16x32_bf16 v[220:223], a[248:251], v[32:35], v[220:223]
    v_exp_f32 v27, v27
    v_mfma_f32_16x16x32_bf16 v[220:223], a[252:255], v[36:39], v[220:223]
    ds_read_b128 a[124:127], v1 offset:960
    v_smfmac_f32_16x16x64_bf16 a[8:11], a[16:19], v[32:39], v11
    s_waitcnt vmcnt(9) lgkmcnt(12)
    s_barrier
    v_mfma_f32_16x16x32_bf16 v[16:19], a[64:67], v[64:67], v[48:51]
    v_exp_f32 v28, v28
    v_mfma_f32_16x16x32_bf16 v[16:19], a[68:71], v[68:71], v[16:19]
    v_cvt_pk_bf16_f32 v45, v26, v27
    v_mfma_f32_16x16x32_bf16 v[16:19], a[72:75], v[72:75], v[16:19]
    s_add_u32 m0, s47, 36864
    v_exp_f32 v29, v29
    v_mfma_f32_16x16x32_bf16 v[16:19], a[76:79], v[76:79], v[16:19]
    s_waitcnt lgkmcnt(8)
    buffer_load_dwordx4 v5, s[16:19], s46 offen offset:0 lds
    v_mfma_f32_16x16x32_bf16 v[20:23], a[80:83], v[64:67], v[48:51]
    v_exp_f32 v30, v30
    v_mfma_f32_16x16x32_bf16 v[20:23], a[84:87], v[68:71], v[20:23]
    v_cvt_pk_bf16_f32 v46, v28, v29
    v_mfma_f32_16x16x32_bf16 v[20:23], a[88:91], v[72:75], v[20:23]
    s_add_u32 m0, s47, 36896
    v_exp_f32 v31, v31
    v_mfma_f32_16x16x32_bf16 v[20:23], a[92:95], v[76:79], v[20:23]
    s_waitcnt lgkmcnt(4)
    buffer_load_dwordx4 v5, s[16:19], s46 offen offset:1024 lds
    v_mfma_f32_16x16x32_bf16 v[24:27], a[96:99], v[64:67], v[48:51]
    v_exp_f32 v16, v16
    v_mfma_f32_16x16x32_bf16 v[24:27], a[100:103], v[68:71], v[24:27]
    v_cvt_pk_bf16_f32 v47, v30, v31
    v_mfma_f32_16x16x32_bf16 v[24:27], a[104:107], v[72:75], v[24:27]
    s_add_u32 m0, s47, 36928
    v_exp_f32 v17, v17
    v_mfma_f32_16x16x32_bf16 v[24:27], a[108:111], v[76:79], v[24:27]
    s_waitcnt lgkmcnt(0)
    buffer_load_dwordx4 v5, s[16:19], s46 offen offset:2048 lds
    v_mfma_f32_16x16x32_bf16 v[28:31], a[112:115], v[64:67], v[48:51]
    v_exp_f32 v18, v18
    v_mfma_f32_16x16x32_bf16 v[28:31], a[116:119], v[68:71], v[28:31]
    v_cvt_pk_bf16_f32 v32, v16, v17
    v_mfma_f32_16x16x32_bf16 v[28:31], a[120:123], v[72:75], v[28:31]
    s_add_u32 m0, s47, 36960
    v_exp_f32 v19, v19
    v_mfma_f32_16x16x32_bf16 v[28:31], a[124:127], v[76:79], v[28:31]
    buffer_load_dwordx4 v5, s[16:19], s46 offen offset:3072 lds
    v_mfma_f32_16x16x32_bf16 v[224:227], a[192:195], v[40:43], v[224:227]
    v_exp_f32 v20, v20
    v_mfma_f32_16x16x32_bf16 v[224:227], a[196:199], v[44:47], v[224:227]
    ds_read_b64_tr_b16 a[192:193], v2 offset:36864
    v_cvt_pk_bf16_f32 v33, v18, v19
    v_mfma_f32_16x16x32_bf16 v[228:231], a[200:203], v[40:43], v[228:231]
    s_add_u32 m0, s47, 53760
    v_exp_f32 v21, v21
    v_mfma_f32_16x16x32_bf16 v[228:231], a[204:207], v[44:47], v[228:231]
    buffer_load_dwordx4 v5, s[20:23], s46 offen offset:0 lds
    v_mfma_f32_16x16x32_bf16 v[232:235], a[208:211], v[40:43], v[232:235]
    v_exp_f32 v22, v22
    v_mfma_f32_16x16x32_bf16 v[232:235], a[212:215], v[44:47], v[232:235]
    ds_read_b64_tr_b16 a[194:195], v2 offset:37120
    v_cvt_pk_bf16_f32 v34, v20, v21
    v_mfma_f32_16x16x32_bf16 v[236:239], a[216:219], v[40:43], v[236:239]
    s_add_u32 m0, s47, 53792
    v_exp_f32 v23, v23
    v_mfma_f32_16x16x32_bf16 v[236:239], a[220:223], v[44:47], v[236:239]
    buffer_load_dwordx4 v5, s[20:23], s46 offen offset:1024 lds
    v_mfma_f32_16x16x32_bf16 v[240:243], a[224:227], v[40:43], v[240:243]
    v_exp_f32 v24, v24
    v_mfma_f32_16x16x32_bf16 v[240:243], a[228:231], v[44:47], v[240:243]
    ds_read_b64_tr_b16 a[196:197], v2 offset:37376
    v_cvt_pk_bf16_f32 v35, v22, v23
    v_mfma_f32_16x16x32_bf16 v[244:247], a[232:235], v[40:43], v[244:247]
    s_add_u32 m0, s47, 53824
    v_exp_f32 v25, v25
    v_mfma_f32_16x16x32_bf16 v[244:247], a[236:239], v[44:47], v[244:247]
    buffer_load_dwordx4 v5, s[20:23], s46 offen offset:2048 lds
    v_mfma_f32_16x16x32_bf16 v[248:251], a[240:243], v[40:43], v[248:251]
    v_exp_f32 v26, v26
    v_mfma_f32_16x16x32_bf16 v[248:251], a[244:247], v[44:47], v[248:251]
    ds_read_b64_tr_b16 a[198:199], v2 offset:37632
    v_cvt_pk_bf16_f32 v36, v24, v25
    v_mfma_f32_16x16x32_bf16 v[252:255], a[248:251], v[40:43], v[252:255]
    s_add_u32 m0, s47, 53856
    v_exp_f32 v27, v27
    v_mfma_f32_16x16x32_bf16 v[252:255], a[252:255], v[44:47], v[252:255]
    buffer_load_dwordx4 v5, s[20:23], s46 offen offset:3072 lds
    v_smfmac_f32_16x16x64_bf16 a[12:15], a[16:19], v[40:47], v11
    ds_read_b64_tr_b16 a[200:201], v2 offset:36896
    v_mfma_f32_16x16x32_bf16 v[16:19], a[64:67], v[80:83], v[52:55]
    v_exp_f32 v28, v28
    v_mfma_f32_16x16x32_bf16 v[16:19], a[68:71], v[84:87], v[16:19]
    ds_read_b64_tr_b16 a[202:203], v2 offset:37152
    v_cvt_pk_bf16_f32 v37, v26, v27
    v_mfma_f32_16x16x32_bf16 v[16:19], a[72:75], v[88:91], v[16:19]
    v_exp_f32 v29, v29
    v_mfma_f32_16x16x32_bf16 v[16:19], a[76:79], v[92:95], v[16:19]
    ds_read_b64_tr_b16 a[204:205], v2 offset:37408
    v_mfma_f32_16x16x32_bf16 v[20:23], a[80:83], v[80:83], v[52:55]
    v_exp_f32 v30, v30
    v_mfma_f32_16x16x32_bf16 v[20:23], a[84:87], v[84:87], v[20:23]
    ds_read_b64_tr_b16 a[206:207], v2 offset:37664
    v_cvt_pk_bf16_f32 v38, v28, v29
    v_mfma_f32_16x16x32_bf16 v[20:23], a[88:91], v[88:91], v[20:23]
    v_exp_f32 v31, v31
    v_mfma_f32_16x16x32_bf16 v[20:23], a[92:95], v[92:95], v[20:23]
    ds_read_b64_tr_b16 a[208:209], v2 offset:36928
    v_mfma_f32_16x16x32_bf16 v[24:27], a[96:99], v[80:83], v[52:55]
    v_exp_f32 v16, v16
    v_mfma_f32_16x16x32_bf16 v[24:27], a[100:103], v[84:87], v[24:27]
    ds_read_b64_tr_b16 a[210:211], v2 offset:37184
    v_cvt_pk_bf16_f32 v39, v30, v31
    v_mfma_f32_16x16x32_bf16 v[24:27], a[104:107], v[88:91], v[24:27]
    v_exp_f32 v17, v17
    v_mfma_f32_16x16x32_bf16 v[24:27], a[108:111], v[92:95], v[24:27]
    ds_read_b64_tr_b16 a[212:213], v2 offset:37440
    v_mfma_f32_16x16x32_bf16 v[28:31], a[112:115], v[80:83], v[52:55]
    v_exp_f32 v18, v18
    v_mfma_f32_16x16x32_bf16 v[28:31], a[116:119], v[84:87], v[28:31]
    ds_read_b64_tr_b16 a[214:215], v2 offset:37696
    v_cvt_pk_bf16_f32 v40, v16, v17
    v_mfma_f32_16x16x32_bf16 v[28:31], a[120:123], v[88:91], v[28:31]
    v_exp_f32 v19, v19
    v_mfma_f32_16x16x32_bf16 v[28:31], a[124:127], v[92:95], v[28:31]
    ds_read_b64_tr_b16 a[216:217], v2 offset:36960
    v_mfma_f32_16x16x32_bf16 v[128:131], a[128:131], v[32:35], v[128:131]
    v_exp_f32 v20, v20
    v_mfma_f32_16x16x32_bf16 v[128:131], a[132:135], v[36:39], v[128:131]
    ds_read_b64_tr_b16 a[218:219], v2 offset:37216
    v_cvt_pk_bf16_f32 v41, v18, v19
    v_mfma_f32_16x16x32_bf16 v[132:135], a[136:139], v[32:35], v[132:135]
    v_exp_f32 v21, v21
    v_mfma_f32_16x16x32_bf16 v[132:135], a[140:143], v[36:39], v[132:135]
    ds_read_b64_tr_b16 a[220:221], v2 offset:37472
    v_mfma_f32_16x16x32_bf16 v[136:139], a[144:147], v[32:35], v[136:139]
    v_exp_f32 v22, v22
    v_mfma_f32_16x16x32_bf16 v[136:139], a[148:151], v[36:39], v[136:139]
    ds_read_b64_tr_b16 a[222:223], v2 offset:37728
    v_cvt_pk_bf16_f32 v42, v20, v21
    v_mfma_f32_16x16x32_bf16 v[140:143], a[152:155], v[32:35], v[140:143]
    v_exp_f32 v23, v23
    v_mfma_f32_16x16x32_bf16 v[140:143], a[156:159], v[36:39], v[140:143]
    ds_read_b64_tr_b16 a[224:225], v2 offset:36992
    v_mfma_f32_16x16x32_bf16 v[144:147], a[160:163], v[32:35], v[144:147]
    v_exp_f32 v24, v24
    v_mfma_f32_16x16x32_bf16 v[144:147], a[164:167], v[36:39], v[144:147]
    ds_read_b64_tr_b16 a[226:227], v2 offset:37248
    v_cvt_pk_bf16_f32 v43, v22, v23
    v_mfma_f32_16x16x32_bf16 v[148:151], a[168:171], v[32:35], v[148:151]
    v_exp_f32 v25, v25
    v_mfma_f32_16x16x32_bf16 v[148:151], a[172:175], v[36:39], v[148:151]
    ds_read_b64_tr_b16 a[228:229], v2 offset:37504
    v_mfma_f32_16x16x32_bf16 v[152:155], a[176:179], v[32:35], v[152:155]
    v_exp_f32 v26, v26
    v_mfma_f32_16x16x32_bf16 v[152:155], a[180:183], v[36:39], v[152:155]
    ds_read_b64_tr_b16 a[230:231], v2 offset:37760
    v_cvt_pk_bf16_f32 v44, v24, v25
    v_mfma_f32_16x16x32_bf16 v[156:159], a[184:187], v[32:35], v[156:159]
    v_exp_f32 v27, v27
    v_mfma_f32_16x16x32_bf16 v[156:159], a[188:191], v[36:39], v[156:159]
    ds_read_b64_tr_b16 a[232:233], v2 offset:37024
    v_smfmac_f32_16x16x64_bf16 a[0:3], a[16:19], v[32:39], v11
    ds_read_b64_tr_b16 a[234:235], v2 offset:37280
    v_mfma_f32_16x16x32_bf16 v[16:19], a[64:67], v[96:99], v[56:59]
    v_exp_f32 v28, v28
    v_mfma_f32_16x16x32_bf16 v[16:19], a[68:71], v[100:103], v[16:19]
    ds_read_b64_tr_b16 a[236:237], v2 offset:37536
    v_cvt_pk_bf16_f32 v45, v26, v27
    v_mfma_f32_16x16x32_bf16 v[16:19], a[72:75], v[104:107], v[16:19]
    v_exp_f32 v29, v29
    v_mfma_f32_16x16x32_bf16 v[16:19], a[76:79], v[108:111], v[16:19]
    ds_read_b64_tr_b16 a[238:239], v2 offset:37792
    v_mfma_f32_16x16x32_bf16 v[20:23], a[80:83], v[96:99], v[56:59]
    v_exp_f32 v30, v30
    v_mfma_f32_16x16x32_bf16 v[20:23], a[84:87], v[100:103], v[20:23]
    ds_read_b64_tr_b16 a[240:241], v2 offset:37056
    v_cvt_pk_bf16_f32 v46, v28, v29
    v_mfma_f32_16x16x32_bf16 v[20:23], a[88:91], v[104:107], v[20:23]
    v_exp_f32 v31, v31
    v_mfma_f32_16x16x32_bf16 v[20:23], a[92:95], v[108:111], v[20:23]
    ds_read_b64_tr_b16 a[242:243], v2 offset:37312
    v_mfma_f32_16x16x32_bf16 v[24:27], a[96:99], v[96:99], v[56:59]
    v_exp_f32 v16, v16
    v_mfma_f32_16x16x32_bf16 v[24:27], a[100:103], v[100:103], v[24:27]
    ds_read_b64_tr_b16 a[244:245], v2 offset:37568
    v_cvt_pk_bf16_f32 v47, v30, v31
    v_mfma_f32_16x16x32_bf16 v[24:27], a[104:107], v[104:107], v[24:27]
    v_exp_f32 v17, v17
    v_mfma_f32_16x16x32_bf16 v[24:27], a[108:111], v[108:111], v[24:27]
    ds_read_b64_tr_b16 a[246:247], v2 offset:37824
    v_mfma_f32_16x16x32_bf16 v[28:31], a[112:115], v[96:99], v[56:59]
    v_exp_f32 v18, v18
    v_mfma_f32_16x16x32_bf16 v[28:31], a[116:119], v[100:103], v[28:31]
    ds_read_b64_tr_b16 a[248:249], v2 offset:37088
    v_cvt_pk_bf16_f32 v32, v16, v17
    v_mfma_f32_16x16x32_bf16 v[28:31], a[120:123], v[104:107], v[28:31]
    v_exp_f32 v19, v19
    v_mfma_f32_16x16x32_bf16 v[28:31], a[124:127], v[108:111], v[28:31]
    ds_read_b64_tr_b16 a[250:251], v2 offset:37344
    v_mfma_f32_16x16x32_bf16 v[160:163], a[128:131], v[40:43], v[160:163]
    v_exp_f32 v20, v20
    v_mfma_f32_16x16x32_bf16 v[160:163], a[132:135], v[44:47], v[160:163]
    ds_read_b64_tr_b16 a[252:253], v2 offset:37600
    v_cvt_pk_bf16_f32 v33, v18, v19
    v_mfma_f32_16x16x32_bf16 v[164:167], a[136:139], v[40:43], v[164:167]
    v_exp_f32 v21, v21
    v_mfma_f32_16x16x32_bf16 v[164:167], a[140:143], v[44:47], v[164:167]
    ds_read_b64_tr_b16 a[254:255], v2 offset:37856
    v_mfma_f32_16x16x32_bf16 v[168:171], a[144:147], v[40:43], v[168:171]
    v_exp_f32 v22, v22
    v_mfma_f32_16x16x32_bf16 v[168:171], a[148:151], v[44:47], v[168:171]
    v_cvt_pk_bf16_f32 v34, v20, v21
    v_mfma_f32_16x16x32_bf16 v[172:175], a[152:155], v[40:43], v[172:175]
    v_exp_f32 v23, v23
    v_mfma_f32_16x16x32_bf16 v[172:175], a[156:159], v[44:47], v[172:175]
    v_mfma_f32_16x16x32_bf16 v[176:179], a[160:163], v[40:43], v[176:179]
    v_exp_f32 v24, v24
    v_mfma_f32_16x16x32_bf16 v[176:179], a[164:167], v[44:47], v[176:179]
    v_cvt_pk_bf16_f32 v35, v22, v23
    v_mfma_f32_16x16x32_bf16 v[180:183], a[168:171], v[40:43], v[180:183]
    v_exp_f32 v25, v25
    v_mfma_f32_16x16x32_bf16 v[180:183], a[172:175], v[44:47], v[180:183]
    v_mfma_f32_16x16x32_bf16 v[184:187], a[176:179], v[40:43], v[184:187]
    v_exp_f32 v26, v26
    v_mfma_f32_16x16x32_bf16 v[184:187], a[180:183], v[44:47], v[184:187]
    v_cvt_pk_bf16_f32 v36, v24, v25
    v_mfma_f32_16x16x32_bf16 v[188:191], a[184:187], v[40:43], v[188:191]
    v_exp_f32 v27, v27
    v_mfma_f32_16x16x32_bf16 v[188:191], a[188:191], v[44:47], v[188:191]
    v_smfmac_f32_16x16x64_bf16 a[4:7], a[16:19], v[40:47], v11
    v_mfma_f32_16x16x32_bf16 v[16:19], a[64:67], v[112:115], v[60:63]
    v_exp_f32 v28, v28
    v_mfma_f32_16x16x32_bf16 v[16:19], a[68:71], v[116:119], v[16:19]
    s_add_u32 s46, s46, 16384
    ds_read_b128 a[64:67], v1 offset:36864
    v_cvt_pk_bf16_f32 v37, v26, v27
    v_mfma_f32_16x16x32_bf16 v[16:19], a[72:75], v[120:123], v[16:19]
    v_exp_f32 v29, v29
    v_mfma_f32_16x16x32_bf16 v[16:19], a[76:79], v[124:127], v[16:19]
    ds_read_b128 a[68:71], v1 offset:36928
    v_mfma_f32_16x16x32_bf16 v[20:23], a[80:83], v[112:115], v[60:63]
    v_exp_f32 v30, v30
    v_mfma_f32_16x16x32_bf16 v[20:23], a[84:87], v[116:119], v[20:23]
    ds_read_b128 a[72:75], v1 offset:36992
    v_cvt_pk_bf16_f32 v38, v28, v29
    v_mfma_f32_16x16x32_bf16 v[20:23], a[88:91], v[120:123], v[20:23]
    v_exp_f32 v31, v31
    v_mfma_f32_16x16x32_bf16 v[20:23], a[92:95], v[124:127], v[20:23]
    ds_read_b128 a[76:79], v1 offset:37056
    v_mfma_f32_16x16x32_bf16 v[24:27], a[96:99], v[112:115], v[60:63]
    v_exp_f32 v16, v16
    v_mfma_f32_16x16x32_bf16 v[24:27], a[100:103], v[116:119], v[24:27]
    ds_read_b128 a[80:83], v1 offset:37120
    v_cvt_pk_bf16_f32 v39, v30, v31
    v_mfma_f32_16x16x32_bf16 v[24:27], a[104:107], v[120:123], v[24:27]
    v_exp_f32 v17, v17
    v_mfma_f32_16x16x32_bf16 v[24:27], a[108:111], v[124:127], v[24:27]
    ds_read_b128 a[84:87], v1 offset:37184
    v_mfma_f32_16x16x32_bf16 v[28:31], a[112:115], v[112:115], v[60:63]
    v_exp_f32 v18, v18
    v_mfma_f32_16x16x32_bf16 v[28:31], a[116:119], v[116:119], v[28:31]
    ds_read_b128 a[88:91], v1 offset:37248
    v_cvt_pk_bf16_f32 v40, v16, v17
    v_mfma_f32_16x16x32_bf16 v[28:31], a[120:123], v[120:123], v[28:31]
    v_exp_f32 v19, v19
    v_mfma_f32_16x16x32_bf16 v[28:31], a[124:127], v[124:127], v[28:31]
    ds_read_b128 a[92:95], v1 offset:37312
    v_mfma_f32_16x16x32_bf16 v[192:195], a[128:131], v[32:35], v[192:195]
    v_exp_f32 v20, v20
    v_mfma_f32_16x16x32_bf16 v[192:195], a[132:135], v[36:39], v[192:195]
    ds_read_b128 a[96:99], v1 offset:37376
    v_cvt_pk_bf16_f32 v41, v18, v19
    v_mfma_f32_16x16x32_bf16 v[196:199], a[136:139], v[32:35], v[196:199]
    v_exp_f32 v21, v21
    v_mfma_f32_16x16x32_bf16 v[196:199], a[140:143], v[36:39], v[196:199]
    ds_read_b128 a[100:103], v1 offset:37440
    v_mfma_f32_16x16x32_bf16 v[200:203], a[144:147], v[32:35], v[200:203]
    v_exp_f32 v22, v22
    v_mfma_f32_16x16x32_bf16 v[200:203], a[148:151], v[36:39], v[200:203]
    ds_read_b128 a[104:107], v1 offset:37504
    v_cvt_pk_bf16_f32 v42, v20, v21
    v_mfma_f32_16x16x32_bf16 v[204:207], a[152:155], v[32:35], v[204:207]
    v_exp_f32 v23, v23
    v_mfma_f32_16x16x32_bf16 v[204:207], a[156:159], v[36:39], v[204:207]
    ds_read_b128 a[108:111], v1 offset:37568
    v_mfma_f32_16x16x32_bf16 v[208:211], a[160:163], v[32:35], v[208:211]
L2_pad5:
    s_cbranch_execz L2_pad9
    v_exp_f32 v24, v24
    v_mfma_f32_16x16x32_bf16 v[208:211], a[164:167], v[36:39], v[208:211]
    ds_read_b128 a[112:115], v1 offset:37632
    v_cvt_pk_bf16_f32 v43, v22, v23
    v_mfma_f32_16x16x32_bf16 v[212:215], a[168:171], v[32:35], v[212:215]
    v_exp_f32 v25, v25
    v_mfma_f32_16x16x32_bf16 v[212:215], a[172:175], v[36:39], v[212:215]
    ds_read_b128 a[116:119], v1 offset:37696
    v_mfma_f32_16x16x32_bf16 v[216:219], a[176:179], v[32:35], v[216:219]
    v_exp_f32 v26, v26
    v_mfma_f32_16x16x32_bf16 v[216:219], a[180:183], v[36:39], v[216:219]
    s_sub_u32 s49, s49, 1
    ds_read_b128 a[120:123], v1 offset:37760
    v_cvt_pk_bf16_f32 v44, v24, v25
    v_mfma_f32_16x16x32_bf16 v[220:223], a[184:187], v[32:35], v[220:223]
    s_cmp_lg_u32 s49, 0
    v_exp_f32 v27, v27
    v_mfma_f32_16x16x32_bf16 v[220:223], a[188:191], v[36:39], v[220:223]
    ds_read_b128 a[124:127], v1 offset:37824
    v_smfmac_f32_16x16x64_bf16 a[8:11], a[16:19], v[32:39], v11
    s_waitcnt vmcnt(9) lgkmcnt(12)
    s_barrier
    s_cbranch_scc1 L2_loop
    v_mfma_f32_16x16x32_bf16 v[16:19], a[64:67], v[64:67], v[48:51]
    s_sub_u32 s47, s47, s48
    v_exp_f32 v28, v28
    v_mfma_f32_16x16x32_bf16 v[16:19], a[68:71], v[68:71], v[16:19]
    v_cvt_pk_bf16_f32 v45, v26, v27
    v_add_u32 v1, s48, v1
    v_mfma_f32_16x16x32_bf16 v[16:19], a[72:75], v[72:75], v[16:19]
    s_add_u32 m0, s47, 0
    v_exp_f32 v29, v29
    v_mfma_f32_16x16x32_bf16 v[16:19], a[76:79], v[76:79], v[16:19]
    s_waitcnt lgkmcnt(8)
    buffer_load_dwordx4 v5, s[16:19], s46 offen offset:0 lds
    v_mfma_f32_16x16x32_bf16 v[20:23], a[80:83], v[64:67], v[48:51]
    v_exp_f32 v30, v30
    v_mfma_f32_16x16x32_bf16 v[20:23], a[84:87], v[68:71], v[20:23]
    v_cvt_pk_bf16_f32 v46, v28, v29
    v_add_u32 v2, s48, v2
    v_mfma_f32_16x16x32_bf16 v[20:23], a[88:91], v[72:75], v[20:23]
    s_add_u32 m0, s47, 32
    v_exp_f32 v31, v31
    v_mfma_f32_16x16x32_bf16 v[20:23], a[92:95], v[76:79], v[20:23]
    s_waitcnt lgkmcnt(4)
    buffer_load_dwordx4 v5, s[16:19], s46 offen offset:1024 lds
    v_mfma_f32_16x16x32_bf16 v[24:27], a[96:99], v[64:67], v[48:51]
    s_sub_u32 s48, 0, s48
    v_exp_f32 v16, v16
    v_mfma_f32_16x16x32_bf16 v[24:27], a[100:103], v[68:71], v[24:27]
    v_cvt_pk_bf16_f32 v47, v30, v31
    v_mfma_f32_16x16x32_bf16 v[24:27], a[104:107], v[72:75], v[24:27]
    s_add_u32 m0, s47, 64
    v_exp_f32 v17, v17
    v_mfma_f32_16x16x32_bf16 v[24:27], a[108:111], v[76:79], v[24:27]
    s_waitcnt lgkmcnt(0)
    buffer_load_dwordx4 v5, s[16:19], s46 offen offset:2048 lds
    v_mfma_f32_16x16x32_bf16 v[28:31], a[112:115], v[64:67], v[48:51]
    v_exp_f32 v18, v18
    v_mfma_f32_16x16x32_bf16 v[28:31], a[116:119], v[68:71], v[28:31]
    v_cvt_pk_bf16_f32 v32, v16, v17
    v_mfma_f32_16x16x32_bf16 v[28:31], a[120:123], v[72:75], v[28:31]
    s_add_u32 m0, s47, 96
    v_exp_f32 v19, v19
    v_mfma_f32_16x16x32_bf16 v[28:31], a[124:127], v[76:79], v[28:31]
    buffer_load_dwordx4 v5, s[16:19], s46 offen offset:3072 lds
    v_mfma_f32_16x16x32_bf16 v[224:227], a[128:131], v[40:43], v[224:227]
    v_exp_f32 v20, v20
    v_mfma_f32_16x16x32_bf16 v[224:227], a[132:135], v[44:47], v[224:227]
    ds_read_b64_tr_b16 a[128:129], v2 offset:0
    v_cvt_pk_bf16_f32 v33, v18, v19
    v_mfma_f32_16x16x32_bf16 v[228:231], a[136:139], v[40:43], v[228:231]
    s_add_u32 m0, s47, 16896
    v_exp_f32 v21, v21
    v_mfma_f32_16x16x32_bf16 v[228:231], a[140:143], v[44:47], v[228:231]
    buffer_load_dwordx4 v5, s[20:23], s46 offen offset:0 lds
    v_mfma_f32_16x16x32_bf16 v[232:235], a[144:147], v[40:43], v[232:235]
    v_exp_f32 v22, v22
    v_mfma_f32_16x16x32_bf16 v[232:235], a[148:151], v[44:47], v[232:235]
    ds_read_b64_tr_b16 a[130:131], v2 offset:256
    v_cvt_pk_bf16_f32 v34, v20, v21
    v_mfma_f32_16x16x32_bf16 v[236:239], a[152:155], v[40:43], v[236:239]
    s_add_u32 m0, s47, 16928
    v_exp_f32 v23, v23
    v_mfma_f32_16x16x32_bf16 v[236:239], a[156:159], v[44:47], v[236:239]
    buffer_load_dwordx4 v5, s[20:23], s46 offen offset:1024 lds
    v_mfma_f32_16x16x32_bf16 v[240:243], a[160:163], v[40:43], v[240:243]
    v_exp_f32 v24, v24
    v_mfma_f32_16x16x32_bf16 v[240:243], a[164:167], v[44:47], v[240:243]
    ds_read_b64_tr_b16 a[132:133], v2 offset:512
    v_cvt_pk_bf16_f32 v35, v22, v23
    v_mfma_f32_16x16x32_bf16 v[244:247], a[168:171], v[40:43], v[244:247]
    s_add_u32 m0, s47, 16960
    v_exp_f32 v25, v25
    v_mfma_f32_16x16x32_bf16 v[244:247], a[172:175], v[44:47], v[244:247]
    buffer_load_dwordx4 v5, s[20:23], s46 offen offset:2048 lds
    v_mfma_f32_16x16x32_bf16 v[248:251], a[176:179], v[40:43], v[248:251]
    v_exp_f32 v26, v26
    v_mfma_f32_16x16x32_bf16 v[248:251], a[180:183], v[44:47], v[248:251]
    ds_read_b64_tr_b16 a[134:135], v2 offset:768
    v_cvt_pk_bf16_f32 v36, v24, v25
    v_mfma_f32_16x16x32_bf16 v[252:255], a[184:187], v[40:43], v[252:255]
    s_add_u32 m0, s47, 16992
    v_exp_f32 v27, v27
    v_mfma_f32_16x16x32_bf16 v[252:255], a[188:191], v[44:47], v[252:255]
    buffer_load_dwordx4 v5, s[20:23], s46 offen offset:3072 lds
    v_smfmac_f32_16x16x64_bf16 a[12:15], a[16:19], v[40:47], v11
    ds_read_b64_tr_b16 a[136:137], v2 offset:32
    v_mfma_f32_16x16x32_bf16 v[16:19], a[64:67], v[80:83], v[52:55]
    v_exp_f32 v28, v28
    v_mfma_f32_16x16x32_bf16 v[16:19], a[68:71], v[84:87], v[16:19]
    ds_read_b64_tr_b16 a[138:139], v2 offset:288
    v_cvt_pk_bf16_f32 v37, v26, v27
    v_mfma_f32_16x16x32_bf16 v[16:19], a[72:75], v[88:91], v[16:19]
    v_exp_f32 v29, v29
    v_mfma_f32_16x16x32_bf16 v[16:19], a[76:79], v[92:95], v[16:19]
    global_load_dword a63, v14, s[10:11]
    v_mfma_f32_16x16x32_bf16 v[20:23], a[80:83], v[80:83], v[52:55]
    v_exp_f32 v30, v30
    v_mfma_f32_16x16x32_bf16 v[20:23], a[84:87], v[84:87], v[20:23]
    ds_read_b64_tr_b16 a[140:141], v2 offset:544
    v_cvt_pk_bf16_f32 v38, v28, v29
    v_mfma_f32_16x16x32_bf16 v[20:23], a[88:91], v[88:91], v[20:23]
    v_exp_f32 v31, v31
    v_mfma_f32_16x16x32_bf16 v[20:23], a[92:95], v[92:95], v[20:23]
    ds_read_b64_tr_b16 a[142:143], v2 offset:800
    v_mfma_f32_16x16x32_bf16 v[24:27], a[96:99], v[80:83], v[52:55]
    v_exp_f32 v16, v16
    v_mfma_f32_16x16x32_bf16 v[24:27], a[100:103], v[84:87], v[24:27]
    ds_read_b64_tr_b16 a[144:145], v2 offset:64
    v_cvt_pk_bf16_f32 v39, v30, v31
    v_mfma_f32_16x16x32_bf16 v[24:27], a[104:107], v[88:91], v[24:27]
    s_mov_b32 s54, 0
    v_exp_f32 v17, v17
    v_mfma_f32_16x16x32_bf16 v[24:27], a[108:111], v[92:95], v[24:27]
    buffer_load_dwordx4 a[20:23], v6, s[64:67], s54 offen
    v_mfma_f32_16x16x32_bf16 v[28:31], a[112:115], v[80:83], v[52:55]
    v_exp_f32 v18, v18
    v_mfma_f32_16x16x32_bf16 v[28:31], a[116:119], v[84:87], v[28:31]
    ds_read_b64_tr_b16 a[146:147], v2 offset:320
    v_cvt_pk_bf16_f32 v40, v16, v17
    v_mfma_f32_16x16x32_bf16 v[28:31], a[120:123], v[88:91], v[28:31]
    v_exp_f32 v19, v19
    v_mfma_f32_16x16x32_bf16 v[28:31], a[124:127], v[92:95], v[28:31]
    ds_read_b64_tr_b16 a[148:149], v2 offset:576
    v_mfma_f32_16x16x32_bf16 v[128:131], a[192:195], v[32:35], v[128:131]
    v_exp_f32 v20, v20
    v_mfma_f32_16x16x32_bf16 v[128:131], a[196:199], v[36:39], v[128:131]
    ds_read_b64_tr_b16 a[150:151], v2 offset:832
    v_cvt_pk_bf16_f32 v41, v18, v19
    v_mfma_f32_16x16x32_bf16 v[132:135], a[200:203], v[32:35], v[132:135]
    s_mov_b32 s54, 147456
    v_exp_f32 v21, v21
    v_mfma_f32_16x16x32_bf16 v[132:135], a[204:207], v[36:39], v[132:135]
    buffer_load_dwordx4 a[24:27], v6, s[64:67], s54 offen
    v_mfma_f32_16x16x32_bf16 v[136:139], a[208:211], v[32:35], v[136:139]
    v_exp_f32 v22, v22
    v_mfma_f32_16x16x32_bf16 v[136:139], a[212:215], v[36:39], v[136:139]
    ds_read_b64_tr_b16 a[152:153], v2 offset:96
    v_cvt_pk_bf16_f32 v42, v20, v21
    v_mfma_f32_16x16x32_bf16 v[140:143], a[216:219], v[32:35], v[140:143]
    v_exp_f32 v23, v23
    v_mfma_f32_16x16x32_bf16 v[140:143], a[220:223], v[36:39], v[140:143]
    ds_read_b64_tr_b16 a[154:155], v2 offset:352
    v_mfma_f32_16x16x32_bf16 v[144:147], a[224:227], v[32:35], v[144:147]
    v_exp_f32 v24, v24
    v_mfma_f32_16x16x32_bf16 v[144:147], a[228:231], v[36:39], v[144:147]
    ds_read_b64_tr_b16 a[156:157], v2 offset:608
    v_cvt_pk_bf16_f32 v43, v22, v23
    v_mfma_f32_16x16x32_bf16 v[148:151], a[232:235], v[32:35], v[148:151]
    s_mov_b32 s54, 294912
    v_exp_f32 v25, v25
    v_mfma_f32_16x16x32_bf16 v[148:151], a[236:239], v[36:39], v[148:151]
    buffer_load_dwordx4 a[28:31], v6, s[64:67], s54 offen
    v_mfma_f32_16x16x32_bf16 v[152:155], a[240:243], v[32:35], v[152:155]
    v_exp_f32 v26, v26
    v_mfma_f32_16x16x32_bf16 v[152:155], a[244:247], v[36:39], v[152:155]
    ds_read_b64_tr_b16 a[158:159], v2 offset:864
    v_cvt_pk_bf16_f32 v44, v24, v25
    v_mfma_f32_16x16x32_bf16 v[156:159], a[248:251], v[32:35], v[156:159]
    v_exp_f32 v27, v27
    v_mfma_f32_16x16x32_bf16 v[156:159], a[252:255], v[36:39], v[156:159]
    ds_read_b64_tr_b16 a[160:161], v2 offset:128
    v_smfmac_f32_16x16x64_bf16 a[0:3], a[16:19], v[32:39], v11
    ds_read_b64_tr_b16 a[162:163], v2 offset:384
    v_mfma_f32_16x16x32_bf16 v[16:19], a[64:67], v[96:99], v[56:59]
    v_exp_f32 v28, v28
    v_mfma_f32_16x16x32_bf16 v[16:19], a[68:71], v[100:103], v[16:19]
    ds_read_b64_tr_b16 a[164:165], v2 offset:640
    v_cvt_pk_bf16_f32 v45, v26, v27
    v_mfma_f32_16x16x32_bf16 v[16:19], a[72:75], v[104:107], v[16:19]
    v_exp_f32 v29, v29
    v_mfma_f32_16x16x32_bf16 v[16:19], a[76:79], v[108:111], v[16:19]
    ds_read_b64_tr_b16 a[166:167], v2 offset:896
    v_mfma_f32_16x16x32_bf16 v[20:23], a[80:83], v[96:99], v[56:59]
    v_exp_f32 v30, v30
    v_mfma_f32_16x16x32_bf16 v[20:23], a[84:87], v[100:103], v[20:23]
    ds_read_b64_tr_b16 a[168:169], v2 offset:160
    v_cvt_pk_bf16_f32 v46, v28, v29
    v_mfma_f32_16x16x32_bf16 v[20:23], a[88:91], v[104:107], v[20:23]
    v_exp_f32 v31, v31
    v_mfma_f32_16x16x32_bf16 v[20:23], a[92:95], v[108:111], v[20:23]
    ds_read_b64_tr_b16 a[170:171], v2 offset:416
    v_mfma_f32_16x16x32_bf16 v[24:27], a[96:99], v[96:99], v[56:59]
    v_exp_f32 v16, v16
    v_mfma_f32_16x16x32_bf16 v[24:27], a[100:103], v[100:103], v[24:27]
    ds_read_b64_tr_b16 a[172:173], v2 offset:672
    v_cvt_pk_bf16_f32 v47, v30, v31
    v_mfma_f32_16x16x32_bf16 v[24:27], a[104:107], v[104:107], v[24:27]
    v_exp_f32 v17, v17
    v_mfma_f32_16x16x32_bf16 v[24:27], a[108:111], v[108:111], v[24:27]
    ds_read_b64_tr_b16 a[174:175], v2 offset:928
    v_mfma_f32_16x16x32_bf16 v[28:31], a[112:115], v[96:99], v[56:59]
    v_exp_f32 v18, v18
    v_mfma_f32_16x16x32_bf16 v[28:31], a[116:119], v[100:103], v[28:31]
    ds_read_b64_tr_b16 a[176:177], v2 offset:192
    v_cvt_pk_bf16_f32 v32, v16, v17
    v_mfma_f32_16x16x32_bf16 v[28:31], a[120:123], v[104:107], v[28:31]
    v_exp_f32 v19, v19
    v_mfma_f32_16x16x32_bf16 v[28:31], a[124:127], v[108:111], v[28:31]
    ds_read_b64_tr_b16 a[178:179], v2 offset:448
    v_mfma_f32_16x16x32_bf16 v[160:163], a[192:195], v[40:43], v[160:163]
    v_exp_f32 v20, v20
    v_mfma_f32_16x16x32_bf16 v[160:163], a[196:199], v[44:47], v[160:163]
    ds_read_b64_tr_b16 a[180:181], v2 offset:704
    v_cvt_pk_bf16_f32 v33, v18, v19
    v_mfma_f32_16x16x32_bf16 v[164:167], a[200:203], v[40:43], v[164:167]
    v_exp_f32 v21, v21
    v_mfma_f32_16x16x32_bf16 v[164:167], a[204:207], v[44:47], v[164:167]
    ds_read_b64_tr_b16 a[182:183], v2 offset:960
    v_mfma_f32_16x16x32_bf16 v[168:171], a[208:211], v[40:43], v[168:171]
    v_exp_f32 v22, v22
    v_mfma_f32_16x16x32_bf16 v[168:171], a[212:215], v[44:47], v[168:171]
    ds_read_b64_tr_b16 a[184:185], v2 offset:224
    v_cvt_pk_bf16_f32 v34, v20, v21
    v_mfma_f32_16x16x32_bf16 v[172:175], a[216:219], v[40:43], v[172:175]
    v_exp_f32 v23, v23
    v_mfma_f32_16x16x32_bf16 v[172:175], a[220:223], v[44:47], v[172:175]
    ds_read_b64_tr_b16 a[186:187], v2 offset:480
    v_mfma_f32_16x16x32_bf16 v[176:179], a[224:227], v[40:43], v[176:179]
    v_exp_f32 v24, v24
    v_mfma_f32_16x16x32_bf16 v[176:179], a[228:231], v[44:47], v[176:179]
    ds_read_b64_tr_b16 a[188:189], v2 offset:736
    v_cvt_pk_bf16_f32 v35, v22, v23
    v_mfma_f32_16x16x32_bf16 v[180:183], a[232:235], v[40:43], v[180:183]
    v_exp_f32 v25, v25
    v_mfma_f32_16x16x32_bf16 v[180:183], a[236:239], v[44:47], v[180:183]
    ds_read_b64_tr_b16 a[190:191], v2 offset:992
    v_mfma_f32_16x16x32_bf16 v[184:187], a[240:243], v[40:43], v[184:187]
    v_exp_f32 v26, v26
    v_mfma_f32_16x16x32_bf16 v[184:187], a[244:247], v[44:47], v[184:187]
    v_cvt_pk_bf16_f32 v36, v24, v25
    v_mfma_f32_16x16x32_bf16 v[188:191], a[248:251], v[40:43], v[188:191]
    v_exp_f32 v27, v27
    v_mfma_f32_16x16x32_bf16 v[188:191], a[252:255], v[44:47], v[188:191]
    v_smfmac_f32_16x16x64_bf16 a[4:7], a[16:19], v[40:47], v11
    v_mfma_f32_16x16x32_bf16 v[16:19], a[64:67], v[112:115], v[60:63]
    v_exp_f32 v28, v28
    v_mfma_f32_16x16x32_bf16 v[16:19], a[68:71], v[116:119], v[16:19]
    s_add_u32 s46, s46, 16384
    ds_read_b128 a[64:67], v1 offset:0
    v_cvt_pk_bf16_f32 v37, v26, v27
    v_mfma_f32_16x16x32_bf16 v[16:19], a[72:75], v[120:123], v[16:19]
    v_exp_f32 v29, v29
    v_mfma_f32_16x16x32_bf16 v[16:19], a[76:79], v[124:127], v[16:19]
    ds_read_b128 a[68:71], v1 offset:64
    v_mfma_f32_16x16x32_bf16 v[20:23], a[80:83], v[112:115], v[60:63]
    v_exp_f32 v30, v30
    v_mfma_f32_16x16x32_bf16 v[20:23], a[84:87], v[116:119], v[20:23]
    ds_read_b128 a[72:75], v1 offset:128
    v_cvt_pk_bf16_f32 v38, v28, v29
    v_mfma_f32_16x16x32_bf16 v[20:23], a[88:91], v[120:123], v[20:23]
    v_exp_f32 v31, v31
    v_mfma_f32_16x16x32_bf16 v[20:23], a[92:95], v[124:127], v[20:23]
    ds_read_b128 a[76:79], v1 offset:192
    v_mfma_f32_16x16x32_bf16 v[24:27], a[96:99], v[112:115], v[60:63]
    v_exp_f32 v16, v16
    v_mfma_f32_16x16x32_bf16 v[24:27], a[100:103], v[116:119], v[24:27]
    ds_read_b128 a[80:83], v1 offset:256
    v_cvt_pk_bf16_f32 v39, v30, v31
    v_mfma_f32_16x16x32_bf16 v[24:27], a[104:107], v[120:123], v[24:27]
    v_exp_f32 v17, v17
    v_mfma_f32_16x16x32_bf16 v[24:27], a[108:111], v[124:127], v[24:27]
    ds_read_b128 a[84:87], v1 offset:320
    v_mfma_f32_16x16x32_bf16 v[28:31], a[112:115], v[112:115], v[60:63]
    v_exp_f32 v18, v18
    v_mfma_f32_16x16x32_bf16 v[28:31], a[116:119], v[116:119], v[28:31]
    ds_read_b128 a[88:91], v1 offset:384
    v_cvt_pk_bf16_f32 v40, v16, v17
    v_mfma_f32_16x16x32_bf16 v[28:31], a[120:123], v[120:123], v[28:31]
    v_exp_f32 v19, v19
    v_mfma_f32_16x16x32_bf16 v[28:31], a[124:127], v[124:127], v[28:31]
    ds_read_b128 a[92:95], v1 offset:448
    v_mfma_f32_16x16x32_bf16 v[192:195], a[192:195], v[32:35], v[192:195]
    v_exp_f32 v20, v20
    v_mfma_f32_16x16x32_bf16 v[192:195], a[196:199], v[36:39], v[192:195]
    ds_read_b128 a[96:99], v1 offset:512
    v_cvt_pk_bf16_f32 v41, v18, v19
    v_mfma_f32_16x16x32_bf16 v[196:199], a[200:203], v[32:35], v[196:199]
    v_exp_f32 v21, v21
    v_mfma_f32_16x16x32_bf16 v[196:199], a[204:207], v[36:39], v[196:199]
    ds_read_b128 a[100:103], v1 offset:576
    v_mfma_f32_16x16x32_bf16 v[200:203], a[208:211], v[32:35], v[200:203]
    v_exp_f32 v22, v22
    v_mfma_f32_16x16x32_bf16 v[200:203], a[212:215], v[36:39], v[200:203]
    ds_read_b128 a[104:107], v1 offset:640
    v_cvt_pk_bf16_f32 v42, v20, v21
    v_mfma_f32_16x16x32_bf16 v[204:207], a[216:219], v[32:35], v[204:207]
    v_exp_f32 v23, v23
    v_mfma_f32_16x16x32_bf16 v[204:207], a[220:223], v[36:39], v[204:207]
    ds_read_b128 a[108:111], v1 offset:704
    v_mfma_f32_16x16x32_bf16 v[208:211], a[224:227], v[32:35], v[208:211]
    v_exp_f32 v24, v24
    v_mfma_f32_16x16x32_bf16 v[208:211], a[228:231], v[36:39], v[208:211]
    ds_read_b128 a[112:115], v1 offset:768
    v_cvt_pk_bf16_f32 v43, v22, v23
    v_mfma_f32_16x16x32_bf16 v[212:215], a[232:235], v[32:35], v[212:215]
    v_exp_f32 v25, v25
    v_mfma_f32_16x16x32_bf16 v[212:215], a[236:239], v[36:39], v[212:215]
    ds_read_b128 a[116:119], v1 offset:832
    v_mfma_f32_16x16x32_bf16 v[216:219], a[240:243], v[32:35], v[216:219]
    v_exp_f32 v26, v26
    v_mfma_f32_16x16x32_bf16 v[216:219], a[244:247], v[36:39], v[216:219]
    ds_read_b128 a[120:123], v1 offset:896
    v_cvt_pk_bf16_f32 v44, v24, v25
    v_mfma_f32_16x16x32_bf16 v[220:223], a[248:251], v[32:35], v[220:223]
    v_exp_f32 v27, v27
    v_mfma_f32_16x16x32_bf16 v[220:223], a[252:255], v[36:39], v[220:223]
    ds_read_b128 a[124:127], v1 offset:960
    v_smfmac_f32_16x16x64_bf16 a[8:11], a[16:19], v[32:39], v11
    s_waitcnt vmcnt(12) lgkmcnt(12)
    s_barrier
    v_mfma_f32_16x16x32_bf16 v[16:19], a[64:67], v[64:67], v[48:51]
    v_exp_f32 v28, v28
    v_mfma_f32_16x16x32_bf16 v[16:19], a[68:71], v[68:71], v[16:19]
    v_cvt_pk_bf16_f32 v45, v26, v27
    v_mfma_f32_16x16x32_bf16 v[16:19], a[72:75], v[72:75], v[16:19]
    s_add_u32 m0, s47, 36864
    v_exp_f32 v29, v29
    v_mfma_f32_16x16x32_bf16 v[16:19], a[76:79], v[76:79], v[16:19]
    s_waitcnt lgkmcnt(8)
    buffer_load_dwordx4 v5, s[16:19], s46 offen offset:0 lds
    v_mfma_f32_16x16x32_bf16 v[20:23], a[80:83], v[64:67], v[48:51]
    v_exp_f32 v30, v30
    v_mfma_f32_16x16x32_bf16 v[20:23], a[84:87], v[68:71], v[20:23]
    v_cvt_pk_bf16_f32 v46, v28, v29
    v_mfma_f32_16x16x32_bf16 v[20:23], a[88:91], v[72:75], v[20:23]
    s_add_u32 m0, s47, 36896
    v_exp_f32 v31, v31
    v_mfma_f32_16x16x32_bf16 v[20:23], a[92:95], v[76:79], v[20:23]
    s_waitcnt lgkmcnt(4)
    buffer_load_dwordx4 v5, s[16:19], s46 offen offset:1024 lds
    v_mfma_f32_16x16x32_bf16 v[24:27], a[96:99], v[64:67], v[48:51]
    v_exp_f32 v16, v16
    v_mfma_f32_16x16x32_bf16 v[24:27], a[100:103], v[68:71], v[24:27]
    v_cvt_pk_bf16_f32 v47, v30, v31
    v_mfma_f32_16x16x32_bf16 v[24:27], a[104:107], v[72:75], v[24:27]
    s_add_u32 m0, s47, 36928
    v_exp_f32 v17, v17
    v_mfma_f32_16x16x32_bf16 v[24:27], a[108:111], v[76:79], v[24:27]
    s_waitcnt lgkmcnt(0)
    buffer_load_dwordx4 v5, s[16:19], s46 offen offset:2048 lds
    v_mfma_f32_16x16x32_bf16 v[28:31], a[112:115], v[64:67], v[48:51]
    v_exp_f32 v18, v18
    v_mfma_f32_16x16x32_bf16 v[28:31], a[116:119], v[68:71], v[28:31]
    v_cvt_pk_bf16_f32 v32, v16, v17
    v_mfma_f32_16x16x32_bf16 v[28:31], a[120:123], v[72:75], v[28:31]
    s_add_u32 m0, s47, 36960
    v_exp_f32 v19, v19
    v_mfma_f32_16x16x32_bf16 v[28:31], a[124:127], v[76:79], v[28:31]
    buffer_load_dwordx4 v5, s[16:19], s46 offen offset:3072 lds
    v_mfma_f32_16x16x32_bf16 v[224:227], a[192:195], v[40:43], v[224:227]
    v_exp_f32 v20, v20
    v_mfma_f32_16x16x32_bf16 v[224:227], a[196:199], v[44:47], v[224:227]
    ds_read_b64_tr_b16 a[192:193], v2 offset:36864
    v_cvt_pk_bf16_f32 v33, v18, v19
    v_mfma_f32_16x16x32_bf16 v[228:231], a[200:203], v[40:43], v[228:231]
    s_add_u32 m0, s47, 53760
    v_exp_f32 v21, v21
    v_mfma_f32_16x16x32_bf16 v[228:231], a[204:207], v[44:47], v[228:231]
    buffer_load_dwordx4 v5, s[20:23], s46 offen offset:0 lds
    v_mfma_f32_16x16x32_bf16 v[232:235], a[208:211], v[40:43], v[232:235]
    v_exp_f32 v22, v22
    v_mfma_f32_16x16x32_bf16 v[232:235], a[212:215], v[44:47], v[232:235]
    ds_read_b64_tr_b16 a[194:195], v2 offset:37120
    v_cvt_pk_bf16_f32 v34, v20, v21
    v_mfma_f32_16x16x32_bf16 v[236:239], a[216:219], v[40:43], v[236:239]
    s_add_u32 m0, s47, 53792
    v_exp_f32 v23, v23
    v_mfma_f32_16x16x32_bf16 v[236:239], a[220:223], v[44:47], v[236:239]
    buffer_load_dwordx4 v5, s[20:23], s46 offen offset:1024 lds
    v_mfma_f32_16x16x32_bf16 v[240:243], a[224:227], v[40:43], v[240:243]
    v_exp_f32 v24, v24
    v_mfma_f32_16x16x32_bf16 v[240:243], a[228:231], v[44:47], v[240:243]
    ds_read_b64_tr_b16 a[196:197], v2 offset:37376
    v_cvt_pk_bf16_f32 v35, v22, v23
    v_mfma_f32_16x16x32_bf16 v[244:247], a[232:235], v[40:43], v[244:247]
    s_add_u32 m0, s47, 53824
    v_exp_f32 v25, v25
    v_mfma_f32_16x16x32_bf16 v[244:247], a[236:239], v[44:47], v[244:247]
    buffer_load_dwordx4 v5, s[20:23], s46 offen offset:2048 lds
    v_mfma_f32_16x16x32_bf16 v[248:251], a[240:243], v[40:43], v[248:251]
    v_exp_f32 v26, v26
    v_mfma_f32_16x16x32_bf16 v[248:251], a[244:247], v[44:47], v[248:251]
    ds_read_b64_tr_b16 a[198:199], v2 offset:37632
    v_cvt_pk_bf16_f32 v36, v24, v25
    v_mfma_f32_16x16x32_bf16 v[252:255], a[248:251], v[40:43], v[252:255]
    s_add_u32 m0, s47, 53856
    v_exp_f32 v27, v27
    v_mfma_f32_16x16x32_bf16 v[252:255], a[252:255], v[44:47], v[252:255]
    buffer_load_dwordx4 v5, s[20:23], s46 offen offset:3072 lds
    v_smfmac_f32_16x16x64_bf16 a[12:15], a[16:19], v[40:47], v11
    ds_read_b64_tr_b16 a[200:201], v2 offset:36896
    v_mfma_f32_16x16x32_bf16 v[16:19], a[64:67], v[80:83], v[52:55]
    v_exp_f32 v28, v28
    v_mfma_f32_16x16x32_bf16 v[16:19], a[68:71], v[84:87], v[16:19]
    ds_read_b64_tr_b16 a[202:203], v2 offset:37152
    v_cvt_pk_bf16_f32 v37, v26, v27
    v_mfma_f32_16x16x32_bf16 v[16:19], a[72:75], v[88:91], v[16:19]
    v_exp_f32 v29, v29
    v_mfma_f32_16x16x32_bf16 v[16:19], a[76:79], v[92:95], v[16:19]
    global_load_dword a63, v15, s[10:11]
    v_mfma_f32_16x16x32_bf16 v[20:23], a[80:83], v[80:83], v[52:55]
    v_exp_f32 v30, v30
    v_mfma_f32_16x16x32_bf16 v[20:23], a[84:87], v[84:87], v[20:23]
    ds_read_b64_tr_b16 a[204:205], v2 offset:37408
    v_cvt_pk_bf16_f32 v38, v28, v29
    v_mfma_f32_16x16x32_bf16 v[20:23], a[88:91], v[88:91], v[20:23]
    v_exp_f32 v31, v31
    v_mfma_f32_16x16x32_bf16 v[20:23], a[92:95], v[92:95], v[20:23]
    ds_read_b64_tr_b16 a[206:207], v2 offset:37664
    v_mfma_f32_16x16x32_bf16 v[24:27], a[96:99], v[80:83], v[52:55]
    v_exp_f32 v16, v16
    v_mfma_f32_16x16x32_bf16 v[24:27], a[100:103], v[84:87], v[24:27]
    ds_read_b64_tr_b16 a[208:209], v2 offset:36928
    v_cvt_pk_bf16_f32 v39, v30, v31
    v_mfma_f32_16x16x32_bf16 v[24:27], a[104:107], v[88:91], v[24:27]
    s_mov_b32 s54, 442368
    v_exp_f32 v17, v17
    v_mfma_f32_16x16x32_bf16 v[24:27], a[108:111], v[92:95], v[24:27]
    buffer_load_dwordx4 a[32:35], v6, s[64:67], s54 offen
    v_mfma_f32_16x16x32_bf16 v[28:31], a[112:115], v[80:83], v[52:55]
    v_exp_f32 v18, v18
    v_mfma_f32_16x16x32_bf16 v[28:31], a[116:119], v[84:87], v[28:31]
    ds_read_b64_tr_b16 a[210:211], v2 offset:37184
    v_cvt_pk_bf16_f32 v40, v16, v17
    v_mfma_f32_16x16x32_bf16 v[28:31], a[120:123], v[88:91], v[28:31]
    v_exp_f32 v19, v19
    v_mfma_f32_16x16x32_bf16 v[28:31], a[124:127], v[92:95], v[28:31]
    ds_read_b64_tr_b16 a[212:213], v2 offset:37440
    v_mfma_f32_16x16x32_bf16 v[128:131], a[128:131], v[32:35], v[128:131]
    v_exp_f32 v20, v20
    v_mfma_f32_16x16x32_bf16 v[128:131], a[132:135], v[36:39], v[128:131]
    ds_read_b64_tr_b16 a[214:215], v2 offset:37696
    v_cvt_pk_bf16_f32 v41, v18, v19
    v_mfma_f32_16x16x32_bf16 v[132:135], a[136:139], v[32:35], v[132:135]
    s_mov_b32 s54, 589824
    v_exp_f32 v21, v21
    v_mfma_f32_16x16x32_bf16 v[132:135], a[140:143], v[36:39], v[132:135]
    buffer_load_dwordx4 a[36:39], v6, s[64:67], s54 offen
    v_mfma_f32_16x16x32_bf16 v[136:139], a[144:147], v[32:35], v[136:139]
    v_exp_f32 v22, v22
    v_mfma_f32_16x16x32_bf16 v[136:139], a[148:151], v[36:39], v[136:139]
    ds_read_b64_tr_b16 a[216:217], v2 offset:36960
    v_cvt_pk_bf16_f32 v42, v20, v21
    v_mfma_f32_16x16x32_bf16 v[140:143], a[152:155], v[32:35], v[140:143]
    v_exp_f32 v23, v23
    v_mfma_f32_16x16x32_bf16 v[140:143], a[156:159], v[36:39], v[140:143]
    ds_read_b64_tr_b16 a[218:219], v2 offset:37216
    v_mfma_f32_16x16x32_bf16 v[144:147], a[160:163], v[32:35], v[144:147]
    v_exp_f32 v24, v24
    v_mfma_f32_16x16x32_bf16 v[144:147], a[164:167], v[36:39], v[144:147]
    ds_read_b64_tr_b16 a[220:221], v2 offset:37472
    v_cvt_pk_bf16_f32 v43, v22, v23
    v_mfma_f32_16x16x32_bf16 v[148:151], a[168:171], v[32:35], v[148:151]
    s_mov_b32 s54, 737280
    v_exp_f32 v25, v25
    v_mfma_f32_16x16x32_bf16 v[148:151], a[172:175], v[36:39], v[148:151]
    buffer_load_dwordx4 a[40:43], v6, s[64:67], s54 offen
    v_mfma_f32_16x16x32_bf16 v[152:155], a[176:179], v[32:35], v[152:155]
    v_exp_f32 v26, v26
    v_mfma_f32_16x16x32_bf16 v[152:155], a[180:183], v[36:39], v[152:155]
    ds_read_b64_tr_b16 a[222:223], v2 offset:37728
    v_cvt_pk_bf16_f32 v44, v24, v25
    v_mfma_f32_16x16x32_bf16 v[156:159], a[184:187], v[32:35], v[156:159]
    v_exp_f32 v27, v27
    v_mfma_f32_16x16x32_bf16 v[156:159], a[188:191], v[36:39], v[156:159]
    ds_read_b64_tr_b16 a[224:225], v2 offset:36992
    v_smfmac_f32_16x16x64_bf16 a[0:3], a[16:19], v[32:39], v11
    ds_read_b64_tr_b16 a[226:227], v2 offset:37248
    v_mfma_f32_16x16x32_bf16 v[16:19], a[64:67], v[96:99], v[56:59]
    v_exp_f32 v28, v28
    v_mfma_f32_16x16x32_bf16 v[16:19], a[68:71], v[100:103], v[16:19]
    ds_read_b64_tr_b16 a[228:229], v2 offset:37504
    v_cvt_pk_bf16_f32 v45, v26, v27
    v_mfma_f32_16x16x32_bf16 v[16:19], a[72:75], v[104:107], v[16:19]
    v_exp_f32 v29, v29
    v_mfma_f32_16x16x32_bf16 v[16:19], a[76:79], v[108:111], v[16:19]
    ds_read_b64_tr_b16 a[230:231], v2 offset:37760
    v_mfma_f32_16x16x32_bf16 v[20:23], a[80:83], v[96:99], v[56:59]
    v_exp_f32 v30, v30
    v_mfma_f32_16x16x32_bf16 v[20:23], a[84:87], v[100:103], v[20:23]
    ds_read_b64_tr_b16 a[232:233], v2 offset:37024
    v_cvt_pk_bf16_f32 v46, v28, v29
    v_mfma_f32_16x16x32_bf16 v[20:23], a[88:91], v[104:107], v[20:23]
    v_exp_f32 v31, v31
    v_mfma_f32_16x16x32_bf16 v[20:23], a[92:95], v[108:111], v[20:23]
    ds_read_b64_tr_b16 a[234:235], v2 offset:37280
    v_mfma_f32_16x16x32_bf16 v[24:27], a[96:99], v[96:99], v[56:59]
    v_exp_f32 v16, v16
    v_mfma_f32_16x16x32_bf16 v[24:27], a[100:103], v[100:103], v[24:27]
    ds_read_b64_tr_b16 a[236:237], v2 offset:37536
    v_cvt_pk_bf16_f32 v47, v30, v31
    v_mfma_f32_16x16x32_bf16 v[24:27], a[104:107], v[104:107], v[24:27]
    v_exp_f32 v17, v17
    v_mfma_f32_16x16x32_bf16 v[24:27], a[108:111], v[108:111], v[24:27]
    ds_read_b64_tr_b16 a[238:239], v2 offset:37792
    v_mfma_f32_16x16x32_bf16 v[28:31], a[112:115], v[96:99], v[56:59]
    v_exp_f32 v18, v18
    v_mfma_f32_16x16x32_bf16 v[28:31], a[116:119], v[100:103], v[28:31]
    ds_read_b64_tr_b16 a[240:241], v2 offset:37056
    v_cvt_pk_bf16_f32 v32, v16, v17
    v_mfma_f32_16x16x32_bf16 v[28:31], a[120:123], v[104:107], v[28:31]
    v_exp_f32 v19, v19
    v_mfma_f32_16x16x32_bf16 v[28:31], a[124:127], v[108:111], v[28:31]
    ds_read_b64_tr_b16 a[242:243], v2 offset:37312
    v_mfma_f32_16x16x32_bf16 v[160:163], a[128:131], v[40:43], v[160:163]
    v_exp_f32 v20, v20
    v_mfma_f32_16x16x32_bf16 v[160:163], a[132:135], v[44:47], v[160:163]
    ds_read_b64_tr_b16 a[244:245], v2 offset:37568
    v_cvt_pk_bf16_f32 v33, v18, v19
    v_mfma_f32_16x16x32_bf16 v[164:167], a[136:139], v[40:43], v[164:167]
    v_exp_f32 v21, v21
    v_mfma_f32_16x16x32_bf16 v[164:167], a[140:143], v[44:47], v[164:167]
    ds_read_b64_tr_b16 a[246:247], v2 offset:37824
    v_mfma_f32_16x16x32_bf16 v[168:171], a[144:147], v[40:43], v[168:171]
    v_exp_f32 v22, v22
    v_mfma_f32_16x16x32_bf16 v[168:171], a[148:151], v[44:47], v[168:171]
    ds_read_b64_tr_b16 a[248:249], v2 offset:37088
    v_cvt_pk_bf16_f32 v34, v20, v21
    v_mfma_f32_16x16x32_bf16 v[172:175], a[152:155], v[40:43], v[172:175]
    v_exp_f32 v23, v23
    v_mfma_f32_16x16x32_bf16 v[172:175], a[156:159], v[44:47], v[172:175]
    ds_read_b64_tr_b16 a[250:251], v2 offset:37344
    v_mfma_f32_16x16x32_bf16 v[176:179], a[160:163], v[40:43], v[176:179]
    v_exp_f32 v24, v24
    v_mfma_f32_16x16x32_bf16 v[176:179], a[164:167], v[44:47], v[176:179]
    ds_read_b64_tr_b16 a[252:253], v2 offset:37600
    v_cvt_pk_bf16_f32 v35, v22, v23
    v_mfma_f32_16x16x32_bf16 v[180:183], a[168:171], v[40:43], v[180:183]
    v_exp_f32 v25, v25
    v_mfma_f32_16x16x32_bf16 v[180:183], a[172:175], v[44:47], v[180:183]
    ds_read_b64_tr_b16 a[254:255], v2 offset:37856
    v_mfma_f32_16x16x32_bf16 v[184:187], a[176:179], v[40:43], v[184:187]
    v_exp_f32 v26, v26
    v_mfma_f32_16x16x32_bf16 v[184:187], a[180:183], v[44:47], v[184:187]
    v_cvt_pk_bf16_f32 v36, v24, v25
    v_mfma_f32_16x16x32_bf16 v[188:191], a[184:187], v[40:43], v[188:191]
    v_exp_f32 v27, v27
    v_mfma_f32_16x16x32_bf16 v[188:191], a[188:191], v[44:47], v[188:191]
    v_smfmac_f32_16x16x64_bf16 a[4:7], a[16:19], v[40:47], v11
    v_mfma_f32_16x16x32_bf16 v[16:19], a[64:67], v[112:115], v[60:63]
    v_exp_f32 v28, v28
    v_mfma_f32_16x16x32_bf16 v[16:19], a[68:71], v[116:119], v[16:19]
    s_add_u32 s46, s46, 16384
    ds_read_b128 a[64:67], v1 offset:36864
    v_cvt_pk_bf16_f32 v37, v26, v27
    v_mfma_f32_16x16x32_bf16 v[16:19], a[72:75], v[120:123], v[16:19]
    v_exp_f32 v29, v29
    v_mfma_f32_16x16x32_bf16 v[16:19], a[76:79], v[124:127], v[16:19]
    ds_read_b128 a[68:71], v1 offset:36928
    v_mfma_f32_16x16x32_bf16 v[20:23], a[80:83], v[112:115], v[60:63]
    v_exp_f32 v30, v30
    v_mfma_f32_16x16x32_bf16 v[20:23], a[84:87], v[116:119], v[20:23]
    ds_read_b128 a[72:75], v1 offset:36992
    v_cvt_pk_bf16_f32 v38, v28, v29
    v_mfma_f32_16x16x32_bf16 v[20:23], a[88:91], v[120:123], v[20:23]
    v_exp_f32 v31, v31
    v_mfma_f32_16x16x32_bf16 v[20:23], a[92:95], v[124:127], v[20:23]
    ds_read_b128 a[76:79], v1 offset:37056
    v_mfma_f32_16x16x32_bf16 v[24:27], a[96:99], v[112:115], v[60:63]
    v_exp_f32 v16, v16
    v_mfma_f32_16x16x32_bf16 v[24:27], a[100:103], v[116:119], v[24:27]
L2_pad6:
    s_cbranch_execz L2_pad10
    ds_read_b128 a[80:83], v1 offset:37120
    v_cvt_pk_bf16_f32 v39, v30, v31
    v_mfma_f32_16x16x32_bf16 v[24:27], a[104:107], v[120:123], v[24:27]
    v_exp_f32 v17, v17
    v_mfma_f32_16x16x32_bf16 v[24:27], a[108:111], v[124:127], v[24:27]
    ds_read_b128 a[84:87], v1 offset:37184
    v_mfma_f32_16x16x32_bf16 v[28:31], a[112:115], v[112:115], v[60:63]
    v_exp_f32 v18, v18
    v_mfma_f32_16x16x32_bf16 v[28:31], a[116:119], v[116:119], v[28:31]
    ds_read_b128 a[88:91], v1 offset:37248
    v_cvt_pk_bf16_f32 v40, v16, v17
    v_mfma_f32_16x16x32_bf16 v[28:31], a[120:123], v[120:123], v[28:31]
    v_exp_f32 v19, v19
    v_mfma_f32_16x16x32_bf16 v[28:31], a[124:127], v[124:127], v[28:31]
    ds_read_b128 a[92:95], v1 offset:37312
    v_mfma_f32_16x16x32_bf16 v[192:195], a[128:131], v[32:35], v[192:195]
    v_exp_f32 v20, v20
    v_mfma_f32_16x16x32_bf16 v[192:195], a[132:135], v[36:39], v[192:195]
    ds_read_b128 a[96:99], v1 offset:37376
    v_cvt_pk_bf16_f32 v41, v18, v19
    v_mfma_f32_16x16x32_bf16 v[196:199], a[136:139], v[32:35], v[196:199]
    v_exp_f32 v21, v21
    v_mfma_f32_16x16x32_bf16 v[196:199], a[140:143], v[36:39], v[196:199]
    ds_read_b128 a[100:103], v1 offset:37440
    v_mfma_f32_16x16x32_bf16 v[200:203], a[144:147], v[32:35], v[200:203]
    v_exp_f32 v22, v22
    v_mfma_f32_16x16x32_bf16 v[200:203], a[148:151], v[36:39], v[200:203]
    ds_read_b128 a[104:107], v1 offset:37504
    v_cvt_pk_bf16_f32 v42, v20, v21
    v_mfma_f32_16x16x32_bf16 v[204:207], a[152:155], v[32:35], v[204:207]
    v_exp_f32 v23, v23
    v_mfma_f32_16x16x32_bf16 v[204:207], a[156:159], v[36:39], v[204:207]
    ds_read_b128 a[108:111], v1 offset:37568
    v_mfma_f32_16x16x32_bf16 v[208:211], a[160:163], v[32:35], v[208:211]
    v_exp_f32 v24, v24
    v_mfma_f32_16x16x32_bf16 v[208:211], a[164:167], v[36:39], v[208:211]
    ds_read_b128 a[112:115], v1 offset:37632
    v_cvt_pk_bf16_f32 v43, v22, v23
    v_mfma_f32_16x16x32_bf16 v[212:215], a[168:171], v[32:35], v[212:215]
    v_exp_f32 v25, v25
    v_mfma_f32_16x16x32_bf16 v[212:215], a[172:175], v[36:39], v[212:215]
    ds_read_b128 a[116:119], v1 offset:37696
    v_mfma_f32_16x16x32_bf16 v[216:219], a[176:179], v[32:35], v[216:219]
    v_exp_f32 v26, v26
    v_mfma_f32_16x16x32_bf16 v[216:219], a[180:183], v[36:39], v[216:219]
    ds_read_b128 a[120:123], v1 offset:37760
    v_cvt_pk_bf16_f32 v44, v24, v25
    v_mfma_f32_16x16x32_bf16 v[220:223], a[184:187], v[32:35], v[220:223]
    v_exp_f32 v27, v27
    v_mfma_f32_16x16x32_bf16 v[220:223], a[188:191], v[36:39], v[220:223]
    ds_read_b128 a[124:127], v1 offset:37824
    v_smfmac_f32_16x16x64_bf16 a[8:11], a[16:19], v[32:39], v11
    s_waitcnt vmcnt(16) lgkmcnt(12)
    s_barrier
    v_mfma_f32_16x16x32_bf16 v[16:19], a[64:67], v[64:67], v[48:51]
    s_sub_u32 s47, s47, s48
    v_exp_f32 v28, v28
    v_mfma_f32_16x16x32_bf16 v[16:19], a[68:71], v[68:71], v[16:19]
    v_cvt_pk_bf16_f32 v45, v26, v27
    v_add_u32 v1, s48, v1
    v_mfma_f32_16x16x32_bf16 v[16:19], a[72:75], v[72:75], v[16:19]
    s_add_u32 m0, s47, 0
    v_exp_f32 v29, v29
    v_mfma_f32_16x16x32_bf16 v[16:19], a[76:79], v[76:79], v[16:19]
    s_waitcnt lgkmcnt(8)
    buffer_load_dwordx4 v5, s[16:19], s46 offen offset:0 lds
    v_mfma_f32_16x16x32_bf16 v[20:23], a[80:83], v[64:67], v[48:51]
    v_exp_f32 v30, v30
    v_mfma_f32_16x16x32_bf16 v[20:23], a[84:87], v[68:71], v[20:23]
    v_cvt_pk_bf16_f32 v46, v28, v29
    v_add_u32 v2, s48, v2
    v_mfma_f32_16x16x32_bf16 v[20:23], a[88:91], v[72:75], v[20:23]
    s_add_u32 m0, s47, 32
    v_exp_f32 v31, v31
    v_mfma_f32_16x16x32_bf16 v[20:23], a[92:95], v[76:79], v[20:23]
    s_waitcnt lgkmcnt(4)
    buffer_load_dwordx4 v5, s[16:19], s46 offen offset:1024 lds
    v_mfma_f32_16x16x32_bf16 v[24:27], a[96:99], v[64:67], v[48:51]
    s_sub_u32 s48, 0, s48
    v_exp_f32 v16, v16
    v_mfma_f32_16x16x32_bf16 v[24:27], a[100:103], v[68:71], v[24:27]
    v_cvt_pk_bf16_f32 v47, v30, v31
    v_mfma_f32_16x16x32_bf16 v[24:27], a[104:107], v[72:75], v[24:27]
    s_add_u32 m0, s47, 64
    v_exp_f32 v17, v17
    v_mfma_f32_16x16x32_bf16 v[24:27], a[108:111], v[76:79], v[24:27]
    s_waitcnt lgkmcnt(0)
    buffer_load_dwordx4 v5, s[16:19], s46 offen offset:2048 lds
    v_mfma_f32_16x16x32_bf16 v[28:31], a[112:115], v[64:67], v[48:51]
    v_exp_f32 v18, v18
    v_mfma_f32_16x16x32_bf16 v[28:31], a[116:119], v[68:71], v[28:31]
    v_cvt_pk_bf16_f32 v32, v16, v17
    v_mfma_f32_16x16x32_bf16 v[28:31], a[120:123], v[72:75], v[28:31]
    s_add_u32 m0, s47, 96
    v_exp_f32 v19, v19
    v_mfma_f32_16x16x32_bf16 v[28:31], a[124:127], v[76:79], v[28:31]
    buffer_load_dwordx4 v5, s[16:19], s46 offen offset:3072 lds
    v_mfma_f32_16x16x32_bf16 v[224:227], a[128:131], v[40:43], v[224:227]
    v_exp_f32 v20, v20
    v_mfma_f32_16x16x32_bf16 v[224:227], a[132:135], v[44:47], v[224:227]
    ds_read_b64_tr_b16 a[128:129], v2 offset:0
    v_cvt_pk_bf16_f32 v33, v18, v19
    v_mfma_f32_16x16x32_bf16 v[228:231], a[136:139], v[40:43], v[228:231]
    s_add_u32 m0, s47, 16896
    v_exp_f32 v21, v21
    v_mfma_f32_16x16x32_bf16 v[228:231], a[140:143], v[44:47], v[228:231]
    buffer_load_dwordx4 v5, s[20:23], s46 offen offset:0 lds
    v_mfma_f32_16x16x32_bf16 v[232:235], a[144:147], v[40:43], v[232:235]
    v_exp_f32 v22, v22
    v_mfma_f32_16x16x32_bf16 v[232:235], a[148:151], v[44:47], v[232:235]
    ds_read_b64_tr_b16 a[130:131], v2 offset:256
    v_cvt_pk_bf16_f32 v34, v20, v21
    v_mfma_f32_16x16x32_bf16 v[236:239], a[152:155], v[40:43], v[236:239]
    s_add_u32 m0, s47, 16928
    v_exp_f32 v23, v23
    v_mfma_f32_16x16x32_bf16 v[236:239], a[156:159], v[44:47], v[236:239]
    buffer_load_dwordx4 v5, s[20:23], s46 offen offset:1024 lds
    v_mfma_f32_16x16x32_bf16 v[240:243], a[160:163], v[40:43], v[240:243]
    v_exp_f32 v24, v24
    v_mfma_f32_16x16x32_bf16 v[240:243], a[164:167], v[44:47], v[240:243]
    ds_read_b64_tr_b16 a[132:133], v2 offset:512
    v_cvt_pk_bf16_f32 v35, v22, v23
    v_mfma_f32_16x16x32_bf16 v[244:247], a[168:171], v[40:43], v[244:247]
    s_add_u32 m0, s47, 16960
    v_exp_f32 v25, v25
    v_mfma_f32_16x16x32_bf16 v[244:247], a[172:175], v[44:47], v[244:247]
    buffer_load_dwordx4 v5, s[20:23], s46 offen offset:2048 lds
    v_mfma_f32_16x16x32_bf16 v[248:251], a[176:179], v[40:43], v[248:251]
    v_exp_f32 v26, v26
    v_mfma_f32_16x16x32_bf16 v[248:251], a[180:183], v[44:47], v[248:251]
    ds_read_b64_tr_b16 a[134:135], v2 offset:768
    v_cvt_pk_bf16_f32 v36, v24, v25
    v_mfma_f32_16x16x32_bf16 v[252:255], a[184:187], v[40:43], v[252:255]
    s_add_u32 m0, s47, 16992
    v_exp_f32 v27, v27
    v_mfma_f32_16x16x32_bf16 v[252:255], a[188:191], v[44:47], v[252:255]
    buffer_load_dwordx4 v5, s[20:23], s46 offen offset:3072 lds
    v_smfmac_f32_16x16x64_bf16 a[12:15], a[16:19], v[40:47], v11
    ds_read_b64_tr_b16 a[136:137], v2 offset:32
    v_mfma_f32_16x16x32_bf16 v[16:19], a[64:67], v[80:83], v[52:55]
    v_exp_f32 v28, v28
    v_mfma_f32_16x16x32_bf16 v[16:19], a[68:71], v[84:87], v[16:19]
    ds_read_b64_tr_b16 a[138:139], v2 offset:288
    v_cvt_pk_bf16_f32 v37, v26, v27
    v_mfma_f32_16x16x32_bf16 v[16:19], a[72:75], v[88:91], v[16:19]
    v_exp_f32 v29, v29
    v_mfma_f32_16x16x32_bf16 v[16:19], a[76:79], v[92:95], v[16:19]
    global_load_dword a63, v12, s[6:7]
    v_mfma_f32_16x16x32_bf16 v[20:23], a[80:83], v[80:83], v[52:55]
    v_exp_f32 v30, v30
    v_mfma_f32_16x16x32_bf16 v[20:23], a[84:87], v[84:87], v[20:23]
    ds_read_b64_tr_b16 a[140:141], v2 offset:544
    v_cvt_pk_bf16_f32 v38, v28, v29
    v_mfma_f32_16x16x32_bf16 v[20:23], a[88:91], v[88:91], v[20:23]
    v_exp_f32 v31, v31
    v_mfma_f32_16x16x32_bf16 v[20:23], a[92:95], v[92:95], v[20:23]
    ds_read_b64_tr_b16 a[142:143], v2 offset:800
    v_mfma_f32_16x16x32_bf16 v[24:27], a[96:99], v[80:83], v[52:55]
    v_exp_f32 v16, v16
    v_mfma_f32_16x16x32_bf16 v[24:27], a[100:103], v[84:87], v[24:27]
    ds_read_b64_tr_b16 a[144:145], v2 offset:64
    v_cvt_pk_bf16_f32 v39, v30, v31
    v_mfma_f32_16x16x32_bf16 v[24:27], a[104:107], v[88:91], v[24:27]
    s_mov_b32 s54, 884736
    v_exp_f32 v17, v17
    v_mfma_f32_16x16x32_bf16 v[24:27], a[108:111], v[92:95], v[24:27]
    buffer_load_dwordx4 a[44:47], v6, s[64:67], s54 offen
    v_mfma_f32_16x16x32_bf16 v[28:31], a[112:115], v[80:83], v[52:55]
    v_exp_f32 v18, v18
    v_mfma_f32_16x16x32_bf16 v[28:31], a[116:119], v[84:87], v[28:31]
    ds_read_b64_tr_b16 a[146:147], v2 offset:320
    v_cvt_pk_bf16_f32 v40, v16, v17
    v_mfma_f32_16x16x32_bf16 v[28:31], a[120:123], v[88:91], v[28:31]
    v_exp_f32 v19, v19
    v_mfma_f32_16x16x32_bf16 v[28:31], a[124:127], v[92:95], v[28:31]
    ds_read_b64_tr_b16 a[148:149], v2 offset:576
    v_mfma_f32_16x16x32_bf16 v[128:131], a[192:195], v[32:35], v[128:131]
    v_exp_f32 v20, v20
    v_mfma_f32_16x16x32_bf16 v[128:131], a[196:199], v[36:39], v[128:131]
    ds_read_b64_tr_b16 a[150:151], v2 offset:832
    v_cvt_pk_bf16_f32 v41, v18, v19
    v_mfma_f32_16x16x32_bf16 v[132:135], a[200:203], v[32:35], v[132:135]
    s_mov_b32 s54, 1032192
    v_exp_f32 v21, v21
    v_mfma_f32_16x16x32_bf16 v[132:135], a[204:207], v[36:39], v[132:135]
    buffer_load_dwordx4 a[48:51], v6, s[64:67], s54 offen
    v_mfma_f32_16x16x32_bf16 v[136:139], a[208:211], v[32:35], v[136:139]
    v_exp_f32 v22, v22
    v_mfma_f32_16x16x32_bf16 v[136:139], a[212:215], v[36:39], v[136:139]
    ds_read_b64_tr_b16 a[152:153], v2 offset:96
    v_cvt_pk_bf16_f32 v42, v20, v21
    v_mfma_f32_16x16x32_bf16 v[140:143], a[216:219], v[32:35], v[140:143]
    v_exp_f32 v23, v23
    v_mfma_f32_16x16x32_bf16 v[140:143], a[220:223], v[36:39], v[140:143]
    ds_read_b64_tr_b16 a[154:155], v2 offset:352
    v_mfma_f32_16x16x32_bf16 v[144:147], a[224:227], v[32:35], v[144:147]
    v_exp_f32 v24, v24
    v_mfma_f32_16x16x32_bf16 v[144:147], a[228:231], v[36:39], v[144:147]
    ds_read_b64_tr_b16 a[156:157], v2 offset:608
    v_cvt_pk_bf16_f32 v43, v22, v23
    v_mfma_f32_16x16x32_bf16 v[148:151], a[232:235], v[32:35], v[148:151]
    s_mov_b32 s54, 1179648
    v_exp_f32 v25, v25
    v_mfma_f32_16x16x32_bf16 v[148:151], a[236:239], v[36:39], v[148:151]
    buffer_load_dwordx4 a[52:55], v6, s[64:67], s54 offen
    v_mfma_f32_16x16x32_bf16 v[152:155], a[240:243], v[32:35], v[152:155]
    v_exp_f32 v26, v26
    v_mfma_f32_16x16x32_bf16 v[152:155], a[244:247], v[36:39], v[152:155]
    ds_read_b64_tr_b16 a[158:159], v2 offset:864
    v_cvt_pk_bf16_f32 v44, v24, v25
    v_mfma_f32_16x16x32_bf16 v[156:159], a[248:251], v[32:35], v[156:159]
    v_exp_f32 v27, v27
    v_mfma_f32_16x16x32_bf16 v[156:159], a[252:255], v[36:39], v[156:159]
    ds_read_b64_tr_b16 a[160:161], v2 offset:128
    v_smfmac_f32_16x16x64_bf16 a[0:3], a[16:19], v[32:39], v11
    ds_read_b64_tr_b16 a[162:163], v2 offset:384
    v_mfma_f32_16x16x32_bf16 v[16:19], a[64:67], v[96:99], v[56:59]
    v_exp_f32 v28, v28
    v_mfma_f32_16x16x32_bf16 v[16:19], a[68:71], v[100:103], v[16:19]
    ds_read_b64_tr_b16 a[164:165], v2 offset:640
    v_cvt_pk_bf16_f32 v45, v26, v27
    v_mfma_f32_16x16x32_bf16 v[16:19], a[72:75], v[104:107], v[16:19]
    v_exp_f32 v29, v29
    v_mfma_f32_16x16x32_bf16 v[16:19], a[76:79], v[108:111], v[16:19]
    ds_read_b64_tr_b16 a[166:167], v2 offset:896
    v_mfma_f32_16x16x32_bf16 v[20:23], a[80:83], v[96:99], v[56:59]
    v_exp_f32 v30, v30
    v_mfma_f32_16x16x32_bf16 v[20:23], a[84:87], v[100:103], v[20:23]
    ds_read_b64_tr_b16 a[168:169], v2 offset:160
    v_cvt_pk_bf16_f32 v46, v28, v29
    v_mfma_f32_16x16x32_bf16 v[20:23], a[88:91], v[104:107], v[20:23]
    v_exp_f32 v31, v31
    v_mfma_f32_16x16x32_bf16 v[20:23], a[92:95], v[108:111], v[20:23]
    ds_read_b64_tr_b16 a[170:171], v2 offset:416
    v_mfma_f32_16x16x32_bf16 v[24:27], a[96:99], v[96:99], v[56:59]
    v_exp_f32 v16, v16
    v_mfma_f32_16x16x32_bf16 v[24:27], a[100:103], v[100:103], v[24:27]
    ds_read_b64_tr_b16 a[172:173], v2 offset:672
    v_cvt_pk_bf16_f32 v47, v30, v31
    v_mfma_f32_16x16x32_bf16 v[24:27], a[104:107], v[104:107], v[24:27]
    v_exp_f32 v17, v17
    v_mfma_f32_16x16x32_bf16 v[24:27], a[108:111], v[108:111], v[24:27]
    ds_read_b64_tr_b16 a[174:175], v2 offset:928
    v_mfma_f32_16x16x32_bf16 v[28:31], a[112:115], v[96:99], v[56:59]
    v_exp_f32 v18, v18
    v_mfma_f32_16x16x32_bf16 v[28:31], a[116:119], v[100:103], v[28:31]
    ds_read_b64_tr_b16 a[176:177], v2 offset:192
    v_cvt_pk_bf16_f32 v32, v16, v17
    v_mfma_f32_16x16x32_bf16 v[28:31], a[120:123], v[104:107], v[28:31]
    v_exp_f32 v19, v19
    v_mfma_f32_16x16x32_bf16 v[28:31], a[124:127], v[108:111], v[28:31]
    ds_read_b64_tr_b16 a[178:179], v2 offset:448
    v_mfma_f32_16x16x32_bf16 v[160:163], a[192:195], v[40:43], v[160:163]
    v_exp_f32 v20, v20
    v_mfma_f32_16x16x32_bf16 v[160:163], a[196:199], v[44:47], v[160:163]
    ds_read_b64_tr_b16 a[180:181], v2 offset:704
    v_cvt_pk_bf16_f32 v33, v18, v19
    v_mfma_f32_16x16x32_bf16 v[164:167], a[200:203], v[40:43], v[164:167]
    v_exp_f32 v21, v21
    v_mfma_f32_16x16x32_bf16 v[164:167], a[204:207], v[44:47], v[164:167]
    ds_read_b64_tr_b16 a[182:183], v2 offset:960
    v_mfma_f32_16x16x32_bf16 v[168:171], a[208:211], v[40:43], v[168:171]
    v_exp_f32 v22, v22
    v_mfma_f32_16x16x32_bf16 v[168:171], a[212:215], v[44:47], v[168:171]
    ds_read_b64_tr_b16 a[184:185], v2 offset:224
    v_cvt_pk_bf16_f32 v34, v20, v21
    v_mfma_f32_16x16x32_bf16 v[172:175], a[216:219], v[40:43], v[172:175]
    v_exp_f32 v23, v23
    v_mfma_f32_16x16x32_bf16 v[172:175], a[220:223], v[44:47], v[172:175]
    ds_read_b64_tr_b16 a[186:187], v2 offset:480
    v_mfma_f32_16x16x32_bf16 v[176:179], a[224:227], v[40:43], v[176:179]
    v_exp_f32 v24, v24
    v_mfma_f32_16x16x32_bf16 v[176:179], a[228:231], v[44:47], v[176:179]
    ds_read_b64_tr_b16 a[188:189], v2 offset:736
    v_cvt_pk_bf16_f32 v35, v22, v23
    v_mfma_f32_16x16x32_bf16 v[180:183], a[232:235], v[40:43], v[180:183]
    v_exp_f32 v25, v25
    v_mfma_f32_16x16x32_bf16 v[180:183], a[236:239], v[44:47], v[180:183]
    ds_read_b64_tr_b16 a[190:191], v2 offset:992
    v_mfma_f32_16x16x32_bf16 v[184:187], a[240:243], v[40:43], v[184:187]
    v_exp_f32 v26, v26
    v_mfma_f32_16x16x32_bf16 v[184:187], a[244:247], v[44:47], v[184:187]
    v_cvt_pk_bf16_f32 v36, v24, v25
    v_mfma_f32_16x16x32_bf16 v[188:191], a[248:251], v[40:43], v[188:191]
    v_exp_f32 v27, v27
    v_mfma_f32_16x16x32_bf16 v[188:191], a[252:255], v[44:47], v[188:191]
    v_smfmac_f32_16x16x64_bf16 a[4:7], a[16:19], v[40:47], v11
    v_mfma_f32_16x16x32_bf16 v[16:19], a[64:67], v[112:115], v[60:63]
    v_exp_f32 v28, v28
    v_mfma_f32_16x16x32_bf16 v[16:19], a[68:71], v[116:119], v[16:19]
    s_add_u32 s46, s46, 16384
    ds_read_b128 a[64:67], v1 offset:0
    v_cvt_pk_bf16_f32 v37, v26, v27
    v_mfma_f32_16x16x32_bf16 v[16:19], a[72:75], v[120:123], v[16:19]
    v_exp_f32 v29, v29
    v_mfma_f32_16x16x32_bf16 v[16:19], a[76:79], v[124:127], v[16:19]
    ds_read_b128 a[68:71], v1 offset:64
    v_mfma_f32_16x16x32_bf16 v[20:23], a[80:83], v[112:115], v[60:63]
    v_exp_f32 v30, v30
    v_mfma_f32_16x16x32_bf16 v[20:23], a[84:87], v[116:119], v[20:23]
    ds_read_b128 a[72:75], v1 offset:128
    v_cvt_pk_bf16_f32 v38, v28, v29
    v_mfma_f32_16x16x32_bf16 v[20:23], a[88:91], v[120:123], v[20:23]
    v_exp_f32 v31, v31
    v_mfma_f32_16x16x32_bf16 v[20:23], a[92:95], v[124:127], v[20:23]
    ds_read_b128 a[76:79], v1 offset:192
    v_mfma_f32_16x16x32_bf16 v[24:27], a[96:99], v[112:115], v[60:63]
    v_exp_f32 v16, v16
    v_mfma_f32_16x16x32_bf16 v[24:27], a[100:103], v[116:119], v[24:27]
    ds_read_b128 a[80:83], v1 offset:256
    v_cvt_pk_bf16_f32 v39, v30, v31
    v_mfma_f32_16x16x32_bf16 v[24:27], a[104:107], v[120:123], v[24:27]
    v_exp_f32 v17, v17
    v_mfma_f32_16x16x32_bf16 v[24:27], a[108:111], v[124:127], v[24:27]
    ds_read_b128 a[84:87], v1 offset:320
    v_mfma_f32_16x16x32_bf16 v[28:31], a[112:115], v[112:115], v[60:63]
    v_exp_f32 v18, v18
    v_mfma_f32_16x16x32_bf16 v[28:31], a[116:119], v[116:119], v[28:31]
    ds_read_b128 a[88:91], v1 offset:384
    v_cvt_pk_bf16_f32 v40, v16, v17
    v_mfma_f32_16x16x32_bf16 v[28:31], a[120:123], v[120:123], v[28:31]
    v_exp_f32 v19, v19
    v_mfma_f32_16x16x32_bf16 v[28:31], a[124:127], v[124:127], v[28:31]
    ds_read_b128 a[92:95], v1 offset:448
    v_mfma_f32_16x16x32_bf16 v[192:195], a[192:195], v[32:35], v[192:195]
    v_exp_f32 v20, v20
    v_mfma_f32_16x16x32_bf16 v[192:195], a[196:199], v[36:39], v[192:195]
    ds_read_b128 a[96:99], v1 offset:512
    v_cvt_pk_bf16_f32 v41, v18, v19
    v_mfma_f32_16x16x32_bf16 v[196:199], a[200:203], v[32:35], v[196:199]
    v_exp_f32 v21, v21
    v_mfma_f32_16x16x32_bf16 v[196:199], a[204:207], v[36:39], v[196:199]
    ds_read_b128 a[100:103], v1 offset:576
    v_mfma_f32_16x16x32_bf16 v[200:203], a[208:211], v[32:35], v[200:203]
    v_exp_f32 v22, v22
    v_mfma_f32_16x16x32_bf16 v[200:203], a[212:215], v[36:39], v[200:203]
    ds_read_b128 a[104:107], v1 offset:640
    v_cvt_pk_bf16_f32 v42, v20, v21
    v_mfma_f32_16x16x32_bf16 v[204:207], a[216:219], v[32:35], v[204:207]
    v_exp_f32 v23, v23
    v_mfma_f32_16x16x32_bf16 v[204:207], a[220:223], v[36:39], v[204:207]
    ds_read_b128 a[108:111], v1 offset:704
    v_mfma_f32_16x16x32_bf16 v[208:211], a[224:227], v[32:35], v[208:211]
    v_exp_f32 v24, v24
    v_mfma_f32_16x16x32_bf16 v[208:211], a[228:231], v[36:39], v[208:211]
    ds_read_b128 a[112:115], v1 offset:768
    v_cvt_pk_bf16_f32 v43, v22, v23
    v_mfma_f32_16x16x32_bf16 v[212:215], a[232:235], v[32:35], v[212:215]
    v_exp_f32 v25, v25
    v_mfma_f32_16x16x32_bf16 v[212:215], a[236:239], v[36:39], v[212:215]
    ds_read_b128 a[116:119], v1 offset:832
    v_mfma_f32_16x16x32_bf16 v[216:219], a[240:243], v[32:35], v[216:219]
    v_exp_f32 v26, v26
    v_mfma_f32_16x16x32_bf16 v[216:219], a[244:247], v[36:39], v[216:219]
    ds_read_b128 a[120:123], v1 offset:896
    v_cvt_pk_bf16_f32 v44, v24, v25
    v_mfma_f32_16x16x32_bf16 v[220:223], a[248:251], v[32:35], v[220:223]
    v_exp_f32 v27, v27
    v_mfma_f32_16x16x32_bf16 v[220:223], a[252:255], v[36:39], v[220:223]
    ds_read_b128 a[124:127], v1 offset:960
    v_smfmac_f32_16x16x64_bf16 a[8:11], a[16:19], v[32:39], v11
    s_waitcnt vmcnt(16) lgkmcnt(12)
    s_barrier
    v_mfma_f32_16x16x32_bf16 v[16:19], a[64:67], v[64:67], v[48:51]
    v_exp_f32 v28, v28
    v_mfma_f32_16x16x32_bf16 v[16:19], a[68:71], v[68:71], v[16:19]
    v_cvt_pk_bf16_f32 v45, v26, v27
    v_mfma_f32_16x16x32_bf16 v[16:19], a[72:75], v[72:75], v[16:19]
    s_add_u32 m0, s47, 36864
    v_exp_f32 v29, v29
    v_mfma_f32_16x16x32_bf16 v[16:19], a[76:79], v[76:79], v[16:19]
    s_waitcnt lgkmcnt(8)
    buffer_load_dwordx4 v5, s[16:19], s46 offen offset:0 lds
    v_mfma_f32_16x16x32_bf16 v[20:23], a[80:83], v[64:67], v[48:51]
    v_exp_f32 v30, v30
    v_mfma_f32_16x16x32_bf16 v[20:23], a[84:87], v[68:71], v[20:23]
    v_cvt_pk_bf16_f32 v46, v28, v29
    v_mfma_f32_16x16x32_bf16 v[20:23], a[88:91], v[72:75], v[20:23]
    s_add_u32 m0, s47, 36896
    v_exp_f32 v31, v31
    v_mfma_f32_16x16x32_bf16 v[20:23], a[92:95], v[76:79], v[20:23]
    s_waitcnt lgkmcnt(4)
    buffer_load_dwordx4 v5, s[16:19], s46 offen offset:1024 lds
    v_mfma_f32_16x16x32_bf16 v[24:27], a[96:99], v[64:67], v[48:51]
    v_exp_f32 v16, v16
    v_mfma_f32_16x16x32_bf16 v[24:27], a[100:103], v[68:71], v[24:27]
    v_cvt_pk_bf16_f32 v47, v30, v31
    v_mfma_f32_16x16x32_bf16 v[24:27], a[104:107], v[72:75], v[24:27]
    s_add_u32 m0, s47, 36928
    v_exp_f32 v17, v17
    v_mfma_f32_16x16x32_bf16 v[24:27], a[108:111], v[76:79], v[24:27]
    s_waitcnt lgkmcnt(0)
    buffer_load_dwordx4 v5, s[16:19], s46 offen offset:2048 lds
    v_mfma_f32_16x16x32_bf16 v[28:31], a[112:115], v[64:67], v[48:51]
    v_exp_f32 v18, v18
    v_mfma_f32_16x16x32_bf16 v[28:31], a[116:119], v[68:71], v[28:31]
    v_cvt_pk_bf16_f32 v32, v16, v17
    v_mfma_f32_16x16x32_bf16 v[28:31], a[120:123], v[72:75], v[28:31]
    s_add_u32 m0, s47, 36960
    v_exp_f32 v19, v19
    v_mfma_f32_16x16x32_bf16 v[28:31], a[124:127], v[76:79], v[28:31]
    buffer_load_dwordx4 v5, s[16:19], s46 offen offset:3072 lds
    v_mfma_f32_16x16x32_bf16 v[224:227], a[192:195], v[40:43], v[224:227]
    v_exp_f32 v20, v20
    v_mfma_f32_16x16x32_bf16 v[224:227], a[196:199], v[44:47], v[224:227]
    ds_read_b64_tr_b16 a[192:193], v2 offset:36864
    v_cvt_pk_bf16_f32 v33, v18, v19
    v_mfma_f32_16x16x32_bf16 v[228:231], a[200:203], v[40:43], v[228:231]
    s_add_u32 m0, s47, 53760
    v_exp_f32 v21, v21
    v_mfma_f32_16x16x32_bf16 v[228:231], a[204:207], v[44:47], v[228:231]
    buffer_load_dwordx4 v5, s[20:23], s46 offen offset:0 lds
    v_mfma_f32_16x16x32_bf16 v[232:235], a[208:211], v[40:43], v[232:235]
    v_exp_f32 v22, v22
    v_mfma_f32_16x16x32_bf16 v[232:235], a[212:215], v[44:47], v[232:235]
    ds_read_b64_tr_b16 a[194:195], v2 offset:37120
    v_cvt_pk_bf16_f32 v34, v20, v21
    v_mfma_f32_16x16x32_bf16 v[236:239], a[216:219], v[40:43], v[236:239]
    s_add_u32 m0, s47, 53792
    v_exp_f32 v23, v23
    v_mfma_f32_16x16x32_bf16 v[236:239], a[220:223], v[44:47], v[236:239]
    buffer_load_dwordx4 v5, s[20:23], s46 offen offset:1024 lds
    v_mfma_f32_16x16x32_bf16 v[240:243], a[224:227], v[40:43], v[240:243]
    v_exp_f32 v24, v24
    v_mfma_f32_16x16x32_bf16 v[240:243], a[228:231], v[44:47], v[240:243]
    ds_read_b64_tr_b16 a[196:197], v2 offset:37376
    v_cvt_pk_bf16_f32 v35, v22, v23
    v_mfma_f32_16x16x32_bf16 v[244:247], a[232:235], v[40:43], v[244:247]
    s_add_u32 m0, s47, 53824
    v_exp_f32 v25, v25
    v_mfma_f32_16x16x32_bf16 v[244:247], a[236:239], v[44:47], v[244:247]
    buffer_load_dwordx4 v5, s[20:23], s46 offen offset:2048 lds
    v_mfma_f32_16x16x32_bf16 v[248:251], a[240:243], v[40:43], v[248:251]
    v_exp_f32 v26, v26
    v_mfma_f32_16x16x32_bf16 v[248:251], a[244:247], v[44:47], v[248:251]
    ds_read_b64_tr_b16 a[198:199], v2 offset:37632
    v_cvt_pk_bf16_f32 v36, v24, v25
    v_mfma_f32_16x16x32_bf16 v[252:255], a[248:251], v[40:43], v[252:255]
    s_add_u32 m0, s47, 53856
    v_exp_f32 v27, v27
    v_mfma_f32_16x16x32_bf16 v[252:255], a[252:255], v[44:47], v[252:255]
    buffer_load_dwordx4 v5, s[20:23], s46 offen offset:3072 lds
    v_smfmac_f32_16x16x64_bf16 a[12:15], a[16:19], v[40:47], v11
    ds_read_b64_tr_b16 a[200:201], v2 offset:36896
    v_mfma_f32_16x16x32_bf16 v[16:19], a[64:67], v[80:83], v[52:55]
    v_exp_f32 v28, v28
    v_mfma_f32_16x16x32_bf16 v[16:19], a[68:71], v[84:87], v[16:19]
    ds_read_b64_tr_b16 a[202:203], v2 offset:37152
    v_cvt_pk_bf16_f32 v37, v26, v27
    v_mfma_f32_16x16x32_bf16 v[16:19], a[72:75], v[88:91], v[16:19]
    v_exp_f32 v29, v29
    v_mfma_f32_16x16x32_bf16 v[16:19], a[76:79], v[92:95], v[16:19]
    global_load_dword a63, v13, s[8:9]
    v_mfma_f32_16x16x32_bf16 v[20:23], a[80:83], v[80:83], v[52:55]
    v_exp_f32 v30, v30
    v_mfma_f32_16x16x32_bf16 v[20:23], a[84:87], v[84:87], v[20:23]
    ds_read_b64_tr_b16 a[204:205], v2 offset:37408
    v_cvt_pk_bf16_f32 v38, v28, v29
    v_mfma_f32_16x16x32_bf16 v[20:23], a[88:91], v[88:91], v[20:23]
    v_exp_f32 v31, v31
    v_mfma_f32_16x16x32_bf16 v[20:23], a[92:95], v[92:95], v[20:23]
    ds_read_b64_tr_b16 a[206:207], v2 offset:37664
    v_mfma_f32_16x16x32_bf16 v[24:27], a[96:99], v[80:83], v[52:55]
    v_exp_f32 v16, v16
    v_mfma_f32_16x16x32_bf16 v[24:27], a[100:103], v[84:87], v[24:27]
    ds_read_b64_tr_b16 a[208:209], v2 offset:36928
    v_cvt_pk_bf16_f32 v39, v30, v31
    v_mfma_f32_16x16x32_bf16 v[24:27], a[104:107], v[88:91], v[24:27]
    v_exp_f32 v17, v17
    v_mfma_f32_16x16x32_bf16 v[24:27], a[108:111], v[92:95], v[24:27]
    ds_read_b64_tr_b16 a[210:211], v2 offset:37184
    v_mfma_f32_16x16x32_bf16 v[28:31], a[112:115], v[80:83], v[52:55]
    v_exp_f32 v18, v18
    v_mfma_f32_16x16x32_bf16 v[28:31], a[116:119], v[84:87], v[28:31]
    ds_read_b64_tr_b16 a[212:213], v2 offset:37440
    v_cvt_pk_bf16_f32 v40, v16, v17
    v_mfma_f32_16x16x32_bf16 v[28:31], a[120:123], v[88:91], v[28:31]
    v_exp_f32 v19, v19
    v_mfma_f32_16x16x32_bf16 v[28:31], a[124:127], v[92:95], v[28:31]
    ds_read_b64_tr_b16 a[214:215], v2 offset:37696
    v_mfma_f32_16x16x32_bf16 v[128:131], a[128:131], v[32:35], v[128:131]
    v_exp_f32 v20, v20
    v_mfma_f32_16x16x32_bf16 v[128:131], a[132:135], v[36:39], v[128:131]
    ds_read_b64_tr_b16 a[216:217], v2 offset:36960
    v_cvt_pk_bf16_f32 v41, v18, v19
    v_mfma_f32_16x16x32_bf16 v[132:135], a[136:139], v[32:35], v[132:135]
    v_exp_f32 v21, v21
    v_mfma_f32_16x16x32_bf16 v[132:135], a[140:143], v[36:39], v[132:135]
    ds_read_b64_tr_b16 a[218:219], v2 offset:37216
    v_mfma_f32_16x16x32_bf16 v[136:139], a[144:147], v[32:35], v[136:139]
    v_exp_f32 v22, v22
    v_mfma_f32_16x16x32_bf16 v[136:139], a[148:151], v[36:39], v[136:139]
    ds_read_b64_tr_b16 a[220:221], v2 offset:37472
    v_cvt_pk_bf16_f32 v42, v20, v21
    v_mfma_f32_16x16x32_bf16 v[140:143], a[152:155], v[32:35], v[140:143]
    v_exp_f32 v23, v23
    v_mfma_f32_16x16x32_bf16 v[140:143], a[156:159], v[36:39], v[140:143]
    ds_read_b64_tr_b16 a[222:223], v2 offset:37728
    v_mfma_f32_16x16x32_bf16 v[144:147], a[160:163], v[32:35], v[144:147]
    v_exp_f32 v24, v24
    v_mfma_f32_16x16x32_bf16 v[144:147], a[164:167], v[36:39], v[144:147]
    ds_read_b64_tr_b16 a[224:225], v2 offset:36992
    v_cvt_pk_bf16_f32 v43, v22, v23
    v_mfma_f32_16x16x32_bf16 v[148:151], a[168:171], v[32:35], v[148:151]
    v_exp_f32 v25, v25
    v_mfma_f32_16x16x32_bf16 v[148:151], a[172:175], v[36:39], v[148:151]
    ds_read_b64_tr_b16 a[226:227], v2 offset:37248
    v_mfma_f32_16x16x32_bf16 v[152:155], a[176:179], v[32:35], v[152:155]
    v_exp_f32 v26, v26
    v_mfma_f32_16x16x32_bf16 v[152:155], a[180:183], v[36:39], v[152:155]
    ds_read_b64_tr_b16 a[228:229], v2 offset:37504
    v_cvt_pk_bf16_f32 v44, v24, v25
    v_mfma_f32_16x16x32_bf16 v[156:159], a[184:187], v[32:35], v[156:159]
    v_exp_f32 v27, v27
    v_mfma_f32_16x16x32_bf16 v[156:159], a[188:191], v[36:39], v[156:159]
    ds_read_b64_tr_b16 a[230:231], v2 offset:37760
    v_smfmac_f32_16x16x64_bf16 a[0:3], a[16:19], v[32:39], v11
    ds_read_b64_tr_b16 a[232:233], v2 offset:37024
    v_mfma_f32_16x16x32_bf16 v[16:19], a[64:67], v[96:99], v[56:59]
    v_exp_f32 v28, v28
    v_mfma_f32_16x16x32_bf16 v[16:19], a[68:71], v[100:103], v[16:19]
    ds_read_b64_tr_b16 a[234:235], v2 offset:37280
    v_cvt_pk_bf16_f32 v45, v26, v27
    v_mfma_f32_16x16x32_bf16 v[16:19], a[72:75], v[104:107], v[16:19]
    v_exp_f32 v29, v29
    v_mfma_f32_16x16x32_bf16 v[16:19], a[76:79], v[108:111], v[16:19]
    ds_read_b64_tr_b16 a[236:237], v2 offset:37536
    v_mfma_f32_16x16x32_bf16 v[20:23], a[80:83], v[96:99], v[56:59]
    v_exp_f32 v30, v30
    v_mfma_f32_16x16x32_bf16 v[20:23], a[84:87], v[100:103], v[20:23]
    ds_read_b64_tr_b16 a[238:239], v2 offset:37792
    v_cvt_pk_bf16_f32 v46, v28, v29
    v_mfma_f32_16x16x32_bf16 v[20:23], a[88:91], v[104:107], v[20:23]
    v_exp_f32 v31, v31
    v_mfma_f32_16x16x32_bf16 v[20:23], a[92:95], v[108:111], v[20:23]
    ds_read_b64_tr_b16 a[240:241], v2 offset:37056
    v_mfma_f32_16x16x32_bf16 v[24:27], a[96:99], v[96:99], v[56:59]
    v_exp_f32 v16, v16
    v_mfma_f32_16x16x32_bf16 v[24:27], a[100:103], v[100:103], v[24:27]
    ds_read_b64_tr_b16 a[242:243], v2 offset:37312
    v_cvt_pk_bf16_f32 v47, v30, v31
    v_mfma_f32_16x16x32_bf16 v[24:27], a[104:107], v[104:107], v[24:27]
    v_exp_f32 v17, v17
    v_mfma_f32_16x16x32_bf16 v[24:27], a[108:111], v[108:111], v[24:27]
    ds_read_b64_tr_b16 a[244:245], v2 offset:37568
    v_mfma_f32_16x16x32_bf16 v[28:31], a[112:115], v[96:99], v[56:59]
    v_exp_f32 v18, v18
    v_mfma_f32_16x16x32_bf16 v[28:31], a[116:119], v[100:103], v[28:31]
    ds_read_b64_tr_b16 a[246:247], v2 offset:37824
    v_cvt_pk_bf16_f32 v32, v16, v17
    v_mfma_f32_16x16x32_bf16 v[28:31], a[120:123], v[104:107], v[28:31]
    v_exp_f32 v19, v19
    v_mfma_f32_16x16x32_bf16 v[28:31], a[124:127], v[108:111], v[28:31]
    ds_read_b64_tr_b16 a[248:249], v2 offset:37088
    v_mfma_f32_16x16x32_bf16 v[160:163], a[128:131], v[40:43], v[160:163]
    v_exp_f32 v20, v20
    v_mfma_f32_16x16x32_bf16 v[160:163], a[132:135], v[44:47], v[160:163]
    ds_read_b64_tr_b16 a[250:251], v2 offset:37344
    v_cvt_pk_bf16_f32 v33, v18, v19
    v_mfma_f32_16x16x32_bf16 v[164:167], a[136:139], v[40:43], v[164:167]
    v_exp_f32 v21, v21
    v_mfma_f32_16x16x32_bf16 v[164:167], a[140:143], v[44:47], v[164:167]
    ds_read_b64_tr_b16 a[252:253], v2 offset:37600
    v_mfma_f32_16x16x32_bf16 v[168:171], a[144:147], v[40:43], v[168:171]
    v_exp_f32 v22, v22
    v_mfma_f32_16x16x32_bf16 v[168:171], a[148:151], v[44:47], v[168:171]
    ds_read_b64_tr_b16 a[254:255], v2 offset:37856
    v_cvt_pk_bf16_f32 v34, v20, v21
    v_mfma_f32_16x16x32_bf16 v[172:175], a[152:155], v[40:43], v[172:175]
    v_exp_f32 v23, v23
    v_mfma_f32_16x16x32_bf16 v[172:175], a[156:159], v[44:47], v[172:175]
    v_mfma_f32_16x16x32_bf16 v[176:179], a[160:163], v[40:43], v[176:179]
    v_exp_f32 v24, v24
    v_mfma_f32_16x16x32_bf16 v[176:179], a[164:167], v[44:47], v[176:179]
    v_cvt_pk_bf16_f32 v35, v22, v23
    v_mfma_f32_16x16x32_bf16 v[180:183], a[168:171], v[40:43], v[180:183]
    v_exp_f32 v25, v25
    v_mfma_f32_16x16x32_bf16 v[180:183], a[172:175], v[44:47], v[180:183]
    v_mfma_f32_16x16x32_bf16 v[184:187], a[176:179], v[40:43], v[184:187]
    v_exp_f32 v26, v26
    v_mfma_f32_16x16x32_bf16 v[184:187], a[180:183], v[44:47], v[184:187]
L2_pad7:
    s_cbranch_execz L2_pad11
    v_cvt_pk_bf16_f32 v36, v24, v25
    v_mfma_f32_16x16x32_bf16 v[188:191], a[184:187], v[40:43], v[188:191]
    v_exp_f32 v27, v27
    v_mfma_f32_16x16x32_bf16 v[188:191], a[188:191], v[44:47], v[188:191]
    v_smfmac_f32_16x16x64_bf16 a[4:7], a[16:19], v[40:47], v11
    v_mfma_f32_16x16x32_bf16 v[16:19], a[64:67], v[112:115], v[60:63]
    v_exp_f32 v28, v28
    v_mfma_f32_16x16x32_bf16 v[16:19], a[68:71], v[116:119], v[16:19]
    s_add_u32 s46, s46, 16384
    ds_read_b128 a[64:67], v1 offset:36864
    v_cvt_pk_bf16_f32 v37, v26, v27
    v_mfma_f32_16x16x32_bf16 v[16:19], a[72:75], v[120:123], v[16:19]
    v_exp_f32 v29, v29
    v_mfma_f32_16x16x32_bf16 v[16:19], a[76:79], v[124:127], v[16:19]
    ds_read_b128 a[68:71], v1 offset:36928
    v_mfma_f32_16x16x32_bf16 v[20:23], a[80:83], v[112:115], v[60:63]
    v_exp_f32 v30, v30
    v_mfma_f32_16x16x32_bf16 v[20:23], a[84:87], v[116:119], v[20:23]
    ds_read_b128 a[72:75], v1 offset:36992
    v_cvt_pk_bf16_f32 v38, v28, v29
    v_mfma_f32_16x16x32_bf16 v[20:23], a[88:91], v[120:123], v[20:23]
    v_exp_f32 v31, v31
    v_mfma_f32_16x16x32_bf16 v[20:23], a[92:95], v[124:127], v[20:23]
    ds_read_b128 a[76:79], v1 offset:37056
    v_mfma_f32_16x16x32_bf16 v[24:27], a[96:99], v[112:115], v[60:63]
    v_exp_f32 v16, v16
    v_mfma_f32_16x16x32_bf16 v[24:27], a[100:103], v[116:119], v[24:27]
    ds_read_b128 a[80:83], v1 offset:37120
    v_cvt_pk_bf16_f32 v39, v30, v31
    v_mfma_f32_16x16x32_bf16 v[24:27], a[104:107], v[120:123], v[24:27]
    v_exp_f32 v17, v17
    v_mfma_f32_16x16x32_bf16 v[24:27], a[108:111], v[124:127], v[24:27]
    ds_read_b128 a[84:87], v1 offset:37184
    v_mfma_f32_16x16x32_bf16 v[28:31], a[112:115], v[112:115], v[60:63]
    v_exp_f32 v18, v18
    v_mfma_f32_16x16x32_bf16 v[28:31], a[116:119], v[116:119], v[28:31]
    ds_read_b128 a[88:91], v1 offset:37248
    v_cvt_pk_bf16_f32 v40, v16, v17
    v_mfma_f32_16x16x32_bf16 v[28:31], a[120:123], v[120:123], v[28:31]
    v_exp_f32 v19, v19
    v_mfma_f32_16x16x32_bf16 v[28:31], a[124:127], v[124:127], v[28:31]
    ds_read_b128 a[92:95], v1 offset:37312
    v_mfma_f32_16x16x32_bf16 v[192:195], a[128:131], v[32:35], v[192:195]
    v_exp_f32 v20, v20
    v_mfma_f32_16x16x32_bf16 v[192:195], a[132:135], v[36:39], v[192:195]
    ds_read_b128 a[96:99], v1 offset:37376
    v_cvt_pk_bf16_f32 v41, v18, v19
    v_mfma_f32_16x16x32_bf16 v[196:199], a[136:139], v[32:35], v[196:199]
    v_exp_f32 v21, v21
    v_mfma_f32_16x16x32_bf16 v[196:199], a[140:143], v[36:39], v[196:199]
    ds_read_b128 a[100:103], v1 offset:37440
    v_mfma_f32_16x16x32_bf16 v[200:203], a[144:147], v[32:35], v[200:203]
    v_exp_f32 v22, v22
    v_mfma_f32_16x16x32_bf16 v[200:203], a[148:151], v[36:39], v[200:203]
    ds_read_b128 a[104:107], v1 offset:37504
    v_cvt_pk_bf16_f32 v42, v20, v21
    v_mfma_f32_16x16x32_bf16 v[204:207], a[152:155], v[32:35], v[204:207]
    v_exp_f32 v23, v23
    v_mfma_f32_16x16x32_bf16 v[204:207], a[156:159], v[36:39], v[204:207]
    ds_read_b128 a[108:111], v1 offset:37568
    v_mfma_f32_16x16x32_bf16 v[208:211], a[160:163], v[32:35], v[208:211]
    v_exp_f32 v24, v24
    v_mfma_f32_16x16x32_bf16 v[208:211], a[164:167], v[36:39], v[208:211]
    ds_read_b128 a[112:115], v1 offset:37632
    v_cvt_pk_bf16_f32 v43, v22, v23
    v_mfma_f32_16x16x32_bf16 v[212:215], a[168:171], v[32:35], v[212:215]
    v_exp_f32 v25, v25
    v_mfma_f32_16x16x32_bf16 v[212:215], a[172:175], v[36:39], v[212:215]
    ds_read_b128 a[116:119], v1 offset:37696
    v_mfma_f32_16x16x32_bf16 v[216:219], a[176:179], v[32:35], v[216:219]
    v_exp_f32 v26, v26
    v_mfma_f32_16x16x32_bf16 v[216:219], a[180:183], v[36:39], v[216:219]
    ds_read_b128 a[120:123], v1 offset:37760
    v_cvt_pk_bf16_f32 v44, v24, v25
    v_mfma_f32_16x16x32_bf16 v[220:223], a[184:187], v[32:35], v[220:223]
    v_exp_f32 v27, v27
    v_mfma_f32_16x16x32_bf16 v[220:223], a[188:191], v[36:39], v[220:223]
    ds_read_b128 a[124:127], v1 offset:37824
    v_smfmac_f32_16x16x64_bf16 a[8:11], a[16:19], v[32:39], v11
    s_waitcnt vmcnt(13) lgkmcnt(12)
    s_barrier
    v_mfma_f32_16x16x32_bf16 v[16:19], a[64:67], v[64:67], v[48:51]
    s_sub_u32 s47, s47, s48
    v_exp_f32 v28, v28
    v_mfma_f32_16x16x32_bf16 v[16:19], a[68:71], v[68:71], v[16:19]
    v_cvt_pk_bf16_f32 v45, v26, v27
    v_add_u32 v1, s48, v1
    v_mfma_f32_16x16x32_bf16 v[16:19], a[72:75], v[72:75], v[16:19]
    s_add_u32 m0, s44, 73728
    v_exp_f32 v29, v29
    v_mfma_f32_16x16x32_bf16 v[16:19], a[76:79], v[76:79], v[16:19]
    s_waitcnt lgkmcnt(8)
    s_mov_b32 s45, 0
    buffer_load_dwordx4 v7, s[28:31], s45 offen offset:0 lds
    v_mfma_f32_16x16x32_bf16 v[20:23], a[80:83], v[64:67], v[48:51]
    v_exp_f32 v30, v30
    v_mfma_f32_16x16x32_bf16 v[20:23], a[84:87], v[68:71], v[20:23]
    v_cvt_pk_bf16_f32 v46, v28, v29
    v_add_u32 v2, s48, v2
    v_mfma_f32_16x16x32_bf16 v[20:23], a[88:91], v[72:75], v[20:23]
    s_add_u32 m0, s44, 73632
    v_exp_f32 v31, v31
    v_mfma_f32_16x16x32_bf16 v[20:23], a[92:95], v[76:79], v[20:23]
    s_waitcnt lgkmcnt(4)
    buffer_load_dwordx4 v7, s[28:31], s45 offen offset:1152 lds
    v_mfma_f32_16x16x32_bf16 v[24:27], a[96:99], v[64:67], v[48:51]
    s_sub_u32 s48, 0, s48
    v_exp_f32 v16, v16
    v_mfma_f32_16x16x32_bf16 v[24:27], a[100:103], v[68:71], v[24:27]
    v_cvt_pk_bf16_f32 v47, v30, v31
    v_mfma_f32_16x16x32_bf16 v[24:27], a[104:107], v[72:75], v[24:27]
    s_add_u32 m0, s44, 73536
    v_exp_f32 v17, v17
    v_mfma_f32_16x16x32_bf16 v[24:27], a[108:111], v[76:79], v[24:27]
    s_waitcnt lgkmcnt(0)
    buffer_load_dwordx4 v7, s[28:31], s45 offen offset:2304 lds
    v_mfma_f32_16x16x32_bf16 v[28:31], a[112:115], v[64:67], v[48:51]
    v_exp_f32 v18, v18
    v_mfma_f32_16x16x32_bf16 v[28:31], a[116:119], v[68:71], v[28:31]
    v_cvt_pk_bf16_f32 v32, v16, v17
    v_mfma_f32_16x16x32_bf16 v[28:31], a[120:123], v[72:75], v[28:31]
    s_add_u32 m0, s44, 73440
    v_exp_f32 v19, v19
    v_mfma_f32_16x16x32_bf16 v[28:31], a[124:127], v[76:79], v[28:31]
    buffer_load_dwordx4 v7, s[28:31], s45 offen offset:3456 lds
    v_mfma_f32_16x16x32_bf16 v[224:227], a[128:131], v[40:43], v[224:227]
    v_exp_f32 v20, v20
    v_mfma_f32_16x16x32_bf16 v[224:227], a[132:135], v[44:47], v[224:227]
    ds_read_b64_tr_b16 a[128:129], v2 offset:0
    v_cvt_pk_bf16_f32 v33, v18, v19
    v_mfma_f32_16x16x32_bf16 v[228:231], a[136:139], v[40:43], v[228:231]
    s_add_u32 m0, s44, 90624
    v_exp_f32 v21, v21
    v_mfma_f32_16x16x32_bf16 v[228:231], a[140:143], v[44:47], v[228:231]
    s_mov_b32 s45, 147456
    buffer_load_dwordx4 v7, s[28:31], s45 offen offset:0 lds
    v_mfma_f32_16x16x32_bf16 v[232:235], a[144:147], v[40:43], v[232:235]
    v_exp_f32 v22, v22
    v_mfma_f32_16x16x32_bf16 v[232:235], a[148:151], v[44:47], v[232:235]
    ds_read_b64_tr_b16 a[130:131], v2 offset:256
    v_cvt_pk_bf16_f32 v34, v20, v21
    v_mfma_f32_16x16x32_bf16 v[236:239], a[152:155], v[40:43], v[236:239]
    s_add_u32 m0, s44, 90528
    v_exp_f32 v23, v23
    v_mfma_f32_16x16x32_bf16 v[236:239], a[156:159], v[44:47], v[236:239]
    buffer_load_dwordx4 v7, s[28:31], s45 offen offset:1152 lds
    v_mfma_f32_16x16x32_bf16 v[240:243], a[160:163], v[40:43], v[240:243]
    v_exp_f32 v24, v24
    v_mfma_f32_16x16x32_bf16 v[240:243], a[164:167], v[44:47], v[240:243]
    ds_read_b64_tr_b16 a[132:133], v2 offset:512
    v_cvt_pk_bf16_f32 v35, v22, v23
    v_mfma_f32_16x16x32_bf16 v[244:247], a[168:171], v[40:43], v[244:247]
    s_add_u32 m0, s44, 90432
    v_exp_f32 v25, v25
    v_mfma_f32_16x16x32_bf16 v[244:247], a[172:175], v[44:47], v[244:247]
    buffer_load_dwordx4 v7, s[28:31], s45 offen offset:2304 lds
    v_mfma_f32_16x16x32_bf16 v[248:251], a[176:179], v[40:43], v[248:251]
    v_exp_f32 v26, v26
    v_mfma_f32_16x16x32_bf16 v[248:251], a[180:183], v[44:47], v[248:251]
    ds_read_b64_tr_b16 a[134:135], v2 offset:768
    v_cvt_pk_bf16_f32 v36, v24, v25
    v_mfma_f32_16x16x32_bf16 v[252:255], a[184:187], v[40:43], v[252:255]
    s_add_u32 m0, s44, 90336
    v_exp_f32 v27, v27
    v_mfma_f32_16x16x32_bf16 v[252:255], a[188:191], v[44:47], v[252:255]
    buffer_load_dwordx4 v7, s[28:31], s45 offen offset:3456 lds
    v_smfmac_f32_16x16x64_bf16 a[12:15], a[16:19], v[40:47], v11
    ds_read_b64_tr_b16 a[136:137], v2 offset:32
    v_mfma_f32_16x16x32_bf16 v[16:19], a[64:67], v[80:83], v[52:55]
    v_exp_f32 v28, v28
    v_mfma_f32_16x16x32_bf16 v[16:19], a[68:71], v[84:87], v[16:19]
    ds_read_b64_tr_b16 a[138:139], v2 offset:288
    v_cvt_pk_bf16_f32 v37, v26, v27
    v_mfma_f32_16x16x32_bf16 v[16:19], a[72:75], v[88:91], v[16:19]
    v_exp_f32 v29, v29
    v_mfma_f32_16x16x32_bf16 v[16:19], a[76:79], v[92:95], v[16:19]
    ds_read_b64_tr_b16 a[140:141], v2 offset:544
    v_mfma_f32_16x16x32_bf16 v[20:23], a[80:83], v[80:83], v[52:55]
    v_exp_f32 v30, v30
    v_mfma_f32_16x16x32_bf16 v[20:23], a[84:87], v[84:87], v[20:23]
    ds_read_b64_tr_b16 a[142:143], v2 offset:800
    v_cvt_pk_bf16_f32 v38, v28, v29
    v_mfma_f32_16x16x32_bf16 v[20:23], a[88:91], v[88:91], v[20:23]
    v_exp_f32 v31, v31
    v_mfma_f32_16x16x32_bf16 v[20:23], a[92:95], v[92:95], v[20:23]
    ds_read_b64_tr_b16 a[144:145], v2 offset:64
    v_mfma_f32_16x16x32_bf16 v[24:27], a[96:99], v[80:83], v[52:55]
    v_exp_f32 v16, v16
    v_mfma_f32_16x16x32_bf16 v[24:27], a[100:103], v[84:87], v[24:27]
    ds_read_b64_tr_b16 a[146:147], v2 offset:320
    v_cvt_pk_bf16_f32 v39, v30, v31
    v_mfma_f32_16x16x32_bf16 v[24:27], a[104:107], v[88:91], v[24:27]
    v_exp_f32 v17, v17
    v_mfma_f32_16x16x32_bf16 v[24:27], a[108:111], v[92:95], v[24:27]
    ds_read_b64_tr_b16 a[148:149], v2 offset:576
    v_mfma_f32_16x16x32_bf16 v[28:31], a[112:115], v[80:83], v[52:55]
    v_exp_f32 v18, v18
    v_mfma_f32_16x16x32_bf16 v[28:31], a[116:119], v[84:87], v[28:31]
    ds_read_b64_tr_b16 a[150:151], v2 offset:832
    v_cvt_pk_bf16_f32 v40, v16, v17
    v_mfma_f32_16x16x32_bf16 v[28:31], a[120:123], v[88:91], v[28:31]
    v_exp_f32 v19, v19
    v_mfma_f32_16x16x32_bf16 v[28:31], a[124:127], v[92:95], v[28:31]
    ds_read_b64_tr_b16 a[152:153], v2 offset:96
    v_mfma_f32_16x16x32_bf16 v[128:131], a[192:195], v[32:35], v[128:131]
    v_exp_f32 v20, v20
    v_mfma_f32_16x16x32_bf16 v[128:131], a[196:199], v[36:39], v[128:131]
    ds_read_b64_tr_b16 a[154:155], v2 offset:352
    v_cvt_pk_bf16_f32 v41, v18, v19
    v_mfma_f32_16x16x32_bf16 v[132:135], a[200:203], v[32:35], v[132:135]
    v_exp_f32 v21, v21
    v_mfma_f32_16x16x32_bf16 v[132:135], a[204:207], v[36:39], v[132:135]
    ds_read_b64_tr_b16 a[156:157], v2 offset:608
    v_mfma_f32_16x16x32_bf16 v[136:139], a[208:211], v[32:35], v[136:139]
    v_exp_f32 v22, v22
    v_mfma_f32_16x16x32_bf16 v[136:139], a[212:215], v[36:39], v[136:139]
    ds_read_b64_tr_b16 a[158:159], v2 offset:864
    v_cvt_pk_bf16_f32 v42, v20, v21
    v_mfma_f32_16x16x32_bf16 v[140:143], a[216:219], v[32:35], v[140:143]
    v_exp_f32 v23, v23
    v_mfma_f32_16x16x32_bf16 v[140:143], a[220:223], v[36:39], v[140:143]
    ds_read_b64_tr_b16 a[160:161], v2 offset:128
    v_mfma_f32_16x16x32_bf16 v[144:147], a[224:227], v[32:35], v[144:147]
    v_exp_f32 v24, v24
    v_mfma_f32_16x16x32_bf16 v[144:147], a[228:231], v[36:39], v[144:147]
    ds_read_b64_tr_b16 a[162:163], v2 offset:384
    v_cvt_pk_bf16_f32 v43, v22, v23
    v_mfma_f32_16x16x32_bf16 v[148:151], a[232:235], v[32:35], v[148:151]
    v_exp_f32 v25, v25
    v_mfma_f32_16x16x32_bf16 v[148:151], a[236:239], v[36:39], v[148:151]
    ds_read_b64_tr_b16 a[164:165], v2 offset:640
    v_mfma_f32_16x16x32_bf16 v[152:155], a[240:243], v[32:35], v[152:155]
    v_exp_f32 v26, v26
    v_mfma_f32_16x16x32_bf16 v[152:155], a[244:247], v[36:39], v[152:155]
    ds_read_b64_tr_b16 a[166:167], v2 offset:896
    v_cvt_pk_bf16_f32 v44, v24, v25
    v_mfma_f32_16x16x32_bf16 v[156:159], a[248:251], v[32:35], v[156:159]
    v_exp_f32 v27, v27
    v_mfma_f32_16x16x32_bf16 v[156:159], a[252:255], v[36:39], v[156:159]
    ds_read_b64_tr_b16 a[168:169], v2 offset:160
    v_smfmac_f32_16x16x64_bf16 a[0:3], a[16:19], v[32:39], v11
    ds_read_b64_tr_b16 a[170:171], v2 offset:416
    v_mfma_f32_16x16x32_bf16 v[16:19], a[64:67], v[96:99], v[56:59]
    v_exp_f32 v28, v28
    v_mfma_f32_16x16x32_bf16 v[16:19], a[68:71], v[100:103], v[16:19]
    ds_read_b64_tr_b16 a[172:173], v2 offset:672
    v_cvt_pk_bf16_f32 v45, v26, v27
    v_mfma_f32_16x16x32_bf16 v[16:19], a[72:75], v[104:107], v[16:19]
    v_exp_f32 v29, v29
    v_mfma_f32_16x16x32_bf16 v[16:19], a[76:79], v[108:111], v[16:19]
    ds_read_b64_tr_b16 a[174:175], v2 offset:928
    v_mfma_f32_16x16x32_bf16 v[20:23], a[80:83], v[96:99], v[56:59]
    v_exp_f32 v30, v30
    v_mfma_f32_16x16x32_bf16 v[20:23], a[84:87], v[100:103], v[20:23]
    ds_read_b64_tr_b16 a[176:177], v2 offset:192
    v_cvt_pk_bf16_f32 v46, v28, v29
    v_mfma_f32_16x16x32_bf16 v[20:23], a[88:91], v[104:107], v[20:23]
    v_exp_f32 v31, v31
    v_mfma_f32_16x16x32_bf16 v[20:23], a[92:95], v[108:111], v[20:23]
    ds_read_b64_tr_b16 a[178:179], v2 offset:448
    v_mfma_f32_16x16x32_bf16 v[24:27], a[96:99], v[96:99], v[56:59]
    v_exp_f32 v16, v16
    v_mfma_f32_16x16x32_bf16 v[24:27], a[100:103], v[100:103], v[24:27]
    ds_read_b64_tr_b16 a[180:181], v2 offset:704
    v_cvt_pk_bf16_f32 v47, v30, v31
    v_mfma_f32_16x16x32_bf16 v[24:27], a[104:107], v[104:107], v[24:27]
    v_exp_f32 v17, v17
    v_mfma_f32_16x16x32_bf16 v[24:27], a[108:111], v[108:111], v[24:27]
    ds_read_b64_tr_b16 a[182:183], v2 offset:960
    v_mfma_f32_16x16x32_bf16 v[28:31], a[112:115], v[96:99], v[56:59]
    v_exp_f32 v18, v18
    v_mfma_f32_16x16x32_bf16 v[28:31], a[116:119], v[100:103], v[28:31]
    ds_read_b64_tr_b16 a[184:185], v2 offset:224
    v_cvt_pk_bf16_f32 v32, v16, v17
    v_mfma_f32_16x16x32_bf16 v[28:31], a[120:123], v[104:107], v[28:31]
    v_exp_f32 v19, v19
    v_mfma_f32_16x16x32_bf16 v[28:31], a[124:127], v[108:111], v[28:31]
    ds_read_b64_tr_b16 a[186:187], v2 offset:480
    v_mfma_f32_16x16x32_bf16 v[160:163], a[192:195], v[40:43], v[160:163]
    v_exp_f32 v20, v20
    v_mfma_f32_16x16x32_bf16 v[160:163], a[196:199], v[44:47], v[160:163]
    ds_read_b64_tr_b16 a[188:189], v2 offset:736
    v_cvt_pk_bf16_f32 v33, v18, v19
    v_mfma_f32_16x16x32_bf16 v[164:167], a[200:203], v[40:43], v[164:167]
    v_exp_f32 v21, v21
    v_mfma_f32_16x16x32_bf16 v[164:167], a[204:207], v[44:47], v[164:167]
    ds_read_b64_tr_b16 a[190:191], v2 offset:992
    v_mfma_f32_16x16x32_bf16 v[168:171], a[208:211], v[40:43], v[168:171]
    v_exp_f32 v22, v22
    v_mfma_f32_16x16x32_bf16 v[168:171], a[212:215], v[44:47], v[168:171]
    v_cvt_pk_bf16_f32 v34, v20, v21
    v_mfma_f32_16x16x32_bf16 v[172:175], a[216:219], v[40:43], v[172:175]
    v_exp_f32 v23, v23
    v_mfma_f32_16x16x32_bf16 v[172:175], a[220:223], v[44:47], v[172:175]
    v_mfma_f32_16x16x32_bf16 v[176:179], a[224:227], v[40:43], v[176:179]
    v_exp_f32 v24, v24
    v_mfma_f32_16x16x32_bf16 v[176:179], a[228:231], v[44:47], v[176:179]
    v_cvt_pk_bf16_f32 v35, v22, v23
    v_mfma_f32_16x16x32_bf16 v[180:183], a[232:235], v[40:43], v[180:183]
    v_exp_f32 v25, v25
    v_mfma_f32_16x16x32_bf16 v[180:183], a[236:239], v[44:47], v[180:183]
    v_mfma_f32_16x16x32_bf16 v[184:187], a[240:243], v[40:43], v[184:187]
    v_exp_f32 v26, v26
    v_mfma_f32_16x16x32_bf16 v[184:187], a[244:247], v[44:47], v[184:187]
    v_cvt_pk_bf16_f32 v36, v24, v25
    v_mfma_f32_16x16x32_bf16 v[188:191], a[248:251], v[40:43], v[188:191]
    v_exp_f32 v27, v27
    v_mfma_f32_16x16x32_bf16 v[188:191], a[252:255], v[44:47], v[188:191]
    v_smfmac_f32_16x16x64_bf16 a[4:7], a[16:19], v[40:47], v11
    v_mfma_f32_16x16x32_bf16 v[16:19], a[64:67], v[112:115], v[60:63]
    v_exp_f32 v28, v28
    v_mfma_f32_16x16x32_bf16 v[16:19], a[68:71], v[116:119], v[16:19]
    s_add_u32 s46, s46, 16384
    ds_read_b128 a[64:67], v1 offset:0
    v_cvt_pk_bf16_f32 v37, v26, v27
    v_mfma_f32_16x16x32_bf16 v[16:19], a[72:75], v[120:123], v[16:19]
    v_exp_f32 v29, v29
    v_mfma_f32_16x16x32_bf16 v[16:19], a[76:79], v[124:127], v[16:19]
    ds_read_b128 a[68:71], v1 offset:64
    v_mfma_f32_16x16x32_bf16 v[20:23], a[80:83], v[112:115], v[60:63]
    v_exp_f32 v30, v30
    v_mfma_f32_16x16x32_bf16 v[20:23], a[84:87], v[116:119], v[20:23]
    ds_read_b128 a[72:75], v1 offset:128
    v_cvt_pk_bf16_f32 v38, v28, v29
    v_mfma_f32_16x16x32_bf16 v[20:23], a[88:91], v[120:123], v[20:23]
    v_exp_f32 v31, v31
    v_mfma_f32_16x16x32_bf16 v[20:23], a[92:95], v[124:127], v[20:23]
    ds_read_b128 a[76:79], v1 offset:192
    v_mfma_f32_16x16x32_bf16 v[24:27], a[96:99], v[112:115], v[60:63]
    v_exp_f32 v16, v16
    v_mfma_f32_16x16x32_bf16 v[24:27], a[100:103], v[116:119], v[24:27]
    ds_read_b128 a[80:83], v1 offset:256
    v_cvt_pk_bf16_f32 v39, v30, v31
    v_mfma_f32_16x16x32_bf16 v[24:27], a[104:107], v[120:123], v[24:27]
    v_exp_f32 v17, v17
    v_mfma_f32_16x16x32_bf16 v[24:27], a[108:111], v[124:127], v[24:27]
    ds_read_b128 a[84:87], v1 offset:320
    v_mfma_f32_16x16x32_bf16 v[28:31], a[112:115], v[112:115], v[60:63]
    v_exp_f32 v18, v18
    v_mfma_f32_16x16x32_bf16 v[28:31], a[116:119], v[116:119], v[28:31]
    ds_read_b128 a[88:91], v1 offset:384
    v_cvt_pk_bf16_f32 v40, v16, v17
    v_mfma_f32_16x16x32_bf16 v[28:31], a[120:123], v[120:123], v[28:31]
    v_exp_f32 v19, v19
    v_mfma_f32_16x16x32_bf16 v[28:31], a[124:127], v[124:127], v[28:31]
    ds_read_b128 a[92:95], v1 offset:448
    v_mfma_f32_16x16x32_bf16 v[192:195], a[192:195], v[32:35], v[192:195]
    v_exp_f32 v20, v20
    v_mfma_f32_16x16x32_bf16 v[192:195], a[196:199], v[36:39], v[192:195]
    ds_read_b128 a[96:99], v1 offset:512
    v_cvt_pk_bf16_f32 v41, v18, v19
    v_mfma_f32_16x16x32_bf16 v[196:199], a[200:203], v[32:35], v[196:199]
    v_exp_f32 v21, v21
    v_mfma_f32_16x16x32_bf16 v[196:199], a[204:207], v[36:39], v[196:199]
    ds_read_b128 a[100:103], v1 offset:576
    v_mfma_f32_16x16x32_bf16 v[200:203], a[208:211], v[32:35], v[200:203]
    v_exp_f32 v22, v22
    v_mfma_f32_16x16x32_bf16 v[200:203], a[212:215], v[36:39], v[200:203]
    ds_read_b128 a[104:107], v1 offset:640
    v_cvt_pk_bf16_f32 v42, v20, v21
    v_mfma_f32_16x16x32_bf16 v[204:207], a[216:219], v[32:35], v[204:207]
    v_exp_f32 v23, v23
    v_mfma_f32_16x16x32_bf16 v[204:207], a[220:223], v[36:39], v[204:207]
    ds_read_b128 a[108:111], v1 offset:704
    v_mfma_f32_16x16x32_bf16 v[208:211], a[224:227], v[32:35], v[208:211]
    v_exp_f32 v24, v24
    v_mfma_f32_16x16x32_bf16 v[208:211], a[228:231], v[36:39], v[208:211]
    ds_read_b128 a[112:115], v1 offset:768
    v_cvt_pk_bf16_f32 v43, v22, v23
    v_mfma_f32_16x16x32_bf16 v[212:215], a[232:235], v[32:35], v[212:215]
    v_exp_f32 v25, v25
    v_mfma_f32_16x16x32_bf16 v[212:215], a[236:239], v[36:39], v[212:215]
    ds_read_b128 a[116:119], v1 offset:832
    v_mfma_f32_16x16x32_bf16 v[216:219], a[240:243], v[32:35], v[216:219]
    v_exp_f32 v26, v26
    v_mfma_f32_16x16x32_bf16 v[216:219], a[244:247], v[36:39], v[216:219]
    ds_read_b128 a[120:123], v1 offset:896
    v_cvt_pk_bf16_f32 v44, v24, v25
    v_mfma_f32_16x16x32_bf16 v[220:223], a[248:251], v[32:35], v[220:223]
    v_exp_f32 v27, v27
    v_mfma_f32_16x16x32_bf16 v[220:223], a[252:255], v[36:39], v[220:223]
    ds_read_b128 a[124:127], v1 offset:960
    v_smfmac_f32_16x16x64_bf16 a[8:11], a[16:19], v[32:39], v11
    s_waitcnt vmcnt(9) lgkmcnt(12)
    s_barrier
    v_mfma_f32_16x16x32_bf16 v[16:19], a[64:67], v[64:67], v[48:51]
    v_exp_f32 v28, v28
    v_mfma_f32_16x16x32_bf16 v[16:19], a[68:71], v[68:71], v[16:19]
    v_cvt_pk_bf16_f32 v45, v26, v27
    v_mfma_f32_16x16x32_bf16 v[16:19], a[72:75], v[72:75], v[16:19]
    s_add_u32 m0, s44, 110592
    v_exp_f32 v29, v29
    v_mfma_f32_16x16x32_bf16 v[16:19], a[76:79], v[76:79], v[16:19]
    s_waitcnt lgkmcnt(8)
    s_mov_b32 s45, 128
    buffer_load_dwordx4 v7, s[28:31], s45 offen offset:0 lds
    v_mfma_f32_16x16x32_bf16 v[20:23], a[80:83], v[64:67], v[48:51]
    v_exp_f32 v30, v30
    v_mfma_f32_16x16x32_bf16 v[20:23], a[84:87], v[68:71], v[20:23]
    v_cvt_pk_bf16_f32 v46, v28, v29
    v_mfma_f32_16x16x32_bf16 v[20:23], a[88:91], v[72:75], v[20:23]
    s_add_u32 m0, s44, 110496
    v_exp_f32 v31, v31
    v_mfma_f32_16x16x32_bf16 v[20:23], a[92:95], v[76:79], v[20:23]
    s_waitcnt lgkmcnt(4)
    buffer_load_dwordx4 v7, s[28:31], s45 offen offset:1152 lds
    v_mfma_f32_16x16x32_bf16 v[24:27], a[96:99], v[64:67], v[48:51]
    v_exp_f32 v16, v16
    v_mfma_f32_16x16x32_bf16 v[24:27], a[100:103], v[68:71], v[24:27]
    v_cvt_pk_bf16_f32 v47, v30, v31
    v_mfma_f32_16x16x32_bf16 v[24:27], a[104:107], v[72:75], v[24:27]
    s_add_u32 m0, s44, 110400
    v_exp_f32 v17, v17
    v_mfma_f32_16x16x32_bf16 v[24:27], a[108:111], v[76:79], v[24:27]
    s_waitcnt lgkmcnt(0)
    buffer_load_dwordx4 v7, s[28:31], s45 offen offset:2304 lds
    v_mfma_f32_16x16x32_bf16 v[28:31], a[112:115], v[64:67], v[48:51]
    v_exp_f32 v18, v18
    v_mfma_f32_16x16x32_bf16 v[28:31], a[116:119], v[68:71], v[28:31]
    v_cvt_pk_bf16_f32 v32, v16, v17
    v_mfma_f32_16x16x32_bf16 v[28:31], a[120:123], v[72:75], v[28:31]
    s_add_u32 m0, s44, 110304
    v_exp_f32 v19, v19
    v_mfma_f32_16x16x32_bf16 v[28:31], a[124:127], v[76:79], v[28:31]
    buffer_load_dwordx4 v7, s[28:31], s45 offen offset:3456 lds
    v_mfma_f32_16x16x32_bf16 v[224:227], a[192:195], v[40:43], v[224:227]
    v_exp_f32 v20, v20
    v_mfma_f32_16x16x32_bf16 v[224:227], a[196:199], v[44:47], v[224:227]
    ds_read_b64_tr_b16 a[192:193], v2 offset:36864
    v_cvt_pk_bf16_f32 v33, v18, v19
    v_mfma_f32_16x16x32_bf16 v[228:231], a[200:203], v[40:43], v[228:231]
    s_add_u32 m0, s44, 127488
    v_exp_f32 v21, v21
    v_mfma_f32_16x16x32_bf16 v[228:231], a[204:207], v[44:47], v[228:231]
    s_mov_b32 s45, 147584
    buffer_load_dwordx4 v7, s[28:31], s45 offen offset:0 lds
    v_mfma_f32_16x16x32_bf16 v[232:235], a[208:211], v[40:43], v[232:235]
    v_exp_f32 v22, v22
    v_mfma_f32_16x16x32_bf16 v[232:235], a[212:215], v[44:47], v[232:235]
    ds_read_b64_tr_b16 a[194:195], v2 offset:37120
    v_cvt_pk_bf16_f32 v34, v20, v21
    v_mfma_f32_16x16x32_bf16 v[236:239], a[216:219], v[40:43], v[236:239]
    s_add_u32 m0, s44, 127392
    v_exp_f32 v23, v23
    v_mfma_f32_16x16x32_bf16 v[236:239], a[220:223], v[44:47], v[236:239]
    buffer_load_dwordx4 v7, s[28:31], s45 offen offset:1152 lds
    v_mfma_f32_16x16x32_bf16 v[240:243], a[224:227], v[40:43], v[240:243]
    v_exp_f32 v24, v24
    v_mfma_f32_16x16x32_bf16 v[240:243], a[228:231], v[44:47], v[240:243]
    ds_read_b64_tr_b16 a[196:197], v2 offset:37376
    v_cvt_pk_bf16_f32 v35, v22, v23
    v_mfma_f32_16x16x32_bf16 v[244:247], a[232:235], v[40:43], v[244:247]
    s_add_u32 m0, s44, 127296
    v_exp_f32 v25, v25
    v_mfma_f32_16x16x32_bf16 v[244:247], a[236:239], v[44:47], v[244:247]
    buffer_load_dwordx4 v7, s[28:31], s45 offen offset:2304 lds
    v_mfma_f32_16x16x32_bf16 v[248:251], a[240:243], v[40:43], v[248:251]
    v_exp_f32 v26, v26
    v_mfma_f32_16x16x32_bf16 v[248:251], a[244:247], v[44:47], v[248:251]
    ds_read_b64_tr_b16 a[198:199], v2 offset:37632
    v_cvt_pk_bf16_f32 v36, v24, v25
    v_mfma_f32_16x16x32_bf16 v[252:255], a[248:251], v[40:43], v[252:255]
    s_add_u32 m0, s44, 127200
    v_exp_f32 v27, v27
    v_mfma_f32_16x16x32_bf16 v[252:255], a[252:255], v[44:47], v[252:255]
    buffer_load_dwordx4 v7, s[28:31], s45 offen offset:3456 lds
    v_smfmac_f32_16x16x64_bf16 a[12:15], a[16:19], v[40:47], v11
    ds_read_b64_tr_b16 a[200:201], v2 offset:36896
    v_mfma_f32_16x16x32_bf16 v[16:19], a[64:67], v[80:83], v[52:55]
    v_exp_f32 v28, v28
    v_mfma_f32_16x16x32_bf16 v[16:19], a[68:71], v[84:87], v[16:19]
    ds_read_b64_tr_b16 a[202:203], v2 offset:37152
    v_cvt_pk_bf16_f32 v37, v26, v27
    v_mfma_f32_16x16x32_bf16 v[16:19], a[72:75], v[88:91], v[16:19]
    v_exp_f32 v29, v29
    v_mfma_f32_16x16x32_bf16 v[16:19], a[76:79], v[92:95], v[16:19]
    ds_read_b64_tr_b16 a[204:205], v2 offset:37408
    v_mfma_f32_16x16x32_bf16 v[20:23], a[80:83], v[80:83], v[52:55]
    v_exp_f32 v30, v30
    v_mfma_f32_16x16x32_bf16 v[20:23], a[84:87], v[84:87], v[20:23]
    ds_read_b64_tr_b16 a[206:207], v2 offset:37664
    v_cvt_pk_bf16_f32 v38, v28, v29
    v_mfma_f32_16x16x32_bf16 v[20:23], a[88:91], v[88:91], v[20:23]
    v_exp_f32 v31, v31
    v_mfma_f32_16x16x32_bf16 v[20:23], a[92:95], v[92:95], v[20:23]
    ds_read_b64_tr_b16 a[208:209], v2 offset:36928
    v_mfma_f32_16x16x32_bf16 v[24:27], a[96:99], v[80:83], v[52:55]
    v_exp_f32 v16, v16
    v_mfma_f32_16x16x32_bf16 v[24:27], a[100:103], v[84:87], v[24:27]
    ds_read_b64_tr_b16 a[210:211], v2 offset:37184
    v_cvt_pk_bf16_f32 v39, v30, v31
    v_mfma_f32_16x16x32_bf16 v[24:27], a[104:107], v[88:91], v[24:27]
    v_exp_f32 v17, v17
    v_mfma_f32_16x16x32_bf16 v[24:27], a[108:111], v[92:95], v[24:27]
    ds_read_b64_tr_b16 a[212:213], v2 offset:37440
    v_mfma_f32_16x16x32_bf16 v[28:31], a[112:115], v[80:83], v[52:55]
    v_exp_f32 v18, v18
    v_mfma_f32_16x16x32_bf16 v[28:31], a[116:119], v[84:87], v[28:31]
    ds_read_b64_tr_b16 a[214:215], v2 offset:37696
    v_cvt_pk_bf16_f32 v40, v16, v17
    v_mfma_f32_16x16x32_bf16 v[28:31], a[120:123], v[88:91], v[28:31]
    v_exp_f32 v19, v19
    v_mfma_f32_16x16x32_bf16 v[28:31], a[124:127], v[92:95], v[28:31]
    ds_read_b64_tr_b16 a[216:217], v2 offset:36960
    v_mfma_f32_16x16x32_bf16 v[128:131], a[128:131], v[32:35], v[128:131]
    v_exp_f32 v20, v20
    v_mfma_f32_16x16x32_bf16 v[128:131], a[132:135], v[36:39], v[128:131]
    ds_read_b64_tr_b16 a[218:219], v2 offset:37216
    v_cvt_pk_bf16_f32 v41, v18, v19
    v_mfma_f32_16x16x32_bf16 v[132:135], a[136:139], v[32:35], v[132:135]
    v_exp_f32 v21, v21
    v_mfma_f32_16x16x32_bf16 v[132:135], a[140:143], v[36:39], v[132:135]
    ds_read_b64_tr_b16 a[220:221], v2 offset:37472
    v_mfma_f32_16x16x32_bf16 v[136:139], a[144:147], v[32:35], v[136:139]
    v_exp_f32 v22, v22
    v_mfma_f32_16x16x32_bf16 v[136:139], a[148:151], v[36:39], v[136:139]
    ds_read_b64_tr_b16 a[222:223], v2 offset:37728
    v_cvt_pk_bf16_f32 v42, v20, v21
    v_mfma_f32_16x16x32_bf16 v[140:143], a[152:155], v[32:35], v[140:143]
    v_exp_f32 v23, v23
    v_mfma_f32_16x16x32_bf16 v[140:143], a[156:159], v[36:39], v[140:143]
    ds_read_b64_tr_b16 a[224:225], v2 offset:36992
    v_mfma_f32_16x16x32_bf16 v[144:147], a[160:163], v[32:35], v[144:147]
    v_exp_f32 v24, v24
    v_mfma_f32_16x16x32_bf16 v[144:147], a[164:167], v[36:39], v[144:147]
    ds_read_b64_tr_b16 a[226:227], v2 offset:37248
    v_cvt_pk_bf16_f32 v43, v22, v23
    v_mfma_f32_16x16x32_bf16 v[148:151], a[168:171], v[32:35], v[148:151]
    v_exp_f32 v25, v25
    v_mfma_f32_16x16x32_bf16 v[148:151], a[172:175], v[36:39], v[148:151]
    ds_read_b64_tr_b16 a[228:229], v2 offset:37504
    v_mfma_f32_16x16x32_bf16 v[152:155], a[176:179], v[32:35], v[152:155]
    v_exp_f32 v26, v26
    v_mfma_f32_16x16x32_bf16 v[152:155], a[180:183], v[36:39], v[152:155]
    ds_read_b64_tr_b16 a[230:231], v2 offset:37760
    v_cvt_pk_bf16_f32 v44, v24, v25
    v_mfma_f32_16x16x32_bf16 v[156:159], a[184:187], v[32:35], v[156:159]
    v_exp_f32 v27, v27
    v_mfma_f32_16x16x32_bf16 v[156:159], a[188:191], v[36:39], v[156:159]
    ds_read_b64_tr_b16 a[232:233], v2 offset:37024
    v_smfmac_f32_16x16x64_bf16 a[0:3], a[16:19], v[32:39], v11
    ds_read_b64_tr_b16 a[234:235], v2 offset:37280
    v_mfma_f32_16x16x32_bf16 v[16:19], a[64:67], v[96:99], v[56:59]
    v_exp_f32 v28, v28
    v_mfma_f32_16x16x32_bf16 v[16:19], a[68:71], v[100:103], v[16:19]
    ds_read_b64_tr_b16 a[236:237], v2 offset:37536
    v_cvt_pk_bf16_f32 v45, v26, v27
    v_mfma_f32_16x16x32_bf16 v[16:19], a[72:75], v[104:107], v[16:19]
    v_exp_f32 v29, v29
    v_mfma_f32_16x16x32_bf16 v[16:19], a[76:79], v[108:111], v[16:19]
    ds_read_b64_tr_b16 a[238:239], v2 offset:37792
    v_mfma_f32_16x16x32_bf16 v[20:23], a[80:83], v[96:99], v[56:59]
    v_exp_f32 v30, v30
    v_mfma_f32_16x16x32_bf16 v[20:23], a[84:87], v[100:103], v[20:23]
    ds_read_b64_tr_b16 a[240:241], v2 offset:37056
    v_cvt_pk_bf16_f32 v46, v28, v29
    v_mfma_f32_16x16x32_bf16 v[20:23], a[88:91], v[104:107], v[20:23]
    v_exp_f32 v31, v31
    v_mfma_f32_16x16x32_bf16 v[20:23], a[92:95], v[108:111], v[20:23]
    ds_read_b64_tr_b16 a[242:243], v2 offset:37312
    v_mfma_f32_16x16x32_bf16 v[24:27], a[96:99], v[96:99], v[56:59]
    v_exp_f32 v16, v16
    v_mfma_f32_16x16x32_bf16 v[24:27], a[100:103], v[100:103], v[24:27]
    ds_read_b64_tr_b16 a[244:245], v2 offset:37568
    v_cvt_pk_bf16_f32 v47, v30, v31
    v_mfma_f32_16x16x32_bf16 v[24:27], a[104:107], v[104:107], v[24:27]
    v_exp_f32 v17, v17
    v_mfma_f32_16x16x32_bf16 v[24:27], a[108:111], v[108:111], v[24:27]
    ds_read_b64_tr_b16 a[246:247], v2 offset:37824
    v_mfma_f32_16x16x32_bf16 v[28:31], a[112:115], v[96:99], v[56:59]
    v_exp_f32 v18, v18
    v_mfma_f32_16x16x32_bf16 v[28:31], a[116:119], v[100:103], v[28:31]
    ds_read_b64_tr_b16 a[248:249], v2 offset:37088
    v_cvt_pk_bf16_f32 v32, v16, v17
    v_mfma_f32_16x16x32_bf16 v[28:31], a[120:123], v[104:107], v[28:31]
    v_exp_f32 v19, v19
    v_mfma_f32_16x16x32_bf16 v[28:31], a[124:127], v[108:111], v[28:31]
    ds_read_b64_tr_b16 a[250:251], v2 offset:37344
    v_mfma_f32_16x16x32_bf16 v[160:163], a[128:131], v[40:43], v[160:163]
L2_pad8:
    s_cbranch_execz L2_pad12
    v_exp_f32 v20, v20
    v_mfma_f32_16x16x32_bf16 v[160:163], a[132:135], v[44:47], v[160:163]
    ds_read_b64_tr_b16 a[252:253], v2 offset:37600
    v_cvt_pk_bf16_f32 v33, v18, v19
    v_mfma_f32_16x16x32_bf16 v[164:167], a[136:139], v[40:43], v[164:167]
    v_exp_f32 v21, v21
    v_mfma_f32_16x16x32_bf16 v[164:167], a[140:143], v[44:47], v[164:167]
    ds_read_b64_tr_b16 a[254:255], v2 offset:37856
    v_mfma_f32_16x16x32_bf16 v[168:171], a[144:147], v[40:43], v[168:171]
    v_exp_f32 v22, v22
    v_mfma_f32_16x16x32_bf16 v[168:171], a[148:151], v[44:47], v[168:171]
    v_cvt_pk_bf16_f32 v34, v20, v21
    v_mfma_f32_16x16x32_bf16 v[172:175], a[152:155], v[40:43], v[172:175]
    v_exp_f32 v23, v23
    v_mfma_f32_16x16x32_bf16 v[172:175], a[156:159], v[44:47], v[172:175]
    v_mfma_f32_16x16x32_bf16 v[176:179], a[160:163], v[40:43], v[176:179]
    v_exp_f32 v24, v24
    v_mfma_f32_16x16x32_bf16 v[176:179], a[164:167], v[44:47], v[176:179]
    v_cvt_pk_bf16_f32 v35, v22, v23
    v_mfma_f32_16x16x32_bf16 v[180:183], a[168:171], v[40:43], v[180:183]
    v_exp_f32 v25, v25
    v_mfma_f32_16x16x32_bf16 v[180:183], a[172:175], v[44:47], v[180:183]
    v_mfma_f32_16x16x32_bf16 v[184:187], a[176:179], v[40:43], v[184:187]
    v_exp_f32 v26, v26
    v_mfma_f32_16x16x32_bf16 v[184:187], a[180:183], v[44:47], v[184:187]
    v_cvt_pk_bf16_f32 v36, v24, v25
    v_mfma_f32_16x16x32_bf16 v[188:191], a[184:187], v[40:43], v[188:191]
    v_exp_f32 v27, v27
    v_mfma_f32_16x16x32_bf16 v[188:191], a[188:191], v[44:47], v[188:191]
    v_smfmac_f32_16x16x64_bf16 a[4:7], a[16:19], v[40:47], v11
    v_mfma_f32_16x16x32_bf16 v[16:19], a[64:67], v[112:115], v[60:63]
    v_exp_f32 v28, v28
    v_mfma_f32_16x16x32_bf16 v[16:19], a[68:71], v[116:119], v[16:19]
    s_add_u32 s46, s46, 16384
    ds_read_b128 a[64:67], v1 offset:36864
    v_cvt_pk_bf16_f32 v37, v26, v27
    v_mfma_f32_16x16x32_bf16 v[16:19], a[72:75], v[120:123], v[16:19]
    v_exp_f32 v29, v29
    v_mfma_f32_16x16x32_bf16 v[16:19], a[76:79], v[124:127], v[16:19]
    ds_read_b128 a[68:71], v1 offset:36928
    v_mfma_f32_16x16x32_bf16 v[20:23], a[80:83], v[112:115], v[60:63]
    v_exp_f32 v30, v30
    v_mfma_f32_16x16x32_bf16 v[20:23], a[84:87], v[116:119], v[20:23]
    ds_read_b128 a[72:75], v1 offset:36992
    v_cvt_pk_bf16_f32 v38, v28, v29
    v_mfma_f32_16x16x32_bf16 v[20:23], a[88:91], v[120:123], v[20:23]
    v_exp_f32 v31, v31
    v_mfma_f32_16x16x32_bf16 v[20:23], a[92:95], v[124:127], v[20:23]
    ds_read_b128 a[76:79], v1 offset:37056
    v_mfma_f32_16x16x32_bf16 v[24:27], a[96:99], v[112:115], v[60:63]
    v_exp_f32 v16, v16
    v_mfma_f32_16x16x32_bf16 v[24:27], a[100:103], v[116:119], v[24:27]
    ds_read_b128 a[80:83], v1 offset:37120
    v_cvt_pk_bf16_f32 v39, v30, v31
    v_mfma_f32_16x16x32_bf16 v[24:27], a[104:107], v[120:123], v[24:27]
    v_exp_f32 v17, v17
    v_mfma_f32_16x16x32_bf16 v[24:27], a[108:111], v[124:127], v[24:27]
    ds_read_b128 a[84:87], v1 offset:37184
    v_mfma_f32_16x16x32_bf16 v[28:31], a[112:115], v[112:115], v[60:63]
    v_exp_f32 v18, v18
    v_mfma_f32_16x16x32_bf16 v[28:31], a[116:119], v[116:119], v[28:31]
    ds_read_b128 a[88:91], v1 offset:37248
    v_cvt_pk_bf16_f32 v40, v16, v17
    v_mfma_f32_16x16x32_bf16 v[28:31], a[120:123], v[120:123], v[28:31]
    v_exp_f32 v19, v19
    v_mfma_f32_16x16x32_bf16 v[28:31], a[124:127], v[124:127], v[28:31]
    ds_read_b128 a[92:95], v1 offset:37312
    v_mfma_f32_16x16x32_bf16 v[192:195], a[128:131], v[32:35], v[192:195]
    v_exp_f32 v20, v20
    v_mfma_f32_16x16x32_bf16 v[192:195], a[132:135], v[36:39], v[192:195]
    ds_read_b128 a[96:99], v1 offset:37376
    v_cvt_pk_bf16_f32 v41, v18, v19
    v_mfma_f32_16x16x32_bf16 v[196:199], a[136:139], v[32:35], v[196:199]
    v_exp_f32 v21, v21
    v_mfma_f32_16x16x32_bf16 v[196:199], a[140:143], v[36:39], v[196:199]
    ds_read_b128 a[100:103], v1 offset:37440
    v_mfma_f32_16x16x32_bf16 v[200:203], a[144:147], v[32:35], v[200:203]
    v_exp_f32 v22, v22
    v_mfma_f32_16x16x32_bf16 v[200:203], a[148:151], v[36:39], v[200:203]
    ds_read_b128 a[104:107], v1 offset:37504
    v_cvt_pk_bf16_f32 v42, v20, v21
    v_mfma_f32_16x16x32_bf16 v[204:207], a[152:155], v[32:35], v[204:207]
    v_exp_f32 v23, v23
    v_mfma_f32_16x16x32_bf16 v[204:207], a[156:159], v[36:39], v[204:207]
    ds_read_b128 a[108:111], v1 offset:37568
    v_mfma_f32_16x16x32_bf16 v[208:211], a[160:163], v[32:35], v[208:211]
    v_exp_f32 v24, v24
    v_mfma_f32_16x16x32_bf16 v[208:211], a[164:167], v[36:39], v[208:211]
    ds_read_b128 a[112:115], v1 offset:37632
    v_cvt_pk_bf16_f32 v43, v22, v23
    v_mfma_f32_16x16x32_bf16 v[212:215], a[168:171], v[32:35], v[212:215]
    v_exp_f32 v25, v25
    v_mfma_f32_16x16x32_bf16 v[212:215], a[172:175], v[36:39], v[212:215]
    ds_read_b128 a[116:119], v1 offset:37696
    v_mfma_f32_16x16x32_bf16 v[216:219], a[176:179], v[32:35], v[216:219]
    v_exp_f32 v26, v26
    v_mfma_f32_16x16x32_bf16 v[216:219], a[180:183], v[36:39], v[216:219]
    ds_read_b128 a[120:123], v1 offset:37760
    v_cvt_pk_bf16_f32 v44, v24, v25
    v_mfma_f32_16x16x32_bf16 v[220:223], a[184:187], v[32:35], v[220:223]
    v_exp_f32 v27, v27
    v_mfma_f32_16x16x32_bf16 v[220:223], a[188:191], v[36:39], v[220:223]
    ds_read_b128 a[124:127], v1 offset:37824
    v_smfmac_f32_16x16x64_bf16 a[8:11], a[16:19], v[32:39], v11
    s_waitcnt vmcnt(8) lgkmcnt(12)
    s_barrier
    v_mfma_f32_16x16x32_bf16 v[16:19], a[64:67], v[64:67], v[48:51]
    v_exp_f32 v28, v28
    v_mfma_f32_16x16x32_bf16 v[16:19], a[68:71], v[68:71], v[16:19]
    v_cvt_pk_bf16_f32 v45, v26, v27
    v_mfma_f32_16x16x32_bf16 v[16:19], a[72:75], v[72:75], v[16:19]
    s_add_u32 m0, s44, 0
    v_exp_f32 v29, v29
    v_mfma_f32_16x16x32_bf16 v[16:19], a[76:79], v[76:79], v[16:19]
    s_waitcnt lgkmcnt(8)
    s_mov_b32 s45, 256
    buffer_load_dwordx4 v7, s[28:31], s45 offen offset:0 lds
    v_mfma_f32_16x16x32_bf16 v[20:23], a[80:83], v[64:67], v[48:51]
    v_exp_f32 v30, v30
    v_mfma_f32_16x16x32_bf16 v[20:23], a[84:87], v[68:71], v[20:23]
    v_cvt_pk_bf16_f32 v46, v28, v29
    v_mfma_f32_16x16x32_bf16 v[20:23], a[88:91], v[72:75], v[20:23]
    s_add_u32 m0, s44, -96
    v_exp_f32 v31, v31
    v_mfma_f32_16x16x32_bf16 v[20:23], a[92:95], v[76:79], v[20:23]
    s_waitcnt lgkmcnt(4)
    buffer_load_dwordx4 v7, s[28:31], s45 offen offset:1152 lds
    v_mfma_f32_16x16x32_bf16 v[24:27], a[96:99], v[64:67], v[48:51]
    v_exp_f32 v16, v16
    v_mfma_f32_16x16x32_bf16 v[24:27], a[100:103], v[68:71], v[24:27]
    v_cvt_pk_bf16_f32 v47, v30, v31
    v_mfma_f32_16x16x32_bf16 v[24:27], a[104:107], v[72:75], v[24:27]
    s_add_u32 m0, s44, -192
    v_exp_f32 v17, v17
    v_mfma_f32_16x16x32_bf16 v[24:27], a[108:111], v[76:79], v[24:27]
    s_waitcnt lgkmcnt(0)
    buffer_load_dwordx4 v7, s[28:31], s45 offen offset:2304 lds
    v_mfma_f32_16x16x32_bf16 v[28:31], a[112:115], v[64:67], v[48:51]
    v_exp_f32 v18, v18
    v_mfma_f32_16x16x32_bf16 v[28:31], a[116:119], v[68:71], v[28:31]
    v_cvt_pk_bf16_f32 v32, v16, v17
    v_mfma_f32_16x16x32_bf16 v[28:31], a[120:123], v[72:75], v[28:31]
    s_add_u32 m0, s44, -288
    v_exp_f32 v19, v19
    v_mfma_f32_16x16x32_bf16 v[28:31], a[124:127], v[76:79], v[28:31]
    buffer_load_dwordx4 v7, s[28:31], s45 offen offset:3456 lds
    v_mfma_f32_16x16x32_bf16 v[224:227], a[128:131], v[40:43], v[224:227]
    v_exp_f32 v20, v20
    v_mfma_f32_16x16x32_bf16 v[224:227], a[132:135], v[44:47], v[224:227]
    v_cvt_pk_bf16_f32 v33, v18, v19
    v_mfma_f32_16x16x32_bf16 v[228:231], a[136:139], v[40:43], v[228:231]
    s_add_u32 m0, s44, 16896
    v_exp_f32 v21, v21
    v_mfma_f32_16x16x32_bf16 v[228:231], a[140:143], v[44:47], v[228:231]
    s_mov_b32 s45, 147712
    buffer_load_dwordx4 v7, s[28:31], s45 offen offset:0 lds
    v_mfma_f32_16x16x32_bf16 v[232:235], a[144:147], v[40:43], v[232:235]
    v_exp_f32 v22, v22
    v_mfma_f32_16x16x32_bf16 v[232:235], a[148:151], v[44:47], v[232:235]
    v_cvt_pk_bf16_f32 v34, v20, v21
    v_mfma_f32_16x16x32_bf16 v[236:239], a[152:155], v[40:43], v[236:239]
    s_add_u32 m0, s44, 16800
    v_exp_f32 v23, v23
    v_mfma_f32_16x16x32_bf16 v[236:239], a[156:159], v[44:47], v[236:239]
    buffer_load_dwordx4 v7, s[28:31], s45 offen offset:1152 lds
    v_mfma_f32_16x16x32_bf16 v[240:243], a[160:163], v[40:43], v[240:243]
    v_exp_f32 v24, v24
    v_mfma_f32_16x16x32_bf16 v[240:243], a[164:167], v[44:47], v[240:243]
    v_cvt_pk_bf16_f32 v35, v22, v23
    v_mfma_f32_16x16x32_bf16 v[244:247], a[168:171], v[40:43], v[244:247]
    s_add_u32 m0, s44, 16704
    v_exp_f32 v25, v25
    v_mfma_f32_16x16x32_bf16 v[244:247], a[172:175], v[44:47], v[244:247]
    buffer_load_dwordx4 v7, s[28:31], s45 offen offset:2304 lds
    v_mfma_f32_16x16x32_bf16 v[248:251], a[176:179], v[40:43], v[248:251]
    v_exp_f32 v26, v26
    v_mfma_f32_16x16x32_bf16 v[248:251], a[180:183], v[44:47], v[248:251]
    v_cvt_pk_bf16_f32 v36, v24, v25
    v_mfma_f32_16x16x32_bf16 v[252:255], a[184:187], v[40:43], v[252:255]
    s_add_u32 m0, s44, 16608
    v_exp_f32 v27, v27
    v_mfma_f32_16x16x32_bf16 v[252:255], a[188:191], v[44:47], v[252:255]
    buffer_load_dwordx4 v7, s[28:31], s45 offen offset:3456 lds
    v_smfmac_f32_16x16x64_bf16 a[12:15], a[16:19], v[40:47], v11
    v_mfma_f32_16x16x32_bf16 v[16:19], a[64:67], v[80:83], v[52:55]
    v_exp_f32 v28, v28
    v_mfma_f32_16x16x32_bf16 v[16:19], a[68:71], v[84:87], v[16:19]
    v_cvt_pk_bf16_f32 v37, v26, v27
    v_mfma_f32_16x16x32_bf16 v[16:19], a[72:75], v[88:91], v[16:19]
    s_mov_b32 s54, 0
    v_exp_f32 v29, v29
    v_mfma_f32_16x16x32_bf16 v[16:19], a[76:79], v[92:95], v[16:19]
    buffer_load_dwordx4 a[128:131], v6, s[68:71], s54 offen
    v_mfma_f32_16x16x32_bf16 v[20:23], a[80:83], v[80:83], v[52:55]
    v_exp_f32 v30, v30
    v_mfma_f32_16x16x32_bf16 v[20:23], a[84:87], v[84:87], v[20:23]
    v_cvt_pk_bf16_f32 v38, v28, v29
    v_mfma_f32_16x16x32_bf16 v[20:23], a[88:91], v[88:91], v[20:23]
    s_add_u32 s54, s55, 0
    v_exp_f32 v31, v31
    v_mfma_f32_16x16x32_bf16 v[20:23], a[92:95], v[92:95], v[20:23]
    s_mov_b32 s15, 0x5d800000
    buffer_load_dwordx4 a[164:167], v8, s[72:75], s54 offen
    v_mfma_f32_16x16x32_bf16 v[24:27], a[96:99], v[80:83], v[52:55]
    v_exp_f32 v16, v16
    v_mfma_f32_16x16x32_bf16 v[24:27], a[100:103], v[84:87], v[24:27]
    v_cvt_pk_bf16_f32 v39, v30, v31
    v_mfma_f32_16x16x32_bf16 v[24:27], a[104:107], v[88:91], v[24:27]
    s_mov_b32 s54, 147456
    v_exp_f32 v17, v17
    v_mfma_f32_16x16x32_bf16 v[24:27], a[108:111], v[92:95], v[24:27]
    buffer_load_dwordx4 a[132:135], v6, s[68:71], s54 offen
    v_mfma_f32_16x16x32_bf16 v[28:31], a[112:115], v[80:83], v[52:55]
    v_exp_f32 v18, v18
    v_mfma_f32_16x16x32_bf16 v[28:31], a[116:119], v[84:87], v[28:31]
    v_cvt_pk_bf16_f32 v40, v16, v17
    v_mfma_f32_16x16x32_bf16 v[28:31], a[120:123], v[88:91], v[28:31]
    s_add_u32 s54, s55, 1024
    v_exp_f32 v19, v19
    v_mfma_f32_16x16x32_bf16 v[28:31], a[124:127], v[92:95], v[28:31]
    buffer_load_dwordx4 a[168:171], v8, s[72:75], s54 offen
    v_mfma_f32_16x16x32_bf16 v[128:131], a[192:195], v[32:35], v[128:131]
    v_exp_f32 v20, v20
    v_mfma_f32_16x16x32_bf16 v[128:131], a[196:199], v[36:39], v[128:131]
    v_cvt_pk_bf16_f32 v41, v18, v19
    v_mfma_f32_16x16x32_bf16 v[132:135], a[200:203], v[32:35], v[132:135]
    s_mov_b32 s54, 294912
    v_exp_f32 v21, v21
    v_mfma_f32_16x16x32_bf16 v[132:135], a[204:207], v[36:39], v[132:135]
    buffer_load_dwordx4 a[136:139], v6, s[68:71], s54 offen
    v_mfma_f32_16x16x32_bf16 v[136:139], a[208:211], v[32:35], v[136:139]
    v_exp_f32 v22, v22
    v_mfma_f32_16x16x32_bf16 v[136:139], a[212:215], v[36:39], v[136:139]
    v_cvt_pk_bf16_f32 v42, v20, v21
    v_mfma_f32_16x16x32_bf16 v[140:143], a[216:219], v[32:35], v[140:143]
    s_add_u32 s54, s55, 2048
    v_exp_f32 v23, v23
    v_mfma_f32_16x16x32_bf16 v[140:143], a[220:223], v[36:39], v[140:143]
    buffer_load_dwordx4 a[172:175], v8, s[72:75], s54 offen
    v_mfma_f32_16x16x32_bf16 v[144:147], a[224:227], v[32:35], v[144:147]
    v_exp_f32 v24, v24
    v_mfma_f32_16x16x32_bf16 v[144:147], a[228:231], v[36:39], v[144:147]
    v_cvt_pk_bf16_f32 v43, v22, v23
    v_mfma_f32_16x16x32_bf16 v[148:151], a[232:235], v[32:35], v[148:151]
    s_mov_b32 s54, 442368
    v_exp_f32 v25, v25
    v_mfma_f32_16x16x32_bf16 v[148:151], a[236:239], v[36:39], v[148:151]
    buffer_load_dwordx4 a[140:143], v6, s[68:71], s54 offen
    v_mfma_f32_16x16x32_bf16 v[152:155], a[240:243], v[32:35], v[152:155]
    v_exp_f32 v26, v26
    v_mfma_f32_16x16x32_bf16 v[152:155], a[244:247], v[36:39], v[152:155]
    v_cvt_pk_bf16_f32 v44, v24, v25
    v_mfma_f32_16x16x32_bf16 v[156:159], a[248:251], v[32:35], v[156:159]
    s_add_u32 s54, s55, 3072
    v_exp_f32 v27, v27
    v_mfma_f32_16x16x32_bf16 v[156:159], a[252:255], v[36:39], v[156:159]
    buffer_load_dwordx4 a[176:179], v8, s[72:75], s54 offen
    v_smfmac_f32_16x16x64_bf16 a[0:3], a[16:19], v[32:39], v11
    v_mfma_f32_16x16x32_bf16 v[16:19], a[64:67], v[96:99], v[56:59]
    v_exp_f32 v28, v28
    v_mfma_f32_16x16x32_bf16 v[16:19], a[68:71], v[100:103], v[16:19]
    v_cvt_pk_bf16_f32 v45, v26, v27
    v_mfma_f32_16x16x32_bf16 v[16:19], a[72:75], v[104:107], v[16:19]
    s_mov_b32 s54, 589824
    v_exp_f32 v29, v29
    v_mfma_f32_16x16x32_bf16 v[16:19], a[76:79], v[108:111], v[16:19]
    buffer_load_dwordx4 a[144:147], v6, s[68:71], s54 offen
    v_mfma_f32_16x16x32_bf16 v[20:23], a[80:83], v[96:99], v[56:59]
    v_exp_f32 v30, v30
    v_mfma_f32_16x16x32_bf16 v[20:23], a[84:87], v[100:103], v[20:23]
    v_cvt_pk_bf16_f32 v46, v28, v29
    v_accvgpr_read_b32 v12, a0
    v_mfma_f32_16x16x32_bf16 v[20:23], a[88:91], v[104:107], v[20:23]
    s_add_u32 s54, s55, 4096
    v_exp_f32 v31, v31
    v_mfma_f32_16x16x32_bf16 v[20:23], a[92:95], v[108:111], v[20:23]
    buffer_load_dwordx4 a[180:183], v8, s[72:75], s54 offen
    v_mfma_f32_16x16x32_bf16 v[24:27], a[96:99], v[96:99], v[56:59]
    v_exp_f32 v16, v16
    v_mfma_f32_16x16x32_bf16 v[24:27], a[100:103], v[100:103], v[24:27]
    v_cvt_pk_bf16_f32 v47, v30, v31
    v_accvgpr_read_b32 v13, a1
    v_mfma_f32_16x16x32_bf16 v[24:27], a[104:107], v[104:107], v[24:27]
    s_mov_b32 s54, 737280
    v_exp_f32 v17, v17
    v_mfma_f32_16x16x32_bf16 v[24:27], a[108:111], v[108:111], v[24:27]
    buffer_load_dwordx4 a[148:151], v6, s[68:71], s54 offen
    v_mfma_f32_16x16x32_bf16 v[28:31], a[112:115], v[96:99], v[56:59]
    v_exp_f32 v18, v18
    v_mfma_f32_16x16x32_bf16 v[28:31], a[116:119], v[100:103], v[28:31]
    v_cvt_pk_bf16_f32 v32, v16, v17
    v_add_f32 v12, v12, v13
    v_mfma_f32_16x16x32_bf16 v[28:31], a[120:123], v[104:107], v[28:31]
    s_add_u32 s54, s55, 5120
    v_exp_f32 v19, v19
    v_mfma_f32_16x16x32_bf16 v[28:31], a[124:127], v[108:111], v[28:31]
    buffer_load_dwordx4 a[184:187], v8, s[72:75], s54 offen
    v_mfma_f32_16x16x32_bf16 v[160:163], a[192:195], v[40:43], v[160:163]
    v_exp_f32 v20, v20
    v_mfma_f32_16x16x32_bf16 v[160:163], a[196:199], v[44:47], v[160:163]
    v_cvt_pk_bf16_f32 v33, v18, v19
    v_cmp_nlt_f32 s[56:57], v12, s15
    v_mfma_f32_16x16x32_bf16 v[164:167], a[200:203], v[40:43], v[164:167]
    s_mov_b32 s54, 884736
    v_exp_f32 v21, v21
    v_mfma_f32_16x16x32_bf16 v[164:167], a[204:207], v[44:47], v[164:167]
    buffer_load_dwordx4 a[152:155], v6, s[68:71], s54 offen
    v_mfma_f32_16x16x32_bf16 v[168:171], a[208:211], v[40:43], v[168:171]
    v_exp_f32 v22, v22
    v_mfma_f32_16x16x32_bf16 v[168:171], a[212:215], v[44:47], v[168:171]
    v_cvt_pk_bf16_f32 v34, v20, v21
    v_mfma_f32_16x16x32_bf16 v[172:175], a[216:219], v[40:43], v[172:175]
    s_add_u32 s54, s55, 6144
    v_exp_f32 v23, v23
    v_mfma_f32_16x16x32_bf16 v[172:175], a[220:223], v[44:47], v[172:175]
    buffer_load_dwordx4 a[188:191], v8, s[72:75], s54 offen
    v_mfma_f32_16x16x32_bf16 v[176:179], a[224:227], v[40:43], v[176:179]
    v_exp_f32 v24, v24
    v_mfma_f32_16x16x32_bf16 v[176:179], a[228:231], v[44:47], v[176:179]
    v_cvt_pk_bf16_f32 v35, v22, v23
    v_mfma_f32_16x16x32_bf16 v[180:183], a[232:235], v[40:43], v[180:183]
    s_mov_b32 s54, 1032192
    v_exp_f32 v25, v25
    v_mfma_f32_16x16x32_bf16 v[180:183], a[236:239], v[44:47], v[180:183]
    buffer_load_dwordx4 a[156:159], v6, s[68:71], s54 offen
    v_mfma_f32_16x16x32_bf16 v[184:187], a[240:243], v[40:43], v[184:187]
    v_exp_f32 v26, v26
    v_mfma_f32_16x16x32_bf16 v[184:187], a[244:247], v[44:47], v[184:187]
    v_cvt_pk_bf16_f32 v36, v24, v25
    v_mfma_f32_16x16x32_bf16 v[188:191], a[248:251], v[40:43], v[188:191]
    s_mov_b32 s54, 1179648
    v_exp_f32 v27, v27
    v_mfma_f32_16x16x32_bf16 v[188:191], a[252:255], v[44:47], v[188:191]
    buffer_load_dwordx4 a[160:163], v6, s[68:71], s54 offen
    v_smfmac_f32_16x16x64_bf16 a[4:7], a[16:19], v[40:47], v11
    v_rcp_f32 v12, v12
    v_mfma_f32_16x16x32_bf16 v[16:19], a[64:67], v[112:115], v[60:63]
    v_exp_f32 v28, v28
    v_mfma_f32_16x16x32_bf16 v[16:19], a[68:71], v[116:119], v[16:19]
    v_cvt_pk_bf16_f32 v37, v26, v27
    v_mul_f32 v128, v128, v12
    v_mfma_f32_16x16x32_bf16 v[16:19], a[72:75], v[120:123], v[16:19]
    v_exp_f32 v29, v29
    v_mfma_f32_16x16x32_bf16 v[16:19], a[76:79], v[124:127], v[16:19]
    v_mul_f32 v129, v129, v12
    v_mul_f32 v130, v130, v12
    v_mfma_f32_16x16x32_bf16 v[20:23], a[80:83], v[112:115], v[60:63]
    v_exp_f32 v30, v30
    v_mfma_f32_16x16x32_bf16 v[20:23], a[84:87], v[116:119], v[20:23]
    v_cvt_pk_bf16_f32 v38, v28, v29
    v_mul_f32 v131, v131, v12
    v_mfma_f32_16x16x32_bf16 v[20:23], a[88:91], v[120:123], v[20:23]
    v_exp_f32 v31, v31
    v_mfma_f32_16x16x32_bf16 v[20:23], a[92:95], v[124:127], v[20:23]
    v_mul_f32 v132, v132, v12
    v_mul_f32 v133, v133, v12
    v_mfma_f32_16x16x32_bf16 v[24:27], a[96:99], v[112:115], v[60:63]
    v_exp_f32 v16, v16
    v_mfma_f32_16x16x32_bf16 v[24:27], a[100:103], v[116:119], v[24:27]
    v_cvt_pk_bf16_f32 v39, v30, v31
    v_mul_f32 v134, v134, v12
    v_mfma_f32_16x16x32_bf16 v[24:27], a[104:107], v[120:123], v[24:27]
    v_exp_f32 v17, v17
    v_mfma_f32_16x16x32_bf16 v[24:27], a[108:111], v[124:127], v[24:27]
    v_mul_f32 v135, v135, v12
    v_cvt_pk_bf16_f32 v128, v128, v129
    v_mfma_f32_16x16x32_bf16 v[28:31], a[112:115], v[112:115], v[60:63]
    v_exp_f32 v18, v18
    v_mfma_f32_16x16x32_bf16 v[28:31], a[116:119], v[116:119], v[28:31]
    v_cvt_pk_bf16_f32 v40, v16, v17
    v_cvt_pk_bf16_f32 v129, v130, v131
    v_mfma_f32_16x16x32_bf16 v[28:31], a[120:123], v[120:123], v[28:31]
    v_exp_f32 v19, v19
    v_mfma_f32_16x16x32_bf16 v[28:31], a[124:127], v[124:127], v[28:31]
    v_cvt_pk_bf16_f32 v130, v132, v133
    v_cvt_pk_bf16_f32 v131, v134, v135
    v_mfma_f32_16x16x32_bf16 v[192:195], a[192:195], v[32:35], v[192:195]
    v_exp_f32 v20, v20
    v_mfma_f32_16x16x32_bf16 v[192:195], a[196:199], v[36:39], v[192:195]
    v_cvt_pk_bf16_f32 v41, v18, v19
    v_mul_f32 v136, v136, v12
    v_mfma_f32_16x16x32_bf16 v[196:199], a[200:203], v[32:35], v[196:199]
    v_exp_f32 v21, v21
    v_mfma_f32_16x16x32_bf16 v[196:199], a[204:207], v[36:39], v[196:199]
    v_mul_f32 v137, v137, v12
    v_mul_f32 v138, v138, v12
    v_mfma_f32_16x16x32_bf16 v[200:203], a[208:211], v[32:35], v[200:203]
    v_exp_f32 v22, v22
    v_mfma_f32_16x16x32_bf16 v[200:203], a[212:215], v[36:39], v[200:203]
    v_cvt_pk_bf16_f32 v42, v20, v21
    v_mul_f32 v139, v139, v12
    v_mfma_f32_16x16x32_bf16 v[204:207], a[216:219], v[32:35], v[204:207]
    v_exp_f32 v23, v23
    v_mfma_f32_16x16x32_bf16 v[204:207], a[220:223], v[36:39], v[204:207]
    v_mul_f32 v140, v140, v12
    v_mul_f32 v141, v141, v12
    v_mfma_f32_16x16x32_bf16 v[208:211], a[224:227], v[32:35], v[208:211]
    v_exp_f32 v24, v24
    v_mfma_f32_16x16x32_bf16 v[208:211], a[228:231], v[36:39], v[208:211]
    v_cvt_pk_bf16_f32 v43, v22, v23
    v_mul_f32 v142, v142, v12
    v_mfma_f32_16x16x32_bf16 v[212:215], a[232:235], v[32:35], v[212:215]
    v_exp_f32 v25, v25
    v_mfma_f32_16x16x32_bf16 v[212:215], a[236:239], v[36:39], v[212:215]
    v_mul_f32 v143, v143, v12
    v_cvt_pk_bf16_f32 v136, v136, v137
    v_mfma_f32_16x16x32_bf16 v[216:219], a[240:243], v[32:35], v[216:219]
    v_exp_f32 v26, v26
    v_mfma_f32_16x16x32_bf16 v[216:219], a[244:247], v[36:39], v[216:219]
    v_cvt_pk_bf16_f32 v44, v24, v25
    v_cvt_pk_bf16_f32 v137, v138, v139
    v_mfma_f32_16x16x32_bf16 v[220:223], a[248:251], v[32:35], v[220:223]
    v_exp_f32 v27, v27
    v_mfma_f32_16x16x32_bf16 v[220:223], a[252:255], v[36:39], v[220:223]
    v_cvt_pk_bf16_f32 v138, v140, v141
    v_cvt_pk_bf16_f32 v139, v142, v143
    v_smfmac_f32_16x16x64_bf16 a[8:11], a[16:19], v[32:39], v11
    v_mul_f32 v144, v144, v12
    v_mul_f32 v145, v145, v12
    v_exp_f32 v28, v28
    s_nop 0
    v_cvt_pk_bf16_f32 v45, v26, v27
    v_exp_f32 v29, v29
    s_nop 0
    v_exp_f32 v30, v30
    s_nop 0
    v_cvt_pk_bf16_f32 v46, v28, v29
    v_exp_f32 v31, v31
    s_nop 0
    v_cvt_pk_bf16_f32 v47, v30, v31
    s_nop 1
    v_mfma_f32_16x16x32_bf16 v[224:227], a[192:195], v[40:43], v[224:227]
    v_mul_f32 v146, v146, v12
    v_mul_f32 v147, v147, v12
    v_mfma_f32_16x16x32_bf16 v[224:227], a[196:199], v[44:47], v[224:227]
    ds_read_b64_tr_b16 a[64:65], v4 offset:0
    ds_read_b64_tr_b16 a[66:67], v4 offset:128
    v_mfma_f32_16x16x32_bf16 v[228:231], a[200:203], v[40:43], v[228:231]
    ds_read_b64_tr_b16 a[68:69], v4 offset:256
    ds_read_b64_tr_b16 a[70:71], v4 offset:384
    v_mfma_f32_16x16x32_bf16 v[228:231], a[204:207], v[44:47], v[228:231]
    ds_read_b64_tr_b16 a[72:73], v4 offset:512
    ds_read_b64_tr_b16 a[74:75], v4 offset:640
    v_mfma_f32_16x16x32_bf16 v[232:235], a[208:211], v[40:43], v[232:235]
    ds_read_b64_tr_b16 a[76:77], v4 offset:768
    ds_read_b64_tr_b16 a[78:79], v4 offset:896
    v_mfma_f32_16x16x32_bf16 v[232:235], a[212:215], v[44:47], v[232:235]
    ds_read_b64_tr_b16 a[80:81], v4 offset:16896
    ds_read_b64_tr_b16 a[82:83], v4 offset:17024
    v_mfma_f32_16x16x32_bf16 v[236:239], a[216:219], v[40:43], v[236:239]
    ds_read_b64_tr_b16 a[84:85], v4 offset:17152
    ds_read_b64_tr_b16 a[86:87], v4 offset:17280
    v_mfma_f32_16x16x32_bf16 v[236:239], a[220:223], v[44:47], v[236:239]
    ds_read_b64_tr_b16 a[88:89], v4 offset:17408
    ds_read_b64_tr_b16 a[90:91], v4 offset:17536
    v_mfma_f32_16x16x32_bf16 v[240:243], a[224:227], v[40:43], v[240:243]
    ds_read_b64_tr_b16 a[92:93], v4 offset:17664
    ds_read_b64_tr_b16 a[94:95], v4 offset:17792
    v_mfma_f32_16x16x32_bf16 v[240:243], a[228:231], v[44:47], v[240:243]
    v_mul_f32 v148, v148, v12
    v_mul_f32 v149, v149, v12
    v_mfma_f32_16x16x32_bf16 v[244:247], a[232:235], v[40:43], v[244:247]
    v_mul_f32 v150, v150, v12
    v_mul_f32 v151, v151, v12
    v_mfma_f32_16x16x32_bf16 v[244:247], a[236:239], v[44:47], v[244:247]
    v_cvt_pk_bf16_f32 v144, v144, v145
    v_cvt_pk_bf16_f32 v145, v146, v147
    v_mfma_f32_16x16x32_bf16 v[248:251], a[240:243], v[40:43], v[248:251]
    v_cvt_pk_bf16_f32 v146, v148, v149
    v_cvt_pk_bf16_f32 v147, v150, v151
    v_mfma_f32_16x16x32_bf16 v[248:251], a[244:247], v[44:47], v[248:251]
    v_mul_f32 v152, v152, v12
    v_mul_f32 v153, v153, v12
    v_mfma_f32_16x16x32_bf16 v[252:255], a[248:251], v[40:43], v[252:255]
    v_mul_f32 v154, v154, v12
    v_mul_f32 v155, v155, v12
    v_mfma_f32_16x16x32_bf16 v[252:255], a[252:255], v[44:47], v[252:255]
    v_mul_f32 v156, v156, v12
    v_mul_f32 v157, v157, v12
    v_smfmac_f32_16x16x64_bf16 a[12:15], a[16:19], v[40:47], v11
    v_mul_f32 v158, v158, v12
    v_mul_f32 v159, v159, v12
    v_cvt_pk_bf16_f32 v152, v152, v153
    v_cvt_pk_bf16_f32 v153, v154, v155
    v_cvt_pk_bf16_f32 v154, v156, v157
    v_cvt_pk_bf16_f32 v155, v158, v159
    v_accvgpr_read_b32 v14, a4
    v_accvgpr_read_b32 v15, a5
    v_add_f32 v14, v14, v15
    v_cmp_nlt_f32 s[58:59], v14, s15
    v_rcp_f32 v14, v14
    v_accvgpr_read_b32 v12, a8
    v_accvgpr_read_b32 v13, a9
    v_add_f32 v12, v12, v13
    v_cmp_nlt_f32 s[60:61], v12, s15
    v_rcp_f32 v12, v12
    v_pk_mul_f32 v[160:161], v[160:161], v[14:15] op_sel_hi:[1,0]
    v_pk_mul_f32 v[162:163], v[162:163], v[14:15] op_sel_hi:[1,0]
    v_pk_mul_f32 v[164:165], v[164:165], v[14:15] op_sel_hi:[1,0]
    v_pk_mul_f32 v[166:167], v[166:167], v[14:15] op_sel_hi:[1,0]
    v_cvt_pk_bf16_f32 v160, v160, v161
    v_cvt_pk_bf16_f32 v161, v162, v163
    v_cvt_pk_bf16_f32 v162, v164, v165
    v_cvt_pk_bf16_f32 v163, v166, v167
    v_pk_mul_f32 v[168:169], v[168:169], v[14:15] op_sel_hi:[1,0]
    v_pk_mul_f32 v[170:171], v[170:171], v[14:15] op_sel_hi:[1,0]
    v_pk_mul_f32 v[172:173], v[172:173], v[14:15] op_sel_hi:[1,0]
    v_pk_mul_f32 v[174:175], v[174:175], v[14:15] op_sel_hi:[1,0]
    v_cvt_pk_bf16_f32 v168, v168, v169
    v_cvt_pk_bf16_f32 v169, v170, v171
    v_cvt_pk_bf16_f32 v170, v172, v173
    v_cvt_pk_bf16_f32 v171, v174, v175
    v_pk_mul_f32 v[176:177], v[176:177], v[14:15] op_sel_hi:[1,0]
    v_pk_mul_f32 v[178:179], v[178:179], v[14:15] op_sel_hi:[1,0]
    v_pk_mul_f32 v[180:181], v[180:181], v[14:15] op_sel_hi:[1,0]
    v_pk_mul_f32 v[182:183], v[182:183], v[14:15] op_sel_hi:[1,0]
    v_cvt_pk_bf16_f32 v176, v176, v177
    v_cvt_pk_bf16_f32 v177, v178, v179
    v_cvt_pk_bf16_f32 v178, v180, v181
    v_cvt_pk_bf16_f32 v179, v182, v183
    v_pk_mul_f32 v[184:185], v[184:185], v[14:15] op_sel_hi:[1,0]
    v_pk_mul_f32 v[186:187], v[186:187], v[14:15] op_sel_hi:[1,0]
    v_pk_mul_f32 v[188:189], v[188:189], v[14:15] op_sel_hi:[1,0]
    v_pk_mul_f32 v[190:191], v[190:191], v[14:15] op_sel_hi:[1,0]
    v_cvt_pk_bf16_f32 v184, v184, v185
    v_cvt_pk_bf16_f32 v185, v186, v187
    v_cvt_pk_bf16_f32 v186, v188, v189
    v_cvt_pk_bf16_f32 v187, v190, v191
    v_accvgpr_read_b32 v14, a12
    v_accvgpr_read_b32 v15, a13
    v_add_f32 v14, v14, v15
    v_cmp_nlt_f32 s[62:63], v14, s15
    s_or_b64 s[56:57], s[56:57], s[58:59]
    v_rcp_f32 v14, v14
    s_or_b64 s[60:61], s[60:61], s[62:63]
    s_or_b64 s[56:57], s[56:57], s[60:61]
    s_cselect_b32 s3, 1, 0
    s_andn2_b32 s3, s3, s50
    s_lshl2_add_u32 s14, s51, 13824
    v_mov_b32 v56, s3
    v_mov_b32 v57, s14
    v_mov_b32 v58, 13824
    ds_write_b32 v57, v56
    v_pk_mul_f32 v[192:193], v[192:193], v[12:13] op_sel_hi:[1,0]
    v_pk_mul_f32 v[194:195], v[194:195], v[12:13] op_sel_hi:[1,0]
    v_pk_mul_f32 v[196:197], v[196:197], v[12:13] op_sel_hi:[1,0]
    v_pk_mul_f32 v[198:199], v[198:199], v[12:13] op_sel_hi:[1,0]
    v_cvt_pk_bf16_f32 v192, v192, v193
    v_cvt_pk_bf16_f32 v193, v194, v195
    v_cvt_pk_bf16_f32 v194, v196, v197
    v_cvt_pk_bf16_f32 v195, v198, v199
    v_pk_mul_f32 v[200:201], v[200:201], v[12:13] op_sel_hi:[1,0]
    v_pk_mul_f32 v[202:203], v[202:203], v[12:13] op_sel_hi:[1,0]
    v_pk_mul_f32 v[204:205], v[204:205], v[12:13] op_sel_hi:[1,0]
    v_pk_mul_f32 v[206:207], v[206:207], v[12:13] op_sel_hi:[1,0]
    v_cvt_pk_bf16_f32 v200, v200, v201
    v_cvt_pk_bf16_f32 v201, v202, v203
    v_cvt_pk_bf16_f32 v202, v204, v205
    v_cvt_pk_bf16_f32 v203, v206, v207
    v_pk_mul_f32 v[208:209], v[208:209], v[12:13] op_sel_hi:[1,0]
    v_pk_mul_f32 v[210:211], v[210:211], v[12:13] op_sel_hi:[1,0]
    v_pk_mul_f32 v[212:213], v[212:213], v[12:13] op_sel_hi:[1,0]
    v_pk_mul_f32 v[214:215], v[214:215], v[12:13] op_sel_hi:[1,0]
    v_cvt_pk_bf16_f32 v208, v208, v209
    v_cvt_pk_bf16_f32 v209, v210, v211
    v_cvt_pk_bf16_f32 v210, v212, v213
    v_cvt_pk_bf16_f32 v211, v214, v215
    v_pk_mul_f32 v[216:217], v[216:217], v[12:13] op_sel_hi:[1,0]
    v_pk_mul_f32 v[218:219], v[218:219], v[12:13] op_sel_hi:[1,0]
    v_pk_mul_f32 v[220:221], v[220:221], v[12:13] op_sel_hi:[1,0]
    v_pk_mul_f32 v[222:223], v[222:223], v[12:13] op_sel_hi:[1,0]
    v_cvt_pk_bf16_f32 v216, v216, v217
    v_cvt_pk_bf16_f32 v217, v218, v219
    v_cvt_pk_bf16_f32 v218, v220, v221
    v_cvt_pk_bf16_f32 v219, v222, v223
    v_pk_mul_f32 v[224:225], v[224:225], v[14:15] op_sel_hi:[1,0]
    v_pk_mul_f32 v[226:227], v[226:227], v[14:15] op_sel_hi:[1,0]
    v_pk_mul_f32 v[228:229], v[228:229], v[14:15] op_sel_hi:[1,0]
    v_pk_mul_f32 v[230:231], v[230:231], v[14:15] op_sel_hi:[1,0]
    v_cvt_pk_bf16_f32 v224, v224, v225
    v_cvt_pk_bf16_f32 v225, v226, v227
    v_cvt_pk_bf16_f32 v226, v228, v229
    v_cvt_pk_bf16_f32 v227, v230, v231
    v_pk_mul_f32 v[232:233], v[232:233], v[14:15] op_sel_hi:[1,0]
    v_pk_mul_f32 v[234:235], v[234:235], v[14:15] op_sel_hi:[1,0]
    v_pk_mul_f32 v[236:237], v[236:237], v[14:15] op_sel_hi:[1,0]
    v_pk_mul_f32 v[238:239], v[238:239], v[14:15] op_sel_hi:[1,0]
    v_cvt_pk_bf16_f32 v232, v232, v233
    v_cvt_pk_bf16_f32 v233, v234, v235
    v_cvt_pk_bf16_f32 v234, v236, v237
    v_cvt_pk_bf16_f32 v235, v238, v239
    v_pk_mul_f32 v[240:241], v[240:241], v[14:15] op_sel_hi:[1,0]
    v_pk_mul_f32 v[242:243], v[242:243], v[14:15] op_sel_hi:[1,0]
    v_pk_mul_f32 v[244:245], v[244:245], v[14:15] op_sel_hi:[1,0]
L2_pad9:
    s_cbranch_execz L2_pad13
    v_pk_mul_f32 v[246:247], v[246:247], v[14:15] op_sel_hi:[1,0]
    v_cvt_pk_bf16_f32 v240, v240, v241
    v_cvt_pk_bf16_f32 v241, v242, v243
    v_cvt_pk_bf16_f32 v242, v244, v245
    v_cvt_pk_bf16_f32 v243, v246, v247
    v_pk_mul_f32 v[248:249], v[248:249], v[14:15] op_sel_hi:[1,0]
    v_pk_mul_f32 v[250:251], v[250:251], v[14:15] op_sel_hi:[1,0]
    v_pk_mul_f32 v[252:253], v[252:253], v[14:15] op_sel_hi:[1,0]
    v_pk_mul_f32 v[254:255], v[254:255], v[14:15] op_sel_hi:[1,0]
    v_cvt_pk_bf16_f32 v248, v248, v249
    v_cvt_pk_bf16_f32 v249, v250, v251
    v_cvt_pk_bf16_f32 v250, v252, v253
    v_cvt_pk_bf16_f32 v251, v254, v255
    s_waitcnt lgkmcnt(13)
    v_mfma_f32_16x16x32_bf16 v[16:19], a[64:67], v[128:131], 0
    ds_read_b64_tr_b16 a[96:97], v4 offset:32
    ds_read_b64_tr_b16 a[98:99], v4 offset:160
    v_mfma_f32_16x16x32_bf16 v[16:19], a[68:71], v[136:139], v[16:19]
    s_waitcnt lgkmcnt(11)
    ds_read_b64_tr_b16 a[100:101], v4 offset:288
    ds_read_b64_tr_b16 a[102:103], v4 offset:416
    v_mfma_f32_16x16x32_bf16 v[16:19], a[72:75], v[144:147], v[16:19]
    s_add_u32 s54, s55, 7168
    ds_read_b64_tr_b16 a[104:105], v4 offset:544
    v_mfma_f32_16x16x32_bf16 v[16:19], a[76:79], v[152:155], v[16:19]
    s_waitcnt lgkmcnt(10)
    buffer_load_dwordx4 a[192:195], v8, s[72:75], s54 offen
    v_mfma_f32_16x16x32_bf16 v[16:19], a[80:83], v[192:195], v[16:19]
    ds_read_b64_tr_b16 a[106:107], v4 offset:672
    v_mfma_f32_16x16x32_bf16 v[16:19], a[84:87], v[200:203], v[16:19]
    s_waitcnt lgkmcnt(7)
    ds_read_b64_tr_b16 a[108:109], v4 offset:800
    v_mfma_f32_16x16x32_bf16 v[16:19], a[88:91], v[208:211], v[16:19]
    s_add_u32 s54, s55, 8192
    ds_read_b64_tr_b16 a[110:111], v4 offset:928
    v_mfma_f32_16x16x32_bf16 v[16:19], a[92:95], v[216:219], v[16:19]
    buffer_load_dwordx4 a[196:199], v8, s[72:75], s54 offen
    v_mfma_f32_16x16x32_bf16 v[20:23], a[64:67], v[160:163], 0
    ds_read_b64_tr_b16 a[112:113], v4 offset:16928
    v_mfma_f32_16x16x32_bf16 v[20:23], a[68:71], v[168:171], v[20:23]
    ds_read_b64_tr_b16 a[114:115], v4 offset:17056
    v_mfma_f32_16x16x32_bf16 v[20:23], a[72:75], v[176:179], v[20:23]
    ds_read_b64_tr_b16 a[116:117], v4 offset:17184
    v_mfma_f32_16x16x32_bf16 v[20:23], a[76:79], v[184:187], v[20:23]
    ds_read_b64_tr_b16 a[118:119], v4 offset:17312
    v_mfma_f32_16x16x32_bf16 v[20:23], a[80:83], v[224:227], v[20:23]
    ds_read_b64_tr_b16 a[120:121], v4 offset:17440
    v_mfma_f32_16x16x32_bf16 v[20:23], a[84:87], v[232:235], v[20:23]
    ds_read_b64_tr_b16 a[122:123], v4 offset:17568
    v_mfma_f32_16x16x32_bf16 v[20:23], a[88:91], v[240:243], v[20:23]
    ds_read_b64_tr_b16 a[124:125], v4 offset:17696
    v_mfma_f32_16x16x32_bf16 v[20:23], a[92:95], v[248:251], v[20:23]
    s_waitcnt lgkmcnt(11)
    ds_read_b64_tr_b16 a[126:127], v4 offset:17824
    v_mfma_f32_16x16x32_bf16 v[24:27], a[96:99], v[128:131], 0
    ds_read_b64_tr_b16 a[64:65], v4 offset:64
    v_mfma_f32_16x16x32_bf16 v[24:27], a[100:103], v[136:139], v[24:27]
    s_waitcnt lgkmcnt(9)
    ds_read_b64_tr_b16 a[66:67], v4 offset:192
    v_mfma_f32_16x16x32_bf16 v[24:27], a[104:107], v[144:147], v[24:27]
    ds_read_b64_tr_b16 a[68:69], v4 offset:320
    v_mfma_f32_16x16x32_bf16 v[24:27], a[108:111], v[152:155], v[24:27]
    s_waitcnt lgkmcnt(7)
    ds_read_b64_tr_b16 a[70:71], v4 offset:448
    v_mfma_f32_16x16x32_bf16 v[24:27], a[112:115], v[192:195], v[24:27]
    ds_read_b64_tr_b16 a[72:73], v4 offset:576
    v_mfma_f32_16x16x32_bf16 v[24:27], a[116:119], v[200:203], v[24:27]
    s_waitcnt lgkmcnt(5)
    ds_read_b64_tr_b16 a[74:75], v4 offset:704
    v_mfma_f32_16x16x32_bf16 v[24:27], a[120:123], v[208:211], v[24:27]
    ds_read_b64_tr_b16 a[76:77], v4 offset:832
    v_mfma_f32_16x16x32_bf16 v[24:27], a[124:127], v[216:219], v[24:27]
    ds_read_b64_tr_b16 a[78:79], v4 offset:960
    v_mfma_f32_16x16x32_bf16 v[28:31], a[96:99], v[160:163], 0
    ds_read_b64_tr_b16 a[80:81], v4 offset:16960
    v_mfma_f32_16x16x32_bf16 v[28:31], a[100:103], v[168:171], v[28:31]
    ds_read_b64_tr_b16 a[82:83], v4 offset:17088
    v_mfma_f32_16x16x32_bf16 v[28:31], a[104:107], v[176:179], v[28:31]
    ds_read_b64_tr_b16 a[84:85], v4 offset:17216
    v_mfma_f32_16x16x32_bf16 v[28:31], a[108:111], v[184:187], v[28:31]
    ds_read_b64_tr_b16 a[86:87], v4 offset:17344
    v_mfma_f32_16x16x32_bf16 v[28:31], a[112:115], v[224:227], v[28:31]
    ds_read_b64_tr_b16 a[88:89], v4 offset:17472
    v_mfma_f32_16x16x32_bf16 v[28:31], a[116:119], v[232:235], v[28:31]
    ds_read_b64_tr_b16 a[90:91], v4 offset:17600
    v_mfma_f32_16x16x32_bf16 v[28:31], a[120:123], v[240:243], v[28:31]
    ds_read_b64_tr_b16 a[92:93], v4 offset:17728
    v_mfma_f32_16x16x32_bf16 v[28:31], a[124:127], v[248:251], v[28:31]
    s_waitcnt lgkmcnt(11)
    ds_read_b64_tr_b16 a[94:95], v4 offset:17856
    v_mfma_f32_16x16x32_bf16 v[32:35], a[64:67], v[128:131], 0
    ds_read_b64_tr_b16 a[96:97], v4 offset:96
    v_cvt_pk_bf16_f32 v48, v16, v17
    v_mfma_f32_16x16x32_bf16 v[32:35], a[68:71], v[136:139], v[32:35]
    s_waitcnt lgkmcnt(9)
    ds_read_b64_tr_b16 a[98:99], v4 offset:224
    v_cvt_pk_bf16_f32 v49, v18, v19
    v_mfma_f32_16x16x32_bf16 v[32:35], a[72:75], v[144:147], v[32:35]
    ds_read_b64_tr_b16 a[100:101], v4 offset:352
    v_cvt_pk_bf16_f32 v50, v24, v25
    v_mfma_f32_16x16x32_bf16 v[32:35], a[76:79], v[152:155], v[32:35]
    s_waitcnt lgkmcnt(7)
    ds_read_b64_tr_b16 a[102:103], v4 offset:480
    v_cvt_pk_bf16_f32 v51, v26, v27
    v_mfma_f32_16x16x32_bf16 v[32:35], a[80:83], v[192:195], v[32:35]
    s_mov_b32 s54, 0
    ds_read_b64_tr_b16 a[104:105], v4 offset:608
    ds_read_b64_tr_b16 a[106:107], v4 offset:736
    v_mfma_f32_16x16x32_bf16 v[32:35], a[84:87], v[200:203], v[32:35]
    s_waitcnt lgkmcnt(6)
    v_permlane32_swap_b32 v48, v50
    v_mfma_f32_16x16x32_bf16 v[32:35], a[88:91], v[208:211], v[32:35]
    v_permlane32_swap_b32 v49, v51
    v_mfma_f32_16x16x32_bf16 v[32:35], a[92:95], v[216:219], v[32:35]
    ds_read_b64_tr_b16 a[108:109], v4 offset:864
    ds_read_b64_tr_b16 a[110:111], v4 offset:992
    buffer_store_dwordx4 v[48:51], v10, s[40:43], s54 offen offset:0 sc1
    buffer_store_dwordx4 v[48:51], v10, s[32:35], s54 offen offset:0
    v_mfma_f32_16x16x32_bf16 v[36:39], a[64:67], v[160:163], 0
    ds_read_b64_tr_b16 a[112:113], v4 offset:16992
    v_cvt_pk_bf16_f32 v52, v20, v21
    v_mfma_f32_16x16x32_bf16 v[36:39], a[68:71], v[168:171], v[36:39]
    ds_read_b64_tr_b16 a[114:115], v4 offset:17120
    v_cvt_pk_bf16_f32 v53, v22, v23
    v_mfma_f32_16x16x32_bf16 v[36:39], a[72:75], v[176:179], v[36:39]
    ds_read_b64_tr_b16 a[116:117], v4 offset:17248
    v_cvt_pk_bf16_f32 v54, v28, v29
    v_mfma_f32_16x16x32_bf16 v[36:39], a[76:79], v[184:187], v[36:39]
    ds_read_b64_tr_b16 a[118:119], v4 offset:17376
    v_cvt_pk_bf16_f32 v55, v30, v31
    v_mfma_f32_16x16x32_bf16 v[36:39], a[80:83], v[224:227], v[36:39]
    s_mov_b32 s54, 294912
    ds_read_b64_tr_b16 a[120:121], v4 offset:17504
    ds_read_b64_tr_b16 a[122:123], v4 offset:17632
    v_mfma_f32_16x16x32_bf16 v[36:39], a[84:87], v[232:235], v[36:39]
    v_permlane32_swap_b32 v52, v54
    v_mfma_f32_16x16x32_bf16 v[36:39], a[88:91], v[240:243], v[36:39]
    v_permlane32_swap_b32 v53, v55
    v_mfma_f32_16x16x32_bf16 v[36:39], a[92:95], v[248:251], v[36:39]
    s_waitcnt vmcnt(27)
    s_barrier
    s_waitcnt lgkmcnt(10)
    ds_read_b64_tr_b16 a[124:125], v4 offset:17760
    ds_read_b64_tr_b16 a[126:127], v4 offset:17888
    ds_read_b128 v[60:63], v58
    buffer_store_dwordx4 v[52:55], v10, s[40:43], s54 offen offset:0 sc1
    buffer_store_dwordx4 v[52:55], v10, s[32:35], s54 offen offset:0
    v_mfma_f32_16x16x32_bf16 v[40:43], a[96:99], v[128:131], 0
    s_add_u32 m0, s44, 36864
    ds_read_b64_tr_b16 a[64:65], v4 offset:36864
    ds_read_b64_tr_b16 a[66:67], v4 offset:36992
    v_mfma_f32_16x16x32_bf16 v[40:43], a[100:103], v[136:139], v[40:43]
    s_mov_b32 s45, 384
    s_waitcnt lgkmcnt(11)
    buffer_load_dwordx4 v7, s[28:31], s45 offen offset:0 lds
    v_mfma_f32_16x16x32_bf16 v[40:43], a[104:107], v[144:147], v[40:43]
    s_add_u32 m0, s44, 36768
    ds_read_b64_tr_b16 a[68:69], v4 offset:37120
    ds_read_b64_tr_b16 a[70:71], v4 offset:37248
    v_mfma_f32_16x16x32_bf16 v[40:43], a[108:111], v[152:155], v[40:43]
    s_waitcnt lgkmcnt(9)
    buffer_load_dwordx4 v7, s[28:31], s45 offen offset:1152 lds
    v_mfma_f32_16x16x32_bf16 v[40:43], a[112:115], v[192:195], v[40:43]
    s_add_u32 m0, s44, 36672
    ds_read_b64_tr_b16 a[72:73], v4 offset:37376
    ds_read_b64_tr_b16 a[74:75], v4 offset:37504
    v_mfma_f32_16x16x32_bf16 v[40:43], a[116:119], v[200:203], v[40:43]
    s_waitcnt lgkmcnt(7)
    buffer_load_dwordx4 v7, s[28:31], s45 offen offset:2304 lds
    v_mfma_f32_16x16x32_bf16 v[40:43], a[120:123], v[208:211], v[40:43]
    s_add_u32 m0, s44, 36576
    ds_read_b64_tr_b16 a[76:77], v4 offset:37632
    ds_read_b64_tr_b16 a[78:79], v4 offset:37760
    v_mfma_f32_16x16x32_bf16 v[40:43], a[124:127], v[216:219], v[40:43]
    s_waitcnt lgkmcnt(8)
    buffer_load_dwordx4 v7, s[28:31], s45 offen offset:3456 lds
    v_or3_b32 v60, v60, v61, v62
    v_or_b32 v60, v60, v63
    v_mfma_f32_16x16x32_bf16 v[44:47], a[96:99], v[160:163], 0
    s_add_u32 m0, s44, 53760
    ds_read_b64_tr_b16 a[80:81], v4 offset:53760
    ds_read_b64_tr_b16 a[82:83], v4 offset:53888
    v_mfma_f32_16x16x32_bf16 v[44:47], a[100:103], v[168:171], v[44:47]
    s_mov_b32 s45, 147840
    buffer_load_dwordx4 v7, s[28:31], s45 offen offset:0 lds
    v_mfma_f32_16x16x32_bf16 v[44:47], a[104:107], v[176:179], v[44:47]
    s_add_u32 m0, s44, 53664
    ds_read_b64_tr_b16 a[84:85], v4 offset:54016
    ds_read_b64_tr_b16 a[86:87], v4 offset:54144
    v_mfma_f32_16x16x32_bf16 v[44:47], a[108:111], v[184:187], v[44:47]
    buffer_load_dwordx4 v7, s[28:31], s45 offen offset:1152 lds
    v_mfma_f32_16x16x32_bf16 v[44:47], a[112:115], v[224:227], v[44:47]
    s_add_u32 m0, s44, 53568
    ds_read_b64_tr_b16 a[88:89], v4 offset:54272
    ds_read_b64_tr_b16 a[90:91], v4 offset:54400
    v_mfma_f32_16x16x32_bf16 v[44:47], a[116:119], v[232:235], v[44:47]
    buffer_load_dwordx4 v7, s[28:31], s45 offen offset:2304 lds
    v_mfma_f32_16x16x32_bf16 v[44:47], a[120:123], v[240:243], v[44:47]
    s_add_u32 m0, s44, 53472
    ds_read_b64_tr_b16 a[92:93], v4 offset:54528
    ds_read_b64_tr_b16 a[94:95], v4 offset:54656
    v_mfma_f32_16x16x32_bf16 v[44:47], a[124:127], v[248:251], v[44:47]
    s_waitcnt lgkmcnt(12)
    buffer_load_dwordx4 v7, s[28:31], s45 offen offset:3456 lds
    v_readfirstlane_b32 s3, v60
    v_mfma_f32_16x16x32_bf16 v[16:19], a[64:67], v[128:131], 0
    ds_read_b64_tr_b16 a[96:97], v4 offset:36896
    v_cvt_pk_bf16_f32 v48, v32, v33
    v_mfma_f32_16x16x32_bf16 v[16:19], a[68:71], v[136:139], v[16:19]
    s_waitcnt lgkmcnt(9)
    s_cmp_lg_u32 s3, 0
    ds_read_b64_tr_b16 a[98:99], v4 offset:37024
    v_cvt_pk_bf16_f32 v49, v34, v35
    v_mfma_f32_16x16x32_bf16 v[16:19], a[72:75], v[144:147], v[16:19]
    s_cbranch_scc1 L2_fallback
    ds_read_b64_tr_b16 a[100:101], v4 offset:37152
    v_cvt_pk_bf16_f32 v50, v40, v41
    v_mfma_f32_16x16x32_bf16 v[16:19], a[76:79], v[152:155], v[16:19]
    s_waitcnt lgkmcnt(7)
    ds_read_b64_tr_b16 a[102:103], v4 offset:37280
    v_cvt_pk_bf16_f32 v51, v42, v43
    v_mfma_f32_16x16x32_bf16 v[16:19], a[80:83], v[192:195], v[16:19]
    s_mov_b32 s54, 0
    ds_read_b64_tr_b16 a[104:105], v4 offset:37408
    ds_read_b64_tr_b16 a[106:107], v4 offset:37536
    v_mfma_f32_16x16x32_bf16 v[16:19], a[84:87], v[200:203], v[16:19]
    s_waitcnt lgkmcnt(6)
    v_permlane32_swap_b32 v48, v50
    v_mfma_f32_16x16x32_bf16 v[16:19], a[88:91], v[208:211], v[16:19]
    v_permlane32_swap_b32 v49, v51
    v_mfma_f32_16x16x32_bf16 v[16:19], a[92:95], v[216:219], v[16:19]
    ds_read_b64_tr_b16 a[108:109], v4 offset:37664
    ds_read_b64_tr_b16 a[110:111], v4 offset:37792
    buffer_store_dwordx4 v[48:51], v10, s[40:43], s54 offen offset:512 sc1
    buffer_store_dwordx4 v[48:51], v10, s[32:35], s54 offen offset:512
    v_mfma_f32_16x16x32_bf16 v[20:23], a[64:67], v[160:163], 0
    ds_read_b64_tr_b16 a[112:113], v4 offset:53792
    v_cvt_pk_bf16_f32 v52, v36, v37
    v_mfma_f32_16x16x32_bf16 v[20:23], a[68:71], v[168:171], v[20:23]
    ds_read_b64_tr_b16 a[114:115], v4 offset:53920
    v_cvt_pk_bf16_f32 v53, v38, v39
    v_mfma_f32_16x16x32_bf16 v[20:23], a[72:75], v[176:179], v[20:23]
    ds_read_b64_tr_b16 a[116:117], v4 offset:54048
    v_cvt_pk_bf16_f32 v54, v44, v45
    v_mfma_f32_16x16x32_bf16 v[20:23], a[76:79], v[184:187], v[20:23]
    ds_read_b64_tr_b16 a[118:119], v4 offset:54176
    v_cvt_pk_bf16_f32 v55, v46, v47
    v_mfma_f32_16x16x32_bf16 v[20:23], a[80:83], v[224:227], v[20:23]
    s_mov_b32 s54, 294912
    ds_read_b64_tr_b16 a[120:121], v4 offset:54304
    ds_read_b64_tr_b16 a[122:123], v4 offset:54432
    v_mfma_f32_16x16x32_bf16 v[20:23], a[84:87], v[232:235], v[20:23]
    v_permlane32_swap_b32 v52, v54
    v_mfma_f32_16x16x32_bf16 v[20:23], a[88:91], v[240:243], v[20:23]
    v_permlane32_swap_b32 v53, v55
    v_mfma_f32_16x16x32_bf16 v[20:23], a[92:95], v[248:251], v[20:23]
    s_waitcnt lgkmcnt(10)
    ds_read_b64_tr_b16 a[124:125], v4 offset:54560
    ds_read_b64_tr_b16 a[126:127], v4 offset:54688
    buffer_store_dwordx4 v[52:55], v10, s[40:43], s54 offen offset:512 sc1
    buffer_store_dwordx4 v[52:55], v10, s[32:35], s54 offen offset:512
    v_mfma_f32_16x16x32_bf16 v[24:27], a[96:99], v[128:131], 0
    s_mul_i32 s3, s51, 128
    ds_read_b64_tr_b16 a[64:65], v4 offset:36928
    v_lshrrev_b32 v14, 3, v0
    v_mfma_f32_16x16x32_bf16 v[24:27], a[100:103], v[136:139], v[24:27]
    s_waitcnt lgkmcnt(9)
    ds_read_b64_tr_b16 a[66:67], v4 offset:37056
    v_lshl_add_u32 v12, v14, 4, s3
    v_mfma_f32_16x16x32_bf16 v[24:27], a[104:107], v[144:147], v[24:27]
    ds_read_b64_tr_b16 a[68:69], v4 offset:37184
    v_and_b32 v14, 1, v14
    v_mfma_f32_16x16x32_bf16 v[24:27], a[108:111], v[152:155], v[24:27]
    s_waitcnt lgkmcnt(7)
    s_mul_i32 s3, s51, 32
    ds_read_b64_tr_b16 a[70:71], v4 offset:37312
    v_lshl_add_u32 v13, v14, 4, s3
    v_mfma_f32_16x16x32_bf16 v[24:27], a[112:115], v[192:195], v[24:27]
    ds_read_b64_tr_b16 a[72:73], v4 offset:37440
    v_and_b32 v14, 7, v0
    v_mfma_f32_16x16x32_bf16 v[24:27], a[116:119], v[200:203], v[24:27]
    s_waitcnt lgkmcnt(5)
    ds_read_b64_tr_b16 a[74:75], v4 offset:37568
    v_mul_u32_u24 v14, 1152, v14
    v_mfma_f32_16x16x32_bf16 v[24:27], a[120:123], v[208:211], v[24:27]
    ds_read_b64_tr_b16 a[76:77], v4 offset:37696
    v_add_u32 v1, v14, v12
    v_mfma_f32_16x16x32_bf16 v[24:27], a[124:127], v[216:219], v[24:27]
    ds_read_b64_tr_b16 a[78:79], v4 offset:37824
    v_add_u32 v2, v14, v13
    v_mfma_f32_16x16x32_bf16 v[28:31], a[96:99], v[160:163], 0
    ds_read_b64_tr_b16 a[80:81], v4 offset:53824
    v_add_u32 v2, 1024, v2
    v_mfma_f32_16x16x32_bf16 v[28:31], a[100:103], v[168:171], v[28:31]
    s_lshl_b32 s14, s51, 10
    ds_read_b64_tr_b16 a[82:83], v4 offset:53952
    v_add_u32 v5, s14, v8
    v_mfma_f32_16x16x32_bf16 v[28:31], a[104:107], v[176:179], v[28:31]
    ds_read_b64_tr_b16 a[84:85], v4 offset:54080
    v_and_b32 v59, 0xf0, v8
    v_mfma_f32_16x16x32_bf16 v[28:31], a[108:111], v[184:187], v[28:31]
    s_lshl_b32 s14, s51, 8
    ds_read_b64_tr_b16 a[86:87], v4 offset:54208
    v_add_u32 v59, s14, v59
    v_mfma_f32_16x16x32_bf16 v[28:31], a[112:115], v[224:227], v[28:31]
    ds_read_b64_tr_b16 a[88:89], v4 offset:54336
    v_and_b32 v6, 15, v0
    v_mfma_f32_16x16x32_bf16 v[28:31], a[116:119], v[232:235], v[28:31]
    ds_read_b64_tr_b16 a[90:91], v4 offset:54464
    v_lshlrev_b32 v6, 8, v6
    v_mfma_f32_16x16x32_bf16 v[28:31], a[120:123], v[240:243], v[28:31]
    ds_read_b64_tr_b16 a[92:93], v4 offset:54592
    v_min_u32 v15, 1, v0
    v_mfma_f32_16x16x32_bf16 v[28:31], a[124:127], v[248:251], v[28:31]
    s_waitcnt lgkmcnt(11)
    ds_read_b64_tr_b16 a[94:95], v4 offset:54720
    v_lshlrev_b32 v15, 30, v15
    v_mfma_f32_16x16x32_bf16 v[32:35], a[64:67], v[128:131], 0
    s_lshl_b32 s15, s53, 14
    s_add_u32 s15, s15, 786432
    s_and_b32 s14, s52, 12
    s_lshl_b32 s14, s14, 10
    s_add_u32 s47, s15, s14
    s_lshl4_add_u32 s3, s51, s52
    s_lshl_b32 s3, s3, 8
    s_add_u32 s56, s3, s15
    ds_read_b64_tr_b16 a[96:97], v4 offset:36960
    v_cvt_pk_bf16_f32 v48, v16, v17
    v_mfma_f32_16x16x32_bf16 v[32:35], a[68:71], v[136:139], v[32:35]
    s_waitcnt lgkmcnt(9)
    ds_read_b64_tr_b16 a[98:99], v4 offset:37088
    v_cvt_pk_bf16_f32 v49, v18, v19
    v_mfma_f32_16x16x32_bf16 v[32:35], a[72:75], v[144:147], v[32:35]
    ds_read_b64_tr_b16 a[100:101], v4 offset:37216
    v_cvt_pk_bf16_f32 v50, v24, v25
    v_mfma_f32_16x16x32_bf16 v[32:35], a[76:79], v[152:155], v[32:35]
    s_waitcnt lgkmcnt(7)
    ds_read_b64_tr_b16 a[102:103], v4 offset:37344
    v_cvt_pk_bf16_f32 v51, v26, v27
    v_mfma_f32_16x16x32_bf16 v[32:35], a[80:83], v[192:195], v[32:35]
    s_mov_b32 s54, 1024
    ds_read_b64_tr_b16 a[104:105], v4 offset:37472
    ds_read_b64_tr_b16 a[106:107], v4 offset:37600
    v_mfma_f32_16x16x32_bf16 v[32:35], a[84:87], v[200:203], v[32:35]
    s_waitcnt lgkmcnt(6)
    v_permlane32_swap_b32 v48, v50
    v_mfma_f32_16x16x32_bf16 v[32:35], a[88:91], v[208:211], v[32:35]
    v_permlane32_swap_b32 v49, v51
    v_mfma_f32_16x16x32_bf16 v[32:35], a[92:95], v[216:219], v[32:35]
    ds_read_b64_tr_b16 a[108:109], v4 offset:37728
    ds_read_b64_tr_b16 a[110:111], v4 offset:37856
    buffer_store_dwordx4 v[48:51], v10, s[40:43], s54 offen offset:0 sc1
    buffer_store_dwordx4 v[48:51], v10, s[32:35], s54 offen offset:0
    v_mfma_f32_16x16x32_bf16 v[36:39], a[64:67], v[160:163], 0
    ds_read_b64_tr_b16 a[112:113], v4 offset:53856
    v_cvt_pk_bf16_f32 v52, v20, v21
    v_mfma_f32_16x16x32_bf16 v[36:39], a[68:71], v[168:171], v[36:39]
    ds_read_b64_tr_b16 a[114:115], v4 offset:53984
    v_cvt_pk_bf16_f32 v53, v22, v23
    v_mfma_f32_16x16x32_bf16 v[36:39], a[72:75], v[176:179], v[36:39]
    ds_read_b64_tr_b16 a[116:117], v4 offset:54112
    v_cvt_pk_bf16_f32 v54, v28, v29
    v_mfma_f32_16x16x32_bf16 v[36:39], a[76:79], v[184:187], v[36:39]
    ds_read_b64_tr_b16 a[118:119], v4 offset:54240
    v_cvt_pk_bf16_f32 v55, v30, v31
    v_mfma_f32_16x16x32_bf16 v[36:39], a[80:83], v[224:227], v[36:39]
    s_mov_b32 s54, 295936
    ds_read_b64_tr_b16 a[120:121], v4 offset:54368
    ds_read_b64_tr_b16 a[122:123], v4 offset:54496
    v_mfma_f32_16x16x32_bf16 v[36:39], a[84:87], v[232:235], v[36:39]
    v_permlane32_swap_b32 v52, v54
    v_mfma_f32_16x16x32_bf16 v[36:39], a[88:91], v[240:243], v[36:39]
    v_permlane32_swap_b32 v53, v55
    v_mfma_f32_16x16x32_bf16 v[36:39], a[92:95], v[248:251], v[36:39]
    s_waitcnt vmcnt(31)
    s_barrier
    s_waitcnt lgkmcnt(10)
    ds_read_b64_tr_b16 a[124:125], v4 offset:54624
    ds_read_b64_tr_b16 a[126:127], v4 offset:54752
    buffer_store_dwordx4 v[52:55], v10, s[40:43], s54 offen offset:0 sc1
    buffer_store_dwordx4 v[52:55], v10, s[32:35], s54 offen offset:0
    v_mfma_f32_16x16x32_bf16 v[40:43], a[96:99], v[128:131], 0
    s_add_u32 m0, s44, 73728
    ds_read_b64_tr_b16 a[64:65], v3 offset:0
    ds_read_b64_tr_b16 a[66:67], v3 offset:128
    v_mfma_f32_16x16x32_bf16 v[40:43], a[100:103], v[136:139], v[40:43]
    s_mov_b32 s45, 512
    s_waitcnt lgkmcnt(10)
    buffer_load_dwordx4 v7, s[28:31], s45 offen offset:0 lds
    v_mfma_f32_16x16x32_bf16 v[40:43], a[104:107], v[144:147], v[40:43]
    s_add_u32 m0, s44, 73632
    ds_read_b64_tr_b16 a[68:69], v3 offset:256
    ds_read_b64_tr_b16 a[70:71], v3 offset:384
    v_mfma_f32_16x16x32_bf16 v[40:43], a[108:111], v[152:155], v[40:43]
    s_waitcnt lgkmcnt(8)
    buffer_load_dwordx4 v7, s[28:31], s45 offen offset:1152 lds
    v_mfma_f32_16x16x32_bf16 v[40:43], a[112:115], v[192:195], v[40:43]
    s_add_u32 m0, s44, 73536
    ds_read_b64_tr_b16 a[72:73], v3 offset:512
    ds_read_b64_tr_b16 a[74:75], v3 offset:640
    v_mfma_f32_16x16x32_bf16 v[40:43], a[116:119], v[200:203], v[40:43]
    s_waitcnt lgkmcnt(6)
    buffer_load_dwordx4 v7, s[28:31], s45 offen offset:2304 lds
    v_mfma_f32_16x16x32_bf16 v[40:43], a[120:123], v[208:211], v[40:43]
    s_add_u32 m0, s44, 73440
    ds_read_b64_tr_b16 a[76:77], v3 offset:768
    ds_read_b64_tr_b16 a[78:79], v3 offset:896
    v_mfma_f32_16x16x32_bf16 v[40:43], a[124:127], v[216:219], v[40:43]
    buffer_load_dwordx4 v7, s[28:31], s45 offen offset:3456 lds
    v_mfma_f32_16x16x32_bf16 v[44:47], a[96:99], v[160:163], 0
    s_add_u32 m0, s44, 90624
    ds_read_b64_tr_b16 a[80:81], v3 offset:16896
    ds_read_b64_tr_b16 a[82:83], v3 offset:17024
    v_mfma_f32_16x16x32_bf16 v[44:47], a[100:103], v[168:171], v[44:47]
    s_mov_b32 s45, 147968
    buffer_load_dwordx4 v7, s[28:31], s45 offen offset:0 lds
    v_mfma_f32_16x16x32_bf16 v[44:47], a[104:107], v[176:179], v[44:47]
    s_add_u32 m0, s44, 90528
    ds_read_b64_tr_b16 a[84:85], v3 offset:17152
    ds_read_b64_tr_b16 a[86:87], v3 offset:17280
    v_mfma_f32_16x16x32_bf16 v[44:47], a[108:111], v[184:187], v[44:47]
    buffer_load_dwordx4 v7, s[28:31], s45 offen offset:1152 lds
    v_mfma_f32_16x16x32_bf16 v[44:47], a[112:115], v[224:227], v[44:47]
    s_add_u32 m0, s44, 90432
    ds_read_b64_tr_b16 a[88:89], v3 offset:17408
    ds_read_b64_tr_b16 a[90:91], v3 offset:17536
    v_mfma_f32_16x16x32_bf16 v[44:47], a[116:119], v[232:235], v[44:47]
    buffer_load_dwordx4 v7, s[28:31], s45 offen offset:2304 lds
    v_mfma_f32_16x16x32_bf16 v[44:47], a[120:123], v[240:243], v[44:47]
    s_add_u32 m0, s44, 90336
    ds_read_b64_tr_b16 a[92:93], v3 offset:17664
    ds_read_b64_tr_b16 a[94:95], v3 offset:17792
    v_mfma_f32_16x16x32_bf16 v[44:47], a[124:127], v[248:251], v[44:47]
    s_waitcnt lgkmcnt(12)
    buffer_load_dwordx4 v7, s[28:31], s45 offen offset:3456 lds
    v_mfma_f32_16x16x32_bf16 v[16:19], a[64:67], v[128:131], 0
    ds_read_b64_tr_b16 a[96:97], v3 offset:32
    v_cvt_pk_bf16_f32 v48, v32, v33
    v_mfma_f32_16x16x32_bf16 v[16:19], a[68:71], v[136:139], v[16:19]
    s_waitcnt lgkmcnt(9)
    ds_read_b64_tr_b16 a[98:99], v3 offset:160
    v_cvt_pk_bf16_f32 v49, v34, v35
    v_mfma_f32_16x16x32_bf16 v[16:19], a[72:75], v[144:147], v[16:19]
    ds_read_b64_tr_b16 a[100:101], v3 offset:288
    v_cvt_pk_bf16_f32 v50, v40, v41
    v_mfma_f32_16x16x32_bf16 v[16:19], a[76:79], v[152:155], v[16:19]
    s_waitcnt lgkmcnt(7)
    ds_read_b64_tr_b16 a[102:103], v3 offset:416
    v_cvt_pk_bf16_f32 v51, v42, v43
    v_mfma_f32_16x16x32_bf16 v[16:19], a[80:83], v[192:195], v[16:19]
    s_mov_b32 s54, 1024
    ds_read_b64_tr_b16 a[104:105], v3 offset:544
    ds_read_b64_tr_b16 a[106:107], v3 offset:672
    v_mfma_f32_16x16x32_bf16 v[16:19], a[84:87], v[200:203], v[16:19]
    s_waitcnt lgkmcnt(6)
    v_permlane32_swap_b32 v48, v50
    v_mfma_f32_16x16x32_bf16 v[16:19], a[88:91], v[208:211], v[16:19]
    v_permlane32_swap_b32 v49, v51
    v_mfma_f32_16x16x32_bf16 v[16:19], a[92:95], v[216:219], v[16:19]
    ds_read_b64_tr_b16 a[108:109], v3 offset:800
    ds_read_b64_tr_b16 a[110:111], v3 offset:928
    buffer_store_dwordx4 v[48:51], v10, s[40:43], s54 offen offset:512 sc1
    buffer_store_dwordx4 v[48:51], v10, s[32:35], s54 offen offset:512
    v_mfma_f32_16x16x32_bf16 v[20:23], a[64:67], v[160:163], 0
    ds_read_b64_tr_b16 a[112:113], v3 offset:16928
    v_cvt_pk_bf16_f32 v52, v36, v37
    v_mfma_f32_16x16x32_bf16 v[20:23], a[68:71], v[168:171], v[20:23]
    ds_read_b64_tr_b16 a[114:115], v3 offset:17056
    v_cvt_pk_bf16_f32 v53, v38, v39
    v_mfma_f32_16x16x32_bf16 v[20:23], a[72:75], v[176:179], v[20:23]
    ds_read_b64_tr_b16 a[116:117], v3 offset:17184
    v_cvt_pk_bf16_f32 v54, v44, v45
    v_mfma_f32_16x16x32_bf16 v[20:23], a[76:79], v[184:187], v[20:23]
    ds_read_b64_tr_b16 a[118:119], v3 offset:17312
    v_cvt_pk_bf16_f32 v55, v46, v47
    v_mfma_f32_16x16x32_bf16 v[20:23], a[80:83], v[224:227], v[20:23]
    s_mov_b32 s54, 295936
    ds_read_b64_tr_b16 a[120:121], v3 offset:17440
    ds_read_b64_tr_b16 a[122:123], v3 offset:17568
    v_mfma_f32_16x16x32_bf16 v[20:23], a[84:87], v[232:235], v[20:23]
    v_permlane32_swap_b32 v52, v54
    v_mfma_f32_16x16x32_bf16 v[20:23], a[88:91], v[240:243], v[20:23]
    v_permlane32_swap_b32 v53, v55
    v_mfma_f32_16x16x32_bf16 v[20:23], a[92:95], v[248:251], v[20:23]
    s_waitcnt lgkmcnt(10)
    ds_read_b64_tr_b16 a[124:125], v3 offset:17696
    ds_read_b64_tr_b16 a[126:127], v3 offset:17824
    buffer_store_dwordx4 v[52:55], v10, s[40:43], s54 offen offset:512 sc1
    buffer_store_dwordx4 v[52:55], v10, s[32:35], s54 offen offset:512
    v_mfma_f32_16x16x32_bf16 v[24:27], a[96:99], v[128:131], 0
    ds_read_b64_tr_b16 a[64:65], v3 offset:64
    v_mfma_f32_16x16x32_bf16 v[24:27], a[100:103], v[136:139], v[24:27]
    s_waitcnt lgkmcnt(9)
    ds_read_b64_tr_b16 a[66:67], v3 offset:192
    v_mfma_f32_16x16x32_bf16 v[24:27], a[104:107], v[144:147], v[24:27]
    ds_read_b64_tr_b16 a[68:69], v3 offset:320
    v_mfma_f32_16x16x32_bf16 v[24:27], a[108:111], v[152:155], v[24:27]
    s_waitcnt lgkmcnt(7)
    ds_read_b64_tr_b16 a[70:71], v3 offset:448
    v_mfma_f32_16x16x32_bf16 v[24:27], a[112:115], v[192:195], v[24:27]
    ds_read_b64_tr_b16 a[72:73], v3 offset:576
    v_mfma_f32_16x16x32_bf16 v[24:27], a[116:119], v[200:203], v[24:27]
    s_waitcnt lgkmcnt(5)
    ds_read_b64_tr_b16 a[74:75], v3 offset:704
    v_mfma_f32_16x16x32_bf16 v[24:27], a[120:123], v[208:211], v[24:27]
    ds_read_b64_tr_b16 a[76:77], v3 offset:832
    v_mfma_f32_16x16x32_bf16 v[24:27], a[124:127], v[216:219], v[24:27]
    ds_read_b64_tr_b16 a[78:79], v3 offset:960
    v_mfma_f32_16x16x32_bf16 v[28:31], a[96:99], v[160:163], 0
    ds_read_b64_tr_b16 a[80:81], v3 offset:16960
    v_mfma_f32_16x16x32_bf16 v[28:31], a[100:103], v[168:171], v[28:31]
    ds_read_b64_tr_b16 a[82:83], v3 offset:17088
    v_mfma_f32_16x16x32_bf16 v[28:31], a[104:107], v[176:179], v[28:31]
    ds_read_b64_tr_b16 a[84:85], v3 offset:17216
    v_mfma_f32_16x16x32_bf16 v[28:31], a[108:111], v[184:187], v[28:31]
    ds_read_b64_tr_b16 a[86:87], v3 offset:17344
    v_mfma_f32_16x16x32_bf16 v[28:31], a[112:115], v[224:227], v[28:31]
    ds_read_b64_tr_b16 a[88:89], v3 offset:17472
    v_mfma_f32_16x16x32_bf16 v[28:31], a[116:119], v[232:235], v[28:31]
    ds_read_b64_tr_b16 a[90:91], v3 offset:17600
    v_mfma_f32_16x16x32_bf16 v[28:31], a[120:123], v[240:243], v[28:31]
    ds_read_b64_tr_b16 a[92:93], v3 offset:17728
    v_mfma_f32_16x16x32_bf16 v[28:31], a[124:127], v[248:251], v[28:31]
    s_waitcnt lgkmcnt(11)
    ds_read_b64_tr_b16 a[94:95], v3 offset:17856
    v_mfma_f32_16x16x32_bf16 v[32:35], a[64:67], v[128:131], 0
    ds_read_b64_tr_b16 a[96:97], v3 offset:96
    v_cvt_pk_bf16_f32 v48, v16, v17
    v_mfma_f32_16x16x32_bf16 v[32:35], a[68:71], v[136:139], v[32:35]
    s_waitcnt lgkmcnt(9)
    ds_read_b64_tr_b16 a[98:99], v3 offset:224
    v_cvt_pk_bf16_f32 v49, v18, v19
    v_mfma_f32_16x16x32_bf16 v[32:35], a[72:75], v[144:147], v[32:35]
    ds_read_b64_tr_b16 a[100:101], v3 offset:352
    v_cvt_pk_bf16_f32 v50, v24, v25
    v_mfma_f32_16x16x32_bf16 v[32:35], a[76:79], v[152:155], v[32:35]
    s_waitcnt lgkmcnt(7)
    ds_read_b64_tr_b16 a[102:103], v3 offset:480
    v_cvt_pk_bf16_f32 v51, v26, v27
    v_mfma_f32_16x16x32_bf16 v[32:35], a[80:83], v[192:195], v[32:35]
    s_mov_b32 s54, 2048
    ds_read_b64_tr_b16 a[104:105], v3 offset:608
    ds_read_b64_tr_b16 a[106:107], v3 offset:736
    v_mfma_f32_16x16x32_bf16 v[32:35], a[84:87], v[200:203], v[32:35]
    s_waitcnt lgkmcnt(6)
    v_permlane32_swap_b32 v48, v50
    v_mfma_f32_16x16x32_bf16 v[32:35], a[88:91], v[208:211], v[32:35]
    v_permlane32_swap_b32 v49, v51
    v_mfma_f32_16x16x32_bf16 v[32:35], a[92:95], v[216:219], v[32:35]
    ds_read_b64_tr_b16 a[108:109], v3 offset:864
    ds_read_b64_tr_b16 a[110:111], v3 offset:992
    buffer_store_dwordx4 v[48:51], v10, s[40:43], s54 offen offset:0 sc1
    buffer_store_dwordx4 v[48:51], v10, s[32:35], s54 offen offset:0
    v_mfma_f32_16x16x32_bf16 v[36:39], a[64:67], v[160:163], 0
L2_pad10:
    s_cbranch_execz L2_pad14
    ds_read_b64_tr_b16 a[112:113], v3 offset:16992
    v_cvt_pk_bf16_f32 v52, v20, v21
    v_mfma_f32_16x16x32_bf16 v[36:39], a[68:71], v[168:171], v[36:39]
    ds_read_b64_tr_b16 a[114:115], v3 offset:17120
    v_cvt_pk_bf16_f32 v53, v22, v23
    v_mfma_f32_16x16x32_bf16 v[36:39], a[72:75], v[176:179], v[36:39]
    ds_read_b64_tr_b16 a[116:117], v3 offset:17248
    v_cvt_pk_bf16_f32 v54, v28, v29
    v_mfma_f32_16x16x32_bf16 v[36:39], a[76:79], v[184:187], v[36:39]
    ds_read_b64_tr_b16 a[118:119], v3 offset:17376
    v_cvt_pk_bf16_f32 v55, v30, v31
    v_mfma_f32_16x16x32_bf16 v[36:39], a[80:83], v[224:227], v[36:39]
    s_mov_b32 s54, 296960
    ds_read_b64_tr_b16 a[120:121], v3 offset:17504
    ds_read_b64_tr_b16 a[122:123], v3 offset:17632
    v_mfma_f32_16x16x32_bf16 v[36:39], a[84:87], v[232:235], v[36:39]
    v_permlane32_swap_b32 v52, v54
    v_mfma_f32_16x16x32_bf16 v[36:39], a[88:91], v[240:243], v[36:39]
    v_permlane32_swap_b32 v53, v55
    v_mfma_f32_16x16x32_bf16 v[36:39], a[92:95], v[248:251], v[36:39]
    s_waitcnt vmcnt(15)
    s_barrier
    s_waitcnt lgkmcnt(10)
    ds_read_b64_tr_b16 a[124:125], v3 offset:17760
    ds_read_b64_tr_b16 a[126:127], v3 offset:17888
    buffer_store_dwordx4 v[52:55], v10, s[40:43], s54 offen offset:0 sc1
    buffer_store_dwordx4 v[52:55], v10, s[32:35], s54 offen offset:0
    v_mfma_f32_16x16x32_bf16 v[40:43], a[96:99], v[128:131], 0
    s_add_u32 m0, s44, 110592
    ds_read_b64_tr_b16 a[64:65], v3 offset:36864
    ds_read_b64_tr_b16 a[66:67], v3 offset:36992
    v_mfma_f32_16x16x32_bf16 v[40:43], a[100:103], v[136:139], v[40:43]
    s_mov_b32 s45, 640
    s_waitcnt lgkmcnt(10)
    buffer_load_dwordx4 v7, s[28:31], s45 offen offset:0 lds
    v_mfma_f32_16x16x32_bf16 v[40:43], a[104:107], v[144:147], v[40:43]
    s_add_u32 m0, s44, 110496
    ds_read_b64_tr_b16 a[68:69], v3 offset:37120
    ds_read_b64_tr_b16 a[70:71], v3 offset:37248
    v_mfma_f32_16x16x32_bf16 v[40:43], a[108:111], v[152:155], v[40:43]
    s_waitcnt lgkmcnt(8)
    buffer_load_dwordx4 v7, s[28:31], s45 offen offset:1152 lds
    v_mfma_f32_16x16x32_bf16 v[40:43], a[112:115], v[192:195], v[40:43]
    s_add_u32 m0, s44, 110400
    ds_read_b64_tr_b16 a[72:73], v3 offset:37376
    ds_read_b64_tr_b16 a[74:75], v3 offset:37504
    v_mfma_f32_16x16x32_bf16 v[40:43], a[116:119], v[200:203], v[40:43]
    s_waitcnt lgkmcnt(6)
    buffer_load_dwordx4 v7, s[28:31], s45 offen offset:2304 lds
    v_mfma_f32_16x16x32_bf16 v[40:43], a[120:123], v[208:211], v[40:43]
    s_add_u32 m0, s44, 110304
    ds_read_b64_tr_b16 a[76:77], v3 offset:37632
    ds_read_b64_tr_b16 a[78:79], v3 offset:37760
    v_mfma_f32_16x16x32_bf16 v[40:43], a[124:127], v[216:219], v[40:43]
    buffer_load_dwordx4 v7, s[28:31], s45 offen offset:3456 lds
    v_mfma_f32_16x16x32_bf16 v[44:47], a[96:99], v[160:163], 0
    s_add_u32 m0, s44, 127488
    ds_read_b64_tr_b16 a[80:81], v3 offset:53760
    ds_read_b64_tr_b16 a[82:83], v3 offset:53888
    v_mfma_f32_16x16x32_bf16 v[44:47], a[100:103], v[168:171], v[44:47]
    s_mov_b32 s45, 148096
    buffer_load_dwordx4 v7, s[28:31], s45 offen offset:0 lds
    v_mfma_f32_16x16x32_bf16 v[44:47], a[104:107], v[176:179], v[44:47]
    s_add_u32 m0, s44, 127392
    ds_read_b64_tr_b16 a[84:85], v3 offset:54016
    ds_read_b64_tr_b16 a[86:87], v3 offset:54144
    v_mfma_f32_16x16x32_bf16 v[44:47], a[108:111], v[184:187], v[44:47]
    buffer_load_dwordx4 v7, s[28:31], s45 offen offset:1152 lds
    v_mfma_f32_16x16x32_bf16 v[44:47], a[112:115], v[224:227], v[44:47]
    s_add_u32 m0, s44, 127296
    ds_read_b64_tr_b16 a[88:89], v3 offset:54272
    ds_read_b64_tr_b16 a[90:91], v3 offset:54400
    v_mfma_f32_16x16x32_bf16 v[44:47], a[116:119], v[232:235], v[44:47]
    buffer_load_dwordx4 v7, s[28:31], s45 offen offset:2304 lds
    v_mfma_f32_16x16x32_bf16 v[44:47], a[120:123], v[240:243], v[44:47]
    s_add_u32 m0, s44, 127200
    ds_read_b64_tr_b16 a[92:93], v3 offset:54528
    ds_read_b64_tr_b16 a[94:95], v3 offset:54656
    v_mfma_f32_16x16x32_bf16 v[44:47], a[124:127], v[248:251], v[44:47]
    s_waitcnt lgkmcnt(12)
    buffer_load_dwordx4 v7, s[28:31], s45 offen offset:3456 lds
    v_mfma_f32_16x16x32_bf16 v[16:19], a[64:67], v[128:131], 0
    ds_read_b64_tr_b16 a[96:97], v3 offset:36896
    v_cvt_pk_bf16_f32 v48, v32, v33
    v_mfma_f32_16x16x32_bf16 v[16:19], a[68:71], v[136:139], v[16:19]
    s_waitcnt lgkmcnt(9)
    ds_read_b64_tr_b16 a[98:99], v3 offset:37024
    v_cvt_pk_bf16_f32 v49, v34, v35
    v_mfma_f32_16x16x32_bf16 v[16:19], a[72:75], v[144:147], v[16:19]
    ds_read_b64_tr_b16 a[100:101], v3 offset:37152
    v_cvt_pk_bf16_f32 v50, v40, v41
    v_mfma_f32_16x16x32_bf16 v[16:19], a[76:79], v[152:155], v[16:19]
    s_waitcnt lgkmcnt(7)
    ds_read_b64_tr_b16 a[102:103], v3 offset:37280
    v_cvt_pk_bf16_f32 v51, v42, v43
    v_mfma_f32_16x16x32_bf16 v[16:19], a[80:83], v[192:195], v[16:19]
    s_mov_b32 s54, 2048
    ds_read_b64_tr_b16 a[104:105], v3 offset:37408
    ds_read_b64_tr_b16 a[106:107], v3 offset:37536
    v_mfma_f32_16x16x32_bf16 v[16:19], a[84:87], v[200:203], v[16:19]
    s_waitcnt lgkmcnt(6)
    v_permlane32_swap_b32 v48, v50
    v_mfma_f32_16x16x32_bf16 v[16:19], a[88:91], v[208:211], v[16:19]
    v_permlane32_swap_b32 v49, v51
    v_mfma_f32_16x16x32_bf16 v[16:19], a[92:95], v[216:219], v[16:19]
    ds_read_b64_tr_b16 a[108:109], v3 offset:37664
    ds_read_b64_tr_b16 a[110:111], v3 offset:37792
    buffer_store_dwordx4 v[48:51], v10, s[40:43], s54 offen offset:512 sc1
    buffer_store_dwordx4 v[48:51], v10, s[32:35], s54 offen offset:512
    v_mfma_f32_16x16x32_bf16 v[20:23], a[64:67], v[160:163], 0
    ds_read_b64_tr_b16 a[112:113], v3 offset:53792
    v_cvt_pk_bf16_f32 v52, v36, v37
    v_mfma_f32_16x16x32_bf16 v[20:23], a[68:71], v[168:171], v[20:23]
    ds_read_b64_tr_b16 a[114:115], v3 offset:53920
    v_cvt_pk_bf16_f32 v53, v38, v39
    v_mfma_f32_16x16x32_bf16 v[20:23], a[72:75], v[176:179], v[20:23]
    ds_read_b64_tr_b16 a[116:117], v3 offset:54048
    v_cvt_pk_bf16_f32 v54, v44, v45
    v_mfma_f32_16x16x32_bf16 v[20:23], a[76:79], v[184:187], v[20:23]
    ds_read_b64_tr_b16 a[118:119], v3 offset:54176
    v_cvt_pk_bf16_f32 v55, v46, v47
    v_mfma_f32_16x16x32_bf16 v[20:23], a[80:83], v[224:227], v[20:23]
    s_mov_b32 s54, 296960
    ds_read_b64_tr_b16 a[120:121], v3 offset:54304
    ds_read_b64_tr_b16 a[122:123], v3 offset:54432
    v_mfma_f32_16x16x32_bf16 v[20:23], a[84:87], v[232:235], v[20:23]
    v_permlane32_swap_b32 v52, v54
    v_mfma_f32_16x16x32_bf16 v[20:23], a[88:91], v[240:243], v[20:23]
    v_permlane32_swap_b32 v53, v55
    v_mfma_f32_16x16x32_bf16 v[20:23], a[92:95], v[248:251], v[20:23]
    s_waitcnt lgkmcnt(10)
    ds_read_b64_tr_b16 a[124:125], v3 offset:54560
    ds_read_b64_tr_b16 a[126:127], v3 offset:54688
    buffer_store_dwordx4 v[52:55], v10, s[40:43], s54 offen offset:512 sc1
    buffer_store_dwordx4 v[52:55], v10, s[32:35], s54 offen offset:512
    v_mfma_f32_16x16x32_bf16 v[24:27], a[96:99], v[128:131], 0
    ds_read_b64_tr_b16 a[64:65], v3 offset:36928
    v_mfma_f32_16x16x32_bf16 v[24:27], a[100:103], v[136:139], v[24:27]
    s_waitcnt lgkmcnt(9)
    ds_read_b64_tr_b16 a[66:67], v3 offset:37056
    v_mfma_f32_16x16x32_bf16 v[24:27], a[104:107], v[144:147], v[24:27]
    ds_read_b64_tr_b16 a[68:69], v3 offset:37184
    v_mfma_f32_16x16x32_bf16 v[24:27], a[108:111], v[152:155], v[24:27]
    s_waitcnt lgkmcnt(7)
    ds_read_b64_tr_b16 a[70:71], v3 offset:37312
    v_mfma_f32_16x16x32_bf16 v[24:27], a[112:115], v[192:195], v[24:27]
    ds_read_b64_tr_b16 a[72:73], v3 offset:37440
    v_mfma_f32_16x16x32_bf16 v[24:27], a[116:119], v[200:203], v[24:27]
    s_waitcnt lgkmcnt(5)
    ds_read_b64_tr_b16 a[74:75], v3 offset:37568
    v_mfma_f32_16x16x32_bf16 v[24:27], a[120:123], v[208:211], v[24:27]
    ds_read_b64_tr_b16 a[76:77], v3 offset:37696
    v_mfma_f32_16x16x32_bf16 v[24:27], a[124:127], v[216:219], v[24:27]
    ds_read_b64_tr_b16 a[78:79], v3 offset:37824
    v_mfma_f32_16x16x32_bf16 v[28:31], a[96:99], v[160:163], 0
    ds_read_b64_tr_b16 a[80:81], v3 offset:53824
    v_mfma_f32_16x16x32_bf16 v[28:31], a[100:103], v[168:171], v[28:31]
    ds_read_b64_tr_b16 a[82:83], v3 offset:53952
    v_mfma_f32_16x16x32_bf16 v[28:31], a[104:107], v[176:179], v[28:31]
    ds_read_b64_tr_b16 a[84:85], v3 offset:54080
    v_mfma_f32_16x16x32_bf16 v[28:31], a[108:111], v[184:187], v[28:31]
    ds_read_b64_tr_b16 a[86:87], v3 offset:54208
    v_mfma_f32_16x16x32_bf16 v[28:31], a[112:115], v[224:227], v[28:31]
    ds_read_b64_tr_b16 a[88:89], v3 offset:54336
    v_mfma_f32_16x16x32_bf16 v[28:31], a[116:119], v[232:235], v[28:31]
    ds_read_b64_tr_b16 a[90:91], v3 offset:54464
    v_mfma_f32_16x16x32_bf16 v[28:31], a[120:123], v[240:243], v[28:31]
    ds_read_b64_tr_b16 a[92:93], v3 offset:54592
    v_mfma_f32_16x16x32_bf16 v[28:31], a[124:127], v[248:251], v[28:31]
    s_waitcnt lgkmcnt(11)
    ds_read_b64_tr_b16 a[94:95], v3 offset:54720
    v_mfma_f32_16x16x32_bf16 v[32:35], a[64:67], v[128:131], 0
    ds_read_b64_tr_b16 a[96:97], v3 offset:36960
    v_cvt_pk_bf16_f32 v48, v16, v17
    v_mfma_f32_16x16x32_bf16 v[32:35], a[68:71], v[136:139], v[32:35]
    s_waitcnt lgkmcnt(9)
    ds_read_b64_tr_b16 a[98:99], v3 offset:37088
    v_cvt_pk_bf16_f32 v49, v18, v19
    v_mfma_f32_16x16x32_bf16 v[32:35], a[72:75], v[144:147], v[32:35]
    ds_read_b64_tr_b16 a[100:101], v3 offset:37216
    v_cvt_pk_bf16_f32 v50, v24, v25
    v_mfma_f32_16x16x32_bf16 v[32:35], a[76:79], v[152:155], v[32:35]
    s_waitcnt lgkmcnt(7)
    ds_read_b64_tr_b16 a[102:103], v3 offset:37344
    v_cvt_pk_bf16_f32 v51, v26, v27
    v_mfma_f32_16x16x32_bf16 v[32:35], a[80:83], v[192:195], v[32:35]
    s_mov_b32 s54, 3072
    ds_read_b64_tr_b16 a[104:105], v3 offset:37472
    ds_read_b64_tr_b16 a[106:107], v3 offset:37600
    v_mfma_f32_16x16x32_bf16 v[32:35], a[84:87], v[200:203], v[32:35]
    s_waitcnt lgkmcnt(6)
    v_permlane32_swap_b32 v48, v50
    v_mfma_f32_16x16x32_bf16 v[32:35], a[88:91], v[208:211], v[32:35]
    v_permlane32_swap_b32 v49, v51
    v_mfma_f32_16x16x32_bf16 v[32:35], a[92:95], v[216:219], v[32:35]
    ds_read_b64_tr_b16 a[108:109], v3 offset:37728
    ds_read_b64_tr_b16 a[110:111], v3 offset:37856
    buffer_store_dwordx4 v[48:51], v10, s[40:43], s54 offen offset:0 sc1
    buffer_store_dwordx4 v[48:51], v10, s[32:35], s54 offen offset:0
    v_mfma_f32_16x16x32_bf16 v[36:39], a[64:67], v[160:163], 0
    ds_read_b64_tr_b16 a[112:113], v3 offset:53856
    v_cvt_pk_bf16_f32 v52, v20, v21
    v_mfma_f32_16x16x32_bf16 v[36:39], a[68:71], v[168:171], v[36:39]
    ds_read_b64_tr_b16 a[114:115], v3 offset:53984
    v_cvt_pk_bf16_f32 v53, v22, v23
    v_mfma_f32_16x16x32_bf16 v[36:39], a[72:75], v[176:179], v[36:39]
    ds_read_b64_tr_b16 a[116:117], v3 offset:54112
    v_cvt_pk_bf16_f32 v54, v28, v29
    v_mfma_f32_16x16x32_bf16 v[36:39], a[76:79], v[184:187], v[36:39]
    ds_read_b64_tr_b16 a[118:119], v3 offset:54240
    v_cvt_pk_bf16_f32 v55, v30, v31
    v_mfma_f32_16x16x32_bf16 v[36:39], a[80:83], v[224:227], v[36:39]
    s_mov_b32 s54, 297984
    ds_read_b64_tr_b16 a[120:121], v3 offset:54368
    ds_read_b64_tr_b16 a[122:123], v3 offset:54496
    v_mfma_f32_16x16x32_bf16 v[36:39], a[84:87], v[232:235], v[36:39]
    v_permlane32_swap_b32 v52, v54
    v_mfma_f32_16x16x32_bf16 v[36:39], a[88:91], v[240:243], v[36:39]
    v_permlane32_swap_b32 v53, v55
    v_mfma_f32_16x16x32_bf16 v[36:39], a[92:95], v[248:251], v[36:39]
    s_waitcnt vmcnt(15)
    s_barrier
    s_waitcnt lgkmcnt(10)
    ds_read_b64_tr_b16 a[124:125], v3 offset:54624
    ds_read_b64_tr_b16 a[126:127], v3 offset:54752
    buffer_store_dwordx4 v[52:55], v10, s[40:43], s54 offen offset:0 sc1
    buffer_store_dwordx4 v[52:55], v10, s[32:35], s54 offen offset:0
    v_mfma_f32_16x16x32_bf16 v[40:43], a[96:99], v[128:131], 0
    s_add_u32 m0, s44, 0
    ds_read_b64_tr_b16 a[64:65], v4 offset:0
    ds_read_b64_tr_b16 a[66:67], v4 offset:128
    v_mfma_f32_16x16x32_bf16 v[40:43], a[100:103], v[136:139], v[40:43]
    s_mov_b32 s45, 768
    s_waitcnt lgkmcnt(10)
    buffer_load_dwordx4 v7, s[28:31], s45 offen offset:0 lds
    v_mfma_f32_16x16x32_bf16 v[40:43], a[104:107], v[144:147], v[40:43]
    s_add_u32 m0, s44, -96
    ds_read_b64_tr_b16 a[68:69], v4 offset:256
    ds_read_b64_tr_b16 a[70:71], v4 offset:384
    v_mfma_f32_16x16x32_bf16 v[40:43], a[108:111], v[152:155], v[40:43]
    s_waitcnt lgkmcnt(8)
    buffer_load_dwordx4 v7, s[28:31], s45 offen offset:1152 lds
    v_mfma_f32_16x16x32_bf16 v[40:43], a[112:115], v[192:195], v[40:43]
    s_add_u32 m0, s44, -192
    ds_read_b64_tr_b16 a[72:73], v4 offset:512
    ds_read_b64_tr_b16 a[74:75], v4 offset:640
    v_mfma_f32_16x16x32_bf16 v[40:43], a[116:119], v[200:203], v[40:43]
    s_waitcnt lgkmcnt(6)
    buffer_load_dwordx4 v7, s[28:31], s45 offen offset:2304 lds
    v_mfma_f32_16x16x32_bf16 v[40:43], a[120:123], v[208:211], v[40:43]
    s_add_u32 m0, s44, -288
    ds_read_b64_tr_b16 a[76:77], v4 offset:768
    ds_read_b64_tr_b16 a[78:79], v4 offset:896
    v_mfma_f32_16x16x32_bf16 v[40:43], a[124:127], v[216:219], v[40:43]
    buffer_load_dwordx4 v7, s[28:31], s45 offen offset:3456 lds
    v_mfma_f32_16x16x32_bf16 v[44:47], a[96:99], v[160:163], 0
    s_add_u32 m0, s44, 16896
    ds_read_b64_tr_b16 a[80:81], v4 offset:16896
    ds_read_b64_tr_b16 a[82:83], v4 offset:17024
    v_mfma_f32_16x16x32_bf16 v[44:47], a[100:103], v[168:171], v[44:47]
    s_mov_b32 s45, 148224
    buffer_load_dwordx4 v7, s[28:31], s45 offen offset:0 lds
    v_mfma_f32_16x16x32_bf16 v[44:47], a[104:107], v[176:179], v[44:47]
    s_add_u32 m0, s44, 16800
    ds_read_b64_tr_b16 a[84:85], v4 offset:17152
    ds_read_b64_tr_b16 a[86:87], v4 offset:17280
    v_mfma_f32_16x16x32_bf16 v[44:47], a[108:111], v[184:187], v[44:47]
    buffer_load_dwordx4 v7, s[28:31], s45 offen offset:1152 lds
    v_mfma_f32_16x16x32_bf16 v[44:47], a[112:115], v[224:227], v[44:47]
    s_add_u32 m0, s44, 16704
    ds_read_b64_tr_b16 a[88:89], v4 offset:17408
    ds_read_b64_tr_b16 a[90:91], v4 offset:17536
    v_mfma_f32_16x16x32_bf16 v[44:47], a[116:119], v[232:235], v[44:47]
    buffer_load_dwordx4 v7, s[28:31], s45 offen offset:2304 lds
    v_mfma_f32_16x16x32_bf16 v[44:47], a[120:123], v[240:243], v[44:47]
    s_add_u32 m0, s44, 16608
    ds_read_b64_tr_b16 a[92:93], v4 offset:17664
    ds_read_b64_tr_b16 a[94:95], v4 offset:17792
    v_mfma_f32_16x16x32_bf16 v[44:47], a[124:127], v[248:251], v[44:47]
    s_waitcnt lgkmcnt(12)
    buffer_load_dwordx4 v7, s[28:31], s45 offen offset:3456 lds
    v_mfma_f32_16x16x32_bf16 v[16:19], a[64:67], v[128:131], 0
    ds_read_b64_tr_b16 a[96:97], v4 offset:32
    v_cvt_pk_bf16_f32 v48, v32, v33
    v_mfma_f32_16x16x32_bf16 v[16:19], a[68:71], v[136:139], v[16:19]
    s_waitcnt lgkmcnt(9)
    ds_read_b64_tr_b16 a[98:99], v4 offset:160
    v_cvt_pk_bf16_f32 v49, v34, v35
    v_mfma_f32_16x16x32_bf16 v[16:19], a[72:75], v[144:147], v[16:19]
    ds_read_b64_tr_b16 a[100:101], v4 offset:288
    v_cvt_pk_bf16_f32 v50, v40, v41
    v_mfma_f32_16x16x32_bf16 v[16:19], a[76:79], v[152:155], v[16:19]
    s_waitcnt lgkmcnt(7)
    ds_read_b64_tr_b16 a[102:103], v4 offset:416
    v_cvt_pk_bf16_f32 v51, v42, v43
    v_mfma_f32_16x16x32_bf16 v[16:19], a[80:83], v[192:195], v[16:19]
    s_mov_b32 s54, 3072
    ds_read_b64_tr_b16 a[104:105], v4 offset:544
    ds_read_b64_tr_b16 a[106:107], v4 offset:672
    v_mfma_f32_16x16x32_bf16 v[16:19], a[84:87], v[200:203], v[16:19]
    s_waitcnt lgkmcnt(6)
    v_permlane32_swap_b32 v48, v50
    v_mfma_f32_16x16x32_bf16 v[16:19], a[88:91], v[208:211], v[16:19]
    v_permlane32_swap_b32 v49, v51
    v_mfma_f32_16x16x32_bf16 v[16:19], a[92:95], v[216:219], v[16:19]
    ds_read_b64_tr_b16 a[108:109], v4 offset:800
    ds_read_b64_tr_b16 a[110:111], v4 offset:928
    buffer_store_dwordx4 v[48:51], v10, s[40:43], s54 offen offset:512 sc1
    buffer_store_dwordx4 v[48:51], v10, s[32:35], s54 offen offset:512
    v_mfma_f32_16x16x32_bf16 v[20:23], a[64:67], v[160:163], 0
    ds_read_b64_tr_b16 a[112:113], v4 offset:16928
    v_cvt_pk_bf16_f32 v52, v36, v37
    v_mfma_f32_16x16x32_bf16 v[20:23], a[68:71], v[168:171], v[20:23]
    ds_read_b64_tr_b16 a[114:115], v4 offset:17056
    v_cvt_pk_bf16_f32 v53, v38, v39
    v_mfma_f32_16x16x32_bf16 v[20:23], a[72:75], v[176:179], v[20:23]
    ds_read_b64_tr_b16 a[116:117], v4 offset:17184
    v_cvt_pk_bf16_f32 v54, v44, v45
    v_mfma_f32_16x16x32_bf16 v[20:23], a[76:79], v[184:187], v[20:23]
    ds_read_b64_tr_b16 a[118:119], v4 offset:17312
    v_cvt_pk_bf16_f32 v55, v46, v47
    v_mfma_f32_16x16x32_bf16 v[20:23], a[80:83], v[224:227], v[20:23]
    s_mov_b32 s54, 297984
    ds_read_b64_tr_b16 a[120:121], v4 offset:17440
    ds_read_b64_tr_b16 a[122:123], v4 offset:17568
    v_mfma_f32_16x16x32_bf16 v[20:23], a[84:87], v[232:235], v[20:23]
    v_permlane32_swap_b32 v52, v54
    v_mfma_f32_16x16x32_bf16 v[20:23], a[88:91], v[240:243], v[20:23]
    v_permlane32_swap_b32 v53, v55
    v_mfma_f32_16x16x32_bf16 v[20:23], a[92:95], v[248:251], v[20:23]
    s_waitcnt lgkmcnt(10)
    ds_read_b64_tr_b16 a[124:125], v4 offset:17696
    ds_read_b64_tr_b16 a[126:127], v4 offset:17824
    buffer_store_dwordx4 v[52:55], v10, s[40:43], s54 offen offset:512 sc1
    buffer_store_dwordx4 v[52:55], v10, s[32:35], s54 offen offset:512
    v_mfma_f32_16x16x32_bf16 v[24:27], a[96:99], v[128:131], 0
    ds_read_b64_tr_b16 a[64:65], v4 offset:64
    v_mfma_f32_16x16x32_bf16 v[24:27], a[100:103], v[136:139], v[24:27]
    s_waitcnt lgkmcnt(9)
    ds_read_b64_tr_b16 a[66:67], v4 offset:192
    v_mfma_f32_16x16x32_bf16 v[24:27], a[104:107], v[144:147], v[24:27]
    ds_read_b64_tr_b16 a[68:69], v4 offset:320
    v_mfma_f32_16x16x32_bf16 v[24:27], a[108:111], v[152:155], v[24:27]
    s_waitcnt lgkmcnt(7)
    ds_read_b64_tr_b16 a[70:71], v4 offset:448
    v_mfma_f32_16x16x32_bf16 v[24:27], a[112:115], v[192:195], v[24:27]
    ds_read_b64_tr_b16 a[72:73], v4 offset:576
    v_mfma_f32_16x16x32_bf16 v[24:27], a[116:119], v[200:203], v[24:27]
    s_waitcnt lgkmcnt(5)
    ds_read_b64_tr_b16 a[74:75], v4 offset:704
    v_mfma_f32_16x16x32_bf16 v[24:27], a[120:123], v[208:211], v[24:27]
    ds_read_b64_tr_b16 a[76:77], v4 offset:832
    v_mfma_f32_16x16x32_bf16 v[24:27], a[124:127], v[216:219], v[24:27]
    ds_read_b64_tr_b16 a[78:79], v4 offset:960
    v_mfma_f32_16x16x32_bf16 v[28:31], a[96:99], v[160:163], 0
    ds_read_b64_tr_b16 a[80:81], v4 offset:16960
    v_mfma_f32_16x16x32_bf16 v[28:31], a[100:103], v[168:171], v[28:31]
    ds_read_b64_tr_b16 a[82:83], v4 offset:17088
    v_mfma_f32_16x16x32_bf16 v[28:31], a[104:107], v[176:179], v[28:31]
    ds_read_b64_tr_b16 a[84:85], v4 offset:17216
    v_mfma_f32_16x16x32_bf16 v[28:31], a[108:111], v[184:187], v[28:31]
    ds_read_b64_tr_b16 a[86:87], v4 offset:17344
    v_mfma_f32_16x16x32_bf16 v[28:31], a[112:115], v[224:227], v[28:31]
    ds_read_b64_tr_b16 a[88:89], v4 offset:17472
    v_mfma_f32_16x16x32_bf16 v[28:31], a[116:119], v[232:235], v[28:31]
    ds_read_b64_tr_b16 a[90:91], v4 offset:17600
    v_mfma_f32_16x16x32_bf16 v[28:31], a[120:123], v[240:243], v[28:31]
    ds_read_b64_tr_b16 a[92:93], v4 offset:17728
    v_mfma_f32_16x16x32_bf16 v[28:31], a[124:127], v[248:251], v[28:31]
    s_waitcnt lgkmcnt(11)
    ds_read_b64_tr_b16 a[94:95], v4 offset:17856
    v_mfma_f32_16x16x32_bf16 v[32:35], a[64:67], v[128:131], 0
    ds_read_b64_tr_b16 a[96:97], v4 offset:96
    v_cvt_pk_bf16_f32 v48, v16, v17
    v_mfma_f32_16x16x32_bf16 v[32:35], a[68:71], v[136:139], v[32:35]
    s_waitcnt lgkmcnt(9)
    ds_read_b64_tr_b16 a[98:99], v4 offset:224
    v_cvt_pk_bf16_f32 v49, v18, v19
    v_mfma_f32_16x16x32_bf16 v[32:35], a[72:75], v[144:147], v[32:35]
    ds_read_b64_tr_b16 a[100:101], v4 offset:352
    v_cvt_pk_bf16_f32 v50, v24, v25
    v_mfma_f32_16x16x32_bf16 v[32:35], a[76:79], v[152:155], v[32:35]
    s_waitcnt lgkmcnt(7)
    ds_read_b64_tr_b16 a[102:103], v4 offset:480
    v_cvt_pk_bf16_f32 v51, v26, v27
    v_mfma_f32_16x16x32_bf16 v[32:35], a[80:83], v[192:195], v[32:35]
    s_mov_b32 s54, 4096
    ds_read_b64_tr_b16 a[104:105], v4 offset:608
    ds_read_b64_tr_b16 a[106:107], v4 offset:736
    v_mfma_f32_16x16x32_bf16 v[32:35], a[84:87], v[200:203], v[32:35]
    s_waitcnt lgkmcnt(6)
    v_permlane32_swap_b32 v48, v50
    v_mfma_f32_16x16x32_bf16 v[32:35], a[88:91], v[208:211], v[32:35]
    v_permlane32_swap_b32 v49, v51
    v_mfma_f32_16x16x32_bf16 v[32:35], a[92:95], v[216:219], v[32:35]
    ds_read_b64_tr_b16 a[108:109], v4 offset:864
    ds_read_b64_tr_b16 a[110:111], v4 offset:992
    buffer_store_dwordx4 v[48:51], v10, s[40:43], s54 offen offset:0 sc1
    buffer_store_dwordx4 v[48:51], v10, s[32:35], s54 offen offset:0
    v_mfma_f32_16x16x32_bf16 v[36:39], a[64:67], v[160:163], 0
    ds_read_b64_tr_b16 a[112:113], v4 offset:16992
    v_cvt_pk_bf16_f32 v52, v20, v21
    v_mfma_f32_16x16x32_bf16 v[36:39], a[68:71], v[168:171], v[36:39]
    ds_read_b64_tr_b16 a[114:115], v4 offset:17120
    v_cvt_pk_bf16_f32 v53, v22, v23
    v_mfma_f32_16x16x32_bf16 v[36:39], a[72:75], v[176:179], v[36:39]
    ds_read_b64_tr_b16 a[116:117], v4 offset:17248
    v_cvt_pk_bf16_f32 v54, v28, v29
    v_mfma_f32_16x16x32_bf16 v[36:39], a[76:79], v[184:187], v[36:39]
    ds_read_b64_tr_b16 a[118:119], v4 offset:17376
    v_cvt_pk_bf16_f32 v55, v30, v31
    v_mfma_f32_16x16x32_bf16 v[36:39], a[80:83], v[224:227], v[36:39]
    s_mov_b32 s54, 299008
    ds_read_b64_tr_b16 a[120:121], v4 offset:17504
    ds_read_b64_tr_b16 a[122:123], v4 offset:17632
    v_mfma_f32_16x16x32_bf16 v[36:39], a[84:87], v[232:235], v[36:39]
    v_permlane32_swap_b32 v52, v54
    v_mfma_f32_16x16x32_bf16 v[36:39], a[88:91], v[240:243], v[36:39]
    v_permlane32_swap_b32 v53, v55
    v_mfma_f32_16x16x32_bf16 v[36:39], a[92:95], v[248:251], v[36:39]
    s_waitcnt vmcnt(15)
    s_barrier
    s_waitcnt lgkmcnt(10)
    ds_read_b64_tr_b16 a[124:125], v4 offset:17760
    ds_read_b64_tr_b16 a[126:127], v4 offset:17888
    buffer_store_dwordx4 v[52:55], v10, s[40:43], s54 offen offset:0 sc1
    buffer_store_dwordx4 v[52:55], v10, s[32:35], s54 offen offset:0
    v_mfma_f32_16x16x32_bf16 v[40:43], a[96:99], v[128:131], 0
    s_add_u32 m0, s44, 36864
    ds_read_b64_tr_b16 a[64:65], v4 offset:36864
    ds_read_b64_tr_b16 a[66:67], v4 offset:36992
    v_mfma_f32_16x16x32_bf16 v[40:43], a[100:103], v[136:139], v[40:43]
    s_mov_b32 s45, 896
    s_waitcnt lgkmcnt(10)
    buffer_load_dwordx4 v7, s[28:31], s45 offen offset:0 lds
    v_mfma_f32_16x16x32_bf16 v[40:43], a[104:107], v[144:147], v[40:43]
    s_add_u32 m0, s44, 36768
    ds_read_b64_tr_b16 a[68:69], v4 offset:37120
    ds_read_b64_tr_b16 a[70:71], v4 offset:37248
    v_mfma_f32_16x16x32_bf16 v[40:43], a[108:111], v[152:155], v[40:43]
    s_waitcnt lgkmcnt(8)
    buffer_load_dwordx4 v7, s[28:31], s45 offen offset:1152 lds
    v_mfma_f32_16x16x32_bf16 v[40:43], a[112:115], v[192:195], v[40:43]
    s_add_u32 m0, s44, 36672
    ds_read_b64_tr_b16 a[72:73], v4 offset:37376
    ds_read_b64_tr_b16 a[74:75], v4 offset:37504
    v_mfma_f32_16x16x32_bf16 v[40:43], a[116:119], v[200:203], v[40:43]
    s_waitcnt lgkmcnt(6)
    buffer_load_dwordx4 v7, s[28:31], s45 offen offset:2304 lds
    v_mfma_f32_16x16x32_bf16 v[40:43], a[120:123], v[208:211], v[40:43]
    s_add_u32 m0, s44, 36576
    ds_read_b64_tr_b16 a[76:77], v4 offset:37632
    ds_read_b64_tr_b16 a[78:79], v4 offset:37760
    v_mfma_f32_16x16x32_bf16 v[40:43], a[124:127], v[216:219], v[40:43]
    buffer_load_dwordx4 v7, s[28:31], s45 offen offset:3456 lds
    v_mfma_f32_16x16x32_bf16 v[44:47], a[96:99], v[160:163], 0
    s_add_u32 m0, s44, 53760
    ds_read_b64_tr_b16 a[80:81], v4 offset:53760
    ds_read_b64_tr_b16 a[82:83], v4 offset:53888
    v_mfma_f32_16x16x32_bf16 v[44:47], a[100:103], v[168:171], v[44:47]
    s_mov_b32 s45, 148352
    buffer_load_dwordx4 v7, s[28:31], s45 offen offset:0 lds
    v_mfma_f32_16x16x32_bf16 v[44:47], a[104:107], v[176:179], v[44:47]
    s_add_u32 m0, s44, 53664
    ds_read_b64_tr_b16 a[84:85], v4 offset:54016
    ds_read_b64_tr_b16 a[86:87], v4 offset:54144
    v_mfma_f32_16x16x32_bf16 v[44:47], a[108:111], v[184:187], v[44:47]
    buffer_load_dwordx4 v7, s[28:31], s45 offen offset:1152 lds
    v_mfma_f32_16x16x32_bf16 v[44:47], a[112:115], v[224:227], v[44:47]
    s_add_u32 m0, s44, 53568
    ds_read_b64_tr_b16 a[88:89], v4 offset:54272
    ds_read_b64_tr_b16 a[90:91], v4 offset:54400
    v_mfma_f32_16x16x32_bf16 v[44:47], a[116:119], v[232:235], v[44:47]
    buffer_load_dwordx4 v7, s[28:31], s45 offen offset:2304 lds
    v_mfma_f32_16x16x32_bf16 v[44:47], a[120:123], v[240:243], v[44:47]
    s_add_u32 m0, s44, 53472
    ds_read_b64_tr_b16 a[92:93], v4 offset:54528
    ds_read_b64_tr_b16 a[94:95], v4 offset:54656
    v_mfma_f32_16x16x32_bf16 v[44:47], a[124:127], v[248:251], v[44:47]
    s_waitcnt lgkmcnt(12)
    buffer_load_dwordx4 v7, s[28:31], s45 offen offset:3456 lds
    v_mfma_f32_16x16x32_bf16 v[16:19], a[64:67], v[128:131], 0
    ds_read_b64_tr_b16 a[96:97], v4 offset:36896
    v_cvt_pk_bf16_f32 v48, v32, v33
    v_mfma_f32_16x16x32_bf16 v[16:19], a[68:71], v[136:139], v[16:19]
    s_waitcnt lgkmcnt(9)
    ds_read_b64_tr_b16 a[98:99], v4 offset:37024
    v_cvt_pk_bf16_f32 v49, v34, v35
    v_mfma_f32_16x16x32_bf16 v[16:19], a[72:75], v[144:147], v[16:19]
    ds_read_b64_tr_b16 a[100:101], v4 offset:37152
    v_cvt_pk_bf16_f32 v50, v40, v41
    v_mfma_f32_16x16x32_bf16 v[16:19], a[76:79], v[152:155], v[16:19]
    s_waitcnt lgkmcnt(7)
    ds_read_b64_tr_b16 a[102:103], v4 offset:37280
    v_cvt_pk_bf16_f32 v51, v42, v43
    v_mfma_f32_16x16x32_bf16 v[16:19], a[80:83], v[192:195], v[16:19]
    s_mov_b32 s54, 4096
    ds_read_b64_tr_b16 a[104:105], v4 offset:37408
    ds_read_b64_tr_b16 a[106:107], v4 offset:37536
    v_mfma_f32_16x16x32_bf16 v[16:19], a[84:87], v[200:203], v[16:19]
    s_waitcnt lgkmcnt(6)
    v_permlane32_swap_b32 v48, v50
    v_mfma_f32_16x16x32_bf16 v[16:19], a[88:91], v[208:211], v[16:19]
    v_permlane32_swap_b32 v49, v51
    v_mfma_f32_16x16x32_bf16 v[16:19], a[92:95], v[216:219], v[16:19]
    ds_read_b64_tr_b16 a[108:109], v4 offset:37664
    ds_read_b64_tr_b16 a[110:111], v4 offset:37792
    buffer_store_dwordx4 v[48:51], v10, s[40:43], s54 offen offset:512 sc1
    buffer_store_dwordx4 v[48:51], v10, s[32:35], s54 offen offset:512
    v_mfma_f32_16x16x32_bf16 v[20:23], a[64:67], v[160:163], 0
    ds_read_b64_tr_b16 a[112:113], v4 offset:53792
    v_cvt_pk_bf16_f32 v52, v36, v37
    v_mfma_f32_16x16x32_bf16 v[20:23], a[68:71], v[168:171], v[20:23]
    ds_read_b64_tr_b16 a[114:115], v4 offset:53920
    v_cvt_pk_bf16_f32 v53, v38, v39
    v_mfma_f32_16x16x32_bf16 v[20:23], a[72:75], v[176:179], v[20:23]
    ds_read_b64_tr_b16 a[116:117], v4 offset:54048
    v_cvt_pk_bf16_f32 v54, v44, v45
    v_mfma_f32_16x16x32_bf16 v[20:23], a[76:79], v[184:187], v[20:23]
    ds_read_b64_tr_b16 a[118:119], v4 offset:54176
    v_cvt_pk_bf16_f32 v55, v46, v47
    v_mfma_f32_16x16x32_bf16 v[20:23], a[80:83], v[224:227], v[20:23]
    s_mov_b32 s54, 299008
    ds_read_b64_tr_b16 a[120:121], v4 offset:54304
    ds_read_b64_tr_b16 a[122:123], v4 offset:54432
    v_mfma_f32_16x16x32_bf16 v[20:23], a[84:87], v[232:235], v[20:23]
    v_permlane32_swap_b32 v52, v54
    v_mfma_f32_16x16x32_bf16 v[20:23], a[88:91], v[240:243], v[20:23]
    v_permlane32_swap_b32 v53, v55
    v_mfma_f32_16x16x32_bf16 v[20:23], a[92:95], v[248:251], v[20:23]
    s_waitcnt lgkmcnt(10)
    ds_read_b64_tr_b16 a[124:125], v4 offset:54560
    ds_read_b64_tr_b16 a[126:127], v4 offset:54688
    buffer_store_dwordx4 v[52:55], v10, s[40:43], s54 offen offset:512 sc1
    buffer_store_dwordx4 v[52:55], v10, s[32:35], s54 offen offset:512
    v_mfma_f32_16x16x32_bf16 v[24:27], a[96:99], v[128:131], 0
    ds_read_b64_tr_b16 a[64:65], v4 offset:36928
    v_mfma_f32_16x16x32_bf16 v[24:27], a[100:103], v[136:139], v[24:27]
    s_waitcnt lgkmcnt(9)
    ds_read_b64_tr_b16 a[66:67], v4 offset:37056
    v_mfma_f32_16x16x32_bf16 v[24:27], a[104:107], v[144:147], v[24:27]
    ds_read_b64_tr_b16 a[68:69], v4 offset:37184
    v_mfma_f32_16x16x32_bf16 v[24:27], a[108:111], v[152:155], v[24:27]
    s_waitcnt lgkmcnt(7)
    ds_read_b64_tr_b16 a[70:71], v4 offset:37312
    v_mfma_f32_16x16x32_bf16 v[24:27], a[112:115], v[192:195], v[24:27]
L2_pad11:
    s_cbranch_execz L2_walkret
    ds_read_b64_tr_b16 a[72:73], v4 offset:37440
    v_mfma_f32_16x16x32_bf16 v[24:27], a[116:119], v[200:203], v[24:27]
    s_waitcnt lgkmcnt(5)
    ds_read_b64_tr_b16 a[74:75], v4 offset:37568
    v_mfma_f32_16x16x32_bf16 v[24:27], a[120:123], v[208:211], v[24:27]
    ds_read_b64_tr_b16 a[76:77], v4 offset:37696
    v_mfma_f32_16x16x32_bf16 v[24:27], a[124:127], v[216:219], v[24:27]
    ds_read_b64_tr_b16 a[78:79], v4 offset:37824
    v_mfma_f32_16x16x32_bf16 v[28:31], a[96:99], v[160:163], 0
    ds_read_b64_tr_b16 a[80:81], v4 offset:53824
    v_mfma_f32_16x16x32_bf16 v[28:31], a[100:103], v[168:171], v[28:31]
    ds_read_b64_tr_b16 a[82:83], v4 offset:53952
    v_mfma_f32_16x16x32_bf16 v[28:31], a[104:107], v[176:179], v[28:31]
    ds_read_b64_tr_b16 a[84:85], v4 offset:54080
    v_mfma_f32_16x16x32_bf16 v[28:31], a[108:111], v[184:187], v[28:31]
    ds_read_b64_tr_b16 a[86:87], v4 offset:54208
    v_mfma_f32_16x16x32_bf16 v[28:31], a[112:115], v[224:227], v[28:31]
    ds_read_b64_tr_b16 a[88:89], v4 offset:54336
    v_mfma_f32_16x16x32_bf16 v[28:31], a[116:119], v[232:235], v[28:31]
    ds_read_b64_tr_b16 a[90:91], v4 offset:54464
    v_mfma_f32_16x16x32_bf16 v[28:31], a[120:123], v[240:243], v[28:31]
    ds_read_b64_tr_b16 a[92:93], v4 offset:54592
    v_mfma_f32_16x16x32_bf16 v[28:31], a[124:127], v[248:251], v[28:31]
    s_waitcnt lgkmcnt(11)
    ds_read_b64_tr_b16 a[94:95], v4 offset:54720
    v_mfma_f32_16x16x32_bf16 v[32:35], a[64:67], v[128:131], 0
    ds_read_b64_tr_b16 a[96:97], v4 offset:36960
    v_cvt_pk_bf16_f32 v48, v16, v17
    v_mfma_f32_16x16x32_bf16 v[32:35], a[68:71], v[136:139], v[32:35]
    s_waitcnt lgkmcnt(9)
    ds_read_b64_tr_b16 a[98:99], v4 offset:37088
    v_cvt_pk_bf16_f32 v49, v18, v19
    v_mfma_f32_16x16x32_bf16 v[32:35], a[72:75], v[144:147], v[32:35]
    ds_read_b64_tr_b16 a[100:101], v4 offset:37216
    v_cvt_pk_bf16_f32 v50, v24, v25
    v_mfma_f32_16x16x32_bf16 v[32:35], a[76:79], v[152:155], v[32:35]
    s_waitcnt lgkmcnt(7)
    ds_read_b64_tr_b16 a[102:103], v4 offset:37344
    v_cvt_pk_bf16_f32 v51, v26, v27
    v_mfma_f32_16x16x32_bf16 v[32:35], a[80:83], v[192:195], v[32:35]
    s_mov_b32 s54, 5120
    ds_read_b64_tr_b16 a[104:105], v4 offset:37472
    ds_read_b64_tr_b16 a[106:107], v4 offset:37600
    v_mfma_f32_16x16x32_bf16 v[32:35], a[84:87], v[200:203], v[32:35]
    s_waitcnt lgkmcnt(6)
    v_permlane32_swap_b32 v48, v50
    v_mfma_f32_16x16x32_bf16 v[32:35], a[88:91], v[208:211], v[32:35]
    v_permlane32_swap_b32 v49, v51
    v_mfma_f32_16x16x32_bf16 v[32:35], a[92:95], v[216:219], v[32:35]
    ds_read_b64_tr_b16 a[108:109], v4 offset:37728
    ds_read_b64_tr_b16 a[110:111], v4 offset:37856
    buffer_store_dwordx4 v[48:51], v10, s[40:43], s54 offen offset:0 sc1
    buffer_store_dwordx4 v[48:51], v10, s[32:35], s54 offen offset:0
    v_mfma_f32_16x16x32_bf16 v[36:39], a[64:67], v[160:163], 0
    ds_read_b64_tr_b16 a[112:113], v4 offset:53856
    v_cvt_pk_bf16_f32 v52, v20, v21
    v_mfma_f32_16x16x32_bf16 v[36:39], a[68:71], v[168:171], v[36:39]
    ds_read_b64_tr_b16 a[114:115], v4 offset:53984
    v_cvt_pk_bf16_f32 v53, v22, v23
    v_mfma_f32_16x16x32_bf16 v[36:39], a[72:75], v[176:179], v[36:39]
    ds_read_b64_tr_b16 a[116:117], v4 offset:54112
    v_cvt_pk_bf16_f32 v54, v28, v29
    v_mfma_f32_16x16x32_bf16 v[36:39], a[76:79], v[184:187], v[36:39]
    ds_read_b64_tr_b16 a[118:119], v4 offset:54240
    v_cvt_pk_bf16_f32 v55, v30, v31
    v_mfma_f32_16x16x32_bf16 v[36:39], a[80:83], v[224:227], v[36:39]
    s_mov_b32 s54, 300032
    ds_read_b64_tr_b16 a[120:121], v4 offset:54368
    ds_read_b64_tr_b16 a[122:123], v4 offset:54496
    v_mfma_f32_16x16x32_bf16 v[36:39], a[84:87], v[232:235], v[36:39]
    v_permlane32_swap_b32 v52, v54
    v_mfma_f32_16x16x32_bf16 v[36:39], a[88:91], v[240:243], v[36:39]
    v_permlane32_swap_b32 v53, v55
    v_mfma_f32_16x16x32_bf16 v[36:39], a[92:95], v[248:251], v[36:39]
    s_waitcnt vmcnt(15)
    s_barrier
    s_waitcnt lgkmcnt(10)
    ds_read_b64_tr_b16 a[124:125], v4 offset:54624
    ds_read_b64_tr_b16 a[126:127], v4 offset:54752
    buffer_store_dwordx4 v[52:55], v10, s[40:43], s54 offen offset:0 sc1
    buffer_store_dwordx4 v[52:55], v10, s[32:35], s54 offen offset:0
    v_mfma_f32_16x16x32_bf16 v[40:43], a[96:99], v[128:131], 0
    s_add_u32 m0, s44, 73728
    ds_read_b64_tr_b16 a[64:65], v3 offset:0
    ds_read_b64_tr_b16 a[66:67], v3 offset:128
    v_mfma_f32_16x16x32_bf16 v[40:43], a[100:103], v[136:139], v[40:43]
    s_mov_b32 s45, 1024
    s_waitcnt lgkmcnt(10)
    buffer_load_dwordx4 v7, s[28:31], s45 offen offset:0 lds
    v_mfma_f32_16x16x32_bf16 v[40:43], a[104:107], v[144:147], v[40:43]
    s_add_u32 m0, s44, 73632
    ds_read_b64_tr_b16 a[68:69], v3 offset:256
    ds_read_b64_tr_b16 a[70:71], v3 offset:384
    v_mfma_f32_16x16x32_bf16 v[40:43], a[108:111], v[152:155], v[40:43]
    s_waitcnt lgkmcnt(8)
    buffer_load_dwordx4 v7, s[28:31], s45 offen offset:1152 lds
    v_mfma_f32_16x16x32_bf16 v[40:43], a[112:115], v[192:195], v[40:43]
    s_add_u32 m0, s44, 73536
    ds_read_b64_tr_b16 a[72:73], v3 offset:512
    ds_read_b64_tr_b16 a[74:75], v3 offset:640
    v_mfma_f32_16x16x32_bf16 v[40:43], a[116:119], v[200:203], v[40:43]
    s_waitcnt lgkmcnt(6)
    buffer_load_dwordx4 v7, s[28:31], s45 offen offset:2304 lds
    v_mfma_f32_16x16x32_bf16 v[40:43], a[120:123], v[208:211], v[40:43]
    s_add_u32 m0, s44, 73440
    ds_read_b64_tr_b16 a[76:77], v3 offset:768
    ds_read_b64_tr_b16 a[78:79], v3 offset:896
    v_mfma_f32_16x16x32_bf16 v[40:43], a[124:127], v[216:219], v[40:43]
    buffer_load_dwordx4 v7, s[28:31], s45 offen offset:3456 lds
    v_mfma_f32_16x16x32_bf16 v[44:47], a[96:99], v[160:163], 0
    s_add_u32 m0, s44, 90624
    ds_read_b64_tr_b16 a[80:81], v3 offset:16896
    ds_read_b64_tr_b16 a[82:83], v3 offset:17024
    v_mfma_f32_16x16x32_bf16 v[44:47], a[100:103], v[168:171], v[44:47]
    s_mov_b32 s45, 148480
    buffer_load_dwordx4 v7, s[28:31], s45 offen offset:0 lds
    v_mfma_f32_16x16x32_bf16 v[44:47], a[104:107], v[176:179], v[44:47]
    s_add_u32 m0, s44, 90528
    ds_read_b64_tr_b16 a[84:85], v3 offset:17152
    ds_read_b64_tr_b16 a[86:87], v3 offset:17280
    v_mfma_f32_16x16x32_bf16 v[44:47], a[108:111], v[184:187], v[44:47]
    buffer_load_dwordx4 v7, s[28:31], s45 offen offset:1152 lds
    v_mfma_f32_16x16x32_bf16 v[44:47], a[112:115], v[224:227], v[44:47]
    s_add_u32 m0, s44, 90432
    ds_read_b64_tr_b16 a[88:89], v3 offset:17408
    ds_read_b64_tr_b16 a[90:91], v3 offset:17536
    v_mfma_f32_16x16x32_bf16 v[44:47], a[116:119], v[232:235], v[44:47]
    buffer_load_dwordx4 v7, s[28:31], s45 offen offset:2304 lds
    v_mfma_f32_16x16x32_bf16 v[44:47], a[120:123], v[240:243], v[44:47]
    s_add_u32 m0, s44, 90336
    ds_read_b64_tr_b16 a[92:93], v3 offset:17664
    ds_read_b64_tr_b16 a[94:95], v3 offset:17792
    v_mfma_f32_16x16x32_bf16 v[44:47], a[124:127], v[248:251], v[44:47]
    s_waitcnt lgkmcnt(12)
    buffer_load_dwordx4 v7, s[28:31], s45 offen offset:3456 lds
    v_mfma_f32_16x16x32_bf16 v[16:19], a[64:67], v[128:131], 0
    ds_read_b64_tr_b16 a[96:97], v3 offset:32
    v_cvt_pk_bf16_f32 v48, v32, v33
    v_mfma_f32_16x16x32_bf16 v[16:19], a[68:71], v[136:139], v[16:19]
    s_waitcnt lgkmcnt(9)
    ds_read_b64_tr_b16 a[98:99], v3 offset:160
    v_cvt_pk_bf16_f32 v49, v34, v35
    v_mfma_f32_16x16x32_bf16 v[16:19], a[72:75], v[144:147], v[16:19]
    ds_read_b64_tr_b16 a[100:101], v3 offset:288
    v_cvt_pk_bf16_f32 v50, v40, v41
    v_mfma_f32_16x16x32_bf16 v[16:19], a[76:79], v[152:155], v[16:19]
    s_waitcnt lgkmcnt(7)
    ds_read_b64_tr_b16 a[102:103], v3 offset:416
    v_cvt_pk_bf16_f32 v51, v42, v43
    v_mfma_f32_16x16x32_bf16 v[16:19], a[80:83], v[192:195], v[16:19]
    s_mov_b32 s54, 5120
    ds_read_b64_tr_b16 a[104:105], v3 offset:544
    ds_read_b64_tr_b16 a[106:107], v3 offset:672
    v_mfma_f32_16x16x32_bf16 v[16:19], a[84:87], v[200:203], v[16:19]
    s_waitcnt lgkmcnt(6)
    v_permlane32_swap_b32 v48, v50
    v_mfma_f32_16x16x32_bf16 v[16:19], a[88:91], v[208:211], v[16:19]
    v_permlane32_swap_b32 v49, v51
    v_mfma_f32_16x16x32_bf16 v[16:19], a[92:95], v[216:219], v[16:19]
    ds_read_b64_tr_b16 a[108:109], v3 offset:800
    ds_read_b64_tr_b16 a[110:111], v3 offset:928
    buffer_store_dwordx4 v[48:51], v10, s[40:43], s54 offen offset:512 sc1
    buffer_store_dwordx4 v[48:51], v10, s[32:35], s54 offen offset:512
    v_mfma_f32_16x16x32_bf16 v[20:23], a[64:67], v[160:163], 0
    ds_read_b64_tr_b16 a[112:113], v3 offset:16928
    v_cvt_pk_bf16_f32 v52, v36, v37
    v_mfma_f32_16x16x32_bf16 v[20:23], a[68:71], v[168:171], v[20:23]
    ds_read_b64_tr_b16 a[114:115], v3 offset:17056
    v_cvt_pk_bf16_f32 v53, v38, v39
    v_mfma_f32_16x16x32_bf16 v[20:23], a[72:75], v[176:179], v[20:23]
    ds_read_b64_tr_b16 a[116:117], v3 offset:17184
    v_cvt_pk_bf16_f32 v54, v44, v45
    v_mfma_f32_16x16x32_bf16 v[20:23], a[76:79], v[184:187], v[20:23]
    ds_read_b64_tr_b16 a[118:119], v3 offset:17312
    v_cvt_pk_bf16_f32 v55, v46, v47
    v_mfma_f32_16x16x32_bf16 v[20:23], a[80:83], v[224:227], v[20:23]
    s_mov_b32 s54, 300032
    ds_read_b64_tr_b16 a[120:121], v3 offset:17440
    ds_read_b64_tr_b16 a[122:123], v3 offset:17568
    v_mfma_f32_16x16x32_bf16 v[20:23], a[84:87], v[232:235], v[20:23]
    v_permlane32_swap_b32 v52, v54
    v_mfma_f32_16x16x32_bf16 v[20:23], a[88:91], v[240:243], v[20:23]
    v_permlane32_swap_b32 v53, v55
    v_mfma_f32_16x16x32_bf16 v[20:23], a[92:95], v[248:251], v[20:23]
    s_waitcnt lgkmcnt(10)
    ds_read_b64_tr_b16 a[124:125], v3 offset:17696
    ds_read_b64_tr_b16 a[126:127], v3 offset:17824
    buffer_store_dwordx4 v[52:55], v10, s[40:43], s54 offen offset:512 sc1
    buffer_store_dwordx4 v[52:55], v10, s[32:35], s54 offen offset:512
    v_mfma_f32_16x16x32_bf16 v[24:27], a[96:99], v[128:131], 0
    ds_read_b64_tr_b16 a[64:65], v3 offset:64
    v_mfma_f32_16x16x32_bf16 v[24:27], a[100:103], v[136:139], v[24:27]
    s_waitcnt lgkmcnt(9)
    ds_read_b64_tr_b16 a[66:67], v3 offset:192
    v_mfma_f32_16x16x32_bf16 v[24:27], a[104:107], v[144:147], v[24:27]
    ds_read_b64_tr_b16 a[68:69], v3 offset:320
    v_mfma_f32_16x16x32_bf16 v[24:27], a[108:111], v[152:155], v[24:27]
    s_waitcnt lgkmcnt(7)
    ds_read_b64_tr_b16 a[70:71], v3 offset:448
    v_mfma_f32_16x16x32_bf16 v[24:27], a[112:115], v[192:195], v[24:27]
    ds_read_b64_tr_b16 a[72:73], v3 offset:576
    v_mfma_f32_16x16x32_bf16 v[24:27], a[116:119], v[200:203], v[24:27]
    s_waitcnt lgkmcnt(5)
    ds_read_b64_tr_b16 a[74:75], v3 offset:704
    v_mfma_f32_16x16x32_bf16 v[24:27], a[120:123], v[208:211], v[24:27]
    ds_read_b64_tr_b16 a[76:77], v3 offset:832
    v_mfma_f32_16x16x32_bf16 v[24:27], a[124:127], v[216:219], v[24:27]
    ds_read_b64_tr_b16 a[78:79], v3 offset:960
    v_mfma_f32_16x16x32_bf16 v[28:31], a[96:99], v[160:163], 0
    ds_read_b64_tr_b16 a[80:81], v3 offset:16960
    v_mfma_f32_16x16x32_bf16 v[28:31], a[100:103], v[168:171], v[28:31]
    ds_read_b64_tr_b16 a[82:83], v3 offset:17088
    v_mfma_f32_16x16x32_bf16 v[28:31], a[104:107], v[176:179], v[28:31]
    ds_read_b64_tr_b16 a[84:85], v3 offset:17216
    v_mfma_f32_16x16x32_bf16 v[28:31], a[108:111], v[184:187], v[28:31]
    ds_read_b64_tr_b16 a[86:87], v3 offset:17344
    v_mfma_f32_16x16x32_bf16 v[28:31], a[112:115], v[224:227], v[28:31]
    ds_read_b64_tr_b16 a[88:89], v3 offset:17472
    v_mfma_f32_16x16x32_bf16 v[28:31], a[116:119], v[232:235], v[28:31]
    ds_read_b64_tr_b16 a[90:91], v3 offset:17600
    v_mfma_f32_16x16x32_bf16 v[28:31], a[120:123], v[240:243], v[28:31]
    ds_read_b64_tr_b16 a[92:93], v3 offset:17728
    v_mfma_f32_16x16x32_bf16 v[28:31], a[124:127], v[248:251], v[28:31]
    s_waitcnt lgkmcnt(11)
    ds_read_b64_tr_b16 a[94:95], v3 offset:17856
    v_mfma_f32_16x16x32_bf16 v[32:35], a[64:67], v[128:131], 0
    ds_read_b64_tr_b16 a[96:97], v3 offset:96
    v_cvt_pk_bf16_f32 v48, v16, v17
    v_mfma_f32_16x16x32_bf16 v[32:35], a[68:71], v[136:139], v[32:35]
    s_waitcnt lgkmcnt(9)
    ds_read_b64_tr_b16 a[98:99], v3 offset:224
    v_cvt_pk_bf16_f32 v49, v18, v19
    v_mfma_f32_16x16x32_bf16 v[32:35], a[72:75], v[144:147], v[32:35]
    ds_read_b64_tr_b16 a[100:101], v3 offset:352
    v_cvt_pk_bf16_f32 v50, v24, v25
    v_mfma_f32_16x16x32_bf16 v[32:35], a[76:79], v[152:155], v[32:35]
    s_waitcnt lgkmcnt(7)
    ds_read_b64_tr_b16 a[102:103], v3 offset:480
    v_cvt_pk_bf16_f32 v51, v26, v27
    v_mfma_f32_16x16x32_bf16 v[32:35], a[80:83], v[192:195], v[32:35]
    s_mov_b32 s54, 6144
    ds_read_b64_tr_b16 a[104:105], v3 offset:608
    ds_read_b64_tr_b16 a[106:107], v3 offset:736
    v_mfma_f32_16x16x32_bf16 v[32:35], a[84:87], v[200:203], v[32:35]
    s_waitcnt lgkmcnt(6)
    v_permlane32_swap_b32 v48, v50
    v_mfma_f32_16x16x32_bf16 v[32:35], a[88:91], v[208:211], v[32:35]
    v_permlane32_swap_b32 v49, v51
    v_mfma_f32_16x16x32_bf16 v[32:35], a[92:95], v[216:219], v[32:35]
    ds_read_b64_tr_b16 a[108:109], v3 offset:864
    ds_read_b64_tr_b16 a[110:111], v3 offset:992
    buffer_store_dwordx4 v[48:51], v10, s[40:43], s54 offen offset:0 sc1
    buffer_store_dwordx4 v[48:51], v10, s[32:35], s54 offen offset:0
    v_mfma_f32_16x16x32_bf16 v[36:39], a[64:67], v[160:163], 0
    ds_read_b64_tr_b16 a[112:113], v3 offset:16992
    v_cvt_pk_bf16_f32 v52, v20, v21
    v_mfma_f32_16x16x32_bf16 v[36:39], a[68:71], v[168:171], v[36:39]
    ds_read_b64_tr_b16 a[114:115], v3 offset:17120
    v_cvt_pk_bf16_f32 v53, v22, v23
    v_mfma_f32_16x16x32_bf16 v[36:39], a[72:75], v[176:179], v[36:39]
    ds_read_b64_tr_b16 a[116:117], v3 offset:17248
    v_cvt_pk_bf16_f32 v54, v28, v29
    v_mfma_f32_16x16x32_bf16 v[36:39], a[76:79], v[184:187], v[36:39]
    ds_read_b64_tr_b16 a[118:119], v3 offset:17376
    v_cvt_pk_bf16_f32 v55, v30, v31
    v_mfma_f32_16x16x32_bf16 v[36:39], a[80:83], v[224:227], v[36:39]
    s_mov_b32 s54, 301056
    ds_read_b64_tr_b16 a[120:121], v3 offset:17504
    ds_read_b64_tr_b16 a[122:123], v3 offset:17632
    v_mfma_f32_16x16x32_bf16 v[36:39], a[84:87], v[232:235], v[36:39]
    v_permlane32_swap_b32 v52, v54
    v_mfma_f32_16x16x32_bf16 v[36:39], a[88:91], v[240:243], v[36:39]
    v_permlane32_swap_b32 v53, v55
    v_mfma_f32_16x16x32_bf16 v[36:39], a[92:95], v[248:251], v[36:39]
    s_waitcnt vmcnt(15)
    s_barrier
    s_waitcnt lgkmcnt(10)
    ds_read_b64_tr_b16 a[124:125], v3 offset:17760
    ds_read_b64_tr_b16 a[126:127], v3 offset:17888
    buffer_store_dwordx4 v[52:55], v10, s[40:43], s54 offen offset:0 sc1
    buffer_store_dwordx4 v[52:55], v10, s[32:35], s54 offen offset:0
    v_mfma_f32_16x16x32_bf16 v[40:43], a[96:99], v[128:131], 0
    ds_read_b64_tr_b16 a[64:65], v3 offset:36864
    v_mfma_f32_16x16x32_bf16 v[40:43], a[100:103], v[136:139], v[40:43]
    s_waitcnt lgkmcnt(9)
    ds_read_b64_tr_b16 a[66:67], v3 offset:36992
    v_mfma_f32_16x16x32_bf16 v[40:43], a[104:107], v[144:147], v[40:43]
    ds_read_b64_tr_b16 a[68:69], v3 offset:37120
    v_mfma_f32_16x16x32_bf16 v[40:43], a[108:111], v[152:155], v[40:43]
    s_waitcnt lgkmcnt(7)
    ds_read_b64_tr_b16 a[70:71], v3 offset:37248
    v_mfma_f32_16x16x32_bf16 v[40:43], a[112:115], v[192:195], v[40:43]
    ds_read_b64_tr_b16 a[72:73], v3 offset:37376
    v_mfma_f32_16x16x32_bf16 v[40:43], a[116:119], v[200:203], v[40:43]
    s_waitcnt lgkmcnt(5)
    ds_read_b64_tr_b16 a[74:75], v3 offset:37504
    v_mfma_f32_16x16x32_bf16 v[40:43], a[120:123], v[208:211], v[40:43]
    ds_read_b64_tr_b16 a[76:77], v3 offset:37632
    v_mfma_f32_16x16x32_bf16 v[40:43], a[124:127], v[216:219], v[40:43]
    s_sub_u32 s28, s88, 4096
    s_subb_u32 s29, s89, 0
    ds_read_b64_tr_b16 a[78:79], v3 offset:37760
    v_mfma_f32_16x16x32_bf16 v[44:47], a[96:99], v[160:163], 0
    ds_read_b64_tr_b16 a[80:81], v3 offset:53760
    v_mfma_f32_16x16x32_bf16 v[44:47], a[100:103], v[168:171], v[44:47]
    ds_read_b64_tr_b16 a[82:83], v3 offset:53888
    v_mfma_f32_16x16x32_bf16 v[44:47], a[104:107], v[176:179], v[44:47]
    ds_read_b64_tr_b16 a[84:85], v3 offset:54016
    v_mfma_f32_16x16x32_bf16 v[44:47], a[108:111], v[184:187], v[44:47]
    ds_read_b64_tr_b16 a[86:87], v3 offset:54144
    v_mfma_f32_16x16x32_bf16 v[44:47], a[112:115], v[224:227], v[44:47]
    ds_read_b64_tr_b16 a[88:89], v3 offset:54272
    v_mfma_f32_16x16x32_bf16 v[44:47], a[116:119], v[232:235], v[44:47]
    ds_read_b64_tr_b16 a[90:91], v3 offset:54400
    v_mfma_f32_16x16x32_bf16 v[44:47], a[120:123], v[240:243], v[44:47]
    ds_read_b64_tr_b16 a[92:93], v3 offset:54528
    v_mfma_f32_16x16x32_bf16 v[44:47], a[124:127], v[248:251], v[44:47]
    s_mov_b32 s49, 0
    s_waitcnt lgkmcnt(11)
    ds_read_b64_tr_b16 a[94:95], v3 offset:54656
    v_mfma_f32_16x16x32_bf16 v[16:19], a[64:67], v[128:131], 0
    ds_read_b64_tr_b16 a[96:97], v3 offset:36896
    v_cvt_pk_bf16_f32 v48, v32, v33
    v_mfma_f32_16x16x32_bf16 v[16:19], a[68:71], v[136:139], v[16:19]
    s_waitcnt lgkmcnt(9)
    ds_read_b64_tr_b16 a[98:99], v3 offset:37024
    v_cvt_pk_bf16_f32 v49, v34, v35
    v_mfma_f32_16x16x32_bf16 v[16:19], a[72:75], v[144:147], v[16:19]
    ds_read_b64_tr_b16 a[100:101], v3 offset:37152
    v_cvt_pk_bf16_f32 v50, v40, v41
    v_mfma_f32_16x16x32_bf16 v[16:19], a[76:79], v[152:155], v[16:19]
    s_waitcnt lgkmcnt(7)
    ds_read_b64_tr_b16 a[102:103], v3 offset:37280
    v_cvt_pk_bf16_f32 v51, v42, v43
    v_mfma_f32_16x16x32_bf16 v[16:19], a[80:83], v[192:195], v[16:19]
    s_mov_b32 s54, 6144
    ds_read_b64_tr_b16 a[104:105], v3 offset:37408
    ds_read_b64_tr_b16 a[106:107], v3 offset:37536
    v_mfma_f32_16x16x32_bf16 v[16:19], a[84:87], v[200:203], v[16:19]
    s_waitcnt lgkmcnt(6)
    v_permlane32_swap_b32 v48, v50
    v_mfma_f32_16x16x32_bf16 v[16:19], a[88:91], v[208:211], v[16:19]
    v_permlane32_swap_b32 v49, v51
    v_mfma_f32_16x16x32_bf16 v[16:19], a[92:95], v[216:219], v[16:19]
    ds_read_b64_tr_b16 a[108:109], v3 offset:37664
    ds_read_b64_tr_b16 a[110:111], v3 offset:37792
    buffer_store_dwordx4 v[48:51], v10, s[40:43], s54 offen offset:512 sc1
    buffer_store_dwordx4 v[48:51], v10, s[32:35], s54 offen offset:512
    v_mfma_f32_16x16x32_bf16 v[20:23], a[64:67], v[160:163], 0
    ds_read_b64_tr_b16 a[112:113], v3 offset:53792
    v_cvt_pk_bf16_f32 v52, v36, v37
    v_mfma_f32_16x16x32_bf16 v[20:23], a[68:71], v[168:171], v[20:23]
    ds_read_b64_tr_b16 a[114:115], v3 offset:53920
    v_cvt_pk_bf16_f32 v53, v38, v39
    v_mfma_f32_16x16x32_bf16 v[20:23], a[72:75], v[176:179], v[20:23]
    ds_read_b64_tr_b16 a[116:117], v3 offset:54048
    v_cvt_pk_bf16_f32 v54, v44, v45
    v_mfma_f32_16x16x32_bf16 v[20:23], a[76:79], v[184:187], v[20:23]
    ds_read_b64_tr_b16 a[118:119], v3 offset:54176
    v_cvt_pk_bf16_f32 v55, v46, v47
    v_mfma_f32_16x16x32_bf16 v[20:23], a[80:83], v[224:227], v[20:23]
    s_mov_b32 s54, 301056
    ds_read_b64_tr_b16 a[120:121], v3 offset:54304
    ds_read_b64_tr_b16 a[122:123], v3 offset:54432
    v_mfma_f32_16x16x32_bf16 v[20:23], a[84:87], v[232:235], v[20:23]
    v_permlane32_swap_b32 v52, v54
    v_mfma_f32_16x16x32_bf16 v[20:23], a[88:91], v[240:243], v[20:23]
    v_permlane32_swap_b32 v53, v55
    v_mfma_f32_16x16x32_bf16 v[20:23], a[92:95], v[248:251], v[20:23]
    s_waitcnt lgkmcnt(10)
    ds_read_b64_tr_b16 a[124:125], v3 offset:54560
    ds_read_b64_tr_b16 a[126:127], v3 offset:54688
    buffer_store_dwordx4 v[52:55], v10, s[40:43], s54 offen offset:512 sc1
    buffer_store_dwordx4 v[52:55], v10, s[32:35], s54 offen offset:512
    v_mfma_f32_16x16x32_bf16 v[24:27], a[96:99], v[128:131], 0
    ds_read_b64_tr_b16 a[64:65], v3 offset:36928
    v_mfma_f32_16x16x32_bf16 v[24:27], a[100:103], v[136:139], v[24:27]
    s_waitcnt lgkmcnt(9)
    ds_read_b64_tr_b16 a[66:67], v3 offset:37056
    v_mfma_f32_16x16x32_bf16 v[24:27], a[104:107], v[144:147], v[24:27]
    ds_read_b64_tr_b16 a[68:69], v3 offset:37184
    v_mfma_f32_16x16x32_bf16 v[24:27], a[108:111], v[152:155], v[24:27]
    s_waitcnt lgkmcnt(7)
    ds_read_b64_tr_b16 a[70:71], v3 offset:37312
    v_mfma_f32_16x16x32_bf16 v[24:27], a[112:115], v[192:195], v[24:27]
    ds_read_b64_tr_b16 a[72:73], v3 offset:37440
    v_mfma_f32_16x16x32_bf16 v[24:27], a[116:119], v[200:203], v[24:27]
    s_waitcnt lgkmcnt(5)
    ds_read_b64_tr_b16 a[74:75], v3 offset:37568
    v_mfma_f32_16x16x32_bf16 v[24:27], a[120:123], v[208:211], v[24:27]
    ds_read_b64_tr_b16 a[76:77], v3 offset:37696
    v_mfma_f32_16x16x32_bf16 v[24:27], a[124:127], v[216:219], v[24:27]
    ds_read_b64_tr_b16 a[78:79], v3 offset:37824
    v_mfma_f32_16x16x32_bf16 v[28:31], a[96:99], v[160:163], 0
    ds_read_b64_tr_b16 a[80:81], v3 offset:53824
    v_mfma_f32_16x16x32_bf16 v[28:31], a[100:103], v[168:171], v[28:31]
    ds_read_b64_tr_b16 a[82:83], v3 offset:53952
    v_mfma_f32_16x16x32_bf16 v[28:31], a[104:107], v[176:179], v[28:31]
    ds_read_b64_tr_b16 a[84:85], v3 offset:54080
    v_mfma_f32_16x16x32_bf16 v[28:31], a[108:111], v[184:187], v[28:31]
    ds_read_b64_tr_b16 a[86:87], v3 offset:54208
    v_mfma_f32_16x16x32_bf16 v[28:31], a[112:115], v[224:227], v[28:31]
    ds_read_b64_tr_b16 a[88:89], v3 offset:54336
    v_mfma_f32_16x16x32_bf16 v[28:31], a[116:119], v[232:235], v[28:31]
    ds_read_b64_tr_b16 a[90:91], v3 offset:54464
    v_mfma_f32_16x16x32_bf16 v[28:31], a[120:123], v[240:243], v[28:31]
    ds_read_b64_tr_b16 a[92:93], v3 offset:54592
    v_mfma_f32_16x16x32_bf16 v[28:31], a[124:127], v[248:251], v[28:31]
    s_waitcnt lgkmcnt(11)
    ds_read_b64_tr_b16 a[94:95], v3 offset:54720
    v_mfma_f32_16x16x32_bf16 v[32:35], a[64:67], v[128:131], 0
    ds_read_b64_tr_b16 a[96:97], v3 offset:36960
    v_cvt_pk_bf16_f32 v48, v16, v17
    v_mfma_f32_16x16x32_bf16 v[32:35], a[68:71], v[136:139], v[32:35]
    s_waitcnt lgkmcnt(9)
    ds_read_b64_tr_b16 a[98:99], v3 offset:37088
    v_cvt_pk_bf16_f32 v49, v18, v19
    v_mfma_f32_16x16x32_bf16 v[32:35], a[72:75], v[144:147], v[32:35]
    ds_read_b64_tr_b16 a[100:101], v3 offset:37216
    v_cvt_pk_bf16_f32 v50, v24, v25
    v_mfma_f32_16x16x32_bf16 v[32:35], a[76:79], v[152:155], v[32:35]
    s_waitcnt lgkmcnt(7)
    ds_read_b64_tr_b16 a[102:103], v3 offset:37344
    v_cvt_pk_bf16_f32 v51, v26, v27
    v_mfma_f32_16x16x32_bf16 v[32:35], a[80:83], v[192:195], v[32:35]
    s_mov_b32 s54, 7168
    ds_read_b64_tr_b16 a[104:105], v3 offset:37472
    ds_read_b64_tr_b16 a[106:107], v3 offset:37600
    v_mfma_f32_16x16x32_bf16 v[32:35], a[84:87], v[200:203], v[32:35]
    s_waitcnt lgkmcnt(6)
    v_permlane32_swap_b32 v48, v50
    v_mfma_f32_16x16x32_bf16 v[32:35], a[88:91], v[208:211], v[32:35]
    v_permlane32_swap_b32 v49, v51
    v_mfma_f32_16x16x32_bf16 v[32:35], a[92:95], v[216:219], v[32:35]
    ds_read_b64_tr_b16 a[108:109], v3 offset:37728
    ds_read_b64_tr_b16 a[110:111], v3 offset:37856
    buffer_store_dwordx4 v[48:51], v10, s[40:43], s54 offen offset:0 sc1
    buffer_store_dwordx4 v[48:51], v10, s[32:35], s54 offen offset:0
    v_mfma_f32_16x16x32_bf16 v[36:39], a[64:67], v[160:163], 0
    ds_read_b64_tr_b16 a[112:113], v3 offset:53856
    v_cvt_pk_bf16_f32 v52, v20, v21
    v_mfma_f32_16x16x32_bf16 v[36:39], a[68:71], v[168:171], v[36:39]
    ds_read_b64_tr_b16 a[114:115], v3 offset:53984
    v_cvt_pk_bf16_f32 v53, v22, v23
    v_mfma_f32_16x16x32_bf16 v[36:39], a[72:75], v[176:179], v[36:39]
    ds_read_b64_tr_b16 a[116:117], v3 offset:54112
    v_cvt_pk_bf16_f32 v54, v28, v29
    v_mfma_f32_16x16x32_bf16 v[36:39], a[76:79], v[184:187], v[36:39]
    ds_read_b64_tr_b16 a[118:119], v3 offset:54240
    v_cvt_pk_bf16_f32 v55, v30, v31
    v_mfma_f32_16x16x32_bf16 v[36:39], a[80:83], v[224:227], v[36:39]
    s_mov_b32 s54, 302080
    ds_read_b64_tr_b16 a[120:121], v3 offset:54368
    ds_read_b64_tr_b16 a[122:123], v3 offset:54496
    v_mfma_f32_16x16x32_bf16 v[36:39], a[84:87], v[232:235], v[36:39]
    v_permlane32_swap_b32 v52, v54
    v_mfma_f32_16x16x32_bf16 v[36:39], a[88:91], v[240:243], v[36:39]
    v_permlane32_swap_b32 v53, v55
    v_mfma_f32_16x16x32_bf16 v[36:39], a[92:95], v[248:251], v[36:39]
    s_waitcnt vmcnt(7)
    s_barrier
    s_waitcnt lgkmcnt(10)
    ds_read_b64_tr_b16 a[124:125], v3 offset:54624
    ds_read_b64_tr_b16 a[126:127], v3 offset:54752
    buffer_store_dwordx4 v[52:55], v10, s[40:43], s54 offen offset:0 sc1
    buffer_store_dwordx4 v[52:55], v10, s[32:35], s54 offen offset:0
    v_mfma_f32_16x16x32_bf16 v[40:43], a[96:99], v[128:131], 0
    ds_read_b64_tr_b16 a[64:65], v4 offset:0
    v_mfma_f32_16x16x32_bf16 v[40:43], a[100:103], v[136:139], v[40:43]
    s_waitcnt lgkmcnt(9)
    ds_read_b64_tr_b16 a[66:67], v4 offset:128
    v_mfma_f32_16x16x32_bf16 v[40:43], a[104:107], v[144:147], v[40:43]
    ds_read_b64_tr_b16 a[68:69], v4 offset:256
    v_mfma_f32_16x16x32_bf16 v[40:43], a[108:111], v[152:155], v[40:43]
    s_waitcnt lgkmcnt(7)
    ds_read_b64_tr_b16 a[70:71], v4 offset:384
    v_mfma_f32_16x16x32_bf16 v[40:43], a[112:115], v[192:195], v[40:43]
    ds_read_b64_tr_b16 a[72:73], v4 offset:512
    v_mfma_f32_16x16x32_bf16 v[40:43], a[116:119], v[200:203], v[40:43]
    s_waitcnt lgkmcnt(5)
    ds_read_b64_tr_b16 a[74:75], v4 offset:640
    v_mfma_f32_16x16x32_bf16 v[40:43], a[120:123], v[208:211], v[40:43]
    ds_read_b64_tr_b16 a[76:77], v4 offset:768
    v_mfma_f32_16x16x32_bf16 v[40:43], a[124:127], v[216:219], v[40:43]
    ds_read_b64_tr_b16 a[78:79], v4 offset:896
    v_mfma_f32_16x16x32_bf16 v[44:47], a[96:99], v[160:163], 0
    ds_read_b64_tr_b16 a[80:81], v4 offset:16896
    v_mfma_f32_16x16x32_bf16 v[44:47], a[100:103], v[168:171], v[44:47]
    ds_read_b64_tr_b16 a[82:83], v4 offset:17024
    v_mfma_f32_16x16x32_bf16 v[44:47], a[104:107], v[176:179], v[44:47]
    ds_read_b64_tr_b16 a[84:85], v4 offset:17152
    v_mfma_f32_16x16x32_bf16 v[44:47], a[108:111], v[184:187], v[44:47]
    ds_read_b64_tr_b16 a[86:87], v4 offset:17280
    v_mfma_f32_16x16x32_bf16 v[44:47], a[112:115], v[224:227], v[44:47]
    ds_read_b64_tr_b16 a[88:89], v4 offset:17408
    v_mfma_f32_16x16x32_bf16 v[44:47], a[116:119], v[232:235], v[44:47]
    ds_read_b64_tr_b16 a[90:91], v4 offset:17536
    v_mfma_f32_16x16x32_bf16 v[44:47], a[120:123], v[240:243], v[44:47]
    ds_read_b64_tr_b16 a[92:93], v4 offset:17664
    v_mfma_f32_16x16x32_bf16 v[44:47], a[124:127], v[248:251], v[44:47]
    s_waitcnt lgkmcnt(11)
    ds_read_b64_tr_b16 a[94:95], v4 offset:17792
    v_mfma_f32_16x16x32_bf16 v[16:19], a[64:67], v[128:131], 0
    ds_read_b64_tr_b16 a[96:97], v4 offset:32
    v_cvt_pk_bf16_f32 v48, v32, v33
    v_mfma_f32_16x16x32_bf16 v[16:19], a[68:71], v[136:139], v[16:19]
    s_waitcnt lgkmcnt(9)
    ds_read_b64_tr_b16 a[98:99], v4 offset:160
    v_cvt_pk_bf16_f32 v49, v34, v35
    v_mfma_f32_16x16x32_bf16 v[16:19], a[72:75], v[144:147], v[16:19]
    ds_read_b64_tr_b16 a[100:101], v4 offset:288
    v_cvt_pk_bf16_f32 v50, v40, v41
    v_mfma_f32_16x16x32_bf16 v[16:19], a[76:79], v[152:155], v[16:19]
    s_waitcnt lgkmcnt(7)
    ds_read_b64_tr_b16 a[102:103], v4 offset:416
    v_cvt_pk_bf16_f32 v51, v42, v43
    v_mfma_f32_16x16x32_bf16 v[16:19], a[80:83], v[192:195], v[16:19]
    s_mov_b32 s54, 7168
    ds_read_b64_tr_b16 a[104:105], v4 offset:544
    ds_read_b64_tr_b16 a[106:107], v4 offset:672
    v_mfma_f32_16x16x32_bf16 v[16:19], a[84:87], v[200:203], v[16:19]
    s_waitcnt lgkmcnt(6)
    v_permlane32_swap_b32 v48, v50
    v_mfma_f32_16x16x32_bf16 v[16:19], a[88:91], v[208:211], v[16:19]
    v_permlane32_swap_b32 v49, v51
    v_mfma_f32_16x16x32_bf16 v[16:19], a[92:95], v[216:219], v[16:19]
    ds_read_b64_tr_b16 a[108:109], v4 offset:800
    ds_read_b64_tr_b16 a[110:111], v4 offset:928
    buffer_store_dwordx4 v[48:51], v10, s[40:43], s54 offen offset:512 sc1
    buffer_store_dwordx4 v[48:51], v10, s[32:35], s54 offen offset:512
    v_mfma_f32_16x16x32_bf16 v[20:23], a[64:67], v[160:163], 0
    ds_read_b64_tr_b16 a[112:113], v4 offset:16928
    v_cvt_pk_bf16_f32 v52, v36, v37
    v_mfma_f32_16x16x32_bf16 v[20:23], a[68:71], v[168:171], v[20:23]
    ds_read_b64_tr_b16 a[114:115], v4 offset:17056
    v_cvt_pk_bf16_f32 v53, v38, v39
    v_mfma_f32_16x16x32_bf16 v[20:23], a[72:75], v[176:179], v[20:23]
    ds_read_b64_tr_b16 a[116:117], v4 offset:17184
    v_cvt_pk_bf16_f32 v54, v44, v45
    v_mfma_f32_16x16x32_bf16 v[20:23], a[76:79], v[184:187], v[20:23]
    ds_read_b64_tr_b16 a[118:119], v4 offset:17312
    v_cvt_pk_bf16_f32 v55, v46, v47
    v_mfma_f32_16x16x32_bf16 v[20:23], a[80:83], v[224:227], v[20:23]
    s_mov_b32 s54, 302080
    ds_read_b64_tr_b16 a[120:121], v4 offset:17440
    ds_read_b64_tr_b16 a[122:123], v4 offset:17568
    v_mfma_f32_16x16x32_bf16 v[20:23], a[84:87], v[232:235], v[20:23]
    v_permlane32_swap_b32 v52, v54
    v_mfma_f32_16x16x32_bf16 v[20:23], a[88:91], v[240:243], v[20:23]
L2_pad12:
    s_cbranch_execz L2_walkret
    v_permlane32_swap_b32 v53, v55
    v_mfma_f32_16x16x32_bf16 v[20:23], a[92:95], v[248:251], v[20:23]
    s_waitcnt lgkmcnt(10)
    ds_read_b64_tr_b16 a[124:125], v4 offset:17696
    ds_read_b64_tr_b16 a[126:127], v4 offset:17824
    buffer_store_dwordx4 v[52:55], v10, s[40:43], s54 offen offset:512 sc1
    buffer_store_dwordx4 v[52:55], v10, s[32:35], s54 offen offset:512
    v_mfma_f32_16x16x32_bf16 v[24:27], a[96:99], v[128:131], 0
    ds_read_b64_tr_b16 a[64:65], v4 offset:64
    v_mfma_f32_16x16x32_bf16 v[24:27], a[100:103], v[136:139], v[24:27]
    s_waitcnt lgkmcnt(9)
    ds_read_b64_tr_b16 a[66:67], v4 offset:192
    v_mfma_f32_16x16x32_bf16 v[24:27], a[104:107], v[144:147], v[24:27]
    ds_read_b64_tr_b16 a[68:69], v4 offset:320
    v_mfma_f32_16x16x32_bf16 v[24:27], a[108:111], v[152:155], v[24:27]
    s_waitcnt lgkmcnt(7)
    ds_read_b64_tr_b16 a[70:71], v4 offset:448
    v_mfma_f32_16x16x32_bf16 v[24:27], a[112:115], v[192:195], v[24:27]
    ds_read_b64_tr_b16 a[72:73], v4 offset:576
    v_mfma_f32_16x16x32_bf16 v[24:27], a[116:119], v[200:203], v[24:27]
    s_waitcnt lgkmcnt(5)
    ds_read_b64_tr_b16 a[74:75], v4 offset:704
    v_mfma_f32_16x16x32_bf16 v[24:27], a[120:123], v[208:211], v[24:27]
    ds_read_b64_tr_b16 a[76:77], v4 offset:832
    v_mfma_f32_16x16x32_bf16 v[24:27], a[124:127], v[216:219], v[24:27]
    ds_read_b64_tr_b16 a[78:79], v4 offset:960
    v_mfma_f32_16x16x32_bf16 v[28:31], a[96:99], v[160:163], 0
    ds_read_b64_tr_b16 a[80:81], v4 offset:16960
    v_mfma_f32_16x16x32_bf16 v[28:31], a[100:103], v[168:171], v[28:31]
    ds_read_b64_tr_b16 a[82:83], v4 offset:17088
    v_mfma_f32_16x16x32_bf16 v[28:31], a[104:107], v[176:179], v[28:31]
    ds_read_b64_tr_b16 a[84:85], v4 offset:17216
    v_mfma_f32_16x16x32_bf16 v[28:31], a[108:111], v[184:187], v[28:31]
    ds_read_b64_tr_b16 a[86:87], v4 offset:17344
    v_mfma_f32_16x16x32_bf16 v[28:31], a[112:115], v[224:227], v[28:31]
    ds_read_b64_tr_b16 a[88:89], v4 offset:17472
    v_mfma_f32_16x16x32_bf16 v[28:31], a[116:119], v[232:235], v[28:31]
    ds_read_b64_tr_b16 a[90:91], v4 offset:17600
    v_mfma_f32_16x16x32_bf16 v[28:31], a[120:123], v[240:243], v[28:31]
    ds_read_b64_tr_b16 a[92:93], v4 offset:17728
    v_mfma_f32_16x16x32_bf16 v[28:31], a[124:127], v[248:251], v[28:31]
    s_waitcnt lgkmcnt(11)
    ds_read_b64_tr_b16 a[94:95], v4 offset:17856
    v_mfma_f32_16x16x32_bf16 v[32:35], a[64:67], v[128:131], 0
    ds_read_b64_tr_b16 a[96:97], v4 offset:96
    v_cvt_pk_bf16_f32 v48, v16, v17
    v_mfma_f32_16x16x32_bf16 v[32:35], a[68:71], v[136:139], v[32:35]
    s_waitcnt lgkmcnt(9)
    ds_read_b64_tr_b16 a[98:99], v4 offset:224
    v_cvt_pk_bf16_f32 v49, v18, v19
    v_mfma_f32_16x16x32_bf16 v[32:35], a[72:75], v[144:147], v[32:35]
    ds_read_b64_tr_b16 a[100:101], v4 offset:352
    v_cvt_pk_bf16_f32 v50, v24, v25
    v_mfma_f32_16x16x32_bf16 v[32:35], a[76:79], v[152:155], v[32:35]
    s_waitcnt lgkmcnt(7)
    ds_read_b64_tr_b16 a[102:103], v4 offset:480
    v_cvt_pk_bf16_f32 v51, v26, v27
    v_mfma_f32_16x16x32_bf16 v[32:35], a[80:83], v[192:195], v[32:35]
    s_mov_b32 s54, 8192
    ds_read_b64_tr_b16 a[104:105], v4 offset:608
    ds_read_b64_tr_b16 a[106:107], v4 offset:736
    v_mfma_f32_16x16x32_bf16 v[32:35], a[84:87], v[200:203], v[32:35]
    s_waitcnt lgkmcnt(6)
    v_permlane32_swap_b32 v48, v50
    v_mfma_f32_16x16x32_bf16 v[32:35], a[88:91], v[208:211], v[32:35]
    v_permlane32_swap_b32 v49, v51
    v_mfma_f32_16x16x32_bf16 v[32:35], a[92:95], v[216:219], v[32:35]
    ds_read_b64_tr_b16 a[108:109], v4 offset:864
    ds_read_b64_tr_b16 a[110:111], v4 offset:992
    buffer_store_dwordx4 v[48:51], v10, s[40:43], s54 offen offset:0 sc1
    buffer_store_dwordx4 v[48:51], v10, s[32:35], s54 offen offset:0
    v_mfma_f32_16x16x32_bf16 v[36:39], a[64:67], v[160:163], 0
    ds_read_b64_tr_b16 a[112:113], v4 offset:16992
    v_cvt_pk_bf16_f32 v52, v20, v21
    v_mfma_f32_16x16x32_bf16 v[36:39], a[68:71], v[168:171], v[36:39]
    ds_read_b64_tr_b16 a[114:115], v4 offset:17120
    v_cvt_pk_bf16_f32 v53, v22, v23
    v_mfma_f32_16x16x32_bf16 v[36:39], a[72:75], v[176:179], v[36:39]
    ds_read_b64_tr_b16 a[116:117], v4 offset:17248
    v_cvt_pk_bf16_f32 v54, v28, v29
    v_mfma_f32_16x16x32_bf16 v[36:39], a[76:79], v[184:187], v[36:39]
    ds_read_b64_tr_b16 a[118:119], v4 offset:17376
    v_cvt_pk_bf16_f32 v55, v30, v31
    v_mfma_f32_16x16x32_bf16 v[36:39], a[80:83], v[224:227], v[36:39]
    s_mov_b32 s54, 303104
    ds_read_b64_tr_b16 a[120:121], v4 offset:17504
    ds_read_b64_tr_b16 a[122:123], v4 offset:17632
    v_mfma_f32_16x16x32_bf16 v[36:39], a[84:87], v[232:235], v[36:39]
    v_permlane32_swap_b32 v52, v54
    v_mfma_f32_16x16x32_bf16 v[36:39], a[88:91], v[240:243], v[36:39]
    v_permlane32_swap_b32 v53, v55
    v_mfma_f32_16x16x32_bf16 v[36:39], a[92:95], v[248:251], v[36:39]
    s_waitcnt lgkmcnt(10)
    ds_read_b64_tr_b16 a[124:125], v4 offset:17760
    ds_read_b64_tr_b16 a[126:127], v4 offset:17888
    buffer_store_dwordx4 v[52:55], v10, s[40:43], s54 offen offset:0 sc1
    buffer_store_dwordx4 v[52:55], v10, s[32:35], s54 offen offset:0
    v_mfma_f32_16x16x32_bf16 v[40:43], a[96:99], v[128:131], 0
    v_mfma_f32_16x16x32_bf16 v[40:43], a[100:103], v[136:139], v[40:43]
    s_waitcnt lgkmcnt(8)
    v_mfma_f32_16x16x32_bf16 v[40:43], a[104:107], v[144:147], v[40:43]
    v_mfma_f32_16x16x32_bf16 v[40:43], a[108:111], v[152:155], v[40:43]
    s_waitcnt lgkmcnt(4)
    v_mfma_f32_16x16x32_bf16 v[40:43], a[112:115], v[192:195], v[40:43]
    v_mfma_f32_16x16x32_bf16 v[40:43], a[116:119], v[200:203], v[40:43]
    s_waitcnt lgkmcnt(0)
    v_mfma_f32_16x16x32_bf16 v[40:43], a[120:123], v[208:211], v[40:43]
    v_mfma_f32_16x16x32_bf16 v[40:43], a[124:127], v[216:219], v[40:43]
    v_mfma_f32_16x16x32_bf16 v[44:47], a[96:99], v[160:163], 0
    v_mfma_f32_16x16x32_bf16 v[44:47], a[100:103], v[168:171], v[44:47]
    v_mfma_f32_16x16x32_bf16 v[44:47], a[104:107], v[176:179], v[44:47]
    v_mfma_f32_16x16x32_bf16 v[44:47], a[108:111], v[184:187], v[44:47]
    v_mfma_f32_16x16x32_bf16 v[44:47], a[112:115], v[224:227], v[44:47]
    v_mfma_f32_16x16x32_bf16 v[44:47], a[116:119], v[232:235], v[44:47]
    v_mfma_f32_16x16x32_bf16 v[44:47], a[120:123], v[240:243], v[44:47]
    v_mfma_f32_16x16x32_bf16 v[44:47], a[124:127], v[248:251], v[44:47]
    s_nop 7
    v_cvt_pk_bf16_f32 v48, v32, v33
    v_cvt_pk_bf16_f32 v49, v34, v35
    v_cvt_pk_bf16_f32 v50, v40, v41
    v_cvt_pk_bf16_f32 v51, v42, v43
    s_nop 1
    v_permlane32_swap_b32 v48, v50
    v_permlane32_swap_b32 v49, v51
    s_mov_b32 s54, 8192
    buffer_store_dwordx4 v[48:51], v10, s[40:43], s54 offen offset:512 sc1
    buffer_store_dwordx4 v[48:51], v10, s[32:35], s54 offen offset:512
    v_cvt_pk_bf16_f32 v52, v36, v37
    v_cvt_pk_bf16_f32 v53, v38, v39
    v_cvt_pk_bf16_f32 v54, v44, v45
    v_cvt_pk_bf16_f32 v55, v46, v47
    s_nop 1
    v_permlane32_swap_b32 v52, v54
    v_permlane32_swap_b32 v53, v55
    s_mov_b32 s54, 303104
    buffer_store_dwordx4 v[52:55], v10, s[40:43], s54 offen offset:512 sc1
    buffer_store_dwordx4 v[52:55], v10, s[32:35], s54 offen offset:512
    buffer_load_dword v9, v6, s[84:87], s47 offen sc1
    s_movk_i32 s45, 4608
    buffer_load_dwordx4 v[76:79], v5, s[84:87], s45 offen sc1
    v_mov_b32 v16, 0
    s_movk_i32 s45, 18432
    buffer_load_dwordx4 v[88:91], v5, s[84:87], s45 offen sc1
    v_mov_b32 v17, 0
    s_movk_i32 s45, 8704
    buffer_load_dwordx4 v[80:83], v5, s[84:87], s45 offen sc1
    v_mov_b32 v18, 0
    s_movk_i32 s45, 22528
    buffer_load_dwordx4 v[92:95], v5, s[84:87], s45 offen sc1
    v_mov_b32 v19, 0
    s_movk_i32 s45, 12800
    buffer_load_dwordx4 v[84:87], v59, s[84:87], s45 offen sc1
    v_mov_b32 v20, 0
    s_movk_i32 s45, 26624
    buffer_load_dwordx4 v[96:99], v59, s[84:87], s45 offen sc1
    v_mov_b32 v21, 0
    buffer_load_dwordx4 v[224:227], v12, s[36:39], 0 offen offset:0
    v_mov_b32 v22, 0
    buffer_load_dwordx4 v[232:235], v12, s[36:39], 0 offen offset:512
    v_mov_b32 v23, 0
    buffer_load_dwordx4 v[240:243], v13, s[36:39], 0 offen offset:1024
    buffer_load_dwordx4 v[64:67], v1, s[76:79], 0 offen offset:0
    buffer_load_dwordx4 v[68:71], v1, s[76:79], 0 offen offset:512
    buffer_load_dwordx4 v[72:75], v2, s[76:79], 0 offen offset:0
    s_waitcnt vmcnt(13)
    buffer_store_dword v3, v15, s[84:87], s56 offen sc1
    s_movk_i32 s48, 0x1111
    v_lshrrev_b32 v15, 4, v0
    v_mul_u32_u24 v15, 9216, v15
    v_add_u32 v15, 4096, v15
    v_add_u32 v7, v59, v15
    s_waitcnt vmcnt(13)
    v_cmp_ne_u32 vcc, 0, v9
    s_nop 0
    s_lshr_b32 s3, vcc_lo, 1
    s_and_b32 s3, s3, vcc_lo
    s_lshr_b32 s14, s3, 2
    s_and_b32 s3, s3, s14
    s_and_b32 s3, s3, s48
    s_cbranch_scc0 L2_g0s
L2_g0r:
    s_ff1_i32_b32 s3, s3
    s_bitset0_b32 s48, s3
    s_mul_i32 s46, s3, 9216
    s_bitcmp1_b32 s49, s3
    s_cselect_b32 s30, 0, 147456
    s_mov_b32 s60, s30
    buffer_load_dword v9, v6, s[84:87], s47 offen sc1
    buffer_load_dwordx4 v[112:115], v7, s[88:91], s46 offen sc1
    buffer_load_dwordx4 v[116:119], v5, s[88:91], s46 offen sc1
    buffer_load_dwordx4 v[120:123], v5, s[28:31], s46 offen sc1
    s_add_u32 s46, s46, 9216
    buffer_load_dwordx4 v[124:127], v5, s[88:91], s46 offen sc1
    buffer_load_dwordx4 v[128:131], v5, s[28:31], s46 offen sc1
    s_add_u32 s46, s46, 9216
    buffer_load_dwordx4 v[132:135], v5, s[88:91], s46 offen sc1
    buffer_load_dwordx4 v[136:139], v5, s[28:31], s46 offen sc1
    s_add_u32 s46, s46, 9216
    buffer_load_dwordx4 v[140:143], v5, s[88:91], s46 offen sc1
    buffer_load_dwordx4 v[144:147], v5, s[28:31], s46 offen sc1
    s_waitcnt vmcnt(11)
    v_mov_b32 v14, v13
    v_max_u32 v13, v76, v77
    v_max3_u32 v13, v13, v78, v79
    v_max3_u32 v13, v13, v88, v89
    v_max3_u32 v13, v13, v90, v91
    v_max3_u32 v13, v13, v80, v81
    v_max3_u32 v13, v13, v82, v83
    v_max3_u32 v13, v13, v92, v93
    v_max3_u32 v13, v13, v94, v95
    v_max3_u32 v13, v13, v84, v85
    v_max3_u32 v13, v13, v86, v87
    v_max3_u32 v13, v13, v96, v97
    v_max3_u32 v13, v13, v98, v99
    v_cmp_eq_u32 vcc, -1, v13
    s_nop 0
    s_cmp_lg_u64 vcc, 0
    s_cbranch_scc1 L2_pns
L2_pnr:
    v_pk_add_f32 v[76:77], v[76:77], v[88:89]
    v_pk_add_f32 v[78:79], v[78:79], v[90:91]
    ds_write_b128 v5, v[76:79] offset:0
    v_pk_add_f32 v[80:81], v[80:81], v[92:93]
    v_pk_add_f32 v[82:83], v[82:83], v[94:95]
    ds_write_b128 v5, v[80:83] offset:4096
    v_pk_add_f32 v[84:85], v[84:85], v[96:97]
    v_pk_add_f32 v[86:87], v[86:87], v[98:99]
    ds_write_b128 v59, v[84:87] offset:8192
    s_waitcnt lgkmcnt(0)
    s_barrier
    s_add_u32 s14, s55, 16384
    v_add_u32 v105, s14, v8
    v_add_u32 v106, 73728, v105
    v_lshlrev_b32 v3, 1, v12
    v_lshlrev_b32 v4, 1, v14
    ds_read_b128 v[76:79], v3 offset:4608
    ds_read_b128 v[80:83], v3 offset:4624
    ds_read_b128 v[84:87], v3 offset:5632
    ds_read_b128 v[88:91], v3 offset:5648
    ds_read_b128 v[92:95], v4 offset:6656
    ds_read_b128 v[96:99], v4 offset:6672
    ds_read_b128 v[40:43], v3 offset:2304
    ds_read_b128 v[44:47], v3 offset:2320
    ds_read_b128 v[48:51], v3 offset:3328
    ds_read_b128 v[52:55], v3 offset:3344
    ds_read_b128 v[56:59], v4 offset:4352
    ds_read_b128 v[60:63], v4 offset:4368
    s_waitcnt vmcnt(9)
    v_cmp_ne_u32 vcc, 0, v9
    s_nop 0
    s_lshr_b32 s3, vcc_lo, 1
    s_and_b32 s3, s3, vcc_lo
    s_lshr_b32 s14, s3, 2
    s_and_b32 s3, s3, s14
    s_and_b32 s3, s3, s48
    s_cbranch_scc0 L2_g1s
L2_g1r:
    s_ff1_i32_b32 s3, s3
    s_bitset0_b32 s48, s3
    s_mul_i32 s46, s3, 9216
    s_bitcmp1_b32 s49, s3
    s_cselect_b32 s30, 0, 147456
    s_mov_b32 s61, s30
    buffer_load_dword v9, v6, s[84:87], s47 offen sc1
    buffer_load_dwordx4 v[148:151], v7, s[88:91], s46 offen sc1
    ds_write_b128 v106, a[20:23] offset:36864
    ds_write_b128 v106, a[24:27] offset:37888
    s_waitcnt lgkmcnt(2)
    v_lshlrev_b32 v12, 16, v224
    v_and_b32 v13, 0xffff0000, v224
    v_pk_mul_f32 v[76:77], v[76:77], v[12:13]
    v_pk_mul_f32 v[40:41], v[40:41], v[12:13]
    v_lshlrev_b32 v14, 16, v225
    v_and_b32 v15, 0xffff0000, v225
    v_pk_mul_f32 v[78:79], v[78:79], v[14:15]
    v_pk_mul_f32 v[42:43], v[42:43], v[14:15]
    v_lshlrev_b32 v12, 16, v226
    v_and_b32 v13, 0xffff0000, v226
    v_pk_mul_f32 v[80:81], v[80:81], v[12:13]
    v_pk_mul_f32 v[44:45], v[44:45], v[12:13]
    v_lshlrev_b32 v14, 16, v227
    v_and_b32 v15, 0xffff0000, v227
    v_pk_mul_f32 v[82:83], v[82:83], v[14:15]
    v_pk_mul_f32 v[46:47], v[46:47], v[14:15]
    v_lshlrev_b32 v12, 16, v232
    v_and_b32 v13, 0xffff0000, v232
    v_pk_mul_f32 v[84:85], v[84:85], v[12:13]
    v_pk_mul_f32 v[48:49], v[48:49], v[12:13]
    v_lshlrev_b32 v14, 16, v233
    v_and_b32 v15, 0xffff0000, v233
    v_pk_mul_f32 v[86:87], v[86:87], v[14:15]
    v_pk_mul_f32 v[50:51], v[50:51], v[14:15]
    buffer_load_dwordx4 v[152:155], v5, s[88:91], s46 offen sc1
    buffer_load_dwordx4 v[156:159], v5, s[28:31], s46 offen sc1
    ds_write_b128 v106, a[28:31] offset:38912
    ds_write_b128 v106, a[32:35] offset:39936
    v_lshlrev_b32 v12, 16, v234
    v_and_b32 v13, 0xffff0000, v234
    v_pk_mul_f32 v[88:89], v[88:89], v[12:13]
    v_pk_mul_f32 v[52:53], v[52:53], v[12:13]
    v_lshlrev_b32 v14, 16, v235
    v_and_b32 v15, 0xffff0000, v235
    v_pk_mul_f32 v[90:91], v[90:91], v[14:15]
    v_pk_mul_f32 v[54:55], v[54:55], v[14:15]
    v_lshlrev_b32 v12, 16, v240
    v_and_b32 v13, 0xffff0000, v240
    v_pk_mul_f32 v[92:93], v[92:93], v[12:13]
    v_pk_mul_f32 v[56:57], v[56:57], v[12:13]
    v_lshlrev_b32 v14, 16, v241
    v_and_b32 v15, 0xffff0000, v241
    v_pk_mul_f32 v[94:95], v[94:95], v[14:15]
    v_pk_mul_f32 v[58:59], v[58:59], v[14:15]
    v_lshlrev_b32 v12, 16, v242
    v_and_b32 v13, 0xffff0000, v242
    v_pk_mul_f32 v[96:97], v[96:97], v[12:13]
    v_pk_mul_f32 v[60:61], v[60:61], v[12:13]
    v_lshlrev_b32 v14, 16, v243
    v_and_b32 v15, 0xffff0000, v243
    v_pk_mul_f32 v[98:99], v[98:99], v[14:15]
    v_pk_mul_f32 v[62:63], v[62:63], v[14:15]
    s_add_u32 s46, s46, 9216
    buffer_load_dwordx4 v[160:163], v5, s[88:91], s46 offen sc1
    buffer_load_dwordx4 v[164:167], v5, s[28:31], s46 offen sc1
    ds_write_b128 v106, a[36:39] offset:40960
    ds_write_b128 v106, a[40:43] offset:41984
    v_pk_add_f32 v[12:13], v[76:77], v[78:79]
    v_pk_add_f32 v[12:13], v[12:13], v[80:81]
    v_pk_add_f32 v[12:13], v[12:13], v[82:83]
    v_pk_add_f32 v[12:13], v[12:13], v[84:85]
    v_pk_add_f32 v[12:13], v[12:13], v[86:87]
    v_pk_add_f32 v[12:13], v[12:13], v[88:89]
    v_pk_add_f32 v[12:13], v[12:13], v[90:91]
    v_pk_add_f32 v[14:15], v[92:93], v[94:95]
    v_pk_add_f32 v[14:15], v[14:15], v[96:97]
    v_pk_add_f32 v[14:15], v[14:15], v[98:99]
    v_add_f32 v100, v12, v13
    v_add_f32 v14, v14, v15
    v_fmac_f32 v100, 0x3e800000, v14
    v_pk_add_f32 v[12:13], v[40:41], v[42:43]
    v_pk_add_f32 v[12:13], v[12:13], v[44:45]
    v_pk_add_f32 v[12:13], v[12:13], v[46:47]
    v_pk_add_f32 v[12:13], v[12:13], v[48:49]
    v_pk_add_f32 v[12:13], v[12:13], v[50:51]
    v_pk_add_f32 v[12:13], v[12:13], v[52:53]
    v_pk_add_f32 v[12:13], v[12:13], v[54:55]
    v_pk_add_f32 v[14:15], v[56:57], v[58:59]
    v_pk_add_f32 v[14:15], v[14:15], v[60:61]
    v_pk_add_f32 v[14:15], v[14:15], v[62:63]
    v_add_f32 v101, v12, v13
    v_add_f32 v14, v14, v15
    v_fmac_f32 v101, 0x3e800000, v14
    ds_read_b128 v[40:43], v3 offset:0
    ds_read_b128 v[44:47], v3 offset:16
    ds_read_b128 v[48:51], v3 offset:1024
    ds_read_b128 v[52:55], v3 offset:1040
    ds_read_b128 v[56:59], v4 offset:2048
    ds_read_b128 v[60:63], v4 offset:2064
    s_add_u32 s46, s46, 9216
    buffer_load_dwordx4 v[168:171], v5, s[88:91], s46 offen sc1
    buffer_load_dwordx4 v[172:175], v5, s[28:31], s46 offen sc1
    ds_write_b128 v106, a[44:47] offset:43008
    ds_write_b128 v106, a[48:51] offset:44032
    s_nop 1
    v_add_f32_dpp v100, v100, v100 row_ror:8 row_mask:0xf bank_mask:0xf
    v_add_f32_dpp v101, v101, v101 row_ror:8 row_mask:0xf bank_mask:0xf
    v_mov_b32 v102, v100
    v_mov_b32 v103, v101
    s_nop 0
    v_permlane16_swap_b32 v102, v100
    v_permlane16_swap_b32 v103, v101
    v_add_f32 v100, v100, v102
    v_add_f32 v101, v101, v103
    v_mov_b32 v102, v100
    v_mov_b32 v103, v101
    s_nop 0
    v_permlane32_swap_b32 v102, v100
    v_permlane32_swap_b32 v103, v101
    v_add_f32 v100, v100, v102
    v_add_f32 v101, v101, v103
    v_and_b32 v14, 7, v0
    v_lshlrev_b32 v11, 4, v14
    v_add_u32 v11, 14080, v11
    s_lshl_b32 s3, s51, 2
    v_add_u32 v10, s3, v11
    ds_write_b32 v10, v100 offset:384
    ds_write_b32 v10, v101 offset:512
    v_lshl_add_u32 v1, v14, 4, v1
    v_lshl_add_u32 v2, v14, 4, v2
    v_add_u32 v1, 90112, v1
    v_add_u32 v2, 90112, v2
    s_and_b32 s3, s51, 1
    s_mul_i32 s3, s3, 288
    v_add_u32 v14, s3, v0
    s_lshl_b32 s45, s3, 4
    s_lshr_b32 s14, s51, 1
    s_mul_i32 s14, s14, 9344
    s_add_u32 s14, s14, 90112
    v_add_u32 v15, 0, v14
    v_mul_u32_u24 v12, 911, v15
    v_lshrrev_b32 v12, 16, v12
    v_add_u32 v15, v15, v12
    v_lshl_add_u32 v107, v15, 4, s14
    v_add_u32 v15, 64, v14
    v_mul_u32_u24 v12, 911, v15
    v_lshrrev_b32 v12, 16, v12
    v_add_u32 v15, v15, v12
    v_lshl_add_u32 v108, v15, 4, s14
    v_add_u32 v15, 128, v14
    v_mul_u32_u24 v12, 911, v15
    v_lshrrev_b32 v12, 16, v12
    v_add_u32 v15, v15, v12
    v_lshl_add_u32 v109, v15, 4, s14
    v_add_u32 v15, 192, v14
    v_mul_u32_u24 v12, 911, v15
    v_lshrrev_b32 v12, 16, v12
    v_add_u32 v15, v15, v12
    v_lshl_add_u32 v110, v15, 4, s14
    v_add_u32 v15, 256, v14
    v_mul_u32_u24 v12, 911, v15
    v_lshrrev_b32 v12, 16, v12
    v_add_u32 v15, v15, v12
    v_lshl_add_u32 v111, v15, 4, s14
    s_mul_i32 s3, s96, 9216
    s_add_u32 s14, s3, 4194304
    s_cmp_lt_u32 s51, 2
    s_cselect_b32 s3, s3, s14
    s_cselect_b64 s[24:25], s[80:81], s[84:85]
    s_add_u32 s24, s24, s3
    s_addc_u32 s25, s25, 0
    s_mov_b32 s26, 9216
    s_mov_b32 s27, 0x20000
    s_add_u32 s46, s46, 9216
    buffer_load_dwordx4 v[176:179], v5, s[88:91], s46 offen sc1
    buffer_load_dwordx4 v[180:183], v5, s[28:31], s46 offen sc1
    ds_write_b128 v106, a[52:55] offset:45056
    ds_write_b128 v105, a[128:131] offset:0
    s_waitcnt lgkmcnt(2)
    s_waitcnt vmcnt(18)
    s_waitcnt vmcnt(9)
    v_cmp_ne_u32 vcc, 0, v9
    s_nop 0
    s_lshr_b32 s3, vcc_lo, 1
    s_and_b32 s3, s3, vcc_lo
    s_lshr_b32 s14, s3, 2
    s_and_b32 s3, s3, s14
    s_and_b32 s3, s3, s48
    s_cbranch_scc0 L2_g2s
L2_g2r:
    s_ff1_i32_b32 s3, s3
    s_bitset0_b32 s48, s3
    s_mul_i32 s46, s3, 9216
    s_bitcmp1_b32 s49, s3
    s_cselect_b32 s30, 0, 147456
    s_mov_b32 s62, s30
    buffer_load_dword v9, v6, s[84:87], s47 offen sc1
    buffer_load_dwordx4 v[184:187], v7, s[88:91], s46 offen sc1
    ds_write_b128 v105, a[132:135] offset:1024
    ds_write_b128 v105, a[136:139] offset:2048
    v_lshlrev_b32 v32, 16, v112
    v_and_b32 v33, 0xffff0000, v112
    v_lshlrev_b32 v34, 16, v113
    v_and_b32 v35, 0xffff0000, v113
    v_lshlrev_b32 v36, 16, v114
    v_and_b32 v37, 0xffff0000, v114
    v_lshlrev_b32 v38, 16, v115
    v_and_b32 v39, 0xffff0000, v115
    buffer_load_dwordx4 v[188:191], v5, s[88:91], s46 offen sc1
    buffer_load_dwordx4 v[192:195], v5, s[28:31], s46 offen sc1
    ds_write_b128 v105, a[140:143] offset:3072
    ds_write_b128 v105, a[144:147] offset:4096
    v_lshlrev_b32 v24, 16, v116
    v_and_b32 v25, 0xffff0000, v116
    v_lshlrev_b32 v26, 16, v117
    v_and_b32 v27, 0xffff0000, v117
    v_lshlrev_b32 v28, 16, v118
    v_and_b32 v29, 0xffff0000, v118
    v_lshlrev_b32 v30, 16, v119
    v_and_b32 v31, 0xffff0000, v119
    s_add_u32 s46, s46, 9216
    buffer_load_dwordx4 v[196:199], v5, s[88:91], s46 offen sc1
    buffer_load_dwordx4 v[200:203], v5, s[28:31], s46 offen sc1
    ds_write_b128 v105, a[148:151] offset:5120
    ds_write_b128 v105, a[152:155] offset:6144
    v_lshlrev_b32 v100, 16, v124
    v_and_b32 v101, 0xffff0000, v124
    v_pk_add_f32 v[24:25], v[24:25], v[100:101]
    v_lshlrev_b32 v102, 16, v125
    v_and_b32 v103, 0xffff0000, v125
    v_pk_add_f32 v[26:27], v[26:27], v[102:103]
    v_lshlrev_b32 v100, 16, v126
    v_and_b32 v101, 0xffff0000, v126
    v_pk_add_f32 v[28:29], v[28:29], v[100:101]
    v_lshlrev_b32 v102, 16, v127
    v_and_b32 v103, 0xffff0000, v127
    v_pk_add_f32 v[30:31], v[30:31], v[102:103]
    s_add_u32 s46, s46, 9216
    buffer_load_dwordx4 v[204:207], v5, s[88:91], s46 offen sc1
    buffer_load_dwordx4 v[208:211], v5, s[28:31], s46 offen sc1
    ds_write_b128 v105, a[156:159] offset:7168
    ds_write_b128 v105, a[160:163] offset:8192
    v_lshlrev_b32 v100, 16, v132
    v_and_b32 v101, 0xffff0000, v132
    v_pk_add_f32 v[24:25], v[24:25], v[100:101]
    v_lshlrev_b32 v102, 16, v133
    v_and_b32 v103, 0xffff0000, v133
    v_pk_add_f32 v[26:27], v[26:27], v[102:103]
    v_lshlrev_b32 v100, 16, v134
    v_and_b32 v101, 0xffff0000, v134
    v_pk_add_f32 v[28:29], v[28:29], v[100:101]
    v_lshlrev_b32 v102, 16, v135
    v_and_b32 v103, 0xffff0000, v135
    v_pk_add_f32 v[30:31], v[30:31], v[102:103]
    s_add_u32 s46, s46, 9216
    buffer_load_dwordx4 v[212:215], v5, s[88:91], s46 offen sc1
    buffer_load_dwordx4 v[216:219], v5, s[28:31], s46 offen sc1
    ds_write_b128 v105, a[164:167] offset:36864
    ds_write_b128 v105, a[168:171] offset:37888
    v_lshlrev_b32 v100, 16, v140
    v_and_b32 v101, 0xffff0000, v140
    v_pk_add_f32 v[24:25], v[24:25], v[100:101]
    v_lshlrev_b32 v102, 16, v141
    v_and_b32 v103, 0xffff0000, v141
    v_pk_add_f32 v[26:27], v[26:27], v[102:103]
    v_lshlrev_b32 v100, 16, v142
    v_and_b32 v101, 0xffff0000, v142
    v_pk_add_f32 v[28:29], v[28:29], v[100:101]
    v_lshlrev_b32 v102, 16, v143
    v_and_b32 v103, 0xffff0000, v143
    v_pk_add_f32 v[30:31], v[30:31], v[102:103]
    s_cmp_eq_u32 s60, 0
    s_cbranch_scc1 L2_ska0
    v_lshlrev_b32 v100, 16, v120
    v_and_b32 v101, 0xffff0000, v120
    v_pk_add_f32 v[16:17], v[16:17], v[100:101]
    v_lshlrev_b32 v102, 16, v121
    v_and_b32 v103, 0xffff0000, v121
    v_pk_add_f32 v[18:19], v[18:19], v[102:103]
    v_lshlrev_b32 v100, 16, v122
    v_and_b32 v101, 0xffff0000, v122
    v_pk_add_f32 v[20:21], v[20:21], v[100:101]
    v_lshlrev_b32 v102, 16, v123
    v_and_b32 v103, 0xffff0000, v123
    v_pk_add_f32 v[22:23], v[22:23], v[102:103]
    v_lshlrev_b32 v100, 16, v128
    v_and_b32 v101, 0xffff0000, v128
    v_pk_add_f32 v[16:17], v[16:17], v[100:101]
    v_lshlrev_b32 v102, 16, v129
    v_and_b32 v103, 0xffff0000, v129
    v_pk_add_f32 v[18:19], v[18:19], v[102:103]
    v_lshlrev_b32 v100, 16, v130
    v_and_b32 v101, 0xffff0000, v130
    v_pk_add_f32 v[20:21], v[20:21], v[100:101]
    v_lshlrev_b32 v102, 16, v131
    v_and_b32 v103, 0xffff0000, v131
    v_pk_add_f32 v[22:23], v[22:23], v[102:103]
    v_lshlrev_b32 v100, 16, v136
    v_and_b32 v101, 0xffff0000, v136
    v_pk_add_f32 v[16:17], v[16:17], v[100:101]
    v_lshlrev_b32 v102, 16, v137
    v_and_b32 v103, 0xffff0000, v137
    v_pk_add_f32 v[18:19], v[18:19], v[102:103]
    v_lshlrev_b32 v100, 16, v138
    v_and_b32 v101, 0xffff0000, v138
    v_pk_add_f32 v[20:21], v[20:21], v[100:101]
    v_lshlrev_b32 v102, 16, v139
    v_and_b32 v103, 0xffff0000, v139
    v_pk_add_f32 v[22:23], v[22:23], v[102:103]
    v_lshlrev_b32 v100, 16, v144
    v_and_b32 v101, 0xffff0000, v144
    v_pk_add_f32 v[16:17], v[16:17], v[100:101]
    v_lshlrev_b32 v102, 16, v145
    v_and_b32 v103, 0xffff0000, v145
    v_pk_add_f32 v[18:19], v[18:19], v[102:103]
    v_lshlrev_b32 v100, 16, v146
    v_and_b32 v101, 0xffff0000, v146
    v_pk_add_f32 v[20:21], v[20:21], v[100:101]
    v_lshlrev_b32 v102, 16, v147
    v_and_b32 v103, 0xffff0000, v147
    v_pk_add_f32 v[22:23], v[22:23], v[102:103]
L2_ska0:
    s_waitcnt vmcnt(18)
    s_waitcnt vmcnt(9)
    v_cmp_ne_u32 vcc, 0, v9
    s_nop 0
    s_lshr_b32 s3, vcc_lo, 1
    s_and_b32 s3, s3, vcc_lo
    s_lshr_b32 s14, s3, 2
    s_and_b32 s3, s3, s14
    s_and_b32 s3, s3, s48
    s_cbranch_scc0 L2_g3s
L2_g3r:
    s_ff1_i32_b32 s3, s3
    s_bitset0_b32 s48, s3
    s_mul_i32 s46, s3, 9216
    s_bitcmp1_b32 s49, s3
    s_cselect_b32 s30, 0, 147456
    s_mov_b32 s63, s30
    buffer_load_dwordx4 v[220:223], v7, s[88:91], s46 offen sc1
    ds_write_b128 v105, a[172:175] offset:38912
    ds_write_b128 v105, a[176:179] offset:39936
    v_lshlrev_b32 v100, 16, v148
    v_and_b32 v101, 0xffff0000, v148
    v_pk_add_f32 v[32:33], v[32:33], v[100:101]
    v_lshlrev_b32 v102, 16, v149
    v_and_b32 v103, 0xffff0000, v149
    v_pk_add_f32 v[34:35], v[34:35], v[102:103]
    v_lshlrev_b32 v100, 16, v150
    v_and_b32 v101, 0xffff0000, v150
    v_pk_add_f32 v[36:37], v[36:37], v[100:101]
    v_lshlrev_b32 v102, 16, v151
    v_and_b32 v103, 0xffff0000, v151
    v_pk_add_f32 v[38:39], v[38:39], v[102:103]
    buffer_load_dwordx4 v[224:227], v5, s[88:91], s46 offen sc1
    buffer_load_dwordx4 v[228:231], v5, s[28:31], s46 offen sc1
    ds_write_b128 v105, a[180:183] offset:40960
    ds_write_b128 v105, a[184:187] offset:41984
    v_lshlrev_b32 v100, 16, v152
    v_and_b32 v101, 0xffff0000, v152
    v_pk_add_f32 v[24:25], v[24:25], v[100:101]
    v_lshlrev_b32 v102, 16, v153
    v_and_b32 v103, 0xffff0000, v153
    v_pk_add_f32 v[26:27], v[26:27], v[102:103]
    v_lshlrev_b32 v100, 16, v154
    v_and_b32 v101, 0xffff0000, v154
    v_pk_add_f32 v[28:29], v[28:29], v[100:101]
    v_lshlrev_b32 v102, 16, v155
    v_and_b32 v103, 0xffff0000, v155
    v_pk_add_f32 v[30:31], v[30:31], v[102:103]
    s_add_u32 s46, s46, 9216
    buffer_load_dwordx4 v[232:235], v5, s[88:91], s46 offen sc1
L2_pad13:
    s_cbranch_execz L2_walkret
    buffer_load_dwordx4 v[236:239], v5, s[28:31], s46 offen sc1
    ds_write_b128 v105, a[188:191] offset:43008
    ds_write_b128 v105, a[192:195] offset:44032
    v_lshlrev_b32 v100, 16, v160
    v_and_b32 v101, 0xffff0000, v160
    v_pk_add_f32 v[24:25], v[24:25], v[100:101]
    v_lshlrev_b32 v102, 16, v161
    v_and_b32 v103, 0xffff0000, v161
    v_pk_add_f32 v[26:27], v[26:27], v[102:103]
    v_lshlrev_b32 v100, 16, v162
    v_and_b32 v101, 0xffff0000, v162
    v_pk_add_f32 v[28:29], v[28:29], v[100:101]
    v_lshlrev_b32 v102, 16, v163
    v_and_b32 v103, 0xffff0000, v163
    v_pk_add_f32 v[30:31], v[30:31], v[102:103]
    s_add_u32 s46, s46, 9216
    buffer_load_dwordx4 v[240:243], v5, s[88:91], s46 offen sc1
    buffer_load_dwordx4 v[244:247], v5, s[28:31], s46 offen sc1
    ds_write_b128 v105, a[196:199] offset:45056
    v_lshlrev_b32 v100, 16, v168
    v_and_b32 v101, 0xffff0000, v168
    v_pk_add_f32 v[24:25], v[24:25], v[100:101]
    v_lshlrev_b32 v102, 16, v169
    v_and_b32 v103, 0xffff0000, v169
    v_pk_add_f32 v[26:27], v[26:27], v[102:103]
    v_lshlrev_b32 v100, 16, v170
    v_and_b32 v101, 0xffff0000, v170
    v_pk_add_f32 v[28:29], v[28:29], v[100:101]
    v_lshlrev_b32 v102, 16, v171
    v_and_b32 v103, 0xffff0000, v171
    v_pk_add_f32 v[30:31], v[30:31], v[102:103]
    s_add_u32 s46, s46, 9216
    buffer_load_dwordx4 v[248:251], v5, s[88:91], s46 offen sc1
    buffer_load_dwordx4 v[252:255], v5, s[28:31], s46 offen sc1
    v_lshlrev_b32 v100, 16, v176
    v_and_b32 v101, 0xffff0000, v176
    v_pk_add_f32 v[24:25], v[24:25], v[100:101]
    v_lshlrev_b32 v102, 16, v177
    v_and_b32 v103, 0xffff0000, v177
    v_pk_add_f32 v[26:27], v[26:27], v[102:103]
    v_lshlrev_b32 v100, 16, v178
    v_and_b32 v101, 0xffff0000, v178
    v_pk_add_f32 v[28:29], v[28:29], v[100:101]
    v_lshlrev_b32 v102, 16, v179
    v_and_b32 v103, 0xffff0000, v179
    v_pk_add_f32 v[30:31], v[30:31], v[102:103]
    s_cmp_eq_u32 s61, 0
    s_cbranch_scc1 L2_ska1
    v_lshlrev_b32 v100, 16, v156
    v_and_b32 v101, 0xffff0000, v156
    v_pk_add_f32 v[16:17], v[16:17], v[100:101]
    v_lshlrev_b32 v102, 16, v157
    v_and_b32 v103, 0xffff0000, v157
    v_pk_add_f32 v[18:19], v[18:19], v[102:103]
    v_lshlrev_b32 v100, 16, v158
    v_and_b32 v101, 0xffff0000, v158
    v_pk_add_f32 v[20:21], v[20:21], v[100:101]
    v_lshlrev_b32 v102, 16, v159
    v_and_b32 v103, 0xffff0000, v159
    v_pk_add_f32 v[22:23], v[22:23], v[102:103]
    v_lshlrev_b32 v100, 16, v164
    v_and_b32 v101, 0xffff0000, v164
    v_pk_add_f32 v[16:17], v[16:17], v[100:101]
    v_lshlrev_b32 v102, 16, v165
    v_and_b32 v103, 0xffff0000, v165
    v_pk_add_f32 v[18:19], v[18:19], v[102:103]
    v_lshlrev_b32 v100, 16, v166
    v_and_b32 v101, 0xffff0000, v166
    v_pk_add_f32 v[20:21], v[20:21], v[100:101]
    v_lshlrev_b32 v102, 16, v167
    v_and_b32 v103, 0xffff0000, v167
    v_pk_add_f32 v[22:23], v[22:23], v[102:103]
    v_lshlrev_b32 v100, 16, v172
    v_and_b32 v101, 0xffff0000, v172
    v_pk_add_f32 v[16:17], v[16:17], v[100:101]
    v_lshlrev_b32 v102, 16, v173
    v_and_b32 v103, 0xffff0000, v173
    v_pk_add_f32 v[18:19], v[18:19], v[102:103]
    v_lshlrev_b32 v100, 16, v174
    v_and_b32 v101, 0xffff0000, v174
    v_pk_add_f32 v[20:21], v[20:21], v[100:101]
    v_lshlrev_b32 v102, 16, v175
    v_and_b32 v103, 0xffff0000, v175
    v_pk_add_f32 v[22:23], v[22:23], v[102:103]
    v_lshlrev_b32 v100, 16, v180
    v_and_b32 v101, 0xffff0000, v180
    v_pk_add_f32 v[16:17], v[16:17], v[100:101]
    v_lshlrev_b32 v102, 16, v181
    v_and_b32 v103, 0xffff0000, v181
    v_pk_add_f32 v[18:19], v[18:19], v[102:103]
    v_lshlrev_b32 v100, 16, v182
    v_and_b32 v101, 0xffff0000, v182
    v_pk_add_f32 v[20:21], v[20:21], v[100:101]
    v_lshlrev_b32 v102, 16, v183
    v_and_b32 v103, 0xffff0000, v183
    v_pk_add_f32 v[22:23], v[22:23], v[102:103]
L2_ska1:
    s_waitcnt vmcnt(17)
    v_lshlrev_b32 v100, 16, v184
    v_and_b32 v101, 0xffff0000, v184
    v_pk_add_f32 v[32:33], v[32:33], v[100:101]
    v_lshlrev_b32 v102, 16, v185
    v_and_b32 v103, 0xffff0000, v185
    v_pk_add_f32 v[34:35], v[34:35], v[102:103]
    v_lshlrev_b32 v100, 16, v186
    v_and_b32 v101, 0xffff0000, v186
    v_pk_add_f32 v[36:37], v[36:37], v[100:101]
    v_lshlrev_b32 v102, 16, v187
    v_and_b32 v103, 0xffff0000, v187
    v_pk_add_f32 v[38:39], v[38:39], v[102:103]
    ds_read_b128 v[112:115], v3 offset:4608
    ds_read_b128 v[116:119], v3 offset:4624
    ds_read_b128 v[120:123], v3 offset:5632
    ds_read_b128 v[124:127], v3 offset:5648
    ds_read_b128 v[128:131], v4 offset:6656
    ds_read_b128 v[132:135], v4 offset:6672
    ds_read_b128 v[136:139], v3 offset:2304
    ds_read_b128 v[140:143], v3 offset:2320
    ds_read_b128 v[144:147], v3 offset:3328
    ds_read_b128 v[148:151], v3 offset:3344
    ds_read_b128 v[152:155], v4 offset:4352
    ds_read_b128 v[156:159], v4 offset:4368
    ds_read_b128 v[160:163], v3 offset:6912
    ds_read_b128 v[164:167], v3 offset:6928
    ds_read_b128 v[168:171], v3 offset:7936
    ds_read_b128 v[172:175], v3 offset:7952
    ds_read_b128 v[176:179], v4 offset:8960
    ds_read_b128 v[180:183], v4 offset:8976
    s_waitcnt vmcnt(16)
    v_lshlrev_b32 v100, 16, v188
    v_and_b32 v101, 0xffff0000, v188
    v_pk_add_f32 v[24:25], v[24:25], v[100:101]
    v_lshlrev_b32 v102, 16, v189
    v_and_b32 v103, 0xffff0000, v189
    v_pk_add_f32 v[26:27], v[26:27], v[102:103]
    v_lshlrev_b32 v100, 16, v190
    v_and_b32 v101, 0xffff0000, v190
    v_pk_add_f32 v[28:29], v[28:29], v[100:101]
    v_lshlrev_b32 v102, 16, v191
    v_and_b32 v103, 0xffff0000, v191
    v_pk_add_f32 v[30:31], v[30:31], v[102:103]
    s_waitcnt vmcnt(14)
    v_lshlrev_b32 v100, 16, v196
    v_and_b32 v101, 0xffff0000, v196
    v_pk_add_f32 v[24:25], v[24:25], v[100:101]
    v_lshlrev_b32 v102, 16, v197
    v_and_b32 v103, 0xffff0000, v197
    v_pk_add_f32 v[26:27], v[26:27], v[102:103]
    v_lshlrev_b32 v100, 16, v198
    v_and_b32 v101, 0xffff0000, v198
    v_pk_add_f32 v[28:29], v[28:29], v[100:101]
    v_lshlrev_b32 v102, 16, v199
    v_and_b32 v103, 0xffff0000, v199
    v_pk_add_f32 v[30:31], v[30:31], v[102:103]
    s_waitcnt vmcnt(12)
    v_lshlrev_b32 v100, 16, v204
    v_and_b32 v101, 0xffff0000, v204
    v_pk_add_f32 v[24:25], v[24:25], v[100:101]
    v_lshlrev_b32 v102, 16, v205
    v_and_b32 v103, 0xffff0000, v205
    v_pk_add_f32 v[26:27], v[26:27], v[102:103]
    v_lshlrev_b32 v100, 16, v206
    v_and_b32 v101, 0xffff0000, v206
    v_pk_add_f32 v[28:29], v[28:29], v[100:101]
    v_lshlrev_b32 v102, 16, v207
    v_and_b32 v103, 0xffff0000, v207
    v_pk_add_f32 v[30:31], v[30:31], v[102:103]
    s_waitcnt vmcnt(10)
    v_lshlrev_b32 v100, 16, v212
    v_and_b32 v101, 0xffff0000, v212
    v_pk_add_f32 v[24:25], v[24:25], v[100:101]
    v_lshlrev_b32 v102, 16, v213
    v_and_b32 v103, 0xffff0000, v213
    v_pk_add_f32 v[26:27], v[26:27], v[102:103]
    v_lshlrev_b32 v100, 16, v214
    v_and_b32 v101, 0xffff0000, v214
    v_pk_add_f32 v[28:29], v[28:29], v[100:101]
    v_lshlrev_b32 v102, 16, v215
    v_and_b32 v103, 0xffff0000, v215
    v_pk_add_f32 v[30:31], v[30:31], v[102:103]
    s_waitcnt vmcnt(9)
    s_cmp_eq_u32 s62, 0
    s_cbranch_scc1 L2_ska2
    v_lshlrev_b32 v100, 16, v192
    v_and_b32 v101, 0xffff0000, v192
    v_pk_add_f32 v[16:17], v[16:17], v[100:101]
    v_lshlrev_b32 v102, 16, v193
    v_and_b32 v103, 0xffff0000, v193
    v_pk_add_f32 v[18:19], v[18:19], v[102:103]
    v_lshlrev_b32 v100, 16, v194
    v_and_b32 v101, 0xffff0000, v194
    v_pk_add_f32 v[20:21], v[20:21], v[100:101]
    v_lshlrev_b32 v102, 16, v195
    v_and_b32 v103, 0xffff0000, v195
    v_pk_add_f32 v[22:23], v[22:23], v[102:103]
    v_lshlrev_b32 v100, 16, v200
    v_and_b32 v101, 0xffff0000, v200
    v_pk_add_f32 v[16:17], v[16:17], v[100:101]
    v_lshlrev_b32 v102, 16, v201
    v_and_b32 v103, 0xffff0000, v201
    v_pk_add_f32 v[18:19], v[18:19], v[102:103]
    v_lshlrev_b32 v100, 16, v202
    v_and_b32 v101, 0xffff0000, v202
    v_pk_add_f32 v[20:21], v[20:21], v[100:101]
    v_lshlrev_b32 v102, 16, v203
    v_and_b32 v103, 0xffff0000, v203
    v_pk_add_f32 v[22:23], v[22:23], v[102:103]
    v_lshlrev_b32 v100, 16, v208
    v_and_b32 v101, 0xffff0000, v208
    v_pk_add_f32 v[16:17], v[16:17], v[100:101]
    v_lshlrev_b32 v102, 16, v209
    v_and_b32 v103, 0xffff0000, v209
    v_pk_add_f32 v[18:19], v[18:19], v[102:103]
    v_lshlrev_b32 v100, 16, v210
    v_and_b32 v101, 0xffff0000, v210
    v_pk_add_f32 v[20:21], v[20:21], v[100:101]
    v_lshlrev_b32 v102, 16, v211
    v_and_b32 v103, 0xffff0000, v211
    v_pk_add_f32 v[22:23], v[22:23], v[102:103]
    v_lshlrev_b32 v100, 16, v216
    v_and_b32 v101, 0xffff0000, v216
    v_pk_add_f32 v[16:17], v[16:17], v[100:101]
    v_lshlrev_b32 v102, 16, v217
    v_and_b32 v103, 0xffff0000, v217
    v_pk_add_f32 v[18:19], v[18:19], v[102:103]
    v_lshlrev_b32 v100, 16, v218
    v_and_b32 v101, 0xffff0000, v218
    v_pk_add_f32 v[20:21], v[20:21], v[100:101]
    v_lshlrev_b32 v102, 16, v219
    v_and_b32 v103, 0xffff0000, v219
    v_pk_add_f32 v[22:23], v[22:23], v[102:103]
L2_ska2:
    s_waitcnt vmcnt(8)
    v_lshlrev_b32 v100, 16, v220
    v_and_b32 v101, 0xffff0000, v220
    v_pk_add_f32 v[32:33], v[32:33], v[100:101]
    v_lshlrev_b32 v102, 16, v221
    v_and_b32 v103, 0xffff0000, v221
    v_pk_add_f32 v[34:35], v[34:35], v[102:103]
    v_lshlrev_b32 v100, 16, v222
    v_and_b32 v101, 0xffff0000, v222
    v_pk_add_f32 v[36:37], v[36:37], v[100:101]
    v_lshlrev_b32 v102, 16, v223
    v_and_b32 v103, 0xffff0000, v223
    v_pk_add_f32 v[38:39], v[38:39], v[102:103]
    v_mov_b32 v208, v32
    v_mov_b32 v209, v33
    v_mov_b32 v210, v34
    v_mov_b32 v211, v35
    v_mov_b32 v212, v36
    v_mov_b32 v213, v37
    v_mov_b32 v214, v38
    v_mov_b32 v215, v39
    v_permlane16_swap_b32 v208, v32
    v_permlane16_swap_b32 v209, v33
    v_permlane16_swap_b32 v210, v34
    v_permlane16_swap_b32 v211, v35
    v_permlane16_swap_b32 v212, v36
    v_permlane16_swap_b32 v213, v37
    v_permlane16_swap_b32 v214, v38
    v_permlane16_swap_b32 v215, v39
    v_add_f32 v32, v32, v208
    v_add_f32 v33, v33, v209
    v_add_f32 v34, v34, v210
    v_add_f32 v35, v35, v211
    v_add_f32 v36, v36, v212
    v_add_f32 v37, v37, v213
    v_add_f32 v38, v38, v214
    v_add_f32 v39, v39, v215
    v_mov_b32 v208, v32
    v_mov_b32 v209, v33
    v_mov_b32 v210, v34
    v_mov_b32 v211, v35
    v_mov_b32 v212, v36
    v_mov_b32 v213, v37
    v_mov_b32 v214, v38
    v_mov_b32 v215, v39
    v_permlane32_swap_b32 v208, v32
    v_permlane32_swap_b32 v209, v33
    v_permlane32_swap_b32 v210, v34
    v_permlane32_swap_b32 v211, v35
    v_permlane32_swap_b32 v212, v36
    v_permlane32_swap_b32 v213, v37
    v_permlane32_swap_b32 v214, v38
    v_permlane32_swap_b32 v215, v39
    v_add_f32 v32, v32, v208
    v_add_f32 v33, v33, v209
    v_add_f32 v34, v34, v210
    v_add_f32 v35, v35, v211
    v_add_f32 v36, v36, v212
    v_add_f32 v37, v37, v213
    v_add_f32 v38, v38, v214
    v_add_f32 v39, v39, v215
    v_lshlrev_b32 v184, 16, v64
    v_and_b32 v185, 0xffff0000, v64
    v_lshlrev_b32 v186, 16, v65
    v_and_b32 v187, 0xffff0000, v65
    v_lshlrev_b32 v188, 16, v66
    v_and_b32 v189, 0xffff0000, v66
    v_lshlrev_b32 v190, 16, v67
    v_and_b32 v191, 0xffff0000, v67
    v_lshlrev_b32 v192, 16, v68
    v_and_b32 v193, 0xffff0000, v68
    v_lshlrev_b32 v194, 16, v69
    v_and_b32 v195, 0xffff0000, v69
    v_lshlrev_b32 v196, 16, v70
    v_and_b32 v197, 0xffff0000, v70
    v_lshlrev_b32 v198, 16, v71
    v_and_b32 v199, 0xffff0000, v71
    v_lshlrev_b32 v200, 16, v72
    v_and_b32 v201, 0xffff0000, v72
    v_lshlrev_b32 v202, 16, v73
    v_and_b32 v203, 0xffff0000, v73
    v_lshlrev_b32 v204, 16, v74
    v_and_b32 v205, 0xffff0000, v74
    v_lshlrev_b32 v206, 16, v75
    v_and_b32 v207, 0xffff0000, v75
    s_waitcnt vmcnt(7)
    v_lshlrev_b32 v100, 16, v224
    v_and_b32 v101, 0xffff0000, v224
    v_pk_add_f32 v[24:25], v[24:25], v[100:101]
    v_lshlrev_b32 v102, 16, v225
    v_and_b32 v103, 0xffff0000, v225
    v_pk_add_f32 v[26:27], v[26:27], v[102:103]
    v_lshlrev_b32 v100, 16, v226
    v_and_b32 v101, 0xffff0000, v226
    v_pk_add_f32 v[28:29], v[28:29], v[100:101]
    v_lshlrev_b32 v102, 16, v227
    v_and_b32 v103, 0xffff0000, v227
    v_pk_add_f32 v[30:31], v[30:31], v[102:103]
    s_waitcnt vmcnt(5)
    v_lshlrev_b32 v100, 16, v232
    v_and_b32 v101, 0xffff0000, v232
    v_pk_add_f32 v[24:25], v[24:25], v[100:101]
    v_lshlrev_b32 v102, 16, v233
    v_and_b32 v103, 0xffff0000, v233
    v_pk_add_f32 v[26:27], v[26:27], v[102:103]
    v_lshlrev_b32 v100, 16, v234
    v_and_b32 v101, 0xffff0000, v234
    v_pk_add_f32 v[28:29], v[28:29], v[100:101]
    v_lshlrev_b32 v102, 16, v235
    v_and_b32 v103, 0xffff0000, v235
    v_pk_add_f32 v[30:31], v[30:31], v[102:103]
    s_waitcnt vmcnt(3)
    v_lshlrev_b32 v100, 16, v240
    v_and_b32 v101, 0xffff0000, v240
    v_pk_add_f32 v[24:25], v[24:25], v[100:101]
    v_lshlrev_b32 v102, 16, v241
    v_and_b32 v103, 0xffff0000, v241
    v_pk_add_f32 v[26:27], v[26:27], v[102:103]
    v_lshlrev_b32 v100, 16, v242
    v_and_b32 v101, 0xffff0000, v242
    v_pk_add_f32 v[28:29], v[28:29], v[100:101]
    v_lshlrev_b32 v102, 16, v243
    v_and_b32 v103, 0xffff0000, v243
    v_pk_add_f32 v[30:31], v[30:31], v[102:103]
    s_waitcnt vmcnt(1)
    v_lshlrev_b32 v100, 16, v248
    v_and_b32 v101, 0xffff0000, v248
    v_pk_add_f32 v[24:25], v[24:25], v[100:101]
    v_lshlrev_b32 v102, 16, v249
    v_and_b32 v103, 0xffff0000, v249
    v_pk_add_f32 v[26:27], v[26:27], v[102:103]
    v_lshlrev_b32 v100, 16, v250
    v_and_b32 v101, 0xffff0000, v250
    v_pk_add_f32 v[28:29], v[28:29], v[100:101]
    v_lshlrev_b32 v102, 16, v251
    v_and_b32 v103, 0xffff0000, v251
    v_pk_add_f32 v[30:31], v[30:31], v[102:103]
    s_waitcnt vmcnt(0)
    s_cmp_eq_u32 s63, 0
    s_cbranch_scc1 L2_ska3
    v_lshlrev_b32 v100, 16, v228
    v_and_b32 v101, 0xffff0000, v228
    v_pk_add_f32 v[16:17], v[16:17], v[100:101]
    v_lshlrev_b32 v102, 16, v229
    v_and_b32 v103, 0xffff0000, v229
    v_pk_add_f32 v[18:19], v[18:19], v[102:103]
    v_lshlrev_b32 v100, 16, v230
    v_and_b32 v101, 0xffff0000, v230
    v_pk_add_f32 v[20:21], v[20:21], v[100:101]
    v_lshlrev_b32 v102, 16, v231
    v_and_b32 v103, 0xffff0000, v231
    v_pk_add_f32 v[22:23], v[22:23], v[102:103]
    v_lshlrev_b32 v100, 16, v236
    v_and_b32 v101, 0xffff0000, v236
    v_pk_add_f32 v[16:17], v[16:17], v[100:101]
    v_lshlrev_b32 v102, 16, v237
    v_and_b32 v103, 0xffff0000, v237
    v_pk_add_f32 v[18:19], v[18:19], v[102:103]
    v_lshlrev_b32 v100, 16, v238
    v_and_b32 v101, 0xffff0000, v238
    v_pk_add_f32 v[20:21], v[20:21], v[100:101]
    v_lshlrev_b32 v102, 16, v239
    v_and_b32 v103, 0xffff0000, v239
    v_pk_add_f32 v[22:23], v[22:23], v[102:103]
    v_lshlrev_b32 v100, 16, v244
    v_and_b32 v101, 0xffff0000, v244
    v_pk_add_f32 v[16:17], v[16:17], v[100:101]
    v_lshlrev_b32 v102, 16, v245
    v_and_b32 v103, 0xffff0000, v245
    v_pk_add_f32 v[18:19], v[18:19], v[102:103]
    v_lshlrev_b32 v100, 16, v246
    v_and_b32 v101, 0xffff0000, v246
    v_pk_add_f32 v[20:21], v[20:21], v[100:101]
    v_lshlrev_b32 v102, 16, v247
    v_and_b32 v103, 0xffff0000, v247
    v_pk_add_f32 v[22:23], v[22:23], v[102:103]
    v_lshlrev_b32 v100, 16, v252
    v_and_b32 v101, 0xffff0000, v252
    v_pk_add_f32 v[16:17], v[16:17], v[100:101]
    v_lshlrev_b32 v102, 16, v253
    v_and_b32 v103, 0xffff0000, v253
    v_pk_add_f32 v[18:19], v[18:19], v[102:103]
    v_lshlrev_b32 v100, 16, v254
    v_and_b32 v101, 0xffff0000, v254
    v_pk_add_f32 v[20:21], v[20:21], v[100:101]
    v_lshlrev_b32 v102, 16, v255
    v_and_b32 v103, 0xffff0000, v255
    v_pk_add_f32 v[22:23], v[22:23], v[102:103]
L2_ska3:
    v_pk_fma_f32 v[16:17], v[16:17], v[40:41], v[184:185]
    v_pk_fma_f32 v[18:19], v[18:19], v[42:43], v[186:187]
    v_pk_fma_f32 v[20:21], v[20:21], v[44:45], v[188:189]
    v_pk_fma_f32 v[22:23], v[22:23], v[46:47], v[190:191]
    v_pk_fma_f32 v[24:25], v[24:25], v[48:49], v[192:193]
    v_pk_fma_f32 v[26:27], v[26:27], v[50:51], v[194:195]
    v_pk_fma_f32 v[28:29], v[28:29], v[52:53], v[196:197]
    v_pk_fma_f32 v[30:31], v[30:31], v[54:55], v[198:199]
    v_pk_fma_f32 v[32:33], v[32:33], v[56:57], v[200:201]
    v_pk_fma_f32 v[34:35], v[34:35], v[58:59], v[202:203]
    v_pk_fma_f32 v[36:37], v[36:37], v[60:61], v[204:205]
    v_pk_fma_f32 v[38:39], v[38:39], v[62:63], v[206:207]
    v_pk_add_f32 v[12:13], v[16:17], v[18:19]
    v_pk_add_f32 v[12:13], v[12:13], v[20:21]
    v_pk_add_f32 v[12:13], v[12:13], v[22:23]
    v_pk_add_f32 v[12:13], v[12:13], v[24:25]
    v_pk_add_f32 v[12:13], v[12:13], v[26:27]
    v_pk_add_f32 v[12:13], v[12:13], v[28:29]
    v_pk_add_f32 v[12:13], v[12:13], v[30:31]
    v_pk_add_f32 v[14:15], v[32:33], v[34:35]
    v_pk_add_f32 v[14:15], v[14:15], v[36:37]
    v_pk_add_f32 v[14:15], v[14:15], v[38:39]
    v_add_f32 v100, v12, v13
    v_add_f32 v14, v14, v15
    v_fmac_f32 v100, 0x3e800000, v14
    s_nop 1
    v_add_f32_dpp v100, v100, v100 row_ror:8 row_mask:0xf bank_mask:0xf
    v_mov_b32 v103, v100
    s_nop 1
    v_permlane16_swap_b32 v103, v100
    v_add_f32 v100, v100, v103
    v_mov_b32 v103, v100
    s_nop 1
    v_permlane32_swap_b32 v103, v100
    v_add_f32 v100, v100, v103
    v_mul_f32 v100, 0x3be38e39, v100
    v_pk_add_f32 v[184:185], v[16:17], v[100:101] op_sel_hi:[1,0] neg_lo:[0,1] neg_hi:[0,1]
    v_pk_add_f32 v[186:187], v[18:19], v[100:101] op_sel_hi:[1,0] neg_lo:[0,1] neg_hi:[0,1]
    v_pk_add_f32 v[188:189], v[20:21], v[100:101] op_sel_hi:[1,0] neg_lo:[0,1] neg_hi:[0,1]
    v_pk_add_f32 v[190:191], v[22:23], v[100:101] op_sel_hi:[1,0] neg_lo:[0,1] neg_hi:[0,1]
    v_pk_add_f32 v[192:193], v[24:25], v[100:101] op_sel_hi:[1,0] neg_lo:[0,1] neg_hi:[0,1]
    v_pk_add_f32 v[194:195], v[26:27], v[100:101] op_sel_hi:[1,0] neg_lo:[0,1] neg_hi:[0,1]
    v_pk_add_f32 v[196:197], v[28:29], v[100:101] op_sel_hi:[1,0] neg_lo:[0,1] neg_hi:[0,1]
    v_pk_add_f32 v[198:199], v[30:31], v[100:101] op_sel_hi:[1,0] neg_lo:[0,1] neg_hi:[0,1]
    v_pk_add_f32 v[200:201], v[32:33], v[100:101] op_sel_hi:[1,0] neg_lo:[0,1] neg_hi:[0,1]
    v_pk_add_f32 v[202:203], v[34:35], v[100:101] op_sel_hi:[1,0] neg_lo:[0,1] neg_hi:[0,1]
    v_pk_add_f32 v[204:205], v[36:37], v[100:101] op_sel_hi:[1,0] neg_lo:[0,1] neg_hi:[0,1]
    v_pk_add_f32 v[206:207], v[38:39], v[100:101] op_sel_hi:[1,0] neg_lo:[0,1] neg_hi:[0,1]
    v_pk_mul_f32 v[12:13], v[184:185], v[184:185]
    v_pk_fma_f32 v[12:13], v[186:187], v[186:187], v[12:13]
    v_pk_fma_f32 v[12:13], v[188:189], v[188:189], v[12:13]
    v_pk_fma_f32 v[12:13], v[190:191], v[190:191], v[12:13]
    v_pk_fma_f32 v[12:13], v[192:193], v[192:193], v[12:13]
    v_pk_fma_f32 v[12:13], v[194:195], v[194:195], v[12:13]
    v_pk_fma_f32 v[12:13], v[196:197], v[196:197], v[12:13]
    v_pk_fma_f32 v[12:13], v[198:199], v[198:199], v[12:13]
    v_pk_mul_f32 v[14:15], v[200:201], v[200:201]
    v_pk_fma_f32 v[14:15], v[202:203], v[202:203], v[14:15]
    v_pk_fma_f32 v[14:15], v[204:205], v[204:205], v[14:15]
    v_pk_fma_f32 v[14:15], v[206:207], v[206:207], v[14:15]
    v_add_f32 v101, v12, v13
    v_add_f32 v14, v14, v15
    v_fmac_f32 v101, 0x3e800000, v14
    v_pk_mul_f32 v[12:13], v[184:185], v[76:77]
    v_pk_fma_f32 v[12:13], v[186:187], v[78:79], v[12:13]
    v_pk_fma_f32 v[12:13], v[188:189], v[80:81], v[12:13]
    v_pk_fma_f32 v[12:13], v[190:191], v[82:83], v[12:13]
    v_pk_fma_f32 v[12:13], v[192:193], v[84:85], v[12:13]
    v_pk_fma_f32 v[12:13], v[194:195], v[86:87], v[12:13]
    v_pk_fma_f32 v[12:13], v[196:197], v[88:89], v[12:13]
    v_pk_fma_f32 v[12:13], v[198:199], v[90:91], v[12:13]
    v_pk_mul_f32 v[14:15], v[200:201], v[92:93]
    v_pk_fma_f32 v[14:15], v[202:203], v[94:95], v[14:15]
    v_pk_fma_f32 v[14:15], v[204:205], v[96:97], v[14:15]
    v_pk_fma_f32 v[14:15], v[206:207], v[98:99], v[14:15]
    v_add_f32 v102, v12, v13
    v_add_f32 v14, v14, v15
    v_fmac_f32 v102, 0x3e800000, v14
    s_nop 1
    v_add_f32_dpp v101, v101, v101 row_ror:8 row_mask:0xf bank_mask:0xf
    v_add_f32_dpp v102, v102, v102 row_ror:8 row_mask:0xf bank_mask:0xf
    v_mov_b32 v103, v101
    v_mov_b32 v104, v102
    s_nop 0
    v_permlane16_swap_b32 v103, v101
    v_permlane16_swap_b32 v104, v102
    v_add_f32 v101, v101, v103
    v_add_f32 v102, v102, v104
    v_mov_b32 v103, v101
    v_mov_b32 v104, v102
    s_nop 0
    v_permlane32_swap_b32 v103, v101
    v_permlane32_swap_b32 v104, v102
    v_add_f32 v101, v101, v103
    v_add_f32 v102, v102, v104
    ds_write_b32 v10, v100 offset:0
    ds_write_b32 v10, v101 offset:128
    ds_write_b32 v10, v102 offset:256
    s_waitcnt lgkmcnt(0)
    s_barrier
    ds_read_b128 v[40:43], v11 offset:0
    ds_read_b128 v[44:47], v11 offset:128
    ds_read_b128 v[48:51], v11 offset:256
    ds_read_b128 v[52:55], v11 offset:384
    ds_read_b128 v[56:59], v11 offset:512
    s_waitcnt lgkmcnt(4)
    v_add_f32 v12, v40, v41
    v_add_f32 v13, v42, v43
    v_add_f32 v12, v12, v13
    v_mul_f32 v12, 0x3e800000, v12
    v_sub_f32 v40, v40, v12
    v_sub_f32 v41, v41, v12
    v_sub_f32 v42, v42, v12
    v_sub_f32 v43, v43, v12
    v_sub_f32 v100, v100, v12
    v_mul_f32 v13, v40, v40
    v_fmac_f32 v13, v41, v41
    v_fmac_f32 v13, v42, v42
    v_fmac_f32 v13, v43, v43
    s_waitcnt lgkmcnt(3)
    v_add_f32 v14, v44, v45
    v_add_f32 v15, v46, v47
    v_add_f32 v14, v14, v15
    v_fmac_f32 v14, 0x43100000, v13
    v_mov_b32 v13, 0x3727c5ac
    v_fmac_f32 v13, 0x3ae38e39, v14
    v_rsq_f32 v13, v13
    s_waitcnt lgkmcnt(0)
    v_mul_f32 v100, v100, v13
    v_pk_fma_f32 v[184:185], v[184:185], v[12:13], v[100:101] op_sel:[0,1,0] op_sel_hi:[1,1,0]
    v_pk_fma_f32 v[186:187], v[186:187], v[12:13], v[100:101] op_sel:[0,1,0] op_sel_hi:[1,1,0]
    v_pk_fma_f32 v[188:189], v[188:189], v[12:13], v[100:101] op_sel:[0,1,0] op_sel_hi:[1,1,0]
    v_pk_fma_f32 v[190:191], v[190:191], v[12:13], v[100:101] op_sel:[0,1,0] op_sel_hi:[1,1,0]
    v_pk_fma_f32 v[192:193], v[192:193], v[12:13], v[100:101] op_sel:[0,1,0] op_sel_hi:[1,1,0]
    v_pk_fma_f32 v[194:195], v[194:195], v[12:13], v[100:101] op_sel:[0,1,0] op_sel_hi:[1,1,0]
    v_pk_fma_f32 v[196:197], v[196:197], v[12:13], v[100:101] op_sel:[0,1,0] op_sel_hi:[1,1,0]
    v_pk_fma_f32 v[198:199], v[198:199], v[12:13], v[100:101] op_sel:[0,1,0] op_sel_hi:[1,1,0]
    v_pk_fma_f32 v[200:201], v[200:201], v[12:13], v[100:101] op_sel:[0,1,0] op_sel_hi:[1,1,0]
    v_pk_fma_f32 v[202:203], v[202:203], v[12:13], v[100:101] op_sel:[0,1,0] op_sel_hi:[1,1,0]
    v_pk_fma_f32 v[204:205], v[204:205], v[12:13], v[100:101] op_sel:[0,1,0] op_sel_hi:[1,1,0]
    v_pk_fma_f32 v[206:207], v[206:207], v[12:13], v[100:101] op_sel:[0,1,0] op_sel_hi:[1,1,0]
    v_pk_fma_f32 v[184:185], v[184:185], v[112:113], v[136:137]
    v_pk_fma_f32 v[186:187], v[186:187], v[114:115], v[138:139]
    v_pk_fma_f32 v[188:189], v[188:189], v[116:117], v[140:141]
    v_pk_fma_f32 v[190:191], v[190:191], v[118:119], v[142:143]
    v_pk_fma_f32 v[192:193], v[192:193], v[120:121], v[144:145]
    v_pk_fma_f32 v[194:195], v[194:195], v[122:123], v[146:147]
    v_pk_fma_f32 v[196:197], v[196:197], v[124:125], v[148:149]
    v_pk_fma_f32 v[198:199], v[198:199], v[126:127], v[150:151]
    v_pk_fma_f32 v[200:201], v[200:201], v[128:129], v[152:153]
    v_pk_fma_f32 v[202:203], v[202:203], v[130:131], v[154:155]
    v_pk_fma_f32 v[204:205], v[204:205], v[132:133], v[156:157]
    v_pk_fma_f32 v[206:207], v[206:207], v[134:135], v[158:159]
    v_pk_fma_f32 v[16:17], v[184:185], v[160:161], v[16:17]
    v_pk_fma_f32 v[18:19], v[186:187], v[162:163], v[18:19]
    v_pk_fma_f32 v[20:21], v[188:189], v[164:165], v[20:21]
    v_pk_fma_f32 v[22:23], v[190:191], v[166:167], v[22:23]
    v_pk_fma_f32 v[24:25], v[192:193], v[168:169], v[24:25]
    v_pk_fma_f32 v[26:27], v[194:195], v[170:171], v[26:27]
    v_pk_fma_f32 v[28:29], v[196:197], v[172:173], v[28:29]
    v_pk_fma_f32 v[30:31], v[198:199], v[174:175], v[30:31]
    v_pk_fma_f32 v[32:33], v[200:201], v[176:177], v[32:33]
    v_pk_fma_f32 v[34:35], v[202:203], v[178:179], v[34:35]
    v_pk_fma_f32 v[36:37], v[204:205], v[180:181], v[36:37]
    v_pk_fma_f32 v[38:39], v[206:207], v[182:183], v[38:39]
    v_cvt_pk_bf16_f32 v112, v16, v17
    v_cvt_pk_bf16_f32 v113, v18, v19
    v_cvt_pk_bf16_f32 v114, v20, v21
    v_cvt_pk_bf16_f32 v115, v22, v23
    ds_write_b128 v1, v[112:115] offset:0
    v_cvt_pk_bf16_f32 v116, v24, v25
    v_cvt_pk_bf16_f32 v117, v26, v27
    v_cvt_pk_bf16_f32 v118, v28, v29
    v_cvt_pk_bf16_f32 v119, v30, v31
    ds_write_b128 v1, v[116:119] offset:512
    v_cvt_pk_bf16_f32 v120, v32, v33
    v_cvt_pk_bf16_f32 v121, v34, v35
    v_cvt_pk_bf16_f32 v122, v36, v37
    v_cvt_pk_bf16_f32 v123, v38, v39
    ds_write_b128 v2, v[120:123] offset:0
    v_cvt_pk_bf16_f32 v124, v184, v185
    v_cvt_pk_bf16_f32 v125, v186, v187
    v_cvt_pk_bf16_f32 v126, v188, v189
    v_cvt_pk_bf16_f32 v127, v190, v191
    ds_write_b128 v1, v[124:127] offset:9344
    v_cvt_pk_bf16_f32 v128, v192, v193
    v_cvt_pk_bf16_f32 v129, v194, v195
    v_cvt_pk_bf16_f32 v130, v196, v197
    v_cvt_pk_bf16_f32 v131, v198, v199
    ds_write_b128 v1, v[128:131] offset:9856
    v_cvt_pk_bf16_f32 v132, v200, v201
    v_cvt_pk_bf16_f32 v133, v202, v203
    v_cvt_pk_bf16_f32 v134, v204, v205
    v_cvt_pk_bf16_f32 v135, v206, v207
    ds_write_b128 v2, v[132:135] offset:9344
    v_fmac_f32 v48, v40, v52
    v_fmac_f32 v49, v41, v53
    v_fmac_f32 v50, v42, v54
    v_fmac_f32 v51, v43, v55
    v_add_f32 v14, v48, v49
    v_add_f32 v15, v50, v51
    v_add_f32 v14, v14, v15
    v_add_f32 v15, v56, v57
    v_add_f32 v12, v58, v59
    v_add_f32 v15, v15, v12
    v_fmac_f32 v15, v14, v13
    s_waitcnt lgkmcnt(0)
    s_barrier
    ds_read_b128 v[160:163], v107
    ds_read_b128 v[164:167], v108
    ds_read_b128 v[168:171], v109
    ds_read_b128 v[172:175], v110
    ds_read_b128 v[176:179], v111
    s_lshl_b32 s3, s96, 3
    s_sub_u32 s3, 0xfff, s3
    v_and_b32 v14, 7, v0
    v_sub_u32 v14, s3, v14
L2_pad14:
    s_cbranch_execz L2_walkret
    v_ashrrev_i32 v12, 31, v15
    v_or_b32 v12, 0x80000000, v12
    v_xor_b32 v12, v12, v15
    v_and_b32 v12, 0xfffff000, v12
    v_or_b32 v100, v12, v14
    v_mov_b32 v101, 0
    s_waitcnt lgkmcnt(4)
    buffer_store_dwordx4 v[160:163], v8, s[24:27], s45 offen offset:0 sc1
    s_waitcnt lgkmcnt(3)
    buffer_store_dwordx4 v[164:167], v8, s[24:27], s45 offen offset:1024 sc1
    s_waitcnt lgkmcnt(2)
    buffer_store_dwordx4 v[168:171], v8, s[24:27], s45 offen offset:2048 sc1
    s_waitcnt lgkmcnt(1)
    buffer_store_dwordx4 v[172:175], v8, s[24:27], s45 offen offset:3072 sc1
    s_waitcnt lgkmcnt(0)
    s_mov_b32 exec_hi, 0
    s_add_u32 s45, s45, 4096
    buffer_store_dwordx4 v[176:179], v8, s[24:27], s45 offen offset:0 sc1
    s_mov_b64 exec, -1
    s_nop 1
    v_mov_b32_dpp v12, v100 row_ror:1 row_mask:0xf bank_mask:0xf
    v_mov_b32_dpp v13, v101 row_ror:1 row_mask:0xf bank_mask:0xf
    v_max_u32 v101, v101, v13
    v_med3_u32 v101, v100, v12, v101
    v_max_u32 v100, v100, v12
    s_nop 1
    v_mov_b32_dpp v12, v100 row_ror:2 row_mask:0xf bank_mask:0xf
    v_mov_b32_dpp v13, v101 row_ror:2 row_mask:0xf bank_mask:0xf
    v_max_u32 v101, v101, v13
    v_med3_u32 v101, v100, v12, v101
    v_max_u32 v100, v100, v12
    s_nop 1
    v_mov_b32_dpp v12, v100 row_ror:4 row_mask:0xf bank_mask:0xf
    v_mov_b32_dpp v13, v101 row_ror:4 row_mask:0xf bank_mask:0xf
    v_max_u32 v101, v101, v13
    v_med3_u32 v101, v100, v12, v101
    v_max_u32 v100, v100, v12
    s_lshl_b32 s3, s96, 7
    s_add_u32 s3, s3, 32776
    v_lshlrev_b32 v14, 7, v0
    s_lshl_b32 s15, s51, 13
    s_add_u32 s15, s15, 32776
    s_waitcnt vmcnt(0)
    s_barrier
    s_cmp_lg_u32 s51, 0
    s_cbranch_scc1 L2_nokey
    s_mov_b64 exec, 1
    buffer_store_dwordx2 v[100:101], v14, s[84:87], s3 offen sc1
    s_mov_b64 exec, -1
L2_nokey:
    s_cmp_lt_u32 s2, 248
    s_cbranch_scc1 L2_nowb
    s_cmp_lg_u32 s51, 0
    s_cbranch_scc1 L2_fin
    buffer_wbl2 sc1
L2_nowb:
    s_cmp_ge_u32 s2, 180
    s_cbranch_scc1 L2_fin
    s_cmp_ge_u32 s2, 144
    s_cbranch_scc1 L2_gather
    v_lshrrev_b32 v21, 4, v0
    v_bfe_u32 v20, v0, 2, 2
    v_lshl_add_u32 v20, v21, 3, v20
    v_and_b32 v21, 3, v0
    v_lshlrev_b32 v22, 6, v20
    v_lshl_add_u32 v22, v21, 3, v22
    s_cmp_lt_u32 s51, 2
    s_cselect_b32 s3, 126976, 0
    s_cselect_b32 s14, 0, 16384
    s_add_u32 s3, s3, s14
    s_and_b32 s14, s51, 1
    s_lshl_b32 s14, s14, 5
    s_add_u32 s3, s3, s14
    v_add_u32 v22, s3, v22
    v_mul_u32_u24 v23, 1152, v20
    v_lshl_add_u32 v23, v21, 3, v23
    s_mul_i32 s3, s51, 288
    s_add_u32 s3, s3, 53248
    v_add_u32 v23, s3, v23
    ds_read_b64_tr_b16 a[64:65], v22 offset:0
    ds_read_b64_tr_b16 a[66:67], v22 offset:256
    ds_read_b64_tr_b16 a[68:69], v22 offset:2048
    ds_read_b64_tr_b16 a[70:71], v22 offset:2304
    ds_read_b64_tr_b16 a[72:73], v22 offset:4096
    ds_read_b64_tr_b16 a[74:75], v22 offset:4352
    ds_read_b64_tr_b16 a[76:77], v22 offset:6144
    ds_read_b64_tr_b16 a[78:79], v22 offset:6400
    ds_read_b64_tr_b16 a[80:81], v22 offset:8192
    ds_read_b64_tr_b16 a[82:83], v22 offset:8448
    ds_read_b64_tr_b16 a[84:85], v22 offset:10240
    ds_read_b64_tr_b16 a[86:87], v22 offset:10496
    ds_read_b64_tr_b16 a[88:89], v22 offset:12288
    ds_read_b64_tr_b16 a[90:91], v22 offset:12544
    ds_read_b64_tr_b16 a[92:93], v22 offset:14336
    ds_read_b64_tr_b16 a[94:95], v22 offset:14592
    ds_read_b64_tr_b16 a[96:97], v22 offset:16384
    ds_read_b64_tr_b16 a[98:99], v22 offset:16640
    ds_read_b64_tr_b16 a[100:101], v22 offset:18432
    ds_read_b64_tr_b16 a[102:103], v22 offset:18688
    ds_read_b64_tr_b16 a[104:105], v22 offset:20480
    ds_read_b64_tr_b16 a[106:107], v22 offset:20736
    ds_read_b64_tr_b16 a[108:109], v22 offset:22528
    ds_read_b64_tr_b16 a[110:111], v22 offset:22784
    ds_read_b64_tr_b16 a[112:113], v22 offset:24576
    ds_read_b64_tr_b16 a[114:115], v22 offset:24832
    ds_read_b64_tr_b16 a[116:117], v22 offset:26624
    ds_read_b64_tr_b16 a[118:119], v22 offset:26880
    ds_read_b64_tr_b16 a[120:121], v22 offset:28672
    ds_read_b64_tr_b16 a[122:123], v22 offset:28928
    ds_read_b64_tr_b16 a[124:125], v22 offset:30720
    ds_read_b64_tr_b16 a[126:127], v22 offset:30976
    ds_read_b64_tr_b16 a[128:129], v22 offset:32768
    ds_read_b64_tr_b16 a[130:131], v22 offset:33024
    ds_read_b64_tr_b16 a[132:133], v22 offset:34816
    ds_read_b64_tr_b16 a[134:135], v22 offset:35072
    ds_read_b64_tr_b16 a[136:137], v23 offset:0
    ds_read_b64_tr_b16 a[138:139], v23 offset:4608
    ds_read_b64_tr_b16 a[140:141], v23 offset:32
    ds_read_b64_tr_b16 a[142:143], v23 offset:4640
    ds_read_b64_tr_b16 a[144:145], v23 offset:64
    ds_read_b64_tr_b16 a[146:147], v23 offset:4672
    ds_read_b64_tr_b16 a[148:149], v23 offset:96
    ds_read_b64_tr_b16 a[150:151], v23 offset:4704
    ds_read_b64_tr_b16 a[152:153], v23 offset:128
    ds_read_b64_tr_b16 a[154:155], v23 offset:4736
    ds_read_b64_tr_b16 a[156:157], v23 offset:160
    ds_read_b64_tr_b16 a[158:159], v23 offset:4768
    ds_read_b64_tr_b16 a[160:161], v23 offset:192
    ds_read_b64_tr_b16 a[162:163], v23 offset:4800
    ds_read_b64_tr_b16 a[164:165], v23 offset:224
    ds_read_b64_tr_b16 a[166:167], v23 offset:4832
    ds_read_b64_tr_b16 a[168:169], v23 offset:256
    ds_read_b64_tr_b16 a[170:171], v23 offset:4864
L2_gather:
    s_mov_b32 s97, 0x20000
L2_p2:
    buffer_load_dwordx2 v[16:17], v14, s[84:87], s15 offen sc1
    s_waitcnt vmcnt(0)
    v_min_u32 v12, v16, v17
    v_cmp_eq_u32 vcc, 0, v12
    s_sub_u32 s97, s97, 1
    s_cselect_b64 vcc, 0, vcc
    s_cmp_eq_u64 vcc, 0
    s_cbranch_scc1 L2_p2_ok
    s_mov_b64 exec, vcc
    s_sleep 1
    s_branch L2_p2
L2_p2_ok:
    s_mov_b64 exec, -1
    s_nop 1
    v_mov_b32_dpp v12, v16 row_ror:1 row_mask:0xf bank_mask:0xf
    v_mov_b32_dpp v13, v17 row_ror:1 row_mask:0xf bank_mask:0xf
    v_max_u32 v17, v17, v13
    v_med3_u32 v17, v16, v12, v17
    v_max_u32 v16, v16, v12
    s_nop 1
    v_mov_b32_dpp v12, v16 row_ror:2 row_mask:0xf bank_mask:0xf
    v_mov_b32_dpp v13, v17 row_ror:2 row_mask:0xf bank_mask:0xf
    v_max_u32 v17, v17, v13
    v_med3_u32 v17, v16, v12, v17
    v_max_u32 v16, v16, v12
    s_nop 1
    v_mov_b32_dpp v12, v16 row_ror:4 row_mask:0xf bank_mask:0xf
    v_mov_b32_dpp v13, v17 row_ror:4 row_mask:0xf bank_mask:0xf
    v_max_u32 v17, v17, v13
    v_med3_u32 v17, v16, v12, v17
    v_max_u32 v16, v16, v12
    s_nop 1
    v_mov_b32_dpp v12, v16 row_ror:8 row_mask:0xf bank_mask:0xf
    v_mov_b32_dpp v13, v17 row_ror:8 row_mask:0xf bank_mask:0xf
    v_max_u32 v17, v17, v13
    v_med3_u32 v17, v16, v12, v17
    v_max_u32 v16, v16, v12
    v_mov_b32 v12, v16
    v_mov_b32 v13, v17
    s_nop 0
    v_permlane16_swap_b32 v12, v16
    v_permlane16_swap_b32 v13, v17
    v_max_u32 v17, v17, v13
    v_med3_u32 v17, v16, v12, v17
    v_max_u32 v16, v16, v12
    v_mov_b32 v12, v16
    v_mov_b32 v13, v17
    s_nop 0
    v_permlane32_swap_b32 v12, v16
    v_permlane32_swap_b32 v13, v17
    v_max_u32 v17, v17, v13
    v_med3_u32 v17, v16, v12, v17
    v_max_u32 v16, v16, v12
    s_lshl_b32 s3, s51, 3
    s_add_u32 s3, s3, 15616
    v_mov_b32 v12, s3
    v_mov_b32 v13, 15616
    ds_write_b64 v12, v[16:17]
    s_waitcnt lgkmcnt(0)
    s_barrier
    ds_read_b128 v[16:19], v13
    ds_read_b128 v[20:23], v13 offset:16
    v_and_b32 v6, 1, v0
    v_lshrrev_b32 v7, 4, v0
    s_waitcnt lgkmcnt(0)
    v_max_u32 v17, v17, v19
    v_med3_u32 v17, v16, v18, v17
    v_max_u32 v16, v16, v18
    v_max_u32 v21, v21, v23
    v_med3_u32 v21, v20, v22, v21
    v_max_u32 v20, v20, v22
    v_max_u32 v17, v17, v21
    v_med3_u32 v17, v16, v20, v17
    v_max_u32 v16, v16, v20
    s_cmp_ge_u32 s2, 144
    s_cbranch_scc1 L2_red
    v_cmp_eq_u32 vcc, 0, v6
    s_nop 1
    v_cndmask_b32 v4, v17, v16, vcc
    v_and_b32 v4, 0x7ff, v4
    v_sub_u32 v4, 2047, v4
    v_mul_u32_u24 v5, 1152, v4
    v_lshl_add_u32 v5, v7, 4, v5
    s_mov_b32 s3, 4194304
    s_mov_b32 exec_lo, 0x30003
    s_mov_b32 exec_hi, 0x30003
    buffer_load_dwordx4 v[128:131], v5, s[84:87], s3 offen offset:0 sc1
    buffer_load_dwordx4 v[132:135], v5, s[84:87], s3 offen offset:64 sc1
    buffer_load_dwordx4 v[136:139], v5, s[84:87], s3 offen offset:128 sc1
    buffer_load_dwordx4 v[140:143], v5, s[84:87], s3 offen offset:192 sc1
    buffer_load_dwordx4 v[144:147], v5, s[84:87], s3 offen offset:256 sc1
    buffer_load_dwordx4 v[148:151], v5, s[84:87], s3 offen offset:320 sc1
    buffer_load_dwordx4 v[152:155], v5, s[84:87], s3 offen offset:384 sc1
    buffer_load_dwordx4 v[156:159], v5, s[84:87], s3 offen offset:448 sc1
    buffer_load_dwordx4 v[160:163], v5, s[84:87], s3 offen offset:512 sc1
    buffer_load_dwordx4 v[164:167], v5, s[84:87], s3 offen offset:576 sc1
    buffer_load_dwordx4 v[168:171], v5, s[84:87], s3 offen offset:640 sc1
    buffer_load_dwordx4 v[172:175], v5, s[84:87], s3 offen offset:704 sc1
    buffer_load_dwordx4 v[176:179], v5, s[84:87], s3 offen offset:768 sc1
    buffer_load_dwordx4 v[180:183], v5, s[84:87], s3 offen offset:832 sc1
    buffer_load_dwordx4 v[184:187], v5, s[84:87], s3 offen offset:896 sc1
    buffer_load_dwordx4 v[188:191], v5, s[84:87], s3 offen offset:960 sc1
    buffer_load_dwordx4 v[192:195], v5, s[84:87], s3 offen offset:1024 sc1
    buffer_load_dwordx4 v[196:199], v5, s[84:87], s3 offen offset:1088 sc1
    s_mov_b64 exec, -1
    v_lshlrev_b32 v11, 7, v6
    v_lshl_add_u32 v13, v7, 5, v11
    v_add_u32 v13, 14848, v13
    v_lshl_add_u32 v11, v7, 4, v11
    s_lshr_b32 s3, s51, 1
    s_lshl_b32 s3, s3, 8
    s_and_b32 s14, s51, 1
    s_lshl_b32 s14, s14, 6
    s_add_u32 s3, s3, s14
    s_add_u32 s3, s3, 14848
    v_add_u32 v11, s3, v11
    s_mul_i32 s14, s51, 1152
    s_add_u32 s3, s14, 110592
    v_mul_u32_u24 v9, 576, v6
    v_lshl_add_u32 v9, v7, 4, v9
    v_add_u32 v9, s3, v9
    v_add_u32 v10, s3, v8
    s_mul_i32 s15, s2, 4608
    s_add_u32 s15, s15, s14
    s_add_u32 s15, s15, 98304
    s_waitcnt vmcnt(17)
    v_mfma_f32_16x16x32_bf16 v[88:91], a[64:67], v[128:131], 0
    s_waitcnt vmcnt(16)
    v_mfma_f32_16x16x32_bf16 v[88:91], a[68:71], v[132:135], v[88:91]
    s_waitcnt vmcnt(15)
    v_mfma_f32_16x16x32_bf16 v[88:91], a[72:75], v[136:139], v[88:91]
    s_waitcnt vmcnt(14)
    v_mfma_f32_16x16x32_bf16 v[88:91], a[76:79], v[140:143], v[88:91]
    s_waitcnt vmcnt(13)
    v_mfma_f32_16x16x32_bf16 v[88:91], a[80:83], v[144:147], v[88:91]
    s_waitcnt vmcnt(12)
    v_mfma_f32_16x16x32_bf16 v[88:91], a[84:87], v[148:151], v[88:91]
    s_waitcnt vmcnt(11)
    v_mfma_f32_16x16x32_bf16 v[88:91], a[88:91], v[152:155], v[88:91]
    s_waitcnt vmcnt(10)
    v_mfma_f32_16x16x32_bf16 v[88:91], a[92:95], v[156:159], v[88:91]
    s_waitcnt vmcnt(9)
    v_mfma_f32_16x16x32_bf16 v[88:91], a[96:99], v[160:163], v[88:91]
    s_waitcnt vmcnt(8)
    v_mfma_f32_16x16x32_bf16 v[88:91], a[100:103], v[164:167], v[88:91]
    s_waitcnt vmcnt(7)
    v_mfma_f32_16x16x32_bf16 v[88:91], a[104:107], v[168:171], v[88:91]
    s_waitcnt vmcnt(6)
    v_mfma_f32_16x16x32_bf16 v[88:91], a[108:111], v[172:175], v[88:91]
    s_waitcnt vmcnt(5)
    v_mfma_f32_16x16x32_bf16 v[88:91], a[112:115], v[176:179], v[88:91]
    s_waitcnt vmcnt(4)
    v_mfma_f32_16x16x32_bf16 v[88:91], a[116:119], v[180:183], v[88:91]
    s_waitcnt vmcnt(3)
    v_mfma_f32_16x16x32_bf16 v[88:91], a[120:123], v[184:187], v[88:91]
    s_waitcnt vmcnt(2)
    v_mfma_f32_16x16x32_bf16 v[88:91], a[124:127], v[188:191], v[88:91]
    s_waitcnt vmcnt(1)
    v_mfma_f32_16x16x32_bf16 v[88:91], a[128:131], v[192:195], v[88:91]
    s_waitcnt vmcnt(0)
    v_mfma_f32_16x16x32_bf16 v[88:91], a[132:135], v[196:199], v[88:91]
    s_nop 5
    s_mov_b32 exec_lo, 0x30003
    s_mov_b32 exec_hi, 0x30003
    ds_write_b128 v11, v[88:91]
    s_mov_b64 exec, -1
    s_waitcnt lgkmcnt(0)
    s_barrier
    ds_read_b128 v[16:19], v13 offset:0
    ds_read_b128 v[20:23], v13 offset:16
    ds_read_b128 v[24:27], v13 offset:256
    ds_read_b128 v[28:31], v13 offset:272
    s_waitcnt lgkmcnt(2)
    v_mul_f32 v32, 0xbfb8aa3b, v16
    v_mul_f32 v33, 0xbfb8aa3b, v17
    v_mul_f32 v34, 0xbfb8aa3b, v18
    v_mul_f32 v35, 0xbfb8aa3b, v19
    v_mul_f32 v36, 0xbfb8aa3b, v20
    v_mul_f32 v37, 0xbfb8aa3b, v21
    v_mul_f32 v38, 0xbfb8aa3b, v22
    v_mul_f32 v39, 0xbfb8aa3b, v23
    v_exp_f32 v32, v32
    v_exp_f32 v33, v33
    v_exp_f32 v34, v34
    v_exp_f32 v35, v35
    v_exp_f32 v36, v36
    v_exp_f32 v37, v37
    v_exp_f32 v38, v38
    v_exp_f32 v39, v39
    v_add_f32 v32, 1.0, v32
    v_add_f32 v33, 1.0, v33
    v_add_f32 v34, 1.0, v34
    v_add_f32 v35, 1.0, v35
    v_add_f32 v36, 1.0, v36
    v_add_f32 v37, 1.0, v37
    v_add_f32 v38, 1.0, v38
    v_add_f32 v39, 1.0, v39
    v_rcp_f32 v32, v32
    v_rcp_f32 v33, v33
    v_rcp_f32 v34, v34
    v_rcp_f32 v35, v35
    v_rcp_f32 v36, v36
    v_rcp_f32 v37, v37
    v_rcp_f32 v38, v38
    v_rcp_f32 v39, v39
    s_waitcnt lgkmcnt(0)
    v_mul_f32 v16, v16, v32
    v_mul_f32 v17, v17, v33
    v_mul_f32 v18, v18, v34
    v_mul_f32 v19, v19, v35
    v_mul_f32 v20, v20, v36
    v_mul_f32 v21, v21, v37
    v_mul_f32 v22, v22, v38
    v_mul_f32 v23, v23, v39
    v_mul_f32 v16, v16, v24
    v_mul_f32 v17, v17, v25
    v_mul_f32 v18, v18, v26
    v_mul_f32 v19, v19, v27
    v_mul_f32 v20, v20, v28
    v_mul_f32 v21, v21, v29
    v_mul_f32 v22, v22, v30
    v_mul_f32 v23, v23, v31
    v_cvt_pk_bf16_f32 v40, v16, v17
    v_cvt_pk_bf16_f32 v41, v18, v19
    v_cvt_pk_bf16_f32 v42, v20, v21
    v_cvt_pk_bf16_f32 v43, v22, v23
    s_nop 1
    v_mfma_f32_16x16x32_bf16 v[48:51], a[136:139], v[40:43], 0
    v_mfma_f32_16x16x32_bf16 v[52:55], a[140:143], v[40:43], 0
    v_mfma_f32_16x16x32_bf16 v[56:59], a[144:147], v[40:43], 0
    v_mfma_f32_16x16x32_bf16 v[60:63], a[148:151], v[40:43], 0
    v_mfma_f32_16x16x32_bf16 v[64:67], a[152:155], v[40:43], 0
    v_mfma_f32_16x16x32_bf16 v[68:71], a[156:159], v[40:43], 0
    v_mfma_f32_16x16x32_bf16 v[72:75], a[160:163], v[40:43], 0
    v_mfma_f32_16x16x32_bf16 v[76:79], a[164:167], v[40:43], 0
    v_mfma_f32_16x16x32_bf16 v[80:83], a[168:171], v[40:43], 0
    s_mov_b32 exec_lo, 0x30003
    s_mov_b32 exec_hi, 0x30003
    ds_write_b128 v9, v[48:51] offset:0
    ds_write_b128 v9, v[52:55] offset:64
    ds_write_b128 v9, v[56:59] offset:128
    ds_write_b128 v9, v[60:63] offset:192
    ds_write_b128 v9, v[64:67] offset:256
    ds_write_b128 v9, v[68:71] offset:320
    ds_write_b128 v9, v[72:75] offset:384
    ds_write_b128 v9, v[76:79] offset:448
    ds_write_b128 v9, v[80:83] offset:512
    s_mov_b64 exec, -1
    ds_read_b128 v[16:19], v10
    ds_read_b128 v[20:23], v10 offset:1024
    s_waitcnt lgkmcnt(0)
    v_min_u32 v16, -2, v16
    v_min_u32 v17, -2, v17
    v_min_u32 v18, -2, v18
    v_min_u32 v19, -2, v19
    v_min_u32 v20, -2, v20
    v_min_u32 v21, -2, v21
    v_min_u32 v22, -2, v22
    v_min_u32 v23, -2, v23
    buffer_store_dwordx4 v[16:19], v8, s[84:87], s15 offen sc1
    s_mov_b64 exec, 0xff
    buffer_store_dwordx4 v[20:23], v8, s[84:87], s15 offen offset:1024 sc1
    s_branch L2_fin
L2_red:
    s_mov_b32 s3, 98304
    s_add_u32 s32, s84, s3
    s_addc_u32 s33, s85, 0
    s_mov_b32 s34, 663552
    s_mov_b32 s35, 0x20000
    s_sub_u32 s3, s2, 144
    s_mul_i32 s14, s3, 7282
    s_lshr_b32 s14, s14, 16
    s_mul_i32 s15, s14, 9
    s_sub_u32 s15, s3, s15
    s_lshl_b32 s15, s15, 5
    s_mul_i32 s14, s14, 144
    v_and_b32 v6, 7, v0
    v_lshl_add_u32 v7, v6, 2, s15
    v_cmp_gt_u32 vcc, 144, v7
    v_subrev_u32 v9, 144, v7
    v_lshrrev_b32 v10, 3, v0
    v_cndmask_b32 v7, v9, v7, vcc
    v_cndmask_b32 v16, v17, v16, vcc
    v_add_u32 v7, s14, v7
    v_and_b32 v9, 0x7ff, v16
    v_sub_u32 v9, 2047, v9
    v_mul_u32_u24 v9, 1152, v9
    v_lshl_add_u32 v9, v7, 1, v9
    v_lshlrev_b32 v7, 2, v7
    buffer_load_dwordx2 v[18:19], v9, s[80:83], 0 offen sc1
    ds_read_b128 v[20:23], v7 offset:6912
    s_lshl_b32 s14, s51, 3
    v_add_u32 v10, s14, v10
    v_mul_u32_u24 v10, 4608, v10
    v_lshl_add_u32 v10, v6, 4, v10
    s_lshl_b32 s3, s3, 7
    v_add_u32 v24, s3, v10
    v_add_u32 v25, 147456, v24
    v_add_u32 v26, 294912, v24
    v_add_u32 v27, 442368, v24
    v_add_u32 v28, 589824, v24
    v_and_b32 v16, 0xfffff800, v16
    v_not_b32 v12, v16
    v_ashrrev_i32 v12, 31, v12
    v_or_b32 v12, 0x80000000, v12
    v_xor_b32 v16, v16, v12
    v_mul_f32 v16, 0xbfb8aa3b, v16
    v_exp_f32 v16, v16
    s_nop 0
    v_add_f32 v16, 1.0, v16
    v_rcp_f32 v16, v16
    s_waitcnt lgkmcnt(0)
    v_mul_f32 v20, v20, v16
    v_mul_f32 v21, v21, v16
    v_mul_f32 v22, v22, v16
    v_mul_f32 v23, v23, v16
    v_lshlrev_b32 v11, 4, v6
    v_add_u32 v11, 15872, v11
    s_lshl_b32 s14, s51, 7
    v_add_u32 v10, s14, v11
    s_mov_b32 s97, 0x20000
L2_p3:
    buffer_load_dwordx4 v[32:35], v24, s[32:35], 0 offen sc1
    buffer_load_dwordx4 v[36:39], v25, s[32:35], 0 offen sc1
    buffer_load_dwordx4 v[40:43], v26, s[32:35], 0 offen sc1
    buffer_load_dwordx4 v[44:47], v27, s[32:35], 0 offen sc1
    buffer_load_dwordx4 v[48:51], v28, s[32:35], 0 offen sc1
    s_waitcnt vmcnt(0)
    v_max3_u32 v12, v32, v33, v34
    v_max3_u32 v12, v12, v35, v36
    v_max3_u32 v12, v12, v37, v38
    v_max3_u32 v12, v12, v39, v40
    v_max3_u32 v12, v12, v41, v42
    v_max3_u32 v12, v12, v43, v44
    v_max3_u32 v12, v12, v45, v46
    v_max3_u32 v12, v12, v47, v48
    v_max3_u32 v12, v12, v49, v50
    v_max_u32 v12, v12, v51
    v_cmp_eq_u32 vcc, -1, v12
    s_sub_u32 s97, s97, 1
    s_cselect_b64 vcc, 0, vcc
    s_cmp_eq_u64 vcc, 0
    s_cbranch_scc1 L2_p3_ok
    s_sleep 1
    s_branch L2_p3
L2_p3_ok:
    v_pk_add_f32 v[32:33], v[32:33], v[36:37]
    v_pk_add_f32 v[40:41], v[40:41], v[44:45]
    v_pk_add_f32 v[32:33], v[32:33], v[48:49]
    v_pk_add_f32 v[32:33], v[32:33], v[40:41]
    v_pk_add_f32 v[34:35], v[34:35], v[38:39]
    v_pk_add_f32 v[42:43], v[42:43], v[46:47]
    v_pk_add_f32 v[34:35], v[34:35], v[50:51]
    v_pk_add_f32 v[34:35], v[34:35], v[42:43]
    s_nop 1
    v_add_f32_dpp v32, v32, v32 row_ror:8 row_mask:0xf bank_mask:0xf
    v_add_f32_dpp v33, v33, v33 row_ror:8 row_mask:0xf bank_mask:0xf
    v_add_f32_dpp v34, v34, v34 row_ror:8 row_mask:0xf bank_mask:0xf
    v_add_f32_dpp v35, v35, v35 row_ror:8 row_mask:0xf bank_mask:0xf
    v_mov_b32 v12, v32
    v_mov_b32 v13, v33
    v_mov_b32 v14, v34
    v_mov_b32 v15, v35
    v_permlane16_swap_b32 v12, v32
    v_permlane16_swap_b32 v13, v33
    v_permlane16_swap_b32 v14, v34
    v_permlane16_swap_b32 v15, v35
    v_add_f32 v32, v32, v12
    v_add_f32 v33, v33, v13
    v_add_f32 v34, v34, v14
    v_add_f32 v35, v35, v15
    v_mov_b32 v12, v32
    v_mov_b32 v13, v33
    v_mov_b32 v14, v34
    v_mov_b32 v15, v35
    v_permlane32_swap_b32 v12, v32
    v_permlane32_swap_b32 v13, v33
    v_permlane32_swap_b32 v14, v34
    v_permlane32_swap_b32 v15, v35
    v_add_f32 v32, v32, v12
    v_add_f32 v33, v33, v13
    v_add_f32 v34, v34, v14
    v_add_f32 v35, v35, v15
    ds_write_b128 v10, v[32:35]
    s_waitcnt lgkmcnt(0)
    s_barrier
    ds_read_b128 v[32:35], v11 offset:0
    ds_read_b128 v[36:39], v11 offset:128
    ds_read_b128 v[40:43], v11 offset:256
    ds_read_b128 v[44:47], v11 offset:384
    v_lshlrev_b32 v12, 16, v18
    v_and_b32 v13, 0xffff0000, v18
    v_lshlrev_b32 v14, 16, v19
    v_and_b32 v15, 0xffff0000, v19
    s_waitcnt lgkmcnt(0)
    v_pk_add_f32 v[32:33], v[32:33], v[36:37]
    v_pk_add_f32 v[40:41], v[40:41], v[44:45]
    v_pk_add_f32 v[32:33], v[32:33], v[40:41]
    v_pk_fma_f32 v[12:13], v[32:33], v[20:21], v[12:13]
    v_pk_add_f32 v[34:35], v[34:35], v[38:39]
    v_pk_add_f32 v[42:43], v[42:43], v[46:47]
    v_pk_add_f32 v[34:35], v[34:35], v[42:43]
    v_pk_fma_f32 v[14:15], v[34:35], v[22:23], v[14:15]
    v_cvt_pk_bf16_f32 v12, v12, v13
    v_cvt_pk_bf16_f32 v13, v14, v15
    s_cmp_lg_u32 s51, 0
    s_cbranch_scc1 L2_fin
    s_mov_b64 exec, 0xff
    buffer_store_dwordx2 v[12:13], v9, s[80:83], 0 offen sc1
L2_fin:
L2_end:
    s_endpgm
L2_p0s:
    s_mov_b32 s97, 0x20000
L2_p0:
    buffer_load_dword v51, v156, s[60:63], 0 offen sc1
    s_waitcnt vmcnt(0)
    v_cmp_eq_u32 vcc, 0, v51
    s_sub_u32 s97, s97, 1
    s_cselect_b64 vcc, 0, vcc
    s_cmp_eq_u64 vcc, 0
    s_cbranch_scc1 L2_p0_ok
    s_sleep 1
    s_branch L2_p0
L2_p0_ok:
    s_branch L2_p0r
L2_pms:
    s_mov_b32 s97, 0x20000
L2_pm:
    buffer_load_dwordx4 v[168:171], v166, s[84:87], 0 offen sc1
    buffer_load_dwordx4 v[176:179], v166, s[84:87], s14 offen sc1
    s_mov_b64 exec, 0xff
    buffer_load_dwordx4 v[172:175], v166, s[84:87], 0 offen offset:1024 sc1
    buffer_load_dwordx4 v[180:183], v166, s[84:87], s14 offen offset:1024 sc1
    s_mov_b64 exec, -1
    s_waitcnt vmcnt(0)
    v_max_u32 v13, v168, v169
    v_max3_u32 v13, v13, v170, v171
    v_max3_u32 v13, v13, v172, v173
    v_max3_u32 v13, v13, v174, v175
    v_max3_u32 v13, v13, v176, v177
    v_max3_u32 v13, v13, v178, v179
    v_max3_u32 v13, v13, v180, v181
    v_max3_u32 v13, v13, v182, v183
    v_cmp_eq_u32 vcc, -1, v13
    s_sub_u32 s97, s97, 1
    s_cselect_b64 vcc, 0, vcc
    s_cmp_eq_u64 vcc, 0
    s_cbranch_scc1 L2_pm_ok
    s_sleep 1
    s_branch L2_pm
L2_pm_ok:
    s_branch L2_pmr
L2_g0s:
    s_mov_b32 s97, 0x20000
L2_g0:
    buffer_load_dword v9, v6, s[84:87], s47 offen sc1
    s_waitcnt vmcnt(0)
    v_cmp_ne_u32 vcc, 0, v9
    s_nop 0
    s_lshr_b32 s3, vcc_lo, 1
    s_and_b32 s3, s3, vcc_lo
    s_lshr_b32 s14, s3, 2
    s_and_b32 s3, s3, s14
    s_and_b32 s3, s3, s48
    s_cselect_b64 vcc, 0, -1
    s_sub_u32 s97, s97, 1
    s_cselect_b64 vcc, 0, vcc
    s_cmp_eq_u64 vcc, 0
    s_cbranch_scc1 L2_g0_ok
    s_sleep 1
    s_branch L2_g0
L2_g0_ok:
    s_cmp_eq_u32 s3, 0
    s_cselect_b32 s3, s48, s3
    s_branch L2_g0r
L2_pns:
    s_mov_b32 s97, 0x20000
L2_pn:
    s_movk_i32 s45, 4608
    buffer_load_dwordx4 v[76:79], v5, s[84:87], s45 offen sc1
    s_movk_i32 s45, 18432
    buffer_load_dwordx4 v[88:91], v5, s[84:87], s45 offen sc1
    s_movk_i32 s45, 8704
    buffer_load_dwordx4 v[80:83], v5, s[84:87], s45 offen sc1
    s_movk_i32 s45, 22528
    buffer_load_dwordx4 v[92:95], v5, s[84:87], s45 offen sc1
    s_movk_i32 s45, 12800
    buffer_load_dwordx4 v[84:87], v59, s[84:87], s45 offen sc1
    s_movk_i32 s45, 26624
    buffer_load_dwordx4 v[96:99], v59, s[84:87], s45 offen sc1
    s_waitcnt vmcnt(0)
    v_max_u32 v13, v76, v77
    v_max3_u32 v13, v13, v78, v79
    v_max3_u32 v13, v13, v88, v89
    v_max3_u32 v13, v13, v90, v91
    v_max3_u32 v13, v13, v80, v81
    v_max3_u32 v13, v13, v82, v83
    v_max3_u32 v13, v13, v92, v93
    v_max3_u32 v13, v13, v94, v95
    v_max3_u32 v13, v13, v84, v85
    v_max3_u32 v13, v13, v86, v87
    v_max3_u32 v13, v13, v96, v97
    v_max3_u32 v13, v13, v98, v99
    v_cmp_eq_u32 vcc, -1, v13
    s_sub_u32 s97, s97, 1
    s_cselect_b64 vcc, 0, vcc
    s_cmp_eq_u64 vcc, 0
    s_cbranch_scc1 L2_pn_ok
    s_sleep 1
    s_branch L2_pn
L2_pn_ok:
    s_branch L2_pnr
L2_g1s:
    s_mov_b32 s97, 0x20000
L2_g1:
    buffer_load_dword v9, v6, s[84:87], s47 offen sc1
    s_waitcnt vmcnt(0)
    v_cmp_ne_u32 vcc, 0, v9
    s_nop 0
    s_lshr_b32 s3, vcc_lo, 1
    s_and_b32 s3, s3, vcc_lo
    s_lshr_b32 s14, s3, 2
    s_and_b32 s3, s3, s14
    s_and_b32 s3, s3, s48
    s_cselect_b64 vcc, 0, -1
    s_sub_u32 s97, s97, 1
    s_cselect_b64 vcc, 0, vcc
    s_cmp_eq_u64 vcc, 0
    s_cbranch_scc1 L2_g1_ok
    s_sleep 1
    s_branch L2_g1
L2_g1_ok:
    s_cmp_eq_u32 s3, 0
    s_cselect_b32 s3, s48, s3
    s_branch L2_g1r
L2_g2s:
    s_mov_b32 s97, 0x20000
L2_g2:
    buffer_load_dword v9, v6, s[84:87], s47 offen sc1
    s_waitcnt vmcnt(0)
    v_cmp_ne_u32 vcc, 0, v9
    s_nop 0
    s_lshr_b32 s3, vcc_lo, 1
    s_and_b32 s3, s3, vcc_lo
    s_lshr_b32 s14, s3, 2
    s_and_b32 s3, s3, s14
    s_and_b32 s3, s3, s48
    s_cselect_b64 vcc, 0, -1
    s_sub_u32 s97, s97, 1
    s_cselect_b64 vcc, 0, vcc
    s_cmp_eq_u64 vcc, 0
    s_cbranch_scc1 L2_g2_ok
    s_sleep 1
    s_branch L2_g2
L2_g2_ok:
    s_cmp_eq_u32 s3, 0
    s_cselect_b32 s3, s48, s3
    s_branch L2_g2r
L2_g3s:
    s_mov_b32 s97, 0x20000
L2_g3:
    buffer_load_dword v9, v6, s[84:87], s47 offen sc1
    s_waitcnt vmcnt(0)
    v_cmp_ne_u32 vcc, 0, v9
    s_nop 0
    s_lshr_b32 s3, vcc_lo, 1
    s_and_b32 s3, s3, vcc_lo
    s_lshr_b32 s14, s3, 2
    s_and_b32 s3, s3, s14
    s_and_b32 s3, s3, s48
    s_cselect_b64 vcc, 0, -1
    s_sub_u32 s97, s97, 1
    s_cselect_b64 vcc, 0, vcc
    s_cmp_eq_u64 vcc, 0
    s_cbranch_scc1 L2_g3_ok
    s_sleep 1
    s_branch L2_g3
L2_g3_ok:
    s_cmp_eq_u32 s3, 0
    s_cselect_b32 s3, s48, s3
    s_branch L2_g3r
L2_fallback:
    s_waitcnt vmcnt(0) lgkmcnt(0)
    s_nop 7
    s_barrier
    s_lshl_b32 s3, s51, 12
    v_add_u32 v5, s3, v8
    v_lshrrev_b32 v14, 2, v0
    v_mul_u32_u24 v14, 1056, v14
    v_and_b32 v15, 3, v0
    v_lshl_add_u32 v14, v15, 3, v14
    v_add_u32 v2, 107008, v14
    v_and_b32 v14, 15, v0
    v_mul_u32_u24 v14, 1056, v14
    v_lshrrev_b32 v15, 4, v0
    v_lshl_add_u32 v14, v15, 4, v14
    v_add_u32 v1, 90112, v14
    v_mov_b32 v32, 0xff800000
    v_mov_b32 v33, 0xff800000
    v_mov_b32 v34, 0xff800000
    v_mov_b32 v35, 0xff800000
    s_mov_b32 s50, 1
    s_mov_b32 s46, 0
L2_fb_loop:
    s_add_u32 m0, s44, 73728
    s_nop 0
    buffer_load_dwordx4 v5, s[16:19], s46 offen offset:0 lds
    s_add_u32 m0, s44, 73760
    s_nop 0
    buffer_load_dwordx4 v5, s[16:19], s46 offen offset:1024 lds
    s_add_u32 m0, s44, 73792
    s_nop 0
    buffer_load_dwordx4 v5, s[16:19], s46 offen offset:2048 lds
    s_add_u32 m0, s44, 73824
    s_nop 0
    buffer_load_dwordx4 v5, s[16:19], s46 offen offset:3072 lds
    s_waitcnt vmcnt(0) lgkmcnt(0)
    s_barrier
    ds_read_b128 a[64:67], v1 offset:0
    ds_read_b128 a[68:71], v1 offset:64
    ds_read_b128 a[72:75], v1 offset:128
    ds_read_b128 a[76:79], v1 offset:192
    ds_read_b128 a[80:83], v1 offset:256
    ds_read_b128 a[84:87], v1 offset:320
    ds_read_b128 a[88:91], v1 offset:384
    ds_read_b128 a[92:95], v1 offset:448
    ds_read_b128 a[96:99], v1 offset:512
    ds_read_b128 a[100:103], v1 offset:576
    ds_read_b128 a[104:107], v1 offset:640
    ds_read_b128 a[108:111], v1 offset:704
    ds_read_b128 a[112:115], v1 offset:768
    ds_read_b128 a[116:119], v1 offset:832
    ds_read_b128 a[120:123], v1 offset:896
    ds_read_b128 a[124:127], v1 offset:960
    s_waitcnt vmcnt(0) lgkmcnt(0)
    s_barrier
    v_mfma_f32_16x16x32_bf16 v[16:19], a[64:67], v[64:67], 0
    v_mfma_f32_16x16x32_bf16 v[16:19], a[68:71], v[68:71], v[16:19]
    v_mfma_f32_16x16x32_bf16 v[16:19], a[72:75], v[72:75], v[16:19]
    v_mfma_f32_16x16x32_bf16 v[16:19], a[76:79], v[76:79], v[16:19]
    v_mfma_f32_16x16x32_bf16 v[20:23], a[80:83], v[64:67], 0
    v_mfma_f32_16x16x32_bf16 v[20:23], a[84:87], v[68:71], v[20:23]
    v_mfma_f32_16x16x32_bf16 v[20:23], a[88:91], v[72:75], v[20:23]
    v_mfma_f32_16x16x32_bf16 v[20:23], a[92:95], v[76:79], v[20:23]
    v_mfma_f32_16x16x32_bf16 v[24:27], a[96:99], v[64:67], 0
    v_mfma_f32_16x16x32_bf16 v[24:27], a[100:103], v[68:71], v[24:27]
    v_mfma_f32_16x16x32_bf16 v[24:27], a[104:107], v[72:75], v[24:27]
    v_mfma_f32_16x16x32_bf16 v[24:27], a[108:111], v[76:79], v[24:27]
    v_mfma_f32_16x16x32_bf16 v[28:31], a[112:115], v[64:67], 0
    v_mfma_f32_16x16x32_bf16 v[28:31], a[116:119], v[68:71], v[28:31]
    v_mfma_f32_16x16x32_bf16 v[28:31], a[120:123], v[72:75], v[28:31]
    v_mfma_f32_16x16x32_bf16 v[28:31], a[124:127], v[76:79], v[28:31]
    s_nop 7
    v_max3_f32 v32, v32, v16, v17
    v_max3_f32 v32, v32, v18, v19
    v_max3_f32 v32, v32, v20, v21
    v_max3_f32 v32, v32, v22, v23
    v_max3_f32 v32, v32, v24, v25
    v_max3_f32 v32, v32, v26, v27
    v_max3_f32 v32, v32, v28, v29
    v_max3_f32 v32, v32, v30, v31
    v_mfma_f32_16x16x32_bf16 v[16:19], a[64:67], v[80:83], 0
    v_mfma_f32_16x16x32_bf16 v[16:19], a[68:71], v[84:87], v[16:19]
    v_mfma_f32_16x16x32_bf16 v[16:19], a[72:75], v[88:91], v[16:19]
    v_mfma_f32_16x16x32_bf16 v[16:19], a[76:79], v[92:95], v[16:19]
    v_mfma_f32_16x16x32_bf16 v[20:23], a[80:83], v[80:83], 0
    v_mfma_f32_16x16x32_bf16 v[20:23], a[84:87], v[84:87], v[20:23]
    v_mfma_f32_16x16x32_bf16 v[20:23], a[88:91], v[88:91], v[20:23]
    v_mfma_f32_16x16x32_bf16 v[20:23], a[92:95], v[92:95], v[20:23]
    v_mfma_f32_16x16x32_bf16 v[24:27], a[96:99], v[80:83], 0
    v_mfma_f32_16x16x32_bf16 v[24:27], a[100:103], v[84:87], v[24:27]
    v_mfma_f32_16x16x32_bf16 v[24:27], a[104:107], v[88:91], v[24:27]
    v_mfma_f32_16x16x32_bf16 v[24:27], a[108:111], v[92:95], v[24:27]
    v_mfma_f32_16x16x32_bf16 v[28:31], a[112:115], v[80:83], 0
    v_mfma_f32_16x16x32_bf16 v[28:31], a[116:119], v[84:87], v[28:31]
    v_mfma_f32_16x16x32_bf16 v[28:31], a[120:123], v[88:91], v[28:31]
    v_mfma_f32_16x16x32_bf16 v[28:31], a[124:127], v[92:95], v[28:31]
    s_nop 7
    v_max3_f32 v33, v33, v16, v17
    v_max3_f32 v33, v33, v18, v19
    v_max3_f32 v33, v33, v20, v21
    v_max3_f32 v33, v33, v22, v23
    v_max3_f32 v33, v33, v24, v25
    v_max3_f32 v33, v33, v26, v27
    v_max3_f32 v33, v33, v28, v29
    v_max3_f32 v33, v33, v30, v31
    v_mfma_f32_16x16x32_bf16 v[16:19], a[64:67], v[96:99], 0
    v_mfma_f32_16x16x32_bf16 v[16:19], a[68:71], v[100:103], v[16:19]
    v_mfma_f32_16x16x32_bf16 v[16:19], a[72:75], v[104:107], v[16:19]
    v_mfma_f32_16x16x32_bf16 v[16:19], a[76:79], v[108:111], v[16:19]
    v_mfma_f32_16x16x32_bf16 v[20:23], a[80:83], v[96:99], 0
    v_mfma_f32_16x16x32_bf16 v[20:23], a[84:87], v[100:103], v[20:23]
    v_mfma_f32_16x16x32_bf16 v[20:23], a[88:91], v[104:107], v[20:23]
    v_mfma_f32_16x16x32_bf16 v[20:23], a[92:95], v[108:111], v[20:23]
    v_mfma_f32_16x16x32_bf16 v[24:27], a[96:99], v[96:99], 0
    v_mfma_f32_16x16x32_bf16 v[24:27], a[100:103], v[100:103], v[24:27]
    v_mfma_f32_16x16x32_bf16 v[24:27], a[104:107], v[104:107], v[24:27]
    v_mfma_f32_16x16x32_bf16 v[24:27], a[108:111], v[108:111], v[24:27]
    v_mfma_f32_16x16x32_bf16 v[28:31], a[112:115], v[96:99], 0
    v_mfma_f32_16x16x32_bf16 v[28:31], a[116:119], v[100:103], v[28:31]
    v_mfma_f32_16x16x32_bf16 v[28:31], a[120:123], v[104:107], v[28:31]
    v_mfma_f32_16x16x32_bf16 v[28:31], a[124:127], v[108:111], v[28:31]
    s_nop 7
    v_max3_f32 v34, v34, v16, v17
    v_max3_f32 v34, v34, v18, v19
    v_max3_f32 v34, v34, v20, v21
    v_max3_f32 v34, v34, v22, v23
    v_max3_f32 v34, v34, v24, v25
    v_max3_f32 v34, v34, v26, v27
    v_max3_f32 v34, v34, v28, v29
    v_max3_f32 v34, v34, v30, v31
    v_mfma_f32_16x16x32_bf16 v[16:19], a[64:67], v[112:115], 0
    v_mfma_f32_16x16x32_bf16 v[16:19], a[68:71], v[116:119], v[16:19]
    v_mfma_f32_16x16x32_bf16 v[16:19], a[72:75], v[120:123], v[16:19]
    v_mfma_f32_16x16x32_bf16 v[16:19], a[76:79], v[124:127], v[16:19]
    v_mfma_f32_16x16x32_bf16 v[20:23], a[80:83], v[112:115], 0
    v_mfma_f32_16x16x32_bf16 v[20:23], a[84:87], v[116:119], v[20:23]
    v_mfma_f32_16x16x32_bf16 v[20:23], a[88:91], v[120:123], v[20:23]
    v_mfma_f32_16x16x32_bf16 v[20:23], a[92:95], v[124:127], v[20:23]
    v_mfma_f32_16x16x32_bf16 v[24:27], a[96:99], v[112:115], 0
    v_mfma_f32_16x16x32_bf16 v[24:27], a[100:103], v[116:119], v[24:27]
    v_mfma_f32_16x16x32_bf16 v[24:27], a[104:107], v[120:123], v[24:27]
    v_mfma_f32_16x16x32_bf16 v[24:27], a[108:111], v[124:127], v[24:27]
    v_mfma_f32_16x16x32_bf16 v[28:31], a[112:115], v[112:115], 0
    v_mfma_f32_16x16x32_bf16 v[28:31], a[116:119], v[116:119], v[28:31]
    v_mfma_f32_16x16x32_bf16 v[28:31], a[120:123], v[120:123], v[28:31]
    v_mfma_f32_16x16x32_bf16 v[28:31], a[124:127], v[124:127], v[28:31]
    s_nop 7
    v_max3_f32 v35, v35, v16, v17
    v_max3_f32 v35, v35, v18, v19
    v_max3_f32 v35, v35, v20, v21
    v_max3_f32 v35, v35, v22, v23
    v_max3_f32 v35, v35, v24, v25
    v_max3_f32 v35, v35, v26, v27
    v_max3_f32 v35, v35, v28, v29
    v_max3_f32 v35, v35, v30, v31
    s_add_u32 s46, s46, 16384
    s_cmp_lt_u32 s46, 524288
    s_cbranch_scc1 L2_fb_loop
    v_mov_b32 v12, v32
    v_mov_b32 v13, v33
    v_mov_b32 v14, v34
    v_mov_b32 v15, v35
    v_permlane16_swap_b32 v12, v32
    v_permlane16_swap_b32 v13, v33
    v_permlane16_swap_b32 v14, v34
    v_permlane16_swap_b32 v15, v35
    v_max_f32 v32, v32, v12
    v_max_f32 v33, v33, v13
    v_max_f32 v34, v34, v14
    v_max_f32 v35, v35, v15
    v_mov_b32 v12, v32
    v_mov_b32 v13, v33
    v_mov_b32 v14, v34
    v_mov_b32 v15, v35
    v_permlane32_swap_b32 v12, v32
    v_permlane32_swap_b32 v13, v33
    v_permlane32_swap_b32 v14, v34
    v_permlane32_swap_b32 v15, v35
    v_max_f32 v32, v32, v12
    v_max_f32 v33, v33, v13
    v_max_f32 v34, v34, v14
    v_max_f32 v35, v35, v15
    v_sub_f32 v48, 0x80000000, v32
    v_sub_f32 v49, 0x80000000, v32
    v_sub_f32 v50, 0x80000000, v32
    v_sub_f32 v51, 0x80000000, v32
    v_sub_f32 v52, 0x80000000, v33
    v_sub_f32 v53, 0x80000000, v33
    v_sub_f32 v54, 0x80000000, v33
    v_sub_f32 v55, 0x80000000, v33
    v_sub_f32 v56, 0x80000000, v34
    v_sub_f32 v57, 0x80000000, v34
    v_sub_f32 v58, 0x80000000, v34
    v_sub_f32 v59, 0x80000000, v34
    v_sub_f32 v60, 0x80000000, v35
    v_sub_f32 v61, 0x80000000, v35
    v_sub_f32 v62, 0x80000000, v35
    v_sub_f32 v63, 0x80000000, v35
    s_add_u32 m0, s44, 73728
    s_mov_b32 s46, 0
    buffer_load_dwordx4 v5, s[16:19], s46 offen offset:0 lds
    s_add_u32 m0, s44, 73760
    s_nop 0
    buffer_load_dwordx4 v5, s[16:19], s46 offen offset:1024 lds
    s_add_u32 m0, s44, 73792
    s_nop 0
    buffer_load_dwordx4 v5, s[16:19], s46 offen offset:2048 lds
    s_add_u32 m0, s44, 73824
    s_nop 0
    buffer_load_dwordx4 v5, s[16:19], s46 offen offset:3072 lds
    s_add_u32 m0, s44, 90624
    s_nop 0
    buffer_load_dwordx4 v5, s[20:23], s46 offen offset:0 lds
    s_add_u32 m0, s44, 90656
    s_nop 0
    buffer_load_dwordx4 v5, s[20:23], s46 offen offset:1024 lds
    s_add_u32 m0, s44, 90688
    s_nop 0
    buffer_load_dwordx4 v5, s[20:23], s46 offen offset:2048 lds
    s_add_u32 m0, s44, 90720
    s_nop 0
    buffer_load_dwordx4 v5, s[20:23], s46 offen offset:3072 lds
    s_add_u32 m0, s44, 110592
    s_mov_b32 s46, 16384
    buffer_load_dwordx4 v5, s[16:19], s46 offen offset:0 lds
    s_add_u32 m0, s44, 110624
    s_nop 0
    buffer_load_dwordx4 v5, s[16:19], s46 offen offset:1024 lds
    s_add_u32 m0, s44, 110656
    s_nop 0
    buffer_load_dwordx4 v5, s[16:19], s46 offen offset:2048 lds
    s_add_u32 m0, s44, 110688
    s_nop 0
    buffer_load_dwordx4 v5, s[16:19], s46 offen offset:3072 lds
    s_add_u32 m0, s44, 127488
    s_nop 0
    buffer_load_dwordx4 v5, s[20:23], s46 offen offset:0 lds
    s_add_u32 m0, s44, 127520
    s_nop 0
    buffer_load_dwordx4 v5, s[20:23], s46 offen offset:1024 lds
    s_add_u32 m0, s44, 127552
    s_nop 0
    buffer_load_dwordx4 v5, s[20:23], s46 offen offset:2048 lds
    s_add_u32 m0, s44, 127584
    s_nop 0
    buffer_load_dwordx4 v5, s[20:23], s46 offen offset:3072 lds
    s_add_u32 m0, s44, 0
    s_mov_b32 s46, 32768
    buffer_load_dwordx4 v5, s[16:19], s46 offen offset:0 lds
    s_add_u32 m0, s44, 32
    s_nop 0
    buffer_load_dwordx4 v5, s[16:19], s46 offen offset:1024 lds
    s_add_u32 m0, s44, 64
    s_nop 0
    buffer_load_dwordx4 v5, s[16:19], s46 offen offset:2048 lds
    s_add_u32 m0, s44, 96
    s_nop 0
    buffer_load_dwordx4 v5, s[16:19], s46 offen offset:3072 lds
    s_add_u32 m0, s44, 16896
    s_nop 0
    buffer_load_dwordx4 v5, s[20:23], s46 offen offset:0 lds
    s_add_u32 m0, s44, 16928
    s_nop 0
    buffer_load_dwordx4 v5, s[20:23], s46 offen offset:1024 lds
    s_add_u32 m0, s44, 16960
    s_nop 0
    buffer_load_dwordx4 v5, s[20:23], s46 offen offset:2048 lds
    s_add_u32 m0, s44, 16992
    s_nop 0
    buffer_load_dwordx4 v5, s[20:23], s46 offen offset:3072 lds
    s_waitcnt vmcnt(0) lgkmcnt(0)
    s_barrier
    ds_read_b128 a[64:67], v1 offset:0
    ds_read_b128 a[68:71], v1 offset:64
    ds_read_b128 a[72:75], v1 offset:128
    ds_read_b128 a[76:79], v1 offset:192
    ds_read_b128 a[80:83], v1 offset:256
    ds_read_b128 a[84:87], v1 offset:320
    ds_read_b128 a[88:91], v1 offset:384
    ds_read_b128 a[92:95], v1 offset:448
    ds_read_b128 a[96:99], v1 offset:512
    ds_read_b128 a[100:103], v1 offset:576
    ds_read_b128 a[104:107], v1 offset:640
    ds_read_b128 a[108:111], v1 offset:704
    ds_read_b128 a[112:115], v1 offset:768
    ds_read_b128 a[116:119], v1 offset:832
    ds_read_b128 a[120:123], v1 offset:896
    ds_read_b128 a[124:127], v1 offset:960
    ds_read_b64_tr_b16 a[128:129], v2 offset:0
    ds_read_b64_tr_b16 a[130:131], v2 offset:256
    ds_read_b64_tr_b16 a[132:133], v2 offset:512
    ds_read_b64_tr_b16 a[134:135], v2 offset:768
    ds_read_b64_tr_b16 a[136:137], v2 offset:32
    ds_read_b64_tr_b16 a[138:139], v2 offset:288
    ds_read_b64_tr_b16 a[140:141], v2 offset:544
    ds_read_b64_tr_b16 a[142:143], v2 offset:800
    ds_read_b64_tr_b16 a[144:145], v2 offset:64
    ds_read_b64_tr_b16 a[146:147], v2 offset:320
    ds_read_b64_tr_b16 a[148:149], v2 offset:576
    ds_read_b64_tr_b16 a[150:151], v2 offset:832
    ds_read_b64_tr_b16 a[152:153], v2 offset:96
    ds_read_b64_tr_b16 a[154:155], v2 offset:352
    ds_read_b64_tr_b16 a[156:157], v2 offset:608
    ds_read_b64_tr_b16 a[158:159], v2 offset:864
    ds_read_b64_tr_b16 a[160:161], v2 offset:128
    ds_read_b64_tr_b16 a[162:163], v2 offset:384
    ds_read_b64_tr_b16 a[164:165], v2 offset:640
    ds_read_b64_tr_b16 a[166:167], v2 offset:896
    ds_read_b64_tr_b16 a[168:169], v2 offset:160
    ds_read_b64_tr_b16 a[170:171], v2 offset:416
    ds_read_b64_tr_b16 a[172:173], v2 offset:672
    ds_read_b64_tr_b16 a[174:175], v2 offset:928
    ds_read_b64_tr_b16 a[176:177], v2 offset:192
    ds_read_b64_tr_b16 a[178:179], v2 offset:448
    ds_read_b64_tr_b16 a[180:181], v2 offset:704
    ds_read_b64_tr_b16 a[182:183], v2 offset:960
    ds_read_b64_tr_b16 a[184:185], v2 offset:224
    ds_read_b64_tr_b16 a[186:187], v2 offset:480
    ds_read_b64_tr_b16 a[188:189], v2 offset:736
    ds_read_b64_tr_b16 a[190:191], v2 offset:992
    s_waitcnt vmcnt(0) lgkmcnt(0)
    s_branch L2_entry
L2_codeend:

.section .rodata,"a"
.p2align 6
.amdhsa_kernel adaLN_cond__gqa_block_cached__moe_arch_mod__prompt_kernel
  .amdhsa_next_free_vgpr 512
  .amdhsa_next_free_sgpr 102
  .amdhsa_accum_offset 256
  .amdhsa_group_segment_fixed_size 0
  .amdhsa_kernarg_size 120
  .amdhsa_user_sgpr_count 2
  .amdhsa_user_sgpr_kernarg_segment_ptr 1
  .amdhsa_system_sgpr_workgroup_id_x 1
  .amdhsa_float_denorm_mode_32 3
.end_amdhsa_kernel
```

```asm
; @launch grid=(256,1,1) block=(256,1,1) lds=163840
.amdgcn_target "amdgcn-amd-amdhsa--gfx950"
.text
.globl adaLN_cond__gqa_block_cached__moe_arch_mod__prompt_kernel
.p2align 8
.type adaLN_cond__gqa_block_cached__moe_arch_mod__prompt_kernel,@function
adaLN_cond__gqa_block_cached__moe_arch_mod__prompt_kernel:
L2_begin:
    s_getpc_b64 s[98:99]
    s_cmp_ge_u32 s2, 256
    s_cbranch_scc1 L2_end
    s_load_dwordx2 s[76:77], s[0:1], 0
    s_load_dwordx2 s[16:17], s[0:1], 80
    s_load_dwordx2 s[88:89], s[0:1], 88
    s_load_dwordx2 s[12:13], s[0:1], 112
    s_load_dwordx2 s[60:61], s[0:1], 104
    s_and_b32 s3, s2, 7
    s_lshr_b32 s14, s2, 3
    v_mov_b32 v155, v0
    v_lshrrev_b32 v10, 6, v0
    v_and_b32 v0, 63, v0
    s_lshl_b32 s15, s14, 9
    v_lshl_add_u32 v13, v10, 7, s15
    v_lshl_add_u32 v13, v0, 14, v13
    v_min_u32 v13, L2_codeend-L2_begin-8, v13
    s_mov_b64 exec, 31
    global_load_dword a63, v13, s[98:99]
    s_mov_b64 exec, -1
    v_readfirstlane_b32 s51, v10
    s_and_b32 s52, s3, 3
    s_and_b32 s15, s14, 3
    s_lshl2_add_u32 s52, s52, s15
    s_lshr_b32 s53, s3, 2
    s_lshr_b32 s15, s14, 2
    s_lshl3_add_u32 s53, s53, s15
    s_lshl4_add_u32 s96, s53, s52
    s_mul_i32 s49, s3, 27
    s_max_u32 s14, s14, 5
    s_add_u32 s49, s49, s14
    s_sub_u32 s49, s49, 5
    s_lshr_b32 s55, s3, 2
    s_mul_i32 s15, s55, 108
    s_sub_u32 s50, s49, s15
    s_mul_i32 s3, s51, 288
    v_lshrrev_b32 v14, 3, v0
    v_lshl_add_u32 v12, v14, 4, s3
    v_and_b32 v14, 1, v14
    v_lshl_add_u32 v13, v14, 4, s3
    v_and_b32 v14, 7, v0
    v_mul_u32_u24 v14, 1152, v14
    v_add_u32 v1, v14, v12
    v_add_u32 v2, v14, v13
    v_add_u32 v2, 256, v2
    v_and_b32 v4, 0xfc, v155
    v_and_b32 v7, 3, v0
    v_mul_u32_u24 v3, 6912, v4
    v_lshl_add_u32 v153, v7, 4, v3
    s_mul_i32 s3, s96, 9216
    s_movk_i32 s78, 9216
    s_mov_b32 s79, 0x20000
    s_mov_b32 s91, s79
    v_lshlrev_b32 v8, 4, v0
    s_mov_b32 s86, 8388608
    s_mov_b32 s87, s79
    s_movk_i32 s62, 256
    s_mov_b32 s63, s79
    s_lshl_b32 s14, s50, 6
    s_sub_u32 s90, 1990656, s14
    s_cmp_ge_u32 s2, 40
    s_cselect_b32 s90, s90, 0
    s_mul_i32 s15, s55, 1990656
    s_add_u32 s14, s14, s15
    s_waitcnt lgkmcnt(0)
    s_add_u32 s76, s76, s3
    s_addc_u32 s77, s77, 0
    buffer_load_dwordx4 v[64:67], v1, s[76:79], 0 offen offset:0
    buffer_load_dwordx4 v[68:71], v1, s[76:79], 0 offen offset:128
    buffer_load_dwordx4 v[72:75], v2, s[76:79], 0 offen offset:0
    s_add_u32 s88, s88, s14
    s_addc_u32 s89, s89, 0
    s_mov_b64 s[84:85], s[12:13]
    s_cmp_ge_u32 s2, 8
    s_cbranch_scc1 L2_noclr
    v_mov_b32 v52, -1
    v_mov_b32 v56, 0
    v_mov_b32 v53, -1
    v_mov_b32 v57, 0
    v_mov_b32 v54, -1
    v_mov_b32 v58, 0
    v_mov_b32 v55, -1
    v_mov_b32 v59, 0
    s_lshl2_add_u32 s15, s2, s51
    s_lshl_b32 s3, s15, 10
    buffer_store_dwordx4 v[52:55], v8, s[84:87], s3 offen sc1
    v_lshrrev_b32 v13, 3, v0
    v_mul_u32_u24 v13, 0, v13
    v_add_u32 v13, v13, v8
    s_mul_i32 s3, s15, 1024
    s_add_u32 s3, s3, 6815744
    buffer_store_dwordx4 v[56:59], v13, s[84:87], s3 offen sc1
L2_noclr:
    buffer_load_dwordx4 v[128:131], v153, s[88:91], 0 offen
    s_movk_i32 s3, 6912
    buffer_load_dwordx4 v[132:135], v153, s[88:91], s3 offen
    s_movk_i32 s3, 13824
    buffer_load_dwordx4 v[136:139], v153, s[88:91], s3 offen
    s_movk_i32 s3, 20736
    buffer_load_dwordx4 v[140:143], v153, s[88:91], s3 offen
    v_lshrrev_b32 v3, 2, v3
    v_lshl_add_u32 v3, v7, 4, v3
    v_add_u32 v154, 1769472, v3
    v_lshrrev_b32 v3, 1, v4
    v_lshlrev_b32 v4, 1, v4
    s_mul_i32 s3, s55, 576
    s_add_u32 s16, s16, s3
    s_addc_u32 s17, s17, 0
    s_mov_b32 s18, 576
    s_mov_b32 s19, 0x20000
    buffer_load_dwordx2 v[148:149], v4, s[16:19], 0 offen
    v_mov_b32 v144, 0
    v_mov_b32 v145, 0
    v_mov_b32 v146, 0
    v_mov_b32 v147, 0
    v_mov_b32 v150, 0
    s_cmp_ge_u32 s51, 2
    s_cbranch_scc1 L2_w23
    buffer_load_dwordx4 v[144:147], v154, s[88:91], 0 offen
    buffer_load_ushort v150, v3, s[16:19], 0 offen offset:512
L2_w23:
    s_load_dwordx8 s[4:11], s[0:1], 8
    s_load_dwordx2 s[64:65], s[0:1], 56
    s_load_dwordx2 s[68:69], s[0:1], 64
    s_load_dwordx2 s[72:73], s[0:1], 72
    s_load_dwordx2 s[80:81], s[0:1], 96
    s_load_dwordx2 s[36:37], s[0:1], 48
    s_cmp_eq_u32 s51, 0
    s_cselect_b32 s3, 0, 0x40000000
    v_mul_u32_u24 v156, 32, v0
    v_or_b32 v156, s3, v156
    s_mul_i32 s44, s51, 4224
    s_add_u32 s44, s44, 16384
    v_lshl_add_u32 v5, v10, 12, v8
    v_lshrrev_b32 v13, 5, v0
    v_lshl_add_u32 v13, v10, 1, v13
    v_lshlrev_b32 v13, 15, v13
    v_and_b32 v14, 31, v0
    v_lshl_add_u32 v6, v14, 4, v13
    v_mov_b32 v56, 0
    v_mov_b32 v60, -1
    v_mov_b32 v57, 0
    v_mov_b32 v61, -1
    v_mov_b32 v58, 0
    v_mov_b32 v62, -1
    v_mov_b32 v59, 0
    v_mov_b32 v63, -1
    s_and_b32 s14, s53, 7
    s_lshl2_add_u32 s14, s14, s51
    v_lshrrev_b32 v13, 2, v0
    v_lshl_add_u32 v13, v13, 5, s14
    v_lshlrev_b32 v13, 13, v13
    v_lshl_add_u32 v13, v7, 7, v13
    s_waitcnt lgkmcnt(0)
    s_lshl_b32 s3, s52, 9
    s_add_u32 s24, s8, s3
    s_addc_u32 s25, s9, 0
    s_mov_b32 s26, 0
    s_mov_b32 s27, 0x20000
    s_sub_u32 s26, 4718592, s3
    s_mov_b64 exec, 0xffff
    buffer_load_dword a63, v13, s[24:27], 0 offen
    s_mov_b64 exec, -1
    s_mov_b32 s38, 1152
    s_mov_b32 s39, 0x20000
    v_and_b32 v14, 7, v0
    v_lshlrev_b32 v157, 4, v14
    v_add_u32 v157, 14080, v157
    v_lshl_add_u32 v158, v10, 2, v157
    s_mul_i32 s3, s51, 4608
    v_lshl_add_u32 v14, v14, 4, s3
    v_lshrrev_b32 v15, 3, v0
    v_lshl_add_u32 v159, v15, 8, v14
    s_lshr_b32 s3, s96, 1
    s_mul_i32 s3, s3, 18432
    s_and_b32 s14, s96, 1
    s_lshl_b32 s14, s14, 7
    s_add_u32 s3, s3, s14
    s_add_u32 s58, s3, 1048576
    s_lshl_b32 s3, s53, 2
    s_add_u32 s3, s3, s51
    s_lshl_b32 s14, s3, 4
    s_add_u32 s14, s14, s52
    s_lshl_b32 s14, s14, 8
    s_add_u32 s56, s14, 786432
    s_mul_i32 s14, s3, 512
    s_add_u32 s59, s14, 6815744
    v_and_b32 v14, 3, v0
    v_mul_u32_u24 v163, 128, v14
    s_mul_i32 s14, s3, 36864
    s_add_u32 s14, s14, 1048576
    s_add_u32 s32, s12, s14
    s_addc_u32 s33, s13, 0
    s_mov_b32 s34, 36864
    s_mov_b32 s35, 0x20000
    s_mul_i32 s15, s2, 4608
    s_mul_i32 s14, s51, 1152
    s_add_u32 s15, s15, s14
    s_add_u32 s57, s15, 98304
    s_cmp_ge_u32 s2, 144
    s_cselect_b32 s14, 0x40000000, 0
    v_or_b32 v160, s14, v8
    v_lshrrev_b32 v12, 4, v155
    v_lshlrev_b32 v12, 7, v12
    v_lshl_add_u32 v161, v7, 5, v12
    v_lshlrev_b32 v162, 2, v0
    s_mul_i32 s3, s50, 3641
    s_lshr_b32 s3, s3, 16
    s_mov_b32 s47, 1.0
    s_mov_b32 s48, 0
    s_cmp_lt_u32 s3, 2
    s_cselect_b32 s47, 0x3e0293ee, s47
    s_cmp_eq_u32 s3, 1
    s_cselect_b32 s48, 0x3e0293ee, s48
    s_cmp_eq_u32 s3, 4
    s_cselect_b32 s48, 1.0, s48
    s_cmp_eq_u32 s55, 0
    s_cselect_b32 s48, s48, 0
    s_lshl_b32 s100, s49, 7
    s_mul_i32 s14, s96, 128
    s_add_u32 s101, s14, 6815744
    s_mul_i32 s3, s51, 1152
    v_add_u32 v166, s3, v8
    s_and_b32 s3, s51, 1
    s_mul_i32 s3, s3, 2304
    s_cmp_lt_u32 s51, 2
    s_cselect_b32 s14, 32, 0
    s_add_u32 s3, s3, s14
    s_add_u32 s3, s3, 9216
    v_lshrrev_b32 v14, 1, v0
    v_lshl_add_u32 v14, v14, 6, s3
    v_and_b32 v15, 1, v0
    v_lshl_add_u32 v167, v15, 4, v14
    s_cmp_eq_u32 s51, 1
    s_cselect_b32 s3, 40, 256
    s_cmp_ge_u32 s2, s3
    s_cselect_b32 s3, 0, 0x40000000
    v_or_b32 v164, s3, v162
    v_mov_b32 v172, 0
    v_mov_b32 v180, 0
    v_mov_b32 v173, 0
    v_mov_b32 v181, 0
    v_mov_b32 v174, 0
    v_mov_b32 v182, 0
    v_mov_b32 v175, 0
    v_mov_b32 v183, 0
    s_lshl_b32 s3, s53, 2
    s_add_u32 s3, s3, s51
    v_mov_b32 v12, v10
    s_mul_i32 s14, s3, 589824
    s_mul_i32 s15, s52, 9216
    s_add_u32 s14, s14, s15
    s_add_u32 s14, s14, 8388608
    s_add_u32 s40, s12, s14
    s_addc_u32 s41, s13, 0
    s_mov_b32 s42, 0
    s_mov_b32 s43, 0x20000
    s_sub_u32 s42, 589824, s15
    s_lshl_b32 s3, s52, 19
    s_add_u32 s16, s4, s3
    s_addc_u32 s17, s5, 0
    s_mov_b32 s18, 524288
    s_mov_b32 s19, 0x20000
    s_add_u32 s20, s6, s3
    s_addc_u32 s21, s7, 0
    s_mov_b32 s22, 524288
    s_mov_b32 s23, 0x20000
    s_mul_i32 s3, s52, 294912
    s_add_u32 s28, s10, s3
    s_addc_u32 s29, s11, 0
    s_mov_b32 s30, 294912
    s_mov_b32 s31, 0x20000
    s_mov_b64 s[4:5], s[64:65]
    s_mov_b64 s[6:7], s[68:69]
    s_mov_b64 s[8:9], s[72:73]
    s_mov_b32 s50, 0
    s_mul_i32 s55, s51, 9216
    s_min_u32 s15, s2, 143
    s_and_b32 s3, s15, 7
    s_mul_i32 s3, s3, 18
    s_lshr_b32 s15, s15, 3
    s_add_u32 s15, s15, s3
    s_lshl_b32 s3, s15, 6
    s_add_u32 s64, s64, s3
    s_addc_u32 s65, s65, 0
    s_mov_b32 s66, 0
    s_mov_b32 s67, 0x20000
    s_add_u32 s68, s68, s3
    s_addc_u32 s69, s69, 0
    s_mov_b32 s70, 0
    s_mov_b32 s71, 0x20000
    s_sub_u32 s14, 5308416, s3
    s_mul_i32 s3, s15, 36864
    s_add_u32 s72, s72, s3
    s_addc_u32 s73, s73, 0
    s_mov_b32 s74, 0
    s_mov_b32 s75, 0x20000
    s_cmp_lt_u32 s2, 144
    s_cselect_b32 s66, s14, 0
    s_cselect_b32 s70, s14, 0
    s_cselect_b32 s74, 36864, 0
    s_mov_b32 s82, 2359296
    s_mov_b32 s83, 0x20000
    v_lshrrev_b32 v13, 4, v0
    v_lshlrev_b32 v9, 6, v13
    v_lshrrev_b32 v14, 2, v0
    v_mul_u32_u24 v14, 1056, v14
    v_add_u32 v14, 16384, v14
    v_and_b32 v15, 1, v0
    v_lshlrev_b32 v15, 4, v15
    v_add_u32 v3, v14, v15
    v_and_b32 v15, 2, v0
    v_lshl_add_u32 v3, v15, 2, v3
    v_add_u32 v4, 73728, v3
    v_lshrrev_b32 v14, 3, v0
    v_lshlrev_b32 v14, 2, v14
    v_add_u32 v14, v14, v12
    v_mul_u32_u24 v14, 4608, v14
    v_and_b32 v15, 7, v0
    v_lshl_add_u32 v7, v15, 4, v14
    v_lshlrev_b32 v10, 4, v15
    v_lshl_add_u32 v10, v13, 7, v10
    v_bfe_u32 v14, v0, 3, 1
    v_mul_u32_u24 v14, 147456, v14
    v_add_u32 v10, v10, v14
    v_lshrrev_b32 v14, 2, v0
    v_mul_u32_u24 v14, 1056, v14
    v_and_b32 v15, 3, v0
    v_lshl_add_u32 v14, v15, 3, v14
    v_add_u32 v2, 107008, v14
    v_and_b32 v14, 15, v0
    v_mul_u32_u24 v14, 1056, v14
    v_lshrrev_b32 v15, 4, v0
    v_lshl_add_u32 v14, v15, 4, v14
    v_add_u32 v1, 90112, v14
    v_and_b32 v14, 1, v0
    v_cmp_eq_u32 vcc, 0, v14
    v_mov_b32 v11, 0xeeeeeeee
    v_mov_b32 v15, 0x44444444
    v_cndmask_b32 v11, v11, v15, vcc
    v_and_b32 v14, 2, v0
    v_cmp_eq_u32 vcc, 0, v14
    v_mov_b32 v15, 0x3f803f80
    s_nop 0
    v_cndmask_b32 v15, 0, v15, vcc
    v_accvgpr_write_b32 a16, v15
    v_accvgpr_write_b32 a56, -1
    v_accvgpr_write_b32 a17, v15
    v_accvgpr_write_b32 a57, -1
    v_accvgpr_write_b32 a18, v15
    v_accvgpr_write_b32 a58, -1
    v_accvgpr_write_b32 a19, v15
    v_accvgpr_write_b32 a59, -1
    s_cmp_ge_u32 s2, 8
    s_cbranch_scc1 L2_noclr2
    s_mul_i32 s14, s2, 32
    s_mov_b64 exec, 1
    s_waitcnt vmcnt(6)
    s_barrier
    buffer_store_dword v60, v156, s[60:63], s14 offen sc1
    s_mov_b64 exec, -1
L2_noclr2:
    s_waitcnt vmcnt(6)
    v_lshlrev_b32 v24, 16, v64
    v_and_b32 v25, 0xffff0000, v64
    v_lshlrev_b32 v26, 16, v65
    v_and_b32 v27, 0xffff0000, v65
    v_lshlrev_b32 v28, 16, v66
    v_and_b32 v29, 0xffff0000, v66
    v_lshlrev_b32 v30, 16, v67
    v_and_b32 v31, 0xffff0000, v67
    v_lshlrev_b32 v32, 16, v68
    v_and_b32 v33, 0xffff0000, v68
    v_lshlrev_b32 v34, 16, v69
    v_and_b32 v35, 0xffff0000, v69
    v_lshlrev_b32 v36, 16, v70
    v_and_b32 v37, 0xffff0000, v70
    v_lshlrev_b32 v38, 16, v71
    v_and_b32 v39, 0xffff0000, v71
    v_lshlrev_b32 v40, 16, v72
    v_and_b32 v41, 0xffff0000, v72
    v_lshlrev_b32 v42, 16, v73
    v_and_b32 v43, 0xffff0000, v73
    v_lshlrev_b32 v44, 16, v74
    v_and_b32 v45, 0xffff0000, v74
    v_lshlrev_b32 v46, 16, v75
    v_and_b32 v47, 0xffff0000, v75
    v_pk_add_f32 v[12:13], v[24:25], v[26:27]
    v_pk_add_f32 v[12:13], v[12:13], v[28:29]
    v_pk_add_f32 v[12:13], v[12:13], v[30:31]
    v_pk_add_f32 v[12:13], v[12:13], v[32:33]
    v_pk_add_f32 v[12:13], v[12:13], v[34:35]
    v_pk_add_f32 v[12:13], v[12:13], v[36:37]
    v_pk_add_f32 v[12:13], v[12:13], v[38:39]
    v_pk_add_f32 v[14:15], v[40:41], v[42:43]
    v_pk_add_f32 v[14:15], v[14:15], v[44:45]
    v_pk_add_f32 v[14:15], v[14:15], v[46:47]
    v_add_f32 v48, v12, v13
    v_add_f32 v14, v14, v15
    v_fmac_f32 v48, 0x3e800000, v14
    s_nop 1
    v_add_f32_dpp v48, v48, v48 row_ror:8 row_mask:0xf bank_mask:0xf
    v_mov_b32 v50, v48
    s_nop 1
    v_permlane16_swap_b32 v50, v48
    v_add_f32 v48, v48, v50
    v_mov_b32 v50, v48
    s_nop 1
    v_permlane32_swap_b32 v50, v48
    v_add_f32 v48, v48, v50
    v_mul_f32 v48, 0x3be38e39, v48
    v_pk_add_f32 v[24:25], v[24:25], v[48:49] op_sel_hi:[1,0] neg_lo:[0,1] neg_hi:[0,1]
    v_pk_add_f32 v[26:27], v[26:27], v[48:49] op_sel_hi:[1,0] neg_lo:[0,1] neg_hi:[0,1]
    v_pk_add_f32 v[28:29], v[28:29], v[48:49] op_sel_hi:[1,0] neg_lo:[0,1] neg_hi:[0,1]
    v_pk_add_f32 v[30:31], v[30:31], v[48:49] op_sel_hi:[1,0] neg_lo:[0,1] neg_hi:[0,1]
    v_pk_add_f32 v[32:33], v[32:33], v[48:49] op_sel_hi:[1,0] neg_lo:[0,1] neg_hi:[0,1]
    v_pk_add_f32 v[34:35], v[34:35], v[48:49] op_sel_hi:[1,0] neg_lo:[0,1] neg_hi:[0,1]
    v_pk_add_f32 v[36:37], v[36:37], v[48:49] op_sel_hi:[1,0] neg_lo:[0,1] neg_hi:[0,1]
    v_pk_add_f32 v[38:39], v[38:39], v[48:49] op_sel_hi:[1,0] neg_lo:[0,1] neg_hi:[0,1]
    v_pk_add_f32 v[40:41], v[40:41], v[48:49] op_sel_hi:[1,0] neg_lo:[0,1] neg_hi:[0,1]
    v_pk_add_f32 v[42:43], v[42:43], v[48:49] op_sel_hi:[1,0] neg_lo:[0,1] neg_hi:[0,1]
    v_pk_add_f32 v[44:45], v[44:45], v[48:49] op_sel_hi:[1,0] neg_lo:[0,1] neg_hi:[0,1]
    v_pk_add_f32 v[46:47], v[46:47], v[48:49] op_sel_hi:[1,0] neg_lo:[0,1] neg_hi:[0,1]
    v_pk_mul_f32 v[12:13], v[24:25], v[24:25]
    v_pk_fma_f32 v[12:13], v[26:27], v[26:27], v[12:13]
    v_pk_fma_f32 v[12:13], v[28:29], v[28:29], v[12:13]
    v_pk_fma_f32 v[12:13], v[30:31], v[30:31], v[12:13]
    v_pk_fma_f32 v[12:13], v[32:33], v[32:33], v[12:13]
    v_pk_fma_f32 v[12:13], v[34:35], v[34:35], v[12:13]
    v_pk_fma_f32 v[12:13], v[36:37], v[36:37], v[12:13]
    v_pk_fma_f32 v[12:13], v[38:39], v[38:39], v[12:13]
    v_pk_mul_f32 v[14:15], v[40:41], v[40:41]
    v_pk_fma_f32 v[14:15], v[42:43], v[42:43], v[14:15]
    v_pk_fma_f32 v[14:15], v[44:45], v[44:45], v[14:15]
    v_pk_fma_f32 v[14:15], v[46:47], v[46:47], v[14:15]
    v_add_f32 v49, v12, v13
    v_add_f32 v14, v14, v15
    v_fmac_f32 v49, 0x3e800000, v14
    s_nop 1
    v_add_f32_dpp v49, v49, v49 row_ror:8 row_mask:0xf bank_mask:0xf
    v_mov_b32 v50, v49
    s_nop 1
    v_permlane16_swap_b32 v50, v49
    v_add_f32 v49, v49, v50
    v_mov_b32 v50, v49
    s_nop 1
    v_permlane32_swap_b32 v50, v49
    v_add_f32 v49, v49, v50
    ds_write_b32 v158, v48
    ds_write_b32 v158, v49 offset:128
    s_waitcnt lgkmcnt(0)
    s_barrier
    ds_read_b128 v[16:19], v157
    ds_read_b128 v[20:23], v157 offset:128
    s_add_u32 s14, s58, 4096
    s_waitcnt lgkmcnt(1)
    v_add_f32 v12, v16, v17
    v_add_f32 v13, v18, v19
    v_add_f32 v12, v12, v13
    v_mul_f32 v12, 0x3e800000, v12
    v_sub_f32 v16, v16, v12
    v_sub_f32 v17, v17, v12
    v_sub_f32 v18, v18, v12
    v_sub_f32 v19, v19, v12
    v_sub_f32 v48, v48, v12
    v_mul_f32 v13, v16, v16
    v_fmac_f32 v13, v17, v17
    v_fmac_f32 v13, v18, v18
    v_fmac_f32 v13, v19, v19
    s_waitcnt lgkmcnt(0)
    v_add_f32 v14, v20, v21
    v_add_f32 v15, v22, v23
    v_add_f32 v14, v14, v15
    v_fmac_f32 v14, 0x43100000, v13
    v_mov_b32 v12, 0x3727c5ac
    v_fmac_f32 v12, 0x3ae38e39, v14
    v_rsq_f32 v12, v12
    s_nop 0
    v_mul_f32 v48, v48, v12
    v_pk_fma_f32 v[24:25], v[24:25], v[12:13], v[48:49] op_sel_hi:[1,0,0]
    v_pk_fma_f32 v[26:27], v[26:27], v[12:13], v[48:49] op_sel_hi:[1,0,0]
    v_pk_fma_f32 v[28:29], v[28:29], v[12:13], v[48:49] op_sel_hi:[1,0,0]
    v_pk_fma_f32 v[30:31], v[30:31], v[12:13], v[48:49] op_sel_hi:[1,0,0]
    v_cvt_pk_f16_f32 v64, v24, v25
    v_cvt_pk_f16_f32 v65, v26, v27
    v_cvt_pk_f16_f32 v66, v28, v29
    v_cvt_pk_f16_f32 v67, v30, v31
    buffer_store_dwordx4 v[64:67], v159, s[84:87], s58 offen offset:0 sc1
    v_pk_fma_f32 v[32:33], v[32:33], v[12:13], v[48:49] op_sel_hi:[1,0,0]
    v_pk_fma_f32 v[34:35], v[34:35], v[12:13], v[48:49] op_sel_hi:[1,0,0]
    v_pk_fma_f32 v[36:37], v[36:37], v[12:13], v[48:49] op_sel_hi:[1,0,0]
    v_pk_fma_f32 v[38:39], v[38:39], v[12:13], v[48:49] op_sel_hi:[1,0,0]
    v_cvt_pk_f16_f32 v68, v32, v33
    v_cvt_pk_f16_f32 v69, v34, v35
    v_cvt_pk_f16_f32 v70, v36, v37
    v_cvt_pk_f16_f32 v71, v38, v39
    buffer_store_dwordx4 v[68:71], v159, s[84:87], s58 offen offset:2048 sc1
    v_pk_fma_f32 v[40:41], v[40:41], v[12:13], v[48:49] op_sel_hi:[1,0,0]
    v_pk_fma_f32 v[42:43], v[42:43], v[12:13], v[48:49] op_sel_hi:[1,0,0]
    v_pk_fma_f32 v[44:45], v[44:45], v[12:13], v[48:49] op_sel_hi:[1,0,0]
    v_pk_fma_f32 v[46:47], v[46:47], v[12:13], v[48:49] op_sel_hi:[1,0,0]
    v_cvt_pk_f16_f32 v72, v40, v41
    v_cvt_pk_f16_f32 v73, v42, v43
    v_cvt_pk_f16_f32 v74, v44, v45
    v_cvt_pk_f16_f32 v75, v46, v47
    s_mov_b64 exec, 0xffff
    buffer_store_dwordx4 v[72:75], v159, s[84:87], s14 offen offset:0 sc1
    buffer_store_dwordx4 v[56:59], v8, s[84:87], s56 offen sc1
    s_mov_b64 exec, 0xff
    buffer_store_dwordx4 v[60:63], v160, s[84:87], s57 offen offset:1024 sc1
    s_mov_b64 exec, -1
    buffer_store_dwordx4 v[60:63], v160, s[84:87], s57 offen sc1
    s_mov_b64 exec, 255
    buffer_load_dword v51, v156, s[60:63], 0 offen sc1
    s_mov_b64 exec, -1
    s_mul_i32 s3, s96, 147456
    s_add_u32 s3, s3, 8392704
    s_add_u32 s88, s12, s3
    s_addc_u32 s89, s13, 0
    s_mov_b32 s90, 143360
    s_mov_b32 s91, 0x20000
    s_waitcnt vmcnt(7)
    v_lshlrev_b32 v40, 16, v148
    v_and_b32 v41, 0xffff0000, v148
    v_lshlrev_b32 v42, 16, v149
    v_and_b32 v43, 0xffff0000, v149
    v_lshlrev_b32 v44, 16, v150
    v_mul_f32 v16, 0xbfb8aa3b, v40
    v_mul_f32 v17, 0xbfb8aa3b, v41
    v_mul_f32 v18, 0xbfb8aa3b, v42
    v_mul_f32 v19, 0xbfb8aa3b, v43
    v_mul_f32 v20, 0xbfb8aa3b, v44
    v_exp_f32 v16, v16
    v_exp_f32 v17, v17
    v_exp_f32 v18, v18
    v_exp_f32 v19, v19
    v_exp_f32 v20, v20
    v_add_f32 v16, 1.0, v16
    v_add_f32 v17, 1.0, v17
    v_add_f32 v18, 1.0, v18
    v_add_f32 v19, 1.0, v19
    v_add_f32 v20, 1.0, v20
    v_rcp_f32 v16, v16
    v_rcp_f32 v17, v17
    v_rcp_f32 v18, v18
    v_rcp_f32 v19, v19
    v_rcp_f32 v20, v20
    v_mul_f32 v24, v40, v16
    v_mul_f32 v26, v41, v17
    v_mul_f32 v28, v42, v18
    v_mul_f32 v30, v43, v19
    v_mul_f32 v32, v44, v20
    v_lshlrev_b32 v12, 16, v128
    v_and_b32 v13, 0xffff0000, v128
    v_pk_mul_f32 v[16:17], v[12:13], v[24:25] op_sel_hi:[1,0]
    v_lshlrev_b32 v14, 16, v129
    v_and_b32 v15, 0xffff0000, v129
    v_pk_mul_f32 v[18:19], v[14:15], v[24:25] op_sel_hi:[1,0]
    v_lshlrev_b32 v12, 16, v130
    v_and_b32 v13, 0xffff0000, v130
    v_pk_mul_f32 v[20:21], v[12:13], v[24:25] op_sel_hi:[1,0]
    v_lshlrev_b32 v14, 16, v131
    v_and_b32 v15, 0xffff0000, v131
    v_pk_mul_f32 v[22:23], v[14:15], v[24:25] op_sel_hi:[1,0]
    v_lshlrev_b32 v12, 16, v132
    v_and_b32 v13, 0xffff0000, v132
    v_pk_fma_f32 v[16:17], v[12:13], v[26:27], v[16:17] op_sel_hi:[1,0,1]
    v_lshlrev_b32 v14, 16, v133
    v_and_b32 v15, 0xffff0000, v133
    v_pk_fma_f32 v[18:19], v[14:15], v[26:27], v[18:19] op_sel_hi:[1,0,1]
    v_lshlrev_b32 v12, 16, v134
    v_and_b32 v13, 0xffff0000, v134
    v_pk_fma_f32 v[20:21], v[12:13], v[26:27], v[20:21] op_sel_hi:[1,0,1]
    v_lshlrev_b32 v14, 16, v135
    v_and_b32 v15, 0xffff0000, v135
    v_pk_fma_f32 v[22:23], v[14:15], v[26:27], v[22:23] op_sel_hi:[1,0,1]
    v_lshlrev_b32 v12, 16, v136
    v_and_b32 v13, 0xffff0000, v136
    v_pk_fma_f32 v[16:17], v[12:13], v[28:29], v[16:17] op_sel_hi:[1,0,1]
    v_lshlrev_b32 v14, 16, v137
    v_and_b32 v15, 0xffff0000, v137
    v_pk_fma_f32 v[18:19], v[14:15], v[28:29], v[18:19] op_sel_hi:[1,0,1]
    v_lshlrev_b32 v12, 16, v138
    v_and_b32 v13, 0xffff0000, v138
    v_pk_fma_f32 v[20:21], v[12:13], v[28:29], v[20:21] op_sel_hi:[1,0,1]
    v_lshlrev_b32 v14, 16, v139
    v_and_b32 v15, 0xffff0000, v139
    v_pk_fma_f32 v[22:23], v[14:15], v[28:29], v[22:23] op_sel_hi:[1,0,1]
    v_lshlrev_b32 v12, 16, v140
    v_and_b32 v13, 0xffff0000, v140
    v_pk_fma_f32 v[16:17], v[12:13], v[30:31], v[16:17] op_sel_hi:[1,0,1]
    v_lshlrev_b32 v14, 16, v141
    v_and_b32 v15, 0xffff0000, v141
    v_pk_fma_f32 v[18:19], v[14:15], v[30:31], v[18:19] op_sel_hi:[1,0,1]
    v_lshlrev_b32 v12, 16, v142
    v_and_b32 v13, 0xffff0000, v142
    v_pk_fma_f32 v[20:21], v[12:13], v[30:31], v[20:21] op_sel_hi:[1,0,1]
    v_lshlrev_b32 v14, 16, v143
    v_and_b32 v15, 0xffff0000, v143
    v_pk_fma_f32 v[22:23], v[14:15], v[30:31], v[22:23] op_sel_hi:[1,0,1]
    v_lshlrev_b32 v12, 16, v144
    v_and_b32 v13, 0xffff0000, v144
    v_pk_fma_f32 v[16:17], v[12:13], v[32:33], v[16:17] op_sel_hi:[1,0,1]
    v_lshlrev_b32 v14, 16, v145
    v_and_b32 v15, 0xffff0000, v145
    v_pk_fma_f32 v[18:19], v[14:15], v[32:33], v[18:19] op_sel_hi:[1,0,1]
    v_lshlrev_b32 v12, 16, v146
    v_and_b32 v13, 0xffff0000, v146
    v_pk_fma_f32 v[20:21], v[12:13], v[32:33], v[20:21] op_sel_hi:[1,0,1]
    v_lshlrev_b32 v14, 16, v147
    v_and_b32 v15, 0xffff0000, v147
    v_pk_fma_f32 v[22:23], v[14:15], v[32:33], v[22:23] op_sel_hi:[1,0,1]
    v_add_f32_dpp v16, v16, v16 row_ror:4 row_mask:0xf bank_mask:0xf
    v_add_f32_dpp v17, v17, v17 row_ror:4 row_mask:0xf bank_mask:0xf
    v_add_f32_dpp v18, v18, v18 row_ror:4 row_mask:0xf bank_mask:0xf
    v_add_f32_dpp v19, v19, v19 row_ror:4 row_mask:0xf bank_mask:0xf
    v_add_f32_dpp v20, v20, v20 row_ror:4 row_mask:0xf bank_mask:0xf
    v_add_f32_dpp v21, v21, v21 row_ror:4 row_mask:0xf bank_mask:0xf
    v_add_f32_dpp v22, v22, v22 row_ror:4 row_mask:0xf bank_mask:0xf
    v_add_f32_dpp v23, v23, v23 row_ror:4 row_mask:0xf bank_mask:0xf
    v_add_f32_dpp v16, v16, v16 row_ror:8 row_mask:0xf bank_mask:0xf
    v_add_f32_dpp v17, v17, v17 row_ror:8 row_mask:0xf bank_mask:0xf
    v_add_f32_dpp v18, v18, v18 row_ror:8 row_mask:0xf bank_mask:0xf
    v_add_f32_dpp v19, v19, v19 row_ror:8 row_mask:0xf bank_mask:0xf
    v_add_f32_dpp v20, v20, v20 row_ror:8 row_mask:0xf bank_mask:0xf
    v_add_f32_dpp v21, v21, v21 row_ror:8 row_mask:0xf bank_mask:0xf
    v_add_f32_dpp v22, v22, v22 row_ror:8 row_mask:0xf bank_mask:0xf
    v_add_f32_dpp v23, v23, v23 row_ror:8 row_mask:0xf bank_mask:0xf
    s_mov_b32 exec_lo, 0xf000f
    s_mov_b32 exec_hi, 0xf000f
    ds_write_b128 v161, v[16:19] offset:16384
    ds_write_b128 v161, v[20:23] offset:16400
    s_mov_b64 exec, 255
    s_waitcnt vmcnt(0)
    v_cmp_eq_u32 vcc, s51, v51
    s_nop 0
    s_cmp_lg_u64 vcc, 0
    s_cbranch_scc1 L2_p0s
L2_p0r:
    s_mov_b64 exec, 1
    s_waitcnt lgkmcnt(0)
    s_barrier
    buffer_store_dword v60, v156, s[84:87], s101 offen sc1
    s_mov_b64 exec, -1
    ds_read_b32 v24, v162 offset:16384
    ds_read_b32 v25, v162 offset:16640
    ds_read_b32 v26, v162 offset:16896
    ds_read_b32 v27, v162 offset:17152
    ds_read_b32 v28, v162 offset:17408
    ds_read_b32 v29, v162 offset:17664
    ds_read_b32 v30, v162 offset:17920
    ds_read_b32 v31, v162 offset:18176
    s_waitcnt lgkmcnt(0)
    v_pk_add_f32 v[24:25], v[24:25], v[26:27]
    v_pk_add_f32 v[28:29], v[28:29], v[30:31]
    v_pk_add_f32 v[24:25], v[24:25], v[28:29]
    v_add_f32 v52, v24, v25
    v_mov_b32 v53, v52
    v_mov_b32 v54, s48
    s_nop 0
    v_permlane32_swap_b32 v53, v52
    v_add_f32 v52, v52, v53
    v_fma_f32 v52, v52, s47, v54
    v_min_u32 v52, -2, v52
    s_mov_b32 exec_hi, 0
    buffer_store_dword v52, v164, s[84:87], s100 offen sc1
    s_mov_b64 exec, -1
    s_add_u32 m0, s44, 36864
    s_mov_b32 s45, 0
    buffer_load_dwordx4 v6, s[24:27], s45 offen lds
    s_add_u32 m0, s44, 37920
    s_mov_b32 s45, 8192
    buffer_load_dwordx4 v6, s[24:27], s45 offen lds
    s_add_u32 m0, s44, 38976
    s_mov_b32 s45, 16384
    buffer_load_dwordx4 v6, s[24:27], s45 offen lds
    s_add_u32 m0, s44, 40032
    s_mov_b32 s45, 24576
    buffer_load_dwordx4 v6, s[24:27], s45 offen lds
    s_add_u32 m0, s44, 53760
    s_mov_b32 s45, 262144
    buffer_load_dwordx4 v6, s[24:27], s45 offen lds
    s_add_u32 m0, s44, 54816
    s_mov_b32 s45, 270336
    buffer_load_dwordx4 v6, s[24:27], s45 offen lds
    s_add_u32 m0, s44, 55872
    s_mov_b32 s45, 278528
    buffer_load_dwordx4 v6, s[24:27], s45 offen lds
    s_add_u32 m0, s44, 56928
    s_mov_b32 s45, 286720
    buffer_load_dwordx4 v6, s[24:27], s45 offen lds
    s_add_u32 m0, s44, 73728
    s_mov_b32 s45, 524288
    buffer_load_dwordx4 v6, s[24:27], s45 offen lds
    s_add_u32 m0, s44, 74784
    s_mov_b32 s45, 532480
    buffer_load_dwordx4 v6, s[24:27], s45 offen lds
    s_add_u32 m0, s44, 75840
    s_mov_b32 s45, 540672
    buffer_load_dwordx4 v6, s[24:27], s45 offen lds
    s_add_u32 m0, s44, 76896
    s_mov_b32 s45, 548864
    buffer_load_dwordx4 v6, s[24:27], s45 offen lds
    s_add_u32 m0, s44, 90624
    s_mov_b32 s45, 786432
    buffer_load_dwordx4 v6, s[24:27], s45 offen lds
    s_add_u32 m0, s44, 91680
    s_mov_b32 s45, 794624
    buffer_load_dwordx4 v6, s[24:27], s45 offen lds
    s_add_u32 m0, s44, 92736
    s_mov_b32 s45, 802816
    buffer_load_dwordx4 v6, s[24:27], s45 offen lds
    s_add_u32 m0, s44, 93792
    s_mov_b32 s45, 811008
    buffer_load_dwordx4 v6, s[24:27], s45 offen lds
    s_mov_b64 exec, 0
    s_cmp_eq_u32 s51, 0
    s_cbranch_scc1 L2_pad0
    s_cmp_eq_u32 s51, 1
    s_cbranch_scc1 L2_pad1
    s_cmp_eq_u32 s51, 2
    s_cbranch_scc1 L2_pad2
    s_branch L2_pad3
.p2align 12
L2_walkret:
    s_mov_b64 exec, 15
    s_mov_b32 s97, 0x20000
L2_px:
    buffer_load_dword v13, v163, s[84:87], s59 offen sc1
    s_waitcnt vmcnt(0)
    v_cmp_eq_u32 vcc, 0, v13
    s_sub_u32 s97, s97, 1
    s_cselect_b64 vcc, 0, vcc
    s_cmp_eq_u64 vcc, 0
    s_cbranch_scc1 L2_px_ok
    s_sleep 1
    s_branch L2_px
L2_px_ok:
    s_mov_b64 exec, -1
    s_movk_i32 s14, 13824
    buffer_load_dwordx4 v[168:171], v166, s[84:87], 0 offen sc1
    buffer_load_dwordx4 v[176:179], v166, s[84:87], s14 offen sc1
    s_mov_b64 exec, 0xff
    buffer_load_dwordx4 v[172:175], v166, s[84:87], 0 offen offset:1024 sc1
    buffer_load_dwordx4 v[180:183], v166, s[84:87], s14 offen offset:1024 sc1
    s_mov_b64 exec, -1
    s_mov_b32 s54, 0
    buffer_load_dwordx4 v[80:83], v8, s[32:35], s54 offen sc1
    s_mov_b32 s54, 1024
    buffer_load_dwordx4 v[84:87], v8, s[32:35], s54 offen sc1
    s_mov_b32 s54, 18432
    buffer_load_dwordx4 v[88:91], v8, s[32:35], s54 offen sc1
    s_mov_b32 s54, 19456
    buffer_load_dwordx4 v[92:95], v8, s[32:35], s54 offen sc1
    s_mov_b32 s54, 2048
    buffer_load_dwordx4 v[96:99], v8, s[32:35], s54 offen sc1
    s_mov_b32 s54, 3072
    buffer_load_dwordx4 v[100:103], v8, s[32:35], s54 offen sc1
    s_mov_b32 s54, 20480
    buffer_load_dwordx4 v[104:107], v8, s[32:35], s54 offen sc1
    s_mov_b32 s54, 21504
    buffer_load_dwordx4 v[108:111], v8, s[32:35], s54 offen sc1
    s_waitcnt vmcnt(8)
    v_max_u32 v13, v168, v169
    v_max3_u32 v13, v13, v170, v171
    v_max3_u32 v13, v13, v172, v173
    v_max3_u32 v13, v13, v174, v175
    v_max3_u32 v13, v13, v176, v177
    v_max3_u32 v13, v13, v178, v179
    v_max3_u32 v13, v13, v180, v181
    v_max3_u32 v13, v13, v182, v183
    v_cmp_eq_u32 vcc, -1, v13
    s_nop 0
    s_cmp_lg_u64 vcc, 0
    s_cbranch_scc1 L2_pms
L2_pmr:
    v_pk_add_f32 v[168:169], v[168:169], v[176:177]
    v_pk_add_f32 v[170:171], v[170:171], v[178:179]
    v_pk_add_f32 v[172:173], v[172:173], v[180:181]
    v_pk_add_f32 v[174:175], v[174:175], v[182:183]
    ds_write_b128 v167, v[168:171]
    s_mov_b64 exec, 0xff
    ds_write_b128 v167, v[172:175] offset:2048
    s_mov_b64 exec, -1
    s_mov_b32 s54, 4096
    buffer_load_dwordx4 v[112:115], v8, s[32:35], s54 offen sc1
    s_mov_b32 s54, 5120
    buffer_load_dwordx4 v[116:119], v8, s[32:35], s54 offen sc1
    s_mov_b32 s54, 22528
    buffer_load_dwordx4 v[120:123], v8, s[32:35], s54 offen sc1
    s_mov_b32 s54, 23552
    buffer_load_dwordx4 v[124:127], v8, s[32:35], s54 offen sc1
    s_waitcnt lgkmcnt(0)
    s_barrier
    ds_read_b128 v[16:19], v9 offset:9216
    ds_read_b128 v[20:23], v9 offset:9248
    ds_read_b128 v[24:27], v9 offset:9232
    ds_read_b128 v[28:31], v9 offset:9264
    s_waitcnt vmcnt(8)
    s_waitcnt lgkmcnt(2)
    v_fma_mix_f32 v32, v80, v16, v20 op_sel:[0,0,0] op_sel_hi:[1,0,0]
    v_fma_mix_f32 v33, v80, v17, v21 op_sel:[1,0,0] op_sel_hi:[1,0,0]
    v_fma_mix_f32 v34, v81, v18, v22 op_sel:[0,0,0] op_sel_hi:[1,0,0]
    v_fma_mix_f32 v35, v81, v19, v23 op_sel:[1,0,0] op_sel_hi:[1,0,0]
    v_cvt_pk_bf16_f32 v80, v32, v33
    v_cvt_pk_bf16_f32 v81, v34, v35
    v_fma_mix_f32 v36, v88, v16, v20 op_sel:[0,0,0] op_sel_hi:[1,0,0]
    v_fma_mix_f32 v37, v88, v17, v21 op_sel:[1,0,0] op_sel_hi:[1,0,0]
    v_fma_mix_f32 v38, v89, v18, v22 op_sel:[0,0,0] op_sel_hi:[1,0,0]
    v_fma_mix_f32 v39, v89, v19, v23 op_sel:[1,0,0] op_sel_hi:[1,0,0]
    v_cvt_pk_bf16_f32 v88, v36, v37
    v_cvt_pk_bf16_f32 v89, v38, v39
    ds_read_b128 v[16:19], v9 offset:9472
    ds_read_b128 v[20:23], v9 offset:9504
    s_waitcnt lgkmcnt(2)
    v_fma_mix_f32 v32, v82, v24, v28 op_sel:[0,0,0] op_sel_hi:[1,0,0]
    v_fma_mix_f32 v33, v82, v25, v29 op_sel:[1,0,0] op_sel_hi:[1,0,0]
    v_fma_mix_f32 v34, v83, v26, v30 op_sel:[0,0,0] op_sel_hi:[1,0,0]
    v_fma_mix_f32 v35, v83, v27, v31 op_sel:[1,0,0] op_sel_hi:[1,0,0]
    v_cvt_pk_bf16_f32 v82, v32, v33
    v_cvt_pk_bf16_f32 v83, v34, v35
    v_fma_mix_f32 v36, v90, v24, v28 op_sel:[0,0,0] op_sel_hi:[1,0,0]
    v_fma_mix_f32 v37, v90, v25, v29 op_sel:[1,0,0] op_sel_hi:[1,0,0]
    v_fma_mix_f32 v38, v91, v26, v30 op_sel:[0,0,0] op_sel_hi:[1,0,0]
    v_fma_mix_f32 v39, v91, v27, v31 op_sel:[1,0,0] op_sel_hi:[1,0,0]
    v_cvt_pk_bf16_f32 v90, v36, v37
    v_cvt_pk_bf16_f32 v91, v38, v39
    ds_read_b128 v[24:27], v9 offset:9488
    ds_read_b128 v[28:31], v9 offset:9520
    s_waitcnt lgkmcnt(2)
    v_fma_mix_f32 v32, v84, v16, v20 op_sel:[0,0,0] op_sel_hi:[1,0,0]
    v_fma_mix_f32 v33, v84, v17, v21 op_sel:[1,0,0] op_sel_hi:[1,0,0]
    v_fma_mix_f32 v34, v85, v18, v22 op_sel:[0,0,0] op_sel_hi:[1,0,0]
    v_fma_mix_f32 v35, v85, v19, v23 op_sel:[1,0,0] op_sel_hi:[1,0,0]
    v_cvt_pk_bf16_f32 v84, v32, v33
    v_cvt_pk_bf16_f32 v85, v34, v35
    v_fma_mix_f32 v36, v92, v16, v20 op_sel:[0,0,0] op_sel_hi:[1,0,0]
    v_fma_mix_f32 v37, v92, v17, v21 op_sel:[1,0,0] op_sel_hi:[1,0,0]
    v_fma_mix_f32 v38, v93, v18, v22 op_sel:[0,0,0] op_sel_hi:[1,0,0]
    v_fma_mix_f32 v39, v93, v19, v23 op_sel:[1,0,0] op_sel_hi:[1,0,0]
    v_cvt_pk_bf16_f32 v92, v36, v37
    v_cvt_pk_bf16_f32 v93, v38, v39
    ds_read_b128 v[16:19], v9 offset:9728
    ds_read_b128 v[20:23], v9 offset:9760
    ds_read_b64_tr_b16 a[192:193], v3 offset:36864
    ds_read_b64_tr_b16 a[194:195], v3 offset:37376
    ds_read_b64_tr_b16 a[196:197], v3 offset:53760
    ds_read_b64_tr_b16 a[198:199], v3 offset:54272
    ds_read_b64_tr_b16 a[200:201], v3 offset:36896
    ds_read_b64_tr_b16 a[202:203], v3 offset:37408
    ds_read_b64_tr_b16 a[204:205], v3 offset:53792
    ds_read_b64_tr_b16 a[206:207], v3 offset:54304
    ds_read_b64_tr_b16 a[208:209], v3 offset:36928
    ds_read_b64_tr_b16 a[210:211], v3 offset:37440
    ds_read_b64_tr_b16 a[212:213], v3 offset:53824
    ds_read_b64_tr_b16 a[214:215], v3 offset:54336
    s_waitcnt lgkmcnt(14)
    v_fma_mix_f32 v32, v86, v24, v28 op_sel:[0,0,0] op_sel_hi:[1,0,0]
    v_fma_mix_f32 v33, v86, v25, v29 op_sel:[1,0,0] op_sel_hi:[1,0,0]
    v_fma_mix_f32 v34, v87, v26, v30 op_sel:[0,0,0] op_sel_hi:[1,0,0]
    v_fma_mix_f32 v35, v87, v27, v31 op_sel:[1,0,0] op_sel_hi:[1,0,0]
    v_cvt_pk_bf16_f32 v86, v32, v33
    v_cvt_pk_bf16_f32 v87, v34, v35
    v_fma_mix_f32 v36, v94, v24, v28 op_sel:[0,0,0] op_sel_hi:[1,0,0]
    v_fma_mix_f32 v37, v94, v25, v29 op_sel:[1,0,0] op_sel_hi:[1,0,0]
    v_fma_mix_f32 v38, v95, v26, v30 op_sel:[0,0,0] op_sel_hi:[1,0,0]
    v_fma_mix_f32 v39, v95, v27, v31 op_sel:[1,0,0] op_sel_hi:[1,0,0]
    v_cvt_pk_bf16_f32 v94, v36, v37
    v_cvt_pk_bf16_f32 v95, v38, v39
    s_waitcnt lgkmcnt(8)
    v_mfma_f32_16x16x32_bf16 v[128:131], a[192:195], v[80:83], 0
    s_waitcnt vmcnt(4)
    ds_read_b64_tr_b16 a[216:217], v3 offset:36960
    ds_read_b128 v[24:27], v9 offset:9744
    v_mfma_f32_16x16x32_bf16 v[128:131], a[196:199], v[84:87], v[128:131]
    ds_read_b64_tr_b16 a[218:219], v3 offset:37472
    ds_read_b64_tr_b16 a[220:221], v3 offset:53856
    v_fma_mix_f32 v32, v96, v16, v20 op_sel:[0,0,0] op_sel_hi:[1,0,0]
    v_mfma_f32_16x16x32_bf16 v[160:163], a[192:195], v[88:91], 0
    s_add_u32 m0, s44, 110592
    ds_read_b64_tr_b16 a[222:223], v3 offset:54368
    ds_read_b128 v[28:31], v9 offset:9776
    v_mfma_f32_16x16x32_bf16 v[160:163], a[196:199], v[92:95], v[160:163]
    s_mov_b32 s45, 1048576
    s_waitcnt lgkmcnt(10)
    buffer_load_dwordx4 v6, s[24:27], s45 offen lds
    v_mfma_f32_16x16x32_bf16 v[132:135], a[200:203], v[80:83], 0
    ds_read_b64_tr_b16 a[224:225], v3 offset:36992
    v_fma_mix_f32 v33, v96, v17, v21 op_sel:[1,0,0] op_sel_hi:[1,0,0]
    v_mfma_f32_16x16x32_bf16 v[132:135], a[204:207], v[84:87], v[132:135]
    ds_read_b64_tr_b16 a[226:227], v3 offset:37504
    ds_read_b64_tr_b16 a[228:229], v3 offset:53888
    v_fma_mix_f32 v34, v97, v18, v22 op_sel:[0,0,0] op_sel_hi:[1,0,0]
    v_mfma_f32_16x16x32_bf16 v[164:167], a[200:203], v[88:91], 0
    s_add_u32 m0, s44, 111648
    ds_read_b64_tr_b16 a[230:231], v3 offset:54400
    v_fma_mix_f32 v35, v97, v19, v23 op_sel:[1,0,0] op_sel_hi:[1,0,0]
    v_mfma_f32_16x16x32_bf16 v[164:167], a[204:207], v[92:95], v[164:167]
    s_mov_b32 s45, 1056768
    s_waitcnt lgkmcnt(10)
    buffer_load_dwordx4 v6, s[24:27], s45 offen lds
    v_mfma_f32_16x16x32_bf16 v[136:139], a[208:211], v[80:83], 0
    ds_read_b64_tr_b16 a[232:233], v3 offset:37024
    v_cvt_pk_bf16_f32 v96, v32, v33
    v_mfma_f32_16x16x32_bf16 v[136:139], a[212:215], v[84:87], v[136:139]
    ds_read_b64_tr_b16 a[234:235], v3 offset:37536
    ds_read_b64_tr_b16 a[236:237], v3 offset:53920
    v_cvt_pk_bf16_f32 v97, v34, v35
    v_mfma_f32_16x16x32_bf16 v[168:171], a[208:211], v[88:91], 0
    s_add_u32 m0, s44, 112704
    ds_read_b64_tr_b16 a[238:239], v3 offset:54432
    v_fma_mix_f32 v36, v104, v16, v20 op_sel:[0,0,0] op_sel_hi:[1,0,0]
    v_mfma_f32_16x16x32_bf16 v[168:171], a[212:215], v[92:95], v[168:171]
    s_mov_b32 s45, 1064960
    s_waitcnt lgkmcnt(9)
    buffer_load_dwordx4 v6, s[24:27], s45 offen lds
    v_fma_mix_f32 v37, v104, v17, v21 op_sel:[1,0,0] op_sel_hi:[1,0,0]
    v_mfma_f32_16x16x32_bf16 v[140:143], a[216:219], v[80:83], 0
    ds_read_b64_tr_b16 a[240:241], v3 offset:37056
    v_fma_mix_f32 v38, v105, v18, v22 op_sel:[0,0,0] op_sel_hi:[1,0,0]
    v_mfma_f32_16x16x32_bf16 v[140:143], a[220:223], v[84:87], v[140:143]
    ds_read_b64_tr_b16 a[242:243], v3 offset:37568
    ds_read_b64_tr_b16 a[244:245], v3 offset:53952
    v_fma_mix_f32 v39, v105, v19, v23 op_sel:[1,0,0] op_sel_hi:[1,0,0]
    v_mfma_f32_16x16x32_bf16 v[172:175], a[216:219], v[88:91], 0
    s_add_u32 m0, s44, 113760
    ds_read_b64_tr_b16 a[246:247], v3 offset:54464
    v_cvt_pk_bf16_f32 v104, v36, v37
    v_mfma_f32_16x16x32_bf16 v[172:175], a[220:223], v[92:95], v[172:175]
    s_mov_b32 s45, 1073152
    s_waitcnt lgkmcnt(8)
    buffer_load_dwordx4 v6, s[24:27], s45 offen lds
    v_cvt_pk_bf16_f32 v105, v38, v39
    v_mfma_f32_16x16x32_bf16 v[144:147], a[224:227], v[80:83], 0
    ds_read_b64_tr_b16 a[248:249], v3 offset:37088
    ds_read_b128 v[16:19], v9 offset:9984
    v_mfma_f32_16x16x32_bf16 v[144:147], a[228:231], v[84:87], v[144:147]
    ds_read_b64_tr_b16 a[250:251], v3 offset:37600
    ds_read_b64_tr_b16 a[252:253], v3 offset:53984
    v_fma_mix_f32 v32, v98, v24, v28 op_sel:[0,0,0] op_sel_hi:[1,0,0]
    v_mfma_f32_16x16x32_bf16 v[176:179], a[224:227], v[88:91], 0
    s_add_u32 m0, s44, 127488
    ds_read_b64_tr_b16 a[254:255], v3 offset:54496
    ds_read_b128 v[20:23], v9 offset:10016
    v_mfma_f32_16x16x32_bf16 v[176:179], a[228:231], v[92:95], v[176:179]
    s_mov_b32 s45, 1310720
    s_waitcnt lgkmcnt(10)
    buffer_load_dwordx4 v6, s[24:27], s45 offen lds
    v_mfma_f32_16x16x32_bf16 v[148:151], a[232:235], v[80:83], 0
    ds_read_b64_tr_b16 a[192:193], v3 offset:37120
    v_fma_mix_f32 v33, v98, v25, v29 op_sel:[1,0,0] op_sel_hi:[1,0,0]
    v_mfma_f32_16x16x32_bf16 v[148:151], a[236:239], v[84:87], v[148:151]
    ds_read_b64_tr_b16 a[194:195], v3 offset:37632
    ds_read_b64_tr_b16 a[196:197], v3 offset:54016
    v_fma_mix_f32 v34, v99, v26, v30 op_sel:[0,0,0] op_sel_hi:[1,0,0]
    v_mfma_f32_16x16x32_bf16 v[180:183], a[232:235], v[88:91], 0
    s_add_u32 m0, s44, 128544
    ds_read_b64_tr_b16 a[198:199], v3 offset:54528
    v_fma_mix_f32 v35, v99, v27, v31 op_sel:[1,0,0] op_sel_hi:[1,0,0]
    v_mfma_f32_16x16x32_bf16 v[180:183], a[236:239], v[92:95], v[180:183]
    s_mov_b32 s45, 1318912
    s_waitcnt lgkmcnt(10)
    buffer_load_dwordx4 v6, s[24:27], s45 offen lds
    v_mfma_f32_16x16x32_bf16 v[152:155], a[240:243], v[80:83], 0
    ds_read_b64_tr_b16 a[200:201], v3 offset:37152
    v_cvt_pk_bf16_f32 v98, v32, v33
    v_mfma_f32_16x16x32_bf16 v[152:155], a[244:247], v[84:87], v[152:155]
    ds_read_b64_tr_b16 a[202:203], v3 offset:37664
    ds_read_b64_tr_b16 a[204:205], v3 offset:54048
    v_cvt_pk_bf16_f32 v99, v34, v35
    v_mfma_f32_16x16x32_bf16 v[184:187], a[240:243], v[88:91], 0
    s_add_u32 m0, s44, 129600
    ds_read_b64_tr_b16 a[206:207], v3 offset:54560
    v_fma_mix_f32 v36, v106, v24, v28 op_sel:[0,0,0] op_sel_hi:[1,0,0]
    v_mfma_f32_16x16x32_bf16 v[184:187], a[244:247], v[92:95], v[184:187]
    s_mov_b32 s45, 1327104
    s_waitcnt lgkmcnt(9)
    buffer_load_dwordx4 v6, s[24:27], s45 offen lds
    v_fma_mix_f32 v37, v106, v25, v29 op_sel:[1,0,0] op_sel_hi:[1,0,0]
    v_mfma_f32_16x16x32_bf16 v[156:159], a[248:251], v[80:83], 0
    ds_read_b64_tr_b16 a[208:209], v3 offset:37184
    v_fma_mix_f32 v38, v107, v26, v30 op_sel:[0,0,0] op_sel_hi:[1,0,0]
    v_mfma_f32_16x16x32_bf16 v[156:159], a[252:255], v[84:87], v[156:159]
    ds_read_b64_tr_b16 a[210:211], v3 offset:37696
    ds_read_b64_tr_b16 a[212:213], v3 offset:54080
    v_fma_mix_f32 v39, v107, v27, v31 op_sel:[1,0,0] op_sel_hi:[1,0,0]
    v_mfma_f32_16x16x32_bf16 v[188:191], a[248:251], v[88:91], 0
    s_add_u32 m0, s44, 130656
    ds_read_b64_tr_b16 a[214:215], v3 offset:54592
    v_cvt_pk_bf16_f32 v106, v36, v37
    v_mfma_f32_16x16x32_bf16 v[188:191], a[252:255], v[92:95], v[188:191]
    s_mov_b32 s45, 1335296
    s_waitcnt lgkmcnt(8)
    buffer_load_dwordx4 v6, s[24:27], s45 offen lds
    v_cvt_pk_bf16_f32 v107, v38, v39
    v_mfma_f32_16x16x32_bf16 v[192:195], a[192:195], v[80:83], 0
    ds_read_b64_tr_b16 a[216:217], v3 offset:37216
    ds_read_b128 v[24:27], v9 offset:10000
    v_mfma_f32_16x16x32_bf16 v[192:195], a[196:199], v[84:87], v[192:195]
    ds_read_b64_tr_b16 a[218:219], v3 offset:37728
    ds_read_b64_tr_b16 a[220:221], v3 offset:54112
    v_fma_mix_f32 v32, v100, v16, v20 op_sel:[0,0,0] op_sel_hi:[1,0,0]
    v_mfma_f32_16x16x32_bf16 v[224:227], a[192:195], v[88:91], 0
    s_mov_b32 s54, 6144
    ds_read_b64_tr_b16 a[222:223], v3 offset:54624
    ds_read_b128 v[28:31], v9 offset:10032
    v_mfma_f32_16x16x32_bf16 v[224:227], a[196:199], v[92:95], v[224:227]
    s_waitcnt lgkmcnt(10)
    buffer_load_dwordx4 v[48:51], v8, s[32:35], s54 offen sc1
    v_mfma_f32_16x16x32_bf16 v[196:199], a[200:203], v[80:83], 0
    ds_read_b64_tr_b16 a[224:225], v3 offset:37248
    v_fma_mix_f32 v33, v100, v17, v21 op_sel:[1,0,0] op_sel_hi:[1,0,0]
    v_mfma_f32_16x16x32_bf16 v[196:199], a[204:207], v[84:87], v[196:199]
    ds_read_b64_tr_b16 a[226:227], v3 offset:37760
    ds_read_b64_tr_b16 a[228:229], v3 offset:54144
    v_fma_mix_f32 v34, v101, v18, v22 op_sel:[0,0,0] op_sel_hi:[1,0,0]
    v_mfma_f32_16x16x32_bf16 v[228:231], a[200:203], v[88:91], 0
    s_mov_b32 s54, 7168
    ds_read_b64_tr_b16 a[230:231], v3 offset:54656
    v_fma_mix_f32 v35, v101, v19, v23 op_sel:[1,0,0] op_sel_hi:[1,0,0]
    v_mfma_f32_16x16x32_bf16 v[228:231], a[204:207], v[92:95], v[228:231]
    s_waitcnt lgkmcnt(10)
    buffer_load_dwordx4 v[52:55], v8, s[32:35], s54 offen sc1
    v_mfma_f32_16x16x32_bf16 v[200:203], a[208:211], v[80:83], 0
    ds_read_b64_tr_b16 a[232:233], v3 offset:37280
    v_cvt_pk_bf16_f32 v100, v32, v33
    v_mfma_f32_16x16x32_bf16 v[200:203], a[212:215], v[84:87], v[200:203]
    ds_read_b64_tr_b16 a[234:235], v3 offset:37792
    ds_read_b64_tr_b16 a[236:237], v3 offset:54176
    v_cvt_pk_bf16_f32 v101, v34, v35
    v_mfma_f32_16x16x32_bf16 v[232:235], a[208:211], v[88:91], 0
    s_mov_b32 s54, 24576
    ds_read_b64_tr_b16 a[238:239], v3 offset:54688
    v_fma_mix_f32 v36, v108, v16, v20 op_sel:[0,0,0] op_sel_hi:[1,0,0]
    v_mfma_f32_16x16x32_bf16 v[232:235], a[212:215], v[92:95], v[232:235]
    s_waitcnt lgkmcnt(9)
    buffer_load_dwordx4 v[56:59], v8, s[32:35], s54 offen sc1
    v_fma_mix_f32 v37, v108, v17, v21 op_sel:[1,0,0] op_sel_hi:[1,0,0]
    v_mfma_f32_16x16x32_bf16 v[204:207], a[216:219], v[80:83], 0
    ds_read_b64_tr_b16 a[240:241], v3 offset:37312
    v_fma_mix_f32 v38, v109, v18, v22 op_sel:[0,0,0] op_sel_hi:[1,0,0]
    v_mfma_f32_16x16x32_bf16 v[204:207], a[220:223], v[84:87], v[204:207]
    ds_read_b64_tr_b16 a[242:243], v3 offset:37824
    ds_read_b64_tr_b16 a[244:245], v3 offset:54208
    v_fma_mix_f32 v39, v109, v19, v23 op_sel:[1,0,0] op_sel_hi:[1,0,0]
    v_mfma_f32_16x16x32_bf16 v[236:239], a[216:219], v[88:91], 0
    s_mov_b32 s54, 25600
    ds_read_b64_tr_b16 a[246:247], v3 offset:54720
    v_cvt_pk_bf16_f32 v108, v36, v37
    v_mfma_f32_16x16x32_bf16 v[236:239], a[220:223], v[92:95], v[236:239]
    s_waitcnt lgkmcnt(8)
    buffer_load_dwordx4 v[60:63], v8, s[32:35], s54 offen sc1
    v_cvt_pk_bf16_f32 v109, v38, v39
    v_mfma_f32_16x16x32_bf16 v[208:211], a[224:227], v[80:83], 0
    ds_read_b64_tr_b16 a[248:249], v3 offset:37344
    ds_read_b128 v[16:19], v9 offset:10240
    v_mfma_f32_16x16x32_bf16 v[208:211], a[228:231], v[84:87], v[208:211]
    ds_read_b64_tr_b16 a[250:251], v3 offset:37856
    ds_read_b128 v[20:23], v9 offset:10272
    v_mfma_f32_16x16x32_bf16 v[240:243], a[224:227], v[88:91], 0
    ds_read_b64_tr_b16 a[252:253], v3 offset:54240
    v_fma_mix_f32 v32, v102, v24, v28 op_sel:[0,0,0] op_sel_hi:[1,0,0]
    v_mfma_f32_16x16x32_bf16 v[240:243], a[228:231], v[92:95], v[240:243]
    s_barrier
    s_waitcnt lgkmcnt(9)
    ds_read_b64_tr_b16 a[254:255], v3 offset:54752
    v_fma_mix_f32 v33, v102, v25, v29 op_sel:[1,0,0] op_sel_hi:[1,0,0]
    v_fma_mix_f32 v34, v103, v26, v30 op_sel:[0,0,0] op_sel_hi:[1,0,0]
    v_mfma_f32_16x16x32_bf16 v[212:215], a[232:235], v[80:83], 0
    ds_read_b64_tr_b16 a[192:193], v4 offset:0
    v_fma_mix_f32 v35, v103, v27, v31 op_sel:[1,0,0] op_sel_hi:[1,0,0]
    v_mfma_f32_16x16x32_bf16 v[212:215], a[236:239], v[84:87], v[212:215]
    ds_read_b64_tr_b16 a[194:195], v4 offset:512
    ds_read_b64_tr_b16 a[196:197], v4 offset:16896
    v_cvt_pk_bf16_f32 v102, v32, v33
    v_mfma_f32_16x16x32_bf16 v[244:247], a[232:235], v[88:91], 0
    s_add_u32 m0, s44, 0
    ds_read_b64_tr_b16 a[198:199], v4 offset:17408
    v_cvt_pk_bf16_f32 v103, v34, v35
    v_mfma_f32_16x16x32_bf16 v[244:247], a[236:239], v[92:95], v[244:247]
    s_mov_b32 s45, 1572864
    s_waitcnt lgkmcnt(10)
    buffer_load_dwordx4 v6, s[24:27], s45 offen lds
    v_mfma_f32_16x16x32_bf16 v[216:219], a[240:243], v[80:83], 0
    ds_read_b64_tr_b16 a[200:201], v4 offset:32
    v_fma_mix_f32 v36, v110, v24, v28 op_sel:[0,0,0] op_sel_hi:[1,0,0]
    v_mfma_f32_16x16x32_bf16 v[216:219], a[244:247], v[84:87], v[216:219]
    ds_read_b64_tr_b16 a[202:203], v4 offset:544
    ds_read_b64_tr_b16 a[204:205], v4 offset:16928
    v_fma_mix_f32 v37, v110, v25, v29 op_sel:[1,0,0] op_sel_hi:[1,0,0]
    v_mfma_f32_16x16x32_bf16 v[248:251], a[240:243], v[88:91], 0
    s_add_u32 m0, s44, 1056
    ds_read_b64_tr_b16 a[206:207], v4 offset:17440
    v_fma_mix_f32 v38, v111, v26, v30 op_sel:[0,0,0] op_sel_hi:[1,0,0]
    v_mfma_f32_16x16x32_bf16 v[248:251], a[244:247], v[92:95], v[248:251]
    s_mov_b32 s45, 1581056
    s_waitcnt lgkmcnt(8)
    buffer_load_dwordx4 v6, s[24:27], s45 offen lds
    v_mfma_f32_16x16x32_bf16 v[220:223], a[248:251], v[80:83], 0
    ds_read_b64_tr_b16 a[208:209], v4 offset:64
    v_fma_mix_f32 v39, v111, v27, v31 op_sel:[1,0,0] op_sel_hi:[1,0,0]
    v_mfma_f32_16x16x32_bf16 v[220:223], a[252:255], v[84:87], v[220:223]
    ds_read_b64_tr_b16 a[210:211], v4 offset:576
    ds_read_b64_tr_b16 a[212:213], v4 offset:16960
    v_cvt_pk_bf16_f32 v110, v36, v37
    v_mfma_f32_16x16x32_bf16 v[252:255], a[248:251], v[88:91], 0
    s_add_u32 m0, s44, 2112
    ds_read_b64_tr_b16 a[214:215], v4 offset:17472
    v_cvt_pk_bf16_f32 v111, v38, v39
    v_mfma_f32_16x16x32_bf16 v[252:255], a[252:255], v[92:95], v[252:255]
    s_mov_b32 s45, 1589248
    s_waitcnt lgkmcnt(8)
    buffer_load_dwordx4 v6, s[24:27], s45 offen lds
    v_mfma_f32_16x16x32_bf16 v[128:131], a[192:195], v[96:99], v[128:131]
    s_waitcnt vmcnt(15)
    ds_read_b64_tr_b16 a[216:217], v4 offset:96
    ds_read_b128 v[24:27], v9 offset:10256
    v_mfma_f32_16x16x32_bf16 v[128:131], a[196:199], v[100:103], v[128:131]
    ds_read_b64_tr_b16 a[218:219], v4 offset:608
    ds_read_b64_tr_b16 a[220:221], v4 offset:16992
    v_fma_mix_f32 v32, v112, v16, v20 op_sel:[0,0,0] op_sel_hi:[1,0,0]
    v_mfma_f32_16x16x32_bf16 v[160:163], a[192:195], v[104:107], v[160:163]
    s_add_u32 m0, s44, 3168
    ds_read_b64_tr_b16 a[222:223], v4 offset:17504
    ds_read_b128 v[28:31], v9 offset:10288
    v_mfma_f32_16x16x32_bf16 v[160:163], a[196:199], v[108:111], v[160:163]
    s_mov_b32 s45, 1597440
    s_waitcnt lgkmcnt(10)
    buffer_load_dwordx4 v6, s[24:27], s45 offen lds
    v_mfma_f32_16x16x32_bf16 v[132:135], a[200:203], v[96:99], v[132:135]
    ds_read_b64_tr_b16 a[224:225], v4 offset:128
    v_fma_mix_f32 v33, v112, v17, v21 op_sel:[1,0,0] op_sel_hi:[1,0,0]
    v_mfma_f32_16x16x32_bf16 v[132:135], a[204:207], v[100:103], v[132:135]
    ds_read_b64_tr_b16 a[226:227], v4 offset:640
    ds_read_b64_tr_b16 a[228:229], v4 offset:17024
    v_fma_mix_f32 v34, v113, v18, v22 op_sel:[0,0,0] op_sel_hi:[1,0,0]
    v_mfma_f32_16x16x32_bf16 v[164:167], a[200:203], v[104:107], v[164:167]
    s_add_u32 m0, s44, 16896
    ds_read_b64_tr_b16 a[230:231], v4 offset:17536
    v_fma_mix_f32 v35, v113, v19, v23 op_sel:[1,0,0] op_sel_hi:[1,0,0]
    v_mfma_f32_16x16x32_bf16 v[164:167], a[204:207], v[108:111], v[164:167]
    s_mov_b32 s45, 1835008
    s_waitcnt lgkmcnt(10)
    buffer_load_dwordx4 v6, s[24:27], s45 offen lds
    v_mfma_f32_16x16x32_bf16 v[136:139], a[208:211], v[96:99], v[136:139]
    ds_read_b64_tr_b16 a[232:233], v4 offset:160
    v_cvt_pk_bf16_f32 v112, v32, v33
    v_mfma_f32_16x16x32_bf16 v[136:139], a[212:215], v[100:103], v[136:139]
    ds_read_b64_tr_b16 a[234:235], v4 offset:672
    ds_read_b64_tr_b16 a[236:237], v4 offset:17056
    v_cvt_pk_bf16_f32 v113, v34, v35
    v_mfma_f32_16x16x32_bf16 v[168:171], a[208:211], v[104:107], v[168:171]
    s_add_u32 m0, s44, 17952
    ds_read_b64_tr_b16 a[238:239], v4 offset:17568
    v_fma_mix_f32 v36, v120, v16, v20 op_sel:[0,0,0] op_sel_hi:[1,0,0]
    v_mfma_f32_16x16x32_bf16 v[168:171], a[212:215], v[108:111], v[168:171]
    s_mov_b32 s45, 1843200
    s_waitcnt lgkmcnt(9)
    buffer_load_dwordx4 v6, s[24:27], s45 offen lds
    v_fma_mix_f32 v37, v120, v17, v21 op_sel:[1,0,0] op_sel_hi:[1,0,0]
    v_mfma_f32_16x16x32_bf16 v[140:143], a[216:219], v[96:99], v[140:143]
    ds_read_b64_tr_b16 a[240:241], v4 offset:192
    v_fma_mix_f32 v38, v121, v18, v22 op_sel:[0,0,0] op_sel_hi:[1,0,0]
    v_mfma_f32_16x16x32_bf16 v[140:143], a[220:223], v[100:103], v[140:143]
    ds_read_b64_tr_b16 a[242:243], v4 offset:704
    ds_read_b64_tr_b16 a[244:245], v4 offset:17088
    v_fma_mix_f32 v39, v121, v19, v23 op_sel:[1,0,0] op_sel_hi:[1,0,0]
    v_mfma_f32_16x16x32_bf16 v[172:175], a[216:219], v[104:107], v[172:175]
    s_add_u32 m0, s44, 19008
    ds_read_b64_tr_b16 a[246:247], v4 offset:17600
    v_cvt_pk_bf16_f32 v120, v36, v37
    v_mfma_f32_16x16x32_bf16 v[172:175], a[220:223], v[108:111], v[172:175]
    s_mov_b32 s45, 1851392
    s_waitcnt lgkmcnt(8)
    buffer_load_dwordx4 v6, s[24:27], s45 offen lds
    v_cvt_pk_bf16_f32 v121, v38, v39
    v_mfma_f32_16x16x32_bf16 v[144:147], a[224:227], v[96:99], v[144:147]
    ds_read_b64_tr_b16 a[248:249], v4 offset:224
    ds_read_b128 v[16:19], v9 offset:10496
    v_mfma_f32_16x16x32_bf16 v[144:147], a[228:231], v[100:103], v[144:147]
    ds_read_b64_tr_b16 a[250:251], v4 offset:736
    ds_read_b64_tr_b16 a[252:253], v4 offset:17120
    v_mfma_f32_16x16x32_bf16 v[176:179], a[224:227], v[104:107], v[176:179]
    s_add_u32 m0, s44, 20064
    ds_read_b64_tr_b16 a[254:255], v4 offset:17632
    ds_read_b128 v[20:23], v9 offset:10528
    v_mfma_f32_16x16x32_bf16 v[176:179], a[228:231], v[108:111], v[176:179]
    s_mov_b32 s45, 1859584
    s_waitcnt lgkmcnt(10)
    buffer_load_dwordx4 v6, s[24:27], s45 offen lds
    v_mfma_f32_16x16x32_bf16 v[148:151], a[232:235], v[96:99], v[148:151]
    ds_read_b64_tr_b16 a[192:193], v4 offset:256
    v_fma_mix_f32 v32, v114, v24, v28 op_sel:[0,0,0] op_sel_hi:[1,0,0]
    v_mfma_f32_16x16x32_bf16 v[148:151], a[236:239], v[100:103], v[148:151]
    ds_read_b64_tr_b16 a[194:195], v4 offset:768
    v_fma_mix_f32 v33, v114, v25, v29 op_sel:[1,0,0] op_sel_hi:[1,0,0]
    v_mfma_f32_16x16x32_bf16 v[180:183], a[232:235], v[104:107], v[180:183]
    ds_read_b64_tr_b16 a[196:197], v4 offset:17152
    v_fma_mix_f32 v34, v115, v26, v30 op_sel:[0,0,0] op_sel_hi:[1,0,0]
    v_mfma_f32_16x16x32_bf16 v[180:183], a[236:239], v[108:111], v[180:183]
    s_waitcnt lgkmcnt(9)
    ds_read_b64_tr_b16 a[198:199], v4 offset:17664
    v_fma_mix_f32 v35, v115, v27, v31 op_sel:[1,0,0] op_sel_hi:[1,0,0]
    v_mfma_f32_16x16x32_bf16 v[152:155], a[240:243], v[96:99], v[152:155]
    ds_read_b64_tr_b16 a[200:201], v4 offset:288
    v_cvt_pk_bf16_f32 v114, v32, v33
    v_mfma_f32_16x16x32_bf16 v[152:155], a[244:247], v[100:103], v[152:155]
    ds_read_b64_tr_b16 a[202:203], v4 offset:800
    v_cvt_pk_bf16_f32 v115, v34, v35
    v_mfma_f32_16x16x32_bf16 v[184:187], a[240:243], v[104:107], v[184:187]
    ds_read_b64_tr_b16 a[204:205], v4 offset:17184
    v_fma_mix_f32 v36, v122, v24, v28 op_sel:[0,0,0] op_sel_hi:[1,0,0]
    v_mfma_f32_16x16x32_bf16 v[184:187], a[244:247], v[108:111], v[184:187]
    s_waitcnt lgkmcnt(8)
    ds_read_b64_tr_b16 a[206:207], v4 offset:17696
    v_fma_mix_f32 v37, v122, v25, v29 op_sel:[1,0,0] op_sel_hi:[1,0,0]
    v_mfma_f32_16x16x32_bf16 v[156:159], a[248:251], v[96:99], v[156:159]
    ds_read_b64_tr_b16 a[208:209], v4 offset:320
    v_fma_mix_f32 v38, v123, v26, v30 op_sel:[0,0,0] op_sel_hi:[1,0,0]
    v_mfma_f32_16x16x32_bf16 v[156:159], a[252:255], v[100:103], v[156:159]
    ds_read_b64_tr_b16 a[210:211], v4 offset:832
    v_fma_mix_f32 v39, v123, v27, v31 op_sel:[1,0,0] op_sel_hi:[1,0,0]
    v_mfma_f32_16x16x32_bf16 v[188:191], a[248:251], v[104:107], v[188:191]
    ds_read_b64_tr_b16 a[212:213], v4 offset:17216
    v_cvt_pk_bf16_f32 v122, v36, v37
    v_mfma_f32_16x16x32_bf16 v[188:191], a[252:255], v[108:111], v[188:191]
    s_waitcnt lgkmcnt(7)
    ds_read_b64_tr_b16 a[214:215], v4 offset:17728
    v_cvt_pk_bf16_f32 v123, v38, v39
    v_mfma_f32_16x16x32_bf16 v[192:195], a[192:195], v[96:99], v[192:195]
    ds_read_b64_tr_b16 a[216:217], v4 offset:352
    ds_read_b128 v[24:27], v9 offset:10512
    v_mfma_f32_16x16x32_bf16 v[192:195], a[196:199], v[100:103], v[192:195]
    ds_read_b64_tr_b16 a[218:219], v4 offset:864
    ds_read_b64_tr_b16 a[220:221], v4 offset:17248
    v_fma_mix_f32 v32, v116, v16, v20 op_sel:[0,0,0] op_sel_hi:[1,0,0]
    v_mfma_f32_16x16x32_bf16 v[224:227], a[192:195], v[104:107], v[224:227]
    s_mov_b32 s54, 8192
    ds_read_b64_tr_b16 a[222:223], v4 offset:17760
    ds_read_b128 v[28:31], v9 offset:10544
    v_mfma_f32_16x16x32_bf16 v[224:227], a[196:199], v[108:111], v[224:227]
    s_waitcnt lgkmcnt(10)
    buffer_load_dwordx4 v[64:67], v8, s[32:35], s54 offen sc1
    v_mfma_f32_16x16x32_bf16 v[196:199], a[200:203], v[96:99], v[196:199]
    ds_read_b64_tr_b16 a[224:225], v4 offset:384
    v_fma_mix_f32 v33, v116, v17, v21 op_sel:[1,0,0] op_sel_hi:[1,0,0]
    v_mfma_f32_16x16x32_bf16 v[196:199], a[204:207], v[100:103], v[196:199]
    ds_read_b64_tr_b16 a[226:227], v4 offset:896
    ds_read_b64_tr_b16 a[228:229], v4 offset:17280
    v_fma_mix_f32 v34, v117, v18, v22 op_sel:[0,0,0] op_sel_hi:[1,0,0]
    v_mfma_f32_16x16x32_bf16 v[228:231], a[200:203], v[104:107], v[228:231]
    s_mov_b32 s54, 9216
    ds_read_b64_tr_b16 a[230:231], v4 offset:17792
    v_fma_mix_f32 v35, v117, v19, v23 op_sel:[1,0,0] op_sel_hi:[1,0,0]
    v_mfma_f32_16x16x32_bf16 v[228:231], a[204:207], v[108:111], v[228:231]
    s_waitcnt lgkmcnt(10)
    buffer_load_dwordx4 v[68:71], v8, s[32:35], s54 offen sc1
    v_mfma_f32_16x16x32_bf16 v[200:203], a[208:211], v[96:99], v[200:203]
    ds_read_b64_tr_b16 a[232:233], v4 offset:416
    v_cvt_pk_bf16_f32 v116, v32, v33
    v_mfma_f32_16x16x32_bf16 v[200:203], a[212:215], v[100:103], v[200:203]
    ds_read_b64_tr_b16 a[234:235], v4 offset:928
    ds_read_b64_tr_b16 a[236:237], v4 offset:17312
    v_cvt_pk_bf16_f32 v117, v34, v35
    v_mfma_f32_16x16x32_bf16 v[232:235], a[208:211], v[104:107], v[232:235]
    s_mov_b32 s54, 26624
    ds_read_b64_tr_b16 a[238:239], v4 offset:17824
    v_fma_mix_f32 v36, v124, v16, v20 op_sel:[0,0,0] op_sel_hi:[1,0,0]
    v_mfma_f32_16x16x32_bf16 v[232:235], a[212:215], v[108:111], v[232:235]
    s_waitcnt lgkmcnt(9)
    buffer_load_dwordx4 v[72:75], v8, s[32:35], s54 offen sc1
    v_fma_mix_f32 v37, v124, v17, v21 op_sel:[1,0,0] op_sel_hi:[1,0,0]
    v_mfma_f32_16x16x32_bf16 v[204:207], a[216:219], v[96:99], v[204:207]
L2_pad0:
    s_cbranch_execz L2_pad4
    ds_read_b64_tr_b16 a[240:241], v4 offset:448
    v_fma_mix_f32 v38, v125, v18, v22 op_sel:[0,0,0] op_sel_hi:[1,0,0]
    v_mfma_f32_16x16x32_bf16 v[204:207], a[220:223], v[100:103], v[204:207]
    ds_read_b64_tr_b16 a[242:243], v4 offset:960
    ds_read_b64_tr_b16 a[244:245], v4 offset:17344
    v_fma_mix_f32 v39, v125, v19, v23 op_sel:[1,0,0] op_sel_hi:[1,0,0]
    v_mfma_f32_16x16x32_bf16 v[236:239], a[216:219], v[104:107], v[236:239]
    s_mov_b32 s54, 27648
    ds_read_b64_tr_b16 a[246:247], v4 offset:17856
    v_cvt_pk_bf16_f32 v124, v36, v37
    v_mfma_f32_16x16x32_bf16 v[236:239], a[220:223], v[108:111], v[236:239]
    s_waitcnt lgkmcnt(8)
    buffer_load_dwordx4 v[76:79], v8, s[32:35], s54 offen sc1
    v_cvt_pk_bf16_f32 v125, v38, v39
    v_mfma_f32_16x16x32_bf16 v[208:211], a[224:227], v[96:99], v[208:211]
    ds_read_b64_tr_b16 a[248:249], v4 offset:480
    ds_read_b128 v[16:19], v9 offset:10752
    v_mfma_f32_16x16x32_bf16 v[208:211], a[228:231], v[100:103], v[208:211]
    ds_read_b64_tr_b16 a[250:251], v4 offset:992
    ds_read_b128 v[20:23], v9 offset:10784
    v_mfma_f32_16x16x32_bf16 v[240:243], a[224:227], v[104:107], v[240:243]
    ds_read_b64_tr_b16 a[252:253], v4 offset:17376
    v_fma_mix_f32 v32, v118, v24, v28 op_sel:[0,0,0] op_sel_hi:[1,0,0]
    v_mfma_f32_16x16x32_bf16 v[240:243], a[228:231], v[108:111], v[240:243]
    s_waitcnt vmcnt(16)
    s_barrier
    s_waitcnt lgkmcnt(9)
    ds_read_b64_tr_b16 a[254:255], v4 offset:17888
    v_fma_mix_f32 v33, v118, v25, v29 op_sel:[1,0,0] op_sel_hi:[1,0,0]
    v_fma_mix_f32 v34, v119, v26, v30 op_sel:[0,0,0] op_sel_hi:[1,0,0]
    v_mfma_f32_16x16x32_bf16 v[212:215], a[232:235], v[96:99], v[212:215]
    ds_read_b64_tr_b16 a[192:193], v4 offset:36864
    v_fma_mix_f32 v35, v119, v27, v31 op_sel:[1,0,0] op_sel_hi:[1,0,0]
    v_mfma_f32_16x16x32_bf16 v[212:215], a[236:239], v[100:103], v[212:215]
    ds_read_b64_tr_b16 a[194:195], v4 offset:37376
    ds_read_b64_tr_b16 a[196:197], v4 offset:53760
    v_cvt_pk_bf16_f32 v118, v32, v33
    v_mfma_f32_16x16x32_bf16 v[244:247], a[232:235], v[104:107], v[244:247]
    s_add_u32 m0, s44, 36864
    ds_read_b64_tr_b16 a[198:199], v4 offset:54272
    v_cvt_pk_bf16_f32 v119, v34, v35
    v_mfma_f32_16x16x32_bf16 v[244:247], a[236:239], v[108:111], v[244:247]
    s_mov_b32 s45, 2097152
    s_waitcnt lgkmcnt(10)
    buffer_load_dwordx4 v6, s[24:27], s45 offen lds
    v_mfma_f32_16x16x32_bf16 v[216:219], a[240:243], v[96:99], v[216:219]
    ds_read_b64_tr_b16 a[200:201], v4 offset:36896
    v_fma_mix_f32 v36, v126, v24, v28 op_sel:[0,0,0] op_sel_hi:[1,0,0]
    v_mfma_f32_16x16x32_bf16 v[216:219], a[244:247], v[100:103], v[216:219]
    ds_read_b64_tr_b16 a[202:203], v4 offset:37408
    ds_read_b64_tr_b16 a[204:205], v4 offset:53792
    v_fma_mix_f32 v37, v126, v25, v29 op_sel:[1,0,0] op_sel_hi:[1,0,0]
    v_mfma_f32_16x16x32_bf16 v[248:251], a[240:243], v[104:107], v[248:251]
    s_add_u32 m0, s44, 37920
    ds_read_b64_tr_b16 a[206:207], v4 offset:54304
    v_fma_mix_f32 v38, v127, v26, v30 op_sel:[0,0,0] op_sel_hi:[1,0,0]
    v_mfma_f32_16x16x32_bf16 v[248:251], a[244:247], v[108:111], v[248:251]
    s_mov_b32 s45, 2105344
    s_waitcnt lgkmcnt(8)
    buffer_load_dwordx4 v6, s[24:27], s45 offen lds
    v_mfma_f32_16x16x32_bf16 v[220:223], a[248:251], v[96:99], v[220:223]
    ds_read_b64_tr_b16 a[208:209], v4 offset:36928
    v_fma_mix_f32 v39, v127, v27, v31 op_sel:[1,0,0] op_sel_hi:[1,0,0]
    v_mfma_f32_16x16x32_bf16 v[220:223], a[252:255], v[100:103], v[220:223]
    ds_read_b64_tr_b16 a[210:211], v4 offset:37440
    ds_read_b64_tr_b16 a[212:213], v4 offset:53824
    v_cvt_pk_bf16_f32 v126, v36, v37
    v_mfma_f32_16x16x32_bf16 v[252:255], a[248:251], v[104:107], v[252:255]
    s_add_u32 m0, s44, 38976
    ds_read_b64_tr_b16 a[214:215], v4 offset:54336
    v_cvt_pk_bf16_f32 v127, v38, v39
    v_mfma_f32_16x16x32_bf16 v[252:255], a[252:255], v[108:111], v[252:255]
    s_mov_b32 s45, 2113536
    s_waitcnt lgkmcnt(8)
    buffer_load_dwordx4 v6, s[24:27], s45 offen lds
    v_mfma_f32_16x16x32_bf16 v[128:131], a[192:195], v[112:115], v[128:131]
    s_waitcnt vmcnt(15)
    ds_read_b64_tr_b16 a[216:217], v4 offset:36960
    ds_read_b128 v[24:27], v9 offset:10768
    v_mfma_f32_16x16x32_bf16 v[128:131], a[196:199], v[116:119], v[128:131]
    ds_read_b64_tr_b16 a[218:219], v4 offset:37472
    ds_read_b64_tr_b16 a[220:221], v4 offset:53856
    v_fma_mix_f32 v32, v48, v16, v20 op_sel:[0,0,0] op_sel_hi:[1,0,0]
    v_mfma_f32_16x16x32_bf16 v[160:163], a[192:195], v[120:123], v[160:163]
    s_add_u32 m0, s44, 40032
    ds_read_b64_tr_b16 a[222:223], v4 offset:54368
    ds_read_b128 v[28:31], v9 offset:10800
    v_mfma_f32_16x16x32_bf16 v[160:163], a[196:199], v[124:127], v[160:163]
    s_mov_b32 s45, 2121728
    s_waitcnt lgkmcnt(10)
    buffer_load_dwordx4 v6, s[24:27], s45 offen lds
    v_mfma_f32_16x16x32_bf16 v[132:135], a[200:203], v[112:115], v[132:135]
    ds_read_b64_tr_b16 a[224:225], v4 offset:36992
    v_fma_mix_f32 v33, v48, v17, v21 op_sel:[1,0,0] op_sel_hi:[1,0,0]
    v_mfma_f32_16x16x32_bf16 v[132:135], a[204:207], v[116:119], v[132:135]
    ds_read_b64_tr_b16 a[226:227], v4 offset:37504
    ds_read_b64_tr_b16 a[228:229], v4 offset:53888
    v_fma_mix_f32 v34, v49, v18, v22 op_sel:[0,0,0] op_sel_hi:[1,0,0]
    v_mfma_f32_16x16x32_bf16 v[164:167], a[200:203], v[120:123], v[164:167]
    s_add_u32 m0, s44, 53760
    ds_read_b64_tr_b16 a[230:231], v4 offset:54400
    v_fma_mix_f32 v35, v49, v19, v23 op_sel:[1,0,0] op_sel_hi:[1,0,0]
    v_mfma_f32_16x16x32_bf16 v[164:167], a[204:207], v[124:127], v[164:167]
    s_mov_b32 s45, 2359296
    s_waitcnt lgkmcnt(10)
    buffer_load_dwordx4 v6, s[24:27], s45 offen lds
    v_mfma_f32_16x16x32_bf16 v[136:139], a[208:211], v[112:115], v[136:139]
    ds_read_b64_tr_b16 a[232:233], v4 offset:37024
    v_cvt_pk_bf16_f32 v48, v32, v33
    v_mfma_f32_16x16x32_bf16 v[136:139], a[212:215], v[116:119], v[136:139]
    ds_read_b64_tr_b16 a[234:235], v4 offset:37536
    ds_read_b64_tr_b16 a[236:237], v4 offset:53920
    v_cvt_pk_bf16_f32 v49, v34, v35
    v_mfma_f32_16x16x32_bf16 v[168:171], a[208:211], v[120:123], v[168:171]
    s_add_u32 m0, s44, 54816
    ds_read_b64_tr_b16 a[238:239], v4 offset:54432
    v_fma_mix_f32 v36, v56, v16, v20 op_sel:[0,0,0] op_sel_hi:[1,0,0]
    v_mfma_f32_16x16x32_bf16 v[168:171], a[212:215], v[124:127], v[168:171]
    s_mov_b32 s45, 2367488
    s_waitcnt lgkmcnt(9)
    buffer_load_dwordx4 v6, s[24:27], s45 offen lds
    v_fma_mix_f32 v37, v56, v17, v21 op_sel:[1,0,0] op_sel_hi:[1,0,0]
    v_mfma_f32_16x16x32_bf16 v[140:143], a[216:219], v[112:115], v[140:143]
    ds_read_b64_tr_b16 a[240:241], v4 offset:37056
    v_fma_mix_f32 v38, v57, v18, v22 op_sel:[0,0,0] op_sel_hi:[1,0,0]
    v_mfma_f32_16x16x32_bf16 v[140:143], a[220:223], v[116:119], v[140:143]
    ds_read_b64_tr_b16 a[242:243], v4 offset:37568
    ds_read_b64_tr_b16 a[244:245], v4 offset:53952
    v_fma_mix_f32 v39, v57, v19, v23 op_sel:[1,0,0] op_sel_hi:[1,0,0]
    v_mfma_f32_16x16x32_bf16 v[172:175], a[216:219], v[120:123], v[172:175]
    s_add_u32 m0, s44, 55872
    ds_read_b64_tr_b16 a[246:247], v4 offset:54464
    v_cvt_pk_bf16_f32 v56, v36, v37
    v_mfma_f32_16x16x32_bf16 v[172:175], a[220:223], v[124:127], v[172:175]
    s_mov_b32 s45, 2375680
    s_waitcnt lgkmcnt(8)
    buffer_load_dwordx4 v6, s[24:27], s45 offen lds
    v_cvt_pk_bf16_f32 v57, v38, v39
    v_mfma_f32_16x16x32_bf16 v[144:147], a[224:227], v[112:115], v[144:147]
    ds_read_b64_tr_b16 a[248:249], v4 offset:37088
    ds_read_b128 v[16:19], v9 offset:11008
    v_mfma_f32_16x16x32_bf16 v[144:147], a[228:231], v[116:119], v[144:147]
    ds_read_b64_tr_b16 a[250:251], v4 offset:37600
    ds_read_b64_tr_b16 a[252:253], v4 offset:53984
    v_mfma_f32_16x16x32_bf16 v[176:179], a[224:227], v[120:123], v[176:179]
    s_add_u32 m0, s44, 56928
    ds_read_b64_tr_b16 a[254:255], v4 offset:54496
    ds_read_b128 v[20:23], v9 offset:11040
    v_mfma_f32_16x16x32_bf16 v[176:179], a[228:231], v[124:127], v[176:179]
    s_mov_b32 s45, 2383872
    s_waitcnt lgkmcnt(10)
    buffer_load_dwordx4 v6, s[24:27], s45 offen lds
    v_mfma_f32_16x16x32_bf16 v[148:151], a[232:235], v[112:115], v[148:151]
    ds_read_b64_tr_b16 a[192:193], v4 offset:37120
    v_fma_mix_f32 v32, v50, v24, v28 op_sel:[0,0,0] op_sel_hi:[1,0,0]
    v_mfma_f32_16x16x32_bf16 v[148:151], a[236:239], v[116:119], v[148:151]
    ds_read_b64_tr_b16 a[194:195], v4 offset:37632
    v_fma_mix_f32 v33, v50, v25, v29 op_sel:[1,0,0] op_sel_hi:[1,0,0]
    v_mfma_f32_16x16x32_bf16 v[180:183], a[232:235], v[120:123], v[180:183]
    ds_read_b64_tr_b16 a[196:197], v4 offset:54016
    v_fma_mix_f32 v34, v51, v26, v30 op_sel:[0,0,0] op_sel_hi:[1,0,0]
    v_mfma_f32_16x16x32_bf16 v[180:183], a[236:239], v[124:127], v[180:183]
    s_waitcnt lgkmcnt(9)
    ds_read_b64_tr_b16 a[198:199], v4 offset:54528
    v_fma_mix_f32 v35, v51, v27, v31 op_sel:[1,0,0] op_sel_hi:[1,0,0]
    v_mfma_f32_16x16x32_bf16 v[152:155], a[240:243], v[112:115], v[152:155]
    ds_read_b64_tr_b16 a[200:201], v4 offset:37152
    v_cvt_pk_bf16_f32 v50, v32, v33
    v_mfma_f32_16x16x32_bf16 v[152:155], a[244:247], v[116:119], v[152:155]
    ds_read_b64_tr_b16 a[202:203], v4 offset:37664
    v_cvt_pk_bf16_f32 v51, v34, v35
    v_mfma_f32_16x16x32_bf16 v[184:187], a[240:243], v[120:123], v[184:187]
    ds_read_b64_tr_b16 a[204:205], v4 offset:54048
    v_fma_mix_f32 v36, v58, v24, v28 op_sel:[0,0,0] op_sel_hi:[1,0,0]
    v_mfma_f32_16x16x32_bf16 v[184:187], a[244:247], v[124:127], v[184:187]
    s_waitcnt lgkmcnt(8)
    ds_read_b64_tr_b16 a[206:207], v4 offset:54560
    v_fma_mix_f32 v37, v58, v25, v29 op_sel:[1,0,0] op_sel_hi:[1,0,0]
    v_mfma_f32_16x16x32_bf16 v[156:159], a[248:251], v[112:115], v[156:159]
    ds_read_b64_tr_b16 a[208:209], v4 offset:37184
    v_fma_mix_f32 v38, v59, v26, v30 op_sel:[0,0,0] op_sel_hi:[1,0,0]
    v_mfma_f32_16x16x32_bf16 v[156:159], a[252:255], v[116:119], v[156:159]
    ds_read_b64_tr_b16 a[210:211], v4 offset:37696
    v_fma_mix_f32 v39, v59, v27, v31 op_sel:[1,0,0] op_sel_hi:[1,0,0]
    v_mfma_f32_16x16x32_bf16 v[188:191], a[248:251], v[120:123], v[188:191]
    ds_read_b64_tr_b16 a[212:213], v4 offset:54080
    v_cvt_pk_bf16_f32 v58, v36, v37
    v_mfma_f32_16x16x32_bf16 v[188:191], a[252:255], v[124:127], v[188:191]
    s_waitcnt lgkmcnt(7)
    ds_read_b64_tr_b16 a[214:215], v4 offset:54592
    v_cvt_pk_bf16_f32 v59, v38, v39
    v_mfma_f32_16x16x32_bf16 v[192:195], a[192:195], v[112:115], v[192:195]
    ds_read_b64_tr_b16 a[216:217], v4 offset:37216
    ds_read_b128 v[24:27], v9 offset:11024
    v_mfma_f32_16x16x32_bf16 v[192:195], a[196:199], v[116:119], v[192:195]
    ds_read_b64_tr_b16 a[218:219], v4 offset:37728
    ds_read_b64_tr_b16 a[220:221], v4 offset:54112
    v_fma_mix_f32 v32, v52, v16, v20 op_sel:[0,0,0] op_sel_hi:[1,0,0]
    v_mfma_f32_16x16x32_bf16 v[224:227], a[192:195], v[120:123], v[224:227]
    s_mov_b32 s54, 10240
    ds_read_b64_tr_b16 a[222:223], v4 offset:54624
    ds_read_b128 v[28:31], v9 offset:11056
    v_mfma_f32_16x16x32_bf16 v[224:227], a[196:199], v[124:127], v[224:227]
    s_waitcnt lgkmcnt(10)
    buffer_load_dwordx4 v[80:83], v8, s[32:35], s54 offen sc1
    v_mfma_f32_16x16x32_bf16 v[196:199], a[200:203], v[112:115], v[196:199]
    ds_read_b64_tr_b16 a[224:225], v4 offset:37248
    v_fma_mix_f32 v33, v52, v17, v21 op_sel:[1,0,0] op_sel_hi:[1,0,0]
    v_mfma_f32_16x16x32_bf16 v[196:199], a[204:207], v[116:119], v[196:199]
    ds_read_b64_tr_b16 a[226:227], v4 offset:37760
    ds_read_b64_tr_b16 a[228:229], v4 offset:54144
    v_fma_mix_f32 v34, v53, v18, v22 op_sel:[0,0,0] op_sel_hi:[1,0,0]
    v_mfma_f32_16x16x32_bf16 v[228:231], a[200:203], v[120:123], v[228:231]
    s_mov_b32 s54, 11264
    ds_read_b64_tr_b16 a[230:231], v4 offset:54656
    v_fma_mix_f32 v35, v53, v19, v23 op_sel:[1,0,0] op_sel_hi:[1,0,0]
    v_mfma_f32_16x16x32_bf16 v[228:231], a[204:207], v[124:127], v[228:231]
    s_waitcnt lgkmcnt(10)
    buffer_load_dwordx4 v[84:87], v8, s[32:35], s54 offen sc1
    v_mfma_f32_16x16x32_bf16 v[200:203], a[208:211], v[112:115], v[200:203]
    ds_read_b64_tr_b16 a[232:233], v4 offset:37280
    v_cvt_pk_bf16_f32 v52, v32, v33
    v_mfma_f32_16x16x32_bf16 v[200:203], a[212:215], v[116:119], v[200:203]
    ds_read_b64_tr_b16 a[234:235], v4 offset:37792
    ds_read_b64_tr_b16 a[236:237], v4 offset:54176
    v_cvt_pk_bf16_f32 v53, v34, v35
    v_mfma_f32_16x16x32_bf16 v[232:235], a[208:211], v[120:123], v[232:235]
    s_mov_b32 s54, 28672
    ds_read_b64_tr_b16 a[238:239], v4 offset:54688
    v_fma_mix_f32 v36, v60, v16, v20 op_sel:[0,0,0] op_sel_hi:[1,0,0]
    v_mfma_f32_16x16x32_bf16 v[232:235], a[212:215], v[124:127], v[232:235]
    s_waitcnt lgkmcnt(9)
    buffer_load_dwordx4 v[88:91], v8, s[32:35], s54 offen sc1
    v_fma_mix_f32 v37, v60, v17, v21 op_sel:[1,0,0] op_sel_hi:[1,0,0]
    v_mfma_f32_16x16x32_bf16 v[204:207], a[216:219], v[112:115], v[204:207]
    ds_read_b64_tr_b16 a[240:241], v4 offset:37312
    v_fma_mix_f32 v38, v61, v18, v22 op_sel:[0,0,0] op_sel_hi:[1,0,0]
    v_mfma_f32_16x16x32_bf16 v[204:207], a[220:223], v[116:119], v[204:207]
    ds_read_b64_tr_b16 a[242:243], v4 offset:37824
    ds_read_b64_tr_b16 a[244:245], v4 offset:54208
    v_fma_mix_f32 v39, v61, v19, v23 op_sel:[1,0,0] op_sel_hi:[1,0,0]
    v_mfma_f32_16x16x32_bf16 v[236:239], a[216:219], v[120:123], v[236:239]
    s_mov_b32 s54, 29696
    ds_read_b64_tr_b16 a[246:247], v4 offset:54720
    v_cvt_pk_bf16_f32 v60, v36, v37
    v_mfma_f32_16x16x32_bf16 v[236:239], a[220:223], v[124:127], v[236:239]
    s_waitcnt lgkmcnt(8)
    buffer_load_dwordx4 v[92:95], v8, s[32:35], s54 offen sc1
    v_cvt_pk_bf16_f32 v61, v38, v39
    v_mfma_f32_16x16x32_bf16 v[208:211], a[224:227], v[112:115], v[208:211]
    ds_read_b64_tr_b16 a[248:249], v4 offset:37344
    ds_read_b128 v[16:19], v9 offset:11264
    v_mfma_f32_16x16x32_bf16 v[208:211], a[228:231], v[116:119], v[208:211]
    ds_read_b64_tr_b16 a[250:251], v4 offset:37856
    ds_read_b128 v[20:23], v9 offset:11296
    v_mfma_f32_16x16x32_bf16 v[240:243], a[224:227], v[120:123], v[240:243]
    ds_read_b64_tr_b16 a[252:253], v4 offset:54240
    v_fma_mix_f32 v32, v54, v24, v28 op_sel:[0,0,0] op_sel_hi:[1,0,0]
    v_mfma_f32_16x16x32_bf16 v[240:243], a[228:231], v[124:127], v[240:243]
    s_waitcnt vmcnt(16)
    s_barrier
    s_waitcnt lgkmcnt(9)
    ds_read_b64_tr_b16 a[254:255], v4 offset:54752
    v_fma_mix_f32 v33, v54, v25, v29 op_sel:[1,0,0] op_sel_hi:[1,0,0]
    v_fma_mix_f32 v34, v55, v26, v30 op_sel:[0,0,0] op_sel_hi:[1,0,0]
    v_mfma_f32_16x16x32_bf16 v[212:215], a[232:235], v[112:115], v[212:215]
    ds_read_b64_tr_b16 a[192:193], v3 offset:0
    v_fma_mix_f32 v35, v55, v27, v31 op_sel:[1,0,0] op_sel_hi:[1,0,0]
    v_mfma_f32_16x16x32_bf16 v[212:215], a[236:239], v[116:119], v[212:215]
    ds_read_b64_tr_b16 a[194:195], v3 offset:512
    ds_read_b64_tr_b16 a[196:197], v3 offset:16896
    v_cvt_pk_bf16_f32 v54, v32, v33
    v_mfma_f32_16x16x32_bf16 v[244:247], a[232:235], v[120:123], v[244:247]
    s_add_u32 m0, s44, 73728
    ds_read_b64_tr_b16 a[198:199], v3 offset:17408
    v_cvt_pk_bf16_f32 v55, v34, v35
    v_mfma_f32_16x16x32_bf16 v[244:247], a[236:239], v[124:127], v[244:247]
    s_mov_b32 s45, 2621440
    s_waitcnt lgkmcnt(10)
    buffer_load_dwordx4 v6, s[24:27], s45 offen lds
    v_mfma_f32_16x16x32_bf16 v[216:219], a[240:243], v[112:115], v[216:219]
    ds_read_b64_tr_b16 a[200:201], v3 offset:32
    v_fma_mix_f32 v36, v62, v24, v28 op_sel:[0,0,0] op_sel_hi:[1,0,0]
    v_mfma_f32_16x16x32_bf16 v[216:219], a[244:247], v[116:119], v[216:219]
    ds_read_b64_tr_b16 a[202:203], v3 offset:544
    ds_read_b64_tr_b16 a[204:205], v3 offset:16928
    v_fma_mix_f32 v37, v62, v25, v29 op_sel:[1,0,0] op_sel_hi:[1,0,0]
    v_mfma_f32_16x16x32_bf16 v[248:251], a[240:243], v[120:123], v[248:251]
    s_add_u32 m0, s44, 74784
    ds_read_b64_tr_b16 a[206:207], v3 offset:17440
    v_fma_mix_f32 v38, v63, v26, v30 op_sel:[0,0,0] op_sel_hi:[1,0,0]
    v_mfma_f32_16x16x32_bf16 v[248:251], a[244:247], v[124:127], v[248:251]
    s_mov_b32 s45, 2629632
    s_waitcnt lgkmcnt(8)
    buffer_load_dwordx4 v6, s[24:27], s45 offen lds
    v_mfma_f32_16x16x32_bf16 v[220:223], a[248:251], v[112:115], v[220:223]
    ds_read_b64_tr_b16 a[208:209], v3 offset:64
    v_fma_mix_f32 v39, v63, v27, v31 op_sel:[1,0,0] op_sel_hi:[1,0,0]
    v_mfma_f32_16x16x32_bf16 v[220:223], a[252:255], v[116:119], v[220:223]
    ds_read_b64_tr_b16 a[210:211], v3 offset:576
    ds_read_b64_tr_b16 a[212:213], v3 offset:16960
    v_cvt_pk_bf16_f32 v62, v36, v37
    v_mfma_f32_16x16x32_bf16 v[252:255], a[248:251], v[120:123], v[252:255]
    s_add_u32 m0, s44, 75840
    ds_read_b64_tr_b16 a[214:215], v3 offset:17472
    v_cvt_pk_bf16_f32 v63, v38, v39
    v_mfma_f32_16x16x32_bf16 v[252:255], a[252:255], v[124:127], v[252:255]
    s_mov_b32 s45, 2637824
    s_waitcnt lgkmcnt(8)
    buffer_load_dwordx4 v6, s[24:27], s45 offen lds
    v_mfma_f32_16x16x32_bf16 v[128:131], a[192:195], v[48:51], v[128:131]
    s_waitcnt vmcnt(15)
    ds_read_b64_tr_b16 a[216:217], v3 offset:96
    ds_read_b128 v[24:27], v9 offset:11280
    v_mfma_f32_16x16x32_bf16 v[128:131], a[196:199], v[52:55], v[128:131]
    ds_read_b64_tr_b16 a[218:219], v3 offset:608
    ds_read_b64_tr_b16 a[220:221], v3 offset:16992
    v_fma_mix_f32 v32, v64, v16, v20 op_sel:[0,0,0] op_sel_hi:[1,0,0]
    v_mfma_f32_16x16x32_bf16 v[160:163], a[192:195], v[56:59], v[160:163]
    s_add_u32 m0, s44, 76896
    ds_read_b64_tr_b16 a[222:223], v3 offset:17504
    ds_read_b128 v[28:31], v9 offset:11312
    v_mfma_f32_16x16x32_bf16 v[160:163], a[196:199], v[60:63], v[160:163]
    s_mov_b32 s45, 2646016
    s_waitcnt lgkmcnt(10)
    buffer_load_dwordx4 v6, s[24:27], s45 offen lds
    v_mfma_f32_16x16x32_bf16 v[132:135], a[200:203], v[48:51], v[132:135]
    ds_read_b64_tr_b16 a[224:225], v3 offset:128
    v_fma_mix_f32 v33, v64, v17, v21 op_sel:[1,0,0] op_sel_hi:[1,0,0]
    v_mfma_f32_16x16x32_bf16 v[132:135], a[204:207], v[52:55], v[132:135]
    ds_read_b64_tr_b16 a[226:227], v3 offset:640
    ds_read_b64_tr_b16 a[228:229], v3 offset:17024
    v_fma_mix_f32 v34, v65, v18, v22 op_sel:[0,0,0] op_sel_hi:[1,0,0]
    v_mfma_f32_16x16x32_bf16 v[164:167], a[200:203], v[56:59], v[164:167]
    s_add_u32 m0, s44, 90624
    ds_read_b64_tr_b16 a[230:231], v3 offset:17536
    v_fma_mix_f32 v35, v65, v19, v23 op_sel:[1,0,0] op_sel_hi:[1,0,0]
    v_mfma_f32_16x16x32_bf16 v[164:167], a[204:207], v[60:63], v[164:167]
    s_mov_b32 s45, 2883584
    s_waitcnt lgkmcnt(10)
    buffer_load_dwordx4 v6, s[24:27], s45 offen lds
    v_mfma_f32_16x16x32_bf16 v[136:139], a[208:211], v[48:51], v[136:139]
    ds_read_b64_tr_b16 a[232:233], v3 offset:160
    v_cvt_pk_bf16_f32 v64, v32, v33
    v_mfma_f32_16x16x32_bf16 v[136:139], a[212:215], v[52:55], v[136:139]
    ds_read_b64_tr_b16 a[234:235], v3 offset:672
    ds_read_b64_tr_b16 a[236:237], v3 offset:17056
    v_cvt_pk_bf16_f32 v65, v34, v35
    v_mfma_f32_16x16x32_bf16 v[168:171], a[208:211], v[56:59], v[168:171]
    s_add_u32 m0, s44, 91680
    ds_read_b64_tr_b16 a[238:239], v3 offset:17568
    v_fma_mix_f32 v36, v72, v16, v20 op_sel:[0,0,0] op_sel_hi:[1,0,0]
    v_mfma_f32_16x16x32_bf16 v[168:171], a[212:215], v[60:63], v[168:171]
    s_mov_b32 s45, 2891776
    s_waitcnt lgkmcnt(9)
    buffer_load_dwordx4 v6, s[24:27], s45 offen lds
    v_fma_mix_f32 v37, v72, v17, v21 op_sel:[1,0,0] op_sel_hi:[1,0,0]
    v_mfma_f32_16x16x32_bf16 v[140:143], a[216:219], v[48:51], v[140:143]
    ds_read_b64_tr_b16 a[240:241], v3 offset:192
    v_fma_mix_f32 v38, v73, v18, v22 op_sel:[0,0,0] op_sel_hi:[1,0,0]
    v_mfma_f32_16x16x32_bf16 v[140:143], a[220:223], v[52:55], v[140:143]
    ds_read_b64_tr_b16 a[242:243], v3 offset:704
    ds_read_b64_tr_b16 a[244:245], v3 offset:17088
    v_fma_mix_f32 v39, v73, v19, v23 op_sel:[1,0,0] op_sel_hi:[1,0,0]
    v_mfma_f32_16x16x32_bf16 v[172:175], a[216:219], v[56:59], v[172:175]
    s_add_u32 m0, s44, 92736
    ds_read_b64_tr_b16 a[246:247], v3 offset:17600
    v_cvt_pk_bf16_f32 v72, v36, v37
    v_mfma_f32_16x16x32_bf16 v[172:175], a[220:223], v[60:63], v[172:175]
    s_mov_b32 s45, 2899968
    s_waitcnt lgkmcnt(8)
    buffer_load_dwordx4 v6, s[24:27], s45 offen lds
    v_cvt_pk_bf16_f32 v73, v38, v39
    v_mfma_f32_16x16x32_bf16 v[144:147], a[224:227], v[48:51], v[144:147]
    ds_read_b64_tr_b16 a[248:249], v3 offset:224
    ds_read_b128 v[16:19], v9 offset:11520
    v_mfma_f32_16x16x32_bf16 v[144:147], a[228:231], v[52:55], v[144:147]
    ds_read_b64_tr_b16 a[250:251], v3 offset:736
    ds_read_b64_tr_b16 a[252:253], v3 offset:17120
    v_mfma_f32_16x16x32_bf16 v[176:179], a[224:227], v[56:59], v[176:179]
    s_add_u32 m0, s44, 93792
    ds_read_b64_tr_b16 a[254:255], v3 offset:17632
    ds_read_b128 v[20:23], v9 offset:11552
    v_mfma_f32_16x16x32_bf16 v[176:179], a[228:231], v[60:63], v[176:179]
    s_mov_b32 s45, 2908160
    s_waitcnt lgkmcnt(10)
    buffer_load_dwordx4 v6, s[24:27], s45 offen lds
    v_mfma_f32_16x16x32_bf16 v[148:151], a[232:235], v[48:51], v[148:151]
    ds_read_b64_tr_b16 a[192:193], v3 offset:256
    v_fma_mix_f32 v32, v66, v24, v28 op_sel:[0,0,0] op_sel_hi:[1,0,0]
    v_mfma_f32_16x16x32_bf16 v[148:151], a[236:239], v[52:55], v[148:151]
    ds_read_b64_tr_b16 a[194:195], v3 offset:768
    v_fma_mix_f32 v33, v66, v25, v29 op_sel:[1,0,0] op_sel_hi:[1,0,0]
    v_mfma_f32_16x16x32_bf16 v[180:183], a[232:235], v[56:59], v[180:183]
    ds_read_b64_tr_b16 a[196:197], v3 offset:17152
    v_fma_mix_f32 v34, v67, v26, v30 op_sel:[0,0,0] op_sel_hi:[1,0,0]
    v_mfma_f32_16x16x32_bf16 v[180:183], a[236:239], v[60:63], v[180:183]
    s_waitcnt lgkmcnt(9)
    ds_read_b64_tr_b16 a[198:199], v3 offset:17664
    v_fma_mix_f32 v35, v67, v27, v31 op_sel:[1,0,0] op_sel_hi:[1,0,0]
    v_mfma_f32_16x16x32_bf16 v[152:155], a[240:243], v[48:51], v[152:155]
    ds_read_b64_tr_b16 a[200:201], v3 offset:288
    v_cvt_pk_bf16_f32 v66, v32, v33
    v_mfma_f32_16x16x32_bf16 v[152:155], a[244:247], v[52:55], v[152:155]
    ds_read_b64_tr_b16 a[202:203], v3 offset:800
    v_cvt_pk_bf16_f32 v67, v34, v35
    v_mfma_f32_16x16x32_bf16 v[184:187], a[240:243], v[56:59], v[184:187]
    ds_read_b64_tr_b16 a[204:205], v3 offset:17184
    v_fma_mix_f32 v36, v74, v24, v28 op_sel:[0,0,0] op_sel_hi:[1,0,0]
    v_mfma_f32_16x16x32_bf16 v[184:187], a[244:247], v[60:63], v[184:187]
    s_waitcnt lgkmcnt(8)
    ds_read_b64_tr_b16 a[206:207], v3 offset:17696
    v_fma_mix_f32 v37, v74, v25, v29 op_sel:[1,0,0] op_sel_hi:[1,0,0]
    v_mfma_f32_16x16x32_bf16 v[156:159], a[248:251], v[48:51], v[156:159]
    ds_read_b64_tr_b16 a[208:209], v3 offset:320
    v_fma_mix_f32 v38, v75, v26, v30 op_sel:[0,0,0] op_sel_hi:[1,0,0]
    v_mfma_f32_16x16x32_bf16 v[156:159], a[252:255], v[52:55], v[156:159]
    ds_read_b64_tr_b16 a[210:211], v3 offset:832
    v_fma_mix_f32 v39, v75, v27, v31 op_sel:[1,0,0] op_sel_hi:[1,0,0]
    v_mfma_f32_16x16x32_bf16 v[188:191], a[248:251], v[56:59], v[188:191]
    ds_read_b64_tr_b16 a[212:213], v3 offset:17216
    v_cvt_pk_bf16_f32 v74, v36, v37
    v_mfma_f32_16x16x32_bf16 v[188:191], a[252:255], v[60:63], v[188:191]
    s_waitcnt lgkmcnt(7)
    ds_read_b64_tr_b16 a[214:215], v3 offset:17728
    v_cvt_pk_bf16_f32 v75, v38, v39
    v_mfma_f32_16x16x32_bf16 v[192:195], a[192:195], v[48:51], v[192:195]
    ds_read_b64_tr_b16 a[216:217], v3 offset:352
    ds_read_b128 v[24:27], v9 offset:11536
    v_mfma_f32_16x16x32_bf16 v[192:195], a[196:199], v[52:55], v[192:195]
    ds_read_b64_tr_b16 a[218:219], v3 offset:864
    ds_read_b64_tr_b16 a[220:221], v3 offset:17248
    v_fma_mix_f32 v32, v68, v16, v20 op_sel:[0,0,0] op_sel_hi:[1,0,0]
    v_mfma_f32_16x16x32_bf16 v[224:227], a[192:195], v[56:59], v[224:227]
    s_mov_b32 s54, 12288
    ds_read_b64_tr_b16 a[222:223], v3 offset:17760
    ds_read_b128 v[28:31], v9 offset:11568
    v_mfma_f32_16x16x32_bf16 v[224:227], a[196:199], v[60:63], v[224:227]
    s_waitcnt lgkmcnt(10)
    buffer_load_dwordx4 v[96:99], v8, s[32:35], s54 offen sc1
    v_mfma_f32_16x16x32_bf16 v[196:199], a[200:203], v[48:51], v[196:199]
    ds_read_b64_tr_b16 a[224:225], v3 offset:384
    v_fma_mix_f32 v33, v68, v17, v21 op_sel:[1,0,0] op_sel_hi:[1,0,0]
    v_mfma_f32_16x16x32_bf16 v[196:199], a[204:207], v[52:55], v[196:199]
    ds_read_b64_tr_b16 a[226:227], v3 offset:896
    ds_read_b64_tr_b16 a[228:229], v3 offset:17280
    v_fma_mix_f32 v34, v69, v18, v22 op_sel:[0,0,0] op_sel_hi:[1,0,0]
    v_mfma_f32_16x16x32_bf16 v[228:231], a[200:203], v[56:59], v[228:231]
    s_mov_b32 s54, 13312
    ds_read_b64_tr_b16 a[230:231], v3 offset:17792
    v_fma_mix_f32 v35, v69, v19, v23 op_sel:[1,0,0] op_sel_hi:[1,0,0]
    v_mfma_f32_16x16x32_bf16 v[228:231], a[204:207], v[60:63], v[228:231]
    s_waitcnt lgkmcnt(10)
    buffer_load_dwordx4 v[100:103], v8, s[32:35], s54 offen sc1
    v_mfma_f32_16x16x32_bf16 v[200:203], a[208:211], v[48:51], v[200:203]
    ds_read_b64_tr_b16 a[232:233], v3 offset:416
    v_cvt_pk_bf16_f32 v68, v32, v33
    v_mfma_f32_16x16x32_bf16 v[200:203], a[212:215], v[52:55], v[200:203]
    ds_read_b64_tr_b16 a[234:235], v3 offset:928
    ds_read_b64_tr_b16 a[236:237], v3 offset:17312
    v_cvt_pk_bf16_f32 v69, v34, v35
    v_mfma_f32_16x16x32_bf16 v[232:235], a[208:211], v[56:59], v[232:235]
    s_mov_b32 s54, 30720
    ds_read_b64_tr_b16 a[238:239], v3 offset:17824
    v_fma_mix_f32 v36, v76, v16, v20 op_sel:[0,0,0] op_sel_hi:[1,0,0]
    v_mfma_f32_16x16x32_bf16 v[232:235], a[212:215], v[60:63], v[232:235]
    s_waitcnt lgkmcnt(9)
    buffer_load_dwordx4 v[104:107], v8, s[32:35], s54 offen sc1
    v_fma_mix_f32 v37, v76, v17, v21 op_sel:[1,0,0] op_sel_hi:[1,0,0]
    v_mfma_f32_16x16x32_bf16 v[204:207], a[216:219], v[48:51], v[204:207]
    ds_read_b64_tr_b16 a[240:241], v3 offset:448
    v_fma_mix_f32 v38, v77, v18, v22 op_sel:[0,0,0] op_sel_hi:[1,0,0]
    v_mfma_f32_16x16x32_bf16 v[204:207], a[220:223], v[52:55], v[204:207]
    ds_read_b64_tr_b16 a[242:243], v3 offset:960
    ds_read_b64_tr_b16 a[244:245], v3 offset:17344
    v_fma_mix_f32 v39, v77, v19, v23 op_sel:[1,0,0] op_sel_hi:[1,0,0]
    v_mfma_f32_16x16x32_bf16 v[236:239], a[216:219], v[56:59], v[236:239]
    s_mov_b32 s54, 31744
    ds_read_b64_tr_b16 a[246:247], v3 offset:17856
    v_cvt_pk_bf16_f32 v76, v36, v37
    v_mfma_f32_16x16x32_bf16 v[236:239], a[220:223], v[60:63], v[236:239]
    s_waitcnt lgkmcnt(8)
    buffer_load_dwordx4 v[108:111], v8, s[32:35], s54 offen sc1
    v_cvt_pk_bf16_f32 v77, v38, v39
    v_mfma_f32_16x16x32_bf16 v[208:211], a[224:227], v[48:51], v[208:211]
    ds_read_b64_tr_b16 a[248:249], v3 offset:480
    ds_read_b128 v[16:19], v9 offset:11776
    v_mfma_f32_16x16x32_bf16 v[208:211], a[228:231], v[52:55], v[208:211]
    ds_read_b64_tr_b16 a[250:251], v3 offset:992
    ds_read_b128 v[20:23], v9 offset:11808
    v_mfma_f32_16x16x32_bf16 v[240:243], a[224:227], v[56:59], v[240:243]
    ds_read_b64_tr_b16 a[252:253], v3 offset:17376
    v_fma_mix_f32 v32, v70, v24, v28 op_sel:[0,0,0] op_sel_hi:[1,0,0]
    v_mfma_f32_16x16x32_bf16 v[240:243], a[228:231], v[60:63], v[240:243]
    s_waitcnt vmcnt(16)
    s_barrier
    s_waitcnt lgkmcnt(9)
    ds_read_b64_tr_b16 a[254:255], v3 offset:17888
    v_fma_mix_f32 v33, v70, v25, v29 op_sel:[1,0,0] op_sel_hi:[1,0,0]
    v_fma_mix_f32 v34, v71, v26, v30 op_sel:[0,0,0] op_sel_hi:[1,0,0]
    v_mfma_f32_16x16x32_bf16 v[212:215], a[232:235], v[48:51], v[212:215]
    ds_read_b64_tr_b16 a[192:193], v3 offset:36864
    v_fma_mix_f32 v35, v71, v27, v31 op_sel:[1,0,0] op_sel_hi:[1,0,0]
    v_mfma_f32_16x16x32_bf16 v[212:215], a[236:239], v[52:55], v[212:215]
    ds_read_b64_tr_b16 a[194:195], v3 offset:37376
    ds_read_b64_tr_b16 a[196:197], v3 offset:53760
    v_cvt_pk_bf16_f32 v70, v32, v33
    v_mfma_f32_16x16x32_bf16 v[244:247], a[232:235], v[56:59], v[244:247]
    s_add_u32 m0, s44, 110592
    ds_read_b64_tr_b16 a[198:199], v3 offset:54272
    v_cvt_pk_bf16_f32 v71, v34, v35
    v_mfma_f32_16x16x32_bf16 v[244:247], a[236:239], v[60:63], v[244:247]
    s_mov_b32 s45, 3145728
    s_waitcnt lgkmcnt(10)
    buffer_load_dwordx4 v6, s[24:27], s45 offen lds
    v_mfma_f32_16x16x32_bf16 v[216:219], a[240:243], v[48:51], v[216:219]
    ds_read_b64_tr_b16 a[200:201], v3 offset:36896
    v_fma_mix_f32 v36, v78, v24, v28 op_sel:[0,0,0] op_sel_hi:[1,0,0]
    v_mfma_f32_16x16x32_bf16 v[216:219], a[244:247], v[52:55], v[216:219]
    ds_read_b64_tr_b16 a[202:203], v3 offset:37408
    ds_read_b64_tr_b16 a[204:205], v3 offset:53792
    v_fma_mix_f32 v37, v78, v25, v29 op_sel:[1,0,0] op_sel_hi:[1,0,0]
    v_mfma_f32_16x16x32_bf16 v[248:251], a[240:243], v[56:59], v[248:251]
    s_add_u32 m0, s44, 111648
    ds_read_b64_tr_b16 a[206:207], v3 offset:54304
    v_fma_mix_f32 v38, v79, v26, v30 op_sel:[0,0,0] op_sel_hi:[1,0,0]
    v_mfma_f32_16x16x32_bf16 v[248:251], a[244:247], v[60:63], v[248:251]
    s_mov_b32 s45, 3153920
    s_waitcnt lgkmcnt(8)
    buffer_load_dwordx4 v6, s[24:27], s45 offen lds
    v_mfma_f32_16x16x32_bf16 v[220:223], a[248:251], v[48:51], v[220:223]
L2_pad1:
    s_cbranch_execz L2_pad5
    ds_read_b64_tr_b16 a[208:209], v3 offset:36928
    v_fma_mix_f32 v39, v79, v27, v31 op_sel:[1,0,0] op_sel_hi:[1,0,0]
    v_mfma_f32_16x16x32_bf16 v[220:223], a[252:255], v[52:55], v[220:223]
    ds_read_b64_tr_b16 a[210:211], v3 offset:37440
    ds_read_b64_tr_b16 a[212:213], v3 offset:53824
    v_cvt_pk_bf16_f32 v78, v36, v37
    v_mfma_f32_16x16x32_bf16 v[252:255], a[248:251], v[56:59], v[252:255]
    s_add_u32 m0, s44, 112704
    ds_read_b64_tr_b16 a[214:215], v3 offset:54336
    v_cvt_pk_bf16_f32 v79, v38, v39
    v_mfma_f32_16x16x32_bf16 v[252:255], a[252:255], v[60:63], v[252:255]
    s_mov_b32 s45, 3162112
    s_waitcnt lgkmcnt(8)
    buffer_load_dwordx4 v6, s[24:27], s45 offen lds
    v_mfma_f32_16x16x32_bf16 v[128:131], a[192:195], v[64:67], v[128:131]
    s_waitcnt vmcnt(15)
    ds_read_b64_tr_b16 a[216:217], v3 offset:36960
    ds_read_b128 v[24:27], v9 offset:11792
    v_mfma_f32_16x16x32_bf16 v[128:131], a[196:199], v[68:71], v[128:131]
    ds_read_b64_tr_b16 a[218:219], v3 offset:37472
    ds_read_b64_tr_b16 a[220:221], v3 offset:53856
    v_fma_mix_f32 v32, v80, v16, v20 op_sel:[0,0,0] op_sel_hi:[1,0,0]
    v_mfma_f32_16x16x32_bf16 v[160:163], a[192:195], v[72:75], v[160:163]
    s_add_u32 m0, s44, 113760
    ds_read_b64_tr_b16 a[222:223], v3 offset:54368
    ds_read_b128 v[28:31], v9 offset:11824
    v_mfma_f32_16x16x32_bf16 v[160:163], a[196:199], v[76:79], v[160:163]
    s_mov_b32 s45, 3170304
    s_waitcnt lgkmcnt(10)
    buffer_load_dwordx4 v6, s[24:27], s45 offen lds
    v_mfma_f32_16x16x32_bf16 v[132:135], a[200:203], v[64:67], v[132:135]
    ds_read_b64_tr_b16 a[224:225], v3 offset:36992
    v_fma_mix_f32 v33, v80, v17, v21 op_sel:[1,0,0] op_sel_hi:[1,0,0]
    v_mfma_f32_16x16x32_bf16 v[132:135], a[204:207], v[68:71], v[132:135]
    ds_read_b64_tr_b16 a[226:227], v3 offset:37504
    ds_read_b64_tr_b16 a[228:229], v3 offset:53888
    v_fma_mix_f32 v34, v81, v18, v22 op_sel:[0,0,0] op_sel_hi:[1,0,0]
    v_mfma_f32_16x16x32_bf16 v[164:167], a[200:203], v[72:75], v[164:167]
    s_add_u32 m0, s44, 127488
    ds_read_b64_tr_b16 a[230:231], v3 offset:54400
    v_fma_mix_f32 v35, v81, v19, v23 op_sel:[1,0,0] op_sel_hi:[1,0,0]
    v_mfma_f32_16x16x32_bf16 v[164:167], a[204:207], v[76:79], v[164:167]
    s_mov_b32 s45, 3407872
    s_waitcnt lgkmcnt(10)
    buffer_load_dwordx4 v6, s[24:27], s45 offen lds
    v_mfma_f32_16x16x32_bf16 v[136:139], a[208:211], v[64:67], v[136:139]
    ds_read_b64_tr_b16 a[232:233], v3 offset:37024
    v_cvt_pk_bf16_f32 v80, v32, v33
    v_mfma_f32_16x16x32_bf16 v[136:139], a[212:215], v[68:71], v[136:139]
    ds_read_b64_tr_b16 a[234:235], v3 offset:37536
    ds_read_b64_tr_b16 a[236:237], v3 offset:53920
    v_cvt_pk_bf16_f32 v81, v34, v35
    v_mfma_f32_16x16x32_bf16 v[168:171], a[208:211], v[72:75], v[168:171]
    s_add_u32 m0, s44, 128544
    ds_read_b64_tr_b16 a[238:239], v3 offset:54432
    v_fma_mix_f32 v36, v88, v16, v20 op_sel:[0,0,0] op_sel_hi:[1,0,0]
    v_mfma_f32_16x16x32_bf16 v[168:171], a[212:215], v[76:79], v[168:171]
    s_mov_b32 s45, 3416064
    s_waitcnt lgkmcnt(9)
    buffer_load_dwordx4 v6, s[24:27], s45 offen lds
    v_fma_mix_f32 v37, v88, v17, v21 op_sel:[1,0,0] op_sel_hi:[1,0,0]
    v_mfma_f32_16x16x32_bf16 v[140:143], a[216:219], v[64:67], v[140:143]
    ds_read_b64_tr_b16 a[240:241], v3 offset:37056
    v_fma_mix_f32 v38, v89, v18, v22 op_sel:[0,0,0] op_sel_hi:[1,0,0]
    v_mfma_f32_16x16x32_bf16 v[140:143], a[220:223], v[68:71], v[140:143]
    ds_read_b64_tr_b16 a[242:243], v3 offset:37568
    ds_read_b64_tr_b16 a[244:245], v3 offset:53952
    v_fma_mix_f32 v39, v89, v19, v23 op_sel:[1,0,0] op_sel_hi:[1,0,0]
    v_mfma_f32_16x16x32_bf16 v[172:175], a[216:219], v[72:75], v[172:175]
    s_add_u32 m0, s44, 129600
    ds_read_b64_tr_b16 a[246:247], v3 offset:54464
    v_cvt_pk_bf16_f32 v88, v36, v37
    v_mfma_f32_16x16x32_bf16 v[172:175], a[220:223], v[76:79], v[172:175]
    s_mov_b32 s45, 3424256
    s_waitcnt lgkmcnt(8)
    buffer_load_dwordx4 v6, s[24:27], s45 offen lds
    v_cvt_pk_bf16_f32 v89, v38, v39
    v_mfma_f32_16x16x32_bf16 v[144:147], a[224:227], v[64:67], v[144:147]
    ds_read_b64_tr_b16 a[248:249], v3 offset:37088
    ds_read_b128 v[16:19], v9 offset:12032
    v_mfma_f32_16x16x32_bf16 v[144:147], a[228:231], v[68:71], v[144:147]
    ds_read_b64_tr_b16 a[250:251], v3 offset:37600
    ds_read_b64_tr_b16 a[252:253], v3 offset:53984
    v_mfma_f32_16x16x32_bf16 v[176:179], a[224:227], v[72:75], v[176:179]
    s_add_u32 m0, s44, 130656
    ds_read_b64_tr_b16 a[254:255], v3 offset:54496
    ds_read_b128 v[20:23], v9 offset:12064
    v_mfma_f32_16x16x32_bf16 v[176:179], a[228:231], v[76:79], v[176:179]
    s_mov_b32 s45, 3432448
    s_waitcnt lgkmcnt(10)
    buffer_load_dwordx4 v6, s[24:27], s45 offen lds
    v_mfma_f32_16x16x32_bf16 v[148:151], a[232:235], v[64:67], v[148:151]
    ds_read_b64_tr_b16 a[192:193], v3 offset:37120
    v_fma_mix_f32 v32, v82, v24, v28 op_sel:[0,0,0] op_sel_hi:[1,0,0]
    v_mfma_f32_16x16x32_bf16 v[148:151], a[236:239], v[68:71], v[148:151]
    ds_read_b64_tr_b16 a[194:195], v3 offset:37632
    v_fma_mix_f32 v33, v82, v25, v29 op_sel:[1,0,0] op_sel_hi:[1,0,0]
    v_mfma_f32_16x16x32_bf16 v[180:183], a[232:235], v[72:75], v[180:183]
    ds_read_b64_tr_b16 a[196:197], v3 offset:54016
    v_fma_mix_f32 v34, v83, v26, v30 op_sel:[0,0,0] op_sel_hi:[1,0,0]
    v_mfma_f32_16x16x32_bf16 v[180:183], a[236:239], v[76:79], v[180:183]
    s_waitcnt lgkmcnt(9)
    ds_read_b64_tr_b16 a[198:199], v3 offset:54528
    v_fma_mix_f32 v35, v83, v27, v31 op_sel:[1,0,0] op_sel_hi:[1,0,0]
    v_mfma_f32_16x16x32_bf16 v[152:155], a[240:243], v[64:67], v[152:155]
    ds_read_b64_tr_b16 a[200:201], v3 offset:37152
    v_cvt_pk_bf16_f32 v82, v32, v33
    v_mfma_f32_16x16x32_bf16 v[152:155], a[244:247], v[68:71], v[152:155]
    ds_read_b64_tr_b16 a[202:203], v3 offset:37664
    v_cvt_pk_bf16_f32 v83, v34, v35
    v_mfma_f32_16x16x32_bf16 v[184:187], a[240:243], v[72:75], v[184:187]
    ds_read_b64_tr_b16 a[204:205], v3 offset:54048
    v_fma_mix_f32 v36, v90, v24, v28 op_sel:[0,0,0] op_sel_hi:[1,0,0]
    v_mfma_f32_16x16x32_bf16 v[184:187], a[244:247], v[76:79], v[184:187]
    s_waitcnt lgkmcnt(8)
    ds_read_b64_tr_b16 a[206:207], v3 offset:54560
    v_fma_mix_f32 v37, v90, v25, v29 op_sel:[1,0,0] op_sel_hi:[1,0,0]
    v_mfma_f32_16x16x32_bf16 v[156:159], a[248:251], v[64:67], v[156:159]
    ds_read_b64_tr_b16 a[208:209], v3 offset:37184
    v_fma_mix_f32 v38, v91, v26, v30 op_sel:[0,0,0] op_sel_hi:[1,0,0]
    v_mfma_f32_16x16x32_bf16 v[156:159], a[252:255], v[68:71], v[156:159]
    ds_read_b64_tr_b16 a[210:211], v3 offset:37696
    v_fma_mix_f32 v39, v91, v27, v31 op_sel:[1,0,0] op_sel_hi:[1,0,0]
    v_mfma_f32_16x16x32_bf16 v[188:191], a[248:251], v[72:75], v[188:191]
    ds_read_b64_tr_b16 a[212:213], v3 offset:54080
    v_cvt_pk_bf16_f32 v90, v36, v37
    v_mfma_f32_16x16x32_bf16 v[188:191], a[252:255], v[76:79], v[188:191]
    s_waitcnt lgkmcnt(7)
    ds_read_b64_tr_b16 a[214:215], v3 offset:54592
    v_cvt_pk_bf16_f32 v91, v38, v39
    v_mfma_f32_16x16x32_bf16 v[192:195], a[192:195], v[64:67], v[192:195]
    ds_read_b64_tr_b16 a[216:217], v3 offset:37216
    ds_read_b128 v[24:27], v9 offset:12048
    v_mfma_f32_16x16x32_bf16 v[192:195], a[196:199], v[68:71], v[192:195]
    ds_read_b64_tr_b16 a[218:219], v3 offset:37728
    ds_read_b64_tr_b16 a[220:221], v3 offset:54112
    v_fma_mix_f32 v32, v84, v16, v20 op_sel:[0,0,0] op_sel_hi:[1,0,0]
    v_mfma_f32_16x16x32_bf16 v[224:227], a[192:195], v[72:75], v[224:227]
    s_mov_b32 s54, 14336
    ds_read_b64_tr_b16 a[222:223], v3 offset:54624
    ds_read_b128 v[28:31], v9 offset:12080
    v_mfma_f32_16x16x32_bf16 v[224:227], a[196:199], v[76:79], v[224:227]
    s_waitcnt lgkmcnt(10)
    buffer_load_dwordx4 v[112:115], v8, s[32:35], s54 offen sc1
    v_mfma_f32_16x16x32_bf16 v[196:199], a[200:203], v[64:67], v[196:199]
    ds_read_b64_tr_b16 a[224:225], v3 offset:37248
    v_fma_mix_f32 v33, v84, v17, v21 op_sel:[1,0,0] op_sel_hi:[1,0,0]
    v_mfma_f32_16x16x32_bf16 v[196:199], a[204:207], v[68:71], v[196:199]
    ds_read_b64_tr_b16 a[226:227], v3 offset:37760
    ds_read_b64_tr_b16 a[228:229], v3 offset:54144
    v_fma_mix_f32 v34, v85, v18, v22 op_sel:[0,0,0] op_sel_hi:[1,0,0]
    v_mfma_f32_16x16x32_bf16 v[228:231], a[200:203], v[72:75], v[228:231]
    s_mov_b32 s54, 15360
    ds_read_b64_tr_b16 a[230:231], v3 offset:54656
    v_fma_mix_f32 v35, v85, v19, v23 op_sel:[1,0,0] op_sel_hi:[1,0,0]
    v_mfma_f32_16x16x32_bf16 v[228:231], a[204:207], v[76:79], v[228:231]
    s_waitcnt lgkmcnt(10)
    buffer_load_dwordx4 v[116:119], v8, s[32:35], s54 offen sc1
    v_mfma_f32_16x16x32_bf16 v[200:203], a[208:211], v[64:67], v[200:203]
    ds_read_b64_tr_b16 a[232:233], v3 offset:37280
    v_cvt_pk_bf16_f32 v84, v32, v33
    v_mfma_f32_16x16x32_bf16 v[200:203], a[212:215], v[68:71], v[200:203]
    ds_read_b64_tr_b16 a[234:235], v3 offset:37792
    ds_read_b64_tr_b16 a[236:237], v3 offset:54176
    v_cvt_pk_bf16_f32 v85, v34, v35
    v_mfma_f32_16x16x32_bf16 v[232:235], a[208:211], v[72:75], v[232:235]
    s_mov_b32 s54, 32768
    ds_read_b64_tr_b16 a[238:239], v3 offset:54688
    v_fma_mix_f32 v36, v92, v16, v20 op_sel:[0,0,0] op_sel_hi:[1,0,0]
    v_mfma_f32_16x16x32_bf16 v[232:235], a[212:215], v[76:79], v[232:235]
    s_waitcnt lgkmcnt(9)
    buffer_load_dwordx4 v[120:123], v8, s[32:35], s54 offen sc1
    v_fma_mix_f32 v37, v92, v17, v21 op_sel:[1,0,0] op_sel_hi:[1,0,0]
    v_mfma_f32_16x16x32_bf16 v[204:207], a[216:219], v[64:67], v[204:207]
    ds_read_b64_tr_b16 a[240:241], v3 offset:37312
    v_fma_mix_f32 v38, v93, v18, v22 op_sel:[0,0,0] op_sel_hi:[1,0,0]
    v_mfma_f32_16x16x32_bf16 v[204:207], a[220:223], v[68:71], v[204:207]
    ds_read_b64_tr_b16 a[242:243], v3 offset:37824
    ds_read_b64_tr_b16 a[244:245], v3 offset:54208
    v_fma_mix_f32 v39, v93, v19, v23 op_sel:[1,0,0] op_sel_hi:[1,0,0]
    v_mfma_f32_16x16x32_bf16 v[236:239], a[216:219], v[72:75], v[236:239]
    s_mov_b32 s54, 33792
    ds_read_b64_tr_b16 a[246:247], v3 offset:54720
    v_cvt_pk_bf16_f32 v92, v36, v37
    v_mfma_f32_16x16x32_bf16 v[236:239], a[220:223], v[76:79], v[236:239]
    s_waitcnt lgkmcnt(8)
    buffer_load_dwordx4 v[124:127], v8, s[32:35], s54 offen sc1
    v_cvt_pk_bf16_f32 v93, v38, v39
    v_mfma_f32_16x16x32_bf16 v[208:211], a[224:227], v[64:67], v[208:211]
    ds_read_b64_tr_b16 a[248:249], v3 offset:37344
    ds_read_b128 v[16:19], v9 offset:12288
    v_mfma_f32_16x16x32_bf16 v[208:211], a[228:231], v[68:71], v[208:211]
    ds_read_b64_tr_b16 a[250:251], v3 offset:37856
    ds_read_b128 v[20:23], v9 offset:12320
    v_mfma_f32_16x16x32_bf16 v[240:243], a[224:227], v[72:75], v[240:243]
    ds_read_b64_tr_b16 a[252:253], v3 offset:54240
    v_fma_mix_f32 v32, v86, v24, v28 op_sel:[0,0,0] op_sel_hi:[1,0,0]
    v_mfma_f32_16x16x32_bf16 v[240:243], a[228:231], v[76:79], v[240:243]
    s_waitcnt vmcnt(16)
    s_barrier
    s_waitcnt lgkmcnt(9)
    ds_read_b64_tr_b16 a[254:255], v3 offset:54752
    v_fma_mix_f32 v33, v86, v25, v29 op_sel:[1,0,0] op_sel_hi:[1,0,0]
    v_fma_mix_f32 v34, v87, v26, v30 op_sel:[0,0,0] op_sel_hi:[1,0,0]
    v_mfma_f32_16x16x32_bf16 v[212:215], a[232:235], v[64:67], v[212:215]
    ds_read_b64_tr_b16 a[192:193], v4 offset:0
    v_fma_mix_f32 v35, v87, v27, v31 op_sel:[1,0,0] op_sel_hi:[1,0,0]
    v_mfma_f32_16x16x32_bf16 v[212:215], a[236:239], v[68:71], v[212:215]
    ds_read_b64_tr_b16 a[194:195], v4 offset:512
    ds_read_b64_tr_b16 a[196:197], v4 offset:16896
    v_cvt_pk_bf16_f32 v86, v32, v33
    v_mfma_f32_16x16x32_bf16 v[244:247], a[232:235], v[72:75], v[244:247]
    s_add_u32 m0, s44, 0
    ds_read_b64_tr_b16 a[198:199], v4 offset:17408
    v_cvt_pk_bf16_f32 v87, v34, v35
    v_mfma_f32_16x16x32_bf16 v[244:247], a[236:239], v[76:79], v[244:247]
    s_mov_b32 s45, 3670016
    s_waitcnt lgkmcnt(10)
    buffer_load_dwordx4 v6, s[24:27], s45 offen lds
    v_mfma_f32_16x16x32_bf16 v[216:219], a[240:243], v[64:67], v[216:219]
    ds_read_b64_tr_b16 a[200:201], v4 offset:32
    v_fma_mix_f32 v36, v94, v24, v28 op_sel:[0,0,0] op_sel_hi:[1,0,0]
    v_mfma_f32_16x16x32_bf16 v[216:219], a[244:247], v[68:71], v[216:219]
    ds_read_b64_tr_b16 a[202:203], v4 offset:544
    ds_read_b64_tr_b16 a[204:205], v4 offset:16928
    v_fma_mix_f32 v37, v94, v25, v29 op_sel:[1,0,0] op_sel_hi:[1,0,0]
    v_mfma_f32_16x16x32_bf16 v[248:251], a[240:243], v[72:75], v[248:251]
    s_add_u32 m0, s44, 1056
    ds_read_b64_tr_b16 a[206:207], v4 offset:17440
    v_fma_mix_f32 v38, v95, v26, v30 op_sel:[0,0,0] op_sel_hi:[1,0,0]
    v_mfma_f32_16x16x32_bf16 v[248:251], a[244:247], v[76:79], v[248:251]
    s_mov_b32 s45, 3678208
    s_waitcnt lgkmcnt(8)
    buffer_load_dwordx4 v6, s[24:27], s45 offen lds
    v_mfma_f32_16x16x32_bf16 v[220:223], a[248:251], v[64:67], v[220:223]
    ds_read_b64_tr_b16 a[208:209], v4 offset:64
    v_fma_mix_f32 v39, v95, v27, v31 op_sel:[1,0,0] op_sel_hi:[1,0,0]
    v_mfma_f32_16x16x32_bf16 v[220:223], a[252:255], v[68:71], v[220:223]
    ds_read_b64_tr_b16 a[210:211], v4 offset:576
    ds_read_b64_tr_b16 a[212:213], v4 offset:16960
    v_cvt_pk_bf16_f32 v94, v36, v37
    v_mfma_f32_16x16x32_bf16 v[252:255], a[248:251], v[72:75], v[252:255]
    s_add_u32 m0, s44, 2112
    ds_read_b64_tr_b16 a[214:215], v4 offset:17472
    v_cvt_pk_bf16_f32 v95, v38, v39
    v_mfma_f32_16x16x32_bf16 v[252:255], a[252:255], v[76:79], v[252:255]
    s_mov_b32 s45, 3686400
    s_waitcnt lgkmcnt(8)
    buffer_load_dwordx4 v6, s[24:27], s45 offen lds
    v_mfma_f32_16x16x32_bf16 v[128:131], a[192:195], v[80:83], v[128:131]
    s_waitcnt vmcnt(15)
    ds_read_b64_tr_b16 a[216:217], v4 offset:96
    ds_read_b128 v[24:27], v9 offset:12304
    v_mfma_f32_16x16x32_bf16 v[128:131], a[196:199], v[84:87], v[128:131]
    ds_read_b64_tr_b16 a[218:219], v4 offset:608
    ds_read_b64_tr_b16 a[220:221], v4 offset:16992
    v_fma_mix_f32 v32, v96, v16, v20 op_sel:[0,0,0] op_sel_hi:[1,0,0]
    v_mfma_f32_16x16x32_bf16 v[160:163], a[192:195], v[88:91], v[160:163]
    s_add_u32 m0, s44, 3168
    ds_read_b64_tr_b16 a[222:223], v4 offset:17504
    ds_read_b128 v[28:31], v9 offset:12336
    v_mfma_f32_16x16x32_bf16 v[160:163], a[196:199], v[92:95], v[160:163]
    s_mov_b32 s45, 3694592
    s_waitcnt lgkmcnt(10)
    buffer_load_dwordx4 v6, s[24:27], s45 offen lds
    v_mfma_f32_16x16x32_bf16 v[132:135], a[200:203], v[80:83], v[132:135]
    ds_read_b64_tr_b16 a[224:225], v4 offset:128
    v_fma_mix_f32 v33, v96, v17, v21 op_sel:[1,0,0] op_sel_hi:[1,0,0]
    v_mfma_f32_16x16x32_bf16 v[132:135], a[204:207], v[84:87], v[132:135]
    ds_read_b64_tr_b16 a[226:227], v4 offset:640
    ds_read_b64_tr_b16 a[228:229], v4 offset:17024
    v_fma_mix_f32 v34, v97, v18, v22 op_sel:[0,0,0] op_sel_hi:[1,0,0]
    v_mfma_f32_16x16x32_bf16 v[164:167], a[200:203], v[88:91], v[164:167]
    s_add_u32 m0, s44, 16896
    ds_read_b64_tr_b16 a[230:231], v4 offset:17536
    v_fma_mix_f32 v35, v97, v19, v23 op_sel:[1,0,0] op_sel_hi:[1,0,0]
    v_mfma_f32_16x16x32_bf16 v[164:167], a[204:207], v[92:95], v[164:167]
    s_mov_b32 s45, 3932160
    s_waitcnt lgkmcnt(10)
    buffer_load_dwordx4 v6, s[24:27], s45 offen lds
    v_mfma_f32_16x16x32_bf16 v[136:139], a[208:211], v[80:83], v[136:139]
    ds_read_b64_tr_b16 a[232:233], v4 offset:160
    v_cvt_pk_bf16_f32 v96, v32, v33
    v_mfma_f32_16x16x32_bf16 v[136:139], a[212:215], v[84:87], v[136:139]
    ds_read_b64_tr_b16 a[234:235], v4 offset:672
    ds_read_b64_tr_b16 a[236:237], v4 offset:17056
    v_cvt_pk_bf16_f32 v97, v34, v35
    v_mfma_f32_16x16x32_bf16 v[168:171], a[208:211], v[88:91], v[168:171]
    s_add_u32 m0, s44, 17952
    ds_read_b64_tr_b16 a[238:239], v4 offset:17568
    v_fma_mix_f32 v36, v104, v16, v20 op_sel:[0,0,0] op_sel_hi:[1,0,0]
    v_mfma_f32_16x16x32_bf16 v[168:171], a[212:215], v[92:95], v[168:171]
    s_mov_b32 s45, 3940352
    s_waitcnt lgkmcnt(9)
    buffer_load_dwordx4 v6, s[24:27], s45 offen lds
    v_fma_mix_f32 v37, v104, v17, v21 op_sel:[1,0,0] op_sel_hi:[1,0,0]
    v_mfma_f32_16x16x32_bf16 v[140:143], a[216:219], v[80:83], v[140:143]
    ds_read_b64_tr_b16 a[240:241], v4 offset:192
    v_fma_mix_f32 v38, v105, v18, v22 op_sel:[0,0,0] op_sel_hi:[1,0,0]
    v_mfma_f32_16x16x32_bf16 v[140:143], a[220:223], v[84:87], v[140:143]
    ds_read_b64_tr_b16 a[242:243], v4 offset:704
    ds_read_b64_tr_b16 a[244:245], v4 offset:17088
    v_fma_mix_f32 v39, v105, v19, v23 op_sel:[1,0,0] op_sel_hi:[1,0,0]
    v_mfma_f32_16x16x32_bf16 v[172:175], a[216:219], v[88:91], v[172:175]
    s_add_u32 m0, s44, 19008
    ds_read_b64_tr_b16 a[246:247], v4 offset:17600
    v_cvt_pk_bf16_f32 v104, v36, v37
    v_mfma_f32_16x16x32_bf16 v[172:175], a[220:223], v[92:95], v[172:175]
    s_mov_b32 s45, 3948544
    s_waitcnt lgkmcnt(8)
    buffer_load_dwordx4 v6, s[24:27], s45 offen lds
    v_cvt_pk_bf16_f32 v105, v38, v39
    v_mfma_f32_16x16x32_bf16 v[144:147], a[224:227], v[80:83], v[144:147]
    ds_read_b64_tr_b16 a[248:249], v4 offset:224
    ds_read_b128 v[16:19], v9 offset:12544
    v_mfma_f32_16x16x32_bf16 v[144:147], a[228:231], v[84:87], v[144:147]
    ds_read_b64_tr_b16 a[250:251], v4 offset:736
    ds_read_b64_tr_b16 a[252:253], v4 offset:17120
    v_mfma_f32_16x16x32_bf16 v[176:179], a[224:227], v[88:91], v[176:179]
    s_add_u32 m0, s44, 20064
    ds_read_b64_tr_b16 a[254:255], v4 offset:17632
    ds_read_b128 v[20:23], v9 offset:12576
    v_mfma_f32_16x16x32_bf16 v[176:179], a[228:231], v[92:95], v[176:179]
    s_mov_b32 s45, 3956736
    s_waitcnt lgkmcnt(10)
    buffer_load_dwordx4 v6, s[24:27], s45 offen lds
    v_mfma_f32_16x16x32_bf16 v[148:151], a[232:235], v[80:83], v[148:151]
    ds_read_b64_tr_b16 a[192:193], v4 offset:256
    v_fma_mix_f32 v32, v98, v24, v28 op_sel:[0,0,0] op_sel_hi:[1,0,0]
    v_mfma_f32_16x16x32_bf16 v[148:151], a[236:239], v[84:87], v[148:151]
    ds_read_b64_tr_b16 a[194:195], v4 offset:768
    v_fma_mix_f32 v33, v98, v25, v29 op_sel:[1,0,0] op_sel_hi:[1,0,0]
    v_mfma_f32_16x16x32_bf16 v[180:183], a[232:235], v[88:91], v[180:183]
    ds_read_b64_tr_b16 a[196:197], v4 offset:17152
    v_fma_mix_f32 v34, v99, v26, v30 op_sel:[0,0,0] op_sel_hi:[1,0,0]
    v_mfma_f32_16x16x32_bf16 v[180:183], a[236:239], v[92:95], v[180:183]
    s_waitcnt lgkmcnt(9)
    ds_read_b64_tr_b16 a[198:199], v4 offset:17664
    v_fma_mix_f32 v35, v99, v27, v31 op_sel:[1,0,0] op_sel_hi:[1,0,0]
    v_mfma_f32_16x16x32_bf16 v[152:155], a[240:243], v[80:83], v[152:155]
    ds_read_b64_tr_b16 a[200:201], v4 offset:288
    v_cvt_pk_bf16_f32 v98, v32, v33
    v_mfma_f32_16x16x32_bf16 v[152:155], a[244:247], v[84:87], v[152:155]
    ds_read_b64_tr_b16 a[202:203], v4 offset:800
    v_cvt_pk_bf16_f32 v99, v34, v35
    v_mfma_f32_16x16x32_bf16 v[184:187], a[240:243], v[88:91], v[184:187]
    ds_read_b64_tr_b16 a[204:205], v4 offset:17184
    v_fma_mix_f32 v36, v106, v24, v28 op_sel:[0,0,0] op_sel_hi:[1,0,0]
    v_mfma_f32_16x16x32_bf16 v[184:187], a[244:247], v[92:95], v[184:187]
    s_waitcnt lgkmcnt(8)
    ds_read_b64_tr_b16 a[206:207], v4 offset:17696
    v_fma_mix_f32 v37, v106, v25, v29 op_sel:[1,0,0] op_sel_hi:[1,0,0]
    v_mfma_f32_16x16x32_bf16 v[156:159], a[248:251], v[80:83], v[156:159]
    ds_read_b64_tr_b16 a[208:209], v4 offset:320
    v_fma_mix_f32 v38, v107, v26, v30 op_sel:[0,0,0] op_sel_hi:[1,0,0]
    v_mfma_f32_16x16x32_bf16 v[156:159], a[252:255], v[84:87], v[156:159]
    ds_read_b64_tr_b16 a[210:211], v4 offset:832
    v_fma_mix_f32 v39, v107, v27, v31 op_sel:[1,0,0] op_sel_hi:[1,0,0]
    v_mfma_f32_16x16x32_bf16 v[188:191], a[248:251], v[88:91], v[188:191]
    ds_read_b64_tr_b16 a[212:213], v4 offset:17216
    v_cvt_pk_bf16_f32 v106, v36, v37
    v_mfma_f32_16x16x32_bf16 v[188:191], a[252:255], v[92:95], v[188:191]
    s_waitcnt lgkmcnt(7)
    ds_read_b64_tr_b16 a[214:215], v4 offset:17728
    v_cvt_pk_bf16_f32 v107, v38, v39
    v_mfma_f32_16x16x32_bf16 v[192:195], a[192:195], v[80:83], v[192:195]
    ds_read_b64_tr_b16 a[216:217], v4 offset:352
    ds_read_b128 v[24:27], v9 offset:12560
    v_mfma_f32_16x16x32_bf16 v[192:195], a[196:199], v[84:87], v[192:195]
    ds_read_b64_tr_b16 a[218:219], v4 offset:864
    ds_read_b64_tr_b16 a[220:221], v4 offset:17248
    v_fma_mix_f32 v32, v100, v16, v20 op_sel:[0,0,0] op_sel_hi:[1,0,0]
    v_mfma_f32_16x16x32_bf16 v[224:227], a[192:195], v[88:91], v[224:227]
    s_mov_b32 s54, 16384
    ds_read_b64_tr_b16 a[222:223], v4 offset:17760
    ds_read_b128 v[28:31], v9 offset:12592
    v_mfma_f32_16x16x32_bf16 v[224:227], a[196:199], v[92:95], v[224:227]
    s_waitcnt lgkmcnt(10)
    buffer_load_dwordx4 v[48:51], v8, s[32:35], s54 offen sc1
    v_mfma_f32_16x16x32_bf16 v[196:199], a[200:203], v[80:83], v[196:199]
    ds_read_b64_tr_b16 a[224:225], v4 offset:384
    v_fma_mix_f32 v33, v100, v17, v21 op_sel:[1,0,0] op_sel_hi:[1,0,0]
    v_mfma_f32_16x16x32_bf16 v[196:199], a[204:207], v[84:87], v[196:199]
    ds_read_b64_tr_b16 a[226:227], v4 offset:896
    ds_read_b64_tr_b16 a[228:229], v4 offset:17280
    v_fma_mix_f32 v34, v101, v18, v22 op_sel:[0,0,0] op_sel_hi:[1,0,0]
    v_mfma_f32_16x16x32_bf16 v[228:231], a[200:203], v[88:91], v[228:231]
    s_mov_b32 s54, 17408
    ds_read_b64_tr_b16 a[230:231], v4 offset:17792
    v_fma_mix_f32 v35, v101, v19, v23 op_sel:[1,0,0] op_sel_hi:[1,0,0]
    v_mfma_f32_16x16x32_bf16 v[228:231], a[204:207], v[92:95], v[228:231]
    s_waitcnt lgkmcnt(10)
    buffer_load_dwordx4 v[52:55], v8, s[32:35], s54 offen sc1
    v_mfma_f32_16x16x32_bf16 v[200:203], a[208:211], v[80:83], v[200:203]
    ds_read_b64_tr_b16 a[232:233], v4 offset:416
    v_cvt_pk_bf16_f32 v100, v32, v33
    v_mfma_f32_16x16x32_bf16 v[200:203], a[212:215], v[84:87], v[200:203]
    ds_read_b64_tr_b16 a[234:235], v4 offset:928
    ds_read_b64_tr_b16 a[236:237], v4 offset:17312
    v_cvt_pk_bf16_f32 v101, v34, v35
    v_mfma_f32_16x16x32_bf16 v[232:235], a[208:211], v[88:91], v[232:235]
    s_mov_b32 s54, 34816
    ds_read_b64_tr_b16 a[238:239], v4 offset:17824
    v_fma_mix_f32 v36, v108, v16, v20 op_sel:[0,0,0] op_sel_hi:[1,0,0]
    v_mfma_f32_16x16x32_bf16 v[232:235], a[212:215], v[92:95], v[232:235]
    s_waitcnt lgkmcnt(9)
    buffer_load_dwordx4 v[56:59], v8, s[32:35], s54 offen sc1
    v_fma_mix_f32 v37, v108, v17, v21 op_sel:[1,0,0] op_sel_hi:[1,0,0]
    v_mfma_f32_16x16x32_bf16 v[204:207], a[216:219], v[80:83], v[204:207]
    ds_read_b64_tr_b16 a[240:241], v4 offset:448
    v_fma_mix_f32 v38, v109, v18, v22 op_sel:[0,0,0] op_sel_hi:[1,0,0]
    v_mfma_f32_16x16x32_bf16 v[204:207], a[220:223], v[84:87], v[204:207]
    ds_read_b64_tr_b16 a[242:243], v4 offset:960
    ds_read_b64_tr_b16 a[244:245], v4 offset:17344
    v_fma_mix_f32 v39, v109, v19, v23 op_sel:[1,0,0] op_sel_hi:[1,0,0]
    v_mfma_f32_16x16x32_bf16 v[236:239], a[216:219], v[88:91], v[236:239]
    s_mov_b32 s54, 35840
    ds_read_b64_tr_b16 a[246:247], v4 offset:17856
    v_cvt_pk_bf16_f32 v108, v36, v37
    v_mfma_f32_16x16x32_bf16 v[236:239], a[220:223], v[92:95], v[236:239]
    s_waitcnt lgkmcnt(8)
    buffer_load_dwordx4 v[60:63], v8, s[32:35], s54 offen sc1
    v_cvt_pk_bf16_f32 v109, v38, v39
    v_mfma_f32_16x16x32_bf16 v[208:211], a[224:227], v[80:83], v[208:211]
    ds_read_b64_tr_b16 a[248:249], v4 offset:480
    ds_read_b128 v[16:19], v9 offset:12800
    v_mfma_f32_16x16x32_bf16 v[208:211], a[228:231], v[84:87], v[208:211]
    ds_read_b64_tr_b16 a[250:251], v4 offset:992
    ds_read_b128 v[20:23], v9 offset:12832
    v_mfma_f32_16x16x32_bf16 v[240:243], a[224:227], v[88:91], v[240:243]
    ds_read_b64_tr_b16 a[252:253], v4 offset:17376
    v_fma_mix_f32 v32, v102, v24, v28 op_sel:[0,0,0] op_sel_hi:[1,0,0]
    v_mfma_f32_16x16x32_bf16 v[240:243], a[228:231], v[92:95], v[240:243]
    s_waitcnt vmcnt(16)
    s_barrier
    s_waitcnt lgkmcnt(9)
    ds_read_b64_tr_b16 a[254:255], v4 offset:17888
    v_fma_mix_f32 v33, v102, v25, v29 op_sel:[1,0,0] op_sel_hi:[1,0,0]
    v_fma_mix_f32 v34, v103, v26, v30 op_sel:[0,0,0] op_sel_hi:[1,0,0]
    v_mfma_f32_16x16x32_bf16 v[212:215], a[232:235], v[80:83], v[212:215]
    ds_read_b64_tr_b16 a[192:193], v4 offset:36864
    v_fma_mix_f32 v35, v103, v27, v31 op_sel:[1,0,0] op_sel_hi:[1,0,0]
    v_mfma_f32_16x16x32_bf16 v[212:215], a[236:239], v[84:87], v[212:215]
    ds_read_b64_tr_b16 a[194:195], v4 offset:37376
    ds_read_b64_tr_b16 a[196:197], v4 offset:53760
    v_cvt_pk_bf16_f32 v102, v32, v33
    v_mfma_f32_16x16x32_bf16 v[244:247], a[232:235], v[88:91], v[244:247]
    s_add_u32 m0, s44, 36864
    ds_read_b64_tr_b16 a[198:199], v4 offset:54272
    v_cvt_pk_bf16_f32 v103, v34, v35
    v_mfma_f32_16x16x32_bf16 v[244:247], a[236:239], v[92:95], v[244:247]
    s_mov_b32 s45, 4194304
    s_waitcnt lgkmcnt(10)
    buffer_load_dwordx4 v6, s[24:27], s45 offen lds
    v_mfma_f32_16x16x32_bf16 v[216:219], a[240:243], v[80:83], v[216:219]
    ds_read_b64_tr_b16 a[200:201], v4 offset:36896
    v_fma_mix_f32 v36, v110, v24, v28 op_sel:[0,0,0] op_sel_hi:[1,0,0]
    v_mfma_f32_16x16x32_bf16 v[216:219], a[244:247], v[84:87], v[216:219]
    ds_read_b64_tr_b16 a[202:203], v4 offset:37408
    ds_read_b64_tr_b16 a[204:205], v4 offset:53792
    v_fma_mix_f32 v37, v110, v25, v29 op_sel:[1,0,0] op_sel_hi:[1,0,0]
    v_mfma_f32_16x16x32_bf16 v[248:251], a[240:243], v[88:91], v[248:251]
    s_add_u32 m0, s44, 37920
    ds_read_b64_tr_b16 a[206:207], v4 offset:54304
    v_fma_mix_f32 v38, v111, v26, v30 op_sel:[0,0,0] op_sel_hi:[1,0,0]
    v_mfma_f32_16x16x32_bf16 v[248:251], a[244:247], v[92:95], v[248:251]
    s_mov_b32 s45, 4202496
    s_waitcnt lgkmcnt(8)
    buffer_load_dwordx4 v6, s[24:27], s45 offen lds
    v_mfma_f32_16x16x32_bf16 v[220:223], a[248:251], v[80:83], v[220:223]
    ds_read_b64_tr_b16 a[208:209], v4 offset:36928
    v_fma_mix_f32 v39, v111, v27, v31 op_sel:[1,0,0] op_sel_hi:[1,0,0]
    v_mfma_f32_16x16x32_bf16 v[220:223], a[252:255], v[84:87], v[220:223]
    ds_read_b64_tr_b16 a[210:211], v4 offset:37440
    ds_read_b64_tr_b16 a[212:213], v4 offset:53824
    v_cvt_pk_bf16_f32 v110, v36, v37
    v_mfma_f32_16x16x32_bf16 v[252:255], a[248:251], v[88:91], v[252:255]
    s_add_u32 m0, s44, 38976
    ds_read_b64_tr_b16 a[214:215], v4 offset:54336
    v_cvt_pk_bf16_f32 v111, v38, v39
    v_mfma_f32_16x16x32_bf16 v[252:255], a[252:255], v[92:95], v[252:255]
    s_mov_b32 s45, 4210688
    s_waitcnt lgkmcnt(8)
    buffer_load_dwordx4 v6, s[24:27], s45 offen lds
    v_mfma_f32_16x16x32_bf16 v[128:131], a[192:195], v[96:99], v[128:131]
    s_waitcnt vmcnt(15)
    ds_read_b64_tr_b16 a[216:217], v4 offset:36960
    ds_read_b128 v[24:27], v9 offset:12816
    v_mfma_f32_16x16x32_bf16 v[128:131], a[196:199], v[100:103], v[128:131]
    ds_read_b64_tr_b16 a[218:219], v4 offset:37472
    ds_read_b64_tr_b16 a[220:221], v4 offset:53856
    v_fma_mix_f32 v32, v112, v16, v20 op_sel:[0,0,0] op_sel_hi:[1,0,0]
    v_mfma_f32_16x16x32_bf16 v[160:163], a[192:195], v[104:107], v[160:163]
    s_add_u32 m0, s44, 40032
    ds_read_b64_tr_b16 a[222:223], v4 offset:54368
    ds_read_b128 v[28:31], v9 offset:12848
    v_mfma_f32_16x16x32_bf16 v[160:163], a[196:199], v[108:111], v[160:163]
    s_mov_b32 s45, 4218880
    s_waitcnt lgkmcnt(10)
    buffer_load_dwordx4 v6, s[24:27], s45 offen lds
    v_mfma_f32_16x16x32_bf16 v[132:135], a[200:203], v[96:99], v[132:135]
    ds_read_b64_tr_b16 a[224:225], v4 offset:36992
    v_fma_mix_f32 v33, v112, v17, v21 op_sel:[1,0,0] op_sel_hi:[1,0,0]
    v_mfma_f32_16x16x32_bf16 v[132:135], a[204:207], v[100:103], v[132:135]
    ds_read_b64_tr_b16 a[226:227], v4 offset:37504
    ds_read_b64_tr_b16 a[228:229], v4 offset:53888
    v_fma_mix_f32 v34, v113, v18, v22 op_sel:[0,0,0] op_sel_hi:[1,0,0]
    v_mfma_f32_16x16x32_bf16 v[164:167], a[200:203], v[104:107], v[164:167]
    s_add_u32 m0, s44, 53760
    ds_read_b64_tr_b16 a[230:231], v4 offset:54400
    v_fma_mix_f32 v35, v113, v19, v23 op_sel:[1,0,0] op_sel_hi:[1,0,0]
    v_mfma_f32_16x16x32_bf16 v[164:167], a[204:207], v[108:111], v[164:167]
    s_mov_b32 s45, 4456448
    s_waitcnt lgkmcnt(10)
    buffer_load_dwordx4 v6, s[24:27], s45 offen lds
    v_mfma_f32_16x16x32_bf16 v[136:139], a[208:211], v[96:99], v[136:139]
    ds_read_b64_tr_b16 a[232:233], v4 offset:37024
    v_cvt_pk_bf16_f32 v112, v32, v33
    v_mfma_f32_16x16x32_bf16 v[136:139], a[212:215], v[100:103], v[136:139]
    ds_read_b64_tr_b16 a[234:235], v4 offset:37536
    ds_read_b64_tr_b16 a[236:237], v4 offset:53920
    v_cvt_pk_bf16_f32 v113, v34, v35
    v_mfma_f32_16x16x32_bf16 v[168:171], a[208:211], v[104:107], v[168:171]
    s_add_u32 m0, s44, 54816
    ds_read_b64_tr_b16 a[238:239], v4 offset:54432
    v_fma_mix_f32 v36, v120, v16, v20 op_sel:[0,0,0] op_sel_hi:[1,0,0]
    v_mfma_f32_16x16x32_bf16 v[168:171], a[212:215], v[108:111], v[168:171]
    s_mov_b32 s45, 4464640
    s_waitcnt lgkmcnt(9)
    buffer_load_dwordx4 v6, s[24:27], s45 offen lds
    v_fma_mix_f32 v37, v120, v17, v21 op_sel:[1,0,0] op_sel_hi:[1,0,0]
    v_mfma_f32_16x16x32_bf16 v[140:143], a[216:219], v[96:99], v[140:143]
    ds_read_b64_tr_b16 a[240:241], v4 offset:37056
    v_fma_mix_f32 v38, v121, v18, v22 op_sel:[0,0,0] op_sel_hi:[1,0,0]
    v_mfma_f32_16x16x32_bf16 v[140:143], a[220:223], v[100:103], v[140:143]
L2_pad2:
    s_cbranch_execz L2_pad6
    ds_read_b64_tr_b16 a[242:243], v4 offset:37568
    ds_read_b64_tr_b16 a[244:245], v4 offset:53952
    v_fma_mix_f32 v39, v121, v19, v23 op_sel:[1,0,0] op_sel_hi:[1,0,0]
    v_mfma_f32_16x16x32_bf16 v[172:175], a[216:219], v[104:107], v[172:175]
    s_add_u32 m0, s44, 55872
    ds_read_b64_tr_b16 a[246:247], v4 offset:54464
    v_cvt_pk_bf16_f32 v120, v36, v37
    v_mfma_f32_16x16x32_bf16 v[172:175], a[220:223], v[108:111], v[172:175]
    s_mov_b32 s45, 4472832
    s_waitcnt lgkmcnt(8)
    buffer_load_dwordx4 v6, s[24:27], s45 offen lds
    v_cvt_pk_bf16_f32 v121, v38, v39
    v_mfma_f32_16x16x32_bf16 v[144:147], a[224:227], v[96:99], v[144:147]
    ds_read_b64_tr_b16 a[248:249], v4 offset:37088
    ds_read_b128 v[16:19], v9 offset:13056
    v_mfma_f32_16x16x32_bf16 v[144:147], a[228:231], v[100:103], v[144:147]
    ds_read_b64_tr_b16 a[250:251], v4 offset:37600
    ds_read_b64_tr_b16 a[252:253], v4 offset:53984
    v_mfma_f32_16x16x32_bf16 v[176:179], a[224:227], v[104:107], v[176:179]
    s_add_u32 m0, s44, 56928
    ds_read_b64_tr_b16 a[254:255], v4 offset:54496
    ds_read_b128 v[20:23], v9 offset:13088
    v_mfma_f32_16x16x32_bf16 v[176:179], a[228:231], v[108:111], v[176:179]
    s_mov_b32 s45, 4481024
    s_waitcnt lgkmcnt(10)
    buffer_load_dwordx4 v6, s[24:27], s45 offen lds
    v_mfma_f32_16x16x32_bf16 v[148:151], a[232:235], v[96:99], v[148:151]
    ds_read_b64_tr_b16 a[192:193], v4 offset:37120
    v_fma_mix_f32 v32, v114, v24, v28 op_sel:[0,0,0] op_sel_hi:[1,0,0]
    v_mfma_f32_16x16x32_bf16 v[148:151], a[236:239], v[100:103], v[148:151]
    ds_read_b64_tr_b16 a[194:195], v4 offset:37632
    v_fma_mix_f32 v33, v114, v25, v29 op_sel:[1,0,0] op_sel_hi:[1,0,0]
    v_mfma_f32_16x16x32_bf16 v[180:183], a[232:235], v[104:107], v[180:183]
    ds_read_b64_tr_b16 a[196:197], v4 offset:54016
    v_fma_mix_f32 v34, v115, v26, v30 op_sel:[0,0,0] op_sel_hi:[1,0,0]
    v_mfma_f32_16x16x32_bf16 v[180:183], a[236:239], v[108:111], v[180:183]
    s_waitcnt lgkmcnt(9)
    ds_read_b64_tr_b16 a[198:199], v4 offset:54528
    v_fma_mix_f32 v35, v115, v27, v31 op_sel:[1,0,0] op_sel_hi:[1,0,0]
    v_mfma_f32_16x16x32_bf16 v[152:155], a[240:243], v[96:99], v[152:155]
    ds_read_b64_tr_b16 a[200:201], v4 offset:37152
    v_cvt_pk_bf16_f32 v114, v32, v33
    v_mfma_f32_16x16x32_bf16 v[152:155], a[244:247], v[100:103], v[152:155]
    ds_read_b64_tr_b16 a[202:203], v4 offset:37664
    v_cvt_pk_bf16_f32 v115, v34, v35
    v_mfma_f32_16x16x32_bf16 v[184:187], a[240:243], v[104:107], v[184:187]
    ds_read_b64_tr_b16 a[204:205], v4 offset:54048
    v_fma_mix_f32 v36, v122, v24, v28 op_sel:[0,0,0] op_sel_hi:[1,0,0]
    v_mfma_f32_16x16x32_bf16 v[184:187], a[244:247], v[108:111], v[184:187]
    s_waitcnt lgkmcnt(8)
    ds_read_b64_tr_b16 a[206:207], v4 offset:54560
    v_fma_mix_f32 v37, v122, v25, v29 op_sel:[1,0,0] op_sel_hi:[1,0,0]
    v_mfma_f32_16x16x32_bf16 v[156:159], a[248:251], v[96:99], v[156:159]
    ds_read_b64_tr_b16 a[208:209], v4 offset:37184
    v_fma_mix_f32 v38, v123, v26, v30 op_sel:[0,0,0] op_sel_hi:[1,0,0]
    v_mfma_f32_16x16x32_bf16 v[156:159], a[252:255], v[100:103], v[156:159]
    ds_read_b64_tr_b16 a[210:211], v4 offset:37696
    v_fma_mix_f32 v39, v123, v27, v31 op_sel:[1,0,0] op_sel_hi:[1,0,0]
    v_mfma_f32_16x16x32_bf16 v[188:191], a[248:251], v[104:107], v[188:191]
    ds_read_b64_tr_b16 a[212:213], v4 offset:54080
    v_cvt_pk_bf16_f32 v122, v36, v37
    v_mfma_f32_16x16x32_bf16 v[188:191], a[252:255], v[108:111], v[188:191]
    s_waitcnt lgkmcnt(7)
    ds_read_b64_tr_b16 a[214:215], v4 offset:54592
    v_cvt_pk_bf16_f32 v123, v38, v39
    v_mfma_f32_16x16x32_bf16 v[192:195], a[192:195], v[96:99], v[192:195]
    ds_read_b64_tr_b16 a[216:217], v4 offset:37216
    ds_read_b128 v[24:27], v9 offset:13072
    v_mfma_f32_16x16x32_bf16 v[192:195], a[196:199], v[100:103], v[192:195]
    ds_read_b64_tr_b16 a[218:219], v4 offset:37728
    ds_read_b128 v[28:31], v9 offset:13104
    v_mfma_f32_16x16x32_bf16 v[224:227], a[192:195], v[104:107], v[224:227]
    ds_read_b64_tr_b16 a[220:221], v4 offset:54112
    v_fma_mix_f32 v32, v116, v16, v20 op_sel:[0,0,0] op_sel_hi:[1,0,0]
    v_mfma_f32_16x16x32_bf16 v[224:227], a[196:199], v[108:111], v[224:227]
    s_waitcnt lgkmcnt(9)
    ds_read_b64_tr_b16 a[222:223], v4 offset:54624
    v_fma_mix_f32 v33, v116, v17, v21 op_sel:[1,0,0] op_sel_hi:[1,0,0]
    v_mfma_f32_16x16x32_bf16 v[196:199], a[200:203], v[96:99], v[196:199]
    ds_read_b64_tr_b16 a[224:225], v4 offset:37248
    v_fma_mix_f32 v34, v117, v18, v22 op_sel:[0,0,0] op_sel_hi:[1,0,0]
    v_mfma_f32_16x16x32_bf16 v[196:199], a[204:207], v[100:103], v[196:199]
    ds_read_b64_tr_b16 a[226:227], v4 offset:37760
    v_fma_mix_f32 v35, v117, v19, v23 op_sel:[1,0,0] op_sel_hi:[1,0,0]
    v_mfma_f32_16x16x32_bf16 v[228:231], a[200:203], v[104:107], v[228:231]
    ds_read_b64_tr_b16 a[228:229], v4 offset:54144
    v_cvt_pk_bf16_f32 v116, v32, v33
    v_mfma_f32_16x16x32_bf16 v[228:231], a[204:207], v[108:111], v[228:231]
    s_waitcnt lgkmcnt(9)
    ds_read_b64_tr_b16 a[230:231], v4 offset:54656
    v_cvt_pk_bf16_f32 v117, v34, v35
    v_mfma_f32_16x16x32_bf16 v[200:203], a[208:211], v[96:99], v[200:203]
    ds_read_b64_tr_b16 a[232:233], v4 offset:37280
    v_fma_mix_f32 v36, v124, v16, v20 op_sel:[0,0,0] op_sel_hi:[1,0,0]
    v_mfma_f32_16x16x32_bf16 v[200:203], a[212:215], v[100:103], v[200:203]
    ds_read_b64_tr_b16 a[234:235], v4 offset:37792
    v_fma_mix_f32 v37, v124, v17, v21 op_sel:[1,0,0] op_sel_hi:[1,0,0]
    v_mfma_f32_16x16x32_bf16 v[232:235], a[208:211], v[104:107], v[232:235]
    ds_read_b64_tr_b16 a[236:237], v4 offset:54176
    v_fma_mix_f32 v38, v125, v18, v22 op_sel:[0,0,0] op_sel_hi:[1,0,0]
    v_mfma_f32_16x16x32_bf16 v[232:235], a[212:215], v[108:111], v[232:235]
    s_waitcnt lgkmcnt(7)
    ds_read_b64_tr_b16 a[238:239], v4 offset:54688
    v_fma_mix_f32 v39, v125, v19, v23 op_sel:[1,0,0] op_sel_hi:[1,0,0]
    v_mfma_f32_16x16x32_bf16 v[204:207], a[216:219], v[96:99], v[204:207]
    ds_read_b64_tr_b16 a[240:241], v4 offset:37312
    v_cvt_pk_bf16_f32 v124, v36, v37
    v_mfma_f32_16x16x32_bf16 v[204:207], a[220:223], v[100:103], v[204:207]
    ds_read_b64_tr_b16 a[242:243], v4 offset:37824
    v_cvt_pk_bf16_f32 v125, v38, v39
    v_mfma_f32_16x16x32_bf16 v[236:239], a[216:219], v[104:107], v[236:239]
    ds_read_b64_tr_b16 a[244:245], v4 offset:54208
    v_mfma_f32_16x16x32_bf16 v[236:239], a[220:223], v[108:111], v[236:239]
    s_waitcnt lgkmcnt(7)
    ds_read_b64_tr_b16 a[246:247], v4 offset:54720
    v_mfma_f32_16x16x32_bf16 v[208:211], a[224:227], v[96:99], v[208:211]
    ds_read_b64_tr_b16 a[248:249], v4 offset:37344
    ds_read_b128 v[16:19], v9 offset:13312
    v_mfma_f32_16x16x32_bf16 v[208:211], a[228:231], v[100:103], v[208:211]
    ds_read_b64_tr_b16 a[250:251], v4 offset:37856
    ds_read_b128 v[20:23], v9 offset:13344
    v_mfma_f32_16x16x32_bf16 v[240:243], a[224:227], v[104:107], v[240:243]
    ds_read_b64_tr_b16 a[252:253], v4 offset:54240
    v_fma_mix_f32 v32, v118, v24, v28 op_sel:[0,0,0] op_sel_hi:[1,0,0]
    v_mfma_f32_16x16x32_bf16 v[240:243], a[228:231], v[108:111], v[240:243]
    s_waitcnt vmcnt(12)
    s_barrier
    s_waitcnt lgkmcnt(9)
    ds_read_b64_tr_b16 a[254:255], v4 offset:54752
    v_fma_mix_f32 v33, v118, v25, v29 op_sel:[1,0,0] op_sel_hi:[1,0,0]
    v_fma_mix_f32 v34, v119, v26, v30 op_sel:[0,0,0] op_sel_hi:[1,0,0]
    v_mfma_f32_16x16x32_bf16 v[212:215], a[232:235], v[96:99], v[212:215]
    ds_read_b64_tr_b16 a[192:193], v3 offset:0
    v_fma_mix_f32 v35, v119, v27, v31 op_sel:[1,0,0] op_sel_hi:[1,0,0]
    v_mfma_f32_16x16x32_bf16 v[212:215], a[236:239], v[100:103], v[212:215]
    ds_read_b64_tr_b16 a[194:195], v3 offset:512
    ds_read_b64_tr_b16 a[196:197], v3 offset:16896
    v_cvt_pk_bf16_f32 v118, v32, v33
    v_mfma_f32_16x16x32_bf16 v[244:247], a[232:235], v[104:107], v[244:247]
    s_add_u32 m0, s44, 73728
    ds_read_b64_tr_b16 a[198:199], v3 offset:17408
    v_cvt_pk_bf16_f32 v119, v34, v35
    v_mfma_f32_16x16x32_bf16 v[244:247], a[236:239], v[108:111], v[244:247]
    s_mov_b32 s46, 0
    s_waitcnt lgkmcnt(10)
    buffer_load_dwordx4 v5, s[16:19], s46 offen offset:0 lds
    v_mfma_f32_16x16x32_bf16 v[216:219], a[240:243], v[96:99], v[216:219]
    ds_read_b64_tr_b16 a[200:201], v3 offset:32
    v_fma_mix_f32 v36, v126, v24, v28 op_sel:[0,0,0] op_sel_hi:[1,0,0]
    v_mfma_f32_16x16x32_bf16 v[216:219], a[244:247], v[100:103], v[216:219]
    ds_read_b64_tr_b16 a[202:203], v3 offset:544
    ds_read_b64_tr_b16 a[204:205], v3 offset:16928
    v_fma_mix_f32 v37, v126, v25, v29 op_sel:[1,0,0] op_sel_hi:[1,0,0]
    v_mfma_f32_16x16x32_bf16 v[248:251], a[240:243], v[104:107], v[248:251]
    s_add_u32 m0, s44, 73760
    ds_read_b64_tr_b16 a[206:207], v3 offset:17440
    v_fma_mix_f32 v38, v127, v26, v30 op_sel:[0,0,0] op_sel_hi:[1,0,0]
    v_mfma_f32_16x16x32_bf16 v[248:251], a[244:247], v[108:111], v[248:251]
    s_waitcnt lgkmcnt(8)
    buffer_load_dwordx4 v5, s[16:19], s46 offen offset:1024 lds
    v_mfma_f32_16x16x32_bf16 v[220:223], a[248:251], v[96:99], v[220:223]
    ds_read_b64_tr_b16 a[208:209], v3 offset:64
    v_fma_mix_f32 v39, v127, v27, v31 op_sel:[1,0,0] op_sel_hi:[1,0,0]
    v_mfma_f32_16x16x32_bf16 v[220:223], a[252:255], v[100:103], v[220:223]
    ds_read_b64_tr_b16 a[210:211], v3 offset:576
    ds_read_b64_tr_b16 a[212:213], v3 offset:16960
    v_cvt_pk_bf16_f32 v126, v36, v37
    v_mfma_f32_16x16x32_bf16 v[252:255], a[248:251], v[104:107], v[252:255]
    s_add_u32 m0, s44, 73792
    ds_read_b64_tr_b16 a[214:215], v3 offset:17472
    v_cvt_pk_bf16_f32 v127, v38, v39
    v_mfma_f32_16x16x32_bf16 v[252:255], a[252:255], v[108:111], v[252:255]
    s_waitcnt lgkmcnt(8)
    buffer_load_dwordx4 v5, s[16:19], s46 offen offset:2048 lds
    v_mfma_f32_16x16x32_bf16 v[128:131], a[192:195], v[112:115], v[128:131]
    s_waitcnt vmcnt(11)
    ds_read_b64_tr_b16 a[216:217], v3 offset:96
    ds_read_b128 v[24:27], v9 offset:13328
    v_mfma_f32_16x16x32_bf16 v[128:131], a[196:199], v[116:119], v[128:131]
    ds_read_b64_tr_b16 a[218:219], v3 offset:608
    ds_read_b64_tr_b16 a[220:221], v3 offset:16992
    v_fma_mix_f32 v32, v48, v16, v20 op_sel:[0,0,0] op_sel_hi:[1,0,0]
    v_mfma_f32_16x16x32_bf16 v[160:163], a[192:195], v[120:123], v[160:163]
    s_add_u32 m0, s44, 73824
    ds_read_b64_tr_b16 a[222:223], v3 offset:17504
    ds_read_b128 v[28:31], v9 offset:13360
    v_mfma_f32_16x16x32_bf16 v[160:163], a[196:199], v[124:127], v[160:163]
    s_waitcnt lgkmcnt(10)
    buffer_load_dwordx4 v5, s[16:19], s46 offen offset:3072 lds
    v_mfma_f32_16x16x32_bf16 v[132:135], a[200:203], v[112:115], v[132:135]
    ds_read_b64_tr_b16 a[224:225], v3 offset:128
    v_fma_mix_f32 v33, v48, v17, v21 op_sel:[1,0,0] op_sel_hi:[1,0,0]
    v_mfma_f32_16x16x32_bf16 v[132:135], a[204:207], v[116:119], v[132:135]
    ds_read_b64_tr_b16 a[226:227], v3 offset:640
    ds_read_b64_tr_b16 a[228:229], v3 offset:17024
    v_fma_mix_f32 v34, v49, v18, v22 op_sel:[0,0,0] op_sel_hi:[1,0,0]
    v_mfma_f32_16x16x32_bf16 v[164:167], a[200:203], v[120:123], v[164:167]
    s_add_u32 m0, s44, 90624
    ds_read_b64_tr_b16 a[230:231], v3 offset:17536
    v_fma_mix_f32 v35, v49, v19, v23 op_sel:[1,0,0] op_sel_hi:[1,0,0]
    v_mfma_f32_16x16x32_bf16 v[164:167], a[204:207], v[124:127], v[164:167]
    s_waitcnt lgkmcnt(10)
    buffer_load_dwordx4 v5, s[20:23], s46 offen offset:0 lds
    v_mfma_f32_16x16x32_bf16 v[136:139], a[208:211], v[112:115], v[136:139]
    ds_read_b64_tr_b16 a[232:233], v3 offset:160
    v_cvt_pk_bf16_f32 v48, v32, v33
    v_mfma_f32_16x16x32_bf16 v[136:139], a[212:215], v[116:119], v[136:139]
    ds_read_b64_tr_b16 a[234:235], v3 offset:672
    ds_read_b64_tr_b16 a[236:237], v3 offset:17056
    v_cvt_pk_bf16_f32 v49, v34, v35
    v_mfma_f32_16x16x32_bf16 v[168:171], a[208:211], v[120:123], v[168:171]
    s_add_u32 m0, s44, 90656
    ds_read_b64_tr_b16 a[238:239], v3 offset:17568
    v_fma_mix_f32 v36, v56, v16, v20 op_sel:[0,0,0] op_sel_hi:[1,0,0]
    v_mfma_f32_16x16x32_bf16 v[168:171], a[212:215], v[124:127], v[168:171]
    s_waitcnt lgkmcnt(9)
    buffer_load_dwordx4 v5, s[20:23], s46 offen offset:1024 lds
    v_fma_mix_f32 v37, v56, v17, v21 op_sel:[1,0,0] op_sel_hi:[1,0,0]
    v_mfma_f32_16x16x32_bf16 v[140:143], a[216:219], v[112:115], v[140:143]
    ds_read_b64_tr_b16 a[240:241], v3 offset:192
    v_fma_mix_f32 v38, v57, v18, v22 op_sel:[0,0,0] op_sel_hi:[1,0,0]
    v_mfma_f32_16x16x32_bf16 v[140:143], a[220:223], v[116:119], v[140:143]
    ds_read_b64_tr_b16 a[242:243], v3 offset:704
    ds_read_b64_tr_b16 a[244:245], v3 offset:17088
    v_fma_mix_f32 v39, v57, v19, v23 op_sel:[1,0,0] op_sel_hi:[1,0,0]
    v_mfma_f32_16x16x32_bf16 v[172:175], a[216:219], v[120:123], v[172:175]
    s_add_u32 m0, s44, 90688
    ds_read_b64_tr_b16 a[246:247], v3 offset:17600
    v_cvt_pk_bf16_f32 v56, v36, v37
    v_mfma_f32_16x16x32_bf16 v[172:175], a[220:223], v[124:127], v[172:175]
    s_waitcnt lgkmcnt(8)
    buffer_load_dwordx4 v5, s[20:23], s46 offen offset:2048 lds
    v_cvt_pk_bf16_f32 v57, v38, v39
    v_mfma_f32_16x16x32_bf16 v[144:147], a[224:227], v[112:115], v[144:147]
    ds_read_b64_tr_b16 a[248:249], v3 offset:224
    ds_read_b128 v[16:19], v9 offset:13568
    v_mfma_f32_16x16x32_bf16 v[144:147], a[228:231], v[116:119], v[144:147]
    ds_read_b64_tr_b16 a[250:251], v3 offset:736
    ds_read_b64_tr_b16 a[252:253], v3 offset:17120
    v_mfma_f32_16x16x32_bf16 v[176:179], a[224:227], v[120:123], v[176:179]
    s_add_u32 m0, s44, 90720
    ds_read_b64_tr_b16 a[254:255], v3 offset:17632
    ds_read_b128 v[20:23], v9 offset:13600
    v_mfma_f32_16x16x32_bf16 v[176:179], a[228:231], v[124:127], v[176:179]
    s_waitcnt lgkmcnt(10)
    buffer_load_dwordx4 v5, s[20:23], s46 offen offset:3072 lds
    v_mfma_f32_16x16x32_bf16 v[148:151], a[232:235], v[112:115], v[148:151]
    ds_read_b64_tr_b16 a[192:193], v3 offset:256
    v_fma_mix_f32 v32, v50, v24, v28 op_sel:[0,0,0] op_sel_hi:[1,0,0]
    v_mfma_f32_16x16x32_bf16 v[148:151], a[236:239], v[116:119], v[148:151]
    ds_read_b64_tr_b16 a[194:195], v3 offset:768
    v_fma_mix_f32 v33, v50, v25, v29 op_sel:[1,0,0] op_sel_hi:[1,0,0]
    v_mfma_f32_16x16x32_bf16 v[180:183], a[232:235], v[120:123], v[180:183]
    ds_read_b64_tr_b16 a[196:197], v3 offset:17152
    v_fma_mix_f32 v34, v51, v26, v30 op_sel:[0,0,0] op_sel_hi:[1,0,0]
    v_mfma_f32_16x16x32_bf16 v[180:183], a[236:239], v[124:127], v[180:183]
    s_waitcnt lgkmcnt(9)
    ds_read_b64_tr_b16 a[198:199], v3 offset:17664
    v_fma_mix_f32 v35, v51, v27, v31 op_sel:[1,0,0] op_sel_hi:[1,0,0]
    v_mfma_f32_16x16x32_bf16 v[152:155], a[240:243], v[112:115], v[152:155]
    ds_read_b64_tr_b16 a[200:201], v3 offset:288
    v_cvt_pk_bf16_f32 v50, v32, v33
    v_mfma_f32_16x16x32_bf16 v[152:155], a[244:247], v[116:119], v[152:155]
    ds_read_b64_tr_b16 a[202:203], v3 offset:800
    v_cvt_pk_bf16_f32 v51, v34, v35
    v_mfma_f32_16x16x32_bf16 v[184:187], a[240:243], v[120:123], v[184:187]
    ds_read_b64_tr_b16 a[204:205], v3 offset:17184
    v_fma_mix_f32 v36, v58, v24, v28 op_sel:[0,0,0] op_sel_hi:[1,0,0]
    v_mfma_f32_16x16x32_bf16 v[184:187], a[244:247], v[124:127], v[184:187]
    s_waitcnt lgkmcnt(8)
    ds_read_b64_tr_b16 a[206:207], v3 offset:17696
    v_fma_mix_f32 v37, v58, v25, v29 op_sel:[1,0,0] op_sel_hi:[1,0,0]
    v_mfma_f32_16x16x32_bf16 v[156:159], a[248:251], v[112:115], v[156:159]
    ds_read_b64_tr_b16 a[208:209], v3 offset:320
    v_fma_mix_f32 v38, v59, v26, v30 op_sel:[0,0,0] op_sel_hi:[1,0,0]
    v_mfma_f32_16x16x32_bf16 v[156:159], a[252:255], v[116:119], v[156:159]
    ds_read_b64_tr_b16 a[210:211], v3 offset:832
    v_fma_mix_f32 v39, v59, v27, v31 op_sel:[1,0,0] op_sel_hi:[1,0,0]
    v_mfma_f32_16x16x32_bf16 v[188:191], a[248:251], v[120:123], v[188:191]
    ds_read_b64_tr_b16 a[212:213], v3 offset:17216
    v_cvt_pk_bf16_f32 v58, v36, v37
    v_mfma_f32_16x16x32_bf16 v[188:191], a[252:255], v[124:127], v[188:191]
    s_waitcnt lgkmcnt(7)
    ds_read_b64_tr_b16 a[214:215], v3 offset:17728
    v_cvt_pk_bf16_f32 v59, v38, v39
    v_mfma_f32_16x16x32_bf16 v[192:195], a[192:195], v[112:115], v[192:195]
    ds_read_b64_tr_b16 a[216:217], v3 offset:352
    ds_read_b128 v[24:27], v9 offset:13584
    v_mfma_f32_16x16x32_bf16 v[192:195], a[196:199], v[116:119], v[192:195]
    ds_read_b64_tr_b16 a[218:219], v3 offset:864
    ds_read_b128 v[28:31], v9 offset:13616
    v_mfma_f32_16x16x32_bf16 v[224:227], a[192:195], v[120:123], v[224:227]
    ds_read_b64_tr_b16 a[220:221], v3 offset:17248
    v_fma_mix_f32 v32, v52, v16, v20 op_sel:[0,0,0] op_sel_hi:[1,0,0]
    v_mfma_f32_16x16x32_bf16 v[224:227], a[196:199], v[124:127], v[224:227]
    s_waitcnt lgkmcnt(9)
    ds_read_b64_tr_b16 a[222:223], v3 offset:17760
    v_fma_mix_f32 v33, v52, v17, v21 op_sel:[1,0,0] op_sel_hi:[1,0,0]
    v_mfma_f32_16x16x32_bf16 v[196:199], a[200:203], v[112:115], v[196:199]
    ds_read_b64_tr_b16 a[224:225], v3 offset:384
    v_fma_mix_f32 v34, v53, v18, v22 op_sel:[0,0,0] op_sel_hi:[1,0,0]
    v_mfma_f32_16x16x32_bf16 v[196:199], a[204:207], v[116:119], v[196:199]
    ds_read_b64_tr_b16 a[226:227], v3 offset:896
    v_fma_mix_f32 v35, v53, v19, v23 op_sel:[1,0,0] op_sel_hi:[1,0,0]
    v_mfma_f32_16x16x32_bf16 v[228:231], a[200:203], v[120:123], v[228:231]
    ds_read_b64_tr_b16 a[228:229], v3 offset:17280
    v_cvt_pk_bf16_f32 v52, v32, v33
    v_mfma_f32_16x16x32_bf16 v[228:231], a[204:207], v[124:127], v[228:231]
    s_waitcnt lgkmcnt(9)
    ds_read_b64_tr_b16 a[230:231], v3 offset:17792
    v_cvt_pk_bf16_f32 v53, v34, v35
    v_mfma_f32_16x16x32_bf16 v[200:203], a[208:211], v[112:115], v[200:203]
    ds_read_b64_tr_b16 a[232:233], v3 offset:416
    v_fma_mix_f32 v36, v60, v16, v20 op_sel:[0,0,0] op_sel_hi:[1,0,0]
    v_mfma_f32_16x16x32_bf16 v[200:203], a[212:215], v[116:119], v[200:203]
    ds_read_b64_tr_b16 a[234:235], v3 offset:928
    v_fma_mix_f32 v37, v60, v17, v21 op_sel:[1,0,0] op_sel_hi:[1,0,0]
    v_mfma_f32_16x16x32_bf16 v[232:235], a[208:211], v[120:123], v[232:235]
    ds_read_b64_tr_b16 a[236:237], v3 offset:17312
    v_fma_mix_f32 v38, v61, v18, v22 op_sel:[0,0,0] op_sel_hi:[1,0,0]
    v_mfma_f32_16x16x32_bf16 v[232:235], a[212:215], v[124:127], v[232:235]
    s_waitcnt lgkmcnt(7)
    ds_read_b64_tr_b16 a[238:239], v3 offset:17824
    v_fma_mix_f32 v39, v61, v19, v23 op_sel:[1,0,0] op_sel_hi:[1,0,0]
    v_mfma_f32_16x16x32_bf16 v[204:207], a[216:219], v[112:115], v[204:207]
    ds_read_b64_tr_b16 a[240:241], v3 offset:448
    v_cvt_pk_bf16_f32 v60, v36, v37
    v_mfma_f32_16x16x32_bf16 v[204:207], a[220:223], v[116:119], v[204:207]
    ds_read_b64_tr_b16 a[242:243], v3 offset:960
    v_cvt_pk_bf16_f32 v61, v38, v39
    v_mfma_f32_16x16x32_bf16 v[236:239], a[216:219], v[120:123], v[236:239]
    ds_read_b64_tr_b16 a[244:245], v3 offset:17344
    v_mfma_f32_16x16x32_bf16 v[236:239], a[220:223], v[124:127], v[236:239]
    s_waitcnt lgkmcnt(7)
    ds_read_b64_tr_b16 a[246:247], v3 offset:17856
    v_mfma_f32_16x16x32_bf16 v[208:211], a[224:227], v[112:115], v[208:211]
    ds_read_b64_tr_b16 a[248:249], v3 offset:480
    v_fma_mix_f32 v32, v54, v24, v28 op_sel:[0,0,0] op_sel_hi:[1,0,0]
    v_mfma_f32_16x16x32_bf16 v[208:211], a[228:231], v[116:119], v[208:211]
    ds_read_b64_tr_b16 a[250:251], v3 offset:992
    v_fma_mix_f32 v33, v54, v25, v29 op_sel:[1,0,0] op_sel_hi:[1,0,0]
    v_mfma_f32_16x16x32_bf16 v[240:243], a[224:227], v[120:123], v[240:243]
    ds_read_b64_tr_b16 a[252:253], v3 offset:17376
    v_fma_mix_f32 v34, v55, v26, v30 op_sel:[0,0,0] op_sel_hi:[1,0,0]
    v_mfma_f32_16x16x32_bf16 v[240:243], a[228:231], v[124:127], v[240:243]
    s_waitcnt vmcnt(8)
    s_barrier
    s_waitcnt lgkmcnt(7)
    ds_read_b64_tr_b16 a[254:255], v3 offset:17888
    v_fma_mix_f32 v35, v55, v27, v31 op_sel:[1,0,0] op_sel_hi:[1,0,0]
    v_mfma_f32_16x16x32_bf16 v[212:215], a[232:235], v[112:115], v[212:215]
    ds_read_b64_tr_b16 a[192:193], v3 offset:36864
    v_cvt_pk_bf16_f32 v54, v32, v33
    v_mfma_f32_16x16x32_bf16 v[212:215], a[236:239], v[116:119], v[212:215]
    ds_read_b64_tr_b16 a[194:195], v3 offset:37376
    ds_read_b64_tr_b16 a[196:197], v3 offset:53760
    v_mfma_f32_16x16x32_bf16 v[244:247], a[232:235], v[120:123], v[244:247]
    s_add_u32 m0, s44, 110592
    ds_read_b64_tr_b16 a[198:199], v3 offset:54272
    v_cvt_pk_bf16_f32 v55, v34, v35
    v_mfma_f32_16x16x32_bf16 v[244:247], a[236:239], v[124:127], v[244:247]
    s_mov_b32 s46, 16384
    s_waitcnt lgkmcnt(8)
    buffer_load_dwordx4 v5, s[16:19], s46 offen offset:0 lds
    v_mfma_f32_16x16x32_bf16 v[216:219], a[240:243], v[112:115], v[216:219]
    ds_read_b64_tr_b16 a[200:201], v3 offset:36896
    v_fma_mix_f32 v36, v62, v24, v28 op_sel:[0,0,0] op_sel_hi:[1,0,0]
    v_mfma_f32_16x16x32_bf16 v[216:219], a[244:247], v[116:119], v[216:219]
    ds_read_b64_tr_b16 a[202:203], v3 offset:37408
    ds_read_b64_tr_b16 a[204:205], v3 offset:53792
    v_fma_mix_f32 v37, v62, v25, v29 op_sel:[1,0,0] op_sel_hi:[1,0,0]
    v_mfma_f32_16x16x32_bf16 v[248:251], a[240:243], v[120:123], v[248:251]
    s_add_u32 m0, s44, 110624
    ds_read_b64_tr_b16 a[206:207], v3 offset:54304
    v_fma_mix_f32 v38, v63, v26, v30 op_sel:[0,0,0] op_sel_hi:[1,0,0]
    v_mfma_f32_16x16x32_bf16 v[248:251], a[244:247], v[124:127], v[248:251]
    s_waitcnt lgkmcnt(8)
    buffer_load_dwordx4 v5, s[16:19], s46 offen offset:1024 lds
    v_mfma_f32_16x16x32_bf16 v[220:223], a[248:251], v[112:115], v[220:223]
    ds_read_b64_tr_b16 a[208:209], v3 offset:36928
    v_fma_mix_f32 v39, v63, v27, v31 op_sel:[1,0,0] op_sel_hi:[1,0,0]
    v_mfma_f32_16x16x32_bf16 v[220:223], a[252:255], v[116:119], v[220:223]
    ds_read_b64_tr_b16 a[210:211], v3 offset:37440
    ds_read_b64_tr_b16 a[212:213], v3 offset:53824
    v_cvt_pk_bf16_f32 v62, v36, v37
    v_mfma_f32_16x16x32_bf16 v[252:255], a[248:251], v[120:123], v[252:255]
    s_add_u32 m0, s44, 110656
    ds_read_b64_tr_b16 a[214:215], v3 offset:54336
    v_cvt_pk_bf16_f32 v63, v38, v39
    v_mfma_f32_16x16x32_bf16 v[252:255], a[252:255], v[124:127], v[252:255]
    s_waitcnt lgkmcnt(8)
    buffer_load_dwordx4 v5, s[16:19], s46 offen offset:2048 lds
    v_mfma_f32_16x16x32_bf16 v[128:131], a[192:195], v[48:51], v[128:131]
    ds_read_b64_tr_b16 a[216:217], v3 offset:36960
    v_mfma_f32_16x16x32_bf16 v[128:131], a[196:199], v[52:55], v[128:131]
    ds_read_b64_tr_b16 a[218:219], v3 offset:37472
    ds_read_b64_tr_b16 a[220:221], v3 offset:53856
    v_mfma_f32_16x16x32_bf16 v[160:163], a[192:195], v[56:59], v[160:163]
    s_add_u32 m0, s44, 110688
    ds_read_b64_tr_b16 a[222:223], v3 offset:54368
    v_mfma_f32_16x16x32_bf16 v[160:163], a[196:199], v[60:63], v[160:163]
    s_waitcnt lgkmcnt(8)
    buffer_load_dwordx4 v5, s[16:19], s46 offen offset:3072 lds
    v_mfma_f32_16x16x32_bf16 v[132:135], a[200:203], v[48:51], v[132:135]
    ds_read_b64_tr_b16 a[224:225], v3 offset:36992
    v_mfma_f32_16x16x32_bf16 v[132:135], a[204:207], v[52:55], v[132:135]
    ds_read_b64_tr_b16 a[226:227], v3 offset:37504
    ds_read_b64_tr_b16 a[228:229], v3 offset:53888
    v_mfma_f32_16x16x32_bf16 v[164:167], a[200:203], v[56:59], v[164:167]
    s_add_u32 m0, s44, 127488
    ds_read_b64_tr_b16 a[230:231], v3 offset:54400
    v_mfma_f32_16x16x32_bf16 v[164:167], a[204:207], v[60:63], v[164:167]
    s_waitcnt lgkmcnt(8)
    buffer_load_dwordx4 v5, s[20:23], s46 offen offset:0 lds
    v_mfma_f32_16x16x32_bf16 v[136:139], a[208:211], v[48:51], v[136:139]
    ds_read_b64_tr_b16 a[232:233], v3 offset:37024
    v_mfma_f32_16x16x32_bf16 v[136:139], a[212:215], v[52:55], v[136:139]
    ds_read_b64_tr_b16 a[234:235], v3 offset:37536
    ds_read_b64_tr_b16 a[236:237], v3 offset:53920
    v_mfma_f32_16x16x32_bf16 v[168:171], a[208:211], v[56:59], v[168:171]
    s_add_u32 m0, s44, 127520
    ds_read_b64_tr_b16 a[238:239], v3 offset:54432
    v_mfma_f32_16x16x32_bf16 v[168:171], a[212:215], v[60:63], v[168:171]
    s_waitcnt lgkmcnt(8)
    buffer_load_dwordx4 v5, s[20:23], s46 offen offset:1024 lds
    v_mfma_f32_16x16x32_bf16 v[140:143], a[216:219], v[48:51], v[140:143]
    ds_read_b64_tr_b16 a[240:241], v3 offset:37056
    v_cvt_pk_bf16_f32 v64, v128, v129
    v_mfma_f32_16x16x32_bf16 v[140:143], a[220:223], v[52:55], v[140:143]
    ds_read_b64_tr_b16 a[242:243], v3 offset:37568
    ds_read_b64_tr_b16 a[244:245], v3 offset:53952
    v_mfma_f32_16x16x32_bf16 v[172:175], a[216:219], v[56:59], v[172:175]
    s_add_u32 m0, s44, 127552
    ds_read_b64_tr_b16 a[246:247], v3 offset:54464
    v_cvt_pk_bf16_f32 v65, v130, v131
    v_mfma_f32_16x16x32_bf16 v[172:175], a[220:223], v[60:63], v[172:175]
    s_waitcnt lgkmcnt(8)
    buffer_load_dwordx4 v5, s[20:23], s46 offen offset:2048 lds
    v_mfma_f32_16x16x32_bf16 v[144:147], a[224:227], v[48:51], v[144:147]
    ds_read_b64_tr_b16 a[248:249], v3 offset:37088
    v_cvt_pk_bf16_f32 v66, v132, v133
    v_mfma_f32_16x16x32_bf16 v[144:147], a[228:231], v[52:55], v[144:147]
    ds_read_b64_tr_b16 a[250:251], v3 offset:37600
    ds_read_b64_tr_b16 a[252:253], v3 offset:53984
    v_mfma_f32_16x16x32_bf16 v[176:179], a[224:227], v[56:59], v[176:179]
    s_add_u32 m0, s44, 127584
    ds_read_b64_tr_b16 a[254:255], v3 offset:54496
    v_cvt_pk_bf16_f32 v67, v134, v135
    v_mfma_f32_16x16x32_bf16 v[176:179], a[228:231], v[60:63], v[176:179]
    s_waitcnt lgkmcnt(8)
    buffer_load_dwordx4 v5, s[20:23], s46 offen offset:3072 lds
    v_mfma_f32_16x16x32_bf16 v[148:151], a[232:235], v[48:51], v[148:151]
    ds_read_b64_tr_b16 a[192:193], v3 offset:37120
    v_cvt_pk_bf16_f32 v80, v160, v161
    v_mfma_f32_16x16x32_bf16 v[148:151], a[236:239], v[52:55], v[148:151]
    ds_read_b64_tr_b16 a[194:195], v3 offset:37632
    v_cvt_pk_bf16_f32 v81, v162, v163
    v_mfma_f32_16x16x32_bf16 v[180:183], a[232:235], v[56:59], v[180:183]
    ds_read_b64_tr_b16 a[196:197], v3 offset:54016
    v_cvt_pk_bf16_f32 v82, v164, v165
    v_mfma_f32_16x16x32_bf16 v[180:183], a[236:239], v[60:63], v[180:183]
    s_waitcnt lgkmcnt(7)
    ds_read_b64_tr_b16 a[198:199], v3 offset:54528
    v_cvt_pk_bf16_f32 v83, v166, v167
    v_mfma_f32_16x16x32_bf16 v[152:155], a[240:243], v[48:51], v[152:155]
    ds_read_b64_tr_b16 a[200:201], v3 offset:37152
    v_cvt_pk_bf16_f32 v68, v136, v137
    v_mfma_f32_16x16x32_bf16 v[152:155], a[244:247], v[52:55], v[152:155]
    ds_read_b64_tr_b16 a[202:203], v3 offset:37664
    v_cvt_pk_bf16_f32 v69, v138, v139
    v_mfma_f32_16x16x32_bf16 v[184:187], a[240:243], v[56:59], v[184:187]
    ds_read_b64_tr_b16 a[204:205], v3 offset:54048
    v_cvt_pk_bf16_f32 v70, v140, v141
    v_mfma_f32_16x16x32_bf16 v[184:187], a[244:247], v[60:63], v[184:187]
    s_waitcnt lgkmcnt(7)
    ds_read_b64_tr_b16 a[206:207], v3 offset:54560
    v_cvt_pk_bf16_f32 v71, v142, v143
    v_mfma_f32_16x16x32_bf16 v[156:159], a[248:251], v[48:51], v[156:159]
    ds_read_b64_tr_b16 a[208:209], v3 offset:37184
    v_cvt_pk_bf16_f32 v84, v168, v169
    v_mfma_f32_16x16x32_bf16 v[156:159], a[252:255], v[52:55], v[156:159]
    ds_read_b64_tr_b16 a[210:211], v3 offset:37696
    v_cvt_pk_bf16_f32 v85, v170, v171
    v_mfma_f32_16x16x32_bf16 v[188:191], a[248:251], v[56:59], v[188:191]
    ds_read_b64_tr_b16 a[212:213], v3 offset:54080
    v_cvt_pk_bf16_f32 v86, v172, v173
    v_mfma_f32_16x16x32_bf16 v[188:191], a[252:255], v[60:63], v[188:191]
    s_waitcnt lgkmcnt(7)
    ds_read_b64_tr_b16 a[214:215], v3 offset:54592
    v_cvt_pk_bf16_f32 v87, v174, v175
    v_mfma_f32_16x16x32_bf16 v[192:195], a[192:195], v[48:51], v[192:195]
    ds_read_b64_tr_b16 a[216:217], v3 offset:37216
    v_cvt_pk_bf16_f32 v72, v144, v145
    v_mfma_f32_16x16x32_bf16 v[192:195], a[196:199], v[52:55], v[192:195]
    ds_read_b64_tr_b16 a[218:219], v3 offset:37728
    v_cvt_pk_bf16_f32 v73, v146, v147
    v_mfma_f32_16x16x32_bf16 v[224:227], a[192:195], v[56:59], v[224:227]
    ds_read_b64_tr_b16 a[220:221], v3 offset:54112
    v_cvt_pk_bf16_f32 v74, v148, v149
    v_mfma_f32_16x16x32_bf16 v[224:227], a[196:199], v[60:63], v[224:227]
    s_waitcnt lgkmcnt(7)
    ds_read_b64_tr_b16 a[222:223], v3 offset:54624
    v_cvt_pk_bf16_f32 v75, v150, v151
    v_mfma_f32_16x16x32_bf16 v[196:199], a[200:203], v[48:51], v[196:199]
    ds_read_b64_tr_b16 a[224:225], v3 offset:37248
    v_cvt_pk_bf16_f32 v88, v176, v177
    v_mfma_f32_16x16x32_bf16 v[196:199], a[204:207], v[52:55], v[196:199]
    ds_read_b64_tr_b16 a[226:227], v3 offset:37760
    v_cvt_pk_bf16_f32 v89, v178, v179
    v_mfma_f32_16x16x32_bf16 v[228:231], a[200:203], v[56:59], v[228:231]
    ds_read_b64_tr_b16 a[228:229], v3 offset:54144
    v_cvt_pk_bf16_f32 v90, v180, v181
    v_mfma_f32_16x16x32_bf16 v[228:231], a[204:207], v[60:63], v[228:231]
    s_waitcnt lgkmcnt(7)
    ds_read_b64_tr_b16 a[230:231], v3 offset:54656
    v_cvt_pk_bf16_f32 v91, v182, v183
    v_mfma_f32_16x16x32_bf16 v[200:203], a[208:211], v[48:51], v[200:203]
    ds_read_b64_tr_b16 a[232:233], v3 offset:37280
    v_cvt_pk_bf16_f32 v76, v152, v153
    v_mfma_f32_16x16x32_bf16 v[200:203], a[212:215], v[52:55], v[200:203]
    ds_read_b64_tr_b16 a[234:235], v3 offset:37792
    v_cvt_pk_bf16_f32 v77, v154, v155
    v_mfma_f32_16x16x32_bf16 v[232:235], a[208:211], v[56:59], v[232:235]
    ds_read_b64_tr_b16 a[236:237], v3 offset:54176
    v_cvt_pk_bf16_f32 v78, v156, v157
    v_mfma_f32_16x16x32_bf16 v[232:235], a[212:215], v[60:63], v[232:235]
    s_waitcnt lgkmcnt(7)
    ds_read_b64_tr_b16 a[238:239], v3 offset:54688
    v_cvt_pk_bf16_f32 v79, v158, v159
    v_mfma_f32_16x16x32_bf16 v[204:207], a[216:219], v[48:51], v[204:207]
    ds_read_b64_tr_b16 a[240:241], v3 offset:37312
    v_cvt_pk_bf16_f32 v92, v184, v185
    v_mfma_f32_16x16x32_bf16 v[204:207], a[220:223], v[52:55], v[204:207]
L2_pad3:
    s_cbranch_execz L2_pad7
    ds_read_b64_tr_b16 a[242:243], v3 offset:37824
    v_cvt_pk_bf16_f32 v93, v186, v187
    v_mfma_f32_16x16x32_bf16 v[236:239], a[216:219], v[56:59], v[236:239]
    ds_read_b64_tr_b16 a[244:245], v3 offset:54208
    v_cvt_pk_bf16_f32 v94, v188, v189
    v_mfma_f32_16x16x32_bf16 v[236:239], a[220:223], v[60:63], v[236:239]
    s_waitcnt lgkmcnt(7)
    ds_read_b64_tr_b16 a[246:247], v3 offset:54720
    v_cvt_pk_bf16_f32 v95, v190, v191
    v_mfma_f32_16x16x32_bf16 v[208:211], a[224:227], v[48:51], v[208:211]
    ds_read_b64_tr_b16 a[248:249], v3 offset:37344
    v_cvt_pk_bf16_f32 v96, v192, v193
    v_mfma_f32_16x16x32_bf16 v[208:211], a[228:231], v[52:55], v[208:211]
    ds_read_b64_tr_b16 a[250:251], v3 offset:37856
    v_cvt_pk_bf16_f32 v97, v194, v195
    v_mfma_f32_16x16x32_bf16 v[240:243], a[224:227], v[56:59], v[240:243]
    ds_read_b64_tr_b16 a[252:253], v3 offset:54240
    v_cvt_pk_bf16_f32 v98, v196, v197
    v_mfma_f32_16x16x32_bf16 v[240:243], a[228:231], v[60:63], v[240:243]
    s_waitcnt vmcnt(8)
    s_barrier
    s_waitcnt lgkmcnt(7)
    ds_read_b64_tr_b16 a[254:255], v3 offset:54752
    v_cvt_pk_bf16_f32 v99, v198, v199
    v_mfma_f32_16x16x32_bf16 v[212:215], a[232:235], v[48:51], v[212:215]
    ds_read_b128 a[64:67], v1 offset:0
    v_cvt_pk_bf16_f32 v112, v224, v225
    v_mfma_f32_16x16x32_bf16 v[212:215], a[236:239], v[52:55], v[212:215]
    ds_read_b128 a[68:71], v1 offset:64
    v_cvt_pk_bf16_f32 v113, v226, v227
    v_mfma_f32_16x16x32_bf16 v[244:247], a[232:235], v[56:59], v[244:247]
    s_add_u32 m0, s44, 0
    ds_read_b128 a[72:75], v1 offset:128
    v_cvt_pk_bf16_f32 v114, v228, v229
    v_mfma_f32_16x16x32_bf16 v[244:247], a[236:239], v[60:63], v[244:247]
    s_mov_b32 s46, 32768
    s_waitcnt lgkmcnt(7)
    buffer_load_dwordx4 v5, s[16:19], s46 offen offset:0 lds
    v_mfma_f32_16x16x32_bf16 v[216:219], a[240:243], v[48:51], v[216:219]
    ds_read_b128 a[76:79], v1 offset:192
    v_cvt_pk_bf16_f32 v115, v230, v231
    v_mfma_f32_16x16x32_bf16 v[216:219], a[244:247], v[52:55], v[216:219]
    ds_read_b128 a[80:83], v1 offset:256
    v_cvt_pk_bf16_f32 v100, v200, v201
    v_mfma_f32_16x16x32_bf16 v[248:251], a[240:243], v[56:59], v[248:251]
    s_add_u32 m0, s44, 32
    ds_read_b128 a[84:87], v1 offset:320
    v_cvt_pk_bf16_f32 v101, v202, v203
    v_mfma_f32_16x16x32_bf16 v[248:251], a[244:247], v[60:63], v[248:251]
    s_waitcnt lgkmcnt(6)
    buffer_load_dwordx4 v5, s[16:19], s46 offen offset:1024 lds
    v_mfma_f32_16x16x32_bf16 v[220:223], a[248:251], v[48:51], v[220:223]
    ds_read_b128 a[88:91], v1 offset:384
    v_cvt_pk_bf16_f32 v102, v204, v205
    v_mfma_f32_16x16x32_bf16 v[220:223], a[252:255], v[52:55], v[220:223]
    ds_read_b128 a[92:95], v1 offset:448
    v_cvt_pk_bf16_f32 v103, v206, v207
    v_mfma_f32_16x16x32_bf16 v[252:255], a[248:251], v[56:59], v[252:255]
    s_add_u32 m0, s44, 64
    ds_read_b128 a[96:99], v1 offset:512
    v_cvt_pk_bf16_f32 v116, v232, v233
    v_mfma_f32_16x16x32_bf16 v[252:255], a[252:255], v[60:63], v[252:255]
    buffer_load_dwordx4 v5, s[16:19], s46 offen offset:2048 lds
    s_mul_i32 s3, s96, 9216
    s_add_u32 s3, s3, 4194304
    s_add_u32 s32, s84, s3
    s_addc_u32 s33, s85, 0
    s_mov_b32 s34, 9216
    s_mov_b32 s35, 0x20000
    v_lshlrev_b32 v14, 7, v0
    s_add_u32 m0, s44, 96
    s_nop 0
    buffer_load_dwordx4 v5, s[16:19], s46 offen offset:3072 lds
    s_add_u32 m0, s44, 16896
    s_nop 0
    buffer_load_dwordx4 v5, s[20:23], s46 offen offset:0 lds
    s_add_u32 m0, s44, 16928
    s_nop 0
    buffer_load_dwordx4 v5, s[20:23], s46 offen offset:1024 lds
    s_add_u32 m0, s44, 16960
    s_nop 0
    buffer_load_dwordx4 v5, s[20:23], s46 offen offset:2048 lds
    s_add_u32 m0, s44, 16992
    s_nop 0
    buffer_load_dwordx4 v5, s[20:23], s46 offen offset:3072 lds
    buffer_load_dword a63, v14, s[36:39], 0 offen
    ds_read_b128 a[100:103], v1 offset:576
    ds_read_b128 a[104:107], v1 offset:640
    ds_read_b128 a[108:111], v1 offset:704
    ds_read_b128 a[112:115], v1 offset:768
    ds_read_b128 a[116:119], v1 offset:832
    ds_read_b128 a[120:123], v1 offset:896
    ds_read_b128 a[124:127], v1 offset:960
    ds_read_b64_tr_b16 a[128:129], v2 offset:0
    ds_read_b64_tr_b16 a[130:131], v2 offset:256
    ds_read_b64_tr_b16 a[132:133], v2 offset:512
    ds_read_b64_tr_b16 a[134:135], v2 offset:768
    ds_read_b64_tr_b16 a[136:137], v2 offset:32
    ds_read_b64_tr_b16 a[138:139], v2 offset:288
    ds_read_b64_tr_b16 a[140:141], v2 offset:544
    ds_read_b64_tr_b16 a[142:143], v2 offset:800
    ds_read_b64_tr_b16 a[144:145], v2 offset:64
    ds_read_b64_tr_b16 a[146:147], v2 offset:320
    ds_read_b64_tr_b16 a[148:149], v2 offset:576
    ds_read_b64_tr_b16 a[150:151], v2 offset:832
    ds_read_b64_tr_b16 a[152:153], v2 offset:96
    ds_read_b64_tr_b16 a[154:155], v2 offset:352
    ds_read_b64_tr_b16 a[156:157], v2 offset:608
    ds_read_b64_tr_b16 a[158:159], v2 offset:864
    ds_read_b64_tr_b16 a[160:161], v2 offset:128
    ds_read_b64_tr_b16 a[162:163], v2 offset:384
    ds_read_b64_tr_b16 a[164:165], v2 offset:640
    ds_read_b64_tr_b16 a[166:167], v2 offset:896
    ds_read_b64_tr_b16 a[168:169], v2 offset:160
    ds_read_b64_tr_b16 a[170:171], v2 offset:416
    ds_read_b64_tr_b16 a[172:173], v2 offset:672
    ds_read_b64_tr_b16 a[174:175], v2 offset:928
    ds_read_b64_tr_b16 a[176:177], v2 offset:192
    ds_read_b64_tr_b16 a[178:179], v2 offset:448
    ds_read_b64_tr_b16 a[180:181], v2 offset:704
    ds_read_b64_tr_b16 a[182:183], v2 offset:960
    ds_read_b64_tr_b16 a[184:185], v2 offset:224
    ds_read_b64_tr_b16 a[186:187], v2 offset:480
    ds_read_b64_tr_b16 a[188:189], v2 offset:736
    ds_read_b64_tr_b16 a[190:191], v2 offset:992
    v_cvt_pk_bf16_f32 v117, v234, v235
    v_cvt_pk_bf16_f32 v118, v236, v237
    v_cvt_pk_bf16_f32 v119, v238, v239
    v_cvt_pk_bf16_f32 v104, v208, v209
    v_cvt_pk_bf16_f32 v105, v210, v211
    v_cvt_pk_bf16_f32 v106, v212, v213
    v_cvt_pk_bf16_f32 v107, v214, v215
    v_cvt_pk_bf16_f32 v120, v240, v241
    v_cvt_pk_bf16_f32 v121, v242, v243
    v_cvt_pk_bf16_f32 v122, v244, v245
    v_cvt_pk_bf16_f32 v123, v246, v247
    v_cvt_pk_bf16_f32 v108, v216, v217
    v_cvt_pk_bf16_f32 v109, v218, v219
    v_cvt_pk_bf16_f32 v110, v220, v221
    v_cvt_pk_bf16_f32 v111, v222, v223
    v_cvt_pk_bf16_f32 v124, v248, v249
    v_cvt_pk_bf16_f32 v125, v250, v251
    v_cvt_pk_bf16_f32 v126, v252, v253
    v_cvt_pk_bf16_f32 v127, v254, v255
    s_nop 0
    v_permlane32_swap_b32 v64, v66
    v_permlane32_swap_b32 v65, v67
    v_permlane32_swap_b32 v80, v82
    v_permlane32_swap_b32 v81, v83
    v_permlane32_swap_b32 v68, v70
    v_permlane32_swap_b32 v69, v71
    v_permlane32_swap_b32 v84, v86
    v_permlane32_swap_b32 v85, v87
    v_permlane32_swap_b32 v72, v74
    v_permlane32_swap_b32 v73, v75
    v_permlane32_swap_b32 v88, v90
    v_permlane32_swap_b32 v89, v91
    v_permlane32_swap_b32 v76, v78
    v_permlane32_swap_b32 v77, v79
    v_permlane32_swap_b32 v92, v94
    v_permlane32_swap_b32 v93, v95
    v_permlane32_swap_b32 v96, v98
    v_permlane32_swap_b32 v97, v99
    v_permlane32_swap_b32 v112, v114
    v_permlane32_swap_b32 v113, v115
    v_permlane32_swap_b32 v100, v102
    v_permlane32_swap_b32 v101, v103
    v_permlane32_swap_b32 v116, v118
    v_permlane32_swap_b32 v117, v119
    v_permlane32_swap_b32 v104, v106
    v_permlane32_swap_b32 v105, v107
    v_permlane32_swap_b32 v120, v122
    v_permlane32_swap_b32 v121, v123
    v_permlane32_swap_b32 v108, v110
    v_permlane32_swap_b32 v109, v111
    v_permlane32_swap_b32 v124, v126
    v_permlane32_swap_b32 v125, v127
    s_waitcnt lgkmcnt(15)
    v_mfma_f32_16x16x32_bf16 v[16:19], a[64:67], v[64:67], 0
    v_mfma_f32_16x16x32_bf16 v[16:19], a[68:71], v[68:71], v[16:19]
    v_mfma_f32_16x16x32_bf16 v[16:19], a[72:75], v[72:75], v[16:19]
    v_mfma_f32_16x16x32_bf16 v[16:19], a[76:79], v[76:79], v[16:19]
    v_mfma_f32_16x16x32_bf16 v[20:23], a[64:67], v[80:83], 0
    v_mfma_f32_16x16x32_bf16 v[20:23], a[68:71], v[84:87], v[20:23]
    v_mfma_f32_16x16x32_bf16 v[20:23], a[72:75], v[88:91], v[20:23]
    v_mfma_f32_16x16x32_bf16 v[20:23], a[76:79], v[92:95], v[20:23]
    v_mfma_f32_16x16x32_bf16 v[24:27], a[64:67], v[96:99], 0
    v_mfma_f32_16x16x32_bf16 v[24:27], a[68:71], v[100:103], v[24:27]
    v_mfma_f32_16x16x32_bf16 v[24:27], a[72:75], v[104:107], v[24:27]
    v_mfma_f32_16x16x32_bf16 v[24:27], a[76:79], v[108:111], v[24:27]
    v_mfma_f32_16x16x32_bf16 v[28:31], a[64:67], v[112:115], 0
    v_mfma_f32_16x16x32_bf16 v[28:31], a[68:71], v[116:119], v[28:31]
    v_mfma_f32_16x16x32_bf16 v[28:31], a[72:75], v[120:123], v[28:31]
    v_mfma_f32_16x16x32_bf16 v[28:31], a[76:79], v[124:127], v[28:31]
    s_nop 1
    v_max3_f32 v16, v16, v17, v18
    v_max_f32 v16, v16, v19
    v_max3_f32 v20, v20, v21, v22
    v_max_f32 v20, v20, v23
    v_max3_f32 v24, v24, v25, v26
    v_max_f32 v24, v24, v27
    v_max3_f32 v28, v28, v29, v30
    v_max_f32 v28, v28, v31
    v_mov_b32 v12, v16
    v_mov_b32 v13, v20
    v_mov_b32 v14, v24
    v_mov_b32 v15, v28
    v_permlane16_swap_b32 v12, v16
    v_permlane16_swap_b32 v13, v20
    v_permlane16_swap_b32 v14, v24
    v_permlane16_swap_b32 v15, v28
    v_max_f32 v16, v16, v12
    v_max_f32 v20, v20, v13
    v_max_f32 v24, v24, v14
    v_max_f32 v28, v28, v15
    v_mov_b32 v12, v16
    v_mov_b32 v13, v20
    v_mov_b32 v14, v24
    v_mov_b32 v15, v28
    v_permlane32_swap_b32 v12, v16
    v_permlane32_swap_b32 v13, v20
    v_permlane32_swap_b32 v14, v24
    v_permlane32_swap_b32 v15, v28
    v_max_f32 v16, v16, v12
    v_max_f32 v20, v20, v13
    v_max_f32 v24, v24, v14
    v_max_f32 v28, v28, v15
    v_sub_f32 v48, 0xc2000000, v16
    v_sub_f32 v49, 0xc2000000, v16
    v_sub_f32 v50, 0xc2000000, v16
    v_sub_f32 v51, 0xc2000000, v16
    v_sub_f32 v52, 0xc2000000, v20
    v_sub_f32 v53, 0xc2000000, v20
    v_sub_f32 v54, 0xc2000000, v20
    v_sub_f32 v55, 0xc2000000, v20
    v_sub_f32 v56, 0xc2000000, v24
    v_sub_f32 v57, 0xc2000000, v24
    v_sub_f32 v58, 0xc2000000, v24
    v_sub_f32 v59, 0xc2000000, v24
    v_sub_f32 v60, 0xc2000000, v28
    v_sub_f32 v61, 0xc2000000, v28
    v_sub_f32 v62, 0xc2000000, v28
    v_sub_f32 v63, 0xc2000000, v28
L2_entry:
    v_accvgpr_write_b32 a0, 0
    v_accvgpr_write_b32 a1, 0
    v_accvgpr_write_b32 a2, 0
    v_accvgpr_write_b32 a3, 0
    v_accvgpr_write_b32 a4, 0
    v_accvgpr_write_b32 a5, 0
    v_accvgpr_write_b32 a6, 0
    v_accvgpr_write_b32 a7, 0
    v_accvgpr_write_b32 a8, 0
    v_accvgpr_write_b32 a9, 0
    v_accvgpr_write_b32 a10, 0
    v_accvgpr_write_b32 a11, 0
    v_accvgpr_write_b32 a12, 0
    v_accvgpr_write_b32 a13, 0
    v_accvgpr_write_b32 a14, 0
    v_accvgpr_write_b32 a15, 0
    v_mov_b32 v224, 0
    v_mov_b32 v225, 0
    v_mov_b32 v226, 0
    v_mov_b32 v227, 0
    v_mov_b32 v228, 0
    v_mov_b32 v229, 0
    v_mov_b32 v230, 0
    v_mov_b32 v231, 0
    v_mov_b32 v232, 0
    v_mov_b32 v233, 0
    v_mov_b32 v234, 0
    v_mov_b32 v235, 0
    v_mov_b32 v236, 0
    v_mov_b32 v237, 0
    v_mov_b32 v238, 0
    v_mov_b32 v239, 0
    v_mov_b32 v240, 0
    v_mov_b32 v241, 0
    v_mov_b32 v242, 0
    v_mov_b32 v243, 0
    v_mov_b32 v244, 0
    v_mov_b32 v245, 0
    v_mov_b32 v246, 0
    v_mov_b32 v247, 0
    v_mov_b32 v248, 0
    v_mov_b32 v249, 0
    v_mov_b32 v250, 0
    v_mov_b32 v251, 0
    v_mov_b32 v252, 0
    v_mov_b32 v253, 0
    v_mov_b32 v254, 0
    v_mov_b32 v255, 0
    s_mov_b32 s47, s44
    s_mov_b32 s48, -73728
    s_mov_b32 s49, 12
    s_mov_b32 s46, 49152
    v_lshrrev_b32 v14, 2, v0
    s_mul_i32 s3, s51, 144
    v_add_u32 v14, s3, v14
    v_mul_u32_u24 v14, 9216, v14
    v_and_b32 v15, 3, v0
    v_lshl_add_u32 v6, v15, 4, v14
    s_lshr_b32 s3, s2, 3
    s_lshl_b32 s3, s3, 2
    s_add_u32 s3, s3, s51
    s_and_b32 s15, s2, 7
    s_lshl_b32 s14, s3, 7
    v_lshl_add_u32 v9, v0, 14, s14
    v_min_u32 v9, L2_codeend-L2_begin-8, v9
    s_mul_i32 s14, s3, 9
    s_lshr_b32 s14, s14, 1
    v_min_u32 v15, 44, v0
    v_mul_u32_u24 v12, 7282, v15
    v_lshrrev_b32 v12, 16, v12
    v_mul_u32_u24 v13, 63, v12
    v_add_u32 v12, v15, v13
    s_mul_i32 s14, s14, 72
    s_mul_i32 s56, s15, 9
    s_add_u32 s14, s14, s56
    v_add_u32 v12, s14, v12
    v_lshlrev_b32 v12, 7, v12
    s_mul_i32 s14, s3, 81
    s_lshr_b32 s14, s14, 1
    s_mul_i32 s56, s15, 5184
    s_add_u32 s14, s14, s56
    v_min_u32 v13, 40, v0
    v_add_u32 v13, s14, v13
    v_lshlrev_b32 v13, 7, v13
    s_mul_i32 s14, s3, 72
    s_andn2_b32 s56, s52, 3
    s_mul_i32 s56, s56, 2304
    s_add_u32 s14, s14, s56
    v_min_u32 v14, 35, v0
    v_add_u32 v14, s14, v14
    v_lshlrev_b32 v14, 7, v14
    v_add_u32 v15, 4608, v14
    s_waitcnt vmcnt(9) lgkmcnt(0)
    s_barrier
    v_mfma_f32_16x16x32_bf16 v[16:19], a[64:67], v[64:67], v[48:51]
    v_mfma_f32_16x16x32_bf16 v[16:19], a[68:71], v[68:71], v[16:19]
    v_mfma_f32_16x16x32_bf16 v[16:19], a[72:75], v[72:75], v[16:19]
    s_add_u32 m0, s47, 36864
    v_mfma_f32_16x16x32_bf16 v[16:19], a[76:79], v[76:79], v[16:19]
    buffer_load_dwordx4 v5, s[16:19], s46 offen offset:0 lds
    v_mfma_f32_16x16x32_bf16 v[20:23], a[80:83], v[64:67], v[48:51]
    v_mfma_f32_16x16x32_bf16 v[20:23], a[84:87], v[68:71], v[20:23]
    v_mfma_f32_16x16x32_bf16 v[20:23], a[88:91], v[72:75], v[20:23]
    s_add_u32 m0, s47, 36896
    v_mfma_f32_16x16x32_bf16 v[20:23], a[92:95], v[76:79], v[20:23]
    buffer_load_dwordx4 v5, s[16:19], s46 offen offset:1024 lds
    v_mfma_f32_16x16x32_bf16 v[24:27], a[96:99], v[64:67], v[48:51]
    s_nop 1
    v_exp_f32 v16, v16
    v_mfma_f32_16x16x32_bf16 v[24:27], a[100:103], v[68:71], v[24:27]
    v_mfma_f32_16x16x32_bf16 v[24:27], a[104:107], v[72:75], v[24:27]
    s_add_u32 m0, s47, 36928
    v_exp_f32 v17, v17
    v_mfma_f32_16x16x32_bf16 v[24:27], a[108:111], v[76:79], v[24:27]
    buffer_load_dwordx4 v5, s[16:19], s46 offen offset:2048 lds
    v_mfma_f32_16x16x32_bf16 v[28:31], a[112:115], v[64:67], v[48:51]
    v_exp_f32 v18, v18
    v_mfma_f32_16x16x32_bf16 v[28:31], a[116:119], v[68:71], v[28:31]
    v_cvt_pk_bf16_f32 v32, v16, v17
    v_mfma_f32_16x16x32_bf16 v[28:31], a[120:123], v[72:75], v[28:31]
    s_add_u32 m0, s47, 36960
    v_exp_f32 v19, v19
    v_mfma_f32_16x16x32_bf16 v[28:31], a[124:127], v[76:79], v[28:31]
    buffer_load_dwordx4 v5, s[16:19], s46 offen offset:3072 lds
    s_nop 3
    v_exp_f32 v20, v20
    s_nop 0
    ds_read_b64_tr_b16 a[192:193], v2 offset:36864
    v_cvt_pk_bf16_f32 v33, v18, v19
    s_add_u32 m0, s47, 53760
    v_exp_f32 v21, v21
    s_nop 0
    buffer_load_dwordx4 v5, s[20:23], s46 offen offset:0 lds
    v_exp_f32 v22, v22
    s_nop 0
    ds_read_b64_tr_b16 a[194:195], v2 offset:37120
    v_cvt_pk_bf16_f32 v34, v20, v21
    s_add_u32 m0, s47, 53792
    v_exp_f32 v23, v23
    s_nop 0
    buffer_load_dwordx4 v5, s[20:23], s46 offen offset:1024 lds
    v_exp_f32 v24, v24
    s_nop 0
    ds_read_b64_tr_b16 a[196:197], v2 offset:37376
    v_cvt_pk_bf16_f32 v35, v22, v23
    s_add_u32 m0, s47, 53824
    v_exp_f32 v25, v25
    s_nop 0
    buffer_load_dwordx4 v5, s[20:23], s46 offen offset:2048 lds
    v_exp_f32 v26, v26
    s_nop 0
    ds_read_b64_tr_b16 a[198:199], v2 offset:37632
    v_cvt_pk_bf16_f32 v36, v24, v25
    s_add_u32 m0, s47, 53856
    v_exp_f32 v27, v27
    s_nop 0
    buffer_load_dwordx4 v5, s[20:23], s46 offen offset:3072 lds
    ds_read_b64_tr_b16 a[200:201], v2 offset:36896
    s_nop 0
    v_mfma_f32_16x16x32_bf16 v[16:19], a[64:67], v[80:83], v[52:55]
    v_exp_f32 v28, v28
    v_mfma_f32_16x16x32_bf16 v[16:19], a[68:71], v[84:87], v[16:19]
    ds_read_b64_tr_b16 a[202:203], v2 offset:37152
    v_cvt_pk_bf16_f32 v37, v26, v27
    v_mfma_f32_16x16x32_bf16 v[16:19], a[72:75], v[88:91], v[16:19]
    v_exp_f32 v29, v29
    v_mfma_f32_16x16x32_bf16 v[16:19], a[76:79], v[92:95], v[16:19]
    ds_read_b64_tr_b16 a[204:205], v2 offset:37408
    v_mfma_f32_16x16x32_bf16 v[20:23], a[80:83], v[80:83], v[52:55]
    v_exp_f32 v30, v30
    v_mfma_f32_16x16x32_bf16 v[20:23], a[84:87], v[84:87], v[20:23]
    ds_read_b64_tr_b16 a[206:207], v2 offset:37664
    v_cvt_pk_bf16_f32 v38, v28, v29
    v_mfma_f32_16x16x32_bf16 v[20:23], a[88:91], v[88:91], v[20:23]
    v_exp_f32 v31, v31
    v_mfma_f32_16x16x32_bf16 v[20:23], a[92:95], v[92:95], v[20:23]
    ds_read_b64_tr_b16 a[208:209], v2 offset:36928
    v_mfma_f32_16x16x32_bf16 v[24:27], a[96:99], v[80:83], v[52:55]
    v_exp_f32 v16, v16
    v_mfma_f32_16x16x32_bf16 v[24:27], a[100:103], v[84:87], v[24:27]
    ds_read_b64_tr_b16 a[210:211], v2 offset:37184
    v_cvt_pk_bf16_f32 v39, v30, v31
    v_mfma_f32_16x16x32_bf16 v[24:27], a[104:107], v[88:91], v[24:27]
    v_exp_f32 v17, v17
    v_mfma_f32_16x16x32_bf16 v[24:27], a[108:111], v[92:95], v[24:27]
    ds_read_b64_tr_b16 a[212:213], v2 offset:37440
    v_mfma_f32_16x16x32_bf16 v[28:31], a[112:115], v[80:83], v[52:55]
    v_exp_f32 v18, v18
    v_mfma_f32_16x16x32_bf16 v[28:31], a[116:119], v[84:87], v[28:31]
    ds_read_b64_tr_b16 a[214:215], v2 offset:37696
    v_cvt_pk_bf16_f32 v40, v16, v17
    v_mfma_f32_16x16x32_bf16 v[28:31], a[120:123], v[88:91], v[28:31]
    v_exp_f32 v19, v19
    v_mfma_f32_16x16x32_bf16 v[28:31], a[124:127], v[92:95], v[28:31]
    ds_read_b64_tr_b16 a[216:217], v2 offset:36960
    v_mfma_f32_16x16x32_bf16 v[128:131], a[128:131], v[32:35], 0
    v_exp_f32 v20, v20
    v_mfma_f32_16x16x32_bf16 v[128:131], a[132:135], v[36:39], v[128:131]
    ds_read_b64_tr_b16 a[218:219], v2 offset:37216
    v_cvt_pk_bf16_f32 v41, v18, v19
    v_mfma_f32_16x16x32_bf16 v[132:135], a[136:139], v[32:35], 0
    v_exp_f32 v21, v21
    v_mfma_f32_16x16x32_bf16 v[132:135], a[140:143], v[36:39], v[132:135]
    ds_read_b64_tr_b16 a[220:221], v2 offset:37472
    v_mfma_f32_16x16x32_bf16 v[136:139], a[144:147], v[32:35], 0
    v_exp_f32 v22, v22
    v_mfma_f32_16x16x32_bf16 v[136:139], a[148:151], v[36:39], v[136:139]
    ds_read_b64_tr_b16 a[222:223], v2 offset:37728
    v_cvt_pk_bf16_f32 v42, v20, v21
    v_mfma_f32_16x16x32_bf16 v[140:143], a[152:155], v[32:35], 0
    v_exp_f32 v23, v23
    v_mfma_f32_16x16x32_bf16 v[140:143], a[156:159], v[36:39], v[140:143]
    ds_read_b64_tr_b16 a[224:225], v2 offset:36992
    v_mfma_f32_16x16x32_bf16 v[144:147], a[160:163], v[32:35], 0
    v_exp_f32 v24, v24
    v_mfma_f32_16x16x32_bf16 v[144:147], a[164:167], v[36:39], v[144:147]
    ds_read_b64_tr_b16 a[226:227], v2 offset:37248
    v_cvt_pk_bf16_f32 v43, v22, v23
    v_mfma_f32_16x16x32_bf16 v[148:151], a[168:171], v[32:35], 0
    v_exp_f32 v25, v25
    v_mfma_f32_16x16x32_bf16 v[148:151], a[172:175], v[36:39], v[148:151]
    ds_read_b64_tr_b16 a[228:229], v2 offset:37504
    v_mfma_f32_16x16x32_bf16 v[152:155], a[176:179], v[32:35], 0
    v_exp_f32 v26, v26
    v_mfma_f32_16x16x32_bf16 v[152:155], a[180:183], v[36:39], v[152:155]
    ds_read_b64_tr_b16 a[230:231], v2 offset:37760
    v_cvt_pk_bf16_f32 v44, v24, v25
    v_mfma_f32_16x16x32_bf16 v[156:159], a[184:187], v[32:35], 0
    v_exp_f32 v27, v27
    v_mfma_f32_16x16x32_bf16 v[156:159], a[188:191], v[36:39], v[156:159]
    ds_read_b64_tr_b16 a[232:233], v2 offset:37024
    v_smfmac_f32_16x16x64_bf16 a[0:3], a[16:19], v[32:39], v11
    ds_read_b64_tr_b16 a[234:235], v2 offset:37280
    v_mfma_f32_16x16x32_bf16 v[16:19], a[64:67], v[96:99], v[56:59]
    v_exp_f32 v28, v28
    v_mfma_f32_16x16x32_bf16 v[16:19], a[68:71], v[100:103], v[16:19]
    ds_read_b64_tr_b16 a[236:237], v2 offset:37536
    v_cvt_pk_bf16_f32 v45, v26, v27
    v_mfma_f32_16x16x32_bf16 v[16:19], a[72:75], v[104:107], v[16:19]
    v_exp_f32 v29, v29
    v_mfma_f32_16x16x32_bf16 v[16:19], a[76:79], v[108:111], v[16:19]
    ds_read_b64_tr_b16 a[238:239], v2 offset:37792
    v_mfma_f32_16x16x32_bf16 v[20:23], a[80:83], v[96:99], v[56:59]
    v_exp_f32 v30, v30
    v_mfma_f32_16x16x32_bf16 v[20:23], a[84:87], v[100:103], v[20:23]
    ds_read_b64_tr_b16 a[240:241], v2 offset:37056
    v_cvt_pk_bf16_f32 v46, v28, v29
    v_mfma_f32_16x16x32_bf16 v[20:23], a[88:91], v[104:107], v[20:23]
    v_exp_f32 v31, v31
    v_mfma_f32_16x16x32_bf16 v[20:23], a[92:95], v[108:111], v[20:23]
    ds_read_b64_tr_b16 a[242:243], v2 offset:37312
    v_mfma_f32_16x16x32_bf16 v[24:27], a[96:99], v[96:99], v[56:59]
    v_exp_f32 v16, v16
    v_mfma_f32_16x16x32_bf16 v[24:27], a[100:103], v[100:103], v[24:27]
    ds_read_b64_tr_b16 a[244:245], v2 offset:37568
    v_cvt_pk_bf16_f32 v47, v30, v31
    v_mfma_f32_16x16x32_bf16 v[24:27], a[104:107], v[104:107], v[24:27]
    v_exp_f32 v17, v17
    v_mfma_f32_16x16x32_bf16 v[24:27], a[108:111], v[108:111], v[24:27]
    ds_read_b64_tr_b16 a[246:247], v2 offset:37824
    v_mfma_f32_16x16x32_bf16 v[28:31], a[112:115], v[96:99], v[56:59]
    v_exp_f32 v18, v18
    v_mfma_f32_16x16x32_bf16 v[28:31], a[116:119], v[100:103], v[28:31]
    ds_read_b64_tr_b16 a[248:249], v2 offset:37088
    v_cvt_pk_bf16_f32 v32, v16, v17
    v_mfma_f32_16x16x32_bf16 v[28:31], a[120:123], v[104:107], v[28:31]
    v_exp_f32 v19, v19
    v_mfma_f32_16x16x32_bf16 v[28:31], a[124:127], v[108:111], v[28:31]
    ds_read_b64_tr_b16 a[250:251], v2 offset:37344
    v_mfma_f32_16x16x32_bf16 v[160:163], a[128:131], v[40:43], 0
    v_exp_f32 v20, v20
    v_mfma_f32_16x16x32_bf16 v[160:163], a[132:135], v[44:47], v[160:163]
    ds_read_b64_tr_b16 a[252:253], v2 offset:37600
    v_cvt_pk_bf16_f32 v33, v18, v19
    v_mfma_f32_16x16x32_bf16 v[164:167], a[136:139], v[40:43], 0
    v_exp_f32 v21, v21
    v_mfma_f32_16x16x32_bf16 v[164:167], a[140:143], v[44:47], v[164:167]
    ds_read_b64_tr_b16 a[254:255], v2 offset:37856
    v_mfma_f32_16x16x32_bf16 v[168:171], a[144:147], v[40:43], 0
    v_exp_f32 v22, v22
    v_mfma_f32_16x16x32_bf16 v[168:171], a[148:151], v[44:47], v[168:171]
    v_cvt_pk_bf16_f32 v34, v20, v21
    v_mfma_f32_16x16x32_bf16 v[172:175], a[152:155], v[40:43], 0
    v_exp_f32 v23, v23
    v_mfma_f32_16x16x32_bf16 v[172:175], a[156:159], v[44:47], v[172:175]
    v_mfma_f32_16x16x32_bf16 v[176:179], a[160:163], v[40:43], 0
    v_exp_f32 v24, v24
    v_mfma_f32_16x16x32_bf16 v[176:179], a[164:167], v[44:47], v[176:179]
    v_cvt_pk_bf16_f32 v35, v22, v23
    v_mfma_f32_16x16x32_bf16 v[180:183], a[168:171], v[40:43], 0
    v_exp_f32 v25, v25
    v_mfma_f32_16x16x32_bf16 v[180:183], a[172:175], v[44:47], v[180:183]
    v_mfma_f32_16x16x32_bf16 v[184:187], a[176:179], v[40:43], 0
    v_exp_f32 v26, v26
    v_mfma_f32_16x16x32_bf16 v[184:187], a[180:183], v[44:47], v[184:187]
    v_cvt_pk_bf16_f32 v36, v24, v25
    v_mfma_f32_16x16x32_bf16 v[188:191], a[184:187], v[40:43], 0
    v_exp_f32 v27, v27
    v_mfma_f32_16x16x32_bf16 v[188:191], a[188:191], v[44:47], v[188:191]
    v_smfmac_f32_16x16x64_bf16 a[4:7], a[16:19], v[40:47], v11
    v_mfma_f32_16x16x32_bf16 v[16:19], a[64:67], v[112:115], v[60:63]
    v_exp_f32 v28, v28
    v_mfma_f32_16x16x32_bf16 v[16:19], a[68:71], v[116:119], v[16:19]
    s_add_u32 s46, s46, 16384
    ds_read_b128 a[64:67], v1 offset:36864
    v_cvt_pk_bf16_f32 v37, v26, v27
    v_mfma_f32_16x16x32_bf16 v[16:19], a[72:75], v[120:123], v[16:19]
    v_exp_f32 v29, v29
    v_mfma_f32_16x16x32_bf16 v[16:19], a[76:79], v[124:127], v[16:19]
    ds_read_b128 a[68:71], v1 offset:36928
    v_mfma_f32_16x16x32_bf16 v[20:23], a[80:83], v[112:115], v[60:63]
    v_exp_f32 v30, v30
    v_mfma_f32_16x16x32_bf16 v[20:23], a[84:87], v[116:119], v[20:23]
    ds_read_b128 a[72:75], v1 offset:36992
    v_cvt_pk_bf16_f32 v38, v28, v29
    v_mfma_f32_16x16x32_bf16 v[20:23], a[88:91], v[120:123], v[20:23]
    v_exp_f32 v31, v31
    v_mfma_f32_16x16x32_bf16 v[20:23], a[92:95], v[124:127], v[20:23]
    ds_read_b128 a[76:79], v1 offset:37056
    v_mfma_f32_16x16x32_bf16 v[24:27], a[96:99], v[112:115], v[60:63]
    v_exp_f32 v16, v16
    v_mfma_f32_16x16x32_bf16 v[24:27], a[100:103], v[116:119], v[24:27]
    ds_read_b128 a[80:83], v1 offset:37120
    v_cvt_pk_bf16_f32 v39, v30, v31
    v_mfma_f32_16x16x32_bf16 v[24:27], a[104:107], v[120:123], v[24:27]
    v_exp_f32 v17, v17
    v_mfma_f32_16x16x32_bf16 v[24:27], a[108:111], v[124:127], v[24:27]
    ds_read_b128 a[84:87], v1 offset:37184
    v_mfma_f32_16x16x32_bf16 v[28:31], a[112:115], v[112:115], v[60:63]
    v_exp_f32 v18, v18
    v_mfma_f32_16x16x32_bf16 v[28:31], a[116:119], v[116:119], v[28:31]
    ds_read_b128 a[88:91], v1 offset:37248
    v_cvt_pk_bf16_f32 v40, v16, v17
    v_mfma_f32_16x16x32_bf16 v[28:31], a[120:123], v[120:123], v[28:31]
    v_exp_f32 v19, v19
    v_mfma_f32_16x16x32_bf16 v[28:31], a[124:127], v[124:127], v[28:31]
    ds_read_b128 a[92:95], v1 offset:37312
    v_mfma_f32_16x16x32_bf16 v[192:195], a[128:131], v[32:35], 0
    v_exp_f32 v20, v20
    v_mfma_f32_16x16x32_bf16 v[192:195], a[132:135], v[36:39], v[192:195]
    ds_read_b128 a[96:99], v1 offset:37376
    v_cvt_pk_bf16_f32 v41, v18, v19
    v_mfma_f32_16x16x32_bf16 v[196:199], a[136:139], v[32:35], 0
    v_exp_f32 v21, v21
    v_mfma_f32_16x16x32_bf16 v[196:199], a[140:143], v[36:39], v[196:199]
    ds_read_b128 a[100:103], v1 offset:37440
    v_mfma_f32_16x16x32_bf16 v[200:203], a[144:147], v[32:35], 0
    v_exp_f32 v22, v22
    v_mfma_f32_16x16x32_bf16 v[200:203], a[148:151], v[36:39], v[200:203]
    ds_read_b128 a[104:107], v1 offset:37504
    v_cvt_pk_bf16_f32 v42, v20, v21
    v_mfma_f32_16x16x32_bf16 v[204:207], a[152:155], v[32:35], 0
    v_exp_f32 v23, v23
    v_mfma_f32_16x16x32_bf16 v[204:207], a[156:159], v[36:39], v[204:207]
    ds_read_b128 a[108:111], v1 offset:37568
    v_mfma_f32_16x16x32_bf16 v[208:211], a[160:163], v[32:35], 0
    v_exp_f32 v24, v24
    v_mfma_f32_16x16x32_bf16 v[208:211], a[164:167], v[36:39], v[208:211]
    ds_read_b128 a[112:115], v1 offset:37632
    v_cvt_pk_bf16_f32 v43, v22, v23
    v_mfma_f32_16x16x32_bf16 v[212:215], a[168:171], v[32:35], 0
    v_exp_f32 v25, v25
    v_mfma_f32_16x16x32_bf16 v[212:215], a[172:175], v[36:39], v[212:215]
    ds_read_b128 a[116:119], v1 offset:37696
    v_mfma_f32_16x16x32_bf16 v[216:219], a[176:179], v[32:35], 0
    v_exp_f32 v26, v26
    v_mfma_f32_16x16x32_bf16 v[216:219], a[180:183], v[36:39], v[216:219]
    ds_read_b128 a[120:123], v1 offset:37760
    v_cvt_pk_bf16_f32 v44, v24, v25
    v_mfma_f32_16x16x32_bf16 v[220:223], a[184:187], v[32:35], 0
    v_exp_f32 v27, v27
    v_mfma_f32_16x16x32_bf16 v[220:223], a[188:191], v[36:39], v[220:223]
    ds_read_b128 a[124:127], v1 offset:37824
    v_smfmac_f32_16x16x64_bf16 a[8:11], a[16:19], v[32:39], v11
    s_waitcnt vmcnt(9) lgkmcnt(12)
    s_barrier
.p2align 5
L2_loop:
    v_mfma_f32_16x16x32_bf16 v[16:19], a[64:67], v[64:67], v[48:51]
    s_sub_u32 s47, s47, s48
    v_exp_f32 v28, v28
    v_mfma_f32_16x16x32_bf16 v[16:19], a[68:71], v[68:71], v[16:19]
L2_pad4:
    s_cbranch_execz L2_pad8
    v_cvt_pk_bf16_f32 v45, v26, v27
    v_add_u32 v1, s48, v1
    v_mfma_f32_16x16x32_bf16 v[16:19], a[72:75], v[72:75], v[16:19]
    s_add_u32 m0, s47, 0
    v_exp_f32 v29, v29
    v_mfma_f32_16x16x32_bf16 v[16:19], a[76:79], v[76:79], v[16:19]
    s_waitcnt lgkmcnt(8)
    buffer_load_dwordx4 v5, s[16:19], s46 offen offset:0 lds
    v_mfma_f32_16x16x32_bf16 v[20:23], a[80:83], v[64:67], v[48:51]
    v_exp_f32 v30, v30
    v_mfma_f32_16x16x32_bf16 v[20:23], a[84:87], v[68:71], v[20:23]
    v_cvt_pk_bf16_f32 v46, v28, v29
    v_add_u32 v2, s48, v2
    v_mfma_f32_16x16x32_bf16 v[20:23], a[88:91], v[72:75], v[20:23]
    s_add_u32 m0, s47, 32
    v_exp_f32 v31, v31
    v_mfma_f32_16x16x32_bf16 v[20:23], a[92:95], v[76:79], v[20:23]
    s_waitcnt lgkmcnt(4)
    buffer_load_dwordx4 v5, s[16:19], s46 offen offset:1024 lds
    v_mfma_f32_16x16x32_bf16 v[24:27], a[96:99], v[64:67], v[48:51]
    s_sub_u32 s48, 0, s48
    v_exp_f32 v16, v16
    v_mfma_f32_16x16x32_bf16 v[24:27], a[100:103], v[68:71], v[24:27]
    v_cvt_pk_bf16_f32 v47, v30, v31
    v_mfma_f32_16x16x32_bf16 v[24:27], a[104:107], v[72:75], v[24:27]
    s_add_u32 m0, s47, 64
    v_exp_f32 v17, v17
    v_mfma_f32_16x16x32_bf16 v[24:27], a[108:111], v[76:79], v[24:27]
    s_waitcnt lgkmcnt(0)
    buffer_load_dwordx4 v5, s[16:19], s46 offen offset:2048 lds
    v_mfma_f32_16x16x32_bf16 v[28:31], a[112:115], v[64:67], v[48:51]
    v_exp_f32 v18, v18
    v_mfma_f32_16x16x32_bf16 v[28:31], a[116:119], v[68:71], v[28:31]
    v_cvt_pk_bf16_f32 v32, v16, v17
    v_mfma_f32_16x16x32_bf16 v[28:31], a[120:123], v[72:75], v[28:31]
    s_add_u32 m0, s47, 96
    v_exp_f32 v19, v19
    v_mfma_f32_16x16x32_bf16 v[28:31], a[124:127], v[76:79], v[28:31]
    buffer_load_dwordx4 v5, s[16:19], s46 offen offset:3072 lds
    v_mfma_f32_16x16x32_bf16 v[224:227], a[128:131], v[40:43], v[224:227]
    v_exp_f32 v20, v20
    v_mfma_f32_16x16x32_bf16 v[224:227], a[132:135], v[44:47], v[224:227]
    ds_read_b64_tr_b16 a[128:129], v2 offset:0
    v_cvt_pk_bf16_f32 v33, v18, v19
    v_mfma_f32_16x16x32_bf16 v[228:231], a[136:139], v[40:43], v[228:231]
    s_add_u32 m0, s47, 16896
    v_exp_f32 v21, v21
    v_mfma_f32_16x16x32_bf16 v[228:231], a[140:143], v[44:47], v[228:231]
    buffer_load_dwordx4 v5, s[20:23], s46 offen offset:0 lds
    v_mfma_f32_16x16x32_bf16 v[232:235], a[144:147], v[40:43], v[232:235]
    v_exp_f32 v22, v22
    v_mfma_f32_16x16x32_bf16 v[232:235], a[148:151], v[44:47], v[232:235]
    ds_read_b64_tr_b16 a[130:131], v2 offset:256
    v_cvt_pk_bf16_f32 v34, v20, v21
    v_mfma_f32_16x16x32_bf16 v[236:239], a[152:155], v[40:43], v[236:239]
    s_add_u32 m0, s47, 16928
    v_exp_f32 v23, v23
    v_mfma_f32_16x16x32_bf16 v[236:239], a[156:159], v[44:47], v[236:239]
    buffer_load_dwordx4 v5, s[20:23], s46 offen offset:1024 lds
    v_mfma_f32_16x16x32_bf16 v[240:243], a[160:163], v[40:43], v[240:243]
    v_exp_f32 v24, v24
    v_mfma_f32_16x16x32_bf16 v[240:243], a[164:167], v[44:47], v[240:243]
    ds_read_b64_tr_b16 a[132:133], v2 offset:512
    v_cvt_pk_bf16_f32 v35, v22, v23
    v_mfma_f32_16x16x32_bf16 v[244:247], a[168:171], v[40:43], v[244:247]
    s_add_u32 m0, s47, 16960
    v_exp_f32 v25, v25
    v_mfma_f32_16x16x32_bf16 v[244:247], a[172:175], v[44:47], v[244:247]
    buffer_load_dwordx4 v5, s[20:23], s46 offen offset:2048 lds
    v_mfma_f32_16x16x32_bf16 v[248:251], a[176:179], v[40:43], v[248:251]
    v_exp_f32 v26, v26
    v_mfma_f32_16x16x32_bf16 v[248:251], a[180:183], v[44:47], v[248:251]
    ds_read_b64_tr_b16 a[134:135], v2 offset:768
    v_cvt_pk_bf16_f32 v36, v24, v25
    v_mfma_f32_16x16x32_bf16 v[252:255], a[184:187], v[40:43], v[252:255]
    s_add_u32 m0, s47, 16992
    v_exp_f32 v27, v27
    v_mfma_f32_16x16x32_bf16 v[252:255], a[188:191], v[44:47], v[252:255]
    buffer_load_dwordx4 v5, s[20:23], s46 offen offset:3072 lds
    v_smfmac_f32_16x16x64_bf16 a[12:15], a[16:19], v[40:47], v11
    ds_read_b64_tr_b16 a[136:137], v2 offset:32
    v_mfma_f32_16x16x32_bf16 v[16:19], a[64:67], v[80:83], v[52:55]
    v_exp_f32 v28, v28
    v_mfma_f32_16x16x32_bf16 v[16:19], a[68:71], v[84:87], v[16:19]
    ds_read_b64_tr_b16 a[138:139], v2 offset:288
    v_cvt_pk_bf16_f32 v37, v26, v27
    v_mfma_f32_16x16x32_bf16 v[16:19], a[72:75], v[88:91], v[16:19]
    v_exp_f32 v29, v29
    v_mfma_f32_16x16x32_bf16 v[16:19], a[76:79], v[92:95], v[16:19]
    global_load_dword a63, v9, s[98:99]
    v_mfma_f32_16x16x32_bf16 v[20:23], a[80:83], v[80:83], v[52:55]
    v_exp_f32 v30, v30
    v_mfma_f32_16x16x32_bf16 v[20:23], a[84:87], v[84:87], v[20:23]
    ds_read_b64_tr_b16 a[140:141], v2 offset:544
    v_cvt_pk_bf16_f32 v38, v28, v29
    v_mfma_f32_16x16x32_bf16 v[20:23], a[88:91], v[88:91], v[20:23]
    v_exp_f32 v31, v31
    v_mfma_f32_16x16x32_bf16 v[20:23], a[92:95], v[92:95], v[20:23]
    ds_read_b64_tr_b16 a[142:143], v2 offset:800
    v_mfma_f32_16x16x32_bf16 v[24:27], a[96:99], v[80:83], v[52:55]
    v_exp_f32 v16, v16
    v_mfma_f32_16x16x32_bf16 v[24:27], a[100:103], v[84:87], v[24:27]
    ds_read_b64_tr_b16 a[144:145], v2 offset:64
    v_cvt_pk_bf16_f32 v39, v30, v31
    v_mfma_f32_16x16x32_bf16 v[24:27], a[104:107], v[88:91], v[24:27]
    v_exp_f32 v17, v17
    v_mfma_f32_16x16x32_bf16 v[24:27], a[108:111], v[92:95], v[24:27]
    ds_read_b64_tr_b16 a[146:147], v2 offset:320
    v_mfma_f32_16x16x32_bf16 v[28:31], a[112:115], v[80:83], v[52:55]
    v_exp_f32 v18, v18
    v_mfma_f32_16x16x32_bf16 v[28:31], a[116:119], v[84:87], v[28:31]
    ds_read_b64_tr_b16 a[148:149], v2 offset:576
    v_cvt_pk_bf16_f32 v40, v16, v17
    v_mfma_f32_16x16x32_bf16 v[28:31], a[120:123], v[88:91], v[28:31]
    v_exp_f32 v19, v19
    v_mfma_f32_16x16x32_bf16 v[28:31], a[124:127], v[92:95], v[28:31]
    ds_read_b64_tr_b16 a[150:151], v2 offset:832
    v_mfma_f32_16x16x32_bf16 v[128:131], a[192:195], v[32:35], v[128:131]
    v_exp_f32 v20, v20
    v_mfma_f32_16x16x32_bf16 v[128:131], a[196:199], v[36:39], v[128:131]
    ds_read_b64_tr_b16 a[152:153], v2 offset:96
    v_cvt_pk_bf16_f32 v41, v18, v19
    v_mfma_f32_16x16x32_bf16 v[132:135], a[200:203], v[32:35], v[132:135]
    v_exp_f32 v21, v21
    v_mfma_f32_16x16x32_bf16 v[132:135], a[204:207], v[36:39], v[132:135]
    ds_read_b64_tr_b16 a[154:155], v2 offset:352
    v_mfma_f32_16x16x32_bf16 v[136:139], a[208:211], v[32:35], v[136:139]
    v_exp_f32 v22, v22
    v_mfma_f32_16x16x32_bf16 v[136:139], a[212:215], v[36:39], v[136:139]
    ds_read_b64_tr_b16 a[156:157], v2 offset:608
    v_cvt_pk_bf16_f32 v42, v20, v21
    v_mfma_f32_16x16x32_bf16 v[140:143], a[216:219], v[32:35], v[140:143]
    v_exp_f32 v23, v23
    v_mfma_f32_16x16x32_bf16 v[140:143], a[220:223], v[36:39], v[140:143]
    ds_read_b64_tr_b16 a[158:159], v2 offset:864
    v_mfma_f32_16x16x32_bf16 v[144:147], a[224:227], v[32:35], v[144:147]
    v_exp_f32 v24, v24
    v_mfma_f32_16x16x32_bf16 v[144:147], a[228:231], v[36:39], v[144:147]
    ds_read_b64_tr_b16 a[160:161], v2 offset:128
    v_cvt_pk_bf16_f32 v43, v22, v23
    v_mfma_f32_16x16x32_bf16 v[148:151], a[232:235], v[32:35], v[148:151]
    v_exp_f32 v25, v25
    v_mfma_f32_16x16x32_bf16 v[148:151], a[236:239], v[36:39], v[148:151]
    ds_read_b64_tr_b16 a[162:163], v2 offset:384
    v_mfma_f32_16x16x32_bf16 v[152:155], a[240:243], v[32:35], v[152:155]
    v_exp_f32 v26, v26
    v_mfma_f32_16x16x32_bf16 v[152:155], a[244:247], v[36:39], v[152:155]
    ds_read_b64_tr_b16 a[164:165], v2 offset:640
    v_cvt_pk_bf16_f32 v44, v24, v25
    v_mfma_f32_16x16x32_bf16 v[156:159], a[248:251], v[32:35], v[156:159]
    v_exp_f32 v27, v27
    v_mfma_f32_16x16x32_bf16 v[156:159], a[252:255], v[36:39], v[156:159]
    ds_read_b64_tr_b16 a[166:167], v2 offset:896
    v_smfmac_f32_16x16x64_bf16 a[0:3], a[16:19], v[32:39], v11
    ds_read_b64_tr_b16 a[168:169], v2 offset:160
    v_mfma_f32_16x16x32_bf16 v[16:19], a[64:67], v[96:99], v[56:59]
    v_exp_f32 v28, v28
    v_mfma_f32_16x16x32_bf16 v[16:19], a[68:71], v[100:103], v[16:19]
    ds_read_b64_tr_b16 a[170:171], v2 offset:416
    v_cvt_pk_bf16_f32 v45, v26, v27
    v_mfma_f32_16x16x32_bf16 v[16:19], a[72:75], v[104:107], v[16:19]
    v_exp_f32 v29, v29
    v_mfma_f32_16x16x32_bf16 v[16:19], a[76:79], v[108:111], v[16:19]
    ds_read_b64_tr_b16 a[172:173], v2 offset:672
    v_mfma_f32_16x16x32_bf16 v[20:23], a[80:83], v[96:99], v[56:59]
    v_exp_f32 v30, v30
    v_mfma_f32_16x16x32_bf16 v[20:23], a[84:87], v[100:103], v[20:23]
    ds_read_b64_tr_b16 a[174:175], v2 offset:928
    v_cvt_pk_bf16_f32 v46, v28, v29
    v_mfma_f32_16x16x32_bf16 v[20:23], a[88:91], v[104:107], v[20:23]
    v_exp_f32 v31, v31
    v_mfma_f32_16x16x32_bf16 v[20:23], a[92:95], v[108:111], v[20:23]
    ds_read_b64_tr_b16 a[176:177], v2 offset:192
    v_mfma_f32_16x16x32_bf16 v[24:27], a[96:99], v[96:99], v[56:59]
    v_exp_f32 v16, v16
    v_mfma_f32_16x16x32_bf16 v[24:27], a[100:103], v[100:103], v[24:27]
    ds_read_b64_tr_b16 a[178:179], v2 offset:448
    v_cvt_pk_bf16_f32 v47, v30, v31
    v_mfma_f32_16x16x32_bf16 v[24:27], a[104:107], v[104:107], v[24:27]
    v_exp_f32 v17, v17
    v_mfma_f32_16x16x32_bf16 v[24:27], a[108:111], v[108:111], v[24:27]
    ds_read_b64_tr_b16 a[180:181], v2 offset:704
    v_mfma_f32_16x16x32_bf16 v[28:31], a[112:115], v[96:99], v[56:59]
    v_exp_f32 v18, v18
    v_mfma_f32_16x16x32_bf16 v[28:31], a[116:119], v[100:103], v[28:31]
    ds_read_b64_tr_b16 a[182:183], v2 offset:960
    v_cvt_pk_bf16_f32 v32, v16, v17
    v_mfma_f32_16x16x32_bf16 v[28:31], a[120:123], v[104:107], v[28:31]
    v_exp_f32 v19, v19
    v_mfma_f32_16x16x32_bf16 v[28:31], a[124:127], v[108:111], v[28:31]
    ds_read_b64_tr_b16 a[184:185], v2 offset:224
    v_mfma_f32_16x16x32_bf16 v[160:163], a[192:195], v[40:43], v[160:163]
    v_exp_f32 v20, v20
    v_mfma_f32_16x16x32_bf16 v[160:163], a[196:199], v[44:47], v[160:163]
    ds_read_b64_tr_b16 a[186:187], v2 offset:480
    v_cvt_pk_bf16_f32 v33, v18, v19
    v_mfma_f32_16x16x32_bf16 v[164:167], a[200:203], v[40:43], v[164:167]
    v_exp_f32 v21, v21
    v_mfma_f32_16x16x32_bf16 v[164:167], a[204:207], v[44:47], v[164:167]
    ds_read_b64_tr_b16 a[188:189], v2 offset:736
    v_mfma_f32_16x16x32_bf16 v[168:171], a[208:211], v[40:43], v[168:171]
    v_exp_f32 v22, v22
    v_mfma_f32_16x16x32_bf16 v[168:171], a[212:215], v[44:47], v[168:171]
    ds_read_b64_tr_b16 a[190:191], v2 offset:992
    v_cvt_pk_bf16_f32 v34, v20, v21
    v_mfma_f32_16x16x32_bf16 v[172:175], a[216:219], v[40:43], v[172:175]
    v_exp_f32 v23, v23
    v_mfma_f32_16x16x32_bf16 v[172:175], a[220:223], v[44:47], v[172:175]
    v_mfma_f32_16x16x32_bf16 v[176:179], a[224:227], v[40:43], v[176:179]
    v_exp_f32 v24, v24
    v_mfma_f32_16x16x32_bf16 v[176:179], a[228:231], v[44:47], v[176:179]
    v_cvt_pk_bf16_f32 v35, v22, v23
    v_mfma_f32_16x16x32_bf16 v[180:183], a[232:235], v[40:43], v[180:183]
    v_exp_f32 v25, v25
    v_mfma_f32_16x16x32_bf16 v[180:183], a[236:239], v[44:47], v[180:183]
    v_mfma_f32_16x16x32_bf16 v[184:187], a[240:243], v[40:43], v[184:187]
    v_exp_f32 v26, v26
    v_mfma_f32_16x16x32_bf16 v[184:187], a[244:247], v[44:47], v[184:187]
    v_cvt_pk_bf16_f32 v36, v24, v25
    v_mfma_f32_16x16x32_bf16 v[188:191], a[248:251], v[40:43], v[188:191]
    v_exp_f32 v27, v27
    v_mfma_f32_16x16x32_bf16 v[188:191], a[252:255], v[44:47], v[188:191]
    v_smfmac_f32_16x16x64_bf16 a[4:7], a[16:19], v[40:47], v11
    v_mfma_f32_16x16x32_bf16 v[16:19], a[64:67], v[112:115], v[60:63]
    v_exp_f32 v28, v28
    v_mfma_f32_16x16x32_bf16 v[16:19], a[68:71], v[116:119], v[16:19]
    s_add_u32 s46, s46, 16384
    ds_read_b128 a[64:67], v1 offset:0
    v_cvt_pk_bf16_f32 v37, v26, v27
    v_mfma_f32_16x16x32_bf16 v[16:19], a[72:75], v[120:123], v[16:19]
    v_exp_f32 v29, v29
    v_mfma_f32_16x16x32_bf16 v[16:19], a[76:79], v[124:127], v[16:19]
    ds_read_b128 a[68:71], v1 offset:64
    v_mfma_f32_16x16x32_bf16 v[20:23], a[80:83], v[112:115], v[60:63]
    v_exp_f32 v30, v30
    v_mfma_f32_16x16x32_bf16 v[20:23], a[84:87], v[116:119], v[20:23]
    ds_read_b128 a[72:75], v1 offset:128
    v_cvt_pk_bf16_f32 v38, v28, v29
    v_mfma_f32_16x16x32_bf16 v[20:23], a[88:91], v[120:123], v[20:23]
    v_exp_f32 v31, v31
    v_mfma_f32_16x16x32_bf16 v[20:23], a[92:95], v[124:127], v[20:23]
    ds_read_b128 a[76:79], v1 offset:192
    v_mfma_f32_16x16x32_bf16 v[24:27], a[96:99], v[112:115], v[60:63]
    v_exp_f32 v16, v16
    v_mfma_f32_16x16x32_bf16 v[24:27], a[100:103], v[116:119], v[24:27]
    ds_read_b128 a[80:83], v1 offset:256
    v_cvt_pk_bf16_f32 v39, v30, v31
    v_mfma_f32_16x16x32_bf16 v[24:27], a[104:107], v[120:123], v[24:27]
    v_exp_f32 v17, v17
    v_mfma_f32_16x16x32_bf16 v[24:27], a[108:111], v[124:127], v[24:27]
    ds_read_b128 a[84:87], v1 offset:320
    v_mfma_f32_16x16x32_bf16 v[28:31], a[112:115], v[112:115], v[60:63]
    v_exp_f32 v18, v18
    v_mfma_f32_16x16x32_bf16 v[28:31], a[116:119], v[116:119], v[28:31]
    ds_read_b128 a[88:91], v1 offset:384
    v_cvt_pk_bf16_f32 v40, v16, v17
    v_mfma_f32_16x16x32_bf16 v[28:31], a[120:123], v[120:123], v[28:31]
    v_exp_f32 v19, v19
    v_mfma_f32_16x16x32_bf16 v[28:31], a[124:127], v[124:127], v[28:31]
    ds_read_b128 a[92:95], v1 offset:448
    v_mfma_f32_16x16x32_bf16 v[192:195], a[192:195], v[32:35], v[192:195]
    v_exp_f32 v20, v20
    v_mfma_f32_16x16x32_bf16 v[192:195], a[196:199], v[36:39], v[192:195]
    ds_read_b128 a[96:99], v1 offset:512
    v_cvt_pk_bf16_f32 v41, v18, v19
    v_mfma_f32_16x16x32_bf16 v[196:199], a[200:203], v[32:35], v[196:199]
    v_exp_f32 v21, v21
    v_mfma_f32_16x16x32_bf16 v[196:199], a[204:207], v[36:39], v[196:199]
    ds_read_b128 a[100:103], v1 offset:576
    v_mfma_f32_16x16x32_bf16 v[200:203], a[208:211], v[32:35], v[200:203]
    v_exp_f32 v22, v22
    v_mfma_f32_16x16x32_bf16 v[200:203], a[212:215], v[36:39], v[200:203]
    ds_read_b128 a[104:107], v1 offset:640
    v_cvt_pk_bf16_f32 v42, v20, v21
    v_mfma_f32_16x16x32_bf16 v[204:207], a[216:219], v[32:35], v[204:207]
    v_exp_f32 v23, v23
    v_mfma_f32_16x16x32_bf16 v[204:207], a[220:223], v[36:39], v[204:207]
    ds_read_b128 a[108:111], v1 offset:704
    v_mfma_f32_16x16x32_bf16 v[208:211], a[224:227], v[32:35], v[208:211]
    v_exp_f32 v24, v24
    v_mfma_f32_16x16x32_bf16 v[208:211], a[228:231], v[36:39], v[208:211]
    ds_read_b128 a[112:115], v1 offset:768
    v_cvt_pk_bf16_f32 v43, v22, v23
    v_mfma_f32_16x16x32_bf16 v[212:215], a[232:235], v[32:35], v[212:215]
    v_exp_f32 v25, v25
    v_mfma_f32_16x16x32_bf16 v[212:215], a[236:239], v[36:39], v[212:215]
    ds_read_b128 a[116:119], v1 offset:832
    v_mfma_f32_16x16x32_bf16 v[216:219], a[240:243], v[32:35], v[216:219]
    v_exp_f32 v26, v26
    v_mfma_f32_16x16x32_bf16 v[216:219], a[244:247], v[36:39], v[216:219]
    ds_read_b128 a[120:123], v1 offset:896
    v_cvt_pk_bf16_f32 v44, v24, v25
    v_mfma_f32_16x16x32_bf16 v[220:223], a[248:251], v[32:35], v[220:223]
    v_exp_f32 v27, v27
    v_mfma_f32_16x16x32_bf16 v[220:223], a[252:255], v[36:39], v[220:223]
    ds_read_b128 a[124:127], v1 offset:960
    v_smfmac_f32_16x16x64_bf16 a[8:11], a[16:19], v[32:39], v11
    s_waitcnt vmcnt(9) lgkmcnt(12)
    s_barrier
    v_mfma_f32_16x16x32_bf16 v[16:19], a[64:67], v[64:67], v[48:51]
    v_exp_f32 v28, v28
    v_mfma_f32_16x16x32_bf16 v[16:19], a[68:71], v[68:71], v[16:19]
    v_cvt_pk_bf16_f32 v45, v26, v27
    v_mfma_f32_16x16x32_bf16 v[16:19], a[72:75], v[72:75], v[16:19]
    s_add_u32 m0, s47, 36864
    v_exp_f32 v29, v29
    v_mfma_f32_16x16x32_bf16 v[16:19], a[76:79], v[76:79], v[16:19]
    s_waitcnt lgkmcnt(8)
    buffer_load_dwordx4 v5, s[16:19], s46 offen offset:0 lds
    v_mfma_f32_16x16x32_bf16 v[20:23], a[80:83], v[64:67], v[48:51]
    v_exp_f32 v30, v30
    v_mfma_f32_16x16x32_bf16 v[20:23], a[84:87], v[68:71], v[20:23]
    v_cvt_pk_bf16_f32 v46, v28, v29
    v_mfma_f32_16x16x32_bf16 v[20:23], a[88:91], v[72:75], v[20:23]
    s_add_u32 m0, s47, 36896
    v_exp_f32 v31, v31
    v_mfma_f32_16x16x32_bf16 v[20:23], a[92:95], v[76:79], v[20:23]
    s_waitcnt lgkmcnt(4)
    buffer_load_dwordx4 v5, s[16:19], s46 offen offset:1024 lds
    v_mfma_f32_16x16x32_bf16 v[24:27], a[96:99], v[64:67], v[48:51]
    v_exp_f32 v16, v16
    v_mfma_f32_16x16x32_bf16 v[24:27], a[100:103], v[68:71], v[24:27]
    v_cvt_pk_bf16_f32 v47, v30, v31
    v_mfma_f32_16x16x32_bf16 v[24:27], a[104:107], v[72:75], v[24:27]
    s_add_u32 m0, s47, 36928
    v_exp_f32 v17, v17
    v_mfma_f32_16x16x32_bf16 v[24:27], a[108:111], v[76:79], v[24:27]
    s_waitcnt lgkmcnt(0)
    buffer_load_dwordx4 v5, s[16:19], s46 offen offset:2048 lds
    v_mfma_f32_16x16x32_bf16 v[28:31], a[112:115], v[64:67], v[48:51]
    v_exp_f32 v18, v18
    v_mfma_f32_16x16x32_bf16 v[28:31], a[116:119], v[68:71], v[28:31]
    v_cvt_pk_bf16_f32 v32, v16, v17
    v_mfma_f32_16x16x32_bf16 v[28:31], a[120:123], v[72:75], v[28:31]
    s_add_u32 m0, s47, 36960
    v_exp_f32 v19, v19
    v_mfma_f32_16x16x32_bf16 v[28:31], a[124:127], v[76:79], v[28:31]
    buffer_load_dwordx4 v5, s[16:19], s46 offen offset:3072 lds
    v_mfma_f32_16x16x32_bf16 v[224:227], a[192:195], v[40:43], v[224:227]
    v_exp_f32 v20, v20
    v_mfma_f32_16x16x32_bf16 v[224:227], a[196:199], v[44:47], v[224:227]
    ds_read_b64_tr_b16 a[192:193], v2 offset:36864
    v_cvt_pk_bf16_f32 v33, v18, v19
    v_mfma_f32_16x16x32_bf16 v[228:231], a[200:203], v[40:43], v[228:231]
    s_add_u32 m0, s47, 53760
    v_exp_f32 v21, v21
    v_mfma_f32_16x16x32_bf16 v[228:231], a[204:207], v[44:47], v[228:231]
    buffer_load_dwordx4 v5, s[20:23], s46 offen offset:0 lds
    v_mfma_f32_16x16x32_bf16 v[232:235], a[208:211], v[40:43], v[232:235]
    v_exp_f32 v22, v22
    v_mfma_f32_16x16x32_bf16 v[232:235], a[212:215], v[44:47], v[232:235]
    ds_read_b64_tr_b16 a[194:195], v2 offset:37120
    v_cvt_pk_bf16_f32 v34, v20, v21
    v_mfma_f32_16x16x32_bf16 v[236:239], a[216:219], v[40:43], v[236:239]
    s_add_u32 m0, s47, 53792
    v_exp_f32 v23, v23
    v_mfma_f32_16x16x32_bf16 v[236:239], a[220:223], v[44:47], v[236:239]
    buffer_load_dwordx4 v5, s[20:23], s46 offen offset:1024 lds
    v_mfma_f32_16x16x32_bf16 v[240:243], a[224:227], v[40:43], v[240:243]
    v_exp_f32 v24, v24
    v_mfma_f32_16x16x32_bf16 v[240:243], a[228:231], v[44:47], v[240:243]
    ds_read_b64_tr_b16 a[196:197], v2 offset:37376
    v_cvt_pk_bf16_f32 v35, v22, v23
    v_mfma_f32_16x16x32_bf16 v[244:247], a[232:235], v[40:43], v[244:247]
    s_add_u32 m0, s47, 53824
    v_exp_f32 v25, v25
    v_mfma_f32_16x16x32_bf16 v[244:247], a[236:239], v[44:47], v[244:247]
    buffer_load_dwordx4 v5, s[20:23], s46 offen offset:2048 lds
    v_mfma_f32_16x16x32_bf16 v[248:251], a[240:243], v[40:43], v[248:251]
    v_exp_f32 v26, v26
    v_mfma_f32_16x16x32_bf16 v[248:251], a[244:247], v[44:47], v[248:251]
    ds_read_b64_tr_b16 a[198:199], v2 offset:37632
    v_cvt_pk_bf16_f32 v36, v24, v25
    v_mfma_f32_16x16x32_bf16 v[252:255], a[248:251], v[40:43], v[252:255]
    s_add_u32 m0, s47, 53856
    v_exp_f32 v27, v27
    v_mfma_f32_16x16x32_bf16 v[252:255], a[252:255], v[44:47], v[252:255]
    buffer_load_dwordx4 v5, s[20:23], s46 offen offset:3072 lds
    v_smfmac_f32_16x16x64_bf16 a[12:15], a[16:19], v[40:47], v11
    ds_read_b64_tr_b16 a[200:201], v2 offset:36896
    v_mfma_f32_16x16x32_bf16 v[16:19], a[64:67], v[80:83], v[52:55]
    v_exp_f32 v28, v28
    v_mfma_f32_16x16x32_bf16 v[16:19], a[68:71], v[84:87], v[16:19]
    ds_read_b64_tr_b16 a[202:203], v2 offset:37152
    v_cvt_pk_bf16_f32 v37, v26, v27
    v_mfma_f32_16x16x32_bf16 v[16:19], a[72:75], v[88:91], v[16:19]
    v_exp_f32 v29, v29
    v_mfma_f32_16x16x32_bf16 v[16:19], a[76:79], v[92:95], v[16:19]
    ds_read_b64_tr_b16 a[204:205], v2 offset:37408
    v_mfma_f32_16x16x32_bf16 v[20:23], a[80:83], v[80:83], v[52:55]
    v_exp_f32 v30, v30
    v_mfma_f32_16x16x32_bf16 v[20:23], a[84:87], v[84:87], v[20:23]
    ds_read_b64_tr_b16 a[206:207], v2 offset:37664
    v_cvt_pk_bf16_f32 v38, v28, v29
    v_mfma_f32_16x16x32_bf16 v[20:23], a[88:91], v[88:91], v[20:23]
    v_exp_f32 v31, v31
    v_mfma_f32_16x16x32_bf16 v[20:23], a[92:95], v[92:95], v[20:23]
    ds_read_b64_tr_b16 a[208:209], v2 offset:36928
    v_mfma_f32_16x16x32_bf16 v[24:27], a[96:99], v[80:83], v[52:55]
    v_exp_f32 v16, v16
    v_mfma_f32_16x16x32_bf16 v[24:27], a[100:103], v[84:87], v[24:27]
    ds_read_b64_tr_b16 a[210:211], v2 offset:37184
    v_cvt_pk_bf16_f32 v39, v30, v31
    v_mfma_f32_16x16x32_bf16 v[24:27], a[104:107], v[88:91], v[24:27]
    v_exp_f32 v17, v17
    v_mfma_f32_16x16x32_bf16 v[24:27], a[108:111], v[92:95], v[24:27]
    ds_read_b64_tr_b16 a[212:213], v2 offset:37440
    v_mfma_f32_16x16x32_bf16 v[28:31], a[112:115], v[80:83], v[52:55]
    v_exp_f32 v18, v18
    v_mfma_f32_16x16x32_bf16 v[28:31], a[116:119], v[84:87], v[28:31]
    ds_read_b64_tr_b16 a[214:215], v2 offset:37696
    v_cvt_pk_bf16_f32 v40, v16, v17
    v_mfma_f32_16x16x32_bf16 v[28:31], a[120:123], v[88:91], v[28:31]
    v_exp_f32 v19, v19
    v_mfma_f32_16x16x32_bf16 v[28:31], a[124:127], v[92:95], v[28:31]
    ds_read_b64_tr_b16 a[216:217], v2 offset:36960
    v_mfma_f32_16x16x32_bf16 v[128:131], a[128:131], v[32:35], v[128:131]
    v_exp_f32 v20, v20
    v_mfma_f32_16x16x32_bf16 v[128:131], a[132:135], v[36:39], v[128:131]
    ds_read_b64_tr_b16 a[218:219], v2 offset:37216
    v_cvt_pk_bf16_f32 v41, v18, v19
    v_mfma_f32_16x16x32_bf16 v[132:135], a[136:139], v[32:35], v[132:135]
    v_exp_f32 v21, v21
    v_mfma_f32_16x16x32_bf16 v[132:135], a[140:143], v[36:39], v[132:135]
    ds_read_b64_tr_b16 a[220:221], v2 offset:37472
    v_mfma_f32_16x16x32_bf16 v[136:139], a[144:147], v[32:35], v[136:139]
    v_exp_f32 v22, v22
    v_mfma_f32_16x16x32_bf16 v[136:139], a[148:151], v[36:39], v[136:139]
    ds_read_b64_tr_b16 a[222:223], v2 offset:37728
    v_cvt_pk_bf16_f32 v42, v20, v21
    v_mfma_f32_16x16x32_bf16 v[140:143], a[152:155], v[32:35], v[140:143]
    v_exp_f32 v23, v23
    v_mfma_f32_16x16x32_bf16 v[140:143], a[156:159], v[36:39], v[140:143]
    ds_read_b64_tr_b16 a[224:225], v2 offset:36992
    v_mfma_f32_16x16x32_bf16 v[144:147], a[160:163], v[32:35], v[144:147]
    v_exp_f32 v24, v24
    v_mfma_f32_16x16x32_bf16 v[144:147], a[164:167], v[36:39], v[144:147]
    ds_read_b64_tr_b16 a[226:227], v2 offset:37248
    v_cvt_pk_bf16_f32 v43, v22, v23
    v_mfma_f32_16x16x32_bf16 v[148:151], a[168:171], v[32:35], v[148:151]
    v_exp_f32 v25, v25
    v_mfma_f32_16x16x32_bf16 v[148:151], a[172:175], v[36:39], v[148:151]
    ds_read_b64_tr_b16 a[228:229], v2 offset:37504
    v_mfma_f32_16x16x32_bf16 v[152:155], a[176:179], v[32:35], v[152:155]
    v_exp_f32 v26, v26
    v_mfma_f32_16x16x32_bf16 v[152:155], a[180:183], v[36:39], v[152:155]
    ds_read_b64_tr_b16 a[230:231], v2 offset:37760
    v_cvt_pk_bf16_f32 v44, v24, v25
    v_mfma_f32_16x16x32_bf16 v[156:159], a[184:187], v[32:35], v[156:159]
    v_exp_f32 v27, v27
    v_mfma_f32_16x16x32_bf16 v[156:159], a[188:191], v[36:39], v[156:159]
    ds_read_b64_tr_b16 a[232:233], v2 offset:37024
    v_smfmac_f32_16x16x64_bf16 a[0:3], a[16:19], v[32:39], v11
    ds_read_b64_tr_b16 a[234:235], v2 offset:37280
    v_mfma_f32_16x16x32_bf16 v[16:19], a[64:67], v[96:99], v[56:59]
    v_exp_f32 v28, v28
    v_mfma_f32_16x16x32_bf16 v[16:19], a[68:71], v[100:103], v[16:19]
    ds_read_b64_tr_b16 a[236:237], v2 offset:37536
    v_cvt_pk_bf16_f32 v45, v26, v27
    v_mfma_f32_16x16x32_bf16 v[16:19], a[72:75], v[104:107], v[16:19]
    v_exp_f32 v29, v29
    v_mfma_f32_16x16x32_bf16 v[16:19], a[76:79], v[108:111], v[16:19]
    ds_read_b64_tr_b16 a[238:239], v2 offset:37792
    v_mfma_f32_16x16x32_bf16 v[20:23], a[80:83], v[96:99], v[56:59]
    v_exp_f32 v30, v30
    v_mfma_f32_16x16x32_bf16 v[20:23], a[84:87], v[100:103], v[20:23]
    ds_read_b64_tr_b16 a[240:241], v2 offset:37056
    v_cvt_pk_bf16_f32 v46, v28, v29
    v_mfma_f32_16x16x32_bf16 v[20:23], a[88:91], v[104:107], v[20:23]
    v_exp_f32 v31, v31
    v_mfma_f32_16x16x32_bf16 v[20:23], a[92:95], v[108:111], v[20:23]
    ds_read_b64_tr_b16 a[242:243], v2 offset:37312
    v_mfma_f32_16x16x32_bf16 v[24:27], a[96:99], v[96:99], v[56:59]
    v_exp_f32 v16, v16
    v_mfma_f32_16x16x32_bf16 v[24:27], a[100:103], v[100:103], v[24:27]
    ds_read_b64_tr_b16 a[244:245], v2 offset:37568
    v_cvt_pk_bf16_f32 v47, v30, v31
    v_mfma_f32_16x16x32_bf16 v[24:27], a[104:107], v[104:107], v[24:27]
    v_exp_f32 v17, v17
    v_mfma_f32_16x16x32_bf16 v[24:27], a[108:111], v[108:111], v[24:27]
    ds_read_b64_tr_b16 a[246:247], v2 offset:37824
    v_mfma_f32_16x16x32_bf16 v[28:31], a[112:115], v[96:99], v[56:59]
    v_exp_f32 v18, v18
    v_mfma_f32_16x16x32_bf16 v[28:31], a[116:119], v[100:103], v[28:31]
    ds_read_b64_tr_b16 a[248:249], v2 offset:37088
    v_cvt_pk_bf16_f32 v32, v16, v17
    v_mfma_f32_16x16x32_bf16 v[28:31], a[120:123], v[104:107], v[28:31]
    v_exp_f32 v19, v19
    v_mfma_f32_16x16x32_bf16 v[28:31], a[124:127], v[108:111], v[28:31]
    ds_read_b64_tr_b16 a[250:251], v2 offset:37344
    v_mfma_f32_16x16x32_bf16 v[160:163], a[128:131], v[40:43], v[160:163]
    v_exp_f32 v20, v20
    v_mfma_f32_16x16x32_bf16 v[160:163], a[132:135], v[44:47], v[160:163]
    ds_read_b64_tr_b16 a[252:253], v2 offset:37600
    v_cvt_pk_bf16_f32 v33, v18, v19
    v_mfma_f32_16x16x32_bf16 v[164:167], a[136:139], v[40:43], v[164:167]
    v_exp_f32 v21, v21
    v_mfma_f32_16x16x32_bf16 v[164:167], a[140:143], v[44:47], v[164:167]
    ds_read_b64_tr_b16 a[254:255], v2 offset:37856
    v_mfma_f32_16x16x32_bf16 v[168:171], a[144:147], v[40:43], v[168:171]
    v_exp_f32 v22, v22
    v_mfma_f32_16x16x32_bf16 v[168:171], a[148:151], v[44:47], v[168:171]
    v_cvt_pk_bf16_f32 v34, v20, v21
    v_mfma_f32_16x16x32_bf16 v[172:175], a[152:155], v[40:43], v[172:175]
    v_exp_f32 v23, v23
    v_mfma_f32_16x16x32_bf16 v[172:175], a[156:159], v[44:47], v[172:175]
    v_mfma_f32_16x16x32_bf16 v[176:179], a[160:163], v[40:43], v[176:179]
    v_exp_f32 v24, v24
    v_mfma_f32_16x16x32_bf16 v[176:179], a[164:167], v[44:47], v[176:179]
    v_cvt_pk_bf16_f32 v35, v22, v23
    v_mfma_f32_16x16x32_bf16 v[180:183], a[168:171], v[40:43], v[180:183]
    v_exp_f32 v25, v25
    v_mfma_f32_16x16x32_bf16 v[180:183], a[172:175], v[44:47], v[180:183]
    v_mfma_f32_16x16x32_bf16 v[184:187], a[176:179], v[40:43], v[184:187]
    v_exp_f32 v26, v26
    v_mfma_f32_16x16x32_bf16 v[184:187], a[180:183], v[44:47], v[184:187]
    v_cvt_pk_bf16_f32 v36, v24, v25
    v_mfma_f32_16x16x32_bf16 v[188:191], a[184:187], v[40:43], v[188:191]
    v_exp_f32 v27, v27
    v_mfma_f32_16x16x32_bf16 v[188:191], a[188:191], v[44:47], v[188:191]
    v_smfmac_f32_16x16x64_bf16 a[4:7], a[16:19], v[40:47], v11
    v_mfma_f32_16x16x32_bf16 v[16:19], a[64:67], v[112:115], v[60:63]
    v_exp_f32 v28, v28
    v_mfma_f32_16x16x32_bf16 v[16:19], a[68:71], v[116:119], v[16:19]
    s_add_u32 s46, s46, 16384
    ds_read_b128 a[64:67], v1 offset:36864
    v_cvt_pk_bf16_f32 v37, v26, v27
    v_mfma_f32_16x16x32_bf16 v[16:19], a[72:75], v[120:123], v[16:19]
    v_exp_f32 v29, v29
    v_mfma_f32_16x16x32_bf16 v[16:19], a[76:79], v[124:127], v[16:19]
    ds_read_b128 a[68:71], v1 offset:36928
    v_mfma_f32_16x16x32_bf16 v[20:23], a[80:83], v[112:115], v[60:63]
    v_exp_f32 v30, v30
    v_mfma_f32_16x16x32_bf16 v[20:23], a[84:87], v[116:119], v[20:23]
    ds_read_b128 a[72:75], v1 offset:36992
    v_cvt_pk_bf16_f32 v38, v28, v29
    v_mfma_f32_16x16x32_bf16 v[20:23], a[88:91], v[120:123], v[20:23]
    v_exp_f32 v31, v31
    v_mfma_f32_16x16x32_bf16 v[20:23], a[92:95], v[124:127], v[20:23]
    ds_read_b128 a[76:79], v1 offset:37056
    v_mfma_f32_16x16x32_bf16 v[24:27], a[96:99], v[112:115], v[60:63]
    v_exp_f32 v16, v16
    v_mfma_f32_16x16x32_bf16 v[24:27], a[100:103], v[116:119], v[24:27]
    ds_read_b128 a[80:83], v1 offset:37120
    v_cvt_pk_bf16_f32 v39, v30, v31
    v_mfma_f32_16x16x32_bf16 v[24:27], a[104:107], v[120:123], v[24:27]
    v_exp_f32 v17, v17
    v_mfma_f32_16x16x32_bf16 v[24:27], a[108:111], v[124:127], v[24:27]
    ds_read_b128 a[84:87], v1 offset:37184
    v_mfma_f32_16x16x32_bf16 v[28:31], a[112:115], v[112:115], v[60:63]
    v_exp_f32 v18, v18
    v_mfma_f32_16x16x32_bf16 v[28:31], a[116:119], v[116:119], v[28:31]
    ds_read_b128 a[88:91], v1 offset:37248
    v_cvt_pk_bf16_f32 v40, v16, v17
    v_mfma_f32_16x16x32_bf16 v[28:31], a[120:123], v[120:123], v[28:31]
    v_exp_f32 v19, v19
    v_mfma_f32_16x16x32_bf16 v[28:31], a[124:127], v[124:127], v[28:31]
    ds_read_b128 a[92:95], v1 offset:37312
    v_mfma_f32_16x16x32_bf16 v[192:195], a[128:131], v[32:35], v[192:195]
    v_exp_f32 v20, v20
    v_mfma_f32_16x16x32_bf16 v[192:195], a[132:135], v[36:39], v[192:195]
    ds_read_b128 a[96:99], v1 offset:37376
    v_cvt_pk_bf16_f32 v41, v18, v19
    v_mfma_f32_16x16x32_bf16 v[196:199], a[136:139], v[32:35], v[196:199]
    v_exp_f32 v21, v21
    v_mfma_f32_16x16x32_bf16 v[196:199], a[140:143], v[36:39], v[196:199]
    ds_read_b128 a[100:103], v1 offset:37440
    v_mfma_f32_16x16x32_bf16 v[200:203], a[144:147], v[32:35], v[200:203]
    v_exp_f32 v22, v22
    v_mfma_f32_16x16x32_bf16 v[200:203], a[148:151], v[36:39], v[200:203]
    ds_read_b128 a[104:107], v1 offset:37504
    v_cvt_pk_bf16_f32 v42, v20, v21
    v_mfma_f32_16x16x32_bf16 v[204:207], a[152:155], v[32:35], v[204:207]
    v_exp_f32 v23, v23
    v_mfma_f32_16x16x32_bf16 v[204:207], a[156:159], v[36:39], v[204:207]
    ds_read_b128 a[108:111], v1 offset:37568
    v_mfma_f32_16x16x32_bf16 v[208:211], a[160:163], v[32:35], v[208:211]
L2_pad5:
    s_cbranch_execz L2_pad9
    v_exp_f32 v24, v24
    v_mfma_f32_16x16x32_bf16 v[208:211], a[164:167], v[36:39], v[208:211]
    ds_read_b128 a[112:115], v1 offset:37632
    v_cvt_pk_bf16_f32 v43, v22, v23
    v_mfma_f32_16x16x32_bf16 v[212:215], a[168:171], v[32:35], v[212:215]
    v_exp_f32 v25, v25
    v_mfma_f32_16x16x32_bf16 v[212:215], a[172:175], v[36:39], v[212:215]
    ds_read_b128 a[116:119], v1 offset:37696
    v_mfma_f32_16x16x32_bf16 v[216:219], a[176:179], v[32:35], v[216:219]
    v_exp_f32 v26, v26
    v_mfma_f32_16x16x32_bf16 v[216:219], a[180:183], v[36:39], v[216:219]
    s_sub_u32 s49, s49, 1
    ds_read_b128 a[120:123], v1 offset:37760
    v_cvt_pk_bf16_f32 v44, v24, v25
    v_mfma_f32_16x16x32_bf16 v[220:223], a[184:187], v[32:35], v[220:223]
    s_cmp_lg_u32 s49, 0
    v_exp_f32 v27, v27
    v_mfma_f32_16x16x32_bf16 v[220:223], a[188:191], v[36:39], v[220:223]
    ds_read_b128 a[124:127], v1 offset:37824
    v_smfmac_f32_16x16x64_bf16 a[8:11], a[16:19], v[32:39], v11
    s_waitcnt vmcnt(9) lgkmcnt(12)
    s_barrier
    s_cbranch_scc1 L2_loop
    v_mfma_f32_16x16x32_bf16 v[16:19], a[64:67], v[64:67], v[48:51]
    s_sub_u32 s47, s47, s48
    v_exp_f32 v28, v28
    v_mfma_f32_16x16x32_bf16 v[16:19], a[68:71], v[68:71], v[16:19]
    v_cvt_pk_bf16_f32 v45, v26, v27
    v_add_u32 v1, s48, v1
    v_mfma_f32_16x16x32_bf16 v[16:19], a[72:75], v[72:75], v[16:19]
    s_add_u32 m0, s47, 0
    v_exp_f32 v29, v29
    v_mfma_f32_16x16x32_bf16 v[16:19], a[76:79], v[76:79], v[16:19]
    s_waitcnt lgkmcnt(8)
    buffer_load_dwordx4 v5, s[16:19], s46 offen offset:0 lds
    v_mfma_f32_16x16x32_bf16 v[20:23], a[80:83], v[64:67], v[48:51]
    v_exp_f32 v30, v30
    v_mfma_f32_16x16x32_bf16 v[20:23], a[84:87], v[68:71], v[20:23]
    v_cvt_pk_bf16_f32 v46, v28, v29
    v_add_u32 v2, s48, v2
    v_mfma_f32_16x16x32_bf16 v[20:23], a[88:91], v[72:75], v[20:23]
    s_add_u32 m0, s47, 32
    v_exp_f32 v31, v31
    v_mfma_f32_16x16x32_bf16 v[20:23], a[92:95], v[76:79], v[20:23]
    s_waitcnt lgkmcnt(4)
    buffer_load_dwordx4 v5, s[16:19], s46 offen offset:1024 lds
    v_mfma_f32_16x16x32_bf16 v[24:27], a[96:99], v[64:67], v[48:51]
    s_sub_u32 s48, 0, s48
    v_exp_f32 v16, v16
    v_mfma_f32_16x16x32_bf16 v[24:27], a[100:103], v[68:71], v[24:27]
    v_cvt_pk_bf16_f32 v47, v30, v31
    v_mfma_f32_16x16x32_bf16 v[24:27], a[104:107], v[72:75], v[24:27]
    s_add_u32 m0, s47, 64
    v_exp_f32 v17, v17
    v_mfma_f32_16x16x32_bf16 v[24:27], a[108:111], v[76:79], v[24:27]
    s_waitcnt lgkmcnt(0)
    buffer_load_dwordx4 v5, s[16:19], s46 offen offset:2048 lds
    v_mfma_f32_16x16x32_bf16 v[28:31], a[112:115], v[64:67], v[48:51]
    v_exp_f32 v18, v18
    v_mfma_f32_16x16x32_bf16 v[28:31], a[116:119], v[68:71], v[28:31]
    v_cvt_pk_bf16_f32 v32, v16, v17
    v_mfma_f32_16x16x32_bf16 v[28:31], a[120:123], v[72:75], v[28:31]
    s_add_u32 m0, s47, 96
    v_exp_f32 v19, v19
    v_mfma_f32_16x16x32_bf16 v[28:31], a[124:127], v[76:79], v[28:31]
    buffer_load_dwordx4 v5, s[16:19], s46 offen offset:3072 lds
    v_mfma_f32_16x16x32_bf16 v[224:227], a[128:131], v[40:43], v[224:227]
    v_exp_f32 v20, v20
    v_mfma_f32_16x16x32_bf16 v[224:227], a[132:135], v[44:47], v[224:227]
    ds_read_b64_tr_b16 a[128:129], v2 offset:0
    v_cvt_pk_bf16_f32 v33, v18, v19
    v_mfma_f32_16x16x32_bf16 v[228:231], a[136:139], v[40:43], v[228:231]
    s_add_u32 m0, s47, 16896
    v_exp_f32 v21, v21
    v_mfma_f32_16x16x32_bf16 v[228:231], a[140:143], v[44:47], v[228:231]
    buffer_load_dwordx4 v5, s[20:23], s46 offen offset:0 lds
    v_mfma_f32_16x16x32_bf16 v[232:235], a[144:147], v[40:43], v[232:235]
    v_exp_f32 v22, v22
    v_mfma_f32_16x16x32_bf16 v[232:235], a[148:151], v[44:47], v[232:235]
    ds_read_b64_tr_b16 a[130:131], v2 offset:256
    v_cvt_pk_bf16_f32 v34, v20, v21
    v_mfma_f32_16x16x32_bf16 v[236:239], a[152:155], v[40:43], v[236:239]
    s_add_u32 m0, s47, 16928
    v_exp_f32 v23, v23
    v_mfma_f32_16x16x32_bf16 v[236:239], a[156:159], v[44:47], v[236:239]
    buffer_load_dwordx4 v5, s[20:23], s46 offen offset:1024 lds
    v_mfma_f32_16x16x32_bf16 v[240:243], a[160:163], v[40:43], v[240:243]
    v_exp_f32 v24, v24
    v_mfma_f32_16x16x32_bf16 v[240:243], a[164:167], v[44:47], v[240:243]
    ds_read_b64_tr_b16 a[132:133], v2 offset:512
    v_cvt_pk_bf16_f32 v35, v22, v23
    v_mfma_f32_16x16x32_bf16 v[244:247], a[168:171], v[40:43], v[244:247]
    s_add_u32 m0, s47, 16960
    v_exp_f32 v25, v25
    v_mfma_f32_16x16x32_bf16 v[244:247], a[172:175], v[44:47], v[244:247]
    buffer_load_dwordx4 v5, s[20:23], s46 offen offset:2048 lds
    v_mfma_f32_16x16x32_bf16 v[248:251], a[176:179], v[40:43], v[248:251]
    v_exp_f32 v26, v26
    v_mfma_f32_16x16x32_bf16 v[248:251], a[180:183], v[44:47], v[248:251]
    ds_read_b64_tr_b16 a[134:135], v2 offset:768
    v_cvt_pk_bf16_f32 v36, v24, v25
    v_mfma_f32_16x16x32_bf16 v[252:255], a[184:187], v[40:43], v[252:255]
    s_add_u32 m0, s47, 16992
    v_exp_f32 v27, v27
    v_mfma_f32_16x16x32_bf16 v[252:255], a[188:191], v[44:47], v[252:255]
    buffer_load_dwordx4 v5, s[20:23], s46 offen offset:3072 lds
    v_smfmac_f32_16x16x64_bf16 a[12:15], a[16:19], v[40:47], v11
    ds_read_b64_tr_b16 a[136:137], v2 offset:32
    v_mfma_f32_16x16x32_bf16 v[16:19], a[64:67], v[80:83], v[52:55]
    v_exp_f32 v28, v28
    v_mfma_f32_16x16x32_bf16 v[16:19], a[68:71], v[84:87], v[16:19]
    ds_read_b64_tr_b16 a[138:139], v2 offset:288
    v_cvt_pk_bf16_f32 v37, v26, v27
    v_mfma_f32_16x16x32_bf16 v[16:19], a[72:75], v[88:91], v[16:19]
    v_exp_f32 v29, v29
    v_mfma_f32_16x16x32_bf16 v[16:19], a[76:79], v[92:95], v[16:19]
    global_load_dword a63, v14, s[10:11]
    v_mfma_f32_16x16x32_bf16 v[20:23], a[80:83], v[80:83], v[52:55]
    v_exp_f32 v30, v30
    v_mfma_f32_16x16x32_bf16 v[20:23], a[84:87], v[84:87], v[20:23]
    ds_read_b64_tr_b16 a[140:141], v2 offset:544
    v_cvt_pk_bf16_f32 v38, v28, v29
    v_mfma_f32_16x16x32_bf16 v[20:23], a[88:91], v[88:91], v[20:23]
    v_exp_f32 v31, v31
    v_mfma_f32_16x16x32_bf16 v[20:23], a[92:95], v[92:95], v[20:23]
    ds_read_b64_tr_b16 a[142:143], v2 offset:800
    v_mfma_f32_16x16x32_bf16 v[24:27], a[96:99], v[80:83], v[52:55]
    v_exp_f32 v16, v16
    v_mfma_f32_16x16x32_bf16 v[24:27], a[100:103], v[84:87], v[24:27]
    ds_read_b64_tr_b16 a[144:145], v2 offset:64
    v_cvt_pk_bf16_f32 v39, v30, v31
    v_mfma_f32_16x16x32_bf16 v[24:27], a[104:107], v[88:91], v[24:27]
    s_mov_b32 s54, 0
    v_exp_f32 v17, v17
    v_mfma_f32_16x16x32_bf16 v[24:27], a[108:111], v[92:95], v[24:27]
    buffer_load_dwordx4 a[20:23], v6, s[64:67], s54 offen
    v_mfma_f32_16x16x32_bf16 v[28:31], a[112:115], v[80:83], v[52:55]
    v_exp_f32 v18, v18
    v_mfma_f32_16x16x32_bf16 v[28:31], a[116:119], v[84:87], v[28:31]
    ds_read_b64_tr_b16 a[146:147], v2 offset:320
    v_cvt_pk_bf16_f32 v40, v16, v17
    v_mfma_f32_16x16x32_bf16 v[28:31], a[120:123], v[88:91], v[28:31]
    v_exp_f32 v19, v19
    v_mfma_f32_16x16x32_bf16 v[28:31], a[124:127], v[92:95], v[28:31]
    ds_read_b64_tr_b16 a[148:149], v2 offset:576
    v_mfma_f32_16x16x32_bf16 v[128:131], a[192:195], v[32:35], v[128:131]
    v_exp_f32 v20, v20
    v_mfma_f32_16x16x32_bf16 v[128:131], a[196:199], v[36:39], v[128:131]
    ds_read_b64_tr_b16 a[150:151], v2 offset:832
    v_cvt_pk_bf16_f32 v41, v18, v19
    v_mfma_f32_16x16x32_bf16 v[132:135], a[200:203], v[32:35], v[132:135]
    s_mov_b32 s54, 147456
    v_exp_f32 v21, v21
    v_mfma_f32_16x16x32_bf16 v[132:135], a[204:207], v[36:39], v[132:135]
    buffer_load_dwordx4 a[24:27], v6, s[64:67], s54 offen
    v_mfma_f32_16x16x32_bf16 v[136:139], a[208:211], v[32:35], v[136:139]
    v_exp_f32 v22, v22
    v_mfma_f32_16x16x32_bf16 v[136:139], a[212:215], v[36:39], v[136:139]
    ds_read_b64_tr_b16 a[152:153], v2 offset:96
    v_cvt_pk_bf16_f32 v42, v20, v21
    v_mfma_f32_16x16x32_bf16 v[140:143], a[216:219], v[32:35], v[140:143]
    v_exp_f32 v23, v23
    v_mfma_f32_16x16x32_bf16 v[140:143], a[220:223], v[36:39], v[140:143]
    ds_read_b64_tr_b16 a[154:155], v2 offset:352
    v_mfma_f32_16x16x32_bf16 v[144:147], a[224:227], v[32:35], v[144:147]
    v_exp_f32 v24, v24
    v_mfma_f32_16x16x32_bf16 v[144:147], a[228:231], v[36:39], v[144:147]
    ds_read_b64_tr_b16 a[156:157], v2 offset:608
    v_cvt_pk_bf16_f32 v43, v22, v23
    v_mfma_f32_16x16x32_bf16 v[148:151], a[232:235], v[32:35], v[148:151]
    s_mov_b32 s54, 294912
    v_exp_f32 v25, v25
    v_mfma_f32_16x16x32_bf16 v[148:151], a[236:239], v[36:39], v[148:151]
    buffer_load_dwordx4 a[28:31], v6, s[64:67], s54 offen
    v_mfma_f32_16x16x32_bf16 v[152:155], a[240:243], v[32:35], v[152:155]
    v_exp_f32 v26, v26
    v_mfma_f32_16x16x32_bf16 v[152:155], a[244:247], v[36:39], v[152:155]
    ds_read_b64_tr_b16 a[158:159], v2 offset:864
    v_cvt_pk_bf16_f32 v44, v24, v25
    v_mfma_f32_16x16x32_bf16 v[156:159], a[248:251], v[32:35], v[156:159]
    v_exp_f32 v27, v27
    v_mfma_f32_16x16x32_bf16 v[156:159], a[252:255], v[36:39], v[156:159]
    ds_read_b64_tr_b16 a[160:161], v2 offset:128
    v_smfmac_f32_16x16x64_bf16 a[0:3], a[16:19], v[32:39], v11
    ds_read_b64_tr_b16 a[162:163], v2 offset:384
    v_mfma_f32_16x16x32_bf16 v[16:19], a[64:67], v[96:99], v[56:59]
    v_exp_f32 v28, v28
    v_mfma_f32_16x16x32_bf16 v[16:19], a[68:71], v[100:103], v[16:19]
    ds_read_b64_tr_b16 a[164:165], v2 offset:640
    v_cvt_pk_bf16_f32 v45, v26, v27
    v_mfma_f32_16x16x32_bf16 v[16:19], a[72:75], v[104:107], v[16:19]
    v_exp_f32 v29, v29
    v_mfma_f32_16x16x32_bf16 v[16:19], a[76:79], v[108:111], v[16:19]
    ds_read_b64_tr_b16 a[166:167], v2 offset:896
    v_mfma_f32_16x16x32_bf16 v[20:23], a[80:83], v[96:99], v[56:59]
    v_exp_f32 v30, v30
    v_mfma_f32_16x16x32_bf16 v[20:23], a[84:87], v[100:103], v[20:23]
    ds_read_b64_tr_b16 a[168:169], v2 offset:160
    v_cvt_pk_bf16_f32 v46, v28, v29
    v_mfma_f32_16x16x32_bf16 v[20:23], a[88:91], v[104:107], v[20:23]
    v_exp_f32 v31, v31
    v_mfma_f32_16x16x32_bf16 v[20:23], a[92:95], v[108:111], v[20:23]
    ds_read_b64_tr_b16 a[170:171], v2 offset:416
    v_mfma_f32_16x16x32_bf16 v[24:27], a[96:99], v[96:99], v[56:59]
    v_exp_f32 v16, v16
    v_mfma_f32_16x16x32_bf16 v[24:27], a[100:103], v[100:103], v[24:27]
    ds_read_b64_tr_b16 a[172:173], v2 offset:672
    v_cvt_pk_bf16_f32 v47, v30, v31
    v_mfma_f32_16x16x32_bf16 v[24:27], a[104:107], v[104:107], v[24:27]
    v_exp_f32 v17, v17
    v_mfma_f32_16x16x32_bf16 v[24:27], a[108:111], v[108:111], v[24:27]
    ds_read_b64_tr_b16 a[174:175], v2 offset:928
    v_mfma_f32_16x16x32_bf16 v[28:31], a[112:115], v[96:99], v[56:59]
    v_exp_f32 v18, v18
    v_mfma_f32_16x16x32_bf16 v[28:31], a[116:119], v[100:103], v[28:31]
    ds_read_b64_tr_b16 a[176:177], v2 offset:192
    v_cvt_pk_bf16_f32 v32, v16, v17
    v_mfma_f32_16x16x32_bf16 v[28:31], a[120:123], v[104:107], v[28:31]
    v_exp_f32 v19, v19
    v_mfma_f32_16x16x32_bf16 v[28:31], a[124:127], v[108:111], v[28:31]
    ds_read_b64_tr_b16 a[178:179], v2 offset:448
    v_mfma_f32_16x16x32_bf16 v[160:163], a[192:195], v[40:43], v[160:163]
    v_exp_f32 v20, v20
    v_mfma_f32_16x16x32_bf16 v[160:163], a[196:199], v[44:47], v[160:163]
    ds_read_b64_tr_b16 a[180:181], v2 offset:704
    v_cvt_pk_bf16_f32 v33, v18, v19
    v_mfma_f32_16x16x32_bf16 v[164:167], a[200:203], v[40:43], v[164:167]
    v_exp_f32 v21, v21
    v_mfma_f32_16x16x32_bf16 v[164:167], a[204:207], v[44:47], v[164:167]
    ds_read_b64_tr_b16 a[182:183], v2 offset:960
    v_mfma_f32_16x16x32_bf16 v[168:171], a[208:211], v[40:43], v[168:171]
    v_exp_f32 v22, v22
    v_mfma_f32_16x16x32_bf16 v[168:171], a[212:215], v[44:47], v[168:171]
    ds_read_b64_tr_b16 a[184:185], v2 offset:224
    v_cvt_pk_bf16_f32 v34, v20, v21
    v_mfma_f32_16x16x32_bf16 v[172:175], a[216:219], v[40:43], v[172:175]
    v_exp_f32 v23, v23
    v_mfma_f32_16x16x32_bf16 v[172:175], a[220:223], v[44:47], v[172:175]
    ds_read_b64_tr_b16 a[186:187], v2 offset:480
    v_mfma_f32_16x16x32_bf16 v[176:179], a[224:227], v[40:43], v[176:179]
    v_exp_f32 v24, v24
    v_mfma_f32_16x16x32_bf16 v[176:179], a[228:231], v[44:47], v[176:179]
    ds_read_b64_tr_b16 a[188:189], v2 offset:736
    v_cvt_pk_bf16_f32 v35, v22, v23
    v_mfma_f32_16x16x32_bf16 v[180:183], a[232:235], v[40:43], v[180:183]
    v_exp_f32 v25, v25
    v_mfma_f32_16x16x32_bf16 v[180:183], a[236:239], v[44:47], v[180:183]
    ds_read_b64_tr_b16 a[190:191], v2 offset:992
    v_mfma_f32_16x16x32_bf16 v[184:187], a[240:243], v[40:43], v[184:187]
    v_exp_f32 v26, v26
    v_mfma_f32_16x16x32_bf16 v[184:187], a[244:247], v[44:47], v[184:187]
    v_cvt_pk_bf16_f32 v36, v24, v25
    v_mfma_f32_16x16x32_bf16 v[188:191], a[248:251], v[40:43], v[188:191]
    v_exp_f32 v27, v27
    v_mfma_f32_16x16x32_bf16 v[188:191], a[252:255], v[44:47], v[188:191]
    v_smfmac_f32_16x16x64_bf16 a[4:7], a[16:19], v[40:47], v11
    v_mfma_f32_16x16x32_bf16 v[16:19], a[64:67], v[112:115], v[60:63]
    v_exp_f32 v28, v28
    v_mfma_f32_16x16x32_bf16 v[16:19], a[68:71], v[116:119], v[16:19]
    s_add_u32 s46, s46, 16384
    ds_read_b128 a[64:67], v1 offset:0
    v_cvt_pk_bf16_f32 v37, v26, v27
    v_mfma_f32_16x16x32_bf16 v[16:19], a[72:75], v[120:123], v[16:19]
    v_exp_f32 v29, v29
    v_mfma_f32_16x16x32_bf16 v[16:19], a[76:79], v[124:127], v[16:19]
    ds_read_b128 a[68:71], v1 offset:64
    v_mfma_f32_16x16x32_bf16 v[20:23], a[80:83], v[112:115], v[60:63]
    v_exp_f32 v30, v30
    v_mfma_f32_16x16x32_bf16 v[20:23], a[84:87], v[116:119], v[20:23]
    ds_read_b128 a[72:75], v1 offset:128
    v_cvt_pk_bf16_f32 v38, v28, v29
    v_mfma_f32_16x16x32_bf16 v[20:23], a[88:91], v[120:123], v[20:23]
    v_exp_f32 v31, v31
    v_mfma_f32_16x16x32_bf16 v[20:23], a[92:95], v[124:127], v[20:23]
    ds_read_b128 a[76:79], v1 offset:192
    v_mfma_f32_16x16x32_bf16 v[24:27], a[96:99], v[112:115], v[60:63]
    v_exp_f32 v16, v16
    v_mfma_f32_16x16x32_bf16 v[24:27], a[100:103], v[116:119], v[24:27]
    ds_read_b128 a[80:83], v1 offset:256
    v_cvt_pk_bf16_f32 v39, v30, v31
    v_mfma_f32_16x16x32_bf16 v[24:27], a[104:107], v[120:123], v[24:27]
    v_exp_f32 v17, v17
    v_mfma_f32_16x16x32_bf16 v[24:27], a[108:111], v[124:127], v[24:27]
    ds_read_b128 a[84:87], v1 offset:320
    v_mfma_f32_16x16x32_bf16 v[28:31], a[112:115], v[112:115], v[60:63]
    v_exp_f32 v18, v18
    v_mfma_f32_16x16x32_bf16 v[28:31], a[116:119], v[116:119], v[28:31]
    ds_read_b128 a[88:91], v1 offset:384
    v_cvt_pk_bf16_f32 v40, v16, v17
    v_mfma_f32_16x16x32_bf16 v[28:31], a[120:123], v[120:123], v[28:31]
    v_exp_f32 v19, v19
    v_mfma_f32_16x16x32_bf16 v[28:31], a[124:127], v[124:127], v[28:31]
    ds_read_b128 a[92:95], v1 offset:448
    v_mfma_f32_16x16x32_bf16 v[192:195], a[192:195], v[32:35], v[192:195]
    v_exp_f32 v20, v20
    v_mfma_f32_16x16x32_bf16 v[192:195], a[196:199], v[36:39], v[192:195]
    ds_read_b128 a[96:99], v1 offset:512
    v_cvt_pk_bf16_f32 v41, v18, v19
    v_mfma_f32_16x16x32_bf16 v[196:199], a[200:203], v[32:35], v[196:199]
    v_exp_f32 v21, v21
    v_mfma_f32_16x16x32_bf16 v[196:199], a[204:207], v[36:39], v[196:199]
    ds_read_b128 a[100:103], v1 offset:576
    v_mfma_f32_16x16x32_bf16 v[200:203], a[208:211], v[32:35], v[200:203]
    v_exp_f32 v22, v22
    v_mfma_f32_16x16x32_bf16 v[200:203], a[212:215], v[36:39], v[200:203]
    ds_read_b128 a[104:107], v1 offset:640
    v_cvt_pk_bf16_f32 v42, v20, v21
    v_mfma_f32_16x16x32_bf16 v[204:207], a[216:219], v[32:35], v[204:207]
    v_exp_f32 v23, v23
    v_mfma_f32_16x16x32_bf16 v[204:207], a[220:223], v[36:39], v[204:207]
    ds_read_b128 a[108:111], v1 offset:704
    v_mfma_f32_16x16x32_bf16 v[208:211], a[224:227], v[32:35], v[208:211]
    v_exp_f32 v24, v24
    v_mfma_f32_16x16x32_bf16 v[208:211], a[228:231], v[36:39], v[208:211]
    ds_read_b128 a[112:115], v1 offset:768
    v_cvt_pk_bf16_f32 v43, v22, v23
    v_mfma_f32_16x16x32_bf16 v[212:215], a[232:235], v[32:35], v[212:215]
    v_exp_f32 v25, v25
    v_mfma_f32_16x16x32_bf16 v[212:215], a[236:239], v[36:39], v[212:215]
    ds_read_b128 a[116:119], v1 offset:832
    v_mfma_f32_16x16x32_bf16 v[216:219], a[240:243], v[32:35], v[216:219]
    v_exp_f32 v26, v26
    v_mfma_f32_16x16x32_bf16 v[216:219], a[244:247], v[36:39], v[216:219]
    ds_read_b128 a[120:123], v1 offset:896
    v_cvt_pk_bf16_f32 v44, v24, v25
    v_mfma_f32_16x16x32_bf16 v[220:223], a[248:251], v[32:35], v[220:223]
    v_exp_f32 v27, v27
    v_mfma_f32_16x16x32_bf16 v[220:223], a[252:255], v[36:39], v[220:223]
    ds_read_b128 a[124:127], v1 offset:960
    v_smfmac_f32_16x16x64_bf16 a[8:11], a[16:19], v[32:39], v11
    s_waitcnt vmcnt(12) lgkmcnt(12)
    s_barrier
    v_mfma_f32_16x16x32_bf16 v[16:19], a[64:67], v[64:67], v[48:51]
    v_exp_f32 v28, v28
    v_mfma_f32_16x16x32_bf16 v[16:19], a[68:71], v[68:71], v[16:19]
    v_cvt_pk_bf16_f32 v45, v26, v27
    v_mfma_f32_16x16x32_bf16 v[16:19], a[72:75], v[72:75], v[16:19]
    s_add_u32 m0, s47, 36864
    v_exp_f32 v29, v29
    v_mfma_f32_16x16x32_bf16 v[16:19], a[76:79], v[76:79], v[16:19]
    s_waitcnt lgkmcnt(8)
    buffer_load_dwordx4 v5, s[16:19], s46 offen offset:0 lds
    v_mfma_f32_16x16x32_bf16 v[20:23], a[80:83], v[64:67], v[48:51]
    v_exp_f32 v30, v30
    v_mfma_f32_16x16x32_bf16 v[20:23], a[84:87], v[68:71], v[20:23]
    v_cvt_pk_bf16_f32 v46, v28, v29
    v_mfma_f32_16x16x32_bf16 v[20:23], a[88:91], v[72:75], v[20:23]
    s_add_u32 m0, s47, 36896
    v_exp_f32 v31, v31
    v_mfma_f32_16x16x32_bf16 v[20:23], a[92:95], v[76:79], v[20:23]
    s_waitcnt lgkmcnt(4)
    buffer_load_dwordx4 v5, s[16:19], s46 offen offset:1024 lds
    v_mfma_f32_16x16x32_bf16 v[24:27], a[96:99], v[64:67], v[48:51]
    v_exp_f32 v16, v16
    v_mfma_f32_16x16x32_bf16 v[24:27], a[100:103], v[68:71], v[24:27]
    v_cvt_pk_bf16_f32 v47, v30, v31
    v_mfma_f32_16x16x32_bf16 v[24:27], a[104:107], v[72:75], v[24:27]
    s_add_u32 m0, s47, 36928
    v_exp_f32 v17, v17
    v_mfma_f32_16x16x32_bf16 v[24:27], a[108:111], v[76:79], v[24:27]
    s_waitcnt lgkmcnt(0)
    buffer_load_dwordx4 v5, s[16:19], s46 offen offset:2048 lds
    v_mfma_f32_16x16x32_bf16 v[28:31], a[112:115], v[64:67], v[48:51]
    v_exp_f32 v18, v18
    v_mfma_f32_16x16x32_bf16 v[28:31], a[116:119], v[68:71], v[28:31]
    v_cvt_pk_bf16_f32 v32, v16, v17
    v_mfma_f32_16x16x32_bf16 v[28:31], a[120:123], v[72:75], v[28:31]
    s_add_u32 m0, s47, 36960
    v_exp_f32 v19, v19
    v_mfma_f32_16x16x32_bf16 v[28:31], a[124:127], v[76:79], v[28:31]
    buffer_load_dwordx4 v5, s[16:19], s46 offen offset:3072 lds
    v_mfma_f32_16x16x32_bf16 v[224:227], a[192:195], v[40:43], v[224:227]
    v_exp_f32 v20, v20
    v_mfma_f32_16x16x32_bf16 v[224:227], a[196:199], v[44:47], v[224:227]
    ds_read_b64_tr_b16 a[192:193], v2 offset:36864
    v_cvt_pk_bf16_f32 v33, v18, v19
    v_mfma_f32_16x16x32_bf16 v[228:231], a[200:203], v[40:43], v[228:231]
    s_add_u32 m0, s47, 53760
    v_exp_f32 v21, v21
    v_mfma_f32_16x16x32_bf16 v[228:231], a[204:207], v[44:47], v[228:231]
    buffer_load_dwordx4 v5, s[20:23], s46 offen offset:0 lds
    v_mfma_f32_16x16x32_bf16 v[232:235], a[208:211], v[40:43], v[232:235]
    v_exp_f32 v22, v22
    v_mfma_f32_16x16x32_bf16 v[232:235], a[212:215], v[44:47], v[232:235]
    ds_read_b64_tr_b16 a[194:195], v2 offset:37120
    v_cvt_pk_bf16_f32 v34, v20, v21
    v_mfma_f32_16x16x32_bf16 v[236:239], a[216:219], v[40:43], v[236:239]
    s_add_u32 m0, s47, 53792
    v_exp_f32 v23, v23
    v_mfma_f32_16x16x32_bf16 v[236:239], a[220:223], v[44:47], v[236:239]
    buffer_load_dwordx4 v5, s[20:23], s46 offen offset:1024 lds
    v_mfma_f32_16x16x32_bf16 v[240:243], a[224:227], v[40:43], v[240:243]
    v_exp_f32 v24, v24
    v_mfma_f32_16x16x32_bf16 v[240:243], a[228:231], v[44:47], v[240:243]
    ds_read_b64_tr_b16 a[196:197], v2 offset:37376
    v_cvt_pk_bf16_f32 v35, v22, v23
    v_mfma_f32_16x16x32_bf16 v[244:247], a[232:235], v[40:43], v[244:247]
    s_add_u32 m0, s47, 53824
    v_exp_f32 v25, v25
    v_mfma_f32_16x16x32_bf16 v[244:247], a[236:239], v[44:47], v[244:247]
    buffer_load_dwordx4 v5, s[20:23], s46 offen offset:2048 lds
    v_mfma_f32_16x16x32_bf16 v[248:251], a[240:243], v[40:43], v[248:251]
    v_exp_f32 v26, v26
    v_mfma_f32_16x16x32_bf16 v[248:251], a[244:247], v[44:47], v[248:251]
    ds_read_b64_tr_b16 a[198:199], v2 offset:37632
    v_cvt_pk_bf16_f32 v36, v24, v25
    v_mfma_f32_16x16x32_bf16 v[252:255], a[248:251], v[40:43], v[252:255]
    s_add_u32 m0, s47, 53856
    v_exp_f32 v27, v27
    v_mfma_f32_16x16x32_bf16 v[252:255], a[252:255], v[44:47], v[252:255]
    buffer_load_dwordx4 v5, s[20:23], s46 offen offset:3072 lds
    v_smfmac_f32_16x16x64_bf16 a[12:15], a[16:19], v[40:47], v11
    ds_read_b64_tr_b16 a[200:201], v2 offset:36896
    v_mfma_f32_16x16x32_bf16 v[16:19], a[64:67], v[80:83], v[52:55]
    v_exp_f32 v28, v28
    v_mfma_f32_16x16x32_bf16 v[16:19], a[68:71], v[84:87], v[16:19]
    ds_read_b64_tr_b16 a[202:203], v2 offset:37152
    v_cvt_pk_bf16_f32 v37, v26, v27
    v_mfma_f32_16x16x32_bf16 v[16:19], a[72:75], v[88:91], v[16:19]
    v_exp_f32 v29, v29
    v_mfma_f32_16x16x32_bf16 v[16:19], a[76:79], v[92:95], v[16:19]
    global_load_dword a63, v15, s[10:11]
    v_mfma_f32_16x16x32_bf16 v[20:23], a[80:83], v[80:83], v[52:55]
    v_exp_f32 v30, v30
    v_mfma_f32_16x16x32_bf16 v[20:23], a[84:87], v[84:87], v[20:23]
    ds_read_b64_tr_b16 a[204:205], v2 offset:37408
    v_cvt_pk_bf16_f32 v38, v28, v29
    v_mfma_f32_16x16x32_bf16 v[20:23], a[88:91], v[88:91], v[20:23]
    v_exp_f32 v31, v31
    v_mfma_f32_16x16x32_bf16 v[20:23], a[92:95], v[92:95], v[20:23]
    ds_read_b64_tr_b16 a[206:207], v2 offset:37664
    v_mfma_f32_16x16x32_bf16 v[24:27], a[96:99], v[80:83], v[52:55]
    v_exp_f32 v16, v16
    v_mfma_f32_16x16x32_bf16 v[24:27], a[100:103], v[84:87], v[24:27]
    ds_read_b64_tr_b16 a[208:209], v2 offset:36928
    v_cvt_pk_bf16_f32 v39, v30, v31
    v_mfma_f32_16x16x32_bf16 v[24:27], a[104:107], v[88:91], v[24:27]
    s_mov_b32 s54, 442368
    v_exp_f32 v17, v17
    v_mfma_f32_16x16x32_bf16 v[24:27], a[108:111], v[92:95], v[24:27]
    buffer_load_dwordx4 a[32:35], v6, s[64:67], s54 offen
    v_mfma_f32_16x16x32_bf16 v[28:31], a[112:115], v[80:83], v[52:55]
    v_exp_f32 v18, v18
    v_mfma_f32_16x16x32_bf16 v[28:31], a[116:119], v[84:87], v[28:31]
    ds_read_b64_tr_b16 a[210:211], v2 offset:37184
    v_cvt_pk_bf16_f32 v40, v16, v17
    v_mfma_f32_16x16x32_bf16 v[28:31], a[120:123], v[88:91], v[28:31]
    v_exp_f32 v19, v19
    v_mfma_f32_16x16x32_bf16 v[28:31], a[124:127], v[92:95], v[28:31]
    ds_read_b64_tr_b16 a[212:213], v2 offset:37440
    v_mfma_f32_16x16x32_bf16 v[128:131], a[128:131], v[32:35], v[128:131]
    v_exp_f32 v20, v20
    v_mfma_f32_16x16x32_bf16 v[128:131], a[132:135], v[36:39], v[128:131]
    ds_read_b64_tr_b16 a[214:215], v2 offset:37696
    v_cvt_pk_bf16_f32 v41, v18, v19
    v_mfma_f32_16x16x32_bf16 v[132:135], a[136:139], v[32:35], v[132:135]
    s_mov_b32 s54, 589824
    v_exp_f32 v21, v21
    v_mfma_f32_16x16x32_bf16 v[132:135], a[140:143], v[36:39], v[132:135]
    buffer_load_dwordx4 a[36:39], v6, s[64:67], s54 offen
    v_mfma_f32_16x16x32_bf16 v[136:139], a[144:147], v[32:35], v[136:139]
    v_exp_f32 v22, v22
    v_mfma_f32_16x16x32_bf16 v[136:139], a[148:151], v[36:39], v[136:139]
    ds_read_b64_tr_b16 a[216:217], v2 offset:36960
    v_cvt_pk_bf16_f32 v42, v20, v21
    v_mfma_f32_16x16x32_bf16 v[140:143], a[152:155], v[32:35], v[140:143]
    v_exp_f32 v23, v23
    v_mfma_f32_16x16x32_bf16 v[140:143], a[156:159], v[36:39], v[140:143]
    ds_read_b64_tr_b16 a[218:219], v2 offset:37216
    v_mfma_f32_16x16x32_bf16 v[144:147], a[160:163], v[32:35], v[144:147]
    v_exp_f32 v24, v24
    v_mfma_f32_16x16x32_bf16 v[144:147], a[164:167], v[36:39], v[144:147]
    ds_read_b64_tr_b16 a[220:221], v2 offset:37472
    v_cvt_pk_bf16_f32 v43, v22, v23
    v_mfma_f32_16x16x32_bf16 v[148:151], a[168:171], v[32:35], v[148:151]
    s_mov_b32 s54, 737280
    v_exp_f32 v25, v25
    v_mfma_f32_16x16x32_bf16 v[148:151], a[172:175], v[36:39], v[148:151]
    buffer_load_dwordx4 a[40:43], v6, s[64:67], s54 offen
    v_mfma_f32_16x16x32_bf16 v[152:155], a[176:179], v[32:35], v[152:155]
    v_exp_f32 v26, v26
    v_mfma_f32_16x16x32_bf16 v[152:155], a[180:183], v[36:39], v[152:155]
    ds_read_b64_tr_b16 a[222:223], v2 offset:37728
    v_cvt_pk_bf16_f32 v44, v24, v25
    v_mfma_f32_16x16x32_bf16 v[156:159], a[184:187], v[32:35], v[156:159]
    v_exp_f32 v27, v27
    v_mfma_f32_16x16x32_bf16 v[156:159], a[188:191], v[36:39], v[156:159]
    ds_read_b64_tr_b16 a[224:225], v2 offset:36992
    v_smfmac_f32_16x16x64_bf16 a[0:3], a[16:19], v[32:39], v11
    ds_read_b64_tr_b16 a[226:227], v2 offset:37248
    v_mfma_f32_16x16x32_bf16 v[16:19], a[64:67], v[96:99], v[56:59]
    v_exp_f32 v28, v28
    v_mfma_f32_16x16x32_bf16 v[16:19], a[68:71], v[100:103], v[16:19]
    ds_read_b64_tr_b16 a[228:229], v2 offset:37504
    v_cvt_pk_bf16_f32 v45, v26, v27
    v_mfma_f32_16x16x32_bf16 v[16:19], a[72:75], v[104:107], v[16:19]
    v_exp_f32 v29, v29
    v_mfma_f32_16x16x32_bf16 v[16:19], a[76:79], v[108:111], v[16:19]
    ds_read_b64_tr_b16 a[230:231], v2 offset:37760
    v_mfma_f32_16x16x32_bf16 v[20:23], a[80:83], v[96:99], v[56:59]
    v_exp_f32 v30, v30
    v_mfma_f32_16x16x32_bf16 v[20:23], a[84:87], v[100:103], v[20:23]
    ds_read_b64_tr_b16 a[232:233], v2 offset:37024
    v_cvt_pk_bf16_f32 v46, v28, v29
    v_mfma_f32_16x16x32_bf16 v[20:23], a[88:91], v[104:107], v[20:23]
    v_exp_f32 v31, v31
    v_mfma_f32_16x16x32_bf16 v[20:23], a[92:95], v[108:111], v[20:23]
    ds_read_b64_tr_b16 a[234:235], v2 offset:37280
    v_mfma_f32_16x16x32_bf16 v[24:27], a[96:99], v[96:99], v[56:59]
    v_exp_f32 v16, v16
    v_mfma_f32_16x16x32_bf16 v[24:27], a[100:103], v[100:103], v[24:27]
    ds_read_b64_tr_b16 a[236:237], v2 offset:37536
    v_cvt_pk_bf16_f32 v47, v30, v31
    v_mfma_f32_16x16x32_bf16 v[24:27], a[104:107], v[104:107], v[24:27]
    v_exp_f32 v17, v17
    v_mfma_f32_16x16x32_bf16 v[24:27], a[108:111], v[108:111], v[24:27]
    ds_read_b64_tr_b16 a[238:239], v2 offset:37792
    v_mfma_f32_16x16x32_bf16 v[28:31], a[112:115], v[96:99], v[56:59]
    v_exp_f32 v18, v18
    v_mfma_f32_16x16x32_bf16 v[28:31], a[116:119], v[100:103], v[28:31]
    ds_read_b64_tr_b16 a[240:241], v2 offset:37056
    v_cvt_pk_bf16_f32 v32, v16, v17
    v_mfma_f32_16x16x32_bf16 v[28:31], a[120:123], v[104:107], v[28:31]
    v_exp_f32 v19, v19
    v_mfma_f32_16x16x32_bf16 v[28:31], a[124:127], v[108:111], v[28:31]
    ds_read_b64_tr_b16 a[242:243], v2 offset:37312
    v_mfma_f32_16x16x32_bf16 v[160:163], a[128:131], v[40:43], v[160:163]
    v_exp_f32 v20, v20
    v_mfma_f32_16x16x32_bf16 v[160:163], a[132:135], v[44:47], v[160:163]
    ds_read_b64_tr_b16 a[244:245], v2 offset:37568
    v_cvt_pk_bf16_f32 v33, v18, v19
    v_mfma_f32_16x16x32_bf16 v[164:167], a[136:139], v[40:43], v[164:167]
    v_exp_f32 v21, v21
    v_mfma_f32_16x16x32_bf16 v[164:167], a[140:143], v[44:47], v[164:167]
    ds_read_b64_tr_b16 a[246:247], v2 offset:37824
    v_mfma_f32_16x16x32_bf16 v[168:171], a[144:147], v[40:43], v[168:171]
    v_exp_f32 v22, v22
    v_mfma_f32_16x16x32_bf16 v[168:171], a[148:151], v[44:47], v[168:171]
    ds_read_b64_tr_b16 a[248:249], v2 offset:37088
    v_cvt_pk_bf16_f32 v34, v20, v21
    v_mfma_f32_16x16x32_bf16 v[172:175], a[152:155], v[40:43], v[172:175]
    v_exp_f32 v23, v23
    v_mfma_f32_16x16x32_bf16 v[172:175], a[156:159], v[44:47], v[172:175]
    ds_read_b64_tr_b16 a[250:251], v2 offset:37344
    v_mfma_f32_16x16x32_bf16 v[176:179], a[160:163], v[40:43], v[176:179]
    v_exp_f32 v24, v24
    v_mfma_f32_16x16x32_bf16 v[176:179], a[164:167], v[44:47], v[176:179]
    ds_read_b64_tr_b16 a[252:253], v2 offset:37600
    v_cvt_pk_bf16_f32 v35, v22, v23
    v_mfma_f32_16x16x32_bf16 v[180:183], a[168:171], v[40:43], v[180:183]
    v_exp_f32 v25, v25
    v_mfma_f32_16x16x32_bf16 v[180:183], a[172:175], v[44:47], v[180:183]
    ds_read_b64_tr_b16 a[254:255], v2 offset:37856
    v_mfma_f32_16x16x32_bf16 v[184:187], a[176:179], v[40:43], v[184:187]
    v_exp_f32 v26, v26
    v_mfma_f32_16x16x32_bf16 v[184:187], a[180:183], v[44:47], v[184:187]
    v_cvt_pk_bf16_f32 v36, v24, v25
    v_mfma_f32_16x16x32_bf16 v[188:191], a[184:187], v[40:43], v[188:191]
    v_exp_f32 v27, v27
    v_mfma_f32_16x16x32_bf16 v[188:191], a[188:191], v[44:47], v[188:191]
    v_smfmac_f32_16x16x64_bf16 a[4:7], a[16:19], v[40:47], v11
    v_mfma_f32_16x16x32_bf16 v[16:19], a[64:67], v[112:115], v[60:63]
    v_exp_f32 v28, v28
    v_mfma_f32_16x16x32_bf16 v[16:19], a[68:71], v[116:119], v[16:19]
    s_add_u32 s46, s46, 16384
    ds_read_b128 a[64:67], v1 offset:36864
    v_cvt_pk_bf16_f32 v37, v26, v27
    v_mfma_f32_16x16x32_bf16 v[16:19], a[72:75], v[120:123], v[16:19]
    v_exp_f32 v29, v29
    v_mfma_f32_16x16x32_bf16 v[16:19], a[76:79], v[124:127], v[16:19]
    ds_read_b128 a[68:71], v1 offset:36928
    v_mfma_f32_16x16x32_bf16 v[20:23], a[80:83], v[112:115], v[60:63]
    v_exp_f32 v30, v30
    v_mfma_f32_16x16x32_bf16 v[20:23], a[84:87], v[116:119], v[20:23]
    ds_read_b128 a[72:75], v1 offset:36992
    v_cvt_pk_bf16_f32 v38, v28, v29
    v_mfma_f32_16x16x32_bf16 v[20:23], a[88:91], v[120:123], v[20:23]
    v_exp_f32 v31, v31
    v_mfma_f32_16x16x32_bf16 v[20:23], a[92:95], v[124:127], v[20:23]
    ds_read_b128 a[76:79], v1 offset:37056
    v_mfma_f32_16x16x32_bf16 v[24:27], a[96:99], v[112:115], v[60:63]
    v_exp_f32 v16, v16
    v_mfma_f32_16x16x32_bf16 v[24:27], a[100:103], v[116:119], v[24:27]
L2_pad6:
    s_cbranch_execz L2_pad10
    ds_read_b128 a[80:83], v1 offset:37120
    v_cvt_pk_bf16_f32 v39, v30, v31
    v_mfma_f32_16x16x32_bf16 v[24:27], a[104:107], v[120:123], v[24:27]
    v_exp_f32 v17, v17
    v_mfma_f32_16x16x32_bf16 v[24:27], a[108:111], v[124:127], v[24:27]
    ds_read_b128 a[84:87], v1 offset:37184
    v_mfma_f32_16x16x32_bf16 v[28:31], a[112:115], v[112:115], v[60:63]
    v_exp_f32 v18, v18
    v_mfma_f32_16x16x32_bf16 v[28:31], a[116:119], v[116:119], v[28:31]
    ds_read_b128 a[88:91], v1 offset:37248
    v_cvt_pk_bf16_f32 v40, v16, v17
    v_mfma_f32_16x16x32_bf16 v[28:31], a[120:123], v[120:123], v[28:31]
    v_exp_f32 v19, v19
    v_mfma_f32_16x16x32_bf16 v[28:31], a[124:127], v[124:127], v[28:31]
    ds_read_b128 a[92:95], v1 offset:37312
    v_mfma_f32_16x16x32_bf16 v[192:195], a[128:131], v[32:35], v[192:195]
    v_exp_f32 v20, v20
    v_mfma_f32_16x16x32_bf16 v[192:195], a[132:135], v[36:39], v[192:195]
    ds_read_b128 a[96:99], v1 offset:37376
    v_cvt_pk_bf16_f32 v41, v18, v19
    v_mfma_f32_16x16x32_bf16 v[196:199], a[136:139], v[32:35], v[196:199]
    v_exp_f32 v21, v21
    v_mfma_f32_16x16x32_bf16 v[196:199], a[140:143], v[36:39], v[196:199]
    ds_read_b128 a[100:103], v1 offset:37440
    v_mfma_f32_16x16x32_bf16 v[200:203], a[144:147], v[32:35], v[200:203]
    v_exp_f32 v22, v22
    v_mfma_f32_16x16x32_bf16 v[200:203], a[148:151], v[36:39], v[200:203]
    ds_read_b128 a[104:107], v1 offset:37504
    v_cvt_pk_bf16_f32 v42, v20, v21
    v_mfma_f32_16x16x32_bf16 v[204:207], a[152:155], v[32:35], v[204:207]
    v_exp_f32 v23, v23
    v_mfma_f32_16x16x32_bf16 v[204:207], a[156:159], v[36:39], v[204:207]
    ds_read_b128 a[108:111], v1 offset:37568
    v_mfma_f32_16x16x32_bf16 v[208:211], a[160:163], v[32:35], v[208:211]
    v_exp_f32 v24, v24
    v_mfma_f32_16x16x32_bf16 v[208:211], a[164:167], v[36:39], v[208:211]
    ds_read_b128 a[112:115], v1 offset:37632
    v_cvt_pk_bf16_f32 v43, v22, v23
    v_mfma_f32_16x16x32_bf16 v[212:215], a[168:171], v[32:35], v[212:215]
    v_exp_f32 v25, v25
    v_mfma_f32_16x16x32_bf16 v[212:215], a[172:175], v[36:39], v[212:215]
    ds_read_b128 a[116:119], v1 offset:37696
    v_mfma_f32_16x16x32_bf16 v[216:219], a[176:179], v[32:35], v[216:219]
    v_exp_f32 v26, v26
    v_mfma_f32_16x16x32_bf16 v[216:219], a[180:183], v[36:39], v[216:219]
    ds_read_b128 a[120:123], v1 offset:37760
    v_cvt_pk_bf16_f32 v44, v24, v25
    v_mfma_f32_16x16x32_bf16 v[220:223], a[184:187], v[32:35], v[220:223]
    v_exp_f32 v27, v27
    v_mfma_f32_16x16x32_bf16 v[220:223], a[188:191], v[36:39], v[220:223]
    ds_read_b128 a[124:127], v1 offset:37824
    v_smfmac_f32_16x16x64_bf16 a[8:11], a[16:19], v[32:39], v11
    s_waitcnt vmcnt(16) lgkmcnt(12)
    s_barrier
    v_mfma_f32_16x16x32_bf16 v[16:19], a[64:67], v[64:67], v[48:51]
    s_sub_u32 s47, s47, s48
    v_exp_f32 v28, v28
    v_mfma_f32_16x16x32_bf16 v[16:19], a[68:71], v[68:71], v[16:19]
    v_cvt_pk_bf16_f32 v45, v26, v27
    v_add_u32 v1, s48, v1
    v_mfma_f32_16x16x32_bf16 v[16:19], a[72:75], v[72:75], v[16:19]
    s_add_u32 m0, s47, 0
    v_exp_f32 v29, v29
    v_mfma_f32_16x16x32_bf16 v[16:19], a[76:79], v[76:79], v[16:19]
    s_waitcnt lgkmcnt(8)
    buffer_load_dwordx4 v5, s[16:19], s46 offen offset:0 lds
    v_mfma_f32_16x16x32_bf16 v[20:23], a[80:83], v[64:67], v[48:51]
    v_exp_f32 v30, v30
    v_mfma_f32_16x16x32_bf16 v[20:23], a[84:87], v[68:71], v[20:23]
    v_cvt_pk_bf16_f32 v46, v28, v29
    v_add_u32 v2, s48, v2
    v_mfma_f32_16x16x32_bf16 v[20:23], a[88:91], v[72:75], v[20:23]
    s_add_u32 m0, s47, 32
    v_exp_f32 v31, v31
    v_mfma_f32_16x16x32_bf16 v[20:23], a[92:95], v[76:79], v[20:23]
    s_waitcnt lgkmcnt(4)
    buffer_load_dwordx4 v5, s[16:19], s46 offen offset:1024 lds
    v_mfma_f32_16x16x32_bf16 v[24:27], a[96:99], v[64:67], v[48:51]
    s_sub_u32 s48, 0, s48
    v_exp_f32 v16, v16
    v_mfma_f32_16x16x32_bf16 v[24:27], a[100:103], v[68:71], v[24:27]
    v_cvt_pk_bf16_f32 v47, v30, v31
    v_mfma_f32_16x16x32_bf16 v[24:27], a[104:107], v[72:75], v[24:27]
    s_add_u32 m0, s47, 64
    v_exp_f32 v17, v17
    v_mfma_f32_16x16x32_bf16 v[24:27], a[108:111], v[76:79], v[24:27]
    s_waitcnt lgkmcnt(0)
    buffer_load_dwordx4 v5, s[16:19], s46 offen offset:2048 lds
    v_mfma_f32_16x16x32_bf16 v[28:31], a[112:115], v[64:67], v[48:51]
    v_exp_f32 v18, v18
    v_mfma_f32_16x16x32_bf16 v[28:31], a[116:119], v[68:71], v[28:31]
    v_cvt_pk_bf16_f32 v32, v16, v17
    v_mfma_f32_16x16x32_bf16 v[28:31], a[120:123], v[72:75], v[28:31]
    s_add_u32 m0, s47, 96
    v_exp_f32 v19, v19
    v_mfma_f32_16x16x32_bf16 v[28:31], a[124:127], v[76:79], v[28:31]
    buffer_load_dwordx4 v5, s[16:19], s46 offen offset:3072 lds
    v_mfma_f32_16x16x32_bf16 v[224:227], a[128:131], v[40:43], v[224:227]
    v_exp_f32 v20, v20
    v_mfma_f32_16x16x32_bf16 v[224:227], a[132:135], v[44:47], v[224:227]
    ds_read_b64_tr_b16 a[128:129], v2 offset:0
    v_cvt_pk_bf16_f32 v33, v18, v19
    v_mfma_f32_16x16x32_bf16 v[228:231], a[136:139], v[40:43], v[228:231]
    s_add_u32 m0, s47, 16896
    v_exp_f32 v21, v21
    v_mfma_f32_16x16x32_bf16 v[228:231], a[140:143], v[44:47], v[228:231]
    buffer_load_dwordx4 v5, s[20:23], s46 offen offset:0 lds
    v_mfma_f32_16x16x32_bf16 v[232:235], a[144:147], v[40:43], v[232:235]
    v_exp_f32 v22, v22
    v_mfma_f32_16x16x32_bf16 v[232:235], a[148:151], v[44:47], v[232:235]
    ds_read_b64_tr_b16 a[130:131], v2 offset:256
    v_cvt_pk_bf16_f32 v34, v20, v21
    v_mfma_f32_16x16x32_bf16 v[236:239], a[152:155], v[40:43], v[236:239]
    s_add_u32 m0, s47, 16928
    v_exp_f32 v23, v23
    v_mfma_f32_16x16x32_bf16 v[236:239], a[156:159], v[44:47], v[236:239]
    buffer_load_dwordx4 v5, s[20:23], s46 offen offset:1024 lds
    v_mfma_f32_16x16x32_bf16 v[240:243], a[160:163], v[40:43], v[240:243]
    v_exp_f32 v24, v24
    v_mfma_f32_16x16x32_bf16 v[240:243], a[164:167], v[44:47], v[240:243]
    ds_read_b64_tr_b16 a[132:133], v2 offset:512
    v_cvt_pk_bf16_f32 v35, v22, v23
    v_mfma_f32_16x16x32_bf16 v[244:247], a[168:171], v[40:43], v[244:247]
    s_add_u32 m0, s47, 16960
    v_exp_f32 v25, v25
    v_mfma_f32_16x16x32_bf16 v[244:247], a[172:175], v[44:47], v[244:247]
    buffer_load_dwordx4 v5, s[20:23], s46 offen offset:2048 lds
    v_mfma_f32_16x16x32_bf16 v[248:251], a[176:179], v[40:43], v[248:251]
    v_exp_f32 v26, v26
    v_mfma_f32_16x16x32_bf16 v[248:251], a[180:183], v[44:47], v[248:251]
    ds_read_b64_tr_b16 a[134:135], v2 offset:768
    v_cvt_pk_bf16_f32 v36, v24, v25
    v_mfma_f32_16x16x32_bf16 v[252:255], a[184:187], v[40:43], v[252:255]
    s_add_u32 m0, s47, 16992
    v_exp_f32 v27, v27
    v_mfma_f32_16x16x32_bf16 v[252:255], a[188:191], v[44:47], v[252:255]
    buffer_load_dwordx4 v5, s[20:23], s46 offen offset:3072 lds
    v_smfmac_f32_16x16x64_bf16 a[12:15], a[16:19], v[40:47], v11
    ds_read_b64_tr_b16 a[136:137], v2 offset:32
    v_mfma_f32_16x16x32_bf16 v[16:19], a[64:67], v[80:83], v[52:55]
    v_exp_f32 v28, v28
    v_mfma_f32_16x16x32_bf16 v[16:19], a[68:71], v[84:87], v[16:19]
    ds_read_b64_tr_b16 a[138:139], v2 offset:288
    v_cvt_pk_bf16_f32 v37, v26, v27
    v_mfma_f32_16x16x32_bf16 v[16:19], a[72:75], v[88:91], v[16:19]
    v_exp_f32 v29, v29
    v_mfma_f32_16x16x32_bf16 v[16:19], a[76:79], v[92:95], v[16:19]
    global_load_dword a63, v12, s[6:7]
    v_mfma_f32_16x16x32_bf16 v[20:23], a[80:83], v[80:83], v[52:55]
    v_exp_f32 v30, v30
    v_mfma_f32_16x16x32_bf16 v[20:23], a[84:87], v[84:87], v[20:23]
    ds_read_b64_tr_b16 a[140:141], v2 offset:544
    v_cvt_pk_bf16_f32 v38, v28, v29
    v_mfma_f32_16x16x32_bf16 v[20:23], a[88:91], v[88:91], v[20:23]
    v_exp_f32 v31, v31
    v_mfma_f32_16x16x32_bf16 v[20:23], a[92:95], v[92:95], v[20:23]
    ds_read_b64_tr_b16 a[142:143], v2 offset:800
    v_mfma_f32_16x16x32_bf16 v[24:27], a[96:99], v[80:83], v[52:55]
    v_exp_f32 v16, v16
    v_mfma_f32_16x16x32_bf16 v[24:27], a[100:103], v[84:87], v[24:27]
    ds_read_b64_tr_b16 a[144:145], v2 offset:64
    v_cvt_pk_bf16_f32 v39, v30, v31
    v_mfma_f32_16x16x32_bf16 v[24:27], a[104:107], v[88:91], v[24:27]
    s_mov_b32 s54, 884736
    v_exp_f32 v17, v17
    v_mfma_f32_16x16x32_bf16 v[24:27], a[108:111], v[92:95], v[24:27]
    buffer_load_dwordx4 a[44:47], v6, s[64:67], s54 offen
    v_mfma_f32_16x16x32_bf16 v[28:31], a[112:115], v[80:83], v[52:55]
    v_exp_f32 v18, v18
    v_mfma_f32_16x16x32_bf16 v[28:31], a[116:119], v[84:87], v[28:31]
    ds_read_b64_tr_b16 a[146:147], v2 offset:320
    v_cvt_pk_bf16_f32 v40, v16, v17
    v_mfma_f32_16x16x32_bf16 v[28:31], a[120:123], v[88:91], v[28:31]
    v_exp_f32 v19, v19
    v_mfma_f32_16x16x32_bf16 v[28:31], a[124:127], v[92:95], v[28:31]
    ds_read_b64_tr_b16 a[148:149], v2 offset:576
    v_mfma_f32_16x16x32_bf16 v[128:131], a[192:195], v[32:35], v[128:131]
    v_exp_f32 v20, v20
    v_mfma_f32_16x16x32_bf16 v[128:131], a[196:199], v[36:39], v[128:131]
    ds_read_b64_tr_b16 a[150:151], v2 offset:832
    v_cvt_pk_bf16_f32 v41, v18, v19
    v_mfma_f32_16x16x32_bf16 v[132:135], a[200:203], v[32:35], v[132:135]
    s_mov_b32 s54, 1032192
    v_exp_f32 v21, v21
    v_mfma_f32_16x16x32_bf16 v[132:135], a[204:207], v[36:39], v[132:135]
    buffer_load_dwordx4 a[48:51], v6, s[64:67], s54 offen
    v_mfma_f32_16x16x32_bf16 v[136:139], a[208:211], v[32:35], v[136:139]
    v_exp_f32 v22, v22
    v_mfma_f32_16x16x32_bf16 v[136:139], a[212:215], v[36:39], v[136:139]
    ds_read_b64_tr_b16 a[152:153], v2 offset:96
    v_cvt_pk_bf16_f32 v42, v20, v21
    v_mfma_f32_16x16x32_bf16 v[140:143], a[216:219], v[32:35], v[140:143]
    v_exp_f32 v23, v23
    v_mfma_f32_16x16x32_bf16 v[140:143], a[220:223], v[36:39], v[140:143]
    ds_read_b64_tr_b16 a[154:155], v2 offset:352
    v_mfma_f32_16x16x32_bf16 v[144:147], a[224:227], v[32:35], v[144:147]
    v_exp_f32 v24, v24
    v_mfma_f32_16x16x32_bf16 v[144:147], a[228:231], v[36:39], v[144:147]
    ds_read_b64_tr_b16 a[156:157], v2 offset:608
    v_cvt_pk_bf16_f32 v43, v22, v23
    v_mfma_f32_16x16x32_bf16 v[148:151], a[232:235], v[32:35], v[148:151]
    s_mov_b32 s54, 1179648
    v_exp_f32 v25, v25
    v_mfma_f32_16x16x32_bf16 v[148:151], a[236:239], v[36:39], v[148:151]
    buffer_load_dwordx4 a[52:55], v6, s[64:67], s54 offen
    v_mfma_f32_16x16x32_bf16 v[152:155], a[240:243], v[32:35], v[152:155]
    v_exp_f32 v26, v26
    v_mfma_f32_16x16x32_bf16 v[152:155], a[244:247], v[36:39], v[152:155]
    ds_read_b64_tr_b16 a[158:159], v2 offset:864
    v_cvt_pk_bf16_f32 v44, v24, v25
    v_mfma_f32_16x16x32_bf16 v[156:159], a[248:251], v[32:35], v[156:159]
    v_exp_f32 v27, v27
    v_mfma_f32_16x16x32_bf16 v[156:159], a[252:255], v[36:39], v[156:159]
    ds_read_b64_tr_b16 a[160:161], v2 offset:128
    v_smfmac_f32_16x16x64_bf16 a[0:3], a[16:19], v[32:39], v11
    ds_read_b64_tr_b16 a[162:163], v2 offset:384
    v_mfma_f32_16x16x32_bf16 v[16:19], a[64:67], v[96:99], v[56:59]
    v_exp_f32 v28, v28
    v_mfma_f32_16x16x32_bf16 v[16:19], a[68:71], v[100:103], v[16:19]
    ds_read_b64_tr_b16 a[164:165], v2 offset:640
    v_cvt_pk_bf16_f32 v45, v26, v27
    v_mfma_f32_16x16x32_bf16 v[16:19], a[72:75], v[104:107], v[16:19]
    v_exp_f32 v29, v29
    v_mfma_f32_16x16x32_bf16 v[16:19], a[76:79], v[108:111], v[16:19]
    ds_read_b64_tr_b16 a[166:167], v2 offset:896
    v_mfma_f32_16x16x32_bf16 v[20:23], a[80:83], v[96:99], v[56:59]
    v_exp_f32 v30, v30
    v_mfma_f32_16x16x32_bf16 v[20:23], a[84:87], v[100:103], v[20:23]
    ds_read_b64_tr_b16 a[168:169], v2 offset:160
    v_cvt_pk_bf16_f32 v46, v28, v29
    v_mfma_f32_16x16x32_bf16 v[20:23], a[88:91], v[104:107], v[20:23]
    v_exp_f32 v31, v31
    v_mfma_f32_16x16x32_bf16 v[20:23], a[92:95], v[108:111], v[20:23]
    ds_read_b64_tr_b16 a[170:171], v2 offset:416
    v_mfma_f32_16x16x32_bf16 v[24:27], a[96:99], v[96:99], v[56:59]
    v_exp_f32 v16, v16
    v_mfma_f32_16x16x32_bf16 v[24:27], a[100:103], v[100:103], v[24:27]
    ds_read_b64_tr_b16 a[172:173], v2 offset:672
    v_cvt_pk_bf16_f32 v47, v30, v31
    v_mfma_f32_16x16x32_bf16 v[24:27], a[104:107], v[104:107], v[24:27]
    v_exp_f32 v17, v17
    v_mfma_f32_16x16x32_bf16 v[24:27], a[108:111], v[108:111], v[24:27]
    ds_read_b64_tr_b16 a[174:175], v2 offset:928
    v_mfma_f32_16x16x32_bf16 v[28:31], a[112:115], v[96:99], v[56:59]
    v_exp_f32 v18, v18
    v_mfma_f32_16x16x32_bf16 v[28:31], a[116:119], v[100:103], v[28:31]
    ds_read_b64_tr_b16 a[176:177], v2 offset:192
    v_cvt_pk_bf16_f32 v32, v16, v17
    v_mfma_f32_16x16x32_bf16 v[28:31], a[120:123], v[104:107], v[28:31]
    v_exp_f32 v19, v19
    v_mfma_f32_16x16x32_bf16 v[28:31], a[124:127], v[108:111], v[28:31]
    ds_read_b64_tr_b16 a[178:179], v2 offset:448
    v_mfma_f32_16x16x32_bf16 v[160:163], a[192:195], v[40:43], v[160:163]
    v_exp_f32 v20, v20
    v_mfma_f32_16x16x32_bf16 v[160:163], a[196:199], v[44:47], v[160:163]
    ds_read_b64_tr_b16 a[180:181], v2 offset:704
    v_cvt_pk_bf16_f32 v33, v18, v19
    v_mfma_f32_16x16x32_bf16 v[164:167], a[200:203], v[40:43], v[164:167]
    v_exp_f32 v21, v21
    v_mfma_f32_16x16x32_bf16 v[164:167], a[204:207], v[44:47], v[164:167]
    ds_read_b64_tr_b16 a[182:183], v2 offset:960
    v_mfma_f32_16x16x32_bf16 v[168:171], a[208:211], v[40:43], v[168:171]
    v_exp_f32 v22, v22
    v_mfma_f32_16x16x32_bf16 v[168:171], a[212:215], v[44:47], v[168:171]
    ds_read_b64_tr_b16 a[184:185], v2 offset:224
    v_cvt_pk_bf16_f32 v34, v20, v21
    v_mfma_f32_16x16x32_bf16 v[172:175], a[216:219], v[40:43], v[172:175]
    v_exp_f32 v23, v23
    v_mfma_f32_16x16x32_bf16 v[172:175], a[220:223], v[44:47], v[172:175]
    ds_read_b64_tr_b16 a[186:187], v2 offset:480
    v_mfma_f32_16x16x32_bf16 v[176:179], a[224:227], v[40:43], v[176:179]
    v_exp_f32 v24, v24
    v_mfma_f32_16x16x32_bf16 v[176:179], a[228:231], v[44:47], v[176:179]
    ds_read_b64_tr_b16 a[188:189], v2 offset:736
    v_cvt_pk_bf16_f32 v35, v22, v23
    v_mfma_f32_16x16x32_bf16 v[180:183], a[232:235], v[40:43], v[180:183]
    v_exp_f32 v25, v25
    v_mfma_f32_16x16x32_bf16 v[180:183], a[236:239], v[44:47], v[180:183]
    ds_read_b64_tr_b16 a[190:191], v2 offset:992
    v_mfma_f32_16x16x32_bf16 v[184:187], a[240:243], v[40:43], v[184:187]
    v_exp_f32 v26, v26
    v_mfma_f32_16x16x32_bf16 v[184:187], a[244:247], v[44:47], v[184:187]
    v_cvt_pk_bf16_f32 v36, v24, v25
    v_mfma_f32_16x16x32_bf16 v[188:191], a[248:251], v[40:43], v[188:191]
    v_exp_f32 v27, v27
    v_mfma_f32_16x16x32_bf16 v[188:191], a[252:255], v[44:47], v[188:191]
    v_smfmac_f32_16x16x64_bf16 a[4:7], a[16:19], v[40:47], v11
    v_mfma_f32_16x16x32_bf16 v[16:19], a[64:67], v[112:115], v[60:63]
    v_exp_f32 v28, v28
    v_mfma_f32_16x16x32_bf16 v[16:19], a[68:71], v[116:119], v[16:19]
    s_add_u32 s46, s46, 16384
    ds_read_b128 a[64:67], v1 offset:0
    v_cvt_pk_bf16_f32 v37, v26, v27
    v_mfma_f32_16x16x32_bf16 v[16:19], a[72:75], v[120:123], v[16:19]
    v_exp_f32 v29, v29
    v_mfma_f32_16x16x32_bf16 v[16:19], a[76:79], v[124:127], v[16:19]
    ds_read_b128 a[68:71], v1 offset:64
    v_mfma_f32_16x16x32_bf16 v[20:23], a[80:83], v[112:115], v[60:63]
    v_exp_f32 v30, v30
    v_mfma_f32_16x16x32_bf16 v[20:23], a[84:87], v[116:119], v[20:23]
    ds_read_b128 a[72:75], v1 offset:128
    v_cvt_pk_bf16_f32 v38, v28, v29
    v_mfma_f32_16x16x32_bf16 v[20:23], a[88:91], v[120:123], v[20:23]
    v_exp_f32 v31, v31
    v_mfma_f32_16x16x32_bf16 v[20:23], a[92:95], v[124:127], v[20:23]
    ds_read_b128 a[76:79], v1 offset:192
    v_mfma_f32_16x16x32_bf16 v[24:27], a[96:99], v[112:115], v[60:63]
    v_exp_f32 v16, v16
    v_mfma_f32_16x16x32_bf16 v[24:27], a[100:103], v[116:119], v[24:27]
    ds_read_b128 a[80:83], v1 offset:256
    v_cvt_pk_bf16_f32 v39, v30, v31
    v_mfma_f32_16x16x32_bf16 v[24:27], a[104:107], v[120:123], v[24:27]
    v_exp_f32 v17, v17
    v_mfma_f32_16x16x32_bf16 v[24:27], a[108:111], v[124:127], v[24:27]
    ds_read_b128 a[84:87], v1 offset:320
    v_mfma_f32_16x16x32_bf16 v[28:31], a[112:115], v[112:115], v[60:63]
    v_exp_f32 v18, v18
    v_mfma_f32_16x16x32_bf16 v[28:31], a[116:119], v[116:119], v[28:31]
    ds_read_b128 a[88:91], v1 offset:384
    v_cvt_pk_bf16_f32 v40, v16, v17
    v_mfma_f32_16x16x32_bf16 v[28:31], a[120:123], v[120:123], v[28:31]
    v_exp_f32 v19, v19
    v_mfma_f32_16x16x32_bf16 v[28:31], a[124:127], v[124:127], v[28:31]
    ds_read_b128 a[92:95], v1 offset:448
    v_mfma_f32_16x16x32_bf16 v[192:195], a[192:195], v[32:35], v[192:195]
    v_exp_f32 v20, v20
    v_mfma_f32_16x16x32_bf16 v[192:195], a[196:199], v[36:39], v[192:195]
    ds_read_b128 a[96:99], v1 offset:512
    v_cvt_pk_bf16_f32 v41, v18, v19
    v_mfma_f32_16x16x32_bf16 v[196:199], a[200:203], v[32:35], v[196:199]
    v_exp_f32 v21, v21
    v_mfma_f32_16x16x32_bf16 v[196:199], a[204:207], v[36:39], v[196:199]
    ds_read_b128 a[100:103], v1 offset:576
    v_mfma_f32_16x16x32_bf16 v[200:203], a[208:211], v[32:35], v[200:203]
    v_exp_f32 v22, v22
    v_mfma_f32_16x16x32_bf16 v[200:203], a[212:215], v[36:39], v[200:203]
    ds_read_b128 a[104:107], v1 offset:640
    v_cvt_pk_bf16_f32 v42, v20, v21
    v_mfma_f32_16x16x32_bf16 v[204:207], a[216:219], v[32:35], v[204:207]
    v_exp_f32 v23, v23
    v_mfma_f32_16x16x32_bf16 v[204:207], a[220:223], v[36:39], v[204:207]
    ds_read_b128 a[108:111], v1 offset:704
    v_mfma_f32_16x16x32_bf16 v[208:211], a[224:227], v[32:35], v[208:211]
    v_exp_f32 v24, v24
    v_mfma_f32_16x16x32_bf16 v[208:211], a[228:231], v[36:39], v[208:211]
    ds_read_b128 a[112:115], v1 offset:768
    v_cvt_pk_bf16_f32 v43, v22, v23
    v_mfma_f32_16x16x32_bf16 v[212:215], a[232:235], v[32:35], v[212:215]
    v_exp_f32 v25, v25
    v_mfma_f32_16x16x32_bf16 v[212:215], a[236:239], v[36:39], v[212:215]
    ds_read_b128 a[116:119], v1 offset:832
    v_mfma_f32_16x16x32_bf16 v[216:219], a[240:243], v[32:35], v[216:219]
    v_exp_f32 v26, v26
    v_mfma_f32_16x16x32_bf16 v[216:219], a[244:247], v[36:39], v[216:219]
    ds_read_b128 a[120:123], v1 offset:896
    v_cvt_pk_bf16_f32 v44, v24, v25
    v_mfma_f32_16x16x32_bf16 v[220:223], a[248:251], v[32:35], v[220:223]
    v_exp_f32 v27, v27
    v_mfma_f32_16x16x32_bf16 v[220:223], a[252:255], v[36:39], v[220:223]
    ds_read_b128 a[124:127], v1 offset:960
    v_smfmac_f32_16x16x64_bf16 a[8:11], a[16:19], v[32:39], v11
    s_waitcnt vmcnt(16) lgkmcnt(12)
    s_barrier
    v_mfma_f32_16x16x32_bf16 v[16:19], a[64:67], v[64:67], v[48:51]
    v_exp_f32 v28, v28
    v_mfma_f32_16x16x32_bf16 v[16:19], a[68:71], v[68:71], v[16:19]
    v_cvt_pk_bf16_f32 v45, v26, v27
    v_mfma_f32_16x16x32_bf16 v[16:19], a[72:75], v[72:75], v[16:19]
    s_add_u32 m0, s47, 36864
    v_exp_f32 v29, v29
    v_mfma_f32_16x16x32_bf16 v[16:19], a[76:79], v[76:79], v[16:19]
    s_waitcnt lgkmcnt(8)
    buffer_load_dwordx4 v5, s[16:19], s46 offen offset:0 lds
    v_mfma_f32_16x16x32_bf16 v[20:23], a[80:83], v[64:67], v[48:51]
    v_exp_f32 v30, v30
    v_mfma_f32_16x16x32_bf16 v[20:23], a[84:87], v[68:71], v[20:23]
    v_cvt_pk_bf16_f32 v46, v28, v29
    v_mfma_f32_16x16x32_bf16 v[20:23], a[88:91], v[72:75], v[20:23]
    s_add_u32 m0, s47, 36896
    v_exp_f32 v31, v31
    v_mfma_f32_16x16x32_bf16 v[20:23], a[92:95], v[76:79], v[20:23]
    s_waitcnt lgkmcnt(4)
    buffer_load_dwordx4 v5, s[16:19], s46 offen offset:1024 lds
    v_mfma_f32_16x16x32_bf16 v[24:27], a[96:99], v[64:67], v[48:51]
    v_exp_f32 v16, v16
    v_mfma_f32_16x16x32_bf16 v[24:27], a[100:103], v[68:71], v[24:27]
    v_cvt_pk_bf16_f32 v47, v30, v31
    v_mfma_f32_16x16x32_bf16 v[24:27], a[104:107], v[72:75], v[24:27]
    s_add_u32 m0, s47, 36928
    v_exp_f32 v17, v17
    v_mfma_f32_16x16x32_bf16 v[24:27], a[108:111], v[76:79], v[24:27]
    s_waitcnt lgkmcnt(0)
    buffer_load_dwordx4 v5, s[16:19], s46 offen offset:2048 lds
    v_mfma_f32_16x16x32_bf16 v[28:31], a[112:115], v[64:67], v[48:51]
    v_exp_f32 v18, v18
    v_mfma_f32_16x16x32_bf16 v[28:31], a[116:119], v[68:71], v[28:31]
    v_cvt_pk_bf16_f32 v32, v16, v17
    v_mfma_f32_16x16x32_bf16 v[28:31], a[120:123], v[72:75], v[28:31]
    s_add_u32 m0, s47, 36960
    v_exp_f32 v19, v19
    v_mfma_f32_16x16x32_bf16 v[28:31], a[124:127], v[76:79], v[28:31]
    buffer_load_dwordx4 v5, s[16:19], s46 offen offset:3072 lds
    v_mfma_f32_16x16x32_bf16 v[224:227], a[192:195], v[40:43], v[224:227]
    v_exp_f32 v20, v20
    v_mfma_f32_16x16x32_bf16 v[224:227], a[196:199], v[44:47], v[224:227]
    ds_read_b64_tr_b16 a[192:193], v2 offset:36864
    v_cvt_pk_bf16_f32 v33, v18, v19
    v_mfma_f32_16x16x32_bf16 v[228:231], a[200:203], v[40:43], v[228:231]
    s_add_u32 m0, s47, 53760
    v_exp_f32 v21, v21
    v_mfma_f32_16x16x32_bf16 v[228:231], a[204:207], v[44:47], v[228:231]
    buffer_load_dwordx4 v5, s[20:23], s46 offen offset:0 lds
    v_mfma_f32_16x16x32_bf16 v[232:235], a[208:211], v[40:43], v[232:235]
    v_exp_f32 v22, v22
    v_mfma_f32_16x16x32_bf16 v[232:235], a[212:215], v[44:47], v[232:235]
    ds_read_b64_tr_b16 a[194:195], v2 offset:37120
    v_cvt_pk_bf16_f32 v34, v20, v21
    v_mfma_f32_16x16x32_bf16 v[236:239], a[216:219], v[40:43], v[236:239]
    s_add_u32 m0, s47, 53792
    v_exp_f32 v23, v23
    v_mfma_f32_16x16x32_bf16 v[236:239], a[220:223], v[44:47], v[236:239]
    buffer_load_dwordx4 v5, s[20:23], s46 offen offset:1024 lds
    v_mfma_f32_16x16x32_bf16 v[240:243], a[224:227], v[40:43], v[240:243]
    v_exp_f32 v24, v24
    v_mfma_f32_16x16x32_bf16 v[240:243], a[228:231], v[44:47], v[240:243]
    ds_read_b64_tr_b16 a[196:197], v2 offset:37376
    v_cvt_pk_bf16_f32 v35, v22, v23
    v_mfma_f32_16x16x32_bf16 v[244:247], a[232:235], v[40:43], v[244:247]
    s_add_u32 m0, s47, 53824
    v_exp_f32 v25, v25
    v_mfma_f32_16x16x32_bf16 v[244:247], a[236:239], v[44:47], v[244:247]
    buffer_load_dwordx4 v5, s[20:23], s46 offen offset:2048 lds
    v_mfma_f32_16x16x32_bf16 v[248:251], a[240:243], v[40:43], v[248:251]
    v_exp_f32 v26, v26
    v_mfma_f32_16x16x32_bf16 v[248:251], a[244:247], v[44:47], v[248:251]
    ds_read_b64_tr_b16 a[198:199], v2 offset:37632
    v_cvt_pk_bf16_f32 v36, v24, v25
    v_mfma_f32_16x16x32_bf16 v[252:255], a[248:251], v[40:43], v[252:255]
    s_add_u32 m0, s47, 53856
    v_exp_f32 v27, v27
    v_mfma_f32_16x16x32_bf16 v[252:255], a[252:255], v[44:47], v[252:255]
    buffer_load_dwordx4 v5, s[20:23], s46 offen offset:3072 lds
    v_smfmac_f32_16x16x64_bf16 a[12:15], a[16:19], v[40:47], v11
    ds_read_b64_tr_b16 a[200:201], v2 offset:36896
    v_mfma_f32_16x16x32_bf16 v[16:19], a[64:67], v[80:83], v[52:55]
    v_exp_f32 v28, v28
    v_mfma_f32_16x16x32_bf16 v[16:19], a[68:71], v[84:87], v[16:19]
    ds_read_b64_tr_b16 a[202:203], v2 offset:37152
    v_cvt_pk_bf16_f32 v37, v26, v27
    v_mfma_f32_16x16x32_bf16 v[16:19], a[72:75], v[88:91], v[16:19]
    v_exp_f32 v29, v29
    v_mfma_f32_16x16x32_bf16 v[16:19], a[76:79], v[92:95], v[16:19]
    global_load_dword a63, v13, s[8:9]
    v_mfma_f32_16x16x32_bf16 v[20:23], a[80:83], v[80:83], v[52:55]
    v_exp_f32 v30, v30
    v_mfma_f32_16x16x32_bf16 v[20:23], a[84:87], v[84:87], v[20:23]
    ds_read_b64_tr_b16 a[204:205], v2 offset:37408
    v_cvt_pk_bf16_f32 v38, v28, v29
    v_mfma_f32_16x16x32_bf16 v[20:23], a[88:91], v[88:91], v[20:23]
    v_exp_f32 v31, v31
    v_mfma_f32_16x16x32_bf16 v[20:23], a[92:95], v[92:95], v[20:23]
    ds_read_b64_tr_b16 a[206:207], v2 offset:37664
    v_mfma_f32_16x16x32_bf16 v[24:27], a[96:99], v[80:83], v[52:55]
    v_exp_f32 v16, v16
    v_mfma_f32_16x16x32_bf16 v[24:27], a[100:103], v[84:87], v[24:27]
    ds_read_b64_tr_b16 a[208:209], v2 offset:36928
    v_cvt_pk_bf16_f32 v39, v30, v31
    v_mfma_f32_16x16x32_bf16 v[24:27], a[104:107], v[88:91], v[24:27]
    v_exp_f32 v17, v17
    v_mfma_f32_16x16x32_bf16 v[24:27], a[108:111], v[92:95], v[24:27]
    ds_read_b64_tr_b16 a[210:211], v2 offset:37184
    v_mfma_f32_16x16x32_bf16 v[28:31], a[112:115], v[80:83], v[52:55]
    v_exp_f32 v18, v18
    v_mfma_f32_16x16x32_bf16 v[28:31], a[116:119], v[84:87], v[28:31]
    ds_read_b64_tr_b16 a[212:213], v2 offset:37440
    v_cvt_pk_bf16_f32 v40, v16, v17
    v_mfma_f32_16x16x32_bf16 v[28:31], a[120:123], v[88:91], v[28:31]
    v_exp_f32 v19, v19
    v_mfma_f32_16x16x32_bf16 v[28:31], a[124:127], v[92:95], v[28:31]
    ds_read_b64_tr_b16 a[214:215], v2 offset:37696
    v_mfma_f32_16x16x32_bf16 v[128:131], a[128:131], v[32:35], v[128:131]
    v_exp_f32 v20, v20
    v_mfma_f32_16x16x32_bf16 v[128:131], a[132:135], v[36:39], v[128:131]
    ds_read_b64_tr_b16 a[216:217], v2 offset:36960
    v_cvt_pk_bf16_f32 v41, v18, v19
    v_mfma_f32_16x16x32_bf16 v[132:135], a[136:139], v[32:35], v[132:135]
    v_exp_f32 v21, v21
    v_mfma_f32_16x16x32_bf16 v[132:135], a[140:143], v[36:39], v[132:135]
    ds_read_b64_tr_b16 a[218:219], v2 offset:37216
    v_mfma_f32_16x16x32_bf16 v[136:139], a[144:147], v[32:35], v[136:139]
    v_exp_f32 v22, v22
    v_mfma_f32_16x16x32_bf16 v[136:139], a[148:151], v[36:39], v[136:139]
    ds_read_b64_tr_b16 a[220:221], v2 offset:37472
    v_cvt_pk_bf16_f32 v42, v20, v21
    v_mfma_f32_16x16x32_bf16 v[140:143], a[152:155], v[32:35], v[140:143]
    v_exp_f32 v23, v23
    v_mfma_f32_16x16x32_bf16 v[140:143], a[156:159], v[36:39], v[140:143]
    ds_read_b64_tr_b16 a[222:223], v2 offset:37728
    v_mfma_f32_16x16x32_bf16 v[144:147], a[160:163], v[32:35], v[144:147]
    v_exp_f32 v24, v24
    v_mfma_f32_16x16x32_bf16 v[144:147], a[164:167], v[36:39], v[144:147]
    ds_read_b64_tr_b16 a[224:225], v2 offset:36992
    v_cvt_pk_bf16_f32 v43, v22, v23
    v_mfma_f32_16x16x32_bf16 v[148:151], a[168:171], v[32:35], v[148:151]
    v_exp_f32 v25, v25
    v_mfma_f32_16x16x32_bf16 v[148:151], a[172:175], v[36:39], v[148:151]
    ds_read_b64_tr_b16 a[226:227], v2 offset:37248
    v_mfma_f32_16x16x32_bf16 v[152:155], a[176:179], v[32:35], v[152:155]
    v_exp_f32 v26, v26
    v_mfma_f32_16x16x32_bf16 v[152:155], a[180:183], v[36:39], v[152:155]
    ds_read_b64_tr_b16 a[228:229], v2 offset:37504
    v_cvt_pk_bf16_f32 v44, v24, v25
    v_mfma_f32_16x16x32_bf16 v[156:159], a[184:187], v[32:35], v[156:159]
    v_exp_f32 v27, v27
    v_mfma_f32_16x16x32_bf16 v[156:159], a[188:191], v[36:39], v[156:159]
    ds_read_b64_tr_b16 a[230:231], v2 offset:37760
    v_smfmac_f32_16x16x64_bf16 a[0:3], a[16:19], v[32:39], v11
    ds_read_b64_tr_b16 a[232:233], v2 offset:37024
    v_mfma_f32_16x16x32_bf16 v[16:19], a[64:67], v[96:99], v[56:59]
    v_exp_f32 v28, v28
    v_mfma_f32_16x16x32_bf16 v[16:19], a[68:71], v[100:103], v[16:19]
    ds_read_b64_tr_b16 a[234:235], v2 offset:37280
    v_cvt_pk_bf16_f32 v45, v26, v27
    v_mfma_f32_16x16x32_bf16 v[16:19], a[72:75], v[104:107], v[16:19]
    v_exp_f32 v29, v29
    v_mfma_f32_16x16x32_bf16 v[16:19], a[76:79], v[108:111], v[16:19]
    ds_read_b64_tr_b16 a[236:237], v2 offset:37536
    v_mfma_f32_16x16x32_bf16 v[20:23], a[80:83], v[96:99], v[56:59]
    v_exp_f32 v30, v30
    v_mfma_f32_16x16x32_bf16 v[20:23], a[84:87], v[100:103], v[20:23]
    ds_read_b64_tr_b16 a[238:239], v2 offset:37792
    v_cvt_pk_bf16_f32 v46, v28, v29
    v_mfma_f32_16x16x32_bf16 v[20:23], a[88:91], v[104:107], v[20:23]
    v_exp_f32 v31, v31
    v_mfma_f32_16x16x32_bf16 v[20:23], a[92:95], v[108:111], v[20:23]
    ds_read_b64_tr_b16 a[240:241], v2 offset:37056
    v_mfma_f32_16x16x32_bf16 v[24:27], a[96:99], v[96:99], v[56:59]
    v_exp_f32 v16, v16
    v_mfma_f32_16x16x32_bf16 v[24:27], a[100:103], v[100:103], v[24:27]
    ds_read_b64_tr_b16 a[242:243], v2 offset:37312
    v_cvt_pk_bf16_f32 v47, v30, v31
    v_mfma_f32_16x16x32_bf16 v[24:27], a[104:107], v[104:107], v[24:27]
    v_exp_f32 v17, v17
    v_mfma_f32_16x16x32_bf16 v[24:27], a[108:111], v[108:111], v[24:27]
    ds_read_b64_tr_b16 a[244:245], v2 offset:37568
    v_mfma_f32_16x16x32_bf16 v[28:31], a[112:115], v[96:99], v[56:59]
    v_exp_f32 v18, v18
    v_mfma_f32_16x16x32_bf16 v[28:31], a[116:119], v[100:103], v[28:31]
    ds_read_b64_tr_b16 a[246:247], v2 offset:37824
    v_cvt_pk_bf16_f32 v32, v16, v17
    v_mfma_f32_16x16x32_bf16 v[28:31], a[120:123], v[104:107], v[28:31]
    v_exp_f32 v19, v19
    v_mfma_f32_16x16x32_bf16 v[28:31], a[124:127], v[108:111], v[28:31]
    ds_read_b64_tr_b16 a[248:249], v2 offset:37088
    v_mfma_f32_16x16x32_bf16 v[160:163], a[128:131], v[40:43], v[160:163]
    v_exp_f32 v20, v20
    v_mfma_f32_16x16x32_bf16 v[160:163], a[132:135], v[44:47], v[160:163]
    ds_read_b64_tr_b16 a[250:251], v2 offset:37344
    v_cvt_pk_bf16_f32 v33, v18, v19
    v_mfma_f32_16x16x32_bf16 v[164:167], a[136:139], v[40:43], v[164:167]
    v_exp_f32 v21, v21
    v_mfma_f32_16x16x32_bf16 v[164:167], a[140:143], v[44:47], v[164:167]
    ds_read_b64_tr_b16 a[252:253], v2 offset:37600
    v_mfma_f32_16x16x32_bf16 v[168:171], a[144:147], v[40:43], v[168:171]
    v_exp_f32 v22, v22
    v_mfma_f32_16x16x32_bf16 v[168:171], a[148:151], v[44:47], v[168:171]
    ds_read_b64_tr_b16 a[254:255], v2 offset:37856
    v_cvt_pk_bf16_f32 v34, v20, v21
    v_mfma_f32_16x16x32_bf16 v[172:175], a[152:155], v[40:43], v[172:175]
    v_exp_f32 v23, v23
    v_mfma_f32_16x16x32_bf16 v[172:175], a[156:159], v[44:47], v[172:175]
    v_mfma_f32_16x16x32_bf16 v[176:179], a[160:163], v[40:43], v[176:179]
    v_exp_f32 v24, v24
    v_mfma_f32_16x16x32_bf16 v[176:179], a[164:167], v[44:47], v[176:179]
    v_cvt_pk_bf16_f32 v35, v22, v23
    v_mfma_f32_16x16x32_bf16 v[180:183], a[168:171], v[40:43], v[180:183]
    v_exp_f32 v25, v25
    v_mfma_f32_16x16x32_bf16 v[180:183], a[172:175], v[44:47], v[180:183]
    v_mfma_f32_16x16x32_bf16 v[184:187], a[176:179], v[40:43], v[184:187]
    v_exp_f32 v26, v26
    v_mfma_f32_16x16x32_bf16 v[184:187], a[180:183], v[44:47], v[184:187]
L2_pad7:
    s_cbranch_execz L2_pad11
    v_cvt_pk_bf16_f32 v36, v24, v25
    v_mfma_f32_16x16x32_bf16 v[188:191], a[184:187], v[40:43], v[188:191]
    v_exp_f32 v27, v27
    v_mfma_f32_16x16x32_bf16 v[188:191], a[188:191], v[44:47], v[188:191]
    v_smfmac_f32_16x16x64_bf16 a[4:7], a[16:19], v[40:47], v11
    v_mfma_f32_16x16x32_bf16 v[16:19], a[64:67], v[112:115], v[60:63]
    v_exp_f32 v28, v28
    v_mfma_f32_16x16x32_bf16 v[16:19], a[68:71], v[116:119], v[16:19]
    s_add_u32 s46, s46, 16384
    ds_read_b128 a[64:67], v1 offset:36864
    v_cvt_pk_bf16_f32 v37, v26, v27
    v_mfma_f32_16x16x32_bf16 v[16:19], a[72:75], v[120:123], v[16:19]
    v_exp_f32 v29, v29
    v_mfma_f32_16x16x32_bf16 v[16:19], a[76:79], v[124:127], v[16:19]
    ds_read_b128 a[68:71], v1 offset:36928
    v_mfma_f32_16x16x32_bf16 v[20:23], a[80:83], v[112:115], v[60:63]
    v_exp_f32 v30, v30
    v_mfma_f32_16x16x32_bf16 v[20:23], a[84:87], v[116:119], v[20:23]
    ds_read_b128 a[72:75], v1 offset:36992
    v_cvt_pk_bf16_f32 v38, v28, v29
    v_mfma_f32_16x16x32_bf16 v[20:23], a[88:91], v[120:123], v[20:23]
    v_exp_f32 v31, v31
    v_mfma_f32_16x16x32_bf16 v[20:23], a[92:95], v[124:127], v[20:23]
    ds_read_b128 a[76:79], v1 offset:37056
    v_mfma_f32_16x16x32_bf16 v[24:27], a[96:99], v[112:115], v[60:63]
    v_exp_f32 v16, v16
    v_mfma_f32_16x16x32_bf16 v[24:27], a[100:103], v[116:119], v[24:27]
    ds_read_b128 a[80:83], v1 offset:37120
    v_cvt_pk_bf16_f32 v39, v30, v31
    v_mfma_f32_16x16x32_bf16 v[24:27], a[104:107], v[120:123], v[24:27]
    v_exp_f32 v17, v17
    v_mfma_f32_16x16x32_bf16 v[24:27], a[108:111], v[124:127], v[24:27]
    ds_read_b128 a[84:87], v1 offset:37184
    v_mfma_f32_16x16x32_bf16 v[28:31], a[112:115], v[112:115], v[60:63]
    v_exp_f32 v18, v18
    v_mfma_f32_16x16x32_bf16 v[28:31], a[116:119], v[116:119], v[28:31]
    ds_read_b128 a[88:91], v1 offset:37248
    v_cvt_pk_bf16_f32 v40, v16, v17
    v_mfma_f32_16x16x32_bf16 v[28:31], a[120:123], v[120:123], v[28:31]
    v_exp_f32 v19, v19
    v_mfma_f32_16x16x32_bf16 v[28:31], a[124:127], v[124:127], v[28:31]
    ds_read_b128 a[92:95], v1 offset:37312
    v_mfma_f32_16x16x32_bf16 v[192:195], a[128:131], v[32:35], v[192:195]
    v_exp_f32 v20, v20
    v_mfma_f32_16x16x32_bf16 v[192:195], a[132:135], v[36:39], v[192:195]
    ds_read_b128 a[96:99], v1 offset:37376
    v_cvt_pk_bf16_f32 v41, v18, v19
    v_mfma_f32_16x16x32_bf16 v[196:199], a[136:139], v[32:35], v[196:199]
    v_exp_f32 v21, v21
    v_mfma_f32_16x16x32_bf16 v[196:199], a[140:143], v[36:39], v[196:199]
    ds_read_b128 a[100:103], v1 offset:37440
    v_mfma_f32_16x16x32_bf16 v[200:203], a[144:147], v[32:35], v[200:203]
    v_exp_f32 v22, v22
    v_mfma_f32_16x16x32_bf16 v[200:203], a[148:151], v[36:39], v[200:203]
    ds_read_b128 a[104:107], v1 offset:37504
    v_cvt_pk_bf16_f32 v42, v20, v21
    v_mfma_f32_16x16x32_bf16 v[204:207], a[152:155], v[32:35], v[204:207]
    v_exp_f32 v23, v23
    v_mfma_f32_16x16x32_bf16 v[204:207], a[156:159], v[36:39], v[204:207]
    ds_read_b128 a[108:111], v1 offset:37568
    v_mfma_f32_16x16x32_bf16 v[208:211], a[160:163], v[32:35], v[208:211]
    v_exp_f32 v24, v24
    v_mfma_f32_16x16x32_bf16 v[208:211], a[164:167], v[36:39], v[208:211]
    ds_read_b128 a[112:115], v1 offset:37632
    v_cvt_pk_bf16_f32 v43, v22, v23
    v_mfma_f32_16x16x32_bf16 v[212:215], a[168:171], v[32:35], v[212:215]
    v_exp_f32 v25, v25
    v_mfma_f32_16x16x32_bf16 v[212:215], a[172:175], v[36:39], v[212:215]
    ds_read_b128 a[116:119], v1 offset:37696
    v_mfma_f32_16x16x32_bf16 v[216:219], a[176:179], v[32:35], v[216:219]
    v_exp_f32 v26, v26
    v_mfma_f32_16x16x32_bf16 v[216:219], a[180:183], v[36:39], v[216:219]
    ds_read_b128 a[120:123], v1 offset:37760
    v_cvt_pk_bf16_f32 v44, v24, v25
    v_mfma_f32_16x16x32_bf16 v[220:223], a[184:187], v[32:35], v[220:223]
    v_exp_f32 v27, v27
    v_mfma_f32_16x16x32_bf16 v[220:223], a[188:191], v[36:39], v[220:223]
    ds_read_b128 a[124:127], v1 offset:37824
    v_smfmac_f32_16x16x64_bf16 a[8:11], a[16:19], v[32:39], v11
    s_waitcnt vmcnt(13) lgkmcnt(12)
    s_barrier
    v_mfma_f32_16x16x32_bf16 v[16:19], a[64:67], v[64:67], v[48:51]
    s_sub_u32 s47, s47, s48
    v_exp_f32 v28, v28
    v_mfma_f32_16x16x32_bf16 v[16:19], a[68:71], v[68:71], v[16:19]
    v_cvt_pk_bf16_f32 v45, v26, v27
    v_add_u32 v1, s48, v1
    v_mfma_f32_16x16x32_bf16 v[16:19], a[72:75], v[72:75], v[16:19]
    s_add_u32 m0, s44, 73728
    v_exp_f32 v29, v29
    v_mfma_f32_16x16x32_bf16 v[16:19], a[76:79], v[76:79], v[16:19]
    s_waitcnt lgkmcnt(8)
    s_mov_b32 s45, 0
    buffer_load_dwordx4 v7, s[28:31], s45 offen offset:0 lds
    v_mfma_f32_16x16x32_bf16 v[20:23], a[80:83], v[64:67], v[48:51]
    v_exp_f32 v30, v30
    v_mfma_f32_16x16x32_bf16 v[20:23], a[84:87], v[68:71], v[20:23]
    v_cvt_pk_bf16_f32 v46, v28, v29
    v_add_u32 v2, s48, v2
    v_mfma_f32_16x16x32_bf16 v[20:23], a[88:91], v[72:75], v[20:23]
    s_add_u32 m0, s44, 73632
    v_exp_f32 v31, v31
    v_mfma_f32_16x16x32_bf16 v[20:23], a[92:95], v[76:79], v[20:23]
    s_waitcnt lgkmcnt(4)
    buffer_load_dwordx4 v7, s[28:31], s45 offen offset:1152 lds
    v_mfma_f32_16x16x32_bf16 v[24:27], a[96:99], v[64:67], v[48:51]
    s_sub_u32 s48, 0, s48
    v_exp_f32 v16, v16
    v_mfma_f32_16x16x32_bf16 v[24:27], a[100:103], v[68:71], v[24:27]
    v_cvt_pk_bf16_f32 v47, v30, v31
    v_mfma_f32_16x16x32_bf16 v[24:27], a[104:107], v[72:75], v[24:27]
    s_add_u32 m0, s44, 73536
    v_exp_f32 v17, v17
    v_mfma_f32_16x16x32_bf16 v[24:27], a[108:111], v[76:79], v[24:27]
    s_waitcnt lgkmcnt(0)
    buffer_load_dwordx4 v7, s[28:31], s45 offen offset:2304 lds
    v_mfma_f32_16x16x32_bf16 v[28:31], a[112:115], v[64:67], v[48:51]
    v_exp_f32 v18, v18
    v_mfma_f32_16x16x32_bf16 v[28:31], a[116:119], v[68:71], v[28:31]
    v_cvt_pk_bf16_f32 v32, v16, v17
    v_mfma_f32_16x16x32_bf16 v[28:31], a[120:123], v[72:75], v[28:31]
    s_add_u32 m0, s44, 73440
    v_exp_f32 v19, v19
    v_mfma_f32_16x16x32_bf16 v[28:31], a[124:127], v[76:79], v[28:31]
    buffer_load_dwordx4 v7, s[28:31], s45 offen offset:3456 lds
    v_mfma_f32_16x16x32_bf16 v[224:227], a[128:131], v[40:43], v[224:227]
    v_exp_f32 v20, v20
    v_mfma_f32_16x16x32_bf16 v[224:227], a[132:135], v[44:47], v[224:227]
    ds_read_b64_tr_b16 a[128:129], v2 offset:0
    v_cvt_pk_bf16_f32 v33, v18, v19
    v_mfma_f32_16x16x32_bf16 v[228:231], a[136:139], v[40:43], v[228:231]
    s_add_u32 m0, s44, 90624
    v_exp_f32 v21, v21
    v_mfma_f32_16x16x32_bf16 v[228:231], a[140:143], v[44:47], v[228:231]
    s_mov_b32 s45, 147456
    buffer_load_dwordx4 v7, s[28:31], s45 offen offset:0 lds
    v_mfma_f32_16x16x32_bf16 v[232:235], a[144:147], v[40:43], v[232:235]
    v_exp_f32 v22, v22
    v_mfma_f32_16x16x32_bf16 v[232:235], a[148:151], v[44:47], v[232:235]
    ds_read_b64_tr_b16 a[130:131], v2 offset:256
    v_cvt_pk_bf16_f32 v34, v20, v21
    v_mfma_f32_16x16x32_bf16 v[236:239], a[152:155], v[40:43], v[236:239]
    s_add_u32 m0, s44, 90528
    v_exp_f32 v23, v23
    v_mfma_f32_16x16x32_bf16 v[236:239], a[156:159], v[44:47], v[236:239]
    buffer_load_dwordx4 v7, s[28:31], s45 offen offset:1152 lds
    v_mfma_f32_16x16x32_bf16 v[240:243], a[160:163], v[40:43], v[240:243]
    v_exp_f32 v24, v24
    v_mfma_f32_16x16x32_bf16 v[240:243], a[164:167], v[44:47], v[240:243]
    ds_read_b64_tr_b16 a[132:133], v2 offset:512
    v_cvt_pk_bf16_f32 v35, v22, v23
    v_mfma_f32_16x16x32_bf16 v[244:247], a[168:171], v[40:43], v[244:247]
    s_add_u32 m0, s44, 90432
    v_exp_f32 v25, v25
    v_mfma_f32_16x16x32_bf16 v[244:247], a[172:175], v[44:47], v[244:247]
    buffer_load_dwordx4 v7, s[28:31], s45 offen offset:2304 lds
    v_mfma_f32_16x16x32_bf16 v[248:251], a[176:179], v[40:43], v[248:251]
    v_exp_f32 v26, v26
    v_mfma_f32_16x16x32_bf16 v[248:251], a[180:183], v[44:47], v[248:251]
    ds_read_b64_tr_b16 a[134:135], v2 offset:768
    v_cvt_pk_bf16_f32 v36, v24, v25
    v_mfma_f32_16x16x32_bf16 v[252:255], a[184:187], v[40:43], v[252:255]
    s_add_u32 m0, s44, 90336
    v_exp_f32 v27, v27
    v_mfma_f32_16x16x32_bf16 v[252:255], a[188:191], v[44:47], v[252:255]
    buffer_load_dwordx4 v7, s[28:31], s45 offen offset:3456 lds
    v_smfmac_f32_16x16x64_bf16 a[12:15], a[16:19], v[40:47], v11
    ds_read_b64_tr_b16 a[136:137], v2 offset:32
    v_mfma_f32_16x16x32_bf16 v[16:19], a[64:67], v[80:83], v[52:55]
    v_exp_f32 v28, v28
    v_mfma_f32_16x16x32_bf16 v[16:19], a[68:71], v[84:87], v[16:19]
    ds_read_b64_tr_b16 a[138:139], v2 offset:288
    v_cvt_pk_bf16_f32 v37, v26, v27
    v_mfma_f32_16x16x32_bf16 v[16:19], a[72:75], v[88:91], v[16:19]
    v_exp_f32 v29, v29
    v_mfma_f32_16x16x32_bf16 v[16:19], a[76:79], v[92:95], v[16:19]
    buffer_store_dwordx4 a[56:59], v5, s[32:35], 0 offen offset:0 sc1
    v_mfma_f32_16x16x32_bf16 v[20:23], a[80:83], v[80:83], v[52:55]
    v_exp_f32 v30, v30
    v_mfma_f32_16x16x32_bf16 v[20:23], a[84:87], v[84:87], v[20:23]
    ds_read_b64_tr_b16 a[140:141], v2 offset:544
    v_cvt_pk_bf16_f32 v38, v28, v29
    v_mfma_f32_16x16x32_bf16 v[20:23], a[88:91], v[88:91], v[20:23]
    v_exp_f32 v31, v31
    v_mfma_f32_16x16x32_bf16 v[20:23], a[92:95], v[92:95], v[20:23]
    ds_read_b64_tr_b16 a[142:143], v2 offset:800
    v_mfma_f32_16x16x32_bf16 v[24:27], a[96:99], v[80:83], v[52:55]
    v_exp_f32 v16, v16
    v_mfma_f32_16x16x32_bf16 v[24:27], a[100:103], v[84:87], v[24:27]
    ds_read_b64_tr_b16 a[144:145], v2 offset:64
    v_cvt_pk_bf16_f32 v39, v30, v31
    v_mfma_f32_16x16x32_bf16 v[24:27], a[104:107], v[88:91], v[24:27]
    v_exp_f32 v17, v17
    v_mfma_f32_16x16x32_bf16 v[24:27], a[108:111], v[92:95], v[24:27]
    buffer_store_dwordx4 a[56:59], v5, s[32:35], 0 offen offset:1024 sc1
    v_mfma_f32_16x16x32_bf16 v[28:31], a[112:115], v[80:83], v[52:55]
    v_exp_f32 v18, v18
    v_mfma_f32_16x16x32_bf16 v[28:31], a[116:119], v[84:87], v[28:31]
    ds_read_b64_tr_b16 a[146:147], v2 offset:320
    v_cvt_pk_bf16_f32 v40, v16, v17
    v_mfma_f32_16x16x32_bf16 v[28:31], a[120:123], v[88:91], v[28:31]
    v_exp_f32 v19, v19
    v_mfma_f32_16x16x32_bf16 v[28:31], a[124:127], v[92:95], v[28:31]
    ds_read_b64_tr_b16 a[148:149], v2 offset:576
    v_mfma_f32_16x16x32_bf16 v[128:131], a[192:195], v[32:35], v[128:131]
    v_exp_f32 v20, v20
    v_mfma_f32_16x16x32_bf16 v[128:131], a[196:199], v[36:39], v[128:131]
    ds_read_b64_tr_b16 a[150:151], v2 offset:832
    v_cvt_pk_bf16_f32 v41, v18, v19
    v_mfma_f32_16x16x32_bf16 v[132:135], a[200:203], v[32:35], v[132:135]
    v_exp_f32 v21, v21
    v_mfma_f32_16x16x32_bf16 v[132:135], a[204:207], v[36:39], v[132:135]
    ds_read_b64_tr_b16 a[152:153], v2 offset:96
    v_mfma_f32_16x16x32_bf16 v[136:139], a[208:211], v[32:35], v[136:139]
    v_exp_f32 v22, v22
    v_mfma_f32_16x16x32_bf16 v[136:139], a[212:215], v[36:39], v[136:139]
    ds_read_b64_tr_b16 a[154:155], v2 offset:352
    v_cvt_pk_bf16_f32 v42, v20, v21
    v_mfma_f32_16x16x32_bf16 v[140:143], a[216:219], v[32:35], v[140:143]
    v_exp_f32 v23, v23
    v_mfma_f32_16x16x32_bf16 v[140:143], a[220:223], v[36:39], v[140:143]
    ds_read_b64_tr_b16 a[156:157], v2 offset:608
    v_mfma_f32_16x16x32_bf16 v[144:147], a[224:227], v[32:35], v[144:147]
    v_exp_f32 v24, v24
    v_mfma_f32_16x16x32_bf16 v[144:147], a[228:231], v[36:39], v[144:147]
    ds_read_b64_tr_b16 a[158:159], v2 offset:864
    v_cvt_pk_bf16_f32 v43, v22, v23
    v_mfma_f32_16x16x32_bf16 v[148:151], a[232:235], v[32:35], v[148:151]
    v_exp_f32 v25, v25
    v_mfma_f32_16x16x32_bf16 v[148:151], a[236:239], v[36:39], v[148:151]
    ds_read_b64_tr_b16 a[160:161], v2 offset:128
    v_mfma_f32_16x16x32_bf16 v[152:155], a[240:243], v[32:35], v[152:155]
    v_exp_f32 v26, v26
    v_mfma_f32_16x16x32_bf16 v[152:155], a[244:247], v[36:39], v[152:155]
    ds_read_b64_tr_b16 a[162:163], v2 offset:384
    v_cvt_pk_bf16_f32 v44, v24, v25
    v_mfma_f32_16x16x32_bf16 v[156:159], a[248:251], v[32:35], v[156:159]
    v_exp_f32 v27, v27
    v_mfma_f32_16x16x32_bf16 v[156:159], a[252:255], v[36:39], v[156:159]
    ds_read_b64_tr_b16 a[164:165], v2 offset:640
    v_smfmac_f32_16x16x64_bf16 a[0:3], a[16:19], v[32:39], v11
    ds_read_b64_tr_b16 a[166:167], v2 offset:896
    v_mfma_f32_16x16x32_bf16 v[16:19], a[64:67], v[96:99], v[56:59]
    v_exp_f32 v28, v28
    v_mfma_f32_16x16x32_bf16 v[16:19], a[68:71], v[100:103], v[16:19]
    ds_read_b64_tr_b16 a[168:169], v2 offset:160
    v_cvt_pk_bf16_f32 v45, v26, v27
    v_mfma_f32_16x16x32_bf16 v[16:19], a[72:75], v[104:107], v[16:19]
    v_exp_f32 v29, v29
    v_mfma_f32_16x16x32_bf16 v[16:19], a[76:79], v[108:111], v[16:19]
    ds_read_b64_tr_b16 a[170:171], v2 offset:416
    v_mfma_f32_16x16x32_bf16 v[20:23], a[80:83], v[96:99], v[56:59]
    v_exp_f32 v30, v30
    v_mfma_f32_16x16x32_bf16 v[20:23], a[84:87], v[100:103], v[20:23]
    ds_read_b64_tr_b16 a[172:173], v2 offset:672
    v_cvt_pk_bf16_f32 v46, v28, v29
    v_mfma_f32_16x16x32_bf16 v[20:23], a[88:91], v[104:107], v[20:23]
    v_exp_f32 v31, v31
    v_mfma_f32_16x16x32_bf16 v[20:23], a[92:95], v[108:111], v[20:23]
    ds_read_b64_tr_b16 a[174:175], v2 offset:928
    v_mfma_f32_16x16x32_bf16 v[24:27], a[96:99], v[96:99], v[56:59]
    v_exp_f32 v16, v16
    v_mfma_f32_16x16x32_bf16 v[24:27], a[100:103], v[100:103], v[24:27]
    ds_read_b64_tr_b16 a[176:177], v2 offset:192
    v_cvt_pk_bf16_f32 v47, v30, v31
    v_mfma_f32_16x16x32_bf16 v[24:27], a[104:107], v[104:107], v[24:27]
    v_exp_f32 v17, v17
    v_mfma_f32_16x16x32_bf16 v[24:27], a[108:111], v[108:111], v[24:27]
    ds_read_b64_tr_b16 a[178:179], v2 offset:448
    v_mfma_f32_16x16x32_bf16 v[28:31], a[112:115], v[96:99], v[56:59]
    v_exp_f32 v18, v18
    v_mfma_f32_16x16x32_bf16 v[28:31], a[116:119], v[100:103], v[28:31]
    ds_read_b64_tr_b16 a[180:181], v2 offset:704
    v_cvt_pk_bf16_f32 v32, v16, v17
    v_mfma_f32_16x16x32_bf16 v[28:31], a[120:123], v[104:107], v[28:31]
    v_exp_f32 v19, v19
    v_mfma_f32_16x16x32_bf16 v[28:31], a[124:127], v[108:111], v[28:31]
    ds_read_b64_tr_b16 a[182:183], v2 offset:960
    v_mfma_f32_16x16x32_bf16 v[160:163], a[192:195], v[40:43], v[160:163]
    v_exp_f32 v20, v20
    v_mfma_f32_16x16x32_bf16 v[160:163], a[196:199], v[44:47], v[160:163]
    ds_read_b64_tr_b16 a[184:185], v2 offset:224
    v_cvt_pk_bf16_f32 v33, v18, v19
    v_mfma_f32_16x16x32_bf16 v[164:167], a[200:203], v[40:43], v[164:167]
    v_exp_f32 v21, v21
    v_mfma_f32_16x16x32_bf16 v[164:167], a[204:207], v[44:47], v[164:167]
    ds_read_b64_tr_b16 a[186:187], v2 offset:480
    v_mfma_f32_16x16x32_bf16 v[168:171], a[208:211], v[40:43], v[168:171]
    v_exp_f32 v22, v22
    v_mfma_f32_16x16x32_bf16 v[168:171], a[212:215], v[44:47], v[168:171]
    ds_read_b64_tr_b16 a[188:189], v2 offset:736
    v_cvt_pk_bf16_f32 v34, v20, v21
    v_mfma_f32_16x16x32_bf16 v[172:175], a[216:219], v[40:43], v[172:175]
    v_exp_f32 v23, v23
    v_mfma_f32_16x16x32_bf16 v[172:175], a[220:223], v[44:47], v[172:175]
    ds_read_b64_tr_b16 a[190:191], v2 offset:992
    v_mfma_f32_16x16x32_bf16 v[176:179], a[224:227], v[40:43], v[176:179]
    v_exp_f32 v24, v24
    v_mfma_f32_16x16x32_bf16 v[176:179], a[228:231], v[44:47], v[176:179]
    v_cvt_pk_bf16_f32 v35, v22, v23
    v_mfma_f32_16x16x32_bf16 v[180:183], a[232:235], v[40:43], v[180:183]
    v_exp_f32 v25, v25
    v_mfma_f32_16x16x32_bf16 v[180:183], a[236:239], v[44:47], v[180:183]
    v_mfma_f32_16x16x32_bf16 v[184:187], a[240:243], v[40:43], v[184:187]
    v_exp_f32 v26, v26
    v_mfma_f32_16x16x32_bf16 v[184:187], a[244:247], v[44:47], v[184:187]
    v_cvt_pk_bf16_f32 v36, v24, v25
    v_mfma_f32_16x16x32_bf16 v[188:191], a[248:251], v[40:43], v[188:191]
    v_exp_f32 v27, v27
    v_mfma_f32_16x16x32_bf16 v[188:191], a[252:255], v[44:47], v[188:191]
    v_smfmac_f32_16x16x64_bf16 a[4:7], a[16:19], v[40:47], v11
    v_mfma_f32_16x16x32_bf16 v[16:19], a[64:67], v[112:115], v[60:63]
    v_exp_f32 v28, v28
    v_mfma_f32_16x16x32_bf16 v[16:19], a[68:71], v[116:119], v[16:19]
    s_add_u32 s46, s46, 16384
    ds_read_b128 a[64:67], v1 offset:0
    v_cvt_pk_bf16_f32 v37, v26, v27
    v_mfma_f32_16x16x32_bf16 v[16:19], a[72:75], v[120:123], v[16:19]
    v_exp_f32 v29, v29
    v_mfma_f32_16x16x32_bf16 v[16:19], a[76:79], v[124:127], v[16:19]
    ds_read_b128 a[68:71], v1 offset:64
    v_mfma_f32_16x16x32_bf16 v[20:23], a[80:83], v[112:115], v[60:63]
    v_exp_f32 v30, v30
    v_mfma_f32_16x16x32_bf16 v[20:23], a[84:87], v[116:119], v[20:23]
    ds_read_b128 a[72:75], v1 offset:128
    v_cvt_pk_bf16_f32 v38, v28, v29
    v_mfma_f32_16x16x32_bf16 v[20:23], a[88:91], v[120:123], v[20:23]
    v_exp_f32 v31, v31
    v_mfma_f32_16x16x32_bf16 v[20:23], a[92:95], v[124:127], v[20:23]
    ds_read_b128 a[76:79], v1 offset:192
    v_mfma_f32_16x16x32_bf16 v[24:27], a[96:99], v[112:115], v[60:63]
    v_exp_f32 v16, v16
    v_mfma_f32_16x16x32_bf16 v[24:27], a[100:103], v[116:119], v[24:27]
    ds_read_b128 a[80:83], v1 offset:256
    v_cvt_pk_bf16_f32 v39, v30, v31
    v_mfma_f32_16x16x32_bf16 v[24:27], a[104:107], v[120:123], v[24:27]
    v_exp_f32 v17, v17
    v_mfma_f32_16x16x32_bf16 v[24:27], a[108:111], v[124:127], v[24:27]
    ds_read_b128 a[84:87], v1 offset:320
    v_mfma_f32_16x16x32_bf16 v[28:31], a[112:115], v[112:115], v[60:63]
    v_exp_f32 v18, v18
    v_mfma_f32_16x16x32_bf16 v[28:31], a[116:119], v[116:119], v[28:31]
    ds_read_b128 a[88:91], v1 offset:384
    v_cvt_pk_bf16_f32 v40, v16, v17
    v_mfma_f32_16x16x32_bf16 v[28:31], a[120:123], v[120:123], v[28:31]
    v_exp_f32 v19, v19
    v_mfma_f32_16x16x32_bf16 v[28:31], a[124:127], v[124:127], v[28:31]
    ds_read_b128 a[92:95], v1 offset:448
    v_mfma_f32_16x16x32_bf16 v[192:195], a[192:195], v[32:35], v[192:195]
    v_exp_f32 v20, v20
    v_mfma_f32_16x16x32_bf16 v[192:195], a[196:199], v[36:39], v[192:195]
    ds_read_b128 a[96:99], v1 offset:512
    v_cvt_pk_bf16_f32 v41, v18, v19
    v_mfma_f32_16x16x32_bf16 v[196:199], a[200:203], v[32:35], v[196:199]
    v_exp_f32 v21, v21
    v_mfma_f32_16x16x32_bf16 v[196:199], a[204:207], v[36:39], v[196:199]
    ds_read_b128 a[100:103], v1 offset:576
    v_mfma_f32_16x16x32_bf16 v[200:203], a[208:211], v[32:35], v[200:203]
    v_exp_f32 v22, v22
    v_mfma_f32_16x16x32_bf16 v[200:203], a[212:215], v[36:39], v[200:203]
    ds_read_b128 a[104:107], v1 offset:640
    v_cvt_pk_bf16_f32 v42, v20, v21
    v_mfma_f32_16x16x32_bf16 v[204:207], a[216:219], v[32:35], v[204:207]
    v_exp_f32 v23, v23
    v_mfma_f32_16x16x32_bf16 v[204:207], a[220:223], v[36:39], v[204:207]
    ds_read_b128 a[108:111], v1 offset:704
    v_mfma_f32_16x16x32_bf16 v[208:211], a[224:227], v[32:35], v[208:211]
    v_exp_f32 v24, v24
    v_mfma_f32_16x16x32_bf16 v[208:211], a[228:231], v[36:39], v[208:211]
    ds_read_b128 a[112:115], v1 offset:768
    v_cvt_pk_bf16_f32 v43, v22, v23
    v_mfma_f32_16x16x32_bf16 v[212:215], a[232:235], v[32:35], v[212:215]
    v_exp_f32 v25, v25
    v_mfma_f32_16x16x32_bf16 v[212:215], a[236:239], v[36:39], v[212:215]
    ds_read_b128 a[116:119], v1 offset:832
    v_mfma_f32_16x16x32_bf16 v[216:219], a[240:243], v[32:35], v[216:219]
    v_exp_f32 v26, v26
    v_mfma_f32_16x16x32_bf16 v[216:219], a[244:247], v[36:39], v[216:219]
    ds_read_b128 a[120:123], v1 offset:896
    v_cvt_pk_bf16_f32 v44, v24, v25
    v_mfma_f32_16x16x32_bf16 v[220:223], a[248:251], v[32:35], v[220:223]
    v_exp_f32 v27, v27
    v_mfma_f32_16x16x32_bf16 v[220:223], a[252:255], v[36:39], v[220:223]
    ds_read_b128 a[124:127], v1 offset:960
    v_smfmac_f32_16x16x64_bf16 a[8:11], a[16:19], v[32:39], v11
    s_waitcnt vmcnt(11) lgkmcnt(12)
    s_barrier
    v_mfma_f32_16x16x32_bf16 v[16:19], a[64:67], v[64:67], v[48:51]
    v_exp_f32 v28, v28
    v_mfma_f32_16x16x32_bf16 v[16:19], a[68:71], v[68:71], v[16:19]
    v_cvt_pk_bf16_f32 v45, v26, v27
    v_mfma_f32_16x16x32_bf16 v[16:19], a[72:75], v[72:75], v[16:19]
    s_add_u32 m0, s44, 110592
    v_exp_f32 v29, v29
    v_mfma_f32_16x16x32_bf16 v[16:19], a[76:79], v[76:79], v[16:19]
    s_waitcnt lgkmcnt(8)
    s_mov_b32 s45, 128
    buffer_load_dwordx4 v7, s[28:31], s45 offen offset:0 lds
    v_mfma_f32_16x16x32_bf16 v[20:23], a[80:83], v[64:67], v[48:51]
    v_exp_f32 v30, v30
    v_mfma_f32_16x16x32_bf16 v[20:23], a[84:87], v[68:71], v[20:23]
    v_cvt_pk_bf16_f32 v46, v28, v29
    v_mfma_f32_16x16x32_bf16 v[20:23], a[88:91], v[72:75], v[20:23]
    s_add_u32 m0, s44, 110496
    v_exp_f32 v31, v31
    v_mfma_f32_16x16x32_bf16 v[20:23], a[92:95], v[76:79], v[20:23]
    s_waitcnt lgkmcnt(4)
    buffer_load_dwordx4 v7, s[28:31], s45 offen offset:1152 lds
    v_mfma_f32_16x16x32_bf16 v[24:27], a[96:99], v[64:67], v[48:51]
    v_exp_f32 v16, v16
    v_mfma_f32_16x16x32_bf16 v[24:27], a[100:103], v[68:71], v[24:27]
    v_cvt_pk_bf16_f32 v47, v30, v31
    v_mfma_f32_16x16x32_bf16 v[24:27], a[104:107], v[72:75], v[24:27]
    s_add_u32 m0, s44, 110400
    v_exp_f32 v17, v17
    v_mfma_f32_16x16x32_bf16 v[24:27], a[108:111], v[76:79], v[24:27]
    s_waitcnt lgkmcnt(0)
    buffer_load_dwordx4 v7, s[28:31], s45 offen offset:2304 lds
    v_mfma_f32_16x16x32_bf16 v[28:31], a[112:115], v[64:67], v[48:51]
    v_exp_f32 v18, v18
    v_mfma_f32_16x16x32_bf16 v[28:31], a[116:119], v[68:71], v[28:31]
    v_cvt_pk_bf16_f32 v32, v16, v17
    v_mfma_f32_16x16x32_bf16 v[28:31], a[120:123], v[72:75], v[28:31]
    s_add_u32 m0, s44, 110304
    v_exp_f32 v19, v19
    v_mfma_f32_16x16x32_bf16 v[28:31], a[124:127], v[76:79], v[28:31]
    buffer_load_dwordx4 v7, s[28:31], s45 offen offset:3456 lds
    v_mfma_f32_16x16x32_bf16 v[224:227], a[192:195], v[40:43], v[224:227]
    v_exp_f32 v20, v20
    v_mfma_f32_16x16x32_bf16 v[224:227], a[196:199], v[44:47], v[224:227]
    ds_read_b64_tr_b16 a[192:193], v2 offset:36864
    v_cvt_pk_bf16_f32 v33, v18, v19
    v_mfma_f32_16x16x32_bf16 v[228:231], a[200:203], v[40:43], v[228:231]
    s_add_u32 m0, s44, 127488
    v_exp_f32 v21, v21
    v_mfma_f32_16x16x32_bf16 v[228:231], a[204:207], v[44:47], v[228:231]
    s_mov_b32 s45, 147584
    buffer_load_dwordx4 v7, s[28:31], s45 offen offset:0 lds
    v_mfma_f32_16x16x32_bf16 v[232:235], a[208:211], v[40:43], v[232:235]
    v_exp_f32 v22, v22
    v_mfma_f32_16x16x32_bf16 v[232:235], a[212:215], v[44:47], v[232:235]
    ds_read_b64_tr_b16 a[194:195], v2 offset:37120
    v_cvt_pk_bf16_f32 v34, v20, v21
    v_mfma_f32_16x16x32_bf16 v[236:239], a[216:219], v[40:43], v[236:239]
    s_add_u32 m0, s44, 127392
    v_exp_f32 v23, v23
    v_mfma_f32_16x16x32_bf16 v[236:239], a[220:223], v[44:47], v[236:239]
    buffer_load_dwordx4 v7, s[28:31], s45 offen offset:1152 lds
    v_mfma_f32_16x16x32_bf16 v[240:243], a[224:227], v[40:43], v[240:243]
    v_exp_f32 v24, v24
    v_mfma_f32_16x16x32_bf16 v[240:243], a[228:231], v[44:47], v[240:243]
    ds_read_b64_tr_b16 a[196:197], v2 offset:37376
    v_cvt_pk_bf16_f32 v35, v22, v23
    v_mfma_f32_16x16x32_bf16 v[244:247], a[232:235], v[40:43], v[244:247]
    s_add_u32 m0, s44, 127296
    v_exp_f32 v25, v25
    v_mfma_f32_16x16x32_bf16 v[244:247], a[236:239], v[44:47], v[244:247]
    buffer_load_dwordx4 v7, s[28:31], s45 offen offset:2304 lds
    v_mfma_f32_16x16x32_bf16 v[248:251], a[240:243], v[40:43], v[248:251]
    v_exp_f32 v26, v26
    v_mfma_f32_16x16x32_bf16 v[248:251], a[244:247], v[44:47], v[248:251]
    ds_read_b64_tr_b16 a[198:199], v2 offset:37632
    v_cvt_pk_bf16_f32 v36, v24, v25
    v_mfma_f32_16x16x32_bf16 v[252:255], a[248:251], v[40:43], v[252:255]
    s_add_u32 m0, s44, 127200
    v_exp_f32 v27, v27
    v_mfma_f32_16x16x32_bf16 v[252:255], a[252:255], v[44:47], v[252:255]
    buffer_load_dwordx4 v7, s[28:31], s45 offen offset:3456 lds
    v_smfmac_f32_16x16x64_bf16 a[12:15], a[16:19], v[40:47], v11
    ds_read_b64_tr_b16 a[200:201], v2 offset:36896
    v_mfma_f32_16x16x32_bf16 v[16:19], a[64:67], v[80:83], v[52:55]
    v_exp_f32 v28, v28
    v_mfma_f32_16x16x32_bf16 v[16:19], a[68:71], v[84:87], v[16:19]
    ds_read_b64_tr_b16 a[202:203], v2 offset:37152
    v_cvt_pk_bf16_f32 v37, v26, v27
    v_mfma_f32_16x16x32_bf16 v[16:19], a[72:75], v[88:91], v[16:19]
    v_exp_f32 v29, v29
    v_mfma_f32_16x16x32_bf16 v[16:19], a[76:79], v[92:95], v[16:19]
    buffer_store_dwordx4 a[56:59], v5, s[32:35], 0 offen offset:2048 sc1
    v_mfma_f32_16x16x32_bf16 v[20:23], a[80:83], v[80:83], v[52:55]
    v_exp_f32 v30, v30
    v_mfma_f32_16x16x32_bf16 v[20:23], a[84:87], v[84:87], v[20:23]
    ds_read_b64_tr_b16 a[204:205], v2 offset:37408
    v_cvt_pk_bf16_f32 v38, v28, v29
    v_mfma_f32_16x16x32_bf16 v[20:23], a[88:91], v[88:91], v[20:23]
    v_exp_f32 v31, v31
    v_mfma_f32_16x16x32_bf16 v[20:23], a[92:95], v[92:95], v[20:23]
    ds_read_b64_tr_b16 a[206:207], v2 offset:37664
    v_mfma_f32_16x16x32_bf16 v[24:27], a[96:99], v[80:83], v[52:55]
    v_exp_f32 v16, v16
    v_mfma_f32_16x16x32_bf16 v[24:27], a[100:103], v[84:87], v[24:27]
    ds_read_b64_tr_b16 a[208:209], v2 offset:36928
    v_cvt_pk_bf16_f32 v39, v30, v31
    v_mfma_f32_16x16x32_bf16 v[24:27], a[104:107], v[88:91], v[24:27]
    v_exp_f32 v17, v17
    v_mfma_f32_16x16x32_bf16 v[24:27], a[108:111], v[92:95], v[24:27]
    buffer_store_dwordx4 a[56:59], v5, s[32:35], 0 offen offset:3072 sc1
    v_mfma_f32_16x16x32_bf16 v[28:31], a[112:115], v[80:83], v[52:55]
    v_exp_f32 v18, v18
    v_mfma_f32_16x16x32_bf16 v[28:31], a[116:119], v[84:87], v[28:31]
    ds_read_b64_tr_b16 a[210:211], v2 offset:37184
    v_cvt_pk_bf16_f32 v40, v16, v17
    v_mfma_f32_16x16x32_bf16 v[28:31], a[120:123], v[88:91], v[28:31]
    v_exp_f32 v19, v19
    v_mfma_f32_16x16x32_bf16 v[28:31], a[124:127], v[92:95], v[28:31]
    ds_read_b64_tr_b16 a[212:213], v2 offset:37440
    v_mfma_f32_16x16x32_bf16 v[128:131], a[128:131], v[32:35], v[128:131]
    v_exp_f32 v20, v20
    v_mfma_f32_16x16x32_bf16 v[128:131], a[132:135], v[36:39], v[128:131]
    ds_read_b64_tr_b16 a[214:215], v2 offset:37696
    v_cvt_pk_bf16_f32 v41, v18, v19
    v_mfma_f32_16x16x32_bf16 v[132:135], a[136:139], v[32:35], v[132:135]
    v_exp_f32 v21, v21
    v_mfma_f32_16x16x32_bf16 v[132:135], a[140:143], v[36:39], v[132:135]
    ds_read_b64_tr_b16 a[216:217], v2 offset:36960
    v_mfma_f32_16x16x32_bf16 v[136:139], a[144:147], v[32:35], v[136:139]
    v_exp_f32 v22, v22
    v_mfma_f32_16x16x32_bf16 v[136:139], a[148:151], v[36:39], v[136:139]
    ds_read_b64_tr_b16 a[218:219], v2 offset:37216
    v_cvt_pk_bf16_f32 v42, v20, v21
    v_mfma_f32_16x16x32_bf16 v[140:143], a[152:155], v[32:35], v[140:143]
    v_exp_f32 v23, v23
    v_mfma_f32_16x16x32_bf16 v[140:143], a[156:159], v[36:39], v[140:143]
    ds_read_b64_tr_b16 a[220:221], v2 offset:37472
    v_mfma_f32_16x16x32_bf16 v[144:147], a[160:163], v[32:35], v[144:147]
    v_exp_f32 v24, v24
    v_mfma_f32_16x16x32_bf16 v[144:147], a[164:167], v[36:39], v[144:147]
    ds_read_b64_tr_b16 a[222:223], v2 offset:37728
    v_cvt_pk_bf16_f32 v43, v22, v23
    v_mfma_f32_16x16x32_bf16 v[148:151], a[168:171], v[32:35], v[148:151]
    v_exp_f32 v25, v25
    v_mfma_f32_16x16x32_bf16 v[148:151], a[172:175], v[36:39], v[148:151]
    ds_read_b64_tr_b16 a[224:225], v2 offset:36992
    v_mfma_f32_16x16x32_bf16 v[152:155], a[176:179], v[32:35], v[152:155]
    v_exp_f32 v26, v26
    v_mfma_f32_16x16x32_bf16 v[152:155], a[180:183], v[36:39], v[152:155]
    ds_read_b64_tr_b16 a[226:227], v2 offset:37248
    v_cvt_pk_bf16_f32 v44, v24, v25
    v_mfma_f32_16x16x32_bf16 v[156:159], a[184:187], v[32:35], v[156:159]
    v_exp_f32 v27, v27
    v_mfma_f32_16x16x32_bf16 v[156:159], a[188:191], v[36:39], v[156:159]
    ds_read_b64_tr_b16 a[228:229], v2 offset:37504
    v_smfmac_f32_16x16x64_bf16 a[0:3], a[16:19], v[32:39], v11
    ds_read_b64_tr_b16 a[230:231], v2 offset:37760
    v_mfma_f32_16x16x32_bf16 v[16:19], a[64:67], v[96:99], v[56:59]
    v_exp_f32 v28, v28
    v_mfma_f32_16x16x32_bf16 v[16:19], a[68:71], v[100:103], v[16:19]
    ds_read_b64_tr_b16 a[232:233], v2 offset:37024
    v_cvt_pk_bf16_f32 v45, v26, v27
    v_mfma_f32_16x16x32_bf16 v[16:19], a[72:75], v[104:107], v[16:19]
    v_exp_f32 v29, v29
    v_mfma_f32_16x16x32_bf16 v[16:19], a[76:79], v[108:111], v[16:19]
    ds_read_b64_tr_b16 a[234:235], v2 offset:37280
    v_mfma_f32_16x16x32_bf16 v[20:23], a[80:83], v[96:99], v[56:59]
    v_exp_f32 v30, v30
    v_mfma_f32_16x16x32_bf16 v[20:23], a[84:87], v[100:103], v[20:23]
    ds_read_b64_tr_b16 a[236:237], v2 offset:37536
    v_cvt_pk_bf16_f32 v46, v28, v29
    v_mfma_f32_16x16x32_bf16 v[20:23], a[88:91], v[104:107], v[20:23]
    v_exp_f32 v31, v31
    v_mfma_f32_16x16x32_bf16 v[20:23], a[92:95], v[108:111], v[20:23]
    ds_read_b64_tr_b16 a[238:239], v2 offset:37792
    v_mfma_f32_16x16x32_bf16 v[24:27], a[96:99], v[96:99], v[56:59]
    v_exp_f32 v16, v16
    v_mfma_f32_16x16x32_bf16 v[24:27], a[100:103], v[100:103], v[24:27]
    ds_read_b64_tr_b16 a[240:241], v2 offset:37056
    v_cvt_pk_bf16_f32 v47, v30, v31
    v_mfma_f32_16x16x32_bf16 v[24:27], a[104:107], v[104:107], v[24:27]
    v_exp_f32 v17, v17
    v_mfma_f32_16x16x32_bf16 v[24:27], a[108:111], v[108:111], v[24:27]
    ds_read_b64_tr_b16 a[242:243], v2 offset:37312
    v_mfma_f32_16x16x32_bf16 v[28:31], a[112:115], v[96:99], v[56:59]
    v_exp_f32 v18, v18
    v_mfma_f32_16x16x32_bf16 v[28:31], a[116:119], v[100:103], v[28:31]
    ds_read_b64_tr_b16 a[244:245], v2 offset:37568
    v_cvt_pk_bf16_f32 v32, v16, v17
    v_mfma_f32_16x16x32_bf16 v[28:31], a[120:123], v[104:107], v[28:31]
    v_exp_f32 v19, v19
    v_mfma_f32_16x16x32_bf16 v[28:31], a[124:127], v[108:111], v[28:31]
L2_pad8:
    s_cbranch_execz L2_pad12
    ds_read_b64_tr_b16 a[246:247], v2 offset:37824
    v_mfma_f32_16x16x32_bf16 v[160:163], a[128:131], v[40:43], v[160:163]
    v_exp_f32 v20, v20
    v_mfma_f32_16x16x32_bf16 v[160:163], a[132:135], v[44:47], v[160:163]
    ds_read_b64_tr_b16 a[248:249], v2 offset:37088
    v_cvt_pk_bf16_f32 v33, v18, v19
    v_mfma_f32_16x16x32_bf16 v[164:167], a[136:139], v[40:43], v[164:167]
    v_exp_f32 v21, v21
    v_mfma_f32_16x16x32_bf16 v[164:167], a[140:143], v[44:47], v[164:167]
    ds_read_b64_tr_b16 a[250:251], v2 offset:37344
    v_mfma_f32_16x16x32_bf16 v[168:171], a[144:147], v[40:43], v[168:171]
    v_exp_f32 v22, v22
    v_mfma_f32_16x16x32_bf16 v[168:171], a[148:151], v[44:47], v[168:171]
    ds_read_b64_tr_b16 a[252:253], v2 offset:37600
    v_cvt_pk_bf16_f32 v34, v20, v21
    v_mfma_f32_16x16x32_bf16 v[172:175], a[152:155], v[40:43], v[172:175]
    v_exp_f32 v23, v23
    v_mfma_f32_16x16x32_bf16 v[172:175], a[156:159], v[44:47], v[172:175]
    ds_read_b64_tr_b16 a[254:255], v2 offset:37856
    v_mfma_f32_16x16x32_bf16 v[176:179], a[160:163], v[40:43], v[176:179]
    v_exp_f32 v24, v24
    v_mfma_f32_16x16x32_bf16 v[176:179], a[164:167], v[44:47], v[176:179]
    v_cvt_pk_bf16_f32 v35, v22, v23
    v_mfma_f32_16x16x32_bf16 v[180:183], a[168:171], v[40:43], v[180:183]
    v_exp_f32 v25, v25
    v_mfma_f32_16x16x32_bf16 v[180:183], a[172:175], v[44:47], v[180:183]
    v_mfma_f32_16x16x32_bf16 v[184:187], a[176:179], v[40:43], v[184:187]
    v_exp_f32 v26, v26
    v_mfma_f32_16x16x32_bf16 v[184:187], a[180:183], v[44:47], v[184:187]
    v_cvt_pk_bf16_f32 v36, v24, v25
    v_mfma_f32_16x16x32_bf16 v[188:191], a[184:187], v[40:43], v[188:191]
    v_exp_f32 v27, v27
    v_mfma_f32_16x16x32_bf16 v[188:191], a[188:191], v[44:47], v[188:191]
    v_smfmac_f32_16x16x64_bf16 a[4:7], a[16:19], v[40:47], v11
    v_mfma_f32_16x16x32_bf16 v[16:19], a[64:67], v[112:115], v[60:63]
    v_exp_f32 v28, v28
    v_mfma_f32_16x16x32_bf16 v[16:19], a[68:71], v[116:119], v[16:19]
    s_add_u32 s46, s46, 16384
    ds_read_b128 a[64:67], v1 offset:36864
    v_cvt_pk_bf16_f32 v37, v26, v27
    v_mfma_f32_16x16x32_bf16 v[16:19], a[72:75], v[120:123], v[16:19]
    v_exp_f32 v29, v29
    v_mfma_f32_16x16x32_bf16 v[16:19], a[76:79], v[124:127], v[16:19]
    ds_read_b128 a[68:71], v1 offset:36928
    v_mfma_f32_16x16x32_bf16 v[20:23], a[80:83], v[112:115], v[60:63]
    v_exp_f32 v30, v30
    v_mfma_f32_16x16x32_bf16 v[20:23], a[84:87], v[116:119], v[20:23]
    ds_read_b128 a[72:75], v1 offset:36992
    v_cvt_pk_bf16_f32 v38, v28, v29
    v_mfma_f32_16x16x32_bf16 v[20:23], a[88:91], v[120:123], v[20:23]
    v_exp_f32 v31, v31
    v_mfma_f32_16x16x32_bf16 v[20:23], a[92:95], v[124:127], v[20:23]
    ds_read_b128 a[76:79], v1 offset:37056
    v_mfma_f32_16x16x32_bf16 v[24:27], a[96:99], v[112:115], v[60:63]
    v_exp_f32 v16, v16
    v_mfma_f32_16x16x32_bf16 v[24:27], a[100:103], v[116:119], v[24:27]
    ds_read_b128 a[80:83], v1 offset:37120
    v_cvt_pk_bf16_f32 v39, v30, v31
    v_mfma_f32_16x16x32_bf16 v[24:27], a[104:107], v[120:123], v[24:27]
    v_exp_f32 v17, v17
    v_mfma_f32_16x16x32_bf16 v[24:27], a[108:111], v[124:127], v[24:27]
    ds_read_b128 a[84:87], v1 offset:37184
    v_mfma_f32_16x16x32_bf16 v[28:31], a[112:115], v[112:115], v[60:63]
    v_exp_f32 v18, v18
    v_mfma_f32_16x16x32_bf16 v[28:31], a[116:119], v[116:119], v[28:31]
    ds_read_b128 a[88:91], v1 offset:37248
    v_cvt_pk_bf16_f32 v40, v16, v17
    v_mfma_f32_16x16x32_bf16 v[28:31], a[120:123], v[120:123], v[28:31]
    v_exp_f32 v19, v19
    v_mfma_f32_16x16x32_bf16 v[28:31], a[124:127], v[124:127], v[28:31]
    ds_read_b128 a[92:95], v1 offset:37312
    v_mfma_f32_16x16x32_bf16 v[192:195], a[128:131], v[32:35], v[192:195]
    v_exp_f32 v20, v20
    v_mfma_f32_16x16x32_bf16 v[192:195], a[132:135], v[36:39], v[192:195]
    ds_read_b128 a[96:99], v1 offset:37376
    v_cvt_pk_bf16_f32 v41, v18, v19
    v_mfma_f32_16x16x32_bf16 v[196:199], a[136:139], v[32:35], v[196:199]
    v_exp_f32 v21, v21
    v_mfma_f32_16x16x32_bf16 v[196:199], a[140:143], v[36:39], v[196:199]
    ds_read_b128 a[100:103], v1 offset:37440
    v_mfma_f32_16x16x32_bf16 v[200:203], a[144:147], v[32:35], v[200:203]
    v_exp_f32 v22, v22
    v_mfma_f32_16x16x32_bf16 v[200:203], a[148:151], v[36:39], v[200:203]
    ds_read_b128 a[104:107], v1 offset:37504
    v_cvt_pk_bf16_f32 v42, v20, v21
    v_mfma_f32_16x16x32_bf16 v[204:207], a[152:155], v[32:35], v[204:207]
    v_exp_f32 v23, v23
    v_mfma_f32_16x16x32_bf16 v[204:207], a[156:159], v[36:39], v[204:207]
    ds_read_b128 a[108:111], v1 offset:37568
    v_mfma_f32_16x16x32_bf16 v[208:211], a[160:163], v[32:35], v[208:211]
    v_exp_f32 v24, v24
    v_mfma_f32_16x16x32_bf16 v[208:211], a[164:167], v[36:39], v[208:211]
    ds_read_b128 a[112:115], v1 offset:37632
    v_cvt_pk_bf16_f32 v43, v22, v23
    v_mfma_f32_16x16x32_bf16 v[212:215], a[168:171], v[32:35], v[212:215]
    v_exp_f32 v25, v25
    v_mfma_f32_16x16x32_bf16 v[212:215], a[172:175], v[36:39], v[212:215]
    ds_read_b128 a[116:119], v1 offset:37696
    v_mfma_f32_16x16x32_bf16 v[216:219], a[176:179], v[32:35], v[216:219]
    v_exp_f32 v26, v26
    v_mfma_f32_16x16x32_bf16 v[216:219], a[180:183], v[36:39], v[216:219]
    ds_read_b128 a[120:123], v1 offset:37760
    v_cvt_pk_bf16_f32 v44, v24, v25
    v_mfma_f32_16x16x32_bf16 v[220:223], a[184:187], v[32:35], v[220:223]
    v_exp_f32 v27, v27
    v_mfma_f32_16x16x32_bf16 v[220:223], a[188:191], v[36:39], v[220:223]
    ds_read_b128 a[124:127], v1 offset:37824
    v_smfmac_f32_16x16x64_bf16 a[8:11], a[16:19], v[32:39], v11
    s_waitcnt vmcnt(12) lgkmcnt(12)
    s_barrier
    v_mfma_f32_16x16x32_bf16 v[16:19], a[64:67], v[64:67], v[48:51]
    v_exp_f32 v28, v28
    v_mfma_f32_16x16x32_bf16 v[16:19], a[68:71], v[68:71], v[16:19]
    v_cvt_pk_bf16_f32 v45, v26, v27
    v_mfma_f32_16x16x32_bf16 v[16:19], a[72:75], v[72:75], v[16:19]
    s_add_u32 m0, s44, 0
    v_exp_f32 v29, v29
    v_mfma_f32_16x16x32_bf16 v[16:19], a[76:79], v[76:79], v[16:19]
    s_waitcnt lgkmcnt(8)
    s_mov_b32 s45, 256
    buffer_load_dwordx4 v7, s[28:31], s45 offen offset:0 lds
    v_mfma_f32_16x16x32_bf16 v[20:23], a[80:83], v[64:67], v[48:51]
    v_exp_f32 v30, v30
    v_mfma_f32_16x16x32_bf16 v[20:23], a[84:87], v[68:71], v[20:23]
    v_cvt_pk_bf16_f32 v46, v28, v29
    v_mfma_f32_16x16x32_bf16 v[20:23], a[88:91], v[72:75], v[20:23]
    s_add_u32 m0, s44, -96
    v_exp_f32 v31, v31
    v_mfma_f32_16x16x32_bf16 v[20:23], a[92:95], v[76:79], v[20:23]
    s_waitcnt lgkmcnt(4)
    buffer_load_dwordx4 v7, s[28:31], s45 offen offset:1152 lds
    v_mfma_f32_16x16x32_bf16 v[24:27], a[96:99], v[64:67], v[48:51]
    v_exp_f32 v16, v16
    v_mfma_f32_16x16x32_bf16 v[24:27], a[100:103], v[68:71], v[24:27]
    v_cvt_pk_bf16_f32 v47, v30, v31
    v_mfma_f32_16x16x32_bf16 v[24:27], a[104:107], v[72:75], v[24:27]
    s_add_u32 m0, s44, -192
    v_exp_f32 v17, v17
    v_mfma_f32_16x16x32_bf16 v[24:27], a[108:111], v[76:79], v[24:27]
    s_waitcnt lgkmcnt(0)
    buffer_load_dwordx4 v7, s[28:31], s45 offen offset:2304 lds
    v_mfma_f32_16x16x32_bf16 v[28:31], a[112:115], v[64:67], v[48:51]
    v_exp_f32 v18, v18
    v_mfma_f32_16x16x32_bf16 v[28:31], a[116:119], v[68:71], v[28:31]
    v_cvt_pk_bf16_f32 v32, v16, v17
    v_mfma_f32_16x16x32_bf16 v[28:31], a[120:123], v[72:75], v[28:31]
    s_add_u32 m0, s44, -288
    v_exp_f32 v19, v19
    v_mfma_f32_16x16x32_bf16 v[28:31], a[124:127], v[76:79], v[28:31]
    buffer_load_dwordx4 v7, s[28:31], s45 offen offset:3456 lds
    v_mfma_f32_16x16x32_bf16 v[224:227], a[128:131], v[40:43], v[224:227]
    v_exp_f32 v20, v20
    v_mfma_f32_16x16x32_bf16 v[224:227], a[132:135], v[44:47], v[224:227]
    v_cvt_pk_bf16_f32 v33, v18, v19
    v_mfma_f32_16x16x32_bf16 v[228:231], a[136:139], v[40:43], v[228:231]
    s_add_u32 m0, s44, 16896
    v_exp_f32 v21, v21
    v_mfma_f32_16x16x32_bf16 v[228:231], a[140:143], v[44:47], v[228:231]
    s_mov_b32 s45, 147712
    buffer_load_dwordx4 v7, s[28:31], s45 offen offset:0 lds
    v_mfma_f32_16x16x32_bf16 v[232:235], a[144:147], v[40:43], v[232:235]
    v_exp_f32 v22, v22
    v_mfma_f32_16x16x32_bf16 v[232:235], a[148:151], v[44:47], v[232:235]
    v_cvt_pk_bf16_f32 v34, v20, v21
    v_mfma_f32_16x16x32_bf16 v[236:239], a[152:155], v[40:43], v[236:239]
    s_add_u32 m0, s44, 16800
    v_exp_f32 v23, v23
    v_mfma_f32_16x16x32_bf16 v[236:239], a[156:159], v[44:47], v[236:239]
    buffer_load_dwordx4 v7, s[28:31], s45 offen offset:1152 lds
    v_mfma_f32_16x16x32_bf16 v[240:243], a[160:163], v[40:43], v[240:243]
    v_exp_f32 v24, v24
    v_mfma_f32_16x16x32_bf16 v[240:243], a[164:167], v[44:47], v[240:243]
    v_cvt_pk_bf16_f32 v35, v22, v23
    v_mfma_f32_16x16x32_bf16 v[244:247], a[168:171], v[40:43], v[244:247]
    s_add_u32 m0, s44, 16704
    v_exp_f32 v25, v25
    v_mfma_f32_16x16x32_bf16 v[244:247], a[172:175], v[44:47], v[244:247]
    buffer_load_dwordx4 v7, s[28:31], s45 offen offset:2304 lds
    v_mfma_f32_16x16x32_bf16 v[248:251], a[176:179], v[40:43], v[248:251]
    v_exp_f32 v26, v26
    v_mfma_f32_16x16x32_bf16 v[248:251], a[180:183], v[44:47], v[248:251]
    v_cvt_pk_bf16_f32 v36, v24, v25
    v_mfma_f32_16x16x32_bf16 v[252:255], a[184:187], v[40:43], v[252:255]
    s_add_u32 m0, s44, 16608
    v_exp_f32 v27, v27
    v_mfma_f32_16x16x32_bf16 v[252:255], a[188:191], v[44:47], v[252:255]
    buffer_load_dwordx4 v7, s[28:31], s45 offen offset:3456 lds
    v_smfmac_f32_16x16x64_bf16 a[12:15], a[16:19], v[40:47], v11
    v_mfma_f32_16x16x32_bf16 v[16:19], a[64:67], v[80:83], v[52:55]
    v_exp_f32 v28, v28
    v_mfma_f32_16x16x32_bf16 v[16:19], a[68:71], v[84:87], v[16:19]
    v_cvt_pk_bf16_f32 v37, v26, v27
    v_mfma_f32_16x16x32_bf16 v[16:19], a[72:75], v[88:91], v[16:19]
    s_mov_b32 s54, 0
    v_exp_f32 v29, v29
    v_mfma_f32_16x16x32_bf16 v[16:19], a[76:79], v[92:95], v[16:19]
    buffer_load_dwordx4 a[128:131], v6, s[68:71], s54 offen
    v_mfma_f32_16x16x32_bf16 v[20:23], a[80:83], v[80:83], v[52:55]
    v_exp_f32 v30, v30
    v_mfma_f32_16x16x32_bf16 v[20:23], a[84:87], v[84:87], v[20:23]
    v_cvt_pk_bf16_f32 v38, v28, v29
    v_mfma_f32_16x16x32_bf16 v[20:23], a[88:91], v[88:91], v[20:23]
    s_add_u32 s54, s55, 0
    v_exp_f32 v31, v31
    v_mfma_f32_16x16x32_bf16 v[20:23], a[92:95], v[92:95], v[20:23]
    s_mov_b32 s15, 0x5d800000
    buffer_load_dwordx4 a[164:167], v8, s[72:75], s54 offen
    v_mfma_f32_16x16x32_bf16 v[24:27], a[96:99], v[80:83], v[52:55]
    v_exp_f32 v16, v16
    v_mfma_f32_16x16x32_bf16 v[24:27], a[100:103], v[84:87], v[24:27]
    v_cvt_pk_bf16_f32 v39, v30, v31
    v_mfma_f32_16x16x32_bf16 v[24:27], a[104:107], v[88:91], v[24:27]
    s_mov_b32 s54, 147456
    v_exp_f32 v17, v17
    v_mfma_f32_16x16x32_bf16 v[24:27], a[108:111], v[92:95], v[24:27]
    buffer_load_dwordx4 a[132:135], v6, s[68:71], s54 offen
    v_mfma_f32_16x16x32_bf16 v[28:31], a[112:115], v[80:83], v[52:55]
    v_exp_f32 v18, v18
    v_mfma_f32_16x16x32_bf16 v[28:31], a[116:119], v[84:87], v[28:31]
    v_cvt_pk_bf16_f32 v40, v16, v17
    v_mfma_f32_16x16x32_bf16 v[28:31], a[120:123], v[88:91], v[28:31]
    s_add_u32 s54, s55, 1024
    v_exp_f32 v19, v19
    v_mfma_f32_16x16x32_bf16 v[28:31], a[124:127], v[92:95], v[28:31]
    buffer_load_dwordx4 a[168:171], v8, s[72:75], s54 offen
    v_mfma_f32_16x16x32_bf16 v[128:131], a[192:195], v[32:35], v[128:131]
    v_exp_f32 v20, v20
    v_mfma_f32_16x16x32_bf16 v[128:131], a[196:199], v[36:39], v[128:131]
    v_cvt_pk_bf16_f32 v41, v18, v19
    v_mfma_f32_16x16x32_bf16 v[132:135], a[200:203], v[32:35], v[132:135]
    s_mov_b32 s54, 294912
    v_exp_f32 v21, v21
    v_mfma_f32_16x16x32_bf16 v[132:135], a[204:207], v[36:39], v[132:135]
    buffer_load_dwordx4 a[136:139], v6, s[68:71], s54 offen
    v_mfma_f32_16x16x32_bf16 v[136:139], a[208:211], v[32:35], v[136:139]
    v_exp_f32 v22, v22
    v_mfma_f32_16x16x32_bf16 v[136:139], a[212:215], v[36:39], v[136:139]
    v_cvt_pk_bf16_f32 v42, v20, v21
    v_mfma_f32_16x16x32_bf16 v[140:143], a[216:219], v[32:35], v[140:143]
    s_add_u32 s54, s55, 2048
    v_exp_f32 v23, v23
    v_mfma_f32_16x16x32_bf16 v[140:143], a[220:223], v[36:39], v[140:143]
    buffer_load_dwordx4 a[172:175], v8, s[72:75], s54 offen
    v_mfma_f32_16x16x32_bf16 v[144:147], a[224:227], v[32:35], v[144:147]
    v_exp_f32 v24, v24
    v_mfma_f32_16x16x32_bf16 v[144:147], a[228:231], v[36:39], v[144:147]
    v_cvt_pk_bf16_f32 v43, v22, v23
    v_mfma_f32_16x16x32_bf16 v[148:151], a[232:235], v[32:35], v[148:151]
    s_mov_b32 s54, 442368
    v_exp_f32 v25, v25
    v_mfma_f32_16x16x32_bf16 v[148:151], a[236:239], v[36:39], v[148:151]
    buffer_load_dwordx4 a[140:143], v6, s[68:71], s54 offen
    v_mfma_f32_16x16x32_bf16 v[152:155], a[240:243], v[32:35], v[152:155]
    v_exp_f32 v26, v26
    v_mfma_f32_16x16x32_bf16 v[152:155], a[244:247], v[36:39], v[152:155]
    v_cvt_pk_bf16_f32 v44, v24, v25
    v_mfma_f32_16x16x32_bf16 v[156:159], a[248:251], v[32:35], v[156:159]
    s_add_u32 s54, s55, 3072
    v_exp_f32 v27, v27
    v_mfma_f32_16x16x32_bf16 v[156:159], a[252:255], v[36:39], v[156:159]
    buffer_load_dwordx4 a[176:179], v8, s[72:75], s54 offen
    v_smfmac_f32_16x16x64_bf16 a[0:3], a[16:19], v[32:39], v11
    v_mfma_f32_16x16x32_bf16 v[16:19], a[64:67], v[96:99], v[56:59]
    v_exp_f32 v28, v28
    v_mfma_f32_16x16x32_bf16 v[16:19], a[68:71], v[100:103], v[16:19]
    v_cvt_pk_bf16_f32 v45, v26, v27
    v_mfma_f32_16x16x32_bf16 v[16:19], a[72:75], v[104:107], v[16:19]
    s_mov_b32 s54, 589824
    v_exp_f32 v29, v29
    v_mfma_f32_16x16x32_bf16 v[16:19], a[76:79], v[108:111], v[16:19]
    buffer_load_dwordx4 a[144:147], v6, s[68:71], s54 offen
    v_mfma_f32_16x16x32_bf16 v[20:23], a[80:83], v[96:99], v[56:59]
    v_exp_f32 v30, v30
    v_mfma_f32_16x16x32_bf16 v[20:23], a[84:87], v[100:103], v[20:23]
    v_cvt_pk_bf16_f32 v46, v28, v29
    v_accvgpr_read_b32 v12, a0
    v_mfma_f32_16x16x32_bf16 v[20:23], a[88:91], v[104:107], v[20:23]
    s_add_u32 s54, s55, 4096
    v_exp_f32 v31, v31
    v_mfma_f32_16x16x32_bf16 v[20:23], a[92:95], v[108:111], v[20:23]
    buffer_load_dwordx4 a[180:183], v8, s[72:75], s54 offen
    v_mfma_f32_16x16x32_bf16 v[24:27], a[96:99], v[96:99], v[56:59]
    v_exp_f32 v16, v16
    v_mfma_f32_16x16x32_bf16 v[24:27], a[100:103], v[100:103], v[24:27]
    v_cvt_pk_bf16_f32 v47, v30, v31
    v_accvgpr_read_b32 v13, a1
    v_mfma_f32_16x16x32_bf16 v[24:27], a[104:107], v[104:107], v[24:27]
    s_mov_b32 s54, 737280
    v_exp_f32 v17, v17
    v_mfma_f32_16x16x32_bf16 v[24:27], a[108:111], v[108:111], v[24:27]
    buffer_load_dwordx4 a[148:151], v6, s[68:71], s54 offen
    v_mfma_f32_16x16x32_bf16 v[28:31], a[112:115], v[96:99], v[56:59]
    v_exp_f32 v18, v18
    v_mfma_f32_16x16x32_bf16 v[28:31], a[116:119], v[100:103], v[28:31]
    v_cvt_pk_bf16_f32 v32, v16, v17
    v_add_f32 v12, v12, v13
    v_mfma_f32_16x16x32_bf16 v[28:31], a[120:123], v[104:107], v[28:31]
    s_add_u32 s54, s55, 5120
    v_exp_f32 v19, v19
    v_mfma_f32_16x16x32_bf16 v[28:31], a[124:127], v[108:111], v[28:31]
    buffer_load_dwordx4 a[184:187], v8, s[72:75], s54 offen
    v_mfma_f32_16x16x32_bf16 v[160:163], a[192:195], v[40:43], v[160:163]
    v_exp_f32 v20, v20
    v_mfma_f32_16x16x32_bf16 v[160:163], a[196:199], v[44:47], v[160:163]
    v_cvt_pk_bf16_f32 v33, v18, v19
    v_cmp_nlt_f32 s[56:57], v12, s15
    v_mfma_f32_16x16x32_bf16 v[164:167], a[200:203], v[40:43], v[164:167]
    s_mov_b32 s54, 884736
    v_exp_f32 v21, v21
    v_mfma_f32_16x16x32_bf16 v[164:167], a[204:207], v[44:47], v[164:167]
    buffer_load_dwordx4 a[152:155], v6, s[68:71], s54 offen
    v_mfma_f32_16x16x32_bf16 v[168:171], a[208:211], v[40:43], v[168:171]
    v_exp_f32 v22, v22
    v_mfma_f32_16x16x32_bf16 v[168:171], a[212:215], v[44:47], v[168:171]
    v_cvt_pk_bf16_f32 v34, v20, v21
    v_mfma_f32_16x16x32_bf16 v[172:175], a[216:219], v[40:43], v[172:175]
    s_add_u32 s54, s55, 6144
    v_exp_f32 v23, v23
    v_mfma_f32_16x16x32_bf16 v[172:175], a[220:223], v[44:47], v[172:175]
    buffer_load_dwordx4 a[188:191], v8, s[72:75], s54 offen
    v_mfma_f32_16x16x32_bf16 v[176:179], a[224:227], v[40:43], v[176:179]
    v_exp_f32 v24, v24
    v_mfma_f32_16x16x32_bf16 v[176:179], a[228:231], v[44:47], v[176:179]
    v_cvt_pk_bf16_f32 v35, v22, v23
    v_mfma_f32_16x16x32_bf16 v[180:183], a[232:235], v[40:43], v[180:183]
    s_mov_b32 s54, 1032192
    v_exp_f32 v25, v25
    v_mfma_f32_16x16x32_bf16 v[180:183], a[236:239], v[44:47], v[180:183]
    buffer_load_dwordx4 a[156:159], v6, s[68:71], s54 offen
    v_mfma_f32_16x16x32_bf16 v[184:187], a[240:243], v[40:43], v[184:187]
    v_exp_f32 v26, v26
    v_mfma_f32_16x16x32_bf16 v[184:187], a[244:247], v[44:47], v[184:187]
    v_cvt_pk_bf16_f32 v36, v24, v25
    v_mfma_f32_16x16x32_bf16 v[188:191], a[248:251], v[40:43], v[188:191]
    s_mov_b32 s54, 1179648
    v_exp_f32 v27, v27
    v_mfma_f32_16x16x32_bf16 v[188:191], a[252:255], v[44:47], v[188:191]
    buffer_load_dwordx4 a[160:163], v6, s[68:71], s54 offen
    v_smfmac_f32_16x16x64_bf16 a[4:7], a[16:19], v[40:47], v11
    v_rcp_f32 v12, v12
    v_mfma_f32_16x16x32_bf16 v[16:19], a[64:67], v[112:115], v[60:63]
    v_exp_f32 v28, v28
    v_mfma_f32_16x16x32_bf16 v[16:19], a[68:71], v[116:119], v[16:19]
    v_cvt_pk_bf16_f32 v37, v26, v27
    v_mul_f32 v128, v128, v12
    v_mfma_f32_16x16x32_bf16 v[16:19], a[72:75], v[120:123], v[16:19]
    v_exp_f32 v29, v29
    v_mfma_f32_16x16x32_bf16 v[16:19], a[76:79], v[124:127], v[16:19]
    v_mul_f32 v129, v129, v12
    v_mul_f32 v130, v130, v12
    v_mfma_f32_16x16x32_bf16 v[20:23], a[80:83], v[112:115], v[60:63]
    v_exp_f32 v30, v30
    v_mfma_f32_16x16x32_bf16 v[20:23], a[84:87], v[116:119], v[20:23]
    v_cvt_pk_bf16_f32 v38, v28, v29
    v_mul_f32 v131, v131, v12
    v_mfma_f32_16x16x32_bf16 v[20:23], a[88:91], v[120:123], v[20:23]
    v_exp_f32 v31, v31
    v_mfma_f32_16x16x32_bf16 v[20:23], a[92:95], v[124:127], v[20:23]
    v_mul_f32 v132, v132, v12
    v_mul_f32 v133, v133, v12
    v_mfma_f32_16x16x32_bf16 v[24:27], a[96:99], v[112:115], v[60:63]
    v_exp_f32 v16, v16
    v_mfma_f32_16x16x32_bf16 v[24:27], a[100:103], v[116:119], v[24:27]
    v_cvt_pk_bf16_f32 v39, v30, v31
    v_mul_f32 v134, v134, v12
    v_mfma_f32_16x16x32_bf16 v[24:27], a[104:107], v[120:123], v[24:27]
    v_exp_f32 v17, v17
    v_mfma_f32_16x16x32_bf16 v[24:27], a[108:111], v[124:127], v[24:27]
    v_mul_f32 v135, v135, v12
    v_cvt_pk_bf16_f32 v128, v128, v129
    v_mfma_f32_16x16x32_bf16 v[28:31], a[112:115], v[112:115], v[60:63]
    v_exp_f32 v18, v18
    v_mfma_f32_16x16x32_bf16 v[28:31], a[116:119], v[116:119], v[28:31]
    v_cvt_pk_bf16_f32 v40, v16, v17
    v_cvt_pk_bf16_f32 v129, v130, v131
    v_mfma_f32_16x16x32_bf16 v[28:31], a[120:123], v[120:123], v[28:31]
    v_exp_f32 v19, v19
    v_mfma_f32_16x16x32_bf16 v[28:31], a[124:127], v[124:127], v[28:31]
    v_cvt_pk_bf16_f32 v130, v132, v133
    v_cvt_pk_bf16_f32 v131, v134, v135
    v_mfma_f32_16x16x32_bf16 v[192:195], a[192:195], v[32:35], v[192:195]
    v_exp_f32 v20, v20
    v_mfma_f32_16x16x32_bf16 v[192:195], a[196:199], v[36:39], v[192:195]
    v_cvt_pk_bf16_f32 v41, v18, v19
    v_mul_f32 v136, v136, v12
    v_mfma_f32_16x16x32_bf16 v[196:199], a[200:203], v[32:35], v[196:199]
    v_exp_f32 v21, v21
    v_mfma_f32_16x16x32_bf16 v[196:199], a[204:207], v[36:39], v[196:199]
    v_mul_f32 v137, v137, v12
    v_mul_f32 v138, v138, v12
    v_mfma_f32_16x16x32_bf16 v[200:203], a[208:211], v[32:35], v[200:203]
    v_exp_f32 v22, v22
    v_mfma_f32_16x16x32_bf16 v[200:203], a[212:215], v[36:39], v[200:203]
    v_cvt_pk_bf16_f32 v42, v20, v21
    v_mul_f32 v139, v139, v12
    v_mfma_f32_16x16x32_bf16 v[204:207], a[216:219], v[32:35], v[204:207]
    v_exp_f32 v23, v23
    v_mfma_f32_16x16x32_bf16 v[204:207], a[220:223], v[36:39], v[204:207]
    v_mul_f32 v140, v140, v12
    v_mul_f32 v141, v141, v12
    v_mfma_f32_16x16x32_bf16 v[208:211], a[224:227], v[32:35], v[208:211]
    v_exp_f32 v24, v24
    v_mfma_f32_16x16x32_bf16 v[208:211], a[228:231], v[36:39], v[208:211]
    v_cvt_pk_bf16_f32 v43, v22, v23
    v_mul_f32 v142, v142, v12
    v_mfma_f32_16x16x32_bf16 v[212:215], a[232:235], v[32:35], v[212:215]
    v_exp_f32 v25, v25
    v_mfma_f32_16x16x32_bf16 v[212:215], a[236:239], v[36:39], v[212:215]
    v_mul_f32 v143, v143, v12
    v_cvt_pk_bf16_f32 v136, v136, v137
    v_mfma_f32_16x16x32_bf16 v[216:219], a[240:243], v[32:35], v[216:219]
    v_exp_f32 v26, v26
    v_mfma_f32_16x16x32_bf16 v[216:219], a[244:247], v[36:39], v[216:219]
    v_cvt_pk_bf16_f32 v44, v24, v25
    v_cvt_pk_bf16_f32 v137, v138, v139
    v_mfma_f32_16x16x32_bf16 v[220:223], a[248:251], v[32:35], v[220:223]
    v_exp_f32 v27, v27
    v_mfma_f32_16x16x32_bf16 v[220:223], a[252:255], v[36:39], v[220:223]
    v_cvt_pk_bf16_f32 v138, v140, v141
    v_cvt_pk_bf16_f32 v139, v142, v143
    v_smfmac_f32_16x16x64_bf16 a[8:11], a[16:19], v[32:39], v11
    v_mul_f32 v144, v144, v12
    v_mul_f32 v145, v145, v12
    v_exp_f32 v28, v28
    s_nop 0
    v_cvt_pk_bf16_f32 v45, v26, v27
    v_exp_f32 v29, v29
    s_nop 0
    v_exp_f32 v30, v30
    s_nop 0
    v_cvt_pk_bf16_f32 v46, v28, v29
    v_exp_f32 v31, v31
    s_nop 0
    v_cvt_pk_bf16_f32 v47, v30, v31
    s_nop 1
    v_mfma_f32_16x16x32_bf16 v[224:227], a[192:195], v[40:43], v[224:227]
    v_mul_f32 v146, v146, v12
    v_mul_f32 v147, v147, v12
    v_mfma_f32_16x16x32_bf16 v[224:227], a[196:199], v[44:47], v[224:227]
    ds_read_b64_tr_b16 a[64:65], v4 offset:0
    ds_read_b64_tr_b16 a[66:67], v4 offset:128
    v_mfma_f32_16x16x32_bf16 v[228:231], a[200:203], v[40:43], v[228:231]
    ds_read_b64_tr_b16 a[68:69], v4 offset:256
    ds_read_b64_tr_b16 a[70:71], v4 offset:384
    v_mfma_f32_16x16x32_bf16 v[228:231], a[204:207], v[44:47], v[228:231]
    ds_read_b64_tr_b16 a[72:73], v4 offset:512
    ds_read_b64_tr_b16 a[74:75], v4 offset:640
    v_mfma_f32_16x16x32_bf16 v[232:235], a[208:211], v[40:43], v[232:235]
    ds_read_b64_tr_b16 a[76:77], v4 offset:768
    ds_read_b64_tr_b16 a[78:79], v4 offset:896
    v_mfma_f32_16x16x32_bf16 v[232:235], a[212:215], v[44:47], v[232:235]
    ds_read_b64_tr_b16 a[80:81], v4 offset:16896
    ds_read_b64_tr_b16 a[82:83], v4 offset:17024
    v_mfma_f32_16x16x32_bf16 v[236:239], a[216:219], v[40:43], v[236:239]
    ds_read_b64_tr_b16 a[84:85], v4 offset:17152
    ds_read_b64_tr_b16 a[86:87], v4 offset:17280
    v_mfma_f32_16x16x32_bf16 v[236:239], a[220:223], v[44:47], v[236:239]
    ds_read_b64_tr_b16 a[88:89], v4 offset:17408
    ds_read_b64_tr_b16 a[90:91], v4 offset:17536
    v_mfma_f32_16x16x32_bf16 v[240:243], a[224:227], v[40:43], v[240:243]
    ds_read_b64_tr_b16 a[92:93], v4 offset:17664
    ds_read_b64_tr_b16 a[94:95], v4 offset:17792
    v_mfma_f32_16x16x32_bf16 v[240:243], a[228:231], v[44:47], v[240:243]
    v_mul_f32 v148, v148, v12
    v_mul_f32 v149, v149, v12
    v_mfma_f32_16x16x32_bf16 v[244:247], a[232:235], v[40:43], v[244:247]
    v_mul_f32 v150, v150, v12
    v_mul_f32 v151, v151, v12
    v_mfma_f32_16x16x32_bf16 v[244:247], a[236:239], v[44:47], v[244:247]
    v_cvt_pk_bf16_f32 v144, v144, v145
    v_cvt_pk_bf16_f32 v145, v146, v147
    v_mfma_f32_16x16x32_bf16 v[248:251], a[240:243], v[40:43], v[248:251]
    v_cvt_pk_bf16_f32 v146, v148, v149
    v_cvt_pk_bf16_f32 v147, v150, v151
    v_mfma_f32_16x16x32_bf16 v[248:251], a[244:247], v[44:47], v[248:251]
    v_mul_f32 v152, v152, v12
    v_mul_f32 v153, v153, v12
    v_mfma_f32_16x16x32_bf16 v[252:255], a[248:251], v[40:43], v[252:255]
    v_mul_f32 v154, v154, v12
    v_mul_f32 v155, v155, v12
    v_mfma_f32_16x16x32_bf16 v[252:255], a[252:255], v[44:47], v[252:255]
    v_mul_f32 v156, v156, v12
    v_mul_f32 v157, v157, v12
    v_smfmac_f32_16x16x64_bf16 a[12:15], a[16:19], v[40:47], v11
    v_mul_f32 v158, v158, v12
    v_mul_f32 v159, v159, v12
    v_cvt_pk_bf16_f32 v152, v152, v153
    v_cvt_pk_bf16_f32 v153, v154, v155
    v_cvt_pk_bf16_f32 v154, v156, v157
    v_cvt_pk_bf16_f32 v155, v158, v159
    v_accvgpr_read_b32 v14, a4
    v_accvgpr_read_b32 v15, a5
    v_add_f32 v14, v14, v15
    v_cmp_nlt_f32 s[58:59], v14, s15
    v_rcp_f32 v14, v14
    v_accvgpr_read_b32 v12, a8
    v_accvgpr_read_b32 v13, a9
    v_add_f32 v12, v12, v13
    v_cmp_nlt_f32 s[60:61], v12, s15
    v_rcp_f32 v12, v12
    v_pk_mul_f32 v[160:161], v[160:161], v[14:15] op_sel_hi:[1,0]
    v_pk_mul_f32 v[162:163], v[162:163], v[14:15] op_sel_hi:[1,0]
    v_pk_mul_f32 v[164:165], v[164:165], v[14:15] op_sel_hi:[1,0]
    v_pk_mul_f32 v[166:167], v[166:167], v[14:15] op_sel_hi:[1,0]
    v_cvt_pk_bf16_f32 v160, v160, v161
    v_cvt_pk_bf16_f32 v161, v162, v163
    v_cvt_pk_bf16_f32 v162, v164, v165
    v_cvt_pk_bf16_f32 v163, v166, v167
    v_pk_mul_f32 v[168:169], v[168:169], v[14:15] op_sel_hi:[1,0]
    v_pk_mul_f32 v[170:171], v[170:171], v[14:15] op_sel_hi:[1,0]
    v_pk_mul_f32 v[172:173], v[172:173], v[14:15] op_sel_hi:[1,0]
    v_pk_mul_f32 v[174:175], v[174:175], v[14:15] op_sel_hi:[1,0]
    v_cvt_pk_bf16_f32 v168, v168, v169
    v_cvt_pk_bf16_f32 v169, v170, v171
    v_cvt_pk_bf16_f32 v170, v172, v173
    v_cvt_pk_bf16_f32 v171, v174, v175
    v_pk_mul_f32 v[176:177], v[176:177], v[14:15] op_sel_hi:[1,0]
    v_pk_mul_f32 v[178:179], v[178:179], v[14:15] op_sel_hi:[1,0]
    v_pk_mul_f32 v[180:181], v[180:181], v[14:15] op_sel_hi:[1,0]
    v_pk_mul_f32 v[182:183], v[182:183], v[14:15] op_sel_hi:[1,0]
    v_cvt_pk_bf16_f32 v176, v176, v177
    v_cvt_pk_bf16_f32 v177, v178, v179
    v_cvt_pk_bf16_f32 v178, v180, v181
    v_cvt_pk_bf16_f32 v179, v182, v183
    v_pk_mul_f32 v[184:185], v[184:185], v[14:15] op_sel_hi:[1,0]
    v_pk_mul_f32 v[186:187], v[186:187], v[14:15] op_sel_hi:[1,0]
    v_pk_mul_f32 v[188:189], v[188:189], v[14:15] op_sel_hi:[1,0]
    v_pk_mul_f32 v[190:191], v[190:191], v[14:15] op_sel_hi:[1,0]
    v_cvt_pk_bf16_f32 v184, v184, v185
    v_cvt_pk_bf16_f32 v185, v186, v187
    v_cvt_pk_bf16_f32 v186, v188, v189
    v_cvt_pk_bf16_f32 v187, v190, v191
    v_accvgpr_read_b32 v14, a12
    v_accvgpr_read_b32 v15, a13
    v_add_f32 v14, v14, v15
    v_cmp_nlt_f32 s[62:63], v14, s15
    s_or_b64 s[56:57], s[56:57], s[58:59]
    v_rcp_f32 v14, v14
    s_or_b64 s[60:61], s[60:61], s[62:63]
    s_or_b64 s[56:57], s[56:57], s[60:61]
    s_cselect_b32 s3, 1, 0
    s_andn2_b32 s3, s3, s50
    s_lshl2_add_u32 s14, s51, 13824
    v_mov_b32 v56, s3
    v_mov_b32 v57, s14
    v_mov_b32 v58, 13824
    ds_write_b32 v57, v56
    v_pk_mul_f32 v[192:193], v[192:193], v[12:13] op_sel_hi:[1,0]
    v_pk_mul_f32 v[194:195], v[194:195], v[12:13] op_sel_hi:[1,0]
    v_pk_mul_f32 v[196:197], v[196:197], v[12:13] op_sel_hi:[1,0]
    v_pk_mul_f32 v[198:199], v[198:199], v[12:13] op_sel_hi:[1,0]
    v_cvt_pk_bf16_f32 v192, v192, v193
    v_cvt_pk_bf16_f32 v193, v194, v195
    v_cvt_pk_bf16_f32 v194, v196, v197
    v_cvt_pk_bf16_f32 v195, v198, v199
    v_pk_mul_f32 v[200:201], v[200:201], v[12:13] op_sel_hi:[1,0]
    v_pk_mul_f32 v[202:203], v[202:203], v[12:13] op_sel_hi:[1,0]
    v_pk_mul_f32 v[204:205], v[204:205], v[12:13] op_sel_hi:[1,0]
    v_pk_mul_f32 v[206:207], v[206:207], v[12:13] op_sel_hi:[1,0]
    v_cvt_pk_bf16_f32 v200, v200, v201
    v_cvt_pk_bf16_f32 v201, v202, v203
    v_cvt_pk_bf16_f32 v202, v204, v205
    v_cvt_pk_bf16_f32 v203, v206, v207
    v_pk_mul_f32 v[208:209], v[208:209], v[12:13] op_sel_hi:[1,0]
    v_pk_mul_f32 v[210:211], v[210:211], v[12:13] op_sel_hi:[1,0]
    v_pk_mul_f32 v[212:213], v[212:213], v[12:13] op_sel_hi:[1,0]
    v_pk_mul_f32 v[214:215], v[214:215], v[12:13] op_sel_hi:[1,0]
    v_cvt_pk_bf16_f32 v208, v208, v209
    v_cvt_pk_bf16_f32 v209, v210, v211
    v_cvt_pk_bf16_f32 v210, v212, v213
    v_cvt_pk_bf16_f32 v211, v214, v215
    v_pk_mul_f32 v[216:217], v[216:217], v[12:13] op_sel_hi:[1,0]
    v_pk_mul_f32 v[218:219], v[218:219], v[12:13] op_sel_hi:[1,0]
    v_pk_mul_f32 v[220:221], v[220:221], v[12:13] op_sel_hi:[1,0]
    v_pk_mul_f32 v[222:223], v[222:223], v[12:13] op_sel_hi:[1,0]
    v_cvt_pk_bf16_f32 v216, v216, v217
    v_cvt_pk_bf16_f32 v217, v218, v219
    v_cvt_pk_bf16_f32 v218, v220, v221
    v_cvt_pk_bf16_f32 v219, v222, v223
    v_pk_mul_f32 v[224:225], v[224:225], v[14:15] op_sel_hi:[1,0]
    v_pk_mul_f32 v[226:227], v[226:227], v[14:15] op_sel_hi:[1,0]
    v_pk_mul_f32 v[228:229], v[228:229], v[14:15] op_sel_hi:[1,0]
    v_pk_mul_f32 v[230:231], v[230:231], v[14:15] op_sel_hi:[1,0]
    v_cvt_pk_bf16_f32 v224, v224, v225
    v_cvt_pk_bf16_f32 v225, v226, v227
    v_cvt_pk_bf16_f32 v226, v228, v229
    v_cvt_pk_bf16_f32 v227, v230, v231
    v_pk_mul_f32 v[232:233], v[232:233], v[14:15] op_sel_hi:[1,0]
    v_pk_mul_f32 v[234:235], v[234:235], v[14:15] op_sel_hi:[1,0]
    v_pk_mul_f32 v[236:237], v[236:237], v[14:15] op_sel_hi:[1,0]
    v_pk_mul_f32 v[238:239], v[238:239], v[14:15] op_sel_hi:[1,0]
    v_cvt_pk_bf16_f32 v232, v232, v233
    v_cvt_pk_bf16_f32 v233, v234, v235
    v_cvt_pk_bf16_f32 v234, v236, v237
L2_pad9:
    s_cbranch_execz L2_pad13
    v_cvt_pk_bf16_f32 v235, v238, v239
    v_pk_mul_f32 v[240:241], v[240:241], v[14:15] op_sel_hi:[1,0]
    v_pk_mul_f32 v[242:243], v[242:243], v[14:15] op_sel_hi:[1,0]
    v_pk_mul_f32 v[244:245], v[244:245], v[14:15] op_sel_hi:[1,0]
    v_pk_mul_f32 v[246:247], v[246:247], v[14:15] op_sel_hi:[1,0]
    v_cvt_pk_bf16_f32 v240, v240, v241
    v_cvt_pk_bf16_f32 v241, v242, v243
    v_cvt_pk_bf16_f32 v242, v244, v245
    v_cvt_pk_bf16_f32 v243, v246, v247
    v_pk_mul_f32 v[248:249], v[248:249], v[14:15] op_sel_hi:[1,0]
    v_pk_mul_f32 v[250:251], v[250:251], v[14:15] op_sel_hi:[1,0]
    v_pk_mul_f32 v[252:253], v[252:253], v[14:15] op_sel_hi:[1,0]
    v_pk_mul_f32 v[254:255], v[254:255], v[14:15] op_sel_hi:[1,0]
    v_cvt_pk_bf16_f32 v248, v248, v249
    v_cvt_pk_bf16_f32 v249, v250, v251
    v_cvt_pk_bf16_f32 v250, v252, v253
    v_cvt_pk_bf16_f32 v251, v254, v255
    s_waitcnt lgkmcnt(13)
    v_mfma_f32_16x16x32_bf16 v[16:19], a[64:67], v[128:131], 0
    ds_read_b64_tr_b16 a[96:97], v4 offset:32
    ds_read_b64_tr_b16 a[98:99], v4 offset:160
    v_mfma_f32_16x16x32_bf16 v[16:19], a[68:71], v[136:139], v[16:19]
    s_waitcnt lgkmcnt(11)
    ds_read_b64_tr_b16 a[100:101], v4 offset:288
    ds_read_b64_tr_b16 a[102:103], v4 offset:416
    v_mfma_f32_16x16x32_bf16 v[16:19], a[72:75], v[144:147], v[16:19]
    s_add_u32 s54, s55, 7168
    ds_read_b64_tr_b16 a[104:105], v4 offset:544
    v_mfma_f32_16x16x32_bf16 v[16:19], a[76:79], v[152:155], v[16:19]
    s_waitcnt lgkmcnt(10)
    buffer_load_dwordx4 a[192:195], v8, s[72:75], s54 offen
    v_mfma_f32_16x16x32_bf16 v[16:19], a[80:83], v[192:195], v[16:19]
    ds_read_b64_tr_b16 a[106:107], v4 offset:672
    v_mfma_f32_16x16x32_bf16 v[16:19], a[84:87], v[200:203], v[16:19]
    s_waitcnt lgkmcnt(7)
    ds_read_b64_tr_b16 a[108:109], v4 offset:800
    v_mfma_f32_16x16x32_bf16 v[16:19], a[88:91], v[208:211], v[16:19]
    s_add_u32 s54, s55, 8192
    ds_read_b64_tr_b16 a[110:111], v4 offset:928
    v_mfma_f32_16x16x32_bf16 v[16:19], a[92:95], v[216:219], v[16:19]
    buffer_load_dwordx4 a[196:199], v8, s[72:75], s54 offen
    v_mfma_f32_16x16x32_bf16 v[20:23], a[64:67], v[160:163], 0
    ds_read_b64_tr_b16 a[112:113], v4 offset:16928
    v_mfma_f32_16x16x32_bf16 v[20:23], a[68:71], v[168:171], v[20:23]
    ds_read_b64_tr_b16 a[114:115], v4 offset:17056
    v_mfma_f32_16x16x32_bf16 v[20:23], a[72:75], v[176:179], v[20:23]
    ds_read_b64_tr_b16 a[116:117], v4 offset:17184
    v_mfma_f32_16x16x32_bf16 v[20:23], a[76:79], v[184:187], v[20:23]
    ds_read_b64_tr_b16 a[118:119], v4 offset:17312
    v_mfma_f32_16x16x32_bf16 v[20:23], a[80:83], v[224:227], v[20:23]
    ds_read_b64_tr_b16 a[120:121], v4 offset:17440
    v_mfma_f32_16x16x32_bf16 v[20:23], a[84:87], v[232:235], v[20:23]
    ds_read_b64_tr_b16 a[122:123], v4 offset:17568
    v_mfma_f32_16x16x32_bf16 v[20:23], a[88:91], v[240:243], v[20:23]
    ds_read_b64_tr_b16 a[124:125], v4 offset:17696
    v_mfma_f32_16x16x32_bf16 v[20:23], a[92:95], v[248:251], v[20:23]
    s_waitcnt lgkmcnt(11)
    ds_read_b64_tr_b16 a[126:127], v4 offset:17824
    v_mfma_f32_16x16x32_bf16 v[24:27], a[96:99], v[128:131], 0
    ds_read_b64_tr_b16 a[64:65], v4 offset:64
    v_mfma_f32_16x16x32_bf16 v[24:27], a[100:103], v[136:139], v[24:27]
    s_waitcnt lgkmcnt(9)
    ds_read_b64_tr_b16 a[66:67], v4 offset:192
    v_mfma_f32_16x16x32_bf16 v[24:27], a[104:107], v[144:147], v[24:27]
    ds_read_b64_tr_b16 a[68:69], v4 offset:320
    v_mfma_f32_16x16x32_bf16 v[24:27], a[108:111], v[152:155], v[24:27]
    s_waitcnt lgkmcnt(7)
    ds_read_b64_tr_b16 a[70:71], v4 offset:448
    v_mfma_f32_16x16x32_bf16 v[24:27], a[112:115], v[192:195], v[24:27]
    ds_read_b64_tr_b16 a[72:73], v4 offset:576
    v_mfma_f32_16x16x32_bf16 v[24:27], a[116:119], v[200:203], v[24:27]
    s_waitcnt lgkmcnt(5)
    ds_read_b64_tr_b16 a[74:75], v4 offset:704
    v_mfma_f32_16x16x32_bf16 v[24:27], a[120:123], v[208:211], v[24:27]
    ds_read_b64_tr_b16 a[76:77], v4 offset:832
    v_mfma_f32_16x16x32_bf16 v[24:27], a[124:127], v[216:219], v[24:27]
    ds_read_b64_tr_b16 a[78:79], v4 offset:960
    v_mfma_f32_16x16x32_bf16 v[28:31], a[96:99], v[160:163], 0
    ds_read_b64_tr_b16 a[80:81], v4 offset:16960
    v_mfma_f32_16x16x32_bf16 v[28:31], a[100:103], v[168:171], v[28:31]
    ds_read_b64_tr_b16 a[82:83], v4 offset:17088
    v_mfma_f32_16x16x32_bf16 v[28:31], a[104:107], v[176:179], v[28:31]
    ds_read_b64_tr_b16 a[84:85], v4 offset:17216
    v_mfma_f32_16x16x32_bf16 v[28:31], a[108:111], v[184:187], v[28:31]
    ds_read_b64_tr_b16 a[86:87], v4 offset:17344
    v_mfma_f32_16x16x32_bf16 v[28:31], a[112:115], v[224:227], v[28:31]
    ds_read_b64_tr_b16 a[88:89], v4 offset:17472
    v_mfma_f32_16x16x32_bf16 v[28:31], a[116:119], v[232:235], v[28:31]
    ds_read_b64_tr_b16 a[90:91], v4 offset:17600
    v_mfma_f32_16x16x32_bf16 v[28:31], a[120:123], v[240:243], v[28:31]
    ds_read_b64_tr_b16 a[92:93], v4 offset:17728
    v_mfma_f32_16x16x32_bf16 v[28:31], a[124:127], v[248:251], v[28:31]
    s_waitcnt lgkmcnt(11)
    ds_read_b64_tr_b16 a[94:95], v4 offset:17856
    v_mfma_f32_16x16x32_bf16 v[32:35], a[64:67], v[128:131], 0
    ds_read_b64_tr_b16 a[96:97], v4 offset:96
    v_cvt_pk_bf16_f32 v48, v16, v17
    v_mfma_f32_16x16x32_bf16 v[32:35], a[68:71], v[136:139], v[32:35]
    s_waitcnt lgkmcnt(9)
    ds_read_b64_tr_b16 a[98:99], v4 offset:224
    v_cvt_pk_bf16_f32 v49, v18, v19
    v_mfma_f32_16x16x32_bf16 v[32:35], a[72:75], v[144:147], v[32:35]
    ds_read_b64_tr_b16 a[100:101], v4 offset:352
    v_cvt_pk_bf16_f32 v50, v24, v25
    v_mfma_f32_16x16x32_bf16 v[32:35], a[76:79], v[152:155], v[32:35]
    s_waitcnt lgkmcnt(7)
    ds_read_b64_tr_b16 a[102:103], v4 offset:480
    v_cvt_pk_bf16_f32 v51, v26, v27
    v_mfma_f32_16x16x32_bf16 v[32:35], a[80:83], v[192:195], v[32:35]
    s_mov_b32 s54, 0
    ds_read_b64_tr_b16 a[104:105], v4 offset:608
    ds_read_b64_tr_b16 a[106:107], v4 offset:736
    v_mfma_f32_16x16x32_bf16 v[32:35], a[84:87], v[200:203], v[32:35]
    s_waitcnt lgkmcnt(6)
    v_permlane32_swap_b32 v48, v50
    v_mfma_f32_16x16x32_bf16 v[32:35], a[88:91], v[208:211], v[32:35]
    v_permlane32_swap_b32 v49, v51
    v_mfma_f32_16x16x32_bf16 v[32:35], a[92:95], v[216:219], v[32:35]
    ds_read_b64_tr_b16 a[108:109], v4 offset:864
    ds_read_b64_tr_b16 a[110:111], v4 offset:992
    buffer_store_dwordx4 v[48:51], v10, s[40:43], s54 offen offset:0 sc1
    v_mfma_f32_16x16x32_bf16 v[36:39], a[64:67], v[160:163], 0
    ds_read_b64_tr_b16 a[112:113], v4 offset:16992
    v_cvt_pk_bf16_f32 v52, v20, v21
    v_mfma_f32_16x16x32_bf16 v[36:39], a[68:71], v[168:171], v[36:39]
    ds_read_b64_tr_b16 a[114:115], v4 offset:17120
    v_cvt_pk_bf16_f32 v53, v22, v23
    v_mfma_f32_16x16x32_bf16 v[36:39], a[72:75], v[176:179], v[36:39]
    ds_read_b64_tr_b16 a[116:117], v4 offset:17248
    v_cvt_pk_bf16_f32 v54, v28, v29
    v_mfma_f32_16x16x32_bf16 v[36:39], a[76:79], v[184:187], v[36:39]
    ds_read_b64_tr_b16 a[118:119], v4 offset:17376
    v_cvt_pk_bf16_f32 v55, v30, v31
    v_mfma_f32_16x16x32_bf16 v[36:39], a[80:83], v[224:227], v[36:39]
    s_mov_b32 s54, 294912
    ds_read_b64_tr_b16 a[120:121], v4 offset:17504
    ds_read_b64_tr_b16 a[122:123], v4 offset:17632
    v_mfma_f32_16x16x32_bf16 v[36:39], a[84:87], v[232:235], v[36:39]
    v_permlane32_swap_b32 v52, v54
    v_mfma_f32_16x16x32_bf16 v[36:39], a[88:91], v[240:243], v[36:39]
    v_permlane32_swap_b32 v53, v55
    v_mfma_f32_16x16x32_bf16 v[36:39], a[92:95], v[248:251], v[36:39]
    s_waitcnt vmcnt(29)
    s_barrier
    s_waitcnt lgkmcnt(10)
    ds_read_b64_tr_b16 a[124:125], v4 offset:17760
    ds_read_b64_tr_b16 a[126:127], v4 offset:17888
    ds_read_b128 v[60:63], v58
    buffer_store_dwordx4 v[52:55], v10, s[40:43], s54 offen offset:0 sc1
    v_mfma_f32_16x16x32_bf16 v[40:43], a[96:99], v[128:131], 0
    s_add_u32 m0, s44, 36864
    ds_read_b64_tr_b16 a[64:65], v4 offset:36864
    ds_read_b64_tr_b16 a[66:67], v4 offset:36992
    v_mfma_f32_16x16x32_bf16 v[40:43], a[100:103], v[136:139], v[40:43]
    s_mov_b32 s45, 384
    s_waitcnt lgkmcnt(11)
    buffer_load_dwordx4 v7, s[28:31], s45 offen offset:0 lds
    v_mfma_f32_16x16x32_bf16 v[40:43], a[104:107], v[144:147], v[40:43]
    s_add_u32 m0, s44, 36768
    ds_read_b64_tr_b16 a[68:69], v4 offset:37120
    ds_read_b64_tr_b16 a[70:71], v4 offset:37248
    v_mfma_f32_16x16x32_bf16 v[40:43], a[108:111], v[152:155], v[40:43]
    s_waitcnt lgkmcnt(9)
    buffer_load_dwordx4 v7, s[28:31], s45 offen offset:1152 lds
    v_mfma_f32_16x16x32_bf16 v[40:43], a[112:115], v[192:195], v[40:43]
    s_add_u32 m0, s44, 36672
    ds_read_b64_tr_b16 a[72:73], v4 offset:37376
    ds_read_b64_tr_b16 a[74:75], v4 offset:37504
    v_mfma_f32_16x16x32_bf16 v[40:43], a[116:119], v[200:203], v[40:43]
    s_waitcnt lgkmcnt(7)
    buffer_load_dwordx4 v7, s[28:31], s45 offen offset:2304 lds
    v_mfma_f32_16x16x32_bf16 v[40:43], a[120:123], v[208:211], v[40:43]
    s_add_u32 m0, s44, 36576
    ds_read_b64_tr_b16 a[76:77], v4 offset:37632
    ds_read_b64_tr_b16 a[78:79], v4 offset:37760
    v_mfma_f32_16x16x32_bf16 v[40:43], a[124:127], v[216:219], v[40:43]
    s_waitcnt lgkmcnt(8)
    buffer_load_dwordx4 v7, s[28:31], s45 offen offset:3456 lds
    v_or3_b32 v60, v60, v61, v62
    v_or_b32 v60, v60, v63
    v_mfma_f32_16x16x32_bf16 v[44:47], a[96:99], v[160:163], 0
    s_add_u32 m0, s44, 53760
    ds_read_b64_tr_b16 a[80:81], v4 offset:53760
    ds_read_b64_tr_b16 a[82:83], v4 offset:53888
    v_mfma_f32_16x16x32_bf16 v[44:47], a[100:103], v[168:171], v[44:47]
    s_mov_b32 s45, 147840
    buffer_load_dwordx4 v7, s[28:31], s45 offen offset:0 lds
    v_mfma_f32_16x16x32_bf16 v[44:47], a[104:107], v[176:179], v[44:47]
    s_add_u32 m0, s44, 53664
    ds_read_b64_tr_b16 a[84:85], v4 offset:54016
    ds_read_b64_tr_b16 a[86:87], v4 offset:54144
    v_mfma_f32_16x16x32_bf16 v[44:47], a[108:111], v[184:187], v[44:47]
    buffer_load_dwordx4 v7, s[28:31], s45 offen offset:1152 lds
    v_mfma_f32_16x16x32_bf16 v[44:47], a[112:115], v[224:227], v[44:47]
    s_add_u32 m0, s44, 53568
    ds_read_b64_tr_b16 a[88:89], v4 offset:54272
    ds_read_b64_tr_b16 a[90:91], v4 offset:54400
    v_mfma_f32_16x16x32_bf16 v[44:47], a[116:119], v[232:235], v[44:47]
    buffer_load_dwordx4 v7, s[28:31], s45 offen offset:2304 lds
    v_mfma_f32_16x16x32_bf16 v[44:47], a[120:123], v[240:243], v[44:47]
    s_add_u32 m0, s44, 53472
    ds_read_b64_tr_b16 a[92:93], v4 offset:54528
    ds_read_b64_tr_b16 a[94:95], v4 offset:54656
    v_mfma_f32_16x16x32_bf16 v[44:47], a[124:127], v[248:251], v[44:47]
    s_waitcnt lgkmcnt(12)
    buffer_load_dwordx4 v7, s[28:31], s45 offen offset:3456 lds
    v_readfirstlane_b32 s3, v60
    v_mfma_f32_16x16x32_bf16 v[16:19], a[64:67], v[128:131], 0
    ds_read_b64_tr_b16 a[96:97], v4 offset:36896
    v_cvt_pk_bf16_f32 v48, v32, v33
    v_mfma_f32_16x16x32_bf16 v[16:19], a[68:71], v[136:139], v[16:19]
    s_waitcnt lgkmcnt(9)
    s_cmp_lg_u32 s3, 0
    ds_read_b64_tr_b16 a[98:99], v4 offset:37024
    v_cvt_pk_bf16_f32 v49, v34, v35
    v_mfma_f32_16x16x32_bf16 v[16:19], a[72:75], v[144:147], v[16:19]
    s_cbranch_scc1 L2_fallback
    ds_read_b64_tr_b16 a[100:101], v4 offset:37152
    v_cvt_pk_bf16_f32 v50, v40, v41
    v_mfma_f32_16x16x32_bf16 v[16:19], a[76:79], v[152:155], v[16:19]
    s_waitcnt lgkmcnt(7)
    ds_read_b64_tr_b16 a[102:103], v4 offset:37280
    v_cvt_pk_bf16_f32 v51, v42, v43
    v_mfma_f32_16x16x32_bf16 v[16:19], a[80:83], v[192:195], v[16:19]
    s_mov_b32 s54, 0
    ds_read_b64_tr_b16 a[104:105], v4 offset:37408
    ds_read_b64_tr_b16 a[106:107], v4 offset:37536
    v_mfma_f32_16x16x32_bf16 v[16:19], a[84:87], v[200:203], v[16:19]
    s_waitcnt lgkmcnt(6)
    v_permlane32_swap_b32 v48, v50
    v_mfma_f32_16x16x32_bf16 v[16:19], a[88:91], v[208:211], v[16:19]
    v_permlane32_swap_b32 v49, v51
    v_mfma_f32_16x16x32_bf16 v[16:19], a[92:95], v[216:219], v[16:19]
    ds_read_b64_tr_b16 a[108:109], v4 offset:37664
    ds_read_b64_tr_b16 a[110:111], v4 offset:37792
    buffer_store_dwordx4 v[48:51], v10, s[40:43], s54 offen offset:512 sc1
    v_mfma_f32_16x16x32_bf16 v[20:23], a[64:67], v[160:163], 0
    ds_read_b64_tr_b16 a[112:113], v4 offset:53792
    v_cvt_pk_bf16_f32 v52, v36, v37
    v_mfma_f32_16x16x32_bf16 v[20:23], a[68:71], v[168:171], v[20:23]
    ds_read_b64_tr_b16 a[114:115], v4 offset:53920
    v_cvt_pk_bf16_f32 v53, v38, v39
    v_mfma_f32_16x16x32_bf16 v[20:23], a[72:75], v[176:179], v[20:23]
    ds_read_b64_tr_b16 a[116:117], v4 offset:54048
    v_cvt_pk_bf16_f32 v54, v44, v45
    v_mfma_f32_16x16x32_bf16 v[20:23], a[76:79], v[184:187], v[20:23]
    ds_read_b64_tr_b16 a[118:119], v4 offset:54176
    v_cvt_pk_bf16_f32 v55, v46, v47
    v_mfma_f32_16x16x32_bf16 v[20:23], a[80:83], v[224:227], v[20:23]
    s_mov_b32 s54, 294912
    ds_read_b64_tr_b16 a[120:121], v4 offset:54304
    ds_read_b64_tr_b16 a[122:123], v4 offset:54432
    v_mfma_f32_16x16x32_bf16 v[20:23], a[84:87], v[232:235], v[20:23]
    v_permlane32_swap_b32 v52, v54
    v_mfma_f32_16x16x32_bf16 v[20:23], a[88:91], v[240:243], v[20:23]
    v_permlane32_swap_b32 v53, v55
    v_mfma_f32_16x16x32_bf16 v[20:23], a[92:95], v[248:251], v[20:23]
    s_waitcnt lgkmcnt(10)
    ds_read_b64_tr_b16 a[124:125], v4 offset:54560
    ds_read_b64_tr_b16 a[126:127], v4 offset:54688
    buffer_store_dwordx4 v[52:55], v10, s[40:43], s54 offen offset:512 sc1
    v_mfma_f32_16x16x32_bf16 v[24:27], a[96:99], v[128:131], 0
    s_mul_i32 s3, s51, 128
    ds_read_b64_tr_b16 a[64:65], v4 offset:36928
    v_lshrrev_b32 v14, 3, v0
    v_mfma_f32_16x16x32_bf16 v[24:27], a[100:103], v[136:139], v[24:27]
    s_waitcnt lgkmcnt(9)
    ds_read_b64_tr_b16 a[66:67], v4 offset:37056
    v_lshl_add_u32 v12, v14, 4, s3
    v_mfma_f32_16x16x32_bf16 v[24:27], a[104:107], v[144:147], v[24:27]
    ds_read_b64_tr_b16 a[68:69], v4 offset:37184
    v_and_b32 v14, 1, v14
    v_mfma_f32_16x16x32_bf16 v[24:27], a[108:111], v[152:155], v[24:27]
    s_waitcnt lgkmcnt(7)
    s_mul_i32 s3, s51, 32
    ds_read_b64_tr_b16 a[70:71], v4 offset:37312
    v_lshl_add_u32 v13, v14, 4, s3
    v_mfma_f32_16x16x32_bf16 v[24:27], a[112:115], v[192:195], v[24:27]
    ds_read_b64_tr_b16 a[72:73], v4 offset:37440
    v_and_b32 v14, 7, v0
    v_mfma_f32_16x16x32_bf16 v[24:27], a[116:119], v[200:203], v[24:27]
    s_waitcnt lgkmcnt(5)
    ds_read_b64_tr_b16 a[74:75], v4 offset:37568
    v_mul_u32_u24 v14, 1152, v14
    v_mfma_f32_16x16x32_bf16 v[24:27], a[120:123], v[208:211], v[24:27]
    ds_read_b64_tr_b16 a[76:77], v4 offset:37696
    v_add_u32 v1, v14, v12
    v_mfma_f32_16x16x32_bf16 v[24:27], a[124:127], v[216:219], v[24:27]
    ds_read_b64_tr_b16 a[78:79], v4 offset:37824
    v_add_u32 v2, v14, v13
    v_mfma_f32_16x16x32_bf16 v[28:31], a[96:99], v[160:163], 0
    ds_read_b64_tr_b16 a[80:81], v4 offset:53824
    v_add_u32 v2, 1024, v2
    v_mfma_f32_16x16x32_bf16 v[28:31], a[100:103], v[168:171], v[28:31]
    s_lshl_b32 s14, s51, 10
    ds_read_b64_tr_b16 a[82:83], v4 offset:53952
    v_add_u32 v5, s14, v8
    v_mfma_f32_16x16x32_bf16 v[28:31], a[104:107], v[176:179], v[28:31]
    ds_read_b64_tr_b16 a[84:85], v4 offset:54080
    v_and_b32 v59, 0xf0, v8
    v_mfma_f32_16x16x32_bf16 v[28:31], a[108:111], v[184:187], v[28:31]
    s_lshl_b32 s14, s51, 8
    ds_read_b64_tr_b16 a[86:87], v4 offset:54208
    v_add_u32 v59, s14, v59
    v_mfma_f32_16x16x32_bf16 v[28:31], a[112:115], v[224:227], v[28:31]
    ds_read_b64_tr_b16 a[88:89], v4 offset:54336
    v_and_b32 v6, 15, v0
    v_mfma_f32_16x16x32_bf16 v[28:31], a[116:119], v[232:235], v[28:31]
    ds_read_b64_tr_b16 a[90:91], v4 offset:54464
    v_lshlrev_b32 v6, 8, v6
    v_mfma_f32_16x16x32_bf16 v[28:31], a[120:123], v[240:243], v[28:31]
    ds_read_b64_tr_b16 a[92:93], v4 offset:54592
    v_min_u32 v15, 1, v0
    v_mfma_f32_16x16x32_bf16 v[28:31], a[124:127], v[248:251], v[28:31]
    s_waitcnt lgkmcnt(11)
    ds_read_b64_tr_b16 a[94:95], v4 offset:54720
    v_lshlrev_b32 v15, 30, v15
    v_mfma_f32_16x16x32_bf16 v[32:35], a[64:67], v[128:131], 0
    s_lshl_b32 s15, s53, 14
    s_add_u32 s15, s15, 786432
    s_and_b32 s14, s52, 12
    s_lshl_b32 s14, s14, 10
    s_add_u32 s47, s15, s14
    s_lshl4_add_u32 s3, s51, s52
    s_lshl_b32 s3, s3, 8
    s_add_u32 s56, s3, s15
    ds_read_b64_tr_b16 a[96:97], v4 offset:36960
    v_cvt_pk_bf16_f32 v48, v16, v17
    v_mfma_f32_16x16x32_bf16 v[32:35], a[68:71], v[136:139], v[32:35]
    s_waitcnt lgkmcnt(9)
    ds_read_b64_tr_b16 a[98:99], v4 offset:37088
    v_cvt_pk_bf16_f32 v49, v18, v19
    v_mfma_f32_16x16x32_bf16 v[32:35], a[72:75], v[144:147], v[32:35]
    ds_read_b64_tr_b16 a[100:101], v4 offset:37216
    v_cvt_pk_bf16_f32 v50, v24, v25
    v_mfma_f32_16x16x32_bf16 v[32:35], a[76:79], v[152:155], v[32:35]
    s_waitcnt lgkmcnt(7)
    ds_read_b64_tr_b16 a[102:103], v4 offset:37344
    v_cvt_pk_bf16_f32 v51, v26, v27
    v_mfma_f32_16x16x32_bf16 v[32:35], a[80:83], v[192:195], v[32:35]
    s_mov_b32 s54, 1024
    ds_read_b64_tr_b16 a[104:105], v4 offset:37472
    ds_read_b64_tr_b16 a[106:107], v4 offset:37600
    v_mfma_f32_16x16x32_bf16 v[32:35], a[84:87], v[200:203], v[32:35]
    s_waitcnt lgkmcnt(6)
    v_permlane32_swap_b32 v48, v50
    v_mfma_f32_16x16x32_bf16 v[32:35], a[88:91], v[208:211], v[32:35]
    v_permlane32_swap_b32 v49, v51
    v_mfma_f32_16x16x32_bf16 v[32:35], a[92:95], v[216:219], v[32:35]
    ds_read_b64_tr_b16 a[108:109], v4 offset:37728
    ds_read_b64_tr_b16 a[110:111], v4 offset:37856
    buffer_store_dwordx4 v[48:51], v10, s[40:43], s54 offen offset:0 sc1
    v_mfma_f32_16x16x32_bf16 v[36:39], a[64:67], v[160:163], 0
    ds_read_b64_tr_b16 a[112:113], v4 offset:53856
    v_cvt_pk_bf16_f32 v52, v20, v21
    v_mfma_f32_16x16x32_bf16 v[36:39], a[68:71], v[168:171], v[36:39]
    ds_read_b64_tr_b16 a[114:115], v4 offset:53984
    v_cvt_pk_bf16_f32 v53, v22, v23
    v_mfma_f32_16x16x32_bf16 v[36:39], a[72:75], v[176:179], v[36:39]
    ds_read_b64_tr_b16 a[116:117], v4 offset:54112
    v_cvt_pk_bf16_f32 v54, v28, v29
    v_mfma_f32_16x16x32_bf16 v[36:39], a[76:79], v[184:187], v[36:39]
    ds_read_b64_tr_b16 a[118:119], v4 offset:54240
    v_cvt_pk_bf16_f32 v55, v30, v31
    v_mfma_f32_16x16x32_bf16 v[36:39], a[80:83], v[224:227], v[36:39]
    s_mov_b32 s54, 295936
    ds_read_b64_tr_b16 a[120:121], v4 offset:54368
    ds_read_b64_tr_b16 a[122:123], v4 offset:54496
    v_mfma_f32_16x16x32_bf16 v[36:39], a[84:87], v[232:235], v[36:39]
    v_permlane32_swap_b32 v52, v54
    v_mfma_f32_16x16x32_bf16 v[36:39], a[88:91], v[240:243], v[36:39]
    v_permlane32_swap_b32 v53, v55
    v_mfma_f32_16x16x32_bf16 v[36:39], a[92:95], v[248:251], v[36:39]
    s_waitcnt vmcnt(31)
    s_barrier
    s_waitcnt lgkmcnt(10)
    ds_read_b64_tr_b16 a[124:125], v4 offset:54624
    ds_read_b64_tr_b16 a[126:127], v4 offset:54752
    buffer_store_dwordx4 v[52:55], v10, s[40:43], s54 offen offset:0 sc1
    v_mfma_f32_16x16x32_bf16 v[40:43], a[96:99], v[128:131], 0
    s_add_u32 m0, s44, 73728
    ds_read_b64_tr_b16 a[64:65], v3 offset:0
    ds_read_b64_tr_b16 a[66:67], v3 offset:128
    v_mfma_f32_16x16x32_bf16 v[40:43], a[100:103], v[136:139], v[40:43]
    s_mov_b32 s45, 512
    s_waitcnt lgkmcnt(10)
    buffer_load_dwordx4 v7, s[28:31], s45 offen offset:0 lds
    v_mfma_f32_16x16x32_bf16 v[40:43], a[104:107], v[144:147], v[40:43]
    s_add_u32 m0, s44, 73632
    ds_read_b64_tr_b16 a[68:69], v3 offset:256
    ds_read_b64_tr_b16 a[70:71], v3 offset:384
    v_mfma_f32_16x16x32_bf16 v[40:43], a[108:111], v[152:155], v[40:43]
    s_waitcnt lgkmcnt(8)
    buffer_load_dwordx4 v7, s[28:31], s45 offen offset:1152 lds
    v_mfma_f32_16x16x32_bf16 v[40:43], a[112:115], v[192:195], v[40:43]
    s_add_u32 m0, s44, 73536
    ds_read_b64_tr_b16 a[72:73], v3 offset:512
    ds_read_b64_tr_b16 a[74:75], v3 offset:640
    v_mfma_f32_16x16x32_bf16 v[40:43], a[116:119], v[200:203], v[40:43]
    s_waitcnt lgkmcnt(6)
    buffer_load_dwordx4 v7, s[28:31], s45 offen offset:2304 lds
    v_mfma_f32_16x16x32_bf16 v[40:43], a[120:123], v[208:211], v[40:43]
    s_add_u32 m0, s44, 73440
    ds_read_b64_tr_b16 a[76:77], v3 offset:768
    ds_read_b64_tr_b16 a[78:79], v3 offset:896
    v_mfma_f32_16x16x32_bf16 v[40:43], a[124:127], v[216:219], v[40:43]
    buffer_load_dwordx4 v7, s[28:31], s45 offen offset:3456 lds
    v_mfma_f32_16x16x32_bf16 v[44:47], a[96:99], v[160:163], 0
    s_add_u32 m0, s44, 90624
    ds_read_b64_tr_b16 a[80:81], v3 offset:16896
    ds_read_b64_tr_b16 a[82:83], v3 offset:17024
    v_mfma_f32_16x16x32_bf16 v[44:47], a[100:103], v[168:171], v[44:47]
    s_mov_b32 s45, 147968
    buffer_load_dwordx4 v7, s[28:31], s45 offen offset:0 lds
    v_mfma_f32_16x16x32_bf16 v[44:47], a[104:107], v[176:179], v[44:47]
    s_add_u32 m0, s44, 90528
    ds_read_b64_tr_b16 a[84:85], v3 offset:17152
    ds_read_b64_tr_b16 a[86:87], v3 offset:17280
    v_mfma_f32_16x16x32_bf16 v[44:47], a[108:111], v[184:187], v[44:47]
    buffer_load_dwordx4 v7, s[28:31], s45 offen offset:1152 lds
    v_mfma_f32_16x16x32_bf16 v[44:47], a[112:115], v[224:227], v[44:47]
    s_add_u32 m0, s44, 90432
    ds_read_b64_tr_b16 a[88:89], v3 offset:17408
    ds_read_b64_tr_b16 a[90:91], v3 offset:17536
    v_mfma_f32_16x16x32_bf16 v[44:47], a[116:119], v[232:235], v[44:47]
    buffer_load_dwordx4 v7, s[28:31], s45 offen offset:2304 lds
    v_mfma_f32_16x16x32_bf16 v[44:47], a[120:123], v[240:243], v[44:47]
    s_add_u32 m0, s44, 90336
    ds_read_b64_tr_b16 a[92:93], v3 offset:17664
    ds_read_b64_tr_b16 a[94:95], v3 offset:17792
    v_mfma_f32_16x16x32_bf16 v[44:47], a[124:127], v[248:251], v[44:47]
    s_waitcnt lgkmcnt(12)
    buffer_load_dwordx4 v7, s[28:31], s45 offen offset:3456 lds
    v_mfma_f32_16x16x32_bf16 v[16:19], a[64:67], v[128:131], 0
    ds_read_b64_tr_b16 a[96:97], v3 offset:32
    v_cvt_pk_bf16_f32 v48, v32, v33
    v_mfma_f32_16x16x32_bf16 v[16:19], a[68:71], v[136:139], v[16:19]
    s_waitcnt lgkmcnt(9)
    ds_read_b64_tr_b16 a[98:99], v3 offset:160
    v_cvt_pk_bf16_f32 v49, v34, v35
    v_mfma_f32_16x16x32_bf16 v[16:19], a[72:75], v[144:147], v[16:19]
    ds_read_b64_tr_b16 a[100:101], v3 offset:288
    v_cvt_pk_bf16_f32 v50, v40, v41
    v_mfma_f32_16x16x32_bf16 v[16:19], a[76:79], v[152:155], v[16:19]
    s_waitcnt lgkmcnt(7)
    ds_read_b64_tr_b16 a[102:103], v3 offset:416
    v_cvt_pk_bf16_f32 v51, v42, v43
    v_mfma_f32_16x16x32_bf16 v[16:19], a[80:83], v[192:195], v[16:19]
    s_mov_b32 s54, 1024
    ds_read_b64_tr_b16 a[104:105], v3 offset:544
    ds_read_b64_tr_b16 a[106:107], v3 offset:672
    v_mfma_f32_16x16x32_bf16 v[16:19], a[84:87], v[200:203], v[16:19]
    s_waitcnt lgkmcnt(6)
    v_permlane32_swap_b32 v48, v50
    v_mfma_f32_16x16x32_bf16 v[16:19], a[88:91], v[208:211], v[16:19]
    v_permlane32_swap_b32 v49, v51
    v_mfma_f32_16x16x32_bf16 v[16:19], a[92:95], v[216:219], v[16:19]
    ds_read_b64_tr_b16 a[108:109], v3 offset:800
    ds_read_b64_tr_b16 a[110:111], v3 offset:928
    buffer_store_dwordx4 v[48:51], v10, s[40:43], s54 offen offset:512 sc1
    v_mfma_f32_16x16x32_bf16 v[20:23], a[64:67], v[160:163], 0
    ds_read_b64_tr_b16 a[112:113], v3 offset:16928
    v_cvt_pk_bf16_f32 v52, v36, v37
    v_mfma_f32_16x16x32_bf16 v[20:23], a[68:71], v[168:171], v[20:23]
    ds_read_b64_tr_b16 a[114:115], v3 offset:17056
    v_cvt_pk_bf16_f32 v53, v38, v39
    v_mfma_f32_16x16x32_bf16 v[20:23], a[72:75], v[176:179], v[20:23]
    ds_read_b64_tr_b16 a[116:117], v3 offset:17184
    v_cvt_pk_bf16_f32 v54, v44, v45
    v_mfma_f32_16x16x32_bf16 v[20:23], a[76:79], v[184:187], v[20:23]
    ds_read_b64_tr_b16 a[118:119], v3 offset:17312
    v_cvt_pk_bf16_f32 v55, v46, v47
    v_mfma_f32_16x16x32_bf16 v[20:23], a[80:83], v[224:227], v[20:23]
    s_mov_b32 s54, 295936
    ds_read_b64_tr_b16 a[120:121], v3 offset:17440
    ds_read_b64_tr_b16 a[122:123], v3 offset:17568
    v_mfma_f32_16x16x32_bf16 v[20:23], a[84:87], v[232:235], v[20:23]
    v_permlane32_swap_b32 v52, v54
    v_mfma_f32_16x16x32_bf16 v[20:23], a[88:91], v[240:243], v[20:23]
    v_permlane32_swap_b32 v53, v55
    v_mfma_f32_16x16x32_bf16 v[20:23], a[92:95], v[248:251], v[20:23]
    s_waitcnt lgkmcnt(10)
    ds_read_b64_tr_b16 a[124:125], v3 offset:17696
    ds_read_b64_tr_b16 a[126:127], v3 offset:17824
    buffer_store_dwordx4 v[52:55], v10, s[40:43], s54 offen offset:512 sc1
    v_mfma_f32_16x16x32_bf16 v[24:27], a[96:99], v[128:131], 0
    ds_read_b64_tr_b16 a[64:65], v3 offset:64
    v_mfma_f32_16x16x32_bf16 v[24:27], a[100:103], v[136:139], v[24:27]
    s_waitcnt lgkmcnt(9)
    ds_read_b64_tr_b16 a[66:67], v3 offset:192
    v_mfma_f32_16x16x32_bf16 v[24:27], a[104:107], v[144:147], v[24:27]
    ds_read_b64_tr_b16 a[68:69], v3 offset:320
    v_mfma_f32_16x16x32_bf16 v[24:27], a[108:111], v[152:155], v[24:27]
    s_waitcnt lgkmcnt(7)
    ds_read_b64_tr_b16 a[70:71], v3 offset:448
    v_mfma_f32_16x16x32_bf16 v[24:27], a[112:115], v[192:195], v[24:27]
    ds_read_b64_tr_b16 a[72:73], v3 offset:576
    v_mfma_f32_16x16x32_bf16 v[24:27], a[116:119], v[200:203], v[24:27]
    s_waitcnt lgkmcnt(5)
    ds_read_b64_tr_b16 a[74:75], v3 offset:704
    v_mfma_f32_16x16x32_bf16 v[24:27], a[120:123], v[208:211], v[24:27]
    ds_read_b64_tr_b16 a[76:77], v3 offset:832
    v_mfma_f32_16x16x32_bf16 v[24:27], a[124:127], v[216:219], v[24:27]
    ds_read_b64_tr_b16 a[78:79], v3 offset:960
    v_mfma_f32_16x16x32_bf16 v[28:31], a[96:99], v[160:163], 0
    ds_read_b64_tr_b16 a[80:81], v3 offset:16960
    v_mfma_f32_16x16x32_bf16 v[28:31], a[100:103], v[168:171], v[28:31]
    ds_read_b64_tr_b16 a[82:83], v3 offset:17088
    v_mfma_f32_16x16x32_bf16 v[28:31], a[104:107], v[176:179], v[28:31]
    ds_read_b64_tr_b16 a[84:85], v3 offset:17216
    v_mfma_f32_16x16x32_bf16 v[28:31], a[108:111], v[184:187], v[28:31]
    ds_read_b64_tr_b16 a[86:87], v3 offset:17344
    v_mfma_f32_16x16x32_bf16 v[28:31], a[112:115], v[224:227], v[28:31]
    ds_read_b64_tr_b16 a[88:89], v3 offset:17472
    v_mfma_f32_16x16x32_bf16 v[28:31], a[116:119], v[232:235], v[28:31]
    ds_read_b64_tr_b16 a[90:91], v3 offset:17600
    v_mfma_f32_16x16x32_bf16 v[28:31], a[120:123], v[240:243], v[28:31]
    ds_read_b64_tr_b16 a[92:93], v3 offset:17728
    v_mfma_f32_16x16x32_bf16 v[28:31], a[124:127], v[248:251], v[28:31]
    s_waitcnt lgkmcnt(11)
    ds_read_b64_tr_b16 a[94:95], v3 offset:17856
    v_mfma_f32_16x16x32_bf16 v[32:35], a[64:67], v[128:131], 0
    ds_read_b64_tr_b16 a[96:97], v3 offset:96
    v_cvt_pk_bf16_f32 v48, v16, v17
    v_mfma_f32_16x16x32_bf16 v[32:35], a[68:71], v[136:139], v[32:35]
    s_waitcnt lgkmcnt(9)
    ds_read_b64_tr_b16 a[98:99], v3 offset:224
    v_cvt_pk_bf16_f32 v49, v18, v19
    v_mfma_f32_16x16x32_bf16 v[32:35], a[72:75], v[144:147], v[32:35]
    ds_read_b64_tr_b16 a[100:101], v3 offset:352
    v_cvt_pk_bf16_f32 v50, v24, v25
    v_mfma_f32_16x16x32_bf16 v[32:35], a[76:79], v[152:155], v[32:35]
    s_waitcnt lgkmcnt(7)
    ds_read_b64_tr_b16 a[102:103], v3 offset:480
    v_cvt_pk_bf16_f32 v51, v26, v27
    v_mfma_f32_16x16x32_bf16 v[32:35], a[80:83], v[192:195], v[32:35]
    s_mov_b32 s54, 2048
    ds_read_b64_tr_b16 a[104:105], v3 offset:608
    ds_read_b64_tr_b16 a[106:107], v3 offset:736
    v_mfma_f32_16x16x32_bf16 v[32:35], a[84:87], v[200:203], v[32:35]
    s_waitcnt lgkmcnt(6)
    v_permlane32_swap_b32 v48, v50
    v_mfma_f32_16x16x32_bf16 v[32:35], a[88:91], v[208:211], v[32:35]
    v_permlane32_swap_b32 v49, v51
    v_mfma_f32_16x16x32_bf16 v[32:35], a[92:95], v[216:219], v[32:35]
    ds_read_b64_tr_b16 a[108:109], v3 offset:864
    ds_read_b64_tr_b16 a[110:111], v3 offset:992
    buffer_store_dwordx4 v[48:51], v10, s[40:43], s54 offen offset:0 sc1
    v_mfma_f32_16x16x32_bf16 v[36:39], a[64:67], v[160:163], 0
    ds_read_b64_tr_b16 a[112:113], v3 offset:16992
    v_cvt_pk_bf16_f32 v52, v20, v21
    v_mfma_f32_16x16x32_bf16 v[36:39], a[68:71], v[168:171], v[36:39]
L2_pad10:
    s_cbranch_execz L2_pad14
    ds_read_b64_tr_b16 a[114:115], v3 offset:17120
    v_cvt_pk_bf16_f32 v53, v22, v23
    v_mfma_f32_16x16x32_bf16 v[36:39], a[72:75], v[176:179], v[36:39]
    ds_read_b64_tr_b16 a[116:117], v3 offset:17248
    v_cvt_pk_bf16_f32 v54, v28, v29
    v_mfma_f32_16x16x32_bf16 v[36:39], a[76:79], v[184:187], v[36:39]
    ds_read_b64_tr_b16 a[118:119], v3 offset:17376
    v_cvt_pk_bf16_f32 v55, v30, v31
    v_mfma_f32_16x16x32_bf16 v[36:39], a[80:83], v[224:227], v[36:39]
    s_mov_b32 s54, 296960
    ds_read_b64_tr_b16 a[120:121], v3 offset:17504
    ds_read_b64_tr_b16 a[122:123], v3 offset:17632
    v_mfma_f32_16x16x32_bf16 v[36:39], a[84:87], v[232:235], v[36:39]
    v_permlane32_swap_b32 v52, v54
    v_mfma_f32_16x16x32_bf16 v[36:39], a[88:91], v[240:243], v[36:39]
    v_permlane32_swap_b32 v53, v55
    v_mfma_f32_16x16x32_bf16 v[36:39], a[92:95], v[248:251], v[36:39]
    s_waitcnt vmcnt(15)
    s_barrier
    s_waitcnt lgkmcnt(10)
    ds_read_b64_tr_b16 a[124:125], v3 offset:17760
    ds_read_b64_tr_b16 a[126:127], v3 offset:17888
    buffer_store_dwordx4 v[52:55], v10, s[40:43], s54 offen offset:0 sc1
    v_mfma_f32_16x16x32_bf16 v[40:43], a[96:99], v[128:131], 0
    s_add_u32 m0, s44, 110592
    ds_read_b64_tr_b16 a[64:65], v3 offset:36864
    ds_read_b64_tr_b16 a[66:67], v3 offset:36992
    v_mfma_f32_16x16x32_bf16 v[40:43], a[100:103], v[136:139], v[40:43]
    s_mov_b32 s45, 640
    s_waitcnt lgkmcnt(10)
    buffer_load_dwordx4 v7, s[28:31], s45 offen offset:0 lds
    v_mfma_f32_16x16x32_bf16 v[40:43], a[104:107], v[144:147], v[40:43]
    s_add_u32 m0, s44, 110496
    ds_read_b64_tr_b16 a[68:69], v3 offset:37120
    ds_read_b64_tr_b16 a[70:71], v3 offset:37248
    v_mfma_f32_16x16x32_bf16 v[40:43], a[108:111], v[152:155], v[40:43]
    s_waitcnt lgkmcnt(8)
    buffer_load_dwordx4 v7, s[28:31], s45 offen offset:1152 lds
    v_mfma_f32_16x16x32_bf16 v[40:43], a[112:115], v[192:195], v[40:43]
    s_add_u32 m0, s44, 110400
    ds_read_b64_tr_b16 a[72:73], v3 offset:37376
    ds_read_b64_tr_b16 a[74:75], v3 offset:37504
    v_mfma_f32_16x16x32_bf16 v[40:43], a[116:119], v[200:203], v[40:43]
    s_waitcnt lgkmcnt(6)
    buffer_load_dwordx4 v7, s[28:31], s45 offen offset:2304 lds
    v_mfma_f32_16x16x32_bf16 v[40:43], a[120:123], v[208:211], v[40:43]
    s_add_u32 m0, s44, 110304
    ds_read_b64_tr_b16 a[76:77], v3 offset:37632
    ds_read_b64_tr_b16 a[78:79], v3 offset:37760
    v_mfma_f32_16x16x32_bf16 v[40:43], a[124:127], v[216:219], v[40:43]
    buffer_load_dwordx4 v7, s[28:31], s45 offen offset:3456 lds
    v_mfma_f32_16x16x32_bf16 v[44:47], a[96:99], v[160:163], 0
    s_add_u32 m0, s44, 127488
    ds_read_b64_tr_b16 a[80:81], v3 offset:53760
    ds_read_b64_tr_b16 a[82:83], v3 offset:53888
    v_mfma_f32_16x16x32_bf16 v[44:47], a[100:103], v[168:171], v[44:47]
    s_mov_b32 s45, 148096
    buffer_load_dwordx4 v7, s[28:31], s45 offen offset:0 lds
    v_mfma_f32_16x16x32_bf16 v[44:47], a[104:107], v[176:179], v[44:47]
    s_add_u32 m0, s44, 127392
    ds_read_b64_tr_b16 a[84:85], v3 offset:54016
    ds_read_b64_tr_b16 a[86:87], v3 offset:54144
    v_mfma_f32_16x16x32_bf16 v[44:47], a[108:111], v[184:187], v[44:47]
    buffer_load_dwordx4 v7, s[28:31], s45 offen offset:1152 lds
    v_mfma_f32_16x16x32_bf16 v[44:47], a[112:115], v[224:227], v[44:47]
    s_add_u32 m0, s44, 127296
    ds_read_b64_tr_b16 a[88:89], v3 offset:54272
    ds_read_b64_tr_b16 a[90:91], v3 offset:54400
    v_mfma_f32_16x16x32_bf16 v[44:47], a[116:119], v[232:235], v[44:47]
    buffer_load_dwordx4 v7, s[28:31], s45 offen offset:2304 lds
    v_mfma_f32_16x16x32_bf16 v[44:47], a[120:123], v[240:243], v[44:47]
    s_add_u32 m0, s44, 127200
    ds_read_b64_tr_b16 a[92:93], v3 offset:54528
    ds_read_b64_tr_b16 a[94:95], v3 offset:54656
    v_mfma_f32_16x16x32_bf16 v[44:47], a[124:127], v[248:251], v[44:47]
    s_waitcnt lgkmcnt(12)
    buffer_load_dwordx4 v7, s[28:31], s45 offen offset:3456 lds
    v_mfma_f32_16x16x32_bf16 v[16:19], a[64:67], v[128:131], 0
    ds_read_b64_tr_b16 a[96:97], v3 offset:36896
    v_cvt_pk_bf16_f32 v48, v32, v33
    v_mfma_f32_16x16x32_bf16 v[16:19], a[68:71], v[136:139], v[16:19]
    s_waitcnt lgkmcnt(9)
    ds_read_b64_tr_b16 a[98:99], v3 offset:37024
    v_cvt_pk_bf16_f32 v49, v34, v35
    v_mfma_f32_16x16x32_bf16 v[16:19], a[72:75], v[144:147], v[16:19]
    ds_read_b64_tr_b16 a[100:101], v3 offset:37152
    v_cvt_pk_bf16_f32 v50, v40, v41
    v_mfma_f32_16x16x32_bf16 v[16:19], a[76:79], v[152:155], v[16:19]
    s_waitcnt lgkmcnt(7)
    ds_read_b64_tr_b16 a[102:103], v3 offset:37280
    v_cvt_pk_bf16_f32 v51, v42, v43
    v_mfma_f32_16x16x32_bf16 v[16:19], a[80:83], v[192:195], v[16:19]
    s_mov_b32 s54, 2048
    ds_read_b64_tr_b16 a[104:105], v3 offset:37408
    ds_read_b64_tr_b16 a[106:107], v3 offset:37536
    v_mfma_f32_16x16x32_bf16 v[16:19], a[84:87], v[200:203], v[16:19]
    s_waitcnt lgkmcnt(6)
    v_permlane32_swap_b32 v48, v50
    v_mfma_f32_16x16x32_bf16 v[16:19], a[88:91], v[208:211], v[16:19]
    v_permlane32_swap_b32 v49, v51
    v_mfma_f32_16x16x32_bf16 v[16:19], a[92:95], v[216:219], v[16:19]
    ds_read_b64_tr_b16 a[108:109], v3 offset:37664
    ds_read_b64_tr_b16 a[110:111], v3 offset:37792
    buffer_store_dwordx4 v[48:51], v10, s[40:43], s54 offen offset:512 sc1
    v_mfma_f32_16x16x32_bf16 v[20:23], a[64:67], v[160:163], 0
    ds_read_b64_tr_b16 a[112:113], v3 offset:53792
    v_cvt_pk_bf16_f32 v52, v36, v37
    v_mfma_f32_16x16x32_bf16 v[20:23], a[68:71], v[168:171], v[20:23]
    ds_read_b64_tr_b16 a[114:115], v3 offset:53920
    v_cvt_pk_bf16_f32 v53, v38, v39
    v_mfma_f32_16x16x32_bf16 v[20:23], a[72:75], v[176:179], v[20:23]
    ds_read_b64_tr_b16 a[116:117], v3 offset:54048
    v_cvt_pk_bf16_f32 v54, v44, v45
    v_mfma_f32_16x16x32_bf16 v[20:23], a[76:79], v[184:187], v[20:23]
    ds_read_b64_tr_b16 a[118:119], v3 offset:54176
    v_cvt_pk_bf16_f32 v55, v46, v47
    v_mfma_f32_16x16x32_bf16 v[20:23], a[80:83], v[224:227], v[20:23]
    s_mov_b32 s54, 296960
    ds_read_b64_tr_b16 a[120:121], v3 offset:54304
    ds_read_b64_tr_b16 a[122:123], v3 offset:54432
    v_mfma_f32_16x16x32_bf16 v[20:23], a[84:87], v[232:235], v[20:23]
    v_permlane32_swap_b32 v52, v54
    v_mfma_f32_16x16x32_bf16 v[20:23], a[88:91], v[240:243], v[20:23]
    v_permlane32_swap_b32 v53, v55
    v_mfma_f32_16x16x32_bf16 v[20:23], a[92:95], v[248:251], v[20:23]
    s_waitcnt lgkmcnt(10)
    ds_read_b64_tr_b16 a[124:125], v3 offset:54560
    ds_read_b64_tr_b16 a[126:127], v3 offset:54688
    buffer_store_dwordx4 v[52:55], v10, s[40:43], s54 offen offset:512 sc1
    v_mfma_f32_16x16x32_bf16 v[24:27], a[96:99], v[128:131], 0
    ds_read_b64_tr_b16 a[64:65], v3 offset:36928
    v_mfma_f32_16x16x32_bf16 v[24:27], a[100:103], v[136:139], v[24:27]
    s_waitcnt lgkmcnt(9)
    ds_read_b64_tr_b16 a[66:67], v3 offset:37056
    v_mfma_f32_16x16x32_bf16 v[24:27], a[104:107], v[144:147], v[24:27]
    ds_read_b64_tr_b16 a[68:69], v3 offset:37184
    v_mfma_f32_16x16x32_bf16 v[24:27], a[108:111], v[152:155], v[24:27]
    s_waitcnt lgkmcnt(7)
    ds_read_b64_tr_b16 a[70:71], v3 offset:37312
    v_mfma_f32_16x16x32_bf16 v[24:27], a[112:115], v[192:195], v[24:27]
    ds_read_b64_tr_b16 a[72:73], v3 offset:37440
    v_mfma_f32_16x16x32_bf16 v[24:27], a[116:119], v[200:203], v[24:27]
    s_waitcnt lgkmcnt(5)
    ds_read_b64_tr_b16 a[74:75], v3 offset:37568
    v_mfma_f32_16x16x32_bf16 v[24:27], a[120:123], v[208:211], v[24:27]
    ds_read_b64_tr_b16 a[76:77], v3 offset:37696
    v_mfma_f32_16x16x32_bf16 v[24:27], a[124:127], v[216:219], v[24:27]
    ds_read_b64_tr_b16 a[78:79], v3 offset:37824
    v_mfma_f32_16x16x32_bf16 v[28:31], a[96:99], v[160:163], 0
    ds_read_b64_tr_b16 a[80:81], v3 offset:53824
    v_mfma_f32_16x16x32_bf16 v[28:31], a[100:103], v[168:171], v[28:31]
    ds_read_b64_tr_b16 a[82:83], v3 offset:53952
    v_mfma_f32_16x16x32_bf16 v[28:31], a[104:107], v[176:179], v[28:31]
    ds_read_b64_tr_b16 a[84:85], v3 offset:54080
    v_mfma_f32_16x16x32_bf16 v[28:31], a[108:111], v[184:187], v[28:31]
    ds_read_b64_tr_b16 a[86:87], v3 offset:54208
    v_mfma_f32_16x16x32_bf16 v[28:31], a[112:115], v[224:227], v[28:31]
    ds_read_b64_tr_b16 a[88:89], v3 offset:54336
    v_mfma_f32_16x16x32_bf16 v[28:31], a[116:119], v[232:235], v[28:31]
    ds_read_b64_tr_b16 a[90:91], v3 offset:54464
    v_mfma_f32_16x16x32_bf16 v[28:31], a[120:123], v[240:243], v[28:31]
    ds_read_b64_tr_b16 a[92:93], v3 offset:54592
    v_mfma_f32_16x16x32_bf16 v[28:31], a[124:127], v[248:251], v[28:31]
    s_waitcnt lgkmcnt(11)
    ds_read_b64_tr_b16 a[94:95], v3 offset:54720
    v_mfma_f32_16x16x32_bf16 v[32:35], a[64:67], v[128:131], 0
    ds_read_b64_tr_b16 a[96:97], v3 offset:36960
    v_cvt_pk_bf16_f32 v48, v16, v17
    v_mfma_f32_16x16x32_bf16 v[32:35], a[68:71], v[136:139], v[32:35]
    s_waitcnt lgkmcnt(9)
    ds_read_b64_tr_b16 a[98:99], v3 offset:37088
    v_cvt_pk_bf16_f32 v49, v18, v19
    v_mfma_f32_16x16x32_bf16 v[32:35], a[72:75], v[144:147], v[32:35]
    ds_read_b64_tr_b16 a[100:101], v3 offset:37216
    v_cvt_pk_bf16_f32 v50, v24, v25
    v_mfma_f32_16x16x32_bf16 v[32:35], a[76:79], v[152:155], v[32:35]
    s_waitcnt lgkmcnt(7)
    ds_read_b64_tr_b16 a[102:103], v3 offset:37344
    v_cvt_pk_bf16_f32 v51, v26, v27
    v_mfma_f32_16x16x32_bf16 v[32:35], a[80:83], v[192:195], v[32:35]
    s_mov_b32 s54, 3072
    ds_read_b64_tr_b16 a[104:105], v3 offset:37472
    ds_read_b64_tr_b16 a[106:107], v3 offset:37600
    v_mfma_f32_16x16x32_bf16 v[32:35], a[84:87], v[200:203], v[32:35]
    s_waitcnt lgkmcnt(6)
    v_permlane32_swap_b32 v48, v50
    v_mfma_f32_16x16x32_bf16 v[32:35], a[88:91], v[208:211], v[32:35]
    v_permlane32_swap_b32 v49, v51
    v_mfma_f32_16x16x32_bf16 v[32:35], a[92:95], v[216:219], v[32:35]
    ds_read_b64_tr_b16 a[108:109], v3 offset:37728
    ds_read_b64_tr_b16 a[110:111], v3 offset:37856
    buffer_store_dwordx4 v[48:51], v10, s[40:43], s54 offen offset:0 sc1
    v_mfma_f32_16x16x32_bf16 v[36:39], a[64:67], v[160:163], 0
    ds_read_b64_tr_b16 a[112:113], v3 offset:53856
    v_cvt_pk_bf16_f32 v52, v20, v21
    v_mfma_f32_16x16x32_bf16 v[36:39], a[68:71], v[168:171], v[36:39]
    ds_read_b64_tr_b16 a[114:115], v3 offset:53984
    v_cvt_pk_bf16_f32 v53, v22, v23
    v_mfma_f32_16x16x32_bf16 v[36:39], a[72:75], v[176:179], v[36:39]
    ds_read_b64_tr_b16 a[116:117], v3 offset:54112
    v_cvt_pk_bf16_f32 v54, v28, v29
    v_mfma_f32_16x16x32_bf16 v[36:39], a[76:79], v[184:187], v[36:39]
    ds_read_b64_tr_b16 a[118:119], v3 offset:54240
    v_cvt_pk_bf16_f32 v55, v30, v31
    v_mfma_f32_16x16x32_bf16 v[36:39], a[80:83], v[224:227], v[36:39]
    s_mov_b32 s54, 297984
    ds_read_b64_tr_b16 a[120:121], v3 offset:54368
    ds_read_b64_tr_b16 a[122:123], v3 offset:54496
    v_mfma_f32_16x16x32_bf16 v[36:39], a[84:87], v[232:235], v[36:39]
    v_permlane32_swap_b32 v52, v54
    v_mfma_f32_16x16x32_bf16 v[36:39], a[88:91], v[240:243], v[36:39]
    v_permlane32_swap_b32 v53, v55
    v_mfma_f32_16x16x32_bf16 v[36:39], a[92:95], v[248:251], v[36:39]
    s_waitcnt vmcnt(15)
    s_barrier
    s_waitcnt lgkmcnt(10)
    ds_read_b64_tr_b16 a[124:125], v3 offset:54624
    ds_read_b64_tr_b16 a[126:127], v3 offset:54752
    buffer_store_dwordx4 v[52:55], v10, s[40:43], s54 offen offset:0 sc1
    v_mfma_f32_16x16x32_bf16 v[40:43], a[96:99], v[128:131], 0
    s_add_u32 m0, s44, 0
    ds_read_b64_tr_b16 a[64:65], v4 offset:0
    ds_read_b64_tr_b16 a[66:67], v4 offset:128
    v_mfma_f32_16x16x32_bf16 v[40:43], a[100:103], v[136:139], v[40:43]
    s_mov_b32 s45, 768
    s_waitcnt lgkmcnt(10)
    buffer_load_dwordx4 v7, s[28:31], s45 offen offset:0 lds
    v_mfma_f32_16x16x32_bf16 v[40:43], a[104:107], v[144:147], v[40:43]
    s_add_u32 m0, s44, -96
    ds_read_b64_tr_b16 a[68:69], v4 offset:256
    ds_read_b64_tr_b16 a[70:71], v4 offset:384
    v_mfma_f32_16x16x32_bf16 v[40:43], a[108:111], v[152:155], v[40:43]
    s_waitcnt lgkmcnt(8)
    buffer_load_dwordx4 v7, s[28:31], s45 offen offset:1152 lds
    v_mfma_f32_16x16x32_bf16 v[40:43], a[112:115], v[192:195], v[40:43]
    s_add_u32 m0, s44, -192
    ds_read_b64_tr_b16 a[72:73], v4 offset:512
    ds_read_b64_tr_b16 a[74:75], v4 offset:640
    v_mfma_f32_16x16x32_bf16 v[40:43], a[116:119], v[200:203], v[40:43]
    s_waitcnt lgkmcnt(6)
    buffer_load_dwordx4 v7, s[28:31], s45 offen offset:2304 lds
    v_mfma_f32_16x16x32_bf16 v[40:43], a[120:123], v[208:211], v[40:43]
    s_add_u32 m0, s44, -288
    ds_read_b64_tr_b16 a[76:77], v4 offset:768
    ds_read_b64_tr_b16 a[78:79], v4 offset:896
    v_mfma_f32_16x16x32_bf16 v[40:43], a[124:127], v[216:219], v[40:43]
    buffer_load_dwordx4 v7, s[28:31], s45 offen offset:3456 lds
    v_mfma_f32_16x16x32_bf16 v[44:47], a[96:99], v[160:163], 0
    s_add_u32 m0, s44, 16896
    ds_read_b64_tr_b16 a[80:81], v4 offset:16896
    ds_read_b64_tr_b16 a[82:83], v4 offset:17024
    v_mfma_f32_16x16x32_bf16 v[44:47], a[100:103], v[168:171], v[44:47]
    s_mov_b32 s45, 148224
    buffer_load_dwordx4 v7, s[28:31], s45 offen offset:0 lds
    v_mfma_f32_16x16x32_bf16 v[44:47], a[104:107], v[176:179], v[44:47]
    s_add_u32 m0, s44, 16800
    ds_read_b64_tr_b16 a[84:85], v4 offset:17152
    ds_read_b64_tr_b16 a[86:87], v4 offset:17280
    v_mfma_f32_16x16x32_bf16 v[44:47], a[108:111], v[184:187], v[44:47]
    buffer_load_dwordx4 v7, s[28:31], s45 offen offset:1152 lds
    v_mfma_f32_16x16x32_bf16 v[44:47], a[112:115], v[224:227], v[44:47]
    s_add_u32 m0, s44, 16704
    ds_read_b64_tr_b16 a[88:89], v4 offset:17408
    ds_read_b64_tr_b16 a[90:91], v4 offset:17536
    v_mfma_f32_16x16x32_bf16 v[44:47], a[116:119], v[232:235], v[44:47]
    buffer_load_dwordx4 v7, s[28:31], s45 offen offset:2304 lds
    v_mfma_f32_16x16x32_bf16 v[44:47], a[120:123], v[240:243], v[44:47]
    s_add_u32 m0, s44, 16608
    ds_read_b64_tr_b16 a[92:93], v4 offset:17664
    ds_read_b64_tr_b16 a[94:95], v4 offset:17792
    v_mfma_f32_16x16x32_bf16 v[44:47], a[124:127], v[248:251], v[44:47]
    s_waitcnt lgkmcnt(12)
    buffer_load_dwordx4 v7, s[28:31], s45 offen offset:3456 lds
    v_mfma_f32_16x16x32_bf16 v[16:19], a[64:67], v[128:131], 0
    ds_read_b64_tr_b16 a[96:97], v4 offset:32
    v_cvt_pk_bf16_f32 v48, v32, v33
    v_mfma_f32_16x16x32_bf16 v[16:19], a[68:71], v[136:139], v[16:19]
    s_waitcnt lgkmcnt(9)
    ds_read_b64_tr_b16 a[98:99], v4 offset:160
    v_cvt_pk_bf16_f32 v49, v34, v35
    v_mfma_f32_16x16x32_bf16 v[16:19], a[72:75], v[144:147], v[16:19]
    ds_read_b64_tr_b16 a[100:101], v4 offset:288
    v_cvt_pk_bf16_f32 v50, v40, v41
    v_mfma_f32_16x16x32_bf16 v[16:19], a[76:79], v[152:155], v[16:19]
    s_waitcnt lgkmcnt(7)
    ds_read_b64_tr_b16 a[102:103], v4 offset:416
    v_cvt_pk_bf16_f32 v51, v42, v43
    v_mfma_f32_16x16x32_bf16 v[16:19], a[80:83], v[192:195], v[16:19]
    s_mov_b32 s54, 3072
    ds_read_b64_tr_b16 a[104:105], v4 offset:544
    ds_read_b64_tr_b16 a[106:107], v4 offset:672
    v_mfma_f32_16x16x32_bf16 v[16:19], a[84:87], v[200:203], v[16:19]
    s_waitcnt lgkmcnt(6)
    v_permlane32_swap_b32 v48, v50
    v_mfma_f32_16x16x32_bf16 v[16:19], a[88:91], v[208:211], v[16:19]
    v_permlane32_swap_b32 v49, v51
    v_mfma_f32_16x16x32_bf16 v[16:19], a[92:95], v[216:219], v[16:19]
    ds_read_b64_tr_b16 a[108:109], v4 offset:800
    ds_read_b64_tr_b16 a[110:111], v4 offset:928
    buffer_store_dwordx4 v[48:51], v10, s[40:43], s54 offen offset:512 sc1
    v_mfma_f32_16x16x32_bf16 v[20:23], a[64:67], v[160:163], 0
    ds_read_b64_tr_b16 a[112:113], v4 offset:16928
    v_cvt_pk_bf16_f32 v52, v36, v37
    v_mfma_f32_16x16x32_bf16 v[20:23], a[68:71], v[168:171], v[20:23]
    ds_read_b64_tr_b16 a[114:115], v4 offset:17056
    v_cvt_pk_bf16_f32 v53, v38, v39
    v_mfma_f32_16x16x32_bf16 v[20:23], a[72:75], v[176:179], v[20:23]
    ds_read_b64_tr_b16 a[116:117], v4 offset:17184
    v_cvt_pk_bf16_f32 v54, v44, v45
    v_mfma_f32_16x16x32_bf16 v[20:23], a[76:79], v[184:187], v[20:23]
    ds_read_b64_tr_b16 a[118:119], v4 offset:17312
    v_cvt_pk_bf16_f32 v55, v46, v47
    v_mfma_f32_16x16x32_bf16 v[20:23], a[80:83], v[224:227], v[20:23]
    s_mov_b32 s54, 297984
    ds_read_b64_tr_b16 a[120:121], v4 offset:17440
    ds_read_b64_tr_b16 a[122:123], v4 offset:17568
    v_mfma_f32_16x16x32_bf16 v[20:23], a[84:87], v[232:235], v[20:23]
    v_permlane32_swap_b32 v52, v54
    v_mfma_f32_16x16x32_bf16 v[20:23], a[88:91], v[240:243], v[20:23]
    v_permlane32_swap_b32 v53, v55
    v_mfma_f32_16x16x32_bf16 v[20:23], a[92:95], v[248:251], v[20:23]
    s_waitcnt lgkmcnt(10)
    ds_read_b64_tr_b16 a[124:125], v4 offset:17696
    ds_read_b64_tr_b16 a[126:127], v4 offset:17824
    buffer_store_dwordx4 v[52:55], v10, s[40:43], s54 offen offset:512 sc1
    v_mfma_f32_16x16x32_bf16 v[24:27], a[96:99], v[128:131], 0
    ds_read_b64_tr_b16 a[64:65], v4 offset:64
    v_mfma_f32_16x16x32_bf16 v[24:27], a[100:103], v[136:139], v[24:27]
    s_waitcnt lgkmcnt(9)
    ds_read_b64_tr_b16 a[66:67], v4 offset:192
    v_mfma_f32_16x16x32_bf16 v[24:27], a[104:107], v[144:147], v[24:27]
    ds_read_b64_tr_b16 a[68:69], v4 offset:320
    v_mfma_f32_16x16x32_bf16 v[24:27], a[108:111], v[152:155], v[24:27]
    s_waitcnt lgkmcnt(7)
    ds_read_b64_tr_b16 a[70:71], v4 offset:448
    v_mfma_f32_16x16x32_bf16 v[24:27], a[112:115], v[192:195], v[24:27]
    ds_read_b64_tr_b16 a[72:73], v4 offset:576
    v_mfma_f32_16x16x32_bf16 v[24:27], a[116:119], v[200:203], v[24:27]
    s_waitcnt lgkmcnt(5)
    ds_read_b64_tr_b16 a[74:75], v4 offset:704
    v_mfma_f32_16x16x32_bf16 v[24:27], a[120:123], v[208:211], v[24:27]
    ds_read_b64_tr_b16 a[76:77], v4 offset:832
    v_mfma_f32_16x16x32_bf16 v[24:27], a[124:127], v[216:219], v[24:27]
    ds_read_b64_tr_b16 a[78:79], v4 offset:960
    v_mfma_f32_16x16x32_bf16 v[28:31], a[96:99], v[160:163], 0
    ds_read_b64_tr_b16 a[80:81], v4 offset:16960
    v_mfma_f32_16x16x32_bf16 v[28:31], a[100:103], v[168:171], v[28:31]
    ds_read_b64_tr_b16 a[82:83], v4 offset:17088
    v_mfma_f32_16x16x32_bf16 v[28:31], a[104:107], v[176:179], v[28:31]
    ds_read_b64_tr_b16 a[84:85], v4 offset:17216
    v_mfma_f32_16x16x32_bf16 v[28:31], a[108:111], v[184:187], v[28:31]
    ds_read_b64_tr_b16 a[86:87], v4 offset:17344
    v_mfma_f32_16x16x32_bf16 v[28:31], a[112:115], v[224:227], v[28:31]
    ds_read_b64_tr_b16 a[88:89], v4 offset:17472
    v_mfma_f32_16x16x32_bf16 v[28:31], a[116:119], v[232:235], v[28:31]
    ds_read_b64_tr_b16 a[90:91], v4 offset:17600
    v_mfma_f32_16x16x32_bf16 v[28:31], a[120:123], v[240:243], v[28:31]
    ds_read_b64_tr_b16 a[92:93], v4 offset:17728
    v_mfma_f32_16x16x32_bf16 v[28:31], a[124:127], v[248:251], v[28:31]
    s_waitcnt lgkmcnt(11)
    ds_read_b64_tr_b16 a[94:95], v4 offset:17856
    v_mfma_f32_16x16x32_bf16 v[32:35], a[64:67], v[128:131], 0
    ds_read_b64_tr_b16 a[96:97], v4 offset:96
    v_cvt_pk_bf16_f32 v48, v16, v17
    v_mfma_f32_16x16x32_bf16 v[32:35], a[68:71], v[136:139], v[32:35]
    s_waitcnt lgkmcnt(9)
    ds_read_b64_tr_b16 a[98:99], v4 offset:224
    v_cvt_pk_bf16_f32 v49, v18, v19
    v_mfma_f32_16x16x32_bf16 v[32:35], a[72:75], v[144:147], v[32:35]
    ds_read_b64_tr_b16 a[100:101], v4 offset:352
    v_cvt_pk_bf16_f32 v50, v24, v25
    v_mfma_f32_16x16x32_bf16 v[32:35], a[76:79], v[152:155], v[32:35]
    s_waitcnt lgkmcnt(7)
    ds_read_b64_tr_b16 a[102:103], v4 offset:480
    v_cvt_pk_bf16_f32 v51, v26, v27
    v_mfma_f32_16x16x32_bf16 v[32:35], a[80:83], v[192:195], v[32:35]
    s_mov_b32 s54, 4096
    ds_read_b64_tr_b16 a[104:105], v4 offset:608
    ds_read_b64_tr_b16 a[106:107], v4 offset:736
    v_mfma_f32_16x16x32_bf16 v[32:35], a[84:87], v[200:203], v[32:35]
    s_waitcnt lgkmcnt(6)
    v_permlane32_swap_b32 v48, v50
    v_mfma_f32_16x16x32_bf16 v[32:35], a[88:91], v[208:211], v[32:35]
    v_permlane32_swap_b32 v49, v51
    v_mfma_f32_16x16x32_bf16 v[32:35], a[92:95], v[216:219], v[32:35]
    ds_read_b64_tr_b16 a[108:109], v4 offset:864
    ds_read_b64_tr_b16 a[110:111], v4 offset:992
    buffer_store_dwordx4 v[48:51], v10, s[40:43], s54 offen offset:0 sc1
    v_mfma_f32_16x16x32_bf16 v[36:39], a[64:67], v[160:163], 0
    ds_read_b64_tr_b16 a[112:113], v4 offset:16992
    v_cvt_pk_bf16_f32 v52, v20, v21
    v_mfma_f32_16x16x32_bf16 v[36:39], a[68:71], v[168:171], v[36:39]
    ds_read_b64_tr_b16 a[114:115], v4 offset:17120
    v_cvt_pk_bf16_f32 v53, v22, v23
    v_mfma_f32_16x16x32_bf16 v[36:39], a[72:75], v[176:179], v[36:39]
    ds_read_b64_tr_b16 a[116:117], v4 offset:17248
    v_cvt_pk_bf16_f32 v54, v28, v29
    v_mfma_f32_16x16x32_bf16 v[36:39], a[76:79], v[184:187], v[36:39]
    ds_read_b64_tr_b16 a[118:119], v4 offset:17376
    v_cvt_pk_bf16_f32 v55, v30, v31
    v_mfma_f32_16x16x32_bf16 v[36:39], a[80:83], v[224:227], v[36:39]
    s_mov_b32 s54, 299008
    ds_read_b64_tr_b16 a[120:121], v4 offset:17504
    ds_read_b64_tr_b16 a[122:123], v4 offset:17632
    v_mfma_f32_16x16x32_bf16 v[36:39], a[84:87], v[232:235], v[36:39]
    v_permlane32_swap_b32 v52, v54
    v_mfma_f32_16x16x32_bf16 v[36:39], a[88:91], v[240:243], v[36:39]
    v_permlane32_swap_b32 v53, v55
    v_mfma_f32_16x16x32_bf16 v[36:39], a[92:95], v[248:251], v[36:39]
    s_waitcnt vmcnt(15)
    s_barrier
    s_waitcnt lgkmcnt(10)
    ds_read_b64_tr_b16 a[124:125], v4 offset:17760
    ds_read_b64_tr_b16 a[126:127], v4 offset:17888
    buffer_store_dwordx4 v[52:55], v10, s[40:43], s54 offen offset:0 sc1
    v_mfma_f32_16x16x32_bf16 v[40:43], a[96:99], v[128:131], 0
    s_add_u32 m0, s44, 36864
    ds_read_b64_tr_b16 a[64:65], v4 offset:36864
    ds_read_b64_tr_b16 a[66:67], v4 offset:36992
    v_mfma_f32_16x16x32_bf16 v[40:43], a[100:103], v[136:139], v[40:43]
    s_mov_b32 s45, 896
    s_waitcnt lgkmcnt(10)
    buffer_load_dwordx4 v7, s[28:31], s45 offen offset:0 lds
    v_mfma_f32_16x16x32_bf16 v[40:43], a[104:107], v[144:147], v[40:43]
    s_add_u32 m0, s44, 36768
    ds_read_b64_tr_b16 a[68:69], v4 offset:37120
    ds_read_b64_tr_b16 a[70:71], v4 offset:37248
    v_mfma_f32_16x16x32_bf16 v[40:43], a[108:111], v[152:155], v[40:43]
    s_waitcnt lgkmcnt(8)
    buffer_load_dwordx4 v7, s[28:31], s45 offen offset:1152 lds
    v_mfma_f32_16x16x32_bf16 v[40:43], a[112:115], v[192:195], v[40:43]
    s_add_u32 m0, s44, 36672
    ds_read_b64_tr_b16 a[72:73], v4 offset:37376
    ds_read_b64_tr_b16 a[74:75], v4 offset:37504
    v_mfma_f32_16x16x32_bf16 v[40:43], a[116:119], v[200:203], v[40:43]
    s_waitcnt lgkmcnt(6)
    buffer_load_dwordx4 v7, s[28:31], s45 offen offset:2304 lds
    v_mfma_f32_16x16x32_bf16 v[40:43], a[120:123], v[208:211], v[40:43]
    s_add_u32 m0, s44, 36576
    ds_read_b64_tr_b16 a[76:77], v4 offset:37632
    ds_read_b64_tr_b16 a[78:79], v4 offset:37760
    v_mfma_f32_16x16x32_bf16 v[40:43], a[124:127], v[216:219], v[40:43]
    buffer_load_dwordx4 v7, s[28:31], s45 offen offset:3456 lds
    v_mfma_f32_16x16x32_bf16 v[44:47], a[96:99], v[160:163], 0
    s_add_u32 m0, s44, 53760
    ds_read_b64_tr_b16 a[80:81], v4 offset:53760
    ds_read_b64_tr_b16 a[82:83], v4 offset:53888
    v_mfma_f32_16x16x32_bf16 v[44:47], a[100:103], v[168:171], v[44:47]
    s_mov_b32 s45, 148352
    buffer_load_dwordx4 v7, s[28:31], s45 offen offset:0 lds
    v_mfma_f32_16x16x32_bf16 v[44:47], a[104:107], v[176:179], v[44:47]
    s_add_u32 m0, s44, 53664
    ds_read_b64_tr_b16 a[84:85], v4 offset:54016
    ds_read_b64_tr_b16 a[86:87], v4 offset:54144
    v_mfma_f32_16x16x32_bf16 v[44:47], a[108:111], v[184:187], v[44:47]
    buffer_load_dwordx4 v7, s[28:31], s45 offen offset:1152 lds
    v_mfma_f32_16x16x32_bf16 v[44:47], a[112:115], v[224:227], v[44:47]
    s_add_u32 m0, s44, 53568
    ds_read_b64_tr_b16 a[88:89], v4 offset:54272
    ds_read_b64_tr_b16 a[90:91], v4 offset:54400
    v_mfma_f32_16x16x32_bf16 v[44:47], a[116:119], v[232:235], v[44:47]
    buffer_load_dwordx4 v7, s[28:31], s45 offen offset:2304 lds
    v_mfma_f32_16x16x32_bf16 v[44:47], a[120:123], v[240:243], v[44:47]
    s_add_u32 m0, s44, 53472
    ds_read_b64_tr_b16 a[92:93], v4 offset:54528
    ds_read_b64_tr_b16 a[94:95], v4 offset:54656
    v_mfma_f32_16x16x32_bf16 v[44:47], a[124:127], v[248:251], v[44:47]
    s_waitcnt lgkmcnt(12)
    buffer_load_dwordx4 v7, s[28:31], s45 offen offset:3456 lds
    v_mfma_f32_16x16x32_bf16 v[16:19], a[64:67], v[128:131], 0
    ds_read_b64_tr_b16 a[96:97], v4 offset:36896
    v_cvt_pk_bf16_f32 v48, v32, v33
    v_mfma_f32_16x16x32_bf16 v[16:19], a[68:71], v[136:139], v[16:19]
    s_waitcnt lgkmcnt(9)
    ds_read_b64_tr_b16 a[98:99], v4 offset:37024
    v_cvt_pk_bf16_f32 v49, v34, v35
    v_mfma_f32_16x16x32_bf16 v[16:19], a[72:75], v[144:147], v[16:19]
    ds_read_b64_tr_b16 a[100:101], v4 offset:37152
    v_cvt_pk_bf16_f32 v50, v40, v41
    v_mfma_f32_16x16x32_bf16 v[16:19], a[76:79], v[152:155], v[16:19]
    s_waitcnt lgkmcnt(7)
    ds_read_b64_tr_b16 a[102:103], v4 offset:37280
    v_cvt_pk_bf16_f32 v51, v42, v43
    v_mfma_f32_16x16x32_bf16 v[16:19], a[80:83], v[192:195], v[16:19]
    s_mov_b32 s54, 4096
    ds_read_b64_tr_b16 a[104:105], v4 offset:37408
    ds_read_b64_tr_b16 a[106:107], v4 offset:37536
    v_mfma_f32_16x16x32_bf16 v[16:19], a[84:87], v[200:203], v[16:19]
    s_waitcnt lgkmcnt(6)
    v_permlane32_swap_b32 v48, v50
    v_mfma_f32_16x16x32_bf16 v[16:19], a[88:91], v[208:211], v[16:19]
    v_permlane32_swap_b32 v49, v51
    v_mfma_f32_16x16x32_bf16 v[16:19], a[92:95], v[216:219], v[16:19]
    ds_read_b64_tr_b16 a[108:109], v4 offset:37664
    ds_read_b64_tr_b16 a[110:111], v4 offset:37792
    buffer_store_dwordx4 v[48:51], v10, s[40:43], s54 offen offset:512 sc1
    v_mfma_f32_16x16x32_bf16 v[20:23], a[64:67], v[160:163], 0
    ds_read_b64_tr_b16 a[112:113], v4 offset:53792
    v_cvt_pk_bf16_f32 v52, v36, v37
    v_mfma_f32_16x16x32_bf16 v[20:23], a[68:71], v[168:171], v[20:23]
    ds_read_b64_tr_b16 a[114:115], v4 offset:53920
    v_cvt_pk_bf16_f32 v53, v38, v39
    v_mfma_f32_16x16x32_bf16 v[20:23], a[72:75], v[176:179], v[20:23]
    ds_read_b64_tr_b16 a[116:117], v4 offset:54048
    v_cvt_pk_bf16_f32 v54, v44, v45
    v_mfma_f32_16x16x32_bf16 v[20:23], a[76:79], v[184:187], v[20:23]
    ds_read_b64_tr_b16 a[118:119], v4 offset:54176
    v_cvt_pk_bf16_f32 v55, v46, v47
    v_mfma_f32_16x16x32_bf16 v[20:23], a[80:83], v[224:227], v[20:23]
    s_mov_b32 s54, 299008
    ds_read_b64_tr_b16 a[120:121], v4 offset:54304
    ds_read_b64_tr_b16 a[122:123], v4 offset:54432
    v_mfma_f32_16x16x32_bf16 v[20:23], a[84:87], v[232:235], v[20:23]
    v_permlane32_swap_b32 v52, v54
    v_mfma_f32_16x16x32_bf16 v[20:23], a[88:91], v[240:243], v[20:23]
    v_permlane32_swap_b32 v53, v55
    v_mfma_f32_16x16x32_bf16 v[20:23], a[92:95], v[248:251], v[20:23]
    s_waitcnt lgkmcnt(10)
    ds_read_b64_tr_b16 a[124:125], v4 offset:54560
    ds_read_b64_tr_b16 a[126:127], v4 offset:54688
    buffer_store_dwordx4 v[52:55], v10, s[40:43], s54 offen offset:512 sc1
    v_mfma_f32_16x16x32_bf16 v[24:27], a[96:99], v[128:131], 0
    ds_read_b64_tr_b16 a[64:65], v4 offset:36928
    v_mfma_f32_16x16x32_bf16 v[24:27], a[100:103], v[136:139], v[24:27]
    s_waitcnt lgkmcnt(9)
    ds_read_b64_tr_b16 a[66:67], v4 offset:37056
    v_mfma_f32_16x16x32_bf16 v[24:27], a[104:107], v[144:147], v[24:27]
    ds_read_b64_tr_b16 a[68:69], v4 offset:37184
    v_mfma_f32_16x16x32_bf16 v[24:27], a[108:111], v[152:155], v[24:27]
    s_waitcnt lgkmcnt(7)
    ds_read_b64_tr_b16 a[70:71], v4 offset:37312
    v_mfma_f32_16x16x32_bf16 v[24:27], a[112:115], v[192:195], v[24:27]
    ds_read_b64_tr_b16 a[72:73], v4 offset:37440
    v_mfma_f32_16x16x32_bf16 v[24:27], a[116:119], v[200:203], v[24:27]
    s_waitcnt lgkmcnt(5)
    ds_read_b64_tr_b16 a[74:75], v4 offset:37568
    v_mfma_f32_16x16x32_bf16 v[24:27], a[120:123], v[208:211], v[24:27]
    ds_read_b64_tr_b16 a[76:77], v4 offset:37696
    v_mfma_f32_16x16x32_bf16 v[24:27], a[124:127], v[216:219], v[24:27]
    ds_read_b64_tr_b16 a[78:79], v4 offset:37824
    v_mfma_f32_16x16x32_bf16 v[28:31], a[96:99], v[160:163], 0
    ds_read_b64_tr_b16 a[80:81], v4 offset:53824
    v_mfma_f32_16x16x32_bf16 v[28:31], a[100:103], v[168:171], v[28:31]
    ds_read_b64_tr_b16 a[82:83], v4 offset:53952
    v_mfma_f32_16x16x32_bf16 v[28:31], a[104:107], v[176:179], v[28:31]
    ds_read_b64_tr_b16 a[84:85], v4 offset:54080
    v_mfma_f32_16x16x32_bf16 v[28:31], a[108:111], v[184:187], v[28:31]
    ds_read_b64_tr_b16 a[86:87], v4 offset:54208
    v_mfma_f32_16x16x32_bf16 v[28:31], a[112:115], v[224:227], v[28:31]
L2_pad11:
    s_cbranch_execz L2_walkret
    ds_read_b64_tr_b16 a[88:89], v4 offset:54336
    v_mfma_f32_16x16x32_bf16 v[28:31], a[116:119], v[232:235], v[28:31]
    ds_read_b64_tr_b16 a[90:91], v4 offset:54464
    v_mfma_f32_16x16x32_bf16 v[28:31], a[120:123], v[240:243], v[28:31]
    ds_read_b64_tr_b16 a[92:93], v4 offset:54592
    v_mfma_f32_16x16x32_bf16 v[28:31], a[124:127], v[248:251], v[28:31]
    s_waitcnt lgkmcnt(11)
    ds_read_b64_tr_b16 a[94:95], v4 offset:54720
    v_mfma_f32_16x16x32_bf16 v[32:35], a[64:67], v[128:131], 0
    ds_read_b64_tr_b16 a[96:97], v4 offset:36960
    v_cvt_pk_bf16_f32 v48, v16, v17
    v_mfma_f32_16x16x32_bf16 v[32:35], a[68:71], v[136:139], v[32:35]
    s_waitcnt lgkmcnt(9)
    ds_read_b64_tr_b16 a[98:99], v4 offset:37088
    v_cvt_pk_bf16_f32 v49, v18, v19
    v_mfma_f32_16x16x32_bf16 v[32:35], a[72:75], v[144:147], v[32:35]
    ds_read_b64_tr_b16 a[100:101], v4 offset:37216
    v_cvt_pk_bf16_f32 v50, v24, v25
    v_mfma_f32_16x16x32_bf16 v[32:35], a[76:79], v[152:155], v[32:35]
    s_waitcnt lgkmcnt(7)
    ds_read_b64_tr_b16 a[102:103], v4 offset:37344
    v_cvt_pk_bf16_f32 v51, v26, v27
    v_mfma_f32_16x16x32_bf16 v[32:35], a[80:83], v[192:195], v[32:35]
    s_mov_b32 s54, 5120
    ds_read_b64_tr_b16 a[104:105], v4 offset:37472
    ds_read_b64_tr_b16 a[106:107], v4 offset:37600
    v_mfma_f32_16x16x32_bf16 v[32:35], a[84:87], v[200:203], v[32:35]
    s_waitcnt lgkmcnt(6)
    v_permlane32_swap_b32 v48, v50
    v_mfma_f32_16x16x32_bf16 v[32:35], a[88:91], v[208:211], v[32:35]
    v_permlane32_swap_b32 v49, v51
    v_mfma_f32_16x16x32_bf16 v[32:35], a[92:95], v[216:219], v[32:35]
    ds_read_b64_tr_b16 a[108:109], v4 offset:37728
    ds_read_b64_tr_b16 a[110:111], v4 offset:37856
    buffer_store_dwordx4 v[48:51], v10, s[40:43], s54 offen offset:0 sc1
    v_mfma_f32_16x16x32_bf16 v[36:39], a[64:67], v[160:163], 0
    ds_read_b64_tr_b16 a[112:113], v4 offset:53856
    v_cvt_pk_bf16_f32 v52, v20, v21
    v_mfma_f32_16x16x32_bf16 v[36:39], a[68:71], v[168:171], v[36:39]
    ds_read_b64_tr_b16 a[114:115], v4 offset:53984
    v_cvt_pk_bf16_f32 v53, v22, v23
    v_mfma_f32_16x16x32_bf16 v[36:39], a[72:75], v[176:179], v[36:39]
    ds_read_b64_tr_b16 a[116:117], v4 offset:54112
    v_cvt_pk_bf16_f32 v54, v28, v29
    v_mfma_f32_16x16x32_bf16 v[36:39], a[76:79], v[184:187], v[36:39]
    ds_read_b64_tr_b16 a[118:119], v4 offset:54240
    v_cvt_pk_bf16_f32 v55, v30, v31
    v_mfma_f32_16x16x32_bf16 v[36:39], a[80:83], v[224:227], v[36:39]
    s_mov_b32 s54, 300032
    ds_read_b64_tr_b16 a[120:121], v4 offset:54368
    ds_read_b64_tr_b16 a[122:123], v4 offset:54496
    v_mfma_f32_16x16x32_bf16 v[36:39], a[84:87], v[232:235], v[36:39]
    v_permlane32_swap_b32 v52, v54
    v_mfma_f32_16x16x32_bf16 v[36:39], a[88:91], v[240:243], v[36:39]
    v_permlane32_swap_b32 v53, v55
    v_mfma_f32_16x16x32_bf16 v[36:39], a[92:95], v[248:251], v[36:39]
    s_waitcnt vmcnt(15)
    s_barrier
    s_waitcnt lgkmcnt(10)
    ds_read_b64_tr_b16 a[124:125], v4 offset:54624
    ds_read_b64_tr_b16 a[126:127], v4 offset:54752
    buffer_store_dwordx4 v[52:55], v10, s[40:43], s54 offen offset:0 sc1
    v_mfma_f32_16x16x32_bf16 v[40:43], a[96:99], v[128:131], 0
    s_add_u32 m0, s44, 73728
    ds_read_b64_tr_b16 a[64:65], v3 offset:0
    ds_read_b64_tr_b16 a[66:67], v3 offset:128
    v_mfma_f32_16x16x32_bf16 v[40:43], a[100:103], v[136:139], v[40:43]
    s_mov_b32 s45, 1024
    s_waitcnt lgkmcnt(10)
    buffer_load_dwordx4 v7, s[28:31], s45 offen offset:0 lds
    v_mfma_f32_16x16x32_bf16 v[40:43], a[104:107], v[144:147], v[40:43]
    s_add_u32 m0, s44, 73632
    ds_read_b64_tr_b16 a[68:69], v3 offset:256
    ds_read_b64_tr_b16 a[70:71], v3 offset:384
    v_mfma_f32_16x16x32_bf16 v[40:43], a[108:111], v[152:155], v[40:43]
    s_waitcnt lgkmcnt(8)
    buffer_load_dwordx4 v7, s[28:31], s45 offen offset:1152 lds
    v_mfma_f32_16x16x32_bf16 v[40:43], a[112:115], v[192:195], v[40:43]
    s_add_u32 m0, s44, 73536
    ds_read_b64_tr_b16 a[72:73], v3 offset:512
    ds_read_b64_tr_b16 a[74:75], v3 offset:640
    v_mfma_f32_16x16x32_bf16 v[40:43], a[116:119], v[200:203], v[40:43]
    s_waitcnt lgkmcnt(6)
    buffer_load_dwordx4 v7, s[28:31], s45 offen offset:2304 lds
    v_mfma_f32_16x16x32_bf16 v[40:43], a[120:123], v[208:211], v[40:43]
    s_add_u32 m0, s44, 73440
    ds_read_b64_tr_b16 a[76:77], v3 offset:768
    ds_read_b64_tr_b16 a[78:79], v3 offset:896
    v_mfma_f32_16x16x32_bf16 v[40:43], a[124:127], v[216:219], v[40:43]
    buffer_load_dwordx4 v7, s[28:31], s45 offen offset:3456 lds
    v_mfma_f32_16x16x32_bf16 v[44:47], a[96:99], v[160:163], 0
    s_add_u32 m0, s44, 90624
    ds_read_b64_tr_b16 a[80:81], v3 offset:16896
    ds_read_b64_tr_b16 a[82:83], v3 offset:17024
    v_mfma_f32_16x16x32_bf16 v[44:47], a[100:103], v[168:171], v[44:47]
    s_mov_b32 s45, 148480
    buffer_load_dwordx4 v7, s[28:31], s45 offen offset:0 lds
    v_mfma_f32_16x16x32_bf16 v[44:47], a[104:107], v[176:179], v[44:47]
    s_add_u32 m0, s44, 90528
    ds_read_b64_tr_b16 a[84:85], v3 offset:17152
    ds_read_b64_tr_b16 a[86:87], v3 offset:17280
    v_mfma_f32_16x16x32_bf16 v[44:47], a[108:111], v[184:187], v[44:47]
    buffer_load_dwordx4 v7, s[28:31], s45 offen offset:1152 lds
    v_mfma_f32_16x16x32_bf16 v[44:47], a[112:115], v[224:227], v[44:47]
    s_add_u32 m0, s44, 90432
    ds_read_b64_tr_b16 a[88:89], v3 offset:17408
    ds_read_b64_tr_b16 a[90:91], v3 offset:17536
    v_mfma_f32_16x16x32_bf16 v[44:47], a[116:119], v[232:235], v[44:47]
    buffer_load_dwordx4 v7, s[28:31], s45 offen offset:2304 lds
    v_mfma_f32_16x16x32_bf16 v[44:47], a[120:123], v[240:243], v[44:47]
    s_add_u32 m0, s44, 90336
    ds_read_b64_tr_b16 a[92:93], v3 offset:17664
    ds_read_b64_tr_b16 a[94:95], v3 offset:17792
    v_mfma_f32_16x16x32_bf16 v[44:47], a[124:127], v[248:251], v[44:47]
    s_waitcnt lgkmcnt(12)
    buffer_load_dwordx4 v7, s[28:31], s45 offen offset:3456 lds
    v_mfma_f32_16x16x32_bf16 v[16:19], a[64:67], v[128:131], 0
    ds_read_b64_tr_b16 a[96:97], v3 offset:32
    v_cvt_pk_bf16_f32 v48, v32, v33
    v_mfma_f32_16x16x32_bf16 v[16:19], a[68:71], v[136:139], v[16:19]
    s_waitcnt lgkmcnt(9)
    ds_read_b64_tr_b16 a[98:99], v3 offset:160
    v_cvt_pk_bf16_f32 v49, v34, v35
    v_mfma_f32_16x16x32_bf16 v[16:19], a[72:75], v[144:147], v[16:19]
    ds_read_b64_tr_b16 a[100:101], v3 offset:288
    v_cvt_pk_bf16_f32 v50, v40, v41
    v_mfma_f32_16x16x32_bf16 v[16:19], a[76:79], v[152:155], v[16:19]
    s_waitcnt lgkmcnt(7)
    ds_read_b64_tr_b16 a[102:103], v3 offset:416
    v_cvt_pk_bf16_f32 v51, v42, v43
    v_mfma_f32_16x16x32_bf16 v[16:19], a[80:83], v[192:195], v[16:19]
    s_mov_b32 s54, 5120
    ds_read_b64_tr_b16 a[104:105], v3 offset:544
    ds_read_b64_tr_b16 a[106:107], v3 offset:672
    v_mfma_f32_16x16x32_bf16 v[16:19], a[84:87], v[200:203], v[16:19]
    s_waitcnt lgkmcnt(6)
    v_permlane32_swap_b32 v48, v50
    v_mfma_f32_16x16x32_bf16 v[16:19], a[88:91], v[208:211], v[16:19]
    v_permlane32_swap_b32 v49, v51
    v_mfma_f32_16x16x32_bf16 v[16:19], a[92:95], v[216:219], v[16:19]
    ds_read_b64_tr_b16 a[108:109], v3 offset:800
    ds_read_b64_tr_b16 a[110:111], v3 offset:928
    buffer_store_dwordx4 v[48:51], v10, s[40:43], s54 offen offset:512 sc1
    v_mfma_f32_16x16x32_bf16 v[20:23], a[64:67], v[160:163], 0
    ds_read_b64_tr_b16 a[112:113], v3 offset:16928
    v_cvt_pk_bf16_f32 v52, v36, v37
    v_mfma_f32_16x16x32_bf16 v[20:23], a[68:71], v[168:171], v[20:23]
    ds_read_b64_tr_b16 a[114:115], v3 offset:17056
    v_cvt_pk_bf16_f32 v53, v38, v39
    v_mfma_f32_16x16x32_bf16 v[20:23], a[72:75], v[176:179], v[20:23]
    ds_read_b64_tr_b16 a[116:117], v3 offset:17184
    v_cvt_pk_bf16_f32 v54, v44, v45
    v_mfma_f32_16x16x32_bf16 v[20:23], a[76:79], v[184:187], v[20:23]
    ds_read_b64_tr_b16 a[118:119], v3 offset:17312
    v_cvt_pk_bf16_f32 v55, v46, v47
    v_mfma_f32_16x16x32_bf16 v[20:23], a[80:83], v[224:227], v[20:23]
    s_mov_b32 s54, 300032
    ds_read_b64_tr_b16 a[120:121], v3 offset:17440
    ds_read_b64_tr_b16 a[122:123], v3 offset:17568
    v_mfma_f32_16x16x32_bf16 v[20:23], a[84:87], v[232:235], v[20:23]
    v_permlane32_swap_b32 v52, v54
    v_mfma_f32_16x16x32_bf16 v[20:23], a[88:91], v[240:243], v[20:23]
    v_permlane32_swap_b32 v53, v55
    v_mfma_f32_16x16x32_bf16 v[20:23], a[92:95], v[248:251], v[20:23]
    s_waitcnt lgkmcnt(10)
    ds_read_b64_tr_b16 a[124:125], v3 offset:17696
    ds_read_b64_tr_b16 a[126:127], v3 offset:17824
    buffer_store_dwordx4 v[52:55], v10, s[40:43], s54 offen offset:512 sc1
    v_mfma_f32_16x16x32_bf16 v[24:27], a[96:99], v[128:131], 0
    ds_read_b64_tr_b16 a[64:65], v3 offset:64
    v_mfma_f32_16x16x32_bf16 v[24:27], a[100:103], v[136:139], v[24:27]
    s_waitcnt lgkmcnt(9)
    ds_read_b64_tr_b16 a[66:67], v3 offset:192
    v_mfma_f32_16x16x32_bf16 v[24:27], a[104:107], v[144:147], v[24:27]
    ds_read_b64_tr_b16 a[68:69], v3 offset:320
    v_mfma_f32_16x16x32_bf16 v[24:27], a[108:111], v[152:155], v[24:27]
    s_waitcnt lgkmcnt(7)
    ds_read_b64_tr_b16 a[70:71], v3 offset:448
    v_mfma_f32_16x16x32_bf16 v[24:27], a[112:115], v[192:195], v[24:27]
    ds_read_b64_tr_b16 a[72:73], v3 offset:576
    v_mfma_f32_16x16x32_bf16 v[24:27], a[116:119], v[200:203], v[24:27]
    s_waitcnt lgkmcnt(5)
    ds_read_b64_tr_b16 a[74:75], v3 offset:704
    v_mfma_f32_16x16x32_bf16 v[24:27], a[120:123], v[208:211], v[24:27]
    ds_read_b64_tr_b16 a[76:77], v3 offset:832
    v_mfma_f32_16x16x32_bf16 v[24:27], a[124:127], v[216:219], v[24:27]
    ds_read_b64_tr_b16 a[78:79], v3 offset:960
    v_mfma_f32_16x16x32_bf16 v[28:31], a[96:99], v[160:163], 0
    ds_read_b64_tr_b16 a[80:81], v3 offset:16960
    v_mfma_f32_16x16x32_bf16 v[28:31], a[100:103], v[168:171], v[28:31]
    ds_read_b64_tr_b16 a[82:83], v3 offset:17088
    v_mfma_f32_16x16x32_bf16 v[28:31], a[104:107], v[176:179], v[28:31]
    ds_read_b64_tr_b16 a[84:85], v3 offset:17216
    v_mfma_f32_16x16x32_bf16 v[28:31], a[108:111], v[184:187], v[28:31]
    ds_read_b64_tr_b16 a[86:87], v3 offset:17344
    v_mfma_f32_16x16x32_bf16 v[28:31], a[112:115], v[224:227], v[28:31]
    ds_read_b64_tr_b16 a[88:89], v3 offset:17472
    v_mfma_f32_16x16x32_bf16 v[28:31], a[116:119], v[232:235], v[28:31]
    ds_read_b64_tr_b16 a[90:91], v3 offset:17600
    v_mfma_f32_16x16x32_bf16 v[28:31], a[120:123], v[240:243], v[28:31]
    ds_read_b64_tr_b16 a[92:93], v3 offset:17728
    v_mfma_f32_16x16x32_bf16 v[28:31], a[124:127], v[248:251], v[28:31]
    s_waitcnt lgkmcnt(11)
    ds_read_b64_tr_b16 a[94:95], v3 offset:17856
    v_mfma_f32_16x16x32_bf16 v[32:35], a[64:67], v[128:131], 0
    ds_read_b64_tr_b16 a[96:97], v3 offset:96
    v_cvt_pk_bf16_f32 v48, v16, v17
    v_mfma_f32_16x16x32_bf16 v[32:35], a[68:71], v[136:139], v[32:35]
    s_waitcnt lgkmcnt(9)
    ds_read_b64_tr_b16 a[98:99], v3 offset:224
    v_cvt_pk_bf16_f32 v49, v18, v19
    v_mfma_f32_16x16x32_bf16 v[32:35], a[72:75], v[144:147], v[32:35]
    ds_read_b64_tr_b16 a[100:101], v3 offset:352
    v_cvt_pk_bf16_f32 v50, v24, v25
    v_mfma_f32_16x16x32_bf16 v[32:35], a[76:79], v[152:155], v[32:35]
    s_waitcnt lgkmcnt(7)
    ds_read_b64_tr_b16 a[102:103], v3 offset:480
    v_cvt_pk_bf16_f32 v51, v26, v27
    v_mfma_f32_16x16x32_bf16 v[32:35], a[80:83], v[192:195], v[32:35]
    s_mov_b32 s54, 6144
    ds_read_b64_tr_b16 a[104:105], v3 offset:608
    ds_read_b64_tr_b16 a[106:107], v3 offset:736
    v_mfma_f32_16x16x32_bf16 v[32:35], a[84:87], v[200:203], v[32:35]
    s_waitcnt lgkmcnt(6)
    v_permlane32_swap_b32 v48, v50
    v_mfma_f32_16x16x32_bf16 v[32:35], a[88:91], v[208:211], v[32:35]
    v_permlane32_swap_b32 v49, v51
    v_mfma_f32_16x16x32_bf16 v[32:35], a[92:95], v[216:219], v[32:35]
    ds_read_b64_tr_b16 a[108:109], v3 offset:864
    ds_read_b64_tr_b16 a[110:111], v3 offset:992
    buffer_store_dwordx4 v[48:51], v10, s[40:43], s54 offen offset:0 sc1
    v_mfma_f32_16x16x32_bf16 v[36:39], a[64:67], v[160:163], 0
    ds_read_b64_tr_b16 a[112:113], v3 offset:16992
    v_cvt_pk_bf16_f32 v52, v20, v21
    v_mfma_f32_16x16x32_bf16 v[36:39], a[68:71], v[168:171], v[36:39]
    ds_read_b64_tr_b16 a[114:115], v3 offset:17120
    v_cvt_pk_bf16_f32 v53, v22, v23
    v_mfma_f32_16x16x32_bf16 v[36:39], a[72:75], v[176:179], v[36:39]
    ds_read_b64_tr_b16 a[116:117], v3 offset:17248
    v_cvt_pk_bf16_f32 v54, v28, v29
    v_mfma_f32_16x16x32_bf16 v[36:39], a[76:79], v[184:187], v[36:39]
    ds_read_b64_tr_b16 a[118:119], v3 offset:17376
    v_cvt_pk_bf16_f32 v55, v30, v31
    v_mfma_f32_16x16x32_bf16 v[36:39], a[80:83], v[224:227], v[36:39]
    s_mov_b32 s54, 301056
    ds_read_b64_tr_b16 a[120:121], v3 offset:17504
    ds_read_b64_tr_b16 a[122:123], v3 offset:17632
    v_mfma_f32_16x16x32_bf16 v[36:39], a[84:87], v[232:235], v[36:39]
    v_permlane32_swap_b32 v52, v54
    v_mfma_f32_16x16x32_bf16 v[36:39], a[88:91], v[240:243], v[36:39]
    v_permlane32_swap_b32 v53, v55
    v_mfma_f32_16x16x32_bf16 v[36:39], a[92:95], v[248:251], v[36:39]
    s_waitcnt vmcnt(15)
    s_barrier
    s_waitcnt lgkmcnt(10)
    ds_read_b64_tr_b16 a[124:125], v3 offset:17760
    ds_read_b64_tr_b16 a[126:127], v3 offset:17888
    buffer_store_dwordx4 v[52:55], v10, s[40:43], s54 offen offset:0 sc1
    v_mfma_f32_16x16x32_bf16 v[40:43], a[96:99], v[128:131], 0
    ds_read_b64_tr_b16 a[64:65], v3 offset:36864
    v_mfma_f32_16x16x32_bf16 v[40:43], a[100:103], v[136:139], v[40:43]
    s_waitcnt lgkmcnt(9)
    ds_read_b64_tr_b16 a[66:67], v3 offset:36992
    v_mfma_f32_16x16x32_bf16 v[40:43], a[104:107], v[144:147], v[40:43]
    ds_read_b64_tr_b16 a[68:69], v3 offset:37120
    v_mfma_f32_16x16x32_bf16 v[40:43], a[108:111], v[152:155], v[40:43]
    s_waitcnt lgkmcnt(7)
    ds_read_b64_tr_b16 a[70:71], v3 offset:37248
    v_mfma_f32_16x16x32_bf16 v[40:43], a[112:115], v[192:195], v[40:43]
    ds_read_b64_tr_b16 a[72:73], v3 offset:37376
    v_mfma_f32_16x16x32_bf16 v[40:43], a[116:119], v[200:203], v[40:43]
    s_waitcnt lgkmcnt(5)
    ds_read_b64_tr_b16 a[74:75], v3 offset:37504
    v_mfma_f32_16x16x32_bf16 v[40:43], a[120:123], v[208:211], v[40:43]
    ds_read_b64_tr_b16 a[76:77], v3 offset:37632
    v_mfma_f32_16x16x32_bf16 v[40:43], a[124:127], v[216:219], v[40:43]
    ds_read_b64_tr_b16 a[78:79], v3 offset:37760
    v_mfma_f32_16x16x32_bf16 v[44:47], a[96:99], v[160:163], 0
    s_sub_u32 s28, s88, 4096
    s_subb_u32 s29, s89, 0
    ds_read_b64_tr_b16 a[80:81], v3 offset:53760
    v_mfma_f32_16x16x32_bf16 v[44:47], a[100:103], v[168:171], v[44:47]
    s_mov_b32 s30, 147456
    ds_read_b64_tr_b16 a[82:83], v3 offset:53888
    v_mfma_f32_16x16x32_bf16 v[44:47], a[104:107], v[176:179], v[44:47]
    ds_read_b64_tr_b16 a[84:85], v3 offset:54016
    v_mfma_f32_16x16x32_bf16 v[44:47], a[108:111], v[184:187], v[44:47]
    ds_read_b64_tr_b16 a[86:87], v3 offset:54144
    v_mfma_f32_16x16x32_bf16 v[44:47], a[112:115], v[224:227], v[44:47]
    ds_read_b64_tr_b16 a[88:89], v3 offset:54272
    v_mfma_f32_16x16x32_bf16 v[44:47], a[116:119], v[232:235], v[44:47]
    ds_read_b64_tr_b16 a[90:91], v3 offset:54400
    v_mfma_f32_16x16x32_bf16 v[44:47], a[120:123], v[240:243], v[44:47]
    ds_read_b64_tr_b16 a[92:93], v3 offset:54528
    v_mfma_f32_16x16x32_bf16 v[44:47], a[124:127], v[248:251], v[44:47]
    s_waitcnt lgkmcnt(11)
    ds_read_b64_tr_b16 a[94:95], v3 offset:54656
    v_mfma_f32_16x16x32_bf16 v[16:19], a[64:67], v[128:131], 0
    ds_read_b64_tr_b16 a[96:97], v3 offset:36896
    v_cvt_pk_bf16_f32 v48, v32, v33
    v_mfma_f32_16x16x32_bf16 v[16:19], a[68:71], v[136:139], v[16:19]
    s_waitcnt lgkmcnt(9)
    ds_read_b64_tr_b16 a[98:99], v3 offset:37024
    v_cvt_pk_bf16_f32 v49, v34, v35
    v_mfma_f32_16x16x32_bf16 v[16:19], a[72:75], v[144:147], v[16:19]
    ds_read_b64_tr_b16 a[100:101], v3 offset:37152
    v_cvt_pk_bf16_f32 v50, v40, v41
    v_mfma_f32_16x16x32_bf16 v[16:19], a[76:79], v[152:155], v[16:19]
    s_waitcnt lgkmcnt(7)
    ds_read_b64_tr_b16 a[102:103], v3 offset:37280
    v_cvt_pk_bf16_f32 v51, v42, v43
    v_mfma_f32_16x16x32_bf16 v[16:19], a[80:83], v[192:195], v[16:19]
    s_mov_b32 s54, 6144
    ds_read_b64_tr_b16 a[104:105], v3 offset:37408
    ds_read_b64_tr_b16 a[106:107], v3 offset:37536
    v_mfma_f32_16x16x32_bf16 v[16:19], a[84:87], v[200:203], v[16:19]
    s_waitcnt lgkmcnt(6)
    v_permlane32_swap_b32 v48, v50
    v_mfma_f32_16x16x32_bf16 v[16:19], a[88:91], v[208:211], v[16:19]
    v_permlane32_swap_b32 v49, v51
    v_mfma_f32_16x16x32_bf16 v[16:19], a[92:95], v[216:219], v[16:19]
    ds_read_b64_tr_b16 a[108:109], v3 offset:37664
    ds_read_b64_tr_b16 a[110:111], v3 offset:37792
    buffer_store_dwordx4 v[48:51], v10, s[40:43], s54 offen offset:512 sc1
    v_mfma_f32_16x16x32_bf16 v[20:23], a[64:67], v[160:163], 0
    ds_read_b64_tr_b16 a[112:113], v3 offset:53792
    v_cvt_pk_bf16_f32 v52, v36, v37
    v_mfma_f32_16x16x32_bf16 v[20:23], a[68:71], v[168:171], v[20:23]
    ds_read_b64_tr_b16 a[114:115], v3 offset:53920
    v_cvt_pk_bf16_f32 v53, v38, v39
    v_mfma_f32_16x16x32_bf16 v[20:23], a[72:75], v[176:179], v[20:23]
    ds_read_b64_tr_b16 a[116:117], v3 offset:54048
    v_cvt_pk_bf16_f32 v54, v44, v45
    v_mfma_f32_16x16x32_bf16 v[20:23], a[76:79], v[184:187], v[20:23]
    ds_read_b64_tr_b16 a[118:119], v3 offset:54176
    v_cvt_pk_bf16_f32 v55, v46, v47
    v_mfma_f32_16x16x32_bf16 v[20:23], a[80:83], v[224:227], v[20:23]
    s_mov_b32 s54, 301056
    ds_read_b64_tr_b16 a[120:121], v3 offset:54304
    ds_read_b64_tr_b16 a[122:123], v3 offset:54432
    v_mfma_f32_16x16x32_bf16 v[20:23], a[84:87], v[232:235], v[20:23]
    v_permlane32_swap_b32 v52, v54
    v_mfma_f32_16x16x32_bf16 v[20:23], a[88:91], v[240:243], v[20:23]
    v_permlane32_swap_b32 v53, v55
    v_mfma_f32_16x16x32_bf16 v[20:23], a[92:95], v[248:251], v[20:23]
    s_waitcnt lgkmcnt(10)
    ds_read_b64_tr_b16 a[124:125], v3 offset:54560
    ds_read_b64_tr_b16 a[126:127], v3 offset:54688
    buffer_store_dwordx4 v[52:55], v10, s[40:43], s54 offen offset:512 sc1
    v_mfma_f32_16x16x32_bf16 v[24:27], a[96:99], v[128:131], 0
    ds_read_b64_tr_b16 a[64:65], v3 offset:36928
    v_mfma_f32_16x16x32_bf16 v[24:27], a[100:103], v[136:139], v[24:27]
    s_waitcnt lgkmcnt(9)
    ds_read_b64_tr_b16 a[66:67], v3 offset:37056
    v_mfma_f32_16x16x32_bf16 v[24:27], a[104:107], v[144:147], v[24:27]
    ds_read_b64_tr_b16 a[68:69], v3 offset:37184
    v_mfma_f32_16x16x32_bf16 v[24:27], a[108:111], v[152:155], v[24:27]
    s_waitcnt lgkmcnt(7)
    ds_read_b64_tr_b16 a[70:71], v3 offset:37312
    v_mfma_f32_16x16x32_bf16 v[24:27], a[112:115], v[192:195], v[24:27]
    ds_read_b64_tr_b16 a[72:73], v3 offset:37440
    v_mfma_f32_16x16x32_bf16 v[24:27], a[116:119], v[200:203], v[24:27]
    s_waitcnt lgkmcnt(5)
    ds_read_b64_tr_b16 a[74:75], v3 offset:37568
    v_mfma_f32_16x16x32_bf16 v[24:27], a[120:123], v[208:211], v[24:27]
    ds_read_b64_tr_b16 a[76:77], v3 offset:37696
    v_mfma_f32_16x16x32_bf16 v[24:27], a[124:127], v[216:219], v[24:27]
    ds_read_b64_tr_b16 a[78:79], v3 offset:37824
    v_mfma_f32_16x16x32_bf16 v[28:31], a[96:99], v[160:163], 0
    ds_read_b64_tr_b16 a[80:81], v3 offset:53824
    v_mfma_f32_16x16x32_bf16 v[28:31], a[100:103], v[168:171], v[28:31]
    ds_read_b64_tr_b16 a[82:83], v3 offset:53952
    v_mfma_f32_16x16x32_bf16 v[28:31], a[104:107], v[176:179], v[28:31]
    ds_read_b64_tr_b16 a[84:85], v3 offset:54080
    v_mfma_f32_16x16x32_bf16 v[28:31], a[108:111], v[184:187], v[28:31]
    ds_read_b64_tr_b16 a[86:87], v3 offset:54208
    v_mfma_f32_16x16x32_bf16 v[28:31], a[112:115], v[224:227], v[28:31]
    ds_read_b64_tr_b16 a[88:89], v3 offset:54336
    v_mfma_f32_16x16x32_bf16 v[28:31], a[116:119], v[232:235], v[28:31]
    ds_read_b64_tr_b16 a[90:91], v3 offset:54464
    v_mfma_f32_16x16x32_bf16 v[28:31], a[120:123], v[240:243], v[28:31]
    ds_read_b64_tr_b16 a[92:93], v3 offset:54592
    v_mfma_f32_16x16x32_bf16 v[28:31], a[124:127], v[248:251], v[28:31]
    s_waitcnt lgkmcnt(11)
    ds_read_b64_tr_b16 a[94:95], v3 offset:54720
    v_mfma_f32_16x16x32_bf16 v[32:35], a[64:67], v[128:131], 0
    ds_read_b64_tr_b16 a[96:97], v3 offset:36960
    v_cvt_pk_bf16_f32 v48, v16, v17
    v_mfma_f32_16x16x32_bf16 v[32:35], a[68:71], v[136:139], v[32:35]
    s_waitcnt lgkmcnt(9)
    ds_read_b64_tr_b16 a[98:99], v3 offset:37088
    v_cvt_pk_bf16_f32 v49, v18, v19
    v_mfma_f32_16x16x32_bf16 v[32:35], a[72:75], v[144:147], v[32:35]
    ds_read_b64_tr_b16 a[100:101], v3 offset:37216
    v_cvt_pk_bf16_f32 v50, v24, v25
    v_mfma_f32_16x16x32_bf16 v[32:35], a[76:79], v[152:155], v[32:35]
    s_waitcnt lgkmcnt(7)
    ds_read_b64_tr_b16 a[102:103], v3 offset:37344
    v_cvt_pk_bf16_f32 v51, v26, v27
    v_mfma_f32_16x16x32_bf16 v[32:35], a[80:83], v[192:195], v[32:35]
    s_mov_b32 s54, 7168
    ds_read_b64_tr_b16 a[104:105], v3 offset:37472
    ds_read_b64_tr_b16 a[106:107], v3 offset:37600
    v_mfma_f32_16x16x32_bf16 v[32:35], a[84:87], v[200:203], v[32:35]
    s_waitcnt lgkmcnt(6)
    v_permlane32_swap_b32 v48, v50
    v_mfma_f32_16x16x32_bf16 v[32:35], a[88:91], v[208:211], v[32:35]
    v_permlane32_swap_b32 v49, v51
    v_mfma_f32_16x16x32_bf16 v[32:35], a[92:95], v[216:219], v[32:35]
    ds_read_b64_tr_b16 a[108:109], v3 offset:37728
    ds_read_b64_tr_b16 a[110:111], v3 offset:37856
    buffer_store_dwordx4 v[48:51], v10, s[40:43], s54 offen offset:0 sc1
    v_mfma_f32_16x16x32_bf16 v[36:39], a[64:67], v[160:163], 0
    ds_read_b64_tr_b16 a[112:113], v3 offset:53856
    v_cvt_pk_bf16_f32 v52, v20, v21
    v_mfma_f32_16x16x32_bf16 v[36:39], a[68:71], v[168:171], v[36:39]
    ds_read_b64_tr_b16 a[114:115], v3 offset:53984
    v_cvt_pk_bf16_f32 v53, v22, v23
    v_mfma_f32_16x16x32_bf16 v[36:39], a[72:75], v[176:179], v[36:39]
    ds_read_b64_tr_b16 a[116:117], v3 offset:54112
    v_cvt_pk_bf16_f32 v54, v28, v29
    v_mfma_f32_16x16x32_bf16 v[36:39], a[76:79], v[184:187], v[36:39]
    ds_read_b64_tr_b16 a[118:119], v3 offset:54240
    v_cvt_pk_bf16_f32 v55, v30, v31
    v_mfma_f32_16x16x32_bf16 v[36:39], a[80:83], v[224:227], v[36:39]
    s_mov_b32 s54, 302080
    ds_read_b64_tr_b16 a[120:121], v3 offset:54368
    ds_read_b64_tr_b16 a[122:123], v3 offset:54496
    v_mfma_f32_16x16x32_bf16 v[36:39], a[84:87], v[232:235], v[36:39]
    v_permlane32_swap_b32 v52, v54
    v_mfma_f32_16x16x32_bf16 v[36:39], a[88:91], v[240:243], v[36:39]
    v_permlane32_swap_b32 v53, v55
    v_mfma_f32_16x16x32_bf16 v[36:39], a[92:95], v[248:251], v[36:39]
    s_waitcnt vmcnt(7)
    s_barrier
    s_waitcnt lgkmcnt(10)
    ds_read_b64_tr_b16 a[124:125], v3 offset:54624
    ds_read_b64_tr_b16 a[126:127], v3 offset:54752
    buffer_store_dwordx4 v[52:55], v10, s[40:43], s54 offen offset:0 sc1
    v_mfma_f32_16x16x32_bf16 v[40:43], a[96:99], v[128:131], 0
    ds_read_b64_tr_b16 a[64:65], v4 offset:0
    v_mfma_f32_16x16x32_bf16 v[40:43], a[100:103], v[136:139], v[40:43]
    s_waitcnt lgkmcnt(9)
    ds_read_b64_tr_b16 a[66:67], v4 offset:128
    v_mfma_f32_16x16x32_bf16 v[40:43], a[104:107], v[144:147], v[40:43]
    ds_read_b64_tr_b16 a[68:69], v4 offset:256
    v_mfma_f32_16x16x32_bf16 v[40:43], a[108:111], v[152:155], v[40:43]
    s_waitcnt lgkmcnt(7)
    ds_read_b64_tr_b16 a[70:71], v4 offset:384
    v_mfma_f32_16x16x32_bf16 v[40:43], a[112:115], v[192:195], v[40:43]
    ds_read_b64_tr_b16 a[72:73], v4 offset:512
    v_mfma_f32_16x16x32_bf16 v[40:43], a[116:119], v[200:203], v[40:43]
    s_waitcnt lgkmcnt(5)
    ds_read_b64_tr_b16 a[74:75], v4 offset:640
    v_mfma_f32_16x16x32_bf16 v[40:43], a[120:123], v[208:211], v[40:43]
    ds_read_b64_tr_b16 a[76:77], v4 offset:768
    v_mfma_f32_16x16x32_bf16 v[40:43], a[124:127], v[216:219], v[40:43]
    ds_read_b64_tr_b16 a[78:79], v4 offset:896
    v_mfma_f32_16x16x32_bf16 v[44:47], a[96:99], v[160:163], 0
    ds_read_b64_tr_b16 a[80:81], v4 offset:16896
    v_mfma_f32_16x16x32_bf16 v[44:47], a[100:103], v[168:171], v[44:47]
    ds_read_b64_tr_b16 a[82:83], v4 offset:17024
    v_mfma_f32_16x16x32_bf16 v[44:47], a[104:107], v[176:179], v[44:47]
    ds_read_b64_tr_b16 a[84:85], v4 offset:17152
    v_mfma_f32_16x16x32_bf16 v[44:47], a[108:111], v[184:187], v[44:47]
    ds_read_b64_tr_b16 a[86:87], v4 offset:17280
    v_mfma_f32_16x16x32_bf16 v[44:47], a[112:115], v[224:227], v[44:47]
    ds_read_b64_tr_b16 a[88:89], v4 offset:17408
    v_mfma_f32_16x16x32_bf16 v[44:47], a[116:119], v[232:235], v[44:47]
    ds_read_b64_tr_b16 a[90:91], v4 offset:17536
    v_mfma_f32_16x16x32_bf16 v[44:47], a[120:123], v[240:243], v[44:47]
    ds_read_b64_tr_b16 a[92:93], v4 offset:17664
    v_mfma_f32_16x16x32_bf16 v[44:47], a[124:127], v[248:251], v[44:47]
    s_waitcnt lgkmcnt(11)
    ds_read_b64_tr_b16 a[94:95], v4 offset:17792
    v_mfma_f32_16x16x32_bf16 v[16:19], a[64:67], v[128:131], 0
    ds_read_b64_tr_b16 a[96:97], v4 offset:32
    v_cvt_pk_bf16_f32 v48, v32, v33
    v_mfma_f32_16x16x32_bf16 v[16:19], a[68:71], v[136:139], v[16:19]
    s_waitcnt lgkmcnt(9)
    ds_read_b64_tr_b16 a[98:99], v4 offset:160
    v_cvt_pk_bf16_f32 v49, v34, v35
    v_mfma_f32_16x16x32_bf16 v[16:19], a[72:75], v[144:147], v[16:19]
    ds_read_b64_tr_b16 a[100:101], v4 offset:288
    v_cvt_pk_bf16_f32 v50, v40, v41
    v_mfma_f32_16x16x32_bf16 v[16:19], a[76:79], v[152:155], v[16:19]
    s_waitcnt lgkmcnt(7)
    ds_read_b64_tr_b16 a[102:103], v4 offset:416
    v_cvt_pk_bf16_f32 v51, v42, v43
    v_mfma_f32_16x16x32_bf16 v[16:19], a[80:83], v[192:195], v[16:19]
    s_mov_b32 s54, 7168
    ds_read_b64_tr_b16 a[104:105], v4 offset:544
    ds_read_b64_tr_b16 a[106:107], v4 offset:672
    v_mfma_f32_16x16x32_bf16 v[16:19], a[84:87], v[200:203], v[16:19]
    s_waitcnt lgkmcnt(6)
    v_permlane32_swap_b32 v48, v50
    v_mfma_f32_16x16x32_bf16 v[16:19], a[88:91], v[208:211], v[16:19]
    v_permlane32_swap_b32 v49, v51
    v_mfma_f32_16x16x32_bf16 v[16:19], a[92:95], v[216:219], v[16:19]
    ds_read_b64_tr_b16 a[108:109], v4 offset:800
    ds_read_b64_tr_b16 a[110:111], v4 offset:928
    buffer_store_dwordx4 v[48:51], v10, s[40:43], s54 offen offset:512 sc1
    v_mfma_f32_16x16x32_bf16 v[20:23], a[64:67], v[160:163], 0
    ds_read_b64_tr_b16 a[112:113], v4 offset:16928
    v_cvt_pk_bf16_f32 v52, v36, v37
    v_mfma_f32_16x16x32_bf16 v[20:23], a[68:71], v[168:171], v[20:23]
    ds_read_b64_tr_b16 a[114:115], v4 offset:17056
    v_cvt_pk_bf16_f32 v53, v38, v39
    v_mfma_f32_16x16x32_bf16 v[20:23], a[72:75], v[176:179], v[20:23]
    ds_read_b64_tr_b16 a[116:117], v4 offset:17184
    v_cvt_pk_bf16_f32 v54, v44, v45
    v_mfma_f32_16x16x32_bf16 v[20:23], a[76:79], v[184:187], v[20:23]
    ds_read_b64_tr_b16 a[118:119], v4 offset:17312
    v_cvt_pk_bf16_f32 v55, v46, v47
    v_mfma_f32_16x16x32_bf16 v[20:23], a[80:83], v[224:227], v[20:23]
    s_mov_b32 s54, 302080
    ds_read_b64_tr_b16 a[120:121], v4 offset:17440
    ds_read_b64_tr_b16 a[122:123], v4 offset:17568
    v_mfma_f32_16x16x32_bf16 v[20:23], a[84:87], v[232:235], v[20:23]
    v_permlane32_swap_b32 v52, v54
    v_mfma_f32_16x16x32_bf16 v[20:23], a[88:91], v[240:243], v[20:23]
    v_permlane32_swap_b32 v53, v55
    v_mfma_f32_16x16x32_bf16 v[20:23], a[92:95], v[248:251], v[20:23]
    s_waitcnt lgkmcnt(10)
    ds_read_b64_tr_b16 a[124:125], v4 offset:17696
    ds_read_b64_tr_b16 a[126:127], v4 offset:17824
    buffer_store_dwordx4 v[52:55], v10, s[40:43], s54 offen offset:512 sc1
    v_mfma_f32_16x16x32_bf16 v[24:27], a[96:99], v[128:131], 0
    ds_read_b64_tr_b16 a[64:65], v4 offset:64
    v_mfma_f32_16x16x32_bf16 v[24:27], a[100:103], v[136:139], v[24:27]
    s_waitcnt lgkmcnt(9)
    ds_read_b64_tr_b16 a[66:67], v4 offset:192
    v_mfma_f32_16x16x32_bf16 v[24:27], a[104:107], v[144:147], v[24:27]
    ds_read_b64_tr_b16 a[68:69], v4 offset:320
    v_mfma_f32_16x16x32_bf16 v[24:27], a[108:111], v[152:155], v[24:27]
    s_waitcnt lgkmcnt(7)
    ds_read_b64_tr_b16 a[70:71], v4 offset:448
    v_mfma_f32_16x16x32_bf16 v[24:27], a[112:115], v[192:195], v[24:27]
    ds_read_b64_tr_b16 a[72:73], v4 offset:576
    v_mfma_f32_16x16x32_bf16 v[24:27], a[116:119], v[200:203], v[24:27]
    s_waitcnt lgkmcnt(5)
    ds_read_b64_tr_b16 a[74:75], v4 offset:704
    v_mfma_f32_16x16x32_bf16 v[24:27], a[120:123], v[208:211], v[24:27]
    ds_read_b64_tr_b16 a[76:77], v4 offset:832
    v_mfma_f32_16x16x32_bf16 v[24:27], a[124:127], v[216:219], v[24:27]
    ds_read_b64_tr_b16 a[78:79], v4 offset:960
    v_mfma_f32_16x16x32_bf16 v[28:31], a[96:99], v[160:163], 0
    ds_read_b64_tr_b16 a[80:81], v4 offset:16960
    v_mfma_f32_16x16x32_bf16 v[28:31], a[100:103], v[168:171], v[28:31]
    ds_read_b64_tr_b16 a[82:83], v4 offset:17088
    v_mfma_f32_16x16x32_bf16 v[28:31], a[104:107], v[176:179], v[28:31]
L2_pad12:
    s_cbranch_execz L2_walkret
    ds_read_b64_tr_b16 a[84:85], v4 offset:17216
    v_mfma_f32_16x16x32_bf16 v[28:31], a[108:111], v[184:187], v[28:31]
    ds_read_b64_tr_b16 a[86:87], v4 offset:17344
    v_mfma_f32_16x16x32_bf16 v[28:31], a[112:115], v[224:227], v[28:31]
    ds_read_b64_tr_b16 a[88:89], v4 offset:17472
    v_mfma_f32_16x16x32_bf16 v[28:31], a[116:119], v[232:235], v[28:31]
    ds_read_b64_tr_b16 a[90:91], v4 offset:17600
    v_mfma_f32_16x16x32_bf16 v[28:31], a[120:123], v[240:243], v[28:31]
    ds_read_b64_tr_b16 a[92:93], v4 offset:17728
    v_mfma_f32_16x16x32_bf16 v[28:31], a[124:127], v[248:251], v[28:31]
    s_waitcnt lgkmcnt(11)
    ds_read_b64_tr_b16 a[94:95], v4 offset:17856
    v_mfma_f32_16x16x32_bf16 v[32:35], a[64:67], v[128:131], 0
    ds_read_b64_tr_b16 a[96:97], v4 offset:96
    v_cvt_pk_bf16_f32 v48, v16, v17
    v_mfma_f32_16x16x32_bf16 v[32:35], a[68:71], v[136:139], v[32:35]
    s_waitcnt lgkmcnt(9)
    ds_read_b64_tr_b16 a[98:99], v4 offset:224
    v_cvt_pk_bf16_f32 v49, v18, v19
    v_mfma_f32_16x16x32_bf16 v[32:35], a[72:75], v[144:147], v[32:35]
    ds_read_b64_tr_b16 a[100:101], v4 offset:352
    v_cvt_pk_bf16_f32 v50, v24, v25
    v_mfma_f32_16x16x32_bf16 v[32:35], a[76:79], v[152:155], v[32:35]
    s_waitcnt lgkmcnt(7)
    ds_read_b64_tr_b16 a[102:103], v4 offset:480
    v_cvt_pk_bf16_f32 v51, v26, v27
    v_mfma_f32_16x16x32_bf16 v[32:35], a[80:83], v[192:195], v[32:35]
    s_mov_b32 s54, 8192
    ds_read_b64_tr_b16 a[104:105], v4 offset:608
    ds_read_b64_tr_b16 a[106:107], v4 offset:736
    v_mfma_f32_16x16x32_bf16 v[32:35], a[84:87], v[200:203], v[32:35]
    s_waitcnt lgkmcnt(6)
    v_permlane32_swap_b32 v48, v50
    v_mfma_f32_16x16x32_bf16 v[32:35], a[88:91], v[208:211], v[32:35]
    v_permlane32_swap_b32 v49, v51
    v_mfma_f32_16x16x32_bf16 v[32:35], a[92:95], v[216:219], v[32:35]
    ds_read_b64_tr_b16 a[108:109], v4 offset:864
    ds_read_b64_tr_b16 a[110:111], v4 offset:992
    buffer_store_dwordx4 v[48:51], v10, s[40:43], s54 offen offset:0 sc1
    v_mfma_f32_16x16x32_bf16 v[36:39], a[64:67], v[160:163], 0
    ds_read_b64_tr_b16 a[112:113], v4 offset:16992
    v_cvt_pk_bf16_f32 v52, v20, v21
    v_mfma_f32_16x16x32_bf16 v[36:39], a[68:71], v[168:171], v[36:39]
    ds_read_b64_tr_b16 a[114:115], v4 offset:17120
    v_cvt_pk_bf16_f32 v53, v22, v23
    v_mfma_f32_16x16x32_bf16 v[36:39], a[72:75], v[176:179], v[36:39]
    ds_read_b64_tr_b16 a[116:117], v4 offset:17248
    v_cvt_pk_bf16_f32 v54, v28, v29
    v_mfma_f32_16x16x32_bf16 v[36:39], a[76:79], v[184:187], v[36:39]
    ds_read_b64_tr_b16 a[118:119], v4 offset:17376
    v_cvt_pk_bf16_f32 v55, v30, v31
    v_mfma_f32_16x16x32_bf16 v[36:39], a[80:83], v[224:227], v[36:39]
    s_mov_b32 s54, 303104
    ds_read_b64_tr_b16 a[120:121], v4 offset:17504
    ds_read_b64_tr_b16 a[122:123], v4 offset:17632
    v_mfma_f32_16x16x32_bf16 v[36:39], a[84:87], v[232:235], v[36:39]
    v_permlane32_swap_b32 v52, v54
    v_mfma_f32_16x16x32_bf16 v[36:39], a[88:91], v[240:243], v[36:39]
    v_permlane32_swap_b32 v53, v55
    v_mfma_f32_16x16x32_bf16 v[36:39], a[92:95], v[248:251], v[36:39]
    s_waitcnt lgkmcnt(10)
    ds_read_b64_tr_b16 a[124:125], v4 offset:17760
    ds_read_b64_tr_b16 a[126:127], v4 offset:17888
    buffer_store_dwordx4 v[52:55], v10, s[40:43], s54 offen offset:0 sc1
    v_mfma_f32_16x16x32_bf16 v[40:43], a[96:99], v[128:131], 0
    v_mfma_f32_16x16x32_bf16 v[40:43], a[100:103], v[136:139], v[40:43]
    s_waitcnt lgkmcnt(8)
    v_mfma_f32_16x16x32_bf16 v[40:43], a[104:107], v[144:147], v[40:43]
    v_mfma_f32_16x16x32_bf16 v[40:43], a[108:111], v[152:155], v[40:43]
    s_waitcnt lgkmcnt(4)
    v_mfma_f32_16x16x32_bf16 v[40:43], a[112:115], v[192:195], v[40:43]
    v_mfma_f32_16x16x32_bf16 v[40:43], a[116:119], v[200:203], v[40:43]
    s_waitcnt lgkmcnt(0)
    v_mfma_f32_16x16x32_bf16 v[40:43], a[120:123], v[208:211], v[40:43]
    v_mfma_f32_16x16x32_bf16 v[40:43], a[124:127], v[216:219], v[40:43]
    v_mfma_f32_16x16x32_bf16 v[44:47], a[96:99], v[160:163], 0
    v_mfma_f32_16x16x32_bf16 v[44:47], a[100:103], v[168:171], v[44:47]
    v_mfma_f32_16x16x32_bf16 v[44:47], a[104:107], v[176:179], v[44:47]
    v_mfma_f32_16x16x32_bf16 v[44:47], a[108:111], v[184:187], v[44:47]
    v_mfma_f32_16x16x32_bf16 v[44:47], a[112:115], v[224:227], v[44:47]
    v_mfma_f32_16x16x32_bf16 v[44:47], a[116:119], v[232:235], v[44:47]
    v_mfma_f32_16x16x32_bf16 v[44:47], a[120:123], v[240:243], v[44:47]
    v_mfma_f32_16x16x32_bf16 v[44:47], a[124:127], v[248:251], v[44:47]
    s_nop 7
    v_cvt_pk_bf16_f32 v48, v32, v33
    v_cvt_pk_bf16_f32 v49, v34, v35
    v_cvt_pk_bf16_f32 v50, v40, v41
    v_cvt_pk_bf16_f32 v51, v42, v43
    s_nop 1
    v_permlane32_swap_b32 v48, v50
    v_permlane32_swap_b32 v49, v51
    s_mov_b32 s54, 8192
    buffer_store_dwordx4 v[48:51], v10, s[40:43], s54 offen offset:512 sc1
    v_cvt_pk_bf16_f32 v52, v36, v37
    v_cvt_pk_bf16_f32 v53, v38, v39
    v_cvt_pk_bf16_f32 v54, v44, v45
    v_cvt_pk_bf16_f32 v55, v46, v47
    s_nop 1
    v_permlane32_swap_b32 v52, v54
    v_permlane32_swap_b32 v53, v55
    s_mov_b32 s54, 303104
    buffer_store_dwordx4 v[52:55], v10, s[40:43], s54 offen offset:512 sc1
    buffer_load_dword v9, v6, s[84:87], s47 offen sc1
    s_movk_i32 s45, 4608
    buffer_load_dwordx4 v[76:79], v5, s[84:87], s45 offen sc1
    s_movk_i32 s45, 18432
    buffer_load_dwordx4 v[88:91], v5, s[84:87], s45 offen sc1
    s_movk_i32 s45, 8704
    buffer_load_dwordx4 v[80:83], v5, s[84:87], s45 offen sc1
    s_movk_i32 s45, 22528
    buffer_load_dwordx4 v[92:95], v5, s[84:87], s45 offen sc1
    s_movk_i32 s45, 12800
    buffer_load_dwordx4 v[84:87], v59, s[84:87], s45 offen sc1
    s_movk_i32 s45, 26624
    buffer_load_dwordx4 v[96:99], v59, s[84:87], s45 offen sc1
    buffer_load_dwordx4 v[224:227], v12, s[36:39], 0 offen offset:0
    buffer_load_dwordx4 v[232:235], v12, s[36:39], 0 offen offset:512
    buffer_load_dwordx4 v[240:243], v13, s[36:39], 0 offen offset:1024
    buffer_load_dwordx4 v[64:67], v1, s[76:79], 0 offen offset:0
    buffer_load_dwordx4 v[68:71], v1, s[76:79], 0 offen offset:512
    buffer_load_dwordx4 v[72:75], v2, s[76:79], 0 offen offset:0
    s_waitcnt vmcnt(13)
    buffer_store_dword v3, v15, s[84:87], s56 offen sc1
    s_movk_i32 s48, 0x1111
    v_lshrrev_b32 v15, 4, v0
    v_mul_u32_u24 v15, 9216, v15
    v_add_u32 v15, 4096, v15
    v_add_u32 v7, v59, v15
    s_waitcnt vmcnt(13)
    v_cmp_ne_u32 vcc, 0, v9
    s_nop 0
    s_lshr_b32 s3, vcc_lo, 1
    s_and_b32 s3, s3, vcc_lo
    s_lshr_b32 s14, s3, 2
    s_and_b32 s3, s3, s14
    s_and_b32 s3, s3, s48
    s_cbranch_scc0 L2_g0s
L2_g0r:
    s_ff1_i32_b32 s3, s3
    s_bitset0_b32 s48, s3
    s_mul_i32 s46, s3, 9216
    buffer_load_dword v9, v6, s[84:87], s47 offen sc1
    buffer_load_dwordx4 v[112:115], v7, s[88:91], s46 offen sc1
    buffer_load_dwordx4 v[116:119], v5, s[88:91], s46 offen sc1
    buffer_load_dwordx4 v[120:123], v5, s[28:31], s46 offen sc1
    s_add_u32 s46, s46, 9216
    buffer_load_dwordx4 v[124:127], v5, s[88:91], s46 offen sc1
    buffer_load_dwordx4 v[128:131], v5, s[28:31], s46 offen sc1
    s_add_u32 s46, s46, 9216
    buffer_load_dwordx4 v[132:135], v5, s[88:91], s46 offen sc1
    buffer_load_dwordx4 v[136:139], v5, s[28:31], s46 offen sc1
    s_add_u32 s46, s46, 9216
    buffer_load_dwordx4 v[140:143], v5, s[88:91], s46 offen sc1
    buffer_load_dwordx4 v[144:147], v5, s[28:31], s46 offen sc1
    s_waitcnt vmcnt(11)
    v_mov_b32 v14, v13
    v_max_u32 v13, v76, v77
    v_max3_u32 v13, v13, v78, v79
    v_max3_u32 v13, v13, v88, v89
    v_max3_u32 v13, v13, v90, v91
    v_max3_u32 v13, v13, v80, v81
    v_max3_u32 v13, v13, v82, v83
    v_max3_u32 v13, v13, v92, v93
    v_max3_u32 v13, v13, v94, v95
    v_max3_u32 v13, v13, v84, v85
    v_max3_u32 v13, v13, v86, v87
    v_max3_u32 v13, v13, v96, v97
    v_max3_u32 v13, v13, v98, v99
    v_cmp_eq_u32 vcc, -1, v13
    s_nop 0
    s_cmp_lg_u64 vcc, 0
    s_cbranch_scc1 L2_pns
L2_pnr:
    v_pk_add_f32 v[76:77], v[76:77], v[88:89]
    v_pk_add_f32 v[78:79], v[78:79], v[90:91]
    ds_write_b128 v5, v[76:79] offset:0
    v_pk_add_f32 v[80:81], v[80:81], v[92:93]
    v_pk_add_f32 v[82:83], v[82:83], v[94:95]
    ds_write_b128 v5, v[80:83] offset:4096
    v_pk_add_f32 v[84:85], v[84:85], v[96:97]
    v_pk_add_f32 v[86:87], v[86:87], v[98:99]
    ds_write_b128 v59, v[84:87] offset:8192
    s_waitcnt lgkmcnt(0)
    s_barrier
    s_add_u32 s14, s55, 16384
    v_add_u32 v105, s14, v8
    v_add_u32 v106, 73728, v105
    v_lshlrev_b32 v3, 1, v12
    v_lshlrev_b32 v4, 1, v14
    ds_read_b128 v[76:79], v3 offset:4608
    ds_read_b128 v[80:83], v3 offset:4624
    ds_read_b128 v[84:87], v3 offset:5632
    ds_read_b128 v[88:91], v3 offset:5648
    ds_read_b128 v[92:95], v4 offset:6656
    ds_read_b128 v[96:99], v4 offset:6672
    ds_read_b128 v[40:43], v3 offset:2304
    ds_read_b128 v[44:47], v3 offset:2320
    ds_read_b128 v[48:51], v3 offset:3328
    ds_read_b128 v[52:55], v3 offset:3344
    ds_read_b128 v[56:59], v4 offset:4352
    ds_read_b128 v[60:63], v4 offset:4368
    s_waitcnt vmcnt(9)
    v_cmp_ne_u32 vcc, 0, v9
    s_nop 0
    s_lshr_b32 s3, vcc_lo, 1
    s_and_b32 s3, s3, vcc_lo
    s_lshr_b32 s14, s3, 2
    s_and_b32 s3, s3, s14
    s_and_b32 s3, s3, s48
    s_cbranch_scc0 L2_g1s
L2_g1r:
    s_ff1_i32_b32 s3, s3
    s_bitset0_b32 s48, s3
    s_mul_i32 s46, s3, 9216
    buffer_load_dword v9, v6, s[84:87], s47 offen sc1
    buffer_load_dwordx4 v[148:151], v7, s[88:91], s46 offen sc1
    ds_write_b128 v106, a[20:23] offset:36864
    ds_write_b128 v106, a[24:27] offset:37888
    s_waitcnt lgkmcnt(2)
    v_lshlrev_b32 v12, 16, v224
    v_and_b32 v13, 0xffff0000, v224
    v_pk_mul_f32 v[76:77], v[76:77], v[12:13]
    v_pk_mul_f32 v[40:41], v[40:41], v[12:13]
    v_lshlrev_b32 v14, 16, v225
    v_and_b32 v15, 0xffff0000, v225
    v_pk_mul_f32 v[78:79], v[78:79], v[14:15]
    v_pk_mul_f32 v[42:43], v[42:43], v[14:15]
    v_lshlrev_b32 v12, 16, v226
    v_and_b32 v13, 0xffff0000, v226
    v_pk_mul_f32 v[80:81], v[80:81], v[12:13]
    v_pk_mul_f32 v[44:45], v[44:45], v[12:13]
    v_lshlrev_b32 v14, 16, v227
    v_and_b32 v15, 0xffff0000, v227
    v_pk_mul_f32 v[82:83], v[82:83], v[14:15]
    v_pk_mul_f32 v[46:47], v[46:47], v[14:15]
    v_lshlrev_b32 v12, 16, v232
    v_and_b32 v13, 0xffff0000, v232
    v_pk_mul_f32 v[84:85], v[84:85], v[12:13]
    v_pk_mul_f32 v[48:49], v[48:49], v[12:13]
    v_lshlrev_b32 v14, 16, v233
    v_and_b32 v15, 0xffff0000, v233
    v_pk_mul_f32 v[86:87], v[86:87], v[14:15]
    v_pk_mul_f32 v[50:51], v[50:51], v[14:15]
    buffer_load_dwordx4 v[152:155], v5, s[88:91], s46 offen sc1
    buffer_load_dwordx4 v[156:159], v5, s[28:31], s46 offen sc1
    ds_write_b128 v106, a[28:31] offset:38912
    ds_write_b128 v106, a[32:35] offset:39936
    v_lshlrev_b32 v12, 16, v234
    v_and_b32 v13, 0xffff0000, v234
    v_pk_mul_f32 v[88:89], v[88:89], v[12:13]
    v_pk_mul_f32 v[52:53], v[52:53], v[12:13]
    v_lshlrev_b32 v14, 16, v235
    v_and_b32 v15, 0xffff0000, v235
    v_pk_mul_f32 v[90:91], v[90:91], v[14:15]
    v_pk_mul_f32 v[54:55], v[54:55], v[14:15]
    v_lshlrev_b32 v12, 16, v240
    v_and_b32 v13, 0xffff0000, v240
    v_pk_mul_f32 v[92:93], v[92:93], v[12:13]
    v_pk_mul_f32 v[56:57], v[56:57], v[12:13]
    v_lshlrev_b32 v14, 16, v241
    v_and_b32 v15, 0xffff0000, v241
    v_pk_mul_f32 v[94:95], v[94:95], v[14:15]
    v_pk_mul_f32 v[58:59], v[58:59], v[14:15]
    v_lshlrev_b32 v12, 16, v242
    v_and_b32 v13, 0xffff0000, v242
    v_pk_mul_f32 v[96:97], v[96:97], v[12:13]
    v_pk_mul_f32 v[60:61], v[60:61], v[12:13]
    v_lshlrev_b32 v14, 16, v243
    v_and_b32 v15, 0xffff0000, v243
    v_pk_mul_f32 v[98:99], v[98:99], v[14:15]
    v_pk_mul_f32 v[62:63], v[62:63], v[14:15]
    s_add_u32 s46, s46, 9216
    buffer_load_dwordx4 v[160:163], v5, s[88:91], s46 offen sc1
    buffer_load_dwordx4 v[164:167], v5, s[28:31], s46 offen sc1
    ds_write_b128 v106, a[36:39] offset:40960
    ds_write_b128 v106, a[40:43] offset:41984
    v_pk_add_f32 v[12:13], v[76:77], v[78:79]
    v_pk_add_f32 v[12:13], v[12:13], v[80:81]
    v_pk_add_f32 v[12:13], v[12:13], v[82:83]
    v_pk_add_f32 v[12:13], v[12:13], v[84:85]
    v_pk_add_f32 v[12:13], v[12:13], v[86:87]
    v_pk_add_f32 v[12:13], v[12:13], v[88:89]
    v_pk_add_f32 v[12:13], v[12:13], v[90:91]
    v_pk_add_f32 v[14:15], v[92:93], v[94:95]
    v_pk_add_f32 v[14:15], v[14:15], v[96:97]
    v_pk_add_f32 v[14:15], v[14:15], v[98:99]
    v_add_f32 v100, v12, v13
    v_add_f32 v14, v14, v15
    v_fmac_f32 v100, 0x3e800000, v14
    v_pk_add_f32 v[12:13], v[40:41], v[42:43]
    v_pk_add_f32 v[12:13], v[12:13], v[44:45]
    v_pk_add_f32 v[12:13], v[12:13], v[46:47]
    v_pk_add_f32 v[12:13], v[12:13], v[48:49]
    v_pk_add_f32 v[12:13], v[12:13], v[50:51]
    v_pk_add_f32 v[12:13], v[12:13], v[52:53]
    v_pk_add_f32 v[12:13], v[12:13], v[54:55]
    v_pk_add_f32 v[14:15], v[56:57], v[58:59]
    v_pk_add_f32 v[14:15], v[14:15], v[60:61]
    v_pk_add_f32 v[14:15], v[14:15], v[62:63]
    v_add_f32 v101, v12, v13
    v_add_f32 v14, v14, v15
    v_fmac_f32 v101, 0x3e800000, v14
    ds_read_b128 v[40:43], v3 offset:0
    ds_read_b128 v[44:47], v3 offset:16
    ds_read_b128 v[48:51], v3 offset:1024
    ds_read_b128 v[52:55], v3 offset:1040
    ds_read_b128 v[56:59], v4 offset:2048
    ds_read_b128 v[60:63], v4 offset:2064
    s_add_u32 s46, s46, 9216
    buffer_load_dwordx4 v[168:171], v5, s[88:91], s46 offen sc1
    buffer_load_dwordx4 v[172:175], v5, s[28:31], s46 offen sc1
    ds_write_b128 v106, a[44:47] offset:43008
    ds_write_b128 v106, a[48:51] offset:44032
    s_nop 1
    v_add_f32_dpp v100, v100, v100 row_ror:8 row_mask:0xf bank_mask:0xf
    v_add_f32_dpp v101, v101, v101 row_ror:8 row_mask:0xf bank_mask:0xf
    v_mov_b32 v102, v100
    v_mov_b32 v103, v101
    s_nop 0
    v_permlane16_swap_b32 v102, v100
    v_permlane16_swap_b32 v103, v101
    v_add_f32 v100, v100, v102
    v_add_f32 v101, v101, v103
    v_mov_b32 v102, v100
    v_mov_b32 v103, v101
    s_nop 0
    v_permlane32_swap_b32 v102, v100
    v_permlane32_swap_b32 v103, v101
    v_add_f32 v100, v100, v102
    v_add_f32 v101, v101, v103
    v_and_b32 v14, 7, v0
    v_lshlrev_b32 v11, 4, v14
    v_add_u32 v11, 14080, v11
    s_lshl_b32 s3, s51, 2
    v_add_u32 v10, s3, v11
    ds_write_b32 v10, v100 offset:384
    ds_write_b32 v10, v101 offset:512
    v_lshl_add_u32 v1, v14, 4, v1
    v_lshl_add_u32 v2, v14, 4, v2
    v_add_u32 v1, 90112, v1
    v_add_u32 v2, 90112, v2
    s_and_b32 s14, s51, 1
    s_mul_i32 s14, s14, 9344
    s_add_u32 s14, s14, 90112
    v_add_u32 v107, s14, v8
    v_lshrrev_b32 v15, 3, v0
    v_mul_u32_u24 v12, 1024, v15
    v_add_u32 v109, v12, v8
    v_lshl_add_u32 v12, v15, 4, v12
    v_add_u32 v108, v12, v107
    s_mul_i32 s3, s96, 9216
    s_cmp_eq_u32 s51, 3
    s_cselect_b32 s3, 0, s3
    s_cselect_b64 s[24:25], s[32:33], s[80:81]
    s_add_u32 s24, s24, s3
    s_addc_u32 s25, s25, 0
    s_mov_b32 s26, 9216
    s_mov_b32 s27, 0x20000
    s_add_u32 s46, s46, 9216
    buffer_load_dwordx4 v[176:179], v5, s[88:91], s46 offen sc1
    buffer_load_dwordx4 v[180:183], v5, s[28:31], s46 offen sc1
    ds_write_b128 v106, a[52:55] offset:45056
    ds_write_b128 v105, a[128:131] offset:0
    s_waitcnt lgkmcnt(2)
    s_waitcnt vmcnt(18)
    ds_write_b128 v105, a[132:135] offset:1024
    ds_write_b128 v105, a[136:139] offset:2048
    v_lshlrev_b32 v32, 16, v112
    v_and_b32 v33, 0xffff0000, v112
    v_lshlrev_b32 v34, 16, v113
    v_and_b32 v35, 0xffff0000, v113
    v_lshlrev_b32 v36, 16, v114
    v_and_b32 v37, 0xffff0000, v114
    v_lshlrev_b32 v38, 16, v115
    v_and_b32 v39, 0xffff0000, v115
    s_waitcnt vmcnt(17)
    ds_write_b128 v105, a[140:143] offset:3072
    ds_write_b128 v105, a[144:147] offset:4096
    v_lshlrev_b32 v24, 16, v116
    v_and_b32 v25, 0xffff0000, v116
    v_lshlrev_b32 v26, 16, v117
    v_and_b32 v27, 0xffff0000, v117
    v_lshlrev_b32 v28, 16, v118
    v_and_b32 v29, 0xffff0000, v118
    v_lshlrev_b32 v30, 16, v119
    v_and_b32 v31, 0xffff0000, v119
    s_waitcnt vmcnt(16)
    v_lshlrev_b32 v16, 16, v120
    v_and_b32 v17, 0xffff0000, v120
    v_lshlrev_b32 v18, 16, v121
    v_and_b32 v19, 0xffff0000, v121
    v_lshlrev_b32 v20, 16, v122
    v_and_b32 v21, 0xffff0000, v122
    v_lshlrev_b32 v22, 16, v123
    v_and_b32 v23, 0xffff0000, v123
    s_waitcnt vmcnt(15)
    ds_write_b128 v105, a[148:151] offset:5120
    ds_write_b128 v105, a[152:155] offset:6144
    v_lshlrev_b32 v100, 16, v124
    v_and_b32 v101, 0xffff0000, v124
    v_pk_add_f32 v[24:25], v[24:25], v[100:101]
    v_lshlrev_b32 v102, 16, v125
    v_and_b32 v103, 0xffff0000, v125
    v_pk_add_f32 v[26:27], v[26:27], v[102:103]
    v_lshlrev_b32 v100, 16, v126
    v_and_b32 v101, 0xffff0000, v126
    v_pk_add_f32 v[28:29], v[28:29], v[100:101]
    v_lshlrev_b32 v102, 16, v127
    v_and_b32 v103, 0xffff0000, v127
    v_pk_add_f32 v[30:31], v[30:31], v[102:103]
    s_waitcnt vmcnt(14)
    v_lshlrev_b32 v100, 16, v128
    v_and_b32 v101, 0xffff0000, v128
    v_pk_add_f32 v[16:17], v[16:17], v[100:101]
    v_lshlrev_b32 v102, 16, v129
    v_and_b32 v103, 0xffff0000, v129
    v_pk_add_f32 v[18:19], v[18:19], v[102:103]
    v_lshlrev_b32 v100, 16, v130
    v_and_b32 v101, 0xffff0000, v130
    v_pk_add_f32 v[20:21], v[20:21], v[100:101]
    v_lshlrev_b32 v102, 16, v131
    v_and_b32 v103, 0xffff0000, v131
    v_pk_add_f32 v[22:23], v[22:23], v[102:103]
    s_waitcnt vmcnt(13)
    ds_write_b128 v105, a[156:159] offset:7168
    ds_write_b128 v105, a[160:163] offset:8192
    v_lshlrev_b32 v100, 16, v132
    v_and_b32 v101, 0xffff0000, v132
    v_pk_add_f32 v[24:25], v[24:25], v[100:101]
    v_lshlrev_b32 v102, 16, v133
    v_and_b32 v103, 0xffff0000, v133
    v_pk_add_f32 v[26:27], v[26:27], v[102:103]
    v_lshlrev_b32 v100, 16, v134
    v_and_b32 v101, 0xffff0000, v134
    v_pk_add_f32 v[28:29], v[28:29], v[100:101]
    v_lshlrev_b32 v102, 16, v135
    v_and_b32 v103, 0xffff0000, v135
    v_pk_add_f32 v[30:31], v[30:31], v[102:103]
    s_waitcnt vmcnt(12)
    v_lshlrev_b32 v100, 16, v136
    v_and_b32 v101, 0xffff0000, v136
    v_pk_add_f32 v[16:17], v[16:17], v[100:101]
    v_lshlrev_b32 v102, 16, v137
    v_and_b32 v103, 0xffff0000, v137
    v_pk_add_f32 v[18:19], v[18:19], v[102:103]
    v_lshlrev_b32 v100, 16, v138
    v_and_b32 v101, 0xffff0000, v138
    v_pk_add_f32 v[20:21], v[20:21], v[100:101]
    v_lshlrev_b32 v102, 16, v139
    v_and_b32 v103, 0xffff0000, v139
    v_pk_add_f32 v[22:23], v[22:23], v[102:103]
    s_waitcnt vmcnt(11)
    ds_write_b128 v105, a[164:167] offset:36864
    ds_write_b128 v105, a[168:171] offset:37888
    v_lshlrev_b32 v100, 16, v140
    v_and_b32 v101, 0xffff0000, v140
    v_pk_add_f32 v[24:25], v[24:25], v[100:101]
    v_lshlrev_b32 v102, 16, v141
    v_and_b32 v103, 0xffff0000, v141
    v_pk_add_f32 v[26:27], v[26:27], v[102:103]
    v_lshlrev_b32 v100, 16, v142
    v_and_b32 v101, 0xffff0000, v142
    v_pk_add_f32 v[28:29], v[28:29], v[100:101]
    v_lshlrev_b32 v102, 16, v143
    v_and_b32 v103, 0xffff0000, v143
    v_pk_add_f32 v[30:31], v[30:31], v[102:103]
    s_waitcnt vmcnt(10)
    v_lshlrev_b32 v100, 16, v144
    v_and_b32 v101, 0xffff0000, v144
    v_pk_add_f32 v[16:17], v[16:17], v[100:101]
    v_lshlrev_b32 v102, 16, v145
    v_and_b32 v103, 0xffff0000, v145
    v_pk_add_f32 v[18:19], v[18:19], v[102:103]
    v_lshlrev_b32 v100, 16, v146
    v_and_b32 v101, 0xffff0000, v146
    v_pk_add_f32 v[20:21], v[20:21], v[100:101]
    v_lshlrev_b32 v102, 16, v147
    v_and_b32 v103, 0xffff0000, v147
    v_pk_add_f32 v[22:23], v[22:23], v[102:103]
    s_waitcnt vmcnt(8)
    ds_write_b128 v105, a[172:175] offset:38912
    ds_write_b128 v105, a[176:179] offset:39936
    v_lshlrev_b32 v100, 16, v148
    v_and_b32 v101, 0xffff0000, v148
    v_pk_add_f32 v[32:33], v[32:33], v[100:101]
    v_lshlrev_b32 v102, 16, v149
    v_and_b32 v103, 0xffff0000, v149
    v_pk_add_f32 v[34:35], v[34:35], v[102:103]
    v_lshlrev_b32 v100, 16, v150
    v_and_b32 v101, 0xffff0000, v150
    v_pk_add_f32 v[36:37], v[36:37], v[100:101]
    v_lshlrev_b32 v102, 16, v151
    v_and_b32 v103, 0xffff0000, v151
    v_pk_add_f32 v[38:39], v[38:39], v[102:103]
    s_waitcnt vmcnt(7)
    ds_write_b128 v105, a[180:183] offset:40960
    ds_write_b128 v105, a[184:187] offset:41984
    v_lshlrev_b32 v100, 16, v152
    v_and_b32 v101, 0xffff0000, v152
    v_pk_add_f32 v[24:25], v[24:25], v[100:101]
    v_lshlrev_b32 v102, 16, v153
    v_and_b32 v103, 0xffff0000, v153
    v_pk_add_f32 v[26:27], v[26:27], v[102:103]
    v_lshlrev_b32 v100, 16, v154
    v_and_b32 v101, 0xffff0000, v154
    v_pk_add_f32 v[28:29], v[28:29], v[100:101]
    v_lshlrev_b32 v102, 16, v155
    v_and_b32 v103, 0xffff0000, v155
    v_pk_add_f32 v[30:31], v[30:31], v[102:103]
    s_waitcnt vmcnt(6)
    v_lshlrev_b32 v100, 16, v156
    v_and_b32 v101, 0xffff0000, v156
    v_pk_add_f32 v[16:17], v[16:17], v[100:101]
    v_lshlrev_b32 v102, 16, v157
    v_and_b32 v103, 0xffff0000, v157
    v_pk_add_f32 v[18:19], v[18:19], v[102:103]
    v_lshlrev_b32 v100, 16, v158
    v_and_b32 v101, 0xffff0000, v158
    v_pk_add_f32 v[20:21], v[20:21], v[100:101]
    v_lshlrev_b32 v102, 16, v159
    v_and_b32 v103, 0xffff0000, v159
    v_pk_add_f32 v[22:23], v[22:23], v[102:103]
    s_waitcnt vmcnt(5)
    v_cmp_ne_u32 vcc, 0, v9
    s_nop 0
    s_lshr_b32 s3, vcc_lo, 1
    s_and_b32 s3, s3, vcc_lo
    s_lshr_b32 s14, s3, 2
    s_and_b32 s3, s3, s14
    s_and_b32 s3, s3, s48
    s_cbranch_scc0 L2_g2s
L2_g2r:
    s_ff1_i32_b32 s3, s3
    s_bitset0_b32 s48, s3
    s_mul_i32 s46, s3, 9216
    buffer_load_dword v9, v6, s[84:87], s47 offen sc1
    buffer_load_dwordx4 v[184:187], v7, s[88:91], s46 offen sc1
    ds_write_b128 v105, a[188:191] offset:43008
    ds_write_b128 v105, a[192:195] offset:44032
    v_lshlrev_b32 v100, 16, v160
    v_and_b32 v101, 0xffff0000, v160
    v_pk_add_f32 v[24:25], v[24:25], v[100:101]
    v_lshlrev_b32 v102, 16, v161
    v_and_b32 v103, 0xffff0000, v161
    v_pk_add_f32 v[26:27], v[26:27], v[102:103]
    v_lshlrev_b32 v100, 16, v162
    v_and_b32 v101, 0xffff0000, v162
    v_pk_add_f32 v[28:29], v[28:29], v[100:101]
    v_lshlrev_b32 v102, 16, v163
    v_and_b32 v103, 0xffff0000, v163
    v_pk_add_f32 v[30:31], v[30:31], v[102:103]
    s_waitcnt vmcnt(6)
    v_lshlrev_b32 v100, 16, v164
    v_and_b32 v101, 0xffff0000, v164
    v_pk_add_f32 v[16:17], v[16:17], v[100:101]
    v_lshlrev_b32 v102, 16, v165
    v_and_b32 v103, 0xffff0000, v165
    v_pk_add_f32 v[18:19], v[18:19], v[102:103]
    v_lshlrev_b32 v100, 16, v166
    v_and_b32 v101, 0xffff0000, v166
    v_pk_add_f32 v[20:21], v[20:21], v[100:101]
    v_lshlrev_b32 v102, 16, v167
    v_and_b32 v103, 0xffff0000, v167
    v_pk_add_f32 v[22:23], v[22:23], v[102:103]
    s_waitcnt vmcnt(5)
    buffer_load_dwordx4 v[188:191], v5, s[88:91], s46 offen sc1
    buffer_load_dwordx4 v[192:195], v5, s[28:31], s46 offen sc1
    ds_write_b128 v105, a[196:199] offset:45056
    v_lshlrev_b32 v100, 16, v168
    v_and_b32 v101, 0xffff0000, v168
    v_pk_add_f32 v[24:25], v[24:25], v[100:101]
    v_lshlrev_b32 v102, 16, v169
    v_and_b32 v103, 0xffff0000, v169
    v_pk_add_f32 v[26:27], v[26:27], v[102:103]
    v_lshlrev_b32 v100, 16, v170
    v_and_b32 v101, 0xffff0000, v170
    v_pk_add_f32 v[28:29], v[28:29], v[100:101]
    v_lshlrev_b32 v102, 16, v171
    v_and_b32 v103, 0xffff0000, v171
    v_pk_add_f32 v[30:31], v[30:31], v[102:103]
    s_waitcnt vmcnt(6)
    v_lshlrev_b32 v100, 16, v172
    v_and_b32 v101, 0xffff0000, v172
    v_pk_add_f32 v[16:17], v[16:17], v[100:101]
    v_lshlrev_b32 v102, 16, v173
    v_and_b32 v103, 0xffff0000, v173
    v_pk_add_f32 v[18:19], v[18:19], v[102:103]
    v_lshlrev_b32 v100, 16, v174
    v_and_b32 v101, 0xffff0000, v174
    v_pk_add_f32 v[20:21], v[20:21], v[100:101]
    v_lshlrev_b32 v102, 16, v175
    v_and_b32 v103, 0xffff0000, v175
    v_pk_add_f32 v[22:23], v[22:23], v[102:103]
    s_waitcnt vmcnt(5)
    s_add_u32 s46, s46, 9216
    buffer_load_dwordx4 v[196:199], v5, s[88:91], s46 offen sc1
    buffer_load_dwordx4 v[200:203], v5, s[28:31], s46 offen sc1
    v_lshlrev_b32 v100, 16, v176
    v_and_b32 v101, 0xffff0000, v176
    v_pk_add_f32 v[24:25], v[24:25], v[100:101]
    v_lshlrev_b32 v102, 16, v177
    v_and_b32 v103, 0xffff0000, v177
    v_pk_add_f32 v[26:27], v[26:27], v[102:103]
    v_lshlrev_b32 v100, 16, v178
    v_and_b32 v101, 0xffff0000, v178
    v_pk_add_f32 v[28:29], v[28:29], v[100:101]
    v_lshlrev_b32 v102, 16, v179
    v_and_b32 v103, 0xffff0000, v179
    v_pk_add_f32 v[30:31], v[30:31], v[102:103]
    s_waitcnt vmcnt(6)
    v_lshlrev_b32 v100, 16, v180
    v_and_b32 v101, 0xffff0000, v180
    v_pk_add_f32 v[16:17], v[16:17], v[100:101]
    v_lshlrev_b32 v102, 16, v181
    v_and_b32 v103, 0xffff0000, v181
    v_pk_add_f32 v[18:19], v[18:19], v[102:103]
    v_lshlrev_b32 v100, 16, v182
    v_and_b32 v101, 0xffff0000, v182
    v_pk_add_f32 v[20:21], v[20:21], v[100:101]
    v_lshlrev_b32 v102, 16, v183
    v_and_b32 v103, 0xffff0000, v183
    v_pk_add_f32 v[22:23], v[22:23], v[102:103]
    s_waitcnt vmcnt(4)
    s_add_u32 s46, s46, 9216
    buffer_load_dwordx4 v[204:207], v5, s[88:91], s46 offen sc1
    buffer_load_dwordx4 v[208:211], v5, s[28:31], s46 offen sc1
    v_lshlrev_b32 v100, 16, v184
L2_pad13:
    s_cbranch_execz L2_walkret
    v_and_b32 v101, 0xffff0000, v184
    v_pk_add_f32 v[32:33], v[32:33], v[100:101]
    v_lshlrev_b32 v102, 16, v185
    v_and_b32 v103, 0xffff0000, v185
    v_pk_add_f32 v[34:35], v[34:35], v[102:103]
    v_lshlrev_b32 v100, 16, v186
    v_and_b32 v101, 0xffff0000, v186
    v_pk_add_f32 v[36:37], v[36:37], v[100:101]
    v_lshlrev_b32 v102, 16, v187
    v_and_b32 v103, 0xffff0000, v187
    v_pk_add_f32 v[38:39], v[38:39], v[102:103]
    v_lshrrev_b32 v12, 4, v0
    v_bfe_u32 v13, v0, 2, 2
    v_lshl_add_u32 v12, v12, 3, v13
    v_and_b32 v13, 3, v0
    v_lshlrev_b32 v14, 6, v12
    v_lshl_add_u32 v14, v13, 3, v14
    s_cmp_lt_u32 s51, 2
    s_cselect_b32 s3, 110592, 0
    s_and_b32 s14, s51, 1
    s_lshl_b32 s14, s14, 5
    s_add_u32 s3, s3, s14
    s_add_u32 s3, s3, 16384
    v_add_u32 v105, s3, v14
    v_mul_u32_u24 v14, 1152, v12
    v_lshl_add_u32 v14, v13, 3, v14
    s_mul_i32 s3, s51, 288
    s_add_u32 s3, s3, 53248
    v_add_u32 v106, s3, v14
    ds_read_b128 v[112:115], v3 offset:4608
    ds_read_b128 v[116:119], v3 offset:4624
    ds_read_b128 v[120:123], v3 offset:5632
    ds_read_b128 v[124:127], v3 offset:5648
    ds_read_b128 v[128:131], v4 offset:6656
    ds_read_b128 v[132:135], v4 offset:6672
    ds_read_b128 v[136:139], v3 offset:2304
    ds_read_b128 v[140:143], v3 offset:2320
    ds_read_b128 v[144:147], v3 offset:3328
    ds_read_b128 v[148:151], v3 offset:3344
    ds_read_b128 v[152:155], v4 offset:4352
    ds_read_b128 v[156:159], v4 offset:4368
    ds_read_b128 v[160:163], v3 offset:6912
    ds_read_b128 v[164:167], v3 offset:6928
    ds_read_b128 v[168:171], v3 offset:7936
    ds_read_b128 v[172:175], v3 offset:7952
    ds_read_b128 v[176:179], v4 offset:8960
    ds_read_b128 v[180:183], v4 offset:8976
    s_waitcnt vmcnt(5)
    s_add_u32 s46, s46, 9216
    buffer_load_dwordx4 v[212:215], v5, s[88:91], s46 offen sc1
    buffer_load_dwordx4 v[216:219], v5, s[28:31], s46 offen sc1
    v_lshlrev_b32 v100, 16, v188
    v_and_b32 v101, 0xffff0000, v188
    v_pk_add_f32 v[24:25], v[24:25], v[100:101]
    v_lshlrev_b32 v102, 16, v189
    v_and_b32 v103, 0xffff0000, v189
    v_pk_add_f32 v[26:27], v[26:27], v[102:103]
    v_lshlrev_b32 v100, 16, v190
    v_and_b32 v101, 0xffff0000, v190
    v_pk_add_f32 v[28:29], v[28:29], v[100:101]
    v_lshlrev_b32 v102, 16, v191
    v_and_b32 v103, 0xffff0000, v191
    v_pk_add_f32 v[30:31], v[30:31], v[102:103]
    s_waitcnt vmcnt(6)
    v_lshlrev_b32 v100, 16, v192
    v_and_b32 v101, 0xffff0000, v192
    v_pk_add_f32 v[16:17], v[16:17], v[100:101]
    v_lshlrev_b32 v102, 16, v193
    v_and_b32 v103, 0xffff0000, v193
    v_pk_add_f32 v[18:19], v[18:19], v[102:103]
    v_lshlrev_b32 v100, 16, v194
    v_and_b32 v101, 0xffff0000, v194
    v_pk_add_f32 v[20:21], v[20:21], v[100:101]
    v_lshlrev_b32 v102, 16, v195
    v_and_b32 v103, 0xffff0000, v195
    v_pk_add_f32 v[22:23], v[22:23], v[102:103]
    s_waitcnt vmcnt(5)
    v_cmp_ne_u32 vcc, 0, v9
    s_nop 0
    s_lshr_b32 s3, vcc_lo, 1
    s_and_b32 s3, s3, vcc_lo
    s_lshr_b32 s14, s3, 2
    s_and_b32 s3, s3, s14
    s_and_b32 s3, s3, s48
    s_cbranch_scc0 L2_g3s
L2_g3r:
    s_ff1_i32_b32 s3, s3
    s_bitset0_b32 s48, s3
    s_mul_i32 s46, s3, 9216
    buffer_load_dwordx4 v[220:223], v7, s[88:91], s46 offen sc1
    v_lshlrev_b32 v100, 16, v196
    v_and_b32 v101, 0xffff0000, v196
    v_pk_add_f32 v[24:25], v[24:25], v[100:101]
    v_lshlrev_b32 v102, 16, v197
    v_and_b32 v103, 0xffff0000, v197
    v_pk_add_f32 v[26:27], v[26:27], v[102:103]
    v_lshlrev_b32 v100, 16, v198
    v_and_b32 v101, 0xffff0000, v198
    v_pk_add_f32 v[28:29], v[28:29], v[100:101]
    v_lshlrev_b32 v102, 16, v199
    v_and_b32 v103, 0xffff0000, v199
    v_pk_add_f32 v[30:31], v[30:31], v[102:103]
    s_waitcnt vmcnt(5)
    v_lshlrev_b32 v100, 16, v200
    v_and_b32 v101, 0xffff0000, v200
    v_pk_add_f32 v[16:17], v[16:17], v[100:101]
    v_lshlrev_b32 v102, 16, v201
    v_and_b32 v103, 0xffff0000, v201
    v_pk_add_f32 v[18:19], v[18:19], v[102:103]
    v_lshlrev_b32 v100, 16, v202
    v_and_b32 v101, 0xffff0000, v202
    v_pk_add_f32 v[20:21], v[20:21], v[100:101]
    v_lshlrev_b32 v102, 16, v203
    v_and_b32 v103, 0xffff0000, v203
    v_pk_add_f32 v[22:23], v[22:23], v[102:103]
    s_waitcnt vmcnt(4)
    buffer_load_dwordx4 v[224:227], v5, s[88:91], s46 offen sc1
    buffer_load_dwordx4 v[228:231], v5, s[28:31], s46 offen sc1
    v_lshlrev_b32 v100, 16, v204
    v_and_b32 v101, 0xffff0000, v204
    v_pk_add_f32 v[24:25], v[24:25], v[100:101]
    v_lshlrev_b32 v102, 16, v205
    v_and_b32 v103, 0xffff0000, v205
    v_pk_add_f32 v[26:27], v[26:27], v[102:103]
    v_lshlrev_b32 v100, 16, v206
    v_and_b32 v101, 0xffff0000, v206
    v_pk_add_f32 v[28:29], v[28:29], v[100:101]
    v_lshlrev_b32 v102, 16, v207
    v_and_b32 v103, 0xffff0000, v207
    v_pk_add_f32 v[30:31], v[30:31], v[102:103]
    s_waitcnt vmcnt(5)
    v_lshlrev_b32 v100, 16, v208
    v_and_b32 v101, 0xffff0000, v208
    v_pk_add_f32 v[16:17], v[16:17], v[100:101]
    v_lshlrev_b32 v102, 16, v209
    v_and_b32 v103, 0xffff0000, v209
    v_pk_add_f32 v[18:19], v[18:19], v[102:103]
    v_lshlrev_b32 v100, 16, v210
    v_and_b32 v101, 0xffff0000, v210
    v_pk_add_f32 v[20:21], v[20:21], v[100:101]
    v_lshlrev_b32 v102, 16, v211
    v_and_b32 v103, 0xffff0000, v211
    v_pk_add_f32 v[22:23], v[22:23], v[102:103]
    s_waitcnt vmcnt(4)
    s_add_u32 s46, s46, 9216
    buffer_load_dwordx4 v[232:235], v5, s[88:91], s46 offen sc1
    buffer_load_dwordx4 v[236:239], v5, s[28:31], s46 offen sc1
    v_lshlrev_b32 v100, 16, v212
    v_and_b32 v101, 0xffff0000, v212
    v_pk_add_f32 v[24:25], v[24:25], v[100:101]
    v_lshlrev_b32 v102, 16, v213
    v_and_b32 v103, 0xffff0000, v213
    v_pk_add_f32 v[26:27], v[26:27], v[102:103]
    v_lshlrev_b32 v100, 16, v214
    v_and_b32 v101, 0xffff0000, v214
    v_pk_add_f32 v[28:29], v[28:29], v[100:101]
    v_lshlrev_b32 v102, 16, v215
    v_and_b32 v103, 0xffff0000, v215
    v_pk_add_f32 v[30:31], v[30:31], v[102:103]
    s_waitcnt vmcnt(5)
    v_lshlrev_b32 v100, 16, v216
    v_and_b32 v101, 0xffff0000, v216
    v_pk_add_f32 v[16:17], v[16:17], v[100:101]
    v_lshlrev_b32 v102, 16, v217
    v_and_b32 v103, 0xffff0000, v217
    v_pk_add_f32 v[18:19], v[18:19], v[102:103]
    v_lshlrev_b32 v100, 16, v218
    v_and_b32 v101, 0xffff0000, v218
    v_pk_add_f32 v[20:21], v[20:21], v[100:101]
    v_lshlrev_b32 v102, 16, v219
    v_and_b32 v103, 0xffff0000, v219
    v_pk_add_f32 v[22:23], v[22:23], v[102:103]
    s_waitcnt vmcnt(4)
    s_add_u32 s46, s46, 9216
    buffer_load_dwordx4 v[240:243], v5, s[88:91], s46 offen sc1
    buffer_load_dwordx4 v[244:247], v5, s[28:31], s46 offen sc1
    v_lshlrev_b32 v100, 16, v220
    v_and_b32 v101, 0xffff0000, v220
    v_pk_add_f32 v[32:33], v[32:33], v[100:101]
    v_lshlrev_b32 v102, 16, v221
    v_and_b32 v103, 0xffff0000, v221
    v_pk_add_f32 v[34:35], v[34:35], v[102:103]
    v_lshlrev_b32 v100, 16, v222
    v_and_b32 v101, 0xffff0000, v222
    v_pk_add_f32 v[36:37], v[36:37], v[100:101]
    v_lshlrev_b32 v102, 16, v223
    v_and_b32 v103, 0xffff0000, v223
    v_pk_add_f32 v[38:39], v[38:39], v[102:103]
    s_lshl_b32 s3, s96, 3
    s_sub_u32 s3, 0xfff, s3
    v_and_b32 v6, 7, v0
    v_sub_u32 v6, s3, v6
    s_mov_b32 s57, 0xfffff000
    s_mul_i32 s58, s96, 128
    s_add_u32 s58, s58, 6815744
    s_xor_b32 s3, s51, 2
    v_or_b32 v9, s3, v0
    v_min_u32 v9, 1, v9
    v_lshlrev_b32 v9, 30, v9
    v_mov_b32 v208, v32
    v_mov_b32 v209, v33
    v_mov_b32 v210, v34
    v_mov_b32 v211, v35
    v_mov_b32 v212, v36
    v_mov_b32 v213, v37
    v_mov_b32 v214, v38
    v_mov_b32 v215, v39
    v_permlane16_swap_b32 v208, v32
    v_permlane16_swap_b32 v209, v33
    v_permlane16_swap_b32 v210, v34
    v_permlane16_swap_b32 v211, v35
    v_permlane16_swap_b32 v212, v36
    v_permlane16_swap_b32 v213, v37
    v_permlane16_swap_b32 v214, v38
    v_permlane16_swap_b32 v215, v39
    v_add_f32 v32, v32, v208
    v_add_f32 v33, v33, v209
    v_add_f32 v34, v34, v210
    v_add_f32 v35, v35, v211
    v_add_f32 v36, v36, v212
    v_add_f32 v37, v37, v213
    v_add_f32 v38, v38, v214
    v_add_f32 v39, v39, v215
    v_mov_b32 v208, v32
    v_mov_b32 v209, v33
    v_mov_b32 v210, v34
    v_mov_b32 v211, v35
    v_mov_b32 v212, v36
    v_mov_b32 v213, v37
    v_mov_b32 v214, v38
    v_mov_b32 v215, v39
    v_permlane32_swap_b32 v208, v32
    v_permlane32_swap_b32 v209, v33
    v_permlane32_swap_b32 v210, v34
    v_permlane32_swap_b32 v211, v35
    v_permlane32_swap_b32 v212, v36
    v_permlane32_swap_b32 v213, v37
    v_permlane32_swap_b32 v214, v38
    v_permlane32_swap_b32 v215, v39
    v_add_f32 v32, v32, v208
    v_add_f32 v33, v33, v209
    v_add_f32 v34, v34, v210
    v_add_f32 v35, v35, v211
    v_add_f32 v36, v36, v212
    v_add_f32 v37, v37, v213
    v_add_f32 v38, v38, v214
    v_add_f32 v39, v39, v215
    v_lshlrev_b32 v184, 16, v64
    v_and_b32 v185, 0xffff0000, v64
    v_lshlrev_b32 v186, 16, v65
    v_and_b32 v187, 0xffff0000, v65
    v_lshlrev_b32 v188, 16, v66
    v_and_b32 v189, 0xffff0000, v66
    v_lshlrev_b32 v190, 16, v67
    v_and_b32 v191, 0xffff0000, v67
    v_lshlrev_b32 v192, 16, v68
    v_and_b32 v193, 0xffff0000, v68
    v_lshlrev_b32 v194, 16, v69
    v_and_b32 v195, 0xffff0000, v69
    v_lshlrev_b32 v196, 16, v70
    v_and_b32 v197, 0xffff0000, v70
    v_lshlrev_b32 v198, 16, v71
    v_and_b32 v199, 0xffff0000, v71
    v_lshlrev_b32 v200, 16, v72
    v_and_b32 v201, 0xffff0000, v72
    v_lshlrev_b32 v202, 16, v73
    v_and_b32 v203, 0xffff0000, v73
    v_lshlrev_b32 v204, 16, v74
    v_and_b32 v205, 0xffff0000, v74
    v_lshlrev_b32 v206, 16, v75
    v_and_b32 v207, 0xffff0000, v75
    s_cmp_lt_u32 s2, 180
    s_cselect_b32 s3, 2, 0
    s_cmp_lt_u32 s51, s3
    s_cselect_b32 s3, 0, 0x40000000
    v_mul_u32_u24 v68, 128, v0
    v_or_b32 v68, s3, v68
    s_mul_i32 s15, s51, 16384
    s_add_u32 s15, s15, 6815744
    s_add_u32 s59, s15, 8192
    s_lshl_b32 s3, s51, 7
    s_sub_u32 s3, s96, s3
    v_cmp_eq_u32 s[60:61], s3, v0
    s_sub_u32 s3, s3, 64
    v_cmp_eq_u32 s[62:63], s3, v0
    s_waitcnt vmcnt(5)
    s_add_u32 s46, s46, 9216
    buffer_load_dwordx4 v[248:251], v5, s[88:91], s46 offen sc1
    buffer_load_dwordx4 v[252:255], v5, s[28:31], s46 offen sc1
    v_lshlrev_b32 v100, 16, v224
    v_and_b32 v101, 0xffff0000, v224
    v_pk_add_f32 v[24:25], v[24:25], v[100:101]
    v_lshlrev_b32 v102, 16, v225
    v_and_b32 v103, 0xffff0000, v225
    v_pk_add_f32 v[26:27], v[26:27], v[102:103]
    v_lshlrev_b32 v100, 16, v226
    v_and_b32 v101, 0xffff0000, v226
    v_pk_add_f32 v[28:29], v[28:29], v[100:101]
    v_lshlrev_b32 v102, 16, v227
    v_and_b32 v103, 0xffff0000, v227
    v_pk_add_f32 v[30:31], v[30:31], v[102:103]
    s_waitcnt vmcnt(6)
    v_lshlrev_b32 v100, 16, v228
    v_and_b32 v101, 0xffff0000, v228
    v_pk_add_f32 v[16:17], v[16:17], v[100:101]
    v_lshlrev_b32 v102, 16, v229
    v_and_b32 v103, 0xffff0000, v229
    v_pk_add_f32 v[18:19], v[18:19], v[102:103]
    v_lshlrev_b32 v100, 16, v230
    v_and_b32 v101, 0xffff0000, v230
    v_pk_add_f32 v[20:21], v[20:21], v[100:101]
    v_lshlrev_b32 v102, 16, v231
    v_and_b32 v103, 0xffff0000, v231
    v_pk_add_f32 v[22:23], v[22:23], v[102:103]
    s_waitcnt vmcnt(5)
    v_lshlrev_b32 v100, 16, v232
    v_and_b32 v101, 0xffff0000, v232
    v_pk_add_f32 v[24:25], v[24:25], v[100:101]
    v_lshlrev_b32 v102, 16, v233
    v_and_b32 v103, 0xffff0000, v233
    v_pk_add_f32 v[26:27], v[26:27], v[102:103]
    v_lshlrev_b32 v100, 16, v234
    v_and_b32 v101, 0xffff0000, v234
    v_pk_add_f32 v[28:29], v[28:29], v[100:101]
    v_lshlrev_b32 v102, 16, v235
    v_and_b32 v103, 0xffff0000, v235
    v_pk_add_f32 v[30:31], v[30:31], v[102:103]
    s_waitcnt vmcnt(4)
    v_lshlrev_b32 v100, 16, v236
    v_and_b32 v101, 0xffff0000, v236
    v_pk_add_f32 v[16:17], v[16:17], v[100:101]
    v_lshlrev_b32 v102, 16, v237
    v_and_b32 v103, 0xffff0000, v237
    v_pk_add_f32 v[18:19], v[18:19], v[102:103]
    v_lshlrev_b32 v100, 16, v238
    v_and_b32 v101, 0xffff0000, v238
    v_pk_add_f32 v[20:21], v[20:21], v[100:101]
    v_lshlrev_b32 v102, 16, v239
    v_and_b32 v103, 0xffff0000, v239
    v_pk_add_f32 v[22:23], v[22:23], v[102:103]
    s_waitcnt vmcnt(3)
    v_lshlrev_b32 v100, 16, v240
    v_and_b32 v101, 0xffff0000, v240
    v_pk_add_f32 v[24:25], v[24:25], v[100:101]
    v_lshlrev_b32 v102, 16, v241
    v_and_b32 v103, 0xffff0000, v241
    v_pk_add_f32 v[26:27], v[26:27], v[102:103]
    v_lshlrev_b32 v100, 16, v242
    v_and_b32 v101, 0xffff0000, v242
    v_pk_add_f32 v[28:29], v[28:29], v[100:101]
    v_lshlrev_b32 v102, 16, v243
    v_and_b32 v103, 0xffff0000, v243
    v_pk_add_f32 v[30:31], v[30:31], v[102:103]
    s_waitcnt vmcnt(2)
    v_lshlrev_b32 v100, 16, v244
    v_and_b32 v101, 0xffff0000, v244
    v_pk_add_f32 v[16:17], v[16:17], v[100:101]
    v_lshlrev_b32 v102, 16, v245
    v_and_b32 v103, 0xffff0000, v245
    v_pk_add_f32 v[18:19], v[18:19], v[102:103]
    v_lshlrev_b32 v100, 16, v246
    v_and_b32 v101, 0xffff0000, v246
    v_pk_add_f32 v[20:21], v[20:21], v[100:101]
    v_lshlrev_b32 v102, 16, v247
    v_and_b32 v103, 0xffff0000, v247
    v_pk_add_f32 v[22:23], v[22:23], v[102:103]
    s_waitcnt vmcnt(1)
    v_lshlrev_b32 v100, 16, v248
    v_and_b32 v101, 0xffff0000, v248
    v_pk_add_f32 v[24:25], v[24:25], v[100:101]
    v_lshlrev_b32 v102, 16, v249
    v_and_b32 v103, 0xffff0000, v249
    v_pk_add_f32 v[26:27], v[26:27], v[102:103]
    v_lshlrev_b32 v100, 16, v250
    v_and_b32 v101, 0xffff0000, v250
    v_pk_add_f32 v[28:29], v[28:29], v[100:101]
    v_lshlrev_b32 v102, 16, v251
    v_and_b32 v103, 0xffff0000, v251
    v_pk_add_f32 v[30:31], v[30:31], v[102:103]
    s_waitcnt vmcnt(0)
    v_lshlrev_b32 v100, 16, v252
    v_and_b32 v101, 0xffff0000, v252
    v_pk_add_f32 v[16:17], v[16:17], v[100:101]
    v_lshlrev_b32 v102, 16, v253
    v_and_b32 v103, 0xffff0000, v253
    v_pk_add_f32 v[18:19], v[18:19], v[102:103]
    v_lshlrev_b32 v100, 16, v254
    v_and_b32 v101, 0xffff0000, v254
    v_pk_add_f32 v[20:21], v[20:21], v[100:101]
    v_lshlrev_b32 v102, 16, v255
    v_and_b32 v103, 0xffff0000, v255
    v_pk_add_f32 v[22:23], v[22:23], v[102:103]
    v_pk_fma_f32 v[16:17], v[16:17], v[40:41], v[184:185]
    v_pk_fma_f32 v[18:19], v[18:19], v[42:43], v[186:187]
    v_pk_fma_f32 v[20:21], v[20:21], v[44:45], v[188:189]
    v_pk_fma_f32 v[22:23], v[22:23], v[46:47], v[190:191]
    v_pk_fma_f32 v[24:25], v[24:25], v[48:49], v[192:193]
    v_pk_fma_f32 v[26:27], v[26:27], v[50:51], v[194:195]
    v_pk_fma_f32 v[28:29], v[28:29], v[52:53], v[196:197]
    v_pk_fma_f32 v[30:31], v[30:31], v[54:55], v[198:199]
    v_pk_fma_f32 v[32:33], v[32:33], v[56:57], v[200:201]
    v_pk_fma_f32 v[34:35], v[34:35], v[58:59], v[202:203]
    v_pk_fma_f32 v[36:37], v[36:37], v[60:61], v[204:205]
    v_pk_fma_f32 v[38:39], v[38:39], v[62:63], v[206:207]
    v_pk_add_f32 v[12:13], v[16:17], v[18:19]
    v_pk_add_f32 v[12:13], v[12:13], v[20:21]
    v_pk_add_f32 v[12:13], v[12:13], v[22:23]
    v_pk_add_f32 v[12:13], v[12:13], v[24:25]
    v_pk_add_f32 v[12:13], v[12:13], v[26:27]
    v_pk_add_f32 v[12:13], v[12:13], v[28:29]
    v_pk_add_f32 v[12:13], v[12:13], v[30:31]
    v_pk_add_f32 v[14:15], v[32:33], v[34:35]
    v_pk_add_f32 v[14:15], v[14:15], v[36:37]
    v_pk_add_f32 v[14:15], v[14:15], v[38:39]
    v_add_f32 v100, v12, v13
    v_add_f32 v14, v14, v15
    v_fmac_f32 v100, 0x3e800000, v14
    s_nop 1
    v_add_f32_dpp v100, v100, v100 row_ror:8 row_mask:0xf bank_mask:0xf
    v_mov_b32 v103, v100
    s_nop 1
    v_permlane16_swap_b32 v103, v100
    v_add_f32 v100, v100, v103
    v_mov_b32 v103, v100
    s_nop 1
    v_permlane32_swap_b32 v103, v100
    v_add_f32 v100, v100, v103
    v_mul_f32 v100, 0x3be38e39, v100
    v_pk_add_f32 v[184:185], v[16:17], v[100:101] op_sel_hi:[1,0] neg_lo:[0,1] neg_hi:[0,1]
    v_pk_add_f32 v[186:187], v[18:19], v[100:101] op_sel_hi:[1,0] neg_lo:[0,1] neg_hi:[0,1]
    v_pk_add_f32 v[188:189], v[20:21], v[100:101] op_sel_hi:[1,0] neg_lo:[0,1] neg_hi:[0,1]
    v_pk_add_f32 v[190:191], v[22:23], v[100:101] op_sel_hi:[1,0] neg_lo:[0,1] neg_hi:[0,1]
    v_pk_add_f32 v[192:193], v[24:25], v[100:101] op_sel_hi:[1,0] neg_lo:[0,1] neg_hi:[0,1]
    v_pk_add_f32 v[194:195], v[26:27], v[100:101] op_sel_hi:[1,0] neg_lo:[0,1] neg_hi:[0,1]
    v_pk_add_f32 v[196:197], v[28:29], v[100:101] op_sel_hi:[1,0] neg_lo:[0,1] neg_hi:[0,1]
    v_pk_add_f32 v[198:199], v[30:31], v[100:101] op_sel_hi:[1,0] neg_lo:[0,1] neg_hi:[0,1]
    v_pk_add_f32 v[200:201], v[32:33], v[100:101] op_sel_hi:[1,0] neg_lo:[0,1] neg_hi:[0,1]
    v_pk_add_f32 v[202:203], v[34:35], v[100:101] op_sel_hi:[1,0] neg_lo:[0,1] neg_hi:[0,1]
    v_pk_add_f32 v[204:205], v[36:37], v[100:101] op_sel_hi:[1,0] neg_lo:[0,1] neg_hi:[0,1]
    v_pk_add_f32 v[206:207], v[38:39], v[100:101] op_sel_hi:[1,0] neg_lo:[0,1] neg_hi:[0,1]
    v_pk_mul_f32 v[12:13], v[184:185], v[184:185]
    v_pk_fma_f32 v[12:13], v[186:187], v[186:187], v[12:13]
    v_pk_fma_f32 v[12:13], v[188:189], v[188:189], v[12:13]
    v_pk_fma_f32 v[12:13], v[190:191], v[190:191], v[12:13]
    v_pk_fma_f32 v[12:13], v[192:193], v[192:193], v[12:13]
    v_pk_fma_f32 v[12:13], v[194:195], v[194:195], v[12:13]
    v_pk_fma_f32 v[12:13], v[196:197], v[196:197], v[12:13]
    v_pk_fma_f32 v[12:13], v[198:199], v[198:199], v[12:13]
    v_pk_mul_f32 v[14:15], v[200:201], v[200:201]
    v_pk_fma_f32 v[14:15], v[202:203], v[202:203], v[14:15]
    v_pk_fma_f32 v[14:15], v[204:205], v[204:205], v[14:15]
    v_pk_fma_f32 v[14:15], v[206:207], v[206:207], v[14:15]
    v_add_f32 v101, v12, v13
    v_add_f32 v14, v14, v15
    v_fmac_f32 v101, 0x3e800000, v14
    v_pk_mul_f32 v[12:13], v[184:185], v[76:77]
    v_pk_fma_f32 v[12:13], v[186:187], v[78:79], v[12:13]
    v_pk_fma_f32 v[12:13], v[188:189], v[80:81], v[12:13]
    v_pk_fma_f32 v[12:13], v[190:191], v[82:83], v[12:13]
    v_pk_fma_f32 v[12:13], v[192:193], v[84:85], v[12:13]
    v_pk_fma_f32 v[12:13], v[194:195], v[86:87], v[12:13]
    v_pk_fma_f32 v[12:13], v[196:197], v[88:89], v[12:13]
    v_pk_fma_f32 v[12:13], v[198:199], v[90:91], v[12:13]
    v_pk_mul_f32 v[14:15], v[200:201], v[92:93]
    v_pk_fma_f32 v[14:15], v[202:203], v[94:95], v[14:15]
    v_pk_fma_f32 v[14:15], v[204:205], v[96:97], v[14:15]
    v_pk_fma_f32 v[14:15], v[206:207], v[98:99], v[14:15]
    v_add_f32 v102, v12, v13
    v_add_f32 v14, v14, v15
    v_fmac_f32 v102, 0x3e800000, v14
    s_nop 1
    v_add_f32_dpp v101, v101, v101 row_ror:8 row_mask:0xf bank_mask:0xf
    v_add_f32_dpp v102, v102, v102 row_ror:8 row_mask:0xf bank_mask:0xf
    v_mov_b32 v103, v101
    v_mov_b32 v104, v102
    s_nop 0
    v_permlane16_swap_b32 v103, v101
    v_permlane16_swap_b32 v104, v102
    v_add_f32 v101, v101, v103
    v_add_f32 v102, v102, v104
    v_mov_b32 v103, v101
    v_mov_b32 v104, v102
    s_nop 0
    v_permlane32_swap_b32 v103, v101
    v_permlane32_swap_b32 v104, v102
    v_add_f32 v101, v101, v103
    v_add_f32 v102, v102, v104
    ds_write_b32 v10, v100 offset:0
    ds_write_b32 v10, v101 offset:128
    ds_write_b32 v10, v102 offset:256
    s_waitcnt lgkmcnt(0)
    s_barrier
    ds_read_b128 v[40:43], v11 offset:0
    ds_read_b128 v[44:47], v11 offset:128
    ds_read_b128 v[48:51], v11 offset:256
    ds_read_b128 v[52:55], v11 offset:384
    ds_read_b128 v[56:59], v11 offset:512
    s_waitcnt lgkmcnt(4)
    v_add_f32 v12, v40, v41
    v_add_f32 v13, v42, v43
    v_add_f32 v12, v12, v13
    v_mul_f32 v12, 0x3e800000, v12
    v_sub_f32 v40, v40, v12
    v_sub_f32 v41, v41, v12
    v_sub_f32 v42, v42, v12
    v_sub_f32 v43, v43, v12
    v_sub_f32 v100, v100, v12
    v_mul_f32 v13, v40, v40
    v_fmac_f32 v13, v41, v41
    v_fmac_f32 v13, v42, v42
    v_fmac_f32 v13, v43, v43
    s_waitcnt lgkmcnt(3)
    v_add_f32 v14, v44, v45
    v_add_f32 v15, v46, v47
    v_add_f32 v14, v14, v15
    v_fmac_f32 v14, 0x43100000, v13
    v_mov_b32 v13, 0x3727c5ac
    v_fmac_f32 v13, 0x3ae38e39, v14
    v_rsq_f32 v13, v13
    s_waitcnt lgkmcnt(0)
    v_pk_fma_f32 v[48:49], v[40:41], v[52:53], v[48:49]
    v_pk_fma_f32 v[50:51], v[42:43], v[54:55], v[50:51]
    v_pk_add_f32 v[48:49], v[48:49], v[50:51]
    v_pk_add_f32 v[56:57], v[56:57], v[58:59]
    v_add_f32 v14, v48, v49
    v_add_f32 v15, v56, v57
    v_fmac_f32 v15, v14, v13
    v_ashrrev_i32 v12, 31, v15
    v_or_b32 v12, 0x80000000, v12
    v_xor_b32 v12, v12, v15
    v_and_or_b32 v44, v12, s57, v6
    v_mov_b32 v45, 0
    s_nop 1
    v_mov_b32_dpp v14, v44 row_ror:1 row_mask:0xf bank_mask:0xf
    v_mov_b32_dpp v15, v45 row_ror:1 row_mask:0xf bank_mask:0xf
    v_max_u32 v45, v45, v15
    v_med3_u32 v45, v44, v14, v45
    v_max_u32 v44, v44, v14
    s_nop 1
    v_mov_b32_dpp v14, v44 row_ror:2 row_mask:0xf bank_mask:0xf
    v_mov_b32_dpp v15, v45 row_ror:2 row_mask:0xf bank_mask:0xf
    v_max_u32 v45, v45, v15
    v_med3_u32 v45, v44, v14, v45
    v_max_u32 v44, v44, v14
    s_nop 1
    v_mov_b32_dpp v14, v44 row_ror:4 row_mask:0xf bank_mask:0xf
    v_mov_b32_dpp v15, v45 row_ror:4 row_mask:0xf bank_mask:0xf
    v_max_u32 v45, v45, v15
    v_med3_u32 v45, v44, v14, v45
    v_max_u32 v44, v44, v14
    buffer_store_dwordx2 v[44:45], v9, s[84:87], s58 offen offset:8 sc1
    v_mul_f32 v100, v100, v13
    v_pk_fma_f32 v[184:185], v[184:185], v[12:13], v[100:101] op_sel:[0,1,0] op_sel_hi:[1,1,0]
    v_pk_fma_f32 v[186:187], v[186:187], v[12:13], v[100:101] op_sel:[0,1,0] op_sel_hi:[1,1,0]
    v_pk_fma_f32 v[188:189], v[188:189], v[12:13], v[100:101] op_sel:[0,1,0] op_sel_hi:[1,1,0]
    v_pk_fma_f32 v[190:191], v[190:191], v[12:13], v[100:101] op_sel:[0,1,0] op_sel_hi:[1,1,0]
    v_pk_fma_f32 v[192:193], v[192:193], v[12:13], v[100:101] op_sel:[0,1,0] op_sel_hi:[1,1,0]
    v_pk_fma_f32 v[194:195], v[194:195], v[12:13], v[100:101] op_sel:[0,1,0] op_sel_hi:[1,1,0]
    v_pk_fma_f32 v[196:197], v[196:197], v[12:13], v[100:101] op_sel:[0,1,0] op_sel_hi:[1,1,0]
    v_pk_fma_f32 v[198:199], v[198:199], v[12:13], v[100:101] op_sel:[0,1,0] op_sel_hi:[1,1,0]
    v_pk_fma_f32 v[200:201], v[200:201], v[12:13], v[100:101] op_sel:[0,1,0] op_sel_hi:[1,1,0]
    v_pk_fma_f32 v[202:203], v[202:203], v[12:13], v[100:101] op_sel:[0,1,0] op_sel_hi:[1,1,0]
    v_pk_fma_f32 v[204:205], v[204:205], v[12:13], v[100:101] op_sel:[0,1,0] op_sel_hi:[1,1,0]
    v_pk_fma_f32 v[206:207], v[206:207], v[12:13], v[100:101] op_sel:[0,1,0] op_sel_hi:[1,1,0]
    v_pk_fma_f32 v[184:185], v[184:185], v[112:113], v[136:137]
    v_pk_fma_f32 v[186:187], v[186:187], v[114:115], v[138:139]
    v_pk_fma_f32 v[188:189], v[188:189], v[116:117], v[140:141]
    v_pk_fma_f32 v[190:191], v[190:191], v[118:119], v[142:143]
    v_pk_fma_f32 v[192:193], v[192:193], v[120:121], v[144:145]
    v_pk_fma_f32 v[194:195], v[194:195], v[122:123], v[146:147]
    v_pk_fma_f32 v[196:197], v[196:197], v[124:125], v[148:149]
    v_pk_fma_f32 v[198:199], v[198:199], v[126:127], v[150:151]
    v_pk_fma_f32 v[200:201], v[200:201], v[128:129], v[152:153]
    v_pk_fma_f32 v[202:203], v[202:203], v[130:131], v[154:155]
    v_pk_fma_f32 v[204:205], v[204:205], v[132:133], v[156:157]
    v_pk_fma_f32 v[206:207], v[206:207], v[134:135], v[158:159]
    v_cvt_pk_bf16_f32 v124, v184, v185
    v_cvt_pk_bf16_f32 v125, v186, v187
    v_cvt_pk_bf16_f32 v126, v188, v189
    v_cvt_pk_bf16_f32 v127, v190, v191
    v_min_u32 v124, -2, v124
    v_min_u32 v125, -2, v125
    v_min_u32 v126, -2, v126
    v_min_u32 v127, -2, v127
    ds_write_b128 v1, v[124:127] offset:9344
    v_cvt_pk_bf16_f32 v128, v192, v193
    v_cvt_pk_bf16_f32 v129, v194, v195
    v_cvt_pk_bf16_f32 v130, v196, v197
    v_cvt_pk_bf16_f32 v131, v198, v199
    v_min_u32 v128, -2, v128
    v_min_u32 v129, -2, v129
    v_min_u32 v130, -2, v130
    v_min_u32 v131, -2, v131
    ds_write_b128 v1, v[128:131] offset:9856
    v_cvt_pk_bf16_f32 v132, v200, v201
    v_cvt_pk_bf16_f32 v133, v202, v203
    v_cvt_pk_bf16_f32 v134, v204, v205
    v_cvt_pk_bf16_f32 v135, v206, v207
    v_min_u32 v132, -2, v132
    v_min_u32 v133, -2, v133
    v_min_u32 v134, -2, v134
    v_min_u32 v135, -2, v135
    ds_write_b128 v2, v[132:135] offset:9344
    v_pk_fma_f32 v[16:17], v[184:185], v[160:161], v[16:17]
    v_pk_fma_f32 v[18:19], v[186:187], v[162:163], v[18:19]
    v_pk_fma_f32 v[20:21], v[188:189], v[164:165], v[20:21]
    v_pk_fma_f32 v[22:23], v[190:191], v[166:167], v[22:23]
    v_pk_fma_f32 v[24:25], v[192:193], v[168:169], v[24:25]
    v_pk_fma_f32 v[26:27], v[194:195], v[170:171], v[26:27]
    v_pk_fma_f32 v[28:29], v[196:197], v[172:173], v[28:29]
    v_pk_fma_f32 v[30:31], v[198:199], v[174:175], v[30:31]
    v_pk_fma_f32 v[32:33], v[200:201], v[176:177], v[32:33]
    v_pk_fma_f32 v[34:35], v[202:203], v[178:179], v[34:35]
    v_pk_fma_f32 v[36:37], v[204:205], v[180:181], v[36:37]
    v_pk_fma_f32 v[38:39], v[206:207], v[182:183], v[38:39]
    v_cvt_pk_bf16_f32 v112, v16, v17
    v_cvt_pk_bf16_f32 v113, v18, v19
    v_cvt_pk_bf16_f32 v114, v20, v21
    v_cvt_pk_bf16_f32 v115, v22, v23
    ds_write_b128 v1, v[112:115] offset:0
    v_cvt_pk_bf16_f32 v116, v24, v25
    v_cvt_pk_bf16_f32 v117, v26, v27
    v_cvt_pk_bf16_f32 v118, v28, v29
    v_cvt_pk_bf16_f32 v119, v30, v31
    ds_write_b128 v1, v[116:119] offset:512
    v_cvt_pk_bf16_f32 v120, v32, v33
    v_cvt_pk_bf16_f32 v121, v34, v35
    v_cvt_pk_bf16_f32 v122, v36, v37
    v_cvt_pk_bf16_f32 v123, v38, v39
    ds_write_b128 v2, v[120:123] offset:0
    v_lshrrev_b32 v7, 4, v0
    v_and_b32 v6, 1, v0
    v_bfe_u32 v5, v0, 2, 2
    v_lshlrev_b32 v5, 6, v5
    v_lshl_add_u32 v5, v7, 4, v5
    v_mov_b32 v14, 15616
    s_waitcnt lgkmcnt(0)
    s_barrier
    s_cmp_lt_u32 s51, 2
    s_cbranch_scc1 L2_keys
    ds_read_b128 v[136:139], v107 offset:0
    ds_read_b128 v[140:143], v107 offset:1168
    ds_read_b128 v[144:147], v107 offset:2336
    ds_read_b128 v[148:151], v107 offset:3504
    ds_read_b128 v[152:155], v107 offset:4672
    ds_read_b128 v[156:159], v107 offset:5840
L2_pad14:
    s_cbranch_execz L2_walkret
    ds_read_b128 v[160:163], v107 offset:7008
    ds_read_b128 v[164:167], v107 offset:8176
    ds_read_b128 v[168:171], v108 offset:1024
    s_movk_i32 s3, 0
    s_waitcnt lgkmcnt(8)
    buffer_store_dwordx4 v[136:139], v8, s[24:27], s3 offen offset:0 sc1
    s_waitcnt lgkmcnt(7)
    buffer_store_dwordx4 v[140:143], v8, s[24:27], s3 offen offset:1152 sc1
    s_waitcnt lgkmcnt(6)
    buffer_store_dwordx4 v[144:147], v8, s[24:27], s3 offen offset:2304 sc1
    s_waitcnt lgkmcnt(5)
    buffer_store_dwordx4 v[148:151], v8, s[24:27], s3 offen offset:3456 sc1
    s_movk_i32 s3, 4608
    s_waitcnt lgkmcnt(4)
    buffer_store_dwordx4 v[152:155], v8, s[24:27], s3 offen offset:0 sc1
    s_waitcnt lgkmcnt(3)
    buffer_store_dwordx4 v[156:159], v8, s[24:27], s3 offen offset:1152 sc1
    s_waitcnt lgkmcnt(2)
    buffer_store_dwordx4 v[160:163], v8, s[24:27], s3 offen offset:2304 sc1
    s_waitcnt lgkmcnt(1)
    buffer_store_dwordx4 v[164:167], v8, s[24:27], s3 offen offset:3456 sc1
    s_waitcnt lgkmcnt(0)
    buffer_store_dwordx4 v[168:171], v109, s[24:27], 0 offen offset:1024 sc1
    ds_read_b64_tr_b16 a[64:65], v105 offset:0
    ds_read_b64_tr_b16 a[66:67], v105 offset:256
    ds_read_b64_tr_b16 a[68:69], v105 offset:2048
    ds_read_b64_tr_b16 a[70:71], v105 offset:2304
    ds_read_b64_tr_b16 a[72:73], v105 offset:4096
    ds_read_b64_tr_b16 a[74:75], v105 offset:4352
    ds_read_b64_tr_b16 a[76:77], v105 offset:6144
    ds_read_b64_tr_b16 a[78:79], v105 offset:6400
    ds_read_b64_tr_b16 a[80:81], v105 offset:8192
    ds_read_b64_tr_b16 a[82:83], v105 offset:8448
    ds_read_b64_tr_b16 a[84:85], v105 offset:10240
    ds_read_b64_tr_b16 a[86:87], v105 offset:10496
    ds_read_b64_tr_b16 a[88:89], v105 offset:12288
    ds_read_b64_tr_b16 a[90:91], v105 offset:12544
    ds_read_b64_tr_b16 a[92:93], v105 offset:14336
    ds_read_b64_tr_b16 a[94:95], v105 offset:14592
    ds_read_b64_tr_b16 a[96:97], v105 offset:16384
    ds_read_b64_tr_b16 a[98:99], v105 offset:16640
    ds_read_b64_tr_b16 a[100:101], v105 offset:18432
    ds_read_b64_tr_b16 a[102:103], v105 offset:18688
    ds_read_b64_tr_b16 a[104:105], v105 offset:20480
    ds_read_b64_tr_b16 a[106:107], v105 offset:20736
    ds_read_b64_tr_b16 a[108:109], v105 offset:22528
    ds_read_b64_tr_b16 a[110:111], v105 offset:22784
    ds_read_b64_tr_b16 a[112:113], v105 offset:24576
    ds_read_b64_tr_b16 a[114:115], v105 offset:24832
    ds_read_b64_tr_b16 a[116:117], v105 offset:26624
    ds_read_b64_tr_b16 a[118:119], v105 offset:26880
    ds_read_b64_tr_b16 a[120:121], v105 offset:28672
    ds_read_b64_tr_b16 a[122:123], v105 offset:28928
    ds_read_b64_tr_b16 a[124:125], v105 offset:30720
    ds_read_b64_tr_b16 a[126:127], v105 offset:30976
    ds_read_b64_tr_b16 a[128:129], v105 offset:32768
    ds_read_b64_tr_b16 a[130:131], v105 offset:33024
    ds_read_b64_tr_b16 a[132:133], v105 offset:34816
    ds_read_b64_tr_b16 a[134:135], v105 offset:35072
    ds_read_b64_tr_b16 a[136:137], v106 offset:0
    ds_read_b64_tr_b16 a[138:139], v106 offset:4608
    ds_read_b64_tr_b16 a[140:141], v106 offset:32
    ds_read_b64_tr_b16 a[142:143], v106 offset:4640
    ds_read_b64_tr_b16 a[144:145], v106 offset:64
    ds_read_b64_tr_b16 a[146:147], v106 offset:4672
    ds_read_b64_tr_b16 a[148:149], v106 offset:96
    ds_read_b64_tr_b16 a[150:151], v106 offset:4704
    ds_read_b64_tr_b16 a[152:153], v106 offset:128
    ds_read_b64_tr_b16 a[154:155], v106 offset:4736
    ds_read_b64_tr_b16 a[156:157], v106 offset:160
    ds_read_b64_tr_b16 a[158:159], v106 offset:4768
    ds_read_b64_tr_b16 a[160:161], v106 offset:192
    ds_read_b64_tr_b16 a[162:163], v106 offset:4800
    ds_read_b64_tr_b16 a[164:165], v106 offset:224
    ds_read_b64_tr_b16 a[166:167], v106 offset:4832
    ds_read_b64_tr_b16 a[168:169], v106 offset:256
    ds_read_b64_tr_b16 a[170:171], v106 offset:4864
    s_cmp_lt_u32 s2, 144
    s_cbranch_scc1 L2_join
    s_waitcnt vmcnt(0)
    buffer_store_dword v14, v9, s[84:87], s56 offen offset:128 sc1
    s_cmp_lt_u32 s2, 180
    s_cbranch_scc1 L2_join
    s_branch L2_fin
L2_keys:
    s_cmp_ge_u32 s2, 180
    s_cbranch_scc1 L2_fin
    buffer_load_dwordx2 v[64:65], v68, s[84:87], s15 offen offset:8 sc1
    buffer_load_dwordx2 v[66:67], v68, s[84:87], s59 offen offset:8 sc1
    ds_read_b64_tr_b16 a[64:65], v105 offset:0
    ds_read_b64_tr_b16 a[66:67], v105 offset:256
    ds_read_b64_tr_b16 a[68:69], v105 offset:2048
    ds_read_b64_tr_b16 a[70:71], v105 offset:2304
    ds_read_b64_tr_b16 a[72:73], v105 offset:4096
    ds_read_b64_tr_b16 a[74:75], v105 offset:4352
    ds_read_b64_tr_b16 a[76:77], v105 offset:6144
    ds_read_b64_tr_b16 a[78:79], v105 offset:6400
    ds_read_b64_tr_b16 a[80:81], v105 offset:8192
    ds_read_b64_tr_b16 a[82:83], v105 offset:8448
    ds_read_b64_tr_b16 a[84:85], v105 offset:10240
    ds_read_b64_tr_b16 a[86:87], v105 offset:10496
    ds_read_b64_tr_b16 a[88:89], v105 offset:12288
    ds_read_b64_tr_b16 a[90:91], v105 offset:12544
    ds_read_b64_tr_b16 a[92:93], v105 offset:14336
    ds_read_b64_tr_b16 a[94:95], v105 offset:14592
    ds_read_b64_tr_b16 a[96:97], v105 offset:16384
    ds_read_b64_tr_b16 a[98:99], v105 offset:16640
    ds_read_b64_tr_b16 a[100:101], v105 offset:18432
    ds_read_b64_tr_b16 a[102:103], v105 offset:18688
    ds_read_b64_tr_b16 a[104:105], v105 offset:20480
    ds_read_b64_tr_b16 a[106:107], v105 offset:20736
    ds_read_b64_tr_b16 a[108:109], v105 offset:22528
    ds_read_b64_tr_b16 a[110:111], v105 offset:22784
    ds_read_b64_tr_b16 a[112:113], v105 offset:24576
    ds_read_b64_tr_b16 a[114:115], v105 offset:24832
    ds_read_b64_tr_b16 a[116:117], v105 offset:26624
    ds_read_b64_tr_b16 a[118:119], v105 offset:26880
    ds_read_b64_tr_b16 a[120:121], v105 offset:28672
    ds_read_b64_tr_b16 a[122:123], v105 offset:28928
    ds_read_b64_tr_b16 a[124:125], v105 offset:30720
    ds_read_b64_tr_b16 a[126:127], v105 offset:30976
    ds_read_b64_tr_b16 a[128:129], v105 offset:32768
    ds_read_b64_tr_b16 a[130:131], v105 offset:33024
    ds_read_b64_tr_b16 a[132:133], v105 offset:34816
    ds_read_b64_tr_b16 a[134:135], v105 offset:35072
    ds_read_b64_tr_b16 a[136:137], v106 offset:0
    ds_read_b64_tr_b16 a[138:139], v106 offset:4608
    ds_read_b64_tr_b16 a[140:141], v106 offset:32
    ds_read_b64_tr_b16 a[142:143], v106 offset:4640
    ds_read_b64_tr_b16 a[144:145], v106 offset:64
    ds_read_b64_tr_b16 a[146:147], v106 offset:4672
    ds_read_b64_tr_b16 a[148:149], v106 offset:96
    ds_read_b64_tr_b16 a[150:151], v106 offset:4704
    ds_read_b64_tr_b16 a[152:153], v106 offset:128
    ds_read_b64_tr_b16 a[154:155], v106 offset:4736
    ds_read_b64_tr_b16 a[156:157], v106 offset:160
    ds_read_b64_tr_b16 a[158:159], v106 offset:4768
    ds_read_b64_tr_b16 a[160:161], v106 offset:192
    ds_read_b64_tr_b16 a[162:163], v106 offset:4800
    ds_read_b64_tr_b16 a[164:165], v106 offset:224
    ds_read_b64_tr_b16 a[166:167], v106 offset:4832
    ds_read_b64_tr_b16 a[168:169], v106 offset:256
    ds_read_b64_tr_b16 a[170:171], v106 offset:4864
    s_waitcnt vmcnt(0)
    v_cndmask_b32 v64, v64, v44, s[60:61]
    v_cndmask_b32 v65, v65, v45, s[60:61]
    v_cndmask_b32 v66, v66, v44, s[62:63]
    v_cndmask_b32 v67, v67, v45, s[62:63]
    v_min_u32 v12, v64, v65
    v_min_u32 v13, v66, v67
    v_cmp_eq_u32 s[4:5], 0, v12
    v_cmp_eq_u32 s[6:7], 0, v13
    s_nop 0
    s_or_b64 vcc, s[4:5], s[6:7]
    s_cbranch_scc0 L2_p2_ok
    s_mov_b32 s97, 0x20000
L2_p2:
    s_or_b64 exec, s[4:5], 1
    buffer_load_dwordx2 v[64:65], v68, s[84:87], s15 offen offset:8 sc1
    s_or_b64 exec, s[6:7], 1
    buffer_load_dwordx2 v[66:67], v68, s[84:87], s59 offen offset:8 sc1
    s_mov_b64 exec, -1
    s_waitcnt vmcnt(0)
    v_cndmask_b32 v64, v64, v44, s[60:61]
    v_cndmask_b32 v65, v65, v45, s[60:61]
    v_cndmask_b32 v66, v66, v44, s[62:63]
    v_cndmask_b32 v67, v67, v45, s[62:63]
    v_min_u32 v12, v64, v65
    v_min_u32 v13, v66, v67
    v_cmp_eq_u32 s[4:5], 0, v12
    v_cmp_eq_u32 s[6:7], 0, v13
    s_nop 0
    s_or_b64 vcc, s[4:5], s[6:7]
    s_sub_u32 s97, s97, 1
    s_cselect_b64 vcc, 0, vcc
    s_cmp_eq_u64 vcc, 0
    s_cbranch_scc1 L2_p2_ok
    s_sleep 1
    s_branch L2_p2
L2_p2_ok:
    v_max_u32 v65, v65, v67
    v_med3_u32 v65, v64, v66, v65
    v_max_u32 v64, v64, v66
    s_nop 1
    v_mov_b32_dpp v12, v64 row_ror:1 row_mask:0xf bank_mask:0xf
    v_mov_b32_dpp v13, v65 row_ror:1 row_mask:0xf bank_mask:0xf
    v_max_u32 v65, v65, v13
    v_med3_u32 v65, v64, v12, v65
    v_max_u32 v64, v64, v12
    s_nop 1
    v_mov_b32_dpp v12, v64 row_ror:2 row_mask:0xf bank_mask:0xf
    v_mov_b32_dpp v13, v65 row_ror:2 row_mask:0xf bank_mask:0xf
    v_max_u32 v65, v65, v13
    v_med3_u32 v65, v64, v12, v65
    v_max_u32 v64, v64, v12
    s_nop 1
    v_mov_b32_dpp v12, v64 row_ror:4 row_mask:0xf bank_mask:0xf
    v_mov_b32_dpp v13, v65 row_ror:4 row_mask:0xf bank_mask:0xf
    v_max_u32 v65, v65, v13
    v_med3_u32 v65, v64, v12, v65
    v_max_u32 v64, v64, v12
    s_nop 1
    v_mov_b32_dpp v12, v64 row_ror:8 row_mask:0xf bank_mask:0xf
    v_mov_b32_dpp v13, v65 row_ror:8 row_mask:0xf bank_mask:0xf
    v_max_u32 v65, v65, v13
    v_med3_u32 v65, v64, v12, v65
    v_max_u32 v64, v64, v12
    v_mov_b32 v12, v64
    v_mov_b32 v13, v65
    s_nop 0
    v_permlane16_swap_b32 v12, v64
    v_permlane16_swap_b32 v13, v65
    v_max_u32 v65, v65, v13
    v_med3_u32 v65, v64, v12, v65
    v_max_u32 v64, v64, v12
    v_mov_b32 v12, v64
    v_mov_b32 v13, v65
    s_nop 0
    v_permlane32_swap_b32 v12, v64
    v_permlane32_swap_b32 v13, v65
    v_max_u32 v65, v65, v13
    v_med3_u32 v65, v64, v12, v65
    v_max_u32 v64, v64, v12
    s_lshl3_add_u32 s3, s51, 15616
    v_mov_b32 v12, s3
    ds_write_b64 v12, v[64:65]
    s_waitcnt lgkmcnt(0)
L2_join:
    s_barrier
    ds_read_b128 v[16:19], v14
    v_cmp_eq_u32 vcc, 0, v6
    s_waitcnt lgkmcnt(0)
    v_max_u32 v17, v17, v19
    v_med3_u32 v17, v16, v18, v17
    v_max_u32 v16, v16, v18
    v_cndmask_b32 v16, v17, v16, vcc
    v_and_b32 v3, 0x7ff, v16
    v_sub_u32 v3, 2047, v3
    v_mul_u32_u24 v4, 1152, v3
    s_cmp_ge_u32 s2, 144
    s_cbranch_scc1 L2_red
    v_add_u32 v5, v5, v4
    s_mov_b32 s59, 4194304
    v_and_b32 v12, 8, v0
    v_lshlrev_b32 v12, 4, v12
    v_sub_u32 v3, v5, v12
    buffer_load_dwordx4 v[128:131], v5, s[84:87], s59 offen offset:0 sc1
    buffer_load_dwordx4 v[132:135], v5, s[84:87], s59 offen offset:256 sc1
    buffer_load_dwordx4 v[136:139], v5, s[84:87], s59 offen offset:512 sc1
    buffer_load_dwordx4 v[140:143], v5, s[84:87], s59 offen offset:768 sc1
    buffer_load_dwordx4 v[144:147], v3, s[84:87], s59 offen offset:1024 sc1
    v_lshlrev_b32 v11, 7, v6
    v_lshl_add_u32 v13, v7, 5, v11
    v_add_u32 v13, 14848, v13
    v_lshl_add_u32 v11, v7, 4, v11
    s_lshr_b32 s3, s51, 1
    s_lshl_b32 s3, s3, 8
    s_and_b32 s14, s51, 1
    s_lshl_b32 s14, s14, 6
    s_add_u32 s3, s3, s14
    s_add_u32 s3, s3, 14848
    v_add_u32 v11, s3, v11
    s_mul_i32 s14, s51, 1152
    s_mul_i32 s15, s2, 4608
    s_add_u32 s15, s15, s14
    s_add_u32 s15, s15, 98304
    v_lshlrev_b32 v10, 3, v0
    s_waitcnt vmcnt(0)
    buffer_store_dword v14, v9, s[84:87], s56 offen offset:128 sc1
L2_hr:
    v_mfma_f32_16x16x32_bf16 v[88:91], a[64:67], v[128:131], 0
    v_max_u32 v12, v128, v129
    v_mfma_f32_16x16x32_bf16 v[92:95], a[68:71], v[128:131], 0
    v_max3_u32 v12, v12, v130, v131
    v_mfma_f32_16x16x32_bf16 v[96:99], a[72:75], v[128:131], 0
    v_max3_u32 v12, v12, v132, v133
    v_mfma_f32_16x16x32_bf16 v[100:103], a[76:79], v[128:131], 0
    v_max3_u32 v12, v12, v134, v135
    v_mfma_f32_16x16x32_bf16 v[88:91], a[80:83], v[132:135], v[88:91]
    v_max3_u32 v12, v12, v136, v137
    v_mfma_f32_16x16x32_bf16 v[92:95], a[84:87], v[132:135], v[92:95]
    v_max3_u32 v12, v12, v138, v139
    v_mfma_f32_16x16x32_bf16 v[96:99], a[88:91], v[132:135], v[96:99]
    v_max3_u32 v12, v12, v140, v141
    v_mfma_f32_16x16x32_bf16 v[100:103], a[92:95], v[132:135], v[100:103]
    v_max3_u32 v12, v12, v142, v143
    v_mfma_f32_16x16x32_bf16 v[88:91], a[96:99], v[136:139], v[88:91]
    v_max3_u32 v12, v12, v144, v145
    v_mfma_f32_16x16x32_bf16 v[92:95], a[100:103], v[136:139], v[92:95]
    v_max3_u32 v12, v12, v146, v147
    v_mfma_f32_16x16x32_bf16 v[96:99], a[104:107], v[136:139], v[96:99]
    v_cmp_eq_u32 vcc, -1, v12
    v_mfma_f32_16x16x32_bf16 v[100:103], a[108:111], v[136:139], v[100:103]
    v_mfma_f32_16x16x32_bf16 v[96:99], a[120:123], v[140:143], v[96:99]
    v_mfma_f32_16x16x32_bf16 v[100:103], a[124:127], v[140:143], v[100:103]
    v_mfma_f32_16x16x32_bf16 v[88:91], a[112:115], v[140:143], v[88:91]
    v_mfma_f32_16x16x32_bf16 v[92:95], a[116:119], v[140:143], v[92:95]
    v_mfma_f32_16x16x32_bf16 v[92:95], a[132:135], v[144:147], v[92:95]
    v_mfma_f32_16x16x32_bf16 v[88:91], a[128:131], v[144:147], v[88:91]
    s_cmp_lg_u64 vcc, 0
    s_cbranch_scc1 L2_hs
    s_nop 1
    v_add_f32_dpp v96, v100, v96 row_shl:4 row_mask:0xf bank_mask:0xf bound_ctrl:1
    v_add_f32_dpp v97, v101, v97 row_shl:4 row_mask:0xf bank_mask:0xf bound_ctrl:1
    v_add_f32_dpp v98, v102, v98 row_shl:4 row_mask:0xf bank_mask:0xf bound_ctrl:1
    v_add_f32_dpp v99, v103, v99 row_shl:4 row_mask:0xf bank_mask:0xf bound_ctrl:1
    v_add_f32_dpp v88, v92, v88 row_shl:4 row_mask:0xf bank_mask:0xf bound_ctrl:1
    v_add_f32_dpp v89, v93, v89 row_shl:4 row_mask:0xf bank_mask:0xf bound_ctrl:1
    v_add_f32_dpp v90, v94, v90 row_shl:4 row_mask:0xf bank_mask:0xf bound_ctrl:1
    v_add_f32_dpp v91, v95, v91 row_shl:4 row_mask:0xf bank_mask:0xf bound_ctrl:1
    v_add_f32_dpp v88, v96, v88 row_shl:8 row_mask:0xf bank_mask:0xf bound_ctrl:1
    v_add_f32_dpp v89, v97, v89 row_shl:8 row_mask:0xf bank_mask:0xf bound_ctrl:1
    v_add_f32_dpp v90, v98, v90 row_shl:8 row_mask:0xf bank_mask:0xf bound_ctrl:1
    v_add_f32_dpp v91, v99, v91 row_shl:8 row_mask:0xf bank_mask:0xf bound_ctrl:1
    s_mov_b32 exec_lo, 0x30003
    s_mov_b32 exec_hi, 0x30003
    ds_write_b128 v11, v[88:91]
    s_mov_b64 exec, -1
    s_waitcnt lgkmcnt(0)
    s_barrier
    ds_read_b128 v[16:19], v13 offset:0
    ds_read_b128 v[20:23], v13 offset:16
    ds_read_b128 v[24:27], v13 offset:256
    ds_read_b128 v[28:31], v13 offset:272
    v_mov_b32 v12, 0xbfb8aa3b
    s_waitcnt lgkmcnt(2)
    v_pk_mul_f32 v[32:33], v[16:17], v[12:13] op_sel_hi:[1,0]
    v_pk_mul_f32 v[34:35], v[18:19], v[12:13] op_sel_hi:[1,0]
    v_pk_mul_f32 v[36:37], v[20:21], v[12:13] op_sel_hi:[1,0]
    v_pk_mul_f32 v[38:39], v[22:23], v[12:13] op_sel_hi:[1,0]
    v_exp_f32 v32, v32
    v_exp_f32 v33, v33
    v_exp_f32 v34, v34
    v_exp_f32 v35, v35
    v_exp_f32 v36, v36
    v_exp_f32 v37, v37
    v_exp_f32 v38, v38
    v_exp_f32 v39, v39
    v_pk_add_f32 v[32:33], v[32:33], 1.0 op_sel_hi:[1,0]
    v_pk_add_f32 v[34:35], v[34:35], 1.0 op_sel_hi:[1,0]
    v_pk_add_f32 v[36:37], v[36:37], 1.0 op_sel_hi:[1,0]
    v_pk_add_f32 v[38:39], v[38:39], 1.0 op_sel_hi:[1,0]
    v_rcp_f32 v32, v32
    v_rcp_f32 v33, v33
    v_rcp_f32 v34, v34
    v_rcp_f32 v35, v35
    v_rcp_f32 v36, v36
    v_rcp_f32 v37, v37
    v_rcp_f32 v38, v38
    v_rcp_f32 v39, v39
    s_waitcnt lgkmcnt(0)
    v_pk_mul_f32 v[16:17], v[16:17], v[32:33]
    v_pk_mul_f32 v[18:19], v[18:19], v[34:35]
    v_pk_mul_f32 v[20:21], v[20:21], v[36:37]
    v_pk_mul_f32 v[22:23], v[22:23], v[38:39]
    v_pk_mul_f32 v[16:17], v[16:17], v[24:25]
    v_pk_mul_f32 v[18:19], v[18:19], v[26:27]
    v_pk_mul_f32 v[20:21], v[20:21], v[28:29]
    v_pk_mul_f32 v[22:23], v[22:23], v[30:31]
    v_cvt_pk_bf16_f32 v40, v16, v17
    v_cvt_pk_bf16_f32 v41, v18, v19
    v_cvt_pk_bf16_f32 v42, v20, v21
    v_cvt_pk_bf16_f32 v43, v22, v23
    s_nop 1
    v_mfma_f32_16x16x32_bf16 v[48:51], v[40:43], a[136:139], 0
    v_mfma_f32_16x16x32_bf16 v[52:55], v[40:43], a[140:143], 0
    v_mfma_f32_16x16x32_bf16 v[56:59], v[40:43], a[144:147], 0
    v_mfma_f32_16x16x32_bf16 v[60:63], v[40:43], a[148:151], 0
    v_mfma_f32_16x16x32_bf16 v[64:67], v[40:43], a[152:155], 0
    v_mfma_f32_16x16x32_bf16 v[68:71], v[40:43], a[156:159], 0
    v_mfma_f32_16x16x32_bf16 v[72:75], v[40:43], a[160:163], 0
    v_mfma_f32_16x16x32_bf16 v[76:79], v[40:43], a[164:167], 0
    v_mfma_f32_16x16x32_bf16 v[80:83], v[40:43], a[168:171], 0
    s_nop 0
    v_mov_b32_dpp v48, v52 quad_perm:[0,1,2,3] row_mask:0x2 bank_mask:0xf
    v_mov_b32_dpp v49, v53 quad_perm:[0,1,2,3] row_mask:0x2 bank_mask:0xf
    s_nop 0
    v_mov_b32_dpp v48, v56 quad_perm:[0,1,2,3] row_mask:0x4 bank_mask:0xf
    v_mov_b32_dpp v49, v57 quad_perm:[0,1,2,3] row_mask:0x4 bank_mask:0xf
    s_nop 0
    v_mov_b32_dpp v48, v60 quad_perm:[0,1,2,3] row_mask:0x8 bank_mask:0xf
    v_mov_b32_dpp v49, v61 quad_perm:[0,1,2,3] row_mask:0x8 bank_mask:0xf
    v_mov_b32_dpp v50, v64 quad_perm:[0,1,2,3] row_mask:0x1 bank_mask:0xf
    v_mov_b32_dpp v51, v65 quad_perm:[0,1,2,3] row_mask:0x1 bank_mask:0xf
    s_nop 0
    v_mov_b32_dpp v50, v68 quad_perm:[0,1,2,3] row_mask:0x2 bank_mask:0xf
    v_mov_b32_dpp v51, v69 quad_perm:[0,1,2,3] row_mask:0x2 bank_mask:0xf
    s_nop 0
    v_mov_b32_dpp v50, v72 quad_perm:[0,1,2,3] row_mask:0x4 bank_mask:0xf
    v_mov_b32_dpp v51, v73 quad_perm:[0,1,2,3] row_mask:0x4 bank_mask:0xf
    s_nop 0
    v_mov_b32_dpp v50, v76 quad_perm:[0,1,2,3] row_mask:0x8 bank_mask:0xf
    v_mov_b32_dpp v51, v77 quad_perm:[0,1,2,3] row_mask:0x8 bank_mask:0xf
    v_min_u32 v48, -2, v48
    v_min_u32 v49, -2, v49
    v_min_u32 v50, -2, v50
    v_min_u32 v51, -2, v51
    v_min_u32 v80, -2, v80
    v_min_u32 v81, -2, v81
    buffer_store_dwordx4 v[48:51], v8, s[84:87], s15 offen sc1
    s_mov_b64 exec, 0xffff
    buffer_store_dwordx2 v[80:81], v10, s[84:87], s15 offen offset:1024 sc1
    s_branch L2_fin
L2_red:
    s_mov_b32 s3, 98304
    s_add_u32 s32, s84, s3
    s_addc_u32 s33, s85, 0
    s_mov_b32 s34, 663552
    s_mov_b32 s35, 0x20000
    s_sub_u32 s3, s2, 144
    s_mul_i32 s14, s3, 7282
    s_lshr_b32 s14, s14, 16
    s_mul_i32 s15, s14, 9
    s_sub_u32 s15, s3, s15
    s_mul_i32 s14, s14, 144
    s_cmp_eq_u32 s15, 8
    s_cselect_b32 s56, 1, 64
    s_cselect_b32 s57, 2, 1
    s_cselect_b32 s15, 16, s15
    s_lshl3_add_u32 s14, s15, s14
    v_bfe_u32 v7, v0, 2, 3
    v_mul_u32_u24 v7, s57, v7
    v_bfe_u32 v9, v0, 1, 1
    v_mul_u32_u24 v9, s56, v9
    v_add3_u32 v7, v7, v9, s14
    v_lshl_add_u32 v9, v7, 1, v4
    v_lshlrev_b32 v7, 2, v7
    v_lshrrev_b32 v12, 7, v3
    v_bfe_u32 v13, v3, 3, 4
    v_lshl_add_u32 v13, v12, 6, v13
    v_lshlrev_b32 v13, 8, v13
    s_mov_b32 s59, 794624
    s_mov_b32 s97, 0x20000
L2_r:
    buffer_load_dword v12, v13, s[84:87], s59 offen offset:128 sc1
    s_waitcnt vmcnt(0)
    v_cmp_eq_u32 vcc, 0, v12
    s_sub_u32 s97, s97, 1
    s_cselect_b64 vcc, 0, vcc
    s_cmp_eq_u64 vcc, 0
    s_cbranch_scc1 L2_r_ok
    s_sleep 1
    s_branch L2_r
L2_r_ok:
    buffer_load_ushort v18, v9, s[80:83], 0 offen sc1
    ds_read_b32 v20, v7 offset:6912
    v_and_b32 v6, 7, v0
    v_lshrrev_b32 v10, 3, v0
    s_lshl_b32 s14, s51, 3
    v_add_u32 v10, s14, v10
    v_mul_u32_u24 v10, 4608, v10
    v_lshl_add_u32 v10, v6, 4, v10
    s_lshl_b32 s3, s3, 7
    v_add_u32 v24, s3, v10
    v_add_u32 v25, 147456, v24
    v_add_u32 v26, 294912, v24
    v_add_u32 v27, 442368, v24
    v_add_u32 v28, 589824, v24
    v_and_b32 v16, 0xfffff800, v16
    v_not_b32 v12, v16
    v_ashrrev_i32 v12, 31, v12
    v_or_b32 v12, 0x80000000, v12
    v_xor_b32 v16, v16, v12
    v_mul_f32 v16, 0xbfb8aa3b, v16
    v_exp_f32 v16, v16
    s_nop 0
    v_add_f32 v16, 1.0, v16
    v_rcp_f32 v16, v16
    s_waitcnt lgkmcnt(0)
    v_mul_f32 v20, v20, v16
    s_lshl_b32 s14, s51, 7
    s_add_u32 s14, s14, 15872
    v_lshl_add_u32 v10, v6, 4, s14
    v_and_b32 v11, 31, v0
    v_lshlrev_b32 v11, 2, v11
    s_mov_b32 s97, 0x20000
L2_p3:
    buffer_load_dwordx4 v[32:35], v24, s[32:35], 0 offen sc1
    buffer_load_dwordx4 v[36:39], v25, s[32:35], 0 offen sc1
    buffer_load_dwordx4 v[40:43], v26, s[32:35], 0 offen sc1
    buffer_load_dwordx4 v[44:47], v27, s[32:35], 0 offen sc1
    buffer_load_dwordx4 v[48:51], v28, s[32:35], 0 offen sc1
    s_waitcnt vmcnt(0)
    v_max3_u32 v12, v32, v33, v34
    v_max3_u32 v12, v12, v35, v36
    v_max3_u32 v12, v12, v37, v38
    v_max3_u32 v12, v12, v39, v40
    v_max3_u32 v12, v12, v41, v42
    v_max3_u32 v12, v12, v43, v44
    v_max3_u32 v12, v12, v45, v46
    v_max3_u32 v12, v12, v47, v48
    v_max3_u32 v12, v12, v49, v50
    v_max_u32 v12, v12, v51
    v_cmp_eq_u32 vcc, -1, v12
    s_sub_u32 s97, s97, 1
    s_cselect_b64 vcc, 0, vcc
    s_cmp_eq_u64 vcc, 0
    s_cbranch_scc1 L2_p3_ok
    s_branch L2_p3
L2_p3_ok:
    v_pk_add_f32 v[32:33], v[32:33], v[36:37]
    v_pk_add_f32 v[40:41], v[40:41], v[44:45]
    v_pk_add_f32 v[32:33], v[32:33], v[48:49]
    v_pk_add_f32 v[32:33], v[32:33], v[40:41]
    v_pk_add_f32 v[34:35], v[34:35], v[38:39]
    v_pk_add_f32 v[42:43], v[42:43], v[46:47]
    v_pk_add_f32 v[34:35], v[34:35], v[50:51]
    v_pk_add_f32 v[34:35], v[34:35], v[42:43]
    s_nop 1
    v_add_f32_dpp v32, v32, v32 row_ror:8 row_mask:0xf bank_mask:0xf
    v_add_f32_dpp v33, v33, v33 row_ror:8 row_mask:0xf bank_mask:0xf
    v_add_f32_dpp v34, v34, v34 row_ror:8 row_mask:0xf bank_mask:0xf
    v_add_f32_dpp v35, v35, v35 row_ror:8 row_mask:0xf bank_mask:0xf
    v_mov_b32 v12, v32
    v_mov_b32 v13, v33
    v_mov_b32 v14, v34
    v_mov_b32 v15, v35
    v_permlane16_swap_b32 v12, v32
    v_permlane16_swap_b32 v13, v33
    v_permlane16_swap_b32 v14, v34
    v_permlane16_swap_b32 v15, v35
    v_add_f32 v32, v32, v12
    v_add_f32 v33, v33, v13
    v_add_f32 v34, v34, v14
    v_add_f32 v35, v35, v15
    v_mov_b32 v12, v32
    v_mov_b32 v13, v33
    v_mov_b32 v14, v34
    v_mov_b32 v15, v35
    v_permlane32_swap_b32 v12, v32
    v_permlane32_swap_b32 v13, v33
    v_permlane32_swap_b32 v14, v34
    v_permlane32_swap_b32 v15, v35
    v_add_f32 v32, v32, v12
    v_add_f32 v33, v33, v13
    v_add_f32 v34, v34, v14
    v_add_f32 v35, v35, v15
    ds_write_b128 v10, v[32:35]
    s_waitcnt lgkmcnt(0)
    s_barrier
    s_cmp_lg_u32 s51, 0
    s_cbranch_scc1 L2_fin
    ds_read_b32 v32, v11 offset:15872
    ds_read_b32 v33, v11 offset:16000
    ds_read_b32 v34, v11 offset:16128
    ds_read_b32 v35, v11 offset:16256
    v_lshlrev_b32 v12, 16, v18
    s_mov_b32 exec_hi, 0
    s_waitcnt lgkmcnt(0)
    v_pk_add_f32 v[32:33], v[32:33], v[34:35]
    v_add_f32 v32, v32, v33
    v_fmac_f32 v12, v32, v20
    v_cvt_pk_bf16_f32 v12, v12, v12
    buffer_store_short v12, v9, s[80:83], 0 offen sc1
L2_fin:
L2_end:
    s_endpgm
L2_p0s:
    s_mov_b32 s97, 0x20000
L2_p0:
    buffer_load_dword v51, v156, s[60:63], 0 offen sc1
    s_waitcnt vmcnt(0)
    v_cmp_eq_u32 vcc, 0, v51
    s_sub_u32 s97, s97, 1
    s_cselect_b64 vcc, 0, vcc
    s_cmp_eq_u64 vcc, 0
    s_cbranch_scc1 L2_p0_ok
    s_sleep 1
    s_branch L2_p0
L2_p0_ok:
    s_branch L2_p0r
L2_pms:
    s_mov_b32 s97, 0x20000
L2_pm:
    buffer_load_dwordx4 v[168:171], v166, s[84:87], 0 offen sc1
    buffer_load_dwordx4 v[176:179], v166, s[84:87], s14 offen sc1
    s_mov_b64 exec, 0xff
    buffer_load_dwordx4 v[172:175], v166, s[84:87], 0 offen offset:1024 sc1
    buffer_load_dwordx4 v[180:183], v166, s[84:87], s14 offen offset:1024 sc1
    s_mov_b64 exec, -1
    s_waitcnt vmcnt(0)
    v_max_u32 v13, v168, v169
    v_max3_u32 v13, v13, v170, v171
    v_max3_u32 v13, v13, v172, v173
    v_max3_u32 v13, v13, v174, v175
    v_max3_u32 v13, v13, v176, v177
    v_max3_u32 v13, v13, v178, v179
    v_max3_u32 v13, v13, v180, v181
    v_max3_u32 v13, v13, v182, v183
    v_cmp_eq_u32 vcc, -1, v13
    s_sub_u32 s97, s97, 1
    s_cselect_b64 vcc, 0, vcc
    s_cmp_eq_u64 vcc, 0
    s_cbranch_scc1 L2_pm_ok
    s_sleep 1
    s_branch L2_pm
L2_pm_ok:
    s_branch L2_pmr
L2_g0s:
    s_mov_b32 s97, 0x20000
L2_g0:
    buffer_load_dword v9, v6, s[84:87], s47 offen sc1
    s_waitcnt vmcnt(0)
    v_cmp_ne_u32 vcc, 0, v9
    s_nop 0
    s_lshr_b32 s3, vcc_lo, 1
    s_and_b32 s3, s3, vcc_lo
    s_lshr_b32 s14, s3, 2
    s_and_b32 s3, s3, s14
    s_and_b32 s3, s3, s48
    s_cselect_b64 vcc, 0, -1
    s_sub_u32 s97, s97, 1
    s_cselect_b64 vcc, 0, vcc
    s_cmp_eq_u64 vcc, 0
    s_cbranch_scc1 L2_g0_ok
    s_sleep 1
    s_branch L2_g0
L2_g0_ok:
    s_cmp_eq_u32 s3, 0
    s_cselect_b32 s3, s48, s3
    s_branch L2_g0r
L2_pns:
    s_mov_b32 s97, 0x20000
L2_pn:
    s_movk_i32 s45, 4608
    buffer_load_dwordx4 v[76:79], v5, s[84:87], s45 offen sc1
    s_movk_i32 s45, 18432
    buffer_load_dwordx4 v[88:91], v5, s[84:87], s45 offen sc1
    s_movk_i32 s45, 8704
    buffer_load_dwordx4 v[80:83], v5, s[84:87], s45 offen sc1
    s_movk_i32 s45, 22528
    buffer_load_dwordx4 v[92:95], v5, s[84:87], s45 offen sc1
    s_movk_i32 s45, 12800
    buffer_load_dwordx4 v[84:87], v59, s[84:87], s45 offen sc1
    s_movk_i32 s45, 26624
    buffer_load_dwordx4 v[96:99], v59, s[84:87], s45 offen sc1
    s_waitcnt vmcnt(0)
    v_max_u32 v13, v76, v77
    v_max3_u32 v13, v13, v78, v79
    v_max3_u32 v13, v13, v88, v89
    v_max3_u32 v13, v13, v90, v91
    v_max3_u32 v13, v13, v80, v81
    v_max3_u32 v13, v13, v82, v83
    v_max3_u32 v13, v13, v92, v93
    v_max3_u32 v13, v13, v94, v95
    v_max3_u32 v13, v13, v84, v85
    v_max3_u32 v13, v13, v86, v87
    v_max3_u32 v13, v13, v96, v97
    v_max3_u32 v13, v13, v98, v99
    v_cmp_eq_u32 vcc, -1, v13
    s_sub_u32 s97, s97, 1
    s_cselect_b64 vcc, 0, vcc
    s_cmp_eq_u64 vcc, 0
    s_cbranch_scc1 L2_pn_ok
    s_sleep 1
    s_branch L2_pn
L2_pn_ok:
    s_branch L2_pnr
L2_g1s:
    s_mov_b32 s97, 0x20000
L2_g1:
    buffer_load_dword v9, v6, s[84:87], s47 offen sc1
    s_waitcnt vmcnt(0)
    v_cmp_ne_u32 vcc, 0, v9
    s_nop 0
    s_lshr_b32 s3, vcc_lo, 1
    s_and_b32 s3, s3, vcc_lo
    s_lshr_b32 s14, s3, 2
    s_and_b32 s3, s3, s14
    s_and_b32 s3, s3, s48
    s_cselect_b64 vcc, 0, -1
    s_sub_u32 s97, s97, 1
    s_cselect_b64 vcc, 0, vcc
    s_cmp_eq_u64 vcc, 0
    s_cbranch_scc1 L2_g1_ok
    s_sleep 1
    s_branch L2_g1
L2_g1_ok:
    s_cmp_eq_u32 s3, 0
    s_cselect_b32 s3, s48, s3
    s_branch L2_g1r
L2_g2s:
    s_mov_b32 s97, 0x20000
L2_g2:
    buffer_load_dword v9, v6, s[84:87], s47 offen sc1
    s_waitcnt vmcnt(0)
    v_cmp_ne_u32 vcc, 0, v9
    s_nop 0
    s_lshr_b32 s3, vcc_lo, 1
    s_and_b32 s3, s3, vcc_lo
    s_lshr_b32 s14, s3, 2
    s_and_b32 s3, s3, s14
    s_and_b32 s3, s3, s48
    s_cselect_b64 vcc, 0, -1
    s_sub_u32 s97, s97, 1
    s_cselect_b64 vcc, 0, vcc
    s_cmp_eq_u64 vcc, 0
    s_cbranch_scc1 L2_g2_ok
    s_sleep 1
    s_branch L2_g2
L2_g2_ok:
    s_cmp_eq_u32 s3, 0
    s_cselect_b32 s3, s48, s3
    s_branch L2_g2r
L2_g3s:
    s_mov_b32 s97, 0x20000
L2_g3:
    buffer_load_dword v9, v6, s[84:87], s47 offen sc1
    s_waitcnt vmcnt(0)
    v_cmp_ne_u32 vcc, 0, v9
    s_nop 0
    s_lshr_b32 s3, vcc_lo, 1
    s_and_b32 s3, s3, vcc_lo
    s_lshr_b32 s14, s3, 2
    s_and_b32 s3, s3, s14
    s_and_b32 s3, s3, s48
    s_cselect_b64 vcc, 0, -1
    s_sub_u32 s97, s97, 1
    s_cselect_b64 vcc, 0, vcc
    s_cmp_eq_u64 vcc, 0
    s_cbranch_scc1 L2_g3_ok
    s_sleep 1
    s_branch L2_g3
L2_g3_ok:
    s_cmp_eq_u32 s3, 0
    s_cselect_b32 s3, s48, s3
    s_branch L2_g3r
L2_hs:
    s_mov_b32 s97, 0x20000
L2_h:
    buffer_load_dwordx4 v[128:131], v5, s[84:87], s59 offen offset:0 sc1
    buffer_load_dwordx4 v[132:135], v5, s[84:87], s59 offen offset:256 sc1
    buffer_load_dwordx4 v[136:139], v5, s[84:87], s59 offen offset:512 sc1
    buffer_load_dwordx4 v[140:143], v5, s[84:87], s59 offen offset:768 sc1
    buffer_load_dwordx4 v[144:147], v3, s[84:87], s59 offen offset:1024 sc1
    s_waitcnt vmcnt(0)
    v_max_u32 v12, v128, v129
    v_max3_u32 v12, v12, v130, v131
    v_max3_u32 v12, v12, v132, v133
    v_max3_u32 v12, v12, v134, v135
    v_max3_u32 v12, v12, v136, v137
    v_max3_u32 v12, v12, v138, v139
    v_max3_u32 v12, v12, v140, v141
    v_max3_u32 v12, v12, v142, v143
    v_max3_u32 v12, v12, v144, v145
    v_max3_u32 v12, v12, v146, v147
    v_cmp_eq_u32 vcc, -1, v12
    s_sub_u32 s97, s97, 1
    s_cselect_b64 vcc, 0, vcc
    s_cmp_eq_u64 vcc, 0
    s_cbranch_scc1 L2_h_ok
    s_sleep 1
    s_branch L2_h
L2_h_ok:
    v_min_u32 v128, -2, v128
    v_min_u32 v129, -2, v129
    v_min_u32 v130, -2, v130
    v_min_u32 v131, -2, v131
    v_min_u32 v132, -2, v132
    v_min_u32 v133, -2, v133
    v_min_u32 v134, -2, v134
    v_min_u32 v135, -2, v135
    v_min_u32 v136, -2, v136
    v_min_u32 v137, -2, v137
    v_min_u32 v138, -2, v138
    v_min_u32 v139, -2, v139
    v_min_u32 v140, -2, v140
    v_min_u32 v141, -2, v141
    v_min_u32 v142, -2, v142
    v_min_u32 v143, -2, v143
    v_min_u32 v144, -2, v144
    v_min_u32 v145, -2, v145
    v_min_u32 v146, -2, v146
    v_min_u32 v147, -2, v147
    s_nop 1
    s_branch L2_hr
L2_fallback:
    s_waitcnt vmcnt(0) lgkmcnt(0)
    s_nop 7
    s_barrier
    s_lshl_b32 s3, s51, 12
    v_add_u32 v5, s3, v8
    v_lshrrev_b32 v14, 2, v0
    v_mul_u32_u24 v14, 1056, v14
    v_and_b32 v15, 3, v0
    v_lshl_add_u32 v14, v15, 3, v14
    v_add_u32 v2, 107008, v14
    v_and_b32 v14, 15, v0
    v_mul_u32_u24 v14, 1056, v14
    v_lshrrev_b32 v15, 4, v0
    v_lshl_add_u32 v14, v15, 4, v14
    v_add_u32 v1, 90112, v14
    v_mov_b32 v32, 0xff800000
    v_mov_b32 v33, 0xff800000
    v_mov_b32 v34, 0xff800000
    v_mov_b32 v35, 0xff800000
    s_mov_b32 s50, 1
    s_mov_b32 s46, 0
L2_fb_loop:
    s_add_u32 m0, s44, 73728
    s_nop 0
    buffer_load_dwordx4 v5, s[16:19], s46 offen offset:0 lds
    s_add_u32 m0, s44, 73760
    s_nop 0
    buffer_load_dwordx4 v5, s[16:19], s46 offen offset:1024 lds
    s_add_u32 m0, s44, 73792
    s_nop 0
    buffer_load_dwordx4 v5, s[16:19], s46 offen offset:2048 lds
    s_add_u32 m0, s44, 73824
    s_nop 0
    buffer_load_dwordx4 v5, s[16:19], s46 offen offset:3072 lds
    s_waitcnt vmcnt(0) lgkmcnt(0)
    s_barrier
    ds_read_b128 a[64:67], v1 offset:0
    ds_read_b128 a[68:71], v1 offset:64
    ds_read_b128 a[72:75], v1 offset:128
    ds_read_b128 a[76:79], v1 offset:192
    ds_read_b128 a[80:83], v1 offset:256
    ds_read_b128 a[84:87], v1 offset:320
    ds_read_b128 a[88:91], v1 offset:384
    ds_read_b128 a[92:95], v1 offset:448
    ds_read_b128 a[96:99], v1 offset:512
    ds_read_b128 a[100:103], v1 offset:576
    ds_read_b128 a[104:107], v1 offset:640
    ds_read_b128 a[108:111], v1 offset:704
    ds_read_b128 a[112:115], v1 offset:768
    ds_read_b128 a[116:119], v1 offset:832
    ds_read_b128 a[120:123], v1 offset:896
    ds_read_b128 a[124:127], v1 offset:960
    s_waitcnt vmcnt(0) lgkmcnt(0)
    s_barrier
    v_mfma_f32_16x16x32_bf16 v[16:19], a[64:67], v[64:67], 0
    v_mfma_f32_16x16x32_bf16 v[16:19], a[68:71], v[68:71], v[16:19]
    v_mfma_f32_16x16x32_bf16 v[16:19], a[72:75], v[72:75], v[16:19]
    v_mfma_f32_16x16x32_bf16 v[16:19], a[76:79], v[76:79], v[16:19]
    v_mfma_f32_16x16x32_bf16 v[20:23], a[80:83], v[64:67], 0
    v_mfma_f32_16x16x32_bf16 v[20:23], a[84:87], v[68:71], v[20:23]
    v_mfma_f32_16x16x32_bf16 v[20:23], a[88:91], v[72:75], v[20:23]
    v_mfma_f32_16x16x32_bf16 v[20:23], a[92:95], v[76:79], v[20:23]
    v_mfma_f32_16x16x32_bf16 v[24:27], a[96:99], v[64:67], 0
    v_mfma_f32_16x16x32_bf16 v[24:27], a[100:103], v[68:71], v[24:27]
    v_mfma_f32_16x16x32_bf16 v[24:27], a[104:107], v[72:75], v[24:27]
    v_mfma_f32_16x16x32_bf16 v[24:27], a[108:111], v[76:79], v[24:27]
    v_mfma_f32_16x16x32_bf16 v[28:31], a[112:115], v[64:67], 0
    v_mfma_f32_16x16x32_bf16 v[28:31], a[116:119], v[68:71], v[28:31]
    v_mfma_f32_16x16x32_bf16 v[28:31], a[120:123], v[72:75], v[28:31]
    v_mfma_f32_16x16x32_bf16 v[28:31], a[124:127], v[76:79], v[28:31]
    s_nop 7
    v_max3_f32 v32, v32, v16, v17
    v_max3_f32 v32, v32, v18, v19
    v_max3_f32 v32, v32, v20, v21
    v_max3_f32 v32, v32, v22, v23
    v_max3_f32 v32, v32, v24, v25
    v_max3_f32 v32, v32, v26, v27
    v_max3_f32 v32, v32, v28, v29
    v_max3_f32 v32, v32, v30, v31
    v_mfma_f32_16x16x32_bf16 v[16:19], a[64:67], v[80:83], 0
    v_mfma_f32_16x16x32_bf16 v[16:19], a[68:71], v[84:87], v[16:19]
    v_mfma_f32_16x16x32_bf16 v[16:19], a[72:75], v[88:91], v[16:19]
    v_mfma_f32_16x16x32_bf16 v[16:19], a[76:79], v[92:95], v[16:19]
    v_mfma_f32_16x16x32_bf16 v[20:23], a[80:83], v[80:83], 0
    v_mfma_f32_16x16x32_bf16 v[20:23], a[84:87], v[84:87], v[20:23]
    v_mfma_f32_16x16x32_bf16 v[20:23], a[88:91], v[88:91], v[20:23]
    v_mfma_f32_16x16x32_bf16 v[20:23], a[92:95], v[92:95], v[20:23]
    v_mfma_f32_16x16x32_bf16 v[24:27], a[96:99], v[80:83], 0
    v_mfma_f32_16x16x32_bf16 v[24:27], a[100:103], v[84:87], v[24:27]
    v_mfma_f32_16x16x32_bf16 v[24:27], a[104:107], v[88:91], v[24:27]
    v_mfma_f32_16x16x32_bf16 v[24:27], a[108:111], v[92:95], v[24:27]
    v_mfma_f32_16x16x32_bf16 v[28:31], a[112:115], v[80:83], 0
    v_mfma_f32_16x16x32_bf16 v[28:31], a[116:119], v[84:87], v[28:31]
    v_mfma_f32_16x16x32_bf16 v[28:31], a[120:123], v[88:91], v[28:31]
    v_mfma_f32_16x16x32_bf16 v[28:31], a[124:127], v[92:95], v[28:31]
    s_nop 7
    v_max3_f32 v33, v33, v16, v17
    v_max3_f32 v33, v33, v18, v19
    v_max3_f32 v33, v33, v20, v21
    v_max3_f32 v33, v33, v22, v23
    v_max3_f32 v33, v33, v24, v25
    v_max3_f32 v33, v33, v26, v27
    v_max3_f32 v33, v33, v28, v29
    v_max3_f32 v33, v33, v30, v31
    v_mfma_f32_16x16x32_bf16 v[16:19], a[64:67], v[96:99], 0
    v_mfma_f32_16x16x32_bf16 v[16:19], a[68:71], v[100:103], v[16:19]
    v_mfma_f32_16x16x32_bf16 v[16:19], a[72:75], v[104:107], v[16:19]
    v_mfma_f32_16x16x32_bf16 v[16:19], a[76:79], v[108:111], v[16:19]
    v_mfma_f32_16x16x32_bf16 v[20:23], a[80:83], v[96:99], 0
    v_mfma_f32_16x16x32_bf16 v[20:23], a[84:87], v[100:103], v[20:23]
    v_mfma_f32_16x16x32_bf16 v[20:23], a[88:91], v[104:107], v[20:23]
    v_mfma_f32_16x16x32_bf16 v[20:23], a[92:95], v[108:111], v[20:23]
    v_mfma_f32_16x16x32_bf16 v[24:27], a[96:99], v[96:99], 0
    v_mfma_f32_16x16x32_bf16 v[24:27], a[100:103], v[100:103], v[24:27]
    v_mfma_f32_16x16x32_bf16 v[24:27], a[104:107], v[104:107], v[24:27]
    v_mfma_f32_16x16x32_bf16 v[24:27], a[108:111], v[108:111], v[24:27]
    v_mfma_f32_16x16x32_bf16 v[28:31], a[112:115], v[96:99], 0
    v_mfma_f32_16x16x32_bf16 v[28:31], a[116:119], v[100:103], v[28:31]
    v_mfma_f32_16x16x32_bf16 v[28:31], a[120:123], v[104:107], v[28:31]
    v_mfma_f32_16x16x32_bf16 v[28:31], a[124:127], v[108:111], v[28:31]
    s_nop 7
    v_max3_f32 v34, v34, v16, v17
    v_max3_f32 v34, v34, v18, v19
    v_max3_f32 v34, v34, v20, v21
    v_max3_f32 v34, v34, v22, v23
    v_max3_f32 v34, v34, v24, v25
    v_max3_f32 v34, v34, v26, v27
    v_max3_f32 v34, v34, v28, v29
    v_max3_f32 v34, v34, v30, v31
    v_mfma_f32_16x16x32_bf16 v[16:19], a[64:67], v[112:115], 0
    v_mfma_f32_16x16x32_bf16 v[16:19], a[68:71], v[116:119], v[16:19]
    v_mfma_f32_16x16x32_bf16 v[16:19], a[72:75], v[120:123], v[16:19]
    v_mfma_f32_16x16x32_bf16 v[16:19], a[76:79], v[124:127], v[16:19]
    v_mfma_f32_16x16x32_bf16 v[20:23], a[80:83], v[112:115], 0
    v_mfma_f32_16x16x32_bf16 v[20:23], a[84:87], v[116:119], v[20:23]
    v_mfma_f32_16x16x32_bf16 v[20:23], a[88:91], v[120:123], v[20:23]
    v_mfma_f32_16x16x32_bf16 v[20:23], a[92:95], v[124:127], v[20:23]
    v_mfma_f32_16x16x32_bf16 v[24:27], a[96:99], v[112:115], 0
    v_mfma_f32_16x16x32_bf16 v[24:27], a[100:103], v[116:119], v[24:27]
    v_mfma_f32_16x16x32_bf16 v[24:27], a[104:107], v[120:123], v[24:27]
    v_mfma_f32_16x16x32_bf16 v[24:27], a[108:111], v[124:127], v[24:27]
    v_mfma_f32_16x16x32_bf16 v[28:31], a[112:115], v[112:115], 0
    v_mfma_f32_16x16x32_bf16 v[28:31], a[116:119], v[116:119], v[28:31]
    v_mfma_f32_16x16x32_bf16 v[28:31], a[120:123], v[120:123], v[28:31]
    v_mfma_f32_16x16x32_bf16 v[28:31], a[124:127], v[124:127], v[28:31]
    s_nop 7
    v_max3_f32 v35, v35, v16, v17
    v_max3_f32 v35, v35, v18, v19
    v_max3_f32 v35, v35, v20, v21
    v_max3_f32 v35, v35, v22, v23
    v_max3_f32 v35, v35, v24, v25
    v_max3_f32 v35, v35, v26, v27
    v_max3_f32 v35, v35, v28, v29
    v_max3_f32 v35, v35, v30, v31
    s_add_u32 s46, s46, 16384
    s_cmp_lt_u32 s46, 524288
    s_cbranch_scc1 L2_fb_loop
    v_mov_b32 v12, v32
    v_mov_b32 v13, v33
    v_mov_b32 v14, v34
    v_mov_b32 v15, v35
    v_permlane16_swap_b32 v12, v32
    v_permlane16_swap_b32 v13, v33
    v_permlane16_swap_b32 v14, v34
    v_permlane16_swap_b32 v15, v35
    v_max_f32 v32, v32, v12
    v_max_f32 v33, v33, v13
    v_max_f32 v34, v34, v14
    v_max_f32 v35, v35, v15
    v_mov_b32 v12, v32
    v_mov_b32 v13, v33
    v_mov_b32 v14, v34
    v_mov_b32 v15, v35
    v_permlane32_swap_b32 v12, v32
    v_permlane32_swap_b32 v13, v33
    v_permlane32_swap_b32 v14, v34
    v_permlane32_swap_b32 v15, v35
    v_max_f32 v32, v32, v12
    v_max_f32 v33, v33, v13
    v_max_f32 v34, v34, v14
    v_max_f32 v35, v35, v15
    v_sub_f32 v48, 0x80000000, v32
    v_sub_f32 v49, 0x80000000, v32
    v_sub_f32 v50, 0x80000000, v32
    v_sub_f32 v51, 0x80000000, v32
    v_sub_f32 v52, 0x80000000, v33
    v_sub_f32 v53, 0x80000000, v33
    v_sub_f32 v54, 0x80000000, v33
    v_sub_f32 v55, 0x80000000, v33
    v_sub_f32 v56, 0x80000000, v34
    v_sub_f32 v57, 0x80000000, v34
    v_sub_f32 v58, 0x80000000, v34
    v_sub_f32 v59, 0x80000000, v34
    v_sub_f32 v60, 0x80000000, v35
    v_sub_f32 v61, 0x80000000, v35
    v_sub_f32 v62, 0x80000000, v35
    v_sub_f32 v63, 0x80000000, v35
    s_add_u32 m0, s44, 73728
    s_mov_b32 s46, 0
    buffer_load_dwordx4 v5, s[16:19], s46 offen offset:0 lds
    s_add_u32 m0, s44, 73760
    s_nop 0
    buffer_load_dwordx4 v5, s[16:19], s46 offen offset:1024 lds
    s_add_u32 m0, s44, 73792
    s_nop 0
    buffer_load_dwordx4 v5, s[16:19], s46 offen offset:2048 lds
    s_add_u32 m0, s44, 73824
    s_nop 0
    buffer_load_dwordx4 v5, s[16:19], s46 offen offset:3072 lds
    s_add_u32 m0, s44, 90624
    s_nop 0
    buffer_load_dwordx4 v5, s[20:23], s46 offen offset:0 lds
    s_add_u32 m0, s44, 90656
    s_nop 0
    buffer_load_dwordx4 v5, s[20:23], s46 offen offset:1024 lds
    s_add_u32 m0, s44, 90688
    s_nop 0
    buffer_load_dwordx4 v5, s[20:23], s46 offen offset:2048 lds
    s_add_u32 m0, s44, 90720
    s_nop 0
    buffer_load_dwordx4 v5, s[20:23], s46 offen offset:3072 lds
    s_add_u32 m0, s44, 110592
    s_mov_b32 s46, 16384
    buffer_load_dwordx4 v5, s[16:19], s46 offen offset:0 lds
    s_add_u32 m0, s44, 110624
    s_nop 0
    buffer_load_dwordx4 v5, s[16:19], s46 offen offset:1024 lds
    s_add_u32 m0, s44, 110656
    s_nop 0
    buffer_load_dwordx4 v5, s[16:19], s46 offen offset:2048 lds
    s_add_u32 m0, s44, 110688
    s_nop 0
    buffer_load_dwordx4 v5, s[16:19], s46 offen offset:3072 lds
    s_add_u32 m0, s44, 127488
    s_nop 0
    buffer_load_dwordx4 v5, s[20:23], s46 offen offset:0 lds
    s_add_u32 m0, s44, 127520
    s_nop 0
    buffer_load_dwordx4 v5, s[20:23], s46 offen offset:1024 lds
    s_add_u32 m0, s44, 127552
    s_nop 0
    buffer_load_dwordx4 v5, s[20:23], s46 offen offset:2048 lds
    s_add_u32 m0, s44, 127584
    s_nop 0
    buffer_load_dwordx4 v5, s[20:23], s46 offen offset:3072 lds
    s_add_u32 m0, s44, 0
    s_mov_b32 s46, 32768
    buffer_load_dwordx4 v5, s[16:19], s46 offen offset:0 lds
    s_add_u32 m0, s44, 32
    s_nop 0
    buffer_load_dwordx4 v5, s[16:19], s46 offen offset:1024 lds
    s_add_u32 m0, s44, 64
    s_nop 0
    buffer_load_dwordx4 v5, s[16:19], s46 offen offset:2048 lds
    s_add_u32 m0, s44, 96
    s_nop 0
    buffer_load_dwordx4 v5, s[16:19], s46 offen offset:3072 lds
    s_add_u32 m0, s44, 16896
    s_nop 0
    buffer_load_dwordx4 v5, s[20:23], s46 offen offset:0 lds
    s_add_u32 m0, s44, 16928
    s_nop 0
    buffer_load_dwordx4 v5, s[20:23], s46 offen offset:1024 lds
    s_add_u32 m0, s44, 16960
    s_nop 0
    buffer_load_dwordx4 v5, s[20:23], s46 offen offset:2048 lds
    s_add_u32 m0, s44, 16992
    s_nop 0
    buffer_load_dwordx4 v5, s[20:23], s46 offen offset:3072 lds
    s_waitcnt vmcnt(0) lgkmcnt(0)
    s_barrier
    ds_read_b128 a[64:67], v1 offset:0
    ds_read_b128 a[68:71], v1 offset:64
    ds_read_b128 a[72:75], v1 offset:128
    ds_read_b128 a[76:79], v1 offset:192
    ds_read_b128 a[80:83], v1 offset:256
    ds_read_b128 a[84:87], v1 offset:320
    ds_read_b128 a[88:91], v1 offset:384
    ds_read_b128 a[92:95], v1 offset:448
    ds_read_b128 a[96:99], v1 offset:512
    ds_read_b128 a[100:103], v1 offset:576
    ds_read_b128 a[104:107], v1 offset:640
    ds_read_b128 a[108:111], v1 offset:704
    ds_read_b128 a[112:115], v1 offset:768
    ds_read_b128 a[116:119], v1 offset:832
    ds_read_b128 a[120:123], v1 offset:896
    ds_read_b128 a[124:127], v1 offset:960
    ds_read_b64_tr_b16 a[128:129], v2 offset:0
    ds_read_b64_tr_b16 a[130:131], v2 offset:256
    ds_read_b64_tr_b16 a[132:133], v2 offset:512
    ds_read_b64_tr_b16 a[134:135], v2 offset:768
    ds_read_b64_tr_b16 a[136:137], v2 offset:32
    ds_read_b64_tr_b16 a[138:139], v2 offset:288
    ds_read_b64_tr_b16 a[140:141], v2 offset:544
    ds_read_b64_tr_b16 a[142:143], v2 offset:800
    ds_read_b64_tr_b16 a[144:145], v2 offset:64
    ds_read_b64_tr_b16 a[146:147], v2 offset:320
    ds_read_b64_tr_b16 a[148:149], v2 offset:576
    ds_read_b64_tr_b16 a[150:151], v2 offset:832
    ds_read_b64_tr_b16 a[152:153], v2 offset:96
    ds_read_b64_tr_b16 a[154:155], v2 offset:352
    ds_read_b64_tr_b16 a[156:157], v2 offset:608
    ds_read_b64_tr_b16 a[158:159], v2 offset:864
    ds_read_b64_tr_b16 a[160:161], v2 offset:128
    ds_read_b64_tr_b16 a[162:163], v2 offset:384
    ds_read_b64_tr_b16 a[164:165], v2 offset:640
    ds_read_b64_tr_b16 a[166:167], v2 offset:896
    ds_read_b64_tr_b16 a[168:169], v2 offset:160
    ds_read_b64_tr_b16 a[170:171], v2 offset:416
    ds_read_b64_tr_b16 a[172:173], v2 offset:672
    ds_read_b64_tr_b16 a[174:175], v2 offset:928
    ds_read_b64_tr_b16 a[176:177], v2 offset:192
    ds_read_b64_tr_b16 a[178:179], v2 offset:448
    ds_read_b64_tr_b16 a[180:181], v2 offset:704
    ds_read_b64_tr_b16 a[182:183], v2 offset:960
    ds_read_b64_tr_b16 a[184:185], v2 offset:224
    ds_read_b64_tr_b16 a[186:187], v2 offset:480
    ds_read_b64_tr_b16 a[188:189], v2 offset:736
    ds_read_b64_tr_b16 a[190:191], v2 offset:992
    s_waitcnt vmcnt(0) lgkmcnt(0)
    s_branch L2_entry
L2_codeend:

.section .rodata,"a"
.p2align 6
.amdhsa_kernel adaLN_cond__gqa_block_cached__moe_arch_mod__prompt_kernel
  .amdhsa_next_free_vgpr 512
  .amdhsa_next_free_sgpr 102
  .amdhsa_accum_offset 256
  .amdhsa_group_segment_fixed_size 0
  .amdhsa_kernarg_size 120
  .amdhsa_user_sgpr_count 2
  .amdhsa_user_sgpr_kernarg_segment_ptr 1
  .amdhsa_system_sgpr_workgroup_id_x 1
  .amdhsa_float_denorm_mode_32 3
.end_amdhsa_kernel
```

```asm
; @launch grid=(256,1,1) block=(256,1,1) lds=163840
.amdgcn_target "amdgcn-amd-amdhsa--gfx950"
.text
.globl adaLN_cond__gqa_block_cached__moe_arch_mod__prompt_kernel
.p2align 8
.type adaLN_cond__gqa_block_cached__moe_arch_mod__prompt_kernel,@function
adaLN_cond__gqa_block_cached__moe_arch_mod__prompt_kernel:
L2_begin:
    s_getpc_b64 s[98:99]
    s_cmp_ge_u32 s2, 256
    s_cbranch_scc1 L2_end
    s_load_dwordx2 s[76:77], s[0:1], 0
    s_load_dwordx2 s[16:17], s[0:1], 80
    s_load_dwordx2 s[88:89], s[0:1], 88
    s_load_dwordx2 s[12:13], s[0:1], 112
    s_load_dwordx2 s[60:61], s[0:1], 104
    s_and_b32 s3, s2, 7
    s_lshr_b32 s14, s2, 3
    v_mov_b32 v155, v0
    v_lshrrev_b32 v10, 6, v0
    v_and_b32 v0, 63, v0
    s_lshl_b32 s15, s14, 9
    v_lshl_add_u32 v13, v10, 7, s15
    v_lshl_add_u32 v13, v0, 14, v13
    v_min_u32 v13, L2_codeend-L2_begin-8, v13
    s_mov_b64 exec, 31
    global_load_dword a63, v13, s[98:99]
    s_mov_b64 exec, -1
    v_readfirstlane_b32 s51, v10
    s_and_b32 s52, s3, 3
    s_and_b32 s15, s14, 3
    s_lshl2_add_u32 s52, s52, s15
    s_lshr_b32 s53, s3, 2
    s_lshr_b32 s15, s14, 2
    s_lshl3_add_u32 s53, s53, s15
    s_lshl4_add_u32 s96, s53, s52
    s_mul_i32 s49, s3, 27
    s_max_u32 s14, s14, 5
    s_add_u32 s49, s49, s14
    s_sub_u32 s49, s49, 5
    s_lshr_b32 s55, s3, 2
    s_mul_i32 s15, s55, 108
    s_sub_u32 s50, s49, s15
    s_mul_i32 s3, s51, 288
    v_lshrrev_b32 v14, 3, v0
    v_lshl_add_u32 v12, v14, 4, s3
    v_and_b32 v14, 1, v14
    v_lshl_add_u32 v13, v14, 4, s3
    v_and_b32 v14, 7, v0
    v_mul_u32_u24 v14, 1152, v14
    v_add_u32 v1, v14, v12
    v_add_u32 v2, v14, v13
    v_add_u32 v2, 256, v2
    v_and_b32 v4, 0xfc, v155
    v_and_b32 v7, 3, v0
    v_mul_u32_u24 v3, 6912, v4
    v_lshl_add_u32 v153, v7, 4, v3
    s_mul_i32 s3, s96, 9216
    s_movk_i32 s78, 9216
    s_mov_b32 s79, 0x20000
    s_mov_b32 s91, s79
    v_lshlrev_b32 v8, 4, v0
    s_mov_b32 s86, 8388608
    s_mov_b32 s87, s79
    s_movk_i32 s62, 256
    s_mov_b32 s63, s79
    s_lshl_b32 s14, s50, 6
    s_sub_u32 s90, 1990656, s14
    s_cmp_ge_u32 s2, 40
    s_cselect_b32 s90, s90, 0
    s_mul_i32 s15, s55, 1990656
    s_add_u32 s14, s14, s15
    s_waitcnt lgkmcnt(0)
    s_add_u32 s76, s76, s3
    s_addc_u32 s77, s77, 0
    buffer_load_dwordx4 v[64:67], v1, s[76:79], 0 offen offset:0
    buffer_load_dwordx4 v[68:71], v1, s[76:79], 0 offen offset:128
    buffer_load_dwordx4 v[72:75], v2, s[76:79], 0 offen offset:0
    s_add_u32 s88, s88, s14
    s_addc_u32 s89, s89, 0
    s_mov_b64 s[84:85], s[12:13]
    s_cmp_ge_u32 s2, 8
    s_cbranch_scc1 L2_noclr
    v_mov_b32 v52, -1
    v_mov_b32 v56, 0
    v_mov_b32 v53, -1
    v_mov_b32 v57, 0
    v_mov_b32 v54, -1
    v_mov_b32 v58, 0
    v_mov_b32 v55, -1
    v_mov_b32 v59, 0
    s_lshl2_add_u32 s15, s2, s51
    s_lshl_b32 s3, s15, 10
    buffer_store_dwordx4 v[52:55], v8, s[84:87], s3 offen sc1
    v_lshrrev_b32 v13, 3, v0
    v_mul_u32_u24 v13, 0, v13
    v_add_u32 v13, v13, v8
    s_mul_i32 s3, s15, 1024
    s_add_u32 s3, s3, 6815744
    buffer_store_dwordx4 v[56:59], v13, s[84:87], s3 offen sc1
L2_noclr:
    buffer_load_dwordx4 v[128:131], v153, s[88:91], 0 offen
    s_movk_i32 s3, 6912
    buffer_load_dwordx4 v[132:135], v153, s[88:91], s3 offen
    s_movk_i32 s3, 13824
    buffer_load_dwordx4 v[136:139], v153, s[88:91], s3 offen
    s_movk_i32 s3, 20736
    buffer_load_dwordx4 v[140:143], v153, s[88:91], s3 offen
    v_lshrrev_b32 v3, 2, v3
    v_lshl_add_u32 v3, v7, 4, v3
    v_add_u32 v154, 1769472, v3
    v_lshrrev_b32 v3, 1, v4
    v_lshlrev_b32 v4, 1, v4
    s_mul_i32 s3, s55, 576
    s_add_u32 s16, s16, s3
    s_addc_u32 s17, s17, 0
    s_mov_b32 s18, 576
    s_mov_b32 s19, 0x20000
    buffer_load_dwordx2 v[148:149], v4, s[16:19], 0 offen
    v_mov_b32 v144, 0
    v_mov_b32 v145, 0
    v_mov_b32 v146, 0
    v_mov_b32 v147, 0
    v_mov_b32 v150, 0
    s_cmp_ge_u32 s51, 2
    s_cbranch_scc1 L2_w23
    buffer_load_dwordx4 v[144:147], v154, s[88:91], 0 offen
    buffer_load_ushort v150, v3, s[16:19], 0 offen offset:512
L2_w23:
    s_load_dwordx8 s[4:11], s[0:1], 8
    s_load_dwordx2 s[64:65], s[0:1], 56
    s_load_dwordx2 s[68:69], s[0:1], 64
    s_load_dwordx2 s[72:73], s[0:1], 72
    s_load_dwordx2 s[80:81], s[0:1], 96
    s_load_dwordx2 s[36:37], s[0:1], 48
    s_cmp_eq_u32 s51, 0
    s_cselect_b32 s3, 0, 0x40000000
    v_mul_u32_u24 v156, 32, v0
    v_or_b32 v156, s3, v156
    s_mul_i32 s44, s51, 4224
    s_add_u32 s44, s44, 16384
    v_lshl_add_u32 v5, v10, 12, v8
    v_lshrrev_b32 v13, 5, v0
    v_lshl_add_u32 v13, v10, 1, v13
    v_lshlrev_b32 v13, 15, v13
    v_and_b32 v14, 31, v0
    v_lshl_add_u32 v6, v14, 4, v13
    v_mov_b32 v56, 0
    v_mov_b32 v60, -1
    v_mov_b32 v57, 0
    v_mov_b32 v61, -1
    v_mov_b32 v58, 0
    v_mov_b32 v62, -1
    v_mov_b32 v59, 0
    v_mov_b32 v63, -1
    s_and_b32 s14, s53, 7
    s_lshl2_add_u32 s14, s14, s51
    v_lshrrev_b32 v13, 2, v0
    v_lshl_add_u32 v13, v13, 5, s14
    v_lshlrev_b32 v13, 13, v13
    v_lshl_add_u32 v13, v7, 7, v13
    s_waitcnt lgkmcnt(0)
    s_lshl_b32 s3, s52, 9
    s_add_u32 s24, s8, s3
    s_addc_u32 s25, s9, 0
    s_mov_b32 s26, 0
    s_mov_b32 s27, 0x20000
    s_sub_u32 s26, 4718592, s3
    s_mov_b64 exec, 0xffff
    buffer_load_dword a63, v13, s[24:27], 0 offen
    s_mov_b64 exec, -1
    s_mov_b32 s38, 1152
    s_mov_b32 s39, 0x20000
    v_and_b32 v14, 7, v0
    v_lshlrev_b32 v157, 4, v14
    v_add_u32 v157, 14080, v157
    v_lshl_add_u32 v158, v10, 2, v157
    s_mul_i32 s3, s51, 4608
    v_lshl_add_u32 v14, v14, 4, s3
    v_lshrrev_b32 v15, 3, v0
    v_lshl_add_u32 v159, v15, 8, v14
    s_lshr_b32 s3, s96, 1
    s_mul_i32 s3, s3, 18432
    s_and_b32 s14, s96, 1
    s_lshl_b32 s14, s14, 7
    s_add_u32 s3, s3, s14
    s_add_u32 s58, s3, 1048576
    s_lshl_b32 s3, s53, 2
    s_add_u32 s3, s3, s51
    s_lshl_b32 s14, s3, 4
    s_add_u32 s14, s14, s52
    s_lshl_b32 s14, s14, 8
    s_add_u32 s56, s14, 786432
    s_mul_i32 s14, s3, 512
    s_add_u32 s59, s14, 6815744
    v_and_b32 v14, 3, v0
    v_mul_u32_u24 v163, 128, v14
    s_mul_i32 s14, s3, 36864
    s_add_u32 s14, s14, 1048576
    s_add_u32 s32, s12, s14
    s_addc_u32 s33, s13, 0
    s_mov_b32 s34, 36864
    s_mov_b32 s35, 0x20000
    s_mul_i32 s15, s2, 4608
    s_mul_i32 s14, s51, 1152
    s_add_u32 s15, s15, s14
    s_add_u32 s57, s15, 98304
    s_cmp_ge_u32 s2, 144
    s_cselect_b32 s14, 0x40000000, 0
    v_or_b32 v160, s14, v8
    v_lshrrev_b32 v12, 4, v155
    v_lshlrev_b32 v12, 7, v12
    v_lshl_add_u32 v161, v7, 5, v12
    v_lshlrev_b32 v162, 2, v0
    s_mul_i32 s3, s50, 3641
    s_lshr_b32 s3, s3, 16
    s_mov_b32 s47, 1.0
    s_mov_b32 s48, 0
    s_cmp_lt_u32 s3, 2
    s_cselect_b32 s47, 0x3e0293ee, s47
    s_cmp_eq_u32 s3, 1
    s_cselect_b32 s48, 0x3e0293ee, s48
    s_cmp_eq_u32 s3, 4
    s_cselect_b32 s48, 1.0, s48
    s_cmp_eq_u32 s55, 0
    s_cselect_b32 s48, s48, 0
    s_lshl_b32 s100, s49, 7
    s_mul_i32 s14, s96, 128
    s_add_u32 s101, s14, 6815744
    s_mul_i32 s3, s51, 1152
    v_add_u32 v166, s3, v8
    s_and_b32 s3, s51, 1
    s_mul_i32 s3, s3, 2304
    s_cmp_lt_u32 s51, 2
    s_cselect_b32 s14, 32, 0
    s_add_u32 s3, s3, s14
    s_add_u32 s3, s3, 9216
    v_lshrrev_b32 v14, 1, v0
    v_lshl_add_u32 v14, v14, 6, s3
    v_and_b32 v15, 1, v0
    v_lshl_add_u32 v167, v15, 4, v14
    s_cmp_eq_u32 s51, 1
    s_cselect_b32 s3, 40, 256
    s_cmp_ge_u32 s2, s3
    s_cselect_b32 s3, 0, 0x40000000
    v_or_b32 v164, s3, v162
    v_mov_b32 v172, 0
    v_mov_b32 v180, 0
    v_mov_b32 v173, 0
    v_mov_b32 v181, 0
    v_mov_b32 v174, 0
    v_mov_b32 v182, 0
    v_mov_b32 v175, 0
    v_mov_b32 v183, 0
    s_lshl_b32 s3, s53, 2
    s_add_u32 s3, s3, s51
    v_mov_b32 v12, v10
    s_mul_i32 s14, s3, 589824
    s_mul_i32 s15, s52, 9216
    s_add_u32 s14, s14, s15
    s_add_u32 s14, s14, 8388608
    s_add_u32 s40, s12, s14
    s_addc_u32 s41, s13, 0
    s_mov_b32 s42, 0
    s_mov_b32 s43, 0x20000
    s_sub_u32 s42, 589824, s15
    s_lshl_b32 s3, s52, 19
    s_add_u32 s16, s4, s3
    s_addc_u32 s17, s5, 0
    s_mov_b32 s18, 524288
    s_mov_b32 s19, 0x20000
    s_add_u32 s20, s6, s3
    s_addc_u32 s21, s7, 0
    s_mov_b32 s22, 524288
    s_mov_b32 s23, 0x20000
    s_mul_i32 s3, s52, 294912
    s_add_u32 s28, s10, s3
    s_addc_u32 s29, s11, 0
    s_mov_b32 s30, 294912
    s_mov_b32 s31, 0x20000
    s_mov_b64 s[4:5], s[64:65]
    s_mov_b64 s[6:7], s[68:69]
    s_mov_b64 s[8:9], s[72:73]
    s_mov_b32 s50, 0
    s_mul_i32 s55, s51, 9216
    s_min_u32 s15, s2, 143
    s_and_b32 s3, s15, 7
    s_mul_i32 s3, s3, 18
    s_lshr_b32 s15, s15, 3
    s_add_u32 s15, s15, s3
    s_lshl_b32 s3, s15, 6
    s_add_u32 s64, s64, s3
    s_addc_u32 s65, s65, 0
    s_mov_b32 s66, 0
    s_mov_b32 s67, 0x20000
    s_add_u32 s68, s68, s3
    s_addc_u32 s69, s69, 0
    s_mov_b32 s70, 0
    s_mov_b32 s71, 0x20000
    s_sub_u32 s14, 5308416, s3
    s_mul_i32 s3, s15, 36864
    s_add_u32 s72, s72, s3
    s_addc_u32 s73, s73, 0
    s_mov_b32 s74, 0
    s_mov_b32 s75, 0x20000
    s_cmp_lt_u32 s2, 144
    s_cselect_b32 s66, s14, 0
    s_cselect_b32 s70, s14, 0
    s_cselect_b32 s74, 36864, 0
    s_mov_b32 s82, 2359296
    s_mov_b32 s83, 0x20000
    v_lshrrev_b32 v13, 4, v0
    v_lshlrev_b32 v9, 6, v13
    v_lshrrev_b32 v14, 2, v0
    v_mul_u32_u24 v14, 1056, v14
    v_add_u32 v14, 16384, v14
    v_and_b32 v15, 1, v0
    v_lshlrev_b32 v15, 4, v15
    v_add_u32 v3, v14, v15
    v_and_b32 v15, 2, v0
    v_lshl_add_u32 v3, v15, 2, v3
    v_add_u32 v4, 73728, v3
    v_lshrrev_b32 v14, 3, v0
    v_lshlrev_b32 v14, 2, v14
    v_add_u32 v14, v14, v12
    v_mul_u32_u24 v14, 4608, v14
    v_and_b32 v15, 7, v0
    v_lshl_add_u32 v7, v15, 4, v14
    v_lshlrev_b32 v10, 4, v15
    v_lshl_add_u32 v10, v13, 7, v10
    v_bfe_u32 v14, v0, 3, 1
    v_mul_u32_u24 v14, 147456, v14
    v_add_u32 v10, v10, v14
    v_lshrrev_b32 v14, 2, v0
    v_mul_u32_u24 v14, 1056, v14
    v_and_b32 v15, 3, v0
    v_lshl_add_u32 v14, v15, 3, v14
    v_add_u32 v2, 107008, v14
    v_and_b32 v14, 15, v0
    v_mul_u32_u24 v14, 1056, v14
    v_lshrrev_b32 v15, 4, v0
    v_lshl_add_u32 v14, v15, 4, v14
    v_add_u32 v1, 90112, v14
    v_and_b32 v14, 1, v0
    v_cmp_eq_u32 vcc, 0, v14
    v_mov_b32 v11, 0xeeeeeeee
    v_mov_b32 v15, 0x44444444
    v_cndmask_b32 v11, v11, v15, vcc
    v_and_b32 v14, 2, v0
    v_cmp_eq_u32 vcc, 0, v14
    v_mov_b32 v15, 0x3f803f80
    s_nop 0
    v_cndmask_b32 v15, 0, v15, vcc
    v_accvgpr_write_b32 a16, v15
    v_accvgpr_write_b32 a56, -1
    v_accvgpr_write_b32 a17, v15
    v_accvgpr_write_b32 a57, -1
    v_accvgpr_write_b32 a18, v15
    v_accvgpr_write_b32 a58, -1
    v_accvgpr_write_b32 a19, v15
    v_accvgpr_write_b32 a59, -1
    v_accvgpr_write_b32 a0, 0
    v_accvgpr_write_b32 a1, 0
    v_accvgpr_write_b32 a2, 0
    v_accvgpr_write_b32 a3, 0
    v_accvgpr_write_b32 a4, 0
    v_accvgpr_write_b32 a5, 0
    v_accvgpr_write_b32 a6, 0
    v_accvgpr_write_b32 a7, 0
    v_accvgpr_write_b32 a8, 0
    v_accvgpr_write_b32 a9, 0
    v_accvgpr_write_b32 a10, 0
    v_accvgpr_write_b32 a11, 0
    v_accvgpr_write_b32 a12, 0
    v_accvgpr_write_b32 a13, 0
    v_accvgpr_write_b32 a14, 0
    v_accvgpr_write_b32 a15, 0
    s_cmp_ge_u32 s2, 8
    s_cbranch_scc1 L2_noclr2
    s_mul_i32 s14, s2, 32
    s_mov_b64 exec, 1
    s_waitcnt vmcnt(6)
    s_barrier
    buffer_store_dword v60, v156, s[60:63], s14 offen sc1
    s_mov_b64 exec, -1
L2_noclr2:
    s_waitcnt vmcnt(6)
    v_lshlrev_b32 v24, 16, v64
    v_and_b32 v25, 0xffff0000, v64
    v_lshlrev_b32 v26, 16, v65
    v_and_b32 v27, 0xffff0000, v65
    v_lshlrev_b32 v28, 16, v66
    v_and_b32 v29, 0xffff0000, v66
    v_lshlrev_b32 v30, 16, v67
    v_and_b32 v31, 0xffff0000, v67
    v_lshlrev_b32 v32, 16, v68
    v_and_b32 v33, 0xffff0000, v68
    v_lshlrev_b32 v34, 16, v69
    v_and_b32 v35, 0xffff0000, v69
    v_lshlrev_b32 v36, 16, v70
    v_and_b32 v37, 0xffff0000, v70
    v_lshlrev_b32 v38, 16, v71
    v_and_b32 v39, 0xffff0000, v71
    v_lshlrev_b32 v40, 16, v72
    v_and_b32 v41, 0xffff0000, v72
    v_lshlrev_b32 v42, 16, v73
    v_and_b32 v43, 0xffff0000, v73
    v_lshlrev_b32 v44, 16, v74
    v_and_b32 v45, 0xffff0000, v74
    v_lshlrev_b32 v46, 16, v75
    v_and_b32 v47, 0xffff0000, v75
    v_pk_add_f32 v[12:13], v[24:25], v[26:27]
    v_pk_add_f32 v[12:13], v[12:13], v[28:29]
    v_pk_add_f32 v[12:13], v[12:13], v[30:31]
    v_pk_add_f32 v[12:13], v[12:13], v[32:33]
    v_pk_add_f32 v[12:13], v[12:13], v[34:35]
    v_pk_add_f32 v[12:13], v[12:13], v[36:37]
    v_pk_add_f32 v[12:13], v[12:13], v[38:39]
    v_pk_add_f32 v[14:15], v[40:41], v[42:43]
    v_pk_add_f32 v[14:15], v[14:15], v[44:45]
    v_pk_add_f32 v[14:15], v[14:15], v[46:47]
    v_add_f32 v48, v12, v13
    v_add_f32 v14, v14, v15
    v_fmac_f32 v48, 0x3e800000, v14
    s_nop 1
    v_add_f32_dpp v48, v48, v48 row_ror:8 row_mask:0xf bank_mask:0xf
    v_mov_b32 v50, v48
    s_nop 1
    v_permlane16_swap_b32 v50, v48
    v_add_f32 v48, v48, v50
    v_mov_b32 v50, v48
    s_nop 1
    v_permlane32_swap_b32 v50, v48
    v_add_f32 v48, v48, v50
    v_mul_f32 v48, 0x3be38e39, v48
    v_pk_add_f32 v[24:25], v[24:25], v[48:49] op_sel_hi:[1,0] neg_lo:[0,1] neg_hi:[0,1]
    v_pk_add_f32 v[26:27], v[26:27], v[48:49] op_sel_hi:[1,0] neg_lo:[0,1] neg_hi:[0,1]
    v_pk_add_f32 v[28:29], v[28:29], v[48:49] op_sel_hi:[1,0] neg_lo:[0,1] neg_hi:[0,1]
    v_pk_add_f32 v[30:31], v[30:31], v[48:49] op_sel_hi:[1,0] neg_lo:[0,1] neg_hi:[0,1]
    v_pk_add_f32 v[32:33], v[32:33], v[48:49] op_sel_hi:[1,0] neg_lo:[0,1] neg_hi:[0,1]
    v_pk_add_f32 v[34:35], v[34:35], v[48:49] op_sel_hi:[1,0] neg_lo:[0,1] neg_hi:[0,1]
    v_pk_add_f32 v[36:37], v[36:37], v[48:49] op_sel_hi:[1,0] neg_lo:[0,1] neg_hi:[0,1]
    v_pk_add_f32 v[38:39], v[38:39], v[48:49] op_sel_hi:[1,0] neg_lo:[0,1] neg_hi:[0,1]
    v_pk_add_f32 v[40:41], v[40:41], v[48:49] op_sel_hi:[1,0] neg_lo:[0,1] neg_hi:[0,1]
    v_pk_add_f32 v[42:43], v[42:43], v[48:49] op_sel_hi:[1,0] neg_lo:[0,1] neg_hi:[0,1]
    v_pk_add_f32 v[44:45], v[44:45], v[48:49] op_sel_hi:[1,0] neg_lo:[0,1] neg_hi:[0,1]
    v_pk_add_f32 v[46:47], v[46:47], v[48:49] op_sel_hi:[1,0] neg_lo:[0,1] neg_hi:[0,1]
    v_pk_mul_f32 v[12:13], v[24:25], v[24:25]
    v_pk_fma_f32 v[12:13], v[26:27], v[26:27], v[12:13]
    v_pk_fma_f32 v[12:13], v[28:29], v[28:29], v[12:13]
    v_pk_fma_f32 v[12:13], v[30:31], v[30:31], v[12:13]
    v_pk_fma_f32 v[12:13], v[32:33], v[32:33], v[12:13]
    v_pk_fma_f32 v[12:13], v[34:35], v[34:35], v[12:13]
    v_pk_fma_f32 v[12:13], v[36:37], v[36:37], v[12:13]
    v_pk_fma_f32 v[12:13], v[38:39], v[38:39], v[12:13]
    v_pk_mul_f32 v[14:15], v[40:41], v[40:41]
    v_pk_fma_f32 v[14:15], v[42:43], v[42:43], v[14:15]
    v_pk_fma_f32 v[14:15], v[44:45], v[44:45], v[14:15]
    v_pk_fma_f32 v[14:15], v[46:47], v[46:47], v[14:15]
    v_add_f32 v49, v12, v13
    v_add_f32 v14, v14, v15
    v_fmac_f32 v49, 0x3e800000, v14
    s_nop 1
    v_add_f32_dpp v49, v49, v49 row_ror:8 row_mask:0xf bank_mask:0xf
    v_mov_b32 v50, v49
    s_nop 1
    v_permlane16_swap_b32 v50, v49
    v_add_f32 v49, v49, v50
    v_mov_b32 v50, v49
    s_nop 1
    v_permlane32_swap_b32 v50, v49
    v_add_f32 v49, v49, v50
    ds_write_b32 v158, v48
    ds_write_b32 v158, v49 offset:128
    s_waitcnt lgkmcnt(0)
    s_barrier
    ds_read_b128 v[16:19], v157
    ds_read_b128 v[20:23], v157 offset:128
    s_add_u32 s14, s58, 4096
    s_waitcnt lgkmcnt(1)
    v_add_f32 v12, v16, v17
    v_add_f32 v13, v18, v19
    v_add_f32 v12, v12, v13
    v_mul_f32 v12, 0x3e800000, v12
    v_sub_f32 v16, v16, v12
    v_sub_f32 v17, v17, v12
    v_sub_f32 v18, v18, v12
    v_sub_f32 v19, v19, v12
    v_sub_f32 v48, v48, v12
    v_mul_f32 v13, v16, v16
    v_fmac_f32 v13, v17, v17
    v_fmac_f32 v13, v18, v18
    v_fmac_f32 v13, v19, v19
    s_waitcnt lgkmcnt(0)
    v_add_f32 v14, v20, v21
    v_add_f32 v15, v22, v23
    v_add_f32 v14, v14, v15
    v_fmac_f32 v14, 0x43100000, v13
    v_mov_b32 v12, 0x3727c5ac
    v_fmac_f32 v12, 0x3ae38e39, v14
    v_rsq_f32 v12, v12
    s_nop 0
    v_mul_f32 v48, v48, v12
    v_pk_fma_f32 v[24:25], v[24:25], v[12:13], v[48:49] op_sel_hi:[1,0,0]
    v_pk_fma_f32 v[26:27], v[26:27], v[12:13], v[48:49] op_sel_hi:[1,0,0]
    v_pk_fma_f32 v[28:29], v[28:29], v[12:13], v[48:49] op_sel_hi:[1,0,0]
    v_pk_fma_f32 v[30:31], v[30:31], v[12:13], v[48:49] op_sel_hi:[1,0,0]
    v_cvt_pk_f16_f32 v64, v24, v25
    v_cvt_pk_f16_f32 v65, v26, v27
    v_cvt_pk_f16_f32 v66, v28, v29
    v_cvt_pk_f16_f32 v67, v30, v31
    buffer_store_dwordx4 v[64:67], v159, s[84:87], s58 offen offset:0 sc1
    v_pk_fma_f32 v[32:33], v[32:33], v[12:13], v[48:49] op_sel_hi:[1,0,0]
    v_pk_fma_f32 v[34:35], v[34:35], v[12:13], v[48:49] op_sel_hi:[1,0,0]
    v_pk_fma_f32 v[36:37], v[36:37], v[12:13], v[48:49] op_sel_hi:[1,0,0]
    v_pk_fma_f32 v[38:39], v[38:39], v[12:13], v[48:49] op_sel_hi:[1,0,0]
    v_cvt_pk_f16_f32 v68, v32, v33
    v_cvt_pk_f16_f32 v69, v34, v35
    v_cvt_pk_f16_f32 v70, v36, v37
    v_cvt_pk_f16_f32 v71, v38, v39
    buffer_store_dwordx4 v[68:71], v159, s[84:87], s58 offen offset:2048 sc1
    v_pk_fma_f32 v[40:41], v[40:41], v[12:13], v[48:49] op_sel_hi:[1,0,0]
    v_pk_fma_f32 v[42:43], v[42:43], v[12:13], v[48:49] op_sel_hi:[1,0,0]
    v_pk_fma_f32 v[44:45], v[44:45], v[12:13], v[48:49] op_sel_hi:[1,0,0]
    v_pk_fma_f32 v[46:47], v[46:47], v[12:13], v[48:49] op_sel_hi:[1,0,0]
    v_cvt_pk_f16_f32 v72, v40, v41
    v_cvt_pk_f16_f32 v73, v42, v43
    v_cvt_pk_f16_f32 v74, v44, v45
    v_cvt_pk_f16_f32 v75, v46, v47
    s_mov_b64 exec, 0xffff
    buffer_store_dwordx4 v[72:75], v159, s[84:87], s14 offen offset:0 sc1
    buffer_store_dwordx4 v[56:59], v8, s[84:87], s56 offen sc1
    s_mov_b64 exec, 0xff
    buffer_store_dwordx4 v[60:63], v160, s[84:87], s57 offen offset:1024 sc1
    s_mov_b64 exec, -1
    buffer_store_dwordx4 v[60:63], v160, s[84:87], s57 offen sc1
    s_mov_b64 exec, 255
    buffer_load_dword v51, v156, s[60:63], 0 offen sc1
    s_mov_b64 exec, -1
    s_mul_i32 s3, s96, 147456
    s_add_u32 s3, s3, 8392704
    s_add_u32 s88, s12, s3
    s_addc_u32 s89, s13, 0
    s_mov_b32 s90, 143360
    s_mov_b32 s91, 0x20000
    s_waitcnt vmcnt(7)
    v_lshlrev_b32 v40, 16, v148
    v_and_b32 v41, 0xffff0000, v148
    v_lshlrev_b32 v42, 16, v149
    v_and_b32 v43, 0xffff0000, v149
    v_lshlrev_b32 v44, 16, v150
    v_mul_f32 v16, 0xbfb8aa3b, v40
    v_mul_f32 v17, 0xbfb8aa3b, v41
    v_mul_f32 v18, 0xbfb8aa3b, v42
    v_mul_f32 v19, 0xbfb8aa3b, v43
    v_mul_f32 v20, 0xbfb8aa3b, v44
    v_exp_f32 v16, v16
    v_exp_f32 v17, v17
    v_exp_f32 v18, v18
    v_exp_f32 v19, v19
    v_exp_f32 v20, v20
    v_add_f32 v16, 1.0, v16
    v_add_f32 v17, 1.0, v17
    v_add_f32 v18, 1.0, v18
    v_add_f32 v19, 1.0, v19
    v_add_f32 v20, 1.0, v20
    v_rcp_f32 v16, v16
    v_rcp_f32 v17, v17
    v_rcp_f32 v18, v18
    v_rcp_f32 v19, v19
    v_rcp_f32 v20, v20
    v_mul_f32 v24, v40, v16
    v_mul_f32 v26, v41, v17
    v_mul_f32 v28, v42, v18
    v_mul_f32 v30, v43, v19
    v_mul_f32 v32, v44, v20
    v_lshlrev_b32 v12, 16, v128
    v_and_b32 v13, 0xffff0000, v128
    v_pk_mul_f32 v[16:17], v[12:13], v[24:25] op_sel_hi:[1,0]
    v_lshlrev_b32 v14, 16, v129
    v_and_b32 v15, 0xffff0000, v129
    v_pk_mul_f32 v[18:19], v[14:15], v[24:25] op_sel_hi:[1,0]
    v_lshlrev_b32 v12, 16, v130
    v_and_b32 v13, 0xffff0000, v130
    v_pk_mul_f32 v[20:21], v[12:13], v[24:25] op_sel_hi:[1,0]
    v_lshlrev_b32 v14, 16, v131
    v_and_b32 v15, 0xffff0000, v131
    v_pk_mul_f32 v[22:23], v[14:15], v[24:25] op_sel_hi:[1,0]
    v_lshlrev_b32 v12, 16, v132
    v_and_b32 v13, 0xffff0000, v132
    v_pk_fma_f32 v[16:17], v[12:13], v[26:27], v[16:17] op_sel_hi:[1,0,1]
    v_lshlrev_b32 v14, 16, v133
    v_and_b32 v15, 0xffff0000, v133
    v_pk_fma_f32 v[18:19], v[14:15], v[26:27], v[18:19] op_sel_hi:[1,0,1]
    v_lshlrev_b32 v12, 16, v134
    v_and_b32 v13, 0xffff0000, v134
    v_pk_fma_f32 v[20:21], v[12:13], v[26:27], v[20:21] op_sel_hi:[1,0,1]
    v_lshlrev_b32 v14, 16, v135
    v_and_b32 v15, 0xffff0000, v135
    v_pk_fma_f32 v[22:23], v[14:15], v[26:27], v[22:23] op_sel_hi:[1,0,1]
    v_lshlrev_b32 v12, 16, v136
    v_and_b32 v13, 0xffff0000, v136
    v_pk_fma_f32 v[16:17], v[12:13], v[28:29], v[16:17] op_sel_hi:[1,0,1]
    v_lshlrev_b32 v14, 16, v137
    v_and_b32 v15, 0xffff0000, v137
    v_pk_fma_f32 v[18:19], v[14:15], v[28:29], v[18:19] op_sel_hi:[1,0,1]
    v_lshlrev_b32 v12, 16, v138
    v_and_b32 v13, 0xffff0000, v138
    v_pk_fma_f32 v[20:21], v[12:13], v[28:29], v[20:21] op_sel_hi:[1,0,1]
    v_lshlrev_b32 v14, 16, v139
    v_and_b32 v15, 0xffff0000, v139
    v_pk_fma_f32 v[22:23], v[14:15], v[28:29], v[22:23] op_sel_hi:[1,0,1]
    v_lshlrev_b32 v12, 16, v140
    v_and_b32 v13, 0xffff0000, v140
    v_pk_fma_f32 v[16:17], v[12:13], v[30:31], v[16:17] op_sel_hi:[1,0,1]
    v_lshlrev_b32 v14, 16, v141
    v_and_b32 v15, 0xffff0000, v141
    v_pk_fma_f32 v[18:19], v[14:15], v[30:31], v[18:19] op_sel_hi:[1,0,1]
    v_lshlrev_b32 v12, 16, v142
    v_and_b32 v13, 0xffff0000, v142
    v_pk_fma_f32 v[20:21], v[12:13], v[30:31], v[20:21] op_sel_hi:[1,0,1]
    v_lshlrev_b32 v14, 16, v143
    v_and_b32 v15, 0xffff0000, v143
    v_pk_fma_f32 v[22:23], v[14:15], v[30:31], v[22:23] op_sel_hi:[1,0,1]
    v_lshlrev_b32 v12, 16, v144
    v_and_b32 v13, 0xffff0000, v144
    v_pk_fma_f32 v[16:17], v[12:13], v[32:33], v[16:17] op_sel_hi:[1,0,1]
    v_lshlrev_b32 v14, 16, v145
    v_and_b32 v15, 0xffff0000, v145
    v_pk_fma_f32 v[18:19], v[14:15], v[32:33], v[18:19] op_sel_hi:[1,0,1]
    v_lshlrev_b32 v12, 16, v146
    v_and_b32 v13, 0xffff0000, v146
    v_pk_fma_f32 v[20:21], v[12:13], v[32:33], v[20:21] op_sel_hi:[1,0,1]
    v_lshlrev_b32 v14, 16, v147
    v_and_b32 v15, 0xffff0000, v147
    v_pk_fma_f32 v[22:23], v[14:15], v[32:33], v[22:23] op_sel_hi:[1,0,1]
    v_add_f32_dpp v16, v16, v16 row_ror:4 row_mask:0xf bank_mask:0xf
    v_add_f32_dpp v17, v17, v17 row_ror:4 row_mask:0xf bank_mask:0xf
    v_add_f32_dpp v18, v18, v18 row_ror:4 row_mask:0xf bank_mask:0xf
    v_add_f32_dpp v19, v19, v19 row_ror:4 row_mask:0xf bank_mask:0xf
    v_add_f32_dpp v20, v20, v20 row_ror:4 row_mask:0xf bank_mask:0xf
    v_add_f32_dpp v21, v21, v21 row_ror:4 row_mask:0xf bank_mask:0xf
    v_add_f32_dpp v22, v22, v22 row_ror:4 row_mask:0xf bank_mask:0xf
    v_add_f32_dpp v23, v23, v23 row_ror:4 row_mask:0xf bank_mask:0xf
    v_add_f32_dpp v16, v16, v16 row_ror:8 row_mask:0xf bank_mask:0xf
    v_add_f32_dpp v17, v17, v17 row_ror:8 row_mask:0xf bank_mask:0xf
    v_add_f32_dpp v18, v18, v18 row_ror:8 row_mask:0xf bank_mask:0xf
    v_add_f32_dpp v19, v19, v19 row_ror:8 row_mask:0xf bank_mask:0xf
    v_add_f32_dpp v20, v20, v20 row_ror:8 row_mask:0xf bank_mask:0xf
    v_add_f32_dpp v21, v21, v21 row_ror:8 row_mask:0xf bank_mask:0xf
    v_add_f32_dpp v22, v22, v22 row_ror:8 row_mask:0xf bank_mask:0xf
    v_add_f32_dpp v23, v23, v23 row_ror:8 row_mask:0xf bank_mask:0xf
    s_mov_b32 exec_lo, 0xf000f
    s_mov_b32 exec_hi, 0xf000f
    ds_write_b128 v161, v[16:19] offset:16384
    ds_write_b128 v161, v[20:23] offset:16400
    s_mov_b64 exec, 255
    s_waitcnt vmcnt(0)
    v_cmp_eq_u32 vcc, s51, v51
    s_nop 0
    s_cmp_lg_u64 vcc, 0
    s_cbranch_scc1 L2_p0s
L2_p0r:
    s_mov_b64 exec, 1
    s_waitcnt lgkmcnt(0)
    s_barrier
    buffer_store_dword v60, v156, s[84:87], s101 offen sc1
    s_mov_b64 exec, -1
    ds_read_b32 v24, v162 offset:16384
    ds_read_b32 v25, v162 offset:16640
    ds_read_b32 v26, v162 offset:16896
    ds_read_b32 v27, v162 offset:17152
    ds_read_b32 v28, v162 offset:17408
    ds_read_b32 v29, v162 offset:17664
    ds_read_b32 v30, v162 offset:17920
    ds_read_b32 v31, v162 offset:18176
    s_waitcnt lgkmcnt(0)
    v_pk_add_f32 v[24:25], v[24:25], v[26:27]
    v_pk_add_f32 v[28:29], v[28:29], v[30:31]
    v_pk_add_f32 v[24:25], v[24:25], v[28:29]
    v_add_f32 v52, v24, v25
    v_mov_b32 v53, v52
    v_mov_b32 v54, s48
    s_nop 0
    v_permlane32_swap_b32 v53, v52
    v_add_f32 v52, v52, v53
    v_fma_f32 v52, v52, s47, v54
    v_min_u32 v52, -2, v52
    s_mov_b32 exec_hi, 0
    buffer_store_dword v52, v164, s[84:87], s100 offen sc1
    s_mov_b64 exec, -1
    s_add_u32 m0, s44, 36864
    s_mov_b32 s45, 0
    buffer_load_dwordx4 v6, s[24:27], s45 offen lds
    s_add_u32 m0, s44, 37920
    s_mov_b32 s45, 8192
    buffer_load_dwordx4 v6, s[24:27], s45 offen lds
    s_add_u32 m0, s44, 38976
    s_mov_b32 s45, 16384
    buffer_load_dwordx4 v6, s[24:27], s45 offen lds
    s_add_u32 m0, s44, 40032
    s_mov_b32 s45, 24576
    buffer_load_dwordx4 v6, s[24:27], s45 offen lds
    s_add_u32 m0, s44, 53760
    s_mov_b32 s45, 262144
    buffer_load_dwordx4 v6, s[24:27], s45 offen lds
    s_add_u32 m0, s44, 54816
    s_mov_b32 s45, 270336
    buffer_load_dwordx4 v6, s[24:27], s45 offen lds
    s_add_u32 m0, s44, 55872
    s_mov_b32 s45, 278528
    buffer_load_dwordx4 v6, s[24:27], s45 offen lds
    s_add_u32 m0, s44, 56928
    s_mov_b32 s45, 286720
    buffer_load_dwordx4 v6, s[24:27], s45 offen lds
    s_add_u32 m0, s44, 73728
    s_mov_b32 s45, 524288
    buffer_load_dwordx4 v6, s[24:27], s45 offen lds
    s_add_u32 m0, s44, 74784
    s_mov_b32 s45, 532480
    buffer_load_dwordx4 v6, s[24:27], s45 offen lds
    s_add_u32 m0, s44, 75840
    s_mov_b32 s45, 540672
    buffer_load_dwordx4 v6, s[24:27], s45 offen lds
    s_add_u32 m0, s44, 76896
    s_mov_b32 s45, 548864
    buffer_load_dwordx4 v6, s[24:27], s45 offen lds
    s_add_u32 m0, s44, 90624
    s_mov_b32 s45, 786432
    buffer_load_dwordx4 v6, s[24:27], s45 offen lds
    s_add_u32 m0, s44, 91680
    s_mov_b32 s45, 794624
    buffer_load_dwordx4 v6, s[24:27], s45 offen lds
    s_add_u32 m0, s44, 92736
    s_mov_b32 s45, 802816
    buffer_load_dwordx4 v6, s[24:27], s45 offen lds
    s_add_u32 m0, s44, 93792
    s_mov_b32 s45, 811008
    buffer_load_dwordx4 v6, s[24:27], s45 offen lds
    s_mov_b64 exec, 0
    s_cmp_eq_u32 s51, 0
    s_cbranch_scc1 L2_pad0
    s_cmp_eq_u32 s51, 1
    s_cbranch_scc1 L2_pad1
    s_cmp_eq_u32 s51, 2
    s_cbranch_scc1 L2_pad2
    s_branch L2_pad3
.p2align 12
L2_walkret:
    s_mov_b64 exec, 15
    s_mov_b32 s97, 0x20000
L2_px:
    buffer_load_dword v13, v163, s[84:87], s59 offen sc1
    s_waitcnt vmcnt(0)
    v_cmp_eq_u32 vcc, 0, v13
    s_sub_u32 s97, s97, 1
    s_cselect_b64 vcc, 0, vcc
    s_cmp_eq_u64 vcc, 0
    s_cbranch_scc1 L2_px_ok
    s_sleep 1
    s_branch L2_px
L2_px_ok:
    s_mov_b64 exec, -1
    s_movk_i32 s14, 13824
    buffer_load_dwordx4 v[168:171], v166, s[84:87], 0 offen sc1
    buffer_load_dwordx4 v[176:179], v166, s[84:87], s14 offen sc1
    s_mov_b64 exec, 0xff
    buffer_load_dwordx4 v[172:175], v166, s[84:87], 0 offen offset:1024 sc1
    buffer_load_dwordx4 v[180:183], v166, s[84:87], s14 offen offset:1024 sc1
    s_mov_b64 exec, -1
    s_mov_b32 s54, 0
    buffer_load_dwordx4 v[80:83], v8, s[32:35], s54 offen sc1
    s_mov_b32 s54, 1024
    buffer_load_dwordx4 v[84:87], v8, s[32:35], s54 offen sc1
    s_mov_b32 s54, 18432
    buffer_load_dwordx4 v[88:91], v8, s[32:35], s54 offen sc1
    s_mov_b32 s54, 19456
    buffer_load_dwordx4 v[92:95], v8, s[32:35], s54 offen sc1
    s_mov_b32 s54, 2048
    buffer_load_dwordx4 v[96:99], v8, s[32:35], s54 offen sc1
    s_mov_b32 s54, 3072
    buffer_load_dwordx4 v[100:103], v8, s[32:35], s54 offen sc1
    s_mov_b32 s54, 20480
    buffer_load_dwordx4 v[104:107], v8, s[32:35], s54 offen sc1
    s_mov_b32 s54, 21504
    buffer_load_dwordx4 v[108:111], v8, s[32:35], s54 offen sc1
    s_waitcnt vmcnt(8)
    v_max_u32 v13, v168, v169
    v_max3_u32 v13, v13, v170, v171
    v_max3_u32 v13, v13, v172, v173
    v_max3_u32 v13, v13, v174, v175
    v_max3_u32 v13, v13, v176, v177
    v_max3_u32 v13, v13, v178, v179
    v_max3_u32 v13, v13, v180, v181
    v_max3_u32 v13, v13, v182, v183
    v_cmp_eq_u32 vcc, -1, v13
    s_nop 0
    s_cmp_lg_u64 vcc, 0
    s_cbranch_scc1 L2_pms
L2_pmr:
    v_pk_add_f32 v[168:169], v[168:169], v[176:177]
    v_pk_add_f32 v[170:171], v[170:171], v[178:179]
    v_pk_add_f32 v[172:173], v[172:173], v[180:181]
    v_pk_add_f32 v[174:175], v[174:175], v[182:183]
    ds_write_b128 v167, v[168:171]
    s_mov_b64 exec, 0xff
    ds_write_b128 v167, v[172:175] offset:2048
    s_mov_b64 exec, -1
    s_mov_b32 s54, 4096
    buffer_load_dwordx4 v[112:115], v8, s[32:35], s54 offen sc1
    s_mov_b32 s54, 5120
    buffer_load_dwordx4 v[116:119], v8, s[32:35], s54 offen sc1
    s_mov_b32 s54, 22528
    buffer_load_dwordx4 v[120:123], v8, s[32:35], s54 offen sc1
    s_mov_b32 s54, 23552
    buffer_load_dwordx4 v[124:127], v8, s[32:35], s54 offen sc1
    s_waitcnt lgkmcnt(0)
    s_barrier
    ds_read_b128 v[16:19], v9 offset:9216
    ds_read_b128 v[20:23], v9 offset:9248
    ds_read_b128 v[24:27], v9 offset:9232
    ds_read_b128 v[28:31], v9 offset:9264
    s_waitcnt vmcnt(8)
    s_waitcnt lgkmcnt(2)
    v_fma_mix_f32 v32, v80, v16, v20 op_sel:[0,0,0] op_sel_hi:[1,0,0]
    v_fma_mix_f32 v33, v80, v17, v21 op_sel:[1,0,0] op_sel_hi:[1,0,0]
    v_fma_mix_f32 v34, v81, v18, v22 op_sel:[0,0,0] op_sel_hi:[1,0,0]
    v_fma_mix_f32 v35, v81, v19, v23 op_sel:[1,0,0] op_sel_hi:[1,0,0]
    v_cvt_pk_bf16_f32 v80, v32, v33
    v_cvt_pk_bf16_f32 v81, v34, v35
    v_fma_mix_f32 v36, v88, v16, v20 op_sel:[0,0,0] op_sel_hi:[1,0,0]
    v_fma_mix_f32 v37, v88, v17, v21 op_sel:[1,0,0] op_sel_hi:[1,0,0]
    v_fma_mix_f32 v38, v89, v18, v22 op_sel:[0,0,0] op_sel_hi:[1,0,0]
    v_fma_mix_f32 v39, v89, v19, v23 op_sel:[1,0,0] op_sel_hi:[1,0,0]
    v_cvt_pk_bf16_f32 v88, v36, v37
    v_cvt_pk_bf16_f32 v89, v38, v39
    ds_read_b128 v[16:19], v9 offset:9472
    ds_read_b128 v[20:23], v9 offset:9504
    s_waitcnt lgkmcnt(2)
    v_fma_mix_f32 v32, v82, v24, v28 op_sel:[0,0,0] op_sel_hi:[1,0,0]
    v_fma_mix_f32 v33, v82, v25, v29 op_sel:[1,0,0] op_sel_hi:[1,0,0]
    v_fma_mix_f32 v34, v83, v26, v30 op_sel:[0,0,0] op_sel_hi:[1,0,0]
    v_fma_mix_f32 v35, v83, v27, v31 op_sel:[1,0,0] op_sel_hi:[1,0,0]
    v_cvt_pk_bf16_f32 v82, v32, v33
    v_cvt_pk_bf16_f32 v83, v34, v35
    v_fma_mix_f32 v36, v90, v24, v28 op_sel:[0,0,0] op_sel_hi:[1,0,0]
    v_fma_mix_f32 v37, v90, v25, v29 op_sel:[1,0,0] op_sel_hi:[1,0,0]
    v_fma_mix_f32 v38, v91, v26, v30 op_sel:[0,0,0] op_sel_hi:[1,0,0]
    v_fma_mix_f32 v39, v91, v27, v31 op_sel:[1,0,0] op_sel_hi:[1,0,0]
    v_cvt_pk_bf16_f32 v90, v36, v37
    v_cvt_pk_bf16_f32 v91, v38, v39
    ds_read_b128 v[24:27], v9 offset:9488
    ds_read_b128 v[28:31], v9 offset:9520
    s_waitcnt lgkmcnt(2)
    v_fma_mix_f32 v32, v84, v16, v20 op_sel:[0,0,0] op_sel_hi:[1,0,0]
    v_fma_mix_f32 v33, v84, v17, v21 op_sel:[1,0,0] op_sel_hi:[1,0,0]
    v_fma_mix_f32 v34, v85, v18, v22 op_sel:[0,0,0] op_sel_hi:[1,0,0]
    v_fma_mix_f32 v35, v85, v19, v23 op_sel:[1,0,0] op_sel_hi:[1,0,0]
    v_cvt_pk_bf16_f32 v84, v32, v33
    v_cvt_pk_bf16_f32 v85, v34, v35
    v_fma_mix_f32 v36, v92, v16, v20 op_sel:[0,0,0] op_sel_hi:[1,0,0]
    v_fma_mix_f32 v37, v92, v17, v21 op_sel:[1,0,0] op_sel_hi:[1,0,0]
    v_fma_mix_f32 v38, v93, v18, v22 op_sel:[0,0,0] op_sel_hi:[1,0,0]
    v_fma_mix_f32 v39, v93, v19, v23 op_sel:[1,0,0] op_sel_hi:[1,0,0]
    v_cvt_pk_bf16_f32 v92, v36, v37
    v_cvt_pk_bf16_f32 v93, v38, v39
    ds_read_b128 v[16:19], v9 offset:9728
    ds_read_b128 v[20:23], v9 offset:9760
    ds_read_b64_tr_b16 a[192:193], v3 offset:36864
    ds_read_b64_tr_b16 a[194:195], v3 offset:37376
    ds_read_b64_tr_b16 a[196:197], v3 offset:53760
    ds_read_b64_tr_b16 a[198:199], v3 offset:54272
    ds_read_b64_tr_b16 a[200:201], v3 offset:36896
    ds_read_b64_tr_b16 a[202:203], v3 offset:37408
    ds_read_b64_tr_b16 a[204:205], v3 offset:53792
    ds_read_b64_tr_b16 a[206:207], v3 offset:54304
    ds_read_b64_tr_b16 a[208:209], v3 offset:36928
    ds_read_b64_tr_b16 a[210:211], v3 offset:37440
    ds_read_b64_tr_b16 a[212:213], v3 offset:53824
    ds_read_b64_tr_b16 a[214:215], v3 offset:54336
    s_waitcnt lgkmcnt(14)
    v_fma_mix_f32 v32, v86, v24, v28 op_sel:[0,0,0] op_sel_hi:[1,0,0]
    v_fma_mix_f32 v33, v86, v25, v29 op_sel:[1,0,0] op_sel_hi:[1,0,0]
    v_fma_mix_f32 v34, v87, v26, v30 op_sel:[0,0,0] op_sel_hi:[1,0,0]
    v_fma_mix_f32 v35, v87, v27, v31 op_sel:[1,0,0] op_sel_hi:[1,0,0]
    v_cvt_pk_bf16_f32 v86, v32, v33
    v_cvt_pk_bf16_f32 v87, v34, v35
    v_fma_mix_f32 v36, v94, v24, v28 op_sel:[0,0,0] op_sel_hi:[1,0,0]
    v_fma_mix_f32 v37, v94, v25, v29 op_sel:[1,0,0] op_sel_hi:[1,0,0]
    v_fma_mix_f32 v38, v95, v26, v30 op_sel:[0,0,0] op_sel_hi:[1,0,0]
    v_fma_mix_f32 v39, v95, v27, v31 op_sel:[1,0,0] op_sel_hi:[1,0,0]
    v_cvt_pk_bf16_f32 v94, v36, v37
    v_cvt_pk_bf16_f32 v95, v38, v39
    s_waitcnt lgkmcnt(8)
    v_mfma_f32_16x16x32_bf16 v[128:131], a[192:195], v[80:83], 0
    s_waitcnt vmcnt(4)
    ds_read_b64_tr_b16 a[216:217], v3 offset:36960
    ds_read_b128 v[24:27], v9 offset:9744
    v_mfma_f32_16x16x32_bf16 v[128:131], a[196:199], v[84:87], v[128:131]
    ds_read_b64_tr_b16 a[218:219], v3 offset:37472
    ds_read_b64_tr_b16 a[220:221], v3 offset:53856
    v_fma_mix_f32 v32, v96, v16, v20 op_sel:[0,0,0] op_sel_hi:[1,0,0]
    v_mfma_f32_16x16x32_bf16 v[160:163], a[192:195], v[88:91], 0
    s_add_u32 m0, s44, 110592
    ds_read_b64_tr_b16 a[222:223], v3 offset:54368
    ds_read_b128 v[28:31], v9 offset:9776
    v_mfma_f32_16x16x32_bf16 v[160:163], a[196:199], v[92:95], v[160:163]
    s_mov_b32 s45, 1048576
    s_waitcnt lgkmcnt(10)
    buffer_load_dwordx4 v6, s[24:27], s45 offen lds
    v_mfma_f32_16x16x32_bf16 v[132:135], a[200:203], v[80:83], 0
    ds_read_b64_tr_b16 a[224:225], v3 offset:36992
    v_fma_mix_f32 v33, v96, v17, v21 op_sel:[1,0,0] op_sel_hi:[1,0,0]
    v_mfma_f32_16x16x32_bf16 v[132:135], a[204:207], v[84:87], v[132:135]
    ds_read_b64_tr_b16 a[226:227], v3 offset:37504
    ds_read_b64_tr_b16 a[228:229], v3 offset:53888
    v_fma_mix_f32 v34, v97, v18, v22 op_sel:[0,0,0] op_sel_hi:[1,0,0]
    v_mfma_f32_16x16x32_bf16 v[164:167], a[200:203], v[88:91], 0
    s_add_u32 m0, s44, 111648
    ds_read_b64_tr_b16 a[230:231], v3 offset:54400
    v_fma_mix_f32 v35, v97, v19, v23 op_sel:[1,0,0] op_sel_hi:[1,0,0]
    v_mfma_f32_16x16x32_bf16 v[164:167], a[204:207], v[92:95], v[164:167]
    s_mov_b32 s45, 1056768
    s_waitcnt lgkmcnt(10)
    buffer_load_dwordx4 v6, s[24:27], s45 offen lds
    v_mfma_f32_16x16x32_bf16 v[136:139], a[208:211], v[80:83], 0
    ds_read_b64_tr_b16 a[232:233], v3 offset:37024
    v_cvt_pk_bf16_f32 v96, v32, v33
    v_mfma_f32_16x16x32_bf16 v[136:139], a[212:215], v[84:87], v[136:139]
    ds_read_b64_tr_b16 a[234:235], v3 offset:37536
    ds_read_b64_tr_b16 a[236:237], v3 offset:53920
    v_cvt_pk_bf16_f32 v97, v34, v35
    v_mfma_f32_16x16x32_bf16 v[168:171], a[208:211], v[88:91], 0
    s_add_u32 m0, s44, 112704
    ds_read_b64_tr_b16 a[238:239], v3 offset:54432
    v_fma_mix_f32 v36, v104, v16, v20 op_sel:[0,0,0] op_sel_hi:[1,0,0]
    v_mfma_f32_16x16x32_bf16 v[168:171], a[212:215], v[92:95], v[168:171]
    s_mov_b32 s45, 1064960
    s_waitcnt lgkmcnt(9)
    buffer_load_dwordx4 v6, s[24:27], s45 offen lds
    v_fma_mix_f32 v37, v104, v17, v21 op_sel:[1,0,0] op_sel_hi:[1,0,0]
    v_mfma_f32_16x16x32_bf16 v[140:143], a[216:219], v[80:83], 0
    ds_read_b64_tr_b16 a[240:241], v3 offset:37056
    v_fma_mix_f32 v38, v105, v18, v22 op_sel:[0,0,0] op_sel_hi:[1,0,0]
    v_mfma_f32_16x16x32_bf16 v[140:143], a[220:223], v[84:87], v[140:143]
    ds_read_b64_tr_b16 a[242:243], v3 offset:37568
    ds_read_b64_tr_b16 a[244:245], v3 offset:53952
    v_fma_mix_f32 v39, v105, v19, v23 op_sel:[1,0,0] op_sel_hi:[1,0,0]
    v_mfma_f32_16x16x32_bf16 v[172:175], a[216:219], v[88:91], 0
    s_add_u32 m0, s44, 113760
    ds_read_b64_tr_b16 a[246:247], v3 offset:54464
    v_cvt_pk_bf16_f32 v104, v36, v37
    v_mfma_f32_16x16x32_bf16 v[172:175], a[220:223], v[92:95], v[172:175]
    s_mov_b32 s45, 1073152
    s_waitcnt lgkmcnt(8)
    buffer_load_dwordx4 v6, s[24:27], s45 offen lds
    v_cvt_pk_bf16_f32 v105, v38, v39
    v_mfma_f32_16x16x32_bf16 v[144:147], a[224:227], v[80:83], 0
    ds_read_b64_tr_b16 a[248:249], v3 offset:37088
    ds_read_b128 v[16:19], v9 offset:9984
    v_mfma_f32_16x16x32_bf16 v[144:147], a[228:231], v[84:87], v[144:147]
    ds_read_b64_tr_b16 a[250:251], v3 offset:37600
    ds_read_b64_tr_b16 a[252:253], v3 offset:53984
    v_fma_mix_f32 v32, v98, v24, v28 op_sel:[0,0,0] op_sel_hi:[1,0,0]
    v_mfma_f32_16x16x32_bf16 v[176:179], a[224:227], v[88:91], 0
    s_add_u32 m0, s44, 127488
    ds_read_b64_tr_b16 a[254:255], v3 offset:54496
    ds_read_b128 v[20:23], v9 offset:10016
    v_mfma_f32_16x16x32_bf16 v[176:179], a[228:231], v[92:95], v[176:179]
    s_mov_b32 s45, 1310720
    s_waitcnt lgkmcnt(10)
    buffer_load_dwordx4 v6, s[24:27], s45 offen lds
    v_mfma_f32_16x16x32_bf16 v[148:151], a[232:235], v[80:83], 0
    ds_read_b64_tr_b16 a[192:193], v3 offset:37120
    v_fma_mix_f32 v33, v98, v25, v29 op_sel:[1,0,0] op_sel_hi:[1,0,0]
    v_mfma_f32_16x16x32_bf16 v[148:151], a[236:239], v[84:87], v[148:151]
    ds_read_b64_tr_b16 a[194:195], v3 offset:37632
    ds_read_b64_tr_b16 a[196:197], v3 offset:54016
    v_fma_mix_f32 v34, v99, v26, v30 op_sel:[0,0,0] op_sel_hi:[1,0,0]
    v_mfma_f32_16x16x32_bf16 v[180:183], a[232:235], v[88:91], 0
    s_add_u32 m0, s44, 128544
    ds_read_b64_tr_b16 a[198:199], v3 offset:54528
    v_fma_mix_f32 v35, v99, v27, v31 op_sel:[1,0,0] op_sel_hi:[1,0,0]
    v_mfma_f32_16x16x32_bf16 v[180:183], a[236:239], v[92:95], v[180:183]
    s_mov_b32 s45, 1318912
    s_waitcnt lgkmcnt(10)
    buffer_load_dwordx4 v6, s[24:27], s45 offen lds
    v_mfma_f32_16x16x32_bf16 v[152:155], a[240:243], v[80:83], 0
    ds_read_b64_tr_b16 a[200:201], v3 offset:37152
    v_cvt_pk_bf16_f32 v98, v32, v33
    v_mfma_f32_16x16x32_bf16 v[152:155], a[244:247], v[84:87], v[152:155]
    ds_read_b64_tr_b16 a[202:203], v3 offset:37664
    ds_read_b64_tr_b16 a[204:205], v3 offset:54048
    v_cvt_pk_bf16_f32 v99, v34, v35
    v_mfma_f32_16x16x32_bf16 v[184:187], a[240:243], v[88:91], 0
    s_add_u32 m0, s44, 129600
    ds_read_b64_tr_b16 a[206:207], v3 offset:54560
    v_fma_mix_f32 v36, v106, v24, v28 op_sel:[0,0,0] op_sel_hi:[1,0,0]
    v_mfma_f32_16x16x32_bf16 v[184:187], a[244:247], v[92:95], v[184:187]
    s_mov_b32 s45, 1327104
    s_waitcnt lgkmcnt(9)
    buffer_load_dwordx4 v6, s[24:27], s45 offen lds
    v_fma_mix_f32 v37, v106, v25, v29 op_sel:[1,0,0] op_sel_hi:[1,0,0]
    v_mfma_f32_16x16x32_bf16 v[156:159], a[248:251], v[80:83], 0
    ds_read_b64_tr_b16 a[208:209], v3 offset:37184
    v_fma_mix_f32 v38, v107, v26, v30 op_sel:[0,0,0] op_sel_hi:[1,0,0]
    v_mfma_f32_16x16x32_bf16 v[156:159], a[252:255], v[84:87], v[156:159]
    ds_read_b64_tr_b16 a[210:211], v3 offset:37696
    ds_read_b64_tr_b16 a[212:213], v3 offset:54080
    v_fma_mix_f32 v39, v107, v27, v31 op_sel:[1,0,0] op_sel_hi:[1,0,0]
    v_mfma_f32_16x16x32_bf16 v[188:191], a[248:251], v[88:91], 0
    s_add_u32 m0, s44, 130656
    ds_read_b64_tr_b16 a[214:215], v3 offset:54592
    v_cvt_pk_bf16_f32 v106, v36, v37
    v_mfma_f32_16x16x32_bf16 v[188:191], a[252:255], v[92:95], v[188:191]
    s_mov_b32 s45, 1335296
    s_waitcnt lgkmcnt(8)
    buffer_load_dwordx4 v6, s[24:27], s45 offen lds
    v_cvt_pk_bf16_f32 v107, v38, v39
    v_mfma_f32_16x16x32_bf16 v[192:195], a[192:195], v[80:83], 0
    ds_read_b64_tr_b16 a[216:217], v3 offset:37216
    ds_read_b128 v[24:27], v9 offset:10000
    v_mfma_f32_16x16x32_bf16 v[192:195], a[196:199], v[84:87], v[192:195]
    ds_read_b64_tr_b16 a[218:219], v3 offset:37728
    ds_read_b64_tr_b16 a[220:221], v3 offset:54112
    v_fma_mix_f32 v32, v100, v16, v20 op_sel:[0,0,0] op_sel_hi:[1,0,0]
    v_mfma_f32_16x16x32_bf16 v[224:227], a[192:195], v[88:91], 0
    s_mov_b32 s54, 6144
    ds_read_b64_tr_b16 a[222:223], v3 offset:54624
    ds_read_b128 v[28:31], v9 offset:10032
    v_mfma_f32_16x16x32_bf16 v[224:227], a[196:199], v[92:95], v[224:227]
    s_waitcnt lgkmcnt(10)
    buffer_load_dwordx4 v[48:51], v8, s[32:35], s54 offen sc1
    v_mfma_f32_16x16x32_bf16 v[196:199], a[200:203], v[80:83], 0
    ds_read_b64_tr_b16 a[224:225], v3 offset:37248
    v_fma_mix_f32 v33, v100, v17, v21 op_sel:[1,0,0] op_sel_hi:[1,0,0]
    v_mfma_f32_16x16x32_bf16 v[196:199], a[204:207], v[84:87], v[196:199]
    ds_read_b64_tr_b16 a[226:227], v3 offset:37760
    ds_read_b64_tr_b16 a[228:229], v3 offset:54144
    v_fma_mix_f32 v34, v101, v18, v22 op_sel:[0,0,0] op_sel_hi:[1,0,0]
    v_mfma_f32_16x16x32_bf16 v[228:231], a[200:203], v[88:91], 0
    s_mov_b32 s54, 7168
    ds_read_b64_tr_b16 a[230:231], v3 offset:54656
    v_fma_mix_f32 v35, v101, v19, v23 op_sel:[1,0,0] op_sel_hi:[1,0,0]
    v_mfma_f32_16x16x32_bf16 v[228:231], a[204:207], v[92:95], v[228:231]
    s_waitcnt lgkmcnt(10)
    buffer_load_dwordx4 v[52:55], v8, s[32:35], s54 offen sc1
    v_mfma_f32_16x16x32_bf16 v[200:203], a[208:211], v[80:83], 0
    ds_read_b64_tr_b16 a[232:233], v3 offset:37280
    v_cvt_pk_bf16_f32 v100, v32, v33
    v_mfma_f32_16x16x32_bf16 v[200:203], a[212:215], v[84:87], v[200:203]
    ds_read_b64_tr_b16 a[234:235], v3 offset:37792
    ds_read_b64_tr_b16 a[236:237], v3 offset:54176
    v_cvt_pk_bf16_f32 v101, v34, v35
    v_mfma_f32_16x16x32_bf16 v[232:235], a[208:211], v[88:91], 0
    s_mov_b32 s54, 24576
    ds_read_b64_tr_b16 a[238:239], v3 offset:54688
    v_fma_mix_f32 v36, v108, v16, v20 op_sel:[0,0,0] op_sel_hi:[1,0,0]
    v_mfma_f32_16x16x32_bf16 v[232:235], a[212:215], v[92:95], v[232:235]
    s_waitcnt lgkmcnt(9)
    buffer_load_dwordx4 v[56:59], v8, s[32:35], s54 offen sc1
    v_fma_mix_f32 v37, v108, v17, v21 op_sel:[1,0,0] op_sel_hi:[1,0,0]
    v_mfma_f32_16x16x32_bf16 v[204:207], a[216:219], v[80:83], 0
    ds_read_b64_tr_b16 a[240:241], v3 offset:37312
    v_fma_mix_f32 v38, v109, v18, v22 op_sel:[0,0,0] op_sel_hi:[1,0,0]
    v_mfma_f32_16x16x32_bf16 v[204:207], a[220:223], v[84:87], v[204:207]
    ds_read_b64_tr_b16 a[242:243], v3 offset:37824
    ds_read_b64_tr_b16 a[244:245], v3 offset:54208
    v_fma_mix_f32 v39, v109, v19, v23 op_sel:[1,0,0] op_sel_hi:[1,0,0]
    v_mfma_f32_16x16x32_bf16 v[236:239], a[216:219], v[88:91], 0
    s_mov_b32 s54, 25600
    ds_read_b64_tr_b16 a[246:247], v3 offset:54720
    v_cvt_pk_bf16_f32 v108, v36, v37
    v_mfma_f32_16x16x32_bf16 v[236:239], a[220:223], v[92:95], v[236:239]
    s_waitcnt lgkmcnt(8)
    buffer_load_dwordx4 v[60:63], v8, s[32:35], s54 offen sc1
    v_cvt_pk_bf16_f32 v109, v38, v39
    v_mfma_f32_16x16x32_bf16 v[208:211], a[224:227], v[80:83], 0
    ds_read_b64_tr_b16 a[248:249], v3 offset:37344
    ds_read_b128 v[16:19], v9 offset:10240
    v_mfma_f32_16x16x32_bf16 v[208:211], a[228:231], v[84:87], v[208:211]
    ds_read_b64_tr_b16 a[250:251], v3 offset:37856
    ds_read_b128 v[20:23], v9 offset:10272
    v_mfma_f32_16x16x32_bf16 v[240:243], a[224:227], v[88:91], 0
    ds_read_b64_tr_b16 a[252:253], v3 offset:54240
    v_fma_mix_f32 v32, v102, v24, v28 op_sel:[0,0,0] op_sel_hi:[1,0,0]
    v_mfma_f32_16x16x32_bf16 v[240:243], a[228:231], v[92:95], v[240:243]
    s_barrier
    s_waitcnt lgkmcnt(9)
    ds_read_b64_tr_b16 a[254:255], v3 offset:54752
    v_fma_mix_f32 v33, v102, v25, v29 op_sel:[1,0,0] op_sel_hi:[1,0,0]
    v_fma_mix_f32 v34, v103, v26, v30 op_sel:[0,0,0] op_sel_hi:[1,0,0]
    v_mfma_f32_16x16x32_bf16 v[212:215], a[232:235], v[80:83], 0
    ds_read_b64_tr_b16 a[192:193], v4 offset:0
    v_fma_mix_f32 v35, v103, v27, v31 op_sel:[1,0,0] op_sel_hi:[1,0,0]
    v_mfma_f32_16x16x32_bf16 v[212:215], a[236:239], v[84:87], v[212:215]
    ds_read_b64_tr_b16 a[194:195], v4 offset:512
    ds_read_b64_tr_b16 a[196:197], v4 offset:16896
    v_cvt_pk_bf16_f32 v102, v32, v33
    v_mfma_f32_16x16x32_bf16 v[244:247], a[232:235], v[88:91], 0
    s_add_u32 m0, s44, 0
    ds_read_b64_tr_b16 a[198:199], v4 offset:17408
    v_cvt_pk_bf16_f32 v103, v34, v35
    v_mfma_f32_16x16x32_bf16 v[244:247], a[236:239], v[92:95], v[244:247]
    s_mov_b32 s45, 1572864
    s_waitcnt lgkmcnt(10)
    buffer_load_dwordx4 v6, s[24:27], s45 offen lds
    v_mfma_f32_16x16x32_bf16 v[216:219], a[240:243], v[80:83], 0
    ds_read_b64_tr_b16 a[200:201], v4 offset:32
    v_fma_mix_f32 v36, v110, v24, v28 op_sel:[0,0,0] op_sel_hi:[1,0,0]
    v_mfma_f32_16x16x32_bf16 v[216:219], a[244:247], v[84:87], v[216:219]
    ds_read_b64_tr_b16 a[202:203], v4 offset:544
    ds_read_b64_tr_b16 a[204:205], v4 offset:16928
    v_fma_mix_f32 v37, v110, v25, v29 op_sel:[1,0,0] op_sel_hi:[1,0,0]
    v_mfma_f32_16x16x32_bf16 v[248:251], a[240:243], v[88:91], 0
    s_add_u32 m0, s44, 1056
    ds_read_b64_tr_b16 a[206:207], v4 offset:17440
    v_fma_mix_f32 v38, v111, v26, v30 op_sel:[0,0,0] op_sel_hi:[1,0,0]
    v_mfma_f32_16x16x32_bf16 v[248:251], a[244:247], v[92:95], v[248:251]
    s_mov_b32 s45, 1581056
    s_waitcnt lgkmcnt(8)
    buffer_load_dwordx4 v6, s[24:27], s45 offen lds
    v_mfma_f32_16x16x32_bf16 v[220:223], a[248:251], v[80:83], 0
    ds_read_b64_tr_b16 a[208:209], v4 offset:64
    v_fma_mix_f32 v39, v111, v27, v31 op_sel:[1,0,0] op_sel_hi:[1,0,0]
    v_mfma_f32_16x16x32_bf16 v[220:223], a[252:255], v[84:87], v[220:223]
    ds_read_b64_tr_b16 a[210:211], v4 offset:576
    ds_read_b64_tr_b16 a[212:213], v4 offset:16960
    v_cvt_pk_bf16_f32 v110, v36, v37
    v_mfma_f32_16x16x32_bf16 v[252:255], a[248:251], v[88:91], 0
    s_add_u32 m0, s44, 2112
    ds_read_b64_tr_b16 a[214:215], v4 offset:17472
    v_cvt_pk_bf16_f32 v111, v38, v39
    v_mfma_f32_16x16x32_bf16 v[252:255], a[252:255], v[92:95], v[252:255]
    s_mov_b32 s45, 1589248
    s_waitcnt lgkmcnt(8)
    buffer_load_dwordx4 v6, s[24:27], s45 offen lds
    v_mfma_f32_16x16x32_bf16 v[128:131], a[192:195], v[96:99], v[128:131]
    s_waitcnt vmcnt(15)
    ds_read_b64_tr_b16 a[216:217], v4 offset:96
    ds_read_b128 v[24:27], v9 offset:10256
    v_mfma_f32_16x16x32_bf16 v[128:131], a[196:199], v[100:103], v[128:131]
    ds_read_b64_tr_b16 a[218:219], v4 offset:608
    ds_read_b64_tr_b16 a[220:221], v4 offset:16992
    v_fma_mix_f32 v32, v112, v16, v20 op_sel:[0,0,0] op_sel_hi:[1,0,0]
    v_mfma_f32_16x16x32_bf16 v[160:163], a[192:195], v[104:107], v[160:163]
    s_add_u32 m0, s44, 3168
    ds_read_b64_tr_b16 a[222:223], v4 offset:17504
    ds_read_b128 v[28:31], v9 offset:10288
    v_mfma_f32_16x16x32_bf16 v[160:163], a[196:199], v[108:111], v[160:163]
    s_mov_b32 s45, 1597440
    s_waitcnt lgkmcnt(10)
    buffer_load_dwordx4 v6, s[24:27], s45 offen lds
    v_mfma_f32_16x16x32_bf16 v[132:135], a[200:203], v[96:99], v[132:135]
    ds_read_b64_tr_b16 a[224:225], v4 offset:128
    v_fma_mix_f32 v33, v112, v17, v21 op_sel:[1,0,0] op_sel_hi:[1,0,0]
    v_mfma_f32_16x16x32_bf16 v[132:135], a[204:207], v[100:103], v[132:135]
    ds_read_b64_tr_b16 a[226:227], v4 offset:640
    ds_read_b64_tr_b16 a[228:229], v4 offset:17024
    v_fma_mix_f32 v34, v113, v18, v22 op_sel:[0,0,0] op_sel_hi:[1,0,0]
    v_mfma_f32_16x16x32_bf16 v[164:167], a[200:203], v[104:107], v[164:167]
    s_add_u32 m0, s44, 16896
    ds_read_b64_tr_b16 a[230:231], v4 offset:17536
    v_fma_mix_f32 v35, v113, v19, v23 op_sel:[1,0,0] op_sel_hi:[1,0,0]
    v_mfma_f32_16x16x32_bf16 v[164:167], a[204:207], v[108:111], v[164:167]
    s_mov_b32 s45, 1835008
    s_waitcnt lgkmcnt(10)
    buffer_load_dwordx4 v6, s[24:27], s45 offen lds
    v_mfma_f32_16x16x32_bf16 v[136:139], a[208:211], v[96:99], v[136:139]
    ds_read_b64_tr_b16 a[232:233], v4 offset:160
    v_cvt_pk_bf16_f32 v112, v32, v33
    v_mfma_f32_16x16x32_bf16 v[136:139], a[212:215], v[100:103], v[136:139]
    ds_read_b64_tr_b16 a[234:235], v4 offset:672
    ds_read_b64_tr_b16 a[236:237], v4 offset:17056
    v_cvt_pk_bf16_f32 v113, v34, v35
    v_mfma_f32_16x16x32_bf16 v[168:171], a[208:211], v[104:107], v[168:171]
    s_add_u32 m0, s44, 17952
    ds_read_b64_tr_b16 a[238:239], v4 offset:17568
    v_fma_mix_f32 v36, v120, v16, v20 op_sel:[0,0,0] op_sel_hi:[1,0,0]
    v_mfma_f32_16x16x32_bf16 v[168:171], a[212:215], v[108:111], v[168:171]
    s_mov_b32 s45, 1843200
    s_waitcnt lgkmcnt(9)
    buffer_load_dwordx4 v6, s[24:27], s45 offen lds
    v_fma_mix_f32 v37, v120, v17, v21 op_sel:[1,0,0] op_sel_hi:[1,0,0]
    v_mfma_f32_16x16x32_bf16 v[140:143], a[216:219], v[96:99], v[140:143]
    ds_read_b64_tr_b16 a[240:241], v4 offset:192
    v_fma_mix_f32 v38, v121, v18, v22 op_sel:[0,0,0] op_sel_hi:[1,0,0]
    v_mfma_f32_16x16x32_bf16 v[140:143], a[220:223], v[100:103], v[140:143]
    ds_read_b64_tr_b16 a[242:243], v4 offset:704
    ds_read_b64_tr_b16 a[244:245], v4 offset:17088
    v_fma_mix_f32 v39, v121, v19, v23 op_sel:[1,0,0] op_sel_hi:[1,0,0]
    v_mfma_f32_16x16x32_bf16 v[172:175], a[216:219], v[104:107], v[172:175]
    s_add_u32 m0, s44, 19008
    ds_read_b64_tr_b16 a[246:247], v4 offset:17600
    v_cvt_pk_bf16_f32 v120, v36, v37
    v_mfma_f32_16x16x32_bf16 v[172:175], a[220:223], v[108:111], v[172:175]
    s_mov_b32 s45, 1851392
    s_waitcnt lgkmcnt(8)
    buffer_load_dwordx4 v6, s[24:27], s45 offen lds
    v_cvt_pk_bf16_f32 v121, v38, v39
    v_mfma_f32_16x16x32_bf16 v[144:147], a[224:227], v[96:99], v[144:147]
    ds_read_b64_tr_b16 a[248:249], v4 offset:224
    ds_read_b128 v[16:19], v9 offset:10496
    v_mfma_f32_16x16x32_bf16 v[144:147], a[228:231], v[100:103], v[144:147]
    ds_read_b64_tr_b16 a[250:251], v4 offset:736
    ds_read_b64_tr_b16 a[252:253], v4 offset:17120
    v_mfma_f32_16x16x32_bf16 v[176:179], a[224:227], v[104:107], v[176:179]
    s_add_u32 m0, s44, 20064
    ds_read_b64_tr_b16 a[254:255], v4 offset:17632
    ds_read_b128 v[20:23], v9 offset:10528
    v_mfma_f32_16x16x32_bf16 v[176:179], a[228:231], v[108:111], v[176:179]
    s_mov_b32 s45, 1859584
    s_waitcnt lgkmcnt(10)
    buffer_load_dwordx4 v6, s[24:27], s45 offen lds
    v_mfma_f32_16x16x32_bf16 v[148:151], a[232:235], v[96:99], v[148:151]
    ds_read_b64_tr_b16 a[192:193], v4 offset:256
    v_fma_mix_f32 v32, v114, v24, v28 op_sel:[0,0,0] op_sel_hi:[1,0,0]
    v_mfma_f32_16x16x32_bf16 v[148:151], a[236:239], v[100:103], v[148:151]
    ds_read_b64_tr_b16 a[194:195], v4 offset:768
    v_fma_mix_f32 v33, v114, v25, v29 op_sel:[1,0,0] op_sel_hi:[1,0,0]
    v_mfma_f32_16x16x32_bf16 v[180:183], a[232:235], v[104:107], v[180:183]
    ds_read_b64_tr_b16 a[196:197], v4 offset:17152
    v_fma_mix_f32 v34, v115, v26, v30 op_sel:[0,0,0] op_sel_hi:[1,0,0]
    v_mfma_f32_16x16x32_bf16 v[180:183], a[236:239], v[108:111], v[180:183]
    s_waitcnt lgkmcnt(9)
    ds_read_b64_tr_b16 a[198:199], v4 offset:17664
    v_fma_mix_f32 v35, v115, v27, v31 op_sel:[1,0,0] op_sel_hi:[1,0,0]
    v_mfma_f32_16x16x32_bf16 v[152:155], a[240:243], v[96:99], v[152:155]
    ds_read_b64_tr_b16 a[200:201], v4 offset:288
    v_cvt_pk_bf16_f32 v114, v32, v33
    v_mfma_f32_16x16x32_bf16 v[152:155], a[244:247], v[100:103], v[152:155]
    ds_read_b64_tr_b16 a[202:203], v4 offset:800
    v_cvt_pk_bf16_f32 v115, v34, v35
    v_mfma_f32_16x16x32_bf16 v[184:187], a[240:243], v[104:107], v[184:187]
    ds_read_b64_tr_b16 a[204:205], v4 offset:17184
    v_fma_mix_f32 v36, v122, v24, v28 op_sel:[0,0,0] op_sel_hi:[1,0,0]
    v_mfma_f32_16x16x32_bf16 v[184:187], a[244:247], v[108:111], v[184:187]
    s_waitcnt lgkmcnt(8)
    ds_read_b64_tr_b16 a[206:207], v4 offset:17696
    v_fma_mix_f32 v37, v122, v25, v29 op_sel:[1,0,0] op_sel_hi:[1,0,0]
    v_mfma_f32_16x16x32_bf16 v[156:159], a[248:251], v[96:99], v[156:159]
    ds_read_b64_tr_b16 a[208:209], v4 offset:320
    v_fma_mix_f32 v38, v123, v26, v30 op_sel:[0,0,0] op_sel_hi:[1,0,0]
    v_mfma_f32_16x16x32_bf16 v[156:159], a[252:255], v[100:103], v[156:159]
    ds_read_b64_tr_b16 a[210:211], v4 offset:832
    v_fma_mix_f32 v39, v123, v27, v31 op_sel:[1,0,0] op_sel_hi:[1,0,0]
    v_mfma_f32_16x16x32_bf16 v[188:191], a[248:251], v[104:107], v[188:191]
    ds_read_b64_tr_b16 a[212:213], v4 offset:17216
    v_cvt_pk_bf16_f32 v122, v36, v37
    v_mfma_f32_16x16x32_bf16 v[188:191], a[252:255], v[108:111], v[188:191]
    s_waitcnt lgkmcnt(7)
    ds_read_b64_tr_b16 a[214:215], v4 offset:17728
    v_cvt_pk_bf16_f32 v123, v38, v39
    v_mfma_f32_16x16x32_bf16 v[192:195], a[192:195], v[96:99], v[192:195]
    ds_read_b64_tr_b16 a[216:217], v4 offset:352
    ds_read_b128 v[24:27], v9 offset:10512
    v_mfma_f32_16x16x32_bf16 v[192:195], a[196:199], v[100:103], v[192:195]
    ds_read_b64_tr_b16 a[218:219], v4 offset:864
    ds_read_b64_tr_b16 a[220:221], v4 offset:17248
    v_fma_mix_f32 v32, v116, v16, v20 op_sel:[0,0,0] op_sel_hi:[1,0,0]
    v_mfma_f32_16x16x32_bf16 v[224:227], a[192:195], v[104:107], v[224:227]
    s_mov_b32 s54, 8192
    ds_read_b64_tr_b16 a[222:223], v4 offset:17760
    ds_read_b128 v[28:31], v9 offset:10544
    v_mfma_f32_16x16x32_bf16 v[224:227], a[196:199], v[108:111], v[224:227]
    s_waitcnt lgkmcnt(10)
    buffer_load_dwordx4 v[64:67], v8, s[32:35], s54 offen sc1
    v_mfma_f32_16x16x32_bf16 v[196:199], a[200:203], v[96:99], v[196:199]
    ds_read_b64_tr_b16 a[224:225], v4 offset:384
    v_fma_mix_f32 v33, v116, v17, v21 op_sel:[1,0,0] op_sel_hi:[1,0,0]
    v_mfma_f32_16x16x32_bf16 v[196:199], a[204:207], v[100:103], v[196:199]
    ds_read_b64_tr_b16 a[226:227], v4 offset:896
    ds_read_b64_tr_b16 a[228:229], v4 offset:17280
    v_fma_mix_f32 v34, v117, v18, v22 op_sel:[0,0,0] op_sel_hi:[1,0,0]
    v_mfma_f32_16x16x32_bf16 v[228:231], a[200:203], v[104:107], v[228:231]
    s_mov_b32 s54, 9216
    ds_read_b64_tr_b16 a[230:231], v4 offset:17792
    v_fma_mix_f32 v35, v117, v19, v23 op_sel:[1,0,0] op_sel_hi:[1,0,0]
    v_mfma_f32_16x16x32_bf16 v[228:231], a[204:207], v[108:111], v[228:231]
    s_waitcnt lgkmcnt(10)
    buffer_load_dwordx4 v[68:71], v8, s[32:35], s54 offen sc1
    v_mfma_f32_16x16x32_bf16 v[200:203], a[208:211], v[96:99], v[200:203]
    ds_read_b64_tr_b16 a[232:233], v4 offset:416
    v_cvt_pk_bf16_f32 v116, v32, v33
    v_mfma_f32_16x16x32_bf16 v[200:203], a[212:215], v[100:103], v[200:203]
    ds_read_b64_tr_b16 a[234:235], v4 offset:928
    ds_read_b64_tr_b16 a[236:237], v4 offset:17312
    v_cvt_pk_bf16_f32 v117, v34, v35
    v_mfma_f32_16x16x32_bf16 v[232:235], a[208:211], v[104:107], v[232:235]
    s_mov_b32 s54, 26624
    ds_read_b64_tr_b16 a[238:239], v4 offset:17824
    v_fma_mix_f32 v36, v124, v16, v20 op_sel:[0,0,0] op_sel_hi:[1,0,0]
    v_mfma_f32_16x16x32_bf16 v[232:235], a[212:215], v[108:111], v[232:235]
    s_waitcnt lgkmcnt(9)
    buffer_load_dwordx4 v[72:75], v8, s[32:35], s54 offen sc1
    v_fma_mix_f32 v37, v124, v17, v21 op_sel:[1,0,0] op_sel_hi:[1,0,0]
    v_mfma_f32_16x16x32_bf16 v[204:207], a[216:219], v[96:99], v[204:207]
L2_pad0:
    s_cbranch_execz L2_pad4
    ds_read_b64_tr_b16 a[240:241], v4 offset:448
    v_fma_mix_f32 v38, v125, v18, v22 op_sel:[0,0,0] op_sel_hi:[1,0,0]
    v_mfma_f32_16x16x32_bf16 v[204:207], a[220:223], v[100:103], v[204:207]
    ds_read_b64_tr_b16 a[242:243], v4 offset:960
    ds_read_b64_tr_b16 a[244:245], v4 offset:17344
    v_fma_mix_f32 v39, v125, v19, v23 op_sel:[1,0,0] op_sel_hi:[1,0,0]
    v_mfma_f32_16x16x32_bf16 v[236:239], a[216:219], v[104:107], v[236:239]
    s_mov_b32 s54, 27648
    ds_read_b64_tr_b16 a[246:247], v4 offset:17856
    v_cvt_pk_bf16_f32 v124, v36, v37
    v_mfma_f32_16x16x32_bf16 v[236:239], a[220:223], v[108:111], v[236:239]
    s_waitcnt lgkmcnt(8)
    buffer_load_dwordx4 v[76:79], v8, s[32:35], s54 offen sc1
    v_cvt_pk_bf16_f32 v125, v38, v39
    v_mfma_f32_16x16x32_bf16 v[208:211], a[224:227], v[96:99], v[208:211]
    ds_read_b64_tr_b16 a[248:249], v4 offset:480
    ds_read_b128 v[16:19], v9 offset:10752
    v_mfma_f32_16x16x32_bf16 v[208:211], a[228:231], v[100:103], v[208:211]
    ds_read_b64_tr_b16 a[250:251], v4 offset:992
    ds_read_b128 v[20:23], v9 offset:10784
    v_mfma_f32_16x16x32_bf16 v[240:243], a[224:227], v[104:107], v[240:243]
    ds_read_b64_tr_b16 a[252:253], v4 offset:17376
    v_fma_mix_f32 v32, v118, v24, v28 op_sel:[0,0,0] op_sel_hi:[1,0,0]
    v_mfma_f32_16x16x32_bf16 v[240:243], a[228:231], v[108:111], v[240:243]
    s_waitcnt vmcnt(16)
    s_barrier
    s_waitcnt lgkmcnt(9)
    ds_read_b64_tr_b16 a[254:255], v4 offset:17888
    v_fma_mix_f32 v33, v118, v25, v29 op_sel:[1,0,0] op_sel_hi:[1,0,0]
    v_fma_mix_f32 v34, v119, v26, v30 op_sel:[0,0,0] op_sel_hi:[1,0,0]
    v_mfma_f32_16x16x32_bf16 v[212:215], a[232:235], v[96:99], v[212:215]
    ds_read_b64_tr_b16 a[192:193], v4 offset:36864
    v_fma_mix_f32 v35, v119, v27, v31 op_sel:[1,0,0] op_sel_hi:[1,0,0]
    v_mfma_f32_16x16x32_bf16 v[212:215], a[236:239], v[100:103], v[212:215]
    ds_read_b64_tr_b16 a[194:195], v4 offset:37376
    ds_read_b64_tr_b16 a[196:197], v4 offset:53760
    v_cvt_pk_bf16_f32 v118, v32, v33
    v_mfma_f32_16x16x32_bf16 v[244:247], a[232:235], v[104:107], v[244:247]
    s_add_u32 m0, s44, 36864
    ds_read_b64_tr_b16 a[198:199], v4 offset:54272
    v_cvt_pk_bf16_f32 v119, v34, v35
    v_mfma_f32_16x16x32_bf16 v[244:247], a[236:239], v[108:111], v[244:247]
    s_mov_b32 s45, 2097152
    s_waitcnt lgkmcnt(10)
    buffer_load_dwordx4 v6, s[24:27], s45 offen lds
    v_mfma_f32_16x16x32_bf16 v[216:219], a[240:243], v[96:99], v[216:219]
    ds_read_b64_tr_b16 a[200:201], v4 offset:36896
    v_fma_mix_f32 v36, v126, v24, v28 op_sel:[0,0,0] op_sel_hi:[1,0,0]
    v_mfma_f32_16x16x32_bf16 v[216:219], a[244:247], v[100:103], v[216:219]
    ds_read_b64_tr_b16 a[202:203], v4 offset:37408
    ds_read_b64_tr_b16 a[204:205], v4 offset:53792
    v_fma_mix_f32 v37, v126, v25, v29 op_sel:[1,0,0] op_sel_hi:[1,0,0]
    v_mfma_f32_16x16x32_bf16 v[248:251], a[240:243], v[104:107], v[248:251]
    s_add_u32 m0, s44, 37920
    ds_read_b64_tr_b16 a[206:207], v4 offset:54304
    v_fma_mix_f32 v38, v127, v26, v30 op_sel:[0,0,0] op_sel_hi:[1,0,0]
    v_mfma_f32_16x16x32_bf16 v[248:251], a[244:247], v[108:111], v[248:251]
    s_mov_b32 s45, 2105344
    s_waitcnt lgkmcnt(8)
    buffer_load_dwordx4 v6, s[24:27], s45 offen lds
    v_mfma_f32_16x16x32_bf16 v[220:223], a[248:251], v[96:99], v[220:223]
    ds_read_b64_tr_b16 a[208:209], v4 offset:36928
    v_fma_mix_f32 v39, v127, v27, v31 op_sel:[1,0,0] op_sel_hi:[1,0,0]
    v_mfma_f32_16x16x32_bf16 v[220:223], a[252:255], v[100:103], v[220:223]
    ds_read_b64_tr_b16 a[210:211], v4 offset:37440
    ds_read_b64_tr_b16 a[212:213], v4 offset:53824
    v_cvt_pk_bf16_f32 v126, v36, v37
    v_mfma_f32_16x16x32_bf16 v[252:255], a[248:251], v[104:107], v[252:255]
    s_add_u32 m0, s44, 38976
    ds_read_b64_tr_b16 a[214:215], v4 offset:54336
    v_cvt_pk_bf16_f32 v127, v38, v39
    v_mfma_f32_16x16x32_bf16 v[252:255], a[252:255], v[108:111], v[252:255]
    s_mov_b32 s45, 2113536
    s_waitcnt lgkmcnt(8)
    buffer_load_dwordx4 v6, s[24:27], s45 offen lds
    v_mfma_f32_16x16x32_bf16 v[128:131], a[192:195], v[112:115], v[128:131]
    s_waitcnt vmcnt(15)
    ds_read_b64_tr_b16 a[216:217], v4 offset:36960
    ds_read_b128 v[24:27], v9 offset:10768
    v_mfma_f32_16x16x32_bf16 v[128:131], a[196:199], v[116:119], v[128:131]
    ds_read_b64_tr_b16 a[218:219], v4 offset:37472
    ds_read_b64_tr_b16 a[220:221], v4 offset:53856
    v_fma_mix_f32 v32, v48, v16, v20 op_sel:[0,0,0] op_sel_hi:[1,0,0]
    v_mfma_f32_16x16x32_bf16 v[160:163], a[192:195], v[120:123], v[160:163]
    s_add_u32 m0, s44, 40032
    ds_read_b64_tr_b16 a[222:223], v4 offset:54368
    ds_read_b128 v[28:31], v9 offset:10800
    v_mfma_f32_16x16x32_bf16 v[160:163], a[196:199], v[124:127], v[160:163]
    s_mov_b32 s45, 2121728
    s_waitcnt lgkmcnt(10)
    buffer_load_dwordx4 v6, s[24:27], s45 offen lds
    v_mfma_f32_16x16x32_bf16 v[132:135], a[200:203], v[112:115], v[132:135]
    ds_read_b64_tr_b16 a[224:225], v4 offset:36992
    v_fma_mix_f32 v33, v48, v17, v21 op_sel:[1,0,0] op_sel_hi:[1,0,0]
    v_mfma_f32_16x16x32_bf16 v[132:135], a[204:207], v[116:119], v[132:135]
    ds_read_b64_tr_b16 a[226:227], v4 offset:37504
    ds_read_b64_tr_b16 a[228:229], v4 offset:53888
    v_fma_mix_f32 v34, v49, v18, v22 op_sel:[0,0,0] op_sel_hi:[1,0,0]
    v_mfma_f32_16x16x32_bf16 v[164:167], a[200:203], v[120:123], v[164:167]
    s_add_u32 m0, s44, 53760
    ds_read_b64_tr_b16 a[230:231], v4 offset:54400
    v_fma_mix_f32 v35, v49, v19, v23 op_sel:[1,0,0] op_sel_hi:[1,0,0]
    v_mfma_f32_16x16x32_bf16 v[164:167], a[204:207], v[124:127], v[164:167]
    s_mov_b32 s45, 2359296
    s_waitcnt lgkmcnt(10)
    buffer_load_dwordx4 v6, s[24:27], s45 offen lds
    v_mfma_f32_16x16x32_bf16 v[136:139], a[208:211], v[112:115], v[136:139]
    ds_read_b64_tr_b16 a[232:233], v4 offset:37024
    v_cvt_pk_bf16_f32 v48, v32, v33
    v_mfma_f32_16x16x32_bf16 v[136:139], a[212:215], v[116:119], v[136:139]
    ds_read_b64_tr_b16 a[234:235], v4 offset:37536
    ds_read_b64_tr_b16 a[236:237], v4 offset:53920
    v_cvt_pk_bf16_f32 v49, v34, v35
    v_mfma_f32_16x16x32_bf16 v[168:171], a[208:211], v[120:123], v[168:171]
    s_add_u32 m0, s44, 54816
    ds_read_b64_tr_b16 a[238:239], v4 offset:54432
    v_fma_mix_f32 v36, v56, v16, v20 op_sel:[0,0,0] op_sel_hi:[1,0,0]
    v_mfma_f32_16x16x32_bf16 v[168:171], a[212:215], v[124:127], v[168:171]
    s_mov_b32 s45, 2367488
    s_waitcnt lgkmcnt(9)
    buffer_load_dwordx4 v6, s[24:27], s45 offen lds
    v_fma_mix_f32 v37, v56, v17, v21 op_sel:[1,0,0] op_sel_hi:[1,0,0]
    v_mfma_f32_16x16x32_bf16 v[140:143], a[216:219], v[112:115], v[140:143]
    ds_read_b64_tr_b16 a[240:241], v4 offset:37056
    v_fma_mix_f32 v38, v57, v18, v22 op_sel:[0,0,0] op_sel_hi:[1,0,0]
    v_mfma_f32_16x16x32_bf16 v[140:143], a[220:223], v[116:119], v[140:143]
    ds_read_b64_tr_b16 a[242:243], v4 offset:37568
    ds_read_b64_tr_b16 a[244:245], v4 offset:53952
    v_fma_mix_f32 v39, v57, v19, v23 op_sel:[1,0,0] op_sel_hi:[1,0,0]
    v_mfma_f32_16x16x32_bf16 v[172:175], a[216:219], v[120:123], v[172:175]
    s_add_u32 m0, s44, 55872
    ds_read_b64_tr_b16 a[246:247], v4 offset:54464
    v_cvt_pk_bf16_f32 v56, v36, v37
    v_mfma_f32_16x16x32_bf16 v[172:175], a[220:223], v[124:127], v[172:175]
    s_mov_b32 s45, 2375680
    s_waitcnt lgkmcnt(8)
    buffer_load_dwordx4 v6, s[24:27], s45 offen lds
    v_cvt_pk_bf16_f32 v57, v38, v39
    v_mfma_f32_16x16x32_bf16 v[144:147], a[224:227], v[112:115], v[144:147]
    ds_read_b64_tr_b16 a[248:249], v4 offset:37088
    ds_read_b128 v[16:19], v9 offset:11008
    v_mfma_f32_16x16x32_bf16 v[144:147], a[228:231], v[116:119], v[144:147]
    ds_read_b64_tr_b16 a[250:251], v4 offset:37600
    ds_read_b64_tr_b16 a[252:253], v4 offset:53984
    v_mfma_f32_16x16x32_bf16 v[176:179], a[224:227], v[120:123], v[176:179]
    s_add_u32 m0, s44, 56928
    ds_read_b64_tr_b16 a[254:255], v4 offset:54496
    ds_read_b128 v[20:23], v9 offset:11040
    v_mfma_f32_16x16x32_bf16 v[176:179], a[228:231], v[124:127], v[176:179]
    s_mov_b32 s45, 2383872
    s_waitcnt lgkmcnt(10)
    buffer_load_dwordx4 v6, s[24:27], s45 offen lds
    v_mfma_f32_16x16x32_bf16 v[148:151], a[232:235], v[112:115], v[148:151]
    ds_read_b64_tr_b16 a[192:193], v4 offset:37120
    v_fma_mix_f32 v32, v50, v24, v28 op_sel:[0,0,0] op_sel_hi:[1,0,0]
    v_mfma_f32_16x16x32_bf16 v[148:151], a[236:239], v[116:119], v[148:151]
    ds_read_b64_tr_b16 a[194:195], v4 offset:37632
    v_fma_mix_f32 v33, v50, v25, v29 op_sel:[1,0,0] op_sel_hi:[1,0,0]
    v_mfma_f32_16x16x32_bf16 v[180:183], a[232:235], v[120:123], v[180:183]
    ds_read_b64_tr_b16 a[196:197], v4 offset:54016
    v_fma_mix_f32 v34, v51, v26, v30 op_sel:[0,0,0] op_sel_hi:[1,0,0]
    v_mfma_f32_16x16x32_bf16 v[180:183], a[236:239], v[124:127], v[180:183]
    s_waitcnt lgkmcnt(9)
    ds_read_b64_tr_b16 a[198:199], v4 offset:54528
    v_fma_mix_f32 v35, v51, v27, v31 op_sel:[1,0,0] op_sel_hi:[1,0,0]
    v_mfma_f32_16x16x32_bf16 v[152:155], a[240:243], v[112:115], v[152:155]
    ds_read_b64_tr_b16 a[200:201], v4 offset:37152
    v_cvt_pk_bf16_f32 v50, v32, v33
    v_mfma_f32_16x16x32_bf16 v[152:155], a[244:247], v[116:119], v[152:155]
    ds_read_b64_tr_b16 a[202:203], v4 offset:37664
    v_cvt_pk_bf16_f32 v51, v34, v35
    v_mfma_f32_16x16x32_bf16 v[184:187], a[240:243], v[120:123], v[184:187]
    ds_read_b64_tr_b16 a[204:205], v4 offset:54048
    v_fma_mix_f32 v36, v58, v24, v28 op_sel:[0,0,0] op_sel_hi:[1,0,0]
    v_mfma_f32_16x16x32_bf16 v[184:187], a[244:247], v[124:127], v[184:187]
    s_waitcnt lgkmcnt(8)
    ds_read_b64_tr_b16 a[206:207], v4 offset:54560
    v_fma_mix_f32 v37, v58, v25, v29 op_sel:[1,0,0] op_sel_hi:[1,0,0]
    v_mfma_f32_16x16x32_bf16 v[156:159], a[248:251], v[112:115], v[156:159]
    ds_read_b64_tr_b16 a[208:209], v4 offset:37184
    v_fma_mix_f32 v38, v59, v26, v30 op_sel:[0,0,0] op_sel_hi:[1,0,0]
    v_mfma_f32_16x16x32_bf16 v[156:159], a[252:255], v[116:119], v[156:159]
    ds_read_b64_tr_b16 a[210:211], v4 offset:37696
    v_fma_mix_f32 v39, v59, v27, v31 op_sel:[1,0,0] op_sel_hi:[1,0,0]
    v_mfma_f32_16x16x32_bf16 v[188:191], a[248:251], v[120:123], v[188:191]
    ds_read_b64_tr_b16 a[212:213], v4 offset:54080
    v_cvt_pk_bf16_f32 v58, v36, v37
    v_mfma_f32_16x16x32_bf16 v[188:191], a[252:255], v[124:127], v[188:191]
    s_waitcnt lgkmcnt(7)
    ds_read_b64_tr_b16 a[214:215], v4 offset:54592
    v_cvt_pk_bf16_f32 v59, v38, v39
    v_mfma_f32_16x16x32_bf16 v[192:195], a[192:195], v[112:115], v[192:195]
    ds_read_b64_tr_b16 a[216:217], v4 offset:37216
    ds_read_b128 v[24:27], v9 offset:11024
    v_mfma_f32_16x16x32_bf16 v[192:195], a[196:199], v[116:119], v[192:195]
    ds_read_b64_tr_b16 a[218:219], v4 offset:37728
    ds_read_b64_tr_b16 a[220:221], v4 offset:54112
    v_fma_mix_f32 v32, v52, v16, v20 op_sel:[0,0,0] op_sel_hi:[1,0,0]
    v_mfma_f32_16x16x32_bf16 v[224:227], a[192:195], v[120:123], v[224:227]
    s_mov_b32 s54, 10240
    ds_read_b64_tr_b16 a[222:223], v4 offset:54624
    ds_read_b128 v[28:31], v9 offset:11056
    v_mfma_f32_16x16x32_bf16 v[224:227], a[196:199], v[124:127], v[224:227]
    s_waitcnt lgkmcnt(10)
    buffer_load_dwordx4 v[80:83], v8, s[32:35], s54 offen sc1
    v_mfma_f32_16x16x32_bf16 v[196:199], a[200:203], v[112:115], v[196:199]
    ds_read_b64_tr_b16 a[224:225], v4 offset:37248
    v_fma_mix_f32 v33, v52, v17, v21 op_sel:[1,0,0] op_sel_hi:[1,0,0]
    v_mfma_f32_16x16x32_bf16 v[196:199], a[204:207], v[116:119], v[196:199]
    ds_read_b64_tr_b16 a[226:227], v4 offset:37760
    ds_read_b64_tr_b16 a[228:229], v4 offset:54144
    v_fma_mix_f32 v34, v53, v18, v22 op_sel:[0,0,0] op_sel_hi:[1,0,0]
    v_mfma_f32_16x16x32_bf16 v[228:231], a[200:203], v[120:123], v[228:231]
    s_mov_b32 s54, 11264
    ds_read_b64_tr_b16 a[230:231], v4 offset:54656
    v_fma_mix_f32 v35, v53, v19, v23 op_sel:[1,0,0] op_sel_hi:[1,0,0]
    v_mfma_f32_16x16x32_bf16 v[228:231], a[204:207], v[124:127], v[228:231]
    s_waitcnt lgkmcnt(10)
    buffer_load_dwordx4 v[84:87], v8, s[32:35], s54 offen sc1
    v_mfma_f32_16x16x32_bf16 v[200:203], a[208:211], v[112:115], v[200:203]
    ds_read_b64_tr_b16 a[232:233], v4 offset:37280
    v_cvt_pk_bf16_f32 v52, v32, v33
    v_mfma_f32_16x16x32_bf16 v[200:203], a[212:215], v[116:119], v[200:203]
    ds_read_b64_tr_b16 a[234:235], v4 offset:37792
    ds_read_b64_tr_b16 a[236:237], v4 offset:54176
    v_cvt_pk_bf16_f32 v53, v34, v35
    v_mfma_f32_16x16x32_bf16 v[232:235], a[208:211], v[120:123], v[232:235]
    s_mov_b32 s54, 28672
    ds_read_b64_tr_b16 a[238:239], v4 offset:54688
    v_fma_mix_f32 v36, v60, v16, v20 op_sel:[0,0,0] op_sel_hi:[1,0,0]
    v_mfma_f32_16x16x32_bf16 v[232:235], a[212:215], v[124:127], v[232:235]
    s_waitcnt lgkmcnt(9)
    buffer_load_dwordx4 v[88:91], v8, s[32:35], s54 offen sc1
    v_fma_mix_f32 v37, v60, v17, v21 op_sel:[1,0,0] op_sel_hi:[1,0,0]
    v_mfma_f32_16x16x32_bf16 v[204:207], a[216:219], v[112:115], v[204:207]
    ds_read_b64_tr_b16 a[240:241], v4 offset:37312
    v_fma_mix_f32 v38, v61, v18, v22 op_sel:[0,0,0] op_sel_hi:[1,0,0]
    v_mfma_f32_16x16x32_bf16 v[204:207], a[220:223], v[116:119], v[204:207]
    ds_read_b64_tr_b16 a[242:243], v4 offset:37824
    ds_read_b64_tr_b16 a[244:245], v4 offset:54208
    v_fma_mix_f32 v39, v61, v19, v23 op_sel:[1,0,0] op_sel_hi:[1,0,0]
    v_mfma_f32_16x16x32_bf16 v[236:239], a[216:219], v[120:123], v[236:239]
    s_mov_b32 s54, 29696
    ds_read_b64_tr_b16 a[246:247], v4 offset:54720
    v_cvt_pk_bf16_f32 v60, v36, v37
    v_mfma_f32_16x16x32_bf16 v[236:239], a[220:223], v[124:127], v[236:239]
    s_waitcnt lgkmcnt(8)
    buffer_load_dwordx4 v[92:95], v8, s[32:35], s54 offen sc1
    v_cvt_pk_bf16_f32 v61, v38, v39
    v_mfma_f32_16x16x32_bf16 v[208:211], a[224:227], v[112:115], v[208:211]
    ds_read_b64_tr_b16 a[248:249], v4 offset:37344
    ds_read_b128 v[16:19], v9 offset:11264
    v_mfma_f32_16x16x32_bf16 v[208:211], a[228:231], v[116:119], v[208:211]
    ds_read_b64_tr_b16 a[250:251], v4 offset:37856
    ds_read_b128 v[20:23], v9 offset:11296
    v_mfma_f32_16x16x32_bf16 v[240:243], a[224:227], v[120:123], v[240:243]
    ds_read_b64_tr_b16 a[252:253], v4 offset:54240
    v_fma_mix_f32 v32, v54, v24, v28 op_sel:[0,0,0] op_sel_hi:[1,0,0]
    v_mfma_f32_16x16x32_bf16 v[240:243], a[228:231], v[124:127], v[240:243]
    s_waitcnt vmcnt(16)
    s_barrier
    s_waitcnt lgkmcnt(9)
    ds_read_b64_tr_b16 a[254:255], v4 offset:54752
    v_fma_mix_f32 v33, v54, v25, v29 op_sel:[1,0,0] op_sel_hi:[1,0,0]
    v_fma_mix_f32 v34, v55, v26, v30 op_sel:[0,0,0] op_sel_hi:[1,0,0]
    v_mfma_f32_16x16x32_bf16 v[212:215], a[232:235], v[112:115], v[212:215]
    ds_read_b64_tr_b16 a[192:193], v3 offset:0
    v_fma_mix_f32 v35, v55, v27, v31 op_sel:[1,0,0] op_sel_hi:[1,0,0]
    v_mfma_f32_16x16x32_bf16 v[212:215], a[236:239], v[116:119], v[212:215]
    ds_read_b64_tr_b16 a[194:195], v3 offset:512
    ds_read_b64_tr_b16 a[196:197], v3 offset:16896
    v_cvt_pk_bf16_f32 v54, v32, v33
    v_mfma_f32_16x16x32_bf16 v[244:247], a[232:235], v[120:123], v[244:247]
    s_add_u32 m0, s44, 73728
    ds_read_b64_tr_b16 a[198:199], v3 offset:17408
    v_cvt_pk_bf16_f32 v55, v34, v35
    v_mfma_f32_16x16x32_bf16 v[244:247], a[236:239], v[124:127], v[244:247]
    s_mov_b32 s45, 2621440
    s_waitcnt lgkmcnt(10)
    buffer_load_dwordx4 v6, s[24:27], s45 offen lds
    v_mfma_f32_16x16x32_bf16 v[216:219], a[240:243], v[112:115], v[216:219]
    ds_read_b64_tr_b16 a[200:201], v3 offset:32
    v_fma_mix_f32 v36, v62, v24, v28 op_sel:[0,0,0] op_sel_hi:[1,0,0]
    v_mfma_f32_16x16x32_bf16 v[216:219], a[244:247], v[116:119], v[216:219]
    ds_read_b64_tr_b16 a[202:203], v3 offset:544
    ds_read_b64_tr_b16 a[204:205], v3 offset:16928
    v_fma_mix_f32 v37, v62, v25, v29 op_sel:[1,0,0] op_sel_hi:[1,0,0]
    v_mfma_f32_16x16x32_bf16 v[248:251], a[240:243], v[120:123], v[248:251]
    s_add_u32 m0, s44, 74784
    ds_read_b64_tr_b16 a[206:207], v3 offset:17440
    v_fma_mix_f32 v38, v63, v26, v30 op_sel:[0,0,0] op_sel_hi:[1,0,0]
    v_mfma_f32_16x16x32_bf16 v[248:251], a[244:247], v[124:127], v[248:251]
    s_mov_b32 s45, 2629632
    s_waitcnt lgkmcnt(8)
    buffer_load_dwordx4 v6, s[24:27], s45 offen lds
    v_mfma_f32_16x16x32_bf16 v[220:223], a[248:251], v[112:115], v[220:223]
    ds_read_b64_tr_b16 a[208:209], v3 offset:64
    v_fma_mix_f32 v39, v63, v27, v31 op_sel:[1,0,0] op_sel_hi:[1,0,0]
    v_mfma_f32_16x16x32_bf16 v[220:223], a[252:255], v[116:119], v[220:223]
    ds_read_b64_tr_b16 a[210:211], v3 offset:576
    ds_read_b64_tr_b16 a[212:213], v3 offset:16960
    v_cvt_pk_bf16_f32 v62, v36, v37
    v_mfma_f32_16x16x32_bf16 v[252:255], a[248:251], v[120:123], v[252:255]
    s_add_u32 m0, s44, 75840
    ds_read_b64_tr_b16 a[214:215], v3 offset:17472
    v_cvt_pk_bf16_f32 v63, v38, v39
    v_mfma_f32_16x16x32_bf16 v[252:255], a[252:255], v[124:127], v[252:255]
    s_mov_b32 s45, 2637824
    s_waitcnt lgkmcnt(8)
    buffer_load_dwordx4 v6, s[24:27], s45 offen lds
    v_mfma_f32_16x16x32_bf16 v[128:131], a[192:195], v[48:51], v[128:131]
    s_waitcnt vmcnt(15)
    ds_read_b64_tr_b16 a[216:217], v3 offset:96
    ds_read_b128 v[24:27], v9 offset:11280
    v_mfma_f32_16x16x32_bf16 v[128:131], a[196:199], v[52:55], v[128:131]
    ds_read_b64_tr_b16 a[218:219], v3 offset:608
    ds_read_b64_tr_b16 a[220:221], v3 offset:16992
    v_fma_mix_f32 v32, v64, v16, v20 op_sel:[0,0,0] op_sel_hi:[1,0,0]
    v_mfma_f32_16x16x32_bf16 v[160:163], a[192:195], v[56:59], v[160:163]
    s_add_u32 m0, s44, 76896
    ds_read_b64_tr_b16 a[222:223], v3 offset:17504
    ds_read_b128 v[28:31], v9 offset:11312
    v_mfma_f32_16x16x32_bf16 v[160:163], a[196:199], v[60:63], v[160:163]
    s_mov_b32 s45, 2646016
    s_waitcnt lgkmcnt(10)
    buffer_load_dwordx4 v6, s[24:27], s45 offen lds
    v_mfma_f32_16x16x32_bf16 v[132:135], a[200:203], v[48:51], v[132:135]
    ds_read_b64_tr_b16 a[224:225], v3 offset:128
    v_fma_mix_f32 v33, v64, v17, v21 op_sel:[1,0,0] op_sel_hi:[1,0,0]
    v_mfma_f32_16x16x32_bf16 v[132:135], a[204:207], v[52:55], v[132:135]
    ds_read_b64_tr_b16 a[226:227], v3 offset:640
    ds_read_b64_tr_b16 a[228:229], v3 offset:17024
    v_fma_mix_f32 v34, v65, v18, v22 op_sel:[0,0,0] op_sel_hi:[1,0,0]
    v_mfma_f32_16x16x32_bf16 v[164:167], a[200:203], v[56:59], v[164:167]
    s_add_u32 m0, s44, 90624
    ds_read_b64_tr_b16 a[230:231], v3 offset:17536
    v_fma_mix_f32 v35, v65, v19, v23 op_sel:[1,0,0] op_sel_hi:[1,0,0]
    v_mfma_f32_16x16x32_bf16 v[164:167], a[204:207], v[60:63], v[164:167]
    s_mov_b32 s45, 2883584
    s_waitcnt lgkmcnt(10)
    buffer_load_dwordx4 v6, s[24:27], s45 offen lds
    v_mfma_f32_16x16x32_bf16 v[136:139], a[208:211], v[48:51], v[136:139]
    ds_read_b64_tr_b16 a[232:233], v3 offset:160
    v_cvt_pk_bf16_f32 v64, v32, v33
    v_mfma_f32_16x16x32_bf16 v[136:139], a[212:215], v[52:55], v[136:139]
    ds_read_b64_tr_b16 a[234:235], v3 offset:672
    ds_read_b64_tr_b16 a[236:237], v3 offset:17056
    v_cvt_pk_bf16_f32 v65, v34, v35
    v_mfma_f32_16x16x32_bf16 v[168:171], a[208:211], v[56:59], v[168:171]
    s_add_u32 m0, s44, 91680
    ds_read_b64_tr_b16 a[238:239], v3 offset:17568
    v_fma_mix_f32 v36, v72, v16, v20 op_sel:[0,0,0] op_sel_hi:[1,0,0]
    v_mfma_f32_16x16x32_bf16 v[168:171], a[212:215], v[60:63], v[168:171]
    s_mov_b32 s45, 2891776
    s_waitcnt lgkmcnt(9)
    buffer_load_dwordx4 v6, s[24:27], s45 offen lds
    v_fma_mix_f32 v37, v72, v17, v21 op_sel:[1,0,0] op_sel_hi:[1,0,0]
    v_mfma_f32_16x16x32_bf16 v[140:143], a[216:219], v[48:51], v[140:143]
    ds_read_b64_tr_b16 a[240:241], v3 offset:192
    v_fma_mix_f32 v38, v73, v18, v22 op_sel:[0,0,0] op_sel_hi:[1,0,0]
    v_mfma_f32_16x16x32_bf16 v[140:143], a[220:223], v[52:55], v[140:143]
    ds_read_b64_tr_b16 a[242:243], v3 offset:704
    ds_read_b64_tr_b16 a[244:245], v3 offset:17088
    v_fma_mix_f32 v39, v73, v19, v23 op_sel:[1,0,0] op_sel_hi:[1,0,0]
    v_mfma_f32_16x16x32_bf16 v[172:175], a[216:219], v[56:59], v[172:175]
    s_add_u32 m0, s44, 92736
    ds_read_b64_tr_b16 a[246:247], v3 offset:17600
    v_cvt_pk_bf16_f32 v72, v36, v37
    v_mfma_f32_16x16x32_bf16 v[172:175], a[220:223], v[60:63], v[172:175]
    s_mov_b32 s45, 2899968
    s_waitcnt lgkmcnt(8)
    buffer_load_dwordx4 v6, s[24:27], s45 offen lds
    v_cvt_pk_bf16_f32 v73, v38, v39
    v_mfma_f32_16x16x32_bf16 v[144:147], a[224:227], v[48:51], v[144:147]
    ds_read_b64_tr_b16 a[248:249], v3 offset:224
    ds_read_b128 v[16:19], v9 offset:11520
    v_mfma_f32_16x16x32_bf16 v[144:147], a[228:231], v[52:55], v[144:147]
    ds_read_b64_tr_b16 a[250:251], v3 offset:736
    ds_read_b64_tr_b16 a[252:253], v3 offset:17120
    v_mfma_f32_16x16x32_bf16 v[176:179], a[224:227], v[56:59], v[176:179]
    s_add_u32 m0, s44, 93792
    ds_read_b64_tr_b16 a[254:255], v3 offset:17632
    ds_read_b128 v[20:23], v9 offset:11552
    v_mfma_f32_16x16x32_bf16 v[176:179], a[228:231], v[60:63], v[176:179]
    s_mov_b32 s45, 2908160
    s_waitcnt lgkmcnt(10)
    buffer_load_dwordx4 v6, s[24:27], s45 offen lds
    v_mfma_f32_16x16x32_bf16 v[148:151], a[232:235], v[48:51], v[148:151]
    ds_read_b64_tr_b16 a[192:193], v3 offset:256
    v_fma_mix_f32 v32, v66, v24, v28 op_sel:[0,0,0] op_sel_hi:[1,0,0]
    v_mfma_f32_16x16x32_bf16 v[148:151], a[236:239], v[52:55], v[148:151]
    ds_read_b64_tr_b16 a[194:195], v3 offset:768
    v_fma_mix_f32 v33, v66, v25, v29 op_sel:[1,0,0] op_sel_hi:[1,0,0]
    v_mfma_f32_16x16x32_bf16 v[180:183], a[232:235], v[56:59], v[180:183]
    ds_read_b64_tr_b16 a[196:197], v3 offset:17152
    v_fma_mix_f32 v34, v67, v26, v30 op_sel:[0,0,0] op_sel_hi:[1,0,0]
    v_mfma_f32_16x16x32_bf16 v[180:183], a[236:239], v[60:63], v[180:183]
    s_waitcnt lgkmcnt(9)
    ds_read_b64_tr_b16 a[198:199], v3 offset:17664
    v_fma_mix_f32 v35, v67, v27, v31 op_sel:[1,0,0] op_sel_hi:[1,0,0]
    v_mfma_f32_16x16x32_bf16 v[152:155], a[240:243], v[48:51], v[152:155]
    ds_read_b64_tr_b16 a[200:201], v3 offset:288
    v_cvt_pk_bf16_f32 v66, v32, v33
    v_mfma_f32_16x16x32_bf16 v[152:155], a[244:247], v[52:55], v[152:155]
    ds_read_b64_tr_b16 a[202:203], v3 offset:800
    v_cvt_pk_bf16_f32 v67, v34, v35
    v_mfma_f32_16x16x32_bf16 v[184:187], a[240:243], v[56:59], v[184:187]
    ds_read_b64_tr_b16 a[204:205], v3 offset:17184
    v_fma_mix_f32 v36, v74, v24, v28 op_sel:[0,0,0] op_sel_hi:[1,0,0]
    v_mfma_f32_16x16x32_bf16 v[184:187], a[244:247], v[60:63], v[184:187]
    s_waitcnt lgkmcnt(8)
    ds_read_b64_tr_b16 a[206:207], v3 offset:17696
    v_fma_mix_f32 v37, v74, v25, v29 op_sel:[1,0,0] op_sel_hi:[1,0,0]
    v_mfma_f32_16x16x32_bf16 v[156:159], a[248:251], v[48:51], v[156:159]
    ds_read_b64_tr_b16 a[208:209], v3 offset:320
    v_fma_mix_f32 v38, v75, v26, v30 op_sel:[0,0,0] op_sel_hi:[1,0,0]
    v_mfma_f32_16x16x32_bf16 v[156:159], a[252:255], v[52:55], v[156:159]
    ds_read_b64_tr_b16 a[210:211], v3 offset:832
    v_fma_mix_f32 v39, v75, v27, v31 op_sel:[1,0,0] op_sel_hi:[1,0,0]
    v_mfma_f32_16x16x32_bf16 v[188:191], a[248:251], v[56:59], v[188:191]
    ds_read_b64_tr_b16 a[212:213], v3 offset:17216
    v_cvt_pk_bf16_f32 v74, v36, v37
    v_mfma_f32_16x16x32_bf16 v[188:191], a[252:255], v[60:63], v[188:191]
    s_waitcnt lgkmcnt(7)
    ds_read_b64_tr_b16 a[214:215], v3 offset:17728
    v_cvt_pk_bf16_f32 v75, v38, v39
    v_mfma_f32_16x16x32_bf16 v[192:195], a[192:195], v[48:51], v[192:195]
    ds_read_b64_tr_b16 a[216:217], v3 offset:352
    ds_read_b128 v[24:27], v9 offset:11536
    v_mfma_f32_16x16x32_bf16 v[192:195], a[196:199], v[52:55], v[192:195]
    ds_read_b64_tr_b16 a[218:219], v3 offset:864
    ds_read_b64_tr_b16 a[220:221], v3 offset:17248
    v_fma_mix_f32 v32, v68, v16, v20 op_sel:[0,0,0] op_sel_hi:[1,0,0]
    v_mfma_f32_16x16x32_bf16 v[224:227], a[192:195], v[56:59], v[224:227]
    s_mov_b32 s54, 12288
    ds_read_b64_tr_b16 a[222:223], v3 offset:17760
    ds_read_b128 v[28:31], v9 offset:11568
    v_mfma_f32_16x16x32_bf16 v[224:227], a[196:199], v[60:63], v[224:227]
    s_waitcnt lgkmcnt(10)
    buffer_load_dwordx4 v[96:99], v8, s[32:35], s54 offen sc1
    v_mfma_f32_16x16x32_bf16 v[196:199], a[200:203], v[48:51], v[196:199]
    ds_read_b64_tr_b16 a[224:225], v3 offset:384
    v_fma_mix_f32 v33, v68, v17, v21 op_sel:[1,0,0] op_sel_hi:[1,0,0]
    v_mfma_f32_16x16x32_bf16 v[196:199], a[204:207], v[52:55], v[196:199]
    ds_read_b64_tr_b16 a[226:227], v3 offset:896
    ds_read_b64_tr_b16 a[228:229], v3 offset:17280
    v_fma_mix_f32 v34, v69, v18, v22 op_sel:[0,0,0] op_sel_hi:[1,0,0]
    v_mfma_f32_16x16x32_bf16 v[228:231], a[200:203], v[56:59], v[228:231]
    s_mov_b32 s54, 13312
    ds_read_b64_tr_b16 a[230:231], v3 offset:17792
    v_fma_mix_f32 v35, v69, v19, v23 op_sel:[1,0,0] op_sel_hi:[1,0,0]
    v_mfma_f32_16x16x32_bf16 v[228:231], a[204:207], v[60:63], v[228:231]
    s_waitcnt lgkmcnt(10)
    buffer_load_dwordx4 v[100:103], v8, s[32:35], s54 offen sc1
    v_mfma_f32_16x16x32_bf16 v[200:203], a[208:211], v[48:51], v[200:203]
    ds_read_b64_tr_b16 a[232:233], v3 offset:416
    v_cvt_pk_bf16_f32 v68, v32, v33
    v_mfma_f32_16x16x32_bf16 v[200:203], a[212:215], v[52:55], v[200:203]
    ds_read_b64_tr_b16 a[234:235], v3 offset:928
    ds_read_b64_tr_b16 a[236:237], v3 offset:17312
    v_cvt_pk_bf16_f32 v69, v34, v35
    v_mfma_f32_16x16x32_bf16 v[232:235], a[208:211], v[56:59], v[232:235]
    s_mov_b32 s54, 30720
    ds_read_b64_tr_b16 a[238:239], v3 offset:17824
    v_fma_mix_f32 v36, v76, v16, v20 op_sel:[0,0,0] op_sel_hi:[1,0,0]
    v_mfma_f32_16x16x32_bf16 v[232:235], a[212:215], v[60:63], v[232:235]
    s_waitcnt lgkmcnt(9)
    buffer_load_dwordx4 v[104:107], v8, s[32:35], s54 offen sc1
    v_fma_mix_f32 v37, v76, v17, v21 op_sel:[1,0,0] op_sel_hi:[1,0,0]
    v_mfma_f32_16x16x32_bf16 v[204:207], a[216:219], v[48:51], v[204:207]
    ds_read_b64_tr_b16 a[240:241], v3 offset:448
    v_fma_mix_f32 v38, v77, v18, v22 op_sel:[0,0,0] op_sel_hi:[1,0,0]
    v_mfma_f32_16x16x32_bf16 v[204:207], a[220:223], v[52:55], v[204:207]
    ds_read_b64_tr_b16 a[242:243], v3 offset:960
    ds_read_b64_tr_b16 a[244:245], v3 offset:17344
    v_fma_mix_f32 v39, v77, v19, v23 op_sel:[1,0,0] op_sel_hi:[1,0,0]
    v_mfma_f32_16x16x32_bf16 v[236:239], a[216:219], v[56:59], v[236:239]
    s_mov_b32 s54, 31744
    ds_read_b64_tr_b16 a[246:247], v3 offset:17856
    v_cvt_pk_bf16_f32 v76, v36, v37
    v_mfma_f32_16x16x32_bf16 v[236:239], a[220:223], v[60:63], v[236:239]
    s_waitcnt lgkmcnt(8)
    buffer_load_dwordx4 v[108:111], v8, s[32:35], s54 offen sc1
    v_cvt_pk_bf16_f32 v77, v38, v39
    v_mfma_f32_16x16x32_bf16 v[208:211], a[224:227], v[48:51], v[208:211]
    ds_read_b64_tr_b16 a[248:249], v3 offset:480
    ds_read_b128 v[16:19], v9 offset:11776
    v_mfma_f32_16x16x32_bf16 v[208:211], a[228:231], v[52:55], v[208:211]
    ds_read_b64_tr_b16 a[250:251], v3 offset:992
    ds_read_b128 v[20:23], v9 offset:11808
    v_mfma_f32_16x16x32_bf16 v[240:243], a[224:227], v[56:59], v[240:243]
    ds_read_b64_tr_b16 a[252:253], v3 offset:17376
    v_fma_mix_f32 v32, v70, v24, v28 op_sel:[0,0,0] op_sel_hi:[1,0,0]
    v_mfma_f32_16x16x32_bf16 v[240:243], a[228:231], v[60:63], v[240:243]
    s_waitcnt vmcnt(16)
    s_barrier
    s_waitcnt lgkmcnt(9)
    ds_read_b64_tr_b16 a[254:255], v3 offset:17888
    v_fma_mix_f32 v33, v70, v25, v29 op_sel:[1,0,0] op_sel_hi:[1,0,0]
    v_fma_mix_f32 v34, v71, v26, v30 op_sel:[0,0,0] op_sel_hi:[1,0,0]
    v_mfma_f32_16x16x32_bf16 v[212:215], a[232:235], v[48:51], v[212:215]
    ds_read_b64_tr_b16 a[192:193], v3 offset:36864
    v_fma_mix_f32 v35, v71, v27, v31 op_sel:[1,0,0] op_sel_hi:[1,0,0]
    v_mfma_f32_16x16x32_bf16 v[212:215], a[236:239], v[52:55], v[212:215]
    ds_read_b64_tr_b16 a[194:195], v3 offset:37376
    ds_read_b64_tr_b16 a[196:197], v3 offset:53760
    v_cvt_pk_bf16_f32 v70, v32, v33
    v_mfma_f32_16x16x32_bf16 v[244:247], a[232:235], v[56:59], v[244:247]
    s_add_u32 m0, s44, 110592
    ds_read_b64_tr_b16 a[198:199], v3 offset:54272
    v_cvt_pk_bf16_f32 v71, v34, v35
    v_mfma_f32_16x16x32_bf16 v[244:247], a[236:239], v[60:63], v[244:247]
    s_mov_b32 s45, 3145728
    s_waitcnt lgkmcnt(10)
    buffer_load_dwordx4 v6, s[24:27], s45 offen lds
    v_mfma_f32_16x16x32_bf16 v[216:219], a[240:243], v[48:51], v[216:219]
    ds_read_b64_tr_b16 a[200:201], v3 offset:36896
    v_fma_mix_f32 v36, v78, v24, v28 op_sel:[0,0,0] op_sel_hi:[1,0,0]
    v_mfma_f32_16x16x32_bf16 v[216:219], a[244:247], v[52:55], v[216:219]
    ds_read_b64_tr_b16 a[202:203], v3 offset:37408
    ds_read_b64_tr_b16 a[204:205], v3 offset:53792
    v_fma_mix_f32 v37, v78, v25, v29 op_sel:[1,0,0] op_sel_hi:[1,0,0]
    v_mfma_f32_16x16x32_bf16 v[248:251], a[240:243], v[56:59], v[248:251]
    s_add_u32 m0, s44, 111648
    ds_read_b64_tr_b16 a[206:207], v3 offset:54304
    v_fma_mix_f32 v38, v79, v26, v30 op_sel:[0,0,0] op_sel_hi:[1,0,0]
    v_mfma_f32_16x16x32_bf16 v[248:251], a[244:247], v[60:63], v[248:251]
    s_mov_b32 s45, 3153920
    s_waitcnt lgkmcnt(8)
    buffer_load_dwordx4 v6, s[24:27], s45 offen lds
    v_mfma_f32_16x16x32_bf16 v[220:223], a[248:251], v[48:51], v[220:223]
L2_pad1:
    s_cbranch_execz L2_pad5
    ds_read_b64_tr_b16 a[208:209], v3 offset:36928
    v_fma_mix_f32 v39, v79, v27, v31 op_sel:[1,0,0] op_sel_hi:[1,0,0]
    v_mfma_f32_16x16x32_bf16 v[220:223], a[252:255], v[52:55], v[220:223]
    ds_read_b64_tr_b16 a[210:211], v3 offset:37440
    ds_read_b64_tr_b16 a[212:213], v3 offset:53824
    v_cvt_pk_bf16_f32 v78, v36, v37
    v_mfma_f32_16x16x32_bf16 v[252:255], a[248:251], v[56:59], v[252:255]
    s_add_u32 m0, s44, 112704
    ds_read_b64_tr_b16 a[214:215], v3 offset:54336
    v_cvt_pk_bf16_f32 v79, v38, v39
    v_mfma_f32_16x16x32_bf16 v[252:255], a[252:255], v[60:63], v[252:255]
    s_mov_b32 s45, 3162112
    s_waitcnt lgkmcnt(8)
    buffer_load_dwordx4 v6, s[24:27], s45 offen lds
    v_mfma_f32_16x16x32_bf16 v[128:131], a[192:195], v[64:67], v[128:131]
    s_waitcnt vmcnt(15)
    ds_read_b64_tr_b16 a[216:217], v3 offset:36960
    ds_read_b128 v[24:27], v9 offset:11792
    v_mfma_f32_16x16x32_bf16 v[128:131], a[196:199], v[68:71], v[128:131]
    ds_read_b64_tr_b16 a[218:219], v3 offset:37472
    ds_read_b64_tr_b16 a[220:221], v3 offset:53856
    v_fma_mix_f32 v32, v80, v16, v20 op_sel:[0,0,0] op_sel_hi:[1,0,0]
    v_mfma_f32_16x16x32_bf16 v[160:163], a[192:195], v[72:75], v[160:163]
    s_add_u32 m0, s44, 113760
    ds_read_b64_tr_b16 a[222:223], v3 offset:54368
    ds_read_b128 v[28:31], v9 offset:11824
    v_mfma_f32_16x16x32_bf16 v[160:163], a[196:199], v[76:79], v[160:163]
    s_mov_b32 s45, 3170304
    s_waitcnt lgkmcnt(10)
    buffer_load_dwordx4 v6, s[24:27], s45 offen lds
    v_mfma_f32_16x16x32_bf16 v[132:135], a[200:203], v[64:67], v[132:135]
    ds_read_b64_tr_b16 a[224:225], v3 offset:36992
    v_fma_mix_f32 v33, v80, v17, v21 op_sel:[1,0,0] op_sel_hi:[1,0,0]
    v_mfma_f32_16x16x32_bf16 v[132:135], a[204:207], v[68:71], v[132:135]
    ds_read_b64_tr_b16 a[226:227], v3 offset:37504
    ds_read_b64_tr_b16 a[228:229], v3 offset:53888
    v_fma_mix_f32 v34, v81, v18, v22 op_sel:[0,0,0] op_sel_hi:[1,0,0]
    v_mfma_f32_16x16x32_bf16 v[164:167], a[200:203], v[72:75], v[164:167]
    s_add_u32 m0, s44, 127488
    ds_read_b64_tr_b16 a[230:231], v3 offset:54400
    v_fma_mix_f32 v35, v81, v19, v23 op_sel:[1,0,0] op_sel_hi:[1,0,0]
    v_mfma_f32_16x16x32_bf16 v[164:167], a[204:207], v[76:79], v[164:167]
    s_mov_b32 s45, 3407872
    s_waitcnt lgkmcnt(10)
    buffer_load_dwordx4 v6, s[24:27], s45 offen lds
    v_mfma_f32_16x16x32_bf16 v[136:139], a[208:211], v[64:67], v[136:139]
    ds_read_b64_tr_b16 a[232:233], v3 offset:37024
    v_cvt_pk_bf16_f32 v80, v32, v33
    v_mfma_f32_16x16x32_bf16 v[136:139], a[212:215], v[68:71], v[136:139]
    ds_read_b64_tr_b16 a[234:235], v3 offset:37536
    ds_read_b64_tr_b16 a[236:237], v3 offset:53920
    v_cvt_pk_bf16_f32 v81, v34, v35
    v_mfma_f32_16x16x32_bf16 v[168:171], a[208:211], v[72:75], v[168:171]
    s_add_u32 m0, s44, 128544
    ds_read_b64_tr_b16 a[238:239], v3 offset:54432
    v_fma_mix_f32 v36, v88, v16, v20 op_sel:[0,0,0] op_sel_hi:[1,0,0]
    v_mfma_f32_16x16x32_bf16 v[168:171], a[212:215], v[76:79], v[168:171]
    s_mov_b32 s45, 3416064
    s_waitcnt lgkmcnt(9)
    buffer_load_dwordx4 v6, s[24:27], s45 offen lds
    v_fma_mix_f32 v37, v88, v17, v21 op_sel:[1,0,0] op_sel_hi:[1,0,0]
    v_mfma_f32_16x16x32_bf16 v[140:143], a[216:219], v[64:67], v[140:143]
    ds_read_b64_tr_b16 a[240:241], v3 offset:37056
    v_fma_mix_f32 v38, v89, v18, v22 op_sel:[0,0,0] op_sel_hi:[1,0,0]
    v_mfma_f32_16x16x32_bf16 v[140:143], a[220:223], v[68:71], v[140:143]
    ds_read_b64_tr_b16 a[242:243], v3 offset:37568
    ds_read_b64_tr_b16 a[244:245], v3 offset:53952
    v_fma_mix_f32 v39, v89, v19, v23 op_sel:[1,0,0] op_sel_hi:[1,0,0]
    v_mfma_f32_16x16x32_bf16 v[172:175], a[216:219], v[72:75], v[172:175]
    s_add_u32 m0, s44, 129600
    ds_read_b64_tr_b16 a[246:247], v3 offset:54464
    v_cvt_pk_bf16_f32 v88, v36, v37
    v_mfma_f32_16x16x32_bf16 v[172:175], a[220:223], v[76:79], v[172:175]
    s_mov_b32 s45, 3424256
    s_waitcnt lgkmcnt(8)
    buffer_load_dwordx4 v6, s[24:27], s45 offen lds
    v_cvt_pk_bf16_f32 v89, v38, v39
    v_mfma_f32_16x16x32_bf16 v[144:147], a[224:227], v[64:67], v[144:147]
    ds_read_b64_tr_b16 a[248:249], v3 offset:37088
    ds_read_b128 v[16:19], v9 offset:12032
    v_mfma_f32_16x16x32_bf16 v[144:147], a[228:231], v[68:71], v[144:147]
    ds_read_b64_tr_b16 a[250:251], v3 offset:37600
    ds_read_b64_tr_b16 a[252:253], v3 offset:53984
    v_mfma_f32_16x16x32_bf16 v[176:179], a[224:227], v[72:75], v[176:179]
    s_add_u32 m0, s44, 130656
    ds_read_b64_tr_b16 a[254:255], v3 offset:54496
    ds_read_b128 v[20:23], v9 offset:12064
    v_mfma_f32_16x16x32_bf16 v[176:179], a[228:231], v[76:79], v[176:179]
    s_mov_b32 s45, 3432448
    s_waitcnt lgkmcnt(10)
    buffer_load_dwordx4 v6, s[24:27], s45 offen lds
    v_mfma_f32_16x16x32_bf16 v[148:151], a[232:235], v[64:67], v[148:151]
    ds_read_b64_tr_b16 a[192:193], v3 offset:37120
    v_fma_mix_f32 v32, v82, v24, v28 op_sel:[0,0,0] op_sel_hi:[1,0,0]
    v_mfma_f32_16x16x32_bf16 v[148:151], a[236:239], v[68:71], v[148:151]
    ds_read_b64_tr_b16 a[194:195], v3 offset:37632
    v_fma_mix_f32 v33, v82, v25, v29 op_sel:[1,0,0] op_sel_hi:[1,0,0]
    v_mfma_f32_16x16x32_bf16 v[180:183], a[232:235], v[72:75], v[180:183]
    ds_read_b64_tr_b16 a[196:197], v3 offset:54016
    v_fma_mix_f32 v34, v83, v26, v30 op_sel:[0,0,0] op_sel_hi:[1,0,0]
    v_mfma_f32_16x16x32_bf16 v[180:183], a[236:239], v[76:79], v[180:183]
    s_waitcnt lgkmcnt(9)
    ds_read_b64_tr_b16 a[198:199], v3 offset:54528
    v_fma_mix_f32 v35, v83, v27, v31 op_sel:[1,0,0] op_sel_hi:[1,0,0]
    v_mfma_f32_16x16x32_bf16 v[152:155], a[240:243], v[64:67], v[152:155]
    ds_read_b64_tr_b16 a[200:201], v3 offset:37152
    v_cvt_pk_bf16_f32 v82, v32, v33
    v_mfma_f32_16x16x32_bf16 v[152:155], a[244:247], v[68:71], v[152:155]
    ds_read_b64_tr_b16 a[202:203], v3 offset:37664
    v_cvt_pk_bf16_f32 v83, v34, v35
    v_mfma_f32_16x16x32_bf16 v[184:187], a[240:243], v[72:75], v[184:187]
    ds_read_b64_tr_b16 a[204:205], v3 offset:54048
    v_fma_mix_f32 v36, v90, v24, v28 op_sel:[0,0,0] op_sel_hi:[1,0,0]
    v_mfma_f32_16x16x32_bf16 v[184:187], a[244:247], v[76:79], v[184:187]
    s_waitcnt lgkmcnt(8)
    ds_read_b64_tr_b16 a[206:207], v3 offset:54560
    v_fma_mix_f32 v37, v90, v25, v29 op_sel:[1,0,0] op_sel_hi:[1,0,0]
    v_mfma_f32_16x16x32_bf16 v[156:159], a[248:251], v[64:67], v[156:159]
    ds_read_b64_tr_b16 a[208:209], v3 offset:37184
    v_fma_mix_f32 v38, v91, v26, v30 op_sel:[0,0,0] op_sel_hi:[1,0,0]
    v_mfma_f32_16x16x32_bf16 v[156:159], a[252:255], v[68:71], v[156:159]
    ds_read_b64_tr_b16 a[210:211], v3 offset:37696
    v_fma_mix_f32 v39, v91, v27, v31 op_sel:[1,0,0] op_sel_hi:[1,0,0]
    v_mfma_f32_16x16x32_bf16 v[188:191], a[248:251], v[72:75], v[188:191]
    ds_read_b64_tr_b16 a[212:213], v3 offset:54080
    v_cvt_pk_bf16_f32 v90, v36, v37
    v_mfma_f32_16x16x32_bf16 v[188:191], a[252:255], v[76:79], v[188:191]
    s_waitcnt lgkmcnt(7)
    ds_read_b64_tr_b16 a[214:215], v3 offset:54592
    v_cvt_pk_bf16_f32 v91, v38, v39
    v_mfma_f32_16x16x32_bf16 v[192:195], a[192:195], v[64:67], v[192:195]
    ds_read_b64_tr_b16 a[216:217], v3 offset:37216
    ds_read_b128 v[24:27], v9 offset:12048
    v_mfma_f32_16x16x32_bf16 v[192:195], a[196:199], v[68:71], v[192:195]
    ds_read_b64_tr_b16 a[218:219], v3 offset:37728
    ds_read_b64_tr_b16 a[220:221], v3 offset:54112
    v_fma_mix_f32 v32, v84, v16, v20 op_sel:[0,0,0] op_sel_hi:[1,0,0]
    v_mfma_f32_16x16x32_bf16 v[224:227], a[192:195], v[72:75], v[224:227]
    s_mov_b32 s54, 14336
    ds_read_b64_tr_b16 a[222:223], v3 offset:54624
    ds_read_b128 v[28:31], v9 offset:12080
    v_mfma_f32_16x16x32_bf16 v[224:227], a[196:199], v[76:79], v[224:227]
    s_waitcnt lgkmcnt(10)
    buffer_load_dwordx4 v[112:115], v8, s[32:35], s54 offen sc1
    v_mfma_f32_16x16x32_bf16 v[196:199], a[200:203], v[64:67], v[196:199]
    ds_read_b64_tr_b16 a[224:225], v3 offset:37248
    v_fma_mix_f32 v33, v84, v17, v21 op_sel:[1,0,0] op_sel_hi:[1,0,0]
    v_mfma_f32_16x16x32_bf16 v[196:199], a[204:207], v[68:71], v[196:199]
    ds_read_b64_tr_b16 a[226:227], v3 offset:37760
    ds_read_b64_tr_b16 a[228:229], v3 offset:54144
    v_fma_mix_f32 v34, v85, v18, v22 op_sel:[0,0,0] op_sel_hi:[1,0,0]
    v_mfma_f32_16x16x32_bf16 v[228:231], a[200:203], v[72:75], v[228:231]
    s_mov_b32 s54, 15360
    ds_read_b64_tr_b16 a[230:231], v3 offset:54656
    v_fma_mix_f32 v35, v85, v19, v23 op_sel:[1,0,0] op_sel_hi:[1,0,0]
    v_mfma_f32_16x16x32_bf16 v[228:231], a[204:207], v[76:79], v[228:231]
    s_waitcnt lgkmcnt(10)
    buffer_load_dwordx4 v[116:119], v8, s[32:35], s54 offen sc1
    v_mfma_f32_16x16x32_bf16 v[200:203], a[208:211], v[64:67], v[200:203]
    ds_read_b64_tr_b16 a[232:233], v3 offset:37280
    v_cvt_pk_bf16_f32 v84, v32, v33
    v_mfma_f32_16x16x32_bf16 v[200:203], a[212:215], v[68:71], v[200:203]
    ds_read_b64_tr_b16 a[234:235], v3 offset:37792
    ds_read_b64_tr_b16 a[236:237], v3 offset:54176
    v_cvt_pk_bf16_f32 v85, v34, v35
    v_mfma_f32_16x16x32_bf16 v[232:235], a[208:211], v[72:75], v[232:235]
    s_mov_b32 s54, 32768
    ds_read_b64_tr_b16 a[238:239], v3 offset:54688
    v_fma_mix_f32 v36, v92, v16, v20 op_sel:[0,0,0] op_sel_hi:[1,0,0]
    v_mfma_f32_16x16x32_bf16 v[232:235], a[212:215], v[76:79], v[232:235]
    s_waitcnt lgkmcnt(9)
    buffer_load_dwordx4 v[120:123], v8, s[32:35], s54 offen sc1
    v_fma_mix_f32 v37, v92, v17, v21 op_sel:[1,0,0] op_sel_hi:[1,0,0]
    v_mfma_f32_16x16x32_bf16 v[204:207], a[216:219], v[64:67], v[204:207]
    ds_read_b64_tr_b16 a[240:241], v3 offset:37312
    v_fma_mix_f32 v38, v93, v18, v22 op_sel:[0,0,0] op_sel_hi:[1,0,0]
    v_mfma_f32_16x16x32_bf16 v[204:207], a[220:223], v[68:71], v[204:207]
    ds_read_b64_tr_b16 a[242:243], v3 offset:37824
    ds_read_b64_tr_b16 a[244:245], v3 offset:54208
    v_fma_mix_f32 v39, v93, v19, v23 op_sel:[1,0,0] op_sel_hi:[1,0,0]
    v_mfma_f32_16x16x32_bf16 v[236:239], a[216:219], v[72:75], v[236:239]
    s_mov_b32 s54, 33792
    ds_read_b64_tr_b16 a[246:247], v3 offset:54720
    v_cvt_pk_bf16_f32 v92, v36, v37
    v_mfma_f32_16x16x32_bf16 v[236:239], a[220:223], v[76:79], v[236:239]
    s_waitcnt lgkmcnt(8)
    buffer_load_dwordx4 v[124:127], v8, s[32:35], s54 offen sc1
    v_cvt_pk_bf16_f32 v93, v38, v39
    v_mfma_f32_16x16x32_bf16 v[208:211], a[224:227], v[64:67], v[208:211]
    ds_read_b64_tr_b16 a[248:249], v3 offset:37344
    ds_read_b128 v[16:19], v9 offset:12288
    v_mfma_f32_16x16x32_bf16 v[208:211], a[228:231], v[68:71], v[208:211]
    ds_read_b64_tr_b16 a[250:251], v3 offset:37856
    ds_read_b128 v[20:23], v9 offset:12320
    v_mfma_f32_16x16x32_bf16 v[240:243], a[224:227], v[72:75], v[240:243]
    ds_read_b64_tr_b16 a[252:253], v3 offset:54240
    v_fma_mix_f32 v32, v86, v24, v28 op_sel:[0,0,0] op_sel_hi:[1,0,0]
    v_mfma_f32_16x16x32_bf16 v[240:243], a[228:231], v[76:79], v[240:243]
    s_waitcnt vmcnt(16)
    s_barrier
    s_waitcnt lgkmcnt(9)
    ds_read_b64_tr_b16 a[254:255], v3 offset:54752
    v_fma_mix_f32 v33, v86, v25, v29 op_sel:[1,0,0] op_sel_hi:[1,0,0]
    v_fma_mix_f32 v34, v87, v26, v30 op_sel:[0,0,0] op_sel_hi:[1,0,0]
    v_mfma_f32_16x16x32_bf16 v[212:215], a[232:235], v[64:67], v[212:215]
    ds_read_b64_tr_b16 a[192:193], v4 offset:0
    v_fma_mix_f32 v35, v87, v27, v31 op_sel:[1,0,0] op_sel_hi:[1,0,0]
    v_mfma_f32_16x16x32_bf16 v[212:215], a[236:239], v[68:71], v[212:215]
    ds_read_b64_tr_b16 a[194:195], v4 offset:512
    ds_read_b64_tr_b16 a[196:197], v4 offset:16896
    v_cvt_pk_bf16_f32 v86, v32, v33
    v_mfma_f32_16x16x32_bf16 v[244:247], a[232:235], v[72:75], v[244:247]
    s_add_u32 m0, s44, 0
    ds_read_b64_tr_b16 a[198:199], v4 offset:17408
    v_cvt_pk_bf16_f32 v87, v34, v35
    v_mfma_f32_16x16x32_bf16 v[244:247], a[236:239], v[76:79], v[244:247]
    s_mov_b32 s45, 3670016
    s_waitcnt lgkmcnt(10)
    buffer_load_dwordx4 v6, s[24:27], s45 offen lds
    v_mfma_f32_16x16x32_bf16 v[216:219], a[240:243], v[64:67], v[216:219]
    ds_read_b64_tr_b16 a[200:201], v4 offset:32
    v_fma_mix_f32 v36, v94, v24, v28 op_sel:[0,0,0] op_sel_hi:[1,0,0]
    v_mfma_f32_16x16x32_bf16 v[216:219], a[244:247], v[68:71], v[216:219]
    ds_read_b64_tr_b16 a[202:203], v4 offset:544
    ds_read_b64_tr_b16 a[204:205], v4 offset:16928
    v_fma_mix_f32 v37, v94, v25, v29 op_sel:[1,0,0] op_sel_hi:[1,0,0]
    v_mfma_f32_16x16x32_bf16 v[248:251], a[240:243], v[72:75], v[248:251]
    s_add_u32 m0, s44, 1056
    ds_read_b64_tr_b16 a[206:207], v4 offset:17440
    v_fma_mix_f32 v38, v95, v26, v30 op_sel:[0,0,0] op_sel_hi:[1,0,0]
    v_mfma_f32_16x16x32_bf16 v[248:251], a[244:247], v[76:79], v[248:251]
    s_mov_b32 s45, 3678208
    s_waitcnt lgkmcnt(8)
    buffer_load_dwordx4 v6, s[24:27], s45 offen lds
    v_mfma_f32_16x16x32_bf16 v[220:223], a[248:251], v[64:67], v[220:223]
    ds_read_b64_tr_b16 a[208:209], v4 offset:64
    v_fma_mix_f32 v39, v95, v27, v31 op_sel:[1,0,0] op_sel_hi:[1,0,0]
    v_mfma_f32_16x16x32_bf16 v[220:223], a[252:255], v[68:71], v[220:223]
    ds_read_b64_tr_b16 a[210:211], v4 offset:576
    ds_read_b64_tr_b16 a[212:213], v4 offset:16960
    v_cvt_pk_bf16_f32 v94, v36, v37
    v_mfma_f32_16x16x32_bf16 v[252:255], a[248:251], v[72:75], v[252:255]
    s_add_u32 m0, s44, 2112
    ds_read_b64_tr_b16 a[214:215], v4 offset:17472
    v_cvt_pk_bf16_f32 v95, v38, v39
    v_mfma_f32_16x16x32_bf16 v[252:255], a[252:255], v[76:79], v[252:255]
    s_mov_b32 s45, 3686400
    s_waitcnt lgkmcnt(8)
    buffer_load_dwordx4 v6, s[24:27], s45 offen lds
    v_mfma_f32_16x16x32_bf16 v[128:131], a[192:195], v[80:83], v[128:131]
    s_waitcnt vmcnt(15)
    ds_read_b64_tr_b16 a[216:217], v4 offset:96
    ds_read_b128 v[24:27], v9 offset:12304
    v_mfma_f32_16x16x32_bf16 v[128:131], a[196:199], v[84:87], v[128:131]
    ds_read_b64_tr_b16 a[218:219], v4 offset:608
    ds_read_b64_tr_b16 a[220:221], v4 offset:16992
    v_fma_mix_f32 v32, v96, v16, v20 op_sel:[0,0,0] op_sel_hi:[1,0,0]
    v_mfma_f32_16x16x32_bf16 v[160:163], a[192:195], v[88:91], v[160:163]
    s_add_u32 m0, s44, 3168
    ds_read_b64_tr_b16 a[222:223], v4 offset:17504
    ds_read_b128 v[28:31], v9 offset:12336
    v_mfma_f32_16x16x32_bf16 v[160:163], a[196:199], v[92:95], v[160:163]
    s_mov_b32 s45, 3694592
    s_waitcnt lgkmcnt(10)
    buffer_load_dwordx4 v6, s[24:27], s45 offen lds
    v_mfma_f32_16x16x32_bf16 v[132:135], a[200:203], v[80:83], v[132:135]
    ds_read_b64_tr_b16 a[224:225], v4 offset:128
    v_fma_mix_f32 v33, v96, v17, v21 op_sel:[1,0,0] op_sel_hi:[1,0,0]
    v_mfma_f32_16x16x32_bf16 v[132:135], a[204:207], v[84:87], v[132:135]
    ds_read_b64_tr_b16 a[226:227], v4 offset:640
    ds_read_b64_tr_b16 a[228:229], v4 offset:17024
    v_fma_mix_f32 v34, v97, v18, v22 op_sel:[0,0,0] op_sel_hi:[1,0,0]
    v_mfma_f32_16x16x32_bf16 v[164:167], a[200:203], v[88:91], v[164:167]
    s_add_u32 m0, s44, 16896
    ds_read_b64_tr_b16 a[230:231], v4 offset:17536
    v_fma_mix_f32 v35, v97, v19, v23 op_sel:[1,0,0] op_sel_hi:[1,0,0]
    v_mfma_f32_16x16x32_bf16 v[164:167], a[204:207], v[92:95], v[164:167]
    s_mov_b32 s45, 3932160
    s_waitcnt lgkmcnt(10)
    buffer_load_dwordx4 v6, s[24:27], s45 offen lds
    v_mfma_f32_16x16x32_bf16 v[136:139], a[208:211], v[80:83], v[136:139]
    ds_read_b64_tr_b16 a[232:233], v4 offset:160
    v_cvt_pk_bf16_f32 v96, v32, v33
    v_mfma_f32_16x16x32_bf16 v[136:139], a[212:215], v[84:87], v[136:139]
    ds_read_b64_tr_b16 a[234:235], v4 offset:672
    ds_read_b64_tr_b16 a[236:237], v4 offset:17056
    v_cvt_pk_bf16_f32 v97, v34, v35
    v_mfma_f32_16x16x32_bf16 v[168:171], a[208:211], v[88:91], v[168:171]
    s_add_u32 m0, s44, 17952
    ds_read_b64_tr_b16 a[238:239], v4 offset:17568
    v_fma_mix_f32 v36, v104, v16, v20 op_sel:[0,0,0] op_sel_hi:[1,0,0]
    v_mfma_f32_16x16x32_bf16 v[168:171], a[212:215], v[92:95], v[168:171]
    s_mov_b32 s45, 3940352
    s_waitcnt lgkmcnt(9)
    buffer_load_dwordx4 v6, s[24:27], s45 offen lds
    v_fma_mix_f32 v37, v104, v17, v21 op_sel:[1,0,0] op_sel_hi:[1,0,0]
    v_mfma_f32_16x16x32_bf16 v[140:143], a[216:219], v[80:83], v[140:143]
    ds_read_b64_tr_b16 a[240:241], v4 offset:192
    v_fma_mix_f32 v38, v105, v18, v22 op_sel:[0,0,0] op_sel_hi:[1,0,0]
    v_mfma_f32_16x16x32_bf16 v[140:143], a[220:223], v[84:87], v[140:143]
    ds_read_b64_tr_b16 a[242:243], v4 offset:704
    ds_read_b64_tr_b16 a[244:245], v4 offset:17088
    v_fma_mix_f32 v39, v105, v19, v23 op_sel:[1,0,0] op_sel_hi:[1,0,0]
    v_mfma_f32_16x16x32_bf16 v[172:175], a[216:219], v[88:91], v[172:175]
    s_add_u32 m0, s44, 19008
    ds_read_b64_tr_b16 a[246:247], v4 offset:17600
    v_cvt_pk_bf16_f32 v104, v36, v37
    v_mfma_f32_16x16x32_bf16 v[172:175], a[220:223], v[92:95], v[172:175]
    s_mov_b32 s45, 3948544
    s_waitcnt lgkmcnt(8)
    buffer_load_dwordx4 v6, s[24:27], s45 offen lds
    v_cvt_pk_bf16_f32 v105, v38, v39
    v_mfma_f32_16x16x32_bf16 v[144:147], a[224:227], v[80:83], v[144:147]
    ds_read_b64_tr_b16 a[248:249], v4 offset:224
    ds_read_b128 v[16:19], v9 offset:12544
    v_mfma_f32_16x16x32_bf16 v[144:147], a[228:231], v[84:87], v[144:147]
    ds_read_b64_tr_b16 a[250:251], v4 offset:736
    ds_read_b64_tr_b16 a[252:253], v4 offset:17120
    v_mfma_f32_16x16x32_bf16 v[176:179], a[224:227], v[88:91], v[176:179]
    s_add_u32 m0, s44, 20064
    ds_read_b64_tr_b16 a[254:255], v4 offset:17632
    ds_read_b128 v[20:23], v9 offset:12576
    v_mfma_f32_16x16x32_bf16 v[176:179], a[228:231], v[92:95], v[176:179]
    s_mov_b32 s45, 3956736
    s_waitcnt lgkmcnt(10)
    buffer_load_dwordx4 v6, s[24:27], s45 offen lds
    v_mfma_f32_16x16x32_bf16 v[148:151], a[232:235], v[80:83], v[148:151]
    ds_read_b64_tr_b16 a[192:193], v4 offset:256
    v_fma_mix_f32 v32, v98, v24, v28 op_sel:[0,0,0] op_sel_hi:[1,0,0]
    v_mfma_f32_16x16x32_bf16 v[148:151], a[236:239], v[84:87], v[148:151]
    ds_read_b64_tr_b16 a[194:195], v4 offset:768
    v_fma_mix_f32 v33, v98, v25, v29 op_sel:[1,0,0] op_sel_hi:[1,0,0]
    v_mfma_f32_16x16x32_bf16 v[180:183], a[232:235], v[88:91], v[180:183]
    ds_read_b64_tr_b16 a[196:197], v4 offset:17152
    v_fma_mix_f32 v34, v99, v26, v30 op_sel:[0,0,0] op_sel_hi:[1,0,0]
    v_mfma_f32_16x16x32_bf16 v[180:183], a[236:239], v[92:95], v[180:183]
    s_waitcnt lgkmcnt(9)
    ds_read_b64_tr_b16 a[198:199], v4 offset:17664
    v_fma_mix_f32 v35, v99, v27, v31 op_sel:[1,0,0] op_sel_hi:[1,0,0]
    v_mfma_f32_16x16x32_bf16 v[152:155], a[240:243], v[80:83], v[152:155]
    ds_read_b64_tr_b16 a[200:201], v4 offset:288
    v_cvt_pk_bf16_f32 v98, v32, v33
    v_mfma_f32_16x16x32_bf16 v[152:155], a[244:247], v[84:87], v[152:155]
    ds_read_b64_tr_b16 a[202:203], v4 offset:800
    v_cvt_pk_bf16_f32 v99, v34, v35
    v_mfma_f32_16x16x32_bf16 v[184:187], a[240:243], v[88:91], v[184:187]
    ds_read_b64_tr_b16 a[204:205], v4 offset:17184
    v_fma_mix_f32 v36, v106, v24, v28 op_sel:[0,0,0] op_sel_hi:[1,0,0]
    v_mfma_f32_16x16x32_bf16 v[184:187], a[244:247], v[92:95], v[184:187]
    s_waitcnt lgkmcnt(8)
    ds_read_b64_tr_b16 a[206:207], v4 offset:17696
    v_fma_mix_f32 v37, v106, v25, v29 op_sel:[1,0,0] op_sel_hi:[1,0,0]
    v_mfma_f32_16x16x32_bf16 v[156:159], a[248:251], v[80:83], v[156:159]
    ds_read_b64_tr_b16 a[208:209], v4 offset:320
    v_fma_mix_f32 v38, v107, v26, v30 op_sel:[0,0,0] op_sel_hi:[1,0,0]
    v_mfma_f32_16x16x32_bf16 v[156:159], a[252:255], v[84:87], v[156:159]
    ds_read_b64_tr_b16 a[210:211], v4 offset:832
    v_fma_mix_f32 v39, v107, v27, v31 op_sel:[1,0,0] op_sel_hi:[1,0,0]
    v_mfma_f32_16x16x32_bf16 v[188:191], a[248:251], v[88:91], v[188:191]
    ds_read_b64_tr_b16 a[212:213], v4 offset:17216
    v_cvt_pk_bf16_f32 v106, v36, v37
    v_mfma_f32_16x16x32_bf16 v[188:191], a[252:255], v[92:95], v[188:191]
    s_waitcnt lgkmcnt(7)
    ds_read_b64_tr_b16 a[214:215], v4 offset:17728
    v_cvt_pk_bf16_f32 v107, v38, v39
    v_mfma_f32_16x16x32_bf16 v[192:195], a[192:195], v[80:83], v[192:195]
    ds_read_b64_tr_b16 a[216:217], v4 offset:352
    ds_read_b128 v[24:27], v9 offset:12560
    v_mfma_f32_16x16x32_bf16 v[192:195], a[196:199], v[84:87], v[192:195]
    ds_read_b64_tr_b16 a[218:219], v4 offset:864
    ds_read_b64_tr_b16 a[220:221], v4 offset:17248
    v_fma_mix_f32 v32, v100, v16, v20 op_sel:[0,0,0] op_sel_hi:[1,0,0]
    v_mfma_f32_16x16x32_bf16 v[224:227], a[192:195], v[88:91], v[224:227]
    s_mov_b32 s54, 16384
    ds_read_b64_tr_b16 a[222:223], v4 offset:17760
    ds_read_b128 v[28:31], v9 offset:12592
    v_mfma_f32_16x16x32_bf16 v[224:227], a[196:199], v[92:95], v[224:227]
    s_waitcnt lgkmcnt(10)
    buffer_load_dwordx4 v[48:51], v8, s[32:35], s54 offen sc1
    v_mfma_f32_16x16x32_bf16 v[196:199], a[200:203], v[80:83], v[196:199]
    ds_read_b64_tr_b16 a[224:225], v4 offset:384
    v_fma_mix_f32 v33, v100, v17, v21 op_sel:[1,0,0] op_sel_hi:[1,0,0]
    v_mfma_f32_16x16x32_bf16 v[196:199], a[204:207], v[84:87], v[196:199]
    ds_read_b64_tr_b16 a[226:227], v4 offset:896
    ds_read_b64_tr_b16 a[228:229], v4 offset:17280
    v_fma_mix_f32 v34, v101, v18, v22 op_sel:[0,0,0] op_sel_hi:[1,0,0]
    v_mfma_f32_16x16x32_bf16 v[228:231], a[200:203], v[88:91], v[228:231]
    s_mov_b32 s54, 17408
    ds_read_b64_tr_b16 a[230:231], v4 offset:17792
    v_fma_mix_f32 v35, v101, v19, v23 op_sel:[1,0,0] op_sel_hi:[1,0,0]
    v_mfma_f32_16x16x32_bf16 v[228:231], a[204:207], v[92:95], v[228:231]
    s_waitcnt lgkmcnt(10)
    buffer_load_dwordx4 v[52:55], v8, s[32:35], s54 offen sc1
    v_mfma_f32_16x16x32_bf16 v[200:203], a[208:211], v[80:83], v[200:203]
    ds_read_b64_tr_b16 a[232:233], v4 offset:416
    v_cvt_pk_bf16_f32 v100, v32, v33
    v_mfma_f32_16x16x32_bf16 v[200:203], a[212:215], v[84:87], v[200:203]
    ds_read_b64_tr_b16 a[234:235], v4 offset:928
    ds_read_b64_tr_b16 a[236:237], v4 offset:17312
    v_cvt_pk_bf16_f32 v101, v34, v35
    v_mfma_f32_16x16x32_bf16 v[232:235], a[208:211], v[88:91], v[232:235]
    s_mov_b32 s54, 34816
    ds_read_b64_tr_b16 a[238:239], v4 offset:17824
    v_fma_mix_f32 v36, v108, v16, v20 op_sel:[0,0,0] op_sel_hi:[1,0,0]
    v_mfma_f32_16x16x32_bf16 v[232:235], a[212:215], v[92:95], v[232:235]
    s_waitcnt lgkmcnt(9)
    buffer_load_dwordx4 v[56:59], v8, s[32:35], s54 offen sc1
    v_fma_mix_f32 v37, v108, v17, v21 op_sel:[1,0,0] op_sel_hi:[1,0,0]
    v_mfma_f32_16x16x32_bf16 v[204:207], a[216:219], v[80:83], v[204:207]
    ds_read_b64_tr_b16 a[240:241], v4 offset:448
    v_fma_mix_f32 v38, v109, v18, v22 op_sel:[0,0,0] op_sel_hi:[1,0,0]
    v_mfma_f32_16x16x32_bf16 v[204:207], a[220:223], v[84:87], v[204:207]
    ds_read_b64_tr_b16 a[242:243], v4 offset:960
    ds_read_b64_tr_b16 a[244:245], v4 offset:17344
    v_fma_mix_f32 v39, v109, v19, v23 op_sel:[1,0,0] op_sel_hi:[1,0,0]
    v_mfma_f32_16x16x32_bf16 v[236:239], a[216:219], v[88:91], v[236:239]
    s_mov_b32 s54, 35840
    ds_read_b64_tr_b16 a[246:247], v4 offset:17856
    v_cvt_pk_bf16_f32 v108, v36, v37
    v_mfma_f32_16x16x32_bf16 v[236:239], a[220:223], v[92:95], v[236:239]
    s_waitcnt lgkmcnt(8)
    buffer_load_dwordx4 v[60:63], v8, s[32:35], s54 offen sc1
    v_cvt_pk_bf16_f32 v109, v38, v39
    v_mfma_f32_16x16x32_bf16 v[208:211], a[224:227], v[80:83], v[208:211]
    ds_read_b64_tr_b16 a[248:249], v4 offset:480
    ds_read_b128 v[16:19], v9 offset:12800
    v_mfma_f32_16x16x32_bf16 v[208:211], a[228:231], v[84:87], v[208:211]
    ds_read_b64_tr_b16 a[250:251], v4 offset:992
    ds_read_b128 v[20:23], v9 offset:12832
    v_mfma_f32_16x16x32_bf16 v[240:243], a[224:227], v[88:91], v[240:243]
    ds_read_b64_tr_b16 a[252:253], v4 offset:17376
    v_fma_mix_f32 v32, v102, v24, v28 op_sel:[0,0,0] op_sel_hi:[1,0,0]
    v_mfma_f32_16x16x32_bf16 v[240:243], a[228:231], v[92:95], v[240:243]
    s_waitcnt vmcnt(16)
    s_barrier
    s_waitcnt lgkmcnt(9)
    ds_read_b64_tr_b16 a[254:255], v4 offset:17888
    v_fma_mix_f32 v33, v102, v25, v29 op_sel:[1,0,0] op_sel_hi:[1,0,0]
    v_fma_mix_f32 v34, v103, v26, v30 op_sel:[0,0,0] op_sel_hi:[1,0,0]
    v_mfma_f32_16x16x32_bf16 v[212:215], a[232:235], v[80:83], v[212:215]
    ds_read_b64_tr_b16 a[192:193], v4 offset:36864
    v_fma_mix_f32 v35, v103, v27, v31 op_sel:[1,0,0] op_sel_hi:[1,0,0]
    v_mfma_f32_16x16x32_bf16 v[212:215], a[236:239], v[84:87], v[212:215]
    ds_read_b64_tr_b16 a[194:195], v4 offset:37376
    ds_read_b64_tr_b16 a[196:197], v4 offset:53760
    v_cvt_pk_bf16_f32 v102, v32, v33
    v_mfma_f32_16x16x32_bf16 v[244:247], a[232:235], v[88:91], v[244:247]
    s_add_u32 m0, s44, 36864
    ds_read_b64_tr_b16 a[198:199], v4 offset:54272
    v_cvt_pk_bf16_f32 v103, v34, v35
    v_mfma_f32_16x16x32_bf16 v[244:247], a[236:239], v[92:95], v[244:247]
    s_mov_b32 s45, 4194304
    s_waitcnt lgkmcnt(10)
    buffer_load_dwordx4 v6, s[24:27], s45 offen lds
    v_mfma_f32_16x16x32_bf16 v[216:219], a[240:243], v[80:83], v[216:219]
    ds_read_b64_tr_b16 a[200:201], v4 offset:36896
    v_fma_mix_f32 v36, v110, v24, v28 op_sel:[0,0,0] op_sel_hi:[1,0,0]
    v_mfma_f32_16x16x32_bf16 v[216:219], a[244:247], v[84:87], v[216:219]
    ds_read_b64_tr_b16 a[202:203], v4 offset:37408
    ds_read_b64_tr_b16 a[204:205], v4 offset:53792
    v_fma_mix_f32 v37, v110, v25, v29 op_sel:[1,0,0] op_sel_hi:[1,0,0]
    v_mfma_f32_16x16x32_bf16 v[248:251], a[240:243], v[88:91], v[248:251]
    s_add_u32 m0, s44, 37920
    ds_read_b64_tr_b16 a[206:207], v4 offset:54304
    v_fma_mix_f32 v38, v111, v26, v30 op_sel:[0,0,0] op_sel_hi:[1,0,0]
    v_mfma_f32_16x16x32_bf16 v[248:251], a[244:247], v[92:95], v[248:251]
    s_mov_b32 s45, 4202496
    s_waitcnt lgkmcnt(8)
    buffer_load_dwordx4 v6, s[24:27], s45 offen lds
    v_mfma_f32_16x16x32_bf16 v[220:223], a[248:251], v[80:83], v[220:223]
    ds_read_b64_tr_b16 a[208:209], v4 offset:36928
    v_fma_mix_f32 v39, v111, v27, v31 op_sel:[1,0,0] op_sel_hi:[1,0,0]
    v_mfma_f32_16x16x32_bf16 v[220:223], a[252:255], v[84:87], v[220:223]
    ds_read_b64_tr_b16 a[210:211], v4 offset:37440
    ds_read_b64_tr_b16 a[212:213], v4 offset:53824
    v_cvt_pk_bf16_f32 v110, v36, v37
    v_mfma_f32_16x16x32_bf16 v[252:255], a[248:251], v[88:91], v[252:255]
    s_add_u32 m0, s44, 38976
    ds_read_b64_tr_b16 a[214:215], v4 offset:54336
    v_cvt_pk_bf16_f32 v111, v38, v39
    v_mfma_f32_16x16x32_bf16 v[252:255], a[252:255], v[92:95], v[252:255]
    s_mov_b32 s45, 4210688
    s_waitcnt lgkmcnt(8)
    buffer_load_dwordx4 v6, s[24:27], s45 offen lds
    v_mfma_f32_16x16x32_bf16 v[128:131], a[192:195], v[96:99], v[128:131]
    s_waitcnt vmcnt(15)
    ds_read_b64_tr_b16 a[216:217], v4 offset:36960
    ds_read_b128 v[24:27], v9 offset:12816
    v_mfma_f32_16x16x32_bf16 v[128:131], a[196:199], v[100:103], v[128:131]
    ds_read_b64_tr_b16 a[218:219], v4 offset:37472
    ds_read_b64_tr_b16 a[220:221], v4 offset:53856
    v_fma_mix_f32 v32, v112, v16, v20 op_sel:[0,0,0] op_sel_hi:[1,0,0]
    v_mfma_f32_16x16x32_bf16 v[160:163], a[192:195], v[104:107], v[160:163]
    s_add_u32 m0, s44, 40032
    ds_read_b64_tr_b16 a[222:223], v4 offset:54368
    ds_read_b128 v[28:31], v9 offset:12848
    v_mfma_f32_16x16x32_bf16 v[160:163], a[196:199], v[108:111], v[160:163]
    s_mov_b32 s45, 4218880
    s_waitcnt lgkmcnt(10)
    buffer_load_dwordx4 v6, s[24:27], s45 offen lds
    v_mfma_f32_16x16x32_bf16 v[132:135], a[200:203], v[96:99], v[132:135]
    ds_read_b64_tr_b16 a[224:225], v4 offset:36992
    v_fma_mix_f32 v33, v112, v17, v21 op_sel:[1,0,0] op_sel_hi:[1,0,0]
    v_mfma_f32_16x16x32_bf16 v[132:135], a[204:207], v[100:103], v[132:135]
    ds_read_b64_tr_b16 a[226:227], v4 offset:37504
    ds_read_b64_tr_b16 a[228:229], v4 offset:53888
    v_fma_mix_f32 v34, v113, v18, v22 op_sel:[0,0,0] op_sel_hi:[1,0,0]
    v_mfma_f32_16x16x32_bf16 v[164:167], a[200:203], v[104:107], v[164:167]
    s_add_u32 m0, s44, 53760
    ds_read_b64_tr_b16 a[230:231], v4 offset:54400
    v_fma_mix_f32 v35, v113, v19, v23 op_sel:[1,0,0] op_sel_hi:[1,0,0]
    v_mfma_f32_16x16x32_bf16 v[164:167], a[204:207], v[108:111], v[164:167]
    s_mov_b32 s45, 4456448
    s_waitcnt lgkmcnt(10)
    buffer_load_dwordx4 v6, s[24:27], s45 offen lds
    v_mfma_f32_16x16x32_bf16 v[136:139], a[208:211], v[96:99], v[136:139]
    ds_read_b64_tr_b16 a[232:233], v4 offset:37024
    v_cvt_pk_bf16_f32 v112, v32, v33
    v_mfma_f32_16x16x32_bf16 v[136:139], a[212:215], v[100:103], v[136:139]
    ds_read_b64_tr_b16 a[234:235], v4 offset:37536
    ds_read_b64_tr_b16 a[236:237], v4 offset:53920
    v_cvt_pk_bf16_f32 v113, v34, v35
    v_mfma_f32_16x16x32_bf16 v[168:171], a[208:211], v[104:107], v[168:171]
    s_add_u32 m0, s44, 54816
    ds_read_b64_tr_b16 a[238:239], v4 offset:54432
    v_fma_mix_f32 v36, v120, v16, v20 op_sel:[0,0,0] op_sel_hi:[1,0,0]
    v_mfma_f32_16x16x32_bf16 v[168:171], a[212:215], v[108:111], v[168:171]
    s_mov_b32 s45, 4464640
    s_waitcnt lgkmcnt(9)
    buffer_load_dwordx4 v6, s[24:27], s45 offen lds
    v_fma_mix_f32 v37, v120, v17, v21 op_sel:[1,0,0] op_sel_hi:[1,0,0]
    v_mfma_f32_16x16x32_bf16 v[140:143], a[216:219], v[96:99], v[140:143]
    ds_read_b64_tr_b16 a[240:241], v4 offset:37056
    v_fma_mix_f32 v38, v121, v18, v22 op_sel:[0,0,0] op_sel_hi:[1,0,0]
    v_mfma_f32_16x16x32_bf16 v[140:143], a[220:223], v[100:103], v[140:143]
L2_pad2:
    s_cbranch_execz L2_pad6
    ds_read_b64_tr_b16 a[242:243], v4 offset:37568
    ds_read_b64_tr_b16 a[244:245], v4 offset:53952
    v_fma_mix_f32 v39, v121, v19, v23 op_sel:[1,0,0] op_sel_hi:[1,0,0]
    v_mfma_f32_16x16x32_bf16 v[172:175], a[216:219], v[104:107], v[172:175]
    s_add_u32 m0, s44, 55872
    ds_read_b64_tr_b16 a[246:247], v4 offset:54464
    v_cvt_pk_bf16_f32 v120, v36, v37
    v_mfma_f32_16x16x32_bf16 v[172:175], a[220:223], v[108:111], v[172:175]
    s_mov_b32 s45, 4472832
    s_waitcnt lgkmcnt(8)
    buffer_load_dwordx4 v6, s[24:27], s45 offen lds
    v_cvt_pk_bf16_f32 v121, v38, v39
    v_mfma_f32_16x16x32_bf16 v[144:147], a[224:227], v[96:99], v[144:147]
    ds_read_b64_tr_b16 a[248:249], v4 offset:37088
    ds_read_b128 v[16:19], v9 offset:13056
    v_mfma_f32_16x16x32_bf16 v[144:147], a[228:231], v[100:103], v[144:147]
    ds_read_b64_tr_b16 a[250:251], v4 offset:37600
    ds_read_b64_tr_b16 a[252:253], v4 offset:53984
    v_mfma_f32_16x16x32_bf16 v[176:179], a[224:227], v[104:107], v[176:179]
    s_add_u32 m0, s44, 56928
    ds_read_b64_tr_b16 a[254:255], v4 offset:54496
    ds_read_b128 v[20:23], v9 offset:13088
    v_mfma_f32_16x16x32_bf16 v[176:179], a[228:231], v[108:111], v[176:179]
    s_mov_b32 s45, 4481024
    s_waitcnt lgkmcnt(10)
    buffer_load_dwordx4 v6, s[24:27], s45 offen lds
    v_mfma_f32_16x16x32_bf16 v[148:151], a[232:235], v[96:99], v[148:151]
    ds_read_b64_tr_b16 a[192:193], v4 offset:37120
    v_fma_mix_f32 v32, v114, v24, v28 op_sel:[0,0,0] op_sel_hi:[1,0,0]
    v_mfma_f32_16x16x32_bf16 v[148:151], a[236:239], v[100:103], v[148:151]
    ds_read_b64_tr_b16 a[194:195], v4 offset:37632
    v_fma_mix_f32 v33, v114, v25, v29 op_sel:[1,0,0] op_sel_hi:[1,0,0]
    v_mfma_f32_16x16x32_bf16 v[180:183], a[232:235], v[104:107], v[180:183]
    ds_read_b64_tr_b16 a[196:197], v4 offset:54016
    v_fma_mix_f32 v34, v115, v26, v30 op_sel:[0,0,0] op_sel_hi:[1,0,0]
    v_mfma_f32_16x16x32_bf16 v[180:183], a[236:239], v[108:111], v[180:183]
    s_waitcnt lgkmcnt(9)
    ds_read_b64_tr_b16 a[198:199], v4 offset:54528
    v_fma_mix_f32 v35, v115, v27, v31 op_sel:[1,0,0] op_sel_hi:[1,0,0]
    v_mfma_f32_16x16x32_bf16 v[152:155], a[240:243], v[96:99], v[152:155]
    ds_read_b64_tr_b16 a[200:201], v4 offset:37152
    v_cvt_pk_bf16_f32 v114, v32, v33
    v_mfma_f32_16x16x32_bf16 v[152:155], a[244:247], v[100:103], v[152:155]
    ds_read_b64_tr_b16 a[202:203], v4 offset:37664
    v_cvt_pk_bf16_f32 v115, v34, v35
    v_mfma_f32_16x16x32_bf16 v[184:187], a[240:243], v[104:107], v[184:187]
    ds_read_b64_tr_b16 a[204:205], v4 offset:54048
    v_fma_mix_f32 v36, v122, v24, v28 op_sel:[0,0,0] op_sel_hi:[1,0,0]
    v_mfma_f32_16x16x32_bf16 v[184:187], a[244:247], v[108:111], v[184:187]
    s_waitcnt lgkmcnt(8)
    ds_read_b64_tr_b16 a[206:207], v4 offset:54560
    v_fma_mix_f32 v37, v122, v25, v29 op_sel:[1,0,0] op_sel_hi:[1,0,0]
    v_mfma_f32_16x16x32_bf16 v[156:159], a[248:251], v[96:99], v[156:159]
    ds_read_b64_tr_b16 a[208:209], v4 offset:37184
    v_fma_mix_f32 v38, v123, v26, v30 op_sel:[0,0,0] op_sel_hi:[1,0,0]
    v_mfma_f32_16x16x32_bf16 v[156:159], a[252:255], v[100:103], v[156:159]
    ds_read_b64_tr_b16 a[210:211], v4 offset:37696
    v_fma_mix_f32 v39, v123, v27, v31 op_sel:[1,0,0] op_sel_hi:[1,0,0]
    v_mfma_f32_16x16x32_bf16 v[188:191], a[248:251], v[104:107], v[188:191]
    ds_read_b64_tr_b16 a[212:213], v4 offset:54080
    v_cvt_pk_bf16_f32 v122, v36, v37
    v_mfma_f32_16x16x32_bf16 v[188:191], a[252:255], v[108:111], v[188:191]
    s_waitcnt lgkmcnt(7)
    ds_read_b64_tr_b16 a[214:215], v4 offset:54592
    v_cvt_pk_bf16_f32 v123, v38, v39
    v_mfma_f32_16x16x32_bf16 v[192:195], a[192:195], v[96:99], v[192:195]
    ds_read_b64_tr_b16 a[216:217], v4 offset:37216
    ds_read_b128 v[24:27], v9 offset:13072
    v_mfma_f32_16x16x32_bf16 v[192:195], a[196:199], v[100:103], v[192:195]
    ds_read_b64_tr_b16 a[218:219], v4 offset:37728
    ds_read_b128 v[28:31], v9 offset:13104
    v_mfma_f32_16x16x32_bf16 v[224:227], a[192:195], v[104:107], v[224:227]
    ds_read_b64_tr_b16 a[220:221], v4 offset:54112
    v_fma_mix_f32 v32, v116, v16, v20 op_sel:[0,0,0] op_sel_hi:[1,0,0]
    v_mfma_f32_16x16x32_bf16 v[224:227], a[196:199], v[108:111], v[224:227]
    s_waitcnt lgkmcnt(9)
    ds_read_b64_tr_b16 a[222:223], v4 offset:54624
    v_fma_mix_f32 v33, v116, v17, v21 op_sel:[1,0,0] op_sel_hi:[1,0,0]
    v_mfma_f32_16x16x32_bf16 v[196:199], a[200:203], v[96:99], v[196:199]
    ds_read_b64_tr_b16 a[224:225], v4 offset:37248
    v_fma_mix_f32 v34, v117, v18, v22 op_sel:[0,0,0] op_sel_hi:[1,0,0]
    v_mfma_f32_16x16x32_bf16 v[196:199], a[204:207], v[100:103], v[196:199]
    ds_read_b64_tr_b16 a[226:227], v4 offset:37760
    v_fma_mix_f32 v35, v117, v19, v23 op_sel:[1,0,0] op_sel_hi:[1,0,0]
    v_mfma_f32_16x16x32_bf16 v[228:231], a[200:203], v[104:107], v[228:231]
    ds_read_b64_tr_b16 a[228:229], v4 offset:54144
    v_cvt_pk_bf16_f32 v116, v32, v33
    v_mfma_f32_16x16x32_bf16 v[228:231], a[204:207], v[108:111], v[228:231]
    s_waitcnt lgkmcnt(9)
    ds_read_b64_tr_b16 a[230:231], v4 offset:54656
    v_cvt_pk_bf16_f32 v117, v34, v35
    v_mfma_f32_16x16x32_bf16 v[200:203], a[208:211], v[96:99], v[200:203]
    ds_read_b64_tr_b16 a[232:233], v4 offset:37280
    v_fma_mix_f32 v36, v124, v16, v20 op_sel:[0,0,0] op_sel_hi:[1,0,0]
    v_mfma_f32_16x16x32_bf16 v[200:203], a[212:215], v[100:103], v[200:203]
    ds_read_b64_tr_b16 a[234:235], v4 offset:37792
    v_fma_mix_f32 v37, v124, v17, v21 op_sel:[1,0,0] op_sel_hi:[1,0,0]
    v_mfma_f32_16x16x32_bf16 v[232:235], a[208:211], v[104:107], v[232:235]
    ds_read_b64_tr_b16 a[236:237], v4 offset:54176
    v_fma_mix_f32 v38, v125, v18, v22 op_sel:[0,0,0] op_sel_hi:[1,0,0]
    v_mfma_f32_16x16x32_bf16 v[232:235], a[212:215], v[108:111], v[232:235]
    s_waitcnt lgkmcnt(7)
    ds_read_b64_tr_b16 a[238:239], v4 offset:54688
    v_fma_mix_f32 v39, v125, v19, v23 op_sel:[1,0,0] op_sel_hi:[1,0,0]
    v_mfma_f32_16x16x32_bf16 v[204:207], a[216:219], v[96:99], v[204:207]
    ds_read_b64_tr_b16 a[240:241], v4 offset:37312
    v_cvt_pk_bf16_f32 v124, v36, v37
    v_mfma_f32_16x16x32_bf16 v[204:207], a[220:223], v[100:103], v[204:207]
    ds_read_b64_tr_b16 a[242:243], v4 offset:37824
    v_cvt_pk_bf16_f32 v125, v38, v39
    v_mfma_f32_16x16x32_bf16 v[236:239], a[216:219], v[104:107], v[236:239]
    ds_read_b64_tr_b16 a[244:245], v4 offset:54208
    v_mfma_f32_16x16x32_bf16 v[236:239], a[220:223], v[108:111], v[236:239]
    s_waitcnt lgkmcnt(7)
    ds_read_b64_tr_b16 a[246:247], v4 offset:54720
    v_mfma_f32_16x16x32_bf16 v[208:211], a[224:227], v[96:99], v[208:211]
    ds_read_b64_tr_b16 a[248:249], v4 offset:37344
    ds_read_b128 v[16:19], v9 offset:13312
    v_mfma_f32_16x16x32_bf16 v[208:211], a[228:231], v[100:103], v[208:211]
    ds_read_b64_tr_b16 a[250:251], v4 offset:37856
    ds_read_b128 v[20:23], v9 offset:13344
    v_mfma_f32_16x16x32_bf16 v[240:243], a[224:227], v[104:107], v[240:243]
    ds_read_b64_tr_b16 a[252:253], v4 offset:54240
    v_fma_mix_f32 v32, v118, v24, v28 op_sel:[0,0,0] op_sel_hi:[1,0,0]
    v_mfma_f32_16x16x32_bf16 v[240:243], a[228:231], v[108:111], v[240:243]
    s_waitcnt vmcnt(12)
    s_barrier
    s_waitcnt lgkmcnt(9)
    ds_read_b64_tr_b16 a[254:255], v4 offset:54752
    v_fma_mix_f32 v33, v118, v25, v29 op_sel:[1,0,0] op_sel_hi:[1,0,0]
    v_fma_mix_f32 v34, v119, v26, v30 op_sel:[0,0,0] op_sel_hi:[1,0,0]
    v_mfma_f32_16x16x32_bf16 v[212:215], a[232:235], v[96:99], v[212:215]
    ds_read_b64_tr_b16 a[192:193], v3 offset:0
    v_fma_mix_f32 v35, v119, v27, v31 op_sel:[1,0,0] op_sel_hi:[1,0,0]
    v_mfma_f32_16x16x32_bf16 v[212:215], a[236:239], v[100:103], v[212:215]
    ds_read_b64_tr_b16 a[194:195], v3 offset:512
    ds_read_b64_tr_b16 a[196:197], v3 offset:16896
    v_cvt_pk_bf16_f32 v118, v32, v33
    v_mfma_f32_16x16x32_bf16 v[244:247], a[232:235], v[104:107], v[244:247]
    s_add_u32 m0, s44, 73728
    ds_read_b64_tr_b16 a[198:199], v3 offset:17408
    v_cvt_pk_bf16_f32 v119, v34, v35
    v_mfma_f32_16x16x32_bf16 v[244:247], a[236:239], v[108:111], v[244:247]
    s_mov_b32 s46, 0
    s_waitcnt lgkmcnt(10)
    buffer_load_dwordx4 v5, s[16:19], s46 offen offset:0 lds
    v_mfma_f32_16x16x32_bf16 v[216:219], a[240:243], v[96:99], v[216:219]
    ds_read_b64_tr_b16 a[200:201], v3 offset:32
    v_fma_mix_f32 v36, v126, v24, v28 op_sel:[0,0,0] op_sel_hi:[1,0,0]
    v_mfma_f32_16x16x32_bf16 v[216:219], a[244:247], v[100:103], v[216:219]
    ds_read_b64_tr_b16 a[202:203], v3 offset:544
    ds_read_b64_tr_b16 a[204:205], v3 offset:16928
    v_fma_mix_f32 v37, v126, v25, v29 op_sel:[1,0,0] op_sel_hi:[1,0,0]
    v_mfma_f32_16x16x32_bf16 v[248:251], a[240:243], v[104:107], v[248:251]
    s_add_u32 m0, s44, 73760
    ds_read_b64_tr_b16 a[206:207], v3 offset:17440
    v_fma_mix_f32 v38, v127, v26, v30 op_sel:[0,0,0] op_sel_hi:[1,0,0]
    v_mfma_f32_16x16x32_bf16 v[248:251], a[244:247], v[108:111], v[248:251]
    s_waitcnt lgkmcnt(8)
    buffer_load_dwordx4 v5, s[16:19], s46 offen offset:1024 lds
    v_mfma_f32_16x16x32_bf16 v[220:223], a[248:251], v[96:99], v[220:223]
    ds_read_b64_tr_b16 a[208:209], v3 offset:64
    v_fma_mix_f32 v39, v127, v27, v31 op_sel:[1,0,0] op_sel_hi:[1,0,0]
    v_mfma_f32_16x16x32_bf16 v[220:223], a[252:255], v[100:103], v[220:223]
    ds_read_b64_tr_b16 a[210:211], v3 offset:576
    ds_read_b64_tr_b16 a[212:213], v3 offset:16960
    v_cvt_pk_bf16_f32 v126, v36, v37
    v_mfma_f32_16x16x32_bf16 v[252:255], a[248:251], v[104:107], v[252:255]
    s_add_u32 m0, s44, 73792
    ds_read_b64_tr_b16 a[214:215], v3 offset:17472
    v_cvt_pk_bf16_f32 v127, v38, v39
    v_mfma_f32_16x16x32_bf16 v[252:255], a[252:255], v[108:111], v[252:255]
    s_waitcnt lgkmcnt(8)
    buffer_load_dwordx4 v5, s[16:19], s46 offen offset:2048 lds
    v_mfma_f32_16x16x32_bf16 v[128:131], a[192:195], v[112:115], v[128:131]
    s_waitcnt vmcnt(11)
    ds_read_b64_tr_b16 a[216:217], v3 offset:96
    ds_read_b128 v[24:27], v9 offset:13328
    v_mfma_f32_16x16x32_bf16 v[128:131], a[196:199], v[116:119], v[128:131]
    ds_read_b64_tr_b16 a[218:219], v3 offset:608
    ds_read_b64_tr_b16 a[220:221], v3 offset:16992
    v_fma_mix_f32 v32, v48, v16, v20 op_sel:[0,0,0] op_sel_hi:[1,0,0]
    v_mfma_f32_16x16x32_bf16 v[160:163], a[192:195], v[120:123], v[160:163]
    s_add_u32 m0, s44, 73824
    ds_read_b64_tr_b16 a[222:223], v3 offset:17504
    ds_read_b128 v[28:31], v9 offset:13360
    v_mfma_f32_16x16x32_bf16 v[160:163], a[196:199], v[124:127], v[160:163]
    s_waitcnt lgkmcnt(10)
    buffer_load_dwordx4 v5, s[16:19], s46 offen offset:3072 lds
    v_mfma_f32_16x16x32_bf16 v[132:135], a[200:203], v[112:115], v[132:135]
    ds_read_b64_tr_b16 a[224:225], v3 offset:128
    v_fma_mix_f32 v33, v48, v17, v21 op_sel:[1,0,0] op_sel_hi:[1,0,0]
    v_mfma_f32_16x16x32_bf16 v[132:135], a[204:207], v[116:119], v[132:135]
    ds_read_b64_tr_b16 a[226:227], v3 offset:640
    ds_read_b64_tr_b16 a[228:229], v3 offset:17024
    v_fma_mix_f32 v34, v49, v18, v22 op_sel:[0,0,0] op_sel_hi:[1,0,0]
    v_mfma_f32_16x16x32_bf16 v[164:167], a[200:203], v[120:123], v[164:167]
    s_add_u32 m0, s44, 90624
    ds_read_b64_tr_b16 a[230:231], v3 offset:17536
    v_fma_mix_f32 v35, v49, v19, v23 op_sel:[1,0,0] op_sel_hi:[1,0,0]
    v_mfma_f32_16x16x32_bf16 v[164:167], a[204:207], v[124:127], v[164:167]
    s_waitcnt lgkmcnt(10)
    buffer_load_dwordx4 v5, s[20:23], s46 offen offset:0 lds
    v_mfma_f32_16x16x32_bf16 v[136:139], a[208:211], v[112:115], v[136:139]
    ds_read_b64_tr_b16 a[232:233], v3 offset:160
    v_cvt_pk_bf16_f32 v48, v32, v33
    v_mfma_f32_16x16x32_bf16 v[136:139], a[212:215], v[116:119], v[136:139]
    ds_read_b64_tr_b16 a[234:235], v3 offset:672
    ds_read_b64_tr_b16 a[236:237], v3 offset:17056
    v_cvt_pk_bf16_f32 v49, v34, v35
    v_mfma_f32_16x16x32_bf16 v[168:171], a[208:211], v[120:123], v[168:171]
    s_add_u32 m0, s44, 90656
    ds_read_b64_tr_b16 a[238:239], v3 offset:17568
    v_fma_mix_f32 v36, v56, v16, v20 op_sel:[0,0,0] op_sel_hi:[1,0,0]
    v_mfma_f32_16x16x32_bf16 v[168:171], a[212:215], v[124:127], v[168:171]
    s_waitcnt lgkmcnt(9)
    buffer_load_dwordx4 v5, s[20:23], s46 offen offset:1024 lds
    v_fma_mix_f32 v37, v56, v17, v21 op_sel:[1,0,0] op_sel_hi:[1,0,0]
    v_mfma_f32_16x16x32_bf16 v[140:143], a[216:219], v[112:115], v[140:143]
    ds_read_b64_tr_b16 a[240:241], v3 offset:192
    v_fma_mix_f32 v38, v57, v18, v22 op_sel:[0,0,0] op_sel_hi:[1,0,0]
    v_mfma_f32_16x16x32_bf16 v[140:143], a[220:223], v[116:119], v[140:143]
    ds_read_b64_tr_b16 a[242:243], v3 offset:704
    ds_read_b64_tr_b16 a[244:245], v3 offset:17088
    v_fma_mix_f32 v39, v57, v19, v23 op_sel:[1,0,0] op_sel_hi:[1,0,0]
    v_mfma_f32_16x16x32_bf16 v[172:175], a[216:219], v[120:123], v[172:175]
    s_add_u32 m0, s44, 90688
    ds_read_b64_tr_b16 a[246:247], v3 offset:17600
    v_cvt_pk_bf16_f32 v56, v36, v37
    v_mfma_f32_16x16x32_bf16 v[172:175], a[220:223], v[124:127], v[172:175]
    s_waitcnt lgkmcnt(8)
    buffer_load_dwordx4 v5, s[20:23], s46 offen offset:2048 lds
    v_cvt_pk_bf16_f32 v57, v38, v39
    v_mfma_f32_16x16x32_bf16 v[144:147], a[224:227], v[112:115], v[144:147]
    ds_read_b64_tr_b16 a[248:249], v3 offset:224
    ds_read_b128 v[16:19], v9 offset:13568
    v_mfma_f32_16x16x32_bf16 v[144:147], a[228:231], v[116:119], v[144:147]
    ds_read_b64_tr_b16 a[250:251], v3 offset:736
    ds_read_b64_tr_b16 a[252:253], v3 offset:17120
    v_mfma_f32_16x16x32_bf16 v[176:179], a[224:227], v[120:123], v[176:179]
    s_add_u32 m0, s44, 90720
    ds_read_b64_tr_b16 a[254:255], v3 offset:17632
    ds_read_b128 v[20:23], v9 offset:13600
    v_mfma_f32_16x16x32_bf16 v[176:179], a[228:231], v[124:127], v[176:179]
    s_waitcnt lgkmcnt(10)
    buffer_load_dwordx4 v5, s[20:23], s46 offen offset:3072 lds
    v_mfma_f32_16x16x32_bf16 v[148:151], a[232:235], v[112:115], v[148:151]
    ds_read_b64_tr_b16 a[192:193], v3 offset:256
    v_fma_mix_f32 v32, v50, v24, v28 op_sel:[0,0,0] op_sel_hi:[1,0,0]
    v_mfma_f32_16x16x32_bf16 v[148:151], a[236:239], v[116:119], v[148:151]
    ds_read_b64_tr_b16 a[194:195], v3 offset:768
    v_fma_mix_f32 v33, v50, v25, v29 op_sel:[1,0,0] op_sel_hi:[1,0,0]
    v_mfma_f32_16x16x32_bf16 v[180:183], a[232:235], v[120:123], v[180:183]
    ds_read_b64_tr_b16 a[196:197], v3 offset:17152
    v_fma_mix_f32 v34, v51, v26, v30 op_sel:[0,0,0] op_sel_hi:[1,0,0]
    v_mfma_f32_16x16x32_bf16 v[180:183], a[236:239], v[124:127], v[180:183]
    s_waitcnt lgkmcnt(9)
    ds_read_b64_tr_b16 a[198:199], v3 offset:17664
    v_fma_mix_f32 v35, v51, v27, v31 op_sel:[1,0,0] op_sel_hi:[1,0,0]
    v_mfma_f32_16x16x32_bf16 v[152:155], a[240:243], v[112:115], v[152:155]
    ds_read_b64_tr_b16 a[200:201], v3 offset:288
    v_cvt_pk_bf16_f32 v50, v32, v33
    v_mfma_f32_16x16x32_bf16 v[152:155], a[244:247], v[116:119], v[152:155]
    ds_read_b64_tr_b16 a[202:203], v3 offset:800
    v_cvt_pk_bf16_f32 v51, v34, v35
    v_mfma_f32_16x16x32_bf16 v[184:187], a[240:243], v[120:123], v[184:187]
    ds_read_b64_tr_b16 a[204:205], v3 offset:17184
    v_fma_mix_f32 v36, v58, v24, v28 op_sel:[0,0,0] op_sel_hi:[1,0,0]
    v_mfma_f32_16x16x32_bf16 v[184:187], a[244:247], v[124:127], v[184:187]
    s_waitcnt lgkmcnt(8)
    ds_read_b64_tr_b16 a[206:207], v3 offset:17696
    v_fma_mix_f32 v37, v58, v25, v29 op_sel:[1,0,0] op_sel_hi:[1,0,0]
    v_mfma_f32_16x16x32_bf16 v[156:159], a[248:251], v[112:115], v[156:159]
    ds_read_b64_tr_b16 a[208:209], v3 offset:320
    v_fma_mix_f32 v38, v59, v26, v30 op_sel:[0,0,0] op_sel_hi:[1,0,0]
    v_mfma_f32_16x16x32_bf16 v[156:159], a[252:255], v[116:119], v[156:159]
    ds_read_b64_tr_b16 a[210:211], v3 offset:832
    v_fma_mix_f32 v39, v59, v27, v31 op_sel:[1,0,0] op_sel_hi:[1,0,0]
    v_mfma_f32_16x16x32_bf16 v[188:191], a[248:251], v[120:123], v[188:191]
    ds_read_b64_tr_b16 a[212:213], v3 offset:17216
    v_cvt_pk_bf16_f32 v58, v36, v37
    v_mfma_f32_16x16x32_bf16 v[188:191], a[252:255], v[124:127], v[188:191]
    s_waitcnt lgkmcnt(7)
    ds_read_b64_tr_b16 a[214:215], v3 offset:17728
    v_cvt_pk_bf16_f32 v59, v38, v39
    v_mfma_f32_16x16x32_bf16 v[192:195], a[192:195], v[112:115], v[192:195]
    ds_read_b64_tr_b16 a[216:217], v3 offset:352
    ds_read_b128 v[24:27], v9 offset:13584
    v_mfma_f32_16x16x32_bf16 v[192:195], a[196:199], v[116:119], v[192:195]
    ds_read_b64_tr_b16 a[218:219], v3 offset:864
    ds_read_b128 v[28:31], v9 offset:13616
    v_mfma_f32_16x16x32_bf16 v[224:227], a[192:195], v[120:123], v[224:227]
    ds_read_b64_tr_b16 a[220:221], v3 offset:17248
    v_fma_mix_f32 v32, v52, v16, v20 op_sel:[0,0,0] op_sel_hi:[1,0,0]
    v_mfma_f32_16x16x32_bf16 v[224:227], a[196:199], v[124:127], v[224:227]
    s_waitcnt lgkmcnt(9)
    ds_read_b64_tr_b16 a[222:223], v3 offset:17760
    v_fma_mix_f32 v33, v52, v17, v21 op_sel:[1,0,0] op_sel_hi:[1,0,0]
    v_mfma_f32_16x16x32_bf16 v[196:199], a[200:203], v[112:115], v[196:199]
    ds_read_b64_tr_b16 a[224:225], v3 offset:384
    v_fma_mix_f32 v34, v53, v18, v22 op_sel:[0,0,0] op_sel_hi:[1,0,0]
    v_mfma_f32_16x16x32_bf16 v[196:199], a[204:207], v[116:119], v[196:199]
    ds_read_b64_tr_b16 a[226:227], v3 offset:896
    v_fma_mix_f32 v35, v53, v19, v23 op_sel:[1,0,0] op_sel_hi:[1,0,0]
    v_mfma_f32_16x16x32_bf16 v[228:231], a[200:203], v[120:123], v[228:231]
    ds_read_b64_tr_b16 a[228:229], v3 offset:17280
    v_cvt_pk_bf16_f32 v52, v32, v33
    v_mfma_f32_16x16x32_bf16 v[228:231], a[204:207], v[124:127], v[228:231]
    s_waitcnt lgkmcnt(9)
    ds_read_b64_tr_b16 a[230:231], v3 offset:17792
    v_cvt_pk_bf16_f32 v53, v34, v35
    v_mfma_f32_16x16x32_bf16 v[200:203], a[208:211], v[112:115], v[200:203]
    ds_read_b64_tr_b16 a[232:233], v3 offset:416
    v_fma_mix_f32 v36, v60, v16, v20 op_sel:[0,0,0] op_sel_hi:[1,0,0]
    v_mfma_f32_16x16x32_bf16 v[200:203], a[212:215], v[116:119], v[200:203]
    ds_read_b64_tr_b16 a[234:235], v3 offset:928
    v_fma_mix_f32 v37, v60, v17, v21 op_sel:[1,0,0] op_sel_hi:[1,0,0]
    v_mfma_f32_16x16x32_bf16 v[232:235], a[208:211], v[120:123], v[232:235]
    ds_read_b64_tr_b16 a[236:237], v3 offset:17312
    v_fma_mix_f32 v38, v61, v18, v22 op_sel:[0,0,0] op_sel_hi:[1,0,0]
    v_mfma_f32_16x16x32_bf16 v[232:235], a[212:215], v[124:127], v[232:235]
    s_waitcnt lgkmcnt(7)
    ds_read_b64_tr_b16 a[238:239], v3 offset:17824
    v_fma_mix_f32 v39, v61, v19, v23 op_sel:[1,0,0] op_sel_hi:[1,0,0]
    v_mfma_f32_16x16x32_bf16 v[204:207], a[216:219], v[112:115], v[204:207]
    ds_read_b64_tr_b16 a[240:241], v3 offset:448
    v_cvt_pk_bf16_f32 v60, v36, v37
    v_mfma_f32_16x16x32_bf16 v[204:207], a[220:223], v[116:119], v[204:207]
    ds_read_b64_tr_b16 a[242:243], v3 offset:960
    v_cvt_pk_bf16_f32 v61, v38, v39
    v_mfma_f32_16x16x32_bf16 v[236:239], a[216:219], v[120:123], v[236:239]
    ds_read_b64_tr_b16 a[244:245], v3 offset:17344
    v_mfma_f32_16x16x32_bf16 v[236:239], a[220:223], v[124:127], v[236:239]
    s_waitcnt lgkmcnt(7)
    ds_read_b64_tr_b16 a[246:247], v3 offset:17856
    v_mfma_f32_16x16x32_bf16 v[208:211], a[224:227], v[112:115], v[208:211]
    ds_read_b64_tr_b16 a[248:249], v3 offset:480
    v_fma_mix_f32 v32, v54, v24, v28 op_sel:[0,0,0] op_sel_hi:[1,0,0]
    v_mfma_f32_16x16x32_bf16 v[208:211], a[228:231], v[116:119], v[208:211]
    ds_read_b64_tr_b16 a[250:251], v3 offset:992
    v_fma_mix_f32 v33, v54, v25, v29 op_sel:[1,0,0] op_sel_hi:[1,0,0]
    v_mfma_f32_16x16x32_bf16 v[240:243], a[224:227], v[120:123], v[240:243]
    ds_read_b64_tr_b16 a[252:253], v3 offset:17376
    v_fma_mix_f32 v34, v55, v26, v30 op_sel:[0,0,0] op_sel_hi:[1,0,0]
    v_mfma_f32_16x16x32_bf16 v[240:243], a[228:231], v[124:127], v[240:243]
    s_waitcnt vmcnt(8)
    s_barrier
    s_waitcnt lgkmcnt(7)
    ds_read_b64_tr_b16 a[254:255], v3 offset:17888
    v_fma_mix_f32 v35, v55, v27, v31 op_sel:[1,0,0] op_sel_hi:[1,0,0]
    v_mfma_f32_16x16x32_bf16 v[212:215], a[232:235], v[112:115], v[212:215]
    ds_read_b64_tr_b16 a[192:193], v3 offset:36864
    v_cvt_pk_bf16_f32 v54, v32, v33
    v_mfma_f32_16x16x32_bf16 v[212:215], a[236:239], v[116:119], v[212:215]
    ds_read_b64_tr_b16 a[194:195], v3 offset:37376
    ds_read_b64_tr_b16 a[196:197], v3 offset:53760
    v_mfma_f32_16x16x32_bf16 v[244:247], a[232:235], v[120:123], v[244:247]
    s_add_u32 m0, s44, 110592
    ds_read_b64_tr_b16 a[198:199], v3 offset:54272
    v_cvt_pk_bf16_f32 v55, v34, v35
    v_mfma_f32_16x16x32_bf16 v[244:247], a[236:239], v[124:127], v[244:247]
    s_mov_b32 s46, 16384
    s_waitcnt lgkmcnt(8)
    buffer_load_dwordx4 v5, s[16:19], s46 offen offset:0 lds
    v_mfma_f32_16x16x32_bf16 v[216:219], a[240:243], v[112:115], v[216:219]
    ds_read_b64_tr_b16 a[200:201], v3 offset:36896
    v_fma_mix_f32 v36, v62, v24, v28 op_sel:[0,0,0] op_sel_hi:[1,0,0]
    v_mfma_f32_16x16x32_bf16 v[216:219], a[244:247], v[116:119], v[216:219]
    ds_read_b64_tr_b16 a[202:203], v3 offset:37408
    ds_read_b64_tr_b16 a[204:205], v3 offset:53792
    v_fma_mix_f32 v37, v62, v25, v29 op_sel:[1,0,0] op_sel_hi:[1,0,0]
    v_mfma_f32_16x16x32_bf16 v[248:251], a[240:243], v[120:123], v[248:251]
    s_add_u32 m0, s44, 110624
    ds_read_b64_tr_b16 a[206:207], v3 offset:54304
    v_fma_mix_f32 v38, v63, v26, v30 op_sel:[0,0,0] op_sel_hi:[1,0,0]
    v_mfma_f32_16x16x32_bf16 v[248:251], a[244:247], v[124:127], v[248:251]
    s_waitcnt lgkmcnt(8)
    buffer_load_dwordx4 v5, s[16:19], s46 offen offset:1024 lds
    v_mfma_f32_16x16x32_bf16 v[220:223], a[248:251], v[112:115], v[220:223]
    ds_read_b64_tr_b16 a[208:209], v3 offset:36928
    v_fma_mix_f32 v39, v63, v27, v31 op_sel:[1,0,0] op_sel_hi:[1,0,0]
    v_mfma_f32_16x16x32_bf16 v[220:223], a[252:255], v[116:119], v[220:223]
    ds_read_b64_tr_b16 a[210:211], v3 offset:37440
    ds_read_b64_tr_b16 a[212:213], v3 offset:53824
    v_cvt_pk_bf16_f32 v62, v36, v37
    v_mfma_f32_16x16x32_bf16 v[252:255], a[248:251], v[120:123], v[252:255]
    s_add_u32 m0, s44, 110656
    ds_read_b64_tr_b16 a[214:215], v3 offset:54336
    v_cvt_pk_bf16_f32 v63, v38, v39
    v_mfma_f32_16x16x32_bf16 v[252:255], a[252:255], v[124:127], v[252:255]
    s_waitcnt lgkmcnt(8)
    buffer_load_dwordx4 v5, s[16:19], s46 offen offset:2048 lds
    v_mfma_f32_16x16x32_bf16 v[128:131], a[192:195], v[48:51], v[128:131]
    ds_read_b64_tr_b16 a[216:217], v3 offset:36960
    v_lshrrev_b32 v14, 2, v0
    v_mfma_f32_16x16x32_bf16 v[128:131], a[196:199], v[52:55], v[128:131]
    s_mul_i32 s3, s51, 144
    ds_read_b64_tr_b16 a[218:219], v3 offset:37472
    ds_read_b64_tr_b16 a[220:221], v3 offset:53856
    v_mfma_f32_16x16x32_bf16 v[160:163], a[192:195], v[56:59], v[160:163]
    s_add_u32 m0, s44, 110688
    ds_read_b64_tr_b16 a[222:223], v3 offset:54368
    v_add_u32 v14, s3, v14
    v_mfma_f32_16x16x32_bf16 v[160:163], a[196:199], v[60:63], v[160:163]
    s_waitcnt lgkmcnt(8)
    buffer_load_dwordx4 v5, s[16:19], s46 offen offset:3072 lds
    v_mfma_f32_16x16x32_bf16 v[132:135], a[200:203], v[48:51], v[132:135]
    ds_read_b64_tr_b16 a[224:225], v3 offset:36992
    v_mul_u32_u24 v14, 9216, v14
    v_mfma_f32_16x16x32_bf16 v[132:135], a[204:207], v[52:55], v[132:135]
    ds_read_b64_tr_b16 a[226:227], v3 offset:37504
    ds_read_b64_tr_b16 a[228:229], v3 offset:53888
    v_mfma_f32_16x16x32_bf16 v[164:167], a[200:203], v[56:59], v[164:167]
    s_add_u32 m0, s44, 127488
    ds_read_b64_tr_b16 a[230:231], v3 offset:54400
    v_and_b32 v15, 3, v0
    v_mfma_f32_16x16x32_bf16 v[164:167], a[204:207], v[60:63], v[164:167]
    s_waitcnt lgkmcnt(8)
    buffer_load_dwordx4 v5, s[20:23], s46 offen offset:0 lds
    v_mfma_f32_16x16x32_bf16 v[136:139], a[208:211], v[48:51], v[136:139]
    ds_read_b64_tr_b16 a[232:233], v3 offset:37024
    v_lshl_add_u32 v6, v15, 4, v14
    v_mfma_f32_16x16x32_bf16 v[136:139], a[212:215], v[52:55], v[136:139]
    s_lshr_b32 s3, s2, 3
    s_lshl2_add_u32 s3, s3, s51
    s_and_b32 s15, s2, 7
    ds_read_b64_tr_b16 a[234:235], v3 offset:37536
    ds_read_b64_tr_b16 a[236:237], v3 offset:53920
    v_mfma_f32_16x16x32_bf16 v[168:171], a[208:211], v[56:59], v[168:171]
    s_add_u32 m0, s44, 127520
    ds_read_b64_tr_b16 a[238:239], v3 offset:54432
    v_lshlrev_b32 v9, 7, v0
    v_mfma_f32_16x16x32_bf16 v[168:171], a[212:215], v[60:63], v[168:171]
    s_waitcnt lgkmcnt(8)
    s_mul_i32 s14, s3, 9
    s_lshr_b32 s14, s14, 1
    buffer_load_dwordx4 v5, s[20:23], s46 offen offset:1024 lds
    v_mfma_f32_16x16x32_bf16 v[140:143], a[216:219], v[48:51], v[140:143]
    ds_read_b64_tr_b16 a[240:241], v3 offset:37056
    v_min_u32 v15, 44, v0
    v_mfma_f32_16x16x32_bf16 v[140:143], a[220:223], v[52:55], v[140:143]
    ds_read_b64_tr_b16 a[242:243], v3 offset:37568
    ds_read_b64_tr_b16 a[244:245], v3 offset:53952
    v_mfma_f32_16x16x32_bf16 v[172:175], a[216:219], v[56:59], v[172:175]
    s_add_u32 m0, s44, 127552
    ds_read_b64_tr_b16 a[246:247], v3 offset:54464
    v_mul_u32_u24 v12, 7282, v15
    v_mfma_f32_16x16x32_bf16 v[172:175], a[220:223], v[60:63], v[172:175]
    s_waitcnt lgkmcnt(8)
    buffer_load_dwordx4 v5, s[20:23], s46 offen offset:2048 lds
    v_mfma_f32_16x16x32_bf16 v[144:147], a[224:227], v[48:51], v[144:147]
    ds_read_b64_tr_b16 a[248:249], v3 offset:37088
    v_lshrrev_b32 v12, 16, v12
    v_mfma_f32_16x16x32_bf16 v[144:147], a[228:231], v[52:55], v[144:147]
    ds_read_b64_tr_b16 a[250:251], v3 offset:37600
    ds_read_b64_tr_b16 a[252:253], v3 offset:53984
    v_mfma_f32_16x16x32_bf16 v[176:179], a[224:227], v[56:59], v[176:179]
    s_add_u32 m0, s44, 127584
    ds_read_b64_tr_b16 a[254:255], v3 offset:54496
    v_mul_u32_u24 v13, 63, v12
    v_mfma_f32_16x16x32_bf16 v[176:179], a[228:231], v[60:63], v[176:179]
    s_waitcnt lgkmcnt(8)
    buffer_load_dwordx4 v5, s[20:23], s46 offen offset:3072 lds
    v_mfma_f32_16x16x32_bf16 v[148:151], a[232:235], v[48:51], v[148:151]
    ds_read_b64_tr_b16 a[192:193], v3 offset:37120
    v_add_u32 v12, v15, v13
    v_mfma_f32_16x16x32_bf16 v[148:151], a[236:239], v[52:55], v[148:151]
    s_mul_i32 s14, s14, 72
    s_mul_i32 s56, s15, 9
    s_add_u32 s14, s14, s56
    ds_read_b64_tr_b16 a[194:195], v3 offset:37632
    v_add_lshl_u32 v12, s14, v12, 7
    v_mfma_f32_16x16x32_bf16 v[180:183], a[232:235], v[56:59], v[180:183]
    s_mul_i32 s14, s3, 81
    s_lshr_b32 s14, s14, 1
    s_mul_i32 s56, s15, 5184
    s_add_u32 s14, s14, s56
    ds_read_b64_tr_b16 a[196:197], v3 offset:54016
    v_min_u32 v13, 40, v0
    v_mfma_f32_16x16x32_bf16 v[180:183], a[236:239], v[60:63], v[180:183]
    s_waitcnt lgkmcnt(7)
    ds_read_b64_tr_b16 a[198:199], v3 offset:54528
    v_add_lshl_u32 v13, s14, v13, 7
    v_mfma_f32_16x16x32_bf16 v[152:155], a[240:243], v[48:51], v[152:155]
    s_mul_i32 s14, s3, 72
    s_andn2_b32 s56, s52, 3
    s_mul_i32 s56, s56, 2304
    s_add_u32 s14, s14, s56
    ds_read_b64_tr_b16 a[200:201], v3 offset:37152
    v_min_u32 v14, 35, v0
    v_mfma_f32_16x16x32_bf16 v[152:155], a[244:247], v[52:55], v[152:155]
    ds_read_b64_tr_b16 a[202:203], v3 offset:37664
    v_add_lshl_u32 v14, s14, v14, 7
    v_mfma_f32_16x16x32_bf16 v[184:187], a[240:243], v[56:59], v[184:187]
    ds_read_b64_tr_b16 a[204:205], v3 offset:54048
    v_add_u32 v15, 4608, v14
    v_mfma_f32_16x16x32_bf16 v[184:187], a[244:247], v[60:63], v[184:187]
    s_waitcnt lgkmcnt(7)
    ds_read_b64_tr_b16 a[206:207], v3 offset:54560
    v_cvt_pk_bf16_f32 v64, v128, v129
    v_mfma_f32_16x16x32_bf16 v[156:159], a[248:251], v[48:51], v[156:159]
    ds_read_b64_tr_b16 a[208:209], v3 offset:37184
    v_cvt_pk_bf16_f32 v65, v130, v131
    v_mfma_f32_16x16x32_bf16 v[156:159], a[252:255], v[52:55], v[156:159]
    ds_read_b64_tr_b16 a[210:211], v3 offset:37696
    v_cvt_pk_bf16_f32 v66, v132, v133
    v_mfma_f32_16x16x32_bf16 v[188:191], a[248:251], v[56:59], v[188:191]
    ds_read_b64_tr_b16 a[212:213], v3 offset:54080
    v_cvt_pk_bf16_f32 v67, v134, v135
    v_mfma_f32_16x16x32_bf16 v[188:191], a[252:255], v[60:63], v[188:191]
    s_waitcnt lgkmcnt(7)
    ds_read_b64_tr_b16 a[214:215], v3 offset:54592
    v_cvt_pk_bf16_f32 v80, v160, v161
    v_mfma_f32_16x16x32_bf16 v[192:195], a[192:195], v[48:51], v[192:195]
    ds_read_b64_tr_b16 a[216:217], v3 offset:37216
    v_cvt_pk_bf16_f32 v81, v162, v163
    v_mfma_f32_16x16x32_bf16 v[192:195], a[196:199], v[52:55], v[192:195]
    ds_read_b64_tr_b16 a[218:219], v3 offset:37728
    v_cvt_pk_bf16_f32 v82, v164, v165
    v_mfma_f32_16x16x32_bf16 v[224:227], a[192:195], v[56:59], v[224:227]
    ds_read_b64_tr_b16 a[220:221], v3 offset:54112
    v_cvt_pk_bf16_f32 v83, v166, v167
    v_mfma_f32_16x16x32_bf16 v[224:227], a[196:199], v[60:63], v[224:227]
    s_waitcnt lgkmcnt(7)
    ds_read_b64_tr_b16 a[222:223], v3 offset:54624
    v_cvt_pk_bf16_f32 v68, v136, v137
    v_mfma_f32_16x16x32_bf16 v[196:199], a[200:203], v[48:51], v[196:199]
    ds_read_b64_tr_b16 a[224:225], v3 offset:37248
    v_cvt_pk_bf16_f32 v69, v138, v139
    v_mfma_f32_16x16x32_bf16 v[196:199], a[204:207], v[52:55], v[196:199]
    ds_read_b64_tr_b16 a[226:227], v3 offset:37760
    v_cvt_pk_bf16_f32 v70, v140, v141
    v_mfma_f32_16x16x32_bf16 v[228:231], a[200:203], v[56:59], v[228:231]
    ds_read_b64_tr_b16 a[228:229], v3 offset:54144
    v_cvt_pk_bf16_f32 v71, v142, v143
    v_mfma_f32_16x16x32_bf16 v[228:231], a[204:207], v[60:63], v[228:231]
    s_waitcnt vmcnt(8)
    s_barrier
    s_waitcnt lgkmcnt(7)
    ds_read_b64_tr_b16 a[230:231], v3 offset:54656
    v_cvt_pk_bf16_f32 v84, v168, v169
    v_mfma_f32_16x16x32_bf16 v[200:203], a[208:211], v[48:51], v[200:203]
    ds_read_b64_tr_b16 a[232:233], v3 offset:37280
    v_cvt_pk_bf16_f32 v85, v170, v171
    v_mfma_f32_16x16x32_bf16 v[200:203], a[212:215], v[52:55], v[200:203]
L2_pad3:
    s_cbranch_execz L2_pad7
    ds_read_b64_tr_b16 a[234:235], v3 offset:37792
    ds_read_b64_tr_b16 a[236:237], v3 offset:54176
    v_mfma_f32_16x16x32_bf16 v[232:235], a[208:211], v[56:59], v[232:235]
    s_add_u32 m0, s44, 0
    ds_read_b64_tr_b16 a[238:239], v3 offset:54688
    v_cvt_pk_bf16_f32 v86, v172, v173
    v_mfma_f32_16x16x32_bf16 v[232:235], a[212:215], v[60:63], v[232:235]
    s_mov_b32 s46, 32768
    s_waitcnt lgkmcnt(8)
    buffer_load_dwordx4 v5, s[16:19], s46 offen offset:0 lds
    v_mfma_f32_16x16x32_bf16 v[204:207], a[216:219], v[48:51], v[204:207]
    ds_read_b64_tr_b16 a[240:241], v3 offset:37312
    v_cvt_pk_bf16_f32 v87, v174, v175
    v_mfma_f32_16x16x32_bf16 v[204:207], a[220:223], v[52:55], v[204:207]
    ds_read_b64_tr_b16 a[242:243], v3 offset:37824
    ds_read_b64_tr_b16 a[244:245], v3 offset:54208
    v_mfma_f32_16x16x32_bf16 v[236:239], a[216:219], v[56:59], v[236:239]
    s_add_u32 m0, s44, 32
    ds_read_b64_tr_b16 a[246:247], v3 offset:54720
    v_cvt_pk_bf16_f32 v72, v144, v145
    v_mfma_f32_16x16x32_bf16 v[236:239], a[220:223], v[60:63], v[236:239]
    s_waitcnt lgkmcnt(8)
    buffer_load_dwordx4 v5, s[16:19], s46 offen offset:1024 lds
    v_mfma_f32_16x16x32_bf16 v[208:211], a[224:227], v[48:51], v[208:211]
    ds_read_b64_tr_b16 a[248:249], v3 offset:37344
    v_cvt_pk_bf16_f32 v73, v146, v147
    v_mfma_f32_16x16x32_bf16 v[208:211], a[228:231], v[52:55], v[208:211]
    ds_read_b64_tr_b16 a[250:251], v3 offset:37856
    ds_read_b64_tr_b16 a[252:253], v3 offset:54240
    v_mfma_f32_16x16x32_bf16 v[240:243], a[224:227], v[56:59], v[240:243]
    s_add_u32 m0, s44, 64
    ds_read_b64_tr_b16 a[254:255], v3 offset:54752
    v_cvt_pk_bf16_f32 v74, v148, v149
    v_mfma_f32_16x16x32_bf16 v[240:243], a[228:231], v[60:63], v[240:243]
    s_waitcnt lgkmcnt(8)
    buffer_load_dwordx4 v5, s[16:19], s46 offen offset:2048 lds
    v_mfma_f32_16x16x32_bf16 v[212:215], a[232:235], v[48:51], v[212:215]
    ds_read_b128 a[64:67], v1 offset:0
    ds_read_b128 a[68:71], v1 offset:64
    v_mfma_f32_16x16x32_bf16 v[212:215], a[236:239], v[52:55], v[212:215]
    ds_read_b128 a[72:75], v1 offset:128
    ds_read_b128 a[76:79], v1 offset:192
    v_mfma_f32_16x16x32_bf16 v[244:247], a[232:235], v[56:59], v[244:247]
    s_add_u32 m0, s44, 96
    ds_read_b128 a[80:83], v1 offset:256
    ds_read_b128 a[84:87], v1 offset:320
    v_mfma_f32_16x16x32_bf16 v[244:247], a[236:239], v[60:63], v[244:247]
    s_waitcnt lgkmcnt(10)
    buffer_load_dwordx4 v5, s[16:19], s46 offen offset:3072 lds
    v_mfma_f32_16x16x32_bf16 v[216:219], a[240:243], v[48:51], v[216:219]
    ds_read_b128 a[88:91], v1 offset:384
    ds_read_b128 a[92:95], v1 offset:448
    v_mfma_f32_16x16x32_bf16 v[216:219], a[244:247], v[52:55], v[216:219]
    ds_read_b128 a[96:99], v1 offset:512
    ds_read_b128 a[100:103], v1 offset:576
    v_mfma_f32_16x16x32_bf16 v[248:251], a[240:243], v[56:59], v[248:251]
    s_add_u32 m0, s44, 16896
    ds_read_b128 a[104:107], v1 offset:640
    ds_read_b128 a[108:111], v1 offset:704
    v_mfma_f32_16x16x32_bf16 v[248:251], a[244:247], v[60:63], v[248:251]
    s_waitcnt lgkmcnt(12)
    buffer_load_dwordx4 v5, s[20:23], s46 offen offset:0 lds
    v_mfma_f32_16x16x32_bf16 v[220:223], a[248:251], v[48:51], v[220:223]
    ds_read_b128 a[112:115], v1 offset:768
    ds_read_b128 a[116:119], v1 offset:832
    v_mfma_f32_16x16x32_bf16 v[220:223], a[252:255], v[52:55], v[220:223]
    ds_read_b128 a[120:123], v1 offset:896
    ds_read_b128 a[124:127], v1 offset:960
    v_mfma_f32_16x16x32_bf16 v[252:255], a[248:251], v[56:59], v[252:255]
    s_add_u32 m0, s44, 16928
    v_cvt_pk_bf16_f32 v75, v150, v151
    v_cvt_pk_bf16_f32 v88, v176, v177
    v_mfma_f32_16x16x32_bf16 v[252:255], a[252:255], v[60:63], v[252:255]
    buffer_load_dwordx4 v5, s[20:23], s46 offen offset:1024 lds
    s_mul_i32 s3, s96, 9216
    s_add_u32 s3, s3, 4194304
    s_add_u32 s32, s84, s3
    s_addc_u32 s33, s85, 0
    s_mov_b32 s34, 9216
    s_mov_b32 s35, 0x20000
    s_add_u32 m0, s44, 16960
    s_nop 0
    buffer_load_dwordx4 v5, s[20:23], s46 offen offset:2048 lds
    s_add_u32 m0, s44, 16992
    s_nop 0
    buffer_load_dwordx4 v5, s[20:23], s46 offen offset:3072 lds
    v_cvt_pk_bf16_f32 v89, v178, v179
    v_cvt_pk_bf16_f32 v90, v180, v181
    v_cvt_pk_bf16_f32 v91, v182, v183
    v_cvt_pk_bf16_f32 v76, v152, v153
    v_cvt_pk_bf16_f32 v77, v154, v155
    v_cvt_pk_bf16_f32 v78, v156, v157
    v_cvt_pk_bf16_f32 v79, v158, v159
    v_cvt_pk_bf16_f32 v92, v184, v185
    v_cvt_pk_bf16_f32 v93, v186, v187
    v_cvt_pk_bf16_f32 v94, v188, v189
    v_cvt_pk_bf16_f32 v95, v190, v191
    v_permlane32_swap_b32 v64, v66
    v_permlane32_swap_b32 v65, v67
    v_permlane32_swap_b32 v80, v82
    v_permlane32_swap_b32 v81, v83
    v_permlane32_swap_b32 v68, v70
    v_permlane32_swap_b32 v69, v71
    v_permlane32_swap_b32 v84, v86
    v_permlane32_swap_b32 v85, v87
    v_permlane32_swap_b32 v72, v74
    v_permlane32_swap_b32 v73, v75
    v_permlane32_swap_b32 v88, v90
    v_permlane32_swap_b32 v89, v91
    v_permlane32_swap_b32 v76, v78
    v_permlane32_swap_b32 v77, v79
    v_permlane32_swap_b32 v92, v94
    v_permlane32_swap_b32 v93, v95
    v_cvt_pk_bf16_f32 v96, v192, v193
    v_cvt_pk_bf16_f32 v97, v194, v195
    v_cvt_pk_bf16_f32 v98, v196, v197
    v_cvt_pk_bf16_f32 v99, v198, v199
    v_cvt_pk_bf16_f32 v112, v224, v225
    v_cvt_pk_bf16_f32 v113, v226, v227
    v_cvt_pk_bf16_f32 v114, v228, v229
    v_cvt_pk_bf16_f32 v115, v230, v231
    v_cvt_pk_bf16_f32 v100, v200, v201
    v_cvt_pk_bf16_f32 v101, v202, v203
    v_cvt_pk_bf16_f32 v102, v204, v205
    v_cvt_pk_bf16_f32 v103, v206, v207
    v_cvt_pk_bf16_f32 v116, v232, v233
    v_cvt_pk_bf16_f32 v117, v234, v235
    v_cvt_pk_bf16_f32 v118, v236, v237
    v_cvt_pk_bf16_f32 v119, v238, v239
    v_cvt_pk_bf16_f32 v104, v208, v209
    v_cvt_pk_bf16_f32 v105, v210, v211
    v_cvt_pk_bf16_f32 v106, v212, v213
    v_cvt_pk_bf16_f32 v107, v214, v215
    v_cvt_pk_bf16_f32 v120, v240, v241
    v_cvt_pk_bf16_f32 v121, v242, v243
    v_cvt_pk_bf16_f32 v122, v244, v245
    v_cvt_pk_bf16_f32 v123, v246, v247
    v_cvt_pk_bf16_f32 v108, v216, v217
    v_cvt_pk_bf16_f32 v109, v218, v219
    v_cvt_pk_bf16_f32 v110, v220, v221
    v_cvt_pk_bf16_f32 v111, v222, v223
    v_cvt_pk_bf16_f32 v124, v248, v249
    v_cvt_pk_bf16_f32 v125, v250, v251
    v_cvt_pk_bf16_f32 v126, v252, v253
    v_cvt_pk_bf16_f32 v127, v254, v255
    s_nop 0
    v_permlane32_swap_b32 v96, v98
    v_permlane32_swap_b32 v97, v99
    v_permlane32_swap_b32 v112, v114
    v_permlane32_swap_b32 v113, v115
    v_permlane32_swap_b32 v100, v102
    v_permlane32_swap_b32 v101, v103
    v_permlane32_swap_b32 v116, v118
    v_permlane32_swap_b32 v117, v119
    v_permlane32_swap_b32 v104, v106
    v_permlane32_swap_b32 v105, v107
    v_permlane32_swap_b32 v120, v122
    v_permlane32_swap_b32 v121, v123
    v_permlane32_swap_b32 v108, v110
    v_permlane32_swap_b32 v109, v111
    v_permlane32_swap_b32 v124, v126
    v_permlane32_swap_b32 v125, v127
    s_waitcnt lgkmcnt(12)
    v_mfma_f32_16x16x32_bf16 v[16:19], a[64:67], v[64:67], 0
    v_mfma_f32_16x16x32_bf16 v[16:19], a[68:71], v[68:71], v[16:19]
    v_mfma_f32_16x16x32_bf16 v[16:19], a[72:75], v[72:75], v[16:19]
    v_mfma_f32_16x16x32_bf16 v[16:19], a[76:79], v[76:79], v[16:19]
    v_mfma_f32_16x16x32_bf16 v[20:23], a[64:67], v[80:83], 0
    v_mfma_f32_16x16x32_bf16 v[20:23], a[68:71], v[84:87], v[20:23]
    v_mfma_f32_16x16x32_bf16 v[20:23], a[72:75], v[88:91], v[20:23]
    v_mfma_f32_16x16x32_bf16 v[20:23], a[76:79], v[92:95], v[20:23]
    v_mfma_f32_16x16x32_bf16 v[24:27], a[64:67], v[96:99], 0
    v_mfma_f32_16x16x32_bf16 v[24:27], a[68:71], v[100:103], v[24:27]
    v_mfma_f32_16x16x32_bf16 v[24:27], a[72:75], v[104:107], v[24:27]
    v_mfma_f32_16x16x32_bf16 v[24:27], a[76:79], v[108:111], v[24:27]
    v_mfma_f32_16x16x32_bf16 v[28:31], a[64:67], v[112:115], 0
    v_mfma_f32_16x16x32_bf16 v[28:31], a[68:71], v[116:119], v[28:31]
    v_mfma_f32_16x16x32_bf16 v[28:31], a[72:75], v[120:123], v[28:31]
    v_mfma_f32_16x16x32_bf16 v[28:31], a[76:79], v[124:127], v[28:31]
    s_nop 1
    v_max3_f32 v16, v16, v17, v18
    v_max_f32 v16, v16, v19
    v_max3_f32 v20, v20, v21, v22
    v_max_f32 v20, v20, v23
    v_max3_f32 v24, v24, v25, v26
    v_max_f32 v24, v24, v27
    v_max3_f32 v28, v28, v29, v30
    v_max_f32 v28, v28, v31
    v_mov_b32 v40, v16
    v_mov_b32 v41, v20
    v_mov_b32 v42, v24
    v_mov_b32 v43, v28
    v_permlane16_swap_b32 v40, v16
    v_permlane16_swap_b32 v41, v20
    v_permlane16_swap_b32 v42, v24
    v_permlane16_swap_b32 v43, v28
    v_max_f32 v16, v16, v40
    v_max_f32 v20, v20, v41
    v_max_f32 v24, v24, v42
    v_max_f32 v28, v28, v43
    v_mov_b32 v40, v16
    v_mov_b32 v41, v20
    v_mov_b32 v42, v24
    v_mov_b32 v43, v28
    v_permlane32_swap_b32 v40, v16
    v_permlane32_swap_b32 v41, v20
    v_permlane32_swap_b32 v42, v24
    v_permlane32_swap_b32 v43, v28
    v_max_f32 v16, v16, v40
    v_max_f32 v20, v20, v41
    v_max_f32 v24, v24, v42
    v_max_f32 v28, v28, v43
    v_sub_f32 v48, 0xc2000000, v16
    v_sub_f32 v49, 0xc2000000, v16
    v_sub_f32 v50, 0xc2000000, v16
    v_sub_f32 v51, 0xc2000000, v16
    v_sub_f32 v52, 0xc2000000, v20
    v_sub_f32 v53, 0xc2000000, v20
    v_sub_f32 v54, 0xc2000000, v20
    v_sub_f32 v55, 0xc2000000, v20
    v_sub_f32 v56, 0xc2000000, v24
    v_sub_f32 v57, 0xc2000000, v24
    v_sub_f32 v58, 0xc2000000, v24
    v_sub_f32 v59, 0xc2000000, v24
    v_sub_f32 v60, 0xc2000000, v28
    v_sub_f32 v61, 0xc2000000, v28
    v_sub_f32 v62, 0xc2000000, v28
    v_sub_f32 v63, 0xc2000000, v28
L2_entry:
    s_mov_b32 s47, s44
    s_mov_b32 s48, -73728
    s_mov_b32 s49, 12
    s_mov_b32 s46, 32768
    s_waitcnt vmcnt(8)
    s_barrier
    v_mfma_f32_16x16x32_bf16 v[16:19], a[64:67], v[64:67], v[48:51]
    ds_read_b64_tr_b16 a[128:129], v2 offset:0
    ds_read_b64_tr_b16 a[130:131], v2 offset:256
    v_mfma_f32_16x16x32_bf16 v[16:19], a[68:71], v[68:71], v[16:19]
    ds_read_b64_tr_b16 a[132:133], v2 offset:512
    ds_read_b64_tr_b16 a[134:135], v2 offset:768
    v_mfma_f32_16x16x32_bf16 v[16:19], a[72:75], v[72:75], v[16:19]
    s_add_u32 m0, s47, 36864
    ds_read_b64_tr_b16 a[136:137], v2 offset:32
    ds_read_b64_tr_b16 a[138:139], v2 offset:288
    v_mfma_f32_16x16x32_bf16 v[16:19], a[76:79], v[76:79], v[16:19]
    s_waitcnt lgkmcnt(14)
    s_add_u32 s46, s46, 16384
    buffer_load_dwordx4 v5, s[16:19], s46 offen offset:0 lds
    v_mfma_f32_16x16x32_bf16 v[20:23], a[80:83], v[64:67], v[48:51]
    ds_read_b64_tr_b16 a[140:141], v2 offset:544
    ds_read_b64_tr_b16 a[142:143], v2 offset:800
    v_mfma_f32_16x16x32_bf16 v[20:23], a[84:87], v[68:71], v[20:23]
    ds_read_b64_tr_b16 a[144:145], v2 offset:64
    ds_read_b64_tr_b16 a[146:147], v2 offset:320
    v_mfma_f32_16x16x32_bf16 v[20:23], a[88:91], v[72:75], v[20:23]
    s_add_u32 m0, s47, 36896
    ds_read_b64_tr_b16 a[148:149], v2 offset:576
    ds_read_b64_tr_b16 a[150:151], v2 offset:832
    v_mfma_f32_16x16x32_bf16 v[20:23], a[92:95], v[76:79], v[20:23]
    s_waitcnt lgkmcnt(15)
    buffer_load_dwordx4 v5, s[16:19], s46 offen offset:1024 lds
    v_mfma_f32_16x16x32_bf16 v[24:27], a[96:99], v[64:67], v[48:51]
    s_nop 1
    v_exp_f32 v16, v16
    v_mfma_f32_16x16x32_bf16 v[24:27], a[100:103], v[68:71], v[24:27]
    ds_read_b64_tr_b16 a[152:153], v2 offset:96
    ds_read_b64_tr_b16 a[154:155], v2 offset:352
    v_mfma_f32_16x16x32_bf16 v[24:27], a[104:107], v[72:75], v[24:27]
    s_add_u32 m0, s47, 36928
    v_exp_f32 v17, v17
    v_mfma_f32_16x16x32_bf16 v[24:27], a[108:111], v[76:79], v[24:27]
    s_waitcnt lgkmcnt(14)
    buffer_load_dwordx4 v5, s[16:19], s46 offen offset:2048 lds
    v_mfma_f32_16x16x32_bf16 v[28:31], a[112:115], v[64:67], v[48:51]
    v_exp_f32 v18, v18
    v_mfma_f32_16x16x32_bf16 v[28:31], a[116:119], v[68:71], v[28:31]
    ds_read_b64_tr_b16 a[156:157], v2 offset:608
    v_cvt_pk_bf16_f32 v32, v16, v17
    v_mfma_f32_16x16x32_bf16 v[28:31], a[120:123], v[72:75], v[28:31]
    s_add_u32 m0, s47, 36960
    v_exp_f32 v19, v19
    v_mfma_f32_16x16x32_bf16 v[28:31], a[124:127], v[76:79], v[28:31]
    buffer_load_dwordx4 v5, s[16:19], s46 offen offset:3072 lds
    s_nop 3
    ds_read_b64_tr_b16 a[158:159], v2 offset:864
    ds_read_b64_tr_b16 a[160:161], v2 offset:128
    ds_read_b64_tr_b16 a[162:163], v2 offset:384
    ds_read_b64_tr_b16 a[164:165], v2 offset:640
    ds_read_b64_tr_b16 a[166:167], v2 offset:896
    ds_read_b64_tr_b16 a[168:169], v2 offset:160
    ds_read_b64_tr_b16 a[170:171], v2 offset:416
    ds_read_b64_tr_b16 a[172:173], v2 offset:672
    ds_read_b64_tr_b16 a[174:175], v2 offset:928
    ds_read_b64_tr_b16 a[176:177], v2 offset:192
    ds_read_b64_tr_b16 a[178:179], v2 offset:448
    ds_read_b64_tr_b16 a[180:181], v2 offset:704
    ds_read_b64_tr_b16 a[182:183], v2 offset:960
    ds_read_b64_tr_b16 a[184:185], v2 offset:224
    ds_read_b64_tr_b16 a[186:187], v2 offset:480
    ds_read_b64_tr_b16 a[188:189], v2 offset:736
    ds_read_b64_tr_b16 a[190:191], v2 offset:992
    v_exp_f32 v20, v20
    s_nop 0
    ds_read_b64_tr_b16 a[192:193], v2 offset:36864
    v_cvt_pk_bf16_f32 v33, v18, v19
    s_add_u32 m0, s47, 53760
    v_exp_f32 v21, v21
    s_nop 0
    buffer_load_dwordx4 v5, s[20:23], s46 offen offset:0 lds
    v_exp_f32 v22, v22
    s_nop 0
    ds_read_b64_tr_b16 a[194:195], v2 offset:37120
    v_cvt_pk_bf16_f32 v34, v20, v21
    s_add_u32 m0, s47, 53792
    v_exp_f32 v23, v23
    s_nop 0
    buffer_load_dwordx4 v5, s[20:23], s46 offen offset:1024 lds
    v_exp_f32 v24, v24
    s_nop 0
    ds_read_b64_tr_b16 a[196:197], v2 offset:37376
    v_cvt_pk_bf16_f32 v35, v22, v23
    s_add_u32 m0, s47, 53824
    v_exp_f32 v25, v25
    s_nop 0
    buffer_load_dwordx4 v5, s[20:23], s46 offen offset:2048 lds
    v_exp_f32 v26, v26
    s_nop 0
    ds_read_b64_tr_b16 a[198:199], v2 offset:37632
    v_cvt_pk_bf16_f32 v36, v24, v25
    s_add_u32 m0, s47, 53856
    v_exp_f32 v27, v27
    s_nop 0
    buffer_load_dwordx4 v5, s[20:23], s46 offen offset:3072 lds
    ds_read_b64_tr_b16 a[200:201], v2 offset:36896
    s_nop 0
    v_mfma_f32_16x16x32_bf16 v[16:19], a[64:67], v[80:83], v[52:55]
    v_exp_f32 v28, v28
    v_mfma_f32_16x16x32_bf16 v[16:19], a[68:71], v[84:87], v[16:19]
    ds_read_b64_tr_b16 a[202:203], v2 offset:37152
    v_cvt_pk_bf16_f32 v37, v26, v27
    v_mfma_f32_16x16x32_bf16 v[16:19], a[72:75], v[88:91], v[16:19]
    v_exp_f32 v29, v29
    v_mfma_f32_16x16x32_bf16 v[16:19], a[76:79], v[92:95], v[16:19]
    ds_read_b64_tr_b16 a[204:205], v2 offset:37408
    v_mov_b32 v224, 0
    v_mfma_f32_16x16x32_bf16 v[20:23], a[80:83], v[80:83], v[52:55]
    v_exp_f32 v30, v30
    v_mfma_f32_16x16x32_bf16 v[20:23], a[84:87], v[84:87], v[20:23]
    ds_read_b64_tr_b16 a[206:207], v2 offset:37664
    v_cvt_pk_bf16_f32 v38, v28, v29
    v_mfma_f32_16x16x32_bf16 v[20:23], a[88:91], v[88:91], v[20:23]
    v_exp_f32 v31, v31
    v_mfma_f32_16x16x32_bf16 v[20:23], a[92:95], v[92:95], v[20:23]
    ds_read_b64_tr_b16 a[208:209], v2 offset:36928
    v_mov_b32 v225, 0
    v_mfma_f32_16x16x32_bf16 v[24:27], a[96:99], v[80:83], v[52:55]
    v_exp_f32 v16, v16
    v_mfma_f32_16x16x32_bf16 v[24:27], a[100:103], v[84:87], v[24:27]
    ds_read_b64_tr_b16 a[210:211], v2 offset:37184
    v_cvt_pk_bf16_f32 v39, v30, v31
    v_mfma_f32_16x16x32_bf16 v[24:27], a[104:107], v[88:91], v[24:27]
    v_exp_f32 v17, v17
    v_mfma_f32_16x16x32_bf16 v[24:27], a[108:111], v[92:95], v[24:27]
    ds_read_b64_tr_b16 a[212:213], v2 offset:37440
    v_mov_b32 v226, 0
    v_mfma_f32_16x16x32_bf16 v[28:31], a[112:115], v[80:83], v[52:55]
    v_exp_f32 v18, v18
    v_mfma_f32_16x16x32_bf16 v[28:31], a[116:119], v[84:87], v[28:31]
    ds_read_b64_tr_b16 a[214:215], v2 offset:37696
    v_cvt_pk_bf16_f32 v40, v16, v17
    v_mfma_f32_16x16x32_bf16 v[28:31], a[120:123], v[88:91], v[28:31]
    s_waitcnt lgkmcnt(12)
    v_exp_f32 v19, v19
    v_mfma_f32_16x16x32_bf16 v[28:31], a[124:127], v[92:95], v[28:31]
    ds_read_b64_tr_b16 a[216:217], v2 offset:36960
    v_mov_b32 v227, 0
    v_mfma_f32_16x16x32_bf16 v[128:131], a[128:131], v[32:35], 0
    v_exp_f32 v20, v20
    v_mfma_f32_16x16x32_bf16 v[128:131], a[132:135], v[36:39], v[128:131]
    ds_read_b64_tr_b16 a[218:219], v2 offset:37216
    v_cvt_pk_bf16_f32 v41, v18, v19
    v_mfma_f32_16x16x32_bf16 v[132:135], a[136:139], v[32:35], 0
    v_exp_f32 v21, v21
    v_mfma_f32_16x16x32_bf16 v[132:135], a[140:143], v[36:39], v[132:135]
    ds_read_b64_tr_b16 a[220:221], v2 offset:37472
    v_mov_b32 v228, 0
    v_mfma_f32_16x16x32_bf16 v[136:139], a[144:147], v[32:35], 0
    v_exp_f32 v22, v22
    v_mfma_f32_16x16x32_bf16 v[136:139], a[148:151], v[36:39], v[136:139]
    ds_read_b64_tr_b16 a[222:223], v2 offset:37728
    v_cvt_pk_bf16_f32 v42, v20, v21
    v_mfma_f32_16x16x32_bf16 v[140:143], a[152:155], v[32:35], 0
    v_exp_f32 v23, v23
    v_mfma_f32_16x16x32_bf16 v[140:143], a[156:159], v[36:39], v[140:143]
    ds_read_b64_tr_b16 a[224:225], v2 offset:36992
    v_mov_b32 v229, 0
    v_mfma_f32_16x16x32_bf16 v[144:147], a[160:163], v[32:35], 0
    v_exp_f32 v24, v24
    v_mfma_f32_16x16x32_bf16 v[144:147], a[164:167], v[36:39], v[144:147]
    ds_read_b64_tr_b16 a[226:227], v2 offset:37248
    v_cvt_pk_bf16_f32 v43, v22, v23
    v_mfma_f32_16x16x32_bf16 v[148:151], a[168:171], v[32:35], 0
    v_exp_f32 v25, v25
    v_mfma_f32_16x16x32_bf16 v[148:151], a[172:175], v[36:39], v[148:151]
    ds_read_b64_tr_b16 a[228:229], v2 offset:37504
    v_mov_b32 v230, 0
    v_mfma_f32_16x16x32_bf16 v[152:155], a[176:179], v[32:35], 0
    v_exp_f32 v26, v26
    v_mfma_f32_16x16x32_bf16 v[152:155], a[180:183], v[36:39], v[152:155]
    ds_read_b64_tr_b16 a[230:231], v2 offset:37760
    v_cvt_pk_bf16_f32 v44, v24, v25
    v_mfma_f32_16x16x32_bf16 v[156:159], a[184:187], v[32:35], 0
    v_exp_f32 v27, v27
    v_mfma_f32_16x16x32_bf16 v[156:159], a[188:191], v[36:39], v[156:159]
    ds_read_b64_tr_b16 a[232:233], v2 offset:37024
    v_mov_b32 v231, 0
    v_smfmac_f32_16x16x64_bf16 a[0:3], a[16:19], v[32:39], v11
    ds_read_b64_tr_b16 a[234:235], v2 offset:37280
    v_mov_b32 v232, 0
    v_mfma_f32_16x16x32_bf16 v[16:19], a[64:67], v[96:99], v[56:59]
    v_exp_f32 v28, v28
    v_mfma_f32_16x16x32_bf16 v[16:19], a[68:71], v[100:103], v[16:19]
    ds_read_b64_tr_b16 a[236:237], v2 offset:37536
    v_cvt_pk_bf16_f32 v45, v26, v27
    v_mfma_f32_16x16x32_bf16 v[16:19], a[72:75], v[104:107], v[16:19]
    v_exp_f32 v29, v29
    v_mfma_f32_16x16x32_bf16 v[16:19], a[76:79], v[108:111], v[16:19]
    ds_read_b64_tr_b16 a[238:239], v2 offset:37792
    v_mov_b32 v233, 0
    v_mfma_f32_16x16x32_bf16 v[20:23], a[80:83], v[96:99], v[56:59]
    v_exp_f32 v30, v30
    v_mfma_f32_16x16x32_bf16 v[20:23], a[84:87], v[100:103], v[20:23]
    ds_read_b64_tr_b16 a[240:241], v2 offset:37056
    v_cvt_pk_bf16_f32 v46, v28, v29
    v_mfma_f32_16x16x32_bf16 v[20:23], a[88:91], v[104:107], v[20:23]
    v_exp_f32 v31, v31
    v_mfma_f32_16x16x32_bf16 v[20:23], a[92:95], v[108:111], v[20:23]
    ds_read_b64_tr_b16 a[242:243], v2 offset:37312
    v_mov_b32 v234, 0
    v_mfma_f32_16x16x32_bf16 v[24:27], a[96:99], v[96:99], v[56:59]
    v_exp_f32 v16, v16
    v_mfma_f32_16x16x32_bf16 v[24:27], a[100:103], v[100:103], v[24:27]
    ds_read_b64_tr_b16 a[244:245], v2 offset:37568
    v_cvt_pk_bf16_f32 v47, v30, v31
    v_mfma_f32_16x16x32_bf16 v[24:27], a[104:107], v[104:107], v[24:27]
    v_exp_f32 v17, v17
    v_mfma_f32_16x16x32_bf16 v[24:27], a[108:111], v[108:111], v[24:27]
    ds_read_b64_tr_b16 a[246:247], v2 offset:37824
    v_mov_b32 v235, 0
    v_mfma_f32_16x16x32_bf16 v[28:31], a[112:115], v[96:99], v[56:59]
    v_exp_f32 v18, v18
    v_mfma_f32_16x16x32_bf16 v[28:31], a[116:119], v[100:103], v[28:31]
    ds_read_b64_tr_b16 a[248:249], v2 offset:37088
    v_cvt_pk_bf16_f32 v32, v16, v17
    v_mfma_f32_16x16x32_bf16 v[28:31], a[120:123], v[104:107], v[28:31]
    v_exp_f32 v19, v19
    v_mfma_f32_16x16x32_bf16 v[28:31], a[124:127], v[108:111], v[28:31]
    ds_read_b64_tr_b16 a[250:251], v2 offset:37344
    v_mov_b32 v236, 0
    v_mfma_f32_16x16x32_bf16 v[160:163], a[128:131], v[40:43], 0
    v_exp_f32 v20, v20
    v_mfma_f32_16x16x32_bf16 v[160:163], a[132:135], v[44:47], v[160:163]
    ds_read_b64_tr_b16 a[252:253], v2 offset:37600
    v_cvt_pk_bf16_f32 v33, v18, v19
    v_mfma_f32_16x16x32_bf16 v[164:167], a[136:139], v[40:43], 0
    v_exp_f32 v21, v21
    v_mfma_f32_16x16x32_bf16 v[164:167], a[140:143], v[44:47], v[164:167]
    ds_read_b64_tr_b16 a[254:255], v2 offset:37856
    v_mov_b32 v237, 0
    v_mfma_f32_16x16x32_bf16 v[168:171], a[144:147], v[40:43], 0
    v_exp_f32 v22, v22
    v_mfma_f32_16x16x32_bf16 v[168:171], a[148:151], v[44:47], v[168:171]
    v_cvt_pk_bf16_f32 v34, v20, v21
    v_mov_b32 v238, 0
    v_mfma_f32_16x16x32_bf16 v[172:175], a[152:155], v[40:43], 0
    v_exp_f32 v23, v23
    v_mfma_f32_16x16x32_bf16 v[172:175], a[156:159], v[44:47], v[172:175]
    v_mov_b32 v239, 0
    v_mov_b32 v240, 0
    v_mfma_f32_16x16x32_bf16 v[176:179], a[160:163], v[40:43], 0
    v_exp_f32 v24, v24
    v_mfma_f32_16x16x32_bf16 v[176:179], a[164:167], v[44:47], v[176:179]
    v_cvt_pk_bf16_f32 v35, v22, v23
    v_mov_b32 v241, 0
    v_mfma_f32_16x16x32_bf16 v[180:183], a[168:171], v[40:43], 0
    v_exp_f32 v25, v25
    v_mfma_f32_16x16x32_bf16 v[180:183], a[172:175], v[44:47], v[180:183]
    v_mov_b32 v242, 0
    v_mov_b32 v243, 0
    v_mfma_f32_16x16x32_bf16 v[184:187], a[176:179], v[40:43], 0
    v_exp_f32 v26, v26
    v_mfma_f32_16x16x32_bf16 v[184:187], a[180:183], v[44:47], v[184:187]
    v_cvt_pk_bf16_f32 v36, v24, v25
    v_mov_b32 v244, 0
    v_mfma_f32_16x16x32_bf16 v[188:191], a[184:187], v[40:43], 0
    v_exp_f32 v27, v27
    v_mfma_f32_16x16x32_bf16 v[188:191], a[188:191], v[44:47], v[188:191]
    v_mov_b32 v245, 0
    v_mov_b32 v246, 0
    v_smfmac_f32_16x16x64_bf16 a[4:7], a[16:19], v[40:47], v11
    v_mov_b32 v247, 0
    v_mov_b32 v248, 0
    v_mfma_f32_16x16x32_bf16 v[16:19], a[64:67], v[112:115], v[60:63]
    v_exp_f32 v28, v28
    v_mfma_f32_16x16x32_bf16 v[16:19], a[68:71], v[116:119], v[16:19]
    ds_read_b128 a[64:67], v1 offset:36864
    v_cvt_pk_bf16_f32 v37, v26, v27
    v_mfma_f32_16x16x32_bf16 v[16:19], a[72:75], v[120:123], v[16:19]
    v_exp_f32 v29, v29
    v_mfma_f32_16x16x32_bf16 v[16:19], a[76:79], v[124:127], v[16:19]
    ds_read_b128 a[68:71], v1 offset:36928
    v_mov_b32 v249, 0
    v_mfma_f32_16x16x32_bf16 v[20:23], a[80:83], v[112:115], v[60:63]
    v_exp_f32 v30, v30
    v_mfma_f32_16x16x32_bf16 v[20:23], a[84:87], v[116:119], v[20:23]
    ds_read_b128 a[72:75], v1 offset:36992
    v_cvt_pk_bf16_f32 v38, v28, v29
    v_mfma_f32_16x16x32_bf16 v[20:23], a[88:91], v[120:123], v[20:23]
    v_exp_f32 v31, v31
    v_mfma_f32_16x16x32_bf16 v[20:23], a[92:95], v[124:127], v[20:23]
    ds_read_b128 a[76:79], v1 offset:37056
    v_mov_b32 v250, 0
    v_mfma_f32_16x16x32_bf16 v[24:27], a[96:99], v[112:115], v[60:63]
    v_exp_f32 v16, v16
    v_mfma_f32_16x16x32_bf16 v[24:27], a[100:103], v[116:119], v[24:27]
    ds_read_b128 a[80:83], v1 offset:37120
    v_cvt_pk_bf16_f32 v39, v30, v31
    v_mfma_f32_16x16x32_bf16 v[24:27], a[104:107], v[120:123], v[24:27]
    v_exp_f32 v17, v17
    v_mfma_f32_16x16x32_bf16 v[24:27], a[108:111], v[124:127], v[24:27]
    ds_read_b128 a[84:87], v1 offset:37184
    v_mov_b32 v251, 0
    v_mfma_f32_16x16x32_bf16 v[28:31], a[112:115], v[112:115], v[60:63]
    v_exp_f32 v18, v18
    v_mfma_f32_16x16x32_bf16 v[28:31], a[116:119], v[116:119], v[28:31]
    ds_read_b128 a[88:91], v1 offset:37248
    v_cvt_pk_bf16_f32 v40, v16, v17
    v_mfma_f32_16x16x32_bf16 v[28:31], a[120:123], v[120:123], v[28:31]
    v_exp_f32 v19, v19
    v_mfma_f32_16x16x32_bf16 v[28:31], a[124:127], v[124:127], v[28:31]
    ds_read_b128 a[92:95], v1 offset:37312
    v_mov_b32 v252, 0
    v_mfma_f32_16x16x32_bf16 v[192:195], a[128:131], v[32:35], 0
    v_exp_f32 v20, v20
    v_mfma_f32_16x16x32_bf16 v[192:195], a[132:135], v[36:39], v[192:195]
    ds_read_b128 a[96:99], v1 offset:37376
    v_cvt_pk_bf16_f32 v41, v18, v19
    v_mfma_f32_16x16x32_bf16 v[196:199], a[136:139], v[32:35], 0
    v_exp_f32 v21, v21
    v_mfma_f32_16x16x32_bf16 v[196:199], a[140:143], v[36:39], v[196:199]
    ds_read_b128 a[100:103], v1 offset:37440
    v_mov_b32 v253, 0
    v_mfma_f32_16x16x32_bf16 v[200:203], a[144:147], v[32:35], 0
    v_exp_f32 v22, v22
    v_mfma_f32_16x16x32_bf16 v[200:203], a[148:151], v[36:39], v[200:203]
    ds_read_b128 a[104:107], v1 offset:37504
    v_cvt_pk_bf16_f32 v42, v20, v21
    v_mfma_f32_16x16x32_bf16 v[204:207], a[152:155], v[32:35], 0
    v_exp_f32 v23, v23
    v_mfma_f32_16x16x32_bf16 v[204:207], a[156:159], v[36:39], v[204:207]
    ds_read_b128 a[108:111], v1 offset:37568
    v_mov_b32 v254, 0
    v_mfma_f32_16x16x32_bf16 v[208:211], a[160:163], v[32:35], 0
    v_exp_f32 v24, v24
    v_mfma_f32_16x16x32_bf16 v[208:211], a[164:167], v[36:39], v[208:211]
    ds_read_b128 a[112:115], v1 offset:37632
    v_cvt_pk_bf16_f32 v43, v22, v23
    v_mfma_f32_16x16x32_bf16 v[212:215], a[168:171], v[32:35], 0
    v_exp_f32 v25, v25
    v_mfma_f32_16x16x32_bf16 v[212:215], a[172:175], v[36:39], v[212:215]
    ds_read_b128 a[116:119], v1 offset:37696
    v_mov_b32 v255, 0
    v_mfma_f32_16x16x32_bf16 v[216:219], a[176:179], v[32:35], 0
    v_exp_f32 v26, v26
    v_mfma_f32_16x16x32_bf16 v[216:219], a[180:183], v[36:39], v[216:219]
    ds_read_b128 a[120:123], v1 offset:37760
    v_cvt_pk_bf16_f32 v44, v24, v25
    v_mfma_f32_16x16x32_bf16 v[220:223], a[184:187], v[32:35], 0
    v_exp_f32 v27, v27
    v_mfma_f32_16x16x32_bf16 v[220:223], a[188:191], v[36:39], v[220:223]
    ds_read_b128 a[124:127], v1 offset:37824
    v_smfmac_f32_16x16x64_bf16 a[8:11], a[16:19], v[32:39], v11
    s_waitcnt lgkmcnt(12)
.p2align 5
L2_loop:
    v_mfma_f32_16x16x32_bf16 v[16:19], a[64:67], v[64:67], v[48:51]
    s_sub_u32 s47, s47, s48
    v_exp_f32 v28, v28
    v_mfma_f32_16x16x32_bf16 v[16:19], a[68:71], v[68:71], v[16:19]
    v_cvt_pk_bf16_f32 v45, v26, v27
    v_add_u32 v1, s48, v1
    v_mfma_f32_16x16x32_bf16 v[16:19], a[72:75], v[72:75], v[16:19]
    v_exp_f32 v29, v29
    v_mfma_f32_16x16x32_bf16 v[16:19], a[76:79], v[76:79], v[16:19]
    s_waitcnt lgkmcnt(8)
    v_mfma_f32_16x16x32_bf16 v[20:23], a[80:83], v[64:67], v[48:51]
    v_exp_f32 v30, v30
    v_mfma_f32_16x16x32_bf16 v[20:23], a[84:87], v[68:71], v[20:23]
    v_cvt_pk_bf16_f32 v46, v28, v29
    v_add_u32 v2, s48, v2
    v_mfma_f32_16x16x32_bf16 v[20:23], a[88:91], v[72:75], v[20:23]
    v_exp_f32 v31, v31
    v_mfma_f32_16x16x32_bf16 v[20:23], a[92:95], v[76:79], v[20:23]
    s_waitcnt lgkmcnt(4)
    v_mfma_f32_16x16x32_bf16 v[24:27], a[96:99], v[64:67], v[48:51]
    s_sub_u32 s48, 0, s48
    v_exp_f32 v16, v16
    v_mfma_f32_16x16x32_bf16 v[24:27], a[100:103], v[68:71], v[24:27]
    v_cvt_pk_bf16_f32 v47, v30, v31
    v_mfma_f32_16x16x32_bf16 v[24:27], a[104:107], v[72:75], v[24:27]
    v_exp_f32 v17, v17
    v_mfma_f32_16x16x32_bf16 v[24:27], a[108:111], v[76:79], v[24:27]
    s_waitcnt lgkmcnt(0)
    v_mfma_f32_16x16x32_bf16 v[28:31], a[112:115], v[64:67], v[48:51]
L2_pad4:
    s_cbranch_execz L2_pad8
    v_exp_f32 v18, v18
    v_mfma_f32_16x16x32_bf16 v[28:31], a[116:119], v[68:71], v[28:31]
    v_cvt_pk_bf16_f32 v32, v16, v17
    v_mfma_f32_16x16x32_bf16 v[28:31], a[120:123], v[72:75], v[28:31]
    v_exp_f32 v19, v19
    v_mfma_f32_16x16x32_bf16 v[28:31], a[124:127], v[76:79], v[28:31]
    s_waitcnt vmcnt(0)
    s_barrier
    v_mfma_f32_16x16x32_bf16 v[224:227], a[128:131], v[40:43], v[224:227]
    v_exp_f32 v20, v20
    v_mfma_f32_16x16x32_bf16 v[224:227], a[132:135], v[44:47], v[224:227]
    ds_read_b64_tr_b16 a[128:129], v2 offset:0
    v_cvt_pk_bf16_f32 v33, v18, v19
    v_mfma_f32_16x16x32_bf16 v[228:231], a[136:139], v[40:43], v[228:231]
    s_add_u32 m0, s47, 0
    v_exp_f32 v21, v21
    v_mfma_f32_16x16x32_bf16 v[228:231], a[140:143], v[44:47], v[228:231]
    s_add_u32 s46, s46, 16384
    buffer_load_dwordx4 v5, s[16:19], s46 offen offset:0 lds
    v_mfma_f32_16x16x32_bf16 v[232:235], a[144:147], v[40:43], v[232:235]
    v_exp_f32 v22, v22
    v_mfma_f32_16x16x32_bf16 v[232:235], a[148:151], v[44:47], v[232:235]
    ds_read_b64_tr_b16 a[130:131], v2 offset:256
    v_cvt_pk_bf16_f32 v34, v20, v21
    v_mfma_f32_16x16x32_bf16 v[236:239], a[152:155], v[40:43], v[236:239]
    s_add_u32 m0, s47, 32
    v_exp_f32 v23, v23
    v_mfma_f32_16x16x32_bf16 v[236:239], a[156:159], v[44:47], v[236:239]
    buffer_load_dwordx4 v5, s[16:19], s46 offen offset:1024 lds
    v_mfma_f32_16x16x32_bf16 v[240:243], a[160:163], v[40:43], v[240:243]
    v_exp_f32 v24, v24
    v_mfma_f32_16x16x32_bf16 v[240:243], a[164:167], v[44:47], v[240:243]
    ds_read_b64_tr_b16 a[132:133], v2 offset:512
    v_cvt_pk_bf16_f32 v35, v22, v23
    v_mfma_f32_16x16x32_bf16 v[244:247], a[168:171], v[40:43], v[244:247]
    s_add_u32 m0, s47, 64
    v_exp_f32 v25, v25
    v_mfma_f32_16x16x32_bf16 v[244:247], a[172:175], v[44:47], v[244:247]
    buffer_load_dwordx4 v5, s[16:19], s46 offen offset:2048 lds
    v_mfma_f32_16x16x32_bf16 v[248:251], a[176:179], v[40:43], v[248:251]
    v_exp_f32 v26, v26
    v_mfma_f32_16x16x32_bf16 v[248:251], a[180:183], v[44:47], v[248:251]
    ds_read_b64_tr_b16 a[134:135], v2 offset:768
    v_cvt_pk_bf16_f32 v36, v24, v25
    v_mfma_f32_16x16x32_bf16 v[252:255], a[184:187], v[40:43], v[252:255]
    s_add_u32 m0, s47, 96
    v_exp_f32 v27, v27
    v_mfma_f32_16x16x32_bf16 v[252:255], a[188:191], v[44:47], v[252:255]
    buffer_load_dwordx4 v5, s[16:19], s46 offen offset:3072 lds
    v_smfmac_f32_16x16x64_bf16 a[12:15], a[16:19], v[40:47], v11
    ds_read_b64_tr_b16 a[136:137], v2 offset:32
    v_mfma_f32_16x16x32_bf16 v[16:19], a[64:67], v[80:83], v[52:55]
    v_exp_f32 v28, v28
    v_mfma_f32_16x16x32_bf16 v[16:19], a[68:71], v[84:87], v[16:19]
    ds_read_b64_tr_b16 a[138:139], v2 offset:288
    v_cvt_pk_bf16_f32 v37, v26, v27
    v_mfma_f32_16x16x32_bf16 v[16:19], a[72:75], v[88:91], v[16:19]
    s_add_u32 m0, s47, 16896
    v_exp_f32 v29, v29
    v_mfma_f32_16x16x32_bf16 v[16:19], a[76:79], v[92:95], v[16:19]
    buffer_load_dwordx4 v5, s[20:23], s46 offen offset:0 lds
    v_mfma_f32_16x16x32_bf16 v[20:23], a[80:83], v[80:83], v[52:55]
    v_exp_f32 v30, v30
    v_mfma_f32_16x16x32_bf16 v[20:23], a[84:87], v[84:87], v[20:23]
    ds_read_b64_tr_b16 a[140:141], v2 offset:544
    v_cvt_pk_bf16_f32 v38, v28, v29
    v_mfma_f32_16x16x32_bf16 v[20:23], a[88:91], v[88:91], v[20:23]
    s_add_u32 m0, s47, 16928
    v_exp_f32 v31, v31
    v_mfma_f32_16x16x32_bf16 v[20:23], a[92:95], v[92:95], v[20:23]
    buffer_load_dwordx4 v5, s[20:23], s46 offen offset:1024 lds
    v_mfma_f32_16x16x32_bf16 v[24:27], a[96:99], v[80:83], v[52:55]
    v_exp_f32 v16, v16
    v_mfma_f32_16x16x32_bf16 v[24:27], a[100:103], v[84:87], v[24:27]
    ds_read_b64_tr_b16 a[142:143], v2 offset:800
    v_cvt_pk_bf16_f32 v39, v30, v31
    v_mfma_f32_16x16x32_bf16 v[24:27], a[104:107], v[88:91], v[24:27]
    s_add_u32 m0, s47, 16960
    v_exp_f32 v17, v17
    v_mfma_f32_16x16x32_bf16 v[24:27], a[108:111], v[92:95], v[24:27]
    buffer_load_dwordx4 v5, s[20:23], s46 offen offset:2048 lds
    v_mfma_f32_16x16x32_bf16 v[28:31], a[112:115], v[80:83], v[52:55]
    v_exp_f32 v18, v18
    v_mfma_f32_16x16x32_bf16 v[28:31], a[116:119], v[84:87], v[28:31]
    ds_read_b64_tr_b16 a[144:145], v2 offset:64
    v_cvt_pk_bf16_f32 v40, v16, v17
    v_mfma_f32_16x16x32_bf16 v[28:31], a[120:123], v[88:91], v[28:31]
    s_add_u32 m0, s47, 16992
    v_exp_f32 v19, v19
    v_mfma_f32_16x16x32_bf16 v[28:31], a[124:127], v[92:95], v[28:31]
    buffer_load_dwordx4 v5, s[20:23], s46 offen offset:3072 lds
    v_mfma_f32_16x16x32_bf16 v[128:131], a[192:195], v[32:35], v[128:131]
    v_exp_f32 v20, v20
    v_mfma_f32_16x16x32_bf16 v[128:131], a[196:199], v[36:39], v[128:131]
    ds_read_b64_tr_b16 a[146:147], v2 offset:320
    v_cvt_pk_bf16_f32 v41, v18, v19
    v_mfma_f32_16x16x32_bf16 v[132:135], a[200:203], v[32:35], v[132:135]
    s_add_u32 m0, s47, 36864
    v_exp_f32 v21, v21
    v_mfma_f32_16x16x32_bf16 v[132:135], a[204:207], v[36:39], v[132:135]
    s_add_u32 s46, s46, 16384
    buffer_load_dwordx4 v5, s[16:19], s46 offen offset:0 lds
    v_mfma_f32_16x16x32_bf16 v[136:139], a[208:211], v[32:35], v[136:139]
    v_exp_f32 v22, v22
    v_mfma_f32_16x16x32_bf16 v[136:139], a[212:215], v[36:39], v[136:139]
    ds_read_b64_tr_b16 a[148:149], v2 offset:576
    v_cvt_pk_bf16_f32 v42, v20, v21
    v_mfma_f32_16x16x32_bf16 v[140:143], a[216:219], v[32:35], v[140:143]
    s_add_u32 m0, s47, 36896
    v_exp_f32 v23, v23
    v_mfma_f32_16x16x32_bf16 v[140:143], a[220:223], v[36:39], v[140:143]
    buffer_load_dwordx4 v5, s[16:19], s46 offen offset:1024 lds
    v_mfma_f32_16x16x32_bf16 v[144:147], a[224:227], v[32:35], v[144:147]
    v_exp_f32 v24, v24
    v_mfma_f32_16x16x32_bf16 v[144:147], a[228:231], v[36:39], v[144:147]
    ds_read_b64_tr_b16 a[150:151], v2 offset:832
    v_cvt_pk_bf16_f32 v43, v22, v23
    v_mfma_f32_16x16x32_bf16 v[148:151], a[232:235], v[32:35], v[148:151]
    s_add_u32 m0, s47, 36928
    v_exp_f32 v25, v25
    v_mfma_f32_16x16x32_bf16 v[148:151], a[236:239], v[36:39], v[148:151]
    buffer_load_dwordx4 v5, s[16:19], s46 offen offset:2048 lds
    v_mfma_f32_16x16x32_bf16 v[152:155], a[240:243], v[32:35], v[152:155]
    v_exp_f32 v26, v26
    v_mfma_f32_16x16x32_bf16 v[152:155], a[244:247], v[36:39], v[152:155]
    ds_read_b64_tr_b16 a[152:153], v2 offset:96
    v_cvt_pk_bf16_f32 v44, v24, v25
    v_mfma_f32_16x16x32_bf16 v[156:159], a[248:251], v[32:35], v[156:159]
    s_add_u32 m0, s47, 36960
    v_exp_f32 v27, v27
    v_mfma_f32_16x16x32_bf16 v[156:159], a[252:255], v[36:39], v[156:159]
    buffer_load_dwordx4 v5, s[16:19], s46 offen offset:3072 lds
    v_smfmac_f32_16x16x64_bf16 a[0:3], a[16:19], v[32:39], v11
    ds_read_b64_tr_b16 a[154:155], v2 offset:352
    v_mfma_f32_16x16x32_bf16 v[16:19], a[64:67], v[96:99], v[56:59]
    v_exp_f32 v28, v28
    v_mfma_f32_16x16x32_bf16 v[16:19], a[68:71], v[100:103], v[16:19]
    ds_read_b64_tr_b16 a[156:157], v2 offset:608
    v_cvt_pk_bf16_f32 v45, v26, v27
    v_mfma_f32_16x16x32_bf16 v[16:19], a[72:75], v[104:107], v[16:19]
    s_add_u32 m0, s47, 53760
    v_exp_f32 v29, v29
    v_mfma_f32_16x16x32_bf16 v[16:19], a[76:79], v[108:111], v[16:19]
    buffer_load_dwordx4 v5, s[20:23], s46 offen offset:0 lds
    v_mfma_f32_16x16x32_bf16 v[20:23], a[80:83], v[96:99], v[56:59]
    v_exp_f32 v30, v30
    v_mfma_f32_16x16x32_bf16 v[20:23], a[84:87], v[100:103], v[20:23]
    ds_read_b64_tr_b16 a[158:159], v2 offset:864
    v_cvt_pk_bf16_f32 v46, v28, v29
    v_mfma_f32_16x16x32_bf16 v[20:23], a[88:91], v[104:107], v[20:23]
    s_add_u32 m0, s47, 53792
    v_exp_f32 v31, v31
    v_mfma_f32_16x16x32_bf16 v[20:23], a[92:95], v[108:111], v[20:23]
    buffer_load_dwordx4 v5, s[20:23], s46 offen offset:1024 lds
    v_mfma_f32_16x16x32_bf16 v[24:27], a[96:99], v[96:99], v[56:59]
    v_exp_f32 v16, v16
    v_mfma_f32_16x16x32_bf16 v[24:27], a[100:103], v[100:103], v[24:27]
    ds_read_b64_tr_b16 a[160:161], v2 offset:128
    v_cvt_pk_bf16_f32 v47, v30, v31
    v_mfma_f32_16x16x32_bf16 v[24:27], a[104:107], v[104:107], v[24:27]
    s_add_u32 m0, s47, 53824
    v_exp_f32 v17, v17
    v_mfma_f32_16x16x32_bf16 v[24:27], a[108:111], v[108:111], v[24:27]
    buffer_load_dwordx4 v5, s[20:23], s46 offen offset:2048 lds
    v_mfma_f32_16x16x32_bf16 v[28:31], a[112:115], v[96:99], v[56:59]
    v_exp_f32 v18, v18
    v_mfma_f32_16x16x32_bf16 v[28:31], a[116:119], v[100:103], v[28:31]
    ds_read_b64_tr_b16 a[162:163], v2 offset:384
    v_cvt_pk_bf16_f32 v32, v16, v17
    v_mfma_f32_16x16x32_bf16 v[28:31], a[120:123], v[104:107], v[28:31]
    s_add_u32 m0, s47, 53856
    v_exp_f32 v19, v19
    v_mfma_f32_16x16x32_bf16 v[28:31], a[124:127], v[108:111], v[28:31]
    buffer_load_dwordx4 v5, s[20:23], s46 offen offset:3072 lds
    v_mfma_f32_16x16x32_bf16 v[160:163], a[192:195], v[40:43], v[160:163]
    v_exp_f32 v20, v20
    v_mfma_f32_16x16x32_bf16 v[160:163], a[196:199], v[44:47], v[160:163]
    ds_read_b64_tr_b16 a[164:165], v2 offset:640
    v_cvt_pk_bf16_f32 v33, v18, v19
    v_mfma_f32_16x16x32_bf16 v[164:167], a[200:203], v[40:43], v[164:167]
    v_exp_f32 v21, v21
    v_mfma_f32_16x16x32_bf16 v[164:167], a[204:207], v[44:47], v[164:167]
    ds_read_b64_tr_b16 a[166:167], v2 offset:896
    ds_read_b64_tr_b16 a[168:169], v2 offset:160
    v_mfma_f32_16x16x32_bf16 v[168:171], a[208:211], v[40:43], v[168:171]
    v_exp_f32 v22, v22
    v_mfma_f32_16x16x32_bf16 v[168:171], a[212:215], v[44:47], v[168:171]
    ds_read_b64_tr_b16 a[170:171], v2 offset:416
    v_cvt_pk_bf16_f32 v34, v20, v21
    v_mfma_f32_16x16x32_bf16 v[172:175], a[216:219], v[40:43], v[172:175]
    v_exp_f32 v23, v23
    v_mfma_f32_16x16x32_bf16 v[172:175], a[220:223], v[44:47], v[172:175]
    ds_read_b64_tr_b16 a[172:173], v2 offset:672
    ds_read_b64_tr_b16 a[174:175], v2 offset:928
    v_mfma_f32_16x16x32_bf16 v[176:179], a[224:227], v[40:43], v[176:179]
    v_exp_f32 v24, v24
    v_mfma_f32_16x16x32_bf16 v[176:179], a[228:231], v[44:47], v[176:179]
    ds_read_b64_tr_b16 a[176:177], v2 offset:192
    v_cvt_pk_bf16_f32 v35, v22, v23
    v_mfma_f32_16x16x32_bf16 v[180:183], a[232:235], v[40:43], v[180:183]
    v_exp_f32 v25, v25
    v_mfma_f32_16x16x32_bf16 v[180:183], a[236:239], v[44:47], v[180:183]
    ds_read_b64_tr_b16 a[178:179], v2 offset:448
    ds_read_b64_tr_b16 a[180:181], v2 offset:704
    v_mfma_f32_16x16x32_bf16 v[184:187], a[240:243], v[40:43], v[184:187]
    v_exp_f32 v26, v26
    v_mfma_f32_16x16x32_bf16 v[184:187], a[244:247], v[44:47], v[184:187]
    ds_read_b64_tr_b16 a[182:183], v2 offset:960
    v_cvt_pk_bf16_f32 v36, v24, v25
    v_mfma_f32_16x16x32_bf16 v[188:191], a[248:251], v[40:43], v[188:191]
    v_exp_f32 v27, v27
    v_mfma_f32_16x16x32_bf16 v[188:191], a[252:255], v[44:47], v[188:191]
    ds_read_b64_tr_b16 a[184:185], v2 offset:224
    ds_read_b64_tr_b16 a[186:187], v2 offset:480
    v_smfmac_f32_16x16x64_bf16 a[4:7], a[16:19], v[40:47], v11
    ds_read_b64_tr_b16 a[188:189], v2 offset:736
    ds_read_b64_tr_b16 a[190:191], v2 offset:992
    v_mfma_f32_16x16x32_bf16 v[16:19], a[64:67], v[112:115], v[60:63]
    v_exp_f32 v28, v28
    v_mfma_f32_16x16x32_bf16 v[16:19], a[68:71], v[116:119], v[16:19]
    ds_read_b128 a[64:67], v1 offset:0
    v_cvt_pk_bf16_f32 v37, v26, v27
    v_mfma_f32_16x16x32_bf16 v[16:19], a[72:75], v[120:123], v[16:19]
    v_exp_f32 v29, v29
    v_mfma_f32_16x16x32_bf16 v[16:19], a[76:79], v[124:127], v[16:19]
    ds_read_b128 a[68:71], v1 offset:64
    v_mfma_f32_16x16x32_bf16 v[20:23], a[80:83], v[112:115], v[60:63]
    v_exp_f32 v30, v30
    v_mfma_f32_16x16x32_bf16 v[20:23], a[84:87], v[116:119], v[20:23]
    ds_read_b128 a[72:75], v1 offset:128
    v_cvt_pk_bf16_f32 v38, v28, v29
    v_mfma_f32_16x16x32_bf16 v[20:23], a[88:91], v[120:123], v[20:23]
    v_exp_f32 v31, v31
    v_mfma_f32_16x16x32_bf16 v[20:23], a[92:95], v[124:127], v[20:23]
    ds_read_b128 a[76:79], v1 offset:192
    v_mfma_f32_16x16x32_bf16 v[24:27], a[96:99], v[112:115], v[60:63]
    v_exp_f32 v16, v16
    v_mfma_f32_16x16x32_bf16 v[24:27], a[100:103], v[116:119], v[24:27]
    ds_read_b128 a[80:83], v1 offset:256
    v_cvt_pk_bf16_f32 v39, v30, v31
    v_mfma_f32_16x16x32_bf16 v[24:27], a[104:107], v[120:123], v[24:27]
    v_exp_f32 v17, v17
    v_mfma_f32_16x16x32_bf16 v[24:27], a[108:111], v[124:127], v[24:27]
    ds_read_b128 a[84:87], v1 offset:320
    v_mfma_f32_16x16x32_bf16 v[28:31], a[112:115], v[112:115], v[60:63]
    v_exp_f32 v18, v18
    v_mfma_f32_16x16x32_bf16 v[28:31], a[116:119], v[116:119], v[28:31]
    ds_read_b128 a[88:91], v1 offset:384
    v_cvt_pk_bf16_f32 v40, v16, v17
    v_mfma_f32_16x16x32_bf16 v[28:31], a[120:123], v[120:123], v[28:31]
    v_exp_f32 v19, v19
    v_mfma_f32_16x16x32_bf16 v[28:31], a[124:127], v[124:127], v[28:31]
    ds_read_b128 a[92:95], v1 offset:448
    v_mfma_f32_16x16x32_bf16 v[192:195], a[192:195], v[32:35], v[192:195]
    v_exp_f32 v20, v20
    v_mfma_f32_16x16x32_bf16 v[192:195], a[196:199], v[36:39], v[192:195]
    ds_read_b128 a[96:99], v1 offset:512
    v_cvt_pk_bf16_f32 v41, v18, v19
    v_mfma_f32_16x16x32_bf16 v[196:199], a[200:203], v[32:35], v[196:199]
    v_exp_f32 v21, v21
    v_mfma_f32_16x16x32_bf16 v[196:199], a[204:207], v[36:39], v[196:199]
    ds_read_b128 a[100:103], v1 offset:576
    v_mfma_f32_16x16x32_bf16 v[200:203], a[208:211], v[32:35], v[200:203]
    v_exp_f32 v22, v22
    v_mfma_f32_16x16x32_bf16 v[200:203], a[212:215], v[36:39], v[200:203]
    ds_read_b128 a[104:107], v1 offset:640
    v_cvt_pk_bf16_f32 v42, v20, v21
    v_mfma_f32_16x16x32_bf16 v[204:207], a[216:219], v[32:35], v[204:207]
    v_exp_f32 v23, v23
    v_mfma_f32_16x16x32_bf16 v[204:207], a[220:223], v[36:39], v[204:207]
    ds_read_b128 a[108:111], v1 offset:704
    v_mfma_f32_16x16x32_bf16 v[208:211], a[224:227], v[32:35], v[208:211]
    v_exp_f32 v24, v24
    v_mfma_f32_16x16x32_bf16 v[208:211], a[228:231], v[36:39], v[208:211]
    ds_read_b128 a[112:115], v1 offset:768
    v_cvt_pk_bf16_f32 v43, v22, v23
    v_mfma_f32_16x16x32_bf16 v[212:215], a[232:235], v[32:35], v[212:215]
    v_exp_f32 v25, v25
    v_mfma_f32_16x16x32_bf16 v[212:215], a[236:239], v[36:39], v[212:215]
    ds_read_b128 a[116:119], v1 offset:832
    v_mfma_f32_16x16x32_bf16 v[216:219], a[240:243], v[32:35], v[216:219]
    v_exp_f32 v26, v26
    v_mfma_f32_16x16x32_bf16 v[216:219], a[244:247], v[36:39], v[216:219]
    ds_read_b128 a[120:123], v1 offset:896
    v_cvt_pk_bf16_f32 v44, v24, v25
    v_mfma_f32_16x16x32_bf16 v[220:223], a[248:251], v[32:35], v[220:223]
    v_exp_f32 v27, v27
    v_mfma_f32_16x16x32_bf16 v[220:223], a[252:255], v[36:39], v[220:223]
    ds_read_b128 a[124:127], v1 offset:960
    v_smfmac_f32_16x16x64_bf16 a[8:11], a[16:19], v[32:39], v11
    s_waitcnt lgkmcnt(12)
    v_mfma_f32_16x16x32_bf16 v[16:19], a[64:67], v[64:67], v[48:51]
    v_exp_f32 v28, v28
    v_mfma_f32_16x16x32_bf16 v[16:19], a[68:71], v[68:71], v[16:19]
    v_cvt_pk_bf16_f32 v45, v26, v27
    v_mfma_f32_16x16x32_bf16 v[16:19], a[72:75], v[72:75], v[16:19]
    v_exp_f32 v29, v29
    v_mfma_f32_16x16x32_bf16 v[16:19], a[76:79], v[76:79], v[16:19]
    s_waitcnt lgkmcnt(8)
    v_mfma_f32_16x16x32_bf16 v[20:23], a[80:83], v[64:67], v[48:51]
    v_exp_f32 v30, v30
    v_mfma_f32_16x16x32_bf16 v[20:23], a[84:87], v[68:71], v[20:23]
    v_cvt_pk_bf16_f32 v46, v28, v29
    v_mfma_f32_16x16x32_bf16 v[20:23], a[88:91], v[72:75], v[20:23]
    v_exp_f32 v31, v31
    v_mfma_f32_16x16x32_bf16 v[20:23], a[92:95], v[76:79], v[20:23]
    s_waitcnt lgkmcnt(4)
    v_mfma_f32_16x16x32_bf16 v[24:27], a[96:99], v[64:67], v[48:51]
    v_exp_f32 v16, v16
    v_mfma_f32_16x16x32_bf16 v[24:27], a[100:103], v[68:71], v[24:27]
    v_cvt_pk_bf16_f32 v47, v30, v31
    v_mfma_f32_16x16x32_bf16 v[24:27], a[104:107], v[72:75], v[24:27]
    v_exp_f32 v17, v17
    v_mfma_f32_16x16x32_bf16 v[24:27], a[108:111], v[76:79], v[24:27]
    s_waitcnt lgkmcnt(0)
    v_mfma_f32_16x16x32_bf16 v[28:31], a[112:115], v[64:67], v[48:51]
    v_exp_f32 v18, v18
    v_mfma_f32_16x16x32_bf16 v[28:31], a[116:119], v[68:71], v[28:31]
    v_cvt_pk_bf16_f32 v32, v16, v17
    v_mfma_f32_16x16x32_bf16 v[28:31], a[120:123], v[72:75], v[28:31]
    v_exp_f32 v19, v19
    v_mfma_f32_16x16x32_bf16 v[28:31], a[124:127], v[76:79], v[28:31]
    v_mfma_f32_16x16x32_bf16 v[224:227], a[192:195], v[40:43], v[224:227]
    v_exp_f32 v20, v20
    v_mfma_f32_16x16x32_bf16 v[224:227], a[196:199], v[44:47], v[224:227]
    ds_read_b64_tr_b16 a[192:193], v2 offset:36864
    v_cvt_pk_bf16_f32 v33, v18, v19
    v_mfma_f32_16x16x32_bf16 v[228:231], a[200:203], v[40:43], v[228:231]
    v_exp_f32 v21, v21
    v_mfma_f32_16x16x32_bf16 v[228:231], a[204:207], v[44:47], v[228:231]
    ds_read_b64_tr_b16 a[194:195], v2 offset:37120
    v_mfma_f32_16x16x32_bf16 v[232:235], a[208:211], v[40:43], v[232:235]
    v_exp_f32 v22, v22
    v_mfma_f32_16x16x32_bf16 v[232:235], a[212:215], v[44:47], v[232:235]
    ds_read_b64_tr_b16 a[196:197], v2 offset:37376
    v_cvt_pk_bf16_f32 v34, v20, v21
    v_mfma_f32_16x16x32_bf16 v[236:239], a[216:219], v[40:43], v[236:239]
    v_exp_f32 v23, v23
    v_mfma_f32_16x16x32_bf16 v[236:239], a[220:223], v[44:47], v[236:239]
    ds_read_b64_tr_b16 a[198:199], v2 offset:37632
    v_mfma_f32_16x16x32_bf16 v[240:243], a[224:227], v[40:43], v[240:243]
    v_exp_f32 v24, v24
    v_mfma_f32_16x16x32_bf16 v[240:243], a[228:231], v[44:47], v[240:243]
    ds_read_b64_tr_b16 a[200:201], v2 offset:36896
    v_cvt_pk_bf16_f32 v35, v22, v23
    v_mfma_f32_16x16x32_bf16 v[244:247], a[232:235], v[40:43], v[244:247]
    v_exp_f32 v25, v25
    v_mfma_f32_16x16x32_bf16 v[244:247], a[236:239], v[44:47], v[244:247]
    ds_read_b64_tr_b16 a[202:203], v2 offset:37152
    v_mfma_f32_16x16x32_bf16 v[248:251], a[240:243], v[40:43], v[248:251]
    v_exp_f32 v26, v26
    v_mfma_f32_16x16x32_bf16 v[248:251], a[244:247], v[44:47], v[248:251]
    ds_read_b64_tr_b16 a[204:205], v2 offset:37408
    v_cvt_pk_bf16_f32 v36, v24, v25
    v_mfma_f32_16x16x32_bf16 v[252:255], a[248:251], v[40:43], v[252:255]
    v_exp_f32 v27, v27
    v_mfma_f32_16x16x32_bf16 v[252:255], a[252:255], v[44:47], v[252:255]
    ds_read_b64_tr_b16 a[206:207], v2 offset:37664
    v_smfmac_f32_16x16x64_bf16 a[12:15], a[16:19], v[40:47], v11
    ds_read_b64_tr_b16 a[208:209], v2 offset:36928
    v_mfma_f32_16x16x32_bf16 v[16:19], a[64:67], v[80:83], v[52:55]
    v_exp_f32 v28, v28
    v_mfma_f32_16x16x32_bf16 v[16:19], a[68:71], v[84:87], v[16:19]
    ds_read_b64_tr_b16 a[210:211], v2 offset:37184
    v_cvt_pk_bf16_f32 v37, v26, v27
    v_mfma_f32_16x16x32_bf16 v[16:19], a[72:75], v[88:91], v[16:19]
    v_exp_f32 v29, v29
    v_mfma_f32_16x16x32_bf16 v[16:19], a[76:79], v[92:95], v[16:19]
    ds_read_b64_tr_b16 a[212:213], v2 offset:37440
    v_mfma_f32_16x16x32_bf16 v[20:23], a[80:83], v[80:83], v[52:55]
    v_exp_f32 v30, v30
    v_mfma_f32_16x16x32_bf16 v[20:23], a[84:87], v[84:87], v[20:23]
    ds_read_b64_tr_b16 a[214:215], v2 offset:37696
    v_cvt_pk_bf16_f32 v38, v28, v29
    v_mfma_f32_16x16x32_bf16 v[20:23], a[88:91], v[88:91], v[20:23]
    v_exp_f32 v31, v31
    v_mfma_f32_16x16x32_bf16 v[20:23], a[92:95], v[92:95], v[20:23]
    ds_read_b64_tr_b16 a[216:217], v2 offset:36960
    v_mfma_f32_16x16x32_bf16 v[24:27], a[96:99], v[80:83], v[52:55]
    v_exp_f32 v16, v16
    v_mfma_f32_16x16x32_bf16 v[24:27], a[100:103], v[84:87], v[24:27]
    ds_read_b64_tr_b16 a[218:219], v2 offset:37216
    v_cvt_pk_bf16_f32 v39, v30, v31
    v_mfma_f32_16x16x32_bf16 v[24:27], a[104:107], v[88:91], v[24:27]
    v_exp_f32 v17, v17
    v_mfma_f32_16x16x32_bf16 v[24:27], a[108:111], v[92:95], v[24:27]
    ds_read_b64_tr_b16 a[220:221], v2 offset:37472
    v_mfma_f32_16x16x32_bf16 v[28:31], a[112:115], v[80:83], v[52:55]
    v_exp_f32 v18, v18
    v_mfma_f32_16x16x32_bf16 v[28:31], a[116:119], v[84:87], v[28:31]
    ds_read_b64_tr_b16 a[222:223], v2 offset:37728
    v_cvt_pk_bf16_f32 v40, v16, v17
    v_mfma_f32_16x16x32_bf16 v[28:31], a[120:123], v[88:91], v[28:31]
    v_exp_f32 v19, v19
    v_mfma_f32_16x16x32_bf16 v[28:31], a[124:127], v[92:95], v[28:31]
    ds_read_b64_tr_b16 a[224:225], v2 offset:36992
    v_mfma_f32_16x16x32_bf16 v[128:131], a[128:131], v[32:35], v[128:131]
    v_exp_f32 v20, v20
    v_mfma_f32_16x16x32_bf16 v[128:131], a[132:135], v[36:39], v[128:131]
    ds_read_b64_tr_b16 a[226:227], v2 offset:37248
    v_cvt_pk_bf16_f32 v41, v18, v19
    v_mfma_f32_16x16x32_bf16 v[132:135], a[136:139], v[32:35], v[132:135]
    v_exp_f32 v21, v21
    v_mfma_f32_16x16x32_bf16 v[132:135], a[140:143], v[36:39], v[132:135]
    ds_read_b64_tr_b16 a[228:229], v2 offset:37504
    v_mfma_f32_16x16x32_bf16 v[136:139], a[144:147], v[32:35], v[136:139]
    v_exp_f32 v22, v22
    v_mfma_f32_16x16x32_bf16 v[136:139], a[148:151], v[36:39], v[136:139]
    ds_read_b64_tr_b16 a[230:231], v2 offset:37760
    v_cvt_pk_bf16_f32 v42, v20, v21
    v_mfma_f32_16x16x32_bf16 v[140:143], a[152:155], v[32:35], v[140:143]
    v_exp_f32 v23, v23
    v_mfma_f32_16x16x32_bf16 v[140:143], a[156:159], v[36:39], v[140:143]
    ds_read_b64_tr_b16 a[232:233], v2 offset:37024
    v_mfma_f32_16x16x32_bf16 v[144:147], a[160:163], v[32:35], v[144:147]
    v_exp_f32 v24, v24
    v_mfma_f32_16x16x32_bf16 v[144:147], a[164:167], v[36:39], v[144:147]
    ds_read_b64_tr_b16 a[234:235], v2 offset:37280
    v_cvt_pk_bf16_f32 v43, v22, v23
    v_mfma_f32_16x16x32_bf16 v[148:151], a[168:171], v[32:35], v[148:151]
    v_exp_f32 v25, v25
    v_mfma_f32_16x16x32_bf16 v[148:151], a[172:175], v[36:39], v[148:151]
    ds_read_b64_tr_b16 a[236:237], v2 offset:37536
    v_mfma_f32_16x16x32_bf16 v[152:155], a[176:179], v[32:35], v[152:155]
    v_exp_f32 v26, v26
    v_mfma_f32_16x16x32_bf16 v[152:155], a[180:183], v[36:39], v[152:155]
    ds_read_b64_tr_b16 a[238:239], v2 offset:37792
    v_cvt_pk_bf16_f32 v44, v24, v25
    v_mfma_f32_16x16x32_bf16 v[156:159], a[184:187], v[32:35], v[156:159]
    v_exp_f32 v27, v27
    v_mfma_f32_16x16x32_bf16 v[156:159], a[188:191], v[36:39], v[156:159]
    ds_read_b64_tr_b16 a[240:241], v2 offset:37056
    v_smfmac_f32_16x16x64_bf16 a[0:3], a[16:19], v[32:39], v11
    ds_read_b64_tr_b16 a[242:243], v2 offset:37312
    v_mfma_f32_16x16x32_bf16 v[16:19], a[64:67], v[96:99], v[56:59]
    v_exp_f32 v28, v28
    v_mfma_f32_16x16x32_bf16 v[16:19], a[68:71], v[100:103], v[16:19]
    ds_read_b64_tr_b16 a[244:245], v2 offset:37568
    v_cvt_pk_bf16_f32 v45, v26, v27
    v_mfma_f32_16x16x32_bf16 v[16:19], a[72:75], v[104:107], v[16:19]
    v_exp_f32 v29, v29
    v_mfma_f32_16x16x32_bf16 v[16:19], a[76:79], v[108:111], v[16:19]
    ds_read_b64_tr_b16 a[246:247], v2 offset:37824
    v_mfma_f32_16x16x32_bf16 v[20:23], a[80:83], v[96:99], v[56:59]
    v_exp_f32 v30, v30
    v_mfma_f32_16x16x32_bf16 v[20:23], a[84:87], v[100:103], v[20:23]
    ds_read_b64_tr_b16 a[248:249], v2 offset:37088
    v_cvt_pk_bf16_f32 v46, v28, v29
    v_mfma_f32_16x16x32_bf16 v[20:23], a[88:91], v[104:107], v[20:23]
    v_exp_f32 v31, v31
    v_mfma_f32_16x16x32_bf16 v[20:23], a[92:95], v[108:111], v[20:23]
    ds_read_b64_tr_b16 a[250:251], v2 offset:37344
    v_mfma_f32_16x16x32_bf16 v[24:27], a[96:99], v[96:99], v[56:59]
    v_exp_f32 v16, v16
    v_mfma_f32_16x16x32_bf16 v[24:27], a[100:103], v[100:103], v[24:27]
    ds_read_b64_tr_b16 a[252:253], v2 offset:37600
    v_cvt_pk_bf16_f32 v47, v30, v31
    v_mfma_f32_16x16x32_bf16 v[24:27], a[104:107], v[104:107], v[24:27]
    v_exp_f32 v17, v17
    v_mfma_f32_16x16x32_bf16 v[24:27], a[108:111], v[108:111], v[24:27]
    ds_read_b64_tr_b16 a[254:255], v2 offset:37856
    v_mfma_f32_16x16x32_bf16 v[28:31], a[112:115], v[96:99], v[56:59]
    v_exp_f32 v18, v18
    v_mfma_f32_16x16x32_bf16 v[28:31], a[116:119], v[100:103], v[28:31]
    v_cvt_pk_bf16_f32 v32, v16, v17
    v_mfma_f32_16x16x32_bf16 v[28:31], a[120:123], v[104:107], v[28:31]
    v_exp_f32 v19, v19
    v_mfma_f32_16x16x32_bf16 v[28:31], a[124:127], v[108:111], v[28:31]
    v_mfma_f32_16x16x32_bf16 v[160:163], a[128:131], v[40:43], v[160:163]
    v_exp_f32 v20, v20
    v_mfma_f32_16x16x32_bf16 v[160:163], a[132:135], v[44:47], v[160:163]
    v_cvt_pk_bf16_f32 v33, v18, v19
    v_mfma_f32_16x16x32_bf16 v[164:167], a[136:139], v[40:43], v[164:167]
    v_exp_f32 v21, v21
    v_mfma_f32_16x16x32_bf16 v[164:167], a[140:143], v[44:47], v[164:167]
    v_mfma_f32_16x16x32_bf16 v[168:171], a[144:147], v[40:43], v[168:171]
    v_exp_f32 v22, v22
    v_mfma_f32_16x16x32_bf16 v[168:171], a[148:151], v[44:47], v[168:171]
    v_cvt_pk_bf16_f32 v34, v20, v21
    v_mfma_f32_16x16x32_bf16 v[172:175], a[152:155], v[40:43], v[172:175]
    v_exp_f32 v23, v23
    v_mfma_f32_16x16x32_bf16 v[172:175], a[156:159], v[44:47], v[172:175]
    v_mfma_f32_16x16x32_bf16 v[176:179], a[160:163], v[40:43], v[176:179]
    v_exp_f32 v24, v24
    v_mfma_f32_16x16x32_bf16 v[176:179], a[164:167], v[44:47], v[176:179]
    v_cvt_pk_bf16_f32 v35, v22, v23
    v_mfma_f32_16x16x32_bf16 v[180:183], a[168:171], v[40:43], v[180:183]
    v_exp_f32 v25, v25
    v_mfma_f32_16x16x32_bf16 v[180:183], a[172:175], v[44:47], v[180:183]
    v_mfma_f32_16x16x32_bf16 v[184:187], a[176:179], v[40:43], v[184:187]
    v_exp_f32 v26, v26
    v_mfma_f32_16x16x32_bf16 v[184:187], a[180:183], v[44:47], v[184:187]
    v_cvt_pk_bf16_f32 v36, v24, v25
    v_mfma_f32_16x16x32_bf16 v[188:191], a[184:187], v[40:43], v[188:191]
    v_exp_f32 v27, v27
    v_mfma_f32_16x16x32_bf16 v[188:191], a[188:191], v[44:47], v[188:191]
    v_smfmac_f32_16x16x64_bf16 a[4:7], a[16:19], v[40:47], v11
    v_mfma_f32_16x16x32_bf16 v[16:19], a[64:67], v[112:115], v[60:63]
    v_exp_f32 v28, v28
    v_mfma_f32_16x16x32_bf16 v[16:19], a[68:71], v[116:119], v[16:19]
    ds_read_b128 a[64:67], v1 offset:36864
    v_cvt_pk_bf16_f32 v37, v26, v27
    v_mfma_f32_16x16x32_bf16 v[16:19], a[72:75], v[120:123], v[16:19]
    v_exp_f32 v29, v29
    v_mfma_f32_16x16x32_bf16 v[16:19], a[76:79], v[124:127], v[16:19]
    ds_read_b128 a[68:71], v1 offset:36928
    v_mfma_f32_16x16x32_bf16 v[20:23], a[80:83], v[112:115], v[60:63]
    v_exp_f32 v30, v30
    v_mfma_f32_16x16x32_bf16 v[20:23], a[84:87], v[116:119], v[20:23]
    ds_read_b128 a[72:75], v1 offset:36992
    v_cvt_pk_bf16_f32 v38, v28, v29
    v_mfma_f32_16x16x32_bf16 v[20:23], a[88:91], v[120:123], v[20:23]
    v_exp_f32 v31, v31
    v_mfma_f32_16x16x32_bf16 v[20:23], a[92:95], v[124:127], v[20:23]
    ds_read_b128 a[76:79], v1 offset:37056
    v_mfma_f32_16x16x32_bf16 v[24:27], a[96:99], v[112:115], v[60:63]
    v_exp_f32 v16, v16
    v_mfma_f32_16x16x32_bf16 v[24:27], a[100:103], v[116:119], v[24:27]
    ds_read_b128 a[80:83], v1 offset:37120
    v_cvt_pk_bf16_f32 v39, v30, v31
    v_mfma_f32_16x16x32_bf16 v[24:27], a[104:107], v[120:123], v[24:27]
    v_exp_f32 v17, v17
    v_mfma_f32_16x16x32_bf16 v[24:27], a[108:111], v[124:127], v[24:27]
    ds_read_b128 a[84:87], v1 offset:37184
    v_mfma_f32_16x16x32_bf16 v[28:31], a[112:115], v[112:115], v[60:63]
    v_exp_f32 v18, v18
    v_mfma_f32_16x16x32_bf16 v[28:31], a[116:119], v[116:119], v[28:31]
    ds_read_b128 a[88:91], v1 offset:37248
    v_cvt_pk_bf16_f32 v40, v16, v17
    v_mfma_f32_16x16x32_bf16 v[28:31], a[120:123], v[120:123], v[28:31]
    v_exp_f32 v19, v19
    v_mfma_f32_16x16x32_bf16 v[28:31], a[124:127], v[124:127], v[28:31]
    ds_read_b128 a[92:95], v1 offset:37312
    v_mfma_f32_16x16x32_bf16 v[192:195], a[128:131], v[32:35], v[192:195]
    v_exp_f32 v20, v20
    v_mfma_f32_16x16x32_bf16 v[192:195], a[132:135], v[36:39], v[192:195]
    ds_read_b128 a[96:99], v1 offset:37376
    v_cvt_pk_bf16_f32 v41, v18, v19
    v_mfma_f32_16x16x32_bf16 v[196:199], a[136:139], v[32:35], v[196:199]
    v_exp_f32 v21, v21
    v_mfma_f32_16x16x32_bf16 v[196:199], a[140:143], v[36:39], v[196:199]
    ds_read_b128 a[100:103], v1 offset:37440
    v_mfma_f32_16x16x32_bf16 v[200:203], a[144:147], v[32:35], v[200:203]
    v_exp_f32 v22, v22
    v_mfma_f32_16x16x32_bf16 v[200:203], a[148:151], v[36:39], v[200:203]
    ds_read_b128 a[104:107], v1 offset:37504
    v_cvt_pk_bf16_f32 v42, v20, v21
    v_mfma_f32_16x16x32_bf16 v[204:207], a[152:155], v[32:35], v[204:207]
    v_exp_f32 v23, v23
    v_mfma_f32_16x16x32_bf16 v[204:207], a[156:159], v[36:39], v[204:207]
    ds_read_b128 a[108:111], v1 offset:37568
    v_mfma_f32_16x16x32_bf16 v[208:211], a[160:163], v[32:35], v[208:211]
    v_exp_f32 v24, v24
    v_mfma_f32_16x16x32_bf16 v[208:211], a[164:167], v[36:39], v[208:211]
    ds_read_b128 a[112:115], v1 offset:37632
    v_cvt_pk_bf16_f32 v43, v22, v23
    v_mfma_f32_16x16x32_bf16 v[212:215], a[168:171], v[32:35], v[212:215]
    v_exp_f32 v25, v25
    v_mfma_f32_16x16x32_bf16 v[212:215], a[172:175], v[36:39], v[212:215]
    ds_read_b128 a[116:119], v1 offset:37696
    v_mfma_f32_16x16x32_bf16 v[216:219], a[176:179], v[32:35], v[216:219]
    v_exp_f32 v26, v26
    v_mfma_f32_16x16x32_bf16 v[216:219], a[180:183], v[36:39], v[216:219]
    s_sub_u32 s49, s49, 1
    ds_read_b128 a[120:123], v1 offset:37760
    v_cvt_pk_bf16_f32 v44, v24, v25
    v_mfma_f32_16x16x32_bf16 v[220:223], a[184:187], v[32:35], v[220:223]
    s_cmp_lg_u32 s49, 0
    v_exp_f32 v27, v27
    v_mfma_f32_16x16x32_bf16 v[220:223], a[188:191], v[36:39], v[220:223]
    ds_read_b128 a[124:127], v1 offset:37824
    v_smfmac_f32_16x16x64_bf16 a[8:11], a[16:19], v[32:39], v11
    s_waitcnt lgkmcnt(12)
    s_cbranch_scc1 L2_loop
    v_mfma_f32_16x16x32_bf16 v[16:19], a[64:67], v[64:67], v[48:51]
    s_sub_u32 s47, s47, s48
    v_exp_f32 v28, v28
    v_mfma_f32_16x16x32_bf16 v[16:19], a[68:71], v[68:71], v[16:19]
L2_pad5:
    s_cbranch_execz L2_pad9
    v_cvt_pk_bf16_f32 v45, v26, v27
    v_add_u32 v1, s48, v1
    v_mfma_f32_16x16x32_bf16 v[16:19], a[72:75], v[72:75], v[16:19]
    v_exp_f32 v29, v29
    v_mfma_f32_16x16x32_bf16 v[16:19], a[76:79], v[76:79], v[16:19]
    s_waitcnt lgkmcnt(8)
    v_mfma_f32_16x16x32_bf16 v[20:23], a[80:83], v[64:67], v[48:51]
    v_exp_f32 v30, v30
    v_mfma_f32_16x16x32_bf16 v[20:23], a[84:87], v[68:71], v[20:23]
    v_cvt_pk_bf16_f32 v46, v28, v29
    v_add_u32 v2, s48, v2
    v_mfma_f32_16x16x32_bf16 v[20:23], a[88:91], v[72:75], v[20:23]
    v_exp_f32 v31, v31
    v_mfma_f32_16x16x32_bf16 v[20:23], a[92:95], v[76:79], v[20:23]
    s_waitcnt lgkmcnt(4)
    v_mfma_f32_16x16x32_bf16 v[24:27], a[96:99], v[64:67], v[48:51]
    s_sub_u32 s48, 0, s48
    v_exp_f32 v16, v16
    v_mfma_f32_16x16x32_bf16 v[24:27], a[100:103], v[68:71], v[24:27]
    v_cvt_pk_bf16_f32 v47, v30, v31
    v_mfma_f32_16x16x32_bf16 v[24:27], a[104:107], v[72:75], v[24:27]
    v_exp_f32 v17, v17
    v_mfma_f32_16x16x32_bf16 v[24:27], a[108:111], v[76:79], v[24:27]
    s_waitcnt lgkmcnt(0)
    v_mfma_f32_16x16x32_bf16 v[28:31], a[112:115], v[64:67], v[48:51]
    v_exp_f32 v18, v18
    v_mfma_f32_16x16x32_bf16 v[28:31], a[116:119], v[68:71], v[28:31]
    v_cvt_pk_bf16_f32 v32, v16, v17
    v_mfma_f32_16x16x32_bf16 v[28:31], a[120:123], v[72:75], v[28:31]
    v_exp_f32 v19, v19
    v_mfma_f32_16x16x32_bf16 v[28:31], a[124:127], v[76:79], v[28:31]
    s_waitcnt vmcnt(0)
    s_barrier
    v_mfma_f32_16x16x32_bf16 v[224:227], a[128:131], v[40:43], v[224:227]
    v_exp_f32 v20, v20
    v_mfma_f32_16x16x32_bf16 v[224:227], a[132:135], v[44:47], v[224:227]
    ds_read_b64_tr_b16 a[128:129], v2 offset:0
    v_cvt_pk_bf16_f32 v33, v18, v19
    v_mfma_f32_16x16x32_bf16 v[228:231], a[136:139], v[40:43], v[228:231]
    s_add_u32 m0, s47, 0
    v_exp_f32 v21, v21
    v_mfma_f32_16x16x32_bf16 v[228:231], a[140:143], v[44:47], v[228:231]
    s_add_u32 s46, s46, 16384
    buffer_load_dwordx4 v5, s[16:19], s46 offen offset:0 lds
    v_mfma_f32_16x16x32_bf16 v[232:235], a[144:147], v[40:43], v[232:235]
    v_exp_f32 v22, v22
    v_mfma_f32_16x16x32_bf16 v[232:235], a[148:151], v[44:47], v[232:235]
    ds_read_b64_tr_b16 a[130:131], v2 offset:256
    v_cvt_pk_bf16_f32 v34, v20, v21
    v_mfma_f32_16x16x32_bf16 v[236:239], a[152:155], v[40:43], v[236:239]
    s_add_u32 m0, s47, 32
    v_exp_f32 v23, v23
    v_mfma_f32_16x16x32_bf16 v[236:239], a[156:159], v[44:47], v[236:239]
    buffer_load_dwordx4 v5, s[16:19], s46 offen offset:1024 lds
    v_mfma_f32_16x16x32_bf16 v[240:243], a[160:163], v[40:43], v[240:243]
    v_exp_f32 v24, v24
    v_mfma_f32_16x16x32_bf16 v[240:243], a[164:167], v[44:47], v[240:243]
    ds_read_b64_tr_b16 a[132:133], v2 offset:512
    v_cvt_pk_bf16_f32 v35, v22, v23
    v_mfma_f32_16x16x32_bf16 v[244:247], a[168:171], v[40:43], v[244:247]
    s_add_u32 m0, s47, 64
    v_exp_f32 v25, v25
    v_mfma_f32_16x16x32_bf16 v[244:247], a[172:175], v[44:47], v[244:247]
    buffer_load_dwordx4 v5, s[16:19], s46 offen offset:2048 lds
    v_mfma_f32_16x16x32_bf16 v[248:251], a[176:179], v[40:43], v[248:251]
    v_exp_f32 v26, v26
    v_mfma_f32_16x16x32_bf16 v[248:251], a[180:183], v[44:47], v[248:251]
    ds_read_b64_tr_b16 a[134:135], v2 offset:768
    v_cvt_pk_bf16_f32 v36, v24, v25
    v_mfma_f32_16x16x32_bf16 v[252:255], a[184:187], v[40:43], v[252:255]
    s_add_u32 m0, s47, 96
    v_exp_f32 v27, v27
    v_mfma_f32_16x16x32_bf16 v[252:255], a[188:191], v[44:47], v[252:255]
    buffer_load_dwordx4 v5, s[16:19], s46 offen offset:3072 lds
    v_smfmac_f32_16x16x64_bf16 a[12:15], a[16:19], v[40:47], v11
    ds_read_b64_tr_b16 a[136:137], v2 offset:32
    v_mfma_f32_16x16x32_bf16 v[16:19], a[64:67], v[80:83], v[52:55]
    v_exp_f32 v28, v28
    v_mfma_f32_16x16x32_bf16 v[16:19], a[68:71], v[84:87], v[16:19]
    ds_read_b64_tr_b16 a[138:139], v2 offset:288
    v_cvt_pk_bf16_f32 v37, v26, v27
    v_mfma_f32_16x16x32_bf16 v[16:19], a[72:75], v[88:91], v[16:19]
    s_add_u32 m0, s47, 16896
    v_exp_f32 v29, v29
    v_mfma_f32_16x16x32_bf16 v[16:19], a[76:79], v[92:95], v[16:19]
    buffer_load_dwordx4 v5, s[20:23], s46 offen offset:0 lds
    v_mfma_f32_16x16x32_bf16 v[20:23], a[80:83], v[80:83], v[52:55]
    v_exp_f32 v30, v30
    v_mfma_f32_16x16x32_bf16 v[20:23], a[84:87], v[84:87], v[20:23]
    ds_read_b64_tr_b16 a[140:141], v2 offset:544
    v_cvt_pk_bf16_f32 v38, v28, v29
    v_mfma_f32_16x16x32_bf16 v[20:23], a[88:91], v[88:91], v[20:23]
    s_add_u32 m0, s47, 16928
    v_exp_f32 v31, v31
    v_mfma_f32_16x16x32_bf16 v[20:23], a[92:95], v[92:95], v[20:23]
    buffer_load_dwordx4 v5, s[20:23], s46 offen offset:1024 lds
    v_mfma_f32_16x16x32_bf16 v[24:27], a[96:99], v[80:83], v[52:55]
    v_exp_f32 v16, v16
    v_mfma_f32_16x16x32_bf16 v[24:27], a[100:103], v[84:87], v[24:27]
    ds_read_b64_tr_b16 a[142:143], v2 offset:800
    v_cvt_pk_bf16_f32 v39, v30, v31
    v_mfma_f32_16x16x32_bf16 v[24:27], a[104:107], v[88:91], v[24:27]
    s_add_u32 m0, s47, 16960
    v_exp_f32 v17, v17
    v_mfma_f32_16x16x32_bf16 v[24:27], a[108:111], v[92:95], v[24:27]
    buffer_load_dwordx4 v5, s[20:23], s46 offen offset:2048 lds
    v_mfma_f32_16x16x32_bf16 v[28:31], a[112:115], v[80:83], v[52:55]
    v_exp_f32 v18, v18
    v_mfma_f32_16x16x32_bf16 v[28:31], a[116:119], v[84:87], v[28:31]
    ds_read_b64_tr_b16 a[144:145], v2 offset:64
    v_cvt_pk_bf16_f32 v40, v16, v17
    v_mfma_f32_16x16x32_bf16 v[28:31], a[120:123], v[88:91], v[28:31]
    s_add_u32 m0, s47, 16992
    v_exp_f32 v19, v19
    v_mfma_f32_16x16x32_bf16 v[28:31], a[124:127], v[92:95], v[28:31]
    buffer_load_dwordx4 v5, s[20:23], s46 offen offset:3072 lds
    v_mfma_f32_16x16x32_bf16 v[128:131], a[192:195], v[32:35], v[128:131]
    v_exp_f32 v20, v20
    v_mfma_f32_16x16x32_bf16 v[128:131], a[196:199], v[36:39], v[128:131]
    ds_read_b64_tr_b16 a[146:147], v2 offset:320
    v_cvt_pk_bf16_f32 v41, v18, v19
    v_mfma_f32_16x16x32_bf16 v[132:135], a[200:203], v[32:35], v[132:135]
    s_add_u32 m0, s47, 36864
    v_exp_f32 v21, v21
    v_mfma_f32_16x16x32_bf16 v[132:135], a[204:207], v[36:39], v[132:135]
    s_add_u32 s46, s46, 16384
    buffer_load_dwordx4 v5, s[16:19], s46 offen offset:0 lds
    v_mfma_f32_16x16x32_bf16 v[136:139], a[208:211], v[32:35], v[136:139]
    v_exp_f32 v22, v22
    v_mfma_f32_16x16x32_bf16 v[136:139], a[212:215], v[36:39], v[136:139]
    ds_read_b64_tr_b16 a[148:149], v2 offset:576
    v_cvt_pk_bf16_f32 v42, v20, v21
    v_mfma_f32_16x16x32_bf16 v[140:143], a[216:219], v[32:35], v[140:143]
    s_add_u32 m0, s47, 36896
    v_exp_f32 v23, v23
    v_mfma_f32_16x16x32_bf16 v[140:143], a[220:223], v[36:39], v[140:143]
    buffer_load_dwordx4 v5, s[16:19], s46 offen offset:1024 lds
    v_mfma_f32_16x16x32_bf16 v[144:147], a[224:227], v[32:35], v[144:147]
    v_exp_f32 v24, v24
    v_mfma_f32_16x16x32_bf16 v[144:147], a[228:231], v[36:39], v[144:147]
    ds_read_b64_tr_b16 a[150:151], v2 offset:832
    v_cvt_pk_bf16_f32 v43, v22, v23
    v_mfma_f32_16x16x32_bf16 v[148:151], a[232:235], v[32:35], v[148:151]
    s_add_u32 m0, s47, 36928
    v_exp_f32 v25, v25
    v_mfma_f32_16x16x32_bf16 v[148:151], a[236:239], v[36:39], v[148:151]
    buffer_load_dwordx4 v5, s[16:19], s46 offen offset:2048 lds
    v_mfma_f32_16x16x32_bf16 v[152:155], a[240:243], v[32:35], v[152:155]
    v_exp_f32 v26, v26
    v_mfma_f32_16x16x32_bf16 v[152:155], a[244:247], v[36:39], v[152:155]
    ds_read_b64_tr_b16 a[152:153], v2 offset:96
    v_cvt_pk_bf16_f32 v44, v24, v25
    v_mfma_f32_16x16x32_bf16 v[156:159], a[248:251], v[32:35], v[156:159]
    s_add_u32 m0, s47, 36960
    v_exp_f32 v27, v27
    v_mfma_f32_16x16x32_bf16 v[156:159], a[252:255], v[36:39], v[156:159]
    buffer_load_dwordx4 v5, s[16:19], s46 offen offset:3072 lds
    v_smfmac_f32_16x16x64_bf16 a[0:3], a[16:19], v[32:39], v11
    ds_read_b64_tr_b16 a[154:155], v2 offset:352
    v_mfma_f32_16x16x32_bf16 v[16:19], a[64:67], v[96:99], v[56:59]
    v_exp_f32 v28, v28
    v_mfma_f32_16x16x32_bf16 v[16:19], a[68:71], v[100:103], v[16:19]
    ds_read_b64_tr_b16 a[156:157], v2 offset:608
    v_cvt_pk_bf16_f32 v45, v26, v27
    v_mfma_f32_16x16x32_bf16 v[16:19], a[72:75], v[104:107], v[16:19]
    s_add_u32 m0, s47, 53760
    v_exp_f32 v29, v29
    v_mfma_f32_16x16x32_bf16 v[16:19], a[76:79], v[108:111], v[16:19]
    buffer_load_dwordx4 v5, s[20:23], s46 offen offset:0 lds
    v_mfma_f32_16x16x32_bf16 v[20:23], a[80:83], v[96:99], v[56:59]
    v_exp_f32 v30, v30
    v_mfma_f32_16x16x32_bf16 v[20:23], a[84:87], v[100:103], v[20:23]
    ds_read_b64_tr_b16 a[158:159], v2 offset:864
    v_cvt_pk_bf16_f32 v46, v28, v29
    v_mfma_f32_16x16x32_bf16 v[20:23], a[88:91], v[104:107], v[20:23]
    s_add_u32 m0, s47, 53792
    v_exp_f32 v31, v31
    v_mfma_f32_16x16x32_bf16 v[20:23], a[92:95], v[108:111], v[20:23]
    buffer_load_dwordx4 v5, s[20:23], s46 offen offset:1024 lds
    v_mfma_f32_16x16x32_bf16 v[24:27], a[96:99], v[96:99], v[56:59]
    v_exp_f32 v16, v16
    v_mfma_f32_16x16x32_bf16 v[24:27], a[100:103], v[100:103], v[24:27]
    ds_read_b64_tr_b16 a[160:161], v2 offset:128
    v_cvt_pk_bf16_f32 v47, v30, v31
    v_mfma_f32_16x16x32_bf16 v[24:27], a[104:107], v[104:107], v[24:27]
    s_add_u32 m0, s47, 53824
    v_exp_f32 v17, v17
    v_mfma_f32_16x16x32_bf16 v[24:27], a[108:111], v[108:111], v[24:27]
    buffer_load_dwordx4 v5, s[20:23], s46 offen offset:2048 lds
    v_mfma_f32_16x16x32_bf16 v[28:31], a[112:115], v[96:99], v[56:59]
    v_exp_f32 v18, v18
    v_mfma_f32_16x16x32_bf16 v[28:31], a[116:119], v[100:103], v[28:31]
    ds_read_b64_tr_b16 a[162:163], v2 offset:384
    v_cvt_pk_bf16_f32 v32, v16, v17
    v_mfma_f32_16x16x32_bf16 v[28:31], a[120:123], v[104:107], v[28:31]
    s_add_u32 m0, s47, 53856
    v_exp_f32 v19, v19
    v_mfma_f32_16x16x32_bf16 v[28:31], a[124:127], v[108:111], v[28:31]
    buffer_load_dwordx4 v5, s[20:23], s46 offen offset:3072 lds
    v_mfma_f32_16x16x32_bf16 v[160:163], a[192:195], v[40:43], v[160:163]
    v_exp_f32 v20, v20
    v_mfma_f32_16x16x32_bf16 v[160:163], a[196:199], v[44:47], v[160:163]
    ds_read_b64_tr_b16 a[164:165], v2 offset:640
    v_cvt_pk_bf16_f32 v33, v18, v19
    v_mfma_f32_16x16x32_bf16 v[164:167], a[200:203], v[40:43], v[164:167]
    v_exp_f32 v21, v21
    v_mfma_f32_16x16x32_bf16 v[164:167], a[204:207], v[44:47], v[164:167]
    ds_read_b64_tr_b16 a[166:167], v2 offset:896
    ds_read_b64_tr_b16 a[168:169], v2 offset:160
    v_mfma_f32_16x16x32_bf16 v[168:171], a[208:211], v[40:43], v[168:171]
    v_exp_f32 v22, v22
    v_mfma_f32_16x16x32_bf16 v[168:171], a[212:215], v[44:47], v[168:171]
    ds_read_b64_tr_b16 a[170:171], v2 offset:416
    v_cvt_pk_bf16_f32 v34, v20, v21
    v_mfma_f32_16x16x32_bf16 v[172:175], a[216:219], v[40:43], v[172:175]
    v_exp_f32 v23, v23
    v_mfma_f32_16x16x32_bf16 v[172:175], a[220:223], v[44:47], v[172:175]
    ds_read_b64_tr_b16 a[172:173], v2 offset:672
    ds_read_b64_tr_b16 a[174:175], v2 offset:928
    v_mfma_f32_16x16x32_bf16 v[176:179], a[224:227], v[40:43], v[176:179]
    v_exp_f32 v24, v24
    v_mfma_f32_16x16x32_bf16 v[176:179], a[228:231], v[44:47], v[176:179]
    ds_read_b64_tr_b16 a[176:177], v2 offset:192
    v_cvt_pk_bf16_f32 v35, v22, v23
    v_mfma_f32_16x16x32_bf16 v[180:183], a[232:235], v[40:43], v[180:183]
    v_exp_f32 v25, v25
    v_mfma_f32_16x16x32_bf16 v[180:183], a[236:239], v[44:47], v[180:183]
    ds_read_b64_tr_b16 a[178:179], v2 offset:448
    ds_read_b64_tr_b16 a[180:181], v2 offset:704
    v_mfma_f32_16x16x32_bf16 v[184:187], a[240:243], v[40:43], v[184:187]
    v_exp_f32 v26, v26
    v_mfma_f32_16x16x32_bf16 v[184:187], a[244:247], v[44:47], v[184:187]
    ds_read_b64_tr_b16 a[182:183], v2 offset:960
    v_cvt_pk_bf16_f32 v36, v24, v25
    v_mfma_f32_16x16x32_bf16 v[188:191], a[248:251], v[40:43], v[188:191]
    v_exp_f32 v27, v27
    v_mfma_f32_16x16x32_bf16 v[188:191], a[252:255], v[44:47], v[188:191]
    ds_read_b64_tr_b16 a[184:185], v2 offset:224
    ds_read_b64_tr_b16 a[186:187], v2 offset:480
    v_smfmac_f32_16x16x64_bf16 a[4:7], a[16:19], v[40:47], v11
    ds_read_b64_tr_b16 a[188:189], v2 offset:736
    ds_read_b64_tr_b16 a[190:191], v2 offset:992
    v_mfma_f32_16x16x32_bf16 v[16:19], a[64:67], v[112:115], v[60:63]
    v_exp_f32 v28, v28
    v_mfma_f32_16x16x32_bf16 v[16:19], a[68:71], v[116:119], v[16:19]
    ds_read_b128 a[64:67], v1 offset:0
    v_cvt_pk_bf16_f32 v37, v26, v27
    v_mfma_f32_16x16x32_bf16 v[16:19], a[72:75], v[120:123], v[16:19]
    v_exp_f32 v29, v29
    v_mfma_f32_16x16x32_bf16 v[16:19], a[76:79], v[124:127], v[16:19]
    ds_read_b128 a[68:71], v1 offset:64
    v_mfma_f32_16x16x32_bf16 v[20:23], a[80:83], v[112:115], v[60:63]
    v_exp_f32 v30, v30
    v_mfma_f32_16x16x32_bf16 v[20:23], a[84:87], v[116:119], v[20:23]
    ds_read_b128 a[72:75], v1 offset:128
    v_cvt_pk_bf16_f32 v38, v28, v29
    v_mfma_f32_16x16x32_bf16 v[20:23], a[88:91], v[120:123], v[20:23]
    v_exp_f32 v31, v31
    v_mfma_f32_16x16x32_bf16 v[20:23], a[92:95], v[124:127], v[20:23]
    ds_read_b128 a[76:79], v1 offset:192
    v_mfma_f32_16x16x32_bf16 v[24:27], a[96:99], v[112:115], v[60:63]
    v_exp_f32 v16, v16
    v_mfma_f32_16x16x32_bf16 v[24:27], a[100:103], v[116:119], v[24:27]
    ds_read_b128 a[80:83], v1 offset:256
    v_cvt_pk_bf16_f32 v39, v30, v31
    v_mfma_f32_16x16x32_bf16 v[24:27], a[104:107], v[120:123], v[24:27]
    v_exp_f32 v17, v17
    v_mfma_f32_16x16x32_bf16 v[24:27], a[108:111], v[124:127], v[24:27]
    ds_read_b128 a[84:87], v1 offset:320
    v_mfma_f32_16x16x32_bf16 v[28:31], a[112:115], v[112:115], v[60:63]
    v_exp_f32 v18, v18
    v_mfma_f32_16x16x32_bf16 v[28:31], a[116:119], v[116:119], v[28:31]
    ds_read_b128 a[88:91], v1 offset:384
    v_cvt_pk_bf16_f32 v40, v16, v17
    v_mfma_f32_16x16x32_bf16 v[28:31], a[120:123], v[120:123], v[28:31]
    v_exp_f32 v19, v19
    v_mfma_f32_16x16x32_bf16 v[28:31], a[124:127], v[124:127], v[28:31]
    ds_read_b128 a[92:95], v1 offset:448
    v_mfma_f32_16x16x32_bf16 v[192:195], a[192:195], v[32:35], v[192:195]
    v_exp_f32 v20, v20
    v_mfma_f32_16x16x32_bf16 v[192:195], a[196:199], v[36:39], v[192:195]
    ds_read_b128 a[96:99], v1 offset:512
    v_cvt_pk_bf16_f32 v41, v18, v19
    v_mfma_f32_16x16x32_bf16 v[196:199], a[200:203], v[32:35], v[196:199]
    v_exp_f32 v21, v21
    v_mfma_f32_16x16x32_bf16 v[196:199], a[204:207], v[36:39], v[196:199]
    ds_read_b128 a[100:103], v1 offset:576
    v_mfma_f32_16x16x32_bf16 v[200:203], a[208:211], v[32:35], v[200:203]
    v_exp_f32 v22, v22
    v_mfma_f32_16x16x32_bf16 v[200:203], a[212:215], v[36:39], v[200:203]
    ds_read_b128 a[104:107], v1 offset:640
    v_cvt_pk_bf16_f32 v42, v20, v21
    v_mfma_f32_16x16x32_bf16 v[204:207], a[216:219], v[32:35], v[204:207]
    v_exp_f32 v23, v23
    v_mfma_f32_16x16x32_bf16 v[204:207], a[220:223], v[36:39], v[204:207]
    ds_read_b128 a[108:111], v1 offset:704
    v_mfma_f32_16x16x32_bf16 v[208:211], a[224:227], v[32:35], v[208:211]
    v_exp_f32 v24, v24
    v_mfma_f32_16x16x32_bf16 v[208:211], a[228:231], v[36:39], v[208:211]
    ds_read_b128 a[112:115], v1 offset:768
    v_cvt_pk_bf16_f32 v43, v22, v23
    v_mfma_f32_16x16x32_bf16 v[212:215], a[232:235], v[32:35], v[212:215]
    v_exp_f32 v25, v25
    v_mfma_f32_16x16x32_bf16 v[212:215], a[236:239], v[36:39], v[212:215]
    ds_read_b128 a[116:119], v1 offset:832
    v_mfma_f32_16x16x32_bf16 v[216:219], a[240:243], v[32:35], v[216:219]
    v_exp_f32 v26, v26
    v_mfma_f32_16x16x32_bf16 v[216:219], a[244:247], v[36:39], v[216:219]
    ds_read_b128 a[120:123], v1 offset:896
    v_cvt_pk_bf16_f32 v44, v24, v25
    v_mfma_f32_16x16x32_bf16 v[220:223], a[248:251], v[32:35], v[220:223]
    v_exp_f32 v27, v27
    v_mfma_f32_16x16x32_bf16 v[220:223], a[252:255], v[36:39], v[220:223]
    ds_read_b128 a[124:127], v1 offset:960
    v_smfmac_f32_16x16x64_bf16 a[8:11], a[16:19], v[32:39], v11
    s_waitcnt lgkmcnt(12)
    v_mfma_f32_16x16x32_bf16 v[16:19], a[64:67], v[64:67], v[48:51]
    v_exp_f32 v28, v28
    v_mfma_f32_16x16x32_bf16 v[16:19], a[68:71], v[68:71], v[16:19]
    v_cvt_pk_bf16_f32 v45, v26, v27
    v_mfma_f32_16x16x32_bf16 v[16:19], a[72:75], v[72:75], v[16:19]
    v_exp_f32 v29, v29
    v_mfma_f32_16x16x32_bf16 v[16:19], a[76:79], v[76:79], v[16:19]
    s_waitcnt lgkmcnt(8)
    global_load_dword a63, v14, s[10:11]
    v_mfma_f32_16x16x32_bf16 v[20:23], a[80:83], v[64:67], v[48:51]
    v_exp_f32 v30, v30
    v_mfma_f32_16x16x32_bf16 v[20:23], a[84:87], v[68:71], v[20:23]
    v_cvt_pk_bf16_f32 v46, v28, v29
    v_mfma_f32_16x16x32_bf16 v[20:23], a[88:91], v[72:75], v[20:23]
    v_exp_f32 v31, v31
    v_mfma_f32_16x16x32_bf16 v[20:23], a[92:95], v[76:79], v[20:23]
    s_waitcnt lgkmcnt(4)
    v_mfma_f32_16x16x32_bf16 v[24:27], a[96:99], v[64:67], v[48:51]
    v_exp_f32 v16, v16
    v_mfma_f32_16x16x32_bf16 v[24:27], a[100:103], v[68:71], v[24:27]
    v_cvt_pk_bf16_f32 v47, v30, v31
    v_mfma_f32_16x16x32_bf16 v[24:27], a[104:107], v[72:75], v[24:27]
    s_mov_b32 s54, 0
    v_exp_f32 v17, v17
    v_mfma_f32_16x16x32_bf16 v[24:27], a[108:111], v[76:79], v[24:27]
    s_waitcnt lgkmcnt(0)
    buffer_load_dwordx4 a[20:23], v6, s[64:67], s54 offen
    v_mfma_f32_16x16x32_bf16 v[28:31], a[112:115], v[64:67], v[48:51]
    v_exp_f32 v18, v18
    v_mfma_f32_16x16x32_bf16 v[28:31], a[116:119], v[68:71], v[28:31]
    v_cvt_pk_bf16_f32 v32, v16, v17
    v_mfma_f32_16x16x32_bf16 v[28:31], a[120:123], v[72:75], v[28:31]
    v_exp_f32 v19, v19
    v_mfma_f32_16x16x32_bf16 v[28:31], a[124:127], v[76:79], v[28:31]
    v_mfma_f32_16x16x32_bf16 v[224:227], a[192:195], v[40:43], v[224:227]
    v_exp_f32 v20, v20
    v_mfma_f32_16x16x32_bf16 v[224:227], a[196:199], v[44:47], v[224:227]
    ds_read_b64_tr_b16 a[192:193], v2 offset:36864
    v_cvt_pk_bf16_f32 v33, v18, v19
    v_mfma_f32_16x16x32_bf16 v[228:231], a[200:203], v[40:43], v[228:231]
    s_mov_b32 s54, 147456
    v_exp_f32 v21, v21
    v_mfma_f32_16x16x32_bf16 v[228:231], a[204:207], v[44:47], v[228:231]
    buffer_load_dwordx4 a[24:27], v6, s[64:67], s54 offen
    v_mfma_f32_16x16x32_bf16 v[232:235], a[208:211], v[40:43], v[232:235]
    v_exp_f32 v22, v22
    v_mfma_f32_16x16x32_bf16 v[232:235], a[212:215], v[44:47], v[232:235]
    ds_read_b64_tr_b16 a[194:195], v2 offset:37120
    v_cvt_pk_bf16_f32 v34, v20, v21
    v_mfma_f32_16x16x32_bf16 v[236:239], a[216:219], v[40:43], v[236:239]
    v_exp_f32 v23, v23
    v_mfma_f32_16x16x32_bf16 v[236:239], a[220:223], v[44:47], v[236:239]
    ds_read_b64_tr_b16 a[196:197], v2 offset:37376
    v_mfma_f32_16x16x32_bf16 v[240:243], a[224:227], v[40:43], v[240:243]
    v_exp_f32 v24, v24
    v_mfma_f32_16x16x32_bf16 v[240:243], a[228:231], v[44:47], v[240:243]
    ds_read_b64_tr_b16 a[198:199], v2 offset:37632
    v_cvt_pk_bf16_f32 v35, v22, v23
    v_mfma_f32_16x16x32_bf16 v[244:247], a[232:235], v[40:43], v[244:247]
    s_mov_b32 s54, 294912
    v_exp_f32 v25, v25
    v_mfma_f32_16x16x32_bf16 v[244:247], a[236:239], v[44:47], v[244:247]
    buffer_load_dwordx4 a[28:31], v6, s[64:67], s54 offen
    v_mfma_f32_16x16x32_bf16 v[248:251], a[240:243], v[40:43], v[248:251]
    v_exp_f32 v26, v26
    v_mfma_f32_16x16x32_bf16 v[248:251], a[244:247], v[44:47], v[248:251]
    ds_read_b64_tr_b16 a[200:201], v2 offset:36896
    v_cvt_pk_bf16_f32 v36, v24, v25
    v_mfma_f32_16x16x32_bf16 v[252:255], a[248:251], v[40:43], v[252:255]
    v_exp_f32 v27, v27
    v_mfma_f32_16x16x32_bf16 v[252:255], a[252:255], v[44:47], v[252:255]
    ds_read_b64_tr_b16 a[202:203], v2 offset:37152
    v_smfmac_f32_16x16x64_bf16 a[12:15], a[16:19], v[40:47], v11
    ds_read_b64_tr_b16 a[204:205], v2 offset:37408
    v_mfma_f32_16x16x32_bf16 v[16:19], a[64:67], v[80:83], v[52:55]
    v_exp_f32 v28, v28
    v_mfma_f32_16x16x32_bf16 v[16:19], a[68:71], v[84:87], v[16:19]
    ds_read_b64_tr_b16 a[206:207], v2 offset:37664
    v_cvt_pk_bf16_f32 v37, v26, v27
    v_mfma_f32_16x16x32_bf16 v[16:19], a[72:75], v[88:91], v[16:19]
    s_mov_b32 s54, 442368
    v_exp_f32 v29, v29
    v_mfma_f32_16x16x32_bf16 v[16:19], a[76:79], v[92:95], v[16:19]
    buffer_load_dwordx4 a[32:35], v6, s[64:67], s54 offen
    v_mfma_f32_16x16x32_bf16 v[20:23], a[80:83], v[80:83], v[52:55]
    v_exp_f32 v30, v30
    v_mfma_f32_16x16x32_bf16 v[20:23], a[84:87], v[84:87], v[20:23]
    ds_read_b64_tr_b16 a[208:209], v2 offset:36928
    v_cvt_pk_bf16_f32 v38, v28, v29
    v_mfma_f32_16x16x32_bf16 v[20:23], a[88:91], v[88:91], v[20:23]
    v_exp_f32 v31, v31
    v_mfma_f32_16x16x32_bf16 v[20:23], a[92:95], v[92:95], v[20:23]
    ds_read_b64_tr_b16 a[210:211], v2 offset:37184
    v_mfma_f32_16x16x32_bf16 v[24:27], a[96:99], v[80:83], v[52:55]
    v_exp_f32 v16, v16
    v_mfma_f32_16x16x32_bf16 v[24:27], a[100:103], v[84:87], v[24:27]
    ds_read_b64_tr_b16 a[212:213], v2 offset:37440
    v_cvt_pk_bf16_f32 v39, v30, v31
    v_mfma_f32_16x16x32_bf16 v[24:27], a[104:107], v[88:91], v[24:27]
    v_exp_f32 v17, v17
    v_mfma_f32_16x16x32_bf16 v[24:27], a[108:111], v[92:95], v[24:27]
    global_load_dword a63, v15, s[10:11]
    v_mfma_f32_16x16x32_bf16 v[28:31], a[112:115], v[80:83], v[52:55]
    v_exp_f32 v18, v18
    v_mfma_f32_16x16x32_bf16 v[28:31], a[116:119], v[84:87], v[28:31]
    ds_read_b64_tr_b16 a[214:215], v2 offset:37696
    v_cvt_pk_bf16_f32 v40, v16, v17
    v_mfma_f32_16x16x32_bf16 v[28:31], a[120:123], v[88:91], v[28:31]
    v_exp_f32 v19, v19
    v_mfma_f32_16x16x32_bf16 v[28:31], a[124:127], v[92:95], v[28:31]
    ds_read_b64_tr_b16 a[216:217], v2 offset:36960
    v_mfma_f32_16x16x32_bf16 v[128:131], a[128:131], v[32:35], v[128:131]
    v_exp_f32 v20, v20
    v_mfma_f32_16x16x32_bf16 v[128:131], a[132:135], v[36:39], v[128:131]
    ds_read_b64_tr_b16 a[218:219], v2 offset:37216
    v_cvt_pk_bf16_f32 v41, v18, v19
    v_mfma_f32_16x16x32_bf16 v[132:135], a[136:139], v[32:35], v[132:135]
    s_mov_b32 s54, 589824
    v_exp_f32 v21, v21
    v_mfma_f32_16x16x32_bf16 v[132:135], a[140:143], v[36:39], v[132:135]
    buffer_load_dwordx4 a[36:39], v6, s[64:67], s54 offen
    v_mfma_f32_16x16x32_bf16 v[136:139], a[144:147], v[32:35], v[136:139]
    v_exp_f32 v22, v22
    v_mfma_f32_16x16x32_bf16 v[136:139], a[148:151], v[36:39], v[136:139]
    ds_read_b64_tr_b16 a[220:221], v2 offset:37472
    v_cvt_pk_bf16_f32 v42, v20, v21
    v_mfma_f32_16x16x32_bf16 v[140:143], a[152:155], v[32:35], v[140:143]
    v_exp_f32 v23, v23
    v_mfma_f32_16x16x32_bf16 v[140:143], a[156:159], v[36:39], v[140:143]
    ds_read_b64_tr_b16 a[222:223], v2 offset:37728
    v_mfma_f32_16x16x32_bf16 v[144:147], a[160:163], v[32:35], v[144:147]
    v_exp_f32 v24, v24
    v_mfma_f32_16x16x32_bf16 v[144:147], a[164:167], v[36:39], v[144:147]
    ds_read_b64_tr_b16 a[224:225], v2 offset:36992
    v_cvt_pk_bf16_f32 v43, v22, v23
    v_mfma_f32_16x16x32_bf16 v[148:151], a[168:171], v[32:35], v[148:151]
    v_exp_f32 v25, v25
    v_mfma_f32_16x16x32_bf16 v[148:151], a[172:175], v[36:39], v[148:151]
    ds_read_b64_tr_b16 a[226:227], v2 offset:37248
    v_mfma_f32_16x16x32_bf16 v[152:155], a[176:179], v[32:35], v[152:155]
    v_exp_f32 v26, v26
    v_mfma_f32_16x16x32_bf16 v[152:155], a[180:183], v[36:39], v[152:155]
    ds_read_b64_tr_b16 a[228:229], v2 offset:37504
    v_cvt_pk_bf16_f32 v44, v24, v25
    v_mfma_f32_16x16x32_bf16 v[156:159], a[184:187], v[32:35], v[156:159]
    v_exp_f32 v27, v27
    v_mfma_f32_16x16x32_bf16 v[156:159], a[188:191], v[36:39], v[156:159]
    ds_read_b64_tr_b16 a[230:231], v2 offset:37760
    v_smfmac_f32_16x16x64_bf16 a[0:3], a[16:19], v[32:39], v11
    ds_read_b64_tr_b16 a[232:233], v2 offset:37024
    v_mfma_f32_16x16x32_bf16 v[16:19], a[64:67], v[96:99], v[56:59]
    v_exp_f32 v28, v28
    v_mfma_f32_16x16x32_bf16 v[16:19], a[68:71], v[100:103], v[16:19]
    ds_read_b64_tr_b16 a[234:235], v2 offset:37280
    v_cvt_pk_bf16_f32 v45, v26, v27
    v_mfma_f32_16x16x32_bf16 v[16:19], a[72:75], v[104:107], v[16:19]
    v_exp_f32 v29, v29
    v_mfma_f32_16x16x32_bf16 v[16:19], a[76:79], v[108:111], v[16:19]
    ds_read_b64_tr_b16 a[236:237], v2 offset:37536
    v_mfma_f32_16x16x32_bf16 v[20:23], a[80:83], v[96:99], v[56:59]
    v_exp_f32 v30, v30
    v_mfma_f32_16x16x32_bf16 v[20:23], a[84:87], v[100:103], v[20:23]
    ds_read_b64_tr_b16 a[238:239], v2 offset:37792
    v_cvt_pk_bf16_f32 v46, v28, v29
    v_mfma_f32_16x16x32_bf16 v[20:23], a[88:91], v[104:107], v[20:23]
    v_exp_f32 v31, v31
    v_mfma_f32_16x16x32_bf16 v[20:23], a[92:95], v[108:111], v[20:23]
    ds_read_b64_tr_b16 a[240:241], v2 offset:37056
    v_mfma_f32_16x16x32_bf16 v[24:27], a[96:99], v[96:99], v[56:59]
    v_exp_f32 v16, v16
    v_mfma_f32_16x16x32_bf16 v[24:27], a[100:103], v[100:103], v[24:27]
    ds_read_b64_tr_b16 a[242:243], v2 offset:37312
    v_cvt_pk_bf16_f32 v47, v30, v31
    v_mfma_f32_16x16x32_bf16 v[24:27], a[104:107], v[104:107], v[24:27]
    v_exp_f32 v17, v17
    v_mfma_f32_16x16x32_bf16 v[24:27], a[108:111], v[108:111], v[24:27]
    ds_read_b64_tr_b16 a[244:245], v2 offset:37568
    v_mfma_f32_16x16x32_bf16 v[28:31], a[112:115], v[96:99], v[56:59]
    v_exp_f32 v18, v18
    v_mfma_f32_16x16x32_bf16 v[28:31], a[116:119], v[100:103], v[28:31]
    ds_read_b64_tr_b16 a[246:247], v2 offset:37824
    v_cvt_pk_bf16_f32 v32, v16, v17
    v_mfma_f32_16x16x32_bf16 v[28:31], a[120:123], v[104:107], v[28:31]
    v_exp_f32 v19, v19
    v_mfma_f32_16x16x32_bf16 v[28:31], a[124:127], v[108:111], v[28:31]
    ds_read_b64_tr_b16 a[248:249], v2 offset:37088
    v_mfma_f32_16x16x32_bf16 v[160:163], a[128:131], v[40:43], v[160:163]
    v_exp_f32 v20, v20
    v_mfma_f32_16x16x32_bf16 v[160:163], a[132:135], v[44:47], v[160:163]
    ds_read_b64_tr_b16 a[250:251], v2 offset:37344
    v_cvt_pk_bf16_f32 v33, v18, v19
    v_mfma_f32_16x16x32_bf16 v[164:167], a[136:139], v[40:43], v[164:167]
    v_exp_f32 v21, v21
    v_mfma_f32_16x16x32_bf16 v[164:167], a[140:143], v[44:47], v[164:167]
    ds_read_b64_tr_b16 a[252:253], v2 offset:37600
    v_mfma_f32_16x16x32_bf16 v[168:171], a[144:147], v[40:43], v[168:171]
    v_exp_f32 v22, v22
    v_mfma_f32_16x16x32_bf16 v[168:171], a[148:151], v[44:47], v[168:171]
    ds_read_b64_tr_b16 a[254:255], v2 offset:37856
    v_cvt_pk_bf16_f32 v34, v20, v21
    v_mfma_f32_16x16x32_bf16 v[172:175], a[152:155], v[40:43], v[172:175]
    v_exp_f32 v23, v23
    v_mfma_f32_16x16x32_bf16 v[172:175], a[156:159], v[44:47], v[172:175]
    v_mfma_f32_16x16x32_bf16 v[176:179], a[160:163], v[40:43], v[176:179]
    v_exp_f32 v24, v24
    v_mfma_f32_16x16x32_bf16 v[176:179], a[164:167], v[44:47], v[176:179]
    v_cvt_pk_bf16_f32 v35, v22, v23
    v_mfma_f32_16x16x32_bf16 v[180:183], a[168:171], v[40:43], v[180:183]
    v_exp_f32 v25, v25
    v_mfma_f32_16x16x32_bf16 v[180:183], a[172:175], v[44:47], v[180:183]
    v_mfma_f32_16x16x32_bf16 v[184:187], a[176:179], v[40:43], v[184:187]
    v_exp_f32 v26, v26
    v_mfma_f32_16x16x32_bf16 v[184:187], a[180:183], v[44:47], v[184:187]
    v_cvt_pk_bf16_f32 v36, v24, v25
    v_mfma_f32_16x16x32_bf16 v[188:191], a[184:187], v[40:43], v[188:191]
    v_exp_f32 v27, v27
    v_mfma_f32_16x16x32_bf16 v[188:191], a[188:191], v[44:47], v[188:191]
    v_smfmac_f32_16x16x64_bf16 a[4:7], a[16:19], v[40:47], v11
    v_mfma_f32_16x16x32_bf16 v[16:19], a[64:67], v[112:115], v[60:63]
    v_exp_f32 v28, v28
    v_mfma_f32_16x16x32_bf16 v[16:19], a[68:71], v[116:119], v[16:19]
    ds_read_b128 a[64:67], v1 offset:36864
    v_cvt_pk_bf16_f32 v37, v26, v27
    v_mfma_f32_16x16x32_bf16 v[16:19], a[72:75], v[120:123], v[16:19]
    v_exp_f32 v29, v29
    v_mfma_f32_16x16x32_bf16 v[16:19], a[76:79], v[124:127], v[16:19]
    ds_read_b128 a[68:71], v1 offset:36928
    v_mfma_f32_16x16x32_bf16 v[20:23], a[80:83], v[112:115], v[60:63]
    v_exp_f32 v30, v30
    v_mfma_f32_16x16x32_bf16 v[20:23], a[84:87], v[116:119], v[20:23]
    ds_read_b128 a[72:75], v1 offset:36992
    v_cvt_pk_bf16_f32 v38, v28, v29
    v_mfma_f32_16x16x32_bf16 v[20:23], a[88:91], v[120:123], v[20:23]
    v_exp_f32 v31, v31
    v_mfma_f32_16x16x32_bf16 v[20:23], a[92:95], v[124:127], v[20:23]
    ds_read_b128 a[76:79], v1 offset:37056
    v_mfma_f32_16x16x32_bf16 v[24:27], a[96:99], v[112:115], v[60:63]
    v_exp_f32 v16, v16
    v_mfma_f32_16x16x32_bf16 v[24:27], a[100:103], v[116:119], v[24:27]
    ds_read_b128 a[80:83], v1 offset:37120
    v_cvt_pk_bf16_f32 v39, v30, v31
    v_mfma_f32_16x16x32_bf16 v[24:27], a[104:107], v[120:123], v[24:27]
    v_exp_f32 v17, v17
    v_mfma_f32_16x16x32_bf16 v[24:27], a[108:111], v[124:127], v[24:27]
    ds_read_b128 a[84:87], v1 offset:37184
    v_mfma_f32_16x16x32_bf16 v[28:31], a[112:115], v[112:115], v[60:63]
    v_exp_f32 v18, v18
    v_mfma_f32_16x16x32_bf16 v[28:31], a[116:119], v[116:119], v[28:31]
    ds_read_b128 a[88:91], v1 offset:37248
    v_cvt_pk_bf16_f32 v40, v16, v17
    v_mfma_f32_16x16x32_bf16 v[28:31], a[120:123], v[120:123], v[28:31]
    v_exp_f32 v19, v19
    v_mfma_f32_16x16x32_bf16 v[28:31], a[124:127], v[124:127], v[28:31]
    ds_read_b128 a[92:95], v1 offset:37312
    v_mfma_f32_16x16x32_bf16 v[192:195], a[128:131], v[32:35], v[192:195]
    v_exp_f32 v20, v20
    v_mfma_f32_16x16x32_bf16 v[192:195], a[132:135], v[36:39], v[192:195]
    ds_read_b128 a[96:99], v1 offset:37376
    v_cvt_pk_bf16_f32 v41, v18, v19
    v_mfma_f32_16x16x32_bf16 v[196:199], a[136:139], v[32:35], v[196:199]
    v_exp_f32 v21, v21
    v_mfma_f32_16x16x32_bf16 v[196:199], a[140:143], v[36:39], v[196:199]
    ds_read_b128 a[100:103], v1 offset:37440
    v_mfma_f32_16x16x32_bf16 v[200:203], a[144:147], v[32:35], v[200:203]
L2_pad6:
    s_cbranch_execz L2_pad10
    v_exp_f32 v22, v22
    v_mfma_f32_16x16x32_bf16 v[200:203], a[148:151], v[36:39], v[200:203]
    ds_read_b128 a[104:107], v1 offset:37504
    v_cvt_pk_bf16_f32 v42, v20, v21
    v_mfma_f32_16x16x32_bf16 v[204:207], a[152:155], v[32:35], v[204:207]
    v_exp_f32 v23, v23
    v_mfma_f32_16x16x32_bf16 v[204:207], a[156:159], v[36:39], v[204:207]
    ds_read_b128 a[108:111], v1 offset:37568
    v_mfma_f32_16x16x32_bf16 v[208:211], a[160:163], v[32:35], v[208:211]
    v_exp_f32 v24, v24
    v_mfma_f32_16x16x32_bf16 v[208:211], a[164:167], v[36:39], v[208:211]
    ds_read_b128 a[112:115], v1 offset:37632
    v_cvt_pk_bf16_f32 v43, v22, v23
    v_mfma_f32_16x16x32_bf16 v[212:215], a[168:171], v[32:35], v[212:215]
    v_exp_f32 v25, v25
    v_mfma_f32_16x16x32_bf16 v[212:215], a[172:175], v[36:39], v[212:215]
    ds_read_b128 a[116:119], v1 offset:37696
    v_mfma_f32_16x16x32_bf16 v[216:219], a[176:179], v[32:35], v[216:219]
    v_exp_f32 v26, v26
    v_mfma_f32_16x16x32_bf16 v[216:219], a[180:183], v[36:39], v[216:219]
    ds_read_b128 a[120:123], v1 offset:37760
    v_cvt_pk_bf16_f32 v44, v24, v25
    v_mfma_f32_16x16x32_bf16 v[220:223], a[184:187], v[32:35], v[220:223]
    v_exp_f32 v27, v27
    v_mfma_f32_16x16x32_bf16 v[220:223], a[188:191], v[36:39], v[220:223]
    ds_read_b128 a[124:127], v1 offset:37824
    v_smfmac_f32_16x16x64_bf16 a[8:11], a[16:19], v[32:39], v11
    s_waitcnt lgkmcnt(12)
    v_mfma_f32_16x16x32_bf16 v[16:19], a[64:67], v[64:67], v[48:51]
    s_sub_u32 s47, s47, s48
    v_exp_f32 v28, v28
    v_mfma_f32_16x16x32_bf16 v[16:19], a[68:71], v[68:71], v[16:19]
    v_cvt_pk_bf16_f32 v45, v26, v27
    v_add_u32 v1, s48, v1
    v_mfma_f32_16x16x32_bf16 v[16:19], a[72:75], v[72:75], v[16:19]
    v_exp_f32 v29, v29
    v_mfma_f32_16x16x32_bf16 v[16:19], a[76:79], v[76:79], v[16:19]
    s_waitcnt lgkmcnt(8)
    v_mfma_f32_16x16x32_bf16 v[20:23], a[80:83], v[64:67], v[48:51]
    v_exp_f32 v30, v30
    v_mfma_f32_16x16x32_bf16 v[20:23], a[84:87], v[68:71], v[20:23]
    v_cvt_pk_bf16_f32 v46, v28, v29
    v_add_u32 v2, s48, v2
    v_mfma_f32_16x16x32_bf16 v[20:23], a[88:91], v[72:75], v[20:23]
    v_exp_f32 v31, v31
    v_mfma_f32_16x16x32_bf16 v[20:23], a[92:95], v[76:79], v[20:23]
    s_waitcnt lgkmcnt(4)
    v_mfma_f32_16x16x32_bf16 v[24:27], a[96:99], v[64:67], v[48:51]
    s_sub_u32 s48, 0, s48
    v_exp_f32 v16, v16
    v_mfma_f32_16x16x32_bf16 v[24:27], a[100:103], v[68:71], v[24:27]
    v_cvt_pk_bf16_f32 v47, v30, v31
    v_mfma_f32_16x16x32_bf16 v[24:27], a[104:107], v[72:75], v[24:27]
    v_exp_f32 v17, v17
    v_mfma_f32_16x16x32_bf16 v[24:27], a[108:111], v[76:79], v[24:27]
    s_waitcnt lgkmcnt(0)
    v_mfma_f32_16x16x32_bf16 v[28:31], a[112:115], v[64:67], v[48:51]
    v_exp_f32 v18, v18
    v_mfma_f32_16x16x32_bf16 v[28:31], a[116:119], v[68:71], v[28:31]
    v_cvt_pk_bf16_f32 v32, v16, v17
    v_mfma_f32_16x16x32_bf16 v[28:31], a[120:123], v[72:75], v[28:31]
    v_exp_f32 v19, v19
    v_mfma_f32_16x16x32_bf16 v[28:31], a[124:127], v[76:79], v[28:31]
    s_waitcnt vmcnt(7)
    s_barrier
    v_mfma_f32_16x16x32_bf16 v[224:227], a[128:131], v[40:43], v[224:227]
    v_exp_f32 v20, v20
    v_mfma_f32_16x16x32_bf16 v[224:227], a[132:135], v[44:47], v[224:227]
    ds_read_b64_tr_b16 a[128:129], v2 offset:0
    v_cvt_pk_bf16_f32 v33, v18, v19
    v_mfma_f32_16x16x32_bf16 v[228:231], a[136:139], v[40:43], v[228:231]
    s_add_u32 m0, s47, 0
    v_exp_f32 v21, v21
    v_mfma_f32_16x16x32_bf16 v[228:231], a[140:143], v[44:47], v[228:231]
    s_add_u32 s46, s46, 16384
    buffer_load_dwordx4 v5, s[16:19], s46 offen offset:0 lds
    v_mfma_f32_16x16x32_bf16 v[232:235], a[144:147], v[40:43], v[232:235]
    v_exp_f32 v22, v22
    v_mfma_f32_16x16x32_bf16 v[232:235], a[148:151], v[44:47], v[232:235]
    ds_read_b64_tr_b16 a[130:131], v2 offset:256
    v_cvt_pk_bf16_f32 v34, v20, v21
    v_mfma_f32_16x16x32_bf16 v[236:239], a[152:155], v[40:43], v[236:239]
    s_add_u32 m0, s47, 32
    v_exp_f32 v23, v23
    v_mfma_f32_16x16x32_bf16 v[236:239], a[156:159], v[44:47], v[236:239]
    buffer_load_dwordx4 v5, s[16:19], s46 offen offset:1024 lds
    v_mfma_f32_16x16x32_bf16 v[240:243], a[160:163], v[40:43], v[240:243]
    v_exp_f32 v24, v24
    v_mfma_f32_16x16x32_bf16 v[240:243], a[164:167], v[44:47], v[240:243]
    ds_read_b64_tr_b16 a[132:133], v2 offset:512
    v_cvt_pk_bf16_f32 v35, v22, v23
    v_mfma_f32_16x16x32_bf16 v[244:247], a[168:171], v[40:43], v[244:247]
    s_add_u32 m0, s47, 64
    v_exp_f32 v25, v25
    v_mfma_f32_16x16x32_bf16 v[244:247], a[172:175], v[44:47], v[244:247]
    buffer_load_dwordx4 v5, s[16:19], s46 offen offset:2048 lds
    v_mfma_f32_16x16x32_bf16 v[248:251], a[176:179], v[40:43], v[248:251]
    v_exp_f32 v26, v26
    v_mfma_f32_16x16x32_bf16 v[248:251], a[180:183], v[44:47], v[248:251]
    ds_read_b64_tr_b16 a[134:135], v2 offset:768
    v_cvt_pk_bf16_f32 v36, v24, v25
    v_mfma_f32_16x16x32_bf16 v[252:255], a[184:187], v[40:43], v[252:255]
    s_add_u32 m0, s47, 96
    v_exp_f32 v27, v27
    v_mfma_f32_16x16x32_bf16 v[252:255], a[188:191], v[44:47], v[252:255]
    buffer_load_dwordx4 v5, s[16:19], s46 offen offset:3072 lds
    v_smfmac_f32_16x16x64_bf16 a[12:15], a[16:19], v[40:47], v11
    ds_read_b64_tr_b16 a[136:137], v2 offset:32
    v_mfma_f32_16x16x32_bf16 v[16:19], a[64:67], v[80:83], v[52:55]
    v_exp_f32 v28, v28
    v_mfma_f32_16x16x32_bf16 v[16:19], a[68:71], v[84:87], v[16:19]
    ds_read_b64_tr_b16 a[138:139], v2 offset:288
    v_cvt_pk_bf16_f32 v37, v26, v27
    v_mfma_f32_16x16x32_bf16 v[16:19], a[72:75], v[88:91], v[16:19]
    s_add_u32 m0, s47, 16896
    v_exp_f32 v29, v29
    v_mfma_f32_16x16x32_bf16 v[16:19], a[76:79], v[92:95], v[16:19]
    buffer_load_dwordx4 v5, s[20:23], s46 offen offset:0 lds
    v_mfma_f32_16x16x32_bf16 v[20:23], a[80:83], v[80:83], v[52:55]
    v_exp_f32 v30, v30
    v_mfma_f32_16x16x32_bf16 v[20:23], a[84:87], v[84:87], v[20:23]
    ds_read_b64_tr_b16 a[140:141], v2 offset:544
    v_cvt_pk_bf16_f32 v38, v28, v29
    v_mfma_f32_16x16x32_bf16 v[20:23], a[88:91], v[88:91], v[20:23]
    s_add_u32 m0, s47, 16928
    v_exp_f32 v31, v31
    v_mfma_f32_16x16x32_bf16 v[20:23], a[92:95], v[92:95], v[20:23]
    buffer_load_dwordx4 v5, s[20:23], s46 offen offset:1024 lds
    v_mfma_f32_16x16x32_bf16 v[24:27], a[96:99], v[80:83], v[52:55]
    v_exp_f32 v16, v16
    v_mfma_f32_16x16x32_bf16 v[24:27], a[100:103], v[84:87], v[24:27]
    ds_read_b64_tr_b16 a[142:143], v2 offset:800
    v_cvt_pk_bf16_f32 v39, v30, v31
    v_mfma_f32_16x16x32_bf16 v[24:27], a[104:107], v[88:91], v[24:27]
    s_add_u32 m0, s47, 16960
    v_exp_f32 v17, v17
    v_mfma_f32_16x16x32_bf16 v[24:27], a[108:111], v[92:95], v[24:27]
    buffer_load_dwordx4 v5, s[20:23], s46 offen offset:2048 lds
    v_mfma_f32_16x16x32_bf16 v[28:31], a[112:115], v[80:83], v[52:55]
    v_exp_f32 v18, v18
    v_mfma_f32_16x16x32_bf16 v[28:31], a[116:119], v[84:87], v[28:31]
    ds_read_b64_tr_b16 a[144:145], v2 offset:64
    v_cvt_pk_bf16_f32 v40, v16, v17
    v_mfma_f32_16x16x32_bf16 v[28:31], a[120:123], v[88:91], v[28:31]
    s_add_u32 m0, s47, 16992
    v_exp_f32 v19, v19
    v_mfma_f32_16x16x32_bf16 v[28:31], a[124:127], v[92:95], v[28:31]
    buffer_load_dwordx4 v5, s[20:23], s46 offen offset:3072 lds
    v_mfma_f32_16x16x32_bf16 v[128:131], a[192:195], v[32:35], v[128:131]
    v_exp_f32 v20, v20
    v_mfma_f32_16x16x32_bf16 v[128:131], a[196:199], v[36:39], v[128:131]
    ds_read_b64_tr_b16 a[146:147], v2 offset:320
    v_cvt_pk_bf16_f32 v41, v18, v19
    v_mfma_f32_16x16x32_bf16 v[132:135], a[200:203], v[32:35], v[132:135]
    s_add_u32 m0, s47, 36864
    v_exp_f32 v21, v21
    v_mfma_f32_16x16x32_bf16 v[132:135], a[204:207], v[36:39], v[132:135]
    s_add_u32 s46, s46, 16384
    buffer_load_dwordx4 v5, s[16:19], s46 offen offset:0 lds
    v_mfma_f32_16x16x32_bf16 v[136:139], a[208:211], v[32:35], v[136:139]
    v_exp_f32 v22, v22
    v_mfma_f32_16x16x32_bf16 v[136:139], a[212:215], v[36:39], v[136:139]
    ds_read_b64_tr_b16 a[148:149], v2 offset:576
    v_cvt_pk_bf16_f32 v42, v20, v21
    v_mfma_f32_16x16x32_bf16 v[140:143], a[216:219], v[32:35], v[140:143]
    s_add_u32 m0, s47, 36896
    v_exp_f32 v23, v23
    v_mfma_f32_16x16x32_bf16 v[140:143], a[220:223], v[36:39], v[140:143]
    buffer_load_dwordx4 v5, s[16:19], s46 offen offset:1024 lds
    v_mfma_f32_16x16x32_bf16 v[144:147], a[224:227], v[32:35], v[144:147]
    v_exp_f32 v24, v24
    v_mfma_f32_16x16x32_bf16 v[144:147], a[228:231], v[36:39], v[144:147]
    ds_read_b64_tr_b16 a[150:151], v2 offset:832
    v_cvt_pk_bf16_f32 v43, v22, v23
    v_mfma_f32_16x16x32_bf16 v[148:151], a[232:235], v[32:35], v[148:151]
    s_add_u32 m0, s47, 36928
    v_exp_f32 v25, v25
    v_mfma_f32_16x16x32_bf16 v[148:151], a[236:239], v[36:39], v[148:151]
    buffer_load_dwordx4 v5, s[16:19], s46 offen offset:2048 lds
    v_mfma_f32_16x16x32_bf16 v[152:155], a[240:243], v[32:35], v[152:155]
    v_exp_f32 v26, v26
    v_mfma_f32_16x16x32_bf16 v[152:155], a[244:247], v[36:39], v[152:155]
    ds_read_b64_tr_b16 a[152:153], v2 offset:96
    v_cvt_pk_bf16_f32 v44, v24, v25
    v_mfma_f32_16x16x32_bf16 v[156:159], a[248:251], v[32:35], v[156:159]
    s_add_u32 m0, s47, 36960
    v_exp_f32 v27, v27
    v_mfma_f32_16x16x32_bf16 v[156:159], a[252:255], v[36:39], v[156:159]
    buffer_load_dwordx4 v5, s[16:19], s46 offen offset:3072 lds
    v_smfmac_f32_16x16x64_bf16 a[0:3], a[16:19], v[32:39], v11
    ds_read_b64_tr_b16 a[154:155], v2 offset:352
    v_mfma_f32_16x16x32_bf16 v[16:19], a[64:67], v[96:99], v[56:59]
    v_exp_f32 v28, v28
    v_mfma_f32_16x16x32_bf16 v[16:19], a[68:71], v[100:103], v[16:19]
    ds_read_b64_tr_b16 a[156:157], v2 offset:608
    v_cvt_pk_bf16_f32 v45, v26, v27
    v_mfma_f32_16x16x32_bf16 v[16:19], a[72:75], v[104:107], v[16:19]
    s_add_u32 m0, s47, 53760
    v_exp_f32 v29, v29
    v_mfma_f32_16x16x32_bf16 v[16:19], a[76:79], v[108:111], v[16:19]
    buffer_load_dwordx4 v5, s[20:23], s46 offen offset:0 lds
    v_mfma_f32_16x16x32_bf16 v[20:23], a[80:83], v[96:99], v[56:59]
    v_exp_f32 v30, v30
    v_mfma_f32_16x16x32_bf16 v[20:23], a[84:87], v[100:103], v[20:23]
    ds_read_b64_tr_b16 a[158:159], v2 offset:864
    v_cvt_pk_bf16_f32 v46, v28, v29
    v_mfma_f32_16x16x32_bf16 v[20:23], a[88:91], v[104:107], v[20:23]
    s_add_u32 m0, s47, 53792
    v_exp_f32 v31, v31
    v_mfma_f32_16x16x32_bf16 v[20:23], a[92:95], v[108:111], v[20:23]
    buffer_load_dwordx4 v5, s[20:23], s46 offen offset:1024 lds
    v_mfma_f32_16x16x32_bf16 v[24:27], a[96:99], v[96:99], v[56:59]
    v_exp_f32 v16, v16
    v_mfma_f32_16x16x32_bf16 v[24:27], a[100:103], v[100:103], v[24:27]
    ds_read_b64_tr_b16 a[160:161], v2 offset:128
    v_cvt_pk_bf16_f32 v47, v30, v31
    v_mfma_f32_16x16x32_bf16 v[24:27], a[104:107], v[104:107], v[24:27]
    s_add_u32 m0, s47, 53824
    v_exp_f32 v17, v17
    v_mfma_f32_16x16x32_bf16 v[24:27], a[108:111], v[108:111], v[24:27]
    buffer_load_dwordx4 v5, s[20:23], s46 offen offset:2048 lds
    v_mfma_f32_16x16x32_bf16 v[28:31], a[112:115], v[96:99], v[56:59]
    v_exp_f32 v18, v18
    v_mfma_f32_16x16x32_bf16 v[28:31], a[116:119], v[100:103], v[28:31]
    ds_read_b64_tr_b16 a[162:163], v2 offset:384
    v_cvt_pk_bf16_f32 v32, v16, v17
    v_mfma_f32_16x16x32_bf16 v[28:31], a[120:123], v[104:107], v[28:31]
    s_add_u32 m0, s47, 53856
    v_exp_f32 v19, v19
    v_mfma_f32_16x16x32_bf16 v[28:31], a[124:127], v[108:111], v[28:31]
    buffer_load_dwordx4 v5, s[20:23], s46 offen offset:3072 lds
    v_mfma_f32_16x16x32_bf16 v[160:163], a[192:195], v[40:43], v[160:163]
    v_exp_f32 v20, v20
    v_mfma_f32_16x16x32_bf16 v[160:163], a[196:199], v[44:47], v[160:163]
    ds_read_b64_tr_b16 a[164:165], v2 offset:640
    v_cvt_pk_bf16_f32 v33, v18, v19
    v_mfma_f32_16x16x32_bf16 v[164:167], a[200:203], v[40:43], v[164:167]
    v_exp_f32 v21, v21
    v_mfma_f32_16x16x32_bf16 v[164:167], a[204:207], v[44:47], v[164:167]
    ds_read_b64_tr_b16 a[166:167], v2 offset:896
    ds_read_b64_tr_b16 a[168:169], v2 offset:160
    v_mfma_f32_16x16x32_bf16 v[168:171], a[208:211], v[40:43], v[168:171]
    v_exp_f32 v22, v22
    v_mfma_f32_16x16x32_bf16 v[168:171], a[212:215], v[44:47], v[168:171]
    ds_read_b64_tr_b16 a[170:171], v2 offset:416
    v_cvt_pk_bf16_f32 v34, v20, v21
    v_mfma_f32_16x16x32_bf16 v[172:175], a[216:219], v[40:43], v[172:175]
    v_exp_f32 v23, v23
    v_mfma_f32_16x16x32_bf16 v[172:175], a[220:223], v[44:47], v[172:175]
    ds_read_b64_tr_b16 a[172:173], v2 offset:672
    ds_read_b64_tr_b16 a[174:175], v2 offset:928
    v_mfma_f32_16x16x32_bf16 v[176:179], a[224:227], v[40:43], v[176:179]
    v_exp_f32 v24, v24
    v_mfma_f32_16x16x32_bf16 v[176:179], a[228:231], v[44:47], v[176:179]
    ds_read_b64_tr_b16 a[176:177], v2 offset:192
    v_cvt_pk_bf16_f32 v35, v22, v23
    v_mfma_f32_16x16x32_bf16 v[180:183], a[232:235], v[40:43], v[180:183]
    v_exp_f32 v25, v25
    v_mfma_f32_16x16x32_bf16 v[180:183], a[236:239], v[44:47], v[180:183]
    ds_read_b64_tr_b16 a[178:179], v2 offset:448
    ds_read_b64_tr_b16 a[180:181], v2 offset:704
    v_mfma_f32_16x16x32_bf16 v[184:187], a[240:243], v[40:43], v[184:187]
    v_exp_f32 v26, v26
    v_mfma_f32_16x16x32_bf16 v[184:187], a[244:247], v[44:47], v[184:187]
    ds_read_b64_tr_b16 a[182:183], v2 offset:960
    v_cvt_pk_bf16_f32 v36, v24, v25
    v_mfma_f32_16x16x32_bf16 v[188:191], a[248:251], v[40:43], v[188:191]
    v_exp_f32 v27, v27
    v_mfma_f32_16x16x32_bf16 v[188:191], a[252:255], v[44:47], v[188:191]
    ds_read_b64_tr_b16 a[184:185], v2 offset:224
    ds_read_b64_tr_b16 a[186:187], v2 offset:480
    v_smfmac_f32_16x16x64_bf16 a[4:7], a[16:19], v[40:47], v11
    ds_read_b64_tr_b16 a[188:189], v2 offset:736
    ds_read_b64_tr_b16 a[190:191], v2 offset:992
    v_mfma_f32_16x16x32_bf16 v[16:19], a[64:67], v[112:115], v[60:63]
    v_exp_f32 v28, v28
    v_mfma_f32_16x16x32_bf16 v[16:19], a[68:71], v[116:119], v[16:19]
    ds_read_b128 a[64:67], v1 offset:0
    v_cvt_pk_bf16_f32 v37, v26, v27
    v_mfma_f32_16x16x32_bf16 v[16:19], a[72:75], v[120:123], v[16:19]
    v_exp_f32 v29, v29
    v_mfma_f32_16x16x32_bf16 v[16:19], a[76:79], v[124:127], v[16:19]
    ds_read_b128 a[68:71], v1 offset:64
    v_mfma_f32_16x16x32_bf16 v[20:23], a[80:83], v[112:115], v[60:63]
    v_exp_f32 v30, v30
    v_mfma_f32_16x16x32_bf16 v[20:23], a[84:87], v[116:119], v[20:23]
    ds_read_b128 a[72:75], v1 offset:128
    v_cvt_pk_bf16_f32 v38, v28, v29
    v_mfma_f32_16x16x32_bf16 v[20:23], a[88:91], v[120:123], v[20:23]
    v_exp_f32 v31, v31
    v_mfma_f32_16x16x32_bf16 v[20:23], a[92:95], v[124:127], v[20:23]
    ds_read_b128 a[76:79], v1 offset:192
    v_mfma_f32_16x16x32_bf16 v[24:27], a[96:99], v[112:115], v[60:63]
    v_exp_f32 v16, v16
    v_mfma_f32_16x16x32_bf16 v[24:27], a[100:103], v[116:119], v[24:27]
    ds_read_b128 a[80:83], v1 offset:256
    v_cvt_pk_bf16_f32 v39, v30, v31
    v_mfma_f32_16x16x32_bf16 v[24:27], a[104:107], v[120:123], v[24:27]
    v_exp_f32 v17, v17
    v_mfma_f32_16x16x32_bf16 v[24:27], a[108:111], v[124:127], v[24:27]
    ds_read_b128 a[84:87], v1 offset:320
    v_mfma_f32_16x16x32_bf16 v[28:31], a[112:115], v[112:115], v[60:63]
    v_exp_f32 v18, v18
    v_mfma_f32_16x16x32_bf16 v[28:31], a[116:119], v[116:119], v[28:31]
    ds_read_b128 a[88:91], v1 offset:384
    v_cvt_pk_bf16_f32 v40, v16, v17
    v_mfma_f32_16x16x32_bf16 v[28:31], a[120:123], v[120:123], v[28:31]
    v_exp_f32 v19, v19
    v_mfma_f32_16x16x32_bf16 v[28:31], a[124:127], v[124:127], v[28:31]
    ds_read_b128 a[92:95], v1 offset:448
    v_mfma_f32_16x16x32_bf16 v[192:195], a[192:195], v[32:35], v[192:195]
    v_exp_f32 v20, v20
    v_mfma_f32_16x16x32_bf16 v[192:195], a[196:199], v[36:39], v[192:195]
    ds_read_b128 a[96:99], v1 offset:512
    v_cvt_pk_bf16_f32 v41, v18, v19
    v_mfma_f32_16x16x32_bf16 v[196:199], a[200:203], v[32:35], v[196:199]
    v_exp_f32 v21, v21
    v_mfma_f32_16x16x32_bf16 v[196:199], a[204:207], v[36:39], v[196:199]
    ds_read_b128 a[100:103], v1 offset:576
    v_mfma_f32_16x16x32_bf16 v[200:203], a[208:211], v[32:35], v[200:203]
    v_exp_f32 v22, v22
    v_mfma_f32_16x16x32_bf16 v[200:203], a[212:215], v[36:39], v[200:203]
    ds_read_b128 a[104:107], v1 offset:640
    v_cvt_pk_bf16_f32 v42, v20, v21
    v_mfma_f32_16x16x32_bf16 v[204:207], a[216:219], v[32:35], v[204:207]
    v_exp_f32 v23, v23
    v_mfma_f32_16x16x32_bf16 v[204:207], a[220:223], v[36:39], v[204:207]
    ds_read_b128 a[108:111], v1 offset:704
    v_mfma_f32_16x16x32_bf16 v[208:211], a[224:227], v[32:35], v[208:211]
    v_exp_f32 v24, v24
    v_mfma_f32_16x16x32_bf16 v[208:211], a[228:231], v[36:39], v[208:211]
    ds_read_b128 a[112:115], v1 offset:768
    v_cvt_pk_bf16_f32 v43, v22, v23
    v_mfma_f32_16x16x32_bf16 v[212:215], a[232:235], v[32:35], v[212:215]
    v_exp_f32 v25, v25
    v_mfma_f32_16x16x32_bf16 v[212:215], a[236:239], v[36:39], v[212:215]
    ds_read_b128 a[116:119], v1 offset:832
    v_mfma_f32_16x16x32_bf16 v[216:219], a[240:243], v[32:35], v[216:219]
    v_exp_f32 v26, v26
    v_mfma_f32_16x16x32_bf16 v[216:219], a[244:247], v[36:39], v[216:219]
    ds_read_b128 a[120:123], v1 offset:896
    v_cvt_pk_bf16_f32 v44, v24, v25
    v_mfma_f32_16x16x32_bf16 v[220:223], a[248:251], v[32:35], v[220:223]
    v_exp_f32 v27, v27
    v_mfma_f32_16x16x32_bf16 v[220:223], a[252:255], v[36:39], v[220:223]
    ds_read_b128 a[124:127], v1 offset:960
    v_smfmac_f32_16x16x64_bf16 a[8:11], a[16:19], v[32:39], v11
    s_waitcnt lgkmcnt(12)
    v_mfma_f32_16x16x32_bf16 v[16:19], a[64:67], v[64:67], v[48:51]
    v_exp_f32 v28, v28
    v_mfma_f32_16x16x32_bf16 v[16:19], a[68:71], v[68:71], v[16:19]
    v_cvt_pk_bf16_f32 v45, v26, v27
    v_mfma_f32_16x16x32_bf16 v[16:19], a[72:75], v[72:75], v[16:19]
    v_exp_f32 v29, v29
    v_mfma_f32_16x16x32_bf16 v[16:19], a[76:79], v[76:79], v[16:19]
    s_waitcnt lgkmcnt(8)
    global_load_dword a63, v12, s[6:7]
    v_mfma_f32_16x16x32_bf16 v[20:23], a[80:83], v[64:67], v[48:51]
    v_exp_f32 v30, v30
    v_mfma_f32_16x16x32_bf16 v[20:23], a[84:87], v[68:71], v[20:23]
    v_cvt_pk_bf16_f32 v46, v28, v29
    v_mfma_f32_16x16x32_bf16 v[20:23], a[88:91], v[72:75], v[20:23]
    v_exp_f32 v31, v31
    v_mfma_f32_16x16x32_bf16 v[20:23], a[92:95], v[76:79], v[20:23]
    s_waitcnt lgkmcnt(4)
    v_mfma_f32_16x16x32_bf16 v[24:27], a[96:99], v[64:67], v[48:51]
    v_exp_f32 v16, v16
    v_mfma_f32_16x16x32_bf16 v[24:27], a[100:103], v[68:71], v[24:27]
    v_cvt_pk_bf16_f32 v47, v30, v31
    v_mfma_f32_16x16x32_bf16 v[24:27], a[104:107], v[72:75], v[24:27]
    s_mov_b32 s54, 737280
    v_exp_f32 v17, v17
    v_mfma_f32_16x16x32_bf16 v[24:27], a[108:111], v[76:79], v[24:27]
    s_waitcnt lgkmcnt(0)
    buffer_load_dwordx4 a[40:43], v6, s[64:67], s54 offen
    v_mfma_f32_16x16x32_bf16 v[28:31], a[112:115], v[64:67], v[48:51]
    v_exp_f32 v18, v18
    v_mfma_f32_16x16x32_bf16 v[28:31], a[116:119], v[68:71], v[28:31]
    v_cvt_pk_bf16_f32 v32, v16, v17
    v_mfma_f32_16x16x32_bf16 v[28:31], a[120:123], v[72:75], v[28:31]
    v_exp_f32 v19, v19
    v_mfma_f32_16x16x32_bf16 v[28:31], a[124:127], v[76:79], v[28:31]
    v_mfma_f32_16x16x32_bf16 v[224:227], a[192:195], v[40:43], v[224:227]
    v_exp_f32 v20, v20
    v_mfma_f32_16x16x32_bf16 v[224:227], a[196:199], v[44:47], v[224:227]
    ds_read_b64_tr_b16 a[192:193], v2 offset:36864
    v_cvt_pk_bf16_f32 v33, v18, v19
    v_mfma_f32_16x16x32_bf16 v[228:231], a[200:203], v[40:43], v[228:231]
    s_mov_b32 s54, 884736
    v_exp_f32 v21, v21
    v_mfma_f32_16x16x32_bf16 v[228:231], a[204:207], v[44:47], v[228:231]
    buffer_load_dwordx4 a[44:47], v6, s[64:67], s54 offen
    v_mfma_f32_16x16x32_bf16 v[232:235], a[208:211], v[40:43], v[232:235]
    v_exp_f32 v22, v22
    v_mfma_f32_16x16x32_bf16 v[232:235], a[212:215], v[44:47], v[232:235]
    ds_read_b64_tr_b16 a[194:195], v2 offset:37120
    v_cvt_pk_bf16_f32 v34, v20, v21
    v_mfma_f32_16x16x32_bf16 v[236:239], a[216:219], v[40:43], v[236:239]
    v_exp_f32 v23, v23
    v_mfma_f32_16x16x32_bf16 v[236:239], a[220:223], v[44:47], v[236:239]
    ds_read_b64_tr_b16 a[196:197], v2 offset:37376
    v_mfma_f32_16x16x32_bf16 v[240:243], a[224:227], v[40:43], v[240:243]
    v_exp_f32 v24, v24
    v_mfma_f32_16x16x32_bf16 v[240:243], a[228:231], v[44:47], v[240:243]
    ds_read_b64_tr_b16 a[198:199], v2 offset:37632
    v_cvt_pk_bf16_f32 v35, v22, v23
    v_mfma_f32_16x16x32_bf16 v[244:247], a[232:235], v[40:43], v[244:247]
    s_mov_b32 s54, 1032192
    v_exp_f32 v25, v25
    v_mfma_f32_16x16x32_bf16 v[244:247], a[236:239], v[44:47], v[244:247]
    buffer_load_dwordx4 a[48:51], v6, s[64:67], s54 offen
    v_mfma_f32_16x16x32_bf16 v[248:251], a[240:243], v[40:43], v[248:251]
    v_exp_f32 v26, v26
    v_mfma_f32_16x16x32_bf16 v[248:251], a[244:247], v[44:47], v[248:251]
    ds_read_b64_tr_b16 a[200:201], v2 offset:36896
    v_cvt_pk_bf16_f32 v36, v24, v25
    v_mfma_f32_16x16x32_bf16 v[252:255], a[248:251], v[40:43], v[252:255]
    v_exp_f32 v27, v27
    v_mfma_f32_16x16x32_bf16 v[252:255], a[252:255], v[44:47], v[252:255]
    ds_read_b64_tr_b16 a[202:203], v2 offset:37152
    v_smfmac_f32_16x16x64_bf16 a[12:15], a[16:19], v[40:47], v11
    ds_read_b64_tr_b16 a[204:205], v2 offset:37408
    v_mfma_f32_16x16x32_bf16 v[16:19], a[64:67], v[80:83], v[52:55]
    v_exp_f32 v28, v28
    v_mfma_f32_16x16x32_bf16 v[16:19], a[68:71], v[84:87], v[16:19]
    ds_read_b64_tr_b16 a[206:207], v2 offset:37664
    v_cvt_pk_bf16_f32 v37, v26, v27
    v_mfma_f32_16x16x32_bf16 v[16:19], a[72:75], v[88:91], v[16:19]
    s_mov_b32 s54, 1179648
    v_exp_f32 v29, v29
    v_mfma_f32_16x16x32_bf16 v[16:19], a[76:79], v[92:95], v[16:19]
    buffer_load_dwordx4 a[52:55], v6, s[64:67], s54 offen
    v_mfma_f32_16x16x32_bf16 v[20:23], a[80:83], v[80:83], v[52:55]
    v_exp_f32 v30, v30
    v_mfma_f32_16x16x32_bf16 v[20:23], a[84:87], v[84:87], v[20:23]
    ds_read_b64_tr_b16 a[208:209], v2 offset:36928
    v_cvt_pk_bf16_f32 v38, v28, v29
    v_mfma_f32_16x16x32_bf16 v[20:23], a[88:91], v[88:91], v[20:23]
    v_exp_f32 v31, v31
    v_mfma_f32_16x16x32_bf16 v[20:23], a[92:95], v[92:95], v[20:23]
    ds_read_b64_tr_b16 a[210:211], v2 offset:37184
    v_mfma_f32_16x16x32_bf16 v[24:27], a[96:99], v[80:83], v[52:55]
    v_exp_f32 v16, v16
    v_mfma_f32_16x16x32_bf16 v[24:27], a[100:103], v[84:87], v[24:27]
    ds_read_b64_tr_b16 a[212:213], v2 offset:37440
    v_cvt_pk_bf16_f32 v39, v30, v31
    v_mfma_f32_16x16x32_bf16 v[24:27], a[104:107], v[88:91], v[24:27]
    v_exp_f32 v17, v17
    v_mfma_f32_16x16x32_bf16 v[24:27], a[108:111], v[92:95], v[24:27]
    global_load_dword a63, v13, s[8:9]
    v_mfma_f32_16x16x32_bf16 v[28:31], a[112:115], v[80:83], v[52:55]
    v_exp_f32 v18, v18
    v_mfma_f32_16x16x32_bf16 v[28:31], a[116:119], v[84:87], v[28:31]
    ds_read_b64_tr_b16 a[214:215], v2 offset:37696
    v_cvt_pk_bf16_f32 v40, v16, v17
    v_mfma_f32_16x16x32_bf16 v[28:31], a[120:123], v[88:91], v[28:31]
    v_exp_f32 v19, v19
    v_mfma_f32_16x16x32_bf16 v[28:31], a[124:127], v[92:95], v[28:31]
    ds_read_b64_tr_b16 a[216:217], v2 offset:36960
    v_mfma_f32_16x16x32_bf16 v[128:131], a[128:131], v[32:35], v[128:131]
    v_exp_f32 v20, v20
    v_mfma_f32_16x16x32_bf16 v[128:131], a[132:135], v[36:39], v[128:131]
    ds_read_b64_tr_b16 a[218:219], v2 offset:37216
    v_cvt_pk_bf16_f32 v41, v18, v19
    v_mfma_f32_16x16x32_bf16 v[132:135], a[136:139], v[32:35], v[132:135]
    v_exp_f32 v21, v21
    v_mfma_f32_16x16x32_bf16 v[132:135], a[140:143], v[36:39], v[132:135]
    buffer_load_dword a63, v9, s[36:39], 0 offen
    v_mfma_f32_16x16x32_bf16 v[136:139], a[144:147], v[32:35], v[136:139]
    v_exp_f32 v22, v22
    v_mfma_f32_16x16x32_bf16 v[136:139], a[148:151], v[36:39], v[136:139]
    ds_read_b64_tr_b16 a[220:221], v2 offset:37472
    v_cvt_pk_bf16_f32 v42, v20, v21
    v_mfma_f32_16x16x32_bf16 v[140:143], a[152:155], v[32:35], v[140:143]
    v_exp_f32 v23, v23
    v_mfma_f32_16x16x32_bf16 v[140:143], a[156:159], v[36:39], v[140:143]
    ds_read_b64_tr_b16 a[222:223], v2 offset:37728
    v_mfma_f32_16x16x32_bf16 v[144:147], a[160:163], v[32:35], v[144:147]
    v_exp_f32 v24, v24
    v_mfma_f32_16x16x32_bf16 v[144:147], a[164:167], v[36:39], v[144:147]
    ds_read_b64_tr_b16 a[224:225], v2 offset:36992
    v_cvt_pk_bf16_f32 v43, v22, v23
    v_mfma_f32_16x16x32_bf16 v[148:151], a[168:171], v[32:35], v[148:151]
    v_exp_f32 v25, v25
    v_mfma_f32_16x16x32_bf16 v[148:151], a[172:175], v[36:39], v[148:151]
    ds_read_b64_tr_b16 a[226:227], v2 offset:37248
    v_mfma_f32_16x16x32_bf16 v[152:155], a[176:179], v[32:35], v[152:155]
    v_exp_f32 v26, v26
    v_mfma_f32_16x16x32_bf16 v[152:155], a[180:183], v[36:39], v[152:155]
    ds_read_b64_tr_b16 a[228:229], v2 offset:37504
    v_cvt_pk_bf16_f32 v44, v24, v25
    v_mfma_f32_16x16x32_bf16 v[156:159], a[184:187], v[32:35], v[156:159]
    v_exp_f32 v27, v27
    v_mfma_f32_16x16x32_bf16 v[156:159], a[188:191], v[36:39], v[156:159]
    ds_read_b64_tr_b16 a[230:231], v2 offset:37760
    v_smfmac_f32_16x16x64_bf16 a[0:3], a[16:19], v[32:39], v11
    ds_read_b64_tr_b16 a[232:233], v2 offset:37024
    v_mfma_f32_16x16x32_bf16 v[16:19], a[64:67], v[96:99], v[56:59]
    v_exp_f32 v28, v28
    v_mfma_f32_16x16x32_bf16 v[16:19], a[68:71], v[100:103], v[16:19]
    ds_read_b64_tr_b16 a[234:235], v2 offset:37280
    v_cvt_pk_bf16_f32 v45, v26, v27
    v_mfma_f32_16x16x32_bf16 v[16:19], a[72:75], v[104:107], v[16:19]
    v_exp_f32 v29, v29
    v_mfma_f32_16x16x32_bf16 v[16:19], a[76:79], v[108:111], v[16:19]
    ds_read_b64_tr_b16 a[236:237], v2 offset:37536
    v_mfma_f32_16x16x32_bf16 v[20:23], a[80:83], v[96:99], v[56:59]
    v_exp_f32 v30, v30
    v_mfma_f32_16x16x32_bf16 v[20:23], a[84:87], v[100:103], v[20:23]
    ds_read_b64_tr_b16 a[238:239], v2 offset:37792
    v_cvt_pk_bf16_f32 v46, v28, v29
    v_mfma_f32_16x16x32_bf16 v[20:23], a[88:91], v[104:107], v[20:23]
    v_exp_f32 v31, v31
    v_mfma_f32_16x16x32_bf16 v[20:23], a[92:95], v[108:111], v[20:23]
    ds_read_b64_tr_b16 a[240:241], v2 offset:37056
    v_mfma_f32_16x16x32_bf16 v[24:27], a[96:99], v[96:99], v[56:59]
    v_exp_f32 v16, v16
    v_mfma_f32_16x16x32_bf16 v[24:27], a[100:103], v[100:103], v[24:27]
    ds_read_b64_tr_b16 a[242:243], v2 offset:37312
    v_cvt_pk_bf16_f32 v47, v30, v31
    v_mfma_f32_16x16x32_bf16 v[24:27], a[104:107], v[104:107], v[24:27]
    v_exp_f32 v17, v17
    v_mfma_f32_16x16x32_bf16 v[24:27], a[108:111], v[108:111], v[24:27]
    ds_read_b64_tr_b16 a[244:245], v2 offset:37568
    v_mfma_f32_16x16x32_bf16 v[28:31], a[112:115], v[96:99], v[56:59]
    v_exp_f32 v18, v18
    v_mfma_f32_16x16x32_bf16 v[28:31], a[116:119], v[100:103], v[28:31]
    ds_read_b64_tr_b16 a[246:247], v2 offset:37824
    v_cvt_pk_bf16_f32 v32, v16, v17
    v_mfma_f32_16x16x32_bf16 v[28:31], a[120:123], v[104:107], v[28:31]
    v_exp_f32 v19, v19
    v_mfma_f32_16x16x32_bf16 v[28:31], a[124:127], v[108:111], v[28:31]
    ds_read_b64_tr_b16 a[248:249], v2 offset:37088
    v_mfma_f32_16x16x32_bf16 v[160:163], a[128:131], v[40:43], v[160:163]
    v_exp_f32 v20, v20
    v_mfma_f32_16x16x32_bf16 v[160:163], a[132:135], v[44:47], v[160:163]
    ds_read_b64_tr_b16 a[250:251], v2 offset:37344
    v_cvt_pk_bf16_f32 v33, v18, v19
    v_mfma_f32_16x16x32_bf16 v[164:167], a[136:139], v[40:43], v[164:167]
    v_exp_f32 v21, v21
    v_mfma_f32_16x16x32_bf16 v[164:167], a[140:143], v[44:47], v[164:167]
    ds_read_b64_tr_b16 a[252:253], v2 offset:37600
    v_mfma_f32_16x16x32_bf16 v[168:171], a[144:147], v[40:43], v[168:171]
    v_exp_f32 v22, v22
    v_mfma_f32_16x16x32_bf16 v[168:171], a[148:151], v[44:47], v[168:171]
    ds_read_b64_tr_b16 a[254:255], v2 offset:37856
    v_cvt_pk_bf16_f32 v34, v20, v21
    v_mfma_f32_16x16x32_bf16 v[172:175], a[152:155], v[40:43], v[172:175]
    v_exp_f32 v23, v23
    v_mfma_f32_16x16x32_bf16 v[172:175], a[156:159], v[44:47], v[172:175]
    v_mfma_f32_16x16x32_bf16 v[176:179], a[160:163], v[40:43], v[176:179]
    v_exp_f32 v24, v24
    v_mfma_f32_16x16x32_bf16 v[176:179], a[164:167], v[44:47], v[176:179]
    v_cvt_pk_bf16_f32 v35, v22, v23
    v_mfma_f32_16x16x32_bf16 v[180:183], a[168:171], v[40:43], v[180:183]
    v_exp_f32 v25, v25
    v_mfma_f32_16x16x32_bf16 v[180:183], a[172:175], v[44:47], v[180:183]
    v_mfma_f32_16x16x32_bf16 v[184:187], a[176:179], v[40:43], v[184:187]
    v_exp_f32 v26, v26
    v_mfma_f32_16x16x32_bf16 v[184:187], a[180:183], v[44:47], v[184:187]
    v_cvt_pk_bf16_f32 v36, v24, v25
    v_mfma_f32_16x16x32_bf16 v[188:191], a[184:187], v[40:43], v[188:191]
    v_exp_f32 v27, v27
    v_mfma_f32_16x16x32_bf16 v[188:191], a[188:191], v[44:47], v[188:191]
    v_smfmac_f32_16x16x64_bf16 a[4:7], a[16:19], v[40:47], v11
    v_mfma_f32_16x16x32_bf16 v[16:19], a[64:67], v[112:115], v[60:63]
    v_exp_f32 v28, v28
    v_mfma_f32_16x16x32_bf16 v[16:19], a[68:71], v[116:119], v[16:19]
    ds_read_b128 a[64:67], v1 offset:36864
    v_cvt_pk_bf16_f32 v37, v26, v27
    v_mfma_f32_16x16x32_bf16 v[16:19], a[72:75], v[120:123], v[16:19]
    v_exp_f32 v29, v29
    v_mfma_f32_16x16x32_bf16 v[16:19], a[76:79], v[124:127], v[16:19]
    ds_read_b128 a[68:71], v1 offset:36928
    v_mfma_f32_16x16x32_bf16 v[20:23], a[80:83], v[112:115], v[60:63]
    v_exp_f32 v30, v30
    v_mfma_f32_16x16x32_bf16 v[20:23], a[84:87], v[116:119], v[20:23]
    ds_read_b128 a[72:75], v1 offset:36992
    v_cvt_pk_bf16_f32 v38, v28, v29
    v_mfma_f32_16x16x32_bf16 v[20:23], a[88:91], v[120:123], v[20:23]
L2_pad7:
    s_cbranch_execz L2_pad11
    v_exp_f32 v31, v31
    v_mfma_f32_16x16x32_bf16 v[20:23], a[92:95], v[124:127], v[20:23]
    ds_read_b128 a[76:79], v1 offset:37056
    v_mfma_f32_16x16x32_bf16 v[24:27], a[96:99], v[112:115], v[60:63]
    v_exp_f32 v16, v16
    v_mfma_f32_16x16x32_bf16 v[24:27], a[100:103], v[116:119], v[24:27]
    ds_read_b128 a[80:83], v1 offset:37120
    v_cvt_pk_bf16_f32 v39, v30, v31
    v_mfma_f32_16x16x32_bf16 v[24:27], a[104:107], v[120:123], v[24:27]
    v_exp_f32 v17, v17
    v_mfma_f32_16x16x32_bf16 v[24:27], a[108:111], v[124:127], v[24:27]
    ds_read_b128 a[84:87], v1 offset:37184
    v_mfma_f32_16x16x32_bf16 v[28:31], a[112:115], v[112:115], v[60:63]
    v_exp_f32 v18, v18
    v_mfma_f32_16x16x32_bf16 v[28:31], a[116:119], v[116:119], v[28:31]
    ds_read_b128 a[88:91], v1 offset:37248
    v_cvt_pk_bf16_f32 v40, v16, v17
    v_mfma_f32_16x16x32_bf16 v[28:31], a[120:123], v[120:123], v[28:31]
    v_exp_f32 v19, v19
    v_mfma_f32_16x16x32_bf16 v[28:31], a[124:127], v[124:127], v[28:31]
    ds_read_b128 a[92:95], v1 offset:37312
    v_mfma_f32_16x16x32_bf16 v[192:195], a[128:131], v[32:35], v[192:195]
    v_exp_f32 v20, v20
    v_mfma_f32_16x16x32_bf16 v[192:195], a[132:135], v[36:39], v[192:195]
    ds_read_b128 a[96:99], v1 offset:37376
    v_cvt_pk_bf16_f32 v41, v18, v19
    v_mfma_f32_16x16x32_bf16 v[196:199], a[136:139], v[32:35], v[196:199]
    v_exp_f32 v21, v21
    v_mfma_f32_16x16x32_bf16 v[196:199], a[140:143], v[36:39], v[196:199]
    ds_read_b128 a[100:103], v1 offset:37440
    v_mfma_f32_16x16x32_bf16 v[200:203], a[144:147], v[32:35], v[200:203]
    v_exp_f32 v22, v22
    v_mfma_f32_16x16x32_bf16 v[200:203], a[148:151], v[36:39], v[200:203]
    ds_read_b128 a[104:107], v1 offset:37504
    v_cvt_pk_bf16_f32 v42, v20, v21
    v_mfma_f32_16x16x32_bf16 v[204:207], a[152:155], v[32:35], v[204:207]
    v_exp_f32 v23, v23
    v_mfma_f32_16x16x32_bf16 v[204:207], a[156:159], v[36:39], v[204:207]
    ds_read_b128 a[108:111], v1 offset:37568
    v_mfma_f32_16x16x32_bf16 v[208:211], a[160:163], v[32:35], v[208:211]
    v_exp_f32 v24, v24
    v_mfma_f32_16x16x32_bf16 v[208:211], a[164:167], v[36:39], v[208:211]
    ds_read_b128 a[112:115], v1 offset:37632
    v_cvt_pk_bf16_f32 v43, v22, v23
    v_mfma_f32_16x16x32_bf16 v[212:215], a[168:171], v[32:35], v[212:215]
    v_exp_f32 v25, v25
    v_mfma_f32_16x16x32_bf16 v[212:215], a[172:175], v[36:39], v[212:215]
    ds_read_b128 a[116:119], v1 offset:37696
    v_mfma_f32_16x16x32_bf16 v[216:219], a[176:179], v[32:35], v[216:219]
    v_exp_f32 v26, v26
    v_mfma_f32_16x16x32_bf16 v[216:219], a[180:183], v[36:39], v[216:219]
    ds_read_b128 a[120:123], v1 offset:37760
    v_cvt_pk_bf16_f32 v44, v24, v25
    v_mfma_f32_16x16x32_bf16 v[220:223], a[184:187], v[32:35], v[220:223]
    v_exp_f32 v27, v27
    v_mfma_f32_16x16x32_bf16 v[220:223], a[188:191], v[36:39], v[220:223]
    ds_read_b128 a[124:127], v1 offset:37824
    v_smfmac_f32_16x16x64_bf16 a[8:11], a[16:19], v[32:39], v11
    s_waitcnt lgkmcnt(12)
    v_mfma_f32_16x16x32_bf16 v[16:19], a[64:67], v[64:67], v[48:51]
    s_sub_u32 s47, s47, s48
    v_exp_f32 v28, v28
    v_mfma_f32_16x16x32_bf16 v[16:19], a[68:71], v[68:71], v[16:19]
    v_cvt_pk_bf16_f32 v45, v26, v27
    v_add_u32 v1, s48, v1
    v_mfma_f32_16x16x32_bf16 v[16:19], a[72:75], v[72:75], v[16:19]
    v_exp_f32 v29, v29
    v_mfma_f32_16x16x32_bf16 v[16:19], a[76:79], v[76:79], v[16:19]
    s_waitcnt lgkmcnt(8)
    v_mfma_f32_16x16x32_bf16 v[20:23], a[80:83], v[64:67], v[48:51]
    v_exp_f32 v30, v30
    v_mfma_f32_16x16x32_bf16 v[20:23], a[84:87], v[68:71], v[20:23]
    v_cvt_pk_bf16_f32 v46, v28, v29
    v_add_u32 v2, s48, v2
    v_mfma_f32_16x16x32_bf16 v[20:23], a[88:91], v[72:75], v[20:23]
    v_exp_f32 v31, v31
    v_mfma_f32_16x16x32_bf16 v[20:23], a[92:95], v[76:79], v[20:23]
    s_waitcnt lgkmcnt(4)
    v_mfma_f32_16x16x32_bf16 v[24:27], a[96:99], v[64:67], v[48:51]
    s_sub_u32 s48, 0, s48
    v_exp_f32 v16, v16
    v_mfma_f32_16x16x32_bf16 v[24:27], a[100:103], v[68:71], v[24:27]
    v_cvt_pk_bf16_f32 v47, v30, v31
    v_mfma_f32_16x16x32_bf16 v[24:27], a[104:107], v[72:75], v[24:27]
    v_exp_f32 v17, v17
    v_mfma_f32_16x16x32_bf16 v[24:27], a[108:111], v[76:79], v[24:27]
    s_waitcnt lgkmcnt(0)
    v_mfma_f32_16x16x32_bf16 v[28:31], a[112:115], v[64:67], v[48:51]
    v_exp_f32 v18, v18
    v_mfma_f32_16x16x32_bf16 v[28:31], a[116:119], v[68:71], v[28:31]
    v_cvt_pk_bf16_f32 v32, v16, v17
    v_mfma_f32_16x16x32_bf16 v[28:31], a[120:123], v[72:75], v[28:31]
    v_exp_f32 v19, v19
    v_mfma_f32_16x16x32_bf16 v[28:31], a[124:127], v[76:79], v[28:31]
    s_waitcnt vmcnt(7)
    s_barrier
    v_mfma_f32_16x16x32_bf16 v[224:227], a[128:131], v[40:43], v[224:227]
    v_exp_f32 v20, v20
    v_mfma_f32_16x16x32_bf16 v[224:227], a[132:135], v[44:47], v[224:227]
    ds_read_b64_tr_b16 a[128:129], v2 offset:0
    v_cvt_pk_bf16_f32 v33, v18, v19
    v_mfma_f32_16x16x32_bf16 v[228:231], a[136:139], v[40:43], v[228:231]
    s_add_u32 m0, s44, 73728
    v_exp_f32 v21, v21
    v_mfma_f32_16x16x32_bf16 v[228:231], a[140:143], v[44:47], v[228:231]
    s_mov_b32 s45, 0
    buffer_load_dwordx4 v7, s[28:31], s45 offen offset:0 lds
    v_mfma_f32_16x16x32_bf16 v[232:235], a[144:147], v[40:43], v[232:235]
    v_exp_f32 v22, v22
    v_mfma_f32_16x16x32_bf16 v[232:235], a[148:151], v[44:47], v[232:235]
    ds_read_b64_tr_b16 a[130:131], v2 offset:256
    v_cvt_pk_bf16_f32 v34, v20, v21
    v_mfma_f32_16x16x32_bf16 v[236:239], a[152:155], v[40:43], v[236:239]
    s_add_u32 m0, s44, 73632
    v_exp_f32 v23, v23
    v_mfma_f32_16x16x32_bf16 v[236:239], a[156:159], v[44:47], v[236:239]
    buffer_load_dwordx4 v7, s[28:31], s45 offen offset:1152 lds
    v_mfma_f32_16x16x32_bf16 v[240:243], a[160:163], v[40:43], v[240:243]
    v_exp_f32 v24, v24
    v_mfma_f32_16x16x32_bf16 v[240:243], a[164:167], v[44:47], v[240:243]
    ds_read_b64_tr_b16 a[132:133], v2 offset:512
    v_cvt_pk_bf16_f32 v35, v22, v23
    v_mfma_f32_16x16x32_bf16 v[244:247], a[168:171], v[40:43], v[244:247]
    s_add_u32 m0, s44, 73536
    v_exp_f32 v25, v25
    v_mfma_f32_16x16x32_bf16 v[244:247], a[172:175], v[44:47], v[244:247]
    buffer_load_dwordx4 v7, s[28:31], s45 offen offset:2304 lds
    v_mfma_f32_16x16x32_bf16 v[248:251], a[176:179], v[40:43], v[248:251]
    v_exp_f32 v26, v26
    v_mfma_f32_16x16x32_bf16 v[248:251], a[180:183], v[44:47], v[248:251]
    ds_read_b64_tr_b16 a[134:135], v2 offset:768
    v_cvt_pk_bf16_f32 v36, v24, v25
    v_mfma_f32_16x16x32_bf16 v[252:255], a[184:187], v[40:43], v[252:255]
    s_add_u32 m0, s44, 73440
    v_exp_f32 v27, v27
    v_mfma_f32_16x16x32_bf16 v[252:255], a[188:191], v[44:47], v[252:255]
    buffer_load_dwordx4 v7, s[28:31], s45 offen offset:3456 lds
    v_smfmac_f32_16x16x64_bf16 a[12:15], a[16:19], v[40:47], v11
    ds_read_b64_tr_b16 a[136:137], v2 offset:32
    v_mfma_f32_16x16x32_bf16 v[16:19], a[64:67], v[80:83], v[52:55]
    v_exp_f32 v28, v28
    v_mfma_f32_16x16x32_bf16 v[16:19], a[68:71], v[84:87], v[16:19]
    ds_read_b64_tr_b16 a[138:139], v2 offset:288
    v_cvt_pk_bf16_f32 v37, v26, v27
    v_mfma_f32_16x16x32_bf16 v[16:19], a[72:75], v[88:91], v[16:19]
    s_add_u32 m0, s44, 90624
    v_exp_f32 v29, v29
    v_mfma_f32_16x16x32_bf16 v[16:19], a[76:79], v[92:95], v[16:19]
    s_mov_b32 s45, 147456
    buffer_load_dwordx4 v7, s[28:31], s45 offen offset:0 lds
    v_mfma_f32_16x16x32_bf16 v[20:23], a[80:83], v[80:83], v[52:55]
    v_exp_f32 v30, v30
    v_mfma_f32_16x16x32_bf16 v[20:23], a[84:87], v[84:87], v[20:23]
    ds_read_b64_tr_b16 a[140:141], v2 offset:544
    v_cvt_pk_bf16_f32 v38, v28, v29
    v_mfma_f32_16x16x32_bf16 v[20:23], a[88:91], v[88:91], v[20:23]
    s_add_u32 m0, s44, 90528
    v_exp_f32 v31, v31
    v_mfma_f32_16x16x32_bf16 v[20:23], a[92:95], v[92:95], v[20:23]
    buffer_load_dwordx4 v7, s[28:31], s45 offen offset:1152 lds
    v_mfma_f32_16x16x32_bf16 v[24:27], a[96:99], v[80:83], v[52:55]
    v_exp_f32 v16, v16
    v_mfma_f32_16x16x32_bf16 v[24:27], a[100:103], v[84:87], v[24:27]
    ds_read_b64_tr_b16 a[142:143], v2 offset:800
    v_cvt_pk_bf16_f32 v39, v30, v31
    v_mfma_f32_16x16x32_bf16 v[24:27], a[104:107], v[88:91], v[24:27]
    s_add_u32 m0, s44, 90432
    v_exp_f32 v17, v17
    v_mfma_f32_16x16x32_bf16 v[24:27], a[108:111], v[92:95], v[24:27]
    buffer_load_dwordx4 v7, s[28:31], s45 offen offset:2304 lds
    v_mfma_f32_16x16x32_bf16 v[28:31], a[112:115], v[80:83], v[52:55]
    v_exp_f32 v18, v18
    v_mfma_f32_16x16x32_bf16 v[28:31], a[116:119], v[84:87], v[28:31]
    ds_read_b64_tr_b16 a[144:145], v2 offset:64
    v_cvt_pk_bf16_f32 v40, v16, v17
    v_mfma_f32_16x16x32_bf16 v[28:31], a[120:123], v[88:91], v[28:31]
    s_add_u32 m0, s44, 90336
    v_exp_f32 v19, v19
    v_mfma_f32_16x16x32_bf16 v[28:31], a[124:127], v[92:95], v[28:31]
    buffer_load_dwordx4 v7, s[28:31], s45 offen offset:3456 lds
    v_mfma_f32_16x16x32_bf16 v[128:131], a[192:195], v[32:35], v[128:131]
    v_exp_f32 v20, v20
    v_mfma_f32_16x16x32_bf16 v[128:131], a[196:199], v[36:39], v[128:131]
    ds_read_b64_tr_b16 a[146:147], v2 offset:320
    v_cvt_pk_bf16_f32 v41, v18, v19
    v_mfma_f32_16x16x32_bf16 v[132:135], a[200:203], v[32:35], v[132:135]
    s_add_u32 m0, s44, 110592
    v_exp_f32 v21, v21
    v_mfma_f32_16x16x32_bf16 v[132:135], a[204:207], v[36:39], v[132:135]
    s_mov_b32 s45, 128
    buffer_load_dwordx4 v7, s[28:31], s45 offen offset:0 lds
    v_mfma_f32_16x16x32_bf16 v[136:139], a[208:211], v[32:35], v[136:139]
    v_exp_f32 v22, v22
    v_mfma_f32_16x16x32_bf16 v[136:139], a[212:215], v[36:39], v[136:139]
    ds_read_b64_tr_b16 a[148:149], v2 offset:576
    v_cvt_pk_bf16_f32 v42, v20, v21
    v_mfma_f32_16x16x32_bf16 v[140:143], a[216:219], v[32:35], v[140:143]
    s_add_u32 m0, s44, 110496
    v_exp_f32 v23, v23
    v_mfma_f32_16x16x32_bf16 v[140:143], a[220:223], v[36:39], v[140:143]
    buffer_load_dwordx4 v7, s[28:31], s45 offen offset:1152 lds
    v_mfma_f32_16x16x32_bf16 v[144:147], a[224:227], v[32:35], v[144:147]
    v_exp_f32 v24, v24
    v_mfma_f32_16x16x32_bf16 v[144:147], a[228:231], v[36:39], v[144:147]
    ds_read_b64_tr_b16 a[150:151], v2 offset:832
    v_cvt_pk_bf16_f32 v43, v22, v23
    v_mfma_f32_16x16x32_bf16 v[148:151], a[232:235], v[32:35], v[148:151]
    s_add_u32 m0, s44, 110400
    v_exp_f32 v25, v25
    v_mfma_f32_16x16x32_bf16 v[148:151], a[236:239], v[36:39], v[148:151]
    buffer_load_dwordx4 v7, s[28:31], s45 offen offset:2304 lds
    v_mfma_f32_16x16x32_bf16 v[152:155], a[240:243], v[32:35], v[152:155]
    v_exp_f32 v26, v26
    v_mfma_f32_16x16x32_bf16 v[152:155], a[244:247], v[36:39], v[152:155]
    ds_read_b64_tr_b16 a[152:153], v2 offset:96
    v_cvt_pk_bf16_f32 v44, v24, v25
    v_mfma_f32_16x16x32_bf16 v[156:159], a[248:251], v[32:35], v[156:159]
    s_add_u32 m0, s44, 110304
    v_exp_f32 v27, v27
    v_mfma_f32_16x16x32_bf16 v[156:159], a[252:255], v[36:39], v[156:159]
    buffer_load_dwordx4 v7, s[28:31], s45 offen offset:3456 lds
    v_smfmac_f32_16x16x64_bf16 a[0:3], a[16:19], v[32:39], v11
    ds_read_b64_tr_b16 a[154:155], v2 offset:352
    v_mfma_f32_16x16x32_bf16 v[16:19], a[64:67], v[96:99], v[56:59]
    v_exp_f32 v28, v28
    v_mfma_f32_16x16x32_bf16 v[16:19], a[68:71], v[100:103], v[16:19]
    ds_read_b64_tr_b16 a[156:157], v2 offset:608
    v_cvt_pk_bf16_f32 v45, v26, v27
    v_mfma_f32_16x16x32_bf16 v[16:19], a[72:75], v[104:107], v[16:19]
    s_add_u32 m0, s44, 127488
    v_exp_f32 v29, v29
    v_mfma_f32_16x16x32_bf16 v[16:19], a[76:79], v[108:111], v[16:19]
    s_mov_b32 s45, 147584
    buffer_load_dwordx4 v7, s[28:31], s45 offen offset:0 lds
    v_mfma_f32_16x16x32_bf16 v[20:23], a[80:83], v[96:99], v[56:59]
    v_exp_f32 v30, v30
    v_mfma_f32_16x16x32_bf16 v[20:23], a[84:87], v[100:103], v[20:23]
    ds_read_b64_tr_b16 a[158:159], v2 offset:864
    v_cvt_pk_bf16_f32 v46, v28, v29
    v_mfma_f32_16x16x32_bf16 v[20:23], a[88:91], v[104:107], v[20:23]
    s_add_u32 m0, s44, 127392
    v_exp_f32 v31, v31
    v_mfma_f32_16x16x32_bf16 v[20:23], a[92:95], v[108:111], v[20:23]
    buffer_load_dwordx4 v7, s[28:31], s45 offen offset:1152 lds
    v_mfma_f32_16x16x32_bf16 v[24:27], a[96:99], v[96:99], v[56:59]
    v_exp_f32 v16, v16
    v_mfma_f32_16x16x32_bf16 v[24:27], a[100:103], v[100:103], v[24:27]
    ds_read_b64_tr_b16 a[160:161], v2 offset:128
    v_cvt_pk_bf16_f32 v47, v30, v31
    v_mfma_f32_16x16x32_bf16 v[24:27], a[104:107], v[104:107], v[24:27]
    s_add_u32 m0, s44, 127296
    v_exp_f32 v17, v17
    v_mfma_f32_16x16x32_bf16 v[24:27], a[108:111], v[108:111], v[24:27]
    buffer_load_dwordx4 v7, s[28:31], s45 offen offset:2304 lds
    v_mfma_f32_16x16x32_bf16 v[28:31], a[112:115], v[96:99], v[56:59]
    v_exp_f32 v18, v18
    v_mfma_f32_16x16x32_bf16 v[28:31], a[116:119], v[100:103], v[28:31]
    ds_read_b64_tr_b16 a[162:163], v2 offset:384
    v_cvt_pk_bf16_f32 v32, v16, v17
    v_mfma_f32_16x16x32_bf16 v[28:31], a[120:123], v[104:107], v[28:31]
    s_add_u32 m0, s44, 127200
    v_exp_f32 v19, v19
    v_mfma_f32_16x16x32_bf16 v[28:31], a[124:127], v[108:111], v[28:31]
    buffer_load_dwordx4 v7, s[28:31], s45 offen offset:3456 lds
    v_mfma_f32_16x16x32_bf16 v[160:163], a[192:195], v[40:43], v[160:163]
    v_exp_f32 v20, v20
    v_mfma_f32_16x16x32_bf16 v[160:163], a[196:199], v[44:47], v[160:163]
    ds_read_b64_tr_b16 a[164:165], v2 offset:640
    v_cvt_pk_bf16_f32 v33, v18, v19
    v_mfma_f32_16x16x32_bf16 v[164:167], a[200:203], v[40:43], v[164:167]
    v_exp_f32 v21, v21
    v_mfma_f32_16x16x32_bf16 v[164:167], a[204:207], v[44:47], v[164:167]
    ds_read_b64_tr_b16 a[166:167], v2 offset:896
    ds_read_b64_tr_b16 a[168:169], v2 offset:160
    v_mfma_f32_16x16x32_bf16 v[168:171], a[208:211], v[40:43], v[168:171]
    v_exp_f32 v22, v22
    v_mfma_f32_16x16x32_bf16 v[168:171], a[212:215], v[44:47], v[168:171]
    ds_read_b64_tr_b16 a[170:171], v2 offset:416
    v_cvt_pk_bf16_f32 v34, v20, v21
    v_mfma_f32_16x16x32_bf16 v[172:175], a[216:219], v[40:43], v[172:175]
    v_exp_f32 v23, v23
    v_mfma_f32_16x16x32_bf16 v[172:175], a[220:223], v[44:47], v[172:175]
    ds_read_b64_tr_b16 a[172:173], v2 offset:672
    ds_read_b64_tr_b16 a[174:175], v2 offset:928
    v_mfma_f32_16x16x32_bf16 v[176:179], a[224:227], v[40:43], v[176:179]
    v_exp_f32 v24, v24
    v_mfma_f32_16x16x32_bf16 v[176:179], a[228:231], v[44:47], v[176:179]
    ds_read_b64_tr_b16 a[176:177], v2 offset:192
    v_cvt_pk_bf16_f32 v35, v22, v23
    v_mfma_f32_16x16x32_bf16 v[180:183], a[232:235], v[40:43], v[180:183]
    v_exp_f32 v25, v25
    v_mfma_f32_16x16x32_bf16 v[180:183], a[236:239], v[44:47], v[180:183]
    ds_read_b64_tr_b16 a[178:179], v2 offset:448
    ds_read_b64_tr_b16 a[180:181], v2 offset:704
    v_mfma_f32_16x16x32_bf16 v[184:187], a[240:243], v[40:43], v[184:187]
    v_exp_f32 v26, v26
    v_mfma_f32_16x16x32_bf16 v[184:187], a[244:247], v[44:47], v[184:187]
    ds_read_b64_tr_b16 a[182:183], v2 offset:960
    v_cvt_pk_bf16_f32 v36, v24, v25
    v_mfma_f32_16x16x32_bf16 v[188:191], a[248:251], v[40:43], v[188:191]
    v_exp_f32 v27, v27
    v_mfma_f32_16x16x32_bf16 v[188:191], a[252:255], v[44:47], v[188:191]
    ds_read_b64_tr_b16 a[184:185], v2 offset:224
    ds_read_b64_tr_b16 a[186:187], v2 offset:480
    v_smfmac_f32_16x16x64_bf16 a[4:7], a[16:19], v[40:47], v11
    ds_read_b64_tr_b16 a[188:189], v2 offset:736
    ds_read_b64_tr_b16 a[190:191], v2 offset:992
    v_mfma_f32_16x16x32_bf16 v[16:19], a[64:67], v[112:115], v[60:63]
    v_exp_f32 v28, v28
    v_mfma_f32_16x16x32_bf16 v[16:19], a[68:71], v[116:119], v[16:19]
    ds_read_b128 a[64:67], v1 offset:0
    v_cvt_pk_bf16_f32 v37, v26, v27
    v_mfma_f32_16x16x32_bf16 v[16:19], a[72:75], v[120:123], v[16:19]
    v_exp_f32 v29, v29
    v_mfma_f32_16x16x32_bf16 v[16:19], a[76:79], v[124:127], v[16:19]
    ds_read_b128 a[68:71], v1 offset:64
    v_mfma_f32_16x16x32_bf16 v[20:23], a[80:83], v[112:115], v[60:63]
    v_exp_f32 v30, v30
    v_mfma_f32_16x16x32_bf16 v[20:23], a[84:87], v[116:119], v[20:23]
    ds_read_b128 a[72:75], v1 offset:128
    v_cvt_pk_bf16_f32 v38, v28, v29
    v_mfma_f32_16x16x32_bf16 v[20:23], a[88:91], v[120:123], v[20:23]
    v_exp_f32 v31, v31
    v_mfma_f32_16x16x32_bf16 v[20:23], a[92:95], v[124:127], v[20:23]
    ds_read_b128 a[76:79], v1 offset:192
    v_mfma_f32_16x16x32_bf16 v[24:27], a[96:99], v[112:115], v[60:63]
    v_exp_f32 v16, v16
    v_mfma_f32_16x16x32_bf16 v[24:27], a[100:103], v[116:119], v[24:27]
    ds_read_b128 a[80:83], v1 offset:256
    v_cvt_pk_bf16_f32 v39, v30, v31
    v_mfma_f32_16x16x32_bf16 v[24:27], a[104:107], v[120:123], v[24:27]
    v_exp_f32 v17, v17
    v_mfma_f32_16x16x32_bf16 v[24:27], a[108:111], v[124:127], v[24:27]
    ds_read_b128 a[84:87], v1 offset:320
    v_mfma_f32_16x16x32_bf16 v[28:31], a[112:115], v[112:115], v[60:63]
    v_exp_f32 v18, v18
    v_mfma_f32_16x16x32_bf16 v[28:31], a[116:119], v[116:119], v[28:31]
    ds_read_b128 a[88:91], v1 offset:384
    v_cvt_pk_bf16_f32 v40, v16, v17
    v_mfma_f32_16x16x32_bf16 v[28:31], a[120:123], v[120:123], v[28:31]
    v_exp_f32 v19, v19
    v_mfma_f32_16x16x32_bf16 v[28:31], a[124:127], v[124:127], v[28:31]
    ds_read_b128 a[92:95], v1 offset:448
    v_mfma_f32_16x16x32_bf16 v[192:195], a[192:195], v[32:35], v[192:195]
    v_exp_f32 v20, v20
    v_mfma_f32_16x16x32_bf16 v[192:195], a[196:199], v[36:39], v[192:195]
    ds_read_b128 a[96:99], v1 offset:512
    v_cvt_pk_bf16_f32 v41, v18, v19
    v_mfma_f32_16x16x32_bf16 v[196:199], a[200:203], v[32:35], v[196:199]
    v_exp_f32 v21, v21
    v_mfma_f32_16x16x32_bf16 v[196:199], a[204:207], v[36:39], v[196:199]
    ds_read_b128 a[100:103], v1 offset:576
    v_mfma_f32_16x16x32_bf16 v[200:203], a[208:211], v[32:35], v[200:203]
    v_exp_f32 v22, v22
    v_mfma_f32_16x16x32_bf16 v[200:203], a[212:215], v[36:39], v[200:203]
    ds_read_b128 a[104:107], v1 offset:640
    v_cvt_pk_bf16_f32 v42, v20, v21
    v_mfma_f32_16x16x32_bf16 v[204:207], a[216:219], v[32:35], v[204:207]
    v_exp_f32 v23, v23
    v_mfma_f32_16x16x32_bf16 v[204:207], a[220:223], v[36:39], v[204:207]
    ds_read_b128 a[108:111], v1 offset:704
    v_mfma_f32_16x16x32_bf16 v[208:211], a[224:227], v[32:35], v[208:211]
    v_exp_f32 v24, v24
    v_mfma_f32_16x16x32_bf16 v[208:211], a[228:231], v[36:39], v[208:211]
    ds_read_b128 a[112:115], v1 offset:768
    v_cvt_pk_bf16_f32 v43, v22, v23
    v_mfma_f32_16x16x32_bf16 v[212:215], a[232:235], v[32:35], v[212:215]
    v_exp_f32 v25, v25
    v_mfma_f32_16x16x32_bf16 v[212:215], a[236:239], v[36:39], v[212:215]
    ds_read_b128 a[116:119], v1 offset:832
    v_mfma_f32_16x16x32_bf16 v[216:219], a[240:243], v[32:35], v[216:219]
    v_exp_f32 v26, v26
    v_mfma_f32_16x16x32_bf16 v[216:219], a[244:247], v[36:39], v[216:219]
    ds_read_b128 a[120:123], v1 offset:896
    v_cvt_pk_bf16_f32 v44, v24, v25
    v_mfma_f32_16x16x32_bf16 v[220:223], a[248:251], v[32:35], v[220:223]
    v_exp_f32 v27, v27
    v_mfma_f32_16x16x32_bf16 v[220:223], a[252:255], v[36:39], v[220:223]
    ds_read_b128 a[124:127], v1 offset:960
    v_smfmac_f32_16x16x64_bf16 a[8:11], a[16:19], v[32:39], v11
    s_waitcnt lgkmcnt(12)
    v_mfma_f32_16x16x32_bf16 v[16:19], a[64:67], v[64:67], v[48:51]
    v_exp_f32 v28, v28
    v_mfma_f32_16x16x32_bf16 v[16:19], a[68:71], v[68:71], v[16:19]
    v_cvt_pk_bf16_f32 v45, v26, v27
    v_mfma_f32_16x16x32_bf16 v[16:19], a[72:75], v[72:75], v[16:19]
    v_exp_f32 v29, v29
    v_mfma_f32_16x16x32_bf16 v[16:19], a[76:79], v[76:79], v[16:19]
    s_waitcnt lgkmcnt(8)
    buffer_store_dwordx4 a[56:59], v5, s[32:35], 0 offen offset:0 sc1
    v_mfma_f32_16x16x32_bf16 v[20:23], a[80:83], v[64:67], v[48:51]
    v_exp_f32 v30, v30
    v_mfma_f32_16x16x32_bf16 v[20:23], a[84:87], v[68:71], v[20:23]
    v_cvt_pk_bf16_f32 v46, v28, v29
    v_mfma_f32_16x16x32_bf16 v[20:23], a[88:91], v[72:75], v[20:23]
    v_exp_f32 v31, v31
    v_mfma_f32_16x16x32_bf16 v[20:23], a[92:95], v[76:79], v[20:23]
    s_waitcnt lgkmcnt(4)
    v_mfma_f32_16x16x32_bf16 v[24:27], a[96:99], v[64:67], v[48:51]
    v_exp_f32 v16, v16
    v_mfma_f32_16x16x32_bf16 v[24:27], a[100:103], v[68:71], v[24:27]
    v_cvt_pk_bf16_f32 v47, v30, v31
    v_mfma_f32_16x16x32_bf16 v[24:27], a[104:107], v[72:75], v[24:27]
    v_exp_f32 v17, v17
    v_mfma_f32_16x16x32_bf16 v[24:27], a[108:111], v[76:79], v[24:27]
    s_waitcnt lgkmcnt(0)
    buffer_store_dwordx4 a[56:59], v5, s[32:35], 0 offen offset:1024 sc1
    v_mfma_f32_16x16x32_bf16 v[28:31], a[112:115], v[64:67], v[48:51]
    v_exp_f32 v18, v18
    v_mfma_f32_16x16x32_bf16 v[28:31], a[116:119], v[68:71], v[28:31]
    v_cvt_pk_bf16_f32 v32, v16, v17
    v_mfma_f32_16x16x32_bf16 v[28:31], a[120:123], v[72:75], v[28:31]
    v_exp_f32 v19, v19
    v_mfma_f32_16x16x32_bf16 v[28:31], a[124:127], v[76:79], v[28:31]
    v_mfma_f32_16x16x32_bf16 v[224:227], a[192:195], v[40:43], v[224:227]
    v_exp_f32 v20, v20
    v_mfma_f32_16x16x32_bf16 v[224:227], a[196:199], v[44:47], v[224:227]
    ds_read_b64_tr_b16 a[192:193], v2 offset:36864
    v_cvt_pk_bf16_f32 v33, v18, v19
    v_mfma_f32_16x16x32_bf16 v[228:231], a[200:203], v[40:43], v[228:231]
    v_exp_f32 v21, v21
    v_mfma_f32_16x16x32_bf16 v[228:231], a[204:207], v[44:47], v[228:231]
    buffer_store_dwordx4 a[56:59], v5, s[32:35], 0 offen offset:2048 sc1
    v_mfma_f32_16x16x32_bf16 v[232:235], a[208:211], v[40:43], v[232:235]
    v_exp_f32 v22, v22
    v_mfma_f32_16x16x32_bf16 v[232:235], a[212:215], v[44:47], v[232:235]
    ds_read_b64_tr_b16 a[194:195], v2 offset:37120
    v_cvt_pk_bf16_f32 v34, v20, v21
    v_mfma_f32_16x16x32_bf16 v[236:239], a[216:219], v[40:43], v[236:239]
    v_exp_f32 v23, v23
    v_mfma_f32_16x16x32_bf16 v[236:239], a[220:223], v[44:47], v[236:239]
    ds_read_b64_tr_b16 a[196:197], v2 offset:37376
    v_mfma_f32_16x16x32_bf16 v[240:243], a[224:227], v[40:43], v[240:243]
    v_exp_f32 v24, v24
    v_mfma_f32_16x16x32_bf16 v[240:243], a[228:231], v[44:47], v[240:243]
    ds_read_b64_tr_b16 a[198:199], v2 offset:37632
    v_cvt_pk_bf16_f32 v35, v22, v23
    v_mfma_f32_16x16x32_bf16 v[244:247], a[232:235], v[40:43], v[244:247]
    v_exp_f32 v25, v25
    v_mfma_f32_16x16x32_bf16 v[244:247], a[236:239], v[44:47], v[244:247]
    buffer_store_dwordx4 a[56:59], v5, s[32:35], 0 offen offset:3072 sc1
    v_mfma_f32_16x16x32_bf16 v[248:251], a[240:243], v[40:43], v[248:251]
    v_exp_f32 v26, v26
    v_mfma_f32_16x16x32_bf16 v[248:251], a[244:247], v[44:47], v[248:251]
    ds_read_b64_tr_b16 a[200:201], v2 offset:36896
    v_cvt_pk_bf16_f32 v36, v24, v25
    v_mfma_f32_16x16x32_bf16 v[252:255], a[248:251], v[40:43], v[252:255]
    v_exp_f32 v27, v27
    v_mfma_f32_16x16x32_bf16 v[252:255], a[252:255], v[44:47], v[252:255]
    ds_read_b64_tr_b16 a[202:203], v2 offset:37152
    v_smfmac_f32_16x16x64_bf16 a[12:15], a[16:19], v[40:47], v11
    ds_read_b64_tr_b16 a[204:205], v2 offset:37408
    v_mfma_f32_16x16x32_bf16 v[16:19], a[64:67], v[80:83], v[52:55]
    v_exp_f32 v28, v28
    v_mfma_f32_16x16x32_bf16 v[16:19], a[68:71], v[84:87], v[16:19]
    ds_read_b64_tr_b16 a[206:207], v2 offset:37664
    v_cvt_pk_bf16_f32 v37, v26, v27
    v_mfma_f32_16x16x32_bf16 v[16:19], a[72:75], v[88:91], v[16:19]
    v_exp_f32 v29, v29
    v_mfma_f32_16x16x32_bf16 v[16:19], a[76:79], v[92:95], v[16:19]
    ds_read_b64_tr_b16 a[208:209], v2 offset:36928
    v_mfma_f32_16x16x32_bf16 v[20:23], a[80:83], v[80:83], v[52:55]
    v_exp_f32 v30, v30
    v_mfma_f32_16x16x32_bf16 v[20:23], a[84:87], v[84:87], v[20:23]
    ds_read_b64_tr_b16 a[210:211], v2 offset:37184
    v_cvt_pk_bf16_f32 v38, v28, v29
    v_mfma_f32_16x16x32_bf16 v[20:23], a[88:91], v[88:91], v[20:23]
    v_exp_f32 v31, v31
    v_mfma_f32_16x16x32_bf16 v[20:23], a[92:95], v[92:95], v[20:23]
    ds_read_b64_tr_b16 a[212:213], v2 offset:37440
    v_mfma_f32_16x16x32_bf16 v[24:27], a[96:99], v[80:83], v[52:55]
    v_exp_f32 v16, v16
    v_mfma_f32_16x16x32_bf16 v[24:27], a[100:103], v[84:87], v[24:27]
    ds_read_b64_tr_b16 a[214:215], v2 offset:37696
    v_cvt_pk_bf16_f32 v39, v30, v31
    v_mfma_f32_16x16x32_bf16 v[24:27], a[104:107], v[88:91], v[24:27]
    v_exp_f32 v17, v17
    v_mfma_f32_16x16x32_bf16 v[24:27], a[108:111], v[92:95], v[24:27]
    ds_read_b64_tr_b16 a[216:217], v2 offset:36960
    v_mfma_f32_16x16x32_bf16 v[28:31], a[112:115], v[80:83], v[52:55]
    v_exp_f32 v18, v18
    v_mfma_f32_16x16x32_bf16 v[28:31], a[116:119], v[84:87], v[28:31]
    ds_read_b64_tr_b16 a[218:219], v2 offset:37216
    v_cvt_pk_bf16_f32 v40, v16, v17
    v_mfma_f32_16x16x32_bf16 v[28:31], a[120:123], v[88:91], v[28:31]
    v_exp_f32 v19, v19
    v_mfma_f32_16x16x32_bf16 v[28:31], a[124:127], v[92:95], v[28:31]
    ds_read_b64_tr_b16 a[220:221], v2 offset:37472
    v_mfma_f32_16x16x32_bf16 v[128:131], a[128:131], v[32:35], v[128:131]
    v_exp_f32 v20, v20
    v_mfma_f32_16x16x32_bf16 v[128:131], a[132:135], v[36:39], v[128:131]
    ds_read_b64_tr_b16 a[222:223], v2 offset:37728
    v_cvt_pk_bf16_f32 v41, v18, v19
    v_mfma_f32_16x16x32_bf16 v[132:135], a[136:139], v[32:35], v[132:135]
    v_exp_f32 v21, v21
    v_mfma_f32_16x16x32_bf16 v[132:135], a[140:143], v[36:39], v[132:135]
    ds_read_b64_tr_b16 a[224:225], v2 offset:36992
    v_mfma_f32_16x16x32_bf16 v[136:139], a[144:147], v[32:35], v[136:139]
    v_exp_f32 v22, v22
    v_mfma_f32_16x16x32_bf16 v[136:139], a[148:151], v[36:39], v[136:139]
    ds_read_b64_tr_b16 a[226:227], v2 offset:37248
    v_cvt_pk_bf16_f32 v42, v20, v21
    v_mfma_f32_16x16x32_bf16 v[140:143], a[152:155], v[32:35], v[140:143]
    v_exp_f32 v23, v23
    v_mfma_f32_16x16x32_bf16 v[140:143], a[156:159], v[36:39], v[140:143]
    ds_read_b64_tr_b16 a[228:229], v2 offset:37504
    v_mfma_f32_16x16x32_bf16 v[144:147], a[160:163], v[32:35], v[144:147]
    v_exp_f32 v24, v24
    v_mfma_f32_16x16x32_bf16 v[144:147], a[164:167], v[36:39], v[144:147]
    ds_read_b64_tr_b16 a[230:231], v2 offset:37760
    v_cvt_pk_bf16_f32 v43, v22, v23
    v_mfma_f32_16x16x32_bf16 v[148:151], a[168:171], v[32:35], v[148:151]
    v_exp_f32 v25, v25
    v_mfma_f32_16x16x32_bf16 v[148:151], a[172:175], v[36:39], v[148:151]
    ds_read_b64_tr_b16 a[232:233], v2 offset:37024
    v_mfma_f32_16x16x32_bf16 v[152:155], a[176:179], v[32:35], v[152:155]
    v_exp_f32 v26, v26
    v_mfma_f32_16x16x32_bf16 v[152:155], a[180:183], v[36:39], v[152:155]
    ds_read_b64_tr_b16 a[234:235], v2 offset:37280
    v_cvt_pk_bf16_f32 v44, v24, v25
    v_mfma_f32_16x16x32_bf16 v[156:159], a[184:187], v[32:35], v[156:159]
    v_exp_f32 v27, v27
    v_mfma_f32_16x16x32_bf16 v[156:159], a[188:191], v[36:39], v[156:159]
    ds_read_b64_tr_b16 a[236:237], v2 offset:37536
    v_smfmac_f32_16x16x64_bf16 a[0:3], a[16:19], v[32:39], v11
    ds_read_b64_tr_b16 a[238:239], v2 offset:37792
    v_mfma_f32_16x16x32_bf16 v[16:19], a[64:67], v[96:99], v[56:59]
    v_exp_f32 v28, v28
    v_mfma_f32_16x16x32_bf16 v[16:19], a[68:71], v[100:103], v[16:19]
    ds_read_b64_tr_b16 a[240:241], v2 offset:37056
    v_cvt_pk_bf16_f32 v45, v26, v27
    v_mfma_f32_16x16x32_bf16 v[16:19], a[72:75], v[104:107], v[16:19]
    v_exp_f32 v29, v29
    v_mfma_f32_16x16x32_bf16 v[16:19], a[76:79], v[108:111], v[16:19]
    ds_read_b64_tr_b16 a[242:243], v2 offset:37312
    v_mfma_f32_16x16x32_bf16 v[20:23], a[80:83], v[96:99], v[56:59]
    v_exp_f32 v30, v30
    v_mfma_f32_16x16x32_bf16 v[20:23], a[84:87], v[100:103], v[20:23]
    ds_read_b64_tr_b16 a[244:245], v2 offset:37568
    v_cvt_pk_bf16_f32 v46, v28, v29
    v_mfma_f32_16x16x32_bf16 v[20:23], a[88:91], v[104:107], v[20:23]
    v_exp_f32 v31, v31
    v_mfma_f32_16x16x32_bf16 v[20:23], a[92:95], v[108:111], v[20:23]
    ds_read_b64_tr_b16 a[246:247], v2 offset:37824
    v_mfma_f32_16x16x32_bf16 v[24:27], a[96:99], v[96:99], v[56:59]
    v_exp_f32 v16, v16
    v_mfma_f32_16x16x32_bf16 v[24:27], a[100:103], v[100:103], v[24:27]
    ds_read_b64_tr_b16 a[248:249], v2 offset:37088
    v_cvt_pk_bf16_f32 v47, v30, v31
    v_mfma_f32_16x16x32_bf16 v[24:27], a[104:107], v[104:107], v[24:27]
    v_exp_f32 v17, v17
    v_mfma_f32_16x16x32_bf16 v[24:27], a[108:111], v[108:111], v[24:27]
    ds_read_b64_tr_b16 a[250:251], v2 offset:37344
    v_mfma_f32_16x16x32_bf16 v[28:31], a[112:115], v[96:99], v[56:59]
    v_exp_f32 v18, v18
    v_mfma_f32_16x16x32_bf16 v[28:31], a[116:119], v[100:103], v[28:31]
    ds_read_b64_tr_b16 a[252:253], v2 offset:37600
    v_cvt_pk_bf16_f32 v32, v16, v17
    v_mfma_f32_16x16x32_bf16 v[28:31], a[120:123], v[104:107], v[28:31]
    v_exp_f32 v19, v19
    v_mfma_f32_16x16x32_bf16 v[28:31], a[124:127], v[108:111], v[28:31]
    ds_read_b64_tr_b16 a[254:255], v2 offset:37856
    v_mfma_f32_16x16x32_bf16 v[160:163], a[128:131], v[40:43], v[160:163]
    v_exp_f32 v20, v20
    v_mfma_f32_16x16x32_bf16 v[160:163], a[132:135], v[44:47], v[160:163]
    v_cvt_pk_bf16_f32 v33, v18, v19
    v_mfma_f32_16x16x32_bf16 v[164:167], a[136:139], v[40:43], v[164:167]
    v_exp_f32 v21, v21
    v_mfma_f32_16x16x32_bf16 v[164:167], a[140:143], v[44:47], v[164:167]
    v_mfma_f32_16x16x32_bf16 v[168:171], a[144:147], v[40:43], v[168:171]
    v_exp_f32 v22, v22
    v_mfma_f32_16x16x32_bf16 v[168:171], a[148:151], v[44:47], v[168:171]
    v_cvt_pk_bf16_f32 v34, v20, v21
    v_mfma_f32_16x16x32_bf16 v[172:175], a[152:155], v[40:43], v[172:175]
    v_exp_f32 v23, v23
    v_mfma_f32_16x16x32_bf16 v[172:175], a[156:159], v[44:47], v[172:175]
    v_mfma_f32_16x16x32_bf16 v[176:179], a[160:163], v[40:43], v[176:179]
    v_exp_f32 v24, v24
    v_mfma_f32_16x16x32_bf16 v[176:179], a[164:167], v[44:47], v[176:179]
    v_cvt_pk_bf16_f32 v35, v22, v23
    v_mfma_f32_16x16x32_bf16 v[180:183], a[168:171], v[40:43], v[180:183]
L2_pad8:
    s_cbranch_execz L2_pad12
    v_exp_f32 v25, v25
    v_mfma_f32_16x16x32_bf16 v[180:183], a[172:175], v[44:47], v[180:183]
    v_mfma_f32_16x16x32_bf16 v[184:187], a[176:179], v[40:43], v[184:187]
    v_exp_f32 v26, v26
    v_mfma_f32_16x16x32_bf16 v[184:187], a[180:183], v[44:47], v[184:187]
    v_cvt_pk_bf16_f32 v36, v24, v25
    v_mfma_f32_16x16x32_bf16 v[188:191], a[184:187], v[40:43], v[188:191]
    v_exp_f32 v27, v27
    v_mfma_f32_16x16x32_bf16 v[188:191], a[188:191], v[44:47], v[188:191]
    v_smfmac_f32_16x16x64_bf16 a[4:7], a[16:19], v[40:47], v11
    v_mfma_f32_16x16x32_bf16 v[16:19], a[64:67], v[112:115], v[60:63]
    v_exp_f32 v28, v28
    v_mfma_f32_16x16x32_bf16 v[16:19], a[68:71], v[116:119], v[16:19]
    ds_read_b128 a[64:67], v1 offset:36864
    v_cvt_pk_bf16_f32 v37, v26, v27
    v_mfma_f32_16x16x32_bf16 v[16:19], a[72:75], v[120:123], v[16:19]
    v_exp_f32 v29, v29
    v_mfma_f32_16x16x32_bf16 v[16:19], a[76:79], v[124:127], v[16:19]
    ds_read_b128 a[68:71], v1 offset:36928
    v_mfma_f32_16x16x32_bf16 v[20:23], a[80:83], v[112:115], v[60:63]
    v_exp_f32 v30, v30
    v_mfma_f32_16x16x32_bf16 v[20:23], a[84:87], v[116:119], v[20:23]
    ds_read_b128 a[72:75], v1 offset:36992
    v_cvt_pk_bf16_f32 v38, v28, v29
    v_mfma_f32_16x16x32_bf16 v[20:23], a[88:91], v[120:123], v[20:23]
    v_exp_f32 v31, v31
    v_mfma_f32_16x16x32_bf16 v[20:23], a[92:95], v[124:127], v[20:23]
    ds_read_b128 a[76:79], v1 offset:37056
    v_mfma_f32_16x16x32_bf16 v[24:27], a[96:99], v[112:115], v[60:63]
    v_exp_f32 v16, v16
    v_mfma_f32_16x16x32_bf16 v[24:27], a[100:103], v[116:119], v[24:27]
    ds_read_b128 a[80:83], v1 offset:37120
    v_cvt_pk_bf16_f32 v39, v30, v31
    v_mfma_f32_16x16x32_bf16 v[24:27], a[104:107], v[120:123], v[24:27]
    v_exp_f32 v17, v17
    v_mfma_f32_16x16x32_bf16 v[24:27], a[108:111], v[124:127], v[24:27]
    ds_read_b128 a[84:87], v1 offset:37184
    v_mfma_f32_16x16x32_bf16 v[28:31], a[112:115], v[112:115], v[60:63]
    v_exp_f32 v18, v18
    v_mfma_f32_16x16x32_bf16 v[28:31], a[116:119], v[116:119], v[28:31]
    ds_read_b128 a[88:91], v1 offset:37248
    v_cvt_pk_bf16_f32 v40, v16, v17
    v_mfma_f32_16x16x32_bf16 v[28:31], a[120:123], v[120:123], v[28:31]
    v_exp_f32 v19, v19
    v_mfma_f32_16x16x32_bf16 v[28:31], a[124:127], v[124:127], v[28:31]
    ds_read_b128 a[92:95], v1 offset:37312
    v_mfma_f32_16x16x32_bf16 v[192:195], a[128:131], v[32:35], v[192:195]
    v_exp_f32 v20, v20
    v_mfma_f32_16x16x32_bf16 v[192:195], a[132:135], v[36:39], v[192:195]
    ds_read_b128 a[96:99], v1 offset:37376
    v_cvt_pk_bf16_f32 v41, v18, v19
    v_mfma_f32_16x16x32_bf16 v[196:199], a[136:139], v[32:35], v[196:199]
    v_exp_f32 v21, v21
    v_mfma_f32_16x16x32_bf16 v[196:199], a[140:143], v[36:39], v[196:199]
    ds_read_b128 a[100:103], v1 offset:37440
    v_mfma_f32_16x16x32_bf16 v[200:203], a[144:147], v[32:35], v[200:203]
    v_exp_f32 v22, v22
    v_mfma_f32_16x16x32_bf16 v[200:203], a[148:151], v[36:39], v[200:203]
    ds_read_b128 a[104:107], v1 offset:37504
    v_cvt_pk_bf16_f32 v42, v20, v21
    v_mfma_f32_16x16x32_bf16 v[204:207], a[152:155], v[32:35], v[204:207]
    v_exp_f32 v23, v23
    v_mfma_f32_16x16x32_bf16 v[204:207], a[156:159], v[36:39], v[204:207]
    ds_read_b128 a[108:111], v1 offset:37568
    v_mfma_f32_16x16x32_bf16 v[208:211], a[160:163], v[32:35], v[208:211]
    v_exp_f32 v24, v24
    v_mfma_f32_16x16x32_bf16 v[208:211], a[164:167], v[36:39], v[208:211]
    ds_read_b128 a[112:115], v1 offset:37632
    v_cvt_pk_bf16_f32 v43, v22, v23
    v_mfma_f32_16x16x32_bf16 v[212:215], a[168:171], v[32:35], v[212:215]
    v_exp_f32 v25, v25
    v_mfma_f32_16x16x32_bf16 v[212:215], a[172:175], v[36:39], v[212:215]
    ds_read_b128 a[116:119], v1 offset:37696
    v_mfma_f32_16x16x32_bf16 v[216:219], a[176:179], v[32:35], v[216:219]
    v_exp_f32 v26, v26
    v_mfma_f32_16x16x32_bf16 v[216:219], a[180:183], v[36:39], v[216:219]
    ds_read_b128 a[120:123], v1 offset:37760
    v_cvt_pk_bf16_f32 v44, v24, v25
    v_mfma_f32_16x16x32_bf16 v[220:223], a[184:187], v[32:35], v[220:223]
    v_exp_f32 v27, v27
    v_mfma_f32_16x16x32_bf16 v[220:223], a[188:191], v[36:39], v[220:223]
    ds_read_b128 a[124:127], v1 offset:37824
    v_smfmac_f32_16x16x64_bf16 a[8:11], a[16:19], v[32:39], v11
    s_waitcnt lgkmcnt(12)
    v_mfma_f32_16x16x32_bf16 v[16:19], a[64:67], v[64:67], v[48:51]
    v_exp_f32 v28, v28
    v_mfma_f32_16x16x32_bf16 v[16:19], a[68:71], v[68:71], v[16:19]
    v_cvt_pk_bf16_f32 v45, v26, v27
    v_mfma_f32_16x16x32_bf16 v[16:19], a[72:75], v[72:75], v[16:19]
    v_exp_f32 v29, v29
    v_mfma_f32_16x16x32_bf16 v[16:19], a[76:79], v[76:79], v[16:19]
    s_waitcnt lgkmcnt(8)
    v_mfma_f32_16x16x32_bf16 v[20:23], a[80:83], v[64:67], v[48:51]
    v_exp_f32 v30, v30
    v_mfma_f32_16x16x32_bf16 v[20:23], a[84:87], v[68:71], v[20:23]
    v_cvt_pk_bf16_f32 v46, v28, v29
    v_mfma_f32_16x16x32_bf16 v[20:23], a[88:91], v[72:75], v[20:23]
    v_exp_f32 v31, v31
    v_mfma_f32_16x16x32_bf16 v[20:23], a[92:95], v[76:79], v[20:23]
    s_waitcnt lgkmcnt(4)
    v_mfma_f32_16x16x32_bf16 v[24:27], a[96:99], v[64:67], v[48:51]
    v_exp_f32 v16, v16
    v_mfma_f32_16x16x32_bf16 v[24:27], a[100:103], v[68:71], v[24:27]
    v_cvt_pk_bf16_f32 v47, v30, v31
    v_mfma_f32_16x16x32_bf16 v[24:27], a[104:107], v[72:75], v[24:27]
    v_exp_f32 v17, v17
    v_mfma_f32_16x16x32_bf16 v[24:27], a[108:111], v[76:79], v[24:27]
    s_waitcnt lgkmcnt(0)
    v_mfma_f32_16x16x32_bf16 v[28:31], a[112:115], v[64:67], v[48:51]
    v_exp_f32 v18, v18
    v_mfma_f32_16x16x32_bf16 v[28:31], a[116:119], v[68:71], v[28:31]
    v_cvt_pk_bf16_f32 v32, v16, v17
    v_mfma_f32_16x16x32_bf16 v[28:31], a[120:123], v[72:75], v[28:31]
    v_exp_f32 v19, v19
    v_mfma_f32_16x16x32_bf16 v[28:31], a[124:127], v[76:79], v[28:31]
    s_waitcnt vmcnt(4)
    s_barrier
    v_mfma_f32_16x16x32_bf16 v[224:227], a[128:131], v[40:43], v[224:227]
    v_exp_f32 v20, v20
    v_mfma_f32_16x16x32_bf16 v[224:227], a[132:135], v[44:47], v[224:227]
    v_cvt_pk_bf16_f32 v33, v18, v19
    v_mfma_f32_16x16x32_bf16 v[228:231], a[136:139], v[40:43], v[228:231]
    s_add_u32 m0, s44, 0
    v_exp_f32 v21, v21
    v_mfma_f32_16x16x32_bf16 v[228:231], a[140:143], v[44:47], v[228:231]
    s_mov_b32 s45, 256
    buffer_load_dwordx4 v7, s[28:31], s45 offen offset:0 lds
    v_mfma_f32_16x16x32_bf16 v[232:235], a[144:147], v[40:43], v[232:235]
    v_exp_f32 v22, v22
    v_mfma_f32_16x16x32_bf16 v[232:235], a[148:151], v[44:47], v[232:235]
    v_cvt_pk_bf16_f32 v34, v20, v21
    v_mfma_f32_16x16x32_bf16 v[236:239], a[152:155], v[40:43], v[236:239]
    s_add_u32 m0, s44, -96
    v_exp_f32 v23, v23
    v_mfma_f32_16x16x32_bf16 v[236:239], a[156:159], v[44:47], v[236:239]
    buffer_load_dwordx4 v7, s[28:31], s45 offen offset:1152 lds
    v_mfma_f32_16x16x32_bf16 v[240:243], a[160:163], v[40:43], v[240:243]
    v_exp_f32 v24, v24
    v_mfma_f32_16x16x32_bf16 v[240:243], a[164:167], v[44:47], v[240:243]
    v_cvt_pk_bf16_f32 v35, v22, v23
    v_mfma_f32_16x16x32_bf16 v[244:247], a[168:171], v[40:43], v[244:247]
    s_add_u32 m0, s44, -192
    v_exp_f32 v25, v25
    v_mfma_f32_16x16x32_bf16 v[244:247], a[172:175], v[44:47], v[244:247]
    buffer_load_dwordx4 v7, s[28:31], s45 offen offset:2304 lds
    v_mfma_f32_16x16x32_bf16 v[248:251], a[176:179], v[40:43], v[248:251]
    v_exp_f32 v26, v26
    v_mfma_f32_16x16x32_bf16 v[248:251], a[180:183], v[44:47], v[248:251]
    v_cvt_pk_bf16_f32 v36, v24, v25
    v_mfma_f32_16x16x32_bf16 v[252:255], a[184:187], v[40:43], v[252:255]
    s_add_u32 m0, s44, -288
    v_exp_f32 v27, v27
    v_mfma_f32_16x16x32_bf16 v[252:255], a[188:191], v[44:47], v[252:255]
    buffer_load_dwordx4 v7, s[28:31], s45 offen offset:3456 lds
    v_smfmac_f32_16x16x64_bf16 a[12:15], a[16:19], v[40:47], v11
    v_mfma_f32_16x16x32_bf16 v[16:19], a[64:67], v[80:83], v[52:55]
    v_exp_f32 v28, v28
    v_mfma_f32_16x16x32_bf16 v[16:19], a[68:71], v[84:87], v[16:19]
    v_cvt_pk_bf16_f32 v37, v26, v27
    v_mfma_f32_16x16x32_bf16 v[16:19], a[72:75], v[88:91], v[16:19]
    s_add_u32 m0, s44, 16896
    v_exp_f32 v29, v29
    v_mfma_f32_16x16x32_bf16 v[16:19], a[76:79], v[92:95], v[16:19]
    s_mov_b32 s45, 147712
    buffer_load_dwordx4 v7, s[28:31], s45 offen offset:0 lds
    v_mfma_f32_16x16x32_bf16 v[20:23], a[80:83], v[80:83], v[52:55]
    v_exp_f32 v30, v30
    v_mfma_f32_16x16x32_bf16 v[20:23], a[84:87], v[84:87], v[20:23]
    v_cvt_pk_bf16_f32 v38, v28, v29
    v_mfma_f32_16x16x32_bf16 v[20:23], a[88:91], v[88:91], v[20:23]
    s_add_u32 m0, s44, 16800
    v_exp_f32 v31, v31
    v_mfma_f32_16x16x32_bf16 v[20:23], a[92:95], v[92:95], v[20:23]
    s_mov_b32 s15, 0x5d800000
    buffer_load_dwordx4 v7, s[28:31], s45 offen offset:1152 lds
    v_mfma_f32_16x16x32_bf16 v[24:27], a[96:99], v[80:83], v[52:55]
    v_exp_f32 v16, v16
    v_mfma_f32_16x16x32_bf16 v[24:27], a[100:103], v[84:87], v[24:27]
    v_cvt_pk_bf16_f32 v39, v30, v31
    v_mfma_f32_16x16x32_bf16 v[24:27], a[104:107], v[88:91], v[24:27]
    s_add_u32 m0, s44, 16704
    v_exp_f32 v17, v17
    v_mfma_f32_16x16x32_bf16 v[24:27], a[108:111], v[92:95], v[24:27]
    buffer_load_dwordx4 v7, s[28:31], s45 offen offset:2304 lds
    v_mfma_f32_16x16x32_bf16 v[28:31], a[112:115], v[80:83], v[52:55]
    v_exp_f32 v18, v18
    v_mfma_f32_16x16x32_bf16 v[28:31], a[116:119], v[84:87], v[28:31]
    v_cvt_pk_bf16_f32 v40, v16, v17
    v_mfma_f32_16x16x32_bf16 v[28:31], a[120:123], v[88:91], v[28:31]
    s_add_u32 m0, s44, 16608
    v_exp_f32 v19, v19
    v_mfma_f32_16x16x32_bf16 v[28:31], a[124:127], v[92:95], v[28:31]
    buffer_load_dwordx4 v7, s[28:31], s45 offen offset:3456 lds
    v_mfma_f32_16x16x32_bf16 v[128:131], a[192:195], v[32:35], v[128:131]
    v_exp_f32 v20, v20
    v_mfma_f32_16x16x32_bf16 v[128:131], a[196:199], v[36:39], v[128:131]
    v_cvt_pk_bf16_f32 v41, v18, v19
    v_mfma_f32_16x16x32_bf16 v[132:135], a[200:203], v[32:35], v[132:135]
    s_mov_b32 s54, 0
    v_exp_f32 v21, v21
    v_mfma_f32_16x16x32_bf16 v[132:135], a[204:207], v[36:39], v[132:135]
    buffer_load_dwordx4 a[128:131], v6, s[68:71], s54 offen
    v_mfma_f32_16x16x32_bf16 v[136:139], a[208:211], v[32:35], v[136:139]
    v_exp_f32 v22, v22
    v_mfma_f32_16x16x32_bf16 v[136:139], a[212:215], v[36:39], v[136:139]
    v_cvt_pk_bf16_f32 v42, v20, v21
    v_mfma_f32_16x16x32_bf16 v[140:143], a[216:219], v[32:35], v[140:143]
    s_add_u32 s54, s55, 0
    v_exp_f32 v23, v23
    v_mfma_f32_16x16x32_bf16 v[140:143], a[220:223], v[36:39], v[140:143]
    buffer_load_dwordx4 a[164:167], v8, s[72:75], s54 offen
    v_mfma_f32_16x16x32_bf16 v[144:147], a[224:227], v[32:35], v[144:147]
    v_exp_f32 v24, v24
    v_mfma_f32_16x16x32_bf16 v[144:147], a[228:231], v[36:39], v[144:147]
    v_cvt_pk_bf16_f32 v43, v22, v23
    v_mfma_f32_16x16x32_bf16 v[148:151], a[232:235], v[32:35], v[148:151]
    s_mov_b32 s54, 147456
    v_exp_f32 v25, v25
    v_mfma_f32_16x16x32_bf16 v[148:151], a[236:239], v[36:39], v[148:151]
    buffer_load_dwordx4 a[132:135], v6, s[68:71], s54 offen
    v_mfma_f32_16x16x32_bf16 v[152:155], a[240:243], v[32:35], v[152:155]
    v_exp_f32 v26, v26
    v_mfma_f32_16x16x32_bf16 v[152:155], a[244:247], v[36:39], v[152:155]
    v_cvt_pk_bf16_f32 v44, v24, v25
    v_mfma_f32_16x16x32_bf16 v[156:159], a[248:251], v[32:35], v[156:159]
    s_add_u32 s54, s55, 1024
    v_exp_f32 v27, v27
    v_mfma_f32_16x16x32_bf16 v[156:159], a[252:255], v[36:39], v[156:159]
    buffer_load_dwordx4 a[168:171], v8, s[72:75], s54 offen
    v_smfmac_f32_16x16x64_bf16 a[0:3], a[16:19], v[32:39], v11
    v_mfma_f32_16x16x32_bf16 v[16:19], a[64:67], v[96:99], v[56:59]
    v_exp_f32 v28, v28
    v_mfma_f32_16x16x32_bf16 v[16:19], a[68:71], v[100:103], v[16:19]
    v_cvt_pk_bf16_f32 v45, v26, v27
    v_mfma_f32_16x16x32_bf16 v[16:19], a[72:75], v[104:107], v[16:19]
    s_mov_b32 s54, 294912
    v_exp_f32 v29, v29
    v_mfma_f32_16x16x32_bf16 v[16:19], a[76:79], v[108:111], v[16:19]
    buffer_load_dwordx4 a[136:139], v6, s[68:71], s54 offen
    v_mfma_f32_16x16x32_bf16 v[20:23], a[80:83], v[96:99], v[56:59]
    v_exp_f32 v30, v30
    v_mfma_f32_16x16x32_bf16 v[20:23], a[84:87], v[100:103], v[20:23]
    v_cvt_pk_bf16_f32 v46, v28, v29
    v_accvgpr_read_b32 v12, a0
    v_mfma_f32_16x16x32_bf16 v[20:23], a[88:91], v[104:107], v[20:23]
    s_add_u32 s54, s55, 2048
    v_exp_f32 v31, v31
    v_mfma_f32_16x16x32_bf16 v[20:23], a[92:95], v[108:111], v[20:23]
    buffer_load_dwordx4 a[172:175], v8, s[72:75], s54 offen
    v_mfma_f32_16x16x32_bf16 v[24:27], a[96:99], v[96:99], v[56:59]
    v_exp_f32 v16, v16
    v_mfma_f32_16x16x32_bf16 v[24:27], a[100:103], v[100:103], v[24:27]
    v_cvt_pk_bf16_f32 v47, v30, v31
    v_accvgpr_read_b32 v13, a1
    v_mfma_f32_16x16x32_bf16 v[24:27], a[104:107], v[104:107], v[24:27]
    s_mov_b32 s54, 442368
    v_exp_f32 v17, v17
    v_mfma_f32_16x16x32_bf16 v[24:27], a[108:111], v[108:111], v[24:27]
    buffer_load_dwordx4 a[140:143], v6, s[68:71], s54 offen
    v_mfma_f32_16x16x32_bf16 v[28:31], a[112:115], v[96:99], v[56:59]
    v_exp_f32 v18, v18
    v_mfma_f32_16x16x32_bf16 v[28:31], a[116:119], v[100:103], v[28:31]
    v_cvt_pk_bf16_f32 v32, v16, v17
    v_add_f32 v12, v12, v13
    v_mfma_f32_16x16x32_bf16 v[28:31], a[120:123], v[104:107], v[28:31]
    s_add_u32 s54, s55, 3072
    v_exp_f32 v19, v19
    v_mfma_f32_16x16x32_bf16 v[28:31], a[124:127], v[108:111], v[28:31]
    buffer_load_dwordx4 a[176:179], v8, s[72:75], s54 offen
    v_mfma_f32_16x16x32_bf16 v[160:163], a[192:195], v[40:43], v[160:163]
    v_exp_f32 v20, v20
    v_mfma_f32_16x16x32_bf16 v[160:163], a[196:199], v[44:47], v[160:163]
    v_cvt_pk_bf16_f32 v33, v18, v19
    v_cmp_nlt_f32 s[56:57], v12, s15
    v_mfma_f32_16x16x32_bf16 v[164:167], a[200:203], v[40:43], v[164:167]
    s_mov_b32 s54, 589824
    v_exp_f32 v21, v21
    v_mfma_f32_16x16x32_bf16 v[164:167], a[204:207], v[44:47], v[164:167]
    buffer_load_dwordx4 a[144:147], v6, s[68:71], s54 offen
    v_mfma_f32_16x16x32_bf16 v[168:171], a[208:211], v[40:43], v[168:171]
    v_exp_f32 v22, v22
    v_mfma_f32_16x16x32_bf16 v[168:171], a[212:215], v[44:47], v[168:171]
    v_cvt_pk_bf16_f32 v34, v20, v21
    v_mfma_f32_16x16x32_bf16 v[172:175], a[216:219], v[40:43], v[172:175]
    s_add_u32 s54, s55, 4096
    v_exp_f32 v23, v23
    v_mfma_f32_16x16x32_bf16 v[172:175], a[220:223], v[44:47], v[172:175]
    buffer_load_dwordx4 a[180:183], v8, s[72:75], s54 offen
    v_mfma_f32_16x16x32_bf16 v[176:179], a[224:227], v[40:43], v[176:179]
    v_exp_f32 v24, v24
    v_mfma_f32_16x16x32_bf16 v[176:179], a[228:231], v[44:47], v[176:179]
    v_cvt_pk_bf16_f32 v35, v22, v23
    v_mfma_f32_16x16x32_bf16 v[180:183], a[232:235], v[40:43], v[180:183]
    s_mov_b32 s54, 737280
    v_exp_f32 v25, v25
    v_mfma_f32_16x16x32_bf16 v[180:183], a[236:239], v[44:47], v[180:183]
    buffer_load_dwordx4 a[148:151], v6, s[68:71], s54 offen
    v_mfma_f32_16x16x32_bf16 v[184:187], a[240:243], v[40:43], v[184:187]
    v_exp_f32 v26, v26
    v_mfma_f32_16x16x32_bf16 v[184:187], a[244:247], v[44:47], v[184:187]
    v_cvt_pk_bf16_f32 v36, v24, v25
    v_mfma_f32_16x16x32_bf16 v[188:191], a[248:251], v[40:43], v[188:191]
    s_add_u32 s54, s55, 5120
    v_exp_f32 v27, v27
    v_mfma_f32_16x16x32_bf16 v[188:191], a[252:255], v[44:47], v[188:191]
    buffer_load_dwordx4 a[184:187], v8, s[72:75], s54 offen
    v_smfmac_f32_16x16x64_bf16 a[4:7], a[16:19], v[40:47], v11
    v_rcp_f32 v12, v12
    v_mfma_f32_16x16x32_bf16 v[16:19], a[64:67], v[112:115], v[60:63]
    v_exp_f32 v28, v28
    v_mfma_f32_16x16x32_bf16 v[16:19], a[68:71], v[116:119], v[16:19]
    v_cvt_pk_bf16_f32 v37, v26, v27
    v_mul_f32 v128, v128, v12
    v_mfma_f32_16x16x32_bf16 v[16:19], a[72:75], v[120:123], v[16:19]
    s_mov_b32 s54, 884736
    v_exp_f32 v29, v29
    v_mfma_f32_16x16x32_bf16 v[16:19], a[76:79], v[124:127], v[16:19]
    buffer_load_dwordx4 a[152:155], v6, s[68:71], s54 offen
    v_mfma_f32_16x16x32_bf16 v[20:23], a[80:83], v[112:115], v[60:63]
    v_exp_f32 v30, v30
    v_mfma_f32_16x16x32_bf16 v[20:23], a[84:87], v[116:119], v[20:23]
    v_cvt_pk_bf16_f32 v38, v28, v29
    v_mul_f32 v129, v129, v12
    v_mfma_f32_16x16x32_bf16 v[20:23], a[88:91], v[120:123], v[20:23]
    s_add_u32 s54, s55, 6144
    v_exp_f32 v31, v31
    v_mfma_f32_16x16x32_bf16 v[20:23], a[92:95], v[124:127], v[20:23]
    buffer_load_dwordx4 a[188:191], v8, s[72:75], s54 offen
    v_mfma_f32_16x16x32_bf16 v[24:27], a[96:99], v[112:115], v[60:63]
    v_exp_f32 v16, v16
    v_mfma_f32_16x16x32_bf16 v[24:27], a[100:103], v[116:119], v[24:27]
    v_cvt_pk_bf16_f32 v39, v30, v31
    v_mul_f32 v130, v130, v12
    v_mfma_f32_16x16x32_bf16 v[24:27], a[104:107], v[120:123], v[24:27]
    s_mov_b32 s54, 1032192
    v_exp_f32 v17, v17
    v_mfma_f32_16x16x32_bf16 v[24:27], a[108:111], v[124:127], v[24:27]
    buffer_load_dwordx4 a[156:159], v6, s[68:71], s54 offen
    v_mfma_f32_16x16x32_bf16 v[28:31], a[112:115], v[112:115], v[60:63]
    v_exp_f32 v18, v18
    v_mfma_f32_16x16x32_bf16 v[28:31], a[116:119], v[116:119], v[28:31]
    v_cvt_pk_bf16_f32 v40, v16, v17
    v_mul_f32 v131, v131, v12
    v_mfma_f32_16x16x32_bf16 v[28:31], a[120:123], v[120:123], v[28:31]
    s_mov_b32 s54, 1179648
    v_exp_f32 v19, v19
    v_mfma_f32_16x16x32_bf16 v[28:31], a[124:127], v[124:127], v[28:31]
    buffer_load_dwordx4 a[160:163], v6, s[68:71], s54 offen
    v_mfma_f32_16x16x32_bf16 v[192:195], a[192:195], v[32:35], v[192:195]
    v_exp_f32 v20, v20
    v_mfma_f32_16x16x32_bf16 v[192:195], a[196:199], v[36:39], v[192:195]
    v_cvt_pk_bf16_f32 v41, v18, v19
    v_mul_f32 v132, v132, v12
    v_mfma_f32_16x16x32_bf16 v[196:199], a[200:203], v[32:35], v[196:199]
    v_exp_f32 v21, v21
    v_mfma_f32_16x16x32_bf16 v[196:199], a[204:207], v[36:39], v[196:199]
    v_mul_f32 v133, v133, v12
    v_mul_f32 v134, v134, v12
    v_mfma_f32_16x16x32_bf16 v[200:203], a[208:211], v[32:35], v[200:203]
    v_exp_f32 v22, v22
    v_mfma_f32_16x16x32_bf16 v[200:203], a[212:215], v[36:39], v[200:203]
    v_cvt_pk_bf16_f32 v42, v20, v21
    v_mul_f32 v135, v135, v12
    v_mfma_f32_16x16x32_bf16 v[204:207], a[216:219], v[32:35], v[204:207]
    v_exp_f32 v23, v23
    v_mfma_f32_16x16x32_bf16 v[204:207], a[220:223], v[36:39], v[204:207]
    v_cvt_pk_bf16_f32 v128, v128, v129
    v_cvt_pk_bf16_f32 v129, v130, v131
    v_mfma_f32_16x16x32_bf16 v[208:211], a[224:227], v[32:35], v[208:211]
    v_exp_f32 v24, v24
    v_mfma_f32_16x16x32_bf16 v[208:211], a[228:231], v[36:39], v[208:211]
    v_cvt_pk_bf16_f32 v43, v22, v23
    v_cvt_pk_bf16_f32 v130, v132, v133
    v_mfma_f32_16x16x32_bf16 v[212:215], a[232:235], v[32:35], v[212:215]
    v_exp_f32 v25, v25
    v_mfma_f32_16x16x32_bf16 v[212:215], a[236:239], v[36:39], v[212:215]
    v_cvt_pk_bf16_f32 v131, v134, v135
    v_mul_f32 v136, v136, v12
    v_mfma_f32_16x16x32_bf16 v[216:219], a[240:243], v[32:35], v[216:219]
    v_exp_f32 v26, v26
    v_mfma_f32_16x16x32_bf16 v[216:219], a[244:247], v[36:39], v[216:219]
    v_cvt_pk_bf16_f32 v44, v24, v25
    v_mul_f32 v137, v137, v12
    v_mfma_f32_16x16x32_bf16 v[220:223], a[248:251], v[32:35], v[220:223]
    v_exp_f32 v27, v27
    v_mfma_f32_16x16x32_bf16 v[220:223], a[252:255], v[36:39], v[220:223]
    v_mul_f32 v138, v138, v12
    v_mul_f32 v139, v139, v12
    v_smfmac_f32_16x16x64_bf16 a[8:11], a[16:19], v[32:39], v11
    v_mul_f32 v140, v140, v12
    v_mul_f32 v141, v141, v12
    v_exp_f32 v28, v28
    s_nop 0
    v_cvt_pk_bf16_f32 v45, v26, v27
    v_exp_f32 v29, v29
    s_nop 0
    v_exp_f32 v30, v30
    s_nop 0
    v_cvt_pk_bf16_f32 v46, v28, v29
    v_exp_f32 v31, v31
    s_nop 0
    v_cvt_pk_bf16_f32 v47, v30, v31
    s_nop 1
    v_mfma_f32_16x16x32_bf16 v[224:227], a[192:195], v[40:43], v[224:227]
    v_mul_f32 v142, v142, v12
    v_mul_f32 v143, v143, v12
    v_mfma_f32_16x16x32_bf16 v[224:227], a[196:199], v[44:47], v[224:227]
    ds_read_b64_tr_b16 a[64:65], v4 offset:0
    ds_read_b64_tr_b16 a[66:67], v4 offset:128
    v_mfma_f32_16x16x32_bf16 v[228:231], a[200:203], v[40:43], v[228:231]
    ds_read_b64_tr_b16 a[68:69], v4 offset:256
    ds_read_b64_tr_b16 a[70:71], v4 offset:384
    v_mfma_f32_16x16x32_bf16 v[228:231], a[204:207], v[44:47], v[228:231]
    ds_read_b64_tr_b16 a[72:73], v4 offset:512
    ds_read_b64_tr_b16 a[74:75], v4 offset:640
    v_mfma_f32_16x16x32_bf16 v[232:235], a[208:211], v[40:43], v[232:235]
    ds_read_b64_tr_b16 a[76:77], v4 offset:768
    ds_read_b64_tr_b16 a[78:79], v4 offset:896
    v_mfma_f32_16x16x32_bf16 v[232:235], a[212:215], v[44:47], v[232:235]
    ds_read_b64_tr_b16 a[80:81], v4 offset:16896
    ds_read_b64_tr_b16 a[82:83], v4 offset:17024
    v_mfma_f32_16x16x32_bf16 v[236:239], a[216:219], v[40:43], v[236:239]
    ds_read_b64_tr_b16 a[84:85], v4 offset:17152
    ds_read_b64_tr_b16 a[86:87], v4 offset:17280
    v_mfma_f32_16x16x32_bf16 v[236:239], a[220:223], v[44:47], v[236:239]
    ds_read_b64_tr_b16 a[88:89], v4 offset:17408
    ds_read_b64_tr_b16 a[90:91], v4 offset:17536
    v_mfma_f32_16x16x32_bf16 v[240:243], a[224:227], v[40:43], v[240:243]
    ds_read_b64_tr_b16 a[92:93], v4 offset:17664
    ds_read_b64_tr_b16 a[94:95], v4 offset:17792
    v_mfma_f32_16x16x32_bf16 v[240:243], a[228:231], v[44:47], v[240:243]
    v_cvt_pk_bf16_f32 v136, v136, v137
    v_cvt_pk_bf16_f32 v137, v138, v139
    v_mfma_f32_16x16x32_bf16 v[244:247], a[232:235], v[40:43], v[244:247]
    v_cvt_pk_bf16_f32 v138, v140, v141
    v_cvt_pk_bf16_f32 v139, v142, v143
    v_mfma_f32_16x16x32_bf16 v[244:247], a[236:239], v[44:47], v[244:247]
    v_mul_f32 v144, v144, v12
    v_mul_f32 v145, v145, v12
    v_mfma_f32_16x16x32_bf16 v[248:251], a[240:243], v[40:43], v[248:251]
    v_mul_f32 v146, v146, v12
    v_mul_f32 v147, v147, v12
    v_mfma_f32_16x16x32_bf16 v[248:251], a[244:247], v[44:47], v[248:251]
    v_mul_f32 v148, v148, v12
    v_mul_f32 v149, v149, v12
    v_mfma_f32_16x16x32_bf16 v[252:255], a[248:251], v[40:43], v[252:255]
    v_mul_f32 v150, v150, v12
    v_mul_f32 v151, v151, v12
    v_mfma_f32_16x16x32_bf16 v[252:255], a[252:255], v[44:47], v[252:255]
    v_cvt_pk_bf16_f32 v144, v144, v145
    v_cvt_pk_bf16_f32 v145, v146, v147
    v_smfmac_f32_16x16x64_bf16 a[12:15], a[16:19], v[40:47], v11
    v_cvt_pk_bf16_f32 v146, v148, v149
    v_cvt_pk_bf16_f32 v147, v150, v151
    v_mul_f32 v152, v152, v12
    v_mul_f32 v153, v153, v12
    v_mul_f32 v154, v154, v12
    v_mul_f32 v155, v155, v12
    v_mul_f32 v156, v156, v12
    v_mul_f32 v157, v157, v12
    v_mul_f32 v158, v158, v12
    v_mul_f32 v159, v159, v12
    v_cvt_pk_bf16_f32 v152, v152, v153
    v_cvt_pk_bf16_f32 v153, v154, v155
    v_cvt_pk_bf16_f32 v154, v156, v157
    v_cvt_pk_bf16_f32 v155, v158, v159
    v_accvgpr_read_b32 v14, a4
    v_accvgpr_read_b32 v15, a5
    v_add_f32 v14, v14, v15
    v_cmp_nlt_f32 s[58:59], v14, s15
    v_rcp_f32 v14, v14
    v_accvgpr_read_b32 v12, a8
    v_accvgpr_read_b32 v13, a9
    v_add_f32 v12, v12, v13
    v_cmp_nlt_f32 s[60:61], v12, s15
    v_rcp_f32 v12, v12
    v_pk_mul_f32 v[160:161], v[160:161], v[14:15] op_sel_hi:[1,0]
    v_pk_mul_f32 v[162:163], v[162:163], v[14:15] op_sel_hi:[1,0]
    v_pk_mul_f32 v[164:165], v[164:165], v[14:15] op_sel_hi:[1,0]
    v_pk_mul_f32 v[166:167], v[166:167], v[14:15] op_sel_hi:[1,0]
    v_cvt_pk_bf16_f32 v160, v160, v161
    v_cvt_pk_bf16_f32 v161, v162, v163
    v_cvt_pk_bf16_f32 v162, v164, v165
    v_cvt_pk_bf16_f32 v163, v166, v167
    v_pk_mul_f32 v[168:169], v[168:169], v[14:15] op_sel_hi:[1,0]
    v_pk_mul_f32 v[170:171], v[170:171], v[14:15] op_sel_hi:[1,0]
    v_pk_mul_f32 v[172:173], v[172:173], v[14:15] op_sel_hi:[1,0]
    v_pk_mul_f32 v[174:175], v[174:175], v[14:15] op_sel_hi:[1,0]
    v_cvt_pk_bf16_f32 v168, v168, v169
    v_cvt_pk_bf16_f32 v169, v170, v171
    v_cvt_pk_bf16_f32 v170, v172, v173
    v_cvt_pk_bf16_f32 v171, v174, v175
    v_pk_mul_f32 v[176:177], v[176:177], v[14:15] op_sel_hi:[1,0]
    v_pk_mul_f32 v[178:179], v[178:179], v[14:15] op_sel_hi:[1,0]
    v_pk_mul_f32 v[180:181], v[180:181], v[14:15] op_sel_hi:[1,0]
    v_pk_mul_f32 v[182:183], v[182:183], v[14:15] op_sel_hi:[1,0]
    v_cvt_pk_bf16_f32 v176, v176, v177
    v_cvt_pk_bf16_f32 v177, v178, v179
    v_cvt_pk_bf16_f32 v178, v180, v181
    v_cvt_pk_bf16_f32 v179, v182, v183
    v_pk_mul_f32 v[184:185], v[184:185], v[14:15] op_sel_hi:[1,0]
    v_pk_mul_f32 v[186:187], v[186:187], v[14:15] op_sel_hi:[1,0]
    v_pk_mul_f32 v[188:189], v[188:189], v[14:15] op_sel_hi:[1,0]
    v_pk_mul_f32 v[190:191], v[190:191], v[14:15] op_sel_hi:[1,0]
    v_cvt_pk_bf16_f32 v184, v184, v185
    v_cvt_pk_bf16_f32 v185, v186, v187
    v_cvt_pk_bf16_f32 v186, v188, v189
    v_cvt_pk_bf16_f32 v187, v190, v191
    v_accvgpr_read_b32 v14, a12
    v_accvgpr_read_b32 v15, a13
    v_add_f32 v14, v14, v15
    v_cmp_nlt_f32 s[62:63], v14, s15
    s_or_b64 s[56:57], s[56:57], s[58:59]
    v_rcp_f32 v14, v14
    s_or_b64 s[60:61], s[60:61], s[62:63]
    s_or_b64 s[56:57], s[56:57], s[60:61]
    s_cselect_b32 s3, 1, 0
    s_andn2_b32 s3, s3, s50
    s_lshl2_add_u32 s14, s51, 13824
    v_mov_b32 v56, s3
    v_mov_b32 v57, s14
    v_mov_b32 v58, 13824
    ds_write_b32 v57, v56
    v_pk_mul_f32 v[192:193], v[192:193], v[12:13] op_sel_hi:[1,0]
    v_pk_mul_f32 v[194:195], v[194:195], v[12:13] op_sel_hi:[1,0]
    v_pk_mul_f32 v[196:197], v[196:197], v[12:13] op_sel_hi:[1,0]
    v_pk_mul_f32 v[198:199], v[198:199], v[12:13] op_sel_hi:[1,0]
    v_cvt_pk_bf16_f32 v192, v192, v193
    v_cvt_pk_bf16_f32 v193, v194, v195
    v_cvt_pk_bf16_f32 v194, v196, v197
    v_cvt_pk_bf16_f32 v195, v198, v199
    v_pk_mul_f32 v[200:201], v[200:201], v[12:13] op_sel_hi:[1,0]
    v_pk_mul_f32 v[202:203], v[202:203], v[12:13] op_sel_hi:[1,0]
    v_pk_mul_f32 v[204:205], v[204:205], v[12:13] op_sel_hi:[1,0]
    v_pk_mul_f32 v[206:207], v[206:207], v[12:13] op_sel_hi:[1,0]
    v_cvt_pk_bf16_f32 v200, v200, v201
    v_cvt_pk_bf16_f32 v201, v202, v203
    v_cvt_pk_bf16_f32 v202, v204, v205
    v_cvt_pk_bf16_f32 v203, v206, v207
    v_pk_mul_f32 v[208:209], v[208:209], v[12:13] op_sel_hi:[1,0]
    v_pk_mul_f32 v[210:211], v[210:211], v[12:13] op_sel_hi:[1,0]
    v_pk_mul_f32 v[212:213], v[212:213], v[12:13] op_sel_hi:[1,0]
    v_pk_mul_f32 v[214:215], v[214:215], v[12:13] op_sel_hi:[1,0]
    v_cvt_pk_bf16_f32 v208, v208, v209
    v_cvt_pk_bf16_f32 v209, v210, v211
    v_cvt_pk_bf16_f32 v210, v212, v213
    v_cvt_pk_bf16_f32 v211, v214, v215
    v_pk_mul_f32 v[216:217], v[216:217], v[12:13] op_sel_hi:[1,0]
    v_pk_mul_f32 v[218:219], v[218:219], v[12:13] op_sel_hi:[1,0]
    v_pk_mul_f32 v[220:221], v[220:221], v[12:13] op_sel_hi:[1,0]
    v_pk_mul_f32 v[222:223], v[222:223], v[12:13] op_sel_hi:[1,0]
    v_cvt_pk_bf16_f32 v216, v216, v217
    v_cvt_pk_bf16_f32 v217, v218, v219
    v_cvt_pk_bf16_f32 v218, v220, v221
    v_cvt_pk_bf16_f32 v219, v222, v223
    v_pk_mul_f32 v[224:225], v[224:225], v[14:15] op_sel_hi:[1,0]
    v_pk_mul_f32 v[226:227], v[226:227], v[14:15] op_sel_hi:[1,0]
    v_pk_mul_f32 v[228:229], v[228:229], v[14:15] op_sel_hi:[1,0]
    v_pk_mul_f32 v[230:231], v[230:231], v[14:15] op_sel_hi:[1,0]
    v_cvt_pk_bf16_f32 v224, v224, v225
    v_cvt_pk_bf16_f32 v225, v226, v227
    v_cvt_pk_bf16_f32 v226, v228, v229
    v_cvt_pk_bf16_f32 v227, v230, v231
    v_pk_mul_f32 v[232:233], v[232:233], v[14:15] op_sel_hi:[1,0]
    v_pk_mul_f32 v[234:235], v[234:235], v[14:15] op_sel_hi:[1,0]
    v_pk_mul_f32 v[236:237], v[236:237], v[14:15] op_sel_hi:[1,0]
    v_pk_mul_f32 v[238:239], v[238:239], v[14:15] op_sel_hi:[1,0]
    v_cvt_pk_bf16_f32 v232, v232, v233
    v_cvt_pk_bf16_f32 v233, v234, v235
    v_cvt_pk_bf16_f32 v234, v236, v237
    v_cvt_pk_bf16_f32 v235, v238, v239
    v_pk_mul_f32 v[240:241], v[240:241], v[14:15] op_sel_hi:[1,0]
    v_pk_mul_f32 v[242:243], v[242:243], v[14:15] op_sel_hi:[1,0]
    v_pk_mul_f32 v[244:245], v[244:245], v[14:15] op_sel_hi:[1,0]
    v_pk_mul_f32 v[246:247], v[246:247], v[14:15] op_sel_hi:[1,0]
    v_cvt_pk_bf16_f32 v240, v240, v241
    v_cvt_pk_bf16_f32 v241, v242, v243
    v_cvt_pk_bf16_f32 v242, v244, v245
    v_cvt_pk_bf16_f32 v243, v246, v247
    v_pk_mul_f32 v[248:249], v[248:249], v[14:15] op_sel_hi:[1,0]
    v_pk_mul_f32 v[250:251], v[250:251], v[14:15] op_sel_hi:[1,0]
    v_pk_mul_f32 v[252:253], v[252:253], v[14:15] op_sel_hi:[1,0]
    v_pk_mul_f32 v[254:255], v[254:255], v[14:15] op_sel_hi:[1,0]
    v_cvt_pk_bf16_f32 v248, v248, v249
    v_cvt_pk_bf16_f32 v249, v250, v251
    v_cvt_pk_bf16_f32 v250, v252, v253
    v_cvt_pk_bf16_f32 v251, v254, v255
    s_waitcnt lgkmcnt(13)
    v_mfma_f32_16x16x32_bf16 v[16:19], a[64:67], v[128:131], 0
L2_pad9:
    s_cbranch_execz L2_pad13
    ds_read_b64_tr_b16 a[96:97], v4 offset:32
    ds_read_b64_tr_b16 a[98:99], v4 offset:160
    v_mfma_f32_16x16x32_bf16 v[16:19], a[68:71], v[136:139], v[16:19]
    s_waitcnt lgkmcnt(11)
    ds_read_b64_tr_b16 a[100:101], v4 offset:288
    ds_read_b64_tr_b16 a[102:103], v4 offset:416
    v_mfma_f32_16x16x32_bf16 v[16:19], a[72:75], v[144:147], v[16:19]
    s_add_u32 s54, s55, 7168
    ds_read_b64_tr_b16 a[104:105], v4 offset:544
    v_mfma_f32_16x16x32_bf16 v[16:19], a[76:79], v[152:155], v[16:19]
    s_waitcnt lgkmcnt(10)
    buffer_load_dwordx4 a[192:195], v8, s[72:75], s54 offen
    v_mfma_f32_16x16x32_bf16 v[16:19], a[80:83], v[192:195], v[16:19]
    ds_read_b64_tr_b16 a[106:107], v4 offset:672
    v_mfma_f32_16x16x32_bf16 v[16:19], a[84:87], v[200:203], v[16:19]
    s_waitcnt lgkmcnt(7)
    ds_read_b64_tr_b16 a[108:109], v4 offset:800
    v_mfma_f32_16x16x32_bf16 v[16:19], a[88:91], v[208:211], v[16:19]
    s_add_u32 s54, s55, 8192
    ds_read_b64_tr_b16 a[110:111], v4 offset:928
    v_mfma_f32_16x16x32_bf16 v[16:19], a[92:95], v[216:219], v[16:19]
    buffer_load_dwordx4 a[196:199], v8, s[72:75], s54 offen
    v_mfma_f32_16x16x32_bf16 v[20:23], a[64:67], v[160:163], 0
    ds_read_b64_tr_b16 a[112:113], v4 offset:16928
    v_mfma_f32_16x16x32_bf16 v[20:23], a[68:71], v[168:171], v[20:23]
    ds_read_b64_tr_b16 a[114:115], v4 offset:17056
    v_mfma_f32_16x16x32_bf16 v[20:23], a[72:75], v[176:179], v[20:23]
    ds_read_b64_tr_b16 a[116:117], v4 offset:17184
    v_mfma_f32_16x16x32_bf16 v[20:23], a[76:79], v[184:187], v[20:23]
    ds_read_b64_tr_b16 a[118:119], v4 offset:17312
    v_mfma_f32_16x16x32_bf16 v[20:23], a[80:83], v[224:227], v[20:23]
    ds_read_b64_tr_b16 a[120:121], v4 offset:17440
    v_mfma_f32_16x16x32_bf16 v[20:23], a[84:87], v[232:235], v[20:23]
    ds_read_b64_tr_b16 a[122:123], v4 offset:17568
    v_mfma_f32_16x16x32_bf16 v[20:23], a[88:91], v[240:243], v[20:23]
    ds_read_b64_tr_b16 a[124:125], v4 offset:17696
    v_mfma_f32_16x16x32_bf16 v[20:23], a[92:95], v[248:251], v[20:23]
    s_waitcnt lgkmcnt(11)
    ds_read_b64_tr_b16 a[126:127], v4 offset:17824
    v_mfma_f32_16x16x32_bf16 v[24:27], a[96:99], v[128:131], 0
    ds_read_b64_tr_b16 a[64:65], v4 offset:64
    v_mfma_f32_16x16x32_bf16 v[24:27], a[100:103], v[136:139], v[24:27]
    s_waitcnt lgkmcnt(9)
    ds_read_b64_tr_b16 a[66:67], v4 offset:192
    v_mfma_f32_16x16x32_bf16 v[24:27], a[104:107], v[144:147], v[24:27]
    ds_read_b64_tr_b16 a[68:69], v4 offset:320
    v_mfma_f32_16x16x32_bf16 v[24:27], a[108:111], v[152:155], v[24:27]
    s_waitcnt lgkmcnt(7)
    ds_read_b64_tr_b16 a[70:71], v4 offset:448
    v_mfma_f32_16x16x32_bf16 v[24:27], a[112:115], v[192:195], v[24:27]
    ds_read_b64_tr_b16 a[72:73], v4 offset:576
    v_mfma_f32_16x16x32_bf16 v[24:27], a[116:119], v[200:203], v[24:27]
    s_waitcnt lgkmcnt(5)
    ds_read_b64_tr_b16 a[74:75], v4 offset:704
    v_mfma_f32_16x16x32_bf16 v[24:27], a[120:123], v[208:211], v[24:27]
    ds_read_b64_tr_b16 a[76:77], v4 offset:832
    v_mfma_f32_16x16x32_bf16 v[24:27], a[124:127], v[216:219], v[24:27]
    ds_read_b64_tr_b16 a[78:79], v4 offset:960
    v_mfma_f32_16x16x32_bf16 v[28:31], a[96:99], v[160:163], 0
    ds_read_b64_tr_b16 a[80:81], v4 offset:16960
    v_mfma_f32_16x16x32_bf16 v[28:31], a[100:103], v[168:171], v[28:31]
    ds_read_b64_tr_b16 a[82:83], v4 offset:17088
    v_mfma_f32_16x16x32_bf16 v[28:31], a[104:107], v[176:179], v[28:31]
    ds_read_b64_tr_b16 a[84:85], v4 offset:17216
    v_mfma_f32_16x16x32_bf16 v[28:31], a[108:111], v[184:187], v[28:31]
    ds_read_b64_tr_b16 a[86:87], v4 offset:17344
    v_mfma_f32_16x16x32_bf16 v[28:31], a[112:115], v[224:227], v[28:31]
    ds_read_b64_tr_b16 a[88:89], v4 offset:17472
    v_mfma_f32_16x16x32_bf16 v[28:31], a[116:119], v[232:235], v[28:31]
    ds_read_b64_tr_b16 a[90:91], v4 offset:17600
    v_mfma_f32_16x16x32_bf16 v[28:31], a[120:123], v[240:243], v[28:31]
    ds_read_b64_tr_b16 a[92:93], v4 offset:17728
    v_mfma_f32_16x16x32_bf16 v[28:31], a[124:127], v[248:251], v[28:31]
    s_waitcnt lgkmcnt(11)
    ds_read_b64_tr_b16 a[94:95], v4 offset:17856
    v_mfma_f32_16x16x32_bf16 v[32:35], a[64:67], v[128:131], 0
    ds_read_b64_tr_b16 a[96:97], v4 offset:96
    v_cvt_pk_bf16_f32 v48, v16, v17
    v_mfma_f32_16x16x32_bf16 v[32:35], a[68:71], v[136:139], v[32:35]
    s_waitcnt lgkmcnt(9)
    ds_read_b64_tr_b16 a[98:99], v4 offset:224
    v_cvt_pk_bf16_f32 v49, v18, v19
    v_mfma_f32_16x16x32_bf16 v[32:35], a[72:75], v[144:147], v[32:35]
    ds_read_b64_tr_b16 a[100:101], v4 offset:352
    v_cvt_pk_bf16_f32 v50, v24, v25
    v_mfma_f32_16x16x32_bf16 v[32:35], a[76:79], v[152:155], v[32:35]
    s_waitcnt lgkmcnt(7)
    ds_read_b64_tr_b16 a[102:103], v4 offset:480
    v_cvt_pk_bf16_f32 v51, v26, v27
    v_mfma_f32_16x16x32_bf16 v[32:35], a[80:83], v[192:195], v[32:35]
    s_mov_b32 s54, 0
    ds_read_b64_tr_b16 a[104:105], v4 offset:608
    ds_read_b64_tr_b16 a[106:107], v4 offset:736
    v_mfma_f32_16x16x32_bf16 v[32:35], a[84:87], v[200:203], v[32:35]
    s_waitcnt lgkmcnt(6)
    v_permlane32_swap_b32 v48, v50
    v_mfma_f32_16x16x32_bf16 v[32:35], a[88:91], v[208:211], v[32:35]
    v_permlane32_swap_b32 v49, v51
    v_mfma_f32_16x16x32_bf16 v[32:35], a[92:95], v[216:219], v[32:35]
    ds_read_b64_tr_b16 a[108:109], v4 offset:864
    ds_read_b64_tr_b16 a[110:111], v4 offset:992
    buffer_store_dwordx4 v[48:51], v10, s[40:43], s54 offen offset:0 sc1
    v_mfma_f32_16x16x32_bf16 v[36:39], a[64:67], v[160:163], 0
    ds_read_b64_tr_b16 a[112:113], v4 offset:16992
    v_cvt_pk_bf16_f32 v52, v20, v21
    v_mfma_f32_16x16x32_bf16 v[36:39], a[68:71], v[168:171], v[36:39]
    ds_read_b64_tr_b16 a[114:115], v4 offset:17120
    v_cvt_pk_bf16_f32 v53, v22, v23
    v_mfma_f32_16x16x32_bf16 v[36:39], a[72:75], v[176:179], v[36:39]
    ds_read_b64_tr_b16 a[116:117], v4 offset:17248
    v_cvt_pk_bf16_f32 v54, v28, v29
    v_mfma_f32_16x16x32_bf16 v[36:39], a[76:79], v[184:187], v[36:39]
    ds_read_b64_tr_b16 a[118:119], v4 offset:17376
    v_cvt_pk_bf16_f32 v55, v30, v31
    v_mfma_f32_16x16x32_bf16 v[36:39], a[80:83], v[224:227], v[36:39]
    s_mov_b32 s54, 294912
    ds_read_b64_tr_b16 a[120:121], v4 offset:17504
    ds_read_b64_tr_b16 a[122:123], v4 offset:17632
    v_mfma_f32_16x16x32_bf16 v[36:39], a[84:87], v[232:235], v[36:39]
    v_permlane32_swap_b32 v52, v54
    v_mfma_f32_16x16x32_bf16 v[36:39], a[88:91], v[240:243], v[36:39]
    v_permlane32_swap_b32 v53, v55
    v_mfma_f32_16x16x32_bf16 v[36:39], a[92:95], v[248:251], v[36:39]
    s_barrier
    s_waitcnt lgkmcnt(10)
    ds_read_b64_tr_b16 a[124:125], v4 offset:17760
    ds_read_b64_tr_b16 a[126:127], v4 offset:17888
    ds_read_b128 v[60:63], v58
    buffer_store_dwordx4 v[52:55], v10, s[40:43], s54 offen offset:0 sc1
    v_mfma_f32_16x16x32_bf16 v[40:43], a[96:99], v[128:131], 0
    s_add_u32 m0, s44, 36864
    ds_read_b64_tr_b16 a[64:65], v4 offset:36864
    ds_read_b64_tr_b16 a[66:67], v4 offset:36992
    v_mfma_f32_16x16x32_bf16 v[40:43], a[100:103], v[136:139], v[40:43]
    s_mov_b32 s45, 384
    s_waitcnt lgkmcnt(11)
    buffer_load_dwordx4 v7, s[28:31], s45 offen offset:0 lds
    v_mfma_f32_16x16x32_bf16 v[40:43], a[104:107], v[144:147], v[40:43]
    s_add_u32 m0, s44, 36768
    ds_read_b64_tr_b16 a[68:69], v4 offset:37120
    ds_read_b64_tr_b16 a[70:71], v4 offset:37248
    v_mfma_f32_16x16x32_bf16 v[40:43], a[108:111], v[152:155], v[40:43]
    s_waitcnt lgkmcnt(9)
    buffer_load_dwordx4 v7, s[28:31], s45 offen offset:1152 lds
    v_mfma_f32_16x16x32_bf16 v[40:43], a[112:115], v[192:195], v[40:43]
    s_add_u32 m0, s44, 36672
    ds_read_b64_tr_b16 a[72:73], v4 offset:37376
    ds_read_b64_tr_b16 a[74:75], v4 offset:37504
    v_mfma_f32_16x16x32_bf16 v[40:43], a[116:119], v[200:203], v[40:43]
    s_waitcnt lgkmcnt(7)
    buffer_load_dwordx4 v7, s[28:31], s45 offen offset:2304 lds
    v_mfma_f32_16x16x32_bf16 v[40:43], a[120:123], v[208:211], v[40:43]
    s_add_u32 m0, s44, 36576
    ds_read_b64_tr_b16 a[76:77], v4 offset:37632
    ds_read_b64_tr_b16 a[78:79], v4 offset:37760
    v_mfma_f32_16x16x32_bf16 v[40:43], a[124:127], v[216:219], v[40:43]
    s_waitcnt lgkmcnt(8)
    buffer_load_dwordx4 v7, s[28:31], s45 offen offset:3456 lds
    v_or3_b32 v60, v60, v61, v62
    v_or_b32 v60, v60, v63
    v_mfma_f32_16x16x32_bf16 v[44:47], a[96:99], v[160:163], 0
    s_add_u32 m0, s44, 53760
    ds_read_b64_tr_b16 a[80:81], v4 offset:53760
    ds_read_b64_tr_b16 a[82:83], v4 offset:53888
    v_mfma_f32_16x16x32_bf16 v[44:47], a[100:103], v[168:171], v[44:47]
    s_mov_b32 s45, 147840
    buffer_load_dwordx4 v7, s[28:31], s45 offen offset:0 lds
    v_mfma_f32_16x16x32_bf16 v[44:47], a[104:107], v[176:179], v[44:47]
    s_add_u32 m0, s44, 53664
    ds_read_b64_tr_b16 a[84:85], v4 offset:54016
    ds_read_b64_tr_b16 a[86:87], v4 offset:54144
    v_mfma_f32_16x16x32_bf16 v[44:47], a[108:111], v[184:187], v[44:47]
    buffer_load_dwordx4 v7, s[28:31], s45 offen offset:1152 lds
    v_mfma_f32_16x16x32_bf16 v[44:47], a[112:115], v[224:227], v[44:47]
    s_add_u32 m0, s44, 53568
    ds_read_b64_tr_b16 a[88:89], v4 offset:54272
    ds_read_b64_tr_b16 a[90:91], v4 offset:54400
    v_mfma_f32_16x16x32_bf16 v[44:47], a[116:119], v[232:235], v[44:47]
    buffer_load_dwordx4 v7, s[28:31], s45 offen offset:2304 lds
    v_mfma_f32_16x16x32_bf16 v[44:47], a[120:123], v[240:243], v[44:47]
    s_add_u32 m0, s44, 53472
    ds_read_b64_tr_b16 a[92:93], v4 offset:54528
    ds_read_b64_tr_b16 a[94:95], v4 offset:54656
    v_mfma_f32_16x16x32_bf16 v[44:47], a[124:127], v[248:251], v[44:47]
    s_waitcnt lgkmcnt(12)
    buffer_load_dwordx4 v7, s[28:31], s45 offen offset:3456 lds
    v_readfirstlane_b32 s3, v60
    v_mfma_f32_16x16x32_bf16 v[16:19], a[64:67], v[128:131], 0
    ds_read_b64_tr_b16 a[96:97], v4 offset:36896
    v_cvt_pk_bf16_f32 v48, v32, v33
    v_mfma_f32_16x16x32_bf16 v[16:19], a[68:71], v[136:139], v[16:19]
    s_waitcnt lgkmcnt(9)
    s_cmp_lg_u32 s3, 0
    ds_read_b64_tr_b16 a[98:99], v4 offset:37024
    v_cvt_pk_bf16_f32 v49, v34, v35
    v_mfma_f32_16x16x32_bf16 v[16:19], a[72:75], v[144:147], v[16:19]
    s_cbranch_scc1 L2_fallback
    ds_read_b64_tr_b16 a[100:101], v4 offset:37152
    v_cvt_pk_bf16_f32 v50, v40, v41
    v_mfma_f32_16x16x32_bf16 v[16:19], a[76:79], v[152:155], v[16:19]
    s_waitcnt lgkmcnt(7)
    ds_read_b64_tr_b16 a[102:103], v4 offset:37280
    v_cvt_pk_bf16_f32 v51, v42, v43
    v_mfma_f32_16x16x32_bf16 v[16:19], a[80:83], v[192:195], v[16:19]
    s_mov_b32 s54, 0
    ds_read_b64_tr_b16 a[104:105], v4 offset:37408
    ds_read_b64_tr_b16 a[106:107], v4 offset:37536
    v_mfma_f32_16x16x32_bf16 v[16:19], a[84:87], v[200:203], v[16:19]
    s_waitcnt lgkmcnt(6)
    v_permlane32_swap_b32 v48, v50
    v_mfma_f32_16x16x32_bf16 v[16:19], a[88:91], v[208:211], v[16:19]
    v_permlane32_swap_b32 v49, v51
    v_mfma_f32_16x16x32_bf16 v[16:19], a[92:95], v[216:219], v[16:19]
    ds_read_b64_tr_b16 a[108:109], v4 offset:37664
    ds_read_b64_tr_b16 a[110:111], v4 offset:37792
    buffer_store_dwordx4 v[48:51], v10, s[40:43], s54 offen offset:512 sc1
    v_mfma_f32_16x16x32_bf16 v[20:23], a[64:67], v[160:163], 0
    ds_read_b64_tr_b16 a[112:113], v4 offset:53792
    v_cvt_pk_bf16_f32 v52, v36, v37
    v_mfma_f32_16x16x32_bf16 v[20:23], a[68:71], v[168:171], v[20:23]
    ds_read_b64_tr_b16 a[114:115], v4 offset:53920
    v_cvt_pk_bf16_f32 v53, v38, v39
    v_mfma_f32_16x16x32_bf16 v[20:23], a[72:75], v[176:179], v[20:23]
    ds_read_b64_tr_b16 a[116:117], v4 offset:54048
    v_cvt_pk_bf16_f32 v54, v44, v45
    v_mfma_f32_16x16x32_bf16 v[20:23], a[76:79], v[184:187], v[20:23]
    ds_read_b64_tr_b16 a[118:119], v4 offset:54176
    v_cvt_pk_bf16_f32 v55, v46, v47
    v_mfma_f32_16x16x32_bf16 v[20:23], a[80:83], v[224:227], v[20:23]
    s_mov_b32 s54, 294912
    ds_read_b64_tr_b16 a[120:121], v4 offset:54304
    ds_read_b64_tr_b16 a[122:123], v4 offset:54432
    v_mfma_f32_16x16x32_bf16 v[20:23], a[84:87], v[232:235], v[20:23]
    v_permlane32_swap_b32 v52, v54
    v_mfma_f32_16x16x32_bf16 v[20:23], a[88:91], v[240:243], v[20:23]
    v_permlane32_swap_b32 v53, v55
    v_mfma_f32_16x16x32_bf16 v[20:23], a[92:95], v[248:251], v[20:23]
    s_waitcnt lgkmcnt(10)
    ds_read_b64_tr_b16 a[124:125], v4 offset:54560
    ds_read_b64_tr_b16 a[126:127], v4 offset:54688
    buffer_store_dwordx4 v[52:55], v10, s[40:43], s54 offen offset:512 sc1
    v_mfma_f32_16x16x32_bf16 v[24:27], a[96:99], v[128:131], 0
    s_mul_i32 s3, s51, 128
    ds_read_b64_tr_b16 a[64:65], v4 offset:36928
    v_lshrrev_b32 v14, 3, v0
    v_mfma_f32_16x16x32_bf16 v[24:27], a[100:103], v[136:139], v[24:27]
    s_waitcnt lgkmcnt(9)
    ds_read_b64_tr_b16 a[66:67], v4 offset:37056
    v_lshl_add_u32 v12, v14, 4, s3
    v_mfma_f32_16x16x32_bf16 v[24:27], a[104:107], v[144:147], v[24:27]
    ds_read_b64_tr_b16 a[68:69], v4 offset:37184
    v_and_b32 v14, 1, v14
    v_mfma_f32_16x16x32_bf16 v[24:27], a[108:111], v[152:155], v[24:27]
    s_waitcnt lgkmcnt(7)
    s_mul_i32 s3, s51, 32
    ds_read_b64_tr_b16 a[70:71], v4 offset:37312
    v_lshl_add_u32 v13, v14, 4, s3
    v_mfma_f32_16x16x32_bf16 v[24:27], a[112:115], v[192:195], v[24:27]
    ds_read_b64_tr_b16 a[72:73], v4 offset:37440
    v_and_b32 v14, 7, v0
    v_mfma_f32_16x16x32_bf16 v[24:27], a[116:119], v[200:203], v[24:27]
    s_waitcnt lgkmcnt(5)
    ds_read_b64_tr_b16 a[74:75], v4 offset:37568
    v_mul_u32_u24 v14, 1152, v14
    v_mfma_f32_16x16x32_bf16 v[24:27], a[120:123], v[208:211], v[24:27]
    ds_read_b64_tr_b16 a[76:77], v4 offset:37696
    v_add_u32 v1, v14, v12
    v_mfma_f32_16x16x32_bf16 v[24:27], a[124:127], v[216:219], v[24:27]
    ds_read_b64_tr_b16 a[78:79], v4 offset:37824
    v_add_u32 v2, v14, v13
    v_mfma_f32_16x16x32_bf16 v[28:31], a[96:99], v[160:163], 0
    ds_read_b64_tr_b16 a[80:81], v4 offset:53824
    v_add_u32 v2, 1024, v2
    v_mfma_f32_16x16x32_bf16 v[28:31], a[100:103], v[168:171], v[28:31]
    s_lshl_b32 s14, s51, 10
    ds_read_b64_tr_b16 a[82:83], v4 offset:53952
    v_add_u32 v5, s14, v8
    v_mfma_f32_16x16x32_bf16 v[28:31], a[104:107], v[176:179], v[28:31]
    ds_read_b64_tr_b16 a[84:85], v4 offset:54080
    v_and_b32 v59, 0xf0, v8
    v_mfma_f32_16x16x32_bf16 v[28:31], a[108:111], v[184:187], v[28:31]
    s_lshl_b32 s14, s51, 8
    ds_read_b64_tr_b16 a[86:87], v4 offset:54208
    v_add_u32 v59, s14, v59
    v_mfma_f32_16x16x32_bf16 v[28:31], a[112:115], v[224:227], v[28:31]
    ds_read_b64_tr_b16 a[88:89], v4 offset:54336
    v_and_b32 v6, 15, v0
    v_mfma_f32_16x16x32_bf16 v[28:31], a[116:119], v[232:235], v[28:31]
    ds_read_b64_tr_b16 a[90:91], v4 offset:54464
    v_lshlrev_b32 v6, 8, v6
    v_mfma_f32_16x16x32_bf16 v[28:31], a[120:123], v[240:243], v[28:31]
    ds_read_b64_tr_b16 a[92:93], v4 offset:54592
    v_min_u32 v15, 1, v0
    v_mfma_f32_16x16x32_bf16 v[28:31], a[124:127], v[248:251], v[28:31]
    s_waitcnt lgkmcnt(11)
    ds_read_b64_tr_b16 a[94:95], v4 offset:54720
    v_lshlrev_b32 v15, 30, v15
    v_mfma_f32_16x16x32_bf16 v[32:35], a[64:67], v[128:131], 0
    s_lshl_b32 s15, s53, 14
    s_add_u32 s15, s15, 786432
    s_and_b32 s14, s52, 12
    s_lshl_b32 s14, s14, 10
    s_add_u32 s47, s15, s14
    s_lshl4_add_u32 s3, s51, s52
    s_lshl_b32 s3, s3, 8
    s_add_u32 s56, s3, s15
    s_add_u32 s14, s55, 16384
    ds_read_b64_tr_b16 a[96:97], v4 offset:36960
    v_cvt_pk_bf16_f32 v48, v16, v17
    v_mfma_f32_16x16x32_bf16 v[32:35], a[68:71], v[136:139], v[32:35]
    s_waitcnt lgkmcnt(9)
    ds_read_b64_tr_b16 a[98:99], v4 offset:37088
    v_cvt_pk_bf16_f32 v49, v18, v19
    v_mfma_f32_16x16x32_bf16 v[32:35], a[72:75], v[144:147], v[32:35]
    ds_read_b64_tr_b16 a[100:101], v4 offset:37216
    v_cvt_pk_bf16_f32 v50, v24, v25
    v_mfma_f32_16x16x32_bf16 v[32:35], a[76:79], v[152:155], v[32:35]
    s_waitcnt lgkmcnt(7)
    ds_read_b64_tr_b16 a[102:103], v4 offset:37344
    v_cvt_pk_bf16_f32 v51, v26, v27
    v_mfma_f32_16x16x32_bf16 v[32:35], a[80:83], v[192:195], v[32:35]
    s_mov_b32 s54, 1024
    ds_read_b64_tr_b16 a[104:105], v4 offset:37472
    ds_read_b64_tr_b16 a[106:107], v4 offset:37600
    v_mfma_f32_16x16x32_bf16 v[32:35], a[84:87], v[200:203], v[32:35]
    s_waitcnt lgkmcnt(6)
    v_permlane32_swap_b32 v48, v50
    v_mfma_f32_16x16x32_bf16 v[32:35], a[88:91], v[208:211], v[32:35]
    v_permlane32_swap_b32 v49, v51
    v_mfma_f32_16x16x32_bf16 v[32:35], a[92:95], v[216:219], v[32:35]
    ds_read_b64_tr_b16 a[108:109], v4 offset:37728
    ds_read_b64_tr_b16 a[110:111], v4 offset:37856
    buffer_store_dwordx4 v[48:51], v10, s[40:43], s54 offen offset:0 sc1
    v_mfma_f32_16x16x32_bf16 v[36:39], a[64:67], v[160:163], 0
    ds_read_b64_tr_b16 a[112:113], v4 offset:53856
    v_cvt_pk_bf16_f32 v52, v20, v21
    v_mfma_f32_16x16x32_bf16 v[36:39], a[68:71], v[168:171], v[36:39]
    ds_read_b64_tr_b16 a[114:115], v4 offset:53984
    v_cvt_pk_bf16_f32 v53, v22, v23
    v_mfma_f32_16x16x32_bf16 v[36:39], a[72:75], v[176:179], v[36:39]
    ds_read_b64_tr_b16 a[116:117], v4 offset:54112
    v_cvt_pk_bf16_f32 v54, v28, v29
    v_mfma_f32_16x16x32_bf16 v[36:39], a[76:79], v[184:187], v[36:39]
    ds_read_b64_tr_b16 a[118:119], v4 offset:54240
    v_cvt_pk_bf16_f32 v55, v30, v31
    v_mfma_f32_16x16x32_bf16 v[36:39], a[80:83], v[224:227], v[36:39]
    s_mov_b32 s54, 295936
    ds_read_b64_tr_b16 a[120:121], v4 offset:54368
    ds_read_b64_tr_b16 a[122:123], v4 offset:54496
    v_mfma_f32_16x16x32_bf16 v[36:39], a[84:87], v[232:235], v[36:39]
    v_permlane32_swap_b32 v52, v54
    v_mfma_f32_16x16x32_bf16 v[36:39], a[88:91], v[240:243], v[36:39]
    v_permlane32_swap_b32 v53, v55
    v_mfma_f32_16x16x32_bf16 v[36:39], a[92:95], v[248:251], v[36:39]
    s_waitcnt vmcnt(31)
    s_barrier
    s_waitcnt lgkmcnt(10)
    ds_read_b64_tr_b16 a[124:125], v4 offset:54624
    ds_read_b64_tr_b16 a[126:127], v4 offset:54752
    buffer_store_dwordx4 v[52:55], v10, s[40:43], s54 offen offset:0 sc1
    v_mfma_f32_16x16x32_bf16 v[40:43], a[96:99], v[128:131], 0
    s_add_u32 m0, s44, 73728
    ds_read_b64_tr_b16 a[64:65], v3 offset:0
    ds_read_b64_tr_b16 a[66:67], v3 offset:128
    v_mfma_f32_16x16x32_bf16 v[40:43], a[100:103], v[136:139], v[40:43]
    s_mov_b32 s45, 512
    s_waitcnt lgkmcnt(10)
    buffer_load_dwordx4 v7, s[28:31], s45 offen offset:0 lds
    v_mfma_f32_16x16x32_bf16 v[40:43], a[104:107], v[144:147], v[40:43]
    s_add_u32 m0, s44, 73632
    ds_read_b64_tr_b16 a[68:69], v3 offset:256
    ds_read_b64_tr_b16 a[70:71], v3 offset:384
    v_mfma_f32_16x16x32_bf16 v[40:43], a[108:111], v[152:155], v[40:43]
    s_waitcnt lgkmcnt(8)
    buffer_load_dwordx4 v7, s[28:31], s45 offen offset:1152 lds
    v_mfma_f32_16x16x32_bf16 v[40:43], a[112:115], v[192:195], v[40:43]
    s_add_u32 m0, s44, 73536
    ds_read_b64_tr_b16 a[72:73], v3 offset:512
    ds_read_b64_tr_b16 a[74:75], v3 offset:640
    v_mfma_f32_16x16x32_bf16 v[40:43], a[116:119], v[200:203], v[40:43]
    s_waitcnt lgkmcnt(6)
    buffer_load_dwordx4 v7, s[28:31], s45 offen offset:2304 lds
    v_mfma_f32_16x16x32_bf16 v[40:43], a[120:123], v[208:211], v[40:43]
    s_add_u32 m0, s44, 73440
    ds_read_b64_tr_b16 a[76:77], v3 offset:768
    ds_read_b64_tr_b16 a[78:79], v3 offset:896
    v_mfma_f32_16x16x32_bf16 v[40:43], a[124:127], v[216:219], v[40:43]
    buffer_load_dwordx4 v7, s[28:31], s45 offen offset:3456 lds
    v_mfma_f32_16x16x32_bf16 v[44:47], a[96:99], v[160:163], 0
    s_add_u32 m0, s44, 90624
    ds_read_b64_tr_b16 a[80:81], v3 offset:16896
    ds_read_b64_tr_b16 a[82:83], v3 offset:17024
    v_mfma_f32_16x16x32_bf16 v[44:47], a[100:103], v[168:171], v[44:47]
    s_mov_b32 s45, 147968
    buffer_load_dwordx4 v7, s[28:31], s45 offen offset:0 lds
    v_mfma_f32_16x16x32_bf16 v[44:47], a[104:107], v[176:179], v[44:47]
    s_add_u32 m0, s44, 90528
    ds_read_b64_tr_b16 a[84:85], v3 offset:17152
    ds_read_b64_tr_b16 a[86:87], v3 offset:17280
    v_mfma_f32_16x16x32_bf16 v[44:47], a[108:111], v[184:187], v[44:47]
    buffer_load_dwordx4 v7, s[28:31], s45 offen offset:1152 lds
    v_mfma_f32_16x16x32_bf16 v[44:47], a[112:115], v[224:227], v[44:47]
    s_add_u32 m0, s44, 90432
    ds_read_b64_tr_b16 a[88:89], v3 offset:17408
    ds_read_b64_tr_b16 a[90:91], v3 offset:17536
    v_mfma_f32_16x16x32_bf16 v[44:47], a[116:119], v[232:235], v[44:47]
    buffer_load_dwordx4 v7, s[28:31], s45 offen offset:2304 lds
    v_mfma_f32_16x16x32_bf16 v[44:47], a[120:123], v[240:243], v[44:47]
    s_add_u32 m0, s44, 90336
    ds_read_b64_tr_b16 a[92:93], v3 offset:17664
    ds_read_b64_tr_b16 a[94:95], v3 offset:17792
    v_mfma_f32_16x16x32_bf16 v[44:47], a[124:127], v[248:251], v[44:47]
    s_waitcnt lgkmcnt(12)
    buffer_load_dwordx4 v7, s[28:31], s45 offen offset:3456 lds
    v_mfma_f32_16x16x32_bf16 v[16:19], a[64:67], v[128:131], 0
    ds_read_b64_tr_b16 a[96:97], v3 offset:32
    v_cvt_pk_bf16_f32 v48, v32, v33
    v_mfma_f32_16x16x32_bf16 v[16:19], a[68:71], v[136:139], v[16:19]
    s_waitcnt lgkmcnt(9)
    ds_read_b64_tr_b16 a[98:99], v3 offset:160
    v_cvt_pk_bf16_f32 v49, v34, v35
    v_mfma_f32_16x16x32_bf16 v[16:19], a[72:75], v[144:147], v[16:19]
    ds_read_b64_tr_b16 a[100:101], v3 offset:288
    v_cvt_pk_bf16_f32 v50, v40, v41
    v_mfma_f32_16x16x32_bf16 v[16:19], a[76:79], v[152:155], v[16:19]
    s_waitcnt lgkmcnt(7)
    ds_read_b64_tr_b16 a[102:103], v3 offset:416
    v_cvt_pk_bf16_f32 v51, v42, v43
    v_mfma_f32_16x16x32_bf16 v[16:19], a[80:83], v[192:195], v[16:19]
    s_mov_b32 s54, 1024
    ds_read_b64_tr_b16 a[104:105], v3 offset:544
    ds_read_b64_tr_b16 a[106:107], v3 offset:672
    v_mfma_f32_16x16x32_bf16 v[16:19], a[84:87], v[200:203], v[16:19]
    s_waitcnt lgkmcnt(6)
    v_permlane32_swap_b32 v48, v50
    v_mfma_f32_16x16x32_bf16 v[16:19], a[88:91], v[208:211], v[16:19]
    v_permlane32_swap_b32 v49, v51
    v_mfma_f32_16x16x32_bf16 v[16:19], a[92:95], v[216:219], v[16:19]
    ds_read_b64_tr_b16 a[108:109], v3 offset:800
    ds_read_b64_tr_b16 a[110:111], v3 offset:928
    buffer_store_dwordx4 v[48:51], v10, s[40:43], s54 offen offset:512 sc1
    v_mfma_f32_16x16x32_bf16 v[20:23], a[64:67], v[160:163], 0
    ds_read_b64_tr_b16 a[112:113], v3 offset:16928
    v_cvt_pk_bf16_f32 v52, v36, v37
    v_mfma_f32_16x16x32_bf16 v[20:23], a[68:71], v[168:171], v[20:23]
    ds_read_b64_tr_b16 a[114:115], v3 offset:17056
    v_cvt_pk_bf16_f32 v53, v38, v39
    v_mfma_f32_16x16x32_bf16 v[20:23], a[72:75], v[176:179], v[20:23]
    ds_read_b64_tr_b16 a[116:117], v3 offset:17184
    v_cvt_pk_bf16_f32 v54, v44, v45
    v_mfma_f32_16x16x32_bf16 v[20:23], a[76:79], v[184:187], v[20:23]
    ds_read_b64_tr_b16 a[118:119], v3 offset:17312
    v_cvt_pk_bf16_f32 v55, v46, v47
    v_mfma_f32_16x16x32_bf16 v[20:23], a[80:83], v[224:227], v[20:23]
    s_mov_b32 s54, 295936
    ds_read_b64_tr_b16 a[120:121], v3 offset:17440
    ds_read_b64_tr_b16 a[122:123], v3 offset:17568
    v_mfma_f32_16x16x32_bf16 v[20:23], a[84:87], v[232:235], v[20:23]
    v_permlane32_swap_b32 v52, v54
    v_mfma_f32_16x16x32_bf16 v[20:23], a[88:91], v[240:243], v[20:23]
    v_permlane32_swap_b32 v53, v55
    v_mfma_f32_16x16x32_bf16 v[20:23], a[92:95], v[248:251], v[20:23]
    s_waitcnt lgkmcnt(10)
    ds_read_b64_tr_b16 a[124:125], v3 offset:17696
    ds_read_b64_tr_b16 a[126:127], v3 offset:17824
    buffer_store_dwordx4 v[52:55], v10, s[40:43], s54 offen offset:512 sc1
    v_mfma_f32_16x16x32_bf16 v[24:27], a[96:99], v[128:131], 0
    ds_read_b64_tr_b16 a[64:65], v3 offset:64
    v_add_u32 v105, s14, v8
    v_mfma_f32_16x16x32_bf16 v[24:27], a[100:103], v[136:139], v[24:27]
    s_waitcnt lgkmcnt(9)
    ds_read_b64_tr_b16 a[66:67], v3 offset:192
    v_add_u32 v106, 73728, v105
    v_mfma_f32_16x16x32_bf16 v[24:27], a[104:107], v[144:147], v[24:27]
    ds_read_b64_tr_b16 a[68:69], v3 offset:320
    v_lshrrev_b32 v110, 4, v0
    v_mfma_f32_16x16x32_bf16 v[24:27], a[108:111], v[152:155], v[24:27]
    s_waitcnt lgkmcnt(7)
    ds_read_b64_tr_b16 a[70:71], v3 offset:448
    v_bfe_u32 v14, v0, 2, 2
    v_mfma_f32_16x16x32_bf16 v[24:27], a[112:115], v[192:195], v[24:27]
    ds_read_b64_tr_b16 a[72:73], v3 offset:576
    v_lshl_add_u32 v110, v110, 3, v14
    v_mfma_f32_16x16x32_bf16 v[24:27], a[116:119], v[200:203], v[24:27]
    s_waitcnt lgkmcnt(5)
    ds_read_b64_tr_b16 a[74:75], v3 offset:704
    v_and_b32 v14, 3, v0
    v_mfma_f32_16x16x32_bf16 v[24:27], a[120:123], v[208:211], v[24:27]
    ds_read_b64_tr_b16 a[76:77], v3 offset:832
    v_mul_u32_u24 v111, 1152, v110
    v_mfma_f32_16x16x32_bf16 v[24:27], a[124:127], v[216:219], v[24:27]
    ds_read_b64_tr_b16 a[78:79], v3 offset:960
    v_lshlrev_b32 v110, 6, v110
    v_mfma_f32_16x16x32_bf16 v[28:31], a[96:99], v[160:163], 0
    ds_read_b64_tr_b16 a[80:81], v3 offset:16960
    v_lshl_add_u32 v110, v14, 3, v110
    v_mfma_f32_16x16x32_bf16 v[28:31], a[100:103], v[168:171], v[28:31]
    ds_read_b64_tr_b16 a[82:83], v3 offset:17088
    v_lshl_add_u32 v111, v14, 3, v111
    v_mfma_f32_16x16x32_bf16 v[28:31], a[104:107], v[176:179], v[28:31]
    s_lshr_b32 s3, s51, 1
    s_xor_b32 s3, s3, 1
    s_mul_i32 s3, s3, 110592
    s_and_b32 s14, s51, 1
    s_lshl_b32 s14, s14, 5
    s_add_u32 s3, s3, s14
    s_add_u32 s3, s3, 16384
    ds_read_b64_tr_b16 a[84:85], v3 offset:17216
    v_add_u32 v110, s3, v110
    v_mfma_f32_16x16x32_bf16 v[28:31], a[108:111], v[184:187], v[28:31]
    s_mul_i32 s3, s51, 288
    s_add_u32 s3, s3, 53248
    ds_read_b64_tr_b16 a[86:87], v3 offset:17344
    v_add_u32 v111, s3, v111
    v_mfma_f32_16x16x32_bf16 v[28:31], a[112:115], v[224:227], v[28:31]
    ds_read_b64_tr_b16 a[88:89], v3 offset:17472
    v_mfma_f32_16x16x32_bf16 v[28:31], a[116:119], v[232:235], v[28:31]
    ds_read_b64_tr_b16 a[90:91], v3 offset:17600
    v_mfma_f32_16x16x32_bf16 v[28:31], a[120:123], v[240:243], v[28:31]
    ds_read_b64_tr_b16 a[92:93], v3 offset:17728
    v_mfma_f32_16x16x32_bf16 v[28:31], a[124:127], v[248:251], v[28:31]
    s_waitcnt lgkmcnt(11)
    ds_read_b64_tr_b16 a[94:95], v3 offset:17856
    v_mfma_f32_16x16x32_bf16 v[32:35], a[64:67], v[128:131], 0
    ds_read_b64_tr_b16 a[96:97], v3 offset:96
    v_cvt_pk_bf16_f32 v48, v16, v17
    v_mfma_f32_16x16x32_bf16 v[32:35], a[68:71], v[136:139], v[32:35]
    s_waitcnt lgkmcnt(9)
    ds_read_b64_tr_b16 a[98:99], v3 offset:224
    v_cvt_pk_bf16_f32 v49, v18, v19
    v_mfma_f32_16x16x32_bf16 v[32:35], a[72:75], v[144:147], v[32:35]
    ds_read_b64_tr_b16 a[100:101], v3 offset:352
    v_cvt_pk_bf16_f32 v50, v24, v25
    v_mfma_f32_16x16x32_bf16 v[32:35], a[76:79], v[152:155], v[32:35]
    s_waitcnt lgkmcnt(7)
    ds_read_b64_tr_b16 a[102:103], v3 offset:480
    v_cvt_pk_bf16_f32 v51, v26, v27
    v_mfma_f32_16x16x32_bf16 v[32:35], a[80:83], v[192:195], v[32:35]
    s_mov_b32 s54, 2048
    ds_read_b64_tr_b16 a[104:105], v3 offset:608
    ds_read_b64_tr_b16 a[106:107], v3 offset:736
    v_mfma_f32_16x16x32_bf16 v[32:35], a[84:87], v[200:203], v[32:35]
    s_waitcnt lgkmcnt(6)
    v_permlane32_swap_b32 v48, v50
    v_mfma_f32_16x16x32_bf16 v[32:35], a[88:91], v[208:211], v[32:35]
    v_permlane32_swap_b32 v49, v51
    v_mfma_f32_16x16x32_bf16 v[32:35], a[92:95], v[216:219], v[32:35]
    ds_read_b64_tr_b16 a[108:109], v3 offset:864
    ds_read_b64_tr_b16 a[110:111], v3 offset:992
    buffer_store_dwordx4 v[48:51], v10, s[40:43], s54 offen offset:0 sc1
    v_mfma_f32_16x16x32_bf16 v[36:39], a[64:67], v[160:163], 0
    ds_read_b64_tr_b16 a[112:113], v3 offset:16992
    v_cvt_pk_bf16_f32 v52, v20, v21
    v_mfma_f32_16x16x32_bf16 v[36:39], a[68:71], v[168:171], v[36:39]
    ds_read_b64_tr_b16 a[114:115], v3 offset:17120
    v_cvt_pk_bf16_f32 v53, v22, v23
    v_mfma_f32_16x16x32_bf16 v[36:39], a[72:75], v[176:179], v[36:39]
    ds_read_b64_tr_b16 a[116:117], v3 offset:17248
    v_cvt_pk_bf16_f32 v54, v28, v29
    v_mfma_f32_16x16x32_bf16 v[36:39], a[76:79], v[184:187], v[36:39]
L2_pad10:
    s_cbranch_execz L2_pad14
    ds_read_b64_tr_b16 a[118:119], v3 offset:17376
    v_cvt_pk_bf16_f32 v55, v30, v31
    v_mfma_f32_16x16x32_bf16 v[36:39], a[80:83], v[224:227], v[36:39]
    s_mov_b32 s54, 296960
    ds_read_b64_tr_b16 a[120:121], v3 offset:17504
    ds_read_b64_tr_b16 a[122:123], v3 offset:17632
    v_mfma_f32_16x16x32_bf16 v[36:39], a[84:87], v[232:235], v[36:39]
    v_permlane32_swap_b32 v52, v54
    v_mfma_f32_16x16x32_bf16 v[36:39], a[88:91], v[240:243], v[36:39]
    v_permlane32_swap_b32 v53, v55
    v_mfma_f32_16x16x32_bf16 v[36:39], a[92:95], v[248:251], v[36:39]
    s_waitcnt vmcnt(15)
    s_barrier
    s_waitcnt lgkmcnt(10)
    ds_read_b64_tr_b16 a[124:125], v3 offset:17760
    ds_read_b64_tr_b16 a[126:127], v3 offset:17888
    buffer_store_dwordx4 v[52:55], v10, s[40:43], s54 offen offset:0 sc1
    v_mfma_f32_16x16x32_bf16 v[40:43], a[96:99], v[128:131], 0
    s_add_u32 m0, s44, 110592
    ds_read_b64_tr_b16 a[64:65], v3 offset:36864
    ds_read_b64_tr_b16 a[66:67], v3 offset:36992
    v_mfma_f32_16x16x32_bf16 v[40:43], a[100:103], v[136:139], v[40:43]
    s_mov_b32 s45, 640
    s_waitcnt lgkmcnt(10)
    buffer_load_dwordx4 v7, s[28:31], s45 offen offset:0 lds
    v_mfma_f32_16x16x32_bf16 v[40:43], a[104:107], v[144:147], v[40:43]
    s_add_u32 m0, s44, 110496
    ds_read_b64_tr_b16 a[68:69], v3 offset:37120
    ds_read_b64_tr_b16 a[70:71], v3 offset:37248
    v_mfma_f32_16x16x32_bf16 v[40:43], a[108:111], v[152:155], v[40:43]
    s_waitcnt lgkmcnt(8)
    buffer_load_dwordx4 v7, s[28:31], s45 offen offset:1152 lds
    v_mfma_f32_16x16x32_bf16 v[40:43], a[112:115], v[192:195], v[40:43]
    s_add_u32 m0, s44, 110400
    ds_read_b64_tr_b16 a[72:73], v3 offset:37376
    ds_read_b64_tr_b16 a[74:75], v3 offset:37504
    v_mfma_f32_16x16x32_bf16 v[40:43], a[116:119], v[200:203], v[40:43]
    s_waitcnt lgkmcnt(6)
    buffer_load_dwordx4 v7, s[28:31], s45 offen offset:2304 lds
    v_mfma_f32_16x16x32_bf16 v[40:43], a[120:123], v[208:211], v[40:43]
    s_add_u32 m0, s44, 110304
    ds_read_b64_tr_b16 a[76:77], v3 offset:37632
    ds_read_b64_tr_b16 a[78:79], v3 offset:37760
    v_mfma_f32_16x16x32_bf16 v[40:43], a[124:127], v[216:219], v[40:43]
    buffer_load_dwordx4 v7, s[28:31], s45 offen offset:3456 lds
    v_mfma_f32_16x16x32_bf16 v[44:47], a[96:99], v[160:163], 0
    s_add_u32 m0, s44, 127488
    ds_read_b64_tr_b16 a[80:81], v3 offset:53760
    ds_read_b64_tr_b16 a[82:83], v3 offset:53888
    v_mfma_f32_16x16x32_bf16 v[44:47], a[100:103], v[168:171], v[44:47]
    s_mov_b32 s45, 148096
    buffer_load_dwordx4 v7, s[28:31], s45 offen offset:0 lds
    v_mfma_f32_16x16x32_bf16 v[44:47], a[104:107], v[176:179], v[44:47]
    s_add_u32 m0, s44, 127392
    ds_read_b64_tr_b16 a[84:85], v3 offset:54016
    ds_read_b64_tr_b16 a[86:87], v3 offset:54144
    v_mfma_f32_16x16x32_bf16 v[44:47], a[108:111], v[184:187], v[44:47]
    buffer_load_dwordx4 v7, s[28:31], s45 offen offset:1152 lds
    v_mfma_f32_16x16x32_bf16 v[44:47], a[112:115], v[224:227], v[44:47]
    s_add_u32 m0, s44, 127296
    ds_read_b64_tr_b16 a[88:89], v3 offset:54272
    ds_read_b64_tr_b16 a[90:91], v3 offset:54400
    v_mfma_f32_16x16x32_bf16 v[44:47], a[116:119], v[232:235], v[44:47]
    buffer_load_dwordx4 v7, s[28:31], s45 offen offset:2304 lds
    v_mfma_f32_16x16x32_bf16 v[44:47], a[120:123], v[240:243], v[44:47]
    s_add_u32 m0, s44, 127200
    ds_read_b64_tr_b16 a[92:93], v3 offset:54528
    ds_read_b64_tr_b16 a[94:95], v3 offset:54656
    v_mfma_f32_16x16x32_bf16 v[44:47], a[124:127], v[248:251], v[44:47]
    s_waitcnt lgkmcnt(12)
    buffer_load_dwordx4 v7, s[28:31], s45 offen offset:3456 lds
    v_mfma_f32_16x16x32_bf16 v[16:19], a[64:67], v[128:131], 0
    ds_read_b64_tr_b16 a[96:97], v3 offset:36896
    v_cvt_pk_bf16_f32 v48, v32, v33
    v_mfma_f32_16x16x32_bf16 v[16:19], a[68:71], v[136:139], v[16:19]
    s_waitcnt lgkmcnt(9)
    ds_read_b64_tr_b16 a[98:99], v3 offset:37024
    v_cvt_pk_bf16_f32 v49, v34, v35
    v_mfma_f32_16x16x32_bf16 v[16:19], a[72:75], v[144:147], v[16:19]
    ds_read_b64_tr_b16 a[100:101], v3 offset:37152
    v_cvt_pk_bf16_f32 v50, v40, v41
    v_mfma_f32_16x16x32_bf16 v[16:19], a[76:79], v[152:155], v[16:19]
    s_waitcnt lgkmcnt(7)
    ds_read_b64_tr_b16 a[102:103], v3 offset:37280
    v_cvt_pk_bf16_f32 v51, v42, v43
    v_mfma_f32_16x16x32_bf16 v[16:19], a[80:83], v[192:195], v[16:19]
    s_mov_b32 s54, 2048
    ds_read_b64_tr_b16 a[104:105], v3 offset:37408
    ds_read_b64_tr_b16 a[106:107], v3 offset:37536
    v_mfma_f32_16x16x32_bf16 v[16:19], a[84:87], v[200:203], v[16:19]
    s_waitcnt lgkmcnt(6)
    v_permlane32_swap_b32 v48, v50
    v_mfma_f32_16x16x32_bf16 v[16:19], a[88:91], v[208:211], v[16:19]
    v_permlane32_swap_b32 v49, v51
    v_mfma_f32_16x16x32_bf16 v[16:19], a[92:95], v[216:219], v[16:19]
    ds_read_b64_tr_b16 a[108:109], v3 offset:37664
    ds_read_b64_tr_b16 a[110:111], v3 offset:37792
    buffer_store_dwordx4 v[48:51], v10, s[40:43], s54 offen offset:512 sc1
    v_mfma_f32_16x16x32_bf16 v[20:23], a[64:67], v[160:163], 0
    ds_read_b64_tr_b16 a[112:113], v3 offset:53792
    v_cvt_pk_bf16_f32 v52, v36, v37
    v_mfma_f32_16x16x32_bf16 v[20:23], a[68:71], v[168:171], v[20:23]
    ds_read_b64_tr_b16 a[114:115], v3 offset:53920
    v_cvt_pk_bf16_f32 v53, v38, v39
    v_mfma_f32_16x16x32_bf16 v[20:23], a[72:75], v[176:179], v[20:23]
    ds_read_b64_tr_b16 a[116:117], v3 offset:54048
    v_cvt_pk_bf16_f32 v54, v44, v45
    v_mfma_f32_16x16x32_bf16 v[20:23], a[76:79], v[184:187], v[20:23]
    ds_read_b64_tr_b16 a[118:119], v3 offset:54176
    v_cvt_pk_bf16_f32 v55, v46, v47
    v_mfma_f32_16x16x32_bf16 v[20:23], a[80:83], v[224:227], v[20:23]
    s_mov_b32 s54, 296960
    ds_read_b64_tr_b16 a[120:121], v3 offset:54304
    ds_read_b64_tr_b16 a[122:123], v3 offset:54432
    v_mfma_f32_16x16x32_bf16 v[20:23], a[84:87], v[232:235], v[20:23]
    v_permlane32_swap_b32 v52, v54
    v_mfma_f32_16x16x32_bf16 v[20:23], a[88:91], v[240:243], v[20:23]
    v_permlane32_swap_b32 v53, v55
    v_mfma_f32_16x16x32_bf16 v[20:23], a[92:95], v[248:251], v[20:23]
    s_waitcnt lgkmcnt(10)
    ds_read_b64_tr_b16 a[124:125], v3 offset:54560
    ds_read_b64_tr_b16 a[126:127], v3 offset:54688
    buffer_store_dwordx4 v[52:55], v10, s[40:43], s54 offen offset:512 sc1
    v_mfma_f32_16x16x32_bf16 v[24:27], a[96:99], v[128:131], 0
    ds_read_b64_tr_b16 a[64:65], v3 offset:36928
    v_mfma_f32_16x16x32_bf16 v[24:27], a[100:103], v[136:139], v[24:27]
    s_waitcnt lgkmcnt(9)
    ds_read_b64_tr_b16 a[66:67], v3 offset:37056
    v_mfma_f32_16x16x32_bf16 v[24:27], a[104:107], v[144:147], v[24:27]
    ds_read_b64_tr_b16 a[68:69], v3 offset:37184
    v_mfma_f32_16x16x32_bf16 v[24:27], a[108:111], v[152:155], v[24:27]
    s_waitcnt lgkmcnt(7)
    ds_read_b64_tr_b16 a[70:71], v3 offset:37312
    v_mfma_f32_16x16x32_bf16 v[24:27], a[112:115], v[192:195], v[24:27]
    ds_read_b64_tr_b16 a[72:73], v3 offset:37440
    v_mfma_f32_16x16x32_bf16 v[24:27], a[116:119], v[200:203], v[24:27]
    s_waitcnt lgkmcnt(5)
    ds_read_b64_tr_b16 a[74:75], v3 offset:37568
    v_mfma_f32_16x16x32_bf16 v[24:27], a[120:123], v[208:211], v[24:27]
    ds_read_b64_tr_b16 a[76:77], v3 offset:37696
    v_mfma_f32_16x16x32_bf16 v[24:27], a[124:127], v[216:219], v[24:27]
    ds_read_b64_tr_b16 a[78:79], v3 offset:37824
    v_mfma_f32_16x16x32_bf16 v[28:31], a[96:99], v[160:163], 0
    ds_read_b64_tr_b16 a[80:81], v3 offset:53824
    v_mfma_f32_16x16x32_bf16 v[28:31], a[100:103], v[168:171], v[28:31]
    ds_read_b64_tr_b16 a[82:83], v3 offset:53952
    v_mfma_f32_16x16x32_bf16 v[28:31], a[104:107], v[176:179], v[28:31]
    ds_read_b64_tr_b16 a[84:85], v3 offset:54080
    v_mfma_f32_16x16x32_bf16 v[28:31], a[108:111], v[184:187], v[28:31]
    ds_read_b64_tr_b16 a[86:87], v3 offset:54208
    v_mfma_f32_16x16x32_bf16 v[28:31], a[112:115], v[224:227], v[28:31]
    ds_read_b64_tr_b16 a[88:89], v3 offset:54336
    v_mfma_f32_16x16x32_bf16 v[28:31], a[116:119], v[232:235], v[28:31]
    ds_read_b64_tr_b16 a[90:91], v3 offset:54464
    v_mfma_f32_16x16x32_bf16 v[28:31], a[120:123], v[240:243], v[28:31]
    ds_read_b64_tr_b16 a[92:93], v3 offset:54592
    v_mfma_f32_16x16x32_bf16 v[28:31], a[124:127], v[248:251], v[28:31]
    s_waitcnt lgkmcnt(11)
    ds_read_b64_tr_b16 a[94:95], v3 offset:54720
    v_mfma_f32_16x16x32_bf16 v[32:35], a[64:67], v[128:131], 0
    ds_read_b64_tr_b16 a[96:97], v3 offset:36960
    v_cvt_pk_bf16_f32 v48, v16, v17
    v_mfma_f32_16x16x32_bf16 v[32:35], a[68:71], v[136:139], v[32:35]
    s_waitcnt lgkmcnt(9)
    ds_read_b64_tr_b16 a[98:99], v3 offset:37088
    v_cvt_pk_bf16_f32 v49, v18, v19
    v_mfma_f32_16x16x32_bf16 v[32:35], a[72:75], v[144:147], v[32:35]
    ds_read_b64_tr_b16 a[100:101], v3 offset:37216
    v_cvt_pk_bf16_f32 v50, v24, v25
    v_mfma_f32_16x16x32_bf16 v[32:35], a[76:79], v[152:155], v[32:35]
    s_waitcnt lgkmcnt(7)
    ds_read_b64_tr_b16 a[102:103], v3 offset:37344
    v_cvt_pk_bf16_f32 v51, v26, v27
    v_mfma_f32_16x16x32_bf16 v[32:35], a[80:83], v[192:195], v[32:35]
    s_mov_b32 s54, 3072
    ds_read_b64_tr_b16 a[104:105], v3 offset:37472
    ds_read_b64_tr_b16 a[106:107], v3 offset:37600
    v_mfma_f32_16x16x32_bf16 v[32:35], a[84:87], v[200:203], v[32:35]
    s_waitcnt lgkmcnt(6)
    v_permlane32_swap_b32 v48, v50
    v_mfma_f32_16x16x32_bf16 v[32:35], a[88:91], v[208:211], v[32:35]
    v_permlane32_swap_b32 v49, v51
    v_mfma_f32_16x16x32_bf16 v[32:35], a[92:95], v[216:219], v[32:35]
    ds_read_b64_tr_b16 a[108:109], v3 offset:37728
    ds_read_b64_tr_b16 a[110:111], v3 offset:37856
    buffer_store_dwordx4 v[48:51], v10, s[40:43], s54 offen offset:0 sc1
    v_mfma_f32_16x16x32_bf16 v[36:39], a[64:67], v[160:163], 0
    ds_read_b64_tr_b16 a[112:113], v3 offset:53856
    v_cvt_pk_bf16_f32 v52, v20, v21
    v_mfma_f32_16x16x32_bf16 v[36:39], a[68:71], v[168:171], v[36:39]
    ds_read_b64_tr_b16 a[114:115], v3 offset:53984
    v_cvt_pk_bf16_f32 v53, v22, v23
    v_mfma_f32_16x16x32_bf16 v[36:39], a[72:75], v[176:179], v[36:39]
    ds_read_b64_tr_b16 a[116:117], v3 offset:54112
    v_cvt_pk_bf16_f32 v54, v28, v29
    v_mfma_f32_16x16x32_bf16 v[36:39], a[76:79], v[184:187], v[36:39]
    ds_read_b64_tr_b16 a[118:119], v3 offset:54240
    v_cvt_pk_bf16_f32 v55, v30, v31
    v_mfma_f32_16x16x32_bf16 v[36:39], a[80:83], v[224:227], v[36:39]
    s_mov_b32 s54, 297984
    ds_read_b64_tr_b16 a[120:121], v3 offset:54368
    ds_read_b64_tr_b16 a[122:123], v3 offset:54496
    v_mfma_f32_16x16x32_bf16 v[36:39], a[84:87], v[232:235], v[36:39]
    v_permlane32_swap_b32 v52, v54
    v_mfma_f32_16x16x32_bf16 v[36:39], a[88:91], v[240:243], v[36:39]
    v_permlane32_swap_b32 v53, v55
    v_mfma_f32_16x16x32_bf16 v[36:39], a[92:95], v[248:251], v[36:39]
    s_waitcnt vmcnt(15)
    s_barrier
    s_waitcnt lgkmcnt(10)
    ds_read_b64_tr_b16 a[124:125], v3 offset:54624
    ds_read_b64_tr_b16 a[126:127], v3 offset:54752
    buffer_store_dwordx4 v[52:55], v10, s[40:43], s54 offen offset:0 sc1
    v_mfma_f32_16x16x32_bf16 v[40:43], a[96:99], v[128:131], 0
    s_add_u32 m0, s44, 0
    ds_read_b64_tr_b16 a[64:65], v4 offset:0
    ds_read_b64_tr_b16 a[66:67], v4 offset:128
    v_mfma_f32_16x16x32_bf16 v[40:43], a[100:103], v[136:139], v[40:43]
    s_mov_b32 s45, 768
    s_waitcnt lgkmcnt(10)
    buffer_load_dwordx4 v7, s[28:31], s45 offen offset:0 lds
    v_mfma_f32_16x16x32_bf16 v[40:43], a[104:107], v[144:147], v[40:43]
    s_add_u32 m0, s44, -96
    ds_read_b64_tr_b16 a[68:69], v4 offset:256
    ds_read_b64_tr_b16 a[70:71], v4 offset:384
    v_mfma_f32_16x16x32_bf16 v[40:43], a[108:111], v[152:155], v[40:43]
    s_waitcnt lgkmcnt(8)
    buffer_load_dwordx4 v7, s[28:31], s45 offen offset:1152 lds
    v_mfma_f32_16x16x32_bf16 v[40:43], a[112:115], v[192:195], v[40:43]
    s_add_u32 m0, s44, -192
    ds_read_b64_tr_b16 a[72:73], v4 offset:512
    ds_read_b64_tr_b16 a[74:75], v4 offset:640
    v_mfma_f32_16x16x32_bf16 v[40:43], a[116:119], v[200:203], v[40:43]
    s_waitcnt lgkmcnt(6)
    buffer_load_dwordx4 v7, s[28:31], s45 offen offset:2304 lds
    v_mfma_f32_16x16x32_bf16 v[40:43], a[120:123], v[208:211], v[40:43]
    s_add_u32 m0, s44, -288
    ds_read_b64_tr_b16 a[76:77], v4 offset:768
    ds_read_b64_tr_b16 a[78:79], v4 offset:896
    v_mfma_f32_16x16x32_bf16 v[40:43], a[124:127], v[216:219], v[40:43]
    buffer_load_dwordx4 v7, s[28:31], s45 offen offset:3456 lds
    v_mfma_f32_16x16x32_bf16 v[44:47], a[96:99], v[160:163], 0
    s_add_u32 m0, s44, 16896
    ds_read_b64_tr_b16 a[80:81], v4 offset:16896
    ds_read_b64_tr_b16 a[82:83], v4 offset:17024
    v_mfma_f32_16x16x32_bf16 v[44:47], a[100:103], v[168:171], v[44:47]
    s_mov_b32 s45, 148224
    buffer_load_dwordx4 v7, s[28:31], s45 offen offset:0 lds
    v_mfma_f32_16x16x32_bf16 v[44:47], a[104:107], v[176:179], v[44:47]
    s_add_u32 m0, s44, 16800
    ds_read_b64_tr_b16 a[84:85], v4 offset:17152
    ds_read_b64_tr_b16 a[86:87], v4 offset:17280
    v_mfma_f32_16x16x32_bf16 v[44:47], a[108:111], v[184:187], v[44:47]
    buffer_load_dwordx4 v7, s[28:31], s45 offen offset:1152 lds
    v_mfma_f32_16x16x32_bf16 v[44:47], a[112:115], v[224:227], v[44:47]
    s_add_u32 m0, s44, 16704
    ds_read_b64_tr_b16 a[88:89], v4 offset:17408
    ds_read_b64_tr_b16 a[90:91], v4 offset:17536
    v_mfma_f32_16x16x32_bf16 v[44:47], a[116:119], v[232:235], v[44:47]
    buffer_load_dwordx4 v7, s[28:31], s45 offen offset:2304 lds
    v_mfma_f32_16x16x32_bf16 v[44:47], a[120:123], v[240:243], v[44:47]
    s_add_u32 m0, s44, 16608
    ds_read_b64_tr_b16 a[92:93], v4 offset:17664
    ds_read_b64_tr_b16 a[94:95], v4 offset:17792
    v_mfma_f32_16x16x32_bf16 v[44:47], a[124:127], v[248:251], v[44:47]
    s_waitcnt lgkmcnt(12)
    buffer_load_dwordx4 v7, s[28:31], s45 offen offset:3456 lds
    v_mfma_f32_16x16x32_bf16 v[16:19], a[64:67], v[128:131], 0
    ds_read_b64_tr_b16 a[96:97], v4 offset:32
    v_cvt_pk_bf16_f32 v48, v32, v33
    v_mfma_f32_16x16x32_bf16 v[16:19], a[68:71], v[136:139], v[16:19]
    s_waitcnt lgkmcnt(9)
    ds_read_b64_tr_b16 a[98:99], v4 offset:160
    v_cvt_pk_bf16_f32 v49, v34, v35
    v_mfma_f32_16x16x32_bf16 v[16:19], a[72:75], v[144:147], v[16:19]
    ds_read_b64_tr_b16 a[100:101], v4 offset:288
    v_cvt_pk_bf16_f32 v50, v40, v41
    v_mfma_f32_16x16x32_bf16 v[16:19], a[76:79], v[152:155], v[16:19]
    s_waitcnt lgkmcnt(7)
    ds_read_b64_tr_b16 a[102:103], v4 offset:416
    v_cvt_pk_bf16_f32 v51, v42, v43
    v_mfma_f32_16x16x32_bf16 v[16:19], a[80:83], v[192:195], v[16:19]
    s_mov_b32 s54, 3072
    ds_read_b64_tr_b16 a[104:105], v4 offset:544
    ds_read_b64_tr_b16 a[106:107], v4 offset:672
    v_mfma_f32_16x16x32_bf16 v[16:19], a[84:87], v[200:203], v[16:19]
    s_waitcnt lgkmcnt(6)
    v_permlane32_swap_b32 v48, v50
    v_mfma_f32_16x16x32_bf16 v[16:19], a[88:91], v[208:211], v[16:19]
    v_permlane32_swap_b32 v49, v51
    v_mfma_f32_16x16x32_bf16 v[16:19], a[92:95], v[216:219], v[16:19]
    ds_read_b64_tr_b16 a[108:109], v4 offset:800
    ds_read_b64_tr_b16 a[110:111], v4 offset:928
    buffer_store_dwordx4 v[48:51], v10, s[40:43], s54 offen offset:512 sc1
    v_mfma_f32_16x16x32_bf16 v[20:23], a[64:67], v[160:163], 0
    ds_read_b64_tr_b16 a[112:113], v4 offset:16928
    v_cvt_pk_bf16_f32 v52, v36, v37
    v_mfma_f32_16x16x32_bf16 v[20:23], a[68:71], v[168:171], v[20:23]
    ds_read_b64_tr_b16 a[114:115], v4 offset:17056
    v_cvt_pk_bf16_f32 v53, v38, v39
    v_mfma_f32_16x16x32_bf16 v[20:23], a[72:75], v[176:179], v[20:23]
    ds_read_b64_tr_b16 a[116:117], v4 offset:17184
    v_cvt_pk_bf16_f32 v54, v44, v45
    v_mfma_f32_16x16x32_bf16 v[20:23], a[76:79], v[184:187], v[20:23]
    ds_read_b64_tr_b16 a[118:119], v4 offset:17312
    v_cvt_pk_bf16_f32 v55, v46, v47
    v_mfma_f32_16x16x32_bf16 v[20:23], a[80:83], v[224:227], v[20:23]
    s_mov_b32 s54, 297984
    ds_read_b64_tr_b16 a[120:121], v4 offset:17440
    ds_read_b64_tr_b16 a[122:123], v4 offset:17568
    v_mfma_f32_16x16x32_bf16 v[20:23], a[84:87], v[232:235], v[20:23]
    v_permlane32_swap_b32 v52, v54
    v_mfma_f32_16x16x32_bf16 v[20:23], a[88:91], v[240:243], v[20:23]
    v_permlane32_swap_b32 v53, v55
    v_mfma_f32_16x16x32_bf16 v[20:23], a[92:95], v[248:251], v[20:23]
    s_waitcnt lgkmcnt(10)
    ds_read_b64_tr_b16 a[124:125], v4 offset:17696
    ds_read_b64_tr_b16 a[126:127], v4 offset:17824
    buffer_store_dwordx4 v[52:55], v10, s[40:43], s54 offen offset:512 sc1
    v_mfma_f32_16x16x32_bf16 v[24:27], a[96:99], v[128:131], 0
    ds_read_b64_tr_b16 a[64:65], v4 offset:64
    v_mfma_f32_16x16x32_bf16 v[24:27], a[100:103], v[136:139], v[24:27]
    s_waitcnt lgkmcnt(9)
    ds_read_b64_tr_b16 a[66:67], v4 offset:192
    v_mfma_f32_16x16x32_bf16 v[24:27], a[104:107], v[144:147], v[24:27]
    ds_read_b64_tr_b16 a[68:69], v4 offset:320
    v_mfma_f32_16x16x32_bf16 v[24:27], a[108:111], v[152:155], v[24:27]
    s_waitcnt lgkmcnt(7)
    ds_read_b64_tr_b16 a[70:71], v4 offset:448
    v_mfma_f32_16x16x32_bf16 v[24:27], a[112:115], v[192:195], v[24:27]
    ds_read_b64_tr_b16 a[72:73], v4 offset:576
    v_mfma_f32_16x16x32_bf16 v[24:27], a[116:119], v[200:203], v[24:27]
    s_waitcnt lgkmcnt(5)
    ds_read_b64_tr_b16 a[74:75], v4 offset:704
    v_mfma_f32_16x16x32_bf16 v[24:27], a[120:123], v[208:211], v[24:27]
    ds_read_b64_tr_b16 a[76:77], v4 offset:832
    v_mfma_f32_16x16x32_bf16 v[24:27], a[124:127], v[216:219], v[24:27]
    ds_read_b64_tr_b16 a[78:79], v4 offset:960
    v_mfma_f32_16x16x32_bf16 v[28:31], a[96:99], v[160:163], 0
    ds_read_b64_tr_b16 a[80:81], v4 offset:16960
    v_mfma_f32_16x16x32_bf16 v[28:31], a[100:103], v[168:171], v[28:31]
    ds_read_b64_tr_b16 a[82:83], v4 offset:17088
    v_mfma_f32_16x16x32_bf16 v[28:31], a[104:107], v[176:179], v[28:31]
    ds_read_b64_tr_b16 a[84:85], v4 offset:17216
    v_mfma_f32_16x16x32_bf16 v[28:31], a[108:111], v[184:187], v[28:31]
    ds_read_b64_tr_b16 a[86:87], v4 offset:17344
    v_mfma_f32_16x16x32_bf16 v[28:31], a[112:115], v[224:227], v[28:31]
    ds_read_b64_tr_b16 a[88:89], v4 offset:17472
    v_mfma_f32_16x16x32_bf16 v[28:31], a[116:119], v[232:235], v[28:31]
    ds_read_b64_tr_b16 a[90:91], v4 offset:17600
    v_mfma_f32_16x16x32_bf16 v[28:31], a[120:123], v[240:243], v[28:31]
    ds_read_b64_tr_b16 a[92:93], v4 offset:17728
    v_mfma_f32_16x16x32_bf16 v[28:31], a[124:127], v[248:251], v[28:31]
    s_waitcnt lgkmcnt(11)
    ds_read_b64_tr_b16 a[94:95], v4 offset:17856
    v_mfma_f32_16x16x32_bf16 v[32:35], a[64:67], v[128:131], 0
    ds_read_b64_tr_b16 a[96:97], v4 offset:96
    v_cvt_pk_bf16_f32 v48, v16, v17
    v_mfma_f32_16x16x32_bf16 v[32:35], a[68:71], v[136:139], v[32:35]
    s_waitcnt lgkmcnt(9)
    ds_read_b64_tr_b16 a[98:99], v4 offset:224
    v_cvt_pk_bf16_f32 v49, v18, v19
    v_mfma_f32_16x16x32_bf16 v[32:35], a[72:75], v[144:147], v[32:35]
    ds_read_b64_tr_b16 a[100:101], v4 offset:352
    v_cvt_pk_bf16_f32 v50, v24, v25
    v_mfma_f32_16x16x32_bf16 v[32:35], a[76:79], v[152:155], v[32:35]
    s_waitcnt lgkmcnt(7)
    ds_read_b64_tr_b16 a[102:103], v4 offset:480
    v_cvt_pk_bf16_f32 v51, v26, v27
    v_mfma_f32_16x16x32_bf16 v[32:35], a[80:83], v[192:195], v[32:35]
    s_mov_b32 s54, 4096
    ds_read_b64_tr_b16 a[104:105], v4 offset:608
    ds_read_b64_tr_b16 a[106:107], v4 offset:736
    v_mfma_f32_16x16x32_bf16 v[32:35], a[84:87], v[200:203], v[32:35]
    s_waitcnt lgkmcnt(6)
    v_permlane32_swap_b32 v48, v50
    v_mfma_f32_16x16x32_bf16 v[32:35], a[88:91], v[208:211], v[32:35]
    v_permlane32_swap_b32 v49, v51
    v_mfma_f32_16x16x32_bf16 v[32:35], a[92:95], v[216:219], v[32:35]
    ds_read_b64_tr_b16 a[108:109], v4 offset:864
    ds_read_b64_tr_b16 a[110:111], v4 offset:992
    buffer_store_dwordx4 v[48:51], v10, s[40:43], s54 offen offset:0 sc1
    v_mfma_f32_16x16x32_bf16 v[36:39], a[64:67], v[160:163], 0
    ds_read_b64_tr_b16 a[112:113], v4 offset:16992
    v_cvt_pk_bf16_f32 v52, v20, v21
    v_mfma_f32_16x16x32_bf16 v[36:39], a[68:71], v[168:171], v[36:39]
    ds_read_b64_tr_b16 a[114:115], v4 offset:17120
    v_cvt_pk_bf16_f32 v53, v22, v23
    v_mfma_f32_16x16x32_bf16 v[36:39], a[72:75], v[176:179], v[36:39]
    ds_read_b64_tr_b16 a[116:117], v4 offset:17248
    v_cvt_pk_bf16_f32 v54, v28, v29
    v_mfma_f32_16x16x32_bf16 v[36:39], a[76:79], v[184:187], v[36:39]
    ds_read_b64_tr_b16 a[118:119], v4 offset:17376
    v_cvt_pk_bf16_f32 v55, v30, v31
    v_mfma_f32_16x16x32_bf16 v[36:39], a[80:83], v[224:227], v[36:39]
    s_mov_b32 s54, 299008
    ds_read_b64_tr_b16 a[120:121], v4 offset:17504
    ds_read_b64_tr_b16 a[122:123], v4 offset:17632
    v_mfma_f32_16x16x32_bf16 v[36:39], a[84:87], v[232:235], v[36:39]
    v_permlane32_swap_b32 v52, v54
    v_mfma_f32_16x16x32_bf16 v[36:39], a[88:91], v[240:243], v[36:39]
    v_permlane32_swap_b32 v53, v55
    v_mfma_f32_16x16x32_bf16 v[36:39], a[92:95], v[248:251], v[36:39]
    s_waitcnt vmcnt(15)
    s_barrier
    s_waitcnt lgkmcnt(10)
    ds_read_b64_tr_b16 a[124:125], v4 offset:17760
    ds_read_b64_tr_b16 a[126:127], v4 offset:17888
    buffer_store_dwordx4 v[52:55], v10, s[40:43], s54 offen offset:0 sc1
    v_mfma_f32_16x16x32_bf16 v[40:43], a[96:99], v[128:131], 0
    s_add_u32 m0, s44, 36864
    ds_read_b64_tr_b16 a[64:65], v4 offset:36864
    ds_read_b64_tr_b16 a[66:67], v4 offset:36992
    v_mfma_f32_16x16x32_bf16 v[40:43], a[100:103], v[136:139], v[40:43]
    s_mov_b32 s45, 896
    s_waitcnt lgkmcnt(10)
    buffer_load_dwordx4 v7, s[28:31], s45 offen offset:0 lds
    v_mfma_f32_16x16x32_bf16 v[40:43], a[104:107], v[144:147], v[40:43]
    s_add_u32 m0, s44, 36768
    ds_read_b64_tr_b16 a[68:69], v4 offset:37120
    ds_read_b64_tr_b16 a[70:71], v4 offset:37248
    v_mfma_f32_16x16x32_bf16 v[40:43], a[108:111], v[152:155], v[40:43]
    s_waitcnt lgkmcnt(8)
    buffer_load_dwordx4 v7, s[28:31], s45 offen offset:1152 lds
    v_mfma_f32_16x16x32_bf16 v[40:43], a[112:115], v[192:195], v[40:43]
    s_add_u32 m0, s44, 36672
    ds_read_b64_tr_b16 a[72:73], v4 offset:37376
    ds_read_b64_tr_b16 a[74:75], v4 offset:37504
    v_mfma_f32_16x16x32_bf16 v[40:43], a[116:119], v[200:203], v[40:43]
    s_waitcnt lgkmcnt(6)
    buffer_load_dwordx4 v7, s[28:31], s45 offen offset:2304 lds
    v_mfma_f32_16x16x32_bf16 v[40:43], a[120:123], v[208:211], v[40:43]
    s_add_u32 m0, s44, 36576
    ds_read_b64_tr_b16 a[76:77], v4 offset:37632
    ds_read_b64_tr_b16 a[78:79], v4 offset:37760
    v_mfma_f32_16x16x32_bf16 v[40:43], a[124:127], v[216:219], v[40:43]
    buffer_load_dwordx4 v7, s[28:31], s45 offen offset:3456 lds
    v_mfma_f32_16x16x32_bf16 v[44:47], a[96:99], v[160:163], 0
    s_add_u32 m0, s44, 53760
    ds_read_b64_tr_b16 a[80:81], v4 offset:53760
    ds_read_b64_tr_b16 a[82:83], v4 offset:53888
    v_mfma_f32_16x16x32_bf16 v[44:47], a[100:103], v[168:171], v[44:47]
    s_mov_b32 s45, 148352
    buffer_load_dwordx4 v7, s[28:31], s45 offen offset:0 lds
    v_mfma_f32_16x16x32_bf16 v[44:47], a[104:107], v[176:179], v[44:47]
    s_add_u32 m0, s44, 53664
    ds_read_b64_tr_b16 a[84:85], v4 offset:54016
    ds_read_b64_tr_b16 a[86:87], v4 offset:54144
    v_mfma_f32_16x16x32_bf16 v[44:47], a[108:111], v[184:187], v[44:47]
    buffer_load_dwordx4 v7, s[28:31], s45 offen offset:1152 lds
    v_mfma_f32_16x16x32_bf16 v[44:47], a[112:115], v[224:227], v[44:47]
    s_add_u32 m0, s44, 53568
    ds_read_b64_tr_b16 a[88:89], v4 offset:54272
    ds_read_b64_tr_b16 a[90:91], v4 offset:54400
    v_mfma_f32_16x16x32_bf16 v[44:47], a[116:119], v[232:235], v[44:47]
    buffer_load_dwordx4 v7, s[28:31], s45 offen offset:2304 lds
    v_mfma_f32_16x16x32_bf16 v[44:47], a[120:123], v[240:243], v[44:47]
    s_add_u32 m0, s44, 53472
    ds_read_b64_tr_b16 a[92:93], v4 offset:54528
    ds_read_b64_tr_b16 a[94:95], v4 offset:54656
    v_mfma_f32_16x16x32_bf16 v[44:47], a[124:127], v[248:251], v[44:47]
    s_waitcnt lgkmcnt(12)
    buffer_load_dwordx4 v7, s[28:31], s45 offen offset:3456 lds
    v_mfma_f32_16x16x32_bf16 v[16:19], a[64:67], v[128:131], 0
    ds_read_b64_tr_b16 a[96:97], v4 offset:36896
    v_cvt_pk_bf16_f32 v48, v32, v33
    v_mfma_f32_16x16x32_bf16 v[16:19], a[68:71], v[136:139], v[16:19]
    s_waitcnt lgkmcnt(9)
    ds_read_b64_tr_b16 a[98:99], v4 offset:37024
    v_cvt_pk_bf16_f32 v49, v34, v35
    v_mfma_f32_16x16x32_bf16 v[16:19], a[72:75], v[144:147], v[16:19]
    ds_read_b64_tr_b16 a[100:101], v4 offset:37152
    v_cvt_pk_bf16_f32 v50, v40, v41
    v_mfma_f32_16x16x32_bf16 v[16:19], a[76:79], v[152:155], v[16:19]
    s_waitcnt lgkmcnt(7)
    ds_read_b64_tr_b16 a[102:103], v4 offset:37280
    v_cvt_pk_bf16_f32 v51, v42, v43
    v_mfma_f32_16x16x32_bf16 v[16:19], a[80:83], v[192:195], v[16:19]
    s_mov_b32 s54, 4096
    ds_read_b64_tr_b16 a[104:105], v4 offset:37408
    ds_read_b64_tr_b16 a[106:107], v4 offset:37536
    v_mfma_f32_16x16x32_bf16 v[16:19], a[84:87], v[200:203], v[16:19]
    s_waitcnt lgkmcnt(6)
    v_permlane32_swap_b32 v48, v50
    v_mfma_f32_16x16x32_bf16 v[16:19], a[88:91], v[208:211], v[16:19]
    v_permlane32_swap_b32 v49, v51
    v_mfma_f32_16x16x32_bf16 v[16:19], a[92:95], v[216:219], v[16:19]
    ds_read_b64_tr_b16 a[108:109], v4 offset:37664
    ds_read_b64_tr_b16 a[110:111], v4 offset:37792
    buffer_store_dwordx4 v[48:51], v10, s[40:43], s54 offen offset:512 sc1
    v_mfma_f32_16x16x32_bf16 v[20:23], a[64:67], v[160:163], 0
    ds_read_b64_tr_b16 a[112:113], v4 offset:53792
    v_cvt_pk_bf16_f32 v52, v36, v37
    v_mfma_f32_16x16x32_bf16 v[20:23], a[68:71], v[168:171], v[20:23]
    ds_read_b64_tr_b16 a[114:115], v4 offset:53920
    v_cvt_pk_bf16_f32 v53, v38, v39
    v_mfma_f32_16x16x32_bf16 v[20:23], a[72:75], v[176:179], v[20:23]
    ds_read_b64_tr_b16 a[116:117], v4 offset:54048
    v_cvt_pk_bf16_f32 v54, v44, v45
    v_mfma_f32_16x16x32_bf16 v[20:23], a[76:79], v[184:187], v[20:23]
    ds_read_b64_tr_b16 a[118:119], v4 offset:54176
    v_cvt_pk_bf16_f32 v55, v46, v47
    v_mfma_f32_16x16x32_bf16 v[20:23], a[80:83], v[224:227], v[20:23]
    s_mov_b32 s54, 299008
    ds_read_b64_tr_b16 a[120:121], v4 offset:54304
    ds_read_b64_tr_b16 a[122:123], v4 offset:54432
    v_mfma_f32_16x16x32_bf16 v[20:23], a[84:87], v[232:235], v[20:23]
    v_permlane32_swap_b32 v52, v54
    v_mfma_f32_16x16x32_bf16 v[20:23], a[88:91], v[240:243], v[20:23]
    v_permlane32_swap_b32 v53, v55
    v_mfma_f32_16x16x32_bf16 v[20:23], a[92:95], v[248:251], v[20:23]
    s_waitcnt lgkmcnt(10)
    ds_read_b64_tr_b16 a[124:125], v4 offset:54560
    ds_read_b64_tr_b16 a[126:127], v4 offset:54688
    buffer_store_dwordx4 v[52:55], v10, s[40:43], s54 offen offset:512 sc1
    v_mfma_f32_16x16x32_bf16 v[24:27], a[96:99], v[128:131], 0
    ds_read_b64_tr_b16 a[64:65], v4 offset:36928
    v_mfma_f32_16x16x32_bf16 v[24:27], a[100:103], v[136:139], v[24:27]
    s_waitcnt lgkmcnt(9)
    ds_read_b64_tr_b16 a[66:67], v4 offset:37056
    v_mfma_f32_16x16x32_bf16 v[24:27], a[104:107], v[144:147], v[24:27]
    ds_read_b64_tr_b16 a[68:69], v4 offset:37184
    v_mfma_f32_16x16x32_bf16 v[24:27], a[108:111], v[152:155], v[24:27]
    s_waitcnt lgkmcnt(7)
    ds_read_b64_tr_b16 a[70:71], v4 offset:37312
    v_mfma_f32_16x16x32_bf16 v[24:27], a[112:115], v[192:195], v[24:27]
    ds_read_b64_tr_b16 a[72:73], v4 offset:37440
    v_mfma_f32_16x16x32_bf16 v[24:27], a[116:119], v[200:203], v[24:27]
    s_waitcnt lgkmcnt(5)
    ds_read_b64_tr_b16 a[74:75], v4 offset:37568
    v_mfma_f32_16x16x32_bf16 v[24:27], a[120:123], v[208:211], v[24:27]
    ds_read_b64_tr_b16 a[76:77], v4 offset:37696
    v_mfma_f32_16x16x32_bf16 v[24:27], a[124:127], v[216:219], v[24:27]
    ds_read_b64_tr_b16 a[78:79], v4 offset:37824
    v_mfma_f32_16x16x32_bf16 v[28:31], a[96:99], v[160:163], 0
    ds_read_b64_tr_b16 a[80:81], v4 offset:53824
    v_mfma_f32_16x16x32_bf16 v[28:31], a[100:103], v[168:171], v[28:31]
    ds_read_b64_tr_b16 a[82:83], v4 offset:53952
    v_mfma_f32_16x16x32_bf16 v[28:31], a[104:107], v[176:179], v[28:31]
    ds_read_b64_tr_b16 a[84:85], v4 offset:54080
    v_mfma_f32_16x16x32_bf16 v[28:31], a[108:111], v[184:187], v[28:31]
    ds_read_b64_tr_b16 a[86:87], v4 offset:54208
    v_mfma_f32_16x16x32_bf16 v[28:31], a[112:115], v[224:227], v[28:31]
    ds_read_b64_tr_b16 a[88:89], v4 offset:54336
    v_mfma_f32_16x16x32_bf16 v[28:31], a[116:119], v[232:235], v[28:31]
    ds_read_b64_tr_b16 a[90:91], v4 offset:54464
    v_mfma_f32_16x16x32_bf16 v[28:31], a[120:123], v[240:243], v[28:31]
L2_pad11:
    s_cbranch_execz L2_walkret
    ds_read_b64_tr_b16 a[92:93], v4 offset:54592
    v_mfma_f32_16x16x32_bf16 v[28:31], a[124:127], v[248:251], v[28:31]
    s_waitcnt lgkmcnt(11)
    ds_read_b64_tr_b16 a[94:95], v4 offset:54720
    v_mfma_f32_16x16x32_bf16 v[32:35], a[64:67], v[128:131], 0
    ds_read_b64_tr_b16 a[96:97], v4 offset:36960
    v_cvt_pk_bf16_f32 v48, v16, v17
    v_mfma_f32_16x16x32_bf16 v[32:35], a[68:71], v[136:139], v[32:35]
    s_waitcnt lgkmcnt(9)
    ds_read_b64_tr_b16 a[98:99], v4 offset:37088
    v_cvt_pk_bf16_f32 v49, v18, v19
    v_mfma_f32_16x16x32_bf16 v[32:35], a[72:75], v[144:147], v[32:35]
    ds_read_b64_tr_b16 a[100:101], v4 offset:37216
    v_cvt_pk_bf16_f32 v50, v24, v25
    v_mfma_f32_16x16x32_bf16 v[32:35], a[76:79], v[152:155], v[32:35]
    s_waitcnt lgkmcnt(7)
    ds_read_b64_tr_b16 a[102:103], v4 offset:37344
    v_cvt_pk_bf16_f32 v51, v26, v27
    v_mfma_f32_16x16x32_bf16 v[32:35], a[80:83], v[192:195], v[32:35]
    s_mov_b32 s54, 5120
    ds_read_b64_tr_b16 a[104:105], v4 offset:37472
    ds_read_b64_tr_b16 a[106:107], v4 offset:37600
    v_mfma_f32_16x16x32_bf16 v[32:35], a[84:87], v[200:203], v[32:35]
    s_waitcnt lgkmcnt(6)
    v_permlane32_swap_b32 v48, v50
    v_mfma_f32_16x16x32_bf16 v[32:35], a[88:91], v[208:211], v[32:35]
    v_permlane32_swap_b32 v49, v51
    v_mfma_f32_16x16x32_bf16 v[32:35], a[92:95], v[216:219], v[32:35]
    ds_read_b64_tr_b16 a[108:109], v4 offset:37728
    ds_read_b64_tr_b16 a[110:111], v4 offset:37856
    buffer_store_dwordx4 v[48:51], v10, s[40:43], s54 offen offset:0 sc1
    v_mfma_f32_16x16x32_bf16 v[36:39], a[64:67], v[160:163], 0
    ds_read_b64_tr_b16 a[112:113], v4 offset:53856
    v_cvt_pk_bf16_f32 v52, v20, v21
    v_mfma_f32_16x16x32_bf16 v[36:39], a[68:71], v[168:171], v[36:39]
    ds_read_b64_tr_b16 a[114:115], v4 offset:53984
    v_cvt_pk_bf16_f32 v53, v22, v23
    v_mfma_f32_16x16x32_bf16 v[36:39], a[72:75], v[176:179], v[36:39]
    ds_read_b64_tr_b16 a[116:117], v4 offset:54112
    v_cvt_pk_bf16_f32 v54, v28, v29
    v_mfma_f32_16x16x32_bf16 v[36:39], a[76:79], v[184:187], v[36:39]
    ds_read_b64_tr_b16 a[118:119], v4 offset:54240
    v_cvt_pk_bf16_f32 v55, v30, v31
    v_mfma_f32_16x16x32_bf16 v[36:39], a[80:83], v[224:227], v[36:39]
    s_mov_b32 s54, 300032
    ds_read_b64_tr_b16 a[120:121], v4 offset:54368
    ds_read_b64_tr_b16 a[122:123], v4 offset:54496
    v_mfma_f32_16x16x32_bf16 v[36:39], a[84:87], v[232:235], v[36:39]
    v_permlane32_swap_b32 v52, v54
    v_mfma_f32_16x16x32_bf16 v[36:39], a[88:91], v[240:243], v[36:39]
    v_permlane32_swap_b32 v53, v55
    v_mfma_f32_16x16x32_bf16 v[36:39], a[92:95], v[248:251], v[36:39]
    s_waitcnt vmcnt(15)
    s_barrier
    s_waitcnt lgkmcnt(10)
    ds_read_b64_tr_b16 a[124:125], v4 offset:54624
    ds_read_b64_tr_b16 a[126:127], v4 offset:54752
    buffer_store_dwordx4 v[52:55], v10, s[40:43], s54 offen offset:0 sc1
    v_mfma_f32_16x16x32_bf16 v[40:43], a[96:99], v[128:131], 0
    s_add_u32 m0, s44, 73728
    ds_read_b64_tr_b16 a[64:65], v3 offset:0
    ds_read_b64_tr_b16 a[66:67], v3 offset:128
    v_mfma_f32_16x16x32_bf16 v[40:43], a[100:103], v[136:139], v[40:43]
    s_mov_b32 s45, 1024
    s_waitcnt lgkmcnt(10)
    buffer_load_dwordx4 v7, s[28:31], s45 offen offset:0 lds
    v_mfma_f32_16x16x32_bf16 v[40:43], a[104:107], v[144:147], v[40:43]
    s_add_u32 m0, s44, 73632
    ds_read_b64_tr_b16 a[68:69], v3 offset:256
    ds_read_b64_tr_b16 a[70:71], v3 offset:384
    v_mfma_f32_16x16x32_bf16 v[40:43], a[108:111], v[152:155], v[40:43]
    s_waitcnt lgkmcnt(8)
    buffer_load_dwordx4 v7, s[28:31], s45 offen offset:1152 lds
    v_mfma_f32_16x16x32_bf16 v[40:43], a[112:115], v[192:195], v[40:43]
    s_add_u32 m0, s44, 73536
    ds_read_b64_tr_b16 a[72:73], v3 offset:512
    ds_read_b64_tr_b16 a[74:75], v3 offset:640
    v_mfma_f32_16x16x32_bf16 v[40:43], a[116:119], v[200:203], v[40:43]
    s_waitcnt lgkmcnt(6)
    buffer_load_dwordx4 v7, s[28:31], s45 offen offset:2304 lds
    v_mfma_f32_16x16x32_bf16 v[40:43], a[120:123], v[208:211], v[40:43]
    s_add_u32 m0, s44, 73440
    ds_read_b64_tr_b16 a[76:77], v3 offset:768
    ds_read_b64_tr_b16 a[78:79], v3 offset:896
    v_mfma_f32_16x16x32_bf16 v[40:43], a[124:127], v[216:219], v[40:43]
    buffer_load_dwordx4 v7, s[28:31], s45 offen offset:3456 lds
    v_mfma_f32_16x16x32_bf16 v[44:47], a[96:99], v[160:163], 0
    s_add_u32 m0, s44, 90624
    ds_read_b64_tr_b16 a[80:81], v3 offset:16896
    ds_read_b64_tr_b16 a[82:83], v3 offset:17024
    v_mfma_f32_16x16x32_bf16 v[44:47], a[100:103], v[168:171], v[44:47]
    s_mov_b32 s45, 148480
    buffer_load_dwordx4 v7, s[28:31], s45 offen offset:0 lds
    v_mfma_f32_16x16x32_bf16 v[44:47], a[104:107], v[176:179], v[44:47]
    s_add_u32 m0, s44, 90528
    ds_read_b64_tr_b16 a[84:85], v3 offset:17152
    ds_read_b64_tr_b16 a[86:87], v3 offset:17280
    v_mfma_f32_16x16x32_bf16 v[44:47], a[108:111], v[184:187], v[44:47]
    buffer_load_dwordx4 v7, s[28:31], s45 offen offset:1152 lds
    v_mfma_f32_16x16x32_bf16 v[44:47], a[112:115], v[224:227], v[44:47]
    s_add_u32 m0, s44, 90432
    ds_read_b64_tr_b16 a[88:89], v3 offset:17408
    ds_read_b64_tr_b16 a[90:91], v3 offset:17536
    v_mfma_f32_16x16x32_bf16 v[44:47], a[116:119], v[232:235], v[44:47]
    buffer_load_dwordx4 v7, s[28:31], s45 offen offset:2304 lds
    v_mfma_f32_16x16x32_bf16 v[44:47], a[120:123], v[240:243], v[44:47]
    s_add_u32 m0, s44, 90336
    ds_read_b64_tr_b16 a[92:93], v3 offset:17664
    ds_read_b64_tr_b16 a[94:95], v3 offset:17792
    v_mfma_f32_16x16x32_bf16 v[44:47], a[124:127], v[248:251], v[44:47]
    s_waitcnt lgkmcnt(12)
    buffer_load_dwordx4 v7, s[28:31], s45 offen offset:3456 lds
    v_mfma_f32_16x16x32_bf16 v[16:19], a[64:67], v[128:131], 0
    ds_read_b64_tr_b16 a[96:97], v3 offset:32
    v_cvt_pk_bf16_f32 v48, v32, v33
    v_mfma_f32_16x16x32_bf16 v[16:19], a[68:71], v[136:139], v[16:19]
    s_waitcnt lgkmcnt(9)
    ds_read_b64_tr_b16 a[98:99], v3 offset:160
    v_cvt_pk_bf16_f32 v49, v34, v35
    v_mfma_f32_16x16x32_bf16 v[16:19], a[72:75], v[144:147], v[16:19]
    ds_read_b64_tr_b16 a[100:101], v3 offset:288
    v_cvt_pk_bf16_f32 v50, v40, v41
    v_mfma_f32_16x16x32_bf16 v[16:19], a[76:79], v[152:155], v[16:19]
    s_waitcnt lgkmcnt(7)
    ds_read_b64_tr_b16 a[102:103], v3 offset:416
    v_cvt_pk_bf16_f32 v51, v42, v43
    v_mfma_f32_16x16x32_bf16 v[16:19], a[80:83], v[192:195], v[16:19]
    s_mov_b32 s54, 5120
    ds_read_b64_tr_b16 a[104:105], v3 offset:544
    ds_read_b64_tr_b16 a[106:107], v3 offset:672
    v_mfma_f32_16x16x32_bf16 v[16:19], a[84:87], v[200:203], v[16:19]
    s_waitcnt lgkmcnt(6)
    v_permlane32_swap_b32 v48, v50
    v_mfma_f32_16x16x32_bf16 v[16:19], a[88:91], v[208:211], v[16:19]
    v_permlane32_swap_b32 v49, v51
    v_mfma_f32_16x16x32_bf16 v[16:19], a[92:95], v[216:219], v[16:19]
    ds_read_b64_tr_b16 a[108:109], v3 offset:800
    ds_read_b64_tr_b16 a[110:111], v3 offset:928
    buffer_store_dwordx4 v[48:51], v10, s[40:43], s54 offen offset:512 sc1
    v_mfma_f32_16x16x32_bf16 v[20:23], a[64:67], v[160:163], 0
    ds_read_b64_tr_b16 a[112:113], v3 offset:16928
    v_cvt_pk_bf16_f32 v52, v36, v37
    v_mfma_f32_16x16x32_bf16 v[20:23], a[68:71], v[168:171], v[20:23]
    ds_read_b64_tr_b16 a[114:115], v3 offset:17056
    v_cvt_pk_bf16_f32 v53, v38, v39
    v_mfma_f32_16x16x32_bf16 v[20:23], a[72:75], v[176:179], v[20:23]
    ds_read_b64_tr_b16 a[116:117], v3 offset:17184
    v_cvt_pk_bf16_f32 v54, v44, v45
    v_mfma_f32_16x16x32_bf16 v[20:23], a[76:79], v[184:187], v[20:23]
    ds_read_b64_tr_b16 a[118:119], v3 offset:17312
    v_cvt_pk_bf16_f32 v55, v46, v47
    v_mfma_f32_16x16x32_bf16 v[20:23], a[80:83], v[224:227], v[20:23]
    s_mov_b32 s54, 300032
    ds_read_b64_tr_b16 a[120:121], v3 offset:17440
    ds_read_b64_tr_b16 a[122:123], v3 offset:17568
    v_mfma_f32_16x16x32_bf16 v[20:23], a[84:87], v[232:235], v[20:23]
    v_permlane32_swap_b32 v52, v54
    v_mfma_f32_16x16x32_bf16 v[20:23], a[88:91], v[240:243], v[20:23]
    v_permlane32_swap_b32 v53, v55
    v_mfma_f32_16x16x32_bf16 v[20:23], a[92:95], v[248:251], v[20:23]
    s_waitcnt lgkmcnt(10)
    ds_read_b64_tr_b16 a[124:125], v3 offset:17696
    ds_read_b64_tr_b16 a[126:127], v3 offset:17824
    buffer_store_dwordx4 v[52:55], v10, s[40:43], s54 offen offset:512 sc1
    v_mfma_f32_16x16x32_bf16 v[24:27], a[96:99], v[128:131], 0
    ds_read_b64_tr_b16 a[64:65], v3 offset:64
    v_mfma_f32_16x16x32_bf16 v[24:27], a[100:103], v[136:139], v[24:27]
    s_waitcnt lgkmcnt(9)
    ds_read_b64_tr_b16 a[66:67], v3 offset:192
    v_mfma_f32_16x16x32_bf16 v[24:27], a[104:107], v[144:147], v[24:27]
    ds_read_b64_tr_b16 a[68:69], v3 offset:320
    v_mfma_f32_16x16x32_bf16 v[24:27], a[108:111], v[152:155], v[24:27]
    s_waitcnt lgkmcnt(7)
    ds_read_b64_tr_b16 a[70:71], v3 offset:448
    v_mfma_f32_16x16x32_bf16 v[24:27], a[112:115], v[192:195], v[24:27]
    ds_read_b64_tr_b16 a[72:73], v3 offset:576
    v_mfma_f32_16x16x32_bf16 v[24:27], a[116:119], v[200:203], v[24:27]
    s_waitcnt lgkmcnt(5)
    ds_read_b64_tr_b16 a[74:75], v3 offset:704
    v_mfma_f32_16x16x32_bf16 v[24:27], a[120:123], v[208:211], v[24:27]
    ds_read_b64_tr_b16 a[76:77], v3 offset:832
    v_mfma_f32_16x16x32_bf16 v[24:27], a[124:127], v[216:219], v[24:27]
    ds_read_b64_tr_b16 a[78:79], v3 offset:960
    v_mfma_f32_16x16x32_bf16 v[28:31], a[96:99], v[160:163], 0
    ds_read_b64_tr_b16 a[80:81], v3 offset:16960
    v_mfma_f32_16x16x32_bf16 v[28:31], a[100:103], v[168:171], v[28:31]
    ds_read_b64_tr_b16 a[82:83], v3 offset:17088
    v_mfma_f32_16x16x32_bf16 v[28:31], a[104:107], v[176:179], v[28:31]
    ds_read_b64_tr_b16 a[84:85], v3 offset:17216
    v_mfma_f32_16x16x32_bf16 v[28:31], a[108:111], v[184:187], v[28:31]
    ds_read_b64_tr_b16 a[86:87], v3 offset:17344
    v_mfma_f32_16x16x32_bf16 v[28:31], a[112:115], v[224:227], v[28:31]
    ds_read_b64_tr_b16 a[88:89], v3 offset:17472
    v_mfma_f32_16x16x32_bf16 v[28:31], a[116:119], v[232:235], v[28:31]
    ds_read_b64_tr_b16 a[90:91], v3 offset:17600
    v_mfma_f32_16x16x32_bf16 v[28:31], a[120:123], v[240:243], v[28:31]
    ds_read_b64_tr_b16 a[92:93], v3 offset:17728
    v_mfma_f32_16x16x32_bf16 v[28:31], a[124:127], v[248:251], v[28:31]
    s_waitcnt lgkmcnt(11)
    ds_read_b64_tr_b16 a[94:95], v3 offset:17856
    v_mfma_f32_16x16x32_bf16 v[32:35], a[64:67], v[128:131], 0
    ds_read_b64_tr_b16 a[96:97], v3 offset:96
    v_cvt_pk_bf16_f32 v48, v16, v17
    v_mfma_f32_16x16x32_bf16 v[32:35], a[68:71], v[136:139], v[32:35]
    s_waitcnt lgkmcnt(9)
    ds_read_b64_tr_b16 a[98:99], v3 offset:224
    v_cvt_pk_bf16_f32 v49, v18, v19
    v_mfma_f32_16x16x32_bf16 v[32:35], a[72:75], v[144:147], v[32:35]
    ds_read_b64_tr_b16 a[100:101], v3 offset:352
    v_cvt_pk_bf16_f32 v50, v24, v25
    v_mfma_f32_16x16x32_bf16 v[32:35], a[76:79], v[152:155], v[32:35]
    s_waitcnt lgkmcnt(7)
    ds_read_b64_tr_b16 a[102:103], v3 offset:480
    v_cvt_pk_bf16_f32 v51, v26, v27
    v_mfma_f32_16x16x32_bf16 v[32:35], a[80:83], v[192:195], v[32:35]
    s_mov_b32 s54, 6144
    ds_read_b64_tr_b16 a[104:105], v3 offset:608
    ds_read_b64_tr_b16 a[106:107], v3 offset:736
    v_mfma_f32_16x16x32_bf16 v[32:35], a[84:87], v[200:203], v[32:35]
    s_waitcnt lgkmcnt(6)
    v_permlane32_swap_b32 v48, v50
    v_mfma_f32_16x16x32_bf16 v[32:35], a[88:91], v[208:211], v[32:35]
    v_permlane32_swap_b32 v49, v51
    v_mfma_f32_16x16x32_bf16 v[32:35], a[92:95], v[216:219], v[32:35]
    ds_read_b64_tr_b16 a[108:109], v3 offset:864
    ds_read_b64_tr_b16 a[110:111], v3 offset:992
    buffer_store_dwordx4 v[48:51], v10, s[40:43], s54 offen offset:0 sc1
    v_mfma_f32_16x16x32_bf16 v[36:39], a[64:67], v[160:163], 0
    ds_read_b64_tr_b16 a[112:113], v3 offset:16992
    v_cvt_pk_bf16_f32 v52, v20, v21
    v_mfma_f32_16x16x32_bf16 v[36:39], a[68:71], v[168:171], v[36:39]
    ds_read_b64_tr_b16 a[114:115], v3 offset:17120
    v_cvt_pk_bf16_f32 v53, v22, v23
    v_mfma_f32_16x16x32_bf16 v[36:39], a[72:75], v[176:179], v[36:39]
    ds_read_b64_tr_b16 a[116:117], v3 offset:17248
    v_cvt_pk_bf16_f32 v54, v28, v29
    v_mfma_f32_16x16x32_bf16 v[36:39], a[76:79], v[184:187], v[36:39]
    ds_read_b64_tr_b16 a[118:119], v3 offset:17376
    v_cvt_pk_bf16_f32 v55, v30, v31
    v_mfma_f32_16x16x32_bf16 v[36:39], a[80:83], v[224:227], v[36:39]
    s_mov_b32 s54, 301056
    ds_read_b64_tr_b16 a[120:121], v3 offset:17504
    ds_read_b64_tr_b16 a[122:123], v3 offset:17632
    v_mfma_f32_16x16x32_bf16 v[36:39], a[84:87], v[232:235], v[36:39]
    v_permlane32_swap_b32 v52, v54
    v_mfma_f32_16x16x32_bf16 v[36:39], a[88:91], v[240:243], v[36:39]
    v_permlane32_swap_b32 v53, v55
    v_mfma_f32_16x16x32_bf16 v[36:39], a[92:95], v[248:251], v[36:39]
    s_waitcnt vmcnt(15)
    s_barrier
    s_waitcnt lgkmcnt(10)
    ds_read_b64_tr_b16 a[124:125], v3 offset:17760
    ds_read_b64_tr_b16 a[126:127], v3 offset:17888
    buffer_store_dwordx4 v[52:55], v10, s[40:43], s54 offen offset:0 sc1
    v_mfma_f32_16x16x32_bf16 v[40:43], a[96:99], v[128:131], 0
    ds_read_b64_tr_b16 a[64:65], v3 offset:36864
    v_mfma_f32_16x16x32_bf16 v[40:43], a[100:103], v[136:139], v[40:43]
    s_waitcnt lgkmcnt(9)
    ds_read_b64_tr_b16 a[66:67], v3 offset:36992
    v_mfma_f32_16x16x32_bf16 v[40:43], a[104:107], v[144:147], v[40:43]
    ds_read_b64_tr_b16 a[68:69], v3 offset:37120
    v_mfma_f32_16x16x32_bf16 v[40:43], a[108:111], v[152:155], v[40:43]
    s_waitcnt lgkmcnt(7)
    ds_read_b64_tr_b16 a[70:71], v3 offset:37248
    v_mfma_f32_16x16x32_bf16 v[40:43], a[112:115], v[192:195], v[40:43]
    ds_read_b64_tr_b16 a[72:73], v3 offset:37376
    v_mfma_f32_16x16x32_bf16 v[40:43], a[116:119], v[200:203], v[40:43]
    s_waitcnt lgkmcnt(5)
    ds_read_b64_tr_b16 a[74:75], v3 offset:37504
    v_mfma_f32_16x16x32_bf16 v[40:43], a[120:123], v[208:211], v[40:43]
    ds_read_b64_tr_b16 a[76:77], v3 offset:37632
    v_mfma_f32_16x16x32_bf16 v[40:43], a[124:127], v[216:219], v[40:43]
    ds_read_b64_tr_b16 a[78:79], v3 offset:37760
    v_mfma_f32_16x16x32_bf16 v[44:47], a[96:99], v[160:163], 0
    s_sub_u32 s28, s88, 4096
    s_subb_u32 s29, s89, 0
    ds_read_b64_tr_b16 a[80:81], v3 offset:53760
    v_mfma_f32_16x16x32_bf16 v[44:47], a[100:103], v[168:171], v[44:47]
    s_mov_b32 s30, 147456
    ds_read_b64_tr_b16 a[82:83], v3 offset:53888
    v_mfma_f32_16x16x32_bf16 v[44:47], a[104:107], v[176:179], v[44:47]
    ds_read_b64_tr_b16 a[84:85], v3 offset:54016
    v_mfma_f32_16x16x32_bf16 v[44:47], a[108:111], v[184:187], v[44:47]
    ds_read_b64_tr_b16 a[86:87], v3 offset:54144
    v_mfma_f32_16x16x32_bf16 v[44:47], a[112:115], v[224:227], v[44:47]
    ds_read_b64_tr_b16 a[88:89], v3 offset:54272
    v_mfma_f32_16x16x32_bf16 v[44:47], a[116:119], v[232:235], v[44:47]
    ds_read_b64_tr_b16 a[90:91], v3 offset:54400
    v_mfma_f32_16x16x32_bf16 v[44:47], a[120:123], v[240:243], v[44:47]
    ds_read_b64_tr_b16 a[92:93], v3 offset:54528
    v_mfma_f32_16x16x32_bf16 v[44:47], a[124:127], v[248:251], v[44:47]
    s_waitcnt lgkmcnt(11)
    ds_read_b64_tr_b16 a[94:95], v3 offset:54656
    v_mfma_f32_16x16x32_bf16 v[16:19], a[64:67], v[128:131], 0
    ds_read_b64_tr_b16 a[96:97], v3 offset:36896
    v_cvt_pk_bf16_f32 v48, v32, v33
    v_mfma_f32_16x16x32_bf16 v[16:19], a[68:71], v[136:139], v[16:19]
    s_waitcnt lgkmcnt(9)
    ds_read_b64_tr_b16 a[98:99], v3 offset:37024
    v_cvt_pk_bf16_f32 v49, v34, v35
    v_mfma_f32_16x16x32_bf16 v[16:19], a[72:75], v[144:147], v[16:19]
    ds_read_b64_tr_b16 a[100:101], v3 offset:37152
    v_cvt_pk_bf16_f32 v50, v40, v41
    v_mfma_f32_16x16x32_bf16 v[16:19], a[76:79], v[152:155], v[16:19]
    s_waitcnt lgkmcnt(7)
    ds_read_b64_tr_b16 a[102:103], v3 offset:37280
    v_cvt_pk_bf16_f32 v51, v42, v43
    v_mfma_f32_16x16x32_bf16 v[16:19], a[80:83], v[192:195], v[16:19]
    s_mov_b32 s54, 6144
    ds_read_b64_tr_b16 a[104:105], v3 offset:37408
    ds_read_b64_tr_b16 a[106:107], v3 offset:37536
    v_mfma_f32_16x16x32_bf16 v[16:19], a[84:87], v[200:203], v[16:19]
    s_waitcnt lgkmcnt(6)
    v_permlane32_swap_b32 v48, v50
    v_mfma_f32_16x16x32_bf16 v[16:19], a[88:91], v[208:211], v[16:19]
    v_permlane32_swap_b32 v49, v51
    v_mfma_f32_16x16x32_bf16 v[16:19], a[92:95], v[216:219], v[16:19]
    ds_read_b64_tr_b16 a[108:109], v3 offset:37664
    ds_read_b64_tr_b16 a[110:111], v3 offset:37792
    buffer_store_dwordx4 v[48:51], v10, s[40:43], s54 offen offset:512 sc1
    v_mfma_f32_16x16x32_bf16 v[20:23], a[64:67], v[160:163], 0
    ds_read_b64_tr_b16 a[112:113], v3 offset:53792
    v_cvt_pk_bf16_f32 v52, v36, v37
    v_mfma_f32_16x16x32_bf16 v[20:23], a[68:71], v[168:171], v[20:23]
    ds_read_b64_tr_b16 a[114:115], v3 offset:53920
    v_cvt_pk_bf16_f32 v53, v38, v39
    v_mfma_f32_16x16x32_bf16 v[20:23], a[72:75], v[176:179], v[20:23]
    ds_read_b64_tr_b16 a[116:117], v3 offset:54048
    v_cvt_pk_bf16_f32 v54, v44, v45
    v_mfma_f32_16x16x32_bf16 v[20:23], a[76:79], v[184:187], v[20:23]
    ds_read_b64_tr_b16 a[118:119], v3 offset:54176
    v_cvt_pk_bf16_f32 v55, v46, v47
    v_mfma_f32_16x16x32_bf16 v[20:23], a[80:83], v[224:227], v[20:23]
    s_mov_b32 s54, 301056
    ds_read_b64_tr_b16 a[120:121], v3 offset:54304
    ds_read_b64_tr_b16 a[122:123], v3 offset:54432
    v_mfma_f32_16x16x32_bf16 v[20:23], a[84:87], v[232:235], v[20:23]
    v_permlane32_swap_b32 v52, v54
    v_mfma_f32_16x16x32_bf16 v[20:23], a[88:91], v[240:243], v[20:23]
    v_permlane32_swap_b32 v53, v55
    v_mfma_f32_16x16x32_bf16 v[20:23], a[92:95], v[248:251], v[20:23]
    s_waitcnt lgkmcnt(10)
    ds_read_b64_tr_b16 a[124:125], v3 offset:54560
    ds_read_b64_tr_b16 a[126:127], v3 offset:54688
    buffer_store_dwordx4 v[52:55], v10, s[40:43], s54 offen offset:512 sc1
    v_mfma_f32_16x16x32_bf16 v[24:27], a[96:99], v[128:131], 0
    ds_read_b64_tr_b16 a[64:65], v3 offset:36928
    v_mfma_f32_16x16x32_bf16 v[24:27], a[100:103], v[136:139], v[24:27]
    s_waitcnt lgkmcnt(9)
    ds_read_b64_tr_b16 a[66:67], v3 offset:37056
    v_mfma_f32_16x16x32_bf16 v[24:27], a[104:107], v[144:147], v[24:27]
    ds_read_b64_tr_b16 a[68:69], v3 offset:37184
    v_mfma_f32_16x16x32_bf16 v[24:27], a[108:111], v[152:155], v[24:27]
    s_waitcnt lgkmcnt(7)
    ds_read_b64_tr_b16 a[70:71], v3 offset:37312
    v_mfma_f32_16x16x32_bf16 v[24:27], a[112:115], v[192:195], v[24:27]
    ds_read_b64_tr_b16 a[72:73], v3 offset:37440
    v_mfma_f32_16x16x32_bf16 v[24:27], a[116:119], v[200:203], v[24:27]
    s_waitcnt lgkmcnt(5)
    ds_read_b64_tr_b16 a[74:75], v3 offset:37568
    v_mfma_f32_16x16x32_bf16 v[24:27], a[120:123], v[208:211], v[24:27]
    ds_read_b64_tr_b16 a[76:77], v3 offset:37696
    v_mfma_f32_16x16x32_bf16 v[24:27], a[124:127], v[216:219], v[24:27]
    ds_read_b64_tr_b16 a[78:79], v3 offset:37824
    v_mfma_f32_16x16x32_bf16 v[28:31], a[96:99], v[160:163], 0
    ds_read_b64_tr_b16 a[80:81], v3 offset:53824
    v_mfma_f32_16x16x32_bf16 v[28:31], a[100:103], v[168:171], v[28:31]
    ds_read_b64_tr_b16 a[82:83], v3 offset:53952
    v_mfma_f32_16x16x32_bf16 v[28:31], a[104:107], v[176:179], v[28:31]
    ds_read_b64_tr_b16 a[84:85], v3 offset:54080
    v_mfma_f32_16x16x32_bf16 v[28:31], a[108:111], v[184:187], v[28:31]
    ds_read_b64_tr_b16 a[86:87], v3 offset:54208
    v_mfma_f32_16x16x32_bf16 v[28:31], a[112:115], v[224:227], v[28:31]
    ds_read_b64_tr_b16 a[88:89], v3 offset:54336
    v_mfma_f32_16x16x32_bf16 v[28:31], a[116:119], v[232:235], v[28:31]
    ds_read_b64_tr_b16 a[90:91], v3 offset:54464
    v_mfma_f32_16x16x32_bf16 v[28:31], a[120:123], v[240:243], v[28:31]
    ds_read_b64_tr_b16 a[92:93], v3 offset:54592
    v_mfma_f32_16x16x32_bf16 v[28:31], a[124:127], v[248:251], v[28:31]
    s_waitcnt lgkmcnt(11)
    ds_read_b64_tr_b16 a[94:95], v3 offset:54720
    v_mfma_f32_16x16x32_bf16 v[32:35], a[64:67], v[128:131], 0
    ds_read_b64_tr_b16 a[96:97], v3 offset:36960
    v_cvt_pk_bf16_f32 v48, v16, v17
    v_mfma_f32_16x16x32_bf16 v[32:35], a[68:71], v[136:139], v[32:35]
    s_waitcnt lgkmcnt(9)
    ds_read_b64_tr_b16 a[98:99], v3 offset:37088
    v_cvt_pk_bf16_f32 v49, v18, v19
    v_mfma_f32_16x16x32_bf16 v[32:35], a[72:75], v[144:147], v[32:35]
    ds_read_b64_tr_b16 a[100:101], v3 offset:37216
    v_cvt_pk_bf16_f32 v50, v24, v25
    v_mfma_f32_16x16x32_bf16 v[32:35], a[76:79], v[152:155], v[32:35]
    s_waitcnt lgkmcnt(7)
    ds_read_b64_tr_b16 a[102:103], v3 offset:37344
    v_cvt_pk_bf16_f32 v51, v26, v27
    v_mfma_f32_16x16x32_bf16 v[32:35], a[80:83], v[192:195], v[32:35]
    s_mov_b32 s54, 7168
    ds_read_b64_tr_b16 a[104:105], v3 offset:37472
    ds_read_b64_tr_b16 a[106:107], v3 offset:37600
    v_mfma_f32_16x16x32_bf16 v[32:35], a[84:87], v[200:203], v[32:35]
    s_waitcnt lgkmcnt(6)
    v_permlane32_swap_b32 v48, v50
    v_mfma_f32_16x16x32_bf16 v[32:35], a[88:91], v[208:211], v[32:35]
    v_permlane32_swap_b32 v49, v51
    v_mfma_f32_16x16x32_bf16 v[32:35], a[92:95], v[216:219], v[32:35]
    ds_read_b64_tr_b16 a[108:109], v3 offset:37728
    ds_read_b64_tr_b16 a[110:111], v3 offset:37856
    buffer_store_dwordx4 v[48:51], v10, s[40:43], s54 offen offset:0 sc1
    v_mfma_f32_16x16x32_bf16 v[36:39], a[64:67], v[160:163], 0
    ds_read_b64_tr_b16 a[112:113], v3 offset:53856
    v_cvt_pk_bf16_f32 v52, v20, v21
    v_mfma_f32_16x16x32_bf16 v[36:39], a[68:71], v[168:171], v[36:39]
    ds_read_b64_tr_b16 a[114:115], v3 offset:53984
    v_cvt_pk_bf16_f32 v53, v22, v23
    v_mfma_f32_16x16x32_bf16 v[36:39], a[72:75], v[176:179], v[36:39]
    ds_read_b64_tr_b16 a[116:117], v3 offset:54112
    v_cvt_pk_bf16_f32 v54, v28, v29
    v_mfma_f32_16x16x32_bf16 v[36:39], a[76:79], v[184:187], v[36:39]
    ds_read_b64_tr_b16 a[118:119], v3 offset:54240
    v_cvt_pk_bf16_f32 v55, v30, v31
    v_mfma_f32_16x16x32_bf16 v[36:39], a[80:83], v[224:227], v[36:39]
    s_mov_b32 s54, 302080
    ds_read_b64_tr_b16 a[120:121], v3 offset:54368
    ds_read_b64_tr_b16 a[122:123], v3 offset:54496
    v_mfma_f32_16x16x32_bf16 v[36:39], a[84:87], v[232:235], v[36:39]
    v_permlane32_swap_b32 v52, v54
    v_mfma_f32_16x16x32_bf16 v[36:39], a[88:91], v[240:243], v[36:39]
    v_permlane32_swap_b32 v53, v55
    v_mfma_f32_16x16x32_bf16 v[36:39], a[92:95], v[248:251], v[36:39]
    s_waitcnt vmcnt(7)
    s_barrier
    s_waitcnt lgkmcnt(10)
    ds_read_b64_tr_b16 a[124:125], v3 offset:54624
    ds_read_b64_tr_b16 a[126:127], v3 offset:54752
    buffer_store_dwordx4 v[52:55], v10, s[40:43], s54 offen offset:0 sc1
    v_mfma_f32_16x16x32_bf16 v[40:43], a[96:99], v[128:131], 0
    ds_read_b64_tr_b16 a[64:65], v4 offset:0
    v_mfma_f32_16x16x32_bf16 v[40:43], a[100:103], v[136:139], v[40:43]
    s_waitcnt lgkmcnt(9)
    ds_read_b64_tr_b16 a[66:67], v4 offset:128
    v_mfma_f32_16x16x32_bf16 v[40:43], a[104:107], v[144:147], v[40:43]
    ds_read_b64_tr_b16 a[68:69], v4 offset:256
    v_mfma_f32_16x16x32_bf16 v[40:43], a[108:111], v[152:155], v[40:43]
    s_waitcnt lgkmcnt(7)
    ds_read_b64_tr_b16 a[70:71], v4 offset:384
    v_mfma_f32_16x16x32_bf16 v[40:43], a[112:115], v[192:195], v[40:43]
    ds_read_b64_tr_b16 a[72:73], v4 offset:512
    v_mfma_f32_16x16x32_bf16 v[40:43], a[116:119], v[200:203], v[40:43]
    s_waitcnt lgkmcnt(5)
    ds_read_b64_tr_b16 a[74:75], v4 offset:640
    v_mfma_f32_16x16x32_bf16 v[40:43], a[120:123], v[208:211], v[40:43]
    ds_read_b64_tr_b16 a[76:77], v4 offset:768
    v_mfma_f32_16x16x32_bf16 v[40:43], a[124:127], v[216:219], v[40:43]
    ds_read_b64_tr_b16 a[78:79], v4 offset:896
    v_mfma_f32_16x16x32_bf16 v[44:47], a[96:99], v[160:163], 0
    ds_read_b64_tr_b16 a[80:81], v4 offset:16896
    v_mfma_f32_16x16x32_bf16 v[44:47], a[100:103], v[168:171], v[44:47]
    ds_read_b64_tr_b16 a[82:83], v4 offset:17024
    v_mfma_f32_16x16x32_bf16 v[44:47], a[104:107], v[176:179], v[44:47]
    ds_read_b64_tr_b16 a[84:85], v4 offset:17152
    v_mfma_f32_16x16x32_bf16 v[44:47], a[108:111], v[184:187], v[44:47]
    ds_read_b64_tr_b16 a[86:87], v4 offset:17280
    v_mfma_f32_16x16x32_bf16 v[44:47], a[112:115], v[224:227], v[44:47]
    ds_read_b64_tr_b16 a[88:89], v4 offset:17408
    v_mfma_f32_16x16x32_bf16 v[44:47], a[116:119], v[232:235], v[44:47]
    ds_read_b64_tr_b16 a[90:91], v4 offset:17536
    v_mfma_f32_16x16x32_bf16 v[44:47], a[120:123], v[240:243], v[44:47]
    ds_read_b64_tr_b16 a[92:93], v4 offset:17664
    v_mfma_f32_16x16x32_bf16 v[44:47], a[124:127], v[248:251], v[44:47]
    s_waitcnt lgkmcnt(11)
    ds_read_b64_tr_b16 a[94:95], v4 offset:17792
    v_mfma_f32_16x16x32_bf16 v[16:19], a[64:67], v[128:131], 0
    ds_read_b64_tr_b16 a[96:97], v4 offset:32
    v_cvt_pk_bf16_f32 v48, v32, v33
    v_mfma_f32_16x16x32_bf16 v[16:19], a[68:71], v[136:139], v[16:19]
    s_waitcnt lgkmcnt(9)
    ds_read_b64_tr_b16 a[98:99], v4 offset:160
    v_cvt_pk_bf16_f32 v49, v34, v35
    v_mfma_f32_16x16x32_bf16 v[16:19], a[72:75], v[144:147], v[16:19]
    ds_read_b64_tr_b16 a[100:101], v4 offset:288
    v_cvt_pk_bf16_f32 v50, v40, v41
    v_mfma_f32_16x16x32_bf16 v[16:19], a[76:79], v[152:155], v[16:19]
    s_waitcnt lgkmcnt(7)
    ds_read_b64_tr_b16 a[102:103], v4 offset:416
    v_cvt_pk_bf16_f32 v51, v42, v43
    v_mfma_f32_16x16x32_bf16 v[16:19], a[80:83], v[192:195], v[16:19]
    s_mov_b32 s54, 7168
    ds_read_b64_tr_b16 a[104:105], v4 offset:544
    ds_read_b64_tr_b16 a[106:107], v4 offset:672
    v_mfma_f32_16x16x32_bf16 v[16:19], a[84:87], v[200:203], v[16:19]
    s_waitcnt lgkmcnt(6)
    v_permlane32_swap_b32 v48, v50
    v_mfma_f32_16x16x32_bf16 v[16:19], a[88:91], v[208:211], v[16:19]
    v_permlane32_swap_b32 v49, v51
    v_mfma_f32_16x16x32_bf16 v[16:19], a[92:95], v[216:219], v[16:19]
    ds_read_b64_tr_b16 a[108:109], v4 offset:800
    ds_read_b64_tr_b16 a[110:111], v4 offset:928
    buffer_store_dwordx4 v[48:51], v10, s[40:43], s54 offen offset:512 sc1
    v_mfma_f32_16x16x32_bf16 v[20:23], a[64:67], v[160:163], 0
    ds_read_b64_tr_b16 a[112:113], v4 offset:16928
    v_cvt_pk_bf16_f32 v52, v36, v37
    v_mfma_f32_16x16x32_bf16 v[20:23], a[68:71], v[168:171], v[20:23]
    ds_read_b64_tr_b16 a[114:115], v4 offset:17056
    v_cvt_pk_bf16_f32 v53, v38, v39
    v_mfma_f32_16x16x32_bf16 v[20:23], a[72:75], v[176:179], v[20:23]
    ds_read_b64_tr_b16 a[116:117], v4 offset:17184
    v_cvt_pk_bf16_f32 v54, v44, v45
    v_mfma_f32_16x16x32_bf16 v[20:23], a[76:79], v[184:187], v[20:23]
    ds_read_b64_tr_b16 a[118:119], v4 offset:17312
    v_cvt_pk_bf16_f32 v55, v46, v47
    v_mfma_f32_16x16x32_bf16 v[20:23], a[80:83], v[224:227], v[20:23]
    s_mov_b32 s54, 302080
    ds_read_b64_tr_b16 a[120:121], v4 offset:17440
    ds_read_b64_tr_b16 a[122:123], v4 offset:17568
    v_mfma_f32_16x16x32_bf16 v[20:23], a[84:87], v[232:235], v[20:23]
    v_permlane32_swap_b32 v52, v54
    v_mfma_f32_16x16x32_bf16 v[20:23], a[88:91], v[240:243], v[20:23]
    v_permlane32_swap_b32 v53, v55
    v_mfma_f32_16x16x32_bf16 v[20:23], a[92:95], v[248:251], v[20:23]
    s_waitcnt lgkmcnt(10)
    ds_read_b64_tr_b16 a[124:125], v4 offset:17696
    ds_read_b64_tr_b16 a[126:127], v4 offset:17824
    buffer_store_dwordx4 v[52:55], v10, s[40:43], s54 offen offset:512 sc1
    v_mfma_f32_16x16x32_bf16 v[24:27], a[96:99], v[128:131], 0
    ds_read_b64_tr_b16 a[64:65], v4 offset:64
    v_mfma_f32_16x16x32_bf16 v[24:27], a[100:103], v[136:139], v[24:27]
    s_waitcnt lgkmcnt(9)
    ds_read_b64_tr_b16 a[66:67], v4 offset:192
    v_mfma_f32_16x16x32_bf16 v[24:27], a[104:107], v[144:147], v[24:27]
    ds_read_b64_tr_b16 a[68:69], v4 offset:320
    v_mfma_f32_16x16x32_bf16 v[24:27], a[108:111], v[152:155], v[24:27]
    s_waitcnt lgkmcnt(7)
    ds_read_b64_tr_b16 a[70:71], v4 offset:448
    v_mfma_f32_16x16x32_bf16 v[24:27], a[112:115], v[192:195], v[24:27]
    ds_read_b64_tr_b16 a[72:73], v4 offset:576
    v_mfma_f32_16x16x32_bf16 v[24:27], a[116:119], v[200:203], v[24:27]
    s_waitcnt lgkmcnt(5)
    ds_read_b64_tr_b16 a[74:75], v4 offset:704
    v_mfma_f32_16x16x32_bf16 v[24:27], a[120:123], v[208:211], v[24:27]
    ds_read_b64_tr_b16 a[76:77], v4 offset:832
    v_mfma_f32_16x16x32_bf16 v[24:27], a[124:127], v[216:219], v[24:27]
    ds_read_b64_tr_b16 a[78:79], v4 offset:960
    v_mfma_f32_16x16x32_bf16 v[28:31], a[96:99], v[160:163], 0
    ds_read_b64_tr_b16 a[80:81], v4 offset:16960
    v_mfma_f32_16x16x32_bf16 v[28:31], a[100:103], v[168:171], v[28:31]
    ds_read_b64_tr_b16 a[82:83], v4 offset:17088
    v_mfma_f32_16x16x32_bf16 v[28:31], a[104:107], v[176:179], v[28:31]
    ds_read_b64_tr_b16 a[84:85], v4 offset:17216
    v_mfma_f32_16x16x32_bf16 v[28:31], a[108:111], v[184:187], v[28:31]
    ds_read_b64_tr_b16 a[86:87], v4 offset:17344
    v_mfma_f32_16x16x32_bf16 v[28:31], a[112:115], v[224:227], v[28:31]
L2_pad12:
    s_cbranch_execz L2_walkret
    ds_read_b64_tr_b16 a[88:89], v4 offset:17472
    v_mfma_f32_16x16x32_bf16 v[28:31], a[116:119], v[232:235], v[28:31]
    ds_read_b64_tr_b16 a[90:91], v4 offset:17600
    v_mfma_f32_16x16x32_bf16 v[28:31], a[120:123], v[240:243], v[28:31]
    ds_read_b64_tr_b16 a[92:93], v4 offset:17728
    v_mfma_f32_16x16x32_bf16 v[28:31], a[124:127], v[248:251], v[28:31]
    s_waitcnt lgkmcnt(11)
    ds_read_b64_tr_b16 a[94:95], v4 offset:17856
    v_mfma_f32_16x16x32_bf16 v[32:35], a[64:67], v[128:131], 0
    ds_read_b64_tr_b16 a[96:97], v4 offset:96
    v_cvt_pk_bf16_f32 v48, v16, v17
    v_mfma_f32_16x16x32_bf16 v[32:35], a[68:71], v[136:139], v[32:35]
    s_waitcnt lgkmcnt(9)
    ds_read_b64_tr_b16 a[98:99], v4 offset:224
    v_cvt_pk_bf16_f32 v49, v18, v19
    v_mfma_f32_16x16x32_bf16 v[32:35], a[72:75], v[144:147], v[32:35]
    ds_read_b64_tr_b16 a[100:101], v4 offset:352
    v_cvt_pk_bf16_f32 v50, v24, v25
    v_mfma_f32_16x16x32_bf16 v[32:35], a[76:79], v[152:155], v[32:35]
    s_waitcnt lgkmcnt(7)
    ds_read_b64_tr_b16 a[102:103], v4 offset:480
    v_cvt_pk_bf16_f32 v51, v26, v27
    v_mfma_f32_16x16x32_bf16 v[32:35], a[80:83], v[192:195], v[32:35]
    s_mov_b32 s54, 8192
    ds_read_b64_tr_b16 a[104:105], v4 offset:608
    ds_read_b64_tr_b16 a[106:107], v4 offset:736
    v_mfma_f32_16x16x32_bf16 v[32:35], a[84:87], v[200:203], v[32:35]
    s_waitcnt lgkmcnt(6)
    v_permlane32_swap_b32 v48, v50
    v_mfma_f32_16x16x32_bf16 v[32:35], a[88:91], v[208:211], v[32:35]
    v_permlane32_swap_b32 v49, v51
    v_mfma_f32_16x16x32_bf16 v[32:35], a[92:95], v[216:219], v[32:35]
    ds_read_b64_tr_b16 a[108:109], v4 offset:864
    ds_read_b64_tr_b16 a[110:111], v4 offset:992
    buffer_store_dwordx4 v[48:51], v10, s[40:43], s54 offen offset:0 sc1
    v_mfma_f32_16x16x32_bf16 v[36:39], a[64:67], v[160:163], 0
    ds_read_b64_tr_b16 a[112:113], v4 offset:16992
    v_cvt_pk_bf16_f32 v52, v20, v21
    v_mfma_f32_16x16x32_bf16 v[36:39], a[68:71], v[168:171], v[36:39]
    ds_read_b64_tr_b16 a[114:115], v4 offset:17120
    v_cvt_pk_bf16_f32 v53, v22, v23
    v_mfma_f32_16x16x32_bf16 v[36:39], a[72:75], v[176:179], v[36:39]
    ds_read_b64_tr_b16 a[116:117], v4 offset:17248
    v_cvt_pk_bf16_f32 v54, v28, v29
    v_mfma_f32_16x16x32_bf16 v[36:39], a[76:79], v[184:187], v[36:39]
    ds_read_b64_tr_b16 a[118:119], v4 offset:17376
    v_cvt_pk_bf16_f32 v55, v30, v31
    v_mfma_f32_16x16x32_bf16 v[36:39], a[80:83], v[224:227], v[36:39]
    s_mov_b32 s54, 303104
    ds_read_b64_tr_b16 a[120:121], v4 offset:17504
    ds_read_b64_tr_b16 a[122:123], v4 offset:17632
    v_mfma_f32_16x16x32_bf16 v[36:39], a[84:87], v[232:235], v[36:39]
    v_permlane32_swap_b32 v52, v54
    v_mfma_f32_16x16x32_bf16 v[36:39], a[88:91], v[240:243], v[36:39]
    v_permlane32_swap_b32 v53, v55
    v_mfma_f32_16x16x32_bf16 v[36:39], a[92:95], v[248:251], v[36:39]
    s_waitcnt lgkmcnt(10)
    ds_read_b64_tr_b16 a[124:125], v4 offset:17760
    ds_read_b64_tr_b16 a[126:127], v4 offset:17888
    buffer_store_dwordx4 v[52:55], v10, s[40:43], s54 offen offset:0 sc1
    v_mfma_f32_16x16x32_bf16 v[40:43], a[96:99], v[128:131], 0
    v_mfma_f32_16x16x32_bf16 v[40:43], a[100:103], v[136:139], v[40:43]
    s_waitcnt lgkmcnt(8)
    v_mfma_f32_16x16x32_bf16 v[40:43], a[104:107], v[144:147], v[40:43]
    v_mfma_f32_16x16x32_bf16 v[40:43], a[108:111], v[152:155], v[40:43]
    s_waitcnt lgkmcnt(4)
    v_mfma_f32_16x16x32_bf16 v[40:43], a[112:115], v[192:195], v[40:43]
    v_mfma_f32_16x16x32_bf16 v[40:43], a[116:119], v[200:203], v[40:43]
    s_waitcnt lgkmcnt(0)
    v_mfma_f32_16x16x32_bf16 v[40:43], a[120:123], v[208:211], v[40:43]
    v_mfma_f32_16x16x32_bf16 v[40:43], a[124:127], v[216:219], v[40:43]
    v_mfma_f32_16x16x32_bf16 v[44:47], a[96:99], v[160:163], 0
    v_mfma_f32_16x16x32_bf16 v[44:47], a[100:103], v[168:171], v[44:47]
    v_mfma_f32_16x16x32_bf16 v[44:47], a[104:107], v[176:179], v[44:47]
    v_mfma_f32_16x16x32_bf16 v[44:47], a[108:111], v[184:187], v[44:47]
    v_mfma_f32_16x16x32_bf16 v[44:47], a[112:115], v[224:227], v[44:47]
    v_mfma_f32_16x16x32_bf16 v[44:47], a[116:119], v[232:235], v[44:47]
    v_mfma_f32_16x16x32_bf16 v[44:47], a[120:123], v[240:243], v[44:47]
    v_mfma_f32_16x16x32_bf16 v[44:47], a[124:127], v[248:251], v[44:47]
    s_nop 7
    v_cvt_pk_bf16_f32 v48, v32, v33
    v_cvt_pk_bf16_f32 v49, v34, v35
    v_cvt_pk_bf16_f32 v50, v40, v41
    v_cvt_pk_bf16_f32 v51, v42, v43
    s_nop 1
    v_permlane32_swap_b32 v48, v50
    v_permlane32_swap_b32 v49, v51
    s_mov_b32 s54, 8192
    buffer_store_dwordx4 v[48:51], v10, s[40:43], s54 offen offset:512 sc1
    v_cvt_pk_bf16_f32 v52, v36, v37
    v_cvt_pk_bf16_f32 v53, v38, v39
    v_cvt_pk_bf16_f32 v54, v44, v45
    v_cvt_pk_bf16_f32 v55, v46, v47
    s_nop 1
    v_permlane32_swap_b32 v52, v54
    v_permlane32_swap_b32 v53, v55
    s_mov_b32 s54, 303104
    buffer_store_dwordx4 v[52:55], v10, s[40:43], s54 offen offset:512 sc1
    buffer_load_dword v9, v6, s[84:87], s47 offen sc1
    s_movk_i32 s45, 4608
    buffer_load_dwordx4 v[76:79], v5, s[84:87], s45 offen sc1
    s_movk_i32 s45, 18432
    buffer_load_dwordx4 v[88:91], v5, s[84:87], s45 offen sc1
    s_movk_i32 s45, 8704
    buffer_load_dwordx4 v[80:83], v5, s[84:87], s45 offen sc1
    s_movk_i32 s45, 22528
    buffer_load_dwordx4 v[92:95], v5, s[84:87], s45 offen sc1
    s_movk_i32 s45, 12800
    buffer_load_dwordx4 v[84:87], v59, s[84:87], s45 offen sc1
    s_movk_i32 s45, 26624
    buffer_load_dwordx4 v[96:99], v59, s[84:87], s45 offen sc1
    buffer_load_dwordx4 v[224:227], v12, s[36:39], 0 offen offset:0
    buffer_load_dwordx4 v[232:235], v12, s[36:39], 0 offen offset:512
    buffer_load_dwordx4 v[240:243], v13, s[36:39], 0 offen offset:1024
    buffer_load_dwordx4 v[64:67], v1, s[76:79], 0 offen offset:0
    buffer_load_dwordx4 v[68:71], v1, s[76:79], 0 offen offset:512
    buffer_load_dwordx4 v[72:75], v2, s[76:79], 0 offen offset:0
    s_waitcnt vmcnt(13)
    buffer_store_dword v3, v15, s[84:87], s56 offen sc1
    s_movk_i32 s48, 0x1111
    v_lshrrev_b32 v15, 4, v0
    v_mul_u32_u24 v15, 9216, v15
    v_add_u32 v15, 4096, v15
    v_add_u32 v7, v59, v15
    s_waitcnt vmcnt(13)
    v_cmp_ne_u32 vcc, 0, v9
    s_nop 0
    s_lshr_b32 s3, vcc_lo, 1
    s_and_b32 s3, s3, vcc_lo
    s_lshr_b32 s14, s3, 2
    s_and_b32 s3, s3, s14
    s_and_b32 s3, s3, s48
    s_cbranch_scc0 L2_g0s
L2_g0r:
    s_ff1_i32_b32 s3, s3
    s_bitset0_b32 s48, s3
    s_mul_i32 s46, s3, 9216
    buffer_load_dword v9, v6, s[84:87], s47 offen sc1
    buffer_load_dwordx4 v[112:115], v7, s[88:91], s46 offen sc1
    buffer_load_dwordx4 v[116:119], v5, s[88:91], s46 offen sc1
    buffer_load_dwordx4 v[120:123], v5, s[28:31], s46 offen sc1
    s_add_u32 s46, s46, 9216
    buffer_load_dwordx4 v[124:127], v5, s[88:91], s46 offen sc1
    buffer_load_dwordx4 v[128:131], v5, s[28:31], s46 offen sc1
    s_add_u32 s46, s46, 9216
    buffer_load_dwordx4 v[132:135], v5, s[88:91], s46 offen sc1
    buffer_load_dwordx4 v[136:139], v5, s[28:31], s46 offen sc1
    s_add_u32 s46, s46, 9216
    buffer_load_dwordx4 v[140:143], v5, s[88:91], s46 offen sc1
    buffer_load_dwordx4 v[144:147], v5, s[28:31], s46 offen sc1
    s_waitcnt vmcnt(11)
    v_mov_b32 v14, v13
    v_max_u32 v13, v76, v77
    v_max3_u32 v13, v13, v78, v79
    v_max3_u32 v13, v13, v88, v89
    v_max3_u32 v13, v13, v90, v91
    v_max3_u32 v13, v13, v80, v81
    v_max3_u32 v13, v13, v82, v83
    v_max3_u32 v13, v13, v92, v93
    v_max3_u32 v13, v13, v94, v95
    v_max3_u32 v13, v13, v84, v85
    v_max3_u32 v13, v13, v86, v87
    v_max3_u32 v13, v13, v96, v97
    v_max3_u32 v13, v13, v98, v99
    v_cmp_eq_u32 vcc, -1, v13
    s_nop 0
    s_cmp_lg_u64 vcc, 0
    s_cbranch_scc1 L2_pns
L2_pnr:
    v_pk_add_f32 v[76:77], v[76:77], v[88:89]
    v_pk_add_f32 v[78:79], v[78:79], v[90:91]
    ds_write_b128 v5, v[76:79] offset:0
    v_pk_add_f32 v[80:81], v[80:81], v[92:93]
    v_pk_add_f32 v[82:83], v[82:83], v[94:95]
    ds_write_b128 v5, v[80:83] offset:4096
    v_pk_add_f32 v[84:85], v[84:85], v[96:97]
    v_pk_add_f32 v[86:87], v[86:87], v[98:99]
    ds_write_b128 v59, v[84:87] offset:8192
    s_waitcnt lgkmcnt(0)
    s_barrier
    v_lshlrev_b32 v3, 1, v12
    v_lshlrev_b32 v4, 1, v14
    ds_read_b128 v[76:79], v3 offset:4608
    ds_read_b128 v[80:83], v3 offset:4624
    ds_read_b128 v[84:87], v3 offset:5632
    ds_read_b128 v[88:91], v3 offset:5648
    ds_read_b128 v[92:95], v4 offset:6656
    ds_read_b128 v[96:99], v4 offset:6672
    ds_read_b128 v[40:43], v3 offset:2304
    ds_read_b128 v[44:47], v3 offset:2320
    ds_read_b128 v[48:51], v3 offset:3328
    ds_read_b128 v[52:55], v3 offset:3344
    ds_read_b128 v[56:59], v4 offset:4352
    ds_read_b128 v[60:63], v4 offset:4368
    s_waitcnt vmcnt(9)
    v_cmp_ne_u32 vcc, 0, v9
    s_nop 0
    s_lshr_b32 s3, vcc_lo, 1
    s_and_b32 s3, s3, vcc_lo
    s_lshr_b32 s14, s3, 2
    s_and_b32 s3, s3, s14
    s_and_b32 s3, s3, s48
    s_cbranch_scc0 L2_g1s
L2_g1r:
    s_ff1_i32_b32 s3, s3
    s_bitset0_b32 s48, s3
    s_mul_i32 s46, s3, 9216
    buffer_load_dword v9, v6, s[84:87], s47 offen sc1
    buffer_load_dwordx4 v[148:151], v7, s[88:91], s46 offen sc1
    ds_write_b128 v106, a[20:23] offset:36864
    ds_write_b128 v106, a[24:27] offset:37888
    s_waitcnt lgkmcnt(2)
    v_lshlrev_b32 v12, 16, v224
    v_and_b32 v13, 0xffff0000, v224
    v_pk_mul_f32 v[76:77], v[76:77], v[12:13]
    v_pk_mul_f32 v[40:41], v[40:41], v[12:13]
    v_lshlrev_b32 v14, 16, v225
    v_and_b32 v15, 0xffff0000, v225
    v_pk_mul_f32 v[78:79], v[78:79], v[14:15]
    v_pk_mul_f32 v[42:43], v[42:43], v[14:15]
    v_lshlrev_b32 v12, 16, v226
    v_and_b32 v13, 0xffff0000, v226
    v_pk_mul_f32 v[80:81], v[80:81], v[12:13]
    v_pk_mul_f32 v[44:45], v[44:45], v[12:13]
    v_lshlrev_b32 v14, 16, v227
    v_and_b32 v15, 0xffff0000, v227
    v_pk_mul_f32 v[82:83], v[82:83], v[14:15]
    v_pk_mul_f32 v[46:47], v[46:47], v[14:15]
    v_lshlrev_b32 v12, 16, v232
    v_and_b32 v13, 0xffff0000, v232
    v_pk_mul_f32 v[84:85], v[84:85], v[12:13]
    v_pk_mul_f32 v[48:49], v[48:49], v[12:13]
    v_lshlrev_b32 v14, 16, v233
    v_and_b32 v15, 0xffff0000, v233
    v_pk_mul_f32 v[86:87], v[86:87], v[14:15]
    v_pk_mul_f32 v[50:51], v[50:51], v[14:15]
    buffer_load_dwordx4 v[152:155], v5, s[88:91], s46 offen sc1
    buffer_load_dwordx4 v[156:159], v5, s[28:31], s46 offen sc1
    ds_write_b128 v106, a[28:31] offset:38912
    ds_write_b128 v106, a[32:35] offset:39936
    v_lshlrev_b32 v12, 16, v234
    v_and_b32 v13, 0xffff0000, v234
    v_pk_mul_f32 v[88:89], v[88:89], v[12:13]
    v_pk_mul_f32 v[52:53], v[52:53], v[12:13]
    v_lshlrev_b32 v14, 16, v235
    v_and_b32 v15, 0xffff0000, v235
    v_pk_mul_f32 v[90:91], v[90:91], v[14:15]
    v_pk_mul_f32 v[54:55], v[54:55], v[14:15]
    v_lshlrev_b32 v12, 16, v240
    v_and_b32 v13, 0xffff0000, v240
    v_pk_mul_f32 v[92:93], v[92:93], v[12:13]
    v_pk_mul_f32 v[56:57], v[56:57], v[12:13]
    v_lshlrev_b32 v14, 16, v241
    v_and_b32 v15, 0xffff0000, v241
    v_pk_mul_f32 v[94:95], v[94:95], v[14:15]
    v_pk_mul_f32 v[58:59], v[58:59], v[14:15]
    v_lshlrev_b32 v12, 16, v242
    v_and_b32 v13, 0xffff0000, v242
    v_pk_mul_f32 v[96:97], v[96:97], v[12:13]
    v_pk_mul_f32 v[60:61], v[60:61], v[12:13]
    v_lshlrev_b32 v14, 16, v243
    v_and_b32 v15, 0xffff0000, v243
    v_pk_mul_f32 v[98:99], v[98:99], v[14:15]
    v_pk_mul_f32 v[62:63], v[62:63], v[14:15]
    s_add_u32 s46, s46, 9216
    buffer_load_dwordx4 v[160:163], v5, s[88:91], s46 offen sc1
    buffer_load_dwordx4 v[164:167], v5, s[28:31], s46 offen sc1
    ds_write_b128 v106, a[36:39] offset:40960
    ds_write_b128 v106, a[40:43] offset:41984
    v_pk_add_f32 v[12:13], v[76:77], v[78:79]
    v_pk_add_f32 v[12:13], v[12:13], v[80:81]
    v_pk_add_f32 v[12:13], v[12:13], v[82:83]
    v_pk_add_f32 v[12:13], v[12:13], v[84:85]
    v_pk_add_f32 v[12:13], v[12:13], v[86:87]
    v_pk_add_f32 v[12:13], v[12:13], v[88:89]
    v_pk_add_f32 v[12:13], v[12:13], v[90:91]
    v_pk_add_f32 v[14:15], v[92:93], v[94:95]
    v_pk_add_f32 v[14:15], v[14:15], v[96:97]
    v_pk_add_f32 v[14:15], v[14:15], v[98:99]
    v_add_f32 v100, v12, v13
    v_add_f32 v14, v14, v15
    v_fmac_f32 v100, 0x3e800000, v14
    v_pk_add_f32 v[12:13], v[40:41], v[42:43]
    v_pk_add_f32 v[12:13], v[12:13], v[44:45]
    v_pk_add_f32 v[12:13], v[12:13], v[46:47]
    v_pk_add_f32 v[12:13], v[12:13], v[48:49]
    v_pk_add_f32 v[12:13], v[12:13], v[50:51]
    v_pk_add_f32 v[12:13], v[12:13], v[52:53]
    v_pk_add_f32 v[12:13], v[12:13], v[54:55]
    v_pk_add_f32 v[14:15], v[56:57], v[58:59]
    v_pk_add_f32 v[14:15], v[14:15], v[60:61]
    v_pk_add_f32 v[14:15], v[14:15], v[62:63]
    v_add_f32 v101, v12, v13
    v_add_f32 v14, v14, v15
    v_fmac_f32 v101, 0x3e800000, v14
    ds_read_b128 v[40:43], v3 offset:0
    ds_read_b128 v[44:47], v3 offset:16
    ds_read_b128 v[48:51], v3 offset:1024
    ds_read_b128 v[52:55], v3 offset:1040
    ds_read_b128 v[56:59], v4 offset:2048
    ds_read_b128 v[60:63], v4 offset:2064
    s_add_u32 s46, s46, 9216
    buffer_load_dwordx4 v[168:171], v5, s[88:91], s46 offen sc1
    buffer_load_dwordx4 v[172:175], v5, s[28:31], s46 offen sc1
    ds_write_b128 v106, a[44:47] offset:43008
    ds_write_b128 v106, a[48:51] offset:44032
    s_nop 1
    v_add_f32_dpp v100, v100, v100 row_ror:8 row_mask:0xf bank_mask:0xf
    v_add_f32_dpp v101, v101, v101 row_ror:8 row_mask:0xf bank_mask:0xf
    v_mov_b32 v102, v100
    v_mov_b32 v103, v101
    s_nop 0
    v_permlane16_swap_b32 v102, v100
    v_permlane16_swap_b32 v103, v101
    v_add_f32 v100, v100, v102
    v_add_f32 v101, v101, v103
    v_mov_b32 v102, v100
    v_mov_b32 v103, v101
    s_nop 0
    v_permlane32_swap_b32 v102, v100
    v_permlane32_swap_b32 v103, v101
    v_add_f32 v100, v100, v102
    v_add_f32 v101, v101, v103
    v_and_b32 v14, 7, v0
    v_lshlrev_b32 v11, 4, v14
    v_add_u32 v11, 14080, v11
    s_lshl_b32 s3, s51, 2
    v_add_u32 v10, s3, v11
    ds_write_b32 v10, v100 offset:384
    ds_write_b32 v10, v101 offset:512
    v_lshl_add_u32 v1, v14, 4, v1
    v_lshl_add_u32 v2, v14, 4, v2
    v_add_u32 v1, 90112, v1
    v_add_u32 v2, 90112, v2
    s_and_b32 s14, s51, 1
    s_mul_i32 s14, s14, 9344
    s_add_u32 s14, s14, 90112
    v_add_u32 v107, s14, v8
    v_lshrrev_b32 v15, 3, v0
    v_mul_u32_u24 v12, 1024, v15
    v_add_u32 v109, v12, v8
    v_lshl_add_u32 v12, v15, 4, v12
    v_add_u32 v108, v12, v107
    s_mul_i32 s3, s96, 9216
    s_cmp_eq_u32 s51, 3
    s_cselect_b32 s3, 0, s3
    s_cselect_b64 s[24:25], s[32:33], s[80:81]
    s_add_u32 s24, s24, s3
    s_addc_u32 s25, s25, 0
    s_mov_b32 s26, 9216
    s_mov_b32 s27, 0x20000
    s_add_u32 s46, s46, 9216
    buffer_load_dwordx4 v[176:179], v5, s[88:91], s46 offen sc1
    buffer_load_dwordx4 v[180:183], v5, s[28:31], s46 offen sc1
    ds_write_b128 v106, a[52:55] offset:45056
    ds_write_b128 v105, a[128:131] offset:0
    s_waitcnt lgkmcnt(2)
    s_waitcnt vmcnt(18)
    ds_write_b128 v105, a[132:135] offset:1024
    ds_write_b128 v105, a[136:139] offset:2048
    v_lshlrev_b32 v32, 16, v112
    v_and_b32 v33, 0xffff0000, v112
    v_lshlrev_b32 v34, 16, v113
    v_and_b32 v35, 0xffff0000, v113
    v_lshlrev_b32 v36, 16, v114
    v_and_b32 v37, 0xffff0000, v114
    v_lshlrev_b32 v38, 16, v115
    v_and_b32 v39, 0xffff0000, v115
    s_waitcnt vmcnt(17)
    ds_write_b128 v105, a[140:143] offset:3072
    ds_write_b128 v105, a[144:147] offset:4096
    v_lshlrev_b32 v24, 16, v116
    v_and_b32 v25, 0xffff0000, v116
    v_lshlrev_b32 v26, 16, v117
    v_and_b32 v27, 0xffff0000, v117
    v_lshlrev_b32 v28, 16, v118
    v_and_b32 v29, 0xffff0000, v118
    v_lshlrev_b32 v30, 16, v119
    v_and_b32 v31, 0xffff0000, v119
    s_waitcnt vmcnt(16)
    v_lshlrev_b32 v16, 16, v120
    v_and_b32 v17, 0xffff0000, v120
    v_lshlrev_b32 v18, 16, v121
    v_and_b32 v19, 0xffff0000, v121
    v_lshlrev_b32 v20, 16, v122
    v_and_b32 v21, 0xffff0000, v122
    v_lshlrev_b32 v22, 16, v123
    v_and_b32 v23, 0xffff0000, v123
    s_waitcnt vmcnt(15)
    ds_write_b128 v105, a[148:151] offset:5120
    ds_write_b128 v105, a[152:155] offset:6144
    v_lshlrev_b32 v100, 16, v124
    v_and_b32 v101, 0xffff0000, v124
    v_pk_add_f32 v[24:25], v[24:25], v[100:101]
    v_lshlrev_b32 v102, 16, v125
    v_and_b32 v103, 0xffff0000, v125
    v_pk_add_f32 v[26:27], v[26:27], v[102:103]
    v_lshlrev_b32 v100, 16, v126
    v_and_b32 v101, 0xffff0000, v126
    v_pk_add_f32 v[28:29], v[28:29], v[100:101]
    v_lshlrev_b32 v102, 16, v127
    v_and_b32 v103, 0xffff0000, v127
    v_pk_add_f32 v[30:31], v[30:31], v[102:103]
    s_waitcnt vmcnt(14)
    v_lshlrev_b32 v100, 16, v128
    v_and_b32 v101, 0xffff0000, v128
    v_pk_add_f32 v[16:17], v[16:17], v[100:101]
    v_lshlrev_b32 v102, 16, v129
    v_and_b32 v103, 0xffff0000, v129
    v_pk_add_f32 v[18:19], v[18:19], v[102:103]
    v_lshlrev_b32 v100, 16, v130
    v_and_b32 v101, 0xffff0000, v130
    v_pk_add_f32 v[20:21], v[20:21], v[100:101]
    v_lshlrev_b32 v102, 16, v131
    v_and_b32 v103, 0xffff0000, v131
    v_pk_add_f32 v[22:23], v[22:23], v[102:103]
    s_waitcnt vmcnt(13)
    ds_write_b128 v105, a[156:159] offset:7168
    ds_write_b128 v105, a[160:163] offset:8192
    v_lshlrev_b32 v100, 16, v132
    v_and_b32 v101, 0xffff0000, v132
    v_pk_add_f32 v[24:25], v[24:25], v[100:101]
    v_lshlrev_b32 v102, 16, v133
    v_and_b32 v103, 0xffff0000, v133
    v_pk_add_f32 v[26:27], v[26:27], v[102:103]
    v_lshlrev_b32 v100, 16, v134
    v_and_b32 v101, 0xffff0000, v134
    v_pk_add_f32 v[28:29], v[28:29], v[100:101]
    v_lshlrev_b32 v102, 16, v135
    v_and_b32 v103, 0xffff0000, v135
    v_pk_add_f32 v[30:31], v[30:31], v[102:103]
    s_waitcnt vmcnt(12)
    v_lshlrev_b32 v100, 16, v136
    v_and_b32 v101, 0xffff0000, v136
    v_pk_add_f32 v[16:17], v[16:17], v[100:101]
    v_lshlrev_b32 v102, 16, v137
    v_and_b32 v103, 0xffff0000, v137
    v_pk_add_f32 v[18:19], v[18:19], v[102:103]
    v_lshlrev_b32 v100, 16, v138
    v_and_b32 v101, 0xffff0000, v138
    v_pk_add_f32 v[20:21], v[20:21], v[100:101]
    v_lshlrev_b32 v102, 16, v139
    v_and_b32 v103, 0xffff0000, v139
    v_pk_add_f32 v[22:23], v[22:23], v[102:103]
    s_waitcnt vmcnt(11)
    ds_write_b128 v105, a[164:167] offset:36864
    ds_write_b128 v105, a[168:171] offset:37888
    v_lshlrev_b32 v100, 16, v140
    v_and_b32 v101, 0xffff0000, v140
    v_pk_add_f32 v[24:25], v[24:25], v[100:101]
    v_lshlrev_b32 v102, 16, v141
    v_and_b32 v103, 0xffff0000, v141
    v_pk_add_f32 v[26:27], v[26:27], v[102:103]
    v_lshlrev_b32 v100, 16, v142
    v_and_b32 v101, 0xffff0000, v142
    v_pk_add_f32 v[28:29], v[28:29], v[100:101]
    v_lshlrev_b32 v102, 16, v143
    v_and_b32 v103, 0xffff0000, v143
    v_pk_add_f32 v[30:31], v[30:31], v[102:103]
    s_waitcnt vmcnt(10)
    v_lshlrev_b32 v100, 16, v144
    v_and_b32 v101, 0xffff0000, v144
    v_pk_add_f32 v[16:17], v[16:17], v[100:101]
    v_lshlrev_b32 v102, 16, v145
    v_and_b32 v103, 0xffff0000, v145
    v_pk_add_f32 v[18:19], v[18:19], v[102:103]
    v_lshlrev_b32 v100, 16, v146
    v_and_b32 v101, 0xffff0000, v146
    v_pk_add_f32 v[20:21], v[20:21], v[100:101]
    v_lshlrev_b32 v102, 16, v147
    v_and_b32 v103, 0xffff0000, v147
    v_pk_add_f32 v[22:23], v[22:23], v[102:103]
    s_waitcnt vmcnt(8)
    ds_write_b128 v105, a[172:175] offset:38912
    ds_write_b128 v105, a[176:179] offset:39936
    v_lshlrev_b32 v100, 16, v148
    v_and_b32 v101, 0xffff0000, v148
    v_pk_add_f32 v[32:33], v[32:33], v[100:101]
    v_lshlrev_b32 v102, 16, v149
    v_and_b32 v103, 0xffff0000, v149
    v_pk_add_f32 v[34:35], v[34:35], v[102:103]
    v_lshlrev_b32 v100, 16, v150
    v_and_b32 v101, 0xffff0000, v150
    v_pk_add_f32 v[36:37], v[36:37], v[100:101]
    v_lshlrev_b32 v102, 16, v151
    v_and_b32 v103, 0xffff0000, v151
    v_pk_add_f32 v[38:39], v[38:39], v[102:103]
    s_waitcnt vmcnt(7)
    ds_write_b128 v105, a[180:183] offset:40960
    ds_write_b128 v105, a[184:187] offset:41984
    v_lshlrev_b32 v100, 16, v152
    v_and_b32 v101, 0xffff0000, v152
    v_pk_add_f32 v[24:25], v[24:25], v[100:101]
    v_lshlrev_b32 v102, 16, v153
    v_and_b32 v103, 0xffff0000, v153
    v_pk_add_f32 v[26:27], v[26:27], v[102:103]
    v_lshlrev_b32 v100, 16, v154
    v_and_b32 v101, 0xffff0000, v154
    v_pk_add_f32 v[28:29], v[28:29], v[100:101]
    v_lshlrev_b32 v102, 16, v155
    v_and_b32 v103, 0xffff0000, v155
    v_pk_add_f32 v[30:31], v[30:31], v[102:103]
    s_waitcnt vmcnt(6)
    v_lshlrev_b32 v100, 16, v156
    v_and_b32 v101, 0xffff0000, v156
    v_pk_add_f32 v[16:17], v[16:17], v[100:101]
    v_lshlrev_b32 v102, 16, v157
    v_and_b32 v103, 0xffff0000, v157
    v_pk_add_f32 v[18:19], v[18:19], v[102:103]
    v_lshlrev_b32 v100, 16, v158
    v_and_b32 v101, 0xffff0000, v158
    v_pk_add_f32 v[20:21], v[20:21], v[100:101]
    v_lshlrev_b32 v102, 16, v159
    v_and_b32 v103, 0xffff0000, v159
    v_pk_add_f32 v[22:23], v[22:23], v[102:103]
    s_waitcnt vmcnt(5)
    v_cmp_ne_u32 vcc, 0, v9
    s_nop 0
    s_lshr_b32 s3, vcc_lo, 1
    s_and_b32 s3, s3, vcc_lo
    s_lshr_b32 s14, s3, 2
    s_and_b32 s3, s3, s14
    s_and_b32 s3, s3, s48
    s_cbranch_scc0 L2_g2s
L2_g2r:
    s_ff1_i32_b32 s3, s3
    s_bitset0_b32 s48, s3
    s_mul_i32 s46, s3, 9216
    buffer_load_dword v9, v6, s[84:87], s47 offen sc1
    buffer_load_dwordx4 v[184:187], v7, s[88:91], s46 offen sc1
    ds_write_b128 v105, a[188:191] offset:43008
    ds_write_b128 v105, a[192:195] offset:44032
    v_lshlrev_b32 v100, 16, v160
    v_and_b32 v101, 0xffff0000, v160
    v_pk_add_f32 v[24:25], v[24:25], v[100:101]
    v_lshlrev_b32 v102, 16, v161
    v_and_b32 v103, 0xffff0000, v161
    v_pk_add_f32 v[26:27], v[26:27], v[102:103]
    v_lshlrev_b32 v100, 16, v162
    v_and_b32 v101, 0xffff0000, v162
    v_pk_add_f32 v[28:29], v[28:29], v[100:101]
    v_lshlrev_b32 v102, 16, v163
    v_and_b32 v103, 0xffff0000, v163
    v_pk_add_f32 v[30:31], v[30:31], v[102:103]
    s_waitcnt vmcnt(6)
    v_lshlrev_b32 v100, 16, v164
    v_and_b32 v101, 0xffff0000, v164
    v_pk_add_f32 v[16:17], v[16:17], v[100:101]
    v_lshlrev_b32 v102, 16, v165
    v_and_b32 v103, 0xffff0000, v165
    v_pk_add_f32 v[18:19], v[18:19], v[102:103]
    v_lshlrev_b32 v100, 16, v166
    v_and_b32 v101, 0xffff0000, v166
    v_pk_add_f32 v[20:21], v[20:21], v[100:101]
    v_lshlrev_b32 v102, 16, v167
    v_and_b32 v103, 0xffff0000, v167
    v_pk_add_f32 v[22:23], v[22:23], v[102:103]
    s_waitcnt vmcnt(5)
    buffer_load_dwordx4 v[188:191], v5, s[88:91], s46 offen sc1
    buffer_load_dwordx4 v[192:195], v5, s[28:31], s46 offen sc1
    ds_write_b128 v105, a[196:199] offset:45056
    v_lshlrev_b32 v100, 16, v168
    v_and_b32 v101, 0xffff0000, v168
    v_pk_add_f32 v[24:25], v[24:25], v[100:101]
    v_lshlrev_b32 v102, 16, v169
    v_and_b32 v103, 0xffff0000, v169
    v_pk_add_f32 v[26:27], v[26:27], v[102:103]
    v_lshlrev_b32 v100, 16, v170
    v_and_b32 v101, 0xffff0000, v170
    v_pk_add_f32 v[28:29], v[28:29], v[100:101]
    v_lshlrev_b32 v102, 16, v171
    v_and_b32 v103, 0xffff0000, v171
    v_pk_add_f32 v[30:31], v[30:31], v[102:103]
    s_waitcnt vmcnt(6)
    v_lshlrev_b32 v100, 16, v172
    v_and_b32 v101, 0xffff0000, v172
    v_pk_add_f32 v[16:17], v[16:17], v[100:101]
    v_lshlrev_b32 v102, 16, v173
    v_and_b32 v103, 0xffff0000, v173
    v_pk_add_f32 v[18:19], v[18:19], v[102:103]
    v_lshlrev_b32 v100, 16, v174
    v_and_b32 v101, 0xffff0000, v174
    v_pk_add_f32 v[20:21], v[20:21], v[100:101]
    v_lshlrev_b32 v102, 16, v175
    v_and_b32 v103, 0xffff0000, v175
    v_pk_add_f32 v[22:23], v[22:23], v[102:103]
    s_waitcnt vmcnt(5)
    s_add_u32 s46, s46, 9216
    buffer_load_dwordx4 v[196:199], v5, s[88:91], s46 offen sc1
    buffer_load_dwordx4 v[200:203], v5, s[28:31], s46 offen sc1
    v_lshlrev_b32 v100, 16, v176
    v_and_b32 v101, 0xffff0000, v176
    v_pk_add_f32 v[24:25], v[24:25], v[100:101]
    v_lshlrev_b32 v102, 16, v177
    v_and_b32 v103, 0xffff0000, v177
    v_pk_add_f32 v[26:27], v[26:27], v[102:103]
    v_lshlrev_b32 v100, 16, v178
    v_and_b32 v101, 0xffff0000, v178
    v_pk_add_f32 v[28:29], v[28:29], v[100:101]
    v_lshlrev_b32 v102, 16, v179
    v_and_b32 v103, 0xffff0000, v179
    v_pk_add_f32 v[30:31], v[30:31], v[102:103]
    s_waitcnt vmcnt(6)
    v_lshlrev_b32 v100, 16, v180
    v_and_b32 v101, 0xffff0000, v180
    v_pk_add_f32 v[16:17], v[16:17], v[100:101]
    v_lshlrev_b32 v102, 16, v181
    v_and_b32 v103, 0xffff0000, v181
    v_pk_add_f32 v[18:19], v[18:19], v[102:103]
    v_lshlrev_b32 v100, 16, v182
    v_and_b32 v101, 0xffff0000, v182
    v_pk_add_f32 v[20:21], v[20:21], v[100:101]
    v_lshlrev_b32 v102, 16, v183
    v_and_b32 v103, 0xffff0000, v183
    v_pk_add_f32 v[22:23], v[22:23], v[102:103]
    s_waitcnt vmcnt(4)
    s_add_u32 s46, s46, 9216
    buffer_load_dwordx4 v[204:207], v5, s[88:91], s46 offen sc1
    buffer_load_dwordx4 v[208:211], v5, s[28:31], s46 offen sc1
    v_lshlrev_b32 v100, 16, v184
    v_and_b32 v101, 0xffff0000, v184
    v_pk_add_f32 v[32:33], v[32:33], v[100:101]
    v_lshlrev_b32 v102, 16, v185
    v_and_b32 v103, 0xffff0000, v185
    v_pk_add_f32 v[34:35], v[34:35], v[102:103]
    v_lshlrev_b32 v100, 16, v186
    v_and_b32 v101, 0xffff0000, v186
    v_pk_add_f32 v[36:37], v[36:37], v[100:101]
    v_lshlrev_b32 v102, 16, v187
L2_pad13:
    s_cbranch_execz L2_walkret
    v_and_b32 v103, 0xffff0000, v187
    v_pk_add_f32 v[38:39], v[38:39], v[102:103]
    ds_read_b128 v[112:115], v3 offset:4608
    ds_read_b128 v[116:119], v3 offset:4624
    ds_read_b128 v[120:123], v3 offset:5632
    ds_read_b128 v[124:127], v3 offset:5648
    ds_read_b128 v[128:131], v4 offset:6656
    ds_read_b128 v[132:135], v4 offset:6672
    ds_read_b128 v[136:139], v3 offset:2304
    ds_read_b128 v[140:143], v3 offset:2320
    ds_read_b128 v[144:147], v3 offset:3328
    ds_read_b128 v[148:151], v3 offset:3344
    ds_read_b128 v[152:155], v4 offset:4352
    ds_read_b128 v[156:159], v4 offset:4368
    ds_read_b128 v[160:163], v3 offset:6912
    ds_read_b128 v[164:167], v3 offset:6928
    ds_read_b128 v[168:171], v3 offset:7936
    ds_read_b128 v[172:175], v3 offset:7952
    ds_read_b128 v[176:179], v4 offset:8960
    ds_read_b128 v[180:183], v4 offset:8976
    s_waitcnt vmcnt(5)
    s_add_u32 s46, s46, 9216
    buffer_load_dwordx4 v[212:215], v5, s[88:91], s46 offen sc1
    buffer_load_dwordx4 v[216:219], v5, s[28:31], s46 offen sc1
    v_lshlrev_b32 v100, 16, v188
    v_and_b32 v101, 0xffff0000, v188
    v_pk_add_f32 v[24:25], v[24:25], v[100:101]
    v_lshlrev_b32 v102, 16, v189
    v_and_b32 v103, 0xffff0000, v189
    v_pk_add_f32 v[26:27], v[26:27], v[102:103]
    v_lshlrev_b32 v100, 16, v190
    v_and_b32 v101, 0xffff0000, v190
    v_pk_add_f32 v[28:29], v[28:29], v[100:101]
    v_lshlrev_b32 v102, 16, v191
    v_and_b32 v103, 0xffff0000, v191
    v_pk_add_f32 v[30:31], v[30:31], v[102:103]
    s_waitcnt vmcnt(6)
    v_lshlrev_b32 v100, 16, v192
    v_and_b32 v101, 0xffff0000, v192
    v_pk_add_f32 v[16:17], v[16:17], v[100:101]
    v_lshlrev_b32 v102, 16, v193
    v_and_b32 v103, 0xffff0000, v193
    v_pk_add_f32 v[18:19], v[18:19], v[102:103]
    v_lshlrev_b32 v100, 16, v194
    v_and_b32 v101, 0xffff0000, v194
    v_pk_add_f32 v[20:21], v[20:21], v[100:101]
    v_lshlrev_b32 v102, 16, v195
    v_and_b32 v103, 0xffff0000, v195
    v_pk_add_f32 v[22:23], v[22:23], v[102:103]
    s_waitcnt vmcnt(5)
    v_cmp_ne_u32 vcc, 0, v9
    s_nop 0
    s_lshr_b32 s3, vcc_lo, 1
    s_and_b32 s3, s3, vcc_lo
    s_lshr_b32 s14, s3, 2
    s_and_b32 s3, s3, s14
    s_and_b32 s3, s3, s48
    s_cbranch_scc0 L2_g3s
L2_g3r:
    s_ff1_i32_b32 s3, s3
    s_bitset0_b32 s48, s3
    s_mul_i32 s46, s3, 9216
    buffer_load_dwordx4 v[220:223], v7, s[88:91], s46 offen sc1
    v_lshlrev_b32 v100, 16, v196
    v_and_b32 v101, 0xffff0000, v196
    v_pk_add_f32 v[24:25], v[24:25], v[100:101]
    v_lshlrev_b32 v102, 16, v197
    v_and_b32 v103, 0xffff0000, v197
    v_pk_add_f32 v[26:27], v[26:27], v[102:103]
    v_lshlrev_b32 v100, 16, v198
    v_and_b32 v101, 0xffff0000, v198
    v_pk_add_f32 v[28:29], v[28:29], v[100:101]
    v_lshlrev_b32 v102, 16, v199
    v_and_b32 v103, 0xffff0000, v199
    v_pk_add_f32 v[30:31], v[30:31], v[102:103]
    s_waitcnt vmcnt(5)
    v_lshlrev_b32 v100, 16, v200
    v_and_b32 v101, 0xffff0000, v200
    v_pk_add_f32 v[16:17], v[16:17], v[100:101]
    v_lshlrev_b32 v102, 16, v201
    v_and_b32 v103, 0xffff0000, v201
    v_pk_add_f32 v[18:19], v[18:19], v[102:103]
    v_lshlrev_b32 v100, 16, v202
    v_and_b32 v101, 0xffff0000, v202
    v_pk_add_f32 v[20:21], v[20:21], v[100:101]
    v_lshlrev_b32 v102, 16, v203
    v_and_b32 v103, 0xffff0000, v203
    v_pk_add_f32 v[22:23], v[22:23], v[102:103]
    s_waitcnt vmcnt(4)
    buffer_load_dwordx4 v[224:227], v5, s[88:91], s46 offen sc1
    buffer_load_dwordx4 v[228:231], v5, s[28:31], s46 offen sc1
    v_lshlrev_b32 v100, 16, v204
    v_and_b32 v101, 0xffff0000, v204
    v_pk_add_f32 v[24:25], v[24:25], v[100:101]
    v_lshlrev_b32 v102, 16, v205
    v_and_b32 v103, 0xffff0000, v205
    v_pk_add_f32 v[26:27], v[26:27], v[102:103]
    v_lshlrev_b32 v100, 16, v206
    v_and_b32 v101, 0xffff0000, v206
    v_pk_add_f32 v[28:29], v[28:29], v[100:101]
    v_lshlrev_b32 v102, 16, v207
    v_and_b32 v103, 0xffff0000, v207
    v_pk_add_f32 v[30:31], v[30:31], v[102:103]
    s_waitcnt vmcnt(5)
    v_lshlrev_b32 v100, 16, v208
    v_and_b32 v101, 0xffff0000, v208
    v_pk_add_f32 v[16:17], v[16:17], v[100:101]
    v_lshlrev_b32 v102, 16, v209
    v_and_b32 v103, 0xffff0000, v209
    v_pk_add_f32 v[18:19], v[18:19], v[102:103]
    v_lshlrev_b32 v100, 16, v210
    v_and_b32 v101, 0xffff0000, v210
    v_pk_add_f32 v[20:21], v[20:21], v[100:101]
    v_lshlrev_b32 v102, 16, v211
    v_and_b32 v103, 0xffff0000, v211
    v_pk_add_f32 v[22:23], v[22:23], v[102:103]
    s_waitcnt vmcnt(4)
    s_add_u32 s46, s46, 9216
    buffer_load_dwordx4 v[232:235], v5, s[88:91], s46 offen sc1
    buffer_load_dwordx4 v[236:239], v5, s[28:31], s46 offen sc1
    v_lshlrev_b32 v100, 16, v212
    v_and_b32 v101, 0xffff0000, v212
    v_pk_add_f32 v[24:25], v[24:25], v[100:101]
    v_lshlrev_b32 v102, 16, v213
    v_and_b32 v103, 0xffff0000, v213
    v_pk_add_f32 v[26:27], v[26:27], v[102:103]
    v_lshlrev_b32 v100, 16, v214
    v_and_b32 v101, 0xffff0000, v214
    v_pk_add_f32 v[28:29], v[28:29], v[100:101]
    v_lshlrev_b32 v102, 16, v215
    v_and_b32 v103, 0xffff0000, v215
    v_pk_add_f32 v[30:31], v[30:31], v[102:103]
    s_waitcnt vmcnt(5)
    v_lshlrev_b32 v100, 16, v216
    v_and_b32 v101, 0xffff0000, v216
    v_pk_add_f32 v[16:17], v[16:17], v[100:101]
    v_lshlrev_b32 v102, 16, v217
    v_and_b32 v103, 0xffff0000, v217
    v_pk_add_f32 v[18:19], v[18:19], v[102:103]
    v_lshlrev_b32 v100, 16, v218
    v_and_b32 v101, 0xffff0000, v218
    v_pk_add_f32 v[20:21], v[20:21], v[100:101]
    v_lshlrev_b32 v102, 16, v219
    v_and_b32 v103, 0xffff0000, v219
    v_pk_add_f32 v[22:23], v[22:23], v[102:103]
    s_waitcnt vmcnt(4)
    s_add_u32 s46, s46, 9216
    buffer_load_dwordx4 v[240:243], v5, s[88:91], s46 offen sc1
    buffer_load_dwordx4 v[244:247], v5, s[28:31], s46 offen sc1
    v_lshlrev_b32 v100, 16, v220
    v_and_b32 v101, 0xffff0000, v220
    v_pk_add_f32 v[32:33], v[32:33], v[100:101]
    v_lshlrev_b32 v102, 16, v221
    v_and_b32 v103, 0xffff0000, v221
    v_pk_add_f32 v[34:35], v[34:35], v[102:103]
    v_lshlrev_b32 v100, 16, v222
    v_and_b32 v101, 0xffff0000, v222
    v_pk_add_f32 v[36:37], v[36:37], v[100:101]
    v_lshlrev_b32 v102, 16, v223
    v_and_b32 v103, 0xffff0000, v223
    v_pk_add_f32 v[38:39], v[38:39], v[102:103]
    s_lshl_b32 s3, s96, 3
    s_sub_u32 s3, 0xfff, s3
    v_and_b32 v6, 7, v0
    v_sub_u32 v6, s3, v6
    s_mov_b32 s57, 0xfffff000
    s_mul_i32 s58, s96, 128
    s_add_u32 s58, s58, 6815744
    s_xor_b32 s3, s51, 2
    v_or_b32 v9, s3, v0
    v_min_u32 v9, 1, v9
    v_lshlrev_b32 v9, 30, v9
    v_mov_b32 v208, v32
    v_mov_b32 v209, v33
    v_mov_b32 v210, v34
    v_mov_b32 v211, v35
    v_mov_b32 v212, v36
    v_mov_b32 v213, v37
    v_mov_b32 v214, v38
    v_mov_b32 v215, v39
    v_permlane16_swap_b32 v208, v32
    v_permlane16_swap_b32 v209, v33
    v_permlane16_swap_b32 v210, v34
    v_permlane16_swap_b32 v211, v35
    v_permlane16_swap_b32 v212, v36
    v_permlane16_swap_b32 v213, v37
    v_permlane16_swap_b32 v214, v38
    v_permlane16_swap_b32 v215, v39
    v_add_f32 v32, v32, v208
    v_add_f32 v33, v33, v209
    v_add_f32 v34, v34, v210
    v_add_f32 v35, v35, v211
    v_add_f32 v36, v36, v212
    v_add_f32 v37, v37, v213
    v_add_f32 v38, v38, v214
    v_add_f32 v39, v39, v215
    v_mov_b32 v208, v32
    v_mov_b32 v209, v33
    v_mov_b32 v210, v34
    v_mov_b32 v211, v35
    v_mov_b32 v212, v36
    v_mov_b32 v213, v37
    v_mov_b32 v214, v38
    v_mov_b32 v215, v39
    v_permlane32_swap_b32 v208, v32
    v_permlane32_swap_b32 v209, v33
    v_permlane32_swap_b32 v210, v34
    v_permlane32_swap_b32 v211, v35
    v_permlane32_swap_b32 v212, v36
    v_permlane32_swap_b32 v213, v37
    v_permlane32_swap_b32 v214, v38
    v_permlane32_swap_b32 v215, v39
    v_add_f32 v32, v32, v208
    v_add_f32 v33, v33, v209
    v_add_f32 v34, v34, v210
    v_add_f32 v35, v35, v211
    v_add_f32 v36, v36, v212
    v_add_f32 v37, v37, v213
    v_add_f32 v38, v38, v214
    v_add_f32 v39, v39, v215
    v_lshlrev_b32 v184, 16, v64
    v_and_b32 v185, 0xffff0000, v64
    v_lshlrev_b32 v186, 16, v65
    v_and_b32 v187, 0xffff0000, v65
    v_lshlrev_b32 v188, 16, v66
    v_and_b32 v189, 0xffff0000, v66
    v_lshlrev_b32 v190, 16, v67
    v_and_b32 v191, 0xffff0000, v67
    v_lshlrev_b32 v192, 16, v68
    v_and_b32 v193, 0xffff0000, v68
    v_lshlrev_b32 v194, 16, v69
    v_and_b32 v195, 0xffff0000, v69
    v_lshlrev_b32 v196, 16, v70
    v_and_b32 v197, 0xffff0000, v70
    v_lshlrev_b32 v198, 16, v71
    v_and_b32 v199, 0xffff0000, v71
    v_lshlrev_b32 v200, 16, v72
    v_and_b32 v201, 0xffff0000, v72
    v_lshlrev_b32 v202, 16, v73
    v_and_b32 v203, 0xffff0000, v73
    v_lshlrev_b32 v204, 16, v74
    v_and_b32 v205, 0xffff0000, v74
    v_lshlrev_b32 v206, 16, v75
    v_and_b32 v207, 0xffff0000, v75
    s_cmp_lt_u32 s2, 180
    s_cselect_b32 s3, 2, 0
    s_cmp_lt_u32 s51, s3
    s_cselect_b32 s3, 0, 0x40000000
    v_mul_u32_u24 v68, 128, v0
    v_or_b32 v68, s3, v68
    s_mul_i32 s15, s51, 16384
    s_add_u32 s15, s15, 6815744
    s_add_u32 s59, s15, 8192
    s_lshl_b32 s3, s51, 7
    s_sub_u32 s3, s96, s3
    v_cmp_eq_u32 s[60:61], s3, v0
    s_sub_u32 s3, s3, 64
    v_cmp_eq_u32 s[62:63], s3, v0
    s_waitcnt vmcnt(5)
    s_add_u32 s46, s46, 9216
    buffer_load_dwordx4 v[248:251], v5, s[88:91], s46 offen sc1
    buffer_load_dwordx4 v[252:255], v5, s[28:31], s46 offen sc1
    v_lshlrev_b32 v100, 16, v224
    v_and_b32 v101, 0xffff0000, v224
    v_pk_add_f32 v[24:25], v[24:25], v[100:101]
    v_lshlrev_b32 v102, 16, v225
    v_and_b32 v103, 0xffff0000, v225
    v_pk_add_f32 v[26:27], v[26:27], v[102:103]
    v_lshlrev_b32 v100, 16, v226
    v_and_b32 v101, 0xffff0000, v226
    v_pk_add_f32 v[28:29], v[28:29], v[100:101]
    v_lshlrev_b32 v102, 16, v227
    v_and_b32 v103, 0xffff0000, v227
    v_pk_add_f32 v[30:31], v[30:31], v[102:103]
    s_waitcnt vmcnt(6)
    v_lshlrev_b32 v100, 16, v228
    v_and_b32 v101, 0xffff0000, v228
    v_pk_add_f32 v[16:17], v[16:17], v[100:101]
    v_lshlrev_b32 v102, 16, v229
    v_and_b32 v103, 0xffff0000, v229
    v_pk_add_f32 v[18:19], v[18:19], v[102:103]
    v_lshlrev_b32 v100, 16, v230
    v_and_b32 v101, 0xffff0000, v230
    v_pk_add_f32 v[20:21], v[20:21], v[100:101]
    v_lshlrev_b32 v102, 16, v231
    v_and_b32 v103, 0xffff0000, v231
    v_pk_add_f32 v[22:23], v[22:23], v[102:103]
    s_waitcnt vmcnt(5)
    v_lshlrev_b32 v100, 16, v232
    v_and_b32 v101, 0xffff0000, v232
    v_pk_add_f32 v[24:25], v[24:25], v[100:101]
    v_lshlrev_b32 v102, 16, v233
    v_and_b32 v103, 0xffff0000, v233
    v_pk_add_f32 v[26:27], v[26:27], v[102:103]
    v_lshlrev_b32 v100, 16, v234
    v_and_b32 v101, 0xffff0000, v234
    v_pk_add_f32 v[28:29], v[28:29], v[100:101]
    v_lshlrev_b32 v102, 16, v235
    v_and_b32 v103, 0xffff0000, v235
    v_pk_add_f32 v[30:31], v[30:31], v[102:103]
    s_waitcnt vmcnt(4)
    v_lshlrev_b32 v100, 16, v236
    v_and_b32 v101, 0xffff0000, v236
    v_pk_add_f32 v[16:17], v[16:17], v[100:101]
    v_lshlrev_b32 v102, 16, v237
    v_and_b32 v103, 0xffff0000, v237
    v_pk_add_f32 v[18:19], v[18:19], v[102:103]
    v_lshlrev_b32 v100, 16, v238
    v_and_b32 v101, 0xffff0000, v238
    v_pk_add_f32 v[20:21], v[20:21], v[100:101]
    v_lshlrev_b32 v102, 16, v239
    v_and_b32 v103, 0xffff0000, v239
    v_pk_add_f32 v[22:23], v[22:23], v[102:103]
    s_waitcnt vmcnt(3)
    v_lshlrev_b32 v100, 16, v240
    v_and_b32 v101, 0xffff0000, v240
    v_pk_add_f32 v[24:25], v[24:25], v[100:101]
    v_lshlrev_b32 v102, 16, v241
    v_and_b32 v103, 0xffff0000, v241
    v_pk_add_f32 v[26:27], v[26:27], v[102:103]
    v_lshlrev_b32 v100, 16, v242
    v_and_b32 v101, 0xffff0000, v242
    v_pk_add_f32 v[28:29], v[28:29], v[100:101]
    v_lshlrev_b32 v102, 16, v243
    v_and_b32 v103, 0xffff0000, v243
    v_pk_add_f32 v[30:31], v[30:31], v[102:103]
    s_waitcnt vmcnt(2)
    v_lshlrev_b32 v100, 16, v244
    v_and_b32 v101, 0xffff0000, v244
    v_pk_add_f32 v[16:17], v[16:17], v[100:101]
    v_lshlrev_b32 v102, 16, v245
    v_and_b32 v103, 0xffff0000, v245
    v_pk_add_f32 v[18:19], v[18:19], v[102:103]
    v_lshlrev_b32 v100, 16, v246
    v_and_b32 v101, 0xffff0000, v246
    v_pk_add_f32 v[20:21], v[20:21], v[100:101]
    v_lshlrev_b32 v102, 16, v247
    v_and_b32 v103, 0xffff0000, v247
    v_pk_add_f32 v[22:23], v[22:23], v[102:103]
    s_waitcnt vmcnt(1)
    v_lshlrev_b32 v100, 16, v248
    v_and_b32 v101, 0xffff0000, v248
    v_pk_add_f32 v[24:25], v[24:25], v[100:101]
    v_lshlrev_b32 v102, 16, v249
    v_and_b32 v103, 0xffff0000, v249
    v_pk_add_f32 v[26:27], v[26:27], v[102:103]
    v_lshlrev_b32 v100, 16, v250
    v_and_b32 v101, 0xffff0000, v250
    v_pk_add_f32 v[28:29], v[28:29], v[100:101]
    v_lshlrev_b32 v102, 16, v251
    v_and_b32 v103, 0xffff0000, v251
    v_pk_add_f32 v[30:31], v[30:31], v[102:103]
    s_waitcnt vmcnt(0)
    v_lshlrev_b32 v100, 16, v252
    v_and_b32 v101, 0xffff0000, v252
    v_pk_add_f32 v[16:17], v[16:17], v[100:101]
    v_lshlrev_b32 v102, 16, v253
    v_and_b32 v103, 0xffff0000, v253
    v_pk_add_f32 v[18:19], v[18:19], v[102:103]
    v_lshlrev_b32 v100, 16, v254
    v_and_b32 v101, 0xffff0000, v254
    v_pk_add_f32 v[20:21], v[20:21], v[100:101]
    v_lshlrev_b32 v102, 16, v255
    v_and_b32 v103, 0xffff0000, v255
    v_pk_add_f32 v[22:23], v[22:23], v[102:103]
    v_pk_fma_f32 v[16:17], v[16:17], v[40:41], v[184:185]
    v_pk_fma_f32 v[18:19], v[18:19], v[42:43], v[186:187]
    v_pk_fma_f32 v[20:21], v[20:21], v[44:45], v[188:189]
    v_pk_fma_f32 v[22:23], v[22:23], v[46:47], v[190:191]
    v_pk_fma_f32 v[24:25], v[24:25], v[48:49], v[192:193]
    v_pk_fma_f32 v[26:27], v[26:27], v[50:51], v[194:195]
    v_pk_fma_f32 v[28:29], v[28:29], v[52:53], v[196:197]
    v_pk_fma_f32 v[30:31], v[30:31], v[54:55], v[198:199]
    v_pk_fma_f32 v[32:33], v[32:33], v[56:57], v[200:201]
    v_pk_fma_f32 v[34:35], v[34:35], v[58:59], v[202:203]
    v_pk_fma_f32 v[36:37], v[36:37], v[60:61], v[204:205]
    v_pk_fma_f32 v[38:39], v[38:39], v[62:63], v[206:207]
    v_pk_add_f32 v[12:13], v[16:17], v[18:19]
    v_pk_add_f32 v[12:13], v[12:13], v[20:21]
    v_pk_add_f32 v[12:13], v[12:13], v[22:23]
    v_pk_add_f32 v[12:13], v[12:13], v[24:25]
    v_pk_add_f32 v[12:13], v[12:13], v[26:27]
    v_pk_add_f32 v[12:13], v[12:13], v[28:29]
    v_pk_add_f32 v[12:13], v[12:13], v[30:31]
    v_pk_add_f32 v[14:15], v[32:33], v[34:35]
    v_pk_add_f32 v[14:15], v[14:15], v[36:37]
    v_pk_add_f32 v[14:15], v[14:15], v[38:39]
    v_add_f32 v100, v12, v13
    v_add_f32 v14, v14, v15
    v_fmac_f32 v100, 0x3e800000, v14
    s_nop 1
    v_add_f32_dpp v100, v100, v100 row_ror:8 row_mask:0xf bank_mask:0xf
    v_mov_b32 v103, v100
    s_nop 1
    v_permlane16_swap_b32 v103, v100
    v_add_f32 v100, v100, v103
    v_mov_b32 v103, v100
    s_nop 1
    v_permlane32_swap_b32 v103, v100
    v_add_f32 v100, v100, v103
    v_mul_f32 v100, 0x3be38e39, v100
    v_pk_add_f32 v[184:185], v[16:17], v[100:101] op_sel_hi:[1,0] neg_lo:[0,1] neg_hi:[0,1]
    v_pk_add_f32 v[186:187], v[18:19], v[100:101] op_sel_hi:[1,0] neg_lo:[0,1] neg_hi:[0,1]
    v_pk_add_f32 v[188:189], v[20:21], v[100:101] op_sel_hi:[1,0] neg_lo:[0,1] neg_hi:[0,1]
    v_pk_add_f32 v[190:191], v[22:23], v[100:101] op_sel_hi:[1,0] neg_lo:[0,1] neg_hi:[0,1]
    v_pk_add_f32 v[192:193], v[24:25], v[100:101] op_sel_hi:[1,0] neg_lo:[0,1] neg_hi:[0,1]
    v_pk_add_f32 v[194:195], v[26:27], v[100:101] op_sel_hi:[1,0] neg_lo:[0,1] neg_hi:[0,1]
    v_pk_add_f32 v[196:197], v[28:29], v[100:101] op_sel_hi:[1,0] neg_lo:[0,1] neg_hi:[0,1]
    v_pk_add_f32 v[198:199], v[30:31], v[100:101] op_sel_hi:[1,0] neg_lo:[0,1] neg_hi:[0,1]
    v_pk_add_f32 v[200:201], v[32:33], v[100:101] op_sel_hi:[1,0] neg_lo:[0,1] neg_hi:[0,1]
    v_pk_add_f32 v[202:203], v[34:35], v[100:101] op_sel_hi:[1,0] neg_lo:[0,1] neg_hi:[0,1]
    v_pk_add_f32 v[204:205], v[36:37], v[100:101] op_sel_hi:[1,0] neg_lo:[0,1] neg_hi:[0,1]
    v_pk_add_f32 v[206:207], v[38:39], v[100:101] op_sel_hi:[1,0] neg_lo:[0,1] neg_hi:[0,1]
    v_pk_mul_f32 v[12:13], v[184:185], v[184:185]
    v_pk_fma_f32 v[12:13], v[186:187], v[186:187], v[12:13]
    v_pk_fma_f32 v[12:13], v[188:189], v[188:189], v[12:13]
    v_pk_fma_f32 v[12:13], v[190:191], v[190:191], v[12:13]
    v_pk_fma_f32 v[12:13], v[192:193], v[192:193], v[12:13]
    v_pk_fma_f32 v[12:13], v[194:195], v[194:195], v[12:13]
    v_pk_fma_f32 v[12:13], v[196:197], v[196:197], v[12:13]
    v_pk_fma_f32 v[12:13], v[198:199], v[198:199], v[12:13]
    v_pk_mul_f32 v[14:15], v[200:201], v[200:201]
    v_pk_fma_f32 v[14:15], v[202:203], v[202:203], v[14:15]
    v_pk_fma_f32 v[14:15], v[204:205], v[204:205], v[14:15]
    v_pk_fma_f32 v[14:15], v[206:207], v[206:207], v[14:15]
    v_add_f32 v101, v12, v13
    v_add_f32 v14, v14, v15
    v_fmac_f32 v101, 0x3e800000, v14
    v_pk_mul_f32 v[12:13], v[184:185], v[76:77]
    v_pk_fma_f32 v[12:13], v[186:187], v[78:79], v[12:13]
    v_pk_fma_f32 v[12:13], v[188:189], v[80:81], v[12:13]
    v_pk_fma_f32 v[12:13], v[190:191], v[82:83], v[12:13]
    v_pk_fma_f32 v[12:13], v[192:193], v[84:85], v[12:13]
    v_pk_fma_f32 v[12:13], v[194:195], v[86:87], v[12:13]
    v_pk_fma_f32 v[12:13], v[196:197], v[88:89], v[12:13]
    v_pk_fma_f32 v[12:13], v[198:199], v[90:91], v[12:13]
    v_pk_mul_f32 v[14:15], v[200:201], v[92:93]
    v_pk_fma_f32 v[14:15], v[202:203], v[94:95], v[14:15]
    v_pk_fma_f32 v[14:15], v[204:205], v[96:97], v[14:15]
    v_pk_fma_f32 v[14:15], v[206:207], v[98:99], v[14:15]
    v_add_f32 v102, v12, v13
    v_add_f32 v14, v14, v15
    v_fmac_f32 v102, 0x3e800000, v14
    s_nop 1
    v_add_f32_dpp v101, v101, v101 row_ror:8 row_mask:0xf bank_mask:0xf
    v_add_f32_dpp v102, v102, v102 row_ror:8 row_mask:0xf bank_mask:0xf
    v_mov_b32 v103, v101
    v_mov_b32 v104, v102
    s_nop 0
    v_permlane16_swap_b32 v103, v101
    v_permlane16_swap_b32 v104, v102
    v_add_f32 v101, v101, v103
    v_add_f32 v102, v102, v104
    v_mov_b32 v103, v101
    v_mov_b32 v104, v102
    s_nop 0
    v_permlane32_swap_b32 v103, v101
    v_permlane32_swap_b32 v104, v102
    v_add_f32 v101, v101, v103
    v_add_f32 v102, v102, v104
    ds_write_b32 v10, v100 offset:0
    ds_write_b32 v10, v101 offset:128
    ds_write_b32 v10, v102 offset:256
    s_waitcnt lgkmcnt(0)
    s_barrier
    ds_read_b128 v[40:43], v11 offset:0
    ds_read_b128 v[44:47], v11 offset:128
    ds_read_b128 v[48:51], v11 offset:256
    ds_read_b128 v[52:55], v11 offset:384
    ds_read_b128 v[56:59], v11 offset:512
    s_waitcnt lgkmcnt(4)
    v_add_f32 v12, v40, v41
    v_add_f32 v13, v42, v43
    v_add_f32 v12, v12, v13
    v_mul_f32 v12, 0x3e800000, v12
    v_sub_f32 v40, v40, v12
    v_sub_f32 v41, v41, v12
    v_sub_f32 v42, v42, v12
    v_sub_f32 v43, v43, v12
    v_sub_f32 v100, v100, v12
    v_mul_f32 v13, v40, v40
    v_fmac_f32 v13, v41, v41
    v_fmac_f32 v13, v42, v42
    v_fmac_f32 v13, v43, v43
    s_waitcnt lgkmcnt(3)
    v_add_f32 v14, v44, v45
    v_add_f32 v15, v46, v47
    v_add_f32 v14, v14, v15
    v_fmac_f32 v14, 0x43100000, v13
    v_mov_b32 v13, 0x3727c5ac
    v_fmac_f32 v13, 0x3ae38e39, v14
    v_rsq_f32 v13, v13
    s_waitcnt lgkmcnt(0)
    v_pk_fma_f32 v[48:49], v[40:41], v[52:53], v[48:49]
    v_pk_fma_f32 v[50:51], v[42:43], v[54:55], v[50:51]
    v_pk_add_f32 v[48:49], v[48:49], v[50:51]
    v_pk_add_f32 v[56:57], v[56:57], v[58:59]
    v_add_f32 v14, v48, v49
    v_add_f32 v15, v56, v57
    v_fmac_f32 v15, v14, v13
    v_ashrrev_i32 v12, 31, v15
    v_or_b32 v12, 0x80000000, v12
    v_xor_b32 v12, v12, v15
    v_and_or_b32 v44, v12, s57, v6
    v_mov_b32 v45, 0
    s_nop 1
    v_mov_b32_dpp v14, v44 row_ror:1 row_mask:0xf bank_mask:0xf
    v_mov_b32_dpp v15, v45 row_ror:1 row_mask:0xf bank_mask:0xf
    v_max_u32 v45, v45, v15
    v_med3_u32 v45, v44, v14, v45
    v_max_u32 v44, v44, v14
    s_nop 1
    v_mov_b32_dpp v14, v44 row_ror:2 row_mask:0xf bank_mask:0xf
    v_mov_b32_dpp v15, v45 row_ror:2 row_mask:0xf bank_mask:0xf
    v_max_u32 v45, v45, v15
    v_med3_u32 v45, v44, v14, v45
    v_max_u32 v44, v44, v14
    s_nop 1
    v_mov_b32_dpp v14, v44 row_ror:4 row_mask:0xf bank_mask:0xf
    v_mov_b32_dpp v15, v45 row_ror:4 row_mask:0xf bank_mask:0xf
    v_max_u32 v45, v45, v15
    v_med3_u32 v45, v44, v14, v45
    v_max_u32 v44, v44, v14
    buffer_store_dwordx2 v[44:45], v9, s[84:87], s58 offen offset:8 sc1
    v_mul_f32 v100, v100, v13
    v_pk_fma_f32 v[184:185], v[184:185], v[12:13], v[100:101] op_sel:[0,1,0] op_sel_hi:[1,1,0]
    v_pk_fma_f32 v[186:187], v[186:187], v[12:13], v[100:101] op_sel:[0,1,0] op_sel_hi:[1,1,0]
    v_pk_fma_f32 v[188:189], v[188:189], v[12:13], v[100:101] op_sel:[0,1,0] op_sel_hi:[1,1,0]
    v_pk_fma_f32 v[190:191], v[190:191], v[12:13], v[100:101] op_sel:[0,1,0] op_sel_hi:[1,1,0]
    v_pk_fma_f32 v[192:193], v[192:193], v[12:13], v[100:101] op_sel:[0,1,0] op_sel_hi:[1,1,0]
    v_pk_fma_f32 v[194:195], v[194:195], v[12:13], v[100:101] op_sel:[0,1,0] op_sel_hi:[1,1,0]
    v_pk_fma_f32 v[196:197], v[196:197], v[12:13], v[100:101] op_sel:[0,1,0] op_sel_hi:[1,1,0]
    v_pk_fma_f32 v[198:199], v[198:199], v[12:13], v[100:101] op_sel:[0,1,0] op_sel_hi:[1,1,0]
    v_pk_fma_f32 v[200:201], v[200:201], v[12:13], v[100:101] op_sel:[0,1,0] op_sel_hi:[1,1,0]
    v_pk_fma_f32 v[202:203], v[202:203], v[12:13], v[100:101] op_sel:[0,1,0] op_sel_hi:[1,1,0]
    v_pk_fma_f32 v[204:205], v[204:205], v[12:13], v[100:101] op_sel:[0,1,0] op_sel_hi:[1,1,0]
    v_pk_fma_f32 v[206:207], v[206:207], v[12:13], v[100:101] op_sel:[0,1,0] op_sel_hi:[1,1,0]
    v_pk_fma_f32 v[184:185], v[184:185], v[112:113], v[136:137]
    v_pk_fma_f32 v[186:187], v[186:187], v[114:115], v[138:139]
    v_pk_fma_f32 v[188:189], v[188:189], v[116:117], v[140:141]
    v_pk_fma_f32 v[190:191], v[190:191], v[118:119], v[142:143]
    v_pk_fma_f32 v[192:193], v[192:193], v[120:121], v[144:145]
    v_pk_fma_f32 v[194:195], v[194:195], v[122:123], v[146:147]
    v_pk_fma_f32 v[196:197], v[196:197], v[124:125], v[148:149]
    v_pk_fma_f32 v[198:199], v[198:199], v[126:127], v[150:151]
    v_pk_fma_f32 v[200:201], v[200:201], v[128:129], v[152:153]
    v_pk_fma_f32 v[202:203], v[202:203], v[130:131], v[154:155]
    v_pk_fma_f32 v[204:205], v[204:205], v[132:133], v[156:157]
    v_pk_fma_f32 v[206:207], v[206:207], v[134:135], v[158:159]
    v_cvt_pk_bf16_f32 v124, v184, v185
    v_cvt_pk_bf16_f32 v125, v186, v187
    v_cvt_pk_bf16_f32 v126, v188, v189
    v_cvt_pk_bf16_f32 v127, v190, v191
    v_min_u32 v124, -2, v124
    v_min_u32 v125, -2, v125
    v_min_u32 v126, -2, v126
    v_min_u32 v127, -2, v127
    ds_write_b128 v1, v[124:127] offset:9344
    v_cvt_pk_bf16_f32 v128, v192, v193
    v_cvt_pk_bf16_f32 v129, v194, v195
    v_cvt_pk_bf16_f32 v130, v196, v197
    v_cvt_pk_bf16_f32 v131, v198, v199
    v_min_u32 v128, -2, v128
    v_min_u32 v129, -2, v129
    v_min_u32 v130, -2, v130
    v_min_u32 v131, -2, v131
    ds_write_b128 v1, v[128:131] offset:9856
    v_cvt_pk_bf16_f32 v132, v200, v201
    v_cvt_pk_bf16_f32 v133, v202, v203
    v_cvt_pk_bf16_f32 v134, v204, v205
    v_cvt_pk_bf16_f32 v135, v206, v207
    v_min_u32 v132, -2, v132
    v_min_u32 v133, -2, v133
    v_min_u32 v134, -2, v134
    v_min_u32 v135, -2, v135
    ds_write_b128 v2, v[132:135] offset:9344
    v_pk_fma_f32 v[16:17], v[184:185], v[160:161], v[16:17]
    v_pk_fma_f32 v[18:19], v[186:187], v[162:163], v[18:19]
    v_pk_fma_f32 v[20:21], v[188:189], v[164:165], v[20:21]
    v_pk_fma_f32 v[22:23], v[190:191], v[166:167], v[22:23]
    v_pk_fma_f32 v[24:25], v[192:193], v[168:169], v[24:25]
    v_pk_fma_f32 v[26:27], v[194:195], v[170:171], v[26:27]
    v_pk_fma_f32 v[28:29], v[196:197], v[172:173], v[28:29]
    v_pk_fma_f32 v[30:31], v[198:199], v[174:175], v[30:31]
    v_pk_fma_f32 v[32:33], v[200:201], v[176:177], v[32:33]
    v_pk_fma_f32 v[34:35], v[202:203], v[178:179], v[34:35]
    v_pk_fma_f32 v[36:37], v[204:205], v[180:181], v[36:37]
    v_pk_fma_f32 v[38:39], v[206:207], v[182:183], v[38:39]
    v_cvt_pk_bf16_f32 v112, v16, v17
    v_cvt_pk_bf16_f32 v113, v18, v19
    v_cvt_pk_bf16_f32 v114, v20, v21
    v_cvt_pk_bf16_f32 v115, v22, v23
    ds_write_b128 v1, v[112:115] offset:0
    v_cvt_pk_bf16_f32 v116, v24, v25
    v_cvt_pk_bf16_f32 v117, v26, v27
    v_cvt_pk_bf16_f32 v118, v28, v29
    v_cvt_pk_bf16_f32 v119, v30, v31
    ds_write_b128 v1, v[116:119] offset:512
    v_cvt_pk_bf16_f32 v120, v32, v33
    v_cvt_pk_bf16_f32 v121, v34, v35
    v_cvt_pk_bf16_f32 v122, v36, v37
    v_cvt_pk_bf16_f32 v123, v38, v39
    ds_write_b128 v2, v[120:123] offset:0
    v_lshrrev_b32 v7, 4, v0
    v_and_b32 v6, 1, v0
    v_bfe_u32 v5, v0, 2, 2
    v_lshlrev_b32 v5, 6, v5
    v_lshl_add_u32 v5, v7, 4, v5
    v_mov_b32 v14, 15616
    s_waitcnt lgkmcnt(0)
    s_barrier
    s_cmp_lt_u32 s51, 2
    s_cbranch_scc1 L2_keys
    ds_read_b128 v[136:139], v107 offset:0
    ds_read_b128 v[140:143], v107 offset:1168
    ds_read_b128 v[144:147], v107 offset:2336
    ds_read_b128 v[148:151], v107 offset:3504
    ds_read_b128 v[152:155], v107 offset:4672
    ds_read_b128 v[156:159], v107 offset:5840
    ds_read_b128 v[160:163], v107 offset:7008
    ds_read_b128 v[164:167], v107 offset:8176
    ds_read_b128 v[168:171], v108 offset:1024
    s_movk_i32 s3, 0
    s_waitcnt lgkmcnt(8)
    buffer_store_dwordx4 v[136:139], v8, s[24:27], s3 offen offset:0 sc1
    s_waitcnt lgkmcnt(7)
    buffer_store_dwordx4 v[140:143], v8, s[24:27], s3 offen offset:1152 sc1
    s_waitcnt lgkmcnt(6)
    buffer_store_dwordx4 v[144:147], v8, s[24:27], s3 offen offset:2304 sc1
    s_waitcnt lgkmcnt(5)
    buffer_store_dwordx4 v[148:151], v8, s[24:27], s3 offen offset:3456 sc1
    s_movk_i32 s3, 4608
    s_waitcnt lgkmcnt(4)
    buffer_store_dwordx4 v[152:155], v8, s[24:27], s3 offen offset:0 sc1
    s_waitcnt lgkmcnt(3)
    buffer_store_dwordx4 v[156:159], v8, s[24:27], s3 offen offset:1152 sc1
    s_waitcnt lgkmcnt(2)
    buffer_store_dwordx4 v[160:163], v8, s[24:27], s3 offen offset:2304 sc1
    s_waitcnt lgkmcnt(1)
    buffer_store_dwordx4 v[164:167], v8, s[24:27], s3 offen offset:3456 sc1
    s_waitcnt lgkmcnt(0)
    buffer_store_dwordx4 v[168:171], v109, s[24:27], 0 offen offset:1024 sc1
    ds_read_b64_tr_b16 a[64:65], v110 offset:0
    ds_read_b64_tr_b16 a[66:67], v110 offset:256
    ds_read_b64_tr_b16 a[68:69], v110 offset:2048
    ds_read_b64_tr_b16 a[70:71], v110 offset:2304
L2_pad14:
    s_cbranch_execz L2_walkret
    ds_read_b64_tr_b16 a[72:73], v110 offset:4096
    ds_read_b64_tr_b16 a[74:75], v110 offset:4352
    ds_read_b64_tr_b16 a[76:77], v110 offset:6144
    ds_read_b64_tr_b16 a[78:79], v110 offset:6400
    ds_read_b64_tr_b16 a[80:81], v110 offset:8192
    ds_read_b64_tr_b16 a[82:83], v110 offset:8448
    ds_read_b64_tr_b16 a[84:85], v110 offset:10240
    ds_read_b64_tr_b16 a[86:87], v110 offset:10496
    ds_read_b64_tr_b16 a[88:89], v110 offset:12288
    ds_read_b64_tr_b16 a[90:91], v110 offset:12544
    ds_read_b64_tr_b16 a[92:93], v110 offset:14336
    ds_read_b64_tr_b16 a[94:95], v110 offset:14592
    ds_read_b64_tr_b16 a[96:97], v110 offset:16384
    ds_read_b64_tr_b16 a[98:99], v110 offset:16640
    ds_read_b64_tr_b16 a[100:101], v110 offset:18432
    ds_read_b64_tr_b16 a[102:103], v110 offset:18688
    ds_read_b64_tr_b16 a[104:105], v110 offset:20480
    ds_read_b64_tr_b16 a[106:107], v110 offset:20736
    ds_read_b64_tr_b16 a[108:109], v110 offset:22528
    ds_read_b64_tr_b16 a[110:111], v110 offset:22784
    ds_read_b64_tr_b16 a[112:113], v110 offset:24576
    ds_read_b64_tr_b16 a[114:115], v110 offset:24832
    ds_read_b64_tr_b16 a[116:117], v110 offset:26624
    ds_read_b64_tr_b16 a[118:119], v110 offset:26880
    ds_read_b64_tr_b16 a[120:121], v110 offset:28672
    ds_read_b64_tr_b16 a[122:123], v110 offset:28928
    ds_read_b64_tr_b16 a[124:125], v110 offset:30720
    ds_read_b64_tr_b16 a[126:127], v110 offset:30976
    ds_read_b64_tr_b16 a[128:129], v110 offset:32768
    ds_read_b64_tr_b16 a[130:131], v110 offset:33024
    ds_read_b64_tr_b16 a[132:133], v110 offset:34816
    ds_read_b64_tr_b16 a[134:135], v110 offset:35072
    ds_read_b64_tr_b16 a[136:137], v111 offset:0
    ds_read_b64_tr_b16 a[138:139], v111 offset:4608
    ds_read_b64_tr_b16 a[140:141], v111 offset:32
    ds_read_b64_tr_b16 a[142:143], v111 offset:4640
    ds_read_b64_tr_b16 a[144:145], v111 offset:64
    ds_read_b64_tr_b16 a[146:147], v111 offset:4672
    ds_read_b64_tr_b16 a[148:149], v111 offset:96
    ds_read_b64_tr_b16 a[150:151], v111 offset:4704
    ds_read_b64_tr_b16 a[152:153], v111 offset:128
    ds_read_b64_tr_b16 a[154:155], v111 offset:4736
    ds_read_b64_tr_b16 a[156:157], v111 offset:160
    ds_read_b64_tr_b16 a[158:159], v111 offset:4768
    ds_read_b64_tr_b16 a[160:161], v111 offset:192
    ds_read_b64_tr_b16 a[162:163], v111 offset:4800
    ds_read_b64_tr_b16 a[164:165], v111 offset:224
    ds_read_b64_tr_b16 a[166:167], v111 offset:4832
    ds_read_b64_tr_b16 a[168:169], v111 offset:256
    ds_read_b64_tr_b16 a[170:171], v111 offset:4864
    s_cmp_lt_u32 s2, 144
    s_cbranch_scc1 L2_join
    s_waitcnt vmcnt(0)
    buffer_store_dword v14, v9, s[84:87], s56 offen offset:128 sc1
    s_cmp_lt_u32 s2, 180
    s_cbranch_scc1 L2_join
    s_branch L2_fin
L2_keys:
    s_cmp_ge_u32 s2, 180
    s_cbranch_scc1 L2_fin
    buffer_load_dwordx2 v[64:65], v68, s[84:87], s15 offen offset:8 sc1
    buffer_load_dwordx2 v[66:67], v68, s[84:87], s59 offen offset:8 sc1
    ds_read_b64_tr_b16 a[64:65], v110 offset:0
    ds_read_b64_tr_b16 a[66:67], v110 offset:256
    ds_read_b64_tr_b16 a[68:69], v110 offset:2048
    ds_read_b64_tr_b16 a[70:71], v110 offset:2304
    ds_read_b64_tr_b16 a[72:73], v110 offset:4096
    ds_read_b64_tr_b16 a[74:75], v110 offset:4352
    ds_read_b64_tr_b16 a[76:77], v110 offset:6144
    ds_read_b64_tr_b16 a[78:79], v110 offset:6400
    ds_read_b64_tr_b16 a[80:81], v110 offset:8192
    ds_read_b64_tr_b16 a[82:83], v110 offset:8448
    ds_read_b64_tr_b16 a[84:85], v110 offset:10240
    ds_read_b64_tr_b16 a[86:87], v110 offset:10496
    ds_read_b64_tr_b16 a[88:89], v110 offset:12288
    ds_read_b64_tr_b16 a[90:91], v110 offset:12544
    ds_read_b64_tr_b16 a[92:93], v110 offset:14336
    ds_read_b64_tr_b16 a[94:95], v110 offset:14592
    ds_read_b64_tr_b16 a[96:97], v110 offset:16384
    ds_read_b64_tr_b16 a[98:99], v110 offset:16640
    ds_read_b64_tr_b16 a[100:101], v110 offset:18432
    ds_read_b64_tr_b16 a[102:103], v110 offset:18688
    ds_read_b64_tr_b16 a[104:105], v110 offset:20480
    ds_read_b64_tr_b16 a[106:107], v110 offset:20736
    ds_read_b64_tr_b16 a[108:109], v110 offset:22528
    ds_read_b64_tr_b16 a[110:111], v110 offset:22784
    ds_read_b64_tr_b16 a[112:113], v110 offset:24576
    ds_read_b64_tr_b16 a[114:115], v110 offset:24832
    ds_read_b64_tr_b16 a[116:117], v110 offset:26624
    ds_read_b64_tr_b16 a[118:119], v110 offset:26880
    ds_read_b64_tr_b16 a[120:121], v110 offset:28672
    ds_read_b64_tr_b16 a[122:123], v110 offset:28928
    ds_read_b64_tr_b16 a[124:125], v110 offset:30720
    ds_read_b64_tr_b16 a[126:127], v110 offset:30976
    ds_read_b64_tr_b16 a[128:129], v110 offset:32768
    ds_read_b64_tr_b16 a[130:131], v110 offset:33024
    ds_read_b64_tr_b16 a[132:133], v110 offset:34816
    ds_read_b64_tr_b16 a[134:135], v110 offset:35072
    ds_read_b64_tr_b16 a[136:137], v111 offset:0
    ds_read_b64_tr_b16 a[138:139], v111 offset:4608
    ds_read_b64_tr_b16 a[140:141], v111 offset:32
    ds_read_b64_tr_b16 a[142:143], v111 offset:4640
    ds_read_b64_tr_b16 a[144:145], v111 offset:64
    ds_read_b64_tr_b16 a[146:147], v111 offset:4672
    ds_read_b64_tr_b16 a[148:149], v111 offset:96
    ds_read_b64_tr_b16 a[150:151], v111 offset:4704
    ds_read_b64_tr_b16 a[152:153], v111 offset:128
    ds_read_b64_tr_b16 a[154:155], v111 offset:4736
    ds_read_b64_tr_b16 a[156:157], v111 offset:160
    ds_read_b64_tr_b16 a[158:159], v111 offset:4768
    ds_read_b64_tr_b16 a[160:161], v111 offset:192
    ds_read_b64_tr_b16 a[162:163], v111 offset:4800
    ds_read_b64_tr_b16 a[164:165], v111 offset:224
    ds_read_b64_tr_b16 a[166:167], v111 offset:4832
    ds_read_b64_tr_b16 a[168:169], v111 offset:256
    ds_read_b64_tr_b16 a[170:171], v111 offset:4864
    s_waitcnt vmcnt(0)
    v_cndmask_b32 v64, v64, v44, s[60:61]
    v_cndmask_b32 v65, v65, v45, s[60:61]
    v_cndmask_b32 v66, v66, v44, s[62:63]
    v_cndmask_b32 v67, v67, v45, s[62:63]
    v_min_u32 v12, v64, v65
    v_min_u32 v13, v66, v67
    v_cmp_eq_u32 s[4:5], 0, v12
    v_cmp_eq_u32 s[6:7], 0, v13
    s_nop 0
    s_or_b64 vcc, s[4:5], s[6:7]
    s_cbranch_scc0 L2_p2_ok
    s_mov_b32 s97, 0x20000
L2_p2:
    s_or_b64 exec, s[4:5], 1
    buffer_load_dwordx2 v[64:65], v68, s[84:87], s15 offen offset:8 sc1
    s_or_b64 exec, s[6:7], 1
    buffer_load_dwordx2 v[66:67], v68, s[84:87], s59 offen offset:8 sc1
    s_mov_b64 exec, -1
    s_waitcnt vmcnt(0)
    v_cndmask_b32 v64, v64, v44, s[60:61]
    v_cndmask_b32 v65, v65, v45, s[60:61]
    v_cndmask_b32 v66, v66, v44, s[62:63]
    v_cndmask_b32 v67, v67, v45, s[62:63]
    v_min_u32 v12, v64, v65
    v_min_u32 v13, v66, v67
    v_cmp_eq_u32 s[4:5], 0, v12
    v_cmp_eq_u32 s[6:7], 0, v13
    s_nop 0
    s_or_b64 vcc, s[4:5], s[6:7]
    s_sub_u32 s97, s97, 1
    s_cselect_b64 vcc, 0, vcc
    s_cmp_eq_u64 vcc, 0
    s_cbranch_scc1 L2_p2_ok
    s_sleep 1
    s_branch L2_p2
L2_p2_ok:
    v_max_u32 v65, v65, v67
    v_med3_u32 v65, v64, v66, v65
    v_max_u32 v64, v64, v66
    s_nop 1
    v_mov_b32_dpp v12, v64 row_ror:1 row_mask:0xf bank_mask:0xf
    v_mov_b32_dpp v13, v65 row_ror:1 row_mask:0xf bank_mask:0xf
    v_max_u32 v65, v65, v13
    v_med3_u32 v65, v64, v12, v65
    v_max_u32 v64, v64, v12
    s_nop 1
    v_mov_b32_dpp v12, v64 row_ror:2 row_mask:0xf bank_mask:0xf
    v_mov_b32_dpp v13, v65 row_ror:2 row_mask:0xf bank_mask:0xf
    v_max_u32 v65, v65, v13
    v_med3_u32 v65, v64, v12, v65
    v_max_u32 v64, v64, v12
    s_nop 1
    v_mov_b32_dpp v12, v64 row_ror:4 row_mask:0xf bank_mask:0xf
    v_mov_b32_dpp v13, v65 row_ror:4 row_mask:0xf bank_mask:0xf
    v_max_u32 v65, v65, v13
    v_med3_u32 v65, v64, v12, v65
    v_max_u32 v64, v64, v12
    s_nop 1
    v_mov_b32_dpp v12, v64 row_ror:8 row_mask:0xf bank_mask:0xf
    v_mov_b32_dpp v13, v65 row_ror:8 row_mask:0xf bank_mask:0xf
    v_max_u32 v65, v65, v13
    v_med3_u32 v65, v64, v12, v65
    v_max_u32 v64, v64, v12
    v_mov_b32 v12, v64
    v_mov_b32 v13, v65
    s_nop 0
    v_permlane16_swap_b32 v12, v64
    v_permlane16_swap_b32 v13, v65
    v_max_u32 v65, v65, v13
    v_med3_u32 v65, v64, v12, v65
    v_max_u32 v64, v64, v12
    v_mov_b32 v12, v64
    v_mov_b32 v13, v65
    s_nop 0
    v_permlane32_swap_b32 v12, v64
    v_permlane32_swap_b32 v13, v65
    v_max_u32 v65, v65, v13
    v_med3_u32 v65, v64, v12, v65
    v_max_u32 v64, v64, v12
    s_lshl3_add_u32 s3, s51, 15616
    v_mov_b32 v12, s3
    ds_write_b64 v12, v[64:65]
    s_waitcnt lgkmcnt(0)
L2_join:
    s_barrier
    ds_read_b128 v[16:19], v14
    v_cmp_eq_u32 vcc, 0, v6
    s_waitcnt lgkmcnt(0)
    v_max_u32 v17, v17, v19
    v_med3_u32 v17, v16, v18, v17
    v_max_u32 v16, v16, v18
    v_cndmask_b32 v16, v17, v16, vcc
    v_and_b32 v3, 0x7ff, v16
    v_sub_u32 v3, 2047, v3
    v_mul_u32_u24 v4, 1152, v3
    s_cmp_ge_u32 s2, 144
    s_cbranch_scc1 L2_red
    v_add_u32 v5, v5, v4
    s_mov_b32 s59, 4194304
    v_and_b32 v12, 8, v0
    v_lshlrev_b32 v12, 4, v12
    v_sub_u32 v3, v5, v12
    buffer_load_dwordx4 v[128:131], v5, s[84:87], s59 offen offset:0 sc1
    buffer_load_dwordx4 v[132:135], v5, s[84:87], s59 offen offset:256 sc1
    buffer_load_dwordx4 v[136:139], v5, s[84:87], s59 offen offset:512 sc1
    buffer_load_dwordx4 v[140:143], v5, s[84:87], s59 offen offset:768 sc1
    buffer_load_dwordx4 v[144:147], v3, s[84:87], s59 offen offset:1024 sc1
    v_lshlrev_b32 v11, 7, v6
    v_lshl_add_u32 v13, v7, 5, v11
    v_add_u32 v13, 14848, v13
    v_lshl_add_u32 v11, v7, 4, v11
    s_lshr_b32 s3, s51, 1
    s_lshl_b32 s3, s3, 8
    s_and_b32 s14, s51, 1
    s_lshl_b32 s14, s14, 6
    s_add_u32 s3, s3, s14
    s_add_u32 s3, s3, 14848
    v_add_u32 v11, s3, v11
    s_mul_i32 s14, s51, 1152
    s_mul_i32 s15, s2, 4608
    s_add_u32 s15, s15, s14
    s_add_u32 s15, s15, 98304
    v_lshlrev_b32 v10, 3, v0
    s_waitcnt vmcnt(0)
    buffer_store_dword v14, v9, s[84:87], s56 offen offset:128 sc1
L2_hr:
    v_mfma_f32_16x16x32_bf16 v[88:91], a[64:67], v[128:131], 0
    v_max_u32 v12, v128, v129
    v_mfma_f32_16x16x32_bf16 v[92:95], a[68:71], v[128:131], 0
    v_max3_u32 v12, v12, v130, v131
    v_mfma_f32_16x16x32_bf16 v[96:99], a[72:75], v[128:131], 0
    v_max3_u32 v12, v12, v132, v133
    v_mfma_f32_16x16x32_bf16 v[100:103], a[76:79], v[128:131], 0
    v_max3_u32 v12, v12, v134, v135
    v_mfma_f32_16x16x32_bf16 v[88:91], a[80:83], v[132:135], v[88:91]
    v_max3_u32 v12, v12, v136, v137
    v_mfma_f32_16x16x32_bf16 v[92:95], a[84:87], v[132:135], v[92:95]
    v_max3_u32 v12, v12, v138, v139
    v_mfma_f32_16x16x32_bf16 v[96:99], a[88:91], v[132:135], v[96:99]
    v_max3_u32 v12, v12, v140, v141
    v_mfma_f32_16x16x32_bf16 v[100:103], a[92:95], v[132:135], v[100:103]
    v_max3_u32 v12, v12, v142, v143
    v_mfma_f32_16x16x32_bf16 v[88:91], a[96:99], v[136:139], v[88:91]
    v_max3_u32 v12, v12, v144, v145
    v_mfma_f32_16x16x32_bf16 v[92:95], a[100:103], v[136:139], v[92:95]
    v_max3_u32 v12, v12, v146, v147
    v_mfma_f32_16x16x32_bf16 v[96:99], a[104:107], v[136:139], v[96:99]
    v_cmp_eq_u32 vcc, -1, v12
    v_mfma_f32_16x16x32_bf16 v[100:103], a[108:111], v[136:139], v[100:103]
    v_mfma_f32_16x16x32_bf16 v[96:99], a[120:123], v[140:143], v[96:99]
    v_mfma_f32_16x16x32_bf16 v[100:103], a[124:127], v[140:143], v[100:103]
    v_mfma_f32_16x16x32_bf16 v[88:91], a[112:115], v[140:143], v[88:91]
    v_mfma_f32_16x16x32_bf16 v[92:95], a[116:119], v[140:143], v[92:95]
    v_mfma_f32_16x16x32_bf16 v[92:95], a[132:135], v[144:147], v[92:95]
    v_mfma_f32_16x16x32_bf16 v[88:91], a[128:131], v[144:147], v[88:91]
    s_cmp_lg_u64 vcc, 0
    s_cbranch_scc1 L2_hs
    s_nop 1
    v_add_f32_dpp v96, v100, v96 row_shl:4 row_mask:0xf bank_mask:0xf bound_ctrl:1
    v_add_f32_dpp v97, v101, v97 row_shl:4 row_mask:0xf bank_mask:0xf bound_ctrl:1
    v_add_f32_dpp v98, v102, v98 row_shl:4 row_mask:0xf bank_mask:0xf bound_ctrl:1
    v_add_f32_dpp v99, v103, v99 row_shl:4 row_mask:0xf bank_mask:0xf bound_ctrl:1
    v_add_f32_dpp v88, v92, v88 row_shl:4 row_mask:0xf bank_mask:0xf bound_ctrl:1
    v_add_f32_dpp v89, v93, v89 row_shl:4 row_mask:0xf bank_mask:0xf bound_ctrl:1
    v_add_f32_dpp v90, v94, v90 row_shl:4 row_mask:0xf bank_mask:0xf bound_ctrl:1
    v_add_f32_dpp v91, v95, v91 row_shl:4 row_mask:0xf bank_mask:0xf bound_ctrl:1
    v_add_f32_dpp v88, v96, v88 row_shl:8 row_mask:0xf bank_mask:0xf bound_ctrl:1
    v_add_f32_dpp v89, v97, v89 row_shl:8 row_mask:0xf bank_mask:0xf bound_ctrl:1
    v_add_f32_dpp v90, v98, v90 row_shl:8 row_mask:0xf bank_mask:0xf bound_ctrl:1
    v_add_f32_dpp v91, v99, v91 row_shl:8 row_mask:0xf bank_mask:0xf bound_ctrl:1
    s_mov_b32 exec_lo, 0x30003
    s_mov_b32 exec_hi, 0x30003
    ds_write_b128 v11, v[88:91]
    s_mov_b64 exec, -1
    s_waitcnt lgkmcnt(0)
    s_barrier
    ds_read_b128 v[16:19], v13 offset:0
    ds_read_b128 v[20:23], v13 offset:16
    ds_read_b128 v[24:27], v13 offset:256
    ds_read_b128 v[28:31], v13 offset:272
    v_mov_b32 v12, 0xbfb8aa3b
    s_waitcnt lgkmcnt(2)
    v_pk_mul_f32 v[32:33], v[16:17], v[12:13] op_sel_hi:[1,0]
    v_pk_mul_f32 v[34:35], v[18:19], v[12:13] op_sel_hi:[1,0]
    v_pk_mul_f32 v[36:37], v[20:21], v[12:13] op_sel_hi:[1,0]
    v_pk_mul_f32 v[38:39], v[22:23], v[12:13] op_sel_hi:[1,0]
    v_exp_f32 v32, v32
    v_exp_f32 v33, v33
    v_exp_f32 v34, v34
    v_exp_f32 v35, v35
    v_exp_f32 v36, v36
    v_exp_f32 v37, v37
    v_exp_f32 v38, v38
    v_exp_f32 v39, v39
    v_pk_add_f32 v[32:33], v[32:33], 1.0 op_sel_hi:[1,0]
    v_pk_add_f32 v[34:35], v[34:35], 1.0 op_sel_hi:[1,0]
    v_pk_add_f32 v[36:37], v[36:37], 1.0 op_sel_hi:[1,0]
    v_pk_add_f32 v[38:39], v[38:39], 1.0 op_sel_hi:[1,0]
    v_rcp_f32 v32, v32
    v_rcp_f32 v33, v33
    v_rcp_f32 v34, v34
    v_rcp_f32 v35, v35
    v_rcp_f32 v36, v36
    v_rcp_f32 v37, v37
    v_rcp_f32 v38, v38
    v_rcp_f32 v39, v39
    s_waitcnt lgkmcnt(0)
    v_pk_mul_f32 v[16:17], v[16:17], v[32:33]
    v_pk_mul_f32 v[18:19], v[18:19], v[34:35]
    v_pk_mul_f32 v[20:21], v[20:21], v[36:37]
    v_pk_mul_f32 v[22:23], v[22:23], v[38:39]
    v_pk_mul_f32 v[16:17], v[16:17], v[24:25]
    v_pk_mul_f32 v[18:19], v[18:19], v[26:27]
    v_pk_mul_f32 v[20:21], v[20:21], v[28:29]
    v_pk_mul_f32 v[22:23], v[22:23], v[30:31]
    v_cvt_pk_bf16_f32 v40, v16, v17
    v_cvt_pk_bf16_f32 v41, v18, v19
    v_cvt_pk_bf16_f32 v42, v20, v21
    v_cvt_pk_bf16_f32 v43, v22, v23
    s_nop 1
    v_mfma_f32_16x16x32_bf16 v[48:51], v[40:43], a[136:139], 0
    v_mfma_f32_16x16x32_bf16 v[52:55], v[40:43], a[140:143], 0
    v_mfma_f32_16x16x32_bf16 v[56:59], v[40:43], a[144:147], 0
    v_mfma_f32_16x16x32_bf16 v[60:63], v[40:43], a[148:151], 0
    v_mfma_f32_16x16x32_bf16 v[64:67], v[40:43], a[152:155], 0
    v_mfma_f32_16x16x32_bf16 v[68:71], v[40:43], a[156:159], 0
    v_mfma_f32_16x16x32_bf16 v[72:75], v[40:43], a[160:163], 0
    v_mfma_f32_16x16x32_bf16 v[76:79], v[40:43], a[164:167], 0
    v_mfma_f32_16x16x32_bf16 v[80:83], v[40:43], a[168:171], 0
    s_nop 0
    v_mov_b32_dpp v48, v52 quad_perm:[0,1,2,3] row_mask:0x2 bank_mask:0xf
    v_mov_b32_dpp v49, v53 quad_perm:[0,1,2,3] row_mask:0x2 bank_mask:0xf
    s_nop 0
    v_mov_b32_dpp v48, v56 quad_perm:[0,1,2,3] row_mask:0x4 bank_mask:0xf
    v_mov_b32_dpp v49, v57 quad_perm:[0,1,2,3] row_mask:0x4 bank_mask:0xf
    s_nop 0
    v_mov_b32_dpp v48, v60 quad_perm:[0,1,2,3] row_mask:0x8 bank_mask:0xf
    v_mov_b32_dpp v49, v61 quad_perm:[0,1,2,3] row_mask:0x8 bank_mask:0xf
    v_mov_b32_dpp v50, v64 quad_perm:[0,1,2,3] row_mask:0x1 bank_mask:0xf
    v_mov_b32_dpp v51, v65 quad_perm:[0,1,2,3] row_mask:0x1 bank_mask:0xf
    s_nop 0
    v_mov_b32_dpp v50, v68 quad_perm:[0,1,2,3] row_mask:0x2 bank_mask:0xf
    v_mov_b32_dpp v51, v69 quad_perm:[0,1,2,3] row_mask:0x2 bank_mask:0xf
    s_nop 0
    v_mov_b32_dpp v50, v72 quad_perm:[0,1,2,3] row_mask:0x4 bank_mask:0xf
    v_mov_b32_dpp v51, v73 quad_perm:[0,1,2,3] row_mask:0x4 bank_mask:0xf
    s_nop 0
    v_mov_b32_dpp v50, v76 quad_perm:[0,1,2,3] row_mask:0x8 bank_mask:0xf
    v_mov_b32_dpp v51, v77 quad_perm:[0,1,2,3] row_mask:0x8 bank_mask:0xf
    v_min_u32 v48, -2, v48
    v_min_u32 v49, -2, v49
    v_min_u32 v50, -2, v50
    v_min_u32 v51, -2, v51
    v_min_u32 v80, -2, v80
    v_min_u32 v81, -2, v81
    buffer_store_dwordx4 v[48:51], v8, s[84:87], s15 offen sc1
    s_mov_b64 exec, 0xffff
    buffer_store_dwordx2 v[80:81], v10, s[84:87], s15 offen offset:1024 sc1
    s_branch L2_fin
L2_red:
    s_mov_b32 s3, 98304
    s_add_u32 s32, s84, s3
    s_addc_u32 s33, s85, 0
    s_mov_b32 s34, 663552
    s_mov_b32 s35, 0x20000
    s_sub_u32 s3, s2, 144
    s_mul_i32 s14, s3, 7282
    s_lshr_b32 s14, s14, 16
    s_mul_i32 s15, s14, 9
    s_sub_u32 s15, s3, s15
    s_mul_i32 s14, s14, 144
    s_cmp_eq_u32 s15, 8
    s_cselect_b32 s56, 1, 64
    s_cselect_b32 s57, 2, 1
    s_cselect_b32 s15, 16, s15
    s_lshl3_add_u32 s14, s15, s14
    v_bfe_u32 v7, v0, 2, 3
    v_mul_u32_u24 v7, s57, v7
    v_bfe_u32 v9, v0, 1, 1
    v_mul_u32_u24 v9, s56, v9
    v_add3_u32 v7, v7, v9, s14
    v_lshl_add_u32 v9, v7, 1, v4
    v_lshlrev_b32 v7, 2, v7
    v_lshrrev_b32 v12, 7, v3
    v_bfe_u32 v13, v3, 3, 4
    v_lshl_add_u32 v13, v12, 6, v13
    v_lshlrev_b32 v13, 8, v13
    s_mov_b32 s59, 794624
    s_mov_b32 s97, 0x20000
L2_r:
    buffer_load_dword v12, v13, s[84:87], s59 offen offset:128 sc1
    s_waitcnt vmcnt(0)
    v_cmp_eq_u32 vcc, 0, v12
    s_sub_u32 s97, s97, 1
    s_cselect_b64 vcc, 0, vcc
    s_cmp_eq_u64 vcc, 0
    s_cbranch_scc1 L2_r_ok
    s_sleep 1
    s_branch L2_r
L2_r_ok:
    buffer_load_ushort v18, v9, s[80:83], 0 offen sc1
    ds_read_b32 v20, v7 offset:6912
    v_and_b32 v6, 7, v0
    v_lshrrev_b32 v10, 3, v0
    s_lshl_b32 s14, s51, 3
    v_add_u32 v10, s14, v10
    v_mul_u32_u24 v10, 4608, v10
    v_lshl_add_u32 v10, v6, 4, v10
    s_lshl_b32 s3, s3, 7
    v_add_u32 v24, s3, v10
    v_add_u32 v25, 147456, v24
    v_add_u32 v26, 294912, v24
    v_add_u32 v27, 442368, v24
    v_add_u32 v28, 589824, v24
    v_and_b32 v16, 0xfffff800, v16
    v_not_b32 v12, v16
    v_ashrrev_i32 v12, 31, v12
    v_or_b32 v12, 0x80000000, v12
    v_xor_b32 v16, v16, v12
    v_mul_f32 v16, 0xbfb8aa3b, v16
    v_exp_f32 v16, v16
    s_nop 0
    v_add_f32 v16, 1.0, v16
    v_rcp_f32 v16, v16
    s_waitcnt lgkmcnt(0)
    v_mul_f32 v20, v20, v16
    s_lshl_b32 s14, s51, 7
    s_add_u32 s14, s14, 15872
    v_lshl_add_u32 v10, v6, 4, s14
    v_and_b32 v11, 31, v0
    v_lshlrev_b32 v11, 2, v11
    s_mov_b32 s97, 0x20000
L2_p3:
    buffer_load_dwordx4 v[32:35], v24, s[32:35], 0 offen sc1
    buffer_load_dwordx4 v[36:39], v25, s[32:35], 0 offen sc1
    buffer_load_dwordx4 v[40:43], v26, s[32:35], 0 offen sc1
    buffer_load_dwordx4 v[44:47], v27, s[32:35], 0 offen sc1
    buffer_load_dwordx4 v[48:51], v28, s[32:35], 0 offen sc1
    s_waitcnt vmcnt(0)
    v_max3_u32 v12, v32, v33, v34
    v_max3_u32 v12, v12, v35, v36
    v_max3_u32 v12, v12, v37, v38
    v_max3_u32 v12, v12, v39, v40
    v_max3_u32 v12, v12, v41, v42
    v_max3_u32 v12, v12, v43, v44
    v_max3_u32 v12, v12, v45, v46
    v_max3_u32 v12, v12, v47, v48
    v_max3_u32 v12, v12, v49, v50
    v_max_u32 v12, v12, v51
    v_cmp_eq_u32 vcc, -1, v12
    s_sub_u32 s97, s97, 1
    s_cselect_b64 vcc, 0, vcc
    s_cmp_eq_u64 vcc, 0
    s_cbranch_scc1 L2_p3_ok
    s_branch L2_p3
L2_p3_ok:
    v_pk_add_f32 v[32:33], v[32:33], v[36:37]
    v_pk_add_f32 v[40:41], v[40:41], v[44:45]
    v_pk_add_f32 v[32:33], v[32:33], v[48:49]
    v_pk_add_f32 v[32:33], v[32:33], v[40:41]
    v_pk_add_f32 v[34:35], v[34:35], v[38:39]
    v_pk_add_f32 v[42:43], v[42:43], v[46:47]
    v_pk_add_f32 v[34:35], v[34:35], v[50:51]
    v_pk_add_f32 v[34:35], v[34:35], v[42:43]
    s_nop 1
    v_add_f32_dpp v32, v32, v32 row_ror:8 row_mask:0xf bank_mask:0xf
    v_add_f32_dpp v33, v33, v33 row_ror:8 row_mask:0xf bank_mask:0xf
    v_add_f32_dpp v34, v34, v34 row_ror:8 row_mask:0xf bank_mask:0xf
    v_add_f32_dpp v35, v35, v35 row_ror:8 row_mask:0xf bank_mask:0xf
    v_mov_b32 v12, v32
    v_mov_b32 v13, v33
    v_mov_b32 v14, v34
    v_mov_b32 v15, v35
    v_permlane16_swap_b32 v12, v32
    v_permlane16_swap_b32 v13, v33
    v_permlane16_swap_b32 v14, v34
    v_permlane16_swap_b32 v15, v35
    v_add_f32 v32, v32, v12
    v_add_f32 v33, v33, v13
    v_add_f32 v34, v34, v14
    v_add_f32 v35, v35, v15
    v_mov_b32 v12, v32
    v_mov_b32 v13, v33
    v_mov_b32 v14, v34
    v_mov_b32 v15, v35
    v_permlane32_swap_b32 v12, v32
    v_permlane32_swap_b32 v13, v33
    v_permlane32_swap_b32 v14, v34
    v_permlane32_swap_b32 v15, v35
    v_add_f32 v32, v32, v12
    v_add_f32 v33, v33, v13
    v_add_f32 v34, v34, v14
    v_add_f32 v35, v35, v15
    ds_write_b128 v10, v[32:35]
    s_waitcnt lgkmcnt(0)
    s_barrier
    s_cmp_lg_u32 s51, 0
    s_cbranch_scc1 L2_fin
    ds_read_b32 v32, v11 offset:15872
    ds_read_b32 v33, v11 offset:16000
    ds_read_b32 v34, v11 offset:16128
    ds_read_b32 v35, v11 offset:16256
    v_lshlrev_b32 v12, 16, v18
    s_mov_b32 exec_hi, 0
    s_waitcnt lgkmcnt(0)
    v_pk_add_f32 v[32:33], v[32:33], v[34:35]
    v_add_f32 v32, v32, v33
    v_fmac_f32 v12, v32, v20
    v_cvt_pk_bf16_f32 v12, v12, v12
    buffer_store_short v12, v9, s[80:83], 0 offen sc1
L2_fin:
L2_end:
    s_endpgm
L2_p0s:
    s_mov_b32 s97, 0x20000
L2_p0:
    buffer_load_dword v51, v156, s[60:63], 0 offen sc1
    s_waitcnt vmcnt(0)
    v_cmp_eq_u32 vcc, 0, v51
    s_sub_u32 s97, s97, 1
    s_cselect_b64 vcc, 0, vcc
    s_cmp_eq_u64 vcc, 0
    s_cbranch_scc1 L2_p0_ok
    s_sleep 1
    s_branch L2_p0
L2_p0_ok:
    s_branch L2_p0r
L2_pms:
    s_mov_b32 s97, 0x20000
L2_pm:
    buffer_load_dwordx4 v[168:171], v166, s[84:87], 0 offen sc1
    buffer_load_dwordx4 v[176:179], v166, s[84:87], s14 offen sc1
    s_mov_b64 exec, 0xff
    buffer_load_dwordx4 v[172:175], v166, s[84:87], 0 offen offset:1024 sc1
    buffer_load_dwordx4 v[180:183], v166, s[84:87], s14 offen offset:1024 sc1
    s_mov_b64 exec, -1
    s_waitcnt vmcnt(0)
    v_max_u32 v13, v168, v169
    v_max3_u32 v13, v13, v170, v171
    v_max3_u32 v13, v13, v172, v173
    v_max3_u32 v13, v13, v174, v175
    v_max3_u32 v13, v13, v176, v177
    v_max3_u32 v13, v13, v178, v179
    v_max3_u32 v13, v13, v180, v181
    v_max3_u32 v13, v13, v182, v183
    v_cmp_eq_u32 vcc, -1, v13
    s_sub_u32 s97, s97, 1
    s_cselect_b64 vcc, 0, vcc
    s_cmp_eq_u64 vcc, 0
    s_cbranch_scc1 L2_pm_ok
    s_sleep 1
    s_branch L2_pm
L2_pm_ok:
    s_branch L2_pmr
L2_g0s:
    s_mov_b32 s97, 0x20000
L2_g0:
    buffer_load_dword v9, v6, s[84:87], s47 offen sc1
    s_waitcnt vmcnt(0)
    v_cmp_ne_u32 vcc, 0, v9
    s_nop 0
    s_lshr_b32 s3, vcc_lo, 1
    s_and_b32 s3, s3, vcc_lo
    s_lshr_b32 s14, s3, 2
    s_and_b32 s3, s3, s14
    s_and_b32 s3, s3, s48
    s_cselect_b64 vcc, 0, -1
    s_sub_u32 s97, s97, 1
    s_cselect_b64 vcc, 0, vcc
    s_cmp_eq_u64 vcc, 0
    s_cbranch_scc1 L2_g0_ok
    s_sleep 1
    s_branch L2_g0
L2_g0_ok:
    s_cmp_eq_u32 s3, 0
    s_cselect_b32 s3, s48, s3
    s_branch L2_g0r
L2_pns:
    s_mov_b32 s97, 0x20000
L2_pn:
    s_movk_i32 s45, 4608
    buffer_load_dwordx4 v[76:79], v5, s[84:87], s45 offen sc1
    s_movk_i32 s45, 18432
    buffer_load_dwordx4 v[88:91], v5, s[84:87], s45 offen sc1
    s_movk_i32 s45, 8704
    buffer_load_dwordx4 v[80:83], v5, s[84:87], s45 offen sc1
    s_movk_i32 s45, 22528
    buffer_load_dwordx4 v[92:95], v5, s[84:87], s45 offen sc1
    s_movk_i32 s45, 12800
    buffer_load_dwordx4 v[84:87], v59, s[84:87], s45 offen sc1
    s_movk_i32 s45, 26624
    buffer_load_dwordx4 v[96:99], v59, s[84:87], s45 offen sc1
    s_waitcnt vmcnt(0)
    v_max_u32 v13, v76, v77
    v_max3_u32 v13, v13, v78, v79
    v_max3_u32 v13, v13, v88, v89
    v_max3_u32 v13, v13, v90, v91
    v_max3_u32 v13, v13, v80, v81
    v_max3_u32 v13, v13, v82, v83
    v_max3_u32 v13, v13, v92, v93
    v_max3_u32 v13, v13, v94, v95
    v_max3_u32 v13, v13, v84, v85
    v_max3_u32 v13, v13, v86, v87
    v_max3_u32 v13, v13, v96, v97
    v_max3_u32 v13, v13, v98, v99
    v_cmp_eq_u32 vcc, -1, v13
    s_sub_u32 s97, s97, 1
    s_cselect_b64 vcc, 0, vcc
    s_cmp_eq_u64 vcc, 0
    s_cbranch_scc1 L2_pn_ok
    s_sleep 1
    s_branch L2_pn
L2_pn_ok:
    s_branch L2_pnr
L2_g1s:
    s_mov_b32 s97, 0x20000
L2_g1:
    buffer_load_dword v9, v6, s[84:87], s47 offen sc1
    s_waitcnt vmcnt(0)
    v_cmp_ne_u32 vcc, 0, v9
    s_nop 0
    s_lshr_b32 s3, vcc_lo, 1
    s_and_b32 s3, s3, vcc_lo
    s_lshr_b32 s14, s3, 2
    s_and_b32 s3, s3, s14
    s_and_b32 s3, s3, s48
    s_cselect_b64 vcc, 0, -1
    s_sub_u32 s97, s97, 1
    s_cselect_b64 vcc, 0, vcc
    s_cmp_eq_u64 vcc, 0
    s_cbranch_scc1 L2_g1_ok
    s_sleep 1
    s_branch L2_g1
L2_g1_ok:
    s_cmp_eq_u32 s3, 0
    s_cselect_b32 s3, s48, s3
    s_branch L2_g1r
L2_g2s:
    s_mov_b32 s97, 0x20000
L2_g2:
    buffer_load_dword v9, v6, s[84:87], s47 offen sc1
    s_waitcnt vmcnt(0)
    v_cmp_ne_u32 vcc, 0, v9
    s_nop 0
    s_lshr_b32 s3, vcc_lo, 1
    s_and_b32 s3, s3, vcc_lo
    s_lshr_b32 s14, s3, 2
    s_and_b32 s3, s3, s14
    s_and_b32 s3, s3, s48
    s_cselect_b64 vcc, 0, -1
    s_sub_u32 s97, s97, 1
    s_cselect_b64 vcc, 0, vcc
    s_cmp_eq_u64 vcc, 0
    s_cbranch_scc1 L2_g2_ok
    s_sleep 1
    s_branch L2_g2
L2_g2_ok:
    s_cmp_eq_u32 s3, 0
    s_cselect_b32 s3, s48, s3
    s_branch L2_g2r
L2_g3s:
    s_mov_b32 s97, 0x20000
L2_g3:
    buffer_load_dword v9, v6, s[84:87], s47 offen sc1
    s_waitcnt vmcnt(0)
    v_cmp_ne_u32 vcc, 0, v9
    s_nop 0
    s_lshr_b32 s3, vcc_lo, 1
    s_and_b32 s3, s3, vcc_lo
    s_lshr_b32 s14, s3, 2
    s_and_b32 s3, s3, s14
    s_and_b32 s3, s3, s48
    s_cselect_b64 vcc, 0, -1
    s_sub_u32 s97, s97, 1
    s_cselect_b64 vcc, 0, vcc
    s_cmp_eq_u64 vcc, 0
    s_cbranch_scc1 L2_g3_ok
    s_sleep 1
    s_branch L2_g3
L2_g3_ok:
    s_cmp_eq_u32 s3, 0
    s_cselect_b32 s3, s48, s3
    s_branch L2_g3r
L2_hs:
    s_mov_b32 s97, 0x20000
L2_h:
    buffer_load_dwordx4 v[128:131], v5, s[84:87], s59 offen offset:0 sc1
    buffer_load_dwordx4 v[132:135], v5, s[84:87], s59 offen offset:256 sc1
    buffer_load_dwordx4 v[136:139], v5, s[84:87], s59 offen offset:512 sc1
    buffer_load_dwordx4 v[140:143], v5, s[84:87], s59 offen offset:768 sc1
    buffer_load_dwordx4 v[144:147], v3, s[84:87], s59 offen offset:1024 sc1
    s_waitcnt vmcnt(0)
    v_max_u32 v12, v128, v129
    v_max3_u32 v12, v12, v130, v131
    v_max3_u32 v12, v12, v132, v133
    v_max3_u32 v12, v12, v134, v135
    v_max3_u32 v12, v12, v136, v137
    v_max3_u32 v12, v12, v138, v139
    v_max3_u32 v12, v12, v140, v141
    v_max3_u32 v12, v12, v142, v143
    v_max3_u32 v12, v12, v144, v145
    v_max3_u32 v12, v12, v146, v147
    v_cmp_eq_u32 vcc, -1, v12
    s_sub_u32 s97, s97, 1
    s_cselect_b64 vcc, 0, vcc
    s_cmp_eq_u64 vcc, 0
    s_cbranch_scc1 L2_h_ok
    s_sleep 1
    s_branch L2_h
L2_h_ok:
    v_min_u32 v128, -2, v128
    v_min_u32 v129, -2, v129
    v_min_u32 v130, -2, v130
    v_min_u32 v131, -2, v131
    v_min_u32 v132, -2, v132
    v_min_u32 v133, -2, v133
    v_min_u32 v134, -2, v134
    v_min_u32 v135, -2, v135
    v_min_u32 v136, -2, v136
    v_min_u32 v137, -2, v137
    v_min_u32 v138, -2, v138
    v_min_u32 v139, -2, v139
    v_min_u32 v140, -2, v140
    v_min_u32 v141, -2, v141
    v_min_u32 v142, -2, v142
    v_min_u32 v143, -2, v143
    v_min_u32 v144, -2, v144
    v_min_u32 v145, -2, v145
    v_min_u32 v146, -2, v146
    v_min_u32 v147, -2, v147
    s_nop 1
    s_branch L2_hr
L2_fallback:
    s_waitcnt vmcnt(0) lgkmcnt(0)
    s_nop 7
    s_barrier
    s_lshl_b32 s3, s51, 12
    v_add_u32 v5, s3, v8
    v_lshrrev_b32 v14, 2, v0
    v_mul_u32_u24 v14, 1056, v14
    v_and_b32 v15, 3, v0
    v_lshl_add_u32 v14, v15, 3, v14
    v_add_u32 v2, 107008, v14
    v_and_b32 v14, 15, v0
    v_mul_u32_u24 v14, 1056, v14
    v_lshrrev_b32 v15, 4, v0
    v_lshl_add_u32 v14, v15, 4, v14
    v_add_u32 v1, 90112, v14
    v_mov_b32 v32, 0xff800000
    v_mov_b32 v33, 0xff800000
    v_mov_b32 v34, 0xff800000
    v_mov_b32 v35, 0xff800000
    s_mov_b32 s50, 1
    s_mov_b32 s46, 0
L2_fb_loop:
    s_add_u32 m0, s44, 73728
    s_nop 0
    buffer_load_dwordx4 v5, s[16:19], s46 offen offset:0 lds
    s_add_u32 m0, s44, 73760
    s_nop 0
    buffer_load_dwordx4 v5, s[16:19], s46 offen offset:1024 lds
    s_add_u32 m0, s44, 73792
    s_nop 0
    buffer_load_dwordx4 v5, s[16:19], s46 offen offset:2048 lds
    s_add_u32 m0, s44, 73824
    s_nop 0
    buffer_load_dwordx4 v5, s[16:19], s46 offen offset:3072 lds
    s_waitcnt vmcnt(0) lgkmcnt(0)
    s_barrier
    ds_read_b128 a[64:67], v1 offset:0
    ds_read_b128 a[68:71], v1 offset:64
    ds_read_b128 a[72:75], v1 offset:128
    ds_read_b128 a[76:79], v1 offset:192
    ds_read_b128 a[80:83], v1 offset:256
    ds_read_b128 a[84:87], v1 offset:320
    ds_read_b128 a[88:91], v1 offset:384
    ds_read_b128 a[92:95], v1 offset:448
    ds_read_b128 a[96:99], v1 offset:512
    ds_read_b128 a[100:103], v1 offset:576
    ds_read_b128 a[104:107], v1 offset:640
    ds_read_b128 a[108:111], v1 offset:704
    ds_read_b128 a[112:115], v1 offset:768
    ds_read_b128 a[116:119], v1 offset:832
    ds_read_b128 a[120:123], v1 offset:896
    ds_read_b128 a[124:127], v1 offset:960
    s_waitcnt vmcnt(0) lgkmcnt(0)
    s_barrier
    v_mfma_f32_16x16x32_bf16 v[16:19], a[64:67], v[64:67], 0
    v_mfma_f32_16x16x32_bf16 v[16:19], a[68:71], v[68:71], v[16:19]
    v_mfma_f32_16x16x32_bf16 v[16:19], a[72:75], v[72:75], v[16:19]
    v_mfma_f32_16x16x32_bf16 v[16:19], a[76:79], v[76:79], v[16:19]
    v_mfma_f32_16x16x32_bf16 v[20:23], a[80:83], v[64:67], 0
    v_mfma_f32_16x16x32_bf16 v[20:23], a[84:87], v[68:71], v[20:23]
    v_mfma_f32_16x16x32_bf16 v[20:23], a[88:91], v[72:75], v[20:23]
    v_mfma_f32_16x16x32_bf16 v[20:23], a[92:95], v[76:79], v[20:23]
    v_mfma_f32_16x16x32_bf16 v[24:27], a[96:99], v[64:67], 0
    v_mfma_f32_16x16x32_bf16 v[24:27], a[100:103], v[68:71], v[24:27]
    v_mfma_f32_16x16x32_bf16 v[24:27], a[104:107], v[72:75], v[24:27]
    v_mfma_f32_16x16x32_bf16 v[24:27], a[108:111], v[76:79], v[24:27]
    v_mfma_f32_16x16x32_bf16 v[28:31], a[112:115], v[64:67], 0
    v_mfma_f32_16x16x32_bf16 v[28:31], a[116:119], v[68:71], v[28:31]
    v_mfma_f32_16x16x32_bf16 v[28:31], a[120:123], v[72:75], v[28:31]
    v_mfma_f32_16x16x32_bf16 v[28:31], a[124:127], v[76:79], v[28:31]
    s_nop 7
    v_max3_f32 v32, v32, v16, v17
    v_max3_f32 v32, v32, v18, v19
    v_max3_f32 v32, v32, v20, v21
    v_max3_f32 v32, v32, v22, v23
    v_max3_f32 v32, v32, v24, v25
    v_max3_f32 v32, v32, v26, v27
    v_max3_f32 v32, v32, v28, v29
    v_max3_f32 v32, v32, v30, v31
    v_mfma_f32_16x16x32_bf16 v[16:19], a[64:67], v[80:83], 0
    v_mfma_f32_16x16x32_bf16 v[16:19], a[68:71], v[84:87], v[16:19]
    v_mfma_f32_16x16x32_bf16 v[16:19], a[72:75], v[88:91], v[16:19]
    v_mfma_f32_16x16x32_bf16 v[16:19], a[76:79], v[92:95], v[16:19]
    v_mfma_f32_16x16x32_bf16 v[20:23], a[80:83], v[80:83], 0
    v_mfma_f32_16x16x32_bf16 v[20:23], a[84:87], v[84:87], v[20:23]
    v_mfma_f32_16x16x32_bf16 v[20:23], a[88:91], v[88:91], v[20:23]
    v_mfma_f32_16x16x32_bf16 v[20:23], a[92:95], v[92:95], v[20:23]
    v_mfma_f32_16x16x32_bf16 v[24:27], a[96:99], v[80:83], 0
    v_mfma_f32_16x16x32_bf16 v[24:27], a[100:103], v[84:87], v[24:27]
    v_mfma_f32_16x16x32_bf16 v[24:27], a[104:107], v[88:91], v[24:27]
    v_mfma_f32_16x16x32_bf16 v[24:27], a[108:111], v[92:95], v[24:27]
    v_mfma_f32_16x16x32_bf16 v[28:31], a[112:115], v[80:83], 0
    v_mfma_f32_16x16x32_bf16 v[28:31], a[116:119], v[84:87], v[28:31]
    v_mfma_f32_16x16x32_bf16 v[28:31], a[120:123], v[88:91], v[28:31]
    v_mfma_f32_16x16x32_bf16 v[28:31], a[124:127], v[92:95], v[28:31]
    s_nop 7
    v_max3_f32 v33, v33, v16, v17
    v_max3_f32 v33, v33, v18, v19
    v_max3_f32 v33, v33, v20, v21
    v_max3_f32 v33, v33, v22, v23
    v_max3_f32 v33, v33, v24, v25
    v_max3_f32 v33, v33, v26, v27
    v_max3_f32 v33, v33, v28, v29
    v_max3_f32 v33, v33, v30, v31
    v_mfma_f32_16x16x32_bf16 v[16:19], a[64:67], v[96:99], 0
    v_mfma_f32_16x16x32_bf16 v[16:19], a[68:71], v[100:103], v[16:19]
    v_mfma_f32_16x16x32_bf16 v[16:19], a[72:75], v[104:107], v[16:19]
    v_mfma_f32_16x16x32_bf16 v[16:19], a[76:79], v[108:111], v[16:19]
    v_mfma_f32_16x16x32_bf16 v[20:23], a[80:83], v[96:99], 0
    v_mfma_f32_16x16x32_bf16 v[20:23], a[84:87], v[100:103], v[20:23]
    v_mfma_f32_16x16x32_bf16 v[20:23], a[88:91], v[104:107], v[20:23]
    v_mfma_f32_16x16x32_bf16 v[20:23], a[92:95], v[108:111], v[20:23]
    v_mfma_f32_16x16x32_bf16 v[24:27], a[96:99], v[96:99], 0
    v_mfma_f32_16x16x32_bf16 v[24:27], a[100:103], v[100:103], v[24:27]
    v_mfma_f32_16x16x32_bf16 v[24:27], a[104:107], v[104:107], v[24:27]
    v_mfma_f32_16x16x32_bf16 v[24:27], a[108:111], v[108:111], v[24:27]
    v_mfma_f32_16x16x32_bf16 v[28:31], a[112:115], v[96:99], 0
    v_mfma_f32_16x16x32_bf16 v[28:31], a[116:119], v[100:103], v[28:31]
    v_mfma_f32_16x16x32_bf16 v[28:31], a[120:123], v[104:107], v[28:31]
    v_mfma_f32_16x16x32_bf16 v[28:31], a[124:127], v[108:111], v[28:31]
    s_nop 7
    v_max3_f32 v34, v34, v16, v17
    v_max3_f32 v34, v34, v18, v19
    v_max3_f32 v34, v34, v20, v21
    v_max3_f32 v34, v34, v22, v23
    v_max3_f32 v34, v34, v24, v25
    v_max3_f32 v34, v34, v26, v27
    v_max3_f32 v34, v34, v28, v29
    v_max3_f32 v34, v34, v30, v31
    v_mfma_f32_16x16x32_bf16 v[16:19], a[64:67], v[112:115], 0
    v_mfma_f32_16x16x32_bf16 v[16:19], a[68:71], v[116:119], v[16:19]
    v_mfma_f32_16x16x32_bf16 v[16:19], a[72:75], v[120:123], v[16:19]
    v_mfma_f32_16x16x32_bf16 v[16:19], a[76:79], v[124:127], v[16:19]
    v_mfma_f32_16x16x32_bf16 v[20:23], a[80:83], v[112:115], 0
    v_mfma_f32_16x16x32_bf16 v[20:23], a[84:87], v[116:119], v[20:23]
    v_mfma_f32_16x16x32_bf16 v[20:23], a[88:91], v[120:123], v[20:23]
    v_mfma_f32_16x16x32_bf16 v[20:23], a[92:95], v[124:127], v[20:23]
    v_mfma_f32_16x16x32_bf16 v[24:27], a[96:99], v[112:115], 0
    v_mfma_f32_16x16x32_bf16 v[24:27], a[100:103], v[116:119], v[24:27]
    v_mfma_f32_16x16x32_bf16 v[24:27], a[104:107], v[120:123], v[24:27]
    v_mfma_f32_16x16x32_bf16 v[24:27], a[108:111], v[124:127], v[24:27]
    v_mfma_f32_16x16x32_bf16 v[28:31], a[112:115], v[112:115], 0
    v_mfma_f32_16x16x32_bf16 v[28:31], a[116:119], v[116:119], v[28:31]
    v_mfma_f32_16x16x32_bf16 v[28:31], a[120:123], v[120:123], v[28:31]
    v_mfma_f32_16x16x32_bf16 v[28:31], a[124:127], v[124:127], v[28:31]
    s_nop 7
    v_max3_f32 v35, v35, v16, v17
    v_max3_f32 v35, v35, v18, v19
    v_max3_f32 v35, v35, v20, v21
    v_max3_f32 v35, v35, v22, v23
    v_max3_f32 v35, v35, v24, v25
    v_max3_f32 v35, v35, v26, v27
    v_max3_f32 v35, v35, v28, v29
    v_max3_f32 v35, v35, v30, v31
    s_add_u32 s46, s46, 16384
    s_cmp_lt_u32 s46, 524288
    s_cbranch_scc1 L2_fb_loop
    v_mov_b32 v40, v32
    v_mov_b32 v41, v33
    v_mov_b32 v42, v34
    v_mov_b32 v43, v35
    v_permlane16_swap_b32 v40, v32
    v_permlane16_swap_b32 v41, v33
    v_permlane16_swap_b32 v42, v34
    v_permlane16_swap_b32 v43, v35
    v_max_f32 v32, v32, v40
    v_max_f32 v33, v33, v41
    v_max_f32 v34, v34, v42
    v_max_f32 v35, v35, v43
    v_mov_b32 v40, v32
    v_mov_b32 v41, v33
    v_mov_b32 v42, v34
    v_mov_b32 v43, v35
    v_permlane32_swap_b32 v40, v32
    v_permlane32_swap_b32 v41, v33
    v_permlane32_swap_b32 v42, v34
    v_permlane32_swap_b32 v43, v35
    v_max_f32 v32, v32, v40
    v_max_f32 v33, v33, v41
    v_max_f32 v34, v34, v42
    v_max_f32 v35, v35, v43
    v_sub_f32 v48, 0x80000000, v32
    v_sub_f32 v49, 0x80000000, v32
    v_sub_f32 v50, 0x80000000, v32
    v_sub_f32 v51, 0x80000000, v32
    v_sub_f32 v52, 0x80000000, v33
    v_sub_f32 v53, 0x80000000, v33
    v_sub_f32 v54, 0x80000000, v33
    v_sub_f32 v55, 0x80000000, v33
    v_sub_f32 v56, 0x80000000, v34
    v_sub_f32 v57, 0x80000000, v34
    v_sub_f32 v58, 0x80000000, v34
    v_sub_f32 v59, 0x80000000, v34
    v_sub_f32 v60, 0x80000000, v35
    v_sub_f32 v61, 0x80000000, v35
    v_sub_f32 v62, 0x80000000, v35
    v_sub_f32 v63, 0x80000000, v35
    s_add_u32 m0, s44, 73728
    s_mov_b32 s46, 0
    buffer_load_dwordx4 v5, s[16:19], s46 offen offset:0 lds
    s_add_u32 m0, s44, 73760
    s_nop 0
    buffer_load_dwordx4 v5, s[16:19], s46 offen offset:1024 lds
    s_add_u32 m0, s44, 73792
    s_nop 0
    buffer_load_dwordx4 v5, s[16:19], s46 offen offset:2048 lds
    s_add_u32 m0, s44, 73824
    s_nop 0
    buffer_load_dwordx4 v5, s[16:19], s46 offen offset:3072 lds
    s_add_u32 m0, s44, 90624
    s_nop 0
    buffer_load_dwordx4 v5, s[20:23], s46 offen offset:0 lds
    s_add_u32 m0, s44, 90656
    s_nop 0
    buffer_load_dwordx4 v5, s[20:23], s46 offen offset:1024 lds
    s_add_u32 m0, s44, 90688
    s_nop 0
    buffer_load_dwordx4 v5, s[20:23], s46 offen offset:2048 lds
    s_add_u32 m0, s44, 90720
    s_nop 0
    buffer_load_dwordx4 v5, s[20:23], s46 offen offset:3072 lds
    s_add_u32 m0, s44, 110592
    s_mov_b32 s46, 16384
    buffer_load_dwordx4 v5, s[16:19], s46 offen offset:0 lds
    s_add_u32 m0, s44, 110624
    s_nop 0
    buffer_load_dwordx4 v5, s[16:19], s46 offen offset:1024 lds
    s_add_u32 m0, s44, 110656
    s_nop 0
    buffer_load_dwordx4 v5, s[16:19], s46 offen offset:2048 lds
    s_add_u32 m0, s44, 110688
    s_nop 0
    buffer_load_dwordx4 v5, s[16:19], s46 offen offset:3072 lds
    s_add_u32 m0, s44, 127488
    s_nop 0
    buffer_load_dwordx4 v5, s[20:23], s46 offen offset:0 lds
    s_add_u32 m0, s44, 127520
    s_nop 0
    buffer_load_dwordx4 v5, s[20:23], s46 offen offset:1024 lds
    s_add_u32 m0, s44, 127552
    s_nop 0
    buffer_load_dwordx4 v5, s[20:23], s46 offen offset:2048 lds
    s_add_u32 m0, s44, 127584
    s_nop 0
    buffer_load_dwordx4 v5, s[20:23], s46 offen offset:3072 lds
    s_add_u32 m0, s44, 0
    s_mov_b32 s46, 32768
    buffer_load_dwordx4 v5, s[16:19], s46 offen offset:0 lds
    s_add_u32 m0, s44, 32
    s_nop 0
    buffer_load_dwordx4 v5, s[16:19], s46 offen offset:1024 lds
    s_add_u32 m0, s44, 64
    s_nop 0
    buffer_load_dwordx4 v5, s[16:19], s46 offen offset:2048 lds
    s_add_u32 m0, s44, 96
    s_nop 0
    buffer_load_dwordx4 v5, s[16:19], s46 offen offset:3072 lds
    s_add_u32 m0, s44, 16896
    s_nop 0
    buffer_load_dwordx4 v5, s[20:23], s46 offen offset:0 lds
    s_add_u32 m0, s44, 16928
    s_nop 0
    buffer_load_dwordx4 v5, s[20:23], s46 offen offset:1024 lds
    s_add_u32 m0, s44, 16960
    s_nop 0
    buffer_load_dwordx4 v5, s[20:23], s46 offen offset:2048 lds
    s_add_u32 m0, s44, 16992
    s_nop 0
    buffer_load_dwordx4 v5, s[20:23], s46 offen offset:3072 lds
    s_waitcnt vmcnt(0) lgkmcnt(0)
    s_barrier
    ds_read_b128 a[64:67], v1 offset:0
    ds_read_b128 a[68:71], v1 offset:64
    ds_read_b128 a[72:75], v1 offset:128
    ds_read_b128 a[76:79], v1 offset:192
    ds_read_b128 a[80:83], v1 offset:256
    ds_read_b128 a[84:87], v1 offset:320
    ds_read_b128 a[88:91], v1 offset:384
    ds_read_b128 a[92:95], v1 offset:448
    ds_read_b128 a[96:99], v1 offset:512
    ds_read_b128 a[100:103], v1 offset:576
    ds_read_b128 a[104:107], v1 offset:640
    ds_read_b128 a[108:111], v1 offset:704
    ds_read_b128 a[112:115], v1 offset:768
    ds_read_b128 a[116:119], v1 offset:832
    ds_read_b128 a[120:123], v1 offset:896
    ds_read_b128 a[124:127], v1 offset:960
    v_lshrrev_b32 v14, 2, v0
    s_mul_i32 s3, s51, 144
    v_add_u32 v14, s3, v14
    v_mul_u32_u24 v14, 9216, v14
    v_and_b32 v15, 3, v0
    v_lshl_add_u32 v6, v15, 4, v14
    s_lshr_b32 s3, s2, 3
    s_lshl2_add_u32 s3, s3, s51
    s_and_b32 s15, s2, 7
    v_lshlrev_b32 v9, 7, v0
    s_mul_i32 s14, s3, 9
    s_lshr_b32 s14, s14, 1
    v_min_u32 v15, 44, v0
    v_mul_u32_u24 v12, 7282, v15
    v_lshrrev_b32 v12, 16, v12
    v_mul_u32_u24 v13, 63, v12
    v_add_u32 v12, v15, v13
    s_mul_i32 s14, s14, 72
    s_mul_i32 s56, s15, 9
    s_add_u32 s14, s14, s56
    v_add_lshl_u32 v12, s14, v12, 7
    s_mul_i32 s14, s3, 81
    s_lshr_b32 s14, s14, 1
    s_mul_i32 s56, s15, 5184
    s_add_u32 s14, s14, s56
    v_min_u32 v13, 40, v0
    v_add_lshl_u32 v13, s14, v13, 7
    s_mul_i32 s14, s3, 72
    s_andn2_b32 s56, s52, 3
    s_mul_i32 s56, s56, 2304
    s_add_u32 s14, s14, s56
    v_min_u32 v14, 35, v0
    v_add_lshl_u32 v14, s14, v14, 7
    v_add_u32 v15, 4608, v14
    v_accvgpr_write_b32 a0, 0
    v_accvgpr_write_b32 a1, 0
    v_accvgpr_write_b32 a2, 0
    v_accvgpr_write_b32 a3, 0
    v_accvgpr_write_b32 a4, 0
    v_accvgpr_write_b32 a5, 0
    v_accvgpr_write_b32 a6, 0
    v_accvgpr_write_b32 a7, 0
    v_accvgpr_write_b32 a8, 0
    v_accvgpr_write_b32 a9, 0
    v_accvgpr_write_b32 a10, 0
    v_accvgpr_write_b32 a11, 0
    v_accvgpr_write_b32 a12, 0
    v_accvgpr_write_b32 a13, 0
    v_accvgpr_write_b32 a14, 0
    v_accvgpr_write_b32 a15, 0
    s_waitcnt vmcnt(0) lgkmcnt(0)
    s_branch L2_entry
L2_codeend:

.section .rodata,"a"
.p2align 6
.amdhsa_kernel adaLN_cond__gqa_block_cached__moe_arch_mod__prompt_kernel
  .amdhsa_next_free_vgpr 512
  .amdhsa_next_free_sgpr 102
  .amdhsa_accum_offset 256
  .amdhsa_group_segment_fixed_size 0
  .amdhsa_kernarg_size 120
  .amdhsa_user_sgpr_count 2
  .amdhsa_user_sgpr_kernarg_segment_ptr 1
  .amdhsa_system_sgpr_workgroup_id_x 1
  .amdhsa_float_denorm_mode_32 3
.end_amdhsa_kernel
```

```asm
; @launch grid=(256,1,1) block=(256,1,1) lds=163840
.amdgcn_target "amdgcn-amd-amdhsa--gfx950"
.text
.globl adaLN_cond__gqa_block_cached__moe_arch_mod__prompt_kernel
.p2align 8
.type adaLN_cond__gqa_block_cached__moe_arch_mod__prompt_kernel,@function
adaLN_cond__gqa_block_cached__moe_arch_mod__prompt_kernel:
L2_begin:
    s_getpc_b64 s[98:99]
    s_cmp_ge_u32 s2, 256
    s_cbranch_scc1 L2_end
    s_load_dwordx2 s[76:77], s[0:1], 0
    s_load_dwordx2 s[16:17], s[0:1], 80
    s_load_dwordx2 s[88:89], s[0:1], 88
    s_load_dwordx2 s[12:13], s[0:1], 112
    s_load_dwordx2 s[60:61], s[0:1], 104
    s_and_b32 s3, s2, 7
    s_lshr_b32 s14, s2, 3
    v_mov_b32 v155, v0
    v_lshrrev_b32 v10, 6, v0
    v_and_b32 v0, 63, v0
    s_lshl_b32 s15, s14, 9
    v_lshl_add_u32 v13, v10, 7, s15
    v_lshl_add_u32 v13, v0, 14, v13
    v_min_u32 v13, L2_codeend-L2_begin-8, v13
    s_mov_b64 exec, 31
    global_load_dword a63, v13, s[98:99]
    s_mov_b64 exec, -1
    v_readfirstlane_b32 s51, v10
    s_and_b32 s52, s3, 3
    s_and_b32 s15, s14, 3
    s_lshl2_add_u32 s52, s52, s15
    s_lshr_b32 s53, s3, 2
    s_lshr_b32 s15, s14, 2
    s_lshl3_add_u32 s53, s53, s15
    s_lshl4_add_u32 s96, s53, s52
    s_mul_i32 s49, s3, 27
    s_max_u32 s14, s14, 5
    s_add_u32 s49, s49, s14
    s_sub_u32 s49, s49, 5
    s_lshr_b32 s55, s3, 2
    s_mul_i32 s15, s55, 108
    s_sub_u32 s50, s49, s15
    s_mul_i32 s3, s51, 288
    v_lshrrev_b32 v14, 3, v0
    v_lshl_add_u32 v12, v14, 4, s3
    v_and_b32 v14, 1, v14
    v_lshl_add_u32 v13, v14, 4, s3
    v_and_b32 v14, 7, v0
    v_mul_u32_u24 v14, 1152, v14
    v_add_u32 v1, v14, v12
    v_add_u32 v2, v14, v13
    v_add_u32 v2, 256, v2
    v_and_b32 v4, 0xfc, v155
    v_and_b32 v7, 3, v0
    v_mul_u32_u24 v3, 6912, v4
    v_lshl_add_u32 v153, v7, 4, v3
    s_mul_i32 s3, s96, 9216
    s_movk_i32 s78, 9216
    s_mov_b32 s79, 0x20000
    s_mov_b32 s91, s79
    v_lshlrev_b32 v8, 4, v0
    s_mov_b32 s86, 8388608
    s_mov_b32 s87, s79
    s_movk_i32 s62, 256
    s_mov_b32 s63, s79
    s_lshl_b32 s14, s50, 6
    s_sub_u32 s90, 1990656, s14
    s_cmp_ge_u32 s2, 40
    s_cselect_b32 s90, s90, 0
    s_mul_i32 s15, s55, 1990656
    s_add_u32 s14, s14, s15
    s_waitcnt lgkmcnt(0)
    s_add_u32 s76, s76, s3
    s_addc_u32 s77, s77, 0
    buffer_load_dwordx4 v[64:67], v1, s[76:79], 0 offen offset:0
    buffer_load_dwordx4 v[68:71], v1, s[76:79], 0 offen offset:128
    buffer_load_dwordx4 v[72:75], v2, s[76:79], 0 offen offset:0
    s_add_u32 s88, s88, s14
    s_addc_u32 s89, s89, 0
    s_mov_b64 s[84:85], s[12:13]
    s_cmp_ge_u32 s2, 8
    s_cbranch_scc1 L2_noclr
    v_mov_b32 v52, -1
    v_mov_b32 v56, 0
    v_mov_b32 v53, -1
    v_mov_b32 v57, 0
    v_mov_b32 v54, -1
    v_mov_b32 v58, 0
    v_mov_b32 v55, -1
    v_mov_b32 v59, 0
    s_lshl2_add_u32 s15, s2, s51
    s_lshl_b32 s3, s15, 10
    buffer_store_dwordx4 v[52:55], v8, s[84:87], s3 offen sc1
    v_lshrrev_b32 v13, 3, v0
    v_mul_u32_u24 v13, 0, v13
    v_add_u32 v13, v13, v8
    s_mul_i32 s3, s15, 1024
    s_add_u32 s3, s3, 6815744
    buffer_store_dwordx4 v[56:59], v13, s[84:87], s3 offen sc1
L2_noclr:
    buffer_load_dwordx4 v[128:131], v153, s[88:91], 0 offen
    s_movk_i32 s3, 6912
    buffer_load_dwordx4 v[132:135], v153, s[88:91], s3 offen
    s_movk_i32 s3, 13824
    buffer_load_dwordx4 v[136:139], v153, s[88:91], s3 offen
    s_movk_i32 s3, 20736
    buffer_load_dwordx4 v[140:143], v153, s[88:91], s3 offen
    v_lshrrev_b32 v3, 2, v3
    v_lshl_add_u32 v3, v7, 4, v3
    v_add_u32 v154, 1769472, v3
    v_lshrrev_b32 v3, 1, v4
    v_lshlrev_b32 v4, 1, v4
    s_mul_i32 s3, s55, 576
    s_add_u32 s16, s16, s3
    s_addc_u32 s17, s17, 0
    s_mov_b32 s18, 576
    s_mov_b32 s19, 0x20000
    buffer_load_dwordx2 v[148:149], v4, s[16:19], 0 offen
    v_mov_b32 v144, 0
    v_mov_b32 v145, 0
    v_mov_b32 v146, 0
    v_mov_b32 v147, 0
    v_mov_b32 v150, 0
    s_cmp_ge_u32 s51, 2
    s_cbranch_scc1 L2_w23
    buffer_load_dwordx4 v[144:147], v154, s[88:91], 0 offen
    buffer_load_ushort v150, v3, s[16:19], 0 offen offset:512
L2_w23:
    s_load_dwordx8 s[4:11], s[0:1], 8
    s_load_dwordx2 s[64:65], s[0:1], 56
    s_load_dwordx2 s[68:69], s[0:1], 64
    s_load_dwordx2 s[72:73], s[0:1], 72
    s_load_dwordx2 s[80:81], s[0:1], 96
    s_load_dwordx2 s[36:37], s[0:1], 48
    s_cmp_eq_u32 s51, 0
    s_cselect_b32 s3, 0, 0x40000000
    v_mul_u32_u24 v156, 32, v0
    v_or_b32 v156, s3, v156
    s_mul_i32 s44, s51, 4224
    s_add_u32 s44, s44, 16384
    v_lshl_add_u32 v5, v10, 12, v8
    v_lshrrev_b32 v13, 5, v0
    v_lshl_add_u32 v13, v10, 1, v13
    v_lshlrev_b32 v13, 15, v13
    v_and_b32 v14, 31, v0
    v_lshl_add_u32 v6, v14, 4, v13
    v_mov_b32 v56, 0
    v_mov_b32 v60, -1
    v_mov_b32 v57, 0
    v_mov_b32 v61, -1
    v_mov_b32 v58, 0
    v_mov_b32 v62, -1
    v_mov_b32 v59, 0
    v_mov_b32 v63, -1
    s_and_b32 s14, s53, 7
    s_lshl2_add_u32 s14, s14, s51
    v_lshrrev_b32 v13, 2, v0
    v_lshl_add_u32 v13, v13, 5, s14
    v_lshlrev_b32 v13, 13, v13
    v_lshl_add_u32 v13, v7, 7, v13
    s_waitcnt lgkmcnt(0)
    s_lshl_b32 s3, s52, 9
    s_add_u32 s24, s8, s3
    s_addc_u32 s25, s9, 0
    s_mov_b32 s26, 0
    s_mov_b32 s27, 0x20000
    s_sub_u32 s26, 4718592, s3
    s_mov_b64 exec, 0xffff
    buffer_load_dword a63, v13, s[24:27], 0 offen
    s_mov_b64 exec, -1
    s_mov_b32 s38, 1152
    s_mov_b32 s39, 0x20000
    v_and_b32 v14, 7, v0
    v_lshlrev_b32 v157, 4, v14
    v_add_u32 v157, 14080, v157
    v_lshl_add_u32 v158, v10, 2, v157
    s_mul_i32 s3, s51, 4608
    v_lshl_add_u32 v14, v14, 4, s3
    v_lshrrev_b32 v15, 3, v0
    v_lshl_add_u32 v159, v15, 8, v14
    s_lshr_b32 s3, s96, 1
    s_mul_i32 s3, s3, 18432
    s_and_b32 s14, s96, 1
    s_lshl_b32 s14, s14, 7
    s_add_u32 s3, s3, s14
    s_add_u32 s58, s3, 1048576
    s_lshl_b32 s3, s53, 2
    s_add_u32 s3, s3, s51
    s_lshl_b32 s14, s3, 4
    s_add_u32 s14, s14, s52
    s_lshl_b32 s14, s14, 8
    s_add_u32 s56, s14, 786432
    s_mul_i32 s14, s3, 512
    s_add_u32 s59, s14, 6815744
    v_and_b32 v14, 3, v0
    v_mul_u32_u24 v163, 128, v14
    s_mul_i32 s14, s3, 36864
    s_add_u32 s14, s14, 1048576
    s_add_u32 s32, s12, s14
    s_addc_u32 s33, s13, 0
    s_mov_b32 s34, 36864
    s_mov_b32 s35, 0x20000
    s_mul_i32 s15, s2, 4608
    s_mul_i32 s14, s51, 1152
    s_add_u32 s15, s15, s14
    s_add_u32 s57, s15, 98304
    s_cmp_ge_u32 s2, 144
    s_cselect_b32 s14, 0x40000000, 0
    v_or_b32 v160, s14, v8
    v_lshrrev_b32 v12, 4, v155
    v_lshlrev_b32 v12, 7, v12
    v_lshl_add_u32 v161, v7, 5, v12
    v_lshlrev_b32 v162, 2, v0
    s_mul_i32 s3, s50, 3641
    s_lshr_b32 s3, s3, 16
    s_mov_b32 s47, 1.0
    s_mov_b32 s48, 0
    s_cmp_lt_u32 s3, 2
    s_cselect_b32 s47, 0x3e0293ee, s47
    s_cmp_eq_u32 s3, 1
    s_cselect_b32 s48, 0x3e0293ee, s48
    s_cmp_eq_u32 s3, 4
    s_cselect_b32 s48, 1.0, s48
    s_cmp_eq_u32 s55, 0
    s_cselect_b32 s48, s48, 0
    s_lshl_b32 s100, s49, 7
    s_mul_i32 s14, s96, 128
    s_add_u32 s101, s14, 6815744
    s_mul_i32 s3, s51, 1152
    v_add_u32 v166, s3, v8
    s_and_b32 s3, s51, 1
    s_mul_i32 s3, s3, 2304
    s_cmp_lt_u32 s51, 2
    s_cselect_b32 s14, 32, 0
    s_add_u32 s3, s3, s14
    s_add_u32 s3, s3, 9216
    v_lshrrev_b32 v14, 1, v0
    v_lshl_add_u32 v14, v14, 6, s3
    v_and_b32 v15, 1, v0
    v_lshl_add_u32 v167, v15, 4, v14
    s_cmp_eq_u32 s51, 1
    s_cselect_b32 s3, 40, 256
    s_cmp_ge_u32 s2, s3
    s_cselect_b32 s3, 0, 0x40000000
    v_or_b32 v164, s3, v162
    v_mov_b32 v172, 0
    v_mov_b32 v180, 0
    v_mov_b32 v173, 0
    v_mov_b32 v181, 0
    v_mov_b32 v174, 0
    v_mov_b32 v182, 0
    v_mov_b32 v175, 0
    v_mov_b32 v183, 0
    s_lshl_b32 s3, s53, 2
    s_add_u32 s3, s3, s51
    v_mov_b32 v12, v10
    s_mul_i32 s14, s3, 589824
    s_mul_i32 s15, s52, 9216
    s_add_u32 s14, s14, s15
    s_add_u32 s14, s14, 8388608
    s_add_u32 s40, s12, s14
    s_addc_u32 s41, s13, 0
    s_mov_b32 s42, 0
    s_mov_b32 s43, 0x20000
    s_sub_u32 s42, 589824, s15
    s_lshl_b32 s3, s52, 19
    s_add_u32 s16, s4, s3
    s_addc_u32 s17, s5, 0
    s_mov_b32 s18, 524288
    s_mov_b32 s19, 0x20000
    s_add_u32 s20, s6, s3
    s_addc_u32 s21, s7, 0
    s_mov_b32 s22, 524288
    s_mov_b32 s23, 0x20000
    s_mul_i32 s3, s52, 294912
    s_add_u32 s28, s10, s3
    s_addc_u32 s29, s11, 0
    s_mov_b32 s30, 294912
    s_mov_b32 s31, 0x20000
    s_mov_b64 s[4:5], s[64:65]
    s_mov_b64 s[6:7], s[68:69]
    s_mov_b64 s[8:9], s[72:73]
    s_mov_b32 s50, 0
    s_mul_i32 s55, s51, 9216
    s_min_u32 s15, s2, 143
    s_and_b32 s3, s15, 7
    s_mul_i32 s3, s3, 18
    s_lshr_b32 s15, s15, 3
    s_add_u32 s15, s15, s3
    s_lshl_b32 s3, s15, 6
    s_add_u32 s64, s64, s3
    s_addc_u32 s65, s65, 0
    s_mov_b32 s66, 0
    s_mov_b32 s67, 0x20000
    s_add_u32 s68, s68, s3
    s_addc_u32 s69, s69, 0
    s_mov_b32 s70, 0
    s_mov_b32 s71, 0x20000
    s_sub_u32 s14, 5308416, s3
    s_mul_i32 s3, s15, 36864
    s_add_u32 s72, s72, s3
    s_addc_u32 s73, s73, 0
    s_mov_b32 s74, 0
    s_mov_b32 s75, 0x20000
    s_cmp_lt_u32 s2, 144
    s_cselect_b32 s66, s14, 0
    s_cselect_b32 s70, s14, 0
    s_cselect_b32 s74, 36864, 0
    s_mov_b32 s82, 2359296
    s_mov_b32 s83, 0x20000
    v_lshrrev_b32 v13, 4, v0
    v_lshlrev_b32 v9, 6, v13
    v_lshrrev_b32 v14, 2, v0
    v_mul_u32_u24 v14, 1056, v14
    v_add_u32 v14, 16384, v14
    v_and_b32 v15, 1, v0
    v_lshlrev_b32 v15, 4, v15
    v_add_u32 v3, v14, v15
    v_and_b32 v15, 2, v0
    v_lshl_add_u32 v3, v15, 2, v3
    v_add_u32 v4, 73728, v3
    v_lshrrev_b32 v14, 3, v0
    v_lshlrev_b32 v14, 2, v14
    v_add_u32 v14, v14, v12
    v_mul_u32_u24 v14, 4608, v14
    v_and_b32 v15, 7, v0
    v_lshl_add_u32 v7, v15, 4, v14
    v_lshlrev_b32 v10, 4, v15
    v_lshl_add_u32 v10, v13, 7, v10
    v_bfe_u32 v14, v0, 3, 1
    v_mul_u32_u24 v14, 147456, v14
    v_add_u32 v10, v10, v14
    v_lshrrev_b32 v14, 2, v0
    v_mul_u32_u24 v14, 1056, v14
    v_and_b32 v15, 3, v0
    v_lshl_add_u32 v14, v15, 3, v14
    v_add_u32 v2, 107008, v14
    v_and_b32 v14, 15, v0
    v_mul_u32_u24 v14, 1056, v14
    v_lshrrev_b32 v15, 4, v0
    v_lshl_add_u32 v14, v15, 4, v14
    v_add_u32 v1, 90112, v14
    v_and_b32 v14, 1, v0
    v_cmp_eq_u32 vcc, 0, v14
    v_mov_b32 v11, 0xeeeeeeee
    v_mov_b32 v15, 0x44444444
    v_cndmask_b32 v11, v11, v15, vcc
    v_and_b32 v14, 2, v0
    v_cmp_eq_u32 vcc, 0, v14
    v_mov_b32 v15, 0x3f803f80
    s_nop 0
    v_cndmask_b32 v15, 0, v15, vcc
    v_accvgpr_write_b32 a16, v15
    v_accvgpr_write_b32 a56, -1
    v_accvgpr_write_b32 a17, v15
    v_accvgpr_write_b32 a57, -1
    v_accvgpr_write_b32 a18, v15
    v_accvgpr_write_b32 a58, -1
    v_accvgpr_write_b32 a19, v15
    v_accvgpr_write_b32 a59, -1
    v_accvgpr_write_b32 a0, 0
    v_accvgpr_write_b32 a1, 0
    v_accvgpr_write_b32 a2, 0
    v_accvgpr_write_b32 a3, 0
    v_accvgpr_write_b32 a4, 0
    v_accvgpr_write_b32 a5, 0
    v_accvgpr_write_b32 a6, 0
    v_accvgpr_write_b32 a7, 0
    v_accvgpr_write_b32 a8, 0
    v_accvgpr_write_b32 a9, 0
    v_accvgpr_write_b32 a10, 0
    v_accvgpr_write_b32 a11, 0
    v_accvgpr_write_b32 a12, 0
    v_accvgpr_write_b32 a13, 0
    v_accvgpr_write_b32 a14, 0
    v_accvgpr_write_b32 a15, 0
    s_cmp_ge_u32 s2, 8
    s_cbranch_scc1 L2_noclr2
    s_mul_i32 s14, s2, 32
    s_mov_b64 exec, 1
    s_waitcnt vmcnt(6)
    s_barrier
    buffer_store_dword v60, v156, s[60:63], s14 offen sc1
    s_mov_b64 exec, -1
L2_noclr2:
    s_waitcnt vmcnt(6)
    v_lshlrev_b32 v24, 16, v64
    v_and_b32 v25, 0xffff0000, v64
    v_lshlrev_b32 v26, 16, v65
    v_and_b32 v27, 0xffff0000, v65
    v_lshlrev_b32 v28, 16, v66
    v_and_b32 v29, 0xffff0000, v66
    v_lshlrev_b32 v30, 16, v67
    v_and_b32 v31, 0xffff0000, v67
    v_lshlrev_b32 v32, 16, v68
    v_and_b32 v33, 0xffff0000, v68
    v_lshlrev_b32 v34, 16, v69
    v_and_b32 v35, 0xffff0000, v69
    v_lshlrev_b32 v36, 16, v70
    v_and_b32 v37, 0xffff0000, v70
    v_lshlrev_b32 v38, 16, v71
    v_and_b32 v39, 0xffff0000, v71
    v_lshlrev_b32 v40, 16, v72
    v_and_b32 v41, 0xffff0000, v72
    v_lshlrev_b32 v42, 16, v73
    v_and_b32 v43, 0xffff0000, v73
    v_lshlrev_b32 v44, 16, v74
    v_and_b32 v45, 0xffff0000, v74
    v_lshlrev_b32 v46, 16, v75
    v_and_b32 v47, 0xffff0000, v75
    v_pk_add_f32 v[12:13], v[24:25], v[26:27]
    v_pk_add_f32 v[12:13], v[12:13], v[28:29]
    v_pk_add_f32 v[12:13], v[12:13], v[30:31]
    v_pk_add_f32 v[12:13], v[12:13], v[32:33]
    v_pk_add_f32 v[12:13], v[12:13], v[34:35]
    v_pk_add_f32 v[12:13], v[12:13], v[36:37]
    v_pk_add_f32 v[12:13], v[12:13], v[38:39]
    v_pk_add_f32 v[14:15], v[40:41], v[42:43]
    v_pk_add_f32 v[14:15], v[14:15], v[44:45]
    v_pk_add_f32 v[14:15], v[14:15], v[46:47]
    v_add_f32 v48, v12, v13
    v_add_f32 v14, v14, v15
    v_fmac_f32 v48, 0x3e800000, v14
    s_nop 1
    v_add_f32_dpp v48, v48, v48 row_ror:8 row_mask:0xf bank_mask:0xf
    v_mov_b32 v50, v48
    s_nop 1
    v_permlane16_swap_b32 v50, v48
    v_add_f32 v48, v48, v50
    v_mov_b32 v50, v48
    s_nop 1
    v_permlane32_swap_b32 v50, v48
    v_add_f32 v48, v48, v50
    v_mul_f32 v48, 0x3be38e39, v48
    v_pk_add_f32 v[24:25], v[24:25], v[48:49] op_sel_hi:[1,0] neg_lo:[0,1] neg_hi:[0,1]
    v_pk_add_f32 v[26:27], v[26:27], v[48:49] op_sel_hi:[1,0] neg_lo:[0,1] neg_hi:[0,1]
    v_pk_add_f32 v[28:29], v[28:29], v[48:49] op_sel_hi:[1,0] neg_lo:[0,1] neg_hi:[0,1]
    v_pk_add_f32 v[30:31], v[30:31], v[48:49] op_sel_hi:[1,0] neg_lo:[0,1] neg_hi:[0,1]
    v_pk_add_f32 v[32:33], v[32:33], v[48:49] op_sel_hi:[1,0] neg_lo:[0,1] neg_hi:[0,1]
    v_pk_add_f32 v[34:35], v[34:35], v[48:49] op_sel_hi:[1,0] neg_lo:[0,1] neg_hi:[0,1]
    v_pk_add_f32 v[36:37], v[36:37], v[48:49] op_sel_hi:[1,0] neg_lo:[0,1] neg_hi:[0,1]
    v_pk_add_f32 v[38:39], v[38:39], v[48:49] op_sel_hi:[1,0] neg_lo:[0,1] neg_hi:[0,1]
    v_pk_add_f32 v[40:41], v[40:41], v[48:49] op_sel_hi:[1,0] neg_lo:[0,1] neg_hi:[0,1]
    v_pk_add_f32 v[42:43], v[42:43], v[48:49] op_sel_hi:[1,0] neg_lo:[0,1] neg_hi:[0,1]
    v_pk_add_f32 v[44:45], v[44:45], v[48:49] op_sel_hi:[1,0] neg_lo:[0,1] neg_hi:[0,1]
    v_pk_add_f32 v[46:47], v[46:47], v[48:49] op_sel_hi:[1,0] neg_lo:[0,1] neg_hi:[0,1]
    v_pk_mul_f32 v[12:13], v[24:25], v[24:25]
    v_pk_fma_f32 v[12:13], v[26:27], v[26:27], v[12:13]
    v_pk_fma_f32 v[12:13], v[28:29], v[28:29], v[12:13]
    v_pk_fma_f32 v[12:13], v[30:31], v[30:31], v[12:13]
    v_pk_fma_f32 v[12:13], v[32:33], v[32:33], v[12:13]
    v_pk_fma_f32 v[12:13], v[34:35], v[34:35], v[12:13]
    v_pk_fma_f32 v[12:13], v[36:37], v[36:37], v[12:13]
    v_pk_fma_f32 v[12:13], v[38:39], v[38:39], v[12:13]
    v_pk_mul_f32 v[14:15], v[40:41], v[40:41]
    v_pk_fma_f32 v[14:15], v[42:43], v[42:43], v[14:15]
    v_pk_fma_f32 v[14:15], v[44:45], v[44:45], v[14:15]
    v_pk_fma_f32 v[14:15], v[46:47], v[46:47], v[14:15]
    v_add_f32 v49, v12, v13
    v_add_f32 v14, v14, v15
    v_fmac_f32 v49, 0x3e800000, v14
    s_nop 1
    v_add_f32_dpp v49, v49, v49 row_ror:8 row_mask:0xf bank_mask:0xf
    v_mov_b32 v50, v49
    s_nop 1
    v_permlane16_swap_b32 v50, v49
    v_add_f32 v49, v49, v50
    v_mov_b32 v50, v49
    s_nop 1
    v_permlane32_swap_b32 v50, v49
    v_add_f32 v49, v49, v50
    ds_write_b32 v158, v48
    ds_write_b32 v158, v49 offset:128
    s_waitcnt lgkmcnt(0)
    s_barrier
    ds_read_b128 v[16:19], v157
    ds_read_b128 v[20:23], v157 offset:128
    s_add_u32 s14, s58, 4096
    s_waitcnt lgkmcnt(1)
    v_add_f32 v12, v16, v17
    v_add_f32 v13, v18, v19
    v_add_f32 v12, v12, v13
    v_mul_f32 v12, 0x3e800000, v12
    v_sub_f32 v16, v16, v12
    v_sub_f32 v17, v17, v12
    v_sub_f32 v18, v18, v12
    v_sub_f32 v19, v19, v12
    v_sub_f32 v48, v48, v12
    v_mul_f32 v13, v16, v16
    v_fmac_f32 v13, v17, v17
    v_fmac_f32 v13, v18, v18
    v_fmac_f32 v13, v19, v19
    s_waitcnt lgkmcnt(0)
    v_add_f32 v14, v20, v21
    v_add_f32 v15, v22, v23
    v_add_f32 v14, v14, v15
    v_fmac_f32 v14, 0x43100000, v13
    v_mov_b32 v12, 0x3727c5ac
    v_fmac_f32 v12, 0x3ae38e39, v14
    v_rsq_f32 v12, v12
    s_nop 0
    v_mul_f32 v48, v48, v12
    v_pk_fma_f32 v[24:25], v[24:25], v[12:13], v[48:49] op_sel_hi:[1,0,0]
    v_pk_fma_f32 v[26:27], v[26:27], v[12:13], v[48:49] op_sel_hi:[1,0,0]
    v_pk_fma_f32 v[28:29], v[28:29], v[12:13], v[48:49] op_sel_hi:[1,0,0]
    v_pk_fma_f32 v[30:31], v[30:31], v[12:13], v[48:49] op_sel_hi:[1,0,0]
    v_cvt_pk_f16_f32 v64, v24, v25
    v_cvt_pk_f16_f32 v65, v26, v27
    v_cvt_pk_f16_f32 v66, v28, v29
    v_cvt_pk_f16_f32 v67, v30, v31
    buffer_store_dwordx4 v[64:67], v159, s[84:87], s58 offen offset:0 sc1
    v_pk_fma_f32 v[32:33], v[32:33], v[12:13], v[48:49] op_sel_hi:[1,0,0]
    v_pk_fma_f32 v[34:35], v[34:35], v[12:13], v[48:49] op_sel_hi:[1,0,0]
    v_pk_fma_f32 v[36:37], v[36:37], v[12:13], v[48:49] op_sel_hi:[1,0,0]
    v_pk_fma_f32 v[38:39], v[38:39], v[12:13], v[48:49] op_sel_hi:[1,0,0]
    v_cvt_pk_f16_f32 v68, v32, v33
    v_cvt_pk_f16_f32 v69, v34, v35
    v_cvt_pk_f16_f32 v70, v36, v37
    v_cvt_pk_f16_f32 v71, v38, v39
    buffer_store_dwordx4 v[68:71], v159, s[84:87], s58 offen offset:2048 sc1
    v_pk_fma_f32 v[40:41], v[40:41], v[12:13], v[48:49] op_sel_hi:[1,0,0]
    v_pk_fma_f32 v[42:43], v[42:43], v[12:13], v[48:49] op_sel_hi:[1,0,0]
    v_pk_fma_f32 v[44:45], v[44:45], v[12:13], v[48:49] op_sel_hi:[1,0,0]
    v_pk_fma_f32 v[46:47], v[46:47], v[12:13], v[48:49] op_sel_hi:[1,0,0]
    v_cvt_pk_f16_f32 v72, v40, v41
    v_cvt_pk_f16_f32 v73, v42, v43
    v_cvt_pk_f16_f32 v74, v44, v45
    v_cvt_pk_f16_f32 v75, v46, v47
    s_mov_b64 exec, 0xffff
    buffer_store_dwordx4 v[72:75], v159, s[84:87], s14 offen offset:0 sc1
    buffer_store_dwordx4 v[56:59], v8, s[84:87], s56 offen sc1
    s_mov_b64 exec, 0xff
    buffer_store_dwordx4 v[60:63], v160, s[84:87], s57 offen offset:1024 sc1
    s_mov_b64 exec, -1
    buffer_store_dwordx4 v[60:63], v160, s[84:87], s57 offen sc1
    s_mov_b64 exec, 255
    buffer_load_dword v51, v156, s[60:63], 0 offen sc1
    s_mov_b64 exec, -1
    s_mul_i32 s3, s96, 147456
    s_add_u32 s3, s3, 8392704
    s_add_u32 s88, s12, s3
    s_addc_u32 s89, s13, 0
    s_mov_b32 s90, 143360
    s_mov_b32 s91, 0x20000
    s_waitcnt vmcnt(7)
    v_lshlrev_b32 v40, 16, v148
    v_and_b32 v41, 0xffff0000, v148
    v_lshlrev_b32 v42, 16, v149
    v_and_b32 v43, 0xffff0000, v149
    v_lshlrev_b32 v44, 16, v150
    v_mul_f32 v16, 0xbfb8aa3b, v40
    v_mul_f32 v17, 0xbfb8aa3b, v41
    v_mul_f32 v18, 0xbfb8aa3b, v42
    v_mul_f32 v19, 0xbfb8aa3b, v43
    v_mul_f32 v20, 0xbfb8aa3b, v44
    v_exp_f32 v16, v16
    v_exp_f32 v17, v17
    v_exp_f32 v18, v18
    v_exp_f32 v19, v19
    v_exp_f32 v20, v20
    v_add_f32 v16, 1.0, v16
    v_add_f32 v17, 1.0, v17
    v_add_f32 v18, 1.0, v18
    v_add_f32 v19, 1.0, v19
    v_add_f32 v20, 1.0, v20
    v_rcp_f32 v16, v16
    v_rcp_f32 v17, v17
    v_rcp_f32 v18, v18
    v_rcp_f32 v19, v19
    v_rcp_f32 v20, v20
    v_mul_f32 v24, v40, v16
    v_mul_f32 v26, v41, v17
    v_mul_f32 v28, v42, v18
    v_mul_f32 v30, v43, v19
    v_mul_f32 v32, v44, v20
    v_lshlrev_b32 v12, 16, v128
    v_and_b32 v13, 0xffff0000, v128
    v_pk_mul_f32 v[16:17], v[12:13], v[24:25] op_sel_hi:[1,0]
    v_lshlrev_b32 v14, 16, v129
    v_and_b32 v15, 0xffff0000, v129
    v_pk_mul_f32 v[18:19], v[14:15], v[24:25] op_sel_hi:[1,0]
    v_lshlrev_b32 v12, 16, v130
    v_and_b32 v13, 0xffff0000, v130
    v_pk_mul_f32 v[20:21], v[12:13], v[24:25] op_sel_hi:[1,0]
    v_lshlrev_b32 v14, 16, v131
    v_and_b32 v15, 0xffff0000, v131
    v_pk_mul_f32 v[22:23], v[14:15], v[24:25] op_sel_hi:[1,0]
    v_lshlrev_b32 v12, 16, v132
    v_and_b32 v13, 0xffff0000, v132
    v_pk_fma_f32 v[16:17], v[12:13], v[26:27], v[16:17] op_sel_hi:[1,0,1]
    v_lshlrev_b32 v14, 16, v133
    v_and_b32 v15, 0xffff0000, v133
    v_pk_fma_f32 v[18:19], v[14:15], v[26:27], v[18:19] op_sel_hi:[1,0,1]
    v_lshlrev_b32 v12, 16, v134
    v_and_b32 v13, 0xffff0000, v134
    v_pk_fma_f32 v[20:21], v[12:13], v[26:27], v[20:21] op_sel_hi:[1,0,1]
    v_lshlrev_b32 v14, 16, v135
    v_and_b32 v15, 0xffff0000, v135
    v_pk_fma_f32 v[22:23], v[14:15], v[26:27], v[22:23] op_sel_hi:[1,0,1]
    v_lshlrev_b32 v12, 16, v136
    v_and_b32 v13, 0xffff0000, v136
    v_pk_fma_f32 v[16:17], v[12:13], v[28:29], v[16:17] op_sel_hi:[1,0,1]
    v_lshlrev_b32 v14, 16, v137
    v_and_b32 v15, 0xffff0000, v137
    v_pk_fma_f32 v[18:19], v[14:15], v[28:29], v[18:19] op_sel_hi:[1,0,1]
    v_lshlrev_b32 v12, 16, v138
    v_and_b32 v13, 0xffff0000, v138
    v_pk_fma_f32 v[20:21], v[12:13], v[28:29], v[20:21] op_sel_hi:[1,0,1]
    v_lshlrev_b32 v14, 16, v139
    v_and_b32 v15, 0xffff0000, v139
    v_pk_fma_f32 v[22:23], v[14:15], v[28:29], v[22:23] op_sel_hi:[1,0,1]
    v_lshlrev_b32 v12, 16, v140
    v_and_b32 v13, 0xffff0000, v140
    v_pk_fma_f32 v[16:17], v[12:13], v[30:31], v[16:17] op_sel_hi:[1,0,1]
    v_lshlrev_b32 v14, 16, v141
    v_and_b32 v15, 0xffff0000, v141
    v_pk_fma_f32 v[18:19], v[14:15], v[30:31], v[18:19] op_sel_hi:[1,0,1]
    v_lshlrev_b32 v12, 16, v142
    v_and_b32 v13, 0xffff0000, v142
    v_pk_fma_f32 v[20:21], v[12:13], v[30:31], v[20:21] op_sel_hi:[1,0,1]
    v_lshlrev_b32 v14, 16, v143
    v_and_b32 v15, 0xffff0000, v143
    v_pk_fma_f32 v[22:23], v[14:15], v[30:31], v[22:23] op_sel_hi:[1,0,1]
    v_lshlrev_b32 v12, 16, v144
    v_and_b32 v13, 0xffff0000, v144
    v_pk_fma_f32 v[16:17], v[12:13], v[32:33], v[16:17] op_sel_hi:[1,0,1]
    v_lshlrev_b32 v14, 16, v145
    v_and_b32 v15, 0xffff0000, v145
    v_pk_fma_f32 v[18:19], v[14:15], v[32:33], v[18:19] op_sel_hi:[1,0,1]
    v_lshlrev_b32 v12, 16, v146
    v_and_b32 v13, 0xffff0000, v146
    v_pk_fma_f32 v[20:21], v[12:13], v[32:33], v[20:21] op_sel_hi:[1,0,1]
    v_lshlrev_b32 v14, 16, v147
    v_and_b32 v15, 0xffff0000, v147
    v_pk_fma_f32 v[22:23], v[14:15], v[32:33], v[22:23] op_sel_hi:[1,0,1]
    v_add_f32_dpp v16, v16, v16 row_ror:4 row_mask:0xf bank_mask:0xf
    v_add_f32_dpp v17, v17, v17 row_ror:4 row_mask:0xf bank_mask:0xf
    v_add_f32_dpp v18, v18, v18 row_ror:4 row_mask:0xf bank_mask:0xf
    v_add_f32_dpp v19, v19, v19 row_ror:4 row_mask:0xf bank_mask:0xf
    v_add_f32_dpp v20, v20, v20 row_ror:4 row_mask:0xf bank_mask:0xf
    v_add_f32_dpp v21, v21, v21 row_ror:4 row_mask:0xf bank_mask:0xf
    v_add_f32_dpp v22, v22, v22 row_ror:4 row_mask:0xf bank_mask:0xf
    v_add_f32_dpp v23, v23, v23 row_ror:4 row_mask:0xf bank_mask:0xf
    v_add_f32_dpp v16, v16, v16 row_ror:8 row_mask:0xf bank_mask:0xf
    v_add_f32_dpp v17, v17, v17 row_ror:8 row_mask:0xf bank_mask:0xf
    v_add_f32_dpp v18, v18, v18 row_ror:8 row_mask:0xf bank_mask:0xf
    v_add_f32_dpp v19, v19, v19 row_ror:8 row_mask:0xf bank_mask:0xf
    v_add_f32_dpp v20, v20, v20 row_ror:8 row_mask:0xf bank_mask:0xf
    v_add_f32_dpp v21, v21, v21 row_ror:8 row_mask:0xf bank_mask:0xf
    v_add_f32_dpp v22, v22, v22 row_ror:8 row_mask:0xf bank_mask:0xf
    v_add_f32_dpp v23, v23, v23 row_ror:8 row_mask:0xf bank_mask:0xf
    s_mov_b32 exec_lo, 0xf000f
    s_mov_b32 exec_hi, 0xf000f
    ds_write_b128 v161, v[16:19] offset:16384
    ds_write_b128 v161, v[20:23] offset:16400
    s_mov_b64 exec, 255
    s_waitcnt vmcnt(0)
    v_cmp_eq_u32 vcc, s51, v51
    s_nop 0
    s_cmp_lg_u64 vcc, 0
    s_cbranch_scc1 L2_p0s
L2_p0r:
    s_mov_b64 exec, 1
    s_waitcnt lgkmcnt(0)
    s_barrier
    buffer_store_dword v60, v156, s[84:87], s101 offen sc1
    s_mov_b64 exec, -1
    ds_read_b32 v24, v162 offset:16384
    ds_read_b32 v25, v162 offset:16640
    ds_read_b32 v26, v162 offset:16896
    ds_read_b32 v27, v162 offset:17152
    ds_read_b32 v28, v162 offset:17408
    ds_read_b32 v29, v162 offset:17664
    ds_read_b32 v30, v162 offset:17920
    ds_read_b32 v31, v162 offset:18176
    s_waitcnt lgkmcnt(0)
    v_pk_add_f32 v[24:25], v[24:25], v[26:27]
    v_pk_add_f32 v[28:29], v[28:29], v[30:31]
    v_pk_add_f32 v[24:25], v[24:25], v[28:29]
    v_add_f32 v52, v24, v25
    v_mov_b32 v53, v52
    v_mov_b32 v54, s48
    s_nop 0
    v_permlane32_swap_b32 v53, v52
    v_add_f32 v52, v52, v53
    v_fma_f32 v52, v52, s47, v54
    v_min_u32 v52, -2, v52
    s_mov_b32 exec_hi, 0
    buffer_store_dword v52, v164, s[84:87], s100 offen sc1
    s_mov_b64 exec, -1
    s_add_u32 m0, s44, 36864
    s_mov_b32 s45, 0
    buffer_load_dwordx4 v6, s[24:27], s45 offen lds
    s_add_u32 m0, s44, 37920
    s_mov_b32 s45, 8192
    buffer_load_dwordx4 v6, s[24:27], s45 offen lds
    s_add_u32 m0, s44, 38976
    s_mov_b32 s45, 16384
    buffer_load_dwordx4 v6, s[24:27], s45 offen lds
    s_add_u32 m0, s44, 40032
    s_mov_b32 s45, 24576
    buffer_load_dwordx4 v6, s[24:27], s45 offen lds
    s_add_u32 m0, s44, 53760
    s_mov_b32 s45, 262144
    buffer_load_dwordx4 v6, s[24:27], s45 offen lds
    s_add_u32 m0, s44, 54816
    s_mov_b32 s45, 270336
    buffer_load_dwordx4 v6, s[24:27], s45 offen lds
    s_add_u32 m0, s44, 55872
    s_mov_b32 s45, 278528
    buffer_load_dwordx4 v6, s[24:27], s45 offen lds
    s_add_u32 m0, s44, 56928
    s_mov_b32 s45, 286720
    buffer_load_dwordx4 v6, s[24:27], s45 offen lds
    s_add_u32 m0, s44, 73728
    s_mov_b32 s45, 524288
    buffer_load_dwordx4 v6, s[24:27], s45 offen lds
    s_add_u32 m0, s44, 74784
    s_mov_b32 s45, 532480
    buffer_load_dwordx4 v6, s[24:27], s45 offen lds
    s_add_u32 m0, s44, 75840
    s_mov_b32 s45, 540672
    buffer_load_dwordx4 v6, s[24:27], s45 offen lds
    s_add_u32 m0, s44, 76896
    s_mov_b32 s45, 548864
    buffer_load_dwordx4 v6, s[24:27], s45 offen lds
    s_add_u32 m0, s44, 90624
    s_mov_b32 s45, 786432
    buffer_load_dwordx4 v6, s[24:27], s45 offen lds
    s_add_u32 m0, s44, 91680
    s_mov_b32 s45, 794624
    buffer_load_dwordx4 v6, s[24:27], s45 offen lds
    s_add_u32 m0, s44, 92736
    s_mov_b32 s45, 802816
    buffer_load_dwordx4 v6, s[24:27], s45 offen lds
    s_add_u32 m0, s44, 93792
    s_mov_b32 s45, 811008
    buffer_load_dwordx4 v6, s[24:27], s45 offen lds
    s_mov_b64 exec, 0
    s_cmp_eq_u32 s51, 0
    s_cbranch_scc1 L2_pad0
    s_cmp_eq_u32 s51, 1
    s_cbranch_scc1 L2_pad1
    s_cmp_eq_u32 s51, 2
    s_cbranch_scc1 L2_pad2
    s_branch L2_pad3
.p2align 12
L2_walkret:
    s_mov_b64 exec, 15
    s_mov_b32 s97, 0x20000
L2_px:
    buffer_load_dword v13, v163, s[84:87], s59 offen sc1
    s_waitcnt vmcnt(0)
    v_cmp_eq_u32 vcc, 0, v13
    s_sub_u32 s97, s97, 1
    s_cselect_b64 vcc, 0, vcc
    s_cmp_eq_u64 vcc, 0
    s_cbranch_scc1 L2_px_ok
    s_sleep 1
    s_branch L2_px
L2_px_ok:
    s_mov_b64 exec, -1
    s_movk_i32 s14, 13824
    buffer_load_dwordx4 v[168:171], v166, s[84:87], 0 offen sc1
    buffer_load_dwordx4 v[176:179], v166, s[84:87], s14 offen sc1
    s_mov_b64 exec, 0xff
    buffer_load_dwordx4 v[172:175], v166, s[84:87], 0 offen offset:1024 sc1
    buffer_load_dwordx4 v[180:183], v166, s[84:87], s14 offen offset:1024 sc1
    s_mov_b64 exec, -1
    s_mov_b32 s54, 0
    buffer_load_dwordx4 v[80:83], v8, s[32:35], s54 offen sc1
    s_mov_b32 s54, 1024
    buffer_load_dwordx4 v[84:87], v8, s[32:35], s54 offen sc1
    s_mov_b32 s54, 18432
    buffer_load_dwordx4 v[88:91], v8, s[32:35], s54 offen sc1
    s_mov_b32 s54, 19456
    buffer_load_dwordx4 v[92:95], v8, s[32:35], s54 offen sc1
    s_mov_b32 s54, 2048
    buffer_load_dwordx4 v[96:99], v8, s[32:35], s54 offen sc1
    s_mov_b32 s54, 3072
    buffer_load_dwordx4 v[100:103], v8, s[32:35], s54 offen sc1
    s_mov_b32 s54, 20480
    buffer_load_dwordx4 v[104:107], v8, s[32:35], s54 offen sc1
    s_mov_b32 s54, 21504
    buffer_load_dwordx4 v[108:111], v8, s[32:35], s54 offen sc1
    s_waitcnt vmcnt(8)
    v_max_u32 v13, v168, v169
    v_max3_u32 v13, v13, v170, v171
    v_max3_u32 v13, v13, v172, v173
    v_max3_u32 v13, v13, v174, v175
    v_max3_u32 v13, v13, v176, v177
    v_max3_u32 v13, v13, v178, v179
    v_max3_u32 v13, v13, v180, v181
    v_max3_u32 v13, v13, v182, v183
    v_cmp_eq_u32 vcc, -1, v13
    s_nop 0
    s_cmp_lg_u64 vcc, 0
    s_cbranch_scc1 L2_pms
L2_pmr:
    v_pk_add_f32 v[168:169], v[168:169], v[176:177]
    v_pk_add_f32 v[170:171], v[170:171], v[178:179]
    v_pk_add_f32 v[172:173], v[172:173], v[180:181]
    v_pk_add_f32 v[174:175], v[174:175], v[182:183]
    ds_write_b128 v167, v[168:171]
    s_mov_b64 exec, 0xff
    ds_write_b128 v167, v[172:175] offset:2048
    s_mov_b64 exec, -1
    s_mov_b32 s54, 4096
    buffer_load_dwordx4 v[112:115], v8, s[32:35], s54 offen sc1
    s_mov_b32 s54, 5120
    buffer_load_dwordx4 v[116:119], v8, s[32:35], s54 offen sc1
    s_mov_b32 s54, 22528
    buffer_load_dwordx4 v[120:123], v8, s[32:35], s54 offen sc1
    s_mov_b32 s54, 23552
    buffer_load_dwordx4 v[124:127], v8, s[32:35], s54 offen sc1
    s_waitcnt lgkmcnt(0)
    s_barrier
    ds_read_b128 v[16:19], v9 offset:9216
    ds_read_b128 v[20:23], v9 offset:9248
    ds_read_b128 v[24:27], v9 offset:9232
    ds_read_b128 v[28:31], v9 offset:9264
    s_waitcnt vmcnt(8)
    s_waitcnt lgkmcnt(2)
    v_fma_mix_f32 v32, v80, v16, v20 op_sel:[0,0,0] op_sel_hi:[1,0,0]
    v_fma_mix_f32 v33, v80, v17, v21 op_sel:[1,0,0] op_sel_hi:[1,0,0]
    v_fma_mix_f32 v34, v81, v18, v22 op_sel:[0,0,0] op_sel_hi:[1,0,0]
    v_fma_mix_f32 v35, v81, v19, v23 op_sel:[1,0,0] op_sel_hi:[1,0,0]
    v_cvt_pk_bf16_f32 v80, v32, v33
    v_cvt_pk_bf16_f32 v81, v34, v35
    v_fma_mix_f32 v36, v88, v16, v20 op_sel:[0,0,0] op_sel_hi:[1,0,0]
    v_fma_mix_f32 v37, v88, v17, v21 op_sel:[1,0,0] op_sel_hi:[1,0,0]
    v_fma_mix_f32 v38, v89, v18, v22 op_sel:[0,0,0] op_sel_hi:[1,0,0]
    v_fma_mix_f32 v39, v89, v19, v23 op_sel:[1,0,0] op_sel_hi:[1,0,0]
    v_cvt_pk_bf16_f32 v88, v36, v37
    v_cvt_pk_bf16_f32 v89, v38, v39
    ds_read_b128 v[16:19], v9 offset:9472
    ds_read_b128 v[20:23], v9 offset:9504
    s_waitcnt lgkmcnt(2)
    v_fma_mix_f32 v32, v82, v24, v28 op_sel:[0,0,0] op_sel_hi:[1,0,0]
    v_fma_mix_f32 v33, v82, v25, v29 op_sel:[1,0,0] op_sel_hi:[1,0,0]
    v_fma_mix_f32 v34, v83, v26, v30 op_sel:[0,0,0] op_sel_hi:[1,0,0]
    v_fma_mix_f32 v35, v83, v27, v31 op_sel:[1,0,0] op_sel_hi:[1,0,0]
    v_cvt_pk_bf16_f32 v82, v32, v33
    v_cvt_pk_bf16_f32 v83, v34, v35
    v_fma_mix_f32 v36, v90, v24, v28 op_sel:[0,0,0] op_sel_hi:[1,0,0]
    v_fma_mix_f32 v37, v90, v25, v29 op_sel:[1,0,0] op_sel_hi:[1,0,0]
    v_fma_mix_f32 v38, v91, v26, v30 op_sel:[0,0,0] op_sel_hi:[1,0,0]
    v_fma_mix_f32 v39, v91, v27, v31 op_sel:[1,0,0] op_sel_hi:[1,0,0]
    v_cvt_pk_bf16_f32 v90, v36, v37
    v_cvt_pk_bf16_f32 v91, v38, v39
    ds_read_b128 v[24:27], v9 offset:9488
    ds_read_b128 v[28:31], v9 offset:9520
    s_waitcnt lgkmcnt(2)
    v_fma_mix_f32 v32, v84, v16, v20 op_sel:[0,0,0] op_sel_hi:[1,0,0]
    v_fma_mix_f32 v33, v84, v17, v21 op_sel:[1,0,0] op_sel_hi:[1,0,0]
    v_fma_mix_f32 v34, v85, v18, v22 op_sel:[0,0,0] op_sel_hi:[1,0,0]
    v_fma_mix_f32 v35, v85, v19, v23 op_sel:[1,0,0] op_sel_hi:[1,0,0]
    v_cvt_pk_bf16_f32 v84, v32, v33
    v_cvt_pk_bf16_f32 v85, v34, v35
    v_fma_mix_f32 v36, v92, v16, v20 op_sel:[0,0,0] op_sel_hi:[1,0,0]
    v_fma_mix_f32 v37, v92, v17, v21 op_sel:[1,0,0] op_sel_hi:[1,0,0]
    v_fma_mix_f32 v38, v93, v18, v22 op_sel:[0,0,0] op_sel_hi:[1,0,0]
    v_fma_mix_f32 v39, v93, v19, v23 op_sel:[1,0,0] op_sel_hi:[1,0,0]
    v_cvt_pk_bf16_f32 v92, v36, v37
    v_cvt_pk_bf16_f32 v93, v38, v39
    ds_read_b128 v[16:19], v9 offset:9728
    ds_read_b128 v[20:23], v9 offset:9760
    ds_read_b64_tr_b16 a[192:193], v3 offset:36864
    ds_read_b64_tr_b16 a[194:195], v3 offset:37376
    ds_read_b64_tr_b16 a[196:197], v3 offset:53760
    ds_read_b64_tr_b16 a[198:199], v3 offset:54272
    ds_read_b64_tr_b16 a[200:201], v3 offset:36896
    ds_read_b64_tr_b16 a[202:203], v3 offset:37408
    ds_read_b64_tr_b16 a[204:205], v3 offset:53792
    ds_read_b64_tr_b16 a[206:207], v3 offset:54304
    ds_read_b64_tr_b16 a[208:209], v3 offset:36928
    ds_read_b64_tr_b16 a[210:211], v3 offset:37440
    ds_read_b64_tr_b16 a[212:213], v3 offset:53824
    ds_read_b64_tr_b16 a[214:215], v3 offset:54336
    s_waitcnt lgkmcnt(14)
    v_fma_mix_f32 v32, v86, v24, v28 op_sel:[0,0,0] op_sel_hi:[1,0,0]
    v_fma_mix_f32 v33, v86, v25, v29 op_sel:[1,0,0] op_sel_hi:[1,0,0]
    v_fma_mix_f32 v34, v87, v26, v30 op_sel:[0,0,0] op_sel_hi:[1,0,0]
    v_fma_mix_f32 v35, v87, v27, v31 op_sel:[1,0,0] op_sel_hi:[1,0,0]
    v_cvt_pk_bf16_f32 v86, v32, v33
    v_cvt_pk_bf16_f32 v87, v34, v35
    v_fma_mix_f32 v36, v94, v24, v28 op_sel:[0,0,0] op_sel_hi:[1,0,0]
    v_fma_mix_f32 v37, v94, v25, v29 op_sel:[1,0,0] op_sel_hi:[1,0,0]
    v_fma_mix_f32 v38, v95, v26, v30 op_sel:[0,0,0] op_sel_hi:[1,0,0]
    v_fma_mix_f32 v39, v95, v27, v31 op_sel:[1,0,0] op_sel_hi:[1,0,0]
    v_cvt_pk_bf16_f32 v94, v36, v37
    v_cvt_pk_bf16_f32 v95, v38, v39
    s_waitcnt lgkmcnt(8)
    v_mfma_f32_16x16x32_bf16 v[128:131], a[192:195], v[80:83], 0
    s_waitcnt vmcnt(4)
    ds_read_b64_tr_b16 a[216:217], v3 offset:36960
    ds_read_b128 v[24:27], v9 offset:9744
    v_mfma_f32_16x16x32_bf16 v[128:131], a[196:199], v[84:87], v[128:131]
    ds_read_b64_tr_b16 a[218:219], v3 offset:37472
    ds_read_b64_tr_b16 a[220:221], v3 offset:53856
    v_fma_mix_f32 v32, v96, v16, v20 op_sel:[0,0,0] op_sel_hi:[1,0,0]
    v_mfma_f32_16x16x32_bf16 v[160:163], a[192:195], v[88:91], 0
    s_add_u32 m0, s44, 110592
    ds_read_b64_tr_b16 a[222:223], v3 offset:54368
    ds_read_b128 v[28:31], v9 offset:9776
    v_mfma_f32_16x16x32_bf16 v[160:163], a[196:199], v[92:95], v[160:163]
    s_mov_b32 s45, 1048576
    s_waitcnt lgkmcnt(10)
    buffer_load_dwordx4 v6, s[24:27], s45 offen lds
    v_mfma_f32_16x16x32_bf16 v[132:135], a[200:203], v[80:83], 0
    ds_read_b64_tr_b16 a[224:225], v3 offset:36992
    v_fma_mix_f32 v33, v96, v17, v21 op_sel:[1,0,0] op_sel_hi:[1,0,0]
    v_mfma_f32_16x16x32_bf16 v[132:135], a[204:207], v[84:87], v[132:135]
    ds_read_b64_tr_b16 a[226:227], v3 offset:37504
    ds_read_b64_tr_b16 a[228:229], v3 offset:53888
    v_fma_mix_f32 v34, v97, v18, v22 op_sel:[0,0,0] op_sel_hi:[1,0,0]
    v_mfma_f32_16x16x32_bf16 v[164:167], a[200:203], v[88:91], 0
    s_add_u32 m0, s44, 111648
    ds_read_b64_tr_b16 a[230:231], v3 offset:54400
    v_fma_mix_f32 v35, v97, v19, v23 op_sel:[1,0,0] op_sel_hi:[1,0,0]
    v_mfma_f32_16x16x32_bf16 v[164:167], a[204:207], v[92:95], v[164:167]
    s_mov_b32 s45, 1056768
    s_waitcnt lgkmcnt(10)
    buffer_load_dwordx4 v6, s[24:27], s45 offen lds
    v_mfma_f32_16x16x32_bf16 v[136:139], a[208:211], v[80:83], 0
    ds_read_b64_tr_b16 a[232:233], v3 offset:37024
    v_cvt_pk_bf16_f32 v96, v32, v33
    v_mfma_f32_16x16x32_bf16 v[136:139], a[212:215], v[84:87], v[136:139]
    ds_read_b64_tr_b16 a[234:235], v3 offset:37536
    ds_read_b64_tr_b16 a[236:237], v3 offset:53920
    v_cvt_pk_bf16_f32 v97, v34, v35
    v_mfma_f32_16x16x32_bf16 v[168:171], a[208:211], v[88:91], 0
    s_add_u32 m0, s44, 112704
    ds_read_b64_tr_b16 a[238:239], v3 offset:54432
    v_fma_mix_f32 v36, v104, v16, v20 op_sel:[0,0,0] op_sel_hi:[1,0,0]
    v_mfma_f32_16x16x32_bf16 v[168:171], a[212:215], v[92:95], v[168:171]
    s_mov_b32 s45, 1064960
    s_waitcnt lgkmcnt(9)
    buffer_load_dwordx4 v6, s[24:27], s45 offen lds
    v_fma_mix_f32 v37, v104, v17, v21 op_sel:[1,0,0] op_sel_hi:[1,0,0]
    v_mfma_f32_16x16x32_bf16 v[140:143], a[216:219], v[80:83], 0
    ds_read_b64_tr_b16 a[240:241], v3 offset:37056
    v_fma_mix_f32 v38, v105, v18, v22 op_sel:[0,0,0] op_sel_hi:[1,0,0]
    v_mfma_f32_16x16x32_bf16 v[140:143], a[220:223], v[84:87], v[140:143]
    ds_read_b64_tr_b16 a[242:243], v3 offset:37568
    ds_read_b64_tr_b16 a[244:245], v3 offset:53952
    v_fma_mix_f32 v39, v105, v19, v23 op_sel:[1,0,0] op_sel_hi:[1,0,0]
    v_mfma_f32_16x16x32_bf16 v[172:175], a[216:219], v[88:91], 0
    s_add_u32 m0, s44, 113760
    ds_read_b64_tr_b16 a[246:247], v3 offset:54464
    v_cvt_pk_bf16_f32 v104, v36, v37
    v_mfma_f32_16x16x32_bf16 v[172:175], a[220:223], v[92:95], v[172:175]
    s_mov_b32 s45, 1073152
    s_waitcnt lgkmcnt(8)
    buffer_load_dwordx4 v6, s[24:27], s45 offen lds
    v_cvt_pk_bf16_f32 v105, v38, v39
    v_mfma_f32_16x16x32_bf16 v[144:147], a[224:227], v[80:83], 0
    ds_read_b64_tr_b16 a[248:249], v3 offset:37088
    ds_read_b128 v[16:19], v9 offset:9984
    v_mfma_f32_16x16x32_bf16 v[144:147], a[228:231], v[84:87], v[144:147]
    ds_read_b64_tr_b16 a[250:251], v3 offset:37600
    ds_read_b64_tr_b16 a[252:253], v3 offset:53984
    v_fma_mix_f32 v32, v98, v24, v28 op_sel:[0,0,0] op_sel_hi:[1,0,0]
    v_mfma_f32_16x16x32_bf16 v[176:179], a[224:227], v[88:91], 0
    s_add_u32 m0, s44, 127488
    ds_read_b64_tr_b16 a[254:255], v3 offset:54496
    ds_read_b128 v[20:23], v9 offset:10016
    v_mfma_f32_16x16x32_bf16 v[176:179], a[228:231], v[92:95], v[176:179]
    s_mov_b32 s45, 1310720
    s_waitcnt lgkmcnt(10)
    buffer_load_dwordx4 v6, s[24:27], s45 offen lds
    v_mfma_f32_16x16x32_bf16 v[148:151], a[232:235], v[80:83], 0
    ds_read_b64_tr_b16 a[192:193], v3 offset:37120
    v_fma_mix_f32 v33, v98, v25, v29 op_sel:[1,0,0] op_sel_hi:[1,0,0]
    v_mfma_f32_16x16x32_bf16 v[148:151], a[236:239], v[84:87], v[148:151]
    ds_read_b64_tr_b16 a[194:195], v3 offset:37632
    ds_read_b64_tr_b16 a[196:197], v3 offset:54016
    v_fma_mix_f32 v34, v99, v26, v30 op_sel:[0,0,0] op_sel_hi:[1,0,0]
    v_mfma_f32_16x16x32_bf16 v[180:183], a[232:235], v[88:91], 0
    s_add_u32 m0, s44, 128544
    ds_read_b64_tr_b16 a[198:199], v3 offset:54528
    v_fma_mix_f32 v35, v99, v27, v31 op_sel:[1,0,0] op_sel_hi:[1,0,0]
    v_mfma_f32_16x16x32_bf16 v[180:183], a[236:239], v[92:95], v[180:183]
    s_mov_b32 s45, 1318912
    s_waitcnt lgkmcnt(10)
    buffer_load_dwordx4 v6, s[24:27], s45 offen lds
    v_mfma_f32_16x16x32_bf16 v[152:155], a[240:243], v[80:83], 0
    ds_read_b64_tr_b16 a[200:201], v3 offset:37152
    v_cvt_pk_bf16_f32 v98, v32, v33
    v_mfma_f32_16x16x32_bf16 v[152:155], a[244:247], v[84:87], v[152:155]
    ds_read_b64_tr_b16 a[202:203], v3 offset:37664
    ds_read_b64_tr_b16 a[204:205], v3 offset:54048
    v_cvt_pk_bf16_f32 v99, v34, v35
    v_mfma_f32_16x16x32_bf16 v[184:187], a[240:243], v[88:91], 0
    s_add_u32 m0, s44, 129600
    ds_read_b64_tr_b16 a[206:207], v3 offset:54560
    v_fma_mix_f32 v36, v106, v24, v28 op_sel:[0,0,0] op_sel_hi:[1,0,0]
    v_mfma_f32_16x16x32_bf16 v[184:187], a[244:247], v[92:95], v[184:187]
    s_mov_b32 s45, 1327104
    s_waitcnt lgkmcnt(9)
    buffer_load_dwordx4 v6, s[24:27], s45 offen lds
    v_fma_mix_f32 v37, v106, v25, v29 op_sel:[1,0,0] op_sel_hi:[1,0,0]
    v_mfma_f32_16x16x32_bf16 v[156:159], a[248:251], v[80:83], 0
    ds_read_b64_tr_b16 a[208:209], v3 offset:37184
    v_fma_mix_f32 v38, v107, v26, v30 op_sel:[0,0,0] op_sel_hi:[1,0,0]
    v_mfma_f32_16x16x32_bf16 v[156:159], a[252:255], v[84:87], v[156:159]
    ds_read_b64_tr_b16 a[210:211], v3 offset:37696
    ds_read_b64_tr_b16 a[212:213], v3 offset:54080
    v_fma_mix_f32 v39, v107, v27, v31 op_sel:[1,0,0] op_sel_hi:[1,0,0]
    v_mfma_f32_16x16x32_bf16 v[188:191], a[248:251], v[88:91], 0
    s_add_u32 m0, s44, 130656
    ds_read_b64_tr_b16 a[214:215], v3 offset:54592
    v_cvt_pk_bf16_f32 v106, v36, v37
    v_mfma_f32_16x16x32_bf16 v[188:191], a[252:255], v[92:95], v[188:191]
    s_mov_b32 s45, 1335296
    s_waitcnt lgkmcnt(8)
    buffer_load_dwordx4 v6, s[24:27], s45 offen lds
    v_cvt_pk_bf16_f32 v107, v38, v39
    v_mfma_f32_16x16x32_bf16 v[192:195], a[192:195], v[80:83], 0
    ds_read_b64_tr_b16 a[216:217], v3 offset:37216
    ds_read_b128 v[24:27], v9 offset:10000
    v_mfma_f32_16x16x32_bf16 v[192:195], a[196:199], v[84:87], v[192:195]
    ds_read_b64_tr_b16 a[218:219], v3 offset:37728
    ds_read_b64_tr_b16 a[220:221], v3 offset:54112
    v_fma_mix_f32 v32, v100, v16, v20 op_sel:[0,0,0] op_sel_hi:[1,0,0]
    v_mfma_f32_16x16x32_bf16 v[224:227], a[192:195], v[88:91], 0
    s_mov_b32 s54, 6144
    ds_read_b64_tr_b16 a[222:223], v3 offset:54624
    ds_read_b128 v[28:31], v9 offset:10032
    v_mfma_f32_16x16x32_bf16 v[224:227], a[196:199], v[92:95], v[224:227]
    s_waitcnt lgkmcnt(10)
    buffer_load_dwordx4 v[48:51], v8, s[32:35], s54 offen sc1
    v_mfma_f32_16x16x32_bf16 v[196:199], a[200:203], v[80:83], 0
    ds_read_b64_tr_b16 a[224:225], v3 offset:37248
    v_fma_mix_f32 v33, v100, v17, v21 op_sel:[1,0,0] op_sel_hi:[1,0,0]
    v_mfma_f32_16x16x32_bf16 v[196:199], a[204:207], v[84:87], v[196:199]
    ds_read_b64_tr_b16 a[226:227], v3 offset:37760
    ds_read_b64_tr_b16 a[228:229], v3 offset:54144
    v_fma_mix_f32 v34, v101, v18, v22 op_sel:[0,0,0] op_sel_hi:[1,0,0]
    v_mfma_f32_16x16x32_bf16 v[228:231], a[200:203], v[88:91], 0
    s_mov_b32 s54, 7168
    ds_read_b64_tr_b16 a[230:231], v3 offset:54656
    v_fma_mix_f32 v35, v101, v19, v23 op_sel:[1,0,0] op_sel_hi:[1,0,0]
    v_mfma_f32_16x16x32_bf16 v[228:231], a[204:207], v[92:95], v[228:231]
    s_waitcnt lgkmcnt(10)
    buffer_load_dwordx4 v[52:55], v8, s[32:35], s54 offen sc1
    v_mfma_f32_16x16x32_bf16 v[200:203], a[208:211], v[80:83], 0
    ds_read_b64_tr_b16 a[232:233], v3 offset:37280
    v_cvt_pk_bf16_f32 v100, v32, v33
    v_mfma_f32_16x16x32_bf16 v[200:203], a[212:215], v[84:87], v[200:203]
    ds_read_b64_tr_b16 a[234:235], v3 offset:37792
    ds_read_b64_tr_b16 a[236:237], v3 offset:54176
    v_cvt_pk_bf16_f32 v101, v34, v35
    v_mfma_f32_16x16x32_bf16 v[232:235], a[208:211], v[88:91], 0
    s_mov_b32 s54, 24576
    ds_read_b64_tr_b16 a[238:239], v3 offset:54688
    v_fma_mix_f32 v36, v108, v16, v20 op_sel:[0,0,0] op_sel_hi:[1,0,0]
    v_mfma_f32_16x16x32_bf16 v[232:235], a[212:215], v[92:95], v[232:235]
    s_waitcnt lgkmcnt(9)
    buffer_load_dwordx4 v[56:59], v8, s[32:35], s54 offen sc1
    v_fma_mix_f32 v37, v108, v17, v21 op_sel:[1,0,0] op_sel_hi:[1,0,0]
    v_mfma_f32_16x16x32_bf16 v[204:207], a[216:219], v[80:83], 0
    ds_read_b64_tr_b16 a[240:241], v3 offset:37312
    v_fma_mix_f32 v38, v109, v18, v22 op_sel:[0,0,0] op_sel_hi:[1,0,0]
    v_mfma_f32_16x16x32_bf16 v[204:207], a[220:223], v[84:87], v[204:207]
    ds_read_b64_tr_b16 a[242:243], v3 offset:37824
    ds_read_b64_tr_b16 a[244:245], v3 offset:54208
    v_fma_mix_f32 v39, v109, v19, v23 op_sel:[1,0,0] op_sel_hi:[1,0,0]
    v_mfma_f32_16x16x32_bf16 v[236:239], a[216:219], v[88:91], 0
    s_mov_b32 s54, 25600
    ds_read_b64_tr_b16 a[246:247], v3 offset:54720
    v_cvt_pk_bf16_f32 v108, v36, v37
    v_mfma_f32_16x16x32_bf16 v[236:239], a[220:223], v[92:95], v[236:239]
    s_waitcnt lgkmcnt(8)
    buffer_load_dwordx4 v[60:63], v8, s[32:35], s54 offen sc1
    v_cvt_pk_bf16_f32 v109, v38, v39
    v_mfma_f32_16x16x32_bf16 v[208:211], a[224:227], v[80:83], 0
    ds_read_b64_tr_b16 a[248:249], v3 offset:37344
    ds_read_b128 v[16:19], v9 offset:10240
    v_mfma_f32_16x16x32_bf16 v[208:211], a[228:231], v[84:87], v[208:211]
    ds_read_b64_tr_b16 a[250:251], v3 offset:37856
    ds_read_b128 v[20:23], v9 offset:10272
    v_mfma_f32_16x16x32_bf16 v[240:243], a[224:227], v[88:91], 0
    ds_read_b64_tr_b16 a[252:253], v3 offset:54240
    v_fma_mix_f32 v32, v102, v24, v28 op_sel:[0,0,0] op_sel_hi:[1,0,0]
    v_mfma_f32_16x16x32_bf16 v[240:243], a[228:231], v[92:95], v[240:243]
    s_barrier
    s_waitcnt lgkmcnt(9)
    ds_read_b64_tr_b16 a[254:255], v3 offset:54752
    v_fma_mix_f32 v33, v102, v25, v29 op_sel:[1,0,0] op_sel_hi:[1,0,0]
    v_fma_mix_f32 v34, v103, v26, v30 op_sel:[0,0,0] op_sel_hi:[1,0,0]
    v_mfma_f32_16x16x32_bf16 v[212:215], a[232:235], v[80:83], 0
    ds_read_b64_tr_b16 a[192:193], v4 offset:0
    v_fma_mix_f32 v35, v103, v27, v31 op_sel:[1,0,0] op_sel_hi:[1,0,0]
    v_mfma_f32_16x16x32_bf16 v[212:215], a[236:239], v[84:87], v[212:215]
    ds_read_b64_tr_b16 a[194:195], v4 offset:512
    ds_read_b64_tr_b16 a[196:197], v4 offset:16896
    v_cvt_pk_bf16_f32 v102, v32, v33
    v_mfma_f32_16x16x32_bf16 v[244:247], a[232:235], v[88:91], 0
    s_add_u32 m0, s44, 0
    ds_read_b64_tr_b16 a[198:199], v4 offset:17408
    v_cvt_pk_bf16_f32 v103, v34, v35
    v_mfma_f32_16x16x32_bf16 v[244:247], a[236:239], v[92:95], v[244:247]
    s_mov_b32 s45, 1572864
    s_waitcnt lgkmcnt(10)
    buffer_load_dwordx4 v6, s[24:27], s45 offen lds
    v_mfma_f32_16x16x32_bf16 v[216:219], a[240:243], v[80:83], 0
    ds_read_b64_tr_b16 a[200:201], v4 offset:32
    v_fma_mix_f32 v36, v110, v24, v28 op_sel:[0,0,0] op_sel_hi:[1,0,0]
    v_mfma_f32_16x16x32_bf16 v[216:219], a[244:247], v[84:87], v[216:219]
    ds_read_b64_tr_b16 a[202:203], v4 offset:544
    ds_read_b64_tr_b16 a[204:205], v4 offset:16928
    v_fma_mix_f32 v37, v110, v25, v29 op_sel:[1,0,0] op_sel_hi:[1,0,0]
    v_mfma_f32_16x16x32_bf16 v[248:251], a[240:243], v[88:91], 0
    s_add_u32 m0, s44, 1056
    ds_read_b64_tr_b16 a[206:207], v4 offset:17440
    v_fma_mix_f32 v38, v111, v26, v30 op_sel:[0,0,0] op_sel_hi:[1,0,0]
    v_mfma_f32_16x16x32_bf16 v[248:251], a[244:247], v[92:95], v[248:251]
    s_mov_b32 s45, 1581056
    s_waitcnt lgkmcnt(8)
    buffer_load_dwordx4 v6, s[24:27], s45 offen lds
    v_mfma_f32_16x16x32_bf16 v[220:223], a[248:251], v[80:83], 0
    ds_read_b64_tr_b16 a[208:209], v4 offset:64
    v_fma_mix_f32 v39, v111, v27, v31 op_sel:[1,0,0] op_sel_hi:[1,0,0]
    v_mfma_f32_16x16x32_bf16 v[220:223], a[252:255], v[84:87], v[220:223]
    ds_read_b64_tr_b16 a[210:211], v4 offset:576
    ds_read_b64_tr_b16 a[212:213], v4 offset:16960
    v_cvt_pk_bf16_f32 v110, v36, v37
    v_mfma_f32_16x16x32_bf16 v[252:255], a[248:251], v[88:91], 0
    s_add_u32 m0, s44, 2112
    ds_read_b64_tr_b16 a[214:215], v4 offset:17472
    v_cvt_pk_bf16_f32 v111, v38, v39
    v_mfma_f32_16x16x32_bf16 v[252:255], a[252:255], v[92:95], v[252:255]
    s_mov_b32 s45, 1589248
    s_waitcnt lgkmcnt(8)
    buffer_load_dwordx4 v6, s[24:27], s45 offen lds
    v_mfma_f32_16x16x32_bf16 v[128:131], a[192:195], v[96:99], v[128:131]
    s_waitcnt vmcnt(15)
    ds_read_b64_tr_b16 a[216:217], v4 offset:96
    ds_read_b128 v[24:27], v9 offset:10256
    v_mfma_f32_16x16x32_bf16 v[128:131], a[196:199], v[100:103], v[128:131]
    ds_read_b64_tr_b16 a[218:219], v4 offset:608
    ds_read_b64_tr_b16 a[220:221], v4 offset:16992
    v_fma_mix_f32 v32, v112, v16, v20 op_sel:[0,0,0] op_sel_hi:[1,0,0]
    v_mfma_f32_16x16x32_bf16 v[160:163], a[192:195], v[104:107], v[160:163]
    s_add_u32 m0, s44, 3168
    ds_read_b64_tr_b16 a[222:223], v4 offset:17504
    ds_read_b128 v[28:31], v9 offset:10288
    v_mfma_f32_16x16x32_bf16 v[160:163], a[196:199], v[108:111], v[160:163]
    s_mov_b32 s45, 1597440
    s_waitcnt lgkmcnt(10)
    buffer_load_dwordx4 v6, s[24:27], s45 offen lds
    v_mfma_f32_16x16x32_bf16 v[132:135], a[200:203], v[96:99], v[132:135]
    ds_read_b64_tr_b16 a[224:225], v4 offset:128
    v_fma_mix_f32 v33, v112, v17, v21 op_sel:[1,0,0] op_sel_hi:[1,0,0]
    v_mfma_f32_16x16x32_bf16 v[132:135], a[204:207], v[100:103], v[132:135]
    ds_read_b64_tr_b16 a[226:227], v4 offset:640
    ds_read_b64_tr_b16 a[228:229], v4 offset:17024
    v_fma_mix_f32 v34, v113, v18, v22 op_sel:[0,0,0] op_sel_hi:[1,0,0]
    v_mfma_f32_16x16x32_bf16 v[164:167], a[200:203], v[104:107], v[164:167]
    s_add_u32 m0, s44, 16896
    ds_read_b64_tr_b16 a[230:231], v4 offset:17536
    v_fma_mix_f32 v35, v113, v19, v23 op_sel:[1,0,0] op_sel_hi:[1,0,0]
    v_mfma_f32_16x16x32_bf16 v[164:167], a[204:207], v[108:111], v[164:167]
    s_mov_b32 s45, 1835008
    s_waitcnt lgkmcnt(10)
    buffer_load_dwordx4 v6, s[24:27], s45 offen lds
    v_mfma_f32_16x16x32_bf16 v[136:139], a[208:211], v[96:99], v[136:139]
    ds_read_b64_tr_b16 a[232:233], v4 offset:160
    v_cvt_pk_bf16_f32 v112, v32, v33
    v_mfma_f32_16x16x32_bf16 v[136:139], a[212:215], v[100:103], v[136:139]
    ds_read_b64_tr_b16 a[234:235], v4 offset:672
    ds_read_b64_tr_b16 a[236:237], v4 offset:17056
    v_cvt_pk_bf16_f32 v113, v34, v35
    v_mfma_f32_16x16x32_bf16 v[168:171], a[208:211], v[104:107], v[168:171]
    s_add_u32 m0, s44, 17952
    ds_read_b64_tr_b16 a[238:239], v4 offset:17568
    v_fma_mix_f32 v36, v120, v16, v20 op_sel:[0,0,0] op_sel_hi:[1,0,0]
    v_mfma_f32_16x16x32_bf16 v[168:171], a[212:215], v[108:111], v[168:171]
    s_mov_b32 s45, 1843200
    s_waitcnt lgkmcnt(9)
    buffer_load_dwordx4 v6, s[24:27], s45 offen lds
    v_fma_mix_f32 v37, v120, v17, v21 op_sel:[1,0,0] op_sel_hi:[1,0,0]
    v_mfma_f32_16x16x32_bf16 v[140:143], a[216:219], v[96:99], v[140:143]
    ds_read_b64_tr_b16 a[240:241], v4 offset:192
    v_fma_mix_f32 v38, v121, v18, v22 op_sel:[0,0,0] op_sel_hi:[1,0,0]
    v_mfma_f32_16x16x32_bf16 v[140:143], a[220:223], v[100:103], v[140:143]
    ds_read_b64_tr_b16 a[242:243], v4 offset:704
    ds_read_b64_tr_b16 a[244:245], v4 offset:17088
    v_fma_mix_f32 v39, v121, v19, v23 op_sel:[1,0,0] op_sel_hi:[1,0,0]
    v_mfma_f32_16x16x32_bf16 v[172:175], a[216:219], v[104:107], v[172:175]
    s_add_u32 m0, s44, 19008
    ds_read_b64_tr_b16 a[246:247], v4 offset:17600
    v_cvt_pk_bf16_f32 v120, v36, v37
    v_mfma_f32_16x16x32_bf16 v[172:175], a[220:223], v[108:111], v[172:175]
    s_mov_b32 s45, 1851392
    s_waitcnt lgkmcnt(8)
    buffer_load_dwordx4 v6, s[24:27], s45 offen lds
    v_cvt_pk_bf16_f32 v121, v38, v39
    v_mfma_f32_16x16x32_bf16 v[144:147], a[224:227], v[96:99], v[144:147]
    ds_read_b64_tr_b16 a[248:249], v4 offset:224
    ds_read_b128 v[16:19], v9 offset:10496
    v_mfma_f32_16x16x32_bf16 v[144:147], a[228:231], v[100:103], v[144:147]
    ds_read_b64_tr_b16 a[250:251], v4 offset:736
    ds_read_b64_tr_b16 a[252:253], v4 offset:17120
    v_mfma_f32_16x16x32_bf16 v[176:179], a[224:227], v[104:107], v[176:179]
    s_add_u32 m0, s44, 20064
    ds_read_b64_tr_b16 a[254:255], v4 offset:17632
    ds_read_b128 v[20:23], v9 offset:10528
    v_mfma_f32_16x16x32_bf16 v[176:179], a[228:231], v[108:111], v[176:179]
    s_mov_b32 s45, 1859584
    s_waitcnt lgkmcnt(10)
    buffer_load_dwordx4 v6, s[24:27], s45 offen lds
    v_mfma_f32_16x16x32_bf16 v[148:151], a[232:235], v[96:99], v[148:151]
    ds_read_b64_tr_b16 a[192:193], v4 offset:256
    v_fma_mix_f32 v32, v114, v24, v28 op_sel:[0,0,0] op_sel_hi:[1,0,0]
    v_mfma_f32_16x16x32_bf16 v[148:151], a[236:239], v[100:103], v[148:151]
    ds_read_b64_tr_b16 a[194:195], v4 offset:768
    v_fma_mix_f32 v33, v114, v25, v29 op_sel:[1,0,0] op_sel_hi:[1,0,0]
    v_mfma_f32_16x16x32_bf16 v[180:183], a[232:235], v[104:107], v[180:183]
    ds_read_b64_tr_b16 a[196:197], v4 offset:17152
    v_fma_mix_f32 v34, v115, v26, v30 op_sel:[0,0,0] op_sel_hi:[1,0,0]
    v_mfma_f32_16x16x32_bf16 v[180:183], a[236:239], v[108:111], v[180:183]
    s_waitcnt lgkmcnt(9)
    ds_read_b64_tr_b16 a[198:199], v4 offset:17664
    v_fma_mix_f32 v35, v115, v27, v31 op_sel:[1,0,0] op_sel_hi:[1,0,0]
    v_mfma_f32_16x16x32_bf16 v[152:155], a[240:243], v[96:99], v[152:155]
    ds_read_b64_tr_b16 a[200:201], v4 offset:288
    v_cvt_pk_bf16_f32 v114, v32, v33
    v_mfma_f32_16x16x32_bf16 v[152:155], a[244:247], v[100:103], v[152:155]
    ds_read_b64_tr_b16 a[202:203], v4 offset:800
    v_cvt_pk_bf16_f32 v115, v34, v35
    v_mfma_f32_16x16x32_bf16 v[184:187], a[240:243], v[104:107], v[184:187]
    ds_read_b64_tr_b16 a[204:205], v4 offset:17184
    v_fma_mix_f32 v36, v122, v24, v28 op_sel:[0,0,0] op_sel_hi:[1,0,0]
    v_mfma_f32_16x16x32_bf16 v[184:187], a[244:247], v[108:111], v[184:187]
    s_waitcnt lgkmcnt(8)
    ds_read_b64_tr_b16 a[206:207], v4 offset:17696
    v_fma_mix_f32 v37, v122, v25, v29 op_sel:[1,0,0] op_sel_hi:[1,0,0]
    v_mfma_f32_16x16x32_bf16 v[156:159], a[248:251], v[96:99], v[156:159]
    ds_read_b64_tr_b16 a[208:209], v4 offset:320
    v_fma_mix_f32 v38, v123, v26, v30 op_sel:[0,0,0] op_sel_hi:[1,0,0]
    v_mfma_f32_16x16x32_bf16 v[156:159], a[252:255], v[100:103], v[156:159]
    ds_read_b64_tr_b16 a[210:211], v4 offset:832
    v_fma_mix_f32 v39, v123, v27, v31 op_sel:[1,0,0] op_sel_hi:[1,0,0]
    v_mfma_f32_16x16x32_bf16 v[188:191], a[248:251], v[104:107], v[188:191]
    ds_read_b64_tr_b16 a[212:213], v4 offset:17216
    v_cvt_pk_bf16_f32 v122, v36, v37
    v_mfma_f32_16x16x32_bf16 v[188:191], a[252:255], v[108:111], v[188:191]
    s_waitcnt lgkmcnt(7)
    ds_read_b64_tr_b16 a[214:215], v4 offset:17728
    v_cvt_pk_bf16_f32 v123, v38, v39
    v_mfma_f32_16x16x32_bf16 v[192:195], a[192:195], v[96:99], v[192:195]
    ds_read_b64_tr_b16 a[216:217], v4 offset:352
    ds_read_b128 v[24:27], v9 offset:10512
    v_mfma_f32_16x16x32_bf16 v[192:195], a[196:199], v[100:103], v[192:195]
    ds_read_b64_tr_b16 a[218:219], v4 offset:864
    ds_read_b64_tr_b16 a[220:221], v4 offset:17248
    v_fma_mix_f32 v32, v116, v16, v20 op_sel:[0,0,0] op_sel_hi:[1,0,0]
    v_mfma_f32_16x16x32_bf16 v[224:227], a[192:195], v[104:107], v[224:227]
    s_mov_b32 s54, 8192
    ds_read_b64_tr_b16 a[222:223], v4 offset:17760
    ds_read_b128 v[28:31], v9 offset:10544
    v_mfma_f32_16x16x32_bf16 v[224:227], a[196:199], v[108:111], v[224:227]
    s_waitcnt lgkmcnt(10)
    buffer_load_dwordx4 v[64:67], v8, s[32:35], s54 offen sc1
    v_mfma_f32_16x16x32_bf16 v[196:199], a[200:203], v[96:99], v[196:199]
    ds_read_b64_tr_b16 a[224:225], v4 offset:384
    v_fma_mix_f32 v33, v116, v17, v21 op_sel:[1,0,0] op_sel_hi:[1,0,0]
    v_mfma_f32_16x16x32_bf16 v[196:199], a[204:207], v[100:103], v[196:199]
    ds_read_b64_tr_b16 a[226:227], v4 offset:896
    ds_read_b64_tr_b16 a[228:229], v4 offset:17280
    v_fma_mix_f32 v34, v117, v18, v22 op_sel:[0,0,0] op_sel_hi:[1,0,0]
    v_mfma_f32_16x16x32_bf16 v[228:231], a[200:203], v[104:107], v[228:231]
    s_mov_b32 s54, 9216
    ds_read_b64_tr_b16 a[230:231], v4 offset:17792
    v_fma_mix_f32 v35, v117, v19, v23 op_sel:[1,0,0] op_sel_hi:[1,0,0]
    v_mfma_f32_16x16x32_bf16 v[228:231], a[204:207], v[108:111], v[228:231]
    s_waitcnt lgkmcnt(10)
    buffer_load_dwordx4 v[68:71], v8, s[32:35], s54 offen sc1
    v_mfma_f32_16x16x32_bf16 v[200:203], a[208:211], v[96:99], v[200:203]
    ds_read_b64_tr_b16 a[232:233], v4 offset:416
    v_cvt_pk_bf16_f32 v116, v32, v33
    v_mfma_f32_16x16x32_bf16 v[200:203], a[212:215], v[100:103], v[200:203]
    ds_read_b64_tr_b16 a[234:235], v4 offset:928
    ds_read_b64_tr_b16 a[236:237], v4 offset:17312
    v_cvt_pk_bf16_f32 v117, v34, v35
    v_mfma_f32_16x16x32_bf16 v[232:235], a[208:211], v[104:107], v[232:235]
    s_mov_b32 s54, 26624
    ds_read_b64_tr_b16 a[238:239], v4 offset:17824
    v_fma_mix_f32 v36, v124, v16, v20 op_sel:[0,0,0] op_sel_hi:[1,0,0]
    v_mfma_f32_16x16x32_bf16 v[232:235], a[212:215], v[108:111], v[232:235]
    s_waitcnt lgkmcnt(9)
    buffer_load_dwordx4 v[72:75], v8, s[32:35], s54 offen sc1
    v_fma_mix_f32 v37, v124, v17, v21 op_sel:[1,0,0] op_sel_hi:[1,0,0]
    v_mfma_f32_16x16x32_bf16 v[204:207], a[216:219], v[96:99], v[204:207]
L2_pad0:
    s_cbranch_execz L2_pad4
    ds_read_b64_tr_b16 a[240:241], v4 offset:448
    v_fma_mix_f32 v38, v125, v18, v22 op_sel:[0,0,0] op_sel_hi:[1,0,0]
    v_mfma_f32_16x16x32_bf16 v[204:207], a[220:223], v[100:103], v[204:207]
    ds_read_b64_tr_b16 a[242:243], v4 offset:960
    ds_read_b64_tr_b16 a[244:245], v4 offset:17344
    v_fma_mix_f32 v39, v125, v19, v23 op_sel:[1,0,0] op_sel_hi:[1,0,0]
    v_mfma_f32_16x16x32_bf16 v[236:239], a[216:219], v[104:107], v[236:239]
    s_mov_b32 s54, 27648
    ds_read_b64_tr_b16 a[246:247], v4 offset:17856
    v_cvt_pk_bf16_f32 v124, v36, v37
    v_mfma_f32_16x16x32_bf16 v[236:239], a[220:223], v[108:111], v[236:239]
    s_waitcnt lgkmcnt(8)
    buffer_load_dwordx4 v[76:79], v8, s[32:35], s54 offen sc1
    v_cvt_pk_bf16_f32 v125, v38, v39
    v_mfma_f32_16x16x32_bf16 v[208:211], a[224:227], v[96:99], v[208:211]
    ds_read_b64_tr_b16 a[248:249], v4 offset:480
    ds_read_b128 v[16:19], v9 offset:10752
    v_mfma_f32_16x16x32_bf16 v[208:211], a[228:231], v[100:103], v[208:211]
    ds_read_b64_tr_b16 a[250:251], v4 offset:992
    ds_read_b128 v[20:23], v9 offset:10784
    v_mfma_f32_16x16x32_bf16 v[240:243], a[224:227], v[104:107], v[240:243]
    ds_read_b64_tr_b16 a[252:253], v4 offset:17376
    v_fma_mix_f32 v32, v118, v24, v28 op_sel:[0,0,0] op_sel_hi:[1,0,0]
    v_mfma_f32_16x16x32_bf16 v[240:243], a[228:231], v[108:111], v[240:243]
    s_waitcnt vmcnt(16)
    s_barrier
    s_waitcnt lgkmcnt(9)
    ds_read_b64_tr_b16 a[254:255], v4 offset:17888
    v_fma_mix_f32 v33, v118, v25, v29 op_sel:[1,0,0] op_sel_hi:[1,0,0]
    v_fma_mix_f32 v34, v119, v26, v30 op_sel:[0,0,0] op_sel_hi:[1,0,0]
    v_mfma_f32_16x16x32_bf16 v[212:215], a[232:235], v[96:99], v[212:215]
    ds_read_b64_tr_b16 a[192:193], v4 offset:36864
    v_fma_mix_f32 v35, v119, v27, v31 op_sel:[1,0,0] op_sel_hi:[1,0,0]
    v_mfma_f32_16x16x32_bf16 v[212:215], a[236:239], v[100:103], v[212:215]
    ds_read_b64_tr_b16 a[194:195], v4 offset:37376
    ds_read_b64_tr_b16 a[196:197], v4 offset:53760
    v_cvt_pk_bf16_f32 v118, v32, v33
    v_mfma_f32_16x16x32_bf16 v[244:247], a[232:235], v[104:107], v[244:247]
    s_add_u32 m0, s44, 36864
    ds_read_b64_tr_b16 a[198:199], v4 offset:54272
    v_cvt_pk_bf16_f32 v119, v34, v35
    v_mfma_f32_16x16x32_bf16 v[244:247], a[236:239], v[108:111], v[244:247]
    s_mov_b32 s45, 2097152
    s_waitcnt lgkmcnt(10)
    buffer_load_dwordx4 v6, s[24:27], s45 offen lds
    v_mfma_f32_16x16x32_bf16 v[216:219], a[240:243], v[96:99], v[216:219]
    ds_read_b64_tr_b16 a[200:201], v4 offset:36896
    v_fma_mix_f32 v36, v126, v24, v28 op_sel:[0,0,0] op_sel_hi:[1,0,0]
    v_mfma_f32_16x16x32_bf16 v[216:219], a[244:247], v[100:103], v[216:219]
    ds_read_b64_tr_b16 a[202:203], v4 offset:37408
    ds_read_b64_tr_b16 a[204:205], v4 offset:53792
    v_fma_mix_f32 v37, v126, v25, v29 op_sel:[1,0,0] op_sel_hi:[1,0,0]
    v_mfma_f32_16x16x32_bf16 v[248:251], a[240:243], v[104:107], v[248:251]
    s_add_u32 m0, s44, 37920
    ds_read_b64_tr_b16 a[206:207], v4 offset:54304
    v_fma_mix_f32 v38, v127, v26, v30 op_sel:[0,0,0] op_sel_hi:[1,0,0]
    v_mfma_f32_16x16x32_bf16 v[248:251], a[244:247], v[108:111], v[248:251]
    s_mov_b32 s45, 2105344
    s_waitcnt lgkmcnt(8)
    buffer_load_dwordx4 v6, s[24:27], s45 offen lds
    v_mfma_f32_16x16x32_bf16 v[220:223], a[248:251], v[96:99], v[220:223]
    ds_read_b64_tr_b16 a[208:209], v4 offset:36928
    v_fma_mix_f32 v39, v127, v27, v31 op_sel:[1,0,0] op_sel_hi:[1,0,0]
    v_mfma_f32_16x16x32_bf16 v[220:223], a[252:255], v[100:103], v[220:223]
    ds_read_b64_tr_b16 a[210:211], v4 offset:37440
    ds_read_b64_tr_b16 a[212:213], v4 offset:53824
    v_cvt_pk_bf16_f32 v126, v36, v37
    v_mfma_f32_16x16x32_bf16 v[252:255], a[248:251], v[104:107], v[252:255]
    s_add_u32 m0, s44, 38976
    ds_read_b64_tr_b16 a[214:215], v4 offset:54336
    v_cvt_pk_bf16_f32 v127, v38, v39
    v_mfma_f32_16x16x32_bf16 v[252:255], a[252:255], v[108:111], v[252:255]
    s_mov_b32 s45, 2113536
    s_waitcnt lgkmcnt(8)
    buffer_load_dwordx4 v6, s[24:27], s45 offen lds
    v_mfma_f32_16x16x32_bf16 v[128:131], a[192:195], v[112:115], v[128:131]
    s_waitcnt vmcnt(15)
    ds_read_b64_tr_b16 a[216:217], v4 offset:36960
    ds_read_b128 v[24:27], v9 offset:10768
    v_mfma_f32_16x16x32_bf16 v[128:131], a[196:199], v[116:119], v[128:131]
    ds_read_b64_tr_b16 a[218:219], v4 offset:37472
    ds_read_b64_tr_b16 a[220:221], v4 offset:53856
    v_fma_mix_f32 v32, v48, v16, v20 op_sel:[0,0,0] op_sel_hi:[1,0,0]
    v_mfma_f32_16x16x32_bf16 v[160:163], a[192:195], v[120:123], v[160:163]
    s_add_u32 m0, s44, 40032
    ds_read_b64_tr_b16 a[222:223], v4 offset:54368
    ds_read_b128 v[28:31], v9 offset:10800
    v_mfma_f32_16x16x32_bf16 v[160:163], a[196:199], v[124:127], v[160:163]
    s_mov_b32 s45, 2121728
    s_waitcnt lgkmcnt(10)
    buffer_load_dwordx4 v6, s[24:27], s45 offen lds
    v_mfma_f32_16x16x32_bf16 v[132:135], a[200:203], v[112:115], v[132:135]
    ds_read_b64_tr_b16 a[224:225], v4 offset:36992
    v_fma_mix_f32 v33, v48, v17, v21 op_sel:[1,0,0] op_sel_hi:[1,0,0]
    v_mfma_f32_16x16x32_bf16 v[132:135], a[204:207], v[116:119], v[132:135]
    ds_read_b64_tr_b16 a[226:227], v4 offset:37504
    ds_read_b64_tr_b16 a[228:229], v4 offset:53888
    v_fma_mix_f32 v34, v49, v18, v22 op_sel:[0,0,0] op_sel_hi:[1,0,0]
    v_mfma_f32_16x16x32_bf16 v[164:167], a[200:203], v[120:123], v[164:167]
    s_add_u32 m0, s44, 53760
    ds_read_b64_tr_b16 a[230:231], v4 offset:54400
    v_fma_mix_f32 v35, v49, v19, v23 op_sel:[1,0,0] op_sel_hi:[1,0,0]
    v_mfma_f32_16x16x32_bf16 v[164:167], a[204:207], v[124:127], v[164:167]
    s_mov_b32 s45, 2359296
    s_waitcnt lgkmcnt(10)
    buffer_load_dwordx4 v6, s[24:27], s45 offen lds
    v_mfma_f32_16x16x32_bf16 v[136:139], a[208:211], v[112:115], v[136:139]
    ds_read_b64_tr_b16 a[232:233], v4 offset:37024
    v_cvt_pk_bf16_f32 v48, v32, v33
    v_mfma_f32_16x16x32_bf16 v[136:139], a[212:215], v[116:119], v[136:139]
    ds_read_b64_tr_b16 a[234:235], v4 offset:37536
    ds_read_b64_tr_b16 a[236:237], v4 offset:53920
    v_cvt_pk_bf16_f32 v49, v34, v35
    v_mfma_f32_16x16x32_bf16 v[168:171], a[208:211], v[120:123], v[168:171]
    s_add_u32 m0, s44, 54816
    ds_read_b64_tr_b16 a[238:239], v4 offset:54432
    v_fma_mix_f32 v36, v56, v16, v20 op_sel:[0,0,0] op_sel_hi:[1,0,0]
    v_mfma_f32_16x16x32_bf16 v[168:171], a[212:215], v[124:127], v[168:171]
    s_mov_b32 s45, 2367488
    s_waitcnt lgkmcnt(9)
    buffer_load_dwordx4 v6, s[24:27], s45 offen lds
    v_fma_mix_f32 v37, v56, v17, v21 op_sel:[1,0,0] op_sel_hi:[1,0,0]
    v_mfma_f32_16x16x32_bf16 v[140:143], a[216:219], v[112:115], v[140:143]
    ds_read_b64_tr_b16 a[240:241], v4 offset:37056
    v_fma_mix_f32 v38, v57, v18, v22 op_sel:[0,0,0] op_sel_hi:[1,0,0]
    v_mfma_f32_16x16x32_bf16 v[140:143], a[220:223], v[116:119], v[140:143]
    ds_read_b64_tr_b16 a[242:243], v4 offset:37568
    ds_read_b64_tr_b16 a[244:245], v4 offset:53952
    v_fma_mix_f32 v39, v57, v19, v23 op_sel:[1,0,0] op_sel_hi:[1,0,0]
    v_mfma_f32_16x16x32_bf16 v[172:175], a[216:219], v[120:123], v[172:175]
    s_add_u32 m0, s44, 55872
    ds_read_b64_tr_b16 a[246:247], v4 offset:54464
    v_cvt_pk_bf16_f32 v56, v36, v37
    v_mfma_f32_16x16x32_bf16 v[172:175], a[220:223], v[124:127], v[172:175]
    s_mov_b32 s45, 2375680
    s_waitcnt lgkmcnt(8)
    buffer_load_dwordx4 v6, s[24:27], s45 offen lds
    v_cvt_pk_bf16_f32 v57, v38, v39
    v_mfma_f32_16x16x32_bf16 v[144:147], a[224:227], v[112:115], v[144:147]
    ds_read_b64_tr_b16 a[248:249], v4 offset:37088
    ds_read_b128 v[16:19], v9 offset:11008
    v_mfma_f32_16x16x32_bf16 v[144:147], a[228:231], v[116:119], v[144:147]
    ds_read_b64_tr_b16 a[250:251], v4 offset:37600
    ds_read_b64_tr_b16 a[252:253], v4 offset:53984
    v_mfma_f32_16x16x32_bf16 v[176:179], a[224:227], v[120:123], v[176:179]
    s_add_u32 m0, s44, 56928
    ds_read_b64_tr_b16 a[254:255], v4 offset:54496
    ds_read_b128 v[20:23], v9 offset:11040
    v_mfma_f32_16x16x32_bf16 v[176:179], a[228:231], v[124:127], v[176:179]
    s_mov_b32 s45, 2383872
    s_waitcnt lgkmcnt(10)
    buffer_load_dwordx4 v6, s[24:27], s45 offen lds
    v_mfma_f32_16x16x32_bf16 v[148:151], a[232:235], v[112:115], v[148:151]
    ds_read_b64_tr_b16 a[192:193], v4 offset:37120
    v_fma_mix_f32 v32, v50, v24, v28 op_sel:[0,0,0] op_sel_hi:[1,0,0]
    v_mfma_f32_16x16x32_bf16 v[148:151], a[236:239], v[116:119], v[148:151]
    ds_read_b64_tr_b16 a[194:195], v4 offset:37632
    v_fma_mix_f32 v33, v50, v25, v29 op_sel:[1,0,0] op_sel_hi:[1,0,0]
    v_mfma_f32_16x16x32_bf16 v[180:183], a[232:235], v[120:123], v[180:183]
    ds_read_b64_tr_b16 a[196:197], v4 offset:54016
    v_fma_mix_f32 v34, v51, v26, v30 op_sel:[0,0,0] op_sel_hi:[1,0,0]
    v_mfma_f32_16x16x32_bf16 v[180:183], a[236:239], v[124:127], v[180:183]
    s_waitcnt lgkmcnt(9)
    ds_read_b64_tr_b16 a[198:199], v4 offset:54528
    v_fma_mix_f32 v35, v51, v27, v31 op_sel:[1,0,0] op_sel_hi:[1,0,0]
    v_mfma_f32_16x16x32_bf16 v[152:155], a[240:243], v[112:115], v[152:155]
    ds_read_b64_tr_b16 a[200:201], v4 offset:37152
    v_cvt_pk_bf16_f32 v50, v32, v33
    v_mfma_f32_16x16x32_bf16 v[152:155], a[244:247], v[116:119], v[152:155]
    ds_read_b64_tr_b16 a[202:203], v4 offset:37664
    v_cvt_pk_bf16_f32 v51, v34, v35
    v_mfma_f32_16x16x32_bf16 v[184:187], a[240:243], v[120:123], v[184:187]
    ds_read_b64_tr_b16 a[204:205], v4 offset:54048
    v_fma_mix_f32 v36, v58, v24, v28 op_sel:[0,0,0] op_sel_hi:[1,0,0]
    v_mfma_f32_16x16x32_bf16 v[184:187], a[244:247], v[124:127], v[184:187]
    s_waitcnt lgkmcnt(8)
    ds_read_b64_tr_b16 a[206:207], v4 offset:54560
    v_fma_mix_f32 v37, v58, v25, v29 op_sel:[1,0,0] op_sel_hi:[1,0,0]
    v_mfma_f32_16x16x32_bf16 v[156:159], a[248:251], v[112:115], v[156:159]
    ds_read_b64_tr_b16 a[208:209], v4 offset:37184
    v_fma_mix_f32 v38, v59, v26, v30 op_sel:[0,0,0] op_sel_hi:[1,0,0]
    v_mfma_f32_16x16x32_bf16 v[156:159], a[252:255], v[116:119], v[156:159]
    ds_read_b64_tr_b16 a[210:211], v4 offset:37696
    v_fma_mix_f32 v39, v59, v27, v31 op_sel:[1,0,0] op_sel_hi:[1,0,0]
    v_mfma_f32_16x16x32_bf16 v[188:191], a[248:251], v[120:123], v[188:191]
    ds_read_b64_tr_b16 a[212:213], v4 offset:54080
    v_cvt_pk_bf16_f32 v58, v36, v37
    v_mfma_f32_16x16x32_bf16 v[188:191], a[252:255], v[124:127], v[188:191]
    s_waitcnt lgkmcnt(7)
    ds_read_b64_tr_b16 a[214:215], v4 offset:54592
    v_cvt_pk_bf16_f32 v59, v38, v39
    v_mfma_f32_16x16x32_bf16 v[192:195], a[192:195], v[112:115], v[192:195]
    ds_read_b64_tr_b16 a[216:217], v4 offset:37216
    ds_read_b128 v[24:27], v9 offset:11024
    v_mfma_f32_16x16x32_bf16 v[192:195], a[196:199], v[116:119], v[192:195]
    ds_read_b64_tr_b16 a[218:219], v4 offset:37728
    ds_read_b64_tr_b16 a[220:221], v4 offset:54112
    v_fma_mix_f32 v32, v52, v16, v20 op_sel:[0,0,0] op_sel_hi:[1,0,0]
    v_mfma_f32_16x16x32_bf16 v[224:227], a[192:195], v[120:123], v[224:227]
    s_mov_b32 s54, 10240
    ds_read_b64_tr_b16 a[222:223], v4 offset:54624
    ds_read_b128 v[28:31], v9 offset:11056
    v_mfma_f32_16x16x32_bf16 v[224:227], a[196:199], v[124:127], v[224:227]
    s_waitcnt lgkmcnt(10)
    buffer_load_dwordx4 v[80:83], v8, s[32:35], s54 offen sc1
    v_mfma_f32_16x16x32_bf16 v[196:199], a[200:203], v[112:115], v[196:199]
    ds_read_b64_tr_b16 a[224:225], v4 offset:37248
    v_fma_mix_f32 v33, v52, v17, v21 op_sel:[1,0,0] op_sel_hi:[1,0,0]
    v_mfma_f32_16x16x32_bf16 v[196:199], a[204:207], v[116:119], v[196:199]
    ds_read_b64_tr_b16 a[226:227], v4 offset:37760
    ds_read_b64_tr_b16 a[228:229], v4 offset:54144
    v_fma_mix_f32 v34, v53, v18, v22 op_sel:[0,0,0] op_sel_hi:[1,0,0]
    v_mfma_f32_16x16x32_bf16 v[228:231], a[200:203], v[120:123], v[228:231]
    s_mov_b32 s54, 11264
    ds_read_b64_tr_b16 a[230:231], v4 offset:54656
    v_fma_mix_f32 v35, v53, v19, v23 op_sel:[1,0,0] op_sel_hi:[1,0,0]
    v_mfma_f32_16x16x32_bf16 v[228:231], a[204:207], v[124:127], v[228:231]
    s_waitcnt lgkmcnt(10)
    buffer_load_dwordx4 v[84:87], v8, s[32:35], s54 offen sc1
    v_mfma_f32_16x16x32_bf16 v[200:203], a[208:211], v[112:115], v[200:203]
    ds_read_b64_tr_b16 a[232:233], v4 offset:37280
    v_cvt_pk_bf16_f32 v52, v32, v33
    v_mfma_f32_16x16x32_bf16 v[200:203], a[212:215], v[116:119], v[200:203]
    ds_read_b64_tr_b16 a[234:235], v4 offset:37792
    ds_read_b64_tr_b16 a[236:237], v4 offset:54176
    v_cvt_pk_bf16_f32 v53, v34, v35
    v_mfma_f32_16x16x32_bf16 v[232:235], a[208:211], v[120:123], v[232:235]
    s_mov_b32 s54, 28672
    ds_read_b64_tr_b16 a[238:239], v4 offset:54688
    v_fma_mix_f32 v36, v60, v16, v20 op_sel:[0,0,0] op_sel_hi:[1,0,0]
    v_mfma_f32_16x16x32_bf16 v[232:235], a[212:215], v[124:127], v[232:235]
    s_waitcnt lgkmcnt(9)
    buffer_load_dwordx4 v[88:91], v8, s[32:35], s54 offen sc1
    v_fma_mix_f32 v37, v60, v17, v21 op_sel:[1,0,0] op_sel_hi:[1,0,0]
    v_mfma_f32_16x16x32_bf16 v[204:207], a[216:219], v[112:115], v[204:207]
    ds_read_b64_tr_b16 a[240:241], v4 offset:37312
    v_fma_mix_f32 v38, v61, v18, v22 op_sel:[0,0,0] op_sel_hi:[1,0,0]
    v_mfma_f32_16x16x32_bf16 v[204:207], a[220:223], v[116:119], v[204:207]
    ds_read_b64_tr_b16 a[242:243], v4 offset:37824
    ds_read_b64_tr_b16 a[244:245], v4 offset:54208
    v_fma_mix_f32 v39, v61, v19, v23 op_sel:[1,0,0] op_sel_hi:[1,0,0]
    v_mfma_f32_16x16x32_bf16 v[236:239], a[216:219], v[120:123], v[236:239]
    s_mov_b32 s54, 29696
    ds_read_b64_tr_b16 a[246:247], v4 offset:54720
    v_cvt_pk_bf16_f32 v60, v36, v37
    v_mfma_f32_16x16x32_bf16 v[236:239], a[220:223], v[124:127], v[236:239]
    s_waitcnt lgkmcnt(8)
    buffer_load_dwordx4 v[92:95], v8, s[32:35], s54 offen sc1
    v_cvt_pk_bf16_f32 v61, v38, v39
    v_mfma_f32_16x16x32_bf16 v[208:211], a[224:227], v[112:115], v[208:211]
    ds_read_b64_tr_b16 a[248:249], v4 offset:37344
    ds_read_b128 v[16:19], v9 offset:11264
    v_mfma_f32_16x16x32_bf16 v[208:211], a[228:231], v[116:119], v[208:211]
    ds_read_b64_tr_b16 a[250:251], v4 offset:37856
    ds_read_b128 v[20:23], v9 offset:11296
    v_mfma_f32_16x16x32_bf16 v[240:243], a[224:227], v[120:123], v[240:243]
    ds_read_b64_tr_b16 a[252:253], v4 offset:54240
    v_fma_mix_f32 v32, v54, v24, v28 op_sel:[0,0,0] op_sel_hi:[1,0,0]
    v_mfma_f32_16x16x32_bf16 v[240:243], a[228:231], v[124:127], v[240:243]
    s_waitcnt vmcnt(16)
    s_barrier
    s_waitcnt lgkmcnt(9)
    ds_read_b64_tr_b16 a[254:255], v4 offset:54752
    v_fma_mix_f32 v33, v54, v25, v29 op_sel:[1,0,0] op_sel_hi:[1,0,0]
    v_fma_mix_f32 v34, v55, v26, v30 op_sel:[0,0,0] op_sel_hi:[1,0,0]
    v_mfma_f32_16x16x32_bf16 v[212:215], a[232:235], v[112:115], v[212:215]
    ds_read_b64_tr_b16 a[192:193], v3 offset:0
    v_fma_mix_f32 v35, v55, v27, v31 op_sel:[1,0,0] op_sel_hi:[1,0,0]
    v_mfma_f32_16x16x32_bf16 v[212:215], a[236:239], v[116:119], v[212:215]
    ds_read_b64_tr_b16 a[194:195], v3 offset:512
    ds_read_b64_tr_b16 a[196:197], v3 offset:16896
    v_cvt_pk_bf16_f32 v54, v32, v33
    v_mfma_f32_16x16x32_bf16 v[244:247], a[232:235], v[120:123], v[244:247]
    s_add_u32 m0, s44, 73728
    ds_read_b64_tr_b16 a[198:199], v3 offset:17408
    v_cvt_pk_bf16_f32 v55, v34, v35
    v_mfma_f32_16x16x32_bf16 v[244:247], a[236:239], v[124:127], v[244:247]
    s_mov_b32 s45, 2621440
    s_waitcnt lgkmcnt(10)
    buffer_load_dwordx4 v6, s[24:27], s45 offen lds
    v_mfma_f32_16x16x32_bf16 v[216:219], a[240:243], v[112:115], v[216:219]
    ds_read_b64_tr_b16 a[200:201], v3 offset:32
    v_fma_mix_f32 v36, v62, v24, v28 op_sel:[0,0,0] op_sel_hi:[1,0,0]
    v_mfma_f32_16x16x32_bf16 v[216:219], a[244:247], v[116:119], v[216:219]
    ds_read_b64_tr_b16 a[202:203], v3 offset:544
    ds_read_b64_tr_b16 a[204:205], v3 offset:16928
    v_fma_mix_f32 v37, v62, v25, v29 op_sel:[1,0,0] op_sel_hi:[1,0,0]
    v_mfma_f32_16x16x32_bf16 v[248:251], a[240:243], v[120:123], v[248:251]
    s_add_u32 m0, s44, 74784
    ds_read_b64_tr_b16 a[206:207], v3 offset:17440
    v_fma_mix_f32 v38, v63, v26, v30 op_sel:[0,0,0] op_sel_hi:[1,0,0]
    v_mfma_f32_16x16x32_bf16 v[248:251], a[244:247], v[124:127], v[248:251]
    s_mov_b32 s45, 2629632
    s_waitcnt lgkmcnt(8)
    buffer_load_dwordx4 v6, s[24:27], s45 offen lds
    v_mfma_f32_16x16x32_bf16 v[220:223], a[248:251], v[112:115], v[220:223]
    ds_read_b64_tr_b16 a[208:209], v3 offset:64
    v_fma_mix_f32 v39, v63, v27, v31 op_sel:[1,0,0] op_sel_hi:[1,0,0]
    v_mfma_f32_16x16x32_bf16 v[220:223], a[252:255], v[116:119], v[220:223]
    ds_read_b64_tr_b16 a[210:211], v3 offset:576
    ds_read_b64_tr_b16 a[212:213], v3 offset:16960
    v_cvt_pk_bf16_f32 v62, v36, v37
    v_mfma_f32_16x16x32_bf16 v[252:255], a[248:251], v[120:123], v[252:255]
    s_add_u32 m0, s44, 75840
    ds_read_b64_tr_b16 a[214:215], v3 offset:17472
    v_cvt_pk_bf16_f32 v63, v38, v39
    v_mfma_f32_16x16x32_bf16 v[252:255], a[252:255], v[124:127], v[252:255]
    s_mov_b32 s45, 2637824
    s_waitcnt lgkmcnt(8)
    buffer_load_dwordx4 v6, s[24:27], s45 offen lds
    v_mfma_f32_16x16x32_bf16 v[128:131], a[192:195], v[48:51], v[128:131]
    s_waitcnt vmcnt(15)
    ds_read_b64_tr_b16 a[216:217], v3 offset:96
    ds_read_b128 v[24:27], v9 offset:11280
    v_mfma_f32_16x16x32_bf16 v[128:131], a[196:199], v[52:55], v[128:131]
    ds_read_b64_tr_b16 a[218:219], v3 offset:608
    ds_read_b64_tr_b16 a[220:221], v3 offset:16992
    v_fma_mix_f32 v32, v64, v16, v20 op_sel:[0,0,0] op_sel_hi:[1,0,0]
    v_mfma_f32_16x16x32_bf16 v[160:163], a[192:195], v[56:59], v[160:163]
    s_add_u32 m0, s44, 76896
    ds_read_b64_tr_b16 a[222:223], v3 offset:17504
    ds_read_b128 v[28:31], v9 offset:11312
    v_mfma_f32_16x16x32_bf16 v[160:163], a[196:199], v[60:63], v[160:163]
    s_mov_b32 s45, 2646016
    s_waitcnt lgkmcnt(10)
    buffer_load_dwordx4 v6, s[24:27], s45 offen lds
    v_mfma_f32_16x16x32_bf16 v[132:135], a[200:203], v[48:51], v[132:135]
    ds_read_b64_tr_b16 a[224:225], v3 offset:128
    v_fma_mix_f32 v33, v64, v17, v21 op_sel:[1,0,0] op_sel_hi:[1,0,0]
    v_mfma_f32_16x16x32_bf16 v[132:135], a[204:207], v[52:55], v[132:135]
    ds_read_b64_tr_b16 a[226:227], v3 offset:640
    ds_read_b64_tr_b16 a[228:229], v3 offset:17024
    v_fma_mix_f32 v34, v65, v18, v22 op_sel:[0,0,0] op_sel_hi:[1,0,0]
    v_mfma_f32_16x16x32_bf16 v[164:167], a[200:203], v[56:59], v[164:167]
    s_add_u32 m0, s44, 90624
    ds_read_b64_tr_b16 a[230:231], v3 offset:17536
    v_fma_mix_f32 v35, v65, v19, v23 op_sel:[1,0,0] op_sel_hi:[1,0,0]
    v_mfma_f32_16x16x32_bf16 v[164:167], a[204:207], v[60:63], v[164:167]
    s_mov_b32 s45, 2883584
    s_waitcnt lgkmcnt(10)
    buffer_load_dwordx4 v6, s[24:27], s45 offen lds
    v_mfma_f32_16x16x32_bf16 v[136:139], a[208:211], v[48:51], v[136:139]
    ds_read_b64_tr_b16 a[232:233], v3 offset:160
    v_cvt_pk_bf16_f32 v64, v32, v33
    v_mfma_f32_16x16x32_bf16 v[136:139], a[212:215], v[52:55], v[136:139]
    ds_read_b64_tr_b16 a[234:235], v3 offset:672
    ds_read_b64_tr_b16 a[236:237], v3 offset:17056
    v_cvt_pk_bf16_f32 v65, v34, v35
    v_mfma_f32_16x16x32_bf16 v[168:171], a[208:211], v[56:59], v[168:171]
    s_add_u32 m0, s44, 91680
    ds_read_b64_tr_b16 a[238:239], v3 offset:17568
    v_fma_mix_f32 v36, v72, v16, v20 op_sel:[0,0,0] op_sel_hi:[1,0,0]
    v_mfma_f32_16x16x32_bf16 v[168:171], a[212:215], v[60:63], v[168:171]
    s_mov_b32 s45, 2891776
    s_waitcnt lgkmcnt(9)
    buffer_load_dwordx4 v6, s[24:27], s45 offen lds
    v_fma_mix_f32 v37, v72, v17, v21 op_sel:[1,0,0] op_sel_hi:[1,0,0]
    v_mfma_f32_16x16x32_bf16 v[140:143], a[216:219], v[48:51], v[140:143]
    ds_read_b64_tr_b16 a[240:241], v3 offset:192
    v_fma_mix_f32 v38, v73, v18, v22 op_sel:[0,0,0] op_sel_hi:[1,0,0]
    v_mfma_f32_16x16x32_bf16 v[140:143], a[220:223], v[52:55], v[140:143]
    ds_read_b64_tr_b16 a[242:243], v3 offset:704
    ds_read_b64_tr_b16 a[244:245], v3 offset:17088
    v_fma_mix_f32 v39, v73, v19, v23 op_sel:[1,0,0] op_sel_hi:[1,0,0]
    v_mfma_f32_16x16x32_bf16 v[172:175], a[216:219], v[56:59], v[172:175]
    s_add_u32 m0, s44, 92736
    ds_read_b64_tr_b16 a[246:247], v3 offset:17600
    v_cvt_pk_bf16_f32 v72, v36, v37
    v_mfma_f32_16x16x32_bf16 v[172:175], a[220:223], v[60:63], v[172:175]
    s_mov_b32 s45, 2899968
    s_waitcnt lgkmcnt(8)
    buffer_load_dwordx4 v6, s[24:27], s45 offen lds
    v_cvt_pk_bf16_f32 v73, v38, v39
    v_mfma_f32_16x16x32_bf16 v[144:147], a[224:227], v[48:51], v[144:147]
    ds_read_b64_tr_b16 a[248:249], v3 offset:224
    ds_read_b128 v[16:19], v9 offset:11520
    v_mfma_f32_16x16x32_bf16 v[144:147], a[228:231], v[52:55], v[144:147]
    ds_read_b64_tr_b16 a[250:251], v3 offset:736
    ds_read_b64_tr_b16 a[252:253], v3 offset:17120
    v_mfma_f32_16x16x32_bf16 v[176:179], a[224:227], v[56:59], v[176:179]
    s_add_u32 m0, s44, 93792
    ds_read_b64_tr_b16 a[254:255], v3 offset:17632
    ds_read_b128 v[20:23], v9 offset:11552
    v_mfma_f32_16x16x32_bf16 v[176:179], a[228:231], v[60:63], v[176:179]
    s_mov_b32 s45, 2908160
    s_waitcnt lgkmcnt(10)
    buffer_load_dwordx4 v6, s[24:27], s45 offen lds
    v_mfma_f32_16x16x32_bf16 v[148:151], a[232:235], v[48:51], v[148:151]
    ds_read_b64_tr_b16 a[192:193], v3 offset:256
    v_fma_mix_f32 v32, v66, v24, v28 op_sel:[0,0,0] op_sel_hi:[1,0,0]
    v_mfma_f32_16x16x32_bf16 v[148:151], a[236:239], v[52:55], v[148:151]
    ds_read_b64_tr_b16 a[194:195], v3 offset:768
    v_fma_mix_f32 v33, v66, v25, v29 op_sel:[1,0,0] op_sel_hi:[1,0,0]
    v_mfma_f32_16x16x32_bf16 v[180:183], a[232:235], v[56:59], v[180:183]
    ds_read_b64_tr_b16 a[196:197], v3 offset:17152
    v_fma_mix_f32 v34, v67, v26, v30 op_sel:[0,0,0] op_sel_hi:[1,0,0]
    v_mfma_f32_16x16x32_bf16 v[180:183], a[236:239], v[60:63], v[180:183]
    s_waitcnt lgkmcnt(9)
    ds_read_b64_tr_b16 a[198:199], v3 offset:17664
    v_fma_mix_f32 v35, v67, v27, v31 op_sel:[1,0,0] op_sel_hi:[1,0,0]
    v_mfma_f32_16x16x32_bf16 v[152:155], a[240:243], v[48:51], v[152:155]
    ds_read_b64_tr_b16 a[200:201], v3 offset:288
    v_cvt_pk_bf16_f32 v66, v32, v33
    v_mfma_f32_16x16x32_bf16 v[152:155], a[244:247], v[52:55], v[152:155]
    ds_read_b64_tr_b16 a[202:203], v3 offset:800
    v_cvt_pk_bf16_f32 v67, v34, v35
    v_mfma_f32_16x16x32_bf16 v[184:187], a[240:243], v[56:59], v[184:187]
    ds_read_b64_tr_b16 a[204:205], v3 offset:17184
    v_fma_mix_f32 v36, v74, v24, v28 op_sel:[0,0,0] op_sel_hi:[1,0,0]
    v_mfma_f32_16x16x32_bf16 v[184:187], a[244:247], v[60:63], v[184:187]
    s_waitcnt lgkmcnt(8)
    ds_read_b64_tr_b16 a[206:207], v3 offset:17696
    v_fma_mix_f32 v37, v74, v25, v29 op_sel:[1,0,0] op_sel_hi:[1,0,0]
    v_mfma_f32_16x16x32_bf16 v[156:159], a[248:251], v[48:51], v[156:159]
    ds_read_b64_tr_b16 a[208:209], v3 offset:320
    v_fma_mix_f32 v38, v75, v26, v30 op_sel:[0,0,0] op_sel_hi:[1,0,0]
    v_mfma_f32_16x16x32_bf16 v[156:159], a[252:255], v[52:55], v[156:159]
    ds_read_b64_tr_b16 a[210:211], v3 offset:832
    v_fma_mix_f32 v39, v75, v27, v31 op_sel:[1,0,0] op_sel_hi:[1,0,0]
    v_mfma_f32_16x16x32_bf16 v[188:191], a[248:251], v[56:59], v[188:191]
    ds_read_b64_tr_b16 a[212:213], v3 offset:17216
    v_cvt_pk_bf16_f32 v74, v36, v37
    v_mfma_f32_16x16x32_bf16 v[188:191], a[252:255], v[60:63], v[188:191]
    s_waitcnt lgkmcnt(7)
    ds_read_b64_tr_b16 a[214:215], v3 offset:17728
    v_cvt_pk_bf16_f32 v75, v38, v39
    v_mfma_f32_16x16x32_bf16 v[192:195], a[192:195], v[48:51], v[192:195]
    ds_read_b64_tr_b16 a[216:217], v3 offset:352
    ds_read_b128 v[24:27], v9 offset:11536
    v_mfma_f32_16x16x32_bf16 v[192:195], a[196:199], v[52:55], v[192:195]
    ds_read_b64_tr_b16 a[218:219], v3 offset:864
    ds_read_b64_tr_b16 a[220:221], v3 offset:17248
    v_fma_mix_f32 v32, v68, v16, v20 op_sel:[0,0,0] op_sel_hi:[1,0,0]
    v_mfma_f32_16x16x32_bf16 v[224:227], a[192:195], v[56:59], v[224:227]
    s_mov_b32 s54, 12288
    ds_read_b64_tr_b16 a[222:223], v3 offset:17760
    ds_read_b128 v[28:31], v9 offset:11568
    v_mfma_f32_16x16x32_bf16 v[224:227], a[196:199], v[60:63], v[224:227]
    s_waitcnt lgkmcnt(10)
    buffer_load_dwordx4 v[96:99], v8, s[32:35], s54 offen sc1
    v_mfma_f32_16x16x32_bf16 v[196:199], a[200:203], v[48:51], v[196:199]
    ds_read_b64_tr_b16 a[224:225], v3 offset:384
    v_fma_mix_f32 v33, v68, v17, v21 op_sel:[1,0,0] op_sel_hi:[1,0,0]
    v_mfma_f32_16x16x32_bf16 v[196:199], a[204:207], v[52:55], v[196:199]
    ds_read_b64_tr_b16 a[226:227], v3 offset:896
    ds_read_b64_tr_b16 a[228:229], v3 offset:17280
    v_fma_mix_f32 v34, v69, v18, v22 op_sel:[0,0,0] op_sel_hi:[1,0,0]
    v_mfma_f32_16x16x32_bf16 v[228:231], a[200:203], v[56:59], v[228:231]
    s_mov_b32 s54, 13312
    ds_read_b64_tr_b16 a[230:231], v3 offset:17792
    v_fma_mix_f32 v35, v69, v19, v23 op_sel:[1,0,0] op_sel_hi:[1,0,0]
    v_mfma_f32_16x16x32_bf16 v[228:231], a[204:207], v[60:63], v[228:231]
    s_waitcnt lgkmcnt(10)
    buffer_load_dwordx4 v[100:103], v8, s[32:35], s54 offen sc1
    v_mfma_f32_16x16x32_bf16 v[200:203], a[208:211], v[48:51], v[200:203]
    ds_read_b64_tr_b16 a[232:233], v3 offset:416
    v_cvt_pk_bf16_f32 v68, v32, v33
    v_mfma_f32_16x16x32_bf16 v[200:203], a[212:215], v[52:55], v[200:203]
    ds_read_b64_tr_b16 a[234:235], v3 offset:928
    ds_read_b64_tr_b16 a[236:237], v3 offset:17312
    v_cvt_pk_bf16_f32 v69, v34, v35
    v_mfma_f32_16x16x32_bf16 v[232:235], a[208:211], v[56:59], v[232:235]
    s_mov_b32 s54, 30720
    ds_read_b64_tr_b16 a[238:239], v3 offset:17824
    v_fma_mix_f32 v36, v76, v16, v20 op_sel:[0,0,0] op_sel_hi:[1,0,0]
    v_mfma_f32_16x16x32_bf16 v[232:235], a[212:215], v[60:63], v[232:235]
    s_waitcnt lgkmcnt(9)
    buffer_load_dwordx4 v[104:107], v8, s[32:35], s54 offen sc1
    v_fma_mix_f32 v37, v76, v17, v21 op_sel:[1,0,0] op_sel_hi:[1,0,0]
    v_mfma_f32_16x16x32_bf16 v[204:207], a[216:219], v[48:51], v[204:207]
    ds_read_b64_tr_b16 a[240:241], v3 offset:448
    v_fma_mix_f32 v38, v77, v18, v22 op_sel:[0,0,0] op_sel_hi:[1,0,0]
    v_mfma_f32_16x16x32_bf16 v[204:207], a[220:223], v[52:55], v[204:207]
    ds_read_b64_tr_b16 a[242:243], v3 offset:960
    ds_read_b64_tr_b16 a[244:245], v3 offset:17344
    v_fma_mix_f32 v39, v77, v19, v23 op_sel:[1,0,0] op_sel_hi:[1,0,0]
    v_mfma_f32_16x16x32_bf16 v[236:239], a[216:219], v[56:59], v[236:239]
    s_mov_b32 s54, 31744
    ds_read_b64_tr_b16 a[246:247], v3 offset:17856
    v_cvt_pk_bf16_f32 v76, v36, v37
    v_mfma_f32_16x16x32_bf16 v[236:239], a[220:223], v[60:63], v[236:239]
    s_waitcnt lgkmcnt(8)
    buffer_load_dwordx4 v[108:111], v8, s[32:35], s54 offen sc1
    v_cvt_pk_bf16_f32 v77, v38, v39
    v_mfma_f32_16x16x32_bf16 v[208:211], a[224:227], v[48:51], v[208:211]
    ds_read_b64_tr_b16 a[248:249], v3 offset:480
    ds_read_b128 v[16:19], v9 offset:11776
    v_mfma_f32_16x16x32_bf16 v[208:211], a[228:231], v[52:55], v[208:211]
    ds_read_b64_tr_b16 a[250:251], v3 offset:992
    ds_read_b128 v[20:23], v9 offset:11808
    v_mfma_f32_16x16x32_bf16 v[240:243], a[224:227], v[56:59], v[240:243]
    ds_read_b64_tr_b16 a[252:253], v3 offset:17376
    v_fma_mix_f32 v32, v70, v24, v28 op_sel:[0,0,0] op_sel_hi:[1,0,0]
    v_mfma_f32_16x16x32_bf16 v[240:243], a[228:231], v[60:63], v[240:243]
    s_waitcnt vmcnt(16)
    s_barrier
    s_waitcnt lgkmcnt(9)
    ds_read_b64_tr_b16 a[254:255], v3 offset:17888
    v_fma_mix_f32 v33, v70, v25, v29 op_sel:[1,0,0] op_sel_hi:[1,0,0]
    v_fma_mix_f32 v34, v71, v26, v30 op_sel:[0,0,0] op_sel_hi:[1,0,0]
    v_mfma_f32_16x16x32_bf16 v[212:215], a[232:235], v[48:51], v[212:215]
    ds_read_b64_tr_b16 a[192:193], v3 offset:36864
    v_fma_mix_f32 v35, v71, v27, v31 op_sel:[1,0,0] op_sel_hi:[1,0,0]
    v_mfma_f32_16x16x32_bf16 v[212:215], a[236:239], v[52:55], v[212:215]
    ds_read_b64_tr_b16 a[194:195], v3 offset:37376
    ds_read_b64_tr_b16 a[196:197], v3 offset:53760
    v_cvt_pk_bf16_f32 v70, v32, v33
    v_mfma_f32_16x16x32_bf16 v[244:247], a[232:235], v[56:59], v[244:247]
    s_add_u32 m0, s44, 110592
    ds_read_b64_tr_b16 a[198:199], v3 offset:54272
    v_cvt_pk_bf16_f32 v71, v34, v35
    v_mfma_f32_16x16x32_bf16 v[244:247], a[236:239], v[60:63], v[244:247]
    s_mov_b32 s45, 3145728
    s_waitcnt lgkmcnt(10)
    buffer_load_dwordx4 v6, s[24:27], s45 offen lds
    v_mfma_f32_16x16x32_bf16 v[216:219], a[240:243], v[48:51], v[216:219]
    ds_read_b64_tr_b16 a[200:201], v3 offset:36896
    v_fma_mix_f32 v36, v78, v24, v28 op_sel:[0,0,0] op_sel_hi:[1,0,0]
    v_mfma_f32_16x16x32_bf16 v[216:219], a[244:247], v[52:55], v[216:219]
    ds_read_b64_tr_b16 a[202:203], v3 offset:37408
    ds_read_b64_tr_b16 a[204:205], v3 offset:53792
    v_fma_mix_f32 v37, v78, v25, v29 op_sel:[1,0,0] op_sel_hi:[1,0,0]
    v_mfma_f32_16x16x32_bf16 v[248:251], a[240:243], v[56:59], v[248:251]
    s_add_u32 m0, s44, 111648
    ds_read_b64_tr_b16 a[206:207], v3 offset:54304
    v_fma_mix_f32 v38, v79, v26, v30 op_sel:[0,0,0] op_sel_hi:[1,0,0]
    v_mfma_f32_16x16x32_bf16 v[248:251], a[244:247], v[60:63], v[248:251]
    s_mov_b32 s45, 3153920
    s_waitcnt lgkmcnt(8)
    buffer_load_dwordx4 v6, s[24:27], s45 offen lds
    v_mfma_f32_16x16x32_bf16 v[220:223], a[248:251], v[48:51], v[220:223]
L2_pad1:
    s_cbranch_execz L2_pad5
    ds_read_b64_tr_b16 a[208:209], v3 offset:36928
    v_fma_mix_f32 v39, v79, v27, v31 op_sel:[1,0,0] op_sel_hi:[1,0,0]
    v_mfma_f32_16x16x32_bf16 v[220:223], a[252:255], v[52:55], v[220:223]
    ds_read_b64_tr_b16 a[210:211], v3 offset:37440
    ds_read_b64_tr_b16 a[212:213], v3 offset:53824
    v_cvt_pk_bf16_f32 v78, v36, v37
    v_mfma_f32_16x16x32_bf16 v[252:255], a[248:251], v[56:59], v[252:255]
    s_add_u32 m0, s44, 112704
    ds_read_b64_tr_b16 a[214:215], v3 offset:54336
    v_cvt_pk_bf16_f32 v79, v38, v39
    v_mfma_f32_16x16x32_bf16 v[252:255], a[252:255], v[60:63], v[252:255]
    s_mov_b32 s45, 3162112
    s_waitcnt lgkmcnt(8)
    buffer_load_dwordx4 v6, s[24:27], s45 offen lds
    v_mfma_f32_16x16x32_bf16 v[128:131], a[192:195], v[64:67], v[128:131]
    s_waitcnt vmcnt(15)
    ds_read_b64_tr_b16 a[216:217], v3 offset:36960
    ds_read_b128 v[24:27], v9 offset:11792
    v_mfma_f32_16x16x32_bf16 v[128:131], a[196:199], v[68:71], v[128:131]
    ds_read_b64_tr_b16 a[218:219], v3 offset:37472
    ds_read_b64_tr_b16 a[220:221], v3 offset:53856
    v_fma_mix_f32 v32, v80, v16, v20 op_sel:[0,0,0] op_sel_hi:[1,0,0]
    v_mfma_f32_16x16x32_bf16 v[160:163], a[192:195], v[72:75], v[160:163]
    s_add_u32 m0, s44, 113760
    ds_read_b64_tr_b16 a[222:223], v3 offset:54368
    ds_read_b128 v[28:31], v9 offset:11824
    v_mfma_f32_16x16x32_bf16 v[160:163], a[196:199], v[76:79], v[160:163]
    s_mov_b32 s45, 3170304
    s_waitcnt lgkmcnt(10)
    buffer_load_dwordx4 v6, s[24:27], s45 offen lds
    v_mfma_f32_16x16x32_bf16 v[132:135], a[200:203], v[64:67], v[132:135]
    ds_read_b64_tr_b16 a[224:225], v3 offset:36992
    v_fma_mix_f32 v33, v80, v17, v21 op_sel:[1,0,0] op_sel_hi:[1,0,0]
    v_mfma_f32_16x16x32_bf16 v[132:135], a[204:207], v[68:71], v[132:135]
    ds_read_b64_tr_b16 a[226:227], v3 offset:37504
    ds_read_b64_tr_b16 a[228:229], v3 offset:53888
    v_fma_mix_f32 v34, v81, v18, v22 op_sel:[0,0,0] op_sel_hi:[1,0,0]
    v_mfma_f32_16x16x32_bf16 v[164:167], a[200:203], v[72:75], v[164:167]
    s_add_u32 m0, s44, 127488
    ds_read_b64_tr_b16 a[230:231], v3 offset:54400
    v_fma_mix_f32 v35, v81, v19, v23 op_sel:[1,0,0] op_sel_hi:[1,0,0]
    v_mfma_f32_16x16x32_bf16 v[164:167], a[204:207], v[76:79], v[164:167]
    s_mov_b32 s45, 3407872
    s_waitcnt lgkmcnt(10)
    buffer_load_dwordx4 v6, s[24:27], s45 offen lds
    v_mfma_f32_16x16x32_bf16 v[136:139], a[208:211], v[64:67], v[136:139]
    ds_read_b64_tr_b16 a[232:233], v3 offset:37024
    v_cvt_pk_bf16_f32 v80, v32, v33
    v_mfma_f32_16x16x32_bf16 v[136:139], a[212:215], v[68:71], v[136:139]
    ds_read_b64_tr_b16 a[234:235], v3 offset:37536
    ds_read_b64_tr_b16 a[236:237], v3 offset:53920
    v_cvt_pk_bf16_f32 v81, v34, v35
    v_mfma_f32_16x16x32_bf16 v[168:171], a[208:211], v[72:75], v[168:171]
    s_add_u32 m0, s44, 128544
    ds_read_b64_tr_b16 a[238:239], v3 offset:54432
    v_fma_mix_f32 v36, v88, v16, v20 op_sel:[0,0,0] op_sel_hi:[1,0,0]
    v_mfma_f32_16x16x32_bf16 v[168:171], a[212:215], v[76:79], v[168:171]
    s_mov_b32 s45, 3416064
    s_waitcnt lgkmcnt(9)
    buffer_load_dwordx4 v6, s[24:27], s45 offen lds
    v_fma_mix_f32 v37, v88, v17, v21 op_sel:[1,0,0] op_sel_hi:[1,0,0]
    v_mfma_f32_16x16x32_bf16 v[140:143], a[216:219], v[64:67], v[140:143]
    ds_read_b64_tr_b16 a[240:241], v3 offset:37056
    v_fma_mix_f32 v38, v89, v18, v22 op_sel:[0,0,0] op_sel_hi:[1,0,0]
    v_mfma_f32_16x16x32_bf16 v[140:143], a[220:223], v[68:71], v[140:143]
    ds_read_b64_tr_b16 a[242:243], v3 offset:37568
    ds_read_b64_tr_b16 a[244:245], v3 offset:53952
    v_fma_mix_f32 v39, v89, v19, v23 op_sel:[1,0,0] op_sel_hi:[1,0,0]
    v_mfma_f32_16x16x32_bf16 v[172:175], a[216:219], v[72:75], v[172:175]
    s_add_u32 m0, s44, 129600
    ds_read_b64_tr_b16 a[246:247], v3 offset:54464
    v_cvt_pk_bf16_f32 v88, v36, v37
    v_mfma_f32_16x16x32_bf16 v[172:175], a[220:223], v[76:79], v[172:175]
    s_mov_b32 s45, 3424256
    s_waitcnt lgkmcnt(8)
    buffer_load_dwordx4 v6, s[24:27], s45 offen lds
    v_cvt_pk_bf16_f32 v89, v38, v39
    v_mfma_f32_16x16x32_bf16 v[144:147], a[224:227], v[64:67], v[144:147]
    ds_read_b64_tr_b16 a[248:249], v3 offset:37088
    ds_read_b128 v[16:19], v9 offset:12032
    v_mfma_f32_16x16x32_bf16 v[144:147], a[228:231], v[68:71], v[144:147]
    ds_read_b64_tr_b16 a[250:251], v3 offset:37600
    ds_read_b64_tr_b16 a[252:253], v3 offset:53984
    v_mfma_f32_16x16x32_bf16 v[176:179], a[224:227], v[72:75], v[176:179]
    s_add_u32 m0, s44, 130656
    ds_read_b64_tr_b16 a[254:255], v3 offset:54496
    ds_read_b128 v[20:23], v9 offset:12064
    v_mfma_f32_16x16x32_bf16 v[176:179], a[228:231], v[76:79], v[176:179]
    s_mov_b32 s45, 3432448
    s_waitcnt lgkmcnt(10)
    buffer_load_dwordx4 v6, s[24:27], s45 offen lds
    v_mfma_f32_16x16x32_bf16 v[148:151], a[232:235], v[64:67], v[148:151]
    ds_read_b64_tr_b16 a[192:193], v3 offset:37120
    v_fma_mix_f32 v32, v82, v24, v28 op_sel:[0,0,0] op_sel_hi:[1,0,0]
    v_mfma_f32_16x16x32_bf16 v[148:151], a[236:239], v[68:71], v[148:151]
    ds_read_b64_tr_b16 a[194:195], v3 offset:37632
    v_fma_mix_f32 v33, v82, v25, v29 op_sel:[1,0,0] op_sel_hi:[1,0,0]
    v_mfma_f32_16x16x32_bf16 v[180:183], a[232:235], v[72:75], v[180:183]
    ds_read_b64_tr_b16 a[196:197], v3 offset:54016
    v_fma_mix_f32 v34, v83, v26, v30 op_sel:[0,0,0] op_sel_hi:[1,0,0]
    v_mfma_f32_16x16x32_bf16 v[180:183], a[236:239], v[76:79], v[180:183]
    s_waitcnt lgkmcnt(9)
    ds_read_b64_tr_b16 a[198:199], v3 offset:54528
    v_fma_mix_f32 v35, v83, v27, v31 op_sel:[1,0,0] op_sel_hi:[1,0,0]
    v_mfma_f32_16x16x32_bf16 v[152:155], a[240:243], v[64:67], v[152:155]
    ds_read_b64_tr_b16 a[200:201], v3 offset:37152
    v_cvt_pk_bf16_f32 v82, v32, v33
    v_mfma_f32_16x16x32_bf16 v[152:155], a[244:247], v[68:71], v[152:155]
    ds_read_b64_tr_b16 a[202:203], v3 offset:37664
    v_cvt_pk_bf16_f32 v83, v34, v35
    v_mfma_f32_16x16x32_bf16 v[184:187], a[240:243], v[72:75], v[184:187]
    ds_read_b64_tr_b16 a[204:205], v3 offset:54048
    v_fma_mix_f32 v36, v90, v24, v28 op_sel:[0,0,0] op_sel_hi:[1,0,0]
    v_mfma_f32_16x16x32_bf16 v[184:187], a[244:247], v[76:79], v[184:187]
    s_waitcnt lgkmcnt(8)
    ds_read_b64_tr_b16 a[206:207], v3 offset:54560
    v_fma_mix_f32 v37, v90, v25, v29 op_sel:[1,0,0] op_sel_hi:[1,0,0]
    v_mfma_f32_16x16x32_bf16 v[156:159], a[248:251], v[64:67], v[156:159]
    ds_read_b64_tr_b16 a[208:209], v3 offset:37184
    v_fma_mix_f32 v38, v91, v26, v30 op_sel:[0,0,0] op_sel_hi:[1,0,0]
    v_mfma_f32_16x16x32_bf16 v[156:159], a[252:255], v[68:71], v[156:159]
    ds_read_b64_tr_b16 a[210:211], v3 offset:37696
    v_fma_mix_f32 v39, v91, v27, v31 op_sel:[1,0,0] op_sel_hi:[1,0,0]
    v_mfma_f32_16x16x32_bf16 v[188:191], a[248:251], v[72:75], v[188:191]
    ds_read_b64_tr_b16 a[212:213], v3 offset:54080
    v_cvt_pk_bf16_f32 v90, v36, v37
    v_mfma_f32_16x16x32_bf16 v[188:191], a[252:255], v[76:79], v[188:191]
    s_waitcnt lgkmcnt(7)
    ds_read_b64_tr_b16 a[214:215], v3 offset:54592
    v_cvt_pk_bf16_f32 v91, v38, v39
    v_mfma_f32_16x16x32_bf16 v[192:195], a[192:195], v[64:67], v[192:195]
    ds_read_b64_tr_b16 a[216:217], v3 offset:37216
    ds_read_b128 v[24:27], v9 offset:12048
    v_mfma_f32_16x16x32_bf16 v[192:195], a[196:199], v[68:71], v[192:195]
    ds_read_b64_tr_b16 a[218:219], v3 offset:37728
    ds_read_b64_tr_b16 a[220:221], v3 offset:54112
    v_fma_mix_f32 v32, v84, v16, v20 op_sel:[0,0,0] op_sel_hi:[1,0,0]
    v_mfma_f32_16x16x32_bf16 v[224:227], a[192:195], v[72:75], v[224:227]
    s_mov_b32 s54, 14336
    ds_read_b64_tr_b16 a[222:223], v3 offset:54624
    ds_read_b128 v[28:31], v9 offset:12080
    v_mfma_f32_16x16x32_bf16 v[224:227], a[196:199], v[76:79], v[224:227]
    s_waitcnt lgkmcnt(10)
    buffer_load_dwordx4 v[112:115], v8, s[32:35], s54 offen sc1
    v_mfma_f32_16x16x32_bf16 v[196:199], a[200:203], v[64:67], v[196:199]
    ds_read_b64_tr_b16 a[224:225], v3 offset:37248
    v_fma_mix_f32 v33, v84, v17, v21 op_sel:[1,0,0] op_sel_hi:[1,0,0]
    v_mfma_f32_16x16x32_bf16 v[196:199], a[204:207], v[68:71], v[196:199]
    ds_read_b64_tr_b16 a[226:227], v3 offset:37760
    ds_read_b64_tr_b16 a[228:229], v3 offset:54144
    v_fma_mix_f32 v34, v85, v18, v22 op_sel:[0,0,0] op_sel_hi:[1,0,0]
    v_mfma_f32_16x16x32_bf16 v[228:231], a[200:203], v[72:75], v[228:231]
    s_mov_b32 s54, 15360
    ds_read_b64_tr_b16 a[230:231], v3 offset:54656
    v_fma_mix_f32 v35, v85, v19, v23 op_sel:[1,0,0] op_sel_hi:[1,0,0]
    v_mfma_f32_16x16x32_bf16 v[228:231], a[204:207], v[76:79], v[228:231]
    s_waitcnt lgkmcnt(10)
    buffer_load_dwordx4 v[116:119], v8, s[32:35], s54 offen sc1
    v_mfma_f32_16x16x32_bf16 v[200:203], a[208:211], v[64:67], v[200:203]
    ds_read_b64_tr_b16 a[232:233], v3 offset:37280
    v_cvt_pk_bf16_f32 v84, v32, v33
    v_mfma_f32_16x16x32_bf16 v[200:203], a[212:215], v[68:71], v[200:203]
    ds_read_b64_tr_b16 a[234:235], v3 offset:37792
    ds_read_b64_tr_b16 a[236:237], v3 offset:54176
    v_cvt_pk_bf16_f32 v85, v34, v35
    v_mfma_f32_16x16x32_bf16 v[232:235], a[208:211], v[72:75], v[232:235]
    s_mov_b32 s54, 32768
    ds_read_b64_tr_b16 a[238:239], v3 offset:54688
    v_fma_mix_f32 v36, v92, v16, v20 op_sel:[0,0,0] op_sel_hi:[1,0,0]
    v_mfma_f32_16x16x32_bf16 v[232:235], a[212:215], v[76:79], v[232:235]
    s_waitcnt lgkmcnt(9)
    buffer_load_dwordx4 v[120:123], v8, s[32:35], s54 offen sc1
    v_fma_mix_f32 v37, v92, v17, v21 op_sel:[1,0,0] op_sel_hi:[1,0,0]
    v_mfma_f32_16x16x32_bf16 v[204:207], a[216:219], v[64:67], v[204:207]
    ds_read_b64_tr_b16 a[240:241], v3 offset:37312
    v_fma_mix_f32 v38, v93, v18, v22 op_sel:[0,0,0] op_sel_hi:[1,0,0]
    v_mfma_f32_16x16x32_bf16 v[204:207], a[220:223], v[68:71], v[204:207]
    ds_read_b64_tr_b16 a[242:243], v3 offset:37824
    ds_read_b64_tr_b16 a[244:245], v3 offset:54208
    v_fma_mix_f32 v39, v93, v19, v23 op_sel:[1,0,0] op_sel_hi:[1,0,0]
    v_mfma_f32_16x16x32_bf16 v[236:239], a[216:219], v[72:75], v[236:239]
    s_mov_b32 s54, 33792
    ds_read_b64_tr_b16 a[246:247], v3 offset:54720
    v_cvt_pk_bf16_f32 v92, v36, v37
    v_mfma_f32_16x16x32_bf16 v[236:239], a[220:223], v[76:79], v[236:239]
    s_waitcnt lgkmcnt(8)
    buffer_load_dwordx4 v[124:127], v8, s[32:35], s54 offen sc1
    v_cvt_pk_bf16_f32 v93, v38, v39
    v_mfma_f32_16x16x32_bf16 v[208:211], a[224:227], v[64:67], v[208:211]
    ds_read_b64_tr_b16 a[248:249], v3 offset:37344
    ds_read_b128 v[16:19], v9 offset:12288
    v_mfma_f32_16x16x32_bf16 v[208:211], a[228:231], v[68:71], v[208:211]
    ds_read_b64_tr_b16 a[250:251], v3 offset:37856
    ds_read_b128 v[20:23], v9 offset:12320
    v_mfma_f32_16x16x32_bf16 v[240:243], a[224:227], v[72:75], v[240:243]
    ds_read_b64_tr_b16 a[252:253], v3 offset:54240
    v_fma_mix_f32 v32, v86, v24, v28 op_sel:[0,0,0] op_sel_hi:[1,0,0]
    v_mfma_f32_16x16x32_bf16 v[240:243], a[228:231], v[76:79], v[240:243]
    s_waitcnt vmcnt(16)
    s_barrier
    s_waitcnt lgkmcnt(9)
    ds_read_b64_tr_b16 a[254:255], v3 offset:54752
    v_fma_mix_f32 v33, v86, v25, v29 op_sel:[1,0,0] op_sel_hi:[1,0,0]
    v_fma_mix_f32 v34, v87, v26, v30 op_sel:[0,0,0] op_sel_hi:[1,0,0]
    v_mfma_f32_16x16x32_bf16 v[212:215], a[232:235], v[64:67], v[212:215]
    ds_read_b64_tr_b16 a[192:193], v4 offset:0
    v_fma_mix_f32 v35, v87, v27, v31 op_sel:[1,0,0] op_sel_hi:[1,0,0]
    v_mfma_f32_16x16x32_bf16 v[212:215], a[236:239], v[68:71], v[212:215]
    ds_read_b64_tr_b16 a[194:195], v4 offset:512
    ds_read_b64_tr_b16 a[196:197], v4 offset:16896
    v_cvt_pk_bf16_f32 v86, v32, v33
    v_mfma_f32_16x16x32_bf16 v[244:247], a[232:235], v[72:75], v[244:247]
    s_add_u32 m0, s44, 0
    ds_read_b64_tr_b16 a[198:199], v4 offset:17408
    v_cvt_pk_bf16_f32 v87, v34, v35
    v_mfma_f32_16x16x32_bf16 v[244:247], a[236:239], v[76:79], v[244:247]
    s_mov_b32 s45, 3670016
    s_waitcnt lgkmcnt(10)
    buffer_load_dwordx4 v6, s[24:27], s45 offen lds
    v_mfma_f32_16x16x32_bf16 v[216:219], a[240:243], v[64:67], v[216:219]
    ds_read_b64_tr_b16 a[200:201], v4 offset:32
    v_fma_mix_f32 v36, v94, v24, v28 op_sel:[0,0,0] op_sel_hi:[1,0,0]
    v_mfma_f32_16x16x32_bf16 v[216:219], a[244:247], v[68:71], v[216:219]
    ds_read_b64_tr_b16 a[202:203], v4 offset:544
    ds_read_b64_tr_b16 a[204:205], v4 offset:16928
    v_fma_mix_f32 v37, v94, v25, v29 op_sel:[1,0,0] op_sel_hi:[1,0,0]
    v_mfma_f32_16x16x32_bf16 v[248:251], a[240:243], v[72:75], v[248:251]
    s_add_u32 m0, s44, 1056
    ds_read_b64_tr_b16 a[206:207], v4 offset:17440
    v_fma_mix_f32 v38, v95, v26, v30 op_sel:[0,0,0] op_sel_hi:[1,0,0]
    v_mfma_f32_16x16x32_bf16 v[248:251], a[244:247], v[76:79], v[248:251]
    s_mov_b32 s45, 3678208
    s_waitcnt lgkmcnt(8)
    buffer_load_dwordx4 v6, s[24:27], s45 offen lds
    v_mfma_f32_16x16x32_bf16 v[220:223], a[248:251], v[64:67], v[220:223]
    ds_read_b64_tr_b16 a[208:209], v4 offset:64
    v_fma_mix_f32 v39, v95, v27, v31 op_sel:[1,0,0] op_sel_hi:[1,0,0]
    v_mfma_f32_16x16x32_bf16 v[220:223], a[252:255], v[68:71], v[220:223]
    ds_read_b64_tr_b16 a[210:211], v4 offset:576
    ds_read_b64_tr_b16 a[212:213], v4 offset:16960
    v_cvt_pk_bf16_f32 v94, v36, v37
    v_mfma_f32_16x16x32_bf16 v[252:255], a[248:251], v[72:75], v[252:255]
    s_add_u32 m0, s44, 2112
    ds_read_b64_tr_b16 a[214:215], v4 offset:17472
    v_cvt_pk_bf16_f32 v95, v38, v39
    v_mfma_f32_16x16x32_bf16 v[252:255], a[252:255], v[76:79], v[252:255]
    s_mov_b32 s45, 3686400
    s_waitcnt lgkmcnt(8)
    buffer_load_dwordx4 v6, s[24:27], s45 offen lds
    v_mfma_f32_16x16x32_bf16 v[128:131], a[192:195], v[80:83], v[128:131]
    s_waitcnt vmcnt(15)
    ds_read_b64_tr_b16 a[216:217], v4 offset:96
    ds_read_b128 v[24:27], v9 offset:12304
    v_mfma_f32_16x16x32_bf16 v[128:131], a[196:199], v[84:87], v[128:131]
    ds_read_b64_tr_b16 a[218:219], v4 offset:608
    ds_read_b64_tr_b16 a[220:221], v4 offset:16992
    v_fma_mix_f32 v32, v96, v16, v20 op_sel:[0,0,0] op_sel_hi:[1,0,0]
    v_mfma_f32_16x16x32_bf16 v[160:163], a[192:195], v[88:91], v[160:163]
    s_add_u32 m0, s44, 3168
    ds_read_b64_tr_b16 a[222:223], v4 offset:17504
    ds_read_b128 v[28:31], v9 offset:12336
    v_mfma_f32_16x16x32_bf16 v[160:163], a[196:199], v[92:95], v[160:163]
    s_mov_b32 s45, 3694592
    s_waitcnt lgkmcnt(10)
    buffer_load_dwordx4 v6, s[24:27], s45 offen lds
    v_mfma_f32_16x16x32_bf16 v[132:135], a[200:203], v[80:83], v[132:135]
    ds_read_b64_tr_b16 a[224:225], v4 offset:128
    v_fma_mix_f32 v33, v96, v17, v21 op_sel:[1,0,0] op_sel_hi:[1,0,0]
    v_mfma_f32_16x16x32_bf16 v[132:135], a[204:207], v[84:87], v[132:135]
    ds_read_b64_tr_b16 a[226:227], v4 offset:640
    ds_read_b64_tr_b16 a[228:229], v4 offset:17024
    v_fma_mix_f32 v34, v97, v18, v22 op_sel:[0,0,0] op_sel_hi:[1,0,0]
    v_mfma_f32_16x16x32_bf16 v[164:167], a[200:203], v[88:91], v[164:167]
    s_add_u32 m0, s44, 16896
    ds_read_b64_tr_b16 a[230:231], v4 offset:17536
    v_fma_mix_f32 v35, v97, v19, v23 op_sel:[1,0,0] op_sel_hi:[1,0,0]
    v_mfma_f32_16x16x32_bf16 v[164:167], a[204:207], v[92:95], v[164:167]
    s_mov_b32 s45, 3932160
    s_waitcnt lgkmcnt(10)
    buffer_load_dwordx4 v6, s[24:27], s45 offen lds
    v_mfma_f32_16x16x32_bf16 v[136:139], a[208:211], v[80:83], v[136:139]
    ds_read_b64_tr_b16 a[232:233], v4 offset:160
    v_cvt_pk_bf16_f32 v96, v32, v33
    v_mfma_f32_16x16x32_bf16 v[136:139], a[212:215], v[84:87], v[136:139]
    ds_read_b64_tr_b16 a[234:235], v4 offset:672
    ds_read_b64_tr_b16 a[236:237], v4 offset:17056
    v_cvt_pk_bf16_f32 v97, v34, v35
    v_mfma_f32_16x16x32_bf16 v[168:171], a[208:211], v[88:91], v[168:171]
    s_add_u32 m0, s44, 17952
    ds_read_b64_tr_b16 a[238:239], v4 offset:17568
    v_fma_mix_f32 v36, v104, v16, v20 op_sel:[0,0,0] op_sel_hi:[1,0,0]
    v_mfma_f32_16x16x32_bf16 v[168:171], a[212:215], v[92:95], v[168:171]
    s_mov_b32 s45, 3940352
    s_waitcnt lgkmcnt(9)
    buffer_load_dwordx4 v6, s[24:27], s45 offen lds
    v_fma_mix_f32 v37, v104, v17, v21 op_sel:[1,0,0] op_sel_hi:[1,0,0]
    v_mfma_f32_16x16x32_bf16 v[140:143], a[216:219], v[80:83], v[140:143]
    ds_read_b64_tr_b16 a[240:241], v4 offset:192
    v_fma_mix_f32 v38, v105, v18, v22 op_sel:[0,0,0] op_sel_hi:[1,0,0]
    v_mfma_f32_16x16x32_bf16 v[140:143], a[220:223], v[84:87], v[140:143]
    ds_read_b64_tr_b16 a[242:243], v4 offset:704
    ds_read_b64_tr_b16 a[244:245], v4 offset:17088
    v_fma_mix_f32 v39, v105, v19, v23 op_sel:[1,0,0] op_sel_hi:[1,0,0]
    v_mfma_f32_16x16x32_bf16 v[172:175], a[216:219], v[88:91], v[172:175]
    s_add_u32 m0, s44, 19008
    ds_read_b64_tr_b16 a[246:247], v4 offset:17600
    v_cvt_pk_bf16_f32 v104, v36, v37
    v_mfma_f32_16x16x32_bf16 v[172:175], a[220:223], v[92:95], v[172:175]
    s_mov_b32 s45, 3948544
    s_waitcnt lgkmcnt(8)
    buffer_load_dwordx4 v6, s[24:27], s45 offen lds
    v_cvt_pk_bf16_f32 v105, v38, v39
    v_mfma_f32_16x16x32_bf16 v[144:147], a[224:227], v[80:83], v[144:147]
    ds_read_b64_tr_b16 a[248:249], v4 offset:224
    ds_read_b128 v[16:19], v9 offset:12544
    v_mfma_f32_16x16x32_bf16 v[144:147], a[228:231], v[84:87], v[144:147]
    ds_read_b64_tr_b16 a[250:251], v4 offset:736
    ds_read_b64_tr_b16 a[252:253], v4 offset:17120
    v_mfma_f32_16x16x32_bf16 v[176:179], a[224:227], v[88:91], v[176:179]
    s_add_u32 m0, s44, 20064
    ds_read_b64_tr_b16 a[254:255], v4 offset:17632
    ds_read_b128 v[20:23], v9 offset:12576
    v_mfma_f32_16x16x32_bf16 v[176:179], a[228:231], v[92:95], v[176:179]
    s_mov_b32 s45, 3956736
    s_waitcnt lgkmcnt(10)
    buffer_load_dwordx4 v6, s[24:27], s45 offen lds
    v_mfma_f32_16x16x32_bf16 v[148:151], a[232:235], v[80:83], v[148:151]
    ds_read_b64_tr_b16 a[192:193], v4 offset:256
    v_fma_mix_f32 v32, v98, v24, v28 op_sel:[0,0,0] op_sel_hi:[1,0,0]
    v_mfma_f32_16x16x32_bf16 v[148:151], a[236:239], v[84:87], v[148:151]
    ds_read_b64_tr_b16 a[194:195], v4 offset:768
    v_fma_mix_f32 v33, v98, v25, v29 op_sel:[1,0,0] op_sel_hi:[1,0,0]
    v_mfma_f32_16x16x32_bf16 v[180:183], a[232:235], v[88:91], v[180:183]
    ds_read_b64_tr_b16 a[196:197], v4 offset:17152
    v_fma_mix_f32 v34, v99, v26, v30 op_sel:[0,0,0] op_sel_hi:[1,0,0]
    v_mfma_f32_16x16x32_bf16 v[180:183], a[236:239], v[92:95], v[180:183]
    s_waitcnt lgkmcnt(9)
    ds_read_b64_tr_b16 a[198:199], v4 offset:17664
    v_fma_mix_f32 v35, v99, v27, v31 op_sel:[1,0,0] op_sel_hi:[1,0,0]
    v_mfma_f32_16x16x32_bf16 v[152:155], a[240:243], v[80:83], v[152:155]
    ds_read_b64_tr_b16 a[200:201], v4 offset:288
    v_cvt_pk_bf16_f32 v98, v32, v33
    v_mfma_f32_16x16x32_bf16 v[152:155], a[244:247], v[84:87], v[152:155]
    ds_read_b64_tr_b16 a[202:203], v4 offset:800
    v_cvt_pk_bf16_f32 v99, v34, v35
    v_mfma_f32_16x16x32_bf16 v[184:187], a[240:243], v[88:91], v[184:187]
    ds_read_b64_tr_b16 a[204:205], v4 offset:17184
    v_fma_mix_f32 v36, v106, v24, v28 op_sel:[0,0,0] op_sel_hi:[1,0,0]
    v_mfma_f32_16x16x32_bf16 v[184:187], a[244:247], v[92:95], v[184:187]
    s_waitcnt lgkmcnt(8)
    ds_read_b64_tr_b16 a[206:207], v4 offset:17696
    v_fma_mix_f32 v37, v106, v25, v29 op_sel:[1,0,0] op_sel_hi:[1,0,0]
    v_mfma_f32_16x16x32_bf16 v[156:159], a[248:251], v[80:83], v[156:159]
    ds_read_b64_tr_b16 a[208:209], v4 offset:320
    v_fma_mix_f32 v38, v107, v26, v30 op_sel:[0,0,0] op_sel_hi:[1,0,0]
    v_mfma_f32_16x16x32_bf16 v[156:159], a[252:255], v[84:87], v[156:159]
    ds_read_b64_tr_b16 a[210:211], v4 offset:832
    v_fma_mix_f32 v39, v107, v27, v31 op_sel:[1,0,0] op_sel_hi:[1,0,0]
    v_mfma_f32_16x16x32_bf16 v[188:191], a[248:251], v[88:91], v[188:191]
    ds_read_b64_tr_b16 a[212:213], v4 offset:17216
    v_cvt_pk_bf16_f32 v106, v36, v37
    v_mfma_f32_16x16x32_bf16 v[188:191], a[252:255], v[92:95], v[188:191]
    s_waitcnt lgkmcnt(7)
    ds_read_b64_tr_b16 a[214:215], v4 offset:17728
    v_cvt_pk_bf16_f32 v107, v38, v39
    v_mfma_f32_16x16x32_bf16 v[192:195], a[192:195], v[80:83], v[192:195]
    ds_read_b64_tr_b16 a[216:217], v4 offset:352
    ds_read_b128 v[24:27], v9 offset:12560
    v_mfma_f32_16x16x32_bf16 v[192:195], a[196:199], v[84:87], v[192:195]
    ds_read_b64_tr_b16 a[218:219], v4 offset:864
    ds_read_b64_tr_b16 a[220:221], v4 offset:17248
    v_fma_mix_f32 v32, v100, v16, v20 op_sel:[0,0,0] op_sel_hi:[1,0,0]
    v_mfma_f32_16x16x32_bf16 v[224:227], a[192:195], v[88:91], v[224:227]
    s_mov_b32 s54, 16384
    ds_read_b64_tr_b16 a[222:223], v4 offset:17760
    ds_read_b128 v[28:31], v9 offset:12592
    v_mfma_f32_16x16x32_bf16 v[224:227], a[196:199], v[92:95], v[224:227]
    s_waitcnt lgkmcnt(10)
    buffer_load_dwordx4 v[48:51], v8, s[32:35], s54 offen sc1
    v_mfma_f32_16x16x32_bf16 v[196:199], a[200:203], v[80:83], v[196:199]
    ds_read_b64_tr_b16 a[224:225], v4 offset:384
    v_fma_mix_f32 v33, v100, v17, v21 op_sel:[1,0,0] op_sel_hi:[1,0,0]
    v_mfma_f32_16x16x32_bf16 v[196:199], a[204:207], v[84:87], v[196:199]
    ds_read_b64_tr_b16 a[226:227], v4 offset:896
    ds_read_b64_tr_b16 a[228:229], v4 offset:17280
    v_fma_mix_f32 v34, v101, v18, v22 op_sel:[0,0,0] op_sel_hi:[1,0,0]
    v_mfma_f32_16x16x32_bf16 v[228:231], a[200:203], v[88:91], v[228:231]
    s_mov_b32 s54, 17408
    ds_read_b64_tr_b16 a[230:231], v4 offset:17792
    v_fma_mix_f32 v35, v101, v19, v23 op_sel:[1,0,0] op_sel_hi:[1,0,0]
    v_mfma_f32_16x16x32_bf16 v[228:231], a[204:207], v[92:95], v[228:231]
    s_waitcnt lgkmcnt(10)
    buffer_load_dwordx4 v[52:55], v8, s[32:35], s54 offen sc1
    v_mfma_f32_16x16x32_bf16 v[200:203], a[208:211], v[80:83], v[200:203]
    ds_read_b64_tr_b16 a[232:233], v4 offset:416
    v_cvt_pk_bf16_f32 v100, v32, v33
    v_mfma_f32_16x16x32_bf16 v[200:203], a[212:215], v[84:87], v[200:203]
    ds_read_b64_tr_b16 a[234:235], v4 offset:928
    ds_read_b64_tr_b16 a[236:237], v4 offset:17312
    v_cvt_pk_bf16_f32 v101, v34, v35
    v_mfma_f32_16x16x32_bf16 v[232:235], a[208:211], v[88:91], v[232:235]
    s_mov_b32 s54, 34816
    ds_read_b64_tr_b16 a[238:239], v4 offset:17824
    v_fma_mix_f32 v36, v108, v16, v20 op_sel:[0,0,0] op_sel_hi:[1,0,0]
    v_mfma_f32_16x16x32_bf16 v[232:235], a[212:215], v[92:95], v[232:235]
    s_waitcnt lgkmcnt(9)
    buffer_load_dwordx4 v[56:59], v8, s[32:35], s54 offen sc1
    v_fma_mix_f32 v37, v108, v17, v21 op_sel:[1,0,0] op_sel_hi:[1,0,0]
    v_mfma_f32_16x16x32_bf16 v[204:207], a[216:219], v[80:83], v[204:207]
    ds_read_b64_tr_b16 a[240:241], v4 offset:448
    v_fma_mix_f32 v38, v109, v18, v22 op_sel:[0,0,0] op_sel_hi:[1,0,0]
    v_mfma_f32_16x16x32_bf16 v[204:207], a[220:223], v[84:87], v[204:207]
    ds_read_b64_tr_b16 a[242:243], v4 offset:960
    ds_read_b64_tr_b16 a[244:245], v4 offset:17344
    v_fma_mix_f32 v39, v109, v19, v23 op_sel:[1,0,0] op_sel_hi:[1,0,0]
    v_mfma_f32_16x16x32_bf16 v[236:239], a[216:219], v[88:91], v[236:239]
    s_mov_b32 s54, 35840
    ds_read_b64_tr_b16 a[246:247], v4 offset:17856
    v_cvt_pk_bf16_f32 v108, v36, v37
    v_mfma_f32_16x16x32_bf16 v[236:239], a[220:223], v[92:95], v[236:239]
    s_waitcnt lgkmcnt(8)
    buffer_load_dwordx4 v[60:63], v8, s[32:35], s54 offen sc1
    v_cvt_pk_bf16_f32 v109, v38, v39
    v_mfma_f32_16x16x32_bf16 v[208:211], a[224:227], v[80:83], v[208:211]
    ds_read_b64_tr_b16 a[248:249], v4 offset:480
    ds_read_b128 v[16:19], v9 offset:12800
    v_mfma_f32_16x16x32_bf16 v[208:211], a[228:231], v[84:87], v[208:211]
    ds_read_b64_tr_b16 a[250:251], v4 offset:992
    ds_read_b128 v[20:23], v9 offset:12832
    v_mfma_f32_16x16x32_bf16 v[240:243], a[224:227], v[88:91], v[240:243]
    ds_read_b64_tr_b16 a[252:253], v4 offset:17376
    v_fma_mix_f32 v32, v102, v24, v28 op_sel:[0,0,0] op_sel_hi:[1,0,0]
    v_mfma_f32_16x16x32_bf16 v[240:243], a[228:231], v[92:95], v[240:243]
    s_waitcnt vmcnt(16)
    s_barrier
    s_waitcnt lgkmcnt(9)
    ds_read_b64_tr_b16 a[254:255], v4 offset:17888
    v_fma_mix_f32 v33, v102, v25, v29 op_sel:[1,0,0] op_sel_hi:[1,0,0]
    v_fma_mix_f32 v34, v103, v26, v30 op_sel:[0,0,0] op_sel_hi:[1,0,0]
    v_mfma_f32_16x16x32_bf16 v[212:215], a[232:235], v[80:83], v[212:215]
    ds_read_b64_tr_b16 a[192:193], v4 offset:36864
    v_fma_mix_f32 v35, v103, v27, v31 op_sel:[1,0,0] op_sel_hi:[1,0,0]
    v_mfma_f32_16x16x32_bf16 v[212:215], a[236:239], v[84:87], v[212:215]
    ds_read_b64_tr_b16 a[194:195], v4 offset:37376
    ds_read_b64_tr_b16 a[196:197], v4 offset:53760
    v_cvt_pk_bf16_f32 v102, v32, v33
    v_mfma_f32_16x16x32_bf16 v[244:247], a[232:235], v[88:91], v[244:247]
    s_add_u32 m0, s44, 36864
    ds_read_b64_tr_b16 a[198:199], v4 offset:54272
    v_cvt_pk_bf16_f32 v103, v34, v35
    v_mfma_f32_16x16x32_bf16 v[244:247], a[236:239], v[92:95], v[244:247]
    s_mov_b32 s45, 4194304
    s_waitcnt lgkmcnt(10)
    buffer_load_dwordx4 v6, s[24:27], s45 offen lds
    v_mfma_f32_16x16x32_bf16 v[216:219], a[240:243], v[80:83], v[216:219]
    ds_read_b64_tr_b16 a[200:201], v4 offset:36896
    v_fma_mix_f32 v36, v110, v24, v28 op_sel:[0,0,0] op_sel_hi:[1,0,0]
    v_mfma_f32_16x16x32_bf16 v[216:219], a[244:247], v[84:87], v[216:219]
    ds_read_b64_tr_b16 a[202:203], v4 offset:37408
    ds_read_b64_tr_b16 a[204:205], v4 offset:53792
    v_fma_mix_f32 v37, v110, v25, v29 op_sel:[1,0,0] op_sel_hi:[1,0,0]
    v_mfma_f32_16x16x32_bf16 v[248:251], a[240:243], v[88:91], v[248:251]
    s_add_u32 m0, s44, 37920
    ds_read_b64_tr_b16 a[206:207], v4 offset:54304
    v_fma_mix_f32 v38, v111, v26, v30 op_sel:[0,0,0] op_sel_hi:[1,0,0]
    v_mfma_f32_16x16x32_bf16 v[248:251], a[244:247], v[92:95], v[248:251]
    s_mov_b32 s45, 4202496
    s_waitcnt lgkmcnt(8)
    buffer_load_dwordx4 v6, s[24:27], s45 offen lds
    v_mfma_f32_16x16x32_bf16 v[220:223], a[248:251], v[80:83], v[220:223]
    ds_read_b64_tr_b16 a[208:209], v4 offset:36928
    v_fma_mix_f32 v39, v111, v27, v31 op_sel:[1,0,0] op_sel_hi:[1,0,0]
    v_mfma_f32_16x16x32_bf16 v[220:223], a[252:255], v[84:87], v[220:223]
    ds_read_b64_tr_b16 a[210:211], v4 offset:37440
    ds_read_b64_tr_b16 a[212:213], v4 offset:53824
    v_cvt_pk_bf16_f32 v110, v36, v37
    v_mfma_f32_16x16x32_bf16 v[252:255], a[248:251], v[88:91], v[252:255]
    s_add_u32 m0, s44, 38976
    ds_read_b64_tr_b16 a[214:215], v4 offset:54336
    v_cvt_pk_bf16_f32 v111, v38, v39
    v_mfma_f32_16x16x32_bf16 v[252:255], a[252:255], v[92:95], v[252:255]
    s_mov_b32 s45, 4210688
    s_waitcnt lgkmcnt(8)
    buffer_load_dwordx4 v6, s[24:27], s45 offen lds
    v_mfma_f32_16x16x32_bf16 v[128:131], a[192:195], v[96:99], v[128:131]
    s_waitcnt vmcnt(15)
    ds_read_b64_tr_b16 a[216:217], v4 offset:36960
    ds_read_b128 v[24:27], v9 offset:12816
    v_mfma_f32_16x16x32_bf16 v[128:131], a[196:199], v[100:103], v[128:131]
    ds_read_b64_tr_b16 a[218:219], v4 offset:37472
    ds_read_b64_tr_b16 a[220:221], v4 offset:53856
    v_fma_mix_f32 v32, v112, v16, v20 op_sel:[0,0,0] op_sel_hi:[1,0,0]
    v_mfma_f32_16x16x32_bf16 v[160:163], a[192:195], v[104:107], v[160:163]
    s_add_u32 m0, s44, 40032
    ds_read_b64_tr_b16 a[222:223], v4 offset:54368
    ds_read_b128 v[28:31], v9 offset:12848
    v_mfma_f32_16x16x32_bf16 v[160:163], a[196:199], v[108:111], v[160:163]
    s_mov_b32 s45, 4218880
    s_waitcnt lgkmcnt(10)
    buffer_load_dwordx4 v6, s[24:27], s45 offen lds
    v_mfma_f32_16x16x32_bf16 v[132:135], a[200:203], v[96:99], v[132:135]
    ds_read_b64_tr_b16 a[224:225], v4 offset:36992
    v_fma_mix_f32 v33, v112, v17, v21 op_sel:[1,0,0] op_sel_hi:[1,0,0]
    v_mfma_f32_16x16x32_bf16 v[132:135], a[204:207], v[100:103], v[132:135]
    ds_read_b64_tr_b16 a[226:227], v4 offset:37504
    ds_read_b64_tr_b16 a[228:229], v4 offset:53888
    v_fma_mix_f32 v34, v113, v18, v22 op_sel:[0,0,0] op_sel_hi:[1,0,0]
    v_mfma_f32_16x16x32_bf16 v[164:167], a[200:203], v[104:107], v[164:167]
    s_add_u32 m0, s44, 53760
    ds_read_b64_tr_b16 a[230:231], v4 offset:54400
    v_fma_mix_f32 v35, v113, v19, v23 op_sel:[1,0,0] op_sel_hi:[1,0,0]
    v_mfma_f32_16x16x32_bf16 v[164:167], a[204:207], v[108:111], v[164:167]
    s_mov_b32 s45, 4456448
    s_waitcnt lgkmcnt(10)
    buffer_load_dwordx4 v6, s[24:27], s45 offen lds
    v_mfma_f32_16x16x32_bf16 v[136:139], a[208:211], v[96:99], v[136:139]
    ds_read_b64_tr_b16 a[232:233], v4 offset:37024
    v_cvt_pk_bf16_f32 v112, v32, v33
    v_mfma_f32_16x16x32_bf16 v[136:139], a[212:215], v[100:103], v[136:139]
    ds_read_b64_tr_b16 a[234:235], v4 offset:37536
    ds_read_b64_tr_b16 a[236:237], v4 offset:53920
    v_cvt_pk_bf16_f32 v113, v34, v35
    v_mfma_f32_16x16x32_bf16 v[168:171], a[208:211], v[104:107], v[168:171]
    s_add_u32 m0, s44, 54816
    ds_read_b64_tr_b16 a[238:239], v4 offset:54432
    v_fma_mix_f32 v36, v120, v16, v20 op_sel:[0,0,0] op_sel_hi:[1,0,0]
    v_mfma_f32_16x16x32_bf16 v[168:171], a[212:215], v[108:111], v[168:171]
    s_mov_b32 s45, 4464640
    s_waitcnt lgkmcnt(9)
    buffer_load_dwordx4 v6, s[24:27], s45 offen lds
    v_fma_mix_f32 v37, v120, v17, v21 op_sel:[1,0,0] op_sel_hi:[1,0,0]
    v_mfma_f32_16x16x32_bf16 v[140:143], a[216:219], v[96:99], v[140:143]
    ds_read_b64_tr_b16 a[240:241], v4 offset:37056
    v_fma_mix_f32 v38, v121, v18, v22 op_sel:[0,0,0] op_sel_hi:[1,0,0]
    v_mfma_f32_16x16x32_bf16 v[140:143], a[220:223], v[100:103], v[140:143]
L2_pad2:
    s_cbranch_execz L2_pad6
    ds_read_b64_tr_b16 a[242:243], v4 offset:37568
    ds_read_b64_tr_b16 a[244:245], v4 offset:53952
    v_fma_mix_f32 v39, v121, v19, v23 op_sel:[1,0,0] op_sel_hi:[1,0,0]
    v_mfma_f32_16x16x32_bf16 v[172:175], a[216:219], v[104:107], v[172:175]
    s_add_u32 m0, s44, 55872
    ds_read_b64_tr_b16 a[246:247], v4 offset:54464
    v_cvt_pk_bf16_f32 v120, v36, v37
    v_mfma_f32_16x16x32_bf16 v[172:175], a[220:223], v[108:111], v[172:175]
    s_mov_b32 s45, 4472832
    s_waitcnt lgkmcnt(8)
    buffer_load_dwordx4 v6, s[24:27], s45 offen lds
    v_cvt_pk_bf16_f32 v121, v38, v39
    v_mfma_f32_16x16x32_bf16 v[144:147], a[224:227], v[96:99], v[144:147]
    ds_read_b64_tr_b16 a[248:249], v4 offset:37088
    ds_read_b128 v[16:19], v9 offset:13056
    v_mfma_f32_16x16x32_bf16 v[144:147], a[228:231], v[100:103], v[144:147]
    ds_read_b64_tr_b16 a[250:251], v4 offset:37600
    ds_read_b64_tr_b16 a[252:253], v4 offset:53984
    v_mfma_f32_16x16x32_bf16 v[176:179], a[224:227], v[104:107], v[176:179]
    s_add_u32 m0, s44, 56928
    ds_read_b64_tr_b16 a[254:255], v4 offset:54496
    ds_read_b128 v[20:23], v9 offset:13088
    v_mfma_f32_16x16x32_bf16 v[176:179], a[228:231], v[108:111], v[176:179]
    s_mov_b32 s45, 4481024
    s_waitcnt lgkmcnt(10)
    buffer_load_dwordx4 v6, s[24:27], s45 offen lds
    v_mfma_f32_16x16x32_bf16 v[148:151], a[232:235], v[96:99], v[148:151]
    ds_read_b64_tr_b16 a[192:193], v4 offset:37120
    v_fma_mix_f32 v32, v114, v24, v28 op_sel:[0,0,0] op_sel_hi:[1,0,0]
    v_mfma_f32_16x16x32_bf16 v[148:151], a[236:239], v[100:103], v[148:151]
    ds_read_b64_tr_b16 a[194:195], v4 offset:37632
    v_fma_mix_f32 v33, v114, v25, v29 op_sel:[1,0,0] op_sel_hi:[1,0,0]
    v_mfma_f32_16x16x32_bf16 v[180:183], a[232:235], v[104:107], v[180:183]
    ds_read_b64_tr_b16 a[196:197], v4 offset:54016
    v_fma_mix_f32 v34, v115, v26, v30 op_sel:[0,0,0] op_sel_hi:[1,0,0]
    v_mfma_f32_16x16x32_bf16 v[180:183], a[236:239], v[108:111], v[180:183]
    s_waitcnt lgkmcnt(9)
    ds_read_b64_tr_b16 a[198:199], v4 offset:54528
    v_fma_mix_f32 v35, v115, v27, v31 op_sel:[1,0,0] op_sel_hi:[1,0,0]
    v_mfma_f32_16x16x32_bf16 v[152:155], a[240:243], v[96:99], v[152:155]
    ds_read_b64_tr_b16 a[200:201], v4 offset:37152
    v_cvt_pk_bf16_f32 v114, v32, v33
    v_mfma_f32_16x16x32_bf16 v[152:155], a[244:247], v[100:103], v[152:155]
    ds_read_b64_tr_b16 a[202:203], v4 offset:37664
    v_cvt_pk_bf16_f32 v115, v34, v35
    v_mfma_f32_16x16x32_bf16 v[184:187], a[240:243], v[104:107], v[184:187]
    ds_read_b64_tr_b16 a[204:205], v4 offset:54048
    v_fma_mix_f32 v36, v122, v24, v28 op_sel:[0,0,0] op_sel_hi:[1,0,0]
    v_mfma_f32_16x16x32_bf16 v[184:187], a[244:247], v[108:111], v[184:187]
    s_waitcnt lgkmcnt(8)
    ds_read_b64_tr_b16 a[206:207], v4 offset:54560
    v_fma_mix_f32 v37, v122, v25, v29 op_sel:[1,0,0] op_sel_hi:[1,0,0]
    v_mfma_f32_16x16x32_bf16 v[156:159], a[248:251], v[96:99], v[156:159]
    ds_read_b64_tr_b16 a[208:209], v4 offset:37184
    v_fma_mix_f32 v38, v123, v26, v30 op_sel:[0,0,0] op_sel_hi:[1,0,0]
    v_mfma_f32_16x16x32_bf16 v[156:159], a[252:255], v[100:103], v[156:159]
    ds_read_b64_tr_b16 a[210:211], v4 offset:37696
    v_fma_mix_f32 v39, v123, v27, v31 op_sel:[1,0,0] op_sel_hi:[1,0,0]
    v_mfma_f32_16x16x32_bf16 v[188:191], a[248:251], v[104:107], v[188:191]
    ds_read_b64_tr_b16 a[212:213], v4 offset:54080
    v_cvt_pk_bf16_f32 v122, v36, v37
    v_mfma_f32_16x16x32_bf16 v[188:191], a[252:255], v[108:111], v[188:191]
    s_waitcnt lgkmcnt(7)
    ds_read_b64_tr_b16 a[214:215], v4 offset:54592
    v_cvt_pk_bf16_f32 v123, v38, v39
    v_mfma_f32_16x16x32_bf16 v[192:195], a[192:195], v[96:99], v[192:195]
    ds_read_b64_tr_b16 a[216:217], v4 offset:37216
    ds_read_b128 v[24:27], v9 offset:13072
    v_mfma_f32_16x16x32_bf16 v[192:195], a[196:199], v[100:103], v[192:195]
    ds_read_b64_tr_b16 a[218:219], v4 offset:37728
    ds_read_b128 v[28:31], v9 offset:13104
    v_mfma_f32_16x16x32_bf16 v[224:227], a[192:195], v[104:107], v[224:227]
    ds_read_b64_tr_b16 a[220:221], v4 offset:54112
    v_fma_mix_f32 v32, v116, v16, v20 op_sel:[0,0,0] op_sel_hi:[1,0,0]
    v_mfma_f32_16x16x32_bf16 v[224:227], a[196:199], v[108:111], v[224:227]
    s_waitcnt lgkmcnt(9)
    ds_read_b64_tr_b16 a[222:223], v4 offset:54624
    v_fma_mix_f32 v33, v116, v17, v21 op_sel:[1,0,0] op_sel_hi:[1,0,0]
    v_mfma_f32_16x16x32_bf16 v[196:199], a[200:203], v[96:99], v[196:199]
    ds_read_b64_tr_b16 a[224:225], v4 offset:37248
    v_fma_mix_f32 v34, v117, v18, v22 op_sel:[0,0,0] op_sel_hi:[1,0,0]
    v_mfma_f32_16x16x32_bf16 v[196:199], a[204:207], v[100:103], v[196:199]
    ds_read_b64_tr_b16 a[226:227], v4 offset:37760
    v_fma_mix_f32 v35, v117, v19, v23 op_sel:[1,0,0] op_sel_hi:[1,0,0]
    v_mfma_f32_16x16x32_bf16 v[228:231], a[200:203], v[104:107], v[228:231]
    ds_read_b64_tr_b16 a[228:229], v4 offset:54144
    v_cvt_pk_bf16_f32 v116, v32, v33
    v_mfma_f32_16x16x32_bf16 v[228:231], a[204:207], v[108:111], v[228:231]
    s_waitcnt lgkmcnt(9)
    ds_read_b64_tr_b16 a[230:231], v4 offset:54656
    v_cvt_pk_bf16_f32 v117, v34, v35
    v_mfma_f32_16x16x32_bf16 v[200:203], a[208:211], v[96:99], v[200:203]
    ds_read_b64_tr_b16 a[232:233], v4 offset:37280
    v_fma_mix_f32 v36, v124, v16, v20 op_sel:[0,0,0] op_sel_hi:[1,0,0]
    v_mfma_f32_16x16x32_bf16 v[200:203], a[212:215], v[100:103], v[200:203]
    ds_read_b64_tr_b16 a[234:235], v4 offset:37792
    v_fma_mix_f32 v37, v124, v17, v21 op_sel:[1,0,0] op_sel_hi:[1,0,0]
    v_mfma_f32_16x16x32_bf16 v[232:235], a[208:211], v[104:107], v[232:235]
    ds_read_b64_tr_b16 a[236:237], v4 offset:54176
    v_fma_mix_f32 v38, v125, v18, v22 op_sel:[0,0,0] op_sel_hi:[1,0,0]
    v_mfma_f32_16x16x32_bf16 v[232:235], a[212:215], v[108:111], v[232:235]
    s_waitcnt lgkmcnt(7)
    ds_read_b64_tr_b16 a[238:239], v4 offset:54688
    v_fma_mix_f32 v39, v125, v19, v23 op_sel:[1,0,0] op_sel_hi:[1,0,0]
    v_mfma_f32_16x16x32_bf16 v[204:207], a[216:219], v[96:99], v[204:207]
    ds_read_b64_tr_b16 a[240:241], v4 offset:37312
    v_cvt_pk_bf16_f32 v124, v36, v37
    v_mfma_f32_16x16x32_bf16 v[204:207], a[220:223], v[100:103], v[204:207]
    ds_read_b64_tr_b16 a[242:243], v4 offset:37824
    v_cvt_pk_bf16_f32 v125, v38, v39
    v_mfma_f32_16x16x32_bf16 v[236:239], a[216:219], v[104:107], v[236:239]
    ds_read_b64_tr_b16 a[244:245], v4 offset:54208
    v_mfma_f32_16x16x32_bf16 v[236:239], a[220:223], v[108:111], v[236:239]
    s_waitcnt lgkmcnt(7)
    ds_read_b64_tr_b16 a[246:247], v4 offset:54720
    v_mfma_f32_16x16x32_bf16 v[208:211], a[224:227], v[96:99], v[208:211]
    ds_read_b64_tr_b16 a[248:249], v4 offset:37344
    ds_read_b128 v[16:19], v9 offset:13312
    v_mfma_f32_16x16x32_bf16 v[208:211], a[228:231], v[100:103], v[208:211]
    ds_read_b64_tr_b16 a[250:251], v4 offset:37856
    ds_read_b128 v[20:23], v9 offset:13344
    v_mfma_f32_16x16x32_bf16 v[240:243], a[224:227], v[104:107], v[240:243]
    ds_read_b64_tr_b16 a[252:253], v4 offset:54240
    v_fma_mix_f32 v32, v118, v24, v28 op_sel:[0,0,0] op_sel_hi:[1,0,0]
    v_mfma_f32_16x16x32_bf16 v[240:243], a[228:231], v[108:111], v[240:243]
    s_waitcnt vmcnt(12)
    s_barrier
    s_waitcnt lgkmcnt(9)
    ds_read_b64_tr_b16 a[254:255], v4 offset:54752
    v_fma_mix_f32 v33, v118, v25, v29 op_sel:[1,0,0] op_sel_hi:[1,0,0]
    v_fma_mix_f32 v34, v119, v26, v30 op_sel:[0,0,0] op_sel_hi:[1,0,0]
    v_mfma_f32_16x16x32_bf16 v[212:215], a[232:235], v[96:99], v[212:215]
    ds_read_b64_tr_b16 a[192:193], v3 offset:0
    v_fma_mix_f32 v35, v119, v27, v31 op_sel:[1,0,0] op_sel_hi:[1,0,0]
    v_mfma_f32_16x16x32_bf16 v[212:215], a[236:239], v[100:103], v[212:215]
    ds_read_b64_tr_b16 a[194:195], v3 offset:512
    ds_read_b64_tr_b16 a[196:197], v3 offset:16896
    v_cvt_pk_bf16_f32 v118, v32, v33
    v_mfma_f32_16x16x32_bf16 v[244:247], a[232:235], v[104:107], v[244:247]
    s_add_u32 m0, s44, 73728
    ds_read_b64_tr_b16 a[198:199], v3 offset:17408
    v_cvt_pk_bf16_f32 v119, v34, v35
    v_mfma_f32_16x16x32_bf16 v[244:247], a[236:239], v[108:111], v[244:247]
    s_mov_b32 s46, 0
    s_waitcnt lgkmcnt(10)
    buffer_load_dwordx4 v5, s[16:19], s46 offen offset:0 lds
    v_mfma_f32_16x16x32_bf16 v[216:219], a[240:243], v[96:99], v[216:219]
    ds_read_b64_tr_b16 a[200:201], v3 offset:32
    v_fma_mix_f32 v36, v126, v24, v28 op_sel:[0,0,0] op_sel_hi:[1,0,0]
    v_mfma_f32_16x16x32_bf16 v[216:219], a[244:247], v[100:103], v[216:219]
    ds_read_b64_tr_b16 a[202:203], v3 offset:544
    ds_read_b64_tr_b16 a[204:205], v3 offset:16928
    v_fma_mix_f32 v37, v126, v25, v29 op_sel:[1,0,0] op_sel_hi:[1,0,0]
    v_mfma_f32_16x16x32_bf16 v[248:251], a[240:243], v[104:107], v[248:251]
    s_add_u32 m0, s44, 73760
    ds_read_b64_tr_b16 a[206:207], v3 offset:17440
    v_fma_mix_f32 v38, v127, v26, v30 op_sel:[0,0,0] op_sel_hi:[1,0,0]
    v_mfma_f32_16x16x32_bf16 v[248:251], a[244:247], v[108:111], v[248:251]
    s_waitcnt lgkmcnt(8)
    buffer_load_dwordx4 v5, s[16:19], s46 offen offset:1024 lds
    v_mfma_f32_16x16x32_bf16 v[220:223], a[248:251], v[96:99], v[220:223]
    ds_read_b64_tr_b16 a[208:209], v3 offset:64
    v_fma_mix_f32 v39, v127, v27, v31 op_sel:[1,0,0] op_sel_hi:[1,0,0]
    v_mfma_f32_16x16x32_bf16 v[220:223], a[252:255], v[100:103], v[220:223]
    ds_read_b64_tr_b16 a[210:211], v3 offset:576
    ds_read_b64_tr_b16 a[212:213], v3 offset:16960
    v_cvt_pk_bf16_f32 v126, v36, v37
    v_mfma_f32_16x16x32_bf16 v[252:255], a[248:251], v[104:107], v[252:255]
    s_add_u32 m0, s44, 73792
    ds_read_b64_tr_b16 a[214:215], v3 offset:17472
    v_cvt_pk_bf16_f32 v127, v38, v39
    v_mfma_f32_16x16x32_bf16 v[252:255], a[252:255], v[108:111], v[252:255]
    s_waitcnt lgkmcnt(8)
    buffer_load_dwordx4 v5, s[16:19], s46 offen offset:2048 lds
    v_mfma_f32_16x16x32_bf16 v[128:131], a[192:195], v[112:115], v[128:131]
    s_waitcnt vmcnt(11)
    ds_read_b64_tr_b16 a[216:217], v3 offset:96
    ds_read_b128 v[24:27], v9 offset:13328
    v_mfma_f32_16x16x32_bf16 v[128:131], a[196:199], v[116:119], v[128:131]
    ds_read_b64_tr_b16 a[218:219], v3 offset:608
    ds_read_b64_tr_b16 a[220:221], v3 offset:16992
    v_fma_mix_f32 v32, v48, v16, v20 op_sel:[0,0,0] op_sel_hi:[1,0,0]
    v_mfma_f32_16x16x32_bf16 v[160:163], a[192:195], v[120:123], v[160:163]
    s_add_u32 m0, s44, 73824
    ds_read_b64_tr_b16 a[222:223], v3 offset:17504
    ds_read_b128 v[28:31], v9 offset:13360
    v_mfma_f32_16x16x32_bf16 v[160:163], a[196:199], v[124:127], v[160:163]
    s_waitcnt lgkmcnt(10)
    buffer_load_dwordx4 v5, s[16:19], s46 offen offset:3072 lds
    v_mfma_f32_16x16x32_bf16 v[132:135], a[200:203], v[112:115], v[132:135]
    ds_read_b64_tr_b16 a[224:225], v3 offset:128
    v_fma_mix_f32 v33, v48, v17, v21 op_sel:[1,0,0] op_sel_hi:[1,0,0]
    v_mfma_f32_16x16x32_bf16 v[132:135], a[204:207], v[116:119], v[132:135]
    ds_read_b64_tr_b16 a[226:227], v3 offset:640
    ds_read_b64_tr_b16 a[228:229], v3 offset:17024
    v_fma_mix_f32 v34, v49, v18, v22 op_sel:[0,0,0] op_sel_hi:[1,0,0]
    v_mfma_f32_16x16x32_bf16 v[164:167], a[200:203], v[120:123], v[164:167]
    s_add_u32 m0, s44, 90624
    ds_read_b64_tr_b16 a[230:231], v3 offset:17536
    v_fma_mix_f32 v35, v49, v19, v23 op_sel:[1,0,0] op_sel_hi:[1,0,0]
    v_mfma_f32_16x16x32_bf16 v[164:167], a[204:207], v[124:127], v[164:167]
    s_waitcnt lgkmcnt(10)
    buffer_load_dwordx4 v5, s[20:23], s46 offen offset:0 lds
    v_mfma_f32_16x16x32_bf16 v[136:139], a[208:211], v[112:115], v[136:139]
    ds_read_b64_tr_b16 a[232:233], v3 offset:160
    v_cvt_pk_bf16_f32 v48, v32, v33
    v_mfma_f32_16x16x32_bf16 v[136:139], a[212:215], v[116:119], v[136:139]
    ds_read_b64_tr_b16 a[234:235], v3 offset:672
    ds_read_b64_tr_b16 a[236:237], v3 offset:17056
    v_cvt_pk_bf16_f32 v49, v34, v35
    v_mfma_f32_16x16x32_bf16 v[168:171], a[208:211], v[120:123], v[168:171]
    s_add_u32 m0, s44, 90656
    ds_read_b64_tr_b16 a[238:239], v3 offset:17568
    v_fma_mix_f32 v36, v56, v16, v20 op_sel:[0,0,0] op_sel_hi:[1,0,0]
    v_mfma_f32_16x16x32_bf16 v[168:171], a[212:215], v[124:127], v[168:171]
    s_waitcnt lgkmcnt(9)
    buffer_load_dwordx4 v5, s[20:23], s46 offen offset:1024 lds
    v_fma_mix_f32 v37, v56, v17, v21 op_sel:[1,0,0] op_sel_hi:[1,0,0]
    v_mfma_f32_16x16x32_bf16 v[140:143], a[216:219], v[112:115], v[140:143]
    ds_read_b64_tr_b16 a[240:241], v3 offset:192
    v_fma_mix_f32 v38, v57, v18, v22 op_sel:[0,0,0] op_sel_hi:[1,0,0]
    v_mfma_f32_16x16x32_bf16 v[140:143], a[220:223], v[116:119], v[140:143]
    ds_read_b64_tr_b16 a[242:243], v3 offset:704
    ds_read_b64_tr_b16 a[244:245], v3 offset:17088
    v_fma_mix_f32 v39, v57, v19, v23 op_sel:[1,0,0] op_sel_hi:[1,0,0]
    v_mfma_f32_16x16x32_bf16 v[172:175], a[216:219], v[120:123], v[172:175]
    s_add_u32 m0, s44, 90688
    ds_read_b64_tr_b16 a[246:247], v3 offset:17600
    v_cvt_pk_bf16_f32 v56, v36, v37
    v_mfma_f32_16x16x32_bf16 v[172:175], a[220:223], v[124:127], v[172:175]
    s_waitcnt lgkmcnt(8)
    buffer_load_dwordx4 v5, s[20:23], s46 offen offset:2048 lds
    v_cvt_pk_bf16_f32 v57, v38, v39
    v_mfma_f32_16x16x32_bf16 v[144:147], a[224:227], v[112:115], v[144:147]
    ds_read_b64_tr_b16 a[248:249], v3 offset:224
    ds_read_b128 v[16:19], v9 offset:13568
    v_mfma_f32_16x16x32_bf16 v[144:147], a[228:231], v[116:119], v[144:147]
    ds_read_b64_tr_b16 a[250:251], v3 offset:736
    ds_read_b64_tr_b16 a[252:253], v3 offset:17120
    v_mfma_f32_16x16x32_bf16 v[176:179], a[224:227], v[120:123], v[176:179]
    s_add_u32 m0, s44, 90720
    ds_read_b64_tr_b16 a[254:255], v3 offset:17632
    ds_read_b128 v[20:23], v9 offset:13600
    v_mfma_f32_16x16x32_bf16 v[176:179], a[228:231], v[124:127], v[176:179]
    s_waitcnt lgkmcnt(10)
    buffer_load_dwordx4 v5, s[20:23], s46 offen offset:3072 lds
    v_mfma_f32_16x16x32_bf16 v[148:151], a[232:235], v[112:115], v[148:151]
    ds_read_b64_tr_b16 a[192:193], v3 offset:256
    v_fma_mix_f32 v32, v50, v24, v28 op_sel:[0,0,0] op_sel_hi:[1,0,0]
    v_mfma_f32_16x16x32_bf16 v[148:151], a[236:239], v[116:119], v[148:151]
    ds_read_b64_tr_b16 a[194:195], v3 offset:768
    v_fma_mix_f32 v33, v50, v25, v29 op_sel:[1,0,0] op_sel_hi:[1,0,0]
    v_mfma_f32_16x16x32_bf16 v[180:183], a[232:235], v[120:123], v[180:183]
    ds_read_b64_tr_b16 a[196:197], v3 offset:17152
    v_fma_mix_f32 v34, v51, v26, v30 op_sel:[0,0,0] op_sel_hi:[1,0,0]
    v_mfma_f32_16x16x32_bf16 v[180:183], a[236:239], v[124:127], v[180:183]
    s_waitcnt lgkmcnt(9)
    ds_read_b64_tr_b16 a[198:199], v3 offset:17664
    v_fma_mix_f32 v35, v51, v27, v31 op_sel:[1,0,0] op_sel_hi:[1,0,0]
    v_mfma_f32_16x16x32_bf16 v[152:155], a[240:243], v[112:115], v[152:155]
    ds_read_b64_tr_b16 a[200:201], v3 offset:288
    v_cvt_pk_bf16_f32 v50, v32, v33
    v_mfma_f32_16x16x32_bf16 v[152:155], a[244:247], v[116:119], v[152:155]
    ds_read_b64_tr_b16 a[202:203], v3 offset:800
    v_cvt_pk_bf16_f32 v51, v34, v35
    v_mfma_f32_16x16x32_bf16 v[184:187], a[240:243], v[120:123], v[184:187]
    ds_read_b64_tr_b16 a[204:205], v3 offset:17184
    v_fma_mix_f32 v36, v58, v24, v28 op_sel:[0,0,0] op_sel_hi:[1,0,0]
    v_mfma_f32_16x16x32_bf16 v[184:187], a[244:247], v[124:127], v[184:187]
    s_waitcnt lgkmcnt(8)
    ds_read_b64_tr_b16 a[206:207], v3 offset:17696
    v_fma_mix_f32 v37, v58, v25, v29 op_sel:[1,0,0] op_sel_hi:[1,0,0]
    v_mfma_f32_16x16x32_bf16 v[156:159], a[248:251], v[112:115], v[156:159]
    ds_read_b64_tr_b16 a[208:209], v3 offset:320
    v_fma_mix_f32 v38, v59, v26, v30 op_sel:[0,0,0] op_sel_hi:[1,0,0]
    v_mfma_f32_16x16x32_bf16 v[156:159], a[252:255], v[116:119], v[156:159]
    ds_read_b64_tr_b16 a[210:211], v3 offset:832
    v_fma_mix_f32 v39, v59, v27, v31 op_sel:[1,0,0] op_sel_hi:[1,0,0]
    v_mfma_f32_16x16x32_bf16 v[188:191], a[248:251], v[120:123], v[188:191]
    ds_read_b64_tr_b16 a[212:213], v3 offset:17216
    v_cvt_pk_bf16_f32 v58, v36, v37
    v_mfma_f32_16x16x32_bf16 v[188:191], a[252:255], v[124:127], v[188:191]
    s_waitcnt lgkmcnt(7)
    ds_read_b64_tr_b16 a[214:215], v3 offset:17728
    v_cvt_pk_bf16_f32 v59, v38, v39
    v_mfma_f32_16x16x32_bf16 v[192:195], a[192:195], v[112:115], v[192:195]
    ds_read_b64_tr_b16 a[216:217], v3 offset:352
    ds_read_b128 v[24:27], v9 offset:13584
    v_mfma_f32_16x16x32_bf16 v[192:195], a[196:199], v[116:119], v[192:195]
    ds_read_b64_tr_b16 a[218:219], v3 offset:864
    ds_read_b128 v[28:31], v9 offset:13616
    v_mfma_f32_16x16x32_bf16 v[224:227], a[192:195], v[120:123], v[224:227]
    ds_read_b64_tr_b16 a[220:221], v3 offset:17248
    v_fma_mix_f32 v32, v52, v16, v20 op_sel:[0,0,0] op_sel_hi:[1,0,0]
    v_mfma_f32_16x16x32_bf16 v[224:227], a[196:199], v[124:127], v[224:227]
    s_waitcnt lgkmcnt(9)
    ds_read_b64_tr_b16 a[222:223], v3 offset:17760
    v_fma_mix_f32 v33, v52, v17, v21 op_sel:[1,0,0] op_sel_hi:[1,0,0]
    v_mfma_f32_16x16x32_bf16 v[196:199], a[200:203], v[112:115], v[196:199]
    ds_read_b64_tr_b16 a[224:225], v3 offset:384
    v_fma_mix_f32 v34, v53, v18, v22 op_sel:[0,0,0] op_sel_hi:[1,0,0]
    v_mfma_f32_16x16x32_bf16 v[196:199], a[204:207], v[116:119], v[196:199]
    ds_read_b64_tr_b16 a[226:227], v3 offset:896
    v_fma_mix_f32 v35, v53, v19, v23 op_sel:[1,0,0] op_sel_hi:[1,0,0]
    v_mfma_f32_16x16x32_bf16 v[228:231], a[200:203], v[120:123], v[228:231]
    ds_read_b64_tr_b16 a[228:229], v3 offset:17280
    v_cvt_pk_bf16_f32 v52, v32, v33
    v_mfma_f32_16x16x32_bf16 v[228:231], a[204:207], v[124:127], v[228:231]
    s_waitcnt lgkmcnt(9)
    ds_read_b64_tr_b16 a[230:231], v3 offset:17792
    v_cvt_pk_bf16_f32 v53, v34, v35
    v_mfma_f32_16x16x32_bf16 v[200:203], a[208:211], v[112:115], v[200:203]
    ds_read_b64_tr_b16 a[232:233], v3 offset:416
    v_fma_mix_f32 v36, v60, v16, v20 op_sel:[0,0,0] op_sel_hi:[1,0,0]
    v_mfma_f32_16x16x32_bf16 v[200:203], a[212:215], v[116:119], v[200:203]
    ds_read_b64_tr_b16 a[234:235], v3 offset:928
    v_fma_mix_f32 v37, v60, v17, v21 op_sel:[1,0,0] op_sel_hi:[1,0,0]
    v_mfma_f32_16x16x32_bf16 v[232:235], a[208:211], v[120:123], v[232:235]
    ds_read_b64_tr_b16 a[236:237], v3 offset:17312
    v_fma_mix_f32 v38, v61, v18, v22 op_sel:[0,0,0] op_sel_hi:[1,0,0]
    v_mfma_f32_16x16x32_bf16 v[232:235], a[212:215], v[124:127], v[232:235]
    s_waitcnt lgkmcnt(7)
    ds_read_b64_tr_b16 a[238:239], v3 offset:17824
    v_fma_mix_f32 v39, v61, v19, v23 op_sel:[1,0,0] op_sel_hi:[1,0,0]
    v_mfma_f32_16x16x32_bf16 v[204:207], a[216:219], v[112:115], v[204:207]
    ds_read_b64_tr_b16 a[240:241], v3 offset:448
    v_cvt_pk_bf16_f32 v60, v36, v37
    v_mfma_f32_16x16x32_bf16 v[204:207], a[220:223], v[116:119], v[204:207]
    ds_read_b64_tr_b16 a[242:243], v3 offset:960
    v_cvt_pk_bf16_f32 v61, v38, v39
    v_mfma_f32_16x16x32_bf16 v[236:239], a[216:219], v[120:123], v[236:239]
    ds_read_b64_tr_b16 a[244:245], v3 offset:17344
    v_mfma_f32_16x16x32_bf16 v[236:239], a[220:223], v[124:127], v[236:239]
    s_waitcnt lgkmcnt(7)
    ds_read_b64_tr_b16 a[246:247], v3 offset:17856
    v_mfma_f32_16x16x32_bf16 v[208:211], a[224:227], v[112:115], v[208:211]
    ds_read_b64_tr_b16 a[248:249], v3 offset:480
    v_fma_mix_f32 v32, v54, v24, v28 op_sel:[0,0,0] op_sel_hi:[1,0,0]
    v_mfma_f32_16x16x32_bf16 v[208:211], a[228:231], v[116:119], v[208:211]
    ds_read_b64_tr_b16 a[250:251], v3 offset:992
    v_fma_mix_f32 v33, v54, v25, v29 op_sel:[1,0,0] op_sel_hi:[1,0,0]
    v_mfma_f32_16x16x32_bf16 v[240:243], a[224:227], v[120:123], v[240:243]
    ds_read_b64_tr_b16 a[252:253], v3 offset:17376
    v_fma_mix_f32 v34, v55, v26, v30 op_sel:[0,0,0] op_sel_hi:[1,0,0]
    v_mfma_f32_16x16x32_bf16 v[240:243], a[228:231], v[124:127], v[240:243]
    s_waitcnt vmcnt(8)
    s_barrier
    s_waitcnt lgkmcnt(7)
    ds_read_b64_tr_b16 a[254:255], v3 offset:17888
    v_fma_mix_f32 v35, v55, v27, v31 op_sel:[1,0,0] op_sel_hi:[1,0,0]
    v_mfma_f32_16x16x32_bf16 v[212:215], a[232:235], v[112:115], v[212:215]
    ds_read_b64_tr_b16 a[192:193], v3 offset:36864
    v_cvt_pk_bf16_f32 v54, v32, v33
    v_mfma_f32_16x16x32_bf16 v[212:215], a[236:239], v[116:119], v[212:215]
    ds_read_b64_tr_b16 a[194:195], v3 offset:37376
    ds_read_b64_tr_b16 a[196:197], v3 offset:53760
    v_mfma_f32_16x16x32_bf16 v[244:247], a[232:235], v[120:123], v[244:247]
    s_add_u32 m0, s44, 110592
    ds_read_b64_tr_b16 a[198:199], v3 offset:54272
    v_cvt_pk_bf16_f32 v55, v34, v35
    v_mfma_f32_16x16x32_bf16 v[244:247], a[236:239], v[124:127], v[244:247]
    s_mov_b32 s46, 16384
    s_waitcnt lgkmcnt(8)
    buffer_load_dwordx4 v5, s[16:19], s46 offen offset:0 lds
    v_mfma_f32_16x16x32_bf16 v[216:219], a[240:243], v[112:115], v[216:219]
    ds_read_b64_tr_b16 a[200:201], v3 offset:36896
    v_fma_mix_f32 v36, v62, v24, v28 op_sel:[0,0,0] op_sel_hi:[1,0,0]
    v_mfma_f32_16x16x32_bf16 v[216:219], a[244:247], v[116:119], v[216:219]
    ds_read_b64_tr_b16 a[202:203], v3 offset:37408
    ds_read_b64_tr_b16 a[204:205], v3 offset:53792
    v_fma_mix_f32 v37, v62, v25, v29 op_sel:[1,0,0] op_sel_hi:[1,0,0]
    v_mfma_f32_16x16x32_bf16 v[248:251], a[240:243], v[120:123], v[248:251]
    s_add_u32 m0, s44, 110624
    ds_read_b64_tr_b16 a[206:207], v3 offset:54304
    v_fma_mix_f32 v38, v63, v26, v30 op_sel:[0,0,0] op_sel_hi:[1,0,0]
    v_mfma_f32_16x16x32_bf16 v[248:251], a[244:247], v[124:127], v[248:251]
    s_waitcnt lgkmcnt(8)
    buffer_load_dwordx4 v5, s[16:19], s46 offen offset:1024 lds
    v_mfma_f32_16x16x32_bf16 v[220:223], a[248:251], v[112:115], v[220:223]
    ds_read_b64_tr_b16 a[208:209], v3 offset:36928
    v_fma_mix_f32 v39, v63, v27, v31 op_sel:[1,0,0] op_sel_hi:[1,0,0]
    v_mfma_f32_16x16x32_bf16 v[220:223], a[252:255], v[116:119], v[220:223]
    ds_read_b64_tr_b16 a[210:211], v3 offset:37440
    ds_read_b64_tr_b16 a[212:213], v3 offset:53824
    v_cvt_pk_bf16_f32 v62, v36, v37
    v_mfma_f32_16x16x32_bf16 v[252:255], a[248:251], v[120:123], v[252:255]
    s_add_u32 m0, s44, 110656
    ds_read_b64_tr_b16 a[214:215], v3 offset:54336
    v_cvt_pk_bf16_f32 v63, v38, v39
    v_mfma_f32_16x16x32_bf16 v[252:255], a[252:255], v[124:127], v[252:255]
    s_waitcnt lgkmcnt(8)
    buffer_load_dwordx4 v5, s[16:19], s46 offen offset:2048 lds
    v_mfma_f32_16x16x32_bf16 v[128:131], a[192:195], v[48:51], v[128:131]
    ds_read_b64_tr_b16 a[216:217], v3 offset:36960
    v_lshrrev_b32 v14, 2, v0
    v_mfma_f32_16x16x32_bf16 v[128:131], a[196:199], v[52:55], v[128:131]
    s_mul_i32 s3, s51, 144
    ds_read_b64_tr_b16 a[218:219], v3 offset:37472
    ds_read_b64_tr_b16 a[220:221], v3 offset:53856
    v_mfma_f32_16x16x32_bf16 v[160:163], a[192:195], v[56:59], v[160:163]
    s_add_u32 m0, s44, 110688
    ds_read_b64_tr_b16 a[222:223], v3 offset:54368
    v_add_u32 v14, s3, v14
    v_mfma_f32_16x16x32_bf16 v[160:163], a[196:199], v[60:63], v[160:163]
    s_waitcnt lgkmcnt(8)
    buffer_load_dwordx4 v5, s[16:19], s46 offen offset:3072 lds
    v_mfma_f32_16x16x32_bf16 v[132:135], a[200:203], v[48:51], v[132:135]
    ds_read_b64_tr_b16 a[224:225], v3 offset:36992
    v_mul_u32_u24 v14, 9216, v14
    v_mfma_f32_16x16x32_bf16 v[132:135], a[204:207], v[52:55], v[132:135]
    ds_read_b64_tr_b16 a[226:227], v3 offset:37504
    ds_read_b64_tr_b16 a[228:229], v3 offset:53888
    v_mfma_f32_16x16x32_bf16 v[164:167], a[200:203], v[56:59], v[164:167]
    s_add_u32 m0, s44, 127488
    ds_read_b64_tr_b16 a[230:231], v3 offset:54400
    v_and_b32 v15, 3, v0
    v_mfma_f32_16x16x32_bf16 v[164:167], a[204:207], v[60:63], v[164:167]
    s_waitcnt lgkmcnt(8)
    buffer_load_dwordx4 v5, s[20:23], s46 offen offset:0 lds
    v_mfma_f32_16x16x32_bf16 v[136:139], a[208:211], v[48:51], v[136:139]
    ds_read_b64_tr_b16 a[232:233], v3 offset:37024
    v_lshl_add_u32 v6, v15, 4, v14
    v_mfma_f32_16x16x32_bf16 v[136:139], a[212:215], v[52:55], v[136:139]
    s_lshr_b32 s3, s2, 3
    s_lshl2_add_u32 s3, s3, s51
    s_and_b32 s15, s2, 7
    ds_read_b64_tr_b16 a[234:235], v3 offset:37536
    ds_read_b64_tr_b16 a[236:237], v3 offset:53920
    v_mfma_f32_16x16x32_bf16 v[168:171], a[208:211], v[56:59], v[168:171]
    s_add_u32 m0, s44, 127520
    ds_read_b64_tr_b16 a[238:239], v3 offset:54432
    v_lshlrev_b32 v9, 7, v0
    v_mfma_f32_16x16x32_bf16 v[168:171], a[212:215], v[60:63], v[168:171]
    s_waitcnt lgkmcnt(8)
    s_mul_i32 s14, s3, 9
    s_lshr_b32 s14, s14, 1
    buffer_load_dwordx4 v5, s[20:23], s46 offen offset:1024 lds
    v_mfma_f32_16x16x32_bf16 v[140:143], a[216:219], v[48:51], v[140:143]
    ds_read_b64_tr_b16 a[240:241], v3 offset:37056
    v_min_u32 v15, 44, v0
    v_mfma_f32_16x16x32_bf16 v[140:143], a[220:223], v[52:55], v[140:143]
    ds_read_b64_tr_b16 a[242:243], v3 offset:37568
    ds_read_b64_tr_b16 a[244:245], v3 offset:53952
    v_mfma_f32_16x16x32_bf16 v[172:175], a[216:219], v[56:59], v[172:175]
    s_add_u32 m0, s44, 127552
    ds_read_b64_tr_b16 a[246:247], v3 offset:54464
    v_mul_u32_u24 v12, 7282, v15
    v_mfma_f32_16x16x32_bf16 v[172:175], a[220:223], v[60:63], v[172:175]
    s_waitcnt lgkmcnt(8)
    buffer_load_dwordx4 v5, s[20:23], s46 offen offset:2048 lds
    v_mfma_f32_16x16x32_bf16 v[144:147], a[224:227], v[48:51], v[144:147]
    ds_read_b64_tr_b16 a[248:249], v3 offset:37088
    v_lshrrev_b32 v12, 16, v12
    v_mfma_f32_16x16x32_bf16 v[144:147], a[228:231], v[52:55], v[144:147]
    ds_read_b64_tr_b16 a[250:251], v3 offset:37600
    ds_read_b64_tr_b16 a[252:253], v3 offset:53984
    v_mfma_f32_16x16x32_bf16 v[176:179], a[224:227], v[56:59], v[176:179]
    s_add_u32 m0, s44, 127584
    ds_read_b64_tr_b16 a[254:255], v3 offset:54496
    v_mul_u32_u24 v13, 63, v12
    v_mfma_f32_16x16x32_bf16 v[176:179], a[228:231], v[60:63], v[176:179]
    s_waitcnt lgkmcnt(8)
    buffer_load_dwordx4 v5, s[20:23], s46 offen offset:3072 lds
    v_mfma_f32_16x16x32_bf16 v[148:151], a[232:235], v[48:51], v[148:151]
    ds_read_b64_tr_b16 a[192:193], v3 offset:37120
    v_add_u32 v12, v15, v13
    v_mfma_f32_16x16x32_bf16 v[148:151], a[236:239], v[52:55], v[148:151]
    s_mul_i32 s14, s14, 72
    s_mul_i32 s56, s15, 9
    s_add_u32 s14, s14, s56
    ds_read_b64_tr_b16 a[194:195], v3 offset:37632
    v_add_lshl_u32 v12, s14, v12, 7
    v_mfma_f32_16x16x32_bf16 v[180:183], a[232:235], v[56:59], v[180:183]
    s_mul_i32 s14, s3, 81
    s_lshr_b32 s14, s14, 1
    s_mul_i32 s56, s15, 5184
    s_add_u32 s14, s14, s56
    ds_read_b64_tr_b16 a[196:197], v3 offset:54016
    v_min_u32 v13, 40, v0
    v_mfma_f32_16x16x32_bf16 v[180:183], a[236:239], v[60:63], v[180:183]
    s_waitcnt lgkmcnt(7)
    ds_read_b64_tr_b16 a[198:199], v3 offset:54528
    v_add_lshl_u32 v13, s14, v13, 7
    v_mfma_f32_16x16x32_bf16 v[152:155], a[240:243], v[48:51], v[152:155]
    s_mul_i32 s14, s3, 72
    s_andn2_b32 s56, s52, 3
    s_mul_i32 s56, s56, 2304
    s_add_u32 s14, s14, s56
    ds_read_b64_tr_b16 a[200:201], v3 offset:37152
    v_min_u32 v14, 35, v0
    v_mfma_f32_16x16x32_bf16 v[152:155], a[244:247], v[52:55], v[152:155]
    ds_read_b64_tr_b16 a[202:203], v3 offset:37664
    v_add_lshl_u32 v14, s14, v14, 7
    v_mfma_f32_16x16x32_bf16 v[184:187], a[240:243], v[56:59], v[184:187]
    ds_read_b64_tr_b16 a[204:205], v3 offset:54048
    v_add_u32 v15, 4608, v14
    v_mfma_f32_16x16x32_bf16 v[184:187], a[244:247], v[60:63], v[184:187]
    s_waitcnt lgkmcnt(7)
    ds_read_b64_tr_b16 a[206:207], v3 offset:54560
    v_cvt_pk_bf16_f32 v64, v128, v129
    v_mfma_f32_16x16x32_bf16 v[156:159], a[248:251], v[48:51], v[156:159]
    ds_read_b64_tr_b16 a[208:209], v3 offset:37184
    v_cvt_pk_bf16_f32 v65, v130, v131
    v_mfma_f32_16x16x32_bf16 v[156:159], a[252:255], v[52:55], v[156:159]
    ds_read_b64_tr_b16 a[210:211], v3 offset:37696
    v_cvt_pk_bf16_f32 v66, v132, v133
    v_mfma_f32_16x16x32_bf16 v[188:191], a[248:251], v[56:59], v[188:191]
    ds_read_b64_tr_b16 a[212:213], v3 offset:54080
    v_cvt_pk_bf16_f32 v67, v134, v135
    v_mfma_f32_16x16x32_bf16 v[188:191], a[252:255], v[60:63], v[188:191]
    s_waitcnt lgkmcnt(7)
    ds_read_b64_tr_b16 a[214:215], v3 offset:54592
    v_cvt_pk_bf16_f32 v80, v160, v161
    v_mfma_f32_16x16x32_bf16 v[192:195], a[192:195], v[48:51], v[192:195]
    ds_read_b64_tr_b16 a[216:217], v3 offset:37216
    v_cvt_pk_bf16_f32 v81, v162, v163
    v_mfma_f32_16x16x32_bf16 v[192:195], a[196:199], v[52:55], v[192:195]
    ds_read_b64_tr_b16 a[218:219], v3 offset:37728
    v_cvt_pk_bf16_f32 v82, v164, v165
    v_mfma_f32_16x16x32_bf16 v[224:227], a[192:195], v[56:59], v[224:227]
    ds_read_b64_tr_b16 a[220:221], v3 offset:54112
    v_cvt_pk_bf16_f32 v83, v166, v167
    v_mfma_f32_16x16x32_bf16 v[224:227], a[196:199], v[60:63], v[224:227]
    s_waitcnt lgkmcnt(7)
    ds_read_b64_tr_b16 a[222:223], v3 offset:54624
    v_cvt_pk_bf16_f32 v68, v136, v137
    v_mfma_f32_16x16x32_bf16 v[196:199], a[200:203], v[48:51], v[196:199]
    ds_read_b64_tr_b16 a[224:225], v3 offset:37248
    v_cvt_pk_bf16_f32 v69, v138, v139
    v_mfma_f32_16x16x32_bf16 v[196:199], a[204:207], v[52:55], v[196:199]
    ds_read_b64_tr_b16 a[226:227], v3 offset:37760
    v_cvt_pk_bf16_f32 v70, v140, v141
    v_mfma_f32_16x16x32_bf16 v[228:231], a[200:203], v[56:59], v[228:231]
    ds_read_b64_tr_b16 a[228:229], v3 offset:54144
    v_cvt_pk_bf16_f32 v71, v142, v143
    v_mfma_f32_16x16x32_bf16 v[228:231], a[204:207], v[60:63], v[228:231]
    s_waitcnt vmcnt(8)
    s_barrier
    s_waitcnt lgkmcnt(7)
    ds_read_b64_tr_b16 a[230:231], v3 offset:54656
    v_cvt_pk_bf16_f32 v84, v168, v169
    v_mfma_f32_16x16x32_bf16 v[200:203], a[208:211], v[48:51], v[200:203]
    ds_read_b64_tr_b16 a[232:233], v3 offset:37280
    v_cvt_pk_bf16_f32 v85, v170, v171
    v_mfma_f32_16x16x32_bf16 v[200:203], a[212:215], v[52:55], v[200:203]
L2_pad3:
    s_cbranch_execz L2_pad7
    ds_read_b64_tr_b16 a[234:235], v3 offset:37792
    ds_read_b64_tr_b16 a[236:237], v3 offset:54176
    v_mfma_f32_16x16x32_bf16 v[232:235], a[208:211], v[56:59], v[232:235]
    s_add_u32 m0, s44, 0
    ds_read_b64_tr_b16 a[238:239], v3 offset:54688
    v_cvt_pk_bf16_f32 v86, v172, v173
    v_mfma_f32_16x16x32_bf16 v[232:235], a[212:215], v[60:63], v[232:235]
    s_mov_b32 s46, 32768
    s_waitcnt lgkmcnt(8)
    buffer_load_dwordx4 v5, s[16:19], s46 offen offset:0 lds
    v_mfma_f32_16x16x32_bf16 v[204:207], a[216:219], v[48:51], v[204:207]
    ds_read_b64_tr_b16 a[240:241], v3 offset:37312
    v_cvt_pk_bf16_f32 v87, v174, v175
    v_mfma_f32_16x16x32_bf16 v[204:207], a[220:223], v[52:55], v[204:207]
    ds_read_b64_tr_b16 a[242:243], v3 offset:37824
    ds_read_b64_tr_b16 a[244:245], v3 offset:54208
    v_mfma_f32_16x16x32_bf16 v[236:239], a[216:219], v[56:59], v[236:239]
    s_add_u32 m0, s44, 32
    ds_read_b64_tr_b16 a[246:247], v3 offset:54720
    v_cvt_pk_bf16_f32 v72, v144, v145
    v_mfma_f32_16x16x32_bf16 v[236:239], a[220:223], v[60:63], v[236:239]
    s_waitcnt lgkmcnt(8)
    buffer_load_dwordx4 v5, s[16:19], s46 offen offset:1024 lds
    v_mfma_f32_16x16x32_bf16 v[208:211], a[224:227], v[48:51], v[208:211]
    ds_read_b64_tr_b16 a[248:249], v3 offset:37344
    v_cvt_pk_bf16_f32 v73, v146, v147
    v_mfma_f32_16x16x32_bf16 v[208:211], a[228:231], v[52:55], v[208:211]
    ds_read_b64_tr_b16 a[250:251], v3 offset:37856
    ds_read_b64_tr_b16 a[252:253], v3 offset:54240
    v_mfma_f32_16x16x32_bf16 v[240:243], a[224:227], v[56:59], v[240:243]
    s_add_u32 m0, s44, 64
    ds_read_b64_tr_b16 a[254:255], v3 offset:54752
    v_cvt_pk_bf16_f32 v74, v148, v149
    v_mfma_f32_16x16x32_bf16 v[240:243], a[228:231], v[60:63], v[240:243]
    s_waitcnt lgkmcnt(8)
    buffer_load_dwordx4 v5, s[16:19], s46 offen offset:2048 lds
    v_mfma_f32_16x16x32_bf16 v[212:215], a[232:235], v[48:51], v[212:215]
    ds_read_b128 a[64:67], v1 offset:0
    ds_read_b128 a[68:71], v1 offset:64
    v_mfma_f32_16x16x32_bf16 v[212:215], a[236:239], v[52:55], v[212:215]
    ds_read_b128 a[72:75], v1 offset:128
    ds_read_b128 a[76:79], v1 offset:192
    v_mfma_f32_16x16x32_bf16 v[244:247], a[232:235], v[56:59], v[244:247]
    s_add_u32 m0, s44, 96
    ds_read_b128 a[80:83], v1 offset:256
    ds_read_b128 a[84:87], v1 offset:320
    v_mfma_f32_16x16x32_bf16 v[244:247], a[236:239], v[60:63], v[244:247]
    s_waitcnt lgkmcnt(10)
    buffer_load_dwordx4 v5, s[16:19], s46 offen offset:3072 lds
    v_mfma_f32_16x16x32_bf16 v[216:219], a[240:243], v[48:51], v[216:219]
    ds_read_b128 a[88:91], v1 offset:384
    ds_read_b128 a[92:95], v1 offset:448
    v_mfma_f32_16x16x32_bf16 v[216:219], a[244:247], v[52:55], v[216:219]
    ds_read_b128 a[96:99], v1 offset:512
    ds_read_b128 a[100:103], v1 offset:576
    v_mfma_f32_16x16x32_bf16 v[248:251], a[240:243], v[56:59], v[248:251]
    s_add_u32 m0, s44, 16896
    ds_read_b128 a[104:107], v1 offset:640
    ds_read_b128 a[108:111], v1 offset:704
    v_mfma_f32_16x16x32_bf16 v[248:251], a[244:247], v[60:63], v[248:251]
    s_waitcnt lgkmcnt(12)
    buffer_load_dwordx4 v5, s[20:23], s46 offen offset:0 lds
    v_mfma_f32_16x16x32_bf16 v[220:223], a[248:251], v[48:51], v[220:223]
    ds_read_b128 a[112:115], v1 offset:768
    ds_read_b128 a[116:119], v1 offset:832
    v_mfma_f32_16x16x32_bf16 v[220:223], a[252:255], v[52:55], v[220:223]
    ds_read_b128 a[120:123], v1 offset:896
    ds_read_b128 a[124:127], v1 offset:960
    v_mfma_f32_16x16x32_bf16 v[252:255], a[248:251], v[56:59], v[252:255]
    s_add_u32 m0, s44, 16928
    v_cvt_pk_bf16_f32 v75, v150, v151
    v_cvt_pk_bf16_f32 v88, v176, v177
    v_mfma_f32_16x16x32_bf16 v[252:255], a[252:255], v[60:63], v[252:255]
    buffer_load_dwordx4 v5, s[20:23], s46 offen offset:1024 lds
    s_mul_i32 s3, s96, 9216
    s_add_u32 s3, s3, 4194304
    s_add_u32 s32, s84, s3
    s_addc_u32 s33, s85, 0
    s_mov_b32 s34, 9216
    s_mov_b32 s35, 0x20000
    s_add_u32 m0, s44, 16960
    s_nop 0
    buffer_load_dwordx4 v5, s[20:23], s46 offen offset:2048 lds
    s_add_u32 m0, s44, 16992
    s_nop 0
    buffer_load_dwordx4 v5, s[20:23], s46 offen offset:3072 lds
    v_cvt_pk_bf16_f32 v89, v178, v179
    v_cvt_pk_bf16_f32 v90, v180, v181
    v_cvt_pk_bf16_f32 v91, v182, v183
    v_cvt_pk_bf16_f32 v76, v152, v153
    v_cvt_pk_bf16_f32 v77, v154, v155
    v_cvt_pk_bf16_f32 v78, v156, v157
    v_cvt_pk_bf16_f32 v79, v158, v159
    v_cvt_pk_bf16_f32 v92, v184, v185
    v_cvt_pk_bf16_f32 v93, v186, v187
    v_cvt_pk_bf16_f32 v94, v188, v189
    v_cvt_pk_bf16_f32 v95, v190, v191
    v_permlane32_swap_b32 v64, v66
    v_permlane32_swap_b32 v65, v67
    v_permlane32_swap_b32 v80, v82
    v_permlane32_swap_b32 v81, v83
    v_permlane32_swap_b32 v68, v70
    v_permlane32_swap_b32 v69, v71
    v_permlane32_swap_b32 v84, v86
    v_permlane32_swap_b32 v85, v87
    v_permlane32_swap_b32 v72, v74
    v_permlane32_swap_b32 v73, v75
    v_permlane32_swap_b32 v88, v90
    v_permlane32_swap_b32 v89, v91
    v_permlane32_swap_b32 v76, v78
    v_permlane32_swap_b32 v77, v79
    v_permlane32_swap_b32 v92, v94
    v_permlane32_swap_b32 v93, v95
    v_cvt_pk_bf16_f32 v96, v192, v193
    v_cvt_pk_bf16_f32 v97, v194, v195
    v_cvt_pk_bf16_f32 v98, v196, v197
    v_cvt_pk_bf16_f32 v99, v198, v199
    v_cvt_pk_bf16_f32 v112, v224, v225
    v_cvt_pk_bf16_f32 v113, v226, v227
    v_cvt_pk_bf16_f32 v114, v228, v229
    v_cvt_pk_bf16_f32 v115, v230, v231
    v_cvt_pk_bf16_f32 v100, v200, v201
    v_cvt_pk_bf16_f32 v101, v202, v203
    v_cvt_pk_bf16_f32 v102, v204, v205
    v_cvt_pk_bf16_f32 v103, v206, v207
    v_cvt_pk_bf16_f32 v116, v232, v233
    v_cvt_pk_bf16_f32 v117, v234, v235
    v_cvt_pk_bf16_f32 v118, v236, v237
    v_cvt_pk_bf16_f32 v119, v238, v239
    v_cvt_pk_bf16_f32 v104, v208, v209
    v_cvt_pk_bf16_f32 v105, v210, v211
    v_cvt_pk_bf16_f32 v106, v212, v213
    v_cvt_pk_bf16_f32 v107, v214, v215
    v_cvt_pk_bf16_f32 v120, v240, v241
    v_cvt_pk_bf16_f32 v121, v242, v243
    v_cvt_pk_bf16_f32 v122, v244, v245
    v_cvt_pk_bf16_f32 v123, v246, v247
    v_cvt_pk_bf16_f32 v108, v216, v217
    v_cvt_pk_bf16_f32 v109, v218, v219
    v_cvt_pk_bf16_f32 v110, v220, v221
    v_cvt_pk_bf16_f32 v111, v222, v223
    v_cvt_pk_bf16_f32 v124, v248, v249
    v_cvt_pk_bf16_f32 v125, v250, v251
    v_cvt_pk_bf16_f32 v126, v252, v253
    v_cvt_pk_bf16_f32 v127, v254, v255
    s_nop 0
    v_permlane32_swap_b32 v96, v98
    v_permlane32_swap_b32 v97, v99
    v_permlane32_swap_b32 v112, v114
    v_permlane32_swap_b32 v113, v115
    v_permlane32_swap_b32 v100, v102
    v_permlane32_swap_b32 v101, v103
    v_permlane32_swap_b32 v116, v118
    v_permlane32_swap_b32 v117, v119
    v_permlane32_swap_b32 v104, v106
    v_permlane32_swap_b32 v105, v107
    v_permlane32_swap_b32 v120, v122
    v_permlane32_swap_b32 v121, v123
    v_permlane32_swap_b32 v108, v110
    v_permlane32_swap_b32 v109, v111
    v_permlane32_swap_b32 v124, v126
    v_permlane32_swap_b32 v125, v127
    s_waitcnt lgkmcnt(12)
    v_mfma_f32_16x16x32_bf16 v[16:19], a[64:67], v[64:67], 0
    v_mfma_f32_16x16x32_bf16 v[16:19], a[68:71], v[68:71], v[16:19]
    v_mfma_f32_16x16x32_bf16 v[16:19], a[72:75], v[72:75], v[16:19]
    v_mfma_f32_16x16x32_bf16 v[16:19], a[76:79], v[76:79], v[16:19]
    v_mfma_f32_16x16x32_bf16 v[20:23], a[64:67], v[80:83], 0
    v_mfma_f32_16x16x32_bf16 v[20:23], a[68:71], v[84:87], v[20:23]
    v_mfma_f32_16x16x32_bf16 v[20:23], a[72:75], v[88:91], v[20:23]
    v_mfma_f32_16x16x32_bf16 v[20:23], a[76:79], v[92:95], v[20:23]
    v_mfma_f32_16x16x32_bf16 v[24:27], a[64:67], v[96:99], 0
    v_mfma_f32_16x16x32_bf16 v[24:27], a[68:71], v[100:103], v[24:27]
    v_mfma_f32_16x16x32_bf16 v[24:27], a[72:75], v[104:107], v[24:27]
    v_mfma_f32_16x16x32_bf16 v[24:27], a[76:79], v[108:111], v[24:27]
    v_mfma_f32_16x16x32_bf16 v[28:31], a[64:67], v[112:115], 0
    v_mfma_f32_16x16x32_bf16 v[28:31], a[68:71], v[116:119], v[28:31]
    v_mfma_f32_16x16x32_bf16 v[28:31], a[72:75], v[120:123], v[28:31]
    v_mfma_f32_16x16x32_bf16 v[28:31], a[76:79], v[124:127], v[28:31]
    s_nop 1
    v_max3_f32 v16, v16, v17, v18
    v_max_f32 v16, v16, v19
    v_max3_f32 v20, v20, v21, v22
    v_max_f32 v20, v20, v23
    v_max3_f32 v24, v24, v25, v26
    v_max_f32 v24, v24, v27
    v_max3_f32 v28, v28, v29, v30
    v_max_f32 v28, v28, v31
    v_mov_b32 v40, v16
    v_mov_b32 v41, v20
    v_mov_b32 v42, v24
    v_mov_b32 v43, v28
    v_permlane16_swap_b32 v40, v16
    v_permlane16_swap_b32 v41, v20
    v_permlane16_swap_b32 v42, v24
    v_permlane16_swap_b32 v43, v28
    v_max_f32 v16, v16, v40
    v_max_f32 v20, v20, v41
    v_max_f32 v24, v24, v42
    v_max_f32 v28, v28, v43
    v_mov_b32 v40, v16
    v_mov_b32 v41, v20
    v_mov_b32 v42, v24
    v_mov_b32 v43, v28
    v_permlane32_swap_b32 v40, v16
    v_permlane32_swap_b32 v41, v20
    v_permlane32_swap_b32 v42, v24
    v_permlane32_swap_b32 v43, v28
    v_max_f32 v16, v16, v40
    v_max_f32 v20, v20, v41
    v_max_f32 v24, v24, v42
    v_max_f32 v28, v28, v43
    v_sub_f32 v48, 0xc2000000, v16
    v_sub_f32 v49, 0xc2000000, v16
    v_sub_f32 v50, 0xc2000000, v16
    v_sub_f32 v51, 0xc2000000, v16
    v_sub_f32 v52, 0xc2000000, v20
    v_sub_f32 v53, 0xc2000000, v20
    v_sub_f32 v54, 0xc2000000, v20
    v_sub_f32 v55, 0xc2000000, v20
    v_sub_f32 v56, 0xc2000000, v24
    v_sub_f32 v57, 0xc2000000, v24
    v_sub_f32 v58, 0xc2000000, v24
    v_sub_f32 v59, 0xc2000000, v24
    v_sub_f32 v60, 0xc2000000, v28
    v_sub_f32 v61, 0xc2000000, v28
    v_sub_f32 v62, 0xc2000000, v28
    v_sub_f32 v63, 0xc2000000, v28
L2_entry:
    s_mov_b32 s47, s44
    s_mov_b32 s48, -73728
    s_mov_b32 s49, 11
    s_mov_b32 s46, 32768
    s_waitcnt vmcnt(8)
    s_barrier
    v_mfma_f32_16x16x32_bf16 v[16:19], a[64:67], v[64:67], v[48:51]
    ds_read_b64_tr_b16 a[128:129], v2 offset:0
    ds_read_b64_tr_b16 a[130:131], v2 offset:256
    v_mfma_f32_16x16x32_bf16 v[16:19], a[68:71], v[68:71], v[16:19]
    ds_read_b64_tr_b16 a[132:133], v2 offset:512
    ds_read_b64_tr_b16 a[134:135], v2 offset:768
    v_mfma_f32_16x16x32_bf16 v[16:19], a[72:75], v[72:75], v[16:19]
    s_add_u32 m0, s47, 36864
    ds_read_b64_tr_b16 a[136:137], v2 offset:32
    ds_read_b64_tr_b16 a[138:139], v2 offset:288
    v_mfma_f32_16x16x32_bf16 v[16:19], a[76:79], v[76:79], v[16:19]
    s_waitcnt lgkmcnt(14)
    s_add_u32 s46, s46, 16384
    buffer_load_dwordx4 v5, s[16:19], s46 offen offset:0 lds
    v_mfma_f32_16x16x32_bf16 v[20:23], a[80:83], v[64:67], v[48:51]
    ds_read_b64_tr_b16 a[140:141], v2 offset:544
    ds_read_b64_tr_b16 a[142:143], v2 offset:800
    v_mfma_f32_16x16x32_bf16 v[20:23], a[84:87], v[68:71], v[20:23]
    ds_read_b64_tr_b16 a[144:145], v2 offset:64
    ds_read_b64_tr_b16 a[146:147], v2 offset:320
    v_mfma_f32_16x16x32_bf16 v[20:23], a[88:91], v[72:75], v[20:23]
    s_add_u32 m0, s47, 36896
    ds_read_b64_tr_b16 a[148:149], v2 offset:576
    ds_read_b64_tr_b16 a[150:151], v2 offset:832
    v_mfma_f32_16x16x32_bf16 v[20:23], a[92:95], v[76:79], v[20:23]
    s_waitcnt lgkmcnt(15)
    buffer_load_dwordx4 v5, s[16:19], s46 offen offset:1024 lds
    v_mfma_f32_16x16x32_bf16 v[24:27], a[96:99], v[64:67], v[48:51]
    s_nop 1
    v_exp_f32 v16, v16
    v_mfma_f32_16x16x32_bf16 v[24:27], a[100:103], v[68:71], v[24:27]
    ds_read_b64_tr_b16 a[152:153], v2 offset:96
    ds_read_b64_tr_b16 a[154:155], v2 offset:352
    v_mfma_f32_16x16x32_bf16 v[24:27], a[104:107], v[72:75], v[24:27]
    s_add_u32 m0, s47, 36928
    v_exp_f32 v17, v17
    v_mfma_f32_16x16x32_bf16 v[24:27], a[108:111], v[76:79], v[24:27]
    s_waitcnt lgkmcnt(14)
    buffer_load_dwordx4 v5, s[16:19], s46 offen offset:2048 lds
    v_mfma_f32_16x16x32_bf16 v[28:31], a[112:115], v[64:67], v[48:51]
    v_exp_f32 v18, v18
    v_mfma_f32_16x16x32_bf16 v[28:31], a[116:119], v[68:71], v[28:31]
    ds_read_b64_tr_b16 a[156:157], v2 offset:608
    v_cvt_pk_bf16_f32 v32, v16, v17
    v_mfma_f32_16x16x32_bf16 v[28:31], a[120:123], v[72:75], v[28:31]
    s_add_u32 m0, s47, 36960
    v_exp_f32 v19, v19
    v_mfma_f32_16x16x32_bf16 v[28:31], a[124:127], v[76:79], v[28:31]
    buffer_load_dwordx4 v5, s[16:19], s46 offen offset:3072 lds
    s_nop 3
    ds_read_b64_tr_b16 a[158:159], v2 offset:864
    ds_read_b64_tr_b16 a[160:161], v2 offset:128
    ds_read_b64_tr_b16 a[162:163], v2 offset:384
    ds_read_b64_tr_b16 a[164:165], v2 offset:640
    ds_read_b64_tr_b16 a[166:167], v2 offset:896
    ds_read_b64_tr_b16 a[168:169], v2 offset:160
    ds_read_b64_tr_b16 a[170:171], v2 offset:416
    ds_read_b64_tr_b16 a[172:173], v2 offset:672
    ds_read_b64_tr_b16 a[174:175], v2 offset:928
    ds_read_b64_tr_b16 a[176:177], v2 offset:192
    ds_read_b64_tr_b16 a[178:179], v2 offset:448
    ds_read_b64_tr_b16 a[180:181], v2 offset:704
    ds_read_b64_tr_b16 a[182:183], v2 offset:960
    ds_read_b64_tr_b16 a[184:185], v2 offset:224
    ds_read_b64_tr_b16 a[186:187], v2 offset:480
    ds_read_b64_tr_b16 a[188:189], v2 offset:736
    ds_read_b64_tr_b16 a[190:191], v2 offset:992
    v_exp_f32 v20, v20
    s_nop 0
    ds_read_b64_tr_b16 a[192:193], v2 offset:36864
    v_cvt_pk_bf16_f32 v33, v18, v19
    s_add_u32 m0, s47, 53760
    v_exp_f32 v21, v21
    s_nop 0
    buffer_load_dwordx4 v5, s[20:23], s46 offen offset:0 lds
    v_exp_f32 v22, v22
    s_nop 0
    ds_read_b64_tr_b16 a[194:195], v2 offset:37120
    v_cvt_pk_bf16_f32 v34, v20, v21
    s_add_u32 m0, s47, 53792
    v_exp_f32 v23, v23
    s_nop 0
    buffer_load_dwordx4 v5, s[20:23], s46 offen offset:1024 lds
    v_exp_f32 v24, v24
    s_nop 0
    ds_read_b64_tr_b16 a[196:197], v2 offset:37376
    v_cvt_pk_bf16_f32 v35, v22, v23
    s_add_u32 m0, s47, 53824
    v_exp_f32 v25, v25
    s_nop 0
    buffer_load_dwordx4 v5, s[20:23], s46 offen offset:2048 lds
    v_exp_f32 v26, v26
    s_nop 0
    ds_read_b64_tr_b16 a[198:199], v2 offset:37632
    v_cvt_pk_bf16_f32 v36, v24, v25
    s_add_u32 m0, s47, 53856
    v_exp_f32 v27, v27
    s_nop 0
    buffer_load_dwordx4 v5, s[20:23], s46 offen offset:3072 lds
    ds_read_b64_tr_b16 a[200:201], v2 offset:36896
    s_nop 0
    v_mfma_f32_16x16x32_bf16 v[16:19], a[64:67], v[80:83], v[52:55]
    v_exp_f32 v28, v28
    v_mfma_f32_16x16x32_bf16 v[16:19], a[68:71], v[84:87], v[16:19]
    ds_read_b64_tr_b16 a[202:203], v2 offset:37152
    v_cvt_pk_bf16_f32 v37, v26, v27
    v_mfma_f32_16x16x32_bf16 v[16:19], a[72:75], v[88:91], v[16:19]
    v_exp_f32 v29, v29
    v_mfma_f32_16x16x32_bf16 v[16:19], a[76:79], v[92:95], v[16:19]
    ds_read_b64_tr_b16 a[204:205], v2 offset:37408
    v_mov_b32 v224, 0
    v_mfma_f32_16x16x32_bf16 v[20:23], a[80:83], v[80:83], v[52:55]
    v_exp_f32 v30, v30
    v_mfma_f32_16x16x32_bf16 v[20:23], a[84:87], v[84:87], v[20:23]
    ds_read_b64_tr_b16 a[206:207], v2 offset:37664
    v_cvt_pk_bf16_f32 v38, v28, v29
    v_mfma_f32_16x16x32_bf16 v[20:23], a[88:91], v[88:91], v[20:23]
    v_exp_f32 v31, v31
    v_mfma_f32_16x16x32_bf16 v[20:23], a[92:95], v[92:95], v[20:23]
    ds_read_b64_tr_b16 a[208:209], v2 offset:36928
    v_mov_b32 v225, 0
    v_mfma_f32_16x16x32_bf16 v[24:27], a[96:99], v[80:83], v[52:55]
    v_exp_f32 v16, v16
    v_mfma_f32_16x16x32_bf16 v[24:27], a[100:103], v[84:87], v[24:27]
    ds_read_b64_tr_b16 a[210:211], v2 offset:37184
    v_cvt_pk_bf16_f32 v39, v30, v31
    v_mfma_f32_16x16x32_bf16 v[24:27], a[104:107], v[88:91], v[24:27]
    v_exp_f32 v17, v17
    v_mfma_f32_16x16x32_bf16 v[24:27], a[108:111], v[92:95], v[24:27]
    ds_read_b64_tr_b16 a[212:213], v2 offset:37440
    v_mov_b32 v226, 0
    v_mfma_f32_16x16x32_bf16 v[28:31], a[112:115], v[80:83], v[52:55]
    v_exp_f32 v18, v18
    v_mfma_f32_16x16x32_bf16 v[28:31], a[116:119], v[84:87], v[28:31]
    ds_read_b64_tr_b16 a[214:215], v2 offset:37696
    v_cvt_pk_bf16_f32 v40, v16, v17
    v_mfma_f32_16x16x32_bf16 v[28:31], a[120:123], v[88:91], v[28:31]
    s_waitcnt lgkmcnt(12)
    v_exp_f32 v19, v19
    v_mfma_f32_16x16x32_bf16 v[28:31], a[124:127], v[92:95], v[28:31]
    ds_read_b64_tr_b16 a[216:217], v2 offset:36960
    v_mov_b32 v227, 0
    v_mfma_f32_16x16x32_bf16 v[128:131], a[128:131], v[32:35], 0
    v_exp_f32 v20, v20
    v_mfma_f32_16x16x32_bf16 v[128:131], a[132:135], v[36:39], v[128:131]
    ds_read_b64_tr_b16 a[218:219], v2 offset:37216
    v_cvt_pk_bf16_f32 v41, v18, v19
    v_mfma_f32_16x16x32_bf16 v[132:135], a[136:139], v[32:35], 0
    v_exp_f32 v21, v21
    v_mfma_f32_16x16x32_bf16 v[132:135], a[140:143], v[36:39], v[132:135]
    ds_read_b64_tr_b16 a[220:221], v2 offset:37472
    v_mov_b32 v228, 0
    v_mfma_f32_16x16x32_bf16 v[136:139], a[144:147], v[32:35], 0
    v_exp_f32 v22, v22
    v_mfma_f32_16x16x32_bf16 v[136:139], a[148:151], v[36:39], v[136:139]
    ds_read_b64_tr_b16 a[222:223], v2 offset:37728
    v_cvt_pk_bf16_f32 v42, v20, v21
    v_mfma_f32_16x16x32_bf16 v[140:143], a[152:155], v[32:35], 0
    v_exp_f32 v23, v23
    v_mfma_f32_16x16x32_bf16 v[140:143], a[156:159], v[36:39], v[140:143]
    ds_read_b64_tr_b16 a[224:225], v2 offset:36992
    v_mov_b32 v229, 0
    v_mfma_f32_16x16x32_bf16 v[144:147], a[160:163], v[32:35], 0
    v_exp_f32 v24, v24
    v_mfma_f32_16x16x32_bf16 v[144:147], a[164:167], v[36:39], v[144:147]
    ds_read_b64_tr_b16 a[226:227], v2 offset:37248
    v_cvt_pk_bf16_f32 v43, v22, v23
    v_mfma_f32_16x16x32_bf16 v[148:151], a[168:171], v[32:35], 0
    v_exp_f32 v25, v25
    v_mfma_f32_16x16x32_bf16 v[148:151], a[172:175], v[36:39], v[148:151]
    ds_read_b64_tr_b16 a[228:229], v2 offset:37504
    v_mov_b32 v230, 0
    v_mfma_f32_16x16x32_bf16 v[152:155], a[176:179], v[32:35], 0
    v_exp_f32 v26, v26
    v_mfma_f32_16x16x32_bf16 v[152:155], a[180:183], v[36:39], v[152:155]
    ds_read_b64_tr_b16 a[230:231], v2 offset:37760
    v_cvt_pk_bf16_f32 v44, v24, v25
    v_mfma_f32_16x16x32_bf16 v[156:159], a[184:187], v[32:35], 0
    v_exp_f32 v27, v27
    v_mfma_f32_16x16x32_bf16 v[156:159], a[188:191], v[36:39], v[156:159]
    ds_read_b64_tr_b16 a[232:233], v2 offset:37024
    v_mov_b32 v231, 0
    v_smfmac_f32_16x16x64_bf16 a[0:3], a[16:19], v[32:39], v11
    ds_read_b64_tr_b16 a[234:235], v2 offset:37280
    v_mov_b32 v232, 0
    v_mfma_f32_16x16x32_bf16 v[16:19], a[64:67], v[96:99], v[56:59]
    v_exp_f32 v28, v28
    v_mfma_f32_16x16x32_bf16 v[16:19], a[68:71], v[100:103], v[16:19]
    ds_read_b64_tr_b16 a[236:237], v2 offset:37536
    v_cvt_pk_bf16_f32 v45, v26, v27
    v_mfma_f32_16x16x32_bf16 v[16:19], a[72:75], v[104:107], v[16:19]
    v_exp_f32 v29, v29
    v_mfma_f32_16x16x32_bf16 v[16:19], a[76:79], v[108:111], v[16:19]
    ds_read_b64_tr_b16 a[238:239], v2 offset:37792
    v_mov_b32 v233, 0
    v_mfma_f32_16x16x32_bf16 v[20:23], a[80:83], v[96:99], v[56:59]
    v_exp_f32 v30, v30
    v_mfma_f32_16x16x32_bf16 v[20:23], a[84:87], v[100:103], v[20:23]
    ds_read_b64_tr_b16 a[240:241], v2 offset:37056
    v_cvt_pk_bf16_f32 v46, v28, v29
    v_mfma_f32_16x16x32_bf16 v[20:23], a[88:91], v[104:107], v[20:23]
    v_exp_f32 v31, v31
    v_mfma_f32_16x16x32_bf16 v[20:23], a[92:95], v[108:111], v[20:23]
    ds_read_b64_tr_b16 a[242:243], v2 offset:37312
    v_mov_b32 v234, 0
    v_mfma_f32_16x16x32_bf16 v[24:27], a[96:99], v[96:99], v[56:59]
    v_exp_f32 v16, v16
    v_mfma_f32_16x16x32_bf16 v[24:27], a[100:103], v[100:103], v[24:27]
    ds_read_b64_tr_b16 a[244:245], v2 offset:37568
    v_cvt_pk_bf16_f32 v47, v30, v31
    v_mfma_f32_16x16x32_bf16 v[24:27], a[104:107], v[104:107], v[24:27]
    v_exp_f32 v17, v17
    v_mfma_f32_16x16x32_bf16 v[24:27], a[108:111], v[108:111], v[24:27]
    ds_read_b64_tr_b16 a[246:247], v2 offset:37824
    v_mov_b32 v235, 0
    v_mfma_f32_16x16x32_bf16 v[28:31], a[112:115], v[96:99], v[56:59]
    v_exp_f32 v18, v18
    v_mfma_f32_16x16x32_bf16 v[28:31], a[116:119], v[100:103], v[28:31]
    ds_read_b64_tr_b16 a[248:249], v2 offset:37088
    v_cvt_pk_bf16_f32 v32, v16, v17
    v_mfma_f32_16x16x32_bf16 v[28:31], a[120:123], v[104:107], v[28:31]
    v_exp_f32 v19, v19
    v_mfma_f32_16x16x32_bf16 v[28:31], a[124:127], v[108:111], v[28:31]
    ds_read_b64_tr_b16 a[250:251], v2 offset:37344
    v_mov_b32 v236, 0
    v_mfma_f32_16x16x32_bf16 v[160:163], a[128:131], v[40:43], 0
    v_exp_f32 v20, v20
    v_mfma_f32_16x16x32_bf16 v[160:163], a[132:135], v[44:47], v[160:163]
    ds_read_b64_tr_b16 a[252:253], v2 offset:37600
    v_cvt_pk_bf16_f32 v33, v18, v19
    v_mfma_f32_16x16x32_bf16 v[164:167], a[136:139], v[40:43], 0
    v_exp_f32 v21, v21
    v_mfma_f32_16x16x32_bf16 v[164:167], a[140:143], v[44:47], v[164:167]
    ds_read_b64_tr_b16 a[254:255], v2 offset:37856
    v_mov_b32 v237, 0
    v_mfma_f32_16x16x32_bf16 v[168:171], a[144:147], v[40:43], 0
    v_exp_f32 v22, v22
    v_mfma_f32_16x16x32_bf16 v[168:171], a[148:151], v[44:47], v[168:171]
    v_cvt_pk_bf16_f32 v34, v20, v21
    v_mov_b32 v238, 0
    v_mfma_f32_16x16x32_bf16 v[172:175], a[152:155], v[40:43], 0
    v_exp_f32 v23, v23
    v_mfma_f32_16x16x32_bf16 v[172:175], a[156:159], v[44:47], v[172:175]
    v_mov_b32 v239, 0
    v_mov_b32 v240, 0
    v_mfma_f32_16x16x32_bf16 v[176:179], a[160:163], v[40:43], 0
    v_exp_f32 v24, v24
    v_mfma_f32_16x16x32_bf16 v[176:179], a[164:167], v[44:47], v[176:179]
    v_cvt_pk_bf16_f32 v35, v22, v23
    v_mov_b32 v241, 0
    v_mfma_f32_16x16x32_bf16 v[180:183], a[168:171], v[40:43], 0
    v_exp_f32 v25, v25
    v_mfma_f32_16x16x32_bf16 v[180:183], a[172:175], v[44:47], v[180:183]
    v_mov_b32 v242, 0
    v_mov_b32 v243, 0
    v_mfma_f32_16x16x32_bf16 v[184:187], a[176:179], v[40:43], 0
    v_exp_f32 v26, v26
    v_mfma_f32_16x16x32_bf16 v[184:187], a[180:183], v[44:47], v[184:187]
    v_cvt_pk_bf16_f32 v36, v24, v25
    v_mov_b32 v244, 0
    v_mfma_f32_16x16x32_bf16 v[188:191], a[184:187], v[40:43], 0
    v_exp_f32 v27, v27
    v_mfma_f32_16x16x32_bf16 v[188:191], a[188:191], v[44:47], v[188:191]
    v_mov_b32 v245, 0
    v_mov_b32 v246, 0
    v_smfmac_f32_16x16x64_bf16 a[4:7], a[16:19], v[40:47], v11
    v_mov_b32 v247, 0
    v_mov_b32 v248, 0
    v_mfma_f32_16x16x32_bf16 v[16:19], a[64:67], v[112:115], v[60:63]
    v_exp_f32 v28, v28
    v_mfma_f32_16x16x32_bf16 v[16:19], a[68:71], v[116:119], v[16:19]
    ds_read_b128 a[64:67], v1 offset:36864
    v_cvt_pk_bf16_f32 v37, v26, v27
    v_mfma_f32_16x16x32_bf16 v[16:19], a[72:75], v[120:123], v[16:19]
    v_exp_f32 v29, v29
    v_mfma_f32_16x16x32_bf16 v[16:19], a[76:79], v[124:127], v[16:19]
    ds_read_b128 a[68:71], v1 offset:36928
    v_mov_b32 v249, 0
    v_mfma_f32_16x16x32_bf16 v[20:23], a[80:83], v[112:115], v[60:63]
    v_exp_f32 v30, v30
    v_mfma_f32_16x16x32_bf16 v[20:23], a[84:87], v[116:119], v[20:23]
    ds_read_b128 a[72:75], v1 offset:36992
    v_cvt_pk_bf16_f32 v38, v28, v29
    v_mfma_f32_16x16x32_bf16 v[20:23], a[88:91], v[120:123], v[20:23]
    v_exp_f32 v31, v31
    v_mfma_f32_16x16x32_bf16 v[20:23], a[92:95], v[124:127], v[20:23]
    ds_read_b128 a[76:79], v1 offset:37056
    v_mov_b32 v250, 0
    v_mfma_f32_16x16x32_bf16 v[24:27], a[96:99], v[112:115], v[60:63]
    v_exp_f32 v16, v16
    v_mfma_f32_16x16x32_bf16 v[24:27], a[100:103], v[116:119], v[24:27]
    ds_read_b128 a[80:83], v1 offset:37120
    v_cvt_pk_bf16_f32 v39, v30, v31
    v_mfma_f32_16x16x32_bf16 v[24:27], a[104:107], v[120:123], v[24:27]
    v_exp_f32 v17, v17
    v_mfma_f32_16x16x32_bf16 v[24:27], a[108:111], v[124:127], v[24:27]
    ds_read_b128 a[84:87], v1 offset:37184
    v_mov_b32 v251, 0
    v_mfma_f32_16x16x32_bf16 v[28:31], a[112:115], v[112:115], v[60:63]
    v_exp_f32 v18, v18
    v_mfma_f32_16x16x32_bf16 v[28:31], a[116:119], v[116:119], v[28:31]
    ds_read_b128 a[88:91], v1 offset:37248
    v_cvt_pk_bf16_f32 v40, v16, v17
    v_mfma_f32_16x16x32_bf16 v[28:31], a[120:123], v[120:123], v[28:31]
    v_exp_f32 v19, v19
    v_mfma_f32_16x16x32_bf16 v[28:31], a[124:127], v[124:127], v[28:31]
    ds_read_b128 a[92:95], v1 offset:37312
    v_mov_b32 v252, 0
    v_mfma_f32_16x16x32_bf16 v[192:195], a[128:131], v[32:35], 0
    v_exp_f32 v20, v20
    v_mfma_f32_16x16x32_bf16 v[192:195], a[132:135], v[36:39], v[192:195]
    ds_read_b128 a[96:99], v1 offset:37376
    v_cvt_pk_bf16_f32 v41, v18, v19
    v_mfma_f32_16x16x32_bf16 v[196:199], a[136:139], v[32:35], 0
    v_exp_f32 v21, v21
    v_mfma_f32_16x16x32_bf16 v[196:199], a[140:143], v[36:39], v[196:199]
    ds_read_b128 a[100:103], v1 offset:37440
    v_mov_b32 v253, 0
    v_mfma_f32_16x16x32_bf16 v[200:203], a[144:147], v[32:35], 0
    v_exp_f32 v22, v22
    v_mfma_f32_16x16x32_bf16 v[200:203], a[148:151], v[36:39], v[200:203]
    ds_read_b128 a[104:107], v1 offset:37504
    v_cvt_pk_bf16_f32 v42, v20, v21
    v_mfma_f32_16x16x32_bf16 v[204:207], a[152:155], v[32:35], 0
    v_exp_f32 v23, v23
    v_mfma_f32_16x16x32_bf16 v[204:207], a[156:159], v[36:39], v[204:207]
    ds_read_b128 a[108:111], v1 offset:37568
    v_mov_b32 v254, 0
    v_mfma_f32_16x16x32_bf16 v[208:211], a[160:163], v[32:35], 0
    v_exp_f32 v24, v24
    v_mfma_f32_16x16x32_bf16 v[208:211], a[164:167], v[36:39], v[208:211]
    ds_read_b128 a[112:115], v1 offset:37632
    v_cvt_pk_bf16_f32 v43, v22, v23
    v_mfma_f32_16x16x32_bf16 v[212:215], a[168:171], v[32:35], 0
    v_exp_f32 v25, v25
    v_mfma_f32_16x16x32_bf16 v[212:215], a[172:175], v[36:39], v[212:215]
    ds_read_b128 a[116:119], v1 offset:37696
    v_mov_b32 v255, 0
    v_mfma_f32_16x16x32_bf16 v[216:219], a[176:179], v[32:35], 0
    v_exp_f32 v26, v26
    v_mfma_f32_16x16x32_bf16 v[216:219], a[180:183], v[36:39], v[216:219]
    ds_read_b128 a[120:123], v1 offset:37760
    v_cvt_pk_bf16_f32 v44, v24, v25
    v_mfma_f32_16x16x32_bf16 v[220:223], a[184:187], v[32:35], 0
    v_exp_f32 v27, v27
    v_mfma_f32_16x16x32_bf16 v[220:223], a[188:191], v[36:39], v[220:223]
    ds_read_b128 a[124:127], v1 offset:37824
    v_smfmac_f32_16x16x64_bf16 a[8:11], a[16:19], v[32:39], v11
    s_waitcnt lgkmcnt(12)
.p2align 5
L2_loop:
    v_mfma_f32_16x16x32_bf16 v[16:19], a[64:67], v[64:67], v[48:51]
    s_sub_u32 s47, s47, s48
    v_exp_f32 v28, v28
    v_mfma_f32_16x16x32_bf16 v[16:19], a[68:71], v[68:71], v[16:19]
    v_cvt_pk_bf16_f32 v45, v26, v27
    v_add_u32 v1, s48, v1
    v_mfma_f32_16x16x32_bf16 v[16:19], a[72:75], v[72:75], v[16:19]
    v_exp_f32 v29, v29
    v_mfma_f32_16x16x32_bf16 v[16:19], a[76:79], v[76:79], v[16:19]
    s_waitcnt lgkmcnt(8)
    v_mfma_f32_16x16x32_bf16 v[20:23], a[80:83], v[64:67], v[48:51]
    v_exp_f32 v30, v30
    v_mfma_f32_16x16x32_bf16 v[20:23], a[84:87], v[68:71], v[20:23]
    v_cvt_pk_bf16_f32 v46, v28, v29
    v_add_u32 v2, s48, v2
    v_mfma_f32_16x16x32_bf16 v[20:23], a[88:91], v[72:75], v[20:23]
    v_exp_f32 v31, v31
    v_mfma_f32_16x16x32_bf16 v[20:23], a[92:95], v[76:79], v[20:23]
    s_waitcnt lgkmcnt(4)
    v_mfma_f32_16x16x32_bf16 v[24:27], a[96:99], v[64:67], v[48:51]
    s_sub_u32 s48, 0, s48
    v_exp_f32 v16, v16
    v_mfma_f32_16x16x32_bf16 v[24:27], a[100:103], v[68:71], v[24:27]
    v_cvt_pk_bf16_f32 v47, v30, v31
    v_mfma_f32_16x16x32_bf16 v[24:27], a[104:107], v[72:75], v[24:27]
    v_exp_f32 v17, v17
    v_mfma_f32_16x16x32_bf16 v[24:27], a[108:111], v[76:79], v[24:27]
    s_waitcnt lgkmcnt(0)
    v_mfma_f32_16x16x32_bf16 v[28:31], a[112:115], v[64:67], v[48:51]
L2_pad4:
    s_cbranch_execz L2_pad8
    v_exp_f32 v18, v18
    v_mfma_f32_16x16x32_bf16 v[28:31], a[116:119], v[68:71], v[28:31]
    v_cvt_pk_bf16_f32 v32, v16, v17
    v_mfma_f32_16x16x32_bf16 v[28:31], a[120:123], v[72:75], v[28:31]
    v_exp_f32 v19, v19
    v_mfma_f32_16x16x32_bf16 v[28:31], a[124:127], v[76:79], v[28:31]
    s_waitcnt vmcnt(0)
    s_barrier
    v_mfma_f32_16x16x32_bf16 v[224:227], a[128:131], v[40:43], v[224:227]
    v_exp_f32 v20, v20
    v_mfma_f32_16x16x32_bf16 v[224:227], a[132:135], v[44:47], v[224:227]
    ds_read_b64_tr_b16 a[128:129], v2 offset:0
    v_cvt_pk_bf16_f32 v33, v18, v19
    v_mfma_f32_16x16x32_bf16 v[228:231], a[136:139], v[40:43], v[228:231]
    s_add_u32 m0, s47, 0
    v_exp_f32 v21, v21
    v_mfma_f32_16x16x32_bf16 v[228:231], a[140:143], v[44:47], v[228:231]
    s_add_u32 s46, s46, 16384
    buffer_load_dwordx4 v5, s[16:19], s46 offen offset:0 lds
    v_mfma_f32_16x16x32_bf16 v[232:235], a[144:147], v[40:43], v[232:235]
    v_exp_f32 v22, v22
    v_mfma_f32_16x16x32_bf16 v[232:235], a[148:151], v[44:47], v[232:235]
    ds_read_b64_tr_b16 a[130:131], v2 offset:256
    v_cvt_pk_bf16_f32 v34, v20, v21
    v_mfma_f32_16x16x32_bf16 v[236:239], a[152:155], v[40:43], v[236:239]
    s_add_u32 m0, s47, 32
    v_exp_f32 v23, v23
    v_mfma_f32_16x16x32_bf16 v[236:239], a[156:159], v[44:47], v[236:239]
    buffer_load_dwordx4 v5, s[16:19], s46 offen offset:1024 lds
    v_mfma_f32_16x16x32_bf16 v[240:243], a[160:163], v[40:43], v[240:243]
    v_exp_f32 v24, v24
    v_mfma_f32_16x16x32_bf16 v[240:243], a[164:167], v[44:47], v[240:243]
    ds_read_b64_tr_b16 a[132:133], v2 offset:512
    v_cvt_pk_bf16_f32 v35, v22, v23
    v_mfma_f32_16x16x32_bf16 v[244:247], a[168:171], v[40:43], v[244:247]
    s_add_u32 m0, s47, 64
    v_exp_f32 v25, v25
    v_mfma_f32_16x16x32_bf16 v[244:247], a[172:175], v[44:47], v[244:247]
    buffer_load_dwordx4 v5, s[16:19], s46 offen offset:2048 lds
    v_mfma_f32_16x16x32_bf16 v[248:251], a[176:179], v[40:43], v[248:251]
    v_exp_f32 v26, v26
    v_mfma_f32_16x16x32_bf16 v[248:251], a[180:183], v[44:47], v[248:251]
    ds_read_b64_tr_b16 a[134:135], v2 offset:768
    v_cvt_pk_bf16_f32 v36, v24, v25
    v_mfma_f32_16x16x32_bf16 v[252:255], a[184:187], v[40:43], v[252:255]
    s_add_u32 m0, s47, 96
    v_exp_f32 v27, v27
    v_mfma_f32_16x16x32_bf16 v[252:255], a[188:191], v[44:47], v[252:255]
    buffer_load_dwordx4 v5, s[16:19], s46 offen offset:3072 lds
    v_smfmac_f32_16x16x64_bf16 a[12:15], a[16:19], v[40:47], v11
    ds_read_b64_tr_b16 a[136:137], v2 offset:32
    v_mfma_f32_16x16x32_bf16 v[16:19], a[64:67], v[80:83], v[52:55]
    v_exp_f32 v28, v28
    v_mfma_f32_16x16x32_bf16 v[16:19], a[68:71], v[84:87], v[16:19]
    ds_read_b64_tr_b16 a[138:139], v2 offset:288
    v_cvt_pk_bf16_f32 v37, v26, v27
    v_mfma_f32_16x16x32_bf16 v[16:19], a[72:75], v[88:91], v[16:19]
    s_add_u32 m0, s47, 16896
    v_exp_f32 v29, v29
    v_mfma_f32_16x16x32_bf16 v[16:19], a[76:79], v[92:95], v[16:19]
    buffer_load_dwordx4 v5, s[20:23], s46 offen offset:0 lds
    v_mfma_f32_16x16x32_bf16 v[20:23], a[80:83], v[80:83], v[52:55]
    v_exp_f32 v30, v30
    v_mfma_f32_16x16x32_bf16 v[20:23], a[84:87], v[84:87], v[20:23]
    ds_read_b64_tr_b16 a[140:141], v2 offset:544
    v_cvt_pk_bf16_f32 v38, v28, v29
    v_mfma_f32_16x16x32_bf16 v[20:23], a[88:91], v[88:91], v[20:23]
    s_add_u32 m0, s47, 16928
    v_exp_f32 v31, v31
    v_mfma_f32_16x16x32_bf16 v[20:23], a[92:95], v[92:95], v[20:23]
    buffer_load_dwordx4 v5, s[20:23], s46 offen offset:1024 lds
    v_mfma_f32_16x16x32_bf16 v[24:27], a[96:99], v[80:83], v[52:55]
    v_exp_f32 v16, v16
    v_mfma_f32_16x16x32_bf16 v[24:27], a[100:103], v[84:87], v[24:27]
    ds_read_b64_tr_b16 a[142:143], v2 offset:800
    v_cvt_pk_bf16_f32 v39, v30, v31
    v_mfma_f32_16x16x32_bf16 v[24:27], a[104:107], v[88:91], v[24:27]
    s_add_u32 m0, s47, 16960
    v_exp_f32 v17, v17
    v_mfma_f32_16x16x32_bf16 v[24:27], a[108:111], v[92:95], v[24:27]
    buffer_load_dwordx4 v5, s[20:23], s46 offen offset:2048 lds
    v_mfma_f32_16x16x32_bf16 v[28:31], a[112:115], v[80:83], v[52:55]
    v_exp_f32 v18, v18
    v_mfma_f32_16x16x32_bf16 v[28:31], a[116:119], v[84:87], v[28:31]
    ds_read_b64_tr_b16 a[144:145], v2 offset:64
    v_cvt_pk_bf16_f32 v40, v16, v17
    v_mfma_f32_16x16x32_bf16 v[28:31], a[120:123], v[88:91], v[28:31]
    s_add_u32 m0, s47, 16992
    v_exp_f32 v19, v19
    v_mfma_f32_16x16x32_bf16 v[28:31], a[124:127], v[92:95], v[28:31]
    buffer_load_dwordx4 v5, s[20:23], s46 offen offset:3072 lds
    v_mfma_f32_16x16x32_bf16 v[128:131], a[192:195], v[32:35], v[128:131]
    v_exp_f32 v20, v20
    v_mfma_f32_16x16x32_bf16 v[128:131], a[196:199], v[36:39], v[128:131]
    ds_read_b64_tr_b16 a[146:147], v2 offset:320
    v_cvt_pk_bf16_f32 v41, v18, v19
    v_mfma_f32_16x16x32_bf16 v[132:135], a[200:203], v[32:35], v[132:135]
    v_exp_f32 v21, v21
    v_mfma_f32_16x16x32_bf16 v[132:135], a[204:207], v[36:39], v[132:135]
    ds_read_b64_tr_b16 a[148:149], v2 offset:576
    v_mfma_f32_16x16x32_bf16 v[136:139], a[208:211], v[32:35], v[136:139]
    v_exp_f32 v22, v22
    v_mfma_f32_16x16x32_bf16 v[136:139], a[212:215], v[36:39], v[136:139]
    ds_read_b64_tr_b16 a[150:151], v2 offset:832
    v_cvt_pk_bf16_f32 v42, v20, v21
    v_mfma_f32_16x16x32_bf16 v[140:143], a[216:219], v[32:35], v[140:143]
    v_exp_f32 v23, v23
    v_mfma_f32_16x16x32_bf16 v[140:143], a[220:223], v[36:39], v[140:143]
    ds_read_b64_tr_b16 a[152:153], v2 offset:96
    ds_read_b64_tr_b16 a[154:155], v2 offset:352
    v_mfma_f32_16x16x32_bf16 v[144:147], a[224:227], v[32:35], v[144:147]
    v_exp_f32 v24, v24
    v_mfma_f32_16x16x32_bf16 v[144:147], a[228:231], v[36:39], v[144:147]
    ds_read_b64_tr_b16 a[156:157], v2 offset:608
    v_cvt_pk_bf16_f32 v43, v22, v23
    v_mfma_f32_16x16x32_bf16 v[148:151], a[232:235], v[32:35], v[148:151]
    v_exp_f32 v25, v25
    v_mfma_f32_16x16x32_bf16 v[148:151], a[236:239], v[36:39], v[148:151]
    ds_read_b64_tr_b16 a[158:159], v2 offset:864
    ds_read_b64_tr_b16 a[160:161], v2 offset:128
    v_mfma_f32_16x16x32_bf16 v[152:155], a[240:243], v[32:35], v[152:155]
    v_exp_f32 v26, v26
    v_mfma_f32_16x16x32_bf16 v[152:155], a[244:247], v[36:39], v[152:155]
    ds_read_b64_tr_b16 a[162:163], v2 offset:384
    v_cvt_pk_bf16_f32 v44, v24, v25
    v_mfma_f32_16x16x32_bf16 v[156:159], a[248:251], v[32:35], v[156:159]
    v_exp_f32 v27, v27
    v_mfma_f32_16x16x32_bf16 v[156:159], a[252:255], v[36:39], v[156:159]
    ds_read_b64_tr_b16 a[164:165], v2 offset:640
    ds_read_b64_tr_b16 a[166:167], v2 offset:896
    v_smfmac_f32_16x16x64_bf16 a[0:3], a[16:19], v[32:39], v11
    ds_read_b64_tr_b16 a[168:169], v2 offset:160
    ds_read_b64_tr_b16 a[170:171], v2 offset:416
    v_mfma_f32_16x16x32_bf16 v[16:19], a[64:67], v[96:99], v[56:59]
    v_exp_f32 v28, v28
    v_mfma_f32_16x16x32_bf16 v[16:19], a[68:71], v[100:103], v[16:19]
    ds_read_b64_tr_b16 a[172:173], v2 offset:672
    v_cvt_pk_bf16_f32 v45, v26, v27
    v_mfma_f32_16x16x32_bf16 v[16:19], a[72:75], v[104:107], v[16:19]
    s_add_u32 m0, s47, 36864
    v_exp_f32 v29, v29
    v_mfma_f32_16x16x32_bf16 v[16:19], a[76:79], v[108:111], v[16:19]
    s_add_u32 s46, s46, 16384
    buffer_load_dwordx4 v5, s[16:19], s46 offen offset:0 lds
    v_mfma_f32_16x16x32_bf16 v[20:23], a[80:83], v[96:99], v[56:59]
    v_exp_f32 v30, v30
    v_mfma_f32_16x16x32_bf16 v[20:23], a[84:87], v[100:103], v[20:23]
    ds_read_b64_tr_b16 a[174:175], v2 offset:928
    v_cvt_pk_bf16_f32 v46, v28, v29
    v_mfma_f32_16x16x32_bf16 v[20:23], a[88:91], v[104:107], v[20:23]
    s_add_u32 m0, s47, 36896
    v_exp_f32 v31, v31
    v_mfma_f32_16x16x32_bf16 v[20:23], a[92:95], v[108:111], v[20:23]
    buffer_load_dwordx4 v5, s[16:19], s46 offen offset:1024 lds
    v_mfma_f32_16x16x32_bf16 v[24:27], a[96:99], v[96:99], v[56:59]
    v_exp_f32 v16, v16
    v_mfma_f32_16x16x32_bf16 v[24:27], a[100:103], v[100:103], v[24:27]
    ds_read_b64_tr_b16 a[176:177], v2 offset:192
    v_cvt_pk_bf16_f32 v47, v30, v31
    v_mfma_f32_16x16x32_bf16 v[24:27], a[104:107], v[104:107], v[24:27]
    s_add_u32 m0, s47, 36928
    v_exp_f32 v17, v17
    v_mfma_f32_16x16x32_bf16 v[24:27], a[108:111], v[108:111], v[24:27]
    buffer_load_dwordx4 v5, s[16:19], s46 offen offset:2048 lds
    v_mfma_f32_16x16x32_bf16 v[28:31], a[112:115], v[96:99], v[56:59]
    v_exp_f32 v18, v18
    v_mfma_f32_16x16x32_bf16 v[28:31], a[116:119], v[100:103], v[28:31]
    ds_read_b64_tr_b16 a[178:179], v2 offset:448
    v_cvt_pk_bf16_f32 v32, v16, v17
    v_mfma_f32_16x16x32_bf16 v[28:31], a[120:123], v[104:107], v[28:31]
    s_add_u32 m0, s47, 36960
    v_exp_f32 v19, v19
    v_mfma_f32_16x16x32_bf16 v[28:31], a[124:127], v[108:111], v[28:31]
    buffer_load_dwordx4 v5, s[16:19], s46 offen offset:3072 lds
    v_mfma_f32_16x16x32_bf16 v[160:163], a[192:195], v[40:43], v[160:163]
    v_exp_f32 v20, v20
    v_mfma_f32_16x16x32_bf16 v[160:163], a[196:199], v[44:47], v[160:163]
    ds_read_b64_tr_b16 a[180:181], v2 offset:704
    v_cvt_pk_bf16_f32 v33, v18, v19
    v_mfma_f32_16x16x32_bf16 v[164:167], a[200:203], v[40:43], v[164:167]
    s_add_u32 m0, s47, 53760
    v_exp_f32 v21, v21
    v_mfma_f32_16x16x32_bf16 v[164:167], a[204:207], v[44:47], v[164:167]
    buffer_load_dwordx4 v5, s[20:23], s46 offen offset:0 lds
    v_mfma_f32_16x16x32_bf16 v[168:171], a[208:211], v[40:43], v[168:171]
    v_exp_f32 v22, v22
    v_mfma_f32_16x16x32_bf16 v[168:171], a[212:215], v[44:47], v[168:171]
    ds_read_b64_tr_b16 a[182:183], v2 offset:960
    v_cvt_pk_bf16_f32 v34, v20, v21
    v_mfma_f32_16x16x32_bf16 v[172:175], a[216:219], v[40:43], v[172:175]
    s_add_u32 m0, s47, 53792
    v_exp_f32 v23, v23
    v_mfma_f32_16x16x32_bf16 v[172:175], a[220:223], v[44:47], v[172:175]
    buffer_load_dwordx4 v5, s[20:23], s46 offen offset:1024 lds
    v_mfma_f32_16x16x32_bf16 v[176:179], a[224:227], v[40:43], v[176:179]
    v_exp_f32 v24, v24
    v_mfma_f32_16x16x32_bf16 v[176:179], a[228:231], v[44:47], v[176:179]
    ds_read_b64_tr_b16 a[184:185], v2 offset:224
    v_cvt_pk_bf16_f32 v35, v22, v23
    v_mfma_f32_16x16x32_bf16 v[180:183], a[232:235], v[40:43], v[180:183]
    s_add_u32 m0, s47, 53824
    v_exp_f32 v25, v25
    v_mfma_f32_16x16x32_bf16 v[180:183], a[236:239], v[44:47], v[180:183]
    buffer_load_dwordx4 v5, s[20:23], s46 offen offset:2048 lds
    v_mfma_f32_16x16x32_bf16 v[184:187], a[240:243], v[40:43], v[184:187]
    v_exp_f32 v26, v26
    v_mfma_f32_16x16x32_bf16 v[184:187], a[244:247], v[44:47], v[184:187]
    ds_read_b64_tr_b16 a[186:187], v2 offset:480
    v_cvt_pk_bf16_f32 v36, v24, v25
    v_mfma_f32_16x16x32_bf16 v[188:191], a[248:251], v[40:43], v[188:191]
    s_add_u32 m0, s47, 53856
    v_exp_f32 v27, v27
    v_mfma_f32_16x16x32_bf16 v[188:191], a[252:255], v[44:47], v[188:191]
    buffer_load_dwordx4 v5, s[20:23], s46 offen offset:3072 lds
    v_smfmac_f32_16x16x64_bf16 a[4:7], a[16:19], v[40:47], v11
    ds_read_b64_tr_b16 a[188:189], v2 offset:736
    ds_read_b64_tr_b16 a[190:191], v2 offset:992
    v_mfma_f32_16x16x32_bf16 v[16:19], a[64:67], v[112:115], v[60:63]
    v_exp_f32 v28, v28
    v_mfma_f32_16x16x32_bf16 v[16:19], a[68:71], v[116:119], v[16:19]
    ds_read_b128 a[64:67], v1 offset:0
    v_cvt_pk_bf16_f32 v37, v26, v27
    v_mfma_f32_16x16x32_bf16 v[16:19], a[72:75], v[120:123], v[16:19]
    v_exp_f32 v29, v29
    v_mfma_f32_16x16x32_bf16 v[16:19], a[76:79], v[124:127], v[16:19]
    ds_read_b128 a[68:71], v1 offset:64
    v_mfma_f32_16x16x32_bf16 v[20:23], a[80:83], v[112:115], v[60:63]
    v_exp_f32 v30, v30
    v_mfma_f32_16x16x32_bf16 v[20:23], a[84:87], v[116:119], v[20:23]
    ds_read_b128 a[72:75], v1 offset:128
    v_cvt_pk_bf16_f32 v38, v28, v29
    v_mfma_f32_16x16x32_bf16 v[20:23], a[88:91], v[120:123], v[20:23]
    v_exp_f32 v31, v31
    v_mfma_f32_16x16x32_bf16 v[20:23], a[92:95], v[124:127], v[20:23]
    ds_read_b128 a[76:79], v1 offset:192
    v_mfma_f32_16x16x32_bf16 v[24:27], a[96:99], v[112:115], v[60:63]
    v_exp_f32 v16, v16
    v_mfma_f32_16x16x32_bf16 v[24:27], a[100:103], v[116:119], v[24:27]
    ds_read_b128 a[80:83], v1 offset:256
    v_cvt_pk_bf16_f32 v39, v30, v31
    v_mfma_f32_16x16x32_bf16 v[24:27], a[104:107], v[120:123], v[24:27]
    v_exp_f32 v17, v17
    v_mfma_f32_16x16x32_bf16 v[24:27], a[108:111], v[124:127], v[24:27]
    ds_read_b128 a[84:87], v1 offset:320
    v_mfma_f32_16x16x32_bf16 v[28:31], a[112:115], v[112:115], v[60:63]
    v_exp_f32 v18, v18
    v_mfma_f32_16x16x32_bf16 v[28:31], a[116:119], v[116:119], v[28:31]
    ds_read_b128 a[88:91], v1 offset:384
    v_cvt_pk_bf16_f32 v40, v16, v17
    v_mfma_f32_16x16x32_bf16 v[28:31], a[120:123], v[120:123], v[28:31]
    v_exp_f32 v19, v19
    v_mfma_f32_16x16x32_bf16 v[28:31], a[124:127], v[124:127], v[28:31]
    ds_read_b128 a[92:95], v1 offset:448
    v_mfma_f32_16x16x32_bf16 v[192:195], a[192:195], v[32:35], v[192:195]
    v_exp_f32 v20, v20
    v_mfma_f32_16x16x32_bf16 v[192:195], a[196:199], v[36:39], v[192:195]
    ds_read_b128 a[96:99], v1 offset:512
    v_cvt_pk_bf16_f32 v41, v18, v19
    v_mfma_f32_16x16x32_bf16 v[196:199], a[200:203], v[32:35], v[196:199]
    v_exp_f32 v21, v21
    v_mfma_f32_16x16x32_bf16 v[196:199], a[204:207], v[36:39], v[196:199]
    ds_read_b128 a[100:103], v1 offset:576
    v_mfma_f32_16x16x32_bf16 v[200:203], a[208:211], v[32:35], v[200:203]
    v_exp_f32 v22, v22
    v_mfma_f32_16x16x32_bf16 v[200:203], a[212:215], v[36:39], v[200:203]
    ds_read_b128 a[104:107], v1 offset:640
    v_cvt_pk_bf16_f32 v42, v20, v21
    v_mfma_f32_16x16x32_bf16 v[204:207], a[216:219], v[32:35], v[204:207]
    v_exp_f32 v23, v23
    v_mfma_f32_16x16x32_bf16 v[204:207], a[220:223], v[36:39], v[204:207]
    ds_read_b128 a[108:111], v1 offset:704
    v_mfma_f32_16x16x32_bf16 v[208:211], a[224:227], v[32:35], v[208:211]
    v_exp_f32 v24, v24
    v_mfma_f32_16x16x32_bf16 v[208:211], a[228:231], v[36:39], v[208:211]
    ds_read_b128 a[112:115], v1 offset:768
    v_cvt_pk_bf16_f32 v43, v22, v23
    v_mfma_f32_16x16x32_bf16 v[212:215], a[232:235], v[32:35], v[212:215]
    v_exp_f32 v25, v25
    v_mfma_f32_16x16x32_bf16 v[212:215], a[236:239], v[36:39], v[212:215]
    ds_read_b128 a[116:119], v1 offset:832
    v_mfma_f32_16x16x32_bf16 v[216:219], a[240:243], v[32:35], v[216:219]
    v_exp_f32 v26, v26
    v_mfma_f32_16x16x32_bf16 v[216:219], a[244:247], v[36:39], v[216:219]
    ds_read_b128 a[120:123], v1 offset:896
    v_cvt_pk_bf16_f32 v44, v24, v25
    v_mfma_f32_16x16x32_bf16 v[220:223], a[248:251], v[32:35], v[220:223]
    v_exp_f32 v27, v27
    v_mfma_f32_16x16x32_bf16 v[220:223], a[252:255], v[36:39], v[220:223]
    ds_read_b128 a[124:127], v1 offset:960
    v_smfmac_f32_16x16x64_bf16 a[8:11], a[16:19], v[32:39], v11
    s_waitcnt lgkmcnt(12)
    v_mfma_f32_16x16x32_bf16 v[16:19], a[64:67], v[64:67], v[48:51]
    v_exp_f32 v28, v28
    v_mfma_f32_16x16x32_bf16 v[16:19], a[68:71], v[68:71], v[16:19]
    v_cvt_pk_bf16_f32 v45, v26, v27
    v_mfma_f32_16x16x32_bf16 v[16:19], a[72:75], v[72:75], v[16:19]
    v_exp_f32 v29, v29
    v_mfma_f32_16x16x32_bf16 v[16:19], a[76:79], v[76:79], v[16:19]
    s_waitcnt lgkmcnt(8)
    v_mfma_f32_16x16x32_bf16 v[20:23], a[80:83], v[64:67], v[48:51]
    v_exp_f32 v30, v30
    v_mfma_f32_16x16x32_bf16 v[20:23], a[84:87], v[68:71], v[20:23]
    v_cvt_pk_bf16_f32 v46, v28, v29
    v_mfma_f32_16x16x32_bf16 v[20:23], a[88:91], v[72:75], v[20:23]
    v_exp_f32 v31, v31
    v_mfma_f32_16x16x32_bf16 v[20:23], a[92:95], v[76:79], v[20:23]
    s_waitcnt lgkmcnt(4)
    v_mfma_f32_16x16x32_bf16 v[24:27], a[96:99], v[64:67], v[48:51]
    v_exp_f32 v16, v16
    v_mfma_f32_16x16x32_bf16 v[24:27], a[100:103], v[68:71], v[24:27]
    v_cvt_pk_bf16_f32 v47, v30, v31
    v_mfma_f32_16x16x32_bf16 v[24:27], a[104:107], v[72:75], v[24:27]
    v_exp_f32 v17, v17
    v_mfma_f32_16x16x32_bf16 v[24:27], a[108:111], v[76:79], v[24:27]
    s_waitcnt lgkmcnt(0)
    v_mfma_f32_16x16x32_bf16 v[28:31], a[112:115], v[64:67], v[48:51]
    v_exp_f32 v18, v18
    v_mfma_f32_16x16x32_bf16 v[28:31], a[116:119], v[68:71], v[28:31]
    v_cvt_pk_bf16_f32 v32, v16, v17
    v_mfma_f32_16x16x32_bf16 v[28:31], a[120:123], v[72:75], v[28:31]
    v_exp_f32 v19, v19
    v_mfma_f32_16x16x32_bf16 v[28:31], a[124:127], v[76:79], v[28:31]
    v_mfma_f32_16x16x32_bf16 v[224:227], a[192:195], v[40:43], v[224:227]
    v_exp_f32 v20, v20
    v_mfma_f32_16x16x32_bf16 v[224:227], a[196:199], v[44:47], v[224:227]
    ds_read_b64_tr_b16 a[192:193], v2 offset:36864
    v_cvt_pk_bf16_f32 v33, v18, v19
    v_mfma_f32_16x16x32_bf16 v[228:231], a[200:203], v[40:43], v[228:231]
    v_exp_f32 v21, v21
    v_mfma_f32_16x16x32_bf16 v[228:231], a[204:207], v[44:47], v[228:231]
    ds_read_b64_tr_b16 a[194:195], v2 offset:37120
    v_mfma_f32_16x16x32_bf16 v[232:235], a[208:211], v[40:43], v[232:235]
    v_exp_f32 v22, v22
    v_mfma_f32_16x16x32_bf16 v[232:235], a[212:215], v[44:47], v[232:235]
    ds_read_b64_tr_b16 a[196:197], v2 offset:37376
    v_cvt_pk_bf16_f32 v34, v20, v21
    v_mfma_f32_16x16x32_bf16 v[236:239], a[216:219], v[40:43], v[236:239]
    v_exp_f32 v23, v23
    v_mfma_f32_16x16x32_bf16 v[236:239], a[220:223], v[44:47], v[236:239]
    ds_read_b64_tr_b16 a[198:199], v2 offset:37632
    v_mfma_f32_16x16x32_bf16 v[240:243], a[224:227], v[40:43], v[240:243]
    v_exp_f32 v24, v24
    v_mfma_f32_16x16x32_bf16 v[240:243], a[228:231], v[44:47], v[240:243]
    ds_read_b64_tr_b16 a[200:201], v2 offset:36896
    v_cvt_pk_bf16_f32 v35, v22, v23
    v_mfma_f32_16x16x32_bf16 v[244:247], a[232:235], v[40:43], v[244:247]
    v_exp_f32 v25, v25
    v_mfma_f32_16x16x32_bf16 v[244:247], a[236:239], v[44:47], v[244:247]
    ds_read_b64_tr_b16 a[202:203], v2 offset:37152
    v_mfma_f32_16x16x32_bf16 v[248:251], a[240:243], v[40:43], v[248:251]
    v_exp_f32 v26, v26
    v_mfma_f32_16x16x32_bf16 v[248:251], a[244:247], v[44:47], v[248:251]
    ds_read_b64_tr_b16 a[204:205], v2 offset:37408
    v_cvt_pk_bf16_f32 v36, v24, v25
    v_mfma_f32_16x16x32_bf16 v[252:255], a[248:251], v[40:43], v[252:255]
    v_exp_f32 v27, v27
    v_mfma_f32_16x16x32_bf16 v[252:255], a[252:255], v[44:47], v[252:255]
    ds_read_b64_tr_b16 a[206:207], v2 offset:37664
    v_smfmac_f32_16x16x64_bf16 a[12:15], a[16:19], v[40:47], v11
    ds_read_b64_tr_b16 a[208:209], v2 offset:36928
    v_mfma_f32_16x16x32_bf16 v[16:19], a[64:67], v[80:83], v[52:55]
    v_exp_f32 v28, v28
    v_mfma_f32_16x16x32_bf16 v[16:19], a[68:71], v[84:87], v[16:19]
    ds_read_b64_tr_b16 a[210:211], v2 offset:37184
    v_cvt_pk_bf16_f32 v37, v26, v27
    v_mfma_f32_16x16x32_bf16 v[16:19], a[72:75], v[88:91], v[16:19]
    v_exp_f32 v29, v29
    v_mfma_f32_16x16x32_bf16 v[16:19], a[76:79], v[92:95], v[16:19]
    ds_read_b64_tr_b16 a[212:213], v2 offset:37440
    v_mfma_f32_16x16x32_bf16 v[20:23], a[80:83], v[80:83], v[52:55]
    v_exp_f32 v30, v30
    v_mfma_f32_16x16x32_bf16 v[20:23], a[84:87], v[84:87], v[20:23]
    ds_read_b64_tr_b16 a[214:215], v2 offset:37696
    v_cvt_pk_bf16_f32 v38, v28, v29
    v_mfma_f32_16x16x32_bf16 v[20:23], a[88:91], v[88:91], v[20:23]
    v_exp_f32 v31, v31
    v_mfma_f32_16x16x32_bf16 v[20:23], a[92:95], v[92:95], v[20:23]
    ds_read_b64_tr_b16 a[216:217], v2 offset:36960
    v_mfma_f32_16x16x32_bf16 v[24:27], a[96:99], v[80:83], v[52:55]
    v_exp_f32 v16, v16
    v_mfma_f32_16x16x32_bf16 v[24:27], a[100:103], v[84:87], v[24:27]
    ds_read_b64_tr_b16 a[218:219], v2 offset:37216
    v_cvt_pk_bf16_f32 v39, v30, v31
    v_mfma_f32_16x16x32_bf16 v[24:27], a[104:107], v[88:91], v[24:27]
    v_exp_f32 v17, v17
    v_mfma_f32_16x16x32_bf16 v[24:27], a[108:111], v[92:95], v[24:27]
    ds_read_b64_tr_b16 a[220:221], v2 offset:37472
    v_mfma_f32_16x16x32_bf16 v[28:31], a[112:115], v[80:83], v[52:55]
    v_exp_f32 v18, v18
    v_mfma_f32_16x16x32_bf16 v[28:31], a[116:119], v[84:87], v[28:31]
    ds_read_b64_tr_b16 a[222:223], v2 offset:37728
    v_cvt_pk_bf16_f32 v40, v16, v17
    v_mfma_f32_16x16x32_bf16 v[28:31], a[120:123], v[88:91], v[28:31]
    v_exp_f32 v19, v19
    v_mfma_f32_16x16x32_bf16 v[28:31], a[124:127], v[92:95], v[28:31]
    ds_read_b64_tr_b16 a[224:225], v2 offset:36992
    v_mfma_f32_16x16x32_bf16 v[128:131], a[128:131], v[32:35], v[128:131]
    v_exp_f32 v20, v20
    v_mfma_f32_16x16x32_bf16 v[128:131], a[132:135], v[36:39], v[128:131]
    ds_read_b64_tr_b16 a[226:227], v2 offset:37248
    v_cvt_pk_bf16_f32 v41, v18, v19
    v_mfma_f32_16x16x32_bf16 v[132:135], a[136:139], v[32:35], v[132:135]
    v_exp_f32 v21, v21
    v_mfma_f32_16x16x32_bf16 v[132:135], a[140:143], v[36:39], v[132:135]
    ds_read_b64_tr_b16 a[228:229], v2 offset:37504
    v_mfma_f32_16x16x32_bf16 v[136:139], a[144:147], v[32:35], v[136:139]
    v_exp_f32 v22, v22
    v_mfma_f32_16x16x32_bf16 v[136:139], a[148:151], v[36:39], v[136:139]
    ds_read_b64_tr_b16 a[230:231], v2 offset:37760
    v_cvt_pk_bf16_f32 v42, v20, v21
    v_mfma_f32_16x16x32_bf16 v[140:143], a[152:155], v[32:35], v[140:143]
    v_exp_f32 v23, v23
    v_mfma_f32_16x16x32_bf16 v[140:143], a[156:159], v[36:39], v[140:143]
    ds_read_b64_tr_b16 a[232:233], v2 offset:37024
    v_mfma_f32_16x16x32_bf16 v[144:147], a[160:163], v[32:35], v[144:147]
    v_exp_f32 v24, v24
    v_mfma_f32_16x16x32_bf16 v[144:147], a[164:167], v[36:39], v[144:147]
    ds_read_b64_tr_b16 a[234:235], v2 offset:37280
    v_cvt_pk_bf16_f32 v43, v22, v23
    v_mfma_f32_16x16x32_bf16 v[148:151], a[168:171], v[32:35], v[148:151]
    v_exp_f32 v25, v25
    v_mfma_f32_16x16x32_bf16 v[148:151], a[172:175], v[36:39], v[148:151]
    ds_read_b64_tr_b16 a[236:237], v2 offset:37536
    v_mfma_f32_16x16x32_bf16 v[152:155], a[176:179], v[32:35], v[152:155]
    v_exp_f32 v26, v26
    v_mfma_f32_16x16x32_bf16 v[152:155], a[180:183], v[36:39], v[152:155]
    ds_read_b64_tr_b16 a[238:239], v2 offset:37792
    v_cvt_pk_bf16_f32 v44, v24, v25
    v_mfma_f32_16x16x32_bf16 v[156:159], a[184:187], v[32:35], v[156:159]
    v_exp_f32 v27, v27
    v_mfma_f32_16x16x32_bf16 v[156:159], a[188:191], v[36:39], v[156:159]
    ds_read_b64_tr_b16 a[240:241], v2 offset:37056
    v_smfmac_f32_16x16x64_bf16 a[0:3], a[16:19], v[32:39], v11
    ds_read_b64_tr_b16 a[242:243], v2 offset:37312
    v_mfma_f32_16x16x32_bf16 v[16:19], a[64:67], v[96:99], v[56:59]
    v_exp_f32 v28, v28
    v_mfma_f32_16x16x32_bf16 v[16:19], a[68:71], v[100:103], v[16:19]
    ds_read_b64_tr_b16 a[244:245], v2 offset:37568
    v_cvt_pk_bf16_f32 v45, v26, v27
    v_mfma_f32_16x16x32_bf16 v[16:19], a[72:75], v[104:107], v[16:19]
    v_exp_f32 v29, v29
    v_mfma_f32_16x16x32_bf16 v[16:19], a[76:79], v[108:111], v[16:19]
    ds_read_b64_tr_b16 a[246:247], v2 offset:37824
    v_mfma_f32_16x16x32_bf16 v[20:23], a[80:83], v[96:99], v[56:59]
    v_exp_f32 v30, v30
    v_mfma_f32_16x16x32_bf16 v[20:23], a[84:87], v[100:103], v[20:23]
    ds_read_b64_tr_b16 a[248:249], v2 offset:37088
    v_cvt_pk_bf16_f32 v46, v28, v29
    v_mfma_f32_16x16x32_bf16 v[20:23], a[88:91], v[104:107], v[20:23]
    v_exp_f32 v31, v31
    v_mfma_f32_16x16x32_bf16 v[20:23], a[92:95], v[108:111], v[20:23]
    ds_read_b64_tr_b16 a[250:251], v2 offset:37344
    v_mfma_f32_16x16x32_bf16 v[24:27], a[96:99], v[96:99], v[56:59]
    v_exp_f32 v16, v16
    v_mfma_f32_16x16x32_bf16 v[24:27], a[100:103], v[100:103], v[24:27]
    ds_read_b64_tr_b16 a[252:253], v2 offset:37600
    v_cvt_pk_bf16_f32 v47, v30, v31
    v_mfma_f32_16x16x32_bf16 v[24:27], a[104:107], v[104:107], v[24:27]
    v_exp_f32 v17, v17
    v_mfma_f32_16x16x32_bf16 v[24:27], a[108:111], v[108:111], v[24:27]
    ds_read_b64_tr_b16 a[254:255], v2 offset:37856
    v_mfma_f32_16x16x32_bf16 v[28:31], a[112:115], v[96:99], v[56:59]
    v_exp_f32 v18, v18
    v_mfma_f32_16x16x32_bf16 v[28:31], a[116:119], v[100:103], v[28:31]
    v_cvt_pk_bf16_f32 v32, v16, v17
    v_mfma_f32_16x16x32_bf16 v[28:31], a[120:123], v[104:107], v[28:31]
    v_exp_f32 v19, v19
    v_mfma_f32_16x16x32_bf16 v[28:31], a[124:127], v[108:111], v[28:31]
    v_mfma_f32_16x16x32_bf16 v[160:163], a[128:131], v[40:43], v[160:163]
    v_exp_f32 v20, v20
    v_mfma_f32_16x16x32_bf16 v[160:163], a[132:135], v[44:47], v[160:163]
    v_cvt_pk_bf16_f32 v33, v18, v19
    v_mfma_f32_16x16x32_bf16 v[164:167], a[136:139], v[40:43], v[164:167]
    v_exp_f32 v21, v21
    v_mfma_f32_16x16x32_bf16 v[164:167], a[140:143], v[44:47], v[164:167]
    v_mfma_f32_16x16x32_bf16 v[168:171], a[144:147], v[40:43], v[168:171]
    v_exp_f32 v22, v22
    v_mfma_f32_16x16x32_bf16 v[168:171], a[148:151], v[44:47], v[168:171]
    v_cvt_pk_bf16_f32 v34, v20, v21
    v_mfma_f32_16x16x32_bf16 v[172:175], a[152:155], v[40:43], v[172:175]
    v_exp_f32 v23, v23
    v_mfma_f32_16x16x32_bf16 v[172:175], a[156:159], v[44:47], v[172:175]
    v_mfma_f32_16x16x32_bf16 v[176:179], a[160:163], v[40:43], v[176:179]
    v_exp_f32 v24, v24
    v_mfma_f32_16x16x32_bf16 v[176:179], a[164:167], v[44:47], v[176:179]
    v_cvt_pk_bf16_f32 v35, v22, v23
    v_mfma_f32_16x16x32_bf16 v[180:183], a[168:171], v[40:43], v[180:183]
    v_exp_f32 v25, v25
    v_mfma_f32_16x16x32_bf16 v[180:183], a[172:175], v[44:47], v[180:183]
    v_mfma_f32_16x16x32_bf16 v[184:187], a[176:179], v[40:43], v[184:187]
    v_exp_f32 v26, v26
    v_mfma_f32_16x16x32_bf16 v[184:187], a[180:183], v[44:47], v[184:187]
    v_cvt_pk_bf16_f32 v36, v24, v25
    v_mfma_f32_16x16x32_bf16 v[188:191], a[184:187], v[40:43], v[188:191]
    v_exp_f32 v27, v27
    v_mfma_f32_16x16x32_bf16 v[188:191], a[188:191], v[44:47], v[188:191]
    v_smfmac_f32_16x16x64_bf16 a[4:7], a[16:19], v[40:47], v11
    v_mfma_f32_16x16x32_bf16 v[16:19], a[64:67], v[112:115], v[60:63]
    v_exp_f32 v28, v28
    v_mfma_f32_16x16x32_bf16 v[16:19], a[68:71], v[116:119], v[16:19]
    ds_read_b128 a[64:67], v1 offset:36864
    v_cvt_pk_bf16_f32 v37, v26, v27
    v_mfma_f32_16x16x32_bf16 v[16:19], a[72:75], v[120:123], v[16:19]
    v_exp_f32 v29, v29
    v_mfma_f32_16x16x32_bf16 v[16:19], a[76:79], v[124:127], v[16:19]
    ds_read_b128 a[68:71], v1 offset:36928
    v_mfma_f32_16x16x32_bf16 v[20:23], a[80:83], v[112:115], v[60:63]
    v_exp_f32 v30, v30
    v_mfma_f32_16x16x32_bf16 v[20:23], a[84:87], v[116:119], v[20:23]
    ds_read_b128 a[72:75], v1 offset:36992
    v_cvt_pk_bf16_f32 v38, v28, v29
    v_mfma_f32_16x16x32_bf16 v[20:23], a[88:91], v[120:123], v[20:23]
    v_exp_f32 v31, v31
    v_mfma_f32_16x16x32_bf16 v[20:23], a[92:95], v[124:127], v[20:23]
    ds_read_b128 a[76:79], v1 offset:37056
    v_mfma_f32_16x16x32_bf16 v[24:27], a[96:99], v[112:115], v[60:63]
    v_exp_f32 v16, v16
    v_mfma_f32_16x16x32_bf16 v[24:27], a[100:103], v[116:119], v[24:27]
    ds_read_b128 a[80:83], v1 offset:37120
    v_cvt_pk_bf16_f32 v39, v30, v31
    v_mfma_f32_16x16x32_bf16 v[24:27], a[104:107], v[120:123], v[24:27]
    v_exp_f32 v17, v17
    v_mfma_f32_16x16x32_bf16 v[24:27], a[108:111], v[124:127], v[24:27]
    ds_read_b128 a[84:87], v1 offset:37184
    v_mfma_f32_16x16x32_bf16 v[28:31], a[112:115], v[112:115], v[60:63]
    v_exp_f32 v18, v18
    v_mfma_f32_16x16x32_bf16 v[28:31], a[116:119], v[116:119], v[28:31]
    ds_read_b128 a[88:91], v1 offset:37248
    v_cvt_pk_bf16_f32 v40, v16, v17
    v_mfma_f32_16x16x32_bf16 v[28:31], a[120:123], v[120:123], v[28:31]
    v_exp_f32 v19, v19
    v_mfma_f32_16x16x32_bf16 v[28:31], a[124:127], v[124:127], v[28:31]
    ds_read_b128 a[92:95], v1 offset:37312
    v_mfma_f32_16x16x32_bf16 v[192:195], a[128:131], v[32:35], v[192:195]
    v_exp_f32 v20, v20
    v_mfma_f32_16x16x32_bf16 v[192:195], a[132:135], v[36:39], v[192:195]
    ds_read_b128 a[96:99], v1 offset:37376
    v_cvt_pk_bf16_f32 v41, v18, v19
    v_mfma_f32_16x16x32_bf16 v[196:199], a[136:139], v[32:35], v[196:199]
    v_exp_f32 v21, v21
    v_mfma_f32_16x16x32_bf16 v[196:199], a[140:143], v[36:39], v[196:199]
    ds_read_b128 a[100:103], v1 offset:37440
    v_mfma_f32_16x16x32_bf16 v[200:203], a[144:147], v[32:35], v[200:203]
    v_exp_f32 v22, v22
    v_mfma_f32_16x16x32_bf16 v[200:203], a[148:151], v[36:39], v[200:203]
    ds_read_b128 a[104:107], v1 offset:37504
    v_cvt_pk_bf16_f32 v42, v20, v21
    v_mfma_f32_16x16x32_bf16 v[204:207], a[152:155], v[32:35], v[204:207]
    v_exp_f32 v23, v23
    v_mfma_f32_16x16x32_bf16 v[204:207], a[156:159], v[36:39], v[204:207]
    ds_read_b128 a[108:111], v1 offset:37568
    v_mfma_f32_16x16x32_bf16 v[208:211], a[160:163], v[32:35], v[208:211]
    v_exp_f32 v24, v24
    v_mfma_f32_16x16x32_bf16 v[208:211], a[164:167], v[36:39], v[208:211]
    ds_read_b128 a[112:115], v1 offset:37632
    v_cvt_pk_bf16_f32 v43, v22, v23
    v_mfma_f32_16x16x32_bf16 v[212:215], a[168:171], v[32:35], v[212:215]
    v_exp_f32 v25, v25
    v_mfma_f32_16x16x32_bf16 v[212:215], a[172:175], v[36:39], v[212:215]
    ds_read_b128 a[116:119], v1 offset:37696
    v_mfma_f32_16x16x32_bf16 v[216:219], a[176:179], v[32:35], v[216:219]
    v_exp_f32 v26, v26
    v_mfma_f32_16x16x32_bf16 v[216:219], a[180:183], v[36:39], v[216:219]
    s_sub_u32 s49, s49, 1
    ds_read_b128 a[120:123], v1 offset:37760
    v_cvt_pk_bf16_f32 v44, v24, v25
    v_mfma_f32_16x16x32_bf16 v[220:223], a[184:187], v[32:35], v[220:223]
    s_cmp_lg_u32 s49, 0
    v_exp_f32 v27, v27
    v_mfma_f32_16x16x32_bf16 v[220:223], a[188:191], v[36:39], v[220:223]
    ds_read_b128 a[124:127], v1 offset:37824
    v_smfmac_f32_16x16x64_bf16 a[8:11], a[16:19], v[32:39], v11
    s_waitcnt lgkmcnt(12)
    s_cbranch_scc1 L2_loop
    v_mfma_f32_16x16x32_bf16 v[16:19], a[64:67], v[64:67], v[48:51]
    s_sub_u32 s47, s47, s48
    v_exp_f32 v28, v28
    v_mfma_f32_16x16x32_bf16 v[16:19], a[68:71], v[68:71], v[16:19]
L2_pad5:
    s_cbranch_execz L2_pad9
    v_cvt_pk_bf16_f32 v45, v26, v27
    v_add_u32 v1, s48, v1
    v_mfma_f32_16x16x32_bf16 v[16:19], a[72:75], v[72:75], v[16:19]
    v_exp_f32 v29, v29
    v_mfma_f32_16x16x32_bf16 v[16:19], a[76:79], v[76:79], v[16:19]
    s_waitcnt lgkmcnt(8)
    v_mfma_f32_16x16x32_bf16 v[20:23], a[80:83], v[64:67], v[48:51]
    v_exp_f32 v30, v30
    v_mfma_f32_16x16x32_bf16 v[20:23], a[84:87], v[68:71], v[20:23]
    v_cvt_pk_bf16_f32 v46, v28, v29
    v_add_u32 v2, s48, v2
    v_mfma_f32_16x16x32_bf16 v[20:23], a[88:91], v[72:75], v[20:23]
    v_exp_f32 v31, v31
    v_mfma_f32_16x16x32_bf16 v[20:23], a[92:95], v[76:79], v[20:23]
    s_waitcnt lgkmcnt(4)
    v_mfma_f32_16x16x32_bf16 v[24:27], a[96:99], v[64:67], v[48:51]
    s_sub_u32 s48, 0, s48
    v_exp_f32 v16, v16
    v_mfma_f32_16x16x32_bf16 v[24:27], a[100:103], v[68:71], v[24:27]
    v_cvt_pk_bf16_f32 v47, v30, v31
    v_mfma_f32_16x16x32_bf16 v[24:27], a[104:107], v[72:75], v[24:27]
    v_exp_f32 v17, v17
    v_mfma_f32_16x16x32_bf16 v[24:27], a[108:111], v[76:79], v[24:27]
    s_waitcnt lgkmcnt(0)
    v_mfma_f32_16x16x32_bf16 v[28:31], a[112:115], v[64:67], v[48:51]
    v_exp_f32 v18, v18
    v_mfma_f32_16x16x32_bf16 v[28:31], a[116:119], v[68:71], v[28:31]
    v_cvt_pk_bf16_f32 v32, v16, v17
    v_mfma_f32_16x16x32_bf16 v[28:31], a[120:123], v[72:75], v[28:31]
    v_exp_f32 v19, v19
    v_mfma_f32_16x16x32_bf16 v[28:31], a[124:127], v[76:79], v[28:31]
    s_waitcnt vmcnt(0)
    s_barrier
    v_mfma_f32_16x16x32_bf16 v[224:227], a[128:131], v[40:43], v[224:227]
    v_exp_f32 v20, v20
    v_mfma_f32_16x16x32_bf16 v[224:227], a[132:135], v[44:47], v[224:227]
    ds_read_b64_tr_b16 a[128:129], v2 offset:0
    v_cvt_pk_bf16_f32 v33, v18, v19
    v_mfma_f32_16x16x32_bf16 v[228:231], a[136:139], v[40:43], v[228:231]
    s_add_u32 m0, s47, 0
    v_exp_f32 v21, v21
    v_mfma_f32_16x16x32_bf16 v[228:231], a[140:143], v[44:47], v[228:231]
    s_add_u32 s46, s46, 16384
    buffer_load_dwordx4 v5, s[16:19], s46 offen offset:0 lds
    v_mfma_f32_16x16x32_bf16 v[232:235], a[144:147], v[40:43], v[232:235]
    v_exp_f32 v22, v22
    v_mfma_f32_16x16x32_bf16 v[232:235], a[148:151], v[44:47], v[232:235]
    ds_read_b64_tr_b16 a[130:131], v2 offset:256
    v_cvt_pk_bf16_f32 v34, v20, v21
    v_mfma_f32_16x16x32_bf16 v[236:239], a[152:155], v[40:43], v[236:239]
    s_add_u32 m0, s47, 32
    v_exp_f32 v23, v23
    v_mfma_f32_16x16x32_bf16 v[236:239], a[156:159], v[44:47], v[236:239]
    buffer_load_dwordx4 v5, s[16:19], s46 offen offset:1024 lds
    v_mfma_f32_16x16x32_bf16 v[240:243], a[160:163], v[40:43], v[240:243]
    v_exp_f32 v24, v24
    v_mfma_f32_16x16x32_bf16 v[240:243], a[164:167], v[44:47], v[240:243]
    ds_read_b64_tr_b16 a[132:133], v2 offset:512
    v_cvt_pk_bf16_f32 v35, v22, v23
    v_mfma_f32_16x16x32_bf16 v[244:247], a[168:171], v[40:43], v[244:247]
    s_add_u32 m0, s47, 64
    v_exp_f32 v25, v25
    v_mfma_f32_16x16x32_bf16 v[244:247], a[172:175], v[44:47], v[244:247]
    buffer_load_dwordx4 v5, s[16:19], s46 offen offset:2048 lds
    v_mfma_f32_16x16x32_bf16 v[248:251], a[176:179], v[40:43], v[248:251]
    v_exp_f32 v26, v26
    v_mfma_f32_16x16x32_bf16 v[248:251], a[180:183], v[44:47], v[248:251]
    ds_read_b64_tr_b16 a[134:135], v2 offset:768
    v_cvt_pk_bf16_f32 v36, v24, v25
    v_mfma_f32_16x16x32_bf16 v[252:255], a[184:187], v[40:43], v[252:255]
    s_add_u32 m0, s47, 96
    v_exp_f32 v27, v27
    v_mfma_f32_16x16x32_bf16 v[252:255], a[188:191], v[44:47], v[252:255]
    buffer_load_dwordx4 v5, s[16:19], s46 offen offset:3072 lds
    v_smfmac_f32_16x16x64_bf16 a[12:15], a[16:19], v[40:47], v11
    ds_read_b64_tr_b16 a[136:137], v2 offset:32
    v_mfma_f32_16x16x32_bf16 v[16:19], a[64:67], v[80:83], v[52:55]
    v_exp_f32 v28, v28
    v_mfma_f32_16x16x32_bf16 v[16:19], a[68:71], v[84:87], v[16:19]
    ds_read_b64_tr_b16 a[138:139], v2 offset:288
    v_cvt_pk_bf16_f32 v37, v26, v27
    v_mfma_f32_16x16x32_bf16 v[16:19], a[72:75], v[88:91], v[16:19]
    s_add_u32 m0, s47, 16896
    v_exp_f32 v29, v29
    v_mfma_f32_16x16x32_bf16 v[16:19], a[76:79], v[92:95], v[16:19]
    buffer_load_dwordx4 v5, s[20:23], s46 offen offset:0 lds
    v_mfma_f32_16x16x32_bf16 v[20:23], a[80:83], v[80:83], v[52:55]
    v_exp_f32 v30, v30
    v_mfma_f32_16x16x32_bf16 v[20:23], a[84:87], v[84:87], v[20:23]
    ds_read_b64_tr_b16 a[140:141], v2 offset:544
    v_cvt_pk_bf16_f32 v38, v28, v29
    v_mfma_f32_16x16x32_bf16 v[20:23], a[88:91], v[88:91], v[20:23]
    s_add_u32 m0, s47, 16928
    v_exp_f32 v31, v31
    v_mfma_f32_16x16x32_bf16 v[20:23], a[92:95], v[92:95], v[20:23]
    buffer_load_dwordx4 v5, s[20:23], s46 offen offset:1024 lds
    v_mfma_f32_16x16x32_bf16 v[24:27], a[96:99], v[80:83], v[52:55]
    v_exp_f32 v16, v16
    v_mfma_f32_16x16x32_bf16 v[24:27], a[100:103], v[84:87], v[24:27]
    ds_read_b64_tr_b16 a[142:143], v2 offset:800
    v_cvt_pk_bf16_f32 v39, v30, v31
    v_mfma_f32_16x16x32_bf16 v[24:27], a[104:107], v[88:91], v[24:27]
    s_add_u32 m0, s47, 16960
    v_exp_f32 v17, v17
    v_mfma_f32_16x16x32_bf16 v[24:27], a[108:111], v[92:95], v[24:27]
    buffer_load_dwordx4 v5, s[20:23], s46 offen offset:2048 lds
    v_mfma_f32_16x16x32_bf16 v[28:31], a[112:115], v[80:83], v[52:55]
    v_exp_f32 v18, v18
    v_mfma_f32_16x16x32_bf16 v[28:31], a[116:119], v[84:87], v[28:31]
    ds_read_b64_tr_b16 a[144:145], v2 offset:64
    v_cvt_pk_bf16_f32 v40, v16, v17
    v_mfma_f32_16x16x32_bf16 v[28:31], a[120:123], v[88:91], v[28:31]
    s_add_u32 m0, s47, 16992
    v_exp_f32 v19, v19
    v_mfma_f32_16x16x32_bf16 v[28:31], a[124:127], v[92:95], v[28:31]
    buffer_load_dwordx4 v5, s[20:23], s46 offen offset:3072 lds
    v_mfma_f32_16x16x32_bf16 v[128:131], a[192:195], v[32:35], v[128:131]
    v_exp_f32 v20, v20
    v_mfma_f32_16x16x32_bf16 v[128:131], a[196:199], v[36:39], v[128:131]
    ds_read_b64_tr_b16 a[146:147], v2 offset:320
    v_cvt_pk_bf16_f32 v41, v18, v19
    v_mfma_f32_16x16x32_bf16 v[132:135], a[200:203], v[32:35], v[132:135]
    v_exp_f32 v21, v21
    v_mfma_f32_16x16x32_bf16 v[132:135], a[204:207], v[36:39], v[132:135]
    ds_read_b64_tr_b16 a[148:149], v2 offset:576
    v_mfma_f32_16x16x32_bf16 v[136:139], a[208:211], v[32:35], v[136:139]
    v_exp_f32 v22, v22
    v_mfma_f32_16x16x32_bf16 v[136:139], a[212:215], v[36:39], v[136:139]
    ds_read_b64_tr_b16 a[150:151], v2 offset:832
    v_cvt_pk_bf16_f32 v42, v20, v21
    v_mfma_f32_16x16x32_bf16 v[140:143], a[216:219], v[32:35], v[140:143]
    v_exp_f32 v23, v23
    v_mfma_f32_16x16x32_bf16 v[140:143], a[220:223], v[36:39], v[140:143]
    ds_read_b64_tr_b16 a[152:153], v2 offset:96
    ds_read_b64_tr_b16 a[154:155], v2 offset:352
    v_mfma_f32_16x16x32_bf16 v[144:147], a[224:227], v[32:35], v[144:147]
    v_exp_f32 v24, v24
    v_mfma_f32_16x16x32_bf16 v[144:147], a[228:231], v[36:39], v[144:147]
    ds_read_b64_tr_b16 a[156:157], v2 offset:608
    v_cvt_pk_bf16_f32 v43, v22, v23
    v_mfma_f32_16x16x32_bf16 v[148:151], a[232:235], v[32:35], v[148:151]
    v_exp_f32 v25, v25
    v_mfma_f32_16x16x32_bf16 v[148:151], a[236:239], v[36:39], v[148:151]
    ds_read_b64_tr_b16 a[158:159], v2 offset:864
    ds_read_b64_tr_b16 a[160:161], v2 offset:128
    v_mfma_f32_16x16x32_bf16 v[152:155], a[240:243], v[32:35], v[152:155]
    v_exp_f32 v26, v26
    v_mfma_f32_16x16x32_bf16 v[152:155], a[244:247], v[36:39], v[152:155]
    ds_read_b64_tr_b16 a[162:163], v2 offset:384
    v_cvt_pk_bf16_f32 v44, v24, v25
    v_mfma_f32_16x16x32_bf16 v[156:159], a[248:251], v[32:35], v[156:159]
    v_exp_f32 v27, v27
    v_mfma_f32_16x16x32_bf16 v[156:159], a[252:255], v[36:39], v[156:159]
    ds_read_b64_tr_b16 a[164:165], v2 offset:640
    ds_read_b64_tr_b16 a[166:167], v2 offset:896
    v_smfmac_f32_16x16x64_bf16 a[0:3], a[16:19], v[32:39], v11
    ds_read_b64_tr_b16 a[168:169], v2 offset:160
    ds_read_b64_tr_b16 a[170:171], v2 offset:416
    v_mfma_f32_16x16x32_bf16 v[16:19], a[64:67], v[96:99], v[56:59]
    v_exp_f32 v28, v28
    v_mfma_f32_16x16x32_bf16 v[16:19], a[68:71], v[100:103], v[16:19]
    ds_read_b64_tr_b16 a[172:173], v2 offset:672
    v_cvt_pk_bf16_f32 v45, v26, v27
    v_mfma_f32_16x16x32_bf16 v[16:19], a[72:75], v[104:107], v[16:19]
    s_add_u32 m0, s47, 36864
    v_exp_f32 v29, v29
    v_mfma_f32_16x16x32_bf16 v[16:19], a[76:79], v[108:111], v[16:19]
    s_add_u32 s46, s46, 16384
    buffer_load_dwordx4 v5, s[16:19], s46 offen offset:0 lds
    v_mfma_f32_16x16x32_bf16 v[20:23], a[80:83], v[96:99], v[56:59]
    v_exp_f32 v30, v30
    v_mfma_f32_16x16x32_bf16 v[20:23], a[84:87], v[100:103], v[20:23]
    ds_read_b64_tr_b16 a[174:175], v2 offset:928
    v_cvt_pk_bf16_f32 v46, v28, v29
    v_mfma_f32_16x16x32_bf16 v[20:23], a[88:91], v[104:107], v[20:23]
    s_add_u32 m0, s47, 36896
    v_exp_f32 v31, v31
    v_mfma_f32_16x16x32_bf16 v[20:23], a[92:95], v[108:111], v[20:23]
    buffer_load_dwordx4 v5, s[16:19], s46 offen offset:1024 lds
    v_mfma_f32_16x16x32_bf16 v[24:27], a[96:99], v[96:99], v[56:59]
    v_exp_f32 v16, v16
    v_mfma_f32_16x16x32_bf16 v[24:27], a[100:103], v[100:103], v[24:27]
    ds_read_b64_tr_b16 a[176:177], v2 offset:192
    v_cvt_pk_bf16_f32 v47, v30, v31
    v_mfma_f32_16x16x32_bf16 v[24:27], a[104:107], v[104:107], v[24:27]
    s_add_u32 m0, s47, 36928
    v_exp_f32 v17, v17
    v_mfma_f32_16x16x32_bf16 v[24:27], a[108:111], v[108:111], v[24:27]
    buffer_load_dwordx4 v5, s[16:19], s46 offen offset:2048 lds
    v_mfma_f32_16x16x32_bf16 v[28:31], a[112:115], v[96:99], v[56:59]
    v_exp_f32 v18, v18
    v_mfma_f32_16x16x32_bf16 v[28:31], a[116:119], v[100:103], v[28:31]
    ds_read_b64_tr_b16 a[178:179], v2 offset:448
    v_cvt_pk_bf16_f32 v32, v16, v17
    v_mfma_f32_16x16x32_bf16 v[28:31], a[120:123], v[104:107], v[28:31]
    s_add_u32 m0, s47, 36960
    v_exp_f32 v19, v19
    v_mfma_f32_16x16x32_bf16 v[28:31], a[124:127], v[108:111], v[28:31]
    buffer_load_dwordx4 v5, s[16:19], s46 offen offset:3072 lds
    v_mfma_f32_16x16x32_bf16 v[160:163], a[192:195], v[40:43], v[160:163]
    v_exp_f32 v20, v20
    v_mfma_f32_16x16x32_bf16 v[160:163], a[196:199], v[44:47], v[160:163]
    ds_read_b64_tr_b16 a[180:181], v2 offset:704
    v_cvt_pk_bf16_f32 v33, v18, v19
    v_mfma_f32_16x16x32_bf16 v[164:167], a[200:203], v[40:43], v[164:167]
    s_add_u32 m0, s47, 53760
    v_exp_f32 v21, v21
    v_mfma_f32_16x16x32_bf16 v[164:167], a[204:207], v[44:47], v[164:167]
    buffer_load_dwordx4 v5, s[20:23], s46 offen offset:0 lds
    v_mfma_f32_16x16x32_bf16 v[168:171], a[208:211], v[40:43], v[168:171]
    v_exp_f32 v22, v22
    v_mfma_f32_16x16x32_bf16 v[168:171], a[212:215], v[44:47], v[168:171]
    ds_read_b64_tr_b16 a[182:183], v2 offset:960
    v_cvt_pk_bf16_f32 v34, v20, v21
    v_mfma_f32_16x16x32_bf16 v[172:175], a[216:219], v[40:43], v[172:175]
    s_add_u32 m0, s47, 53792
    v_exp_f32 v23, v23
    v_mfma_f32_16x16x32_bf16 v[172:175], a[220:223], v[44:47], v[172:175]
    buffer_load_dwordx4 v5, s[20:23], s46 offen offset:1024 lds
    v_mfma_f32_16x16x32_bf16 v[176:179], a[224:227], v[40:43], v[176:179]
    v_exp_f32 v24, v24
    v_mfma_f32_16x16x32_bf16 v[176:179], a[228:231], v[44:47], v[176:179]
    ds_read_b64_tr_b16 a[184:185], v2 offset:224
    v_cvt_pk_bf16_f32 v35, v22, v23
    v_mfma_f32_16x16x32_bf16 v[180:183], a[232:235], v[40:43], v[180:183]
    s_add_u32 m0, s47, 53824
    v_exp_f32 v25, v25
    v_mfma_f32_16x16x32_bf16 v[180:183], a[236:239], v[44:47], v[180:183]
    buffer_load_dwordx4 v5, s[20:23], s46 offen offset:2048 lds
    v_mfma_f32_16x16x32_bf16 v[184:187], a[240:243], v[40:43], v[184:187]
    v_exp_f32 v26, v26
    v_mfma_f32_16x16x32_bf16 v[184:187], a[244:247], v[44:47], v[184:187]
    ds_read_b64_tr_b16 a[186:187], v2 offset:480
    v_cvt_pk_bf16_f32 v36, v24, v25
    v_mfma_f32_16x16x32_bf16 v[188:191], a[248:251], v[40:43], v[188:191]
    s_add_u32 m0, s47, 53856
    v_exp_f32 v27, v27
    v_mfma_f32_16x16x32_bf16 v[188:191], a[252:255], v[44:47], v[188:191]
    buffer_load_dwordx4 v5, s[20:23], s46 offen offset:3072 lds
    v_smfmac_f32_16x16x64_bf16 a[4:7], a[16:19], v[40:47], v11
    ds_read_b64_tr_b16 a[188:189], v2 offset:736
    ds_read_b64_tr_b16 a[190:191], v2 offset:992
    v_mfma_f32_16x16x32_bf16 v[16:19], a[64:67], v[112:115], v[60:63]
    v_exp_f32 v28, v28
    v_mfma_f32_16x16x32_bf16 v[16:19], a[68:71], v[116:119], v[16:19]
    ds_read_b128 a[64:67], v1 offset:0
    v_cvt_pk_bf16_f32 v37, v26, v27
    v_mfma_f32_16x16x32_bf16 v[16:19], a[72:75], v[120:123], v[16:19]
    v_exp_f32 v29, v29
    v_mfma_f32_16x16x32_bf16 v[16:19], a[76:79], v[124:127], v[16:19]
    ds_read_b128 a[68:71], v1 offset:64
    v_mfma_f32_16x16x32_bf16 v[20:23], a[80:83], v[112:115], v[60:63]
    v_exp_f32 v30, v30
    v_mfma_f32_16x16x32_bf16 v[20:23], a[84:87], v[116:119], v[20:23]
    ds_read_b128 a[72:75], v1 offset:128
    v_cvt_pk_bf16_f32 v38, v28, v29
    v_mfma_f32_16x16x32_bf16 v[20:23], a[88:91], v[120:123], v[20:23]
    v_exp_f32 v31, v31
    v_mfma_f32_16x16x32_bf16 v[20:23], a[92:95], v[124:127], v[20:23]
    ds_read_b128 a[76:79], v1 offset:192
    v_mfma_f32_16x16x32_bf16 v[24:27], a[96:99], v[112:115], v[60:63]
    v_exp_f32 v16, v16
    v_mfma_f32_16x16x32_bf16 v[24:27], a[100:103], v[116:119], v[24:27]
    ds_read_b128 a[80:83], v1 offset:256
    v_cvt_pk_bf16_f32 v39, v30, v31
    v_mfma_f32_16x16x32_bf16 v[24:27], a[104:107], v[120:123], v[24:27]
    v_exp_f32 v17, v17
    v_mfma_f32_16x16x32_bf16 v[24:27], a[108:111], v[124:127], v[24:27]
    ds_read_b128 a[84:87], v1 offset:320
    v_mfma_f32_16x16x32_bf16 v[28:31], a[112:115], v[112:115], v[60:63]
    v_exp_f32 v18, v18
    v_mfma_f32_16x16x32_bf16 v[28:31], a[116:119], v[116:119], v[28:31]
    ds_read_b128 a[88:91], v1 offset:384
    v_cvt_pk_bf16_f32 v40, v16, v17
    v_mfma_f32_16x16x32_bf16 v[28:31], a[120:123], v[120:123], v[28:31]
    v_exp_f32 v19, v19
    v_mfma_f32_16x16x32_bf16 v[28:31], a[124:127], v[124:127], v[28:31]
    ds_read_b128 a[92:95], v1 offset:448
    v_mfma_f32_16x16x32_bf16 v[192:195], a[192:195], v[32:35], v[192:195]
    v_exp_f32 v20, v20
    v_mfma_f32_16x16x32_bf16 v[192:195], a[196:199], v[36:39], v[192:195]
    ds_read_b128 a[96:99], v1 offset:512
    v_cvt_pk_bf16_f32 v41, v18, v19
    v_mfma_f32_16x16x32_bf16 v[196:199], a[200:203], v[32:35], v[196:199]
    v_exp_f32 v21, v21
    v_mfma_f32_16x16x32_bf16 v[196:199], a[204:207], v[36:39], v[196:199]
    ds_read_b128 a[100:103], v1 offset:576
    v_mfma_f32_16x16x32_bf16 v[200:203], a[208:211], v[32:35], v[200:203]
    v_exp_f32 v22, v22
    v_mfma_f32_16x16x32_bf16 v[200:203], a[212:215], v[36:39], v[200:203]
    ds_read_b128 a[104:107], v1 offset:640
    v_cvt_pk_bf16_f32 v42, v20, v21
    v_mfma_f32_16x16x32_bf16 v[204:207], a[216:219], v[32:35], v[204:207]
    v_exp_f32 v23, v23
    v_mfma_f32_16x16x32_bf16 v[204:207], a[220:223], v[36:39], v[204:207]
    ds_read_b128 a[108:111], v1 offset:704
    v_mfma_f32_16x16x32_bf16 v[208:211], a[224:227], v[32:35], v[208:211]
    v_exp_f32 v24, v24
    v_mfma_f32_16x16x32_bf16 v[208:211], a[228:231], v[36:39], v[208:211]
    ds_read_b128 a[112:115], v1 offset:768
    v_cvt_pk_bf16_f32 v43, v22, v23
    v_mfma_f32_16x16x32_bf16 v[212:215], a[232:235], v[32:35], v[212:215]
    v_exp_f32 v25, v25
    v_mfma_f32_16x16x32_bf16 v[212:215], a[236:239], v[36:39], v[212:215]
    ds_read_b128 a[116:119], v1 offset:832
    v_mfma_f32_16x16x32_bf16 v[216:219], a[240:243], v[32:35], v[216:219]
    v_exp_f32 v26, v26
    v_mfma_f32_16x16x32_bf16 v[216:219], a[244:247], v[36:39], v[216:219]
    ds_read_b128 a[120:123], v1 offset:896
    v_cvt_pk_bf16_f32 v44, v24, v25
    v_mfma_f32_16x16x32_bf16 v[220:223], a[248:251], v[32:35], v[220:223]
    v_exp_f32 v27, v27
    v_mfma_f32_16x16x32_bf16 v[220:223], a[252:255], v[36:39], v[220:223]
    ds_read_b128 a[124:127], v1 offset:960
    v_smfmac_f32_16x16x64_bf16 a[8:11], a[16:19], v[32:39], v11
    s_waitcnt lgkmcnt(12)
    v_mfma_f32_16x16x32_bf16 v[16:19], a[64:67], v[64:67], v[48:51]
    v_exp_f32 v28, v28
    v_mfma_f32_16x16x32_bf16 v[16:19], a[68:71], v[68:71], v[16:19]
    v_cvt_pk_bf16_f32 v45, v26, v27
    v_mfma_f32_16x16x32_bf16 v[16:19], a[72:75], v[72:75], v[16:19]
    v_exp_f32 v29, v29
    v_mfma_f32_16x16x32_bf16 v[16:19], a[76:79], v[76:79], v[16:19]
    s_waitcnt lgkmcnt(8)
    global_load_dword a63, v12, s[4:5]
    v_mfma_f32_16x16x32_bf16 v[20:23], a[80:83], v[64:67], v[48:51]
    v_exp_f32 v30, v30
    v_mfma_f32_16x16x32_bf16 v[20:23], a[84:87], v[68:71], v[20:23]
    v_cvt_pk_bf16_f32 v46, v28, v29
    v_mfma_f32_16x16x32_bf16 v[20:23], a[88:91], v[72:75], v[20:23]
    v_exp_f32 v31, v31
    v_mfma_f32_16x16x32_bf16 v[20:23], a[92:95], v[76:79], v[20:23]
    s_waitcnt lgkmcnt(4)
    v_mfma_f32_16x16x32_bf16 v[24:27], a[96:99], v[64:67], v[48:51]
    v_exp_f32 v16, v16
    v_mfma_f32_16x16x32_bf16 v[24:27], a[100:103], v[68:71], v[24:27]
    v_cvt_pk_bf16_f32 v47, v30, v31
    v_mfma_f32_16x16x32_bf16 v[24:27], a[104:107], v[72:75], v[24:27]
    v_exp_f32 v17, v17
    v_mfma_f32_16x16x32_bf16 v[24:27], a[108:111], v[76:79], v[24:27]
    s_waitcnt lgkmcnt(0)
    global_load_dword a63, v14, s[10:11]
    v_mfma_f32_16x16x32_bf16 v[28:31], a[112:115], v[64:67], v[48:51]
    v_exp_f32 v18, v18
    v_mfma_f32_16x16x32_bf16 v[28:31], a[116:119], v[68:71], v[28:31]
    v_cvt_pk_bf16_f32 v32, v16, v17
    v_mfma_f32_16x16x32_bf16 v[28:31], a[120:123], v[72:75], v[28:31]
    v_exp_f32 v19, v19
    v_mfma_f32_16x16x32_bf16 v[28:31], a[124:127], v[76:79], v[28:31]
    v_mfma_f32_16x16x32_bf16 v[224:227], a[192:195], v[40:43], v[224:227]
    v_exp_f32 v20, v20
    v_mfma_f32_16x16x32_bf16 v[224:227], a[196:199], v[44:47], v[224:227]
    ds_read_b64_tr_b16 a[192:193], v2 offset:36864
    v_cvt_pk_bf16_f32 v33, v18, v19
    v_mfma_f32_16x16x32_bf16 v[228:231], a[200:203], v[40:43], v[228:231]
    v_exp_f32 v21, v21
    v_mfma_f32_16x16x32_bf16 v[228:231], a[204:207], v[44:47], v[228:231]
    ds_read_b64_tr_b16 a[194:195], v2 offset:37120
    v_mfma_f32_16x16x32_bf16 v[232:235], a[208:211], v[40:43], v[232:235]
    v_exp_f32 v22, v22
    v_mfma_f32_16x16x32_bf16 v[232:235], a[212:215], v[44:47], v[232:235]
    ds_read_b64_tr_b16 a[196:197], v2 offset:37376
    v_cvt_pk_bf16_f32 v34, v20, v21
    v_mfma_f32_16x16x32_bf16 v[236:239], a[216:219], v[40:43], v[236:239]
    v_exp_f32 v23, v23
    v_mfma_f32_16x16x32_bf16 v[236:239], a[220:223], v[44:47], v[236:239]
    ds_read_b64_tr_b16 a[198:199], v2 offset:37632
    v_mfma_f32_16x16x32_bf16 v[240:243], a[224:227], v[40:43], v[240:243]
    v_exp_f32 v24, v24
    v_mfma_f32_16x16x32_bf16 v[240:243], a[228:231], v[44:47], v[240:243]
    ds_read_b64_tr_b16 a[200:201], v2 offset:36896
    v_cvt_pk_bf16_f32 v35, v22, v23
    v_mfma_f32_16x16x32_bf16 v[244:247], a[232:235], v[40:43], v[244:247]
    v_exp_f32 v25, v25
    v_mfma_f32_16x16x32_bf16 v[244:247], a[236:239], v[44:47], v[244:247]
    ds_read_b64_tr_b16 a[202:203], v2 offset:37152
    v_mfma_f32_16x16x32_bf16 v[248:251], a[240:243], v[40:43], v[248:251]
    v_exp_f32 v26, v26
    v_mfma_f32_16x16x32_bf16 v[248:251], a[244:247], v[44:47], v[248:251]
    ds_read_b64_tr_b16 a[204:205], v2 offset:37408
    v_cvt_pk_bf16_f32 v36, v24, v25
    v_mfma_f32_16x16x32_bf16 v[252:255], a[248:251], v[40:43], v[252:255]
    v_exp_f32 v27, v27
    v_mfma_f32_16x16x32_bf16 v[252:255], a[252:255], v[44:47], v[252:255]
    ds_read_b64_tr_b16 a[206:207], v2 offset:37664
    v_smfmac_f32_16x16x64_bf16 a[12:15], a[16:19], v[40:47], v11
    ds_read_b64_tr_b16 a[208:209], v2 offset:36928
    v_mfma_f32_16x16x32_bf16 v[16:19], a[64:67], v[80:83], v[52:55]
    v_exp_f32 v28, v28
    v_mfma_f32_16x16x32_bf16 v[16:19], a[68:71], v[84:87], v[16:19]
    ds_read_b64_tr_b16 a[210:211], v2 offset:37184
    v_cvt_pk_bf16_f32 v37, v26, v27
    v_mfma_f32_16x16x32_bf16 v[16:19], a[72:75], v[88:91], v[16:19]
    v_exp_f32 v29, v29
    v_mfma_f32_16x16x32_bf16 v[16:19], a[76:79], v[92:95], v[16:19]
    ds_read_b64_tr_b16 a[212:213], v2 offset:37440
    v_mfma_f32_16x16x32_bf16 v[20:23], a[80:83], v[80:83], v[52:55]
    v_exp_f32 v30, v30
    v_mfma_f32_16x16x32_bf16 v[20:23], a[84:87], v[84:87], v[20:23]
    ds_read_b64_tr_b16 a[214:215], v2 offset:37696
    v_cvt_pk_bf16_f32 v38, v28, v29
    v_mfma_f32_16x16x32_bf16 v[20:23], a[88:91], v[88:91], v[20:23]
    v_exp_f32 v31, v31
    v_mfma_f32_16x16x32_bf16 v[20:23], a[92:95], v[92:95], v[20:23]
    ds_read_b64_tr_b16 a[216:217], v2 offset:36960
    v_mfma_f32_16x16x32_bf16 v[24:27], a[96:99], v[80:83], v[52:55]
    v_exp_f32 v16, v16
    v_mfma_f32_16x16x32_bf16 v[24:27], a[100:103], v[84:87], v[24:27]
    ds_read_b64_tr_b16 a[218:219], v2 offset:37216
    v_cvt_pk_bf16_f32 v39, v30, v31
    v_mfma_f32_16x16x32_bf16 v[24:27], a[104:107], v[88:91], v[24:27]
    v_exp_f32 v17, v17
    v_mfma_f32_16x16x32_bf16 v[24:27], a[108:111], v[92:95], v[24:27]
    ds_read_b64_tr_b16 a[220:221], v2 offset:37472
    v_mfma_f32_16x16x32_bf16 v[28:31], a[112:115], v[80:83], v[52:55]
    v_exp_f32 v18, v18
    v_mfma_f32_16x16x32_bf16 v[28:31], a[116:119], v[84:87], v[28:31]
    ds_read_b64_tr_b16 a[222:223], v2 offset:37728
    v_cvt_pk_bf16_f32 v40, v16, v17
    v_mfma_f32_16x16x32_bf16 v[28:31], a[120:123], v[88:91], v[28:31]
    v_exp_f32 v19, v19
    v_mfma_f32_16x16x32_bf16 v[28:31], a[124:127], v[92:95], v[28:31]
    ds_read_b64_tr_b16 a[224:225], v2 offset:36992
    v_mfma_f32_16x16x32_bf16 v[128:131], a[128:131], v[32:35], v[128:131]
    v_exp_f32 v20, v20
    v_mfma_f32_16x16x32_bf16 v[128:131], a[132:135], v[36:39], v[128:131]
    ds_read_b64_tr_b16 a[226:227], v2 offset:37248
    v_cvt_pk_bf16_f32 v41, v18, v19
    v_mfma_f32_16x16x32_bf16 v[132:135], a[136:139], v[32:35], v[132:135]
    v_exp_f32 v21, v21
    v_mfma_f32_16x16x32_bf16 v[132:135], a[140:143], v[36:39], v[132:135]
    ds_read_b64_tr_b16 a[228:229], v2 offset:37504
    v_mfma_f32_16x16x32_bf16 v[136:139], a[144:147], v[32:35], v[136:139]
    v_exp_f32 v22, v22
    v_mfma_f32_16x16x32_bf16 v[136:139], a[148:151], v[36:39], v[136:139]
    ds_read_b64_tr_b16 a[230:231], v2 offset:37760
    v_cvt_pk_bf16_f32 v42, v20, v21
    v_mfma_f32_16x16x32_bf16 v[140:143], a[152:155], v[32:35], v[140:143]
    v_exp_f32 v23, v23
    v_mfma_f32_16x16x32_bf16 v[140:143], a[156:159], v[36:39], v[140:143]
    ds_read_b64_tr_b16 a[232:233], v2 offset:37024
    v_mfma_f32_16x16x32_bf16 v[144:147], a[160:163], v[32:35], v[144:147]
    v_exp_f32 v24, v24
    v_mfma_f32_16x16x32_bf16 v[144:147], a[164:167], v[36:39], v[144:147]
    ds_read_b64_tr_b16 a[234:235], v2 offset:37280
    v_cvt_pk_bf16_f32 v43, v22, v23
    v_mfma_f32_16x16x32_bf16 v[148:151], a[168:171], v[32:35], v[148:151]
    v_exp_f32 v25, v25
    v_mfma_f32_16x16x32_bf16 v[148:151], a[172:175], v[36:39], v[148:151]
    ds_read_b64_tr_b16 a[236:237], v2 offset:37536
    v_mfma_f32_16x16x32_bf16 v[152:155], a[176:179], v[32:35], v[152:155]
    v_exp_f32 v26, v26
    v_mfma_f32_16x16x32_bf16 v[152:155], a[180:183], v[36:39], v[152:155]
    ds_read_b64_tr_b16 a[238:239], v2 offset:37792
    v_cvt_pk_bf16_f32 v44, v24, v25
    v_mfma_f32_16x16x32_bf16 v[156:159], a[184:187], v[32:35], v[156:159]
    v_exp_f32 v27, v27
    v_mfma_f32_16x16x32_bf16 v[156:159], a[188:191], v[36:39], v[156:159]
    ds_read_b64_tr_b16 a[240:241], v2 offset:37056
    v_smfmac_f32_16x16x64_bf16 a[0:3], a[16:19], v[32:39], v11
    ds_read_b64_tr_b16 a[242:243], v2 offset:37312
    v_mfma_f32_16x16x32_bf16 v[16:19], a[64:67], v[96:99], v[56:59]
    v_exp_f32 v28, v28
    v_mfma_f32_16x16x32_bf16 v[16:19], a[68:71], v[100:103], v[16:19]
    ds_read_b64_tr_b16 a[244:245], v2 offset:37568
    v_cvt_pk_bf16_f32 v45, v26, v27
    v_mfma_f32_16x16x32_bf16 v[16:19], a[72:75], v[104:107], v[16:19]
    v_exp_f32 v29, v29
    v_mfma_f32_16x16x32_bf16 v[16:19], a[76:79], v[108:111], v[16:19]
    ds_read_b64_tr_b16 a[246:247], v2 offset:37824
    v_mfma_f32_16x16x32_bf16 v[20:23], a[80:83], v[96:99], v[56:59]
    v_exp_f32 v30, v30
    v_mfma_f32_16x16x32_bf16 v[20:23], a[84:87], v[100:103], v[20:23]
    ds_read_b64_tr_b16 a[248:249], v2 offset:37088
    v_cvt_pk_bf16_f32 v46, v28, v29
    v_mfma_f32_16x16x32_bf16 v[20:23], a[88:91], v[104:107], v[20:23]
    v_exp_f32 v31, v31
    v_mfma_f32_16x16x32_bf16 v[20:23], a[92:95], v[108:111], v[20:23]
    ds_read_b64_tr_b16 a[250:251], v2 offset:37344
    v_mfma_f32_16x16x32_bf16 v[24:27], a[96:99], v[96:99], v[56:59]
    v_exp_f32 v16, v16
    v_mfma_f32_16x16x32_bf16 v[24:27], a[100:103], v[100:103], v[24:27]
    ds_read_b64_tr_b16 a[252:253], v2 offset:37600
    v_cvt_pk_bf16_f32 v47, v30, v31
    v_mfma_f32_16x16x32_bf16 v[24:27], a[104:107], v[104:107], v[24:27]
    v_exp_f32 v17, v17
    v_mfma_f32_16x16x32_bf16 v[24:27], a[108:111], v[108:111], v[24:27]
    ds_read_b64_tr_b16 a[254:255], v2 offset:37856
    v_mfma_f32_16x16x32_bf16 v[28:31], a[112:115], v[96:99], v[56:59]
    v_exp_f32 v18, v18
    v_mfma_f32_16x16x32_bf16 v[28:31], a[116:119], v[100:103], v[28:31]
    v_cvt_pk_bf16_f32 v32, v16, v17
    v_mfma_f32_16x16x32_bf16 v[28:31], a[120:123], v[104:107], v[28:31]
    v_exp_f32 v19, v19
    v_mfma_f32_16x16x32_bf16 v[28:31], a[124:127], v[108:111], v[28:31]
    v_mfma_f32_16x16x32_bf16 v[160:163], a[128:131], v[40:43], v[160:163]
    v_exp_f32 v20, v20
    v_mfma_f32_16x16x32_bf16 v[160:163], a[132:135], v[44:47], v[160:163]
    v_cvt_pk_bf16_f32 v33, v18, v19
    v_mfma_f32_16x16x32_bf16 v[164:167], a[136:139], v[40:43], v[164:167]
    v_exp_f32 v21, v21
    v_mfma_f32_16x16x32_bf16 v[164:167], a[140:143], v[44:47], v[164:167]
    v_mfma_f32_16x16x32_bf16 v[168:171], a[144:147], v[40:43], v[168:171]
    v_exp_f32 v22, v22
    v_mfma_f32_16x16x32_bf16 v[168:171], a[148:151], v[44:47], v[168:171]
    v_cvt_pk_bf16_f32 v34, v20, v21
    v_mfma_f32_16x16x32_bf16 v[172:175], a[152:155], v[40:43], v[172:175]
    v_exp_f32 v23, v23
    v_mfma_f32_16x16x32_bf16 v[172:175], a[156:159], v[44:47], v[172:175]
    v_mfma_f32_16x16x32_bf16 v[176:179], a[160:163], v[40:43], v[176:179]
    v_exp_f32 v24, v24
    v_mfma_f32_16x16x32_bf16 v[176:179], a[164:167], v[44:47], v[176:179]
    v_cvt_pk_bf16_f32 v35, v22, v23
    v_mfma_f32_16x16x32_bf16 v[180:183], a[168:171], v[40:43], v[180:183]
    v_exp_f32 v25, v25
    v_mfma_f32_16x16x32_bf16 v[180:183], a[172:175], v[44:47], v[180:183]
    v_mfma_f32_16x16x32_bf16 v[184:187], a[176:179], v[40:43], v[184:187]
    v_exp_f32 v26, v26
    v_mfma_f32_16x16x32_bf16 v[184:187], a[180:183], v[44:47], v[184:187]
    v_cvt_pk_bf16_f32 v36, v24, v25
    v_mfma_f32_16x16x32_bf16 v[188:191], a[184:187], v[40:43], v[188:191]
    v_exp_f32 v27, v27
    v_mfma_f32_16x16x32_bf16 v[188:191], a[188:191], v[44:47], v[188:191]
    v_smfmac_f32_16x16x64_bf16 a[4:7], a[16:19], v[40:47], v11
    v_mfma_f32_16x16x32_bf16 v[16:19], a[64:67], v[112:115], v[60:63]
    v_exp_f32 v28, v28
    v_mfma_f32_16x16x32_bf16 v[16:19], a[68:71], v[116:119], v[16:19]
    ds_read_b128 a[64:67], v1 offset:36864
    v_cvt_pk_bf16_f32 v37, v26, v27
    v_mfma_f32_16x16x32_bf16 v[16:19], a[72:75], v[120:123], v[16:19]
    v_exp_f32 v29, v29
    v_mfma_f32_16x16x32_bf16 v[16:19], a[76:79], v[124:127], v[16:19]
    ds_read_b128 a[68:71], v1 offset:36928
    v_mfma_f32_16x16x32_bf16 v[20:23], a[80:83], v[112:115], v[60:63]
    v_exp_f32 v30, v30
    v_mfma_f32_16x16x32_bf16 v[20:23], a[84:87], v[116:119], v[20:23]
    ds_read_b128 a[72:75], v1 offset:36992
    v_cvt_pk_bf16_f32 v38, v28, v29
    v_mfma_f32_16x16x32_bf16 v[20:23], a[88:91], v[120:123], v[20:23]
    v_exp_f32 v31, v31
    v_mfma_f32_16x16x32_bf16 v[20:23], a[92:95], v[124:127], v[20:23]
    ds_read_b128 a[76:79], v1 offset:37056
    v_mfma_f32_16x16x32_bf16 v[24:27], a[96:99], v[112:115], v[60:63]
    v_exp_f32 v16, v16
    v_mfma_f32_16x16x32_bf16 v[24:27], a[100:103], v[116:119], v[24:27]
    ds_read_b128 a[80:83], v1 offset:37120
    v_cvt_pk_bf16_f32 v39, v30, v31
    v_mfma_f32_16x16x32_bf16 v[24:27], a[104:107], v[120:123], v[24:27]
    v_exp_f32 v17, v17
    v_mfma_f32_16x16x32_bf16 v[24:27], a[108:111], v[124:127], v[24:27]
    ds_read_b128 a[84:87], v1 offset:37184
    v_mfma_f32_16x16x32_bf16 v[28:31], a[112:115], v[112:115], v[60:63]
    v_exp_f32 v18, v18
    v_mfma_f32_16x16x32_bf16 v[28:31], a[116:119], v[116:119], v[28:31]
    ds_read_b128 a[88:91], v1 offset:37248
    v_cvt_pk_bf16_f32 v40, v16, v17
    v_mfma_f32_16x16x32_bf16 v[28:31], a[120:123], v[120:123], v[28:31]
    v_exp_f32 v19, v19
    v_mfma_f32_16x16x32_bf16 v[28:31], a[124:127], v[124:127], v[28:31]
    ds_read_b128 a[92:95], v1 offset:37312
    v_mfma_f32_16x16x32_bf16 v[192:195], a[128:131], v[32:35], v[192:195]
    v_exp_f32 v20, v20
    v_mfma_f32_16x16x32_bf16 v[192:195], a[132:135], v[36:39], v[192:195]
    ds_read_b128 a[96:99], v1 offset:37376
    v_cvt_pk_bf16_f32 v41, v18, v19
    v_mfma_f32_16x16x32_bf16 v[196:199], a[136:139], v[32:35], v[196:199]
    v_exp_f32 v21, v21
    v_mfma_f32_16x16x32_bf16 v[196:199], a[140:143], v[36:39], v[196:199]
    ds_read_b128 a[100:103], v1 offset:37440
    v_mfma_f32_16x16x32_bf16 v[200:203], a[144:147], v[32:35], v[200:203]
    v_exp_f32 v22, v22
    v_mfma_f32_16x16x32_bf16 v[200:203], a[148:151], v[36:39], v[200:203]
    ds_read_b128 a[104:107], v1 offset:37504
    v_cvt_pk_bf16_f32 v42, v20, v21
    v_mfma_f32_16x16x32_bf16 v[204:207], a[152:155], v[32:35], v[204:207]
    v_exp_f32 v23, v23
    v_mfma_f32_16x16x32_bf16 v[204:207], a[156:159], v[36:39], v[204:207]
    ds_read_b128 a[108:111], v1 offset:37568
    v_mfma_f32_16x16x32_bf16 v[208:211], a[160:163], v[32:35], v[208:211]
    v_exp_f32 v24, v24
    v_mfma_f32_16x16x32_bf16 v[208:211], a[164:167], v[36:39], v[208:211]
L2_pad6:
    s_cbranch_execz L2_pad10
    ds_read_b128 a[112:115], v1 offset:37632
    v_cvt_pk_bf16_f32 v43, v22, v23
    v_mfma_f32_16x16x32_bf16 v[212:215], a[168:171], v[32:35], v[212:215]
    v_exp_f32 v25, v25
    v_mfma_f32_16x16x32_bf16 v[212:215], a[172:175], v[36:39], v[212:215]
    ds_read_b128 a[116:119], v1 offset:37696
    v_mfma_f32_16x16x32_bf16 v[216:219], a[176:179], v[32:35], v[216:219]
    v_exp_f32 v26, v26
    v_mfma_f32_16x16x32_bf16 v[216:219], a[180:183], v[36:39], v[216:219]
    ds_read_b128 a[120:123], v1 offset:37760
    v_cvt_pk_bf16_f32 v44, v24, v25
    v_mfma_f32_16x16x32_bf16 v[220:223], a[184:187], v[32:35], v[220:223]
    v_exp_f32 v27, v27
    v_mfma_f32_16x16x32_bf16 v[220:223], a[188:191], v[36:39], v[220:223]
    ds_read_b128 a[124:127], v1 offset:37824
    v_smfmac_f32_16x16x64_bf16 a[8:11], a[16:19], v[32:39], v11
    s_waitcnt lgkmcnt(12)
    v_mfma_f32_16x16x32_bf16 v[16:19], a[64:67], v[64:67], v[48:51]
    s_sub_u32 s47, s47, s48
    v_exp_f32 v28, v28
    v_mfma_f32_16x16x32_bf16 v[16:19], a[68:71], v[68:71], v[16:19]
    v_cvt_pk_bf16_f32 v45, v26, v27
    v_add_u32 v1, s48, v1
    v_mfma_f32_16x16x32_bf16 v[16:19], a[72:75], v[72:75], v[16:19]
    v_exp_f32 v29, v29
    v_mfma_f32_16x16x32_bf16 v[16:19], a[76:79], v[76:79], v[16:19]
    s_waitcnt lgkmcnt(8)
    v_mfma_f32_16x16x32_bf16 v[20:23], a[80:83], v[64:67], v[48:51]
    v_exp_f32 v30, v30
    v_mfma_f32_16x16x32_bf16 v[20:23], a[84:87], v[68:71], v[20:23]
    v_cvt_pk_bf16_f32 v46, v28, v29
    v_add_u32 v2, s48, v2
    v_mfma_f32_16x16x32_bf16 v[20:23], a[88:91], v[72:75], v[20:23]
    v_exp_f32 v31, v31
    v_mfma_f32_16x16x32_bf16 v[20:23], a[92:95], v[76:79], v[20:23]
    s_waitcnt lgkmcnt(4)
    v_mfma_f32_16x16x32_bf16 v[24:27], a[96:99], v[64:67], v[48:51]
    s_sub_u32 s48, 0, s48
    v_exp_f32 v16, v16
    v_mfma_f32_16x16x32_bf16 v[24:27], a[100:103], v[68:71], v[24:27]
    v_cvt_pk_bf16_f32 v47, v30, v31
    v_mfma_f32_16x16x32_bf16 v[24:27], a[104:107], v[72:75], v[24:27]
    v_exp_f32 v17, v17
    v_mfma_f32_16x16x32_bf16 v[24:27], a[108:111], v[76:79], v[24:27]
    s_waitcnt lgkmcnt(0)
    v_mfma_f32_16x16x32_bf16 v[28:31], a[112:115], v[64:67], v[48:51]
    v_exp_f32 v18, v18
    v_mfma_f32_16x16x32_bf16 v[28:31], a[116:119], v[68:71], v[28:31]
    v_cvt_pk_bf16_f32 v32, v16, v17
    v_mfma_f32_16x16x32_bf16 v[28:31], a[120:123], v[72:75], v[28:31]
    v_exp_f32 v19, v19
    v_mfma_f32_16x16x32_bf16 v[28:31], a[124:127], v[76:79], v[28:31]
    s_waitcnt vmcnt(2)
    s_barrier
    v_mfma_f32_16x16x32_bf16 v[224:227], a[128:131], v[40:43], v[224:227]
    v_exp_f32 v20, v20
    v_mfma_f32_16x16x32_bf16 v[224:227], a[132:135], v[44:47], v[224:227]
    ds_read_b64_tr_b16 a[128:129], v2 offset:0
    v_cvt_pk_bf16_f32 v33, v18, v19
    v_mfma_f32_16x16x32_bf16 v[228:231], a[136:139], v[40:43], v[228:231]
    s_add_u32 m0, s47, 0
    v_exp_f32 v21, v21
    v_mfma_f32_16x16x32_bf16 v[228:231], a[140:143], v[44:47], v[228:231]
    s_add_u32 s46, s46, 16384
    buffer_load_dwordx4 v5, s[16:19], s46 offen offset:0 lds
    v_mfma_f32_16x16x32_bf16 v[232:235], a[144:147], v[40:43], v[232:235]
    v_exp_f32 v22, v22
    v_mfma_f32_16x16x32_bf16 v[232:235], a[148:151], v[44:47], v[232:235]
    ds_read_b64_tr_b16 a[130:131], v2 offset:256
    v_cvt_pk_bf16_f32 v34, v20, v21
    v_mfma_f32_16x16x32_bf16 v[236:239], a[152:155], v[40:43], v[236:239]
    s_add_u32 m0, s47, 32
    v_exp_f32 v23, v23
    v_mfma_f32_16x16x32_bf16 v[236:239], a[156:159], v[44:47], v[236:239]
    buffer_load_dwordx4 v5, s[16:19], s46 offen offset:1024 lds
    v_mfma_f32_16x16x32_bf16 v[240:243], a[160:163], v[40:43], v[240:243]
    v_exp_f32 v24, v24
    v_mfma_f32_16x16x32_bf16 v[240:243], a[164:167], v[44:47], v[240:243]
    ds_read_b64_tr_b16 a[132:133], v2 offset:512
    v_cvt_pk_bf16_f32 v35, v22, v23
    v_mfma_f32_16x16x32_bf16 v[244:247], a[168:171], v[40:43], v[244:247]
    s_add_u32 m0, s47, 64
    v_exp_f32 v25, v25
    v_mfma_f32_16x16x32_bf16 v[244:247], a[172:175], v[44:47], v[244:247]
    buffer_load_dwordx4 v5, s[16:19], s46 offen offset:2048 lds
    v_mfma_f32_16x16x32_bf16 v[248:251], a[176:179], v[40:43], v[248:251]
    v_exp_f32 v26, v26
    v_mfma_f32_16x16x32_bf16 v[248:251], a[180:183], v[44:47], v[248:251]
    ds_read_b64_tr_b16 a[134:135], v2 offset:768
    v_cvt_pk_bf16_f32 v36, v24, v25
    v_mfma_f32_16x16x32_bf16 v[252:255], a[184:187], v[40:43], v[252:255]
    s_add_u32 m0, s47, 96
    v_exp_f32 v27, v27
    v_mfma_f32_16x16x32_bf16 v[252:255], a[188:191], v[44:47], v[252:255]
    buffer_load_dwordx4 v5, s[16:19], s46 offen offset:3072 lds
    v_smfmac_f32_16x16x64_bf16 a[12:15], a[16:19], v[40:47], v11
    ds_read_b64_tr_b16 a[136:137], v2 offset:32
    v_mfma_f32_16x16x32_bf16 v[16:19], a[64:67], v[80:83], v[52:55]
    v_exp_f32 v28, v28
    v_mfma_f32_16x16x32_bf16 v[16:19], a[68:71], v[84:87], v[16:19]
    ds_read_b64_tr_b16 a[138:139], v2 offset:288
    v_cvt_pk_bf16_f32 v37, v26, v27
    v_mfma_f32_16x16x32_bf16 v[16:19], a[72:75], v[88:91], v[16:19]
    s_add_u32 m0, s47, 16896
    v_exp_f32 v29, v29
    v_mfma_f32_16x16x32_bf16 v[16:19], a[76:79], v[92:95], v[16:19]
    buffer_load_dwordx4 v5, s[20:23], s46 offen offset:0 lds
    v_mfma_f32_16x16x32_bf16 v[20:23], a[80:83], v[80:83], v[52:55]
    v_exp_f32 v30, v30
    v_mfma_f32_16x16x32_bf16 v[20:23], a[84:87], v[84:87], v[20:23]
    ds_read_b64_tr_b16 a[140:141], v2 offset:544
    v_cvt_pk_bf16_f32 v38, v28, v29
    v_mfma_f32_16x16x32_bf16 v[20:23], a[88:91], v[88:91], v[20:23]
    s_add_u32 m0, s47, 16928
    v_exp_f32 v31, v31
    v_mfma_f32_16x16x32_bf16 v[20:23], a[92:95], v[92:95], v[20:23]
    buffer_load_dwordx4 v5, s[20:23], s46 offen offset:1024 lds
    v_mfma_f32_16x16x32_bf16 v[24:27], a[96:99], v[80:83], v[52:55]
    v_exp_f32 v16, v16
    v_mfma_f32_16x16x32_bf16 v[24:27], a[100:103], v[84:87], v[24:27]
    ds_read_b64_tr_b16 a[142:143], v2 offset:800
    v_cvt_pk_bf16_f32 v39, v30, v31
    v_mfma_f32_16x16x32_bf16 v[24:27], a[104:107], v[88:91], v[24:27]
    s_add_u32 m0, s47, 16960
    v_exp_f32 v17, v17
    v_mfma_f32_16x16x32_bf16 v[24:27], a[108:111], v[92:95], v[24:27]
    buffer_load_dwordx4 v5, s[20:23], s46 offen offset:2048 lds
    v_mfma_f32_16x16x32_bf16 v[28:31], a[112:115], v[80:83], v[52:55]
    v_exp_f32 v18, v18
    v_mfma_f32_16x16x32_bf16 v[28:31], a[116:119], v[84:87], v[28:31]
    ds_read_b64_tr_b16 a[144:145], v2 offset:64
    v_cvt_pk_bf16_f32 v40, v16, v17
    v_mfma_f32_16x16x32_bf16 v[28:31], a[120:123], v[88:91], v[28:31]
    s_add_u32 m0, s47, 16992
    v_exp_f32 v19, v19
    v_mfma_f32_16x16x32_bf16 v[28:31], a[124:127], v[92:95], v[28:31]
    buffer_load_dwordx4 v5, s[20:23], s46 offen offset:3072 lds
    v_mfma_f32_16x16x32_bf16 v[128:131], a[192:195], v[32:35], v[128:131]
    v_exp_f32 v20, v20
    v_mfma_f32_16x16x32_bf16 v[128:131], a[196:199], v[36:39], v[128:131]
    ds_read_b64_tr_b16 a[146:147], v2 offset:320
    v_cvt_pk_bf16_f32 v41, v18, v19
    v_mfma_f32_16x16x32_bf16 v[132:135], a[200:203], v[32:35], v[132:135]
    v_exp_f32 v21, v21
    v_mfma_f32_16x16x32_bf16 v[132:135], a[204:207], v[36:39], v[132:135]
    ds_read_b64_tr_b16 a[148:149], v2 offset:576
    v_mfma_f32_16x16x32_bf16 v[136:139], a[208:211], v[32:35], v[136:139]
    v_exp_f32 v22, v22
    v_mfma_f32_16x16x32_bf16 v[136:139], a[212:215], v[36:39], v[136:139]
    ds_read_b64_tr_b16 a[150:151], v2 offset:832
    v_cvt_pk_bf16_f32 v42, v20, v21
    v_mfma_f32_16x16x32_bf16 v[140:143], a[216:219], v[32:35], v[140:143]
    v_exp_f32 v23, v23
    v_mfma_f32_16x16x32_bf16 v[140:143], a[220:223], v[36:39], v[140:143]
    ds_read_b64_tr_b16 a[152:153], v2 offset:96
    ds_read_b64_tr_b16 a[154:155], v2 offset:352
    v_mfma_f32_16x16x32_bf16 v[144:147], a[224:227], v[32:35], v[144:147]
    v_exp_f32 v24, v24
    v_mfma_f32_16x16x32_bf16 v[144:147], a[228:231], v[36:39], v[144:147]
    ds_read_b64_tr_b16 a[156:157], v2 offset:608
    v_cvt_pk_bf16_f32 v43, v22, v23
    v_mfma_f32_16x16x32_bf16 v[148:151], a[232:235], v[32:35], v[148:151]
    v_exp_f32 v25, v25
    v_mfma_f32_16x16x32_bf16 v[148:151], a[236:239], v[36:39], v[148:151]
    ds_read_b64_tr_b16 a[158:159], v2 offset:864
    ds_read_b64_tr_b16 a[160:161], v2 offset:128
    v_mfma_f32_16x16x32_bf16 v[152:155], a[240:243], v[32:35], v[152:155]
    v_exp_f32 v26, v26
    v_mfma_f32_16x16x32_bf16 v[152:155], a[244:247], v[36:39], v[152:155]
    ds_read_b64_tr_b16 a[162:163], v2 offset:384
    v_cvt_pk_bf16_f32 v44, v24, v25
    v_mfma_f32_16x16x32_bf16 v[156:159], a[248:251], v[32:35], v[156:159]
    v_exp_f32 v27, v27
    v_mfma_f32_16x16x32_bf16 v[156:159], a[252:255], v[36:39], v[156:159]
    ds_read_b64_tr_b16 a[164:165], v2 offset:640
    ds_read_b64_tr_b16 a[166:167], v2 offset:896
    v_smfmac_f32_16x16x64_bf16 a[0:3], a[16:19], v[32:39], v11
    ds_read_b64_tr_b16 a[168:169], v2 offset:160
    ds_read_b64_tr_b16 a[170:171], v2 offset:416
    v_mfma_f32_16x16x32_bf16 v[16:19], a[64:67], v[96:99], v[56:59]
    v_exp_f32 v28, v28
    v_mfma_f32_16x16x32_bf16 v[16:19], a[68:71], v[100:103], v[16:19]
    ds_read_b64_tr_b16 a[172:173], v2 offset:672
    v_cvt_pk_bf16_f32 v45, v26, v27
    v_mfma_f32_16x16x32_bf16 v[16:19], a[72:75], v[104:107], v[16:19]
    s_add_u32 m0, s47, 36864
    v_exp_f32 v29, v29
    v_mfma_f32_16x16x32_bf16 v[16:19], a[76:79], v[108:111], v[16:19]
    s_add_u32 s46, s46, 16384
    buffer_load_dwordx4 v5, s[16:19], s46 offen offset:0 lds
    v_mfma_f32_16x16x32_bf16 v[20:23], a[80:83], v[96:99], v[56:59]
    v_exp_f32 v30, v30
    v_mfma_f32_16x16x32_bf16 v[20:23], a[84:87], v[100:103], v[20:23]
    ds_read_b64_tr_b16 a[174:175], v2 offset:928
    v_cvt_pk_bf16_f32 v46, v28, v29
    v_mfma_f32_16x16x32_bf16 v[20:23], a[88:91], v[104:107], v[20:23]
    s_add_u32 m0, s47, 36896
    v_exp_f32 v31, v31
    v_mfma_f32_16x16x32_bf16 v[20:23], a[92:95], v[108:111], v[20:23]
    buffer_load_dwordx4 v5, s[16:19], s46 offen offset:1024 lds
    v_mfma_f32_16x16x32_bf16 v[24:27], a[96:99], v[96:99], v[56:59]
    v_exp_f32 v16, v16
    v_mfma_f32_16x16x32_bf16 v[24:27], a[100:103], v[100:103], v[24:27]
    ds_read_b64_tr_b16 a[176:177], v2 offset:192
    v_cvt_pk_bf16_f32 v47, v30, v31
    v_mfma_f32_16x16x32_bf16 v[24:27], a[104:107], v[104:107], v[24:27]
    s_add_u32 m0, s47, 36928
    v_exp_f32 v17, v17
    v_mfma_f32_16x16x32_bf16 v[24:27], a[108:111], v[108:111], v[24:27]
    buffer_load_dwordx4 v5, s[16:19], s46 offen offset:2048 lds
    v_mfma_f32_16x16x32_bf16 v[28:31], a[112:115], v[96:99], v[56:59]
    v_exp_f32 v18, v18
    v_mfma_f32_16x16x32_bf16 v[28:31], a[116:119], v[100:103], v[28:31]
    ds_read_b64_tr_b16 a[178:179], v2 offset:448
    v_cvt_pk_bf16_f32 v32, v16, v17
    v_mfma_f32_16x16x32_bf16 v[28:31], a[120:123], v[104:107], v[28:31]
    s_add_u32 m0, s47, 36960
    v_exp_f32 v19, v19
    v_mfma_f32_16x16x32_bf16 v[28:31], a[124:127], v[108:111], v[28:31]
    buffer_load_dwordx4 v5, s[16:19], s46 offen offset:3072 lds
    v_mfma_f32_16x16x32_bf16 v[160:163], a[192:195], v[40:43], v[160:163]
    v_exp_f32 v20, v20
    v_mfma_f32_16x16x32_bf16 v[160:163], a[196:199], v[44:47], v[160:163]
    ds_read_b64_tr_b16 a[180:181], v2 offset:704
    v_cvt_pk_bf16_f32 v33, v18, v19
    v_mfma_f32_16x16x32_bf16 v[164:167], a[200:203], v[40:43], v[164:167]
    s_add_u32 m0, s47, 53760
    v_exp_f32 v21, v21
    v_mfma_f32_16x16x32_bf16 v[164:167], a[204:207], v[44:47], v[164:167]
    buffer_load_dwordx4 v5, s[20:23], s46 offen offset:0 lds
    v_mfma_f32_16x16x32_bf16 v[168:171], a[208:211], v[40:43], v[168:171]
    v_exp_f32 v22, v22
    v_mfma_f32_16x16x32_bf16 v[168:171], a[212:215], v[44:47], v[168:171]
    ds_read_b64_tr_b16 a[182:183], v2 offset:960
    v_cvt_pk_bf16_f32 v34, v20, v21
    v_mfma_f32_16x16x32_bf16 v[172:175], a[216:219], v[40:43], v[172:175]
    s_add_u32 m0, s47, 53792
    v_exp_f32 v23, v23
    v_mfma_f32_16x16x32_bf16 v[172:175], a[220:223], v[44:47], v[172:175]
    buffer_load_dwordx4 v5, s[20:23], s46 offen offset:1024 lds
    v_mfma_f32_16x16x32_bf16 v[176:179], a[224:227], v[40:43], v[176:179]
    v_exp_f32 v24, v24
    v_mfma_f32_16x16x32_bf16 v[176:179], a[228:231], v[44:47], v[176:179]
    ds_read_b64_tr_b16 a[184:185], v2 offset:224
    v_cvt_pk_bf16_f32 v35, v22, v23
    v_mfma_f32_16x16x32_bf16 v[180:183], a[232:235], v[40:43], v[180:183]
    s_add_u32 m0, s47, 53824
    v_exp_f32 v25, v25
    v_mfma_f32_16x16x32_bf16 v[180:183], a[236:239], v[44:47], v[180:183]
    buffer_load_dwordx4 v5, s[20:23], s46 offen offset:2048 lds
    v_mfma_f32_16x16x32_bf16 v[184:187], a[240:243], v[40:43], v[184:187]
    v_exp_f32 v26, v26
    v_mfma_f32_16x16x32_bf16 v[184:187], a[244:247], v[44:47], v[184:187]
    ds_read_b64_tr_b16 a[186:187], v2 offset:480
    v_cvt_pk_bf16_f32 v36, v24, v25
    v_mfma_f32_16x16x32_bf16 v[188:191], a[248:251], v[40:43], v[188:191]
    s_add_u32 m0, s47, 53856
    v_exp_f32 v27, v27
    v_mfma_f32_16x16x32_bf16 v[188:191], a[252:255], v[44:47], v[188:191]
    buffer_load_dwordx4 v5, s[20:23], s46 offen offset:3072 lds
    v_smfmac_f32_16x16x64_bf16 a[4:7], a[16:19], v[40:47], v11
    ds_read_b64_tr_b16 a[188:189], v2 offset:736
    ds_read_b64_tr_b16 a[190:191], v2 offset:992
    v_mfma_f32_16x16x32_bf16 v[16:19], a[64:67], v[112:115], v[60:63]
    v_exp_f32 v28, v28
    v_mfma_f32_16x16x32_bf16 v[16:19], a[68:71], v[116:119], v[16:19]
    ds_read_b128 a[64:67], v1 offset:0
    v_cvt_pk_bf16_f32 v37, v26, v27
    v_mfma_f32_16x16x32_bf16 v[16:19], a[72:75], v[120:123], v[16:19]
    v_exp_f32 v29, v29
    v_mfma_f32_16x16x32_bf16 v[16:19], a[76:79], v[124:127], v[16:19]
    ds_read_b128 a[68:71], v1 offset:64
    v_mfma_f32_16x16x32_bf16 v[20:23], a[80:83], v[112:115], v[60:63]
    v_exp_f32 v30, v30
    v_mfma_f32_16x16x32_bf16 v[20:23], a[84:87], v[116:119], v[20:23]
    ds_read_b128 a[72:75], v1 offset:128
    v_cvt_pk_bf16_f32 v38, v28, v29
    v_mfma_f32_16x16x32_bf16 v[20:23], a[88:91], v[120:123], v[20:23]
    v_exp_f32 v31, v31
    v_mfma_f32_16x16x32_bf16 v[20:23], a[92:95], v[124:127], v[20:23]
    ds_read_b128 a[76:79], v1 offset:192
    v_mfma_f32_16x16x32_bf16 v[24:27], a[96:99], v[112:115], v[60:63]
    v_exp_f32 v16, v16
    v_mfma_f32_16x16x32_bf16 v[24:27], a[100:103], v[116:119], v[24:27]
    ds_read_b128 a[80:83], v1 offset:256
    v_cvt_pk_bf16_f32 v39, v30, v31
    v_mfma_f32_16x16x32_bf16 v[24:27], a[104:107], v[120:123], v[24:27]
    v_exp_f32 v17, v17
    v_mfma_f32_16x16x32_bf16 v[24:27], a[108:111], v[124:127], v[24:27]
    ds_read_b128 a[84:87], v1 offset:320
    v_mfma_f32_16x16x32_bf16 v[28:31], a[112:115], v[112:115], v[60:63]
    v_exp_f32 v18, v18
    v_mfma_f32_16x16x32_bf16 v[28:31], a[116:119], v[116:119], v[28:31]
    ds_read_b128 a[88:91], v1 offset:384
    v_cvt_pk_bf16_f32 v40, v16, v17
    v_mfma_f32_16x16x32_bf16 v[28:31], a[120:123], v[120:123], v[28:31]
    v_exp_f32 v19, v19
    v_mfma_f32_16x16x32_bf16 v[28:31], a[124:127], v[124:127], v[28:31]
    ds_read_b128 a[92:95], v1 offset:448
    v_mfma_f32_16x16x32_bf16 v[192:195], a[192:195], v[32:35], v[192:195]
    v_exp_f32 v20, v20
    v_mfma_f32_16x16x32_bf16 v[192:195], a[196:199], v[36:39], v[192:195]
    ds_read_b128 a[96:99], v1 offset:512
    v_cvt_pk_bf16_f32 v41, v18, v19
    v_mfma_f32_16x16x32_bf16 v[196:199], a[200:203], v[32:35], v[196:199]
    v_exp_f32 v21, v21
    v_mfma_f32_16x16x32_bf16 v[196:199], a[204:207], v[36:39], v[196:199]
    ds_read_b128 a[100:103], v1 offset:576
    v_mfma_f32_16x16x32_bf16 v[200:203], a[208:211], v[32:35], v[200:203]
    v_exp_f32 v22, v22
    v_mfma_f32_16x16x32_bf16 v[200:203], a[212:215], v[36:39], v[200:203]
    ds_read_b128 a[104:107], v1 offset:640
    v_cvt_pk_bf16_f32 v42, v20, v21
    v_mfma_f32_16x16x32_bf16 v[204:207], a[216:219], v[32:35], v[204:207]
    v_exp_f32 v23, v23
    v_mfma_f32_16x16x32_bf16 v[204:207], a[220:223], v[36:39], v[204:207]
    ds_read_b128 a[108:111], v1 offset:704
    v_mfma_f32_16x16x32_bf16 v[208:211], a[224:227], v[32:35], v[208:211]
    v_exp_f32 v24, v24
    v_mfma_f32_16x16x32_bf16 v[208:211], a[228:231], v[36:39], v[208:211]
    ds_read_b128 a[112:115], v1 offset:768
    v_cvt_pk_bf16_f32 v43, v22, v23
    v_mfma_f32_16x16x32_bf16 v[212:215], a[232:235], v[32:35], v[212:215]
    v_exp_f32 v25, v25
    v_mfma_f32_16x16x32_bf16 v[212:215], a[236:239], v[36:39], v[212:215]
    ds_read_b128 a[116:119], v1 offset:832
    v_mfma_f32_16x16x32_bf16 v[216:219], a[240:243], v[32:35], v[216:219]
    v_exp_f32 v26, v26
    v_mfma_f32_16x16x32_bf16 v[216:219], a[244:247], v[36:39], v[216:219]
    ds_read_b128 a[120:123], v1 offset:896
    v_cvt_pk_bf16_f32 v44, v24, v25
    v_mfma_f32_16x16x32_bf16 v[220:223], a[248:251], v[32:35], v[220:223]
    v_exp_f32 v27, v27
    v_mfma_f32_16x16x32_bf16 v[220:223], a[252:255], v[36:39], v[220:223]
    ds_read_b128 a[124:127], v1 offset:960
    v_smfmac_f32_16x16x64_bf16 a[8:11], a[16:19], v[32:39], v11
    s_waitcnt lgkmcnt(12)
    v_mfma_f32_16x16x32_bf16 v[16:19], a[64:67], v[64:67], v[48:51]
    v_exp_f32 v28, v28
    v_mfma_f32_16x16x32_bf16 v[16:19], a[68:71], v[68:71], v[16:19]
    v_cvt_pk_bf16_f32 v45, v26, v27
    v_mfma_f32_16x16x32_bf16 v[16:19], a[72:75], v[72:75], v[16:19]
    v_exp_f32 v29, v29
    v_mfma_f32_16x16x32_bf16 v[16:19], a[76:79], v[76:79], v[16:19]
    s_waitcnt lgkmcnt(8)
    global_load_dword a63, v15, s[10:11]
    v_mfma_f32_16x16x32_bf16 v[20:23], a[80:83], v[64:67], v[48:51]
    v_exp_f32 v30, v30
    v_mfma_f32_16x16x32_bf16 v[20:23], a[84:87], v[68:71], v[20:23]
    v_cvt_pk_bf16_f32 v46, v28, v29
    v_mfma_f32_16x16x32_bf16 v[20:23], a[88:91], v[72:75], v[20:23]
    v_exp_f32 v31, v31
    v_mfma_f32_16x16x32_bf16 v[20:23], a[92:95], v[76:79], v[20:23]
    s_waitcnt lgkmcnt(4)
    v_mfma_f32_16x16x32_bf16 v[24:27], a[96:99], v[64:67], v[48:51]
    v_exp_f32 v16, v16
    v_mfma_f32_16x16x32_bf16 v[24:27], a[100:103], v[68:71], v[24:27]
    v_cvt_pk_bf16_f32 v47, v30, v31
    v_mfma_f32_16x16x32_bf16 v[24:27], a[104:107], v[72:75], v[24:27]
    v_exp_f32 v17, v17
    v_mfma_f32_16x16x32_bf16 v[24:27], a[108:111], v[76:79], v[24:27]
    s_waitcnt lgkmcnt(0)
    global_load_dword a63, v12, s[6:7]
    v_mfma_f32_16x16x32_bf16 v[28:31], a[112:115], v[64:67], v[48:51]
    v_exp_f32 v18, v18
    v_mfma_f32_16x16x32_bf16 v[28:31], a[116:119], v[68:71], v[28:31]
    v_cvt_pk_bf16_f32 v32, v16, v17
    v_mfma_f32_16x16x32_bf16 v[28:31], a[120:123], v[72:75], v[28:31]
    v_exp_f32 v19, v19
    v_mfma_f32_16x16x32_bf16 v[28:31], a[124:127], v[76:79], v[28:31]
    v_mfma_f32_16x16x32_bf16 v[224:227], a[192:195], v[40:43], v[224:227]
    v_exp_f32 v20, v20
    v_mfma_f32_16x16x32_bf16 v[224:227], a[196:199], v[44:47], v[224:227]
    ds_read_b64_tr_b16 a[192:193], v2 offset:36864
    v_cvt_pk_bf16_f32 v33, v18, v19
    v_mfma_f32_16x16x32_bf16 v[228:231], a[200:203], v[40:43], v[228:231]
    v_exp_f32 v21, v21
    v_mfma_f32_16x16x32_bf16 v[228:231], a[204:207], v[44:47], v[228:231]
    ds_read_b64_tr_b16 a[194:195], v2 offset:37120
    v_mfma_f32_16x16x32_bf16 v[232:235], a[208:211], v[40:43], v[232:235]
    v_exp_f32 v22, v22
    v_mfma_f32_16x16x32_bf16 v[232:235], a[212:215], v[44:47], v[232:235]
    ds_read_b64_tr_b16 a[196:197], v2 offset:37376
    v_cvt_pk_bf16_f32 v34, v20, v21
    v_mfma_f32_16x16x32_bf16 v[236:239], a[216:219], v[40:43], v[236:239]
    v_exp_f32 v23, v23
    v_mfma_f32_16x16x32_bf16 v[236:239], a[220:223], v[44:47], v[236:239]
    ds_read_b64_tr_b16 a[198:199], v2 offset:37632
    v_mfma_f32_16x16x32_bf16 v[240:243], a[224:227], v[40:43], v[240:243]
    v_exp_f32 v24, v24
    v_mfma_f32_16x16x32_bf16 v[240:243], a[228:231], v[44:47], v[240:243]
    ds_read_b64_tr_b16 a[200:201], v2 offset:36896
    v_cvt_pk_bf16_f32 v35, v22, v23
    v_mfma_f32_16x16x32_bf16 v[244:247], a[232:235], v[40:43], v[244:247]
    v_exp_f32 v25, v25
    v_mfma_f32_16x16x32_bf16 v[244:247], a[236:239], v[44:47], v[244:247]
    ds_read_b64_tr_b16 a[202:203], v2 offset:37152
    v_mfma_f32_16x16x32_bf16 v[248:251], a[240:243], v[40:43], v[248:251]
    v_exp_f32 v26, v26
    v_mfma_f32_16x16x32_bf16 v[248:251], a[244:247], v[44:47], v[248:251]
    ds_read_b64_tr_b16 a[204:205], v2 offset:37408
    v_cvt_pk_bf16_f32 v36, v24, v25
    v_mfma_f32_16x16x32_bf16 v[252:255], a[248:251], v[40:43], v[252:255]
    v_exp_f32 v27, v27
    v_mfma_f32_16x16x32_bf16 v[252:255], a[252:255], v[44:47], v[252:255]
    ds_read_b64_tr_b16 a[206:207], v2 offset:37664
    v_smfmac_f32_16x16x64_bf16 a[12:15], a[16:19], v[40:47], v11
    ds_read_b64_tr_b16 a[208:209], v2 offset:36928
    v_mfma_f32_16x16x32_bf16 v[16:19], a[64:67], v[80:83], v[52:55]
    v_exp_f32 v28, v28
    v_mfma_f32_16x16x32_bf16 v[16:19], a[68:71], v[84:87], v[16:19]
    ds_read_b64_tr_b16 a[210:211], v2 offset:37184
    v_cvt_pk_bf16_f32 v37, v26, v27
    v_mfma_f32_16x16x32_bf16 v[16:19], a[72:75], v[88:91], v[16:19]
    v_exp_f32 v29, v29
    v_mfma_f32_16x16x32_bf16 v[16:19], a[76:79], v[92:95], v[16:19]
    ds_read_b64_tr_b16 a[212:213], v2 offset:37440
    v_mfma_f32_16x16x32_bf16 v[20:23], a[80:83], v[80:83], v[52:55]
    v_exp_f32 v30, v30
    v_mfma_f32_16x16x32_bf16 v[20:23], a[84:87], v[84:87], v[20:23]
    ds_read_b64_tr_b16 a[214:215], v2 offset:37696
    v_cvt_pk_bf16_f32 v38, v28, v29
    v_mfma_f32_16x16x32_bf16 v[20:23], a[88:91], v[88:91], v[20:23]
    v_exp_f32 v31, v31
    v_mfma_f32_16x16x32_bf16 v[20:23], a[92:95], v[92:95], v[20:23]
    ds_read_b64_tr_b16 a[216:217], v2 offset:36960
    v_mfma_f32_16x16x32_bf16 v[24:27], a[96:99], v[80:83], v[52:55]
    v_exp_f32 v16, v16
    v_mfma_f32_16x16x32_bf16 v[24:27], a[100:103], v[84:87], v[24:27]
    ds_read_b64_tr_b16 a[218:219], v2 offset:37216
    v_cvt_pk_bf16_f32 v39, v30, v31
    v_mfma_f32_16x16x32_bf16 v[24:27], a[104:107], v[88:91], v[24:27]
    v_exp_f32 v17, v17
    v_mfma_f32_16x16x32_bf16 v[24:27], a[108:111], v[92:95], v[24:27]
    ds_read_b64_tr_b16 a[220:221], v2 offset:37472
    v_mfma_f32_16x16x32_bf16 v[28:31], a[112:115], v[80:83], v[52:55]
    v_exp_f32 v18, v18
    v_mfma_f32_16x16x32_bf16 v[28:31], a[116:119], v[84:87], v[28:31]
    ds_read_b64_tr_b16 a[222:223], v2 offset:37728
    v_cvt_pk_bf16_f32 v40, v16, v17
    v_mfma_f32_16x16x32_bf16 v[28:31], a[120:123], v[88:91], v[28:31]
    v_exp_f32 v19, v19
    v_mfma_f32_16x16x32_bf16 v[28:31], a[124:127], v[92:95], v[28:31]
    ds_read_b64_tr_b16 a[224:225], v2 offset:36992
    v_mfma_f32_16x16x32_bf16 v[128:131], a[128:131], v[32:35], v[128:131]
    v_exp_f32 v20, v20
    v_mfma_f32_16x16x32_bf16 v[128:131], a[132:135], v[36:39], v[128:131]
    ds_read_b64_tr_b16 a[226:227], v2 offset:37248
    v_cvt_pk_bf16_f32 v41, v18, v19
    v_mfma_f32_16x16x32_bf16 v[132:135], a[136:139], v[32:35], v[132:135]
    v_exp_f32 v21, v21
    v_mfma_f32_16x16x32_bf16 v[132:135], a[140:143], v[36:39], v[132:135]
    ds_read_b64_tr_b16 a[228:229], v2 offset:37504
    v_mfma_f32_16x16x32_bf16 v[136:139], a[144:147], v[32:35], v[136:139]
    v_exp_f32 v22, v22
    v_mfma_f32_16x16x32_bf16 v[136:139], a[148:151], v[36:39], v[136:139]
    ds_read_b64_tr_b16 a[230:231], v2 offset:37760
    v_cvt_pk_bf16_f32 v42, v20, v21
    v_mfma_f32_16x16x32_bf16 v[140:143], a[152:155], v[32:35], v[140:143]
    v_exp_f32 v23, v23
    v_mfma_f32_16x16x32_bf16 v[140:143], a[156:159], v[36:39], v[140:143]
    ds_read_b64_tr_b16 a[232:233], v2 offset:37024
    v_mfma_f32_16x16x32_bf16 v[144:147], a[160:163], v[32:35], v[144:147]
    v_exp_f32 v24, v24
    v_mfma_f32_16x16x32_bf16 v[144:147], a[164:167], v[36:39], v[144:147]
    ds_read_b64_tr_b16 a[234:235], v2 offset:37280
    v_cvt_pk_bf16_f32 v43, v22, v23
    v_mfma_f32_16x16x32_bf16 v[148:151], a[168:171], v[32:35], v[148:151]
    v_exp_f32 v25, v25
    v_mfma_f32_16x16x32_bf16 v[148:151], a[172:175], v[36:39], v[148:151]
    ds_read_b64_tr_b16 a[236:237], v2 offset:37536
    v_mfma_f32_16x16x32_bf16 v[152:155], a[176:179], v[32:35], v[152:155]
    v_exp_f32 v26, v26
    v_mfma_f32_16x16x32_bf16 v[152:155], a[180:183], v[36:39], v[152:155]
    ds_read_b64_tr_b16 a[238:239], v2 offset:37792
    v_cvt_pk_bf16_f32 v44, v24, v25
    v_mfma_f32_16x16x32_bf16 v[156:159], a[184:187], v[32:35], v[156:159]
    v_exp_f32 v27, v27
    v_mfma_f32_16x16x32_bf16 v[156:159], a[188:191], v[36:39], v[156:159]
    ds_read_b64_tr_b16 a[240:241], v2 offset:37056
    v_smfmac_f32_16x16x64_bf16 a[0:3], a[16:19], v[32:39], v11
    ds_read_b64_tr_b16 a[242:243], v2 offset:37312
    v_mfma_f32_16x16x32_bf16 v[16:19], a[64:67], v[96:99], v[56:59]
    v_exp_f32 v28, v28
    v_mfma_f32_16x16x32_bf16 v[16:19], a[68:71], v[100:103], v[16:19]
    ds_read_b64_tr_b16 a[244:245], v2 offset:37568
    v_cvt_pk_bf16_f32 v45, v26, v27
    v_mfma_f32_16x16x32_bf16 v[16:19], a[72:75], v[104:107], v[16:19]
    v_exp_f32 v29, v29
    v_mfma_f32_16x16x32_bf16 v[16:19], a[76:79], v[108:111], v[16:19]
    ds_read_b64_tr_b16 a[246:247], v2 offset:37824
    v_mfma_f32_16x16x32_bf16 v[20:23], a[80:83], v[96:99], v[56:59]
    v_exp_f32 v30, v30
    v_mfma_f32_16x16x32_bf16 v[20:23], a[84:87], v[100:103], v[20:23]
    ds_read_b64_tr_b16 a[248:249], v2 offset:37088
    v_cvt_pk_bf16_f32 v46, v28, v29
    v_mfma_f32_16x16x32_bf16 v[20:23], a[88:91], v[104:107], v[20:23]
    v_exp_f32 v31, v31
    v_mfma_f32_16x16x32_bf16 v[20:23], a[92:95], v[108:111], v[20:23]
    ds_read_b64_tr_b16 a[250:251], v2 offset:37344
    v_mfma_f32_16x16x32_bf16 v[24:27], a[96:99], v[96:99], v[56:59]
    v_exp_f32 v16, v16
    v_mfma_f32_16x16x32_bf16 v[24:27], a[100:103], v[100:103], v[24:27]
    ds_read_b64_tr_b16 a[252:253], v2 offset:37600
    v_cvt_pk_bf16_f32 v47, v30, v31
    v_mfma_f32_16x16x32_bf16 v[24:27], a[104:107], v[104:107], v[24:27]
    v_exp_f32 v17, v17
    v_mfma_f32_16x16x32_bf16 v[24:27], a[108:111], v[108:111], v[24:27]
    ds_read_b64_tr_b16 a[254:255], v2 offset:37856
    v_mfma_f32_16x16x32_bf16 v[28:31], a[112:115], v[96:99], v[56:59]
    v_exp_f32 v18, v18
    v_mfma_f32_16x16x32_bf16 v[28:31], a[116:119], v[100:103], v[28:31]
    v_cvt_pk_bf16_f32 v32, v16, v17
    v_mfma_f32_16x16x32_bf16 v[28:31], a[120:123], v[104:107], v[28:31]
    v_exp_f32 v19, v19
    v_mfma_f32_16x16x32_bf16 v[28:31], a[124:127], v[108:111], v[28:31]
    v_mfma_f32_16x16x32_bf16 v[160:163], a[128:131], v[40:43], v[160:163]
    v_exp_f32 v20, v20
    v_mfma_f32_16x16x32_bf16 v[160:163], a[132:135], v[44:47], v[160:163]
    v_cvt_pk_bf16_f32 v33, v18, v19
    v_mfma_f32_16x16x32_bf16 v[164:167], a[136:139], v[40:43], v[164:167]
    v_exp_f32 v21, v21
    v_mfma_f32_16x16x32_bf16 v[164:167], a[140:143], v[44:47], v[164:167]
    v_mfma_f32_16x16x32_bf16 v[168:171], a[144:147], v[40:43], v[168:171]
    v_exp_f32 v22, v22
    v_mfma_f32_16x16x32_bf16 v[168:171], a[148:151], v[44:47], v[168:171]
    v_cvt_pk_bf16_f32 v34, v20, v21
    v_mfma_f32_16x16x32_bf16 v[172:175], a[152:155], v[40:43], v[172:175]
    v_exp_f32 v23, v23
    v_mfma_f32_16x16x32_bf16 v[172:175], a[156:159], v[44:47], v[172:175]
    v_mfma_f32_16x16x32_bf16 v[176:179], a[160:163], v[40:43], v[176:179]
    v_exp_f32 v24, v24
    v_mfma_f32_16x16x32_bf16 v[176:179], a[164:167], v[44:47], v[176:179]
    v_cvt_pk_bf16_f32 v35, v22, v23
    v_mfma_f32_16x16x32_bf16 v[180:183], a[168:171], v[40:43], v[180:183]
    v_exp_f32 v25, v25
    v_mfma_f32_16x16x32_bf16 v[180:183], a[172:175], v[44:47], v[180:183]
    v_mfma_f32_16x16x32_bf16 v[184:187], a[176:179], v[40:43], v[184:187]
    v_exp_f32 v26, v26
    v_mfma_f32_16x16x32_bf16 v[184:187], a[180:183], v[44:47], v[184:187]
    v_cvt_pk_bf16_f32 v36, v24, v25
    v_mfma_f32_16x16x32_bf16 v[188:191], a[184:187], v[40:43], v[188:191]
    v_exp_f32 v27, v27
    v_mfma_f32_16x16x32_bf16 v[188:191], a[188:191], v[44:47], v[188:191]
    v_smfmac_f32_16x16x64_bf16 a[4:7], a[16:19], v[40:47], v11
    v_mfma_f32_16x16x32_bf16 v[16:19], a[64:67], v[112:115], v[60:63]
    v_exp_f32 v28, v28
    v_mfma_f32_16x16x32_bf16 v[16:19], a[68:71], v[116:119], v[16:19]
    ds_read_b128 a[64:67], v1 offset:36864
    v_cvt_pk_bf16_f32 v37, v26, v27
    v_mfma_f32_16x16x32_bf16 v[16:19], a[72:75], v[120:123], v[16:19]
    v_exp_f32 v29, v29
    v_mfma_f32_16x16x32_bf16 v[16:19], a[76:79], v[124:127], v[16:19]
    ds_read_b128 a[68:71], v1 offset:36928
    v_mfma_f32_16x16x32_bf16 v[20:23], a[80:83], v[112:115], v[60:63]
    v_exp_f32 v30, v30
    v_mfma_f32_16x16x32_bf16 v[20:23], a[84:87], v[116:119], v[20:23]
    ds_read_b128 a[72:75], v1 offset:36992
    v_cvt_pk_bf16_f32 v38, v28, v29
    v_mfma_f32_16x16x32_bf16 v[20:23], a[88:91], v[120:123], v[20:23]
    v_exp_f32 v31, v31
    v_mfma_f32_16x16x32_bf16 v[20:23], a[92:95], v[124:127], v[20:23]
    ds_read_b128 a[76:79], v1 offset:37056
    v_mfma_f32_16x16x32_bf16 v[24:27], a[96:99], v[112:115], v[60:63]
    v_exp_f32 v16, v16
    v_mfma_f32_16x16x32_bf16 v[24:27], a[100:103], v[116:119], v[24:27]
    ds_read_b128 a[80:83], v1 offset:37120
    v_cvt_pk_bf16_f32 v39, v30, v31
    v_mfma_f32_16x16x32_bf16 v[24:27], a[104:107], v[120:123], v[24:27]
    v_exp_f32 v17, v17
    v_mfma_f32_16x16x32_bf16 v[24:27], a[108:111], v[124:127], v[24:27]
    ds_read_b128 a[84:87], v1 offset:37184
    v_mfma_f32_16x16x32_bf16 v[28:31], a[112:115], v[112:115], v[60:63]
    v_exp_f32 v18, v18
    v_mfma_f32_16x16x32_bf16 v[28:31], a[116:119], v[116:119], v[28:31]
    ds_read_b128 a[88:91], v1 offset:37248
    v_cvt_pk_bf16_f32 v40, v16, v17
    v_mfma_f32_16x16x32_bf16 v[28:31], a[120:123], v[120:123], v[28:31]
    v_exp_f32 v19, v19
    v_mfma_f32_16x16x32_bf16 v[28:31], a[124:127], v[124:127], v[28:31]
    ds_read_b128 a[92:95], v1 offset:37312
    v_mfma_f32_16x16x32_bf16 v[192:195], a[128:131], v[32:35], v[192:195]
L2_pad7:
    s_cbranch_execz L2_pad11
    v_exp_f32 v20, v20
    v_mfma_f32_16x16x32_bf16 v[192:195], a[132:135], v[36:39], v[192:195]
    ds_read_b128 a[96:99], v1 offset:37376
    v_cvt_pk_bf16_f32 v41, v18, v19
    v_mfma_f32_16x16x32_bf16 v[196:199], a[136:139], v[32:35], v[196:199]
    v_exp_f32 v21, v21
    v_mfma_f32_16x16x32_bf16 v[196:199], a[140:143], v[36:39], v[196:199]
    ds_read_b128 a[100:103], v1 offset:37440
    v_mfma_f32_16x16x32_bf16 v[200:203], a[144:147], v[32:35], v[200:203]
    v_exp_f32 v22, v22
    v_mfma_f32_16x16x32_bf16 v[200:203], a[148:151], v[36:39], v[200:203]
    ds_read_b128 a[104:107], v1 offset:37504
    v_cvt_pk_bf16_f32 v42, v20, v21
    v_mfma_f32_16x16x32_bf16 v[204:207], a[152:155], v[32:35], v[204:207]
    v_exp_f32 v23, v23
    v_mfma_f32_16x16x32_bf16 v[204:207], a[156:159], v[36:39], v[204:207]
    ds_read_b128 a[108:111], v1 offset:37568
    v_mfma_f32_16x16x32_bf16 v[208:211], a[160:163], v[32:35], v[208:211]
    v_exp_f32 v24, v24
    v_mfma_f32_16x16x32_bf16 v[208:211], a[164:167], v[36:39], v[208:211]
    ds_read_b128 a[112:115], v1 offset:37632
    v_cvt_pk_bf16_f32 v43, v22, v23
    v_mfma_f32_16x16x32_bf16 v[212:215], a[168:171], v[32:35], v[212:215]
    v_exp_f32 v25, v25
    v_mfma_f32_16x16x32_bf16 v[212:215], a[172:175], v[36:39], v[212:215]
    ds_read_b128 a[116:119], v1 offset:37696
    v_mfma_f32_16x16x32_bf16 v[216:219], a[176:179], v[32:35], v[216:219]
    v_exp_f32 v26, v26
    v_mfma_f32_16x16x32_bf16 v[216:219], a[180:183], v[36:39], v[216:219]
    ds_read_b128 a[120:123], v1 offset:37760
    v_cvt_pk_bf16_f32 v44, v24, v25
    v_mfma_f32_16x16x32_bf16 v[220:223], a[184:187], v[32:35], v[220:223]
    v_exp_f32 v27, v27
    v_mfma_f32_16x16x32_bf16 v[220:223], a[188:191], v[36:39], v[220:223]
    ds_read_b128 a[124:127], v1 offset:37824
    v_smfmac_f32_16x16x64_bf16 a[8:11], a[16:19], v[32:39], v11
    s_waitcnt lgkmcnt(12)
    v_mfma_f32_16x16x32_bf16 v[16:19], a[64:67], v[64:67], v[48:51]
    s_sub_u32 s47, s47, s48
    v_exp_f32 v28, v28
    v_mfma_f32_16x16x32_bf16 v[16:19], a[68:71], v[68:71], v[16:19]
    v_cvt_pk_bf16_f32 v45, v26, v27
    v_add_u32 v1, s48, v1
    v_mfma_f32_16x16x32_bf16 v[16:19], a[72:75], v[72:75], v[16:19]
    v_exp_f32 v29, v29
    v_mfma_f32_16x16x32_bf16 v[16:19], a[76:79], v[76:79], v[16:19]
    s_waitcnt lgkmcnt(8)
    v_mfma_f32_16x16x32_bf16 v[20:23], a[80:83], v[64:67], v[48:51]
    v_exp_f32 v30, v30
    v_mfma_f32_16x16x32_bf16 v[20:23], a[84:87], v[68:71], v[20:23]
    v_cvt_pk_bf16_f32 v46, v28, v29
    v_add_u32 v2, s48, v2
    v_mfma_f32_16x16x32_bf16 v[20:23], a[88:91], v[72:75], v[20:23]
    v_exp_f32 v31, v31
    v_mfma_f32_16x16x32_bf16 v[20:23], a[92:95], v[76:79], v[20:23]
    s_waitcnt lgkmcnt(4)
    v_mfma_f32_16x16x32_bf16 v[24:27], a[96:99], v[64:67], v[48:51]
    s_sub_u32 s48, 0, s48
    v_exp_f32 v16, v16
    v_mfma_f32_16x16x32_bf16 v[24:27], a[100:103], v[68:71], v[24:27]
    v_cvt_pk_bf16_f32 v47, v30, v31
    v_mfma_f32_16x16x32_bf16 v[24:27], a[104:107], v[72:75], v[24:27]
    v_exp_f32 v17, v17
    v_mfma_f32_16x16x32_bf16 v[24:27], a[108:111], v[76:79], v[24:27]
    s_waitcnt lgkmcnt(0)
    v_mfma_f32_16x16x32_bf16 v[28:31], a[112:115], v[64:67], v[48:51]
    v_exp_f32 v18, v18
    v_mfma_f32_16x16x32_bf16 v[28:31], a[116:119], v[68:71], v[28:31]
    v_cvt_pk_bf16_f32 v32, v16, v17
    v_mfma_f32_16x16x32_bf16 v[28:31], a[120:123], v[72:75], v[28:31]
    v_exp_f32 v19, v19
    v_mfma_f32_16x16x32_bf16 v[28:31], a[124:127], v[76:79], v[28:31]
    s_waitcnt vmcnt(2)
    s_barrier
    v_mfma_f32_16x16x32_bf16 v[224:227], a[128:131], v[40:43], v[224:227]
    v_exp_f32 v20, v20
    v_mfma_f32_16x16x32_bf16 v[224:227], a[132:135], v[44:47], v[224:227]
    ds_read_b64_tr_b16 a[128:129], v2 offset:0
    v_cvt_pk_bf16_f32 v33, v18, v19
    v_mfma_f32_16x16x32_bf16 v[228:231], a[136:139], v[40:43], v[228:231]
    s_add_u32 m0, s47, 0
    v_exp_f32 v21, v21
    v_mfma_f32_16x16x32_bf16 v[228:231], a[140:143], v[44:47], v[228:231]
    s_add_u32 s46, s46, 16384
    buffer_load_dwordx4 v5, s[16:19], s46 offen offset:0 lds
    v_mfma_f32_16x16x32_bf16 v[232:235], a[144:147], v[40:43], v[232:235]
    v_exp_f32 v22, v22
    v_mfma_f32_16x16x32_bf16 v[232:235], a[148:151], v[44:47], v[232:235]
    ds_read_b64_tr_b16 a[130:131], v2 offset:256
    v_cvt_pk_bf16_f32 v34, v20, v21
    v_mfma_f32_16x16x32_bf16 v[236:239], a[152:155], v[40:43], v[236:239]
    s_add_u32 m0, s47, 32
    v_exp_f32 v23, v23
    v_mfma_f32_16x16x32_bf16 v[236:239], a[156:159], v[44:47], v[236:239]
    buffer_load_dwordx4 v5, s[16:19], s46 offen offset:1024 lds
    v_mfma_f32_16x16x32_bf16 v[240:243], a[160:163], v[40:43], v[240:243]
    v_exp_f32 v24, v24
    v_mfma_f32_16x16x32_bf16 v[240:243], a[164:167], v[44:47], v[240:243]
    ds_read_b64_tr_b16 a[132:133], v2 offset:512
    v_cvt_pk_bf16_f32 v35, v22, v23
    v_mfma_f32_16x16x32_bf16 v[244:247], a[168:171], v[40:43], v[244:247]
    s_add_u32 m0, s47, 64
    v_exp_f32 v25, v25
    v_mfma_f32_16x16x32_bf16 v[244:247], a[172:175], v[44:47], v[244:247]
    buffer_load_dwordx4 v5, s[16:19], s46 offen offset:2048 lds
    v_mfma_f32_16x16x32_bf16 v[248:251], a[176:179], v[40:43], v[248:251]
    v_exp_f32 v26, v26
    v_mfma_f32_16x16x32_bf16 v[248:251], a[180:183], v[44:47], v[248:251]
    ds_read_b64_tr_b16 a[134:135], v2 offset:768
    v_cvt_pk_bf16_f32 v36, v24, v25
    v_mfma_f32_16x16x32_bf16 v[252:255], a[184:187], v[40:43], v[252:255]
    s_add_u32 m0, s47, 96
    v_exp_f32 v27, v27
    v_mfma_f32_16x16x32_bf16 v[252:255], a[188:191], v[44:47], v[252:255]
    buffer_load_dwordx4 v5, s[16:19], s46 offen offset:3072 lds
    v_smfmac_f32_16x16x64_bf16 a[12:15], a[16:19], v[40:47], v11
    ds_read_b64_tr_b16 a[136:137], v2 offset:32
    v_mfma_f32_16x16x32_bf16 v[16:19], a[64:67], v[80:83], v[52:55]
    v_exp_f32 v28, v28
    v_mfma_f32_16x16x32_bf16 v[16:19], a[68:71], v[84:87], v[16:19]
    ds_read_b64_tr_b16 a[138:139], v2 offset:288
    v_cvt_pk_bf16_f32 v37, v26, v27
    v_mfma_f32_16x16x32_bf16 v[16:19], a[72:75], v[88:91], v[16:19]
    s_add_u32 m0, s47, 16896
    v_exp_f32 v29, v29
    v_mfma_f32_16x16x32_bf16 v[16:19], a[76:79], v[92:95], v[16:19]
    buffer_load_dwordx4 v5, s[20:23], s46 offen offset:0 lds
    v_mfma_f32_16x16x32_bf16 v[20:23], a[80:83], v[80:83], v[52:55]
    v_exp_f32 v30, v30
    v_mfma_f32_16x16x32_bf16 v[20:23], a[84:87], v[84:87], v[20:23]
    ds_read_b64_tr_b16 a[140:141], v2 offset:544
    v_cvt_pk_bf16_f32 v38, v28, v29
    v_mfma_f32_16x16x32_bf16 v[20:23], a[88:91], v[88:91], v[20:23]
    s_add_u32 m0, s47, 16928
    v_exp_f32 v31, v31
    v_mfma_f32_16x16x32_bf16 v[20:23], a[92:95], v[92:95], v[20:23]
    buffer_load_dwordx4 v5, s[20:23], s46 offen offset:1024 lds
    v_mfma_f32_16x16x32_bf16 v[24:27], a[96:99], v[80:83], v[52:55]
    v_exp_f32 v16, v16
    v_mfma_f32_16x16x32_bf16 v[24:27], a[100:103], v[84:87], v[24:27]
    ds_read_b64_tr_b16 a[142:143], v2 offset:800
    v_cvt_pk_bf16_f32 v39, v30, v31
    v_mfma_f32_16x16x32_bf16 v[24:27], a[104:107], v[88:91], v[24:27]
    s_add_u32 m0, s47, 16960
    v_exp_f32 v17, v17
    v_mfma_f32_16x16x32_bf16 v[24:27], a[108:111], v[92:95], v[24:27]
    buffer_load_dwordx4 v5, s[20:23], s46 offen offset:2048 lds
    v_mfma_f32_16x16x32_bf16 v[28:31], a[112:115], v[80:83], v[52:55]
    v_exp_f32 v18, v18
    v_mfma_f32_16x16x32_bf16 v[28:31], a[116:119], v[84:87], v[28:31]
    ds_read_b64_tr_b16 a[144:145], v2 offset:64
    v_cvt_pk_bf16_f32 v40, v16, v17
    v_mfma_f32_16x16x32_bf16 v[28:31], a[120:123], v[88:91], v[28:31]
    s_add_u32 m0, s47, 16992
    v_exp_f32 v19, v19
    v_mfma_f32_16x16x32_bf16 v[28:31], a[124:127], v[92:95], v[28:31]
    buffer_load_dwordx4 v5, s[20:23], s46 offen offset:3072 lds
    v_mfma_f32_16x16x32_bf16 v[128:131], a[192:195], v[32:35], v[128:131]
    v_exp_f32 v20, v20
    v_mfma_f32_16x16x32_bf16 v[128:131], a[196:199], v[36:39], v[128:131]
    ds_read_b64_tr_b16 a[146:147], v2 offset:320
    v_cvt_pk_bf16_f32 v41, v18, v19
    v_mfma_f32_16x16x32_bf16 v[132:135], a[200:203], v[32:35], v[132:135]
    v_exp_f32 v21, v21
    v_mfma_f32_16x16x32_bf16 v[132:135], a[204:207], v[36:39], v[132:135]
    ds_read_b64_tr_b16 a[148:149], v2 offset:576
    v_mfma_f32_16x16x32_bf16 v[136:139], a[208:211], v[32:35], v[136:139]
    v_exp_f32 v22, v22
    v_mfma_f32_16x16x32_bf16 v[136:139], a[212:215], v[36:39], v[136:139]
    ds_read_b64_tr_b16 a[150:151], v2 offset:832
    v_cvt_pk_bf16_f32 v42, v20, v21
    v_mfma_f32_16x16x32_bf16 v[140:143], a[216:219], v[32:35], v[140:143]
    v_exp_f32 v23, v23
    v_mfma_f32_16x16x32_bf16 v[140:143], a[220:223], v[36:39], v[140:143]
    ds_read_b64_tr_b16 a[152:153], v2 offset:96
    ds_read_b64_tr_b16 a[154:155], v2 offset:352
    v_mfma_f32_16x16x32_bf16 v[144:147], a[224:227], v[32:35], v[144:147]
    v_exp_f32 v24, v24
    v_mfma_f32_16x16x32_bf16 v[144:147], a[228:231], v[36:39], v[144:147]
    ds_read_b64_tr_b16 a[156:157], v2 offset:608
    v_cvt_pk_bf16_f32 v43, v22, v23
    v_mfma_f32_16x16x32_bf16 v[148:151], a[232:235], v[32:35], v[148:151]
    v_exp_f32 v25, v25
    v_mfma_f32_16x16x32_bf16 v[148:151], a[236:239], v[36:39], v[148:151]
    ds_read_b64_tr_b16 a[158:159], v2 offset:864
    ds_read_b64_tr_b16 a[160:161], v2 offset:128
    v_mfma_f32_16x16x32_bf16 v[152:155], a[240:243], v[32:35], v[152:155]
    v_exp_f32 v26, v26
    v_mfma_f32_16x16x32_bf16 v[152:155], a[244:247], v[36:39], v[152:155]
    ds_read_b64_tr_b16 a[162:163], v2 offset:384
    v_cvt_pk_bf16_f32 v44, v24, v25
    v_mfma_f32_16x16x32_bf16 v[156:159], a[248:251], v[32:35], v[156:159]
    v_exp_f32 v27, v27
    v_mfma_f32_16x16x32_bf16 v[156:159], a[252:255], v[36:39], v[156:159]
    ds_read_b64_tr_b16 a[164:165], v2 offset:640
    ds_read_b64_tr_b16 a[166:167], v2 offset:896
    v_smfmac_f32_16x16x64_bf16 a[0:3], a[16:19], v[32:39], v11
    ds_read_b64_tr_b16 a[168:169], v2 offset:160
    ds_read_b64_tr_b16 a[170:171], v2 offset:416
    v_mfma_f32_16x16x32_bf16 v[16:19], a[64:67], v[96:99], v[56:59]
    v_exp_f32 v28, v28
    v_mfma_f32_16x16x32_bf16 v[16:19], a[68:71], v[100:103], v[16:19]
    ds_read_b64_tr_b16 a[172:173], v2 offset:672
    v_cvt_pk_bf16_f32 v45, v26, v27
    v_mfma_f32_16x16x32_bf16 v[16:19], a[72:75], v[104:107], v[16:19]
    s_add_u32 m0, s47, 36864
    v_exp_f32 v29, v29
    v_mfma_f32_16x16x32_bf16 v[16:19], a[76:79], v[108:111], v[16:19]
    s_add_u32 s46, s46, 16384
    buffer_load_dwordx4 v5, s[16:19], s46 offen offset:0 lds
    v_mfma_f32_16x16x32_bf16 v[20:23], a[80:83], v[96:99], v[56:59]
    v_exp_f32 v30, v30
    v_mfma_f32_16x16x32_bf16 v[20:23], a[84:87], v[100:103], v[20:23]
    ds_read_b64_tr_b16 a[174:175], v2 offset:928
    v_cvt_pk_bf16_f32 v46, v28, v29
    v_mfma_f32_16x16x32_bf16 v[20:23], a[88:91], v[104:107], v[20:23]
    s_add_u32 m0, s47, 36896
    v_exp_f32 v31, v31
    v_mfma_f32_16x16x32_bf16 v[20:23], a[92:95], v[108:111], v[20:23]
    buffer_load_dwordx4 v5, s[16:19], s46 offen offset:1024 lds
    v_mfma_f32_16x16x32_bf16 v[24:27], a[96:99], v[96:99], v[56:59]
    v_exp_f32 v16, v16
    v_mfma_f32_16x16x32_bf16 v[24:27], a[100:103], v[100:103], v[24:27]
    ds_read_b64_tr_b16 a[176:177], v2 offset:192
    v_cvt_pk_bf16_f32 v47, v30, v31
    v_mfma_f32_16x16x32_bf16 v[24:27], a[104:107], v[104:107], v[24:27]
    s_add_u32 m0, s47, 36928
    v_exp_f32 v17, v17
    v_mfma_f32_16x16x32_bf16 v[24:27], a[108:111], v[108:111], v[24:27]
    buffer_load_dwordx4 v5, s[16:19], s46 offen offset:2048 lds
    v_mfma_f32_16x16x32_bf16 v[28:31], a[112:115], v[96:99], v[56:59]
    v_exp_f32 v18, v18
    v_mfma_f32_16x16x32_bf16 v[28:31], a[116:119], v[100:103], v[28:31]
    ds_read_b64_tr_b16 a[178:179], v2 offset:448
    v_cvt_pk_bf16_f32 v32, v16, v17
    v_mfma_f32_16x16x32_bf16 v[28:31], a[120:123], v[104:107], v[28:31]
    s_add_u32 m0, s47, 36960
    v_exp_f32 v19, v19
    v_mfma_f32_16x16x32_bf16 v[28:31], a[124:127], v[108:111], v[28:31]
    buffer_load_dwordx4 v5, s[16:19], s46 offen offset:3072 lds
    v_mfma_f32_16x16x32_bf16 v[160:163], a[192:195], v[40:43], v[160:163]
    v_exp_f32 v20, v20
    v_mfma_f32_16x16x32_bf16 v[160:163], a[196:199], v[44:47], v[160:163]
    ds_read_b64_tr_b16 a[180:181], v2 offset:704
    v_cvt_pk_bf16_f32 v33, v18, v19
    v_mfma_f32_16x16x32_bf16 v[164:167], a[200:203], v[40:43], v[164:167]
    s_add_u32 m0, s47, 53760
    v_exp_f32 v21, v21
    v_mfma_f32_16x16x32_bf16 v[164:167], a[204:207], v[44:47], v[164:167]
    buffer_load_dwordx4 v5, s[20:23], s46 offen offset:0 lds
    v_mfma_f32_16x16x32_bf16 v[168:171], a[208:211], v[40:43], v[168:171]
    v_exp_f32 v22, v22
    v_mfma_f32_16x16x32_bf16 v[168:171], a[212:215], v[44:47], v[168:171]
    ds_read_b64_tr_b16 a[182:183], v2 offset:960
    v_cvt_pk_bf16_f32 v34, v20, v21
    v_mfma_f32_16x16x32_bf16 v[172:175], a[216:219], v[40:43], v[172:175]
    s_add_u32 m0, s47, 53792
    v_exp_f32 v23, v23
    v_mfma_f32_16x16x32_bf16 v[172:175], a[220:223], v[44:47], v[172:175]
    buffer_load_dwordx4 v5, s[20:23], s46 offen offset:1024 lds
    v_mfma_f32_16x16x32_bf16 v[176:179], a[224:227], v[40:43], v[176:179]
    v_exp_f32 v24, v24
    v_mfma_f32_16x16x32_bf16 v[176:179], a[228:231], v[44:47], v[176:179]
    ds_read_b64_tr_b16 a[184:185], v2 offset:224
    v_cvt_pk_bf16_f32 v35, v22, v23
    v_mfma_f32_16x16x32_bf16 v[180:183], a[232:235], v[40:43], v[180:183]
    s_add_u32 m0, s47, 53824
    v_exp_f32 v25, v25
    v_mfma_f32_16x16x32_bf16 v[180:183], a[236:239], v[44:47], v[180:183]
    buffer_load_dwordx4 v5, s[20:23], s46 offen offset:2048 lds
    v_mfma_f32_16x16x32_bf16 v[184:187], a[240:243], v[40:43], v[184:187]
    v_exp_f32 v26, v26
    v_mfma_f32_16x16x32_bf16 v[184:187], a[244:247], v[44:47], v[184:187]
    ds_read_b64_tr_b16 a[186:187], v2 offset:480
    v_cvt_pk_bf16_f32 v36, v24, v25
    v_mfma_f32_16x16x32_bf16 v[188:191], a[248:251], v[40:43], v[188:191]
    s_add_u32 m0, s47, 53856
    v_exp_f32 v27, v27
    v_mfma_f32_16x16x32_bf16 v[188:191], a[252:255], v[44:47], v[188:191]
    buffer_load_dwordx4 v5, s[20:23], s46 offen offset:3072 lds
    v_smfmac_f32_16x16x64_bf16 a[4:7], a[16:19], v[40:47], v11
    ds_read_b64_tr_b16 a[188:189], v2 offset:736
    ds_read_b64_tr_b16 a[190:191], v2 offset:992
    v_mfma_f32_16x16x32_bf16 v[16:19], a[64:67], v[112:115], v[60:63]
    v_exp_f32 v28, v28
    v_mfma_f32_16x16x32_bf16 v[16:19], a[68:71], v[116:119], v[16:19]
    ds_read_b128 a[64:67], v1 offset:0
    v_cvt_pk_bf16_f32 v37, v26, v27
    v_mfma_f32_16x16x32_bf16 v[16:19], a[72:75], v[120:123], v[16:19]
    v_exp_f32 v29, v29
    v_mfma_f32_16x16x32_bf16 v[16:19], a[76:79], v[124:127], v[16:19]
    ds_read_b128 a[68:71], v1 offset:64
    v_mfma_f32_16x16x32_bf16 v[20:23], a[80:83], v[112:115], v[60:63]
    v_exp_f32 v30, v30
    v_mfma_f32_16x16x32_bf16 v[20:23], a[84:87], v[116:119], v[20:23]
    ds_read_b128 a[72:75], v1 offset:128
    v_cvt_pk_bf16_f32 v38, v28, v29
    v_mfma_f32_16x16x32_bf16 v[20:23], a[88:91], v[120:123], v[20:23]
    v_exp_f32 v31, v31
    v_mfma_f32_16x16x32_bf16 v[20:23], a[92:95], v[124:127], v[20:23]
    ds_read_b128 a[76:79], v1 offset:192
    v_mfma_f32_16x16x32_bf16 v[24:27], a[96:99], v[112:115], v[60:63]
    v_exp_f32 v16, v16
    v_mfma_f32_16x16x32_bf16 v[24:27], a[100:103], v[116:119], v[24:27]
    ds_read_b128 a[80:83], v1 offset:256
    v_cvt_pk_bf16_f32 v39, v30, v31
    v_mfma_f32_16x16x32_bf16 v[24:27], a[104:107], v[120:123], v[24:27]
    v_exp_f32 v17, v17
    v_mfma_f32_16x16x32_bf16 v[24:27], a[108:111], v[124:127], v[24:27]
    ds_read_b128 a[84:87], v1 offset:320
    v_mfma_f32_16x16x32_bf16 v[28:31], a[112:115], v[112:115], v[60:63]
    v_exp_f32 v18, v18
    v_mfma_f32_16x16x32_bf16 v[28:31], a[116:119], v[116:119], v[28:31]
    ds_read_b128 a[88:91], v1 offset:384
    v_cvt_pk_bf16_f32 v40, v16, v17
    v_mfma_f32_16x16x32_bf16 v[28:31], a[120:123], v[120:123], v[28:31]
    v_exp_f32 v19, v19
    v_mfma_f32_16x16x32_bf16 v[28:31], a[124:127], v[124:127], v[28:31]
    ds_read_b128 a[92:95], v1 offset:448
    v_mfma_f32_16x16x32_bf16 v[192:195], a[192:195], v[32:35], v[192:195]
    v_exp_f32 v20, v20
    v_mfma_f32_16x16x32_bf16 v[192:195], a[196:199], v[36:39], v[192:195]
    ds_read_b128 a[96:99], v1 offset:512
    v_cvt_pk_bf16_f32 v41, v18, v19
    v_mfma_f32_16x16x32_bf16 v[196:199], a[200:203], v[32:35], v[196:199]
    v_exp_f32 v21, v21
    v_mfma_f32_16x16x32_bf16 v[196:199], a[204:207], v[36:39], v[196:199]
    ds_read_b128 a[100:103], v1 offset:576
    v_mfma_f32_16x16x32_bf16 v[200:203], a[208:211], v[32:35], v[200:203]
    v_exp_f32 v22, v22
    v_mfma_f32_16x16x32_bf16 v[200:203], a[212:215], v[36:39], v[200:203]
    ds_read_b128 a[104:107], v1 offset:640
    v_cvt_pk_bf16_f32 v42, v20, v21
    v_mfma_f32_16x16x32_bf16 v[204:207], a[216:219], v[32:35], v[204:207]
    v_exp_f32 v23, v23
    v_mfma_f32_16x16x32_bf16 v[204:207], a[220:223], v[36:39], v[204:207]
    ds_read_b128 a[108:111], v1 offset:704
    v_mfma_f32_16x16x32_bf16 v[208:211], a[224:227], v[32:35], v[208:211]
    v_exp_f32 v24, v24
    v_mfma_f32_16x16x32_bf16 v[208:211], a[228:231], v[36:39], v[208:211]
    ds_read_b128 a[112:115], v1 offset:768
    v_cvt_pk_bf16_f32 v43, v22, v23
    v_mfma_f32_16x16x32_bf16 v[212:215], a[232:235], v[32:35], v[212:215]
    v_exp_f32 v25, v25
    v_mfma_f32_16x16x32_bf16 v[212:215], a[236:239], v[36:39], v[212:215]
    ds_read_b128 a[116:119], v1 offset:832
    v_mfma_f32_16x16x32_bf16 v[216:219], a[240:243], v[32:35], v[216:219]
    v_exp_f32 v26, v26
    v_mfma_f32_16x16x32_bf16 v[216:219], a[244:247], v[36:39], v[216:219]
    ds_read_b128 a[120:123], v1 offset:896
    v_cvt_pk_bf16_f32 v44, v24, v25
    v_mfma_f32_16x16x32_bf16 v[220:223], a[248:251], v[32:35], v[220:223]
    v_exp_f32 v27, v27
    v_mfma_f32_16x16x32_bf16 v[220:223], a[252:255], v[36:39], v[220:223]
    ds_read_b128 a[124:127], v1 offset:960
    v_smfmac_f32_16x16x64_bf16 a[8:11], a[16:19], v[32:39], v11
    s_waitcnt lgkmcnt(12)
    v_mfma_f32_16x16x32_bf16 v[16:19], a[64:67], v[64:67], v[48:51]
    v_exp_f32 v28, v28
    v_mfma_f32_16x16x32_bf16 v[16:19], a[68:71], v[68:71], v[16:19]
    v_cvt_pk_bf16_f32 v45, v26, v27
    v_mfma_f32_16x16x32_bf16 v[16:19], a[72:75], v[72:75], v[16:19]
    v_exp_f32 v29, v29
    v_mfma_f32_16x16x32_bf16 v[16:19], a[76:79], v[76:79], v[16:19]
    s_waitcnt lgkmcnt(8)
    global_load_dword a63, v13, s[8:9]
    v_mfma_f32_16x16x32_bf16 v[20:23], a[80:83], v[64:67], v[48:51]
    v_exp_f32 v30, v30
    v_mfma_f32_16x16x32_bf16 v[20:23], a[84:87], v[68:71], v[20:23]
    v_cvt_pk_bf16_f32 v46, v28, v29
    v_mfma_f32_16x16x32_bf16 v[20:23], a[88:91], v[72:75], v[20:23]
    v_exp_f32 v31, v31
    v_mfma_f32_16x16x32_bf16 v[20:23], a[92:95], v[76:79], v[20:23]
    s_waitcnt lgkmcnt(4)
    v_mfma_f32_16x16x32_bf16 v[24:27], a[96:99], v[64:67], v[48:51]
    v_exp_f32 v16, v16
    v_mfma_f32_16x16x32_bf16 v[24:27], a[100:103], v[68:71], v[24:27]
    v_cvt_pk_bf16_f32 v47, v30, v31
    v_mfma_f32_16x16x32_bf16 v[24:27], a[104:107], v[72:75], v[24:27]
    v_exp_f32 v17, v17
    v_mfma_f32_16x16x32_bf16 v[24:27], a[108:111], v[76:79], v[24:27]
    s_waitcnt lgkmcnt(0)
    buffer_load_dword a63, v9, s[36:39], 0 offen
    v_mfma_f32_16x16x32_bf16 v[28:31], a[112:115], v[64:67], v[48:51]
    v_exp_f32 v18, v18
    v_mfma_f32_16x16x32_bf16 v[28:31], a[116:119], v[68:71], v[28:31]
    v_cvt_pk_bf16_f32 v32, v16, v17
    v_mfma_f32_16x16x32_bf16 v[28:31], a[120:123], v[72:75], v[28:31]
    v_exp_f32 v19, v19
    v_mfma_f32_16x16x32_bf16 v[28:31], a[124:127], v[76:79], v[28:31]
    v_mfma_f32_16x16x32_bf16 v[224:227], a[192:195], v[40:43], v[224:227]
    v_exp_f32 v20, v20
    v_mfma_f32_16x16x32_bf16 v[224:227], a[196:199], v[44:47], v[224:227]
    ds_read_b64_tr_b16 a[192:193], v2 offset:36864
    v_cvt_pk_bf16_f32 v33, v18, v19
    v_mfma_f32_16x16x32_bf16 v[228:231], a[200:203], v[40:43], v[228:231]
    s_mov_b32 s54, 0
    v_exp_f32 v21, v21
    v_mfma_f32_16x16x32_bf16 v[228:231], a[204:207], v[44:47], v[228:231]
    buffer_load_dwordx4 a[20:23], v6, s[64:67], s54 offen
    v_mfma_f32_16x16x32_bf16 v[232:235], a[208:211], v[40:43], v[232:235]
    v_exp_f32 v22, v22
    v_mfma_f32_16x16x32_bf16 v[232:235], a[212:215], v[44:47], v[232:235]
    ds_read_b64_tr_b16 a[194:195], v2 offset:37120
    v_cvt_pk_bf16_f32 v34, v20, v21
    v_mfma_f32_16x16x32_bf16 v[236:239], a[216:219], v[40:43], v[236:239]
    v_exp_f32 v23, v23
    v_mfma_f32_16x16x32_bf16 v[236:239], a[220:223], v[44:47], v[236:239]
    ds_read_b64_tr_b16 a[196:197], v2 offset:37376
    v_mfma_f32_16x16x32_bf16 v[240:243], a[224:227], v[40:43], v[240:243]
    v_exp_f32 v24, v24
    v_mfma_f32_16x16x32_bf16 v[240:243], a[228:231], v[44:47], v[240:243]
    ds_read_b64_tr_b16 a[198:199], v2 offset:37632
    v_cvt_pk_bf16_f32 v35, v22, v23
    v_mfma_f32_16x16x32_bf16 v[244:247], a[232:235], v[40:43], v[244:247]
    s_mov_b32 s54, 147456
    v_exp_f32 v25, v25
    v_mfma_f32_16x16x32_bf16 v[244:247], a[236:239], v[44:47], v[244:247]
    buffer_load_dwordx4 a[24:27], v6, s[64:67], s54 offen
    v_mfma_f32_16x16x32_bf16 v[248:251], a[240:243], v[40:43], v[248:251]
    v_exp_f32 v26, v26
    v_mfma_f32_16x16x32_bf16 v[248:251], a[244:247], v[44:47], v[248:251]
    ds_read_b64_tr_b16 a[200:201], v2 offset:36896
    v_cvt_pk_bf16_f32 v36, v24, v25
    v_mfma_f32_16x16x32_bf16 v[252:255], a[248:251], v[40:43], v[252:255]
    v_exp_f32 v27, v27
    v_mfma_f32_16x16x32_bf16 v[252:255], a[252:255], v[44:47], v[252:255]
    ds_read_b64_tr_b16 a[202:203], v2 offset:37152
    v_smfmac_f32_16x16x64_bf16 a[12:15], a[16:19], v[40:47], v11
    ds_read_b64_tr_b16 a[204:205], v2 offset:37408
    v_mfma_f32_16x16x32_bf16 v[16:19], a[64:67], v[80:83], v[52:55]
    v_exp_f32 v28, v28
    v_mfma_f32_16x16x32_bf16 v[16:19], a[68:71], v[84:87], v[16:19]
    ds_read_b64_tr_b16 a[206:207], v2 offset:37664
    v_cvt_pk_bf16_f32 v37, v26, v27
    v_mfma_f32_16x16x32_bf16 v[16:19], a[72:75], v[88:91], v[16:19]
    s_mov_b32 s54, 294912
    v_exp_f32 v29, v29
    v_mfma_f32_16x16x32_bf16 v[16:19], a[76:79], v[92:95], v[16:19]
    buffer_load_dwordx4 a[28:31], v6, s[64:67], s54 offen
    v_mfma_f32_16x16x32_bf16 v[20:23], a[80:83], v[80:83], v[52:55]
    v_exp_f32 v30, v30
    v_mfma_f32_16x16x32_bf16 v[20:23], a[84:87], v[84:87], v[20:23]
    ds_read_b64_tr_b16 a[208:209], v2 offset:36928
    v_cvt_pk_bf16_f32 v38, v28, v29
    v_mfma_f32_16x16x32_bf16 v[20:23], a[88:91], v[88:91], v[20:23]
    v_exp_f32 v31, v31
    v_mfma_f32_16x16x32_bf16 v[20:23], a[92:95], v[92:95], v[20:23]
    ds_read_b64_tr_b16 a[210:211], v2 offset:37184
    v_mfma_f32_16x16x32_bf16 v[24:27], a[96:99], v[80:83], v[52:55]
    v_exp_f32 v16, v16
    v_mfma_f32_16x16x32_bf16 v[24:27], a[100:103], v[84:87], v[24:27]
    ds_read_b64_tr_b16 a[212:213], v2 offset:37440
    v_cvt_pk_bf16_f32 v39, v30, v31
    v_mfma_f32_16x16x32_bf16 v[24:27], a[104:107], v[88:91], v[24:27]
    s_mov_b32 s54, 442368
    v_exp_f32 v17, v17
    v_mfma_f32_16x16x32_bf16 v[24:27], a[108:111], v[92:95], v[24:27]
    buffer_load_dwordx4 a[32:35], v6, s[64:67], s54 offen
    v_mfma_f32_16x16x32_bf16 v[28:31], a[112:115], v[80:83], v[52:55]
    v_exp_f32 v18, v18
    v_mfma_f32_16x16x32_bf16 v[28:31], a[116:119], v[84:87], v[28:31]
    ds_read_b64_tr_b16 a[214:215], v2 offset:37696
    v_cvt_pk_bf16_f32 v40, v16, v17
    v_mfma_f32_16x16x32_bf16 v[28:31], a[120:123], v[88:91], v[28:31]
    v_exp_f32 v19, v19
    v_mfma_f32_16x16x32_bf16 v[28:31], a[124:127], v[92:95], v[28:31]
    ds_read_b64_tr_b16 a[216:217], v2 offset:36960
    v_mfma_f32_16x16x32_bf16 v[128:131], a[128:131], v[32:35], v[128:131]
    v_exp_f32 v20, v20
    v_mfma_f32_16x16x32_bf16 v[128:131], a[132:135], v[36:39], v[128:131]
    ds_read_b64_tr_b16 a[218:219], v2 offset:37216
    v_cvt_pk_bf16_f32 v41, v18, v19
    v_mfma_f32_16x16x32_bf16 v[132:135], a[136:139], v[32:35], v[132:135]
    s_mov_b32 s54, 589824
    v_exp_f32 v21, v21
    v_mfma_f32_16x16x32_bf16 v[132:135], a[140:143], v[36:39], v[132:135]
    buffer_load_dwordx4 a[36:39], v6, s[64:67], s54 offen
    v_mfma_f32_16x16x32_bf16 v[136:139], a[144:147], v[32:35], v[136:139]
    v_exp_f32 v22, v22
    v_mfma_f32_16x16x32_bf16 v[136:139], a[148:151], v[36:39], v[136:139]
    ds_read_b64_tr_b16 a[220:221], v2 offset:37472
    v_cvt_pk_bf16_f32 v42, v20, v21
    v_mfma_f32_16x16x32_bf16 v[140:143], a[152:155], v[32:35], v[140:143]
    v_exp_f32 v23, v23
    v_mfma_f32_16x16x32_bf16 v[140:143], a[156:159], v[36:39], v[140:143]
    ds_read_b64_tr_b16 a[222:223], v2 offset:37728
    v_mfma_f32_16x16x32_bf16 v[144:147], a[160:163], v[32:35], v[144:147]
    v_exp_f32 v24, v24
    v_mfma_f32_16x16x32_bf16 v[144:147], a[164:167], v[36:39], v[144:147]
    ds_read_b64_tr_b16 a[224:225], v2 offset:36992
    v_cvt_pk_bf16_f32 v43, v22, v23
    v_mfma_f32_16x16x32_bf16 v[148:151], a[168:171], v[32:35], v[148:151]
    v_exp_f32 v25, v25
    v_mfma_f32_16x16x32_bf16 v[148:151], a[172:175], v[36:39], v[148:151]
    ds_read_b64_tr_b16 a[226:227], v2 offset:37248
    v_mfma_f32_16x16x32_bf16 v[152:155], a[176:179], v[32:35], v[152:155]
    v_exp_f32 v26, v26
    v_mfma_f32_16x16x32_bf16 v[152:155], a[180:183], v[36:39], v[152:155]
    ds_read_b64_tr_b16 a[228:229], v2 offset:37504
    v_cvt_pk_bf16_f32 v44, v24, v25
    v_mfma_f32_16x16x32_bf16 v[156:159], a[184:187], v[32:35], v[156:159]
    v_exp_f32 v27, v27
    v_mfma_f32_16x16x32_bf16 v[156:159], a[188:191], v[36:39], v[156:159]
    ds_read_b64_tr_b16 a[230:231], v2 offset:37760
    v_smfmac_f32_16x16x64_bf16 a[0:3], a[16:19], v[32:39], v11
    ds_read_b64_tr_b16 a[232:233], v2 offset:37024
    v_mfma_f32_16x16x32_bf16 v[16:19], a[64:67], v[96:99], v[56:59]
    v_exp_f32 v28, v28
    v_mfma_f32_16x16x32_bf16 v[16:19], a[68:71], v[100:103], v[16:19]
    ds_read_b64_tr_b16 a[234:235], v2 offset:37280
    v_cvt_pk_bf16_f32 v45, v26, v27
    v_mfma_f32_16x16x32_bf16 v[16:19], a[72:75], v[104:107], v[16:19]
    v_exp_f32 v29, v29
    v_mfma_f32_16x16x32_bf16 v[16:19], a[76:79], v[108:111], v[16:19]
    ds_read_b64_tr_b16 a[236:237], v2 offset:37536
    v_mfma_f32_16x16x32_bf16 v[20:23], a[80:83], v[96:99], v[56:59]
    v_exp_f32 v30, v30
    v_mfma_f32_16x16x32_bf16 v[20:23], a[84:87], v[100:103], v[20:23]
    ds_read_b64_tr_b16 a[238:239], v2 offset:37792
    v_cvt_pk_bf16_f32 v46, v28, v29
    v_mfma_f32_16x16x32_bf16 v[20:23], a[88:91], v[104:107], v[20:23]
    v_exp_f32 v31, v31
    v_mfma_f32_16x16x32_bf16 v[20:23], a[92:95], v[108:111], v[20:23]
    ds_read_b64_tr_b16 a[240:241], v2 offset:37056
    v_mfma_f32_16x16x32_bf16 v[24:27], a[96:99], v[96:99], v[56:59]
    v_exp_f32 v16, v16
    v_mfma_f32_16x16x32_bf16 v[24:27], a[100:103], v[100:103], v[24:27]
    ds_read_b64_tr_b16 a[242:243], v2 offset:37312
    v_cvt_pk_bf16_f32 v47, v30, v31
    v_mfma_f32_16x16x32_bf16 v[24:27], a[104:107], v[104:107], v[24:27]
    v_exp_f32 v17, v17
    v_mfma_f32_16x16x32_bf16 v[24:27], a[108:111], v[108:111], v[24:27]
    ds_read_b64_tr_b16 a[244:245], v2 offset:37568
    v_mfma_f32_16x16x32_bf16 v[28:31], a[112:115], v[96:99], v[56:59]
    v_exp_f32 v18, v18
    v_mfma_f32_16x16x32_bf16 v[28:31], a[116:119], v[100:103], v[28:31]
    ds_read_b64_tr_b16 a[246:247], v2 offset:37824
    v_cvt_pk_bf16_f32 v32, v16, v17
    v_mfma_f32_16x16x32_bf16 v[28:31], a[120:123], v[104:107], v[28:31]
    v_exp_f32 v19, v19
    v_mfma_f32_16x16x32_bf16 v[28:31], a[124:127], v[108:111], v[28:31]
    ds_read_b64_tr_b16 a[248:249], v2 offset:37088
    v_mfma_f32_16x16x32_bf16 v[160:163], a[128:131], v[40:43], v[160:163]
    v_exp_f32 v20, v20
    v_mfma_f32_16x16x32_bf16 v[160:163], a[132:135], v[44:47], v[160:163]
    ds_read_b64_tr_b16 a[250:251], v2 offset:37344
    v_cvt_pk_bf16_f32 v33, v18, v19
    v_mfma_f32_16x16x32_bf16 v[164:167], a[136:139], v[40:43], v[164:167]
    v_exp_f32 v21, v21
    v_mfma_f32_16x16x32_bf16 v[164:167], a[140:143], v[44:47], v[164:167]
    ds_read_b64_tr_b16 a[252:253], v2 offset:37600
    v_mfma_f32_16x16x32_bf16 v[168:171], a[144:147], v[40:43], v[168:171]
    v_exp_f32 v22, v22
    v_mfma_f32_16x16x32_bf16 v[168:171], a[148:151], v[44:47], v[168:171]
    ds_read_b64_tr_b16 a[254:255], v2 offset:37856
    v_cvt_pk_bf16_f32 v34, v20, v21
    v_mfma_f32_16x16x32_bf16 v[172:175], a[152:155], v[40:43], v[172:175]
    v_exp_f32 v23, v23
    v_mfma_f32_16x16x32_bf16 v[172:175], a[156:159], v[44:47], v[172:175]
    v_mfma_f32_16x16x32_bf16 v[176:179], a[160:163], v[40:43], v[176:179]
    v_exp_f32 v24, v24
    v_mfma_f32_16x16x32_bf16 v[176:179], a[164:167], v[44:47], v[176:179]
    v_cvt_pk_bf16_f32 v35, v22, v23
    v_mfma_f32_16x16x32_bf16 v[180:183], a[168:171], v[40:43], v[180:183]
    v_exp_f32 v25, v25
    v_mfma_f32_16x16x32_bf16 v[180:183], a[172:175], v[44:47], v[180:183]
    v_mfma_f32_16x16x32_bf16 v[184:187], a[176:179], v[40:43], v[184:187]
    v_exp_f32 v26, v26
    v_mfma_f32_16x16x32_bf16 v[184:187], a[180:183], v[44:47], v[184:187]
    v_cvt_pk_bf16_f32 v36, v24, v25
    v_mfma_f32_16x16x32_bf16 v[188:191], a[184:187], v[40:43], v[188:191]
    v_exp_f32 v27, v27
    v_mfma_f32_16x16x32_bf16 v[188:191], a[188:191], v[44:47], v[188:191]
    v_smfmac_f32_16x16x64_bf16 a[4:7], a[16:19], v[40:47], v11
    v_mfma_f32_16x16x32_bf16 v[16:19], a[64:67], v[112:115], v[60:63]
    v_exp_f32 v28, v28
    v_mfma_f32_16x16x32_bf16 v[16:19], a[68:71], v[116:119], v[16:19]
    ds_read_b128 a[64:67], v1 offset:36864
    v_cvt_pk_bf16_f32 v37, v26, v27
    v_mfma_f32_16x16x32_bf16 v[16:19], a[72:75], v[120:123], v[16:19]
L2_pad8:
    s_cbranch_execz L2_pad12
    v_exp_f32 v29, v29
    v_mfma_f32_16x16x32_bf16 v[16:19], a[76:79], v[124:127], v[16:19]
    ds_read_b128 a[68:71], v1 offset:36928
    v_mfma_f32_16x16x32_bf16 v[20:23], a[80:83], v[112:115], v[60:63]
    v_exp_f32 v30, v30
    v_mfma_f32_16x16x32_bf16 v[20:23], a[84:87], v[116:119], v[20:23]
    ds_read_b128 a[72:75], v1 offset:36992
    v_cvt_pk_bf16_f32 v38, v28, v29
    v_mfma_f32_16x16x32_bf16 v[20:23], a[88:91], v[120:123], v[20:23]
    v_exp_f32 v31, v31
    v_mfma_f32_16x16x32_bf16 v[20:23], a[92:95], v[124:127], v[20:23]
    ds_read_b128 a[76:79], v1 offset:37056
    v_mfma_f32_16x16x32_bf16 v[24:27], a[96:99], v[112:115], v[60:63]
    v_exp_f32 v16, v16
    v_mfma_f32_16x16x32_bf16 v[24:27], a[100:103], v[116:119], v[24:27]
    ds_read_b128 a[80:83], v1 offset:37120
    v_cvt_pk_bf16_f32 v39, v30, v31
    v_mfma_f32_16x16x32_bf16 v[24:27], a[104:107], v[120:123], v[24:27]
    v_exp_f32 v17, v17
    v_mfma_f32_16x16x32_bf16 v[24:27], a[108:111], v[124:127], v[24:27]
    ds_read_b128 a[84:87], v1 offset:37184
    v_mfma_f32_16x16x32_bf16 v[28:31], a[112:115], v[112:115], v[60:63]
    v_exp_f32 v18, v18
    v_mfma_f32_16x16x32_bf16 v[28:31], a[116:119], v[116:119], v[28:31]
    ds_read_b128 a[88:91], v1 offset:37248
    v_cvt_pk_bf16_f32 v40, v16, v17
    v_mfma_f32_16x16x32_bf16 v[28:31], a[120:123], v[120:123], v[28:31]
    v_exp_f32 v19, v19
    v_mfma_f32_16x16x32_bf16 v[28:31], a[124:127], v[124:127], v[28:31]
    ds_read_b128 a[92:95], v1 offset:37312
    v_mfma_f32_16x16x32_bf16 v[192:195], a[128:131], v[32:35], v[192:195]
    v_exp_f32 v20, v20
    v_mfma_f32_16x16x32_bf16 v[192:195], a[132:135], v[36:39], v[192:195]
    ds_read_b128 a[96:99], v1 offset:37376
    v_cvt_pk_bf16_f32 v41, v18, v19
    v_mfma_f32_16x16x32_bf16 v[196:199], a[136:139], v[32:35], v[196:199]
    v_exp_f32 v21, v21
    v_mfma_f32_16x16x32_bf16 v[196:199], a[140:143], v[36:39], v[196:199]
    ds_read_b128 a[100:103], v1 offset:37440
    v_mfma_f32_16x16x32_bf16 v[200:203], a[144:147], v[32:35], v[200:203]
    v_exp_f32 v22, v22
    v_mfma_f32_16x16x32_bf16 v[200:203], a[148:151], v[36:39], v[200:203]
    ds_read_b128 a[104:107], v1 offset:37504
    v_cvt_pk_bf16_f32 v42, v20, v21
    v_mfma_f32_16x16x32_bf16 v[204:207], a[152:155], v[32:35], v[204:207]
    v_exp_f32 v23, v23
    v_mfma_f32_16x16x32_bf16 v[204:207], a[156:159], v[36:39], v[204:207]
    ds_read_b128 a[108:111], v1 offset:37568
    v_mfma_f32_16x16x32_bf16 v[208:211], a[160:163], v[32:35], v[208:211]
    v_exp_f32 v24, v24
    v_mfma_f32_16x16x32_bf16 v[208:211], a[164:167], v[36:39], v[208:211]
    ds_read_b128 a[112:115], v1 offset:37632
    v_cvt_pk_bf16_f32 v43, v22, v23
    v_mfma_f32_16x16x32_bf16 v[212:215], a[168:171], v[32:35], v[212:215]
    v_exp_f32 v25, v25
    v_mfma_f32_16x16x32_bf16 v[212:215], a[172:175], v[36:39], v[212:215]
    ds_read_b128 a[116:119], v1 offset:37696
    v_mfma_f32_16x16x32_bf16 v[216:219], a[176:179], v[32:35], v[216:219]
    v_exp_f32 v26, v26
    v_mfma_f32_16x16x32_bf16 v[216:219], a[180:183], v[36:39], v[216:219]
    ds_read_b128 a[120:123], v1 offset:37760
    v_cvt_pk_bf16_f32 v44, v24, v25
    v_mfma_f32_16x16x32_bf16 v[220:223], a[184:187], v[32:35], v[220:223]
    v_exp_f32 v27, v27
    v_mfma_f32_16x16x32_bf16 v[220:223], a[188:191], v[36:39], v[220:223]
    ds_read_b128 a[124:127], v1 offset:37824
    v_smfmac_f32_16x16x64_bf16 a[8:11], a[16:19], v[32:39], v11
    s_waitcnt lgkmcnt(12)
    v_mfma_f32_16x16x32_bf16 v[16:19], a[64:67], v[64:67], v[48:51]
    s_sub_u32 s47, s47, s48
    v_exp_f32 v28, v28
    v_mfma_f32_16x16x32_bf16 v[16:19], a[68:71], v[68:71], v[16:19]
    v_cvt_pk_bf16_f32 v45, v26, v27
    v_add_u32 v1, s48, v1
    v_mfma_f32_16x16x32_bf16 v[16:19], a[72:75], v[72:75], v[16:19]
    v_exp_f32 v29, v29
    v_mfma_f32_16x16x32_bf16 v[16:19], a[76:79], v[76:79], v[16:19]
    s_waitcnt lgkmcnt(8)
    v_mfma_f32_16x16x32_bf16 v[20:23], a[80:83], v[64:67], v[48:51]
    v_exp_f32 v30, v30
    v_mfma_f32_16x16x32_bf16 v[20:23], a[84:87], v[68:71], v[20:23]
    v_cvt_pk_bf16_f32 v46, v28, v29
    v_add_u32 v2, s48, v2
    v_mfma_f32_16x16x32_bf16 v[20:23], a[88:91], v[72:75], v[20:23]
    v_exp_f32 v31, v31
    v_mfma_f32_16x16x32_bf16 v[20:23], a[92:95], v[76:79], v[20:23]
    s_waitcnt lgkmcnt(4)
    v_mfma_f32_16x16x32_bf16 v[24:27], a[96:99], v[64:67], v[48:51]
    s_sub_u32 s48, 0, s48
    v_exp_f32 v16, v16
    v_mfma_f32_16x16x32_bf16 v[24:27], a[100:103], v[68:71], v[24:27]
    v_cvt_pk_bf16_f32 v47, v30, v31
    v_mfma_f32_16x16x32_bf16 v[24:27], a[104:107], v[72:75], v[24:27]
    v_exp_f32 v17, v17
    v_mfma_f32_16x16x32_bf16 v[24:27], a[108:111], v[76:79], v[24:27]
    s_waitcnt lgkmcnt(0)
    v_mfma_f32_16x16x32_bf16 v[28:31], a[112:115], v[64:67], v[48:51]
    v_exp_f32 v18, v18
    v_mfma_f32_16x16x32_bf16 v[28:31], a[116:119], v[68:71], v[28:31]
    v_cvt_pk_bf16_f32 v32, v16, v17
    v_mfma_f32_16x16x32_bf16 v[28:31], a[120:123], v[72:75], v[28:31]
    v_exp_f32 v19, v19
    v_mfma_f32_16x16x32_bf16 v[28:31], a[124:127], v[76:79], v[28:31]
    s_waitcnt vmcnt(7)
    s_barrier
    v_mfma_f32_16x16x32_bf16 v[224:227], a[128:131], v[40:43], v[224:227]
    v_exp_f32 v20, v20
    v_mfma_f32_16x16x32_bf16 v[224:227], a[132:135], v[44:47], v[224:227]
    ds_read_b64_tr_b16 a[128:129], v2 offset:0
    v_cvt_pk_bf16_f32 v33, v18, v19
    v_mfma_f32_16x16x32_bf16 v[228:231], a[136:139], v[40:43], v[228:231]
    s_add_u32 m0, s44, 73728
    v_exp_f32 v21, v21
    v_mfma_f32_16x16x32_bf16 v[228:231], a[140:143], v[44:47], v[228:231]
    s_mov_b32 s45, 0
    buffer_load_dwordx4 v7, s[28:31], s45 offen offset:0 lds
    v_mfma_f32_16x16x32_bf16 v[232:235], a[144:147], v[40:43], v[232:235]
    v_exp_f32 v22, v22
    v_mfma_f32_16x16x32_bf16 v[232:235], a[148:151], v[44:47], v[232:235]
    ds_read_b64_tr_b16 a[130:131], v2 offset:256
    v_cvt_pk_bf16_f32 v34, v20, v21
    v_mfma_f32_16x16x32_bf16 v[236:239], a[152:155], v[40:43], v[236:239]
    s_add_u32 m0, s44, 73632
    v_exp_f32 v23, v23
    v_mfma_f32_16x16x32_bf16 v[236:239], a[156:159], v[44:47], v[236:239]
    buffer_load_dwordx4 v7, s[28:31], s45 offen offset:1152 lds
    v_mfma_f32_16x16x32_bf16 v[240:243], a[160:163], v[40:43], v[240:243]
    v_exp_f32 v24, v24
    v_mfma_f32_16x16x32_bf16 v[240:243], a[164:167], v[44:47], v[240:243]
    ds_read_b64_tr_b16 a[132:133], v2 offset:512
    v_cvt_pk_bf16_f32 v35, v22, v23
    v_mfma_f32_16x16x32_bf16 v[244:247], a[168:171], v[40:43], v[244:247]
    s_add_u32 m0, s44, 73536
    v_exp_f32 v25, v25
    v_mfma_f32_16x16x32_bf16 v[244:247], a[172:175], v[44:47], v[244:247]
    buffer_load_dwordx4 v7, s[28:31], s45 offen offset:2304 lds
    v_mfma_f32_16x16x32_bf16 v[248:251], a[176:179], v[40:43], v[248:251]
    v_exp_f32 v26, v26
    v_mfma_f32_16x16x32_bf16 v[248:251], a[180:183], v[44:47], v[248:251]
    ds_read_b64_tr_b16 a[134:135], v2 offset:768
    v_cvt_pk_bf16_f32 v36, v24, v25
    v_mfma_f32_16x16x32_bf16 v[252:255], a[184:187], v[40:43], v[252:255]
    s_add_u32 m0, s44, 73440
    v_exp_f32 v27, v27
    v_mfma_f32_16x16x32_bf16 v[252:255], a[188:191], v[44:47], v[252:255]
    buffer_load_dwordx4 v7, s[28:31], s45 offen offset:3456 lds
    v_smfmac_f32_16x16x64_bf16 a[12:15], a[16:19], v[40:47], v11
    ds_read_b64_tr_b16 a[136:137], v2 offset:32
    v_mfma_f32_16x16x32_bf16 v[16:19], a[64:67], v[80:83], v[52:55]
    v_exp_f32 v28, v28
    v_mfma_f32_16x16x32_bf16 v[16:19], a[68:71], v[84:87], v[16:19]
    ds_read_b64_tr_b16 a[138:139], v2 offset:288
    v_cvt_pk_bf16_f32 v37, v26, v27
    v_mfma_f32_16x16x32_bf16 v[16:19], a[72:75], v[88:91], v[16:19]
    s_add_u32 m0, s44, 90624
    v_exp_f32 v29, v29
    v_mfma_f32_16x16x32_bf16 v[16:19], a[76:79], v[92:95], v[16:19]
    s_mov_b32 s45, 147456
    buffer_load_dwordx4 v7, s[28:31], s45 offen offset:0 lds
    v_mfma_f32_16x16x32_bf16 v[20:23], a[80:83], v[80:83], v[52:55]
    v_exp_f32 v30, v30
    v_mfma_f32_16x16x32_bf16 v[20:23], a[84:87], v[84:87], v[20:23]
    ds_read_b64_tr_b16 a[140:141], v2 offset:544
    v_cvt_pk_bf16_f32 v38, v28, v29
    v_mfma_f32_16x16x32_bf16 v[20:23], a[88:91], v[88:91], v[20:23]
    s_add_u32 m0, s44, 90528
    v_exp_f32 v31, v31
    v_mfma_f32_16x16x32_bf16 v[20:23], a[92:95], v[92:95], v[20:23]
    buffer_load_dwordx4 v7, s[28:31], s45 offen offset:1152 lds
    v_mfma_f32_16x16x32_bf16 v[24:27], a[96:99], v[80:83], v[52:55]
    v_exp_f32 v16, v16
    v_mfma_f32_16x16x32_bf16 v[24:27], a[100:103], v[84:87], v[24:27]
    ds_read_b64_tr_b16 a[142:143], v2 offset:800
    v_cvt_pk_bf16_f32 v39, v30, v31
    v_mfma_f32_16x16x32_bf16 v[24:27], a[104:107], v[88:91], v[24:27]
    s_add_u32 m0, s44, 90432
    v_exp_f32 v17, v17
    v_mfma_f32_16x16x32_bf16 v[24:27], a[108:111], v[92:95], v[24:27]
    buffer_load_dwordx4 v7, s[28:31], s45 offen offset:2304 lds
    v_mfma_f32_16x16x32_bf16 v[28:31], a[112:115], v[80:83], v[52:55]
    v_exp_f32 v18, v18
    v_mfma_f32_16x16x32_bf16 v[28:31], a[116:119], v[84:87], v[28:31]
    ds_read_b64_tr_b16 a[144:145], v2 offset:64
    v_cvt_pk_bf16_f32 v40, v16, v17
    v_mfma_f32_16x16x32_bf16 v[28:31], a[120:123], v[88:91], v[28:31]
    s_add_u32 m0, s44, 90336
    v_exp_f32 v19, v19
    v_mfma_f32_16x16x32_bf16 v[28:31], a[124:127], v[92:95], v[28:31]
    buffer_load_dwordx4 v7, s[28:31], s45 offen offset:3456 lds
    v_mfma_f32_16x16x32_bf16 v[128:131], a[192:195], v[32:35], v[128:131]
    v_exp_f32 v20, v20
    v_mfma_f32_16x16x32_bf16 v[128:131], a[196:199], v[36:39], v[128:131]
    ds_read_b64_tr_b16 a[146:147], v2 offset:320
    v_cvt_pk_bf16_f32 v41, v18, v19
    v_mfma_f32_16x16x32_bf16 v[132:135], a[200:203], v[32:35], v[132:135]
    v_exp_f32 v21, v21
    v_mfma_f32_16x16x32_bf16 v[132:135], a[204:207], v[36:39], v[132:135]
    ds_read_b64_tr_b16 a[148:149], v2 offset:576
    v_mfma_f32_16x16x32_bf16 v[136:139], a[208:211], v[32:35], v[136:139]
    v_exp_f32 v22, v22
    v_mfma_f32_16x16x32_bf16 v[136:139], a[212:215], v[36:39], v[136:139]
    ds_read_b64_tr_b16 a[150:151], v2 offset:832
    v_cvt_pk_bf16_f32 v42, v20, v21
    v_mfma_f32_16x16x32_bf16 v[140:143], a[216:219], v[32:35], v[140:143]
    v_exp_f32 v23, v23
    v_mfma_f32_16x16x32_bf16 v[140:143], a[220:223], v[36:39], v[140:143]
    ds_read_b64_tr_b16 a[152:153], v2 offset:96
    ds_read_b64_tr_b16 a[154:155], v2 offset:352
    v_mfma_f32_16x16x32_bf16 v[144:147], a[224:227], v[32:35], v[144:147]
    v_exp_f32 v24, v24
    v_mfma_f32_16x16x32_bf16 v[144:147], a[228:231], v[36:39], v[144:147]
    ds_read_b64_tr_b16 a[156:157], v2 offset:608
    v_cvt_pk_bf16_f32 v43, v22, v23
    v_mfma_f32_16x16x32_bf16 v[148:151], a[232:235], v[32:35], v[148:151]
    v_exp_f32 v25, v25
    v_mfma_f32_16x16x32_bf16 v[148:151], a[236:239], v[36:39], v[148:151]
    ds_read_b64_tr_b16 a[158:159], v2 offset:864
    ds_read_b64_tr_b16 a[160:161], v2 offset:128
    v_mfma_f32_16x16x32_bf16 v[152:155], a[240:243], v[32:35], v[152:155]
    v_exp_f32 v26, v26
    v_mfma_f32_16x16x32_bf16 v[152:155], a[244:247], v[36:39], v[152:155]
    ds_read_b64_tr_b16 a[162:163], v2 offset:384
    v_cvt_pk_bf16_f32 v44, v24, v25
    v_mfma_f32_16x16x32_bf16 v[156:159], a[248:251], v[32:35], v[156:159]
    v_exp_f32 v27, v27
    v_mfma_f32_16x16x32_bf16 v[156:159], a[252:255], v[36:39], v[156:159]
    ds_read_b64_tr_b16 a[164:165], v2 offset:640
    ds_read_b64_tr_b16 a[166:167], v2 offset:896
    v_smfmac_f32_16x16x64_bf16 a[0:3], a[16:19], v[32:39], v11
    ds_read_b64_tr_b16 a[168:169], v2 offset:160
    ds_read_b64_tr_b16 a[170:171], v2 offset:416
    v_mfma_f32_16x16x32_bf16 v[16:19], a[64:67], v[96:99], v[56:59]
    v_exp_f32 v28, v28
    v_mfma_f32_16x16x32_bf16 v[16:19], a[68:71], v[100:103], v[16:19]
    ds_read_b64_tr_b16 a[172:173], v2 offset:672
    v_cvt_pk_bf16_f32 v45, v26, v27
    v_mfma_f32_16x16x32_bf16 v[16:19], a[72:75], v[104:107], v[16:19]
    s_add_u32 m0, s44, 110592
    v_exp_f32 v29, v29
    v_mfma_f32_16x16x32_bf16 v[16:19], a[76:79], v[108:111], v[16:19]
    s_mov_b32 s45, 128
    buffer_load_dwordx4 v7, s[28:31], s45 offen offset:0 lds
    v_mfma_f32_16x16x32_bf16 v[20:23], a[80:83], v[96:99], v[56:59]
    v_exp_f32 v30, v30
    v_mfma_f32_16x16x32_bf16 v[20:23], a[84:87], v[100:103], v[20:23]
    ds_read_b64_tr_b16 a[174:175], v2 offset:928
    v_cvt_pk_bf16_f32 v46, v28, v29
    v_mfma_f32_16x16x32_bf16 v[20:23], a[88:91], v[104:107], v[20:23]
    s_add_u32 m0, s44, 110496
    v_exp_f32 v31, v31
    v_mfma_f32_16x16x32_bf16 v[20:23], a[92:95], v[108:111], v[20:23]
    buffer_load_dwordx4 v7, s[28:31], s45 offen offset:1152 lds
    v_mfma_f32_16x16x32_bf16 v[24:27], a[96:99], v[96:99], v[56:59]
    v_exp_f32 v16, v16
    v_mfma_f32_16x16x32_bf16 v[24:27], a[100:103], v[100:103], v[24:27]
    ds_read_b64_tr_b16 a[176:177], v2 offset:192
    v_cvt_pk_bf16_f32 v47, v30, v31
    v_mfma_f32_16x16x32_bf16 v[24:27], a[104:107], v[104:107], v[24:27]
    s_add_u32 m0, s44, 110400
    v_exp_f32 v17, v17
    v_mfma_f32_16x16x32_bf16 v[24:27], a[108:111], v[108:111], v[24:27]
    buffer_load_dwordx4 v7, s[28:31], s45 offen offset:2304 lds
    v_mfma_f32_16x16x32_bf16 v[28:31], a[112:115], v[96:99], v[56:59]
    v_exp_f32 v18, v18
    v_mfma_f32_16x16x32_bf16 v[28:31], a[116:119], v[100:103], v[28:31]
    ds_read_b64_tr_b16 a[178:179], v2 offset:448
    v_cvt_pk_bf16_f32 v32, v16, v17
    v_mfma_f32_16x16x32_bf16 v[28:31], a[120:123], v[104:107], v[28:31]
    s_add_u32 m0, s44, 110304
    v_exp_f32 v19, v19
    v_mfma_f32_16x16x32_bf16 v[28:31], a[124:127], v[108:111], v[28:31]
    buffer_load_dwordx4 v7, s[28:31], s45 offen offset:3456 lds
    v_mfma_f32_16x16x32_bf16 v[160:163], a[192:195], v[40:43], v[160:163]
    v_exp_f32 v20, v20
    v_mfma_f32_16x16x32_bf16 v[160:163], a[196:199], v[44:47], v[160:163]
    ds_read_b64_tr_b16 a[180:181], v2 offset:704
    v_cvt_pk_bf16_f32 v33, v18, v19
    v_mfma_f32_16x16x32_bf16 v[164:167], a[200:203], v[40:43], v[164:167]
    s_add_u32 m0, s44, 127488
    v_exp_f32 v21, v21
    v_mfma_f32_16x16x32_bf16 v[164:167], a[204:207], v[44:47], v[164:167]
    s_mov_b32 s45, 147584
    buffer_load_dwordx4 v7, s[28:31], s45 offen offset:0 lds
    v_mfma_f32_16x16x32_bf16 v[168:171], a[208:211], v[40:43], v[168:171]
    v_exp_f32 v22, v22
    v_mfma_f32_16x16x32_bf16 v[168:171], a[212:215], v[44:47], v[168:171]
    ds_read_b64_tr_b16 a[182:183], v2 offset:960
    v_cvt_pk_bf16_f32 v34, v20, v21
    v_mfma_f32_16x16x32_bf16 v[172:175], a[216:219], v[40:43], v[172:175]
    s_add_u32 m0, s44, 127392
    v_exp_f32 v23, v23
    v_mfma_f32_16x16x32_bf16 v[172:175], a[220:223], v[44:47], v[172:175]
    buffer_load_dwordx4 v7, s[28:31], s45 offen offset:1152 lds
    v_mfma_f32_16x16x32_bf16 v[176:179], a[224:227], v[40:43], v[176:179]
    v_exp_f32 v24, v24
    v_mfma_f32_16x16x32_bf16 v[176:179], a[228:231], v[44:47], v[176:179]
    ds_read_b64_tr_b16 a[184:185], v2 offset:224
    v_cvt_pk_bf16_f32 v35, v22, v23
    v_mfma_f32_16x16x32_bf16 v[180:183], a[232:235], v[40:43], v[180:183]
    s_add_u32 m0, s44, 127296
    v_exp_f32 v25, v25
    v_mfma_f32_16x16x32_bf16 v[180:183], a[236:239], v[44:47], v[180:183]
    buffer_load_dwordx4 v7, s[28:31], s45 offen offset:2304 lds
    v_mfma_f32_16x16x32_bf16 v[184:187], a[240:243], v[40:43], v[184:187]
    v_exp_f32 v26, v26
    v_mfma_f32_16x16x32_bf16 v[184:187], a[244:247], v[44:47], v[184:187]
    ds_read_b64_tr_b16 a[186:187], v2 offset:480
    v_cvt_pk_bf16_f32 v36, v24, v25
    v_mfma_f32_16x16x32_bf16 v[188:191], a[248:251], v[40:43], v[188:191]
    s_add_u32 m0, s44, 127200
    v_exp_f32 v27, v27
    v_mfma_f32_16x16x32_bf16 v[188:191], a[252:255], v[44:47], v[188:191]
    buffer_load_dwordx4 v7, s[28:31], s45 offen offset:3456 lds
    v_smfmac_f32_16x16x64_bf16 a[4:7], a[16:19], v[40:47], v11
    ds_read_b64_tr_b16 a[188:189], v2 offset:736
    ds_read_b64_tr_b16 a[190:191], v2 offset:992
    v_mfma_f32_16x16x32_bf16 v[16:19], a[64:67], v[112:115], v[60:63]
    v_exp_f32 v28, v28
    v_mfma_f32_16x16x32_bf16 v[16:19], a[68:71], v[116:119], v[16:19]
    ds_read_b128 a[64:67], v1 offset:0
    v_cvt_pk_bf16_f32 v37, v26, v27
    v_mfma_f32_16x16x32_bf16 v[16:19], a[72:75], v[120:123], v[16:19]
    v_exp_f32 v29, v29
    v_mfma_f32_16x16x32_bf16 v[16:19], a[76:79], v[124:127], v[16:19]
    ds_read_b128 a[68:71], v1 offset:64
    v_mfma_f32_16x16x32_bf16 v[20:23], a[80:83], v[112:115], v[60:63]
    v_exp_f32 v30, v30
    v_mfma_f32_16x16x32_bf16 v[20:23], a[84:87], v[116:119], v[20:23]
    ds_read_b128 a[72:75], v1 offset:128
    v_cvt_pk_bf16_f32 v38, v28, v29
    v_mfma_f32_16x16x32_bf16 v[20:23], a[88:91], v[120:123], v[20:23]
    v_exp_f32 v31, v31
    v_mfma_f32_16x16x32_bf16 v[20:23], a[92:95], v[124:127], v[20:23]
    ds_read_b128 a[76:79], v1 offset:192
    v_mfma_f32_16x16x32_bf16 v[24:27], a[96:99], v[112:115], v[60:63]
    v_exp_f32 v16, v16
    v_mfma_f32_16x16x32_bf16 v[24:27], a[100:103], v[116:119], v[24:27]
    ds_read_b128 a[80:83], v1 offset:256
    v_cvt_pk_bf16_f32 v39, v30, v31
    v_mfma_f32_16x16x32_bf16 v[24:27], a[104:107], v[120:123], v[24:27]
    v_exp_f32 v17, v17
    v_mfma_f32_16x16x32_bf16 v[24:27], a[108:111], v[124:127], v[24:27]
    ds_read_b128 a[84:87], v1 offset:320
    v_mfma_f32_16x16x32_bf16 v[28:31], a[112:115], v[112:115], v[60:63]
    v_exp_f32 v18, v18
    v_mfma_f32_16x16x32_bf16 v[28:31], a[116:119], v[116:119], v[28:31]
    ds_read_b128 a[88:91], v1 offset:384
    v_cvt_pk_bf16_f32 v40, v16, v17
    v_mfma_f32_16x16x32_bf16 v[28:31], a[120:123], v[120:123], v[28:31]
    v_exp_f32 v19, v19
    v_mfma_f32_16x16x32_bf16 v[28:31], a[124:127], v[124:127], v[28:31]
    ds_read_b128 a[92:95], v1 offset:448
    v_mfma_f32_16x16x32_bf16 v[192:195], a[192:195], v[32:35], v[192:195]
    v_exp_f32 v20, v20
    v_mfma_f32_16x16x32_bf16 v[192:195], a[196:199], v[36:39], v[192:195]
    ds_read_b128 a[96:99], v1 offset:512
    v_cvt_pk_bf16_f32 v41, v18, v19
    v_mfma_f32_16x16x32_bf16 v[196:199], a[200:203], v[32:35], v[196:199]
    v_exp_f32 v21, v21
    v_mfma_f32_16x16x32_bf16 v[196:199], a[204:207], v[36:39], v[196:199]
    ds_read_b128 a[100:103], v1 offset:576
    v_mfma_f32_16x16x32_bf16 v[200:203], a[208:211], v[32:35], v[200:203]
    v_exp_f32 v22, v22
    v_mfma_f32_16x16x32_bf16 v[200:203], a[212:215], v[36:39], v[200:203]
    ds_read_b128 a[104:107], v1 offset:640
    v_cvt_pk_bf16_f32 v42, v20, v21
    v_mfma_f32_16x16x32_bf16 v[204:207], a[216:219], v[32:35], v[204:207]
    v_exp_f32 v23, v23
    v_mfma_f32_16x16x32_bf16 v[204:207], a[220:223], v[36:39], v[204:207]
    ds_read_b128 a[108:111], v1 offset:704
    v_mfma_f32_16x16x32_bf16 v[208:211], a[224:227], v[32:35], v[208:211]
    v_exp_f32 v24, v24
    v_mfma_f32_16x16x32_bf16 v[208:211], a[228:231], v[36:39], v[208:211]
    ds_read_b128 a[112:115], v1 offset:768
    v_cvt_pk_bf16_f32 v43, v22, v23
    v_mfma_f32_16x16x32_bf16 v[212:215], a[232:235], v[32:35], v[212:215]
    v_exp_f32 v25, v25
    v_mfma_f32_16x16x32_bf16 v[212:215], a[236:239], v[36:39], v[212:215]
    ds_read_b128 a[116:119], v1 offset:832
    v_mfma_f32_16x16x32_bf16 v[216:219], a[240:243], v[32:35], v[216:219]
    v_exp_f32 v26, v26
    v_mfma_f32_16x16x32_bf16 v[216:219], a[244:247], v[36:39], v[216:219]
    ds_read_b128 a[120:123], v1 offset:896
    v_cvt_pk_bf16_f32 v44, v24, v25
    v_mfma_f32_16x16x32_bf16 v[220:223], a[248:251], v[32:35], v[220:223]
    v_exp_f32 v27, v27
    v_mfma_f32_16x16x32_bf16 v[220:223], a[252:255], v[36:39], v[220:223]
    ds_read_b128 a[124:127], v1 offset:960
    v_smfmac_f32_16x16x64_bf16 a[8:11], a[16:19], v[32:39], v11
    s_waitcnt lgkmcnt(12)
    v_mfma_f32_16x16x32_bf16 v[16:19], a[64:67], v[64:67], v[48:51]
    v_exp_f32 v28, v28
    v_mfma_f32_16x16x32_bf16 v[16:19], a[68:71], v[68:71], v[16:19]
    v_cvt_pk_bf16_f32 v45, v26, v27
    v_mfma_f32_16x16x32_bf16 v[16:19], a[72:75], v[72:75], v[16:19]
    s_mov_b32 s54, 737280
    v_exp_f32 v29, v29
    v_mfma_f32_16x16x32_bf16 v[16:19], a[76:79], v[76:79], v[16:19]
    s_waitcnt lgkmcnt(8)
    buffer_load_dwordx4 a[40:43], v6, s[64:67], s54 offen
    v_mfma_f32_16x16x32_bf16 v[20:23], a[80:83], v[64:67], v[48:51]
    v_exp_f32 v30, v30
    v_mfma_f32_16x16x32_bf16 v[20:23], a[84:87], v[68:71], v[20:23]
    v_cvt_pk_bf16_f32 v46, v28, v29
    v_mfma_f32_16x16x32_bf16 v[20:23], a[88:91], v[72:75], v[20:23]
    v_exp_f32 v31, v31
    v_mfma_f32_16x16x32_bf16 v[20:23], a[92:95], v[76:79], v[20:23]
    s_waitcnt lgkmcnt(4)
    v_mfma_f32_16x16x32_bf16 v[24:27], a[96:99], v[64:67], v[48:51]
    v_exp_f32 v16, v16
    v_mfma_f32_16x16x32_bf16 v[24:27], a[100:103], v[68:71], v[24:27]
    v_cvt_pk_bf16_f32 v47, v30, v31
    v_mfma_f32_16x16x32_bf16 v[24:27], a[104:107], v[72:75], v[24:27]
    s_mov_b32 s54, 884736
    v_exp_f32 v17, v17
    v_mfma_f32_16x16x32_bf16 v[24:27], a[108:111], v[76:79], v[24:27]
    s_waitcnt lgkmcnt(0)
    buffer_load_dwordx4 a[44:47], v6, s[64:67], s54 offen
    v_mfma_f32_16x16x32_bf16 v[28:31], a[112:115], v[64:67], v[48:51]
    v_exp_f32 v18, v18
    v_mfma_f32_16x16x32_bf16 v[28:31], a[116:119], v[68:71], v[28:31]
    v_cvt_pk_bf16_f32 v32, v16, v17
    v_mfma_f32_16x16x32_bf16 v[28:31], a[120:123], v[72:75], v[28:31]
    v_exp_f32 v19, v19
    v_mfma_f32_16x16x32_bf16 v[28:31], a[124:127], v[76:79], v[28:31]
    v_mfma_f32_16x16x32_bf16 v[224:227], a[192:195], v[40:43], v[224:227]
    v_exp_f32 v20, v20
    v_mfma_f32_16x16x32_bf16 v[224:227], a[196:199], v[44:47], v[224:227]
    ds_read_b64_tr_b16 a[192:193], v2 offset:36864
    v_cvt_pk_bf16_f32 v33, v18, v19
    v_mfma_f32_16x16x32_bf16 v[228:231], a[200:203], v[40:43], v[228:231]
    s_mov_b32 s54, 1032192
    v_exp_f32 v21, v21
    v_mfma_f32_16x16x32_bf16 v[228:231], a[204:207], v[44:47], v[228:231]
    buffer_load_dwordx4 a[48:51], v6, s[64:67], s54 offen
    v_mfma_f32_16x16x32_bf16 v[232:235], a[208:211], v[40:43], v[232:235]
    v_exp_f32 v22, v22
    v_mfma_f32_16x16x32_bf16 v[232:235], a[212:215], v[44:47], v[232:235]
    ds_read_b64_tr_b16 a[194:195], v2 offset:37120
    v_cvt_pk_bf16_f32 v34, v20, v21
    v_mfma_f32_16x16x32_bf16 v[236:239], a[216:219], v[40:43], v[236:239]
    v_exp_f32 v23, v23
    v_mfma_f32_16x16x32_bf16 v[236:239], a[220:223], v[44:47], v[236:239]
    ds_read_b64_tr_b16 a[196:197], v2 offset:37376
    v_mfma_f32_16x16x32_bf16 v[240:243], a[224:227], v[40:43], v[240:243]
    v_exp_f32 v24, v24
    v_mfma_f32_16x16x32_bf16 v[240:243], a[228:231], v[44:47], v[240:243]
    ds_read_b64_tr_b16 a[198:199], v2 offset:37632
    v_cvt_pk_bf16_f32 v35, v22, v23
    v_mfma_f32_16x16x32_bf16 v[244:247], a[232:235], v[40:43], v[244:247]
    s_mov_b32 s54, 1179648
    v_exp_f32 v25, v25
    v_mfma_f32_16x16x32_bf16 v[244:247], a[236:239], v[44:47], v[244:247]
    buffer_load_dwordx4 a[52:55], v6, s[64:67], s54 offen
    v_mfma_f32_16x16x32_bf16 v[248:251], a[240:243], v[40:43], v[248:251]
    v_exp_f32 v26, v26
    v_mfma_f32_16x16x32_bf16 v[248:251], a[244:247], v[44:47], v[248:251]
    ds_read_b64_tr_b16 a[200:201], v2 offset:36896
    v_cvt_pk_bf16_f32 v36, v24, v25
    v_mfma_f32_16x16x32_bf16 v[252:255], a[248:251], v[40:43], v[252:255]
    v_exp_f32 v27, v27
    v_mfma_f32_16x16x32_bf16 v[252:255], a[252:255], v[44:47], v[252:255]
    ds_read_b64_tr_b16 a[202:203], v2 offset:37152
    v_smfmac_f32_16x16x64_bf16 a[12:15], a[16:19], v[40:47], v11
    ds_read_b64_tr_b16 a[204:205], v2 offset:37408
    v_mfma_f32_16x16x32_bf16 v[16:19], a[64:67], v[80:83], v[52:55]
    v_exp_f32 v28, v28
    v_mfma_f32_16x16x32_bf16 v[16:19], a[68:71], v[84:87], v[16:19]
    ds_read_b64_tr_b16 a[206:207], v2 offset:37664
    v_cvt_pk_bf16_f32 v37, v26, v27
    v_mfma_f32_16x16x32_bf16 v[16:19], a[72:75], v[88:91], v[16:19]
    v_exp_f32 v29, v29
    v_mfma_f32_16x16x32_bf16 v[16:19], a[76:79], v[92:95], v[16:19]
    buffer_store_dwordx4 a[56:59], v5, s[32:35], 0 offen offset:0 sc1
    v_mfma_f32_16x16x32_bf16 v[20:23], a[80:83], v[80:83], v[52:55]
    v_exp_f32 v30, v30
    v_mfma_f32_16x16x32_bf16 v[20:23], a[84:87], v[84:87], v[20:23]
    ds_read_b64_tr_b16 a[208:209], v2 offset:36928
    v_cvt_pk_bf16_f32 v38, v28, v29
    v_mfma_f32_16x16x32_bf16 v[20:23], a[88:91], v[88:91], v[20:23]
    v_exp_f32 v31, v31
    v_mfma_f32_16x16x32_bf16 v[20:23], a[92:95], v[92:95], v[20:23]
    ds_read_b64_tr_b16 a[210:211], v2 offset:37184
    v_mfma_f32_16x16x32_bf16 v[24:27], a[96:99], v[80:83], v[52:55]
    v_exp_f32 v16, v16
    v_mfma_f32_16x16x32_bf16 v[24:27], a[100:103], v[84:87], v[24:27]
    ds_read_b64_tr_b16 a[212:213], v2 offset:37440
    v_cvt_pk_bf16_f32 v39, v30, v31
    v_mfma_f32_16x16x32_bf16 v[24:27], a[104:107], v[88:91], v[24:27]
    v_exp_f32 v17, v17
    v_mfma_f32_16x16x32_bf16 v[24:27], a[108:111], v[92:95], v[24:27]
    buffer_store_dwordx4 a[56:59], v5, s[32:35], 0 offen offset:1024 sc1
    v_mfma_f32_16x16x32_bf16 v[28:31], a[112:115], v[80:83], v[52:55]
    v_exp_f32 v18, v18
    v_mfma_f32_16x16x32_bf16 v[28:31], a[116:119], v[84:87], v[28:31]
    ds_read_b64_tr_b16 a[214:215], v2 offset:37696
    v_cvt_pk_bf16_f32 v40, v16, v17
    v_mfma_f32_16x16x32_bf16 v[28:31], a[120:123], v[88:91], v[28:31]
    v_exp_f32 v19, v19
    v_mfma_f32_16x16x32_bf16 v[28:31], a[124:127], v[92:95], v[28:31]
    ds_read_b64_tr_b16 a[216:217], v2 offset:36960
    v_mfma_f32_16x16x32_bf16 v[128:131], a[128:131], v[32:35], v[128:131]
    v_exp_f32 v20, v20
    v_mfma_f32_16x16x32_bf16 v[128:131], a[132:135], v[36:39], v[128:131]
    ds_read_b64_tr_b16 a[218:219], v2 offset:37216
    v_cvt_pk_bf16_f32 v41, v18, v19
    v_mfma_f32_16x16x32_bf16 v[132:135], a[136:139], v[32:35], v[132:135]
    v_exp_f32 v21, v21
    v_mfma_f32_16x16x32_bf16 v[132:135], a[140:143], v[36:39], v[132:135]
    buffer_store_dwordx4 a[56:59], v5, s[32:35], 0 offen offset:2048 sc1
    v_mfma_f32_16x16x32_bf16 v[136:139], a[144:147], v[32:35], v[136:139]
    v_exp_f32 v22, v22
    v_mfma_f32_16x16x32_bf16 v[136:139], a[148:151], v[36:39], v[136:139]
    ds_read_b64_tr_b16 a[220:221], v2 offset:37472
    v_cvt_pk_bf16_f32 v42, v20, v21
    v_mfma_f32_16x16x32_bf16 v[140:143], a[152:155], v[32:35], v[140:143]
    v_exp_f32 v23, v23
    v_mfma_f32_16x16x32_bf16 v[140:143], a[156:159], v[36:39], v[140:143]
    ds_read_b64_tr_b16 a[222:223], v2 offset:37728
    v_mfma_f32_16x16x32_bf16 v[144:147], a[160:163], v[32:35], v[144:147]
    v_exp_f32 v24, v24
    v_mfma_f32_16x16x32_bf16 v[144:147], a[164:167], v[36:39], v[144:147]
    ds_read_b64_tr_b16 a[224:225], v2 offset:36992
    v_cvt_pk_bf16_f32 v43, v22, v23
    v_mfma_f32_16x16x32_bf16 v[148:151], a[168:171], v[32:35], v[148:151]
    v_exp_f32 v25, v25
    v_mfma_f32_16x16x32_bf16 v[148:151], a[172:175], v[36:39], v[148:151]
    buffer_store_dwordx4 a[56:59], v5, s[32:35], 0 offen offset:3072 sc1
    v_mfma_f32_16x16x32_bf16 v[152:155], a[176:179], v[32:35], v[152:155]
    v_exp_f32 v26, v26
    v_mfma_f32_16x16x32_bf16 v[152:155], a[180:183], v[36:39], v[152:155]
    ds_read_b64_tr_b16 a[226:227], v2 offset:37248
    v_cvt_pk_bf16_f32 v44, v24, v25
    v_mfma_f32_16x16x32_bf16 v[156:159], a[184:187], v[32:35], v[156:159]
    v_exp_f32 v27, v27
    v_mfma_f32_16x16x32_bf16 v[156:159], a[188:191], v[36:39], v[156:159]
    ds_read_b64_tr_b16 a[228:229], v2 offset:37504
    v_smfmac_f32_16x16x64_bf16 a[0:3], a[16:19], v[32:39], v11
    ds_read_b64_tr_b16 a[230:231], v2 offset:37760
    v_mfma_f32_16x16x32_bf16 v[16:19], a[64:67], v[96:99], v[56:59]
    v_exp_f32 v28, v28
    v_mfma_f32_16x16x32_bf16 v[16:19], a[68:71], v[100:103], v[16:19]
    ds_read_b64_tr_b16 a[232:233], v2 offset:37024
    v_cvt_pk_bf16_f32 v45, v26, v27
    v_mfma_f32_16x16x32_bf16 v[16:19], a[72:75], v[104:107], v[16:19]
    v_exp_f32 v29, v29
    v_mfma_f32_16x16x32_bf16 v[16:19], a[76:79], v[108:111], v[16:19]
    ds_read_b64_tr_b16 a[234:235], v2 offset:37280
    v_mfma_f32_16x16x32_bf16 v[20:23], a[80:83], v[96:99], v[56:59]
    v_exp_f32 v30, v30
    v_mfma_f32_16x16x32_bf16 v[20:23], a[84:87], v[100:103], v[20:23]
    ds_read_b64_tr_b16 a[236:237], v2 offset:37536
    v_cvt_pk_bf16_f32 v46, v28, v29
    v_mfma_f32_16x16x32_bf16 v[20:23], a[88:91], v[104:107], v[20:23]
    v_exp_f32 v31, v31
    v_mfma_f32_16x16x32_bf16 v[20:23], a[92:95], v[108:111], v[20:23]
    ds_read_b64_tr_b16 a[238:239], v2 offset:37792
    v_mfma_f32_16x16x32_bf16 v[24:27], a[96:99], v[96:99], v[56:59]
    v_exp_f32 v16, v16
    v_mfma_f32_16x16x32_bf16 v[24:27], a[100:103], v[100:103], v[24:27]
    ds_read_b64_tr_b16 a[240:241], v2 offset:37056
    v_cvt_pk_bf16_f32 v47, v30, v31
    v_mfma_f32_16x16x32_bf16 v[24:27], a[104:107], v[104:107], v[24:27]
    v_exp_f32 v17, v17
    v_mfma_f32_16x16x32_bf16 v[24:27], a[108:111], v[108:111], v[24:27]
    ds_read_b64_tr_b16 a[242:243], v2 offset:37312
    v_mfma_f32_16x16x32_bf16 v[28:31], a[112:115], v[96:99], v[56:59]
    v_exp_f32 v18, v18
    v_mfma_f32_16x16x32_bf16 v[28:31], a[116:119], v[100:103], v[28:31]
    ds_read_b64_tr_b16 a[244:245], v2 offset:37568
    v_cvt_pk_bf16_f32 v32, v16, v17
    v_mfma_f32_16x16x32_bf16 v[28:31], a[120:123], v[104:107], v[28:31]
    v_exp_f32 v19, v19
    v_mfma_f32_16x16x32_bf16 v[28:31], a[124:127], v[108:111], v[28:31]
    ds_read_b64_tr_b16 a[246:247], v2 offset:37824
    v_mfma_f32_16x16x32_bf16 v[160:163], a[128:131], v[40:43], v[160:163]
    v_exp_f32 v20, v20
    v_mfma_f32_16x16x32_bf16 v[160:163], a[132:135], v[44:47], v[160:163]
L2_pad9:
    s_cbranch_execz L2_pad13
    ds_read_b64_tr_b16 a[248:249], v2 offset:37088
    v_cvt_pk_bf16_f32 v33, v18, v19
    v_mfma_f32_16x16x32_bf16 v[164:167], a[136:139], v[40:43], v[164:167]
    v_exp_f32 v21, v21
    v_mfma_f32_16x16x32_bf16 v[164:167], a[140:143], v[44:47], v[164:167]
    ds_read_b64_tr_b16 a[250:251], v2 offset:37344
    v_mfma_f32_16x16x32_bf16 v[168:171], a[144:147], v[40:43], v[168:171]
    v_exp_f32 v22, v22
    v_mfma_f32_16x16x32_bf16 v[168:171], a[148:151], v[44:47], v[168:171]
    ds_read_b64_tr_b16 a[252:253], v2 offset:37600
    v_cvt_pk_bf16_f32 v34, v20, v21
    v_mfma_f32_16x16x32_bf16 v[172:175], a[152:155], v[40:43], v[172:175]
    v_exp_f32 v23, v23
    v_mfma_f32_16x16x32_bf16 v[172:175], a[156:159], v[44:47], v[172:175]
    ds_read_b64_tr_b16 a[254:255], v2 offset:37856
    v_mfma_f32_16x16x32_bf16 v[176:179], a[160:163], v[40:43], v[176:179]
    v_exp_f32 v24, v24
    v_mfma_f32_16x16x32_bf16 v[176:179], a[164:167], v[44:47], v[176:179]
    v_cvt_pk_bf16_f32 v35, v22, v23
    v_mfma_f32_16x16x32_bf16 v[180:183], a[168:171], v[40:43], v[180:183]
    v_exp_f32 v25, v25
    v_mfma_f32_16x16x32_bf16 v[180:183], a[172:175], v[44:47], v[180:183]
    v_mfma_f32_16x16x32_bf16 v[184:187], a[176:179], v[40:43], v[184:187]
    v_exp_f32 v26, v26
    v_mfma_f32_16x16x32_bf16 v[184:187], a[180:183], v[44:47], v[184:187]
    v_cvt_pk_bf16_f32 v36, v24, v25
    v_mfma_f32_16x16x32_bf16 v[188:191], a[184:187], v[40:43], v[188:191]
    v_exp_f32 v27, v27
    v_mfma_f32_16x16x32_bf16 v[188:191], a[188:191], v[44:47], v[188:191]
    v_smfmac_f32_16x16x64_bf16 a[4:7], a[16:19], v[40:47], v11
    v_mfma_f32_16x16x32_bf16 v[16:19], a[64:67], v[112:115], v[60:63]
    v_exp_f32 v28, v28
    v_mfma_f32_16x16x32_bf16 v[16:19], a[68:71], v[116:119], v[16:19]
    ds_read_b128 a[64:67], v1 offset:36864
    v_cvt_pk_bf16_f32 v37, v26, v27
    v_mfma_f32_16x16x32_bf16 v[16:19], a[72:75], v[120:123], v[16:19]
    v_exp_f32 v29, v29
    v_mfma_f32_16x16x32_bf16 v[16:19], a[76:79], v[124:127], v[16:19]
    ds_read_b128 a[68:71], v1 offset:36928
    v_mfma_f32_16x16x32_bf16 v[20:23], a[80:83], v[112:115], v[60:63]
    v_exp_f32 v30, v30
    v_mfma_f32_16x16x32_bf16 v[20:23], a[84:87], v[116:119], v[20:23]
    ds_read_b128 a[72:75], v1 offset:36992
    v_cvt_pk_bf16_f32 v38, v28, v29
    v_mfma_f32_16x16x32_bf16 v[20:23], a[88:91], v[120:123], v[20:23]
    v_exp_f32 v31, v31
    v_mfma_f32_16x16x32_bf16 v[20:23], a[92:95], v[124:127], v[20:23]
    ds_read_b128 a[76:79], v1 offset:37056
    v_mfma_f32_16x16x32_bf16 v[24:27], a[96:99], v[112:115], v[60:63]
    v_exp_f32 v16, v16
    v_mfma_f32_16x16x32_bf16 v[24:27], a[100:103], v[116:119], v[24:27]
    ds_read_b128 a[80:83], v1 offset:37120
    v_cvt_pk_bf16_f32 v39, v30, v31
    v_mfma_f32_16x16x32_bf16 v[24:27], a[104:107], v[120:123], v[24:27]
    v_exp_f32 v17, v17
    v_mfma_f32_16x16x32_bf16 v[24:27], a[108:111], v[124:127], v[24:27]
    ds_read_b128 a[84:87], v1 offset:37184
    v_mfma_f32_16x16x32_bf16 v[28:31], a[112:115], v[112:115], v[60:63]
    v_exp_f32 v18, v18
    v_mfma_f32_16x16x32_bf16 v[28:31], a[116:119], v[116:119], v[28:31]
    ds_read_b128 a[88:91], v1 offset:37248
    v_cvt_pk_bf16_f32 v40, v16, v17
    v_mfma_f32_16x16x32_bf16 v[28:31], a[120:123], v[120:123], v[28:31]
    v_exp_f32 v19, v19
    v_mfma_f32_16x16x32_bf16 v[28:31], a[124:127], v[124:127], v[28:31]
    ds_read_b128 a[92:95], v1 offset:37312
    v_mfma_f32_16x16x32_bf16 v[192:195], a[128:131], v[32:35], v[192:195]
    v_exp_f32 v20, v20
    v_mfma_f32_16x16x32_bf16 v[192:195], a[132:135], v[36:39], v[192:195]
    ds_read_b128 a[96:99], v1 offset:37376
    v_cvt_pk_bf16_f32 v41, v18, v19
    v_mfma_f32_16x16x32_bf16 v[196:199], a[136:139], v[32:35], v[196:199]
    v_exp_f32 v21, v21
    v_mfma_f32_16x16x32_bf16 v[196:199], a[140:143], v[36:39], v[196:199]
    ds_read_b128 a[100:103], v1 offset:37440
    v_mfma_f32_16x16x32_bf16 v[200:203], a[144:147], v[32:35], v[200:203]
    v_exp_f32 v22, v22
    v_mfma_f32_16x16x32_bf16 v[200:203], a[148:151], v[36:39], v[200:203]
    ds_read_b128 a[104:107], v1 offset:37504
    v_cvt_pk_bf16_f32 v42, v20, v21
    v_mfma_f32_16x16x32_bf16 v[204:207], a[152:155], v[32:35], v[204:207]
    v_exp_f32 v23, v23
    v_mfma_f32_16x16x32_bf16 v[204:207], a[156:159], v[36:39], v[204:207]
    ds_read_b128 a[108:111], v1 offset:37568
    v_mfma_f32_16x16x32_bf16 v[208:211], a[160:163], v[32:35], v[208:211]
    v_exp_f32 v24, v24
    v_mfma_f32_16x16x32_bf16 v[208:211], a[164:167], v[36:39], v[208:211]
    ds_read_b128 a[112:115], v1 offset:37632
    v_cvt_pk_bf16_f32 v43, v22, v23
    v_mfma_f32_16x16x32_bf16 v[212:215], a[168:171], v[32:35], v[212:215]
    v_exp_f32 v25, v25
    v_mfma_f32_16x16x32_bf16 v[212:215], a[172:175], v[36:39], v[212:215]
    ds_read_b128 a[116:119], v1 offset:37696
    v_mfma_f32_16x16x32_bf16 v[216:219], a[176:179], v[32:35], v[216:219]
    v_exp_f32 v26, v26
    v_mfma_f32_16x16x32_bf16 v[216:219], a[180:183], v[36:39], v[216:219]
    ds_read_b128 a[120:123], v1 offset:37760
    v_cvt_pk_bf16_f32 v44, v24, v25
    v_mfma_f32_16x16x32_bf16 v[220:223], a[184:187], v[32:35], v[220:223]
    v_exp_f32 v27, v27
    v_mfma_f32_16x16x32_bf16 v[220:223], a[188:191], v[36:39], v[220:223]
    ds_read_b128 a[124:127], v1 offset:37824
    v_smfmac_f32_16x16x64_bf16 a[8:11], a[16:19], v[32:39], v11
    s_waitcnt lgkmcnt(12)
    v_mfma_f32_16x16x32_bf16 v[16:19], a[64:67], v[64:67], v[48:51]
    v_exp_f32 v28, v28
    v_mfma_f32_16x16x32_bf16 v[16:19], a[68:71], v[68:71], v[16:19]
    v_cvt_pk_bf16_f32 v45, v26, v27
    v_mfma_f32_16x16x32_bf16 v[16:19], a[72:75], v[72:75], v[16:19]
    v_exp_f32 v29, v29
    v_mfma_f32_16x16x32_bf16 v[16:19], a[76:79], v[76:79], v[16:19]
    s_waitcnt lgkmcnt(8)
    v_mfma_f32_16x16x32_bf16 v[20:23], a[80:83], v[64:67], v[48:51]
    v_exp_f32 v30, v30
    v_mfma_f32_16x16x32_bf16 v[20:23], a[84:87], v[68:71], v[20:23]
    v_cvt_pk_bf16_f32 v46, v28, v29
    v_mfma_f32_16x16x32_bf16 v[20:23], a[88:91], v[72:75], v[20:23]
    v_exp_f32 v31, v31
    v_mfma_f32_16x16x32_bf16 v[20:23], a[92:95], v[76:79], v[20:23]
    s_waitcnt lgkmcnt(4)
    v_mfma_f32_16x16x32_bf16 v[24:27], a[96:99], v[64:67], v[48:51]
    v_exp_f32 v16, v16
    v_mfma_f32_16x16x32_bf16 v[24:27], a[100:103], v[68:71], v[24:27]
    v_cvt_pk_bf16_f32 v47, v30, v31
    v_mfma_f32_16x16x32_bf16 v[24:27], a[104:107], v[72:75], v[24:27]
    v_exp_f32 v17, v17
    v_mfma_f32_16x16x32_bf16 v[24:27], a[108:111], v[76:79], v[24:27]
    s_waitcnt lgkmcnt(0)
    v_mfma_f32_16x16x32_bf16 v[28:31], a[112:115], v[64:67], v[48:51]
    v_exp_f32 v18, v18
    v_mfma_f32_16x16x32_bf16 v[28:31], a[116:119], v[68:71], v[28:31]
    v_cvt_pk_bf16_f32 v32, v16, v17
    v_mfma_f32_16x16x32_bf16 v[28:31], a[120:123], v[72:75], v[28:31]
    v_exp_f32 v19, v19
    v_mfma_f32_16x16x32_bf16 v[28:31], a[124:127], v[76:79], v[28:31]
    s_waitcnt vmcnt(8)
    s_barrier
    v_mfma_f32_16x16x32_bf16 v[224:227], a[128:131], v[40:43], v[224:227]
    v_exp_f32 v20, v20
    v_mfma_f32_16x16x32_bf16 v[224:227], a[132:135], v[44:47], v[224:227]
    v_cvt_pk_bf16_f32 v33, v18, v19
    v_mfma_f32_16x16x32_bf16 v[228:231], a[136:139], v[40:43], v[228:231]
    s_add_u32 m0, s44, 0
    v_exp_f32 v21, v21
    v_mfma_f32_16x16x32_bf16 v[228:231], a[140:143], v[44:47], v[228:231]
    s_mov_b32 s45, 256
    buffer_load_dwordx4 v7, s[28:31], s45 offen offset:0 lds
    v_mfma_f32_16x16x32_bf16 v[232:235], a[144:147], v[40:43], v[232:235]
    v_exp_f32 v22, v22
    v_mfma_f32_16x16x32_bf16 v[232:235], a[148:151], v[44:47], v[232:235]
    v_cvt_pk_bf16_f32 v34, v20, v21
    v_mfma_f32_16x16x32_bf16 v[236:239], a[152:155], v[40:43], v[236:239]
    s_add_u32 m0, s44, -96
    v_exp_f32 v23, v23
    v_mfma_f32_16x16x32_bf16 v[236:239], a[156:159], v[44:47], v[236:239]
    buffer_load_dwordx4 v7, s[28:31], s45 offen offset:1152 lds
    v_mfma_f32_16x16x32_bf16 v[240:243], a[160:163], v[40:43], v[240:243]
    v_exp_f32 v24, v24
    v_mfma_f32_16x16x32_bf16 v[240:243], a[164:167], v[44:47], v[240:243]
    v_cvt_pk_bf16_f32 v35, v22, v23
    v_mfma_f32_16x16x32_bf16 v[244:247], a[168:171], v[40:43], v[244:247]
    s_add_u32 m0, s44, -192
    v_exp_f32 v25, v25
    v_mfma_f32_16x16x32_bf16 v[244:247], a[172:175], v[44:47], v[244:247]
    buffer_load_dwordx4 v7, s[28:31], s45 offen offset:2304 lds
    v_mfma_f32_16x16x32_bf16 v[248:251], a[176:179], v[40:43], v[248:251]
    v_exp_f32 v26, v26
    v_mfma_f32_16x16x32_bf16 v[248:251], a[180:183], v[44:47], v[248:251]
    v_cvt_pk_bf16_f32 v36, v24, v25
    v_mfma_f32_16x16x32_bf16 v[252:255], a[184:187], v[40:43], v[252:255]
    s_add_u32 m0, s44, -288
    v_exp_f32 v27, v27
    v_mfma_f32_16x16x32_bf16 v[252:255], a[188:191], v[44:47], v[252:255]
    buffer_load_dwordx4 v7, s[28:31], s45 offen offset:3456 lds
    v_smfmac_f32_16x16x64_bf16 a[12:15], a[16:19], v[40:47], v11
    v_mfma_f32_16x16x32_bf16 v[16:19], a[64:67], v[80:83], v[52:55]
    v_exp_f32 v28, v28
    v_mfma_f32_16x16x32_bf16 v[16:19], a[68:71], v[84:87], v[16:19]
    v_cvt_pk_bf16_f32 v37, v26, v27
    v_mfma_f32_16x16x32_bf16 v[16:19], a[72:75], v[88:91], v[16:19]
    s_add_u32 m0, s44, 16896
    v_exp_f32 v29, v29
    v_mfma_f32_16x16x32_bf16 v[16:19], a[76:79], v[92:95], v[16:19]
    s_mov_b32 s45, 147712
    buffer_load_dwordx4 v7, s[28:31], s45 offen offset:0 lds
    v_mfma_f32_16x16x32_bf16 v[20:23], a[80:83], v[80:83], v[52:55]
    v_exp_f32 v30, v30
    v_mfma_f32_16x16x32_bf16 v[20:23], a[84:87], v[84:87], v[20:23]
    v_cvt_pk_bf16_f32 v38, v28, v29
    v_mfma_f32_16x16x32_bf16 v[20:23], a[88:91], v[88:91], v[20:23]
    s_add_u32 m0, s44, 16800
    v_exp_f32 v31, v31
    v_mfma_f32_16x16x32_bf16 v[20:23], a[92:95], v[92:95], v[20:23]
    s_mov_b32 s15, 0x5d800000
    buffer_load_dwordx4 v7, s[28:31], s45 offen offset:1152 lds
    v_mfma_f32_16x16x32_bf16 v[24:27], a[96:99], v[80:83], v[52:55]
    v_exp_f32 v16, v16
    v_mfma_f32_16x16x32_bf16 v[24:27], a[100:103], v[84:87], v[24:27]
    v_cvt_pk_bf16_f32 v39, v30, v31
    v_mfma_f32_16x16x32_bf16 v[24:27], a[104:107], v[88:91], v[24:27]
    s_add_u32 m0, s44, 16704
    v_exp_f32 v17, v17
    v_mfma_f32_16x16x32_bf16 v[24:27], a[108:111], v[92:95], v[24:27]
    buffer_load_dwordx4 v7, s[28:31], s45 offen offset:2304 lds
    v_mfma_f32_16x16x32_bf16 v[28:31], a[112:115], v[80:83], v[52:55]
    v_exp_f32 v18, v18
    v_mfma_f32_16x16x32_bf16 v[28:31], a[116:119], v[84:87], v[28:31]
    v_cvt_pk_bf16_f32 v40, v16, v17
    v_mfma_f32_16x16x32_bf16 v[28:31], a[120:123], v[88:91], v[28:31]
    s_add_u32 m0, s44, 16608
    v_exp_f32 v19, v19
    v_mfma_f32_16x16x32_bf16 v[28:31], a[124:127], v[92:95], v[28:31]
    buffer_load_dwordx4 v7, s[28:31], s45 offen offset:3456 lds
    v_mfma_f32_16x16x32_bf16 v[128:131], a[192:195], v[32:35], v[128:131]
    v_exp_f32 v20, v20
    v_mfma_f32_16x16x32_bf16 v[128:131], a[196:199], v[36:39], v[128:131]
    v_cvt_pk_bf16_f32 v41, v18, v19
    v_mfma_f32_16x16x32_bf16 v[132:135], a[200:203], v[32:35], v[132:135]
    s_mov_b32 s54, 0
    v_exp_f32 v21, v21
    v_mfma_f32_16x16x32_bf16 v[132:135], a[204:207], v[36:39], v[132:135]
    buffer_load_dwordx4 a[128:131], v6, s[68:71], s54 offen
    v_mfma_f32_16x16x32_bf16 v[136:139], a[208:211], v[32:35], v[136:139]
    v_exp_f32 v22, v22
    v_mfma_f32_16x16x32_bf16 v[136:139], a[212:215], v[36:39], v[136:139]
    v_cvt_pk_bf16_f32 v42, v20, v21
    v_mfma_f32_16x16x32_bf16 v[140:143], a[216:219], v[32:35], v[140:143]
    s_add_u32 s54, s55, 0
    v_exp_f32 v23, v23
    v_mfma_f32_16x16x32_bf16 v[140:143], a[220:223], v[36:39], v[140:143]
    buffer_load_dwordx4 a[164:167], v8, s[72:75], s54 offen
    v_mfma_f32_16x16x32_bf16 v[144:147], a[224:227], v[32:35], v[144:147]
    v_exp_f32 v24, v24
    v_mfma_f32_16x16x32_bf16 v[144:147], a[228:231], v[36:39], v[144:147]
    v_cvt_pk_bf16_f32 v43, v22, v23
    v_mfma_f32_16x16x32_bf16 v[148:151], a[232:235], v[32:35], v[148:151]
    s_mov_b32 s54, 147456
    v_exp_f32 v25, v25
    v_mfma_f32_16x16x32_bf16 v[148:151], a[236:239], v[36:39], v[148:151]
    buffer_load_dwordx4 a[132:135], v6, s[68:71], s54 offen
    v_mfma_f32_16x16x32_bf16 v[152:155], a[240:243], v[32:35], v[152:155]
    v_exp_f32 v26, v26
    v_mfma_f32_16x16x32_bf16 v[152:155], a[244:247], v[36:39], v[152:155]
    v_cvt_pk_bf16_f32 v44, v24, v25
    v_mfma_f32_16x16x32_bf16 v[156:159], a[248:251], v[32:35], v[156:159]
    s_add_u32 s54, s55, 1024
    v_exp_f32 v27, v27
    v_mfma_f32_16x16x32_bf16 v[156:159], a[252:255], v[36:39], v[156:159]
    buffer_load_dwordx4 a[168:171], v8, s[72:75], s54 offen
    v_smfmac_f32_16x16x64_bf16 a[0:3], a[16:19], v[32:39], v11
    v_mfma_f32_16x16x32_bf16 v[16:19], a[64:67], v[96:99], v[56:59]
    v_exp_f32 v28, v28
    v_mfma_f32_16x16x32_bf16 v[16:19], a[68:71], v[100:103], v[16:19]
    v_cvt_pk_bf16_f32 v45, v26, v27
    v_mfma_f32_16x16x32_bf16 v[16:19], a[72:75], v[104:107], v[16:19]
    s_mov_b32 s54, 294912
    v_exp_f32 v29, v29
    v_mfma_f32_16x16x32_bf16 v[16:19], a[76:79], v[108:111], v[16:19]
    buffer_load_dwordx4 a[136:139], v6, s[68:71], s54 offen
    v_mfma_f32_16x16x32_bf16 v[20:23], a[80:83], v[96:99], v[56:59]
    v_exp_f32 v30, v30
    v_mfma_f32_16x16x32_bf16 v[20:23], a[84:87], v[100:103], v[20:23]
    v_cvt_pk_bf16_f32 v46, v28, v29
    v_accvgpr_read_b32 v12, a0
    v_mfma_f32_16x16x32_bf16 v[20:23], a[88:91], v[104:107], v[20:23]
    s_add_u32 s54, s55, 2048
    v_exp_f32 v31, v31
    v_mfma_f32_16x16x32_bf16 v[20:23], a[92:95], v[108:111], v[20:23]
    buffer_load_dwordx4 a[172:175], v8, s[72:75], s54 offen
    v_mfma_f32_16x16x32_bf16 v[24:27], a[96:99], v[96:99], v[56:59]
    v_exp_f32 v16, v16
    v_mfma_f32_16x16x32_bf16 v[24:27], a[100:103], v[100:103], v[24:27]
    v_cvt_pk_bf16_f32 v47, v30, v31
    v_accvgpr_read_b32 v13, a1
    v_mfma_f32_16x16x32_bf16 v[24:27], a[104:107], v[104:107], v[24:27]
    s_mov_b32 s54, 442368
    v_exp_f32 v17, v17
    v_mfma_f32_16x16x32_bf16 v[24:27], a[108:111], v[108:111], v[24:27]
    buffer_load_dwordx4 a[140:143], v6, s[68:71], s54 offen
    v_mfma_f32_16x16x32_bf16 v[28:31], a[112:115], v[96:99], v[56:59]
    v_exp_f32 v18, v18
    v_mfma_f32_16x16x32_bf16 v[28:31], a[116:119], v[100:103], v[28:31]
    v_cvt_pk_bf16_f32 v32, v16, v17
    v_add_f32 v12, v12, v13
    v_mfma_f32_16x16x32_bf16 v[28:31], a[120:123], v[104:107], v[28:31]
    s_add_u32 s54, s55, 3072
    v_exp_f32 v19, v19
    v_mfma_f32_16x16x32_bf16 v[28:31], a[124:127], v[108:111], v[28:31]
    buffer_load_dwordx4 a[176:179], v8, s[72:75], s54 offen
    v_mfma_f32_16x16x32_bf16 v[160:163], a[192:195], v[40:43], v[160:163]
    v_exp_f32 v20, v20
    v_mfma_f32_16x16x32_bf16 v[160:163], a[196:199], v[44:47], v[160:163]
    v_cvt_pk_bf16_f32 v33, v18, v19
    v_cmp_nlt_f32 s[56:57], v12, s15
    v_mfma_f32_16x16x32_bf16 v[164:167], a[200:203], v[40:43], v[164:167]
    s_mov_b32 s54, 589824
    v_exp_f32 v21, v21
    v_mfma_f32_16x16x32_bf16 v[164:167], a[204:207], v[44:47], v[164:167]
    buffer_load_dwordx4 a[144:147], v6, s[68:71], s54 offen
    v_mfma_f32_16x16x32_bf16 v[168:171], a[208:211], v[40:43], v[168:171]
    v_exp_f32 v22, v22
    v_mfma_f32_16x16x32_bf16 v[168:171], a[212:215], v[44:47], v[168:171]
    v_cvt_pk_bf16_f32 v34, v20, v21
    v_mfma_f32_16x16x32_bf16 v[172:175], a[216:219], v[40:43], v[172:175]
    s_add_u32 s54, s55, 4096
    v_exp_f32 v23, v23
    v_mfma_f32_16x16x32_bf16 v[172:175], a[220:223], v[44:47], v[172:175]
    buffer_load_dwordx4 a[180:183], v8, s[72:75], s54 offen
    v_mfma_f32_16x16x32_bf16 v[176:179], a[224:227], v[40:43], v[176:179]
    v_exp_f32 v24, v24
    v_mfma_f32_16x16x32_bf16 v[176:179], a[228:231], v[44:47], v[176:179]
    v_cvt_pk_bf16_f32 v35, v22, v23
    v_mfma_f32_16x16x32_bf16 v[180:183], a[232:235], v[40:43], v[180:183]
    s_mov_b32 s54, 737280
    v_exp_f32 v25, v25
    v_mfma_f32_16x16x32_bf16 v[180:183], a[236:239], v[44:47], v[180:183]
    buffer_load_dwordx4 a[148:151], v6, s[68:71], s54 offen
    v_mfma_f32_16x16x32_bf16 v[184:187], a[240:243], v[40:43], v[184:187]
    v_exp_f32 v26, v26
    v_mfma_f32_16x16x32_bf16 v[184:187], a[244:247], v[44:47], v[184:187]
    v_cvt_pk_bf16_f32 v36, v24, v25
    v_mfma_f32_16x16x32_bf16 v[188:191], a[248:251], v[40:43], v[188:191]
    s_add_u32 s54, s55, 5120
    v_exp_f32 v27, v27
    v_mfma_f32_16x16x32_bf16 v[188:191], a[252:255], v[44:47], v[188:191]
    buffer_load_dwordx4 a[184:187], v8, s[72:75], s54 offen
    v_smfmac_f32_16x16x64_bf16 a[4:7], a[16:19], v[40:47], v11
    v_rcp_f32 v12, v12
    v_mfma_f32_16x16x32_bf16 v[16:19], a[64:67], v[112:115], v[60:63]
    v_exp_f32 v28, v28
    v_mfma_f32_16x16x32_bf16 v[16:19], a[68:71], v[116:119], v[16:19]
    v_cvt_pk_bf16_f32 v37, v26, v27
    v_mul_f32 v128, v128, v12
    v_mfma_f32_16x16x32_bf16 v[16:19], a[72:75], v[120:123], v[16:19]
    s_mov_b32 s54, 884736
    v_exp_f32 v29, v29
    v_mfma_f32_16x16x32_bf16 v[16:19], a[76:79], v[124:127], v[16:19]
    buffer_load_dwordx4 a[152:155], v6, s[68:71], s54 offen
    v_mfma_f32_16x16x32_bf16 v[20:23], a[80:83], v[112:115], v[60:63]
    v_exp_f32 v30, v30
    v_mfma_f32_16x16x32_bf16 v[20:23], a[84:87], v[116:119], v[20:23]
    v_cvt_pk_bf16_f32 v38, v28, v29
    v_mul_f32 v129, v129, v12
    v_mfma_f32_16x16x32_bf16 v[20:23], a[88:91], v[120:123], v[20:23]
    s_add_u32 s54, s55, 6144
    v_exp_f32 v31, v31
    v_mfma_f32_16x16x32_bf16 v[20:23], a[92:95], v[124:127], v[20:23]
    buffer_load_dwordx4 a[188:191], v8, s[72:75], s54 offen
    v_mfma_f32_16x16x32_bf16 v[24:27], a[96:99], v[112:115], v[60:63]
    v_exp_f32 v16, v16
    v_mfma_f32_16x16x32_bf16 v[24:27], a[100:103], v[116:119], v[24:27]
    v_cvt_pk_bf16_f32 v39, v30, v31
    v_mul_f32 v130, v130, v12
    v_mfma_f32_16x16x32_bf16 v[24:27], a[104:107], v[120:123], v[24:27]
    s_mov_b32 s54, 1032192
    v_exp_f32 v17, v17
    v_mfma_f32_16x16x32_bf16 v[24:27], a[108:111], v[124:127], v[24:27]
    buffer_load_dwordx4 a[156:159], v6, s[68:71], s54 offen
    v_mfma_f32_16x16x32_bf16 v[28:31], a[112:115], v[112:115], v[60:63]
    v_exp_f32 v18, v18
    v_mfma_f32_16x16x32_bf16 v[28:31], a[116:119], v[116:119], v[28:31]
    v_cvt_pk_bf16_f32 v40, v16, v17
    v_mul_f32 v131, v131, v12
    v_mfma_f32_16x16x32_bf16 v[28:31], a[120:123], v[120:123], v[28:31]
    s_mov_b32 s54, 1179648
    v_exp_f32 v19, v19
    v_mfma_f32_16x16x32_bf16 v[28:31], a[124:127], v[124:127], v[28:31]
    buffer_load_dwordx4 a[160:163], v6, s[68:71], s54 offen
    v_mfma_f32_16x16x32_bf16 v[192:195], a[192:195], v[32:35], v[192:195]
    v_exp_f32 v20, v20
    v_mfma_f32_16x16x32_bf16 v[192:195], a[196:199], v[36:39], v[192:195]
    v_cvt_pk_bf16_f32 v41, v18, v19
    v_mul_f32 v132, v132, v12
    v_mfma_f32_16x16x32_bf16 v[196:199], a[200:203], v[32:35], v[196:199]
    v_exp_f32 v21, v21
    v_mfma_f32_16x16x32_bf16 v[196:199], a[204:207], v[36:39], v[196:199]
    v_mul_f32 v133, v133, v12
    v_mul_f32 v134, v134, v12
    v_mfma_f32_16x16x32_bf16 v[200:203], a[208:211], v[32:35], v[200:203]
    v_exp_f32 v22, v22
    v_mfma_f32_16x16x32_bf16 v[200:203], a[212:215], v[36:39], v[200:203]
    v_cvt_pk_bf16_f32 v42, v20, v21
    v_mul_f32 v135, v135, v12
    v_mfma_f32_16x16x32_bf16 v[204:207], a[216:219], v[32:35], v[204:207]
    v_exp_f32 v23, v23
    v_mfma_f32_16x16x32_bf16 v[204:207], a[220:223], v[36:39], v[204:207]
    v_cvt_pk_bf16_f32 v128, v128, v129
    v_cvt_pk_bf16_f32 v129, v130, v131
    v_mfma_f32_16x16x32_bf16 v[208:211], a[224:227], v[32:35], v[208:211]
    v_exp_f32 v24, v24
    v_mfma_f32_16x16x32_bf16 v[208:211], a[228:231], v[36:39], v[208:211]
    v_cvt_pk_bf16_f32 v43, v22, v23
    v_cvt_pk_bf16_f32 v130, v132, v133
    v_mfma_f32_16x16x32_bf16 v[212:215], a[232:235], v[32:35], v[212:215]
    v_exp_f32 v25, v25
    v_mfma_f32_16x16x32_bf16 v[212:215], a[236:239], v[36:39], v[212:215]
    v_cvt_pk_bf16_f32 v131, v134, v135
    v_mul_f32 v136, v136, v12
    v_mfma_f32_16x16x32_bf16 v[216:219], a[240:243], v[32:35], v[216:219]
    v_exp_f32 v26, v26
    v_mfma_f32_16x16x32_bf16 v[216:219], a[244:247], v[36:39], v[216:219]
    v_cvt_pk_bf16_f32 v44, v24, v25
    v_mul_f32 v137, v137, v12
    v_mfma_f32_16x16x32_bf16 v[220:223], a[248:251], v[32:35], v[220:223]
    v_exp_f32 v27, v27
    v_mfma_f32_16x16x32_bf16 v[220:223], a[252:255], v[36:39], v[220:223]
    v_mul_f32 v138, v138, v12
    v_mul_f32 v139, v139, v12
    v_smfmac_f32_16x16x64_bf16 a[8:11], a[16:19], v[32:39], v11
    v_mul_f32 v140, v140, v12
    v_mul_f32 v141, v141, v12
    v_exp_f32 v28, v28
    s_nop 0
    v_cvt_pk_bf16_f32 v45, v26, v27
    v_exp_f32 v29, v29
    s_nop 0
    v_exp_f32 v30, v30
    s_nop 0
    v_cvt_pk_bf16_f32 v46, v28, v29
    v_exp_f32 v31, v31
    s_nop 0
    v_cvt_pk_bf16_f32 v47, v30, v31
    s_nop 1
    v_mfma_f32_16x16x32_bf16 v[224:227], a[192:195], v[40:43], v[224:227]
    v_mul_f32 v142, v142, v12
    v_mul_f32 v143, v143, v12
    v_mfma_f32_16x16x32_bf16 v[224:227], a[196:199], v[44:47], v[224:227]
    ds_read_b64_tr_b16 a[64:65], v4 offset:0
    ds_read_b64_tr_b16 a[66:67], v4 offset:128
    v_mfma_f32_16x16x32_bf16 v[228:231], a[200:203], v[40:43], v[228:231]
    ds_read_b64_tr_b16 a[68:69], v4 offset:256
    ds_read_b64_tr_b16 a[70:71], v4 offset:384
    v_mfma_f32_16x16x32_bf16 v[228:231], a[204:207], v[44:47], v[228:231]
    ds_read_b64_tr_b16 a[72:73], v4 offset:512
    ds_read_b64_tr_b16 a[74:75], v4 offset:640
    v_mfma_f32_16x16x32_bf16 v[232:235], a[208:211], v[40:43], v[232:235]
    ds_read_b64_tr_b16 a[76:77], v4 offset:768
    ds_read_b64_tr_b16 a[78:79], v4 offset:896
    v_mfma_f32_16x16x32_bf16 v[232:235], a[212:215], v[44:47], v[232:235]
    ds_read_b64_tr_b16 a[80:81], v4 offset:16896
    ds_read_b64_tr_b16 a[82:83], v4 offset:17024
    v_mfma_f32_16x16x32_bf16 v[236:239], a[216:219], v[40:43], v[236:239]
    ds_read_b64_tr_b16 a[84:85], v4 offset:17152
    ds_read_b64_tr_b16 a[86:87], v4 offset:17280
    v_mfma_f32_16x16x32_bf16 v[236:239], a[220:223], v[44:47], v[236:239]
    ds_read_b64_tr_b16 a[88:89], v4 offset:17408
    ds_read_b64_tr_b16 a[90:91], v4 offset:17536
    v_mfma_f32_16x16x32_bf16 v[240:243], a[224:227], v[40:43], v[240:243]
    ds_read_b64_tr_b16 a[92:93], v4 offset:17664
    ds_read_b64_tr_b16 a[94:95], v4 offset:17792
    v_mfma_f32_16x16x32_bf16 v[240:243], a[228:231], v[44:47], v[240:243]
    v_cvt_pk_bf16_f32 v136, v136, v137
    v_cvt_pk_bf16_f32 v137, v138, v139
    v_mfma_f32_16x16x32_bf16 v[244:247], a[232:235], v[40:43], v[244:247]
    v_cvt_pk_bf16_f32 v138, v140, v141
    v_cvt_pk_bf16_f32 v139, v142, v143
    v_mfma_f32_16x16x32_bf16 v[244:247], a[236:239], v[44:47], v[244:247]
    v_mul_f32 v144, v144, v12
    v_mul_f32 v145, v145, v12
    v_mfma_f32_16x16x32_bf16 v[248:251], a[240:243], v[40:43], v[248:251]
    v_mul_f32 v146, v146, v12
    v_mul_f32 v147, v147, v12
    v_mfma_f32_16x16x32_bf16 v[248:251], a[244:247], v[44:47], v[248:251]
    v_mul_f32 v148, v148, v12
    v_mul_f32 v149, v149, v12
    v_mfma_f32_16x16x32_bf16 v[252:255], a[248:251], v[40:43], v[252:255]
    v_mul_f32 v150, v150, v12
    v_mul_f32 v151, v151, v12
    v_mfma_f32_16x16x32_bf16 v[252:255], a[252:255], v[44:47], v[252:255]
    v_cvt_pk_bf16_f32 v144, v144, v145
    v_cvt_pk_bf16_f32 v145, v146, v147
    v_smfmac_f32_16x16x64_bf16 a[12:15], a[16:19], v[40:47], v11
    v_cvt_pk_bf16_f32 v146, v148, v149
    v_cvt_pk_bf16_f32 v147, v150, v151
    v_mul_f32 v152, v152, v12
    v_mul_f32 v153, v153, v12
    v_mul_f32 v154, v154, v12
    v_mul_f32 v155, v155, v12
    v_mul_f32 v156, v156, v12
    v_mul_f32 v157, v157, v12
    v_mul_f32 v158, v158, v12
    v_mul_f32 v159, v159, v12
    v_cvt_pk_bf16_f32 v152, v152, v153
    v_cvt_pk_bf16_f32 v153, v154, v155
    v_cvt_pk_bf16_f32 v154, v156, v157
    v_cvt_pk_bf16_f32 v155, v158, v159
    v_accvgpr_read_b32 v14, a4
    v_accvgpr_read_b32 v15, a5
    v_add_f32 v14, v14, v15
    v_cmp_nlt_f32 s[58:59], v14, s15
    v_rcp_f32 v14, v14
    v_accvgpr_read_b32 v12, a8
    v_accvgpr_read_b32 v13, a9
    v_add_f32 v12, v12, v13
    v_cmp_nlt_f32 s[60:61], v12, s15
    v_rcp_f32 v12, v12
    v_pk_mul_f32 v[160:161], v[160:161], v[14:15] op_sel_hi:[1,0]
    v_pk_mul_f32 v[162:163], v[162:163], v[14:15] op_sel_hi:[1,0]
    v_pk_mul_f32 v[164:165], v[164:165], v[14:15] op_sel_hi:[1,0]
    v_pk_mul_f32 v[166:167], v[166:167], v[14:15] op_sel_hi:[1,0]
    v_cvt_pk_bf16_f32 v160, v160, v161
    v_cvt_pk_bf16_f32 v161, v162, v163
    v_cvt_pk_bf16_f32 v162, v164, v165
    v_cvt_pk_bf16_f32 v163, v166, v167
    v_pk_mul_f32 v[168:169], v[168:169], v[14:15] op_sel_hi:[1,0]
    v_pk_mul_f32 v[170:171], v[170:171], v[14:15] op_sel_hi:[1,0]
    v_pk_mul_f32 v[172:173], v[172:173], v[14:15] op_sel_hi:[1,0]
    v_pk_mul_f32 v[174:175], v[174:175], v[14:15] op_sel_hi:[1,0]
    v_cvt_pk_bf16_f32 v168, v168, v169
    v_cvt_pk_bf16_f32 v169, v170, v171
    v_cvt_pk_bf16_f32 v170, v172, v173
    v_cvt_pk_bf16_f32 v171, v174, v175
    v_pk_mul_f32 v[176:177], v[176:177], v[14:15] op_sel_hi:[1,0]
    v_pk_mul_f32 v[178:179], v[178:179], v[14:15] op_sel_hi:[1,0]
    v_pk_mul_f32 v[180:181], v[180:181], v[14:15] op_sel_hi:[1,0]
    v_pk_mul_f32 v[182:183], v[182:183], v[14:15] op_sel_hi:[1,0]
    v_cvt_pk_bf16_f32 v176, v176, v177
    v_cvt_pk_bf16_f32 v177, v178, v179
    v_cvt_pk_bf16_f32 v178, v180, v181
    v_cvt_pk_bf16_f32 v179, v182, v183
    v_pk_mul_f32 v[184:185], v[184:185], v[14:15] op_sel_hi:[1,0]
    v_pk_mul_f32 v[186:187], v[186:187], v[14:15] op_sel_hi:[1,0]
    v_pk_mul_f32 v[188:189], v[188:189], v[14:15] op_sel_hi:[1,0]
    v_pk_mul_f32 v[190:191], v[190:191], v[14:15] op_sel_hi:[1,0]
    v_cvt_pk_bf16_f32 v184, v184, v185
    v_cvt_pk_bf16_f32 v185, v186, v187
    v_cvt_pk_bf16_f32 v186, v188, v189
    v_cvt_pk_bf16_f32 v187, v190, v191
    v_accvgpr_read_b32 v14, a12
    v_accvgpr_read_b32 v15, a13
    v_add_f32 v14, v14, v15
    v_cmp_nlt_f32 s[62:63], v14, s15
    s_or_b64 s[56:57], s[56:57], s[58:59]
    v_rcp_f32 v14, v14
    s_or_b64 s[60:61], s[60:61], s[62:63]
    s_or_b64 s[56:57], s[56:57], s[60:61]
    s_cselect_b32 s3, 1, 0
    s_andn2_b32 s3, s3, s50
    s_lshl2_add_u32 s14, s51, 13824
    v_mov_b32 v56, s3
    v_mov_b32 v57, s14
    v_mov_b32 v58, 13824
    ds_write_b32 v57, v56
    v_pk_mul_f32 v[192:193], v[192:193], v[12:13] op_sel_hi:[1,0]
    v_pk_mul_f32 v[194:195], v[194:195], v[12:13] op_sel_hi:[1,0]
    v_pk_mul_f32 v[196:197], v[196:197], v[12:13] op_sel_hi:[1,0]
    v_pk_mul_f32 v[198:199], v[198:199], v[12:13] op_sel_hi:[1,0]
    v_cvt_pk_bf16_f32 v192, v192, v193
    v_cvt_pk_bf16_f32 v193, v194, v195
    v_cvt_pk_bf16_f32 v194, v196, v197
    v_cvt_pk_bf16_f32 v195, v198, v199
    v_pk_mul_f32 v[200:201], v[200:201], v[12:13] op_sel_hi:[1,0]
    v_pk_mul_f32 v[202:203], v[202:203], v[12:13] op_sel_hi:[1,0]
    v_pk_mul_f32 v[204:205], v[204:205], v[12:13] op_sel_hi:[1,0]
    v_pk_mul_f32 v[206:207], v[206:207], v[12:13] op_sel_hi:[1,0]
    v_cvt_pk_bf16_f32 v200, v200, v201
    v_cvt_pk_bf16_f32 v201, v202, v203
    v_cvt_pk_bf16_f32 v202, v204, v205
    v_cvt_pk_bf16_f32 v203, v206, v207
    v_pk_mul_f32 v[208:209], v[208:209], v[12:13] op_sel_hi:[1,0]
    v_pk_mul_f32 v[210:211], v[210:211], v[12:13] op_sel_hi:[1,0]
    v_pk_mul_f32 v[212:213], v[212:213], v[12:13] op_sel_hi:[1,0]
    v_pk_mul_f32 v[214:215], v[214:215], v[12:13] op_sel_hi:[1,0]
    v_cvt_pk_bf16_f32 v208, v208, v209
    v_cvt_pk_bf16_f32 v209, v210, v211
    v_cvt_pk_bf16_f32 v210, v212, v213
    v_cvt_pk_bf16_f32 v211, v214, v215
    v_pk_mul_f32 v[216:217], v[216:217], v[12:13] op_sel_hi:[1,0]
    v_pk_mul_f32 v[218:219], v[218:219], v[12:13] op_sel_hi:[1,0]
    v_pk_mul_f32 v[220:221], v[220:221], v[12:13] op_sel_hi:[1,0]
    v_pk_mul_f32 v[222:223], v[222:223], v[12:13] op_sel_hi:[1,0]
    v_cvt_pk_bf16_f32 v216, v216, v217
    v_cvt_pk_bf16_f32 v217, v218, v219
    v_cvt_pk_bf16_f32 v218, v220, v221
    v_cvt_pk_bf16_f32 v219, v222, v223
    v_pk_mul_f32 v[224:225], v[224:225], v[14:15] op_sel_hi:[1,0]
    v_pk_mul_f32 v[226:227], v[226:227], v[14:15] op_sel_hi:[1,0]
    v_pk_mul_f32 v[228:229], v[228:229], v[14:15] op_sel_hi:[1,0]
    v_pk_mul_f32 v[230:231], v[230:231], v[14:15] op_sel_hi:[1,0]
    v_cvt_pk_bf16_f32 v224, v224, v225
    v_cvt_pk_bf16_f32 v225, v226, v227
    v_cvt_pk_bf16_f32 v226, v228, v229
    v_cvt_pk_bf16_f32 v227, v230, v231
    v_pk_mul_f32 v[232:233], v[232:233], v[14:15] op_sel_hi:[1,0]
    v_pk_mul_f32 v[234:235], v[234:235], v[14:15] op_sel_hi:[1,0]
    v_pk_mul_f32 v[236:237], v[236:237], v[14:15] op_sel_hi:[1,0]
    v_pk_mul_f32 v[238:239], v[238:239], v[14:15] op_sel_hi:[1,0]
    v_cvt_pk_bf16_f32 v232, v232, v233
    v_cvt_pk_bf16_f32 v233, v234, v235
    v_cvt_pk_bf16_f32 v234, v236, v237
    v_cvt_pk_bf16_f32 v235, v238, v239
    v_pk_mul_f32 v[240:241], v[240:241], v[14:15] op_sel_hi:[1,0]
    v_pk_mul_f32 v[242:243], v[242:243], v[14:15] op_sel_hi:[1,0]
    v_pk_mul_f32 v[244:245], v[244:245], v[14:15] op_sel_hi:[1,0]
L2_pad10:
    s_cbranch_execz L2_pad14
    v_pk_mul_f32 v[246:247], v[246:247], v[14:15] op_sel_hi:[1,0]
    v_cvt_pk_bf16_f32 v240, v240, v241
    v_cvt_pk_bf16_f32 v241, v242, v243
    v_cvt_pk_bf16_f32 v242, v244, v245
    v_cvt_pk_bf16_f32 v243, v246, v247
    v_pk_mul_f32 v[248:249], v[248:249], v[14:15] op_sel_hi:[1,0]
    v_pk_mul_f32 v[250:251], v[250:251], v[14:15] op_sel_hi:[1,0]
    v_pk_mul_f32 v[252:253], v[252:253], v[14:15] op_sel_hi:[1,0]
    v_pk_mul_f32 v[254:255], v[254:255], v[14:15] op_sel_hi:[1,0]
    v_cvt_pk_bf16_f32 v248, v248, v249
    v_cvt_pk_bf16_f32 v249, v250, v251
    v_cvt_pk_bf16_f32 v250, v252, v253
    v_cvt_pk_bf16_f32 v251, v254, v255
    s_waitcnt lgkmcnt(13)
    v_mfma_f32_16x16x32_bf16 v[16:19], a[64:67], v[128:131], 0
    ds_read_b64_tr_b16 a[96:97], v4 offset:32
    ds_read_b64_tr_b16 a[98:99], v4 offset:160
    v_mfma_f32_16x16x32_bf16 v[16:19], a[68:71], v[136:139], v[16:19]
    s_waitcnt lgkmcnt(11)
    ds_read_b64_tr_b16 a[100:101], v4 offset:288
    ds_read_b64_tr_b16 a[102:103], v4 offset:416
    v_mfma_f32_16x16x32_bf16 v[16:19], a[72:75], v[144:147], v[16:19]
    s_add_u32 s54, s55, 7168
    ds_read_b64_tr_b16 a[104:105], v4 offset:544
    v_mfma_f32_16x16x32_bf16 v[16:19], a[76:79], v[152:155], v[16:19]
    s_waitcnt lgkmcnt(10)
    buffer_load_dwordx4 a[192:195], v8, s[72:75], s54 offen
    v_mfma_f32_16x16x32_bf16 v[16:19], a[80:83], v[192:195], v[16:19]
    ds_read_b64_tr_b16 a[106:107], v4 offset:672
    v_mfma_f32_16x16x32_bf16 v[16:19], a[84:87], v[200:203], v[16:19]
    s_waitcnt lgkmcnt(7)
    ds_read_b64_tr_b16 a[108:109], v4 offset:800
    v_mfma_f32_16x16x32_bf16 v[16:19], a[88:91], v[208:211], v[16:19]
    s_add_u32 s54, s55, 8192
    ds_read_b64_tr_b16 a[110:111], v4 offset:928
    v_mfma_f32_16x16x32_bf16 v[16:19], a[92:95], v[216:219], v[16:19]
    buffer_load_dwordx4 a[196:199], v8, s[72:75], s54 offen
    v_mfma_f32_16x16x32_bf16 v[20:23], a[64:67], v[160:163], 0
    ds_read_b64_tr_b16 a[112:113], v4 offset:16928
    v_mfma_f32_16x16x32_bf16 v[20:23], a[68:71], v[168:171], v[20:23]
    ds_read_b64_tr_b16 a[114:115], v4 offset:17056
    v_mfma_f32_16x16x32_bf16 v[20:23], a[72:75], v[176:179], v[20:23]
    ds_read_b64_tr_b16 a[116:117], v4 offset:17184
    v_mfma_f32_16x16x32_bf16 v[20:23], a[76:79], v[184:187], v[20:23]
    ds_read_b64_tr_b16 a[118:119], v4 offset:17312
    v_mfma_f32_16x16x32_bf16 v[20:23], a[80:83], v[224:227], v[20:23]
    ds_read_b64_tr_b16 a[120:121], v4 offset:17440
    v_mfma_f32_16x16x32_bf16 v[20:23], a[84:87], v[232:235], v[20:23]
    ds_read_b64_tr_b16 a[122:123], v4 offset:17568
    v_mfma_f32_16x16x32_bf16 v[20:23], a[88:91], v[240:243], v[20:23]
    ds_read_b64_tr_b16 a[124:125], v4 offset:17696
    v_mfma_f32_16x16x32_bf16 v[20:23], a[92:95], v[248:251], v[20:23]
    s_waitcnt lgkmcnt(11)
    ds_read_b64_tr_b16 a[126:127], v4 offset:17824
    v_mfma_f32_16x16x32_bf16 v[24:27], a[96:99], v[128:131], 0
    ds_read_b64_tr_b16 a[64:65], v4 offset:64
    v_mfma_f32_16x16x32_bf16 v[24:27], a[100:103], v[136:139], v[24:27]
    s_waitcnt lgkmcnt(9)
    ds_read_b64_tr_b16 a[66:67], v4 offset:192
    v_mfma_f32_16x16x32_bf16 v[24:27], a[104:107], v[144:147], v[24:27]
    ds_read_b64_tr_b16 a[68:69], v4 offset:320
    v_mfma_f32_16x16x32_bf16 v[24:27], a[108:111], v[152:155], v[24:27]
    s_waitcnt lgkmcnt(7)
    ds_read_b64_tr_b16 a[70:71], v4 offset:448
    v_mfma_f32_16x16x32_bf16 v[24:27], a[112:115], v[192:195], v[24:27]
    ds_read_b64_tr_b16 a[72:73], v4 offset:576
    v_mfma_f32_16x16x32_bf16 v[24:27], a[116:119], v[200:203], v[24:27]
    s_waitcnt lgkmcnt(5)
    ds_read_b64_tr_b16 a[74:75], v4 offset:704
    v_mfma_f32_16x16x32_bf16 v[24:27], a[120:123], v[208:211], v[24:27]
    ds_read_b64_tr_b16 a[76:77], v4 offset:832
    v_mfma_f32_16x16x32_bf16 v[24:27], a[124:127], v[216:219], v[24:27]
    ds_read_b64_tr_b16 a[78:79], v4 offset:960
    v_mfma_f32_16x16x32_bf16 v[28:31], a[96:99], v[160:163], 0
    ds_read_b64_tr_b16 a[80:81], v4 offset:16960
    v_mfma_f32_16x16x32_bf16 v[28:31], a[100:103], v[168:171], v[28:31]
    ds_read_b64_tr_b16 a[82:83], v4 offset:17088
    v_mfma_f32_16x16x32_bf16 v[28:31], a[104:107], v[176:179], v[28:31]
    ds_read_b64_tr_b16 a[84:85], v4 offset:17216
    v_mfma_f32_16x16x32_bf16 v[28:31], a[108:111], v[184:187], v[28:31]
    ds_read_b64_tr_b16 a[86:87], v4 offset:17344
    v_mfma_f32_16x16x32_bf16 v[28:31], a[112:115], v[224:227], v[28:31]
    ds_read_b64_tr_b16 a[88:89], v4 offset:17472
    v_mfma_f32_16x16x32_bf16 v[28:31], a[116:119], v[232:235], v[28:31]
    ds_read_b64_tr_b16 a[90:91], v4 offset:17600
    v_mfma_f32_16x16x32_bf16 v[28:31], a[120:123], v[240:243], v[28:31]
    ds_read_b64_tr_b16 a[92:93], v4 offset:17728
    v_mfma_f32_16x16x32_bf16 v[28:31], a[124:127], v[248:251], v[28:31]
    s_waitcnt lgkmcnt(11)
    ds_read_b64_tr_b16 a[94:95], v4 offset:17856
    v_mfma_f32_16x16x32_bf16 v[32:35], a[64:67], v[128:131], 0
    ds_read_b64_tr_b16 a[96:97], v4 offset:96
    v_cvt_pk_bf16_f32 v48, v16, v17
    v_mfma_f32_16x16x32_bf16 v[32:35], a[68:71], v[136:139], v[32:35]
    s_waitcnt lgkmcnt(9)
    ds_read_b64_tr_b16 a[98:99], v4 offset:224
    v_cvt_pk_bf16_f32 v49, v18, v19
    v_mfma_f32_16x16x32_bf16 v[32:35], a[72:75], v[144:147], v[32:35]
    ds_read_b64_tr_b16 a[100:101], v4 offset:352
    v_cvt_pk_bf16_f32 v50, v24, v25
    v_mfma_f32_16x16x32_bf16 v[32:35], a[76:79], v[152:155], v[32:35]
    s_waitcnt lgkmcnt(7)
    ds_read_b64_tr_b16 a[102:103], v4 offset:480
    v_cvt_pk_bf16_f32 v51, v26, v27
    v_mfma_f32_16x16x32_bf16 v[32:35], a[80:83], v[192:195], v[32:35]
    s_mov_b32 s54, 0
    ds_read_b64_tr_b16 a[104:105], v4 offset:608
    ds_read_b64_tr_b16 a[106:107], v4 offset:736
    v_mfma_f32_16x16x32_bf16 v[32:35], a[84:87], v[200:203], v[32:35]
    s_waitcnt lgkmcnt(6)
    v_permlane32_swap_b32 v48, v50
    v_mfma_f32_16x16x32_bf16 v[32:35], a[88:91], v[208:211], v[32:35]
    v_permlane32_swap_b32 v49, v51
    v_mfma_f32_16x16x32_bf16 v[32:35], a[92:95], v[216:219], v[32:35]
    ds_read_b64_tr_b16 a[108:109], v4 offset:864
    ds_read_b64_tr_b16 a[110:111], v4 offset:992
    buffer_store_dwordx4 v[48:51], v10, s[40:43], s54 offen offset:0 sc1
    v_mfma_f32_16x16x32_bf16 v[36:39], a[64:67], v[160:163], 0
    ds_read_b64_tr_b16 a[112:113], v4 offset:16992
    v_cvt_pk_bf16_f32 v52, v20, v21
    v_mfma_f32_16x16x32_bf16 v[36:39], a[68:71], v[168:171], v[36:39]
    ds_read_b64_tr_b16 a[114:115], v4 offset:17120
    v_cvt_pk_bf16_f32 v53, v22, v23
    v_mfma_f32_16x16x32_bf16 v[36:39], a[72:75], v[176:179], v[36:39]
    ds_read_b64_tr_b16 a[116:117], v4 offset:17248
    v_cvt_pk_bf16_f32 v54, v28, v29
    v_mfma_f32_16x16x32_bf16 v[36:39], a[76:79], v[184:187], v[36:39]
    ds_read_b64_tr_b16 a[118:119], v4 offset:17376
    v_cvt_pk_bf16_f32 v55, v30, v31
    v_mfma_f32_16x16x32_bf16 v[36:39], a[80:83], v[224:227], v[36:39]
    s_mov_b32 s54, 294912
    ds_read_b64_tr_b16 a[120:121], v4 offset:17504
    ds_read_b64_tr_b16 a[122:123], v4 offset:17632
    v_mfma_f32_16x16x32_bf16 v[36:39], a[84:87], v[232:235], v[36:39]
    v_permlane32_swap_b32 v52, v54
    v_mfma_f32_16x16x32_bf16 v[36:39], a[88:91], v[240:243], v[36:39]
    v_permlane32_swap_b32 v53, v55
    v_mfma_f32_16x16x32_bf16 v[36:39], a[92:95], v[248:251], v[36:39]
    s_barrier
    s_waitcnt lgkmcnt(10)
    ds_read_b64_tr_b16 a[124:125], v4 offset:17760
    ds_read_b64_tr_b16 a[126:127], v4 offset:17888
    ds_read_b128 v[60:63], v58
    buffer_store_dwordx4 v[52:55], v10, s[40:43], s54 offen offset:0 sc1
    v_mfma_f32_16x16x32_bf16 v[40:43], a[96:99], v[128:131], 0
    s_add_u32 m0, s44, 36864
    ds_read_b64_tr_b16 a[64:65], v4 offset:36864
    ds_read_b64_tr_b16 a[66:67], v4 offset:36992
    v_mfma_f32_16x16x32_bf16 v[40:43], a[100:103], v[136:139], v[40:43]
    s_mov_b32 s45, 384
    s_waitcnt lgkmcnt(11)
    buffer_load_dwordx4 v7, s[28:31], s45 offen offset:0 lds
    v_mfma_f32_16x16x32_bf16 v[40:43], a[104:107], v[144:147], v[40:43]
    s_add_u32 m0, s44, 36768
    ds_read_b64_tr_b16 a[68:69], v4 offset:37120
    ds_read_b64_tr_b16 a[70:71], v4 offset:37248
    v_mfma_f32_16x16x32_bf16 v[40:43], a[108:111], v[152:155], v[40:43]
    s_waitcnt lgkmcnt(9)
    buffer_load_dwordx4 v7, s[28:31], s45 offen offset:1152 lds
    v_mfma_f32_16x16x32_bf16 v[40:43], a[112:115], v[192:195], v[40:43]
    s_add_u32 m0, s44, 36672
    ds_read_b64_tr_b16 a[72:73], v4 offset:37376
    ds_read_b64_tr_b16 a[74:75], v4 offset:37504
    v_mfma_f32_16x16x32_bf16 v[40:43], a[116:119], v[200:203], v[40:43]
    s_waitcnt lgkmcnt(7)
    buffer_load_dwordx4 v7, s[28:31], s45 offen offset:2304 lds
    v_mfma_f32_16x16x32_bf16 v[40:43], a[120:123], v[208:211], v[40:43]
    s_add_u32 m0, s44, 36576
    ds_read_b64_tr_b16 a[76:77], v4 offset:37632
    ds_read_b64_tr_b16 a[78:79], v4 offset:37760
    v_mfma_f32_16x16x32_bf16 v[40:43], a[124:127], v[216:219], v[40:43]
    s_waitcnt lgkmcnt(8)
    buffer_load_dwordx4 v7, s[28:31], s45 offen offset:3456 lds
    v_or3_b32 v60, v60, v61, v62
    v_or_b32 v60, v60, v63
    v_mfma_f32_16x16x32_bf16 v[44:47], a[96:99], v[160:163], 0
    s_add_u32 m0, s44, 53760
    ds_read_b64_tr_b16 a[80:81], v4 offset:53760
    ds_read_b64_tr_b16 a[82:83], v4 offset:53888
    v_mfma_f32_16x16x32_bf16 v[44:47], a[100:103], v[168:171], v[44:47]
    s_mov_b32 s45, 147840
    buffer_load_dwordx4 v7, s[28:31], s45 offen offset:0 lds
    v_mfma_f32_16x16x32_bf16 v[44:47], a[104:107], v[176:179], v[44:47]
    s_add_u32 m0, s44, 53664
    ds_read_b64_tr_b16 a[84:85], v4 offset:54016
    ds_read_b64_tr_b16 a[86:87], v4 offset:54144
    v_mfma_f32_16x16x32_bf16 v[44:47], a[108:111], v[184:187], v[44:47]
    buffer_load_dwordx4 v7, s[28:31], s45 offen offset:1152 lds
    v_mfma_f32_16x16x32_bf16 v[44:47], a[112:115], v[224:227], v[44:47]
    s_add_u32 m0, s44, 53568
    ds_read_b64_tr_b16 a[88:89], v4 offset:54272
    ds_read_b64_tr_b16 a[90:91], v4 offset:54400
    v_mfma_f32_16x16x32_bf16 v[44:47], a[116:119], v[232:235], v[44:47]
    buffer_load_dwordx4 v7, s[28:31], s45 offen offset:2304 lds
    v_mfma_f32_16x16x32_bf16 v[44:47], a[120:123], v[240:243], v[44:47]
    s_add_u32 m0, s44, 53472
    ds_read_b64_tr_b16 a[92:93], v4 offset:54528
    ds_read_b64_tr_b16 a[94:95], v4 offset:54656
    v_mfma_f32_16x16x32_bf16 v[44:47], a[124:127], v[248:251], v[44:47]
    s_waitcnt lgkmcnt(12)
    buffer_load_dwordx4 v7, s[28:31], s45 offen offset:3456 lds
    v_readfirstlane_b32 s3, v60
    v_mfma_f32_16x16x32_bf16 v[16:19], a[64:67], v[128:131], 0
    ds_read_b64_tr_b16 a[96:97], v4 offset:36896
    v_cvt_pk_bf16_f32 v48, v32, v33
    v_mfma_f32_16x16x32_bf16 v[16:19], a[68:71], v[136:139], v[16:19]
    s_waitcnt lgkmcnt(9)
    s_cmp_lg_u32 s3, 0
    ds_read_b64_tr_b16 a[98:99], v4 offset:37024
    v_cvt_pk_bf16_f32 v49, v34, v35
    v_mfma_f32_16x16x32_bf16 v[16:19], a[72:75], v[144:147], v[16:19]
    s_cbranch_scc1 L2_fallback
    ds_read_b64_tr_b16 a[100:101], v4 offset:37152
    v_cvt_pk_bf16_f32 v50, v40, v41
    v_mfma_f32_16x16x32_bf16 v[16:19], a[76:79], v[152:155], v[16:19]
    s_waitcnt lgkmcnt(7)
    ds_read_b64_tr_b16 a[102:103], v4 offset:37280
    v_cvt_pk_bf16_f32 v51, v42, v43
    v_mfma_f32_16x16x32_bf16 v[16:19], a[80:83], v[192:195], v[16:19]
    s_mov_b32 s54, 0
    ds_read_b64_tr_b16 a[104:105], v4 offset:37408
    ds_read_b64_tr_b16 a[106:107], v4 offset:37536
    v_mfma_f32_16x16x32_bf16 v[16:19], a[84:87], v[200:203], v[16:19]
    s_waitcnt lgkmcnt(6)
    v_permlane32_swap_b32 v48, v50
    v_mfma_f32_16x16x32_bf16 v[16:19], a[88:91], v[208:211], v[16:19]
    v_permlane32_swap_b32 v49, v51
    v_mfma_f32_16x16x32_bf16 v[16:19], a[92:95], v[216:219], v[16:19]
    ds_read_b64_tr_b16 a[108:109], v4 offset:37664
    ds_read_b64_tr_b16 a[110:111], v4 offset:37792
    buffer_store_dwordx4 v[48:51], v10, s[40:43], s54 offen offset:512 sc1
    v_mfma_f32_16x16x32_bf16 v[20:23], a[64:67], v[160:163], 0
    ds_read_b64_tr_b16 a[112:113], v4 offset:53792
    v_cvt_pk_bf16_f32 v52, v36, v37
    v_mfma_f32_16x16x32_bf16 v[20:23], a[68:71], v[168:171], v[20:23]
    ds_read_b64_tr_b16 a[114:115], v4 offset:53920
    v_cvt_pk_bf16_f32 v53, v38, v39
    v_mfma_f32_16x16x32_bf16 v[20:23], a[72:75], v[176:179], v[20:23]
    ds_read_b64_tr_b16 a[116:117], v4 offset:54048
    v_cvt_pk_bf16_f32 v54, v44, v45
    v_mfma_f32_16x16x32_bf16 v[20:23], a[76:79], v[184:187], v[20:23]
    ds_read_b64_tr_b16 a[118:119], v4 offset:54176
    v_cvt_pk_bf16_f32 v55, v46, v47
    v_mfma_f32_16x16x32_bf16 v[20:23], a[80:83], v[224:227], v[20:23]
    s_mov_b32 s54, 294912
    ds_read_b64_tr_b16 a[120:121], v4 offset:54304
    ds_read_b64_tr_b16 a[122:123], v4 offset:54432
    v_mfma_f32_16x16x32_bf16 v[20:23], a[84:87], v[232:235], v[20:23]
    v_permlane32_swap_b32 v52, v54
    v_mfma_f32_16x16x32_bf16 v[20:23], a[88:91], v[240:243], v[20:23]
    v_permlane32_swap_b32 v53, v55
    v_mfma_f32_16x16x32_bf16 v[20:23], a[92:95], v[248:251], v[20:23]
    s_waitcnt lgkmcnt(10)
    ds_read_b64_tr_b16 a[124:125], v4 offset:54560
    ds_read_b64_tr_b16 a[126:127], v4 offset:54688
    buffer_store_dwordx4 v[52:55], v10, s[40:43], s54 offen offset:512 sc1
    v_mfma_f32_16x16x32_bf16 v[24:27], a[96:99], v[128:131], 0
    s_mul_i32 s3, s51, 128
    ds_read_b64_tr_b16 a[64:65], v4 offset:36928
    v_lshrrev_b32 v14, 3, v0
    v_mfma_f32_16x16x32_bf16 v[24:27], a[100:103], v[136:139], v[24:27]
    s_waitcnt lgkmcnt(9)
    ds_read_b64_tr_b16 a[66:67], v4 offset:37056
    v_lshl_add_u32 v12, v14, 4, s3
    v_mfma_f32_16x16x32_bf16 v[24:27], a[104:107], v[144:147], v[24:27]
    ds_read_b64_tr_b16 a[68:69], v4 offset:37184
    v_and_b32 v14, 1, v14
    v_mfma_f32_16x16x32_bf16 v[24:27], a[108:111], v[152:155], v[24:27]
    s_waitcnt lgkmcnt(7)
    s_mul_i32 s3, s51, 32
    ds_read_b64_tr_b16 a[70:71], v4 offset:37312
    v_lshl_add_u32 v13, v14, 4, s3
    v_mfma_f32_16x16x32_bf16 v[24:27], a[112:115], v[192:195], v[24:27]
    ds_read_b64_tr_b16 a[72:73], v4 offset:37440
    v_and_b32 v14, 7, v0
    v_mfma_f32_16x16x32_bf16 v[24:27], a[116:119], v[200:203], v[24:27]
    s_waitcnt lgkmcnt(5)
    ds_read_b64_tr_b16 a[74:75], v4 offset:37568
    v_mul_u32_u24 v14, 1152, v14
    v_mfma_f32_16x16x32_bf16 v[24:27], a[120:123], v[208:211], v[24:27]
    ds_read_b64_tr_b16 a[76:77], v4 offset:37696
    v_add_u32 v1, v14, v12
    v_mfma_f32_16x16x32_bf16 v[24:27], a[124:127], v[216:219], v[24:27]
    ds_read_b64_tr_b16 a[78:79], v4 offset:37824
    v_add_u32 v2, v14, v13
    v_mfma_f32_16x16x32_bf16 v[28:31], a[96:99], v[160:163], 0
    ds_read_b64_tr_b16 a[80:81], v4 offset:53824
    v_add_u32 v2, 1024, v2
    v_mfma_f32_16x16x32_bf16 v[28:31], a[100:103], v[168:171], v[28:31]
    s_lshl_b32 s14, s51, 10
    ds_read_b64_tr_b16 a[82:83], v4 offset:53952
    v_add_u32 v5, s14, v8
    v_mfma_f32_16x16x32_bf16 v[28:31], a[104:107], v[176:179], v[28:31]
    ds_read_b64_tr_b16 a[84:85], v4 offset:54080
    v_and_b32 v59, 0xf0, v8
    v_mfma_f32_16x16x32_bf16 v[28:31], a[108:111], v[184:187], v[28:31]
    s_lshl_b32 s14, s51, 8
    ds_read_b64_tr_b16 a[86:87], v4 offset:54208
    v_add_u32 v59, s14, v59
    v_mfma_f32_16x16x32_bf16 v[28:31], a[112:115], v[224:227], v[28:31]
    ds_read_b64_tr_b16 a[88:89], v4 offset:54336
    v_and_b32 v6, 15, v0
    v_mfma_f32_16x16x32_bf16 v[28:31], a[116:119], v[232:235], v[28:31]
    ds_read_b64_tr_b16 a[90:91], v4 offset:54464
    v_lshlrev_b32 v6, 8, v6
    v_mfma_f32_16x16x32_bf16 v[28:31], a[120:123], v[240:243], v[28:31]
    ds_read_b64_tr_b16 a[92:93], v4 offset:54592
    v_min_u32 v15, 1, v0
    v_mfma_f32_16x16x32_bf16 v[28:31], a[124:127], v[248:251], v[28:31]
    s_waitcnt lgkmcnt(11)
    ds_read_b64_tr_b16 a[94:95], v4 offset:54720
    v_lshlrev_b32 v15, 30, v15
    v_mfma_f32_16x16x32_bf16 v[32:35], a[64:67], v[128:131], 0
    s_lshl_b32 s15, s53, 14
    s_add_u32 s15, s15, 786432
    s_and_b32 s14, s52, 12
    s_lshl_b32 s14, s14, 10
    s_add_u32 s47, s15, s14
    s_lshl4_add_u32 s3, s51, s52
    s_lshl_b32 s3, s3, 8
    s_add_u32 s56, s3, s15
    s_add_u32 s14, s55, 16384
    ds_read_b64_tr_b16 a[96:97], v4 offset:36960
    v_cvt_pk_bf16_f32 v48, v16, v17
    v_mfma_f32_16x16x32_bf16 v[32:35], a[68:71], v[136:139], v[32:35]
    s_waitcnt lgkmcnt(9)
    ds_read_b64_tr_b16 a[98:99], v4 offset:37088
    v_cvt_pk_bf16_f32 v49, v18, v19
    v_mfma_f32_16x16x32_bf16 v[32:35], a[72:75], v[144:147], v[32:35]
    ds_read_b64_tr_b16 a[100:101], v4 offset:37216
    v_cvt_pk_bf16_f32 v50, v24, v25
    v_mfma_f32_16x16x32_bf16 v[32:35], a[76:79], v[152:155], v[32:35]
    s_waitcnt lgkmcnt(7)
    ds_read_b64_tr_b16 a[102:103], v4 offset:37344
    v_cvt_pk_bf16_f32 v51, v26, v27
    v_mfma_f32_16x16x32_bf16 v[32:35], a[80:83], v[192:195], v[32:35]
    s_mov_b32 s54, 1024
    ds_read_b64_tr_b16 a[104:105], v4 offset:37472
    ds_read_b64_tr_b16 a[106:107], v4 offset:37600
    v_mfma_f32_16x16x32_bf16 v[32:35], a[84:87], v[200:203], v[32:35]
    s_waitcnt lgkmcnt(6)
    v_permlane32_swap_b32 v48, v50
    v_mfma_f32_16x16x32_bf16 v[32:35], a[88:91], v[208:211], v[32:35]
    v_permlane32_swap_b32 v49, v51
    v_mfma_f32_16x16x32_bf16 v[32:35], a[92:95], v[216:219], v[32:35]
    ds_read_b64_tr_b16 a[108:109], v4 offset:37728
    ds_read_b64_tr_b16 a[110:111], v4 offset:37856
    buffer_store_dwordx4 v[48:51], v10, s[40:43], s54 offen offset:0 sc1
    v_mfma_f32_16x16x32_bf16 v[36:39], a[64:67], v[160:163], 0
    ds_read_b64_tr_b16 a[112:113], v4 offset:53856
    v_cvt_pk_bf16_f32 v52, v20, v21
    v_mfma_f32_16x16x32_bf16 v[36:39], a[68:71], v[168:171], v[36:39]
    ds_read_b64_tr_b16 a[114:115], v4 offset:53984
    v_cvt_pk_bf16_f32 v53, v22, v23
    v_mfma_f32_16x16x32_bf16 v[36:39], a[72:75], v[176:179], v[36:39]
    ds_read_b64_tr_b16 a[116:117], v4 offset:54112
    v_cvt_pk_bf16_f32 v54, v28, v29
    v_mfma_f32_16x16x32_bf16 v[36:39], a[76:79], v[184:187], v[36:39]
    ds_read_b64_tr_b16 a[118:119], v4 offset:54240
    v_cvt_pk_bf16_f32 v55, v30, v31
    v_mfma_f32_16x16x32_bf16 v[36:39], a[80:83], v[224:227], v[36:39]
    s_mov_b32 s54, 295936
    ds_read_b64_tr_b16 a[120:121], v4 offset:54368
    ds_read_b64_tr_b16 a[122:123], v4 offset:54496
    v_mfma_f32_16x16x32_bf16 v[36:39], a[84:87], v[232:235], v[36:39]
    v_permlane32_swap_b32 v52, v54
    v_mfma_f32_16x16x32_bf16 v[36:39], a[88:91], v[240:243], v[36:39]
    v_permlane32_swap_b32 v53, v55
    v_mfma_f32_16x16x32_bf16 v[36:39], a[92:95], v[248:251], v[36:39]
    s_waitcnt vmcnt(31)
    s_barrier
    s_waitcnt lgkmcnt(10)
    ds_read_b64_tr_b16 a[124:125], v4 offset:54624
    ds_read_b64_tr_b16 a[126:127], v4 offset:54752
    buffer_store_dwordx4 v[52:55], v10, s[40:43], s54 offen offset:0 sc1
    v_mfma_f32_16x16x32_bf16 v[40:43], a[96:99], v[128:131], 0
    s_add_u32 m0, s44, 73728
    ds_read_b64_tr_b16 a[64:65], v3 offset:0
    ds_read_b64_tr_b16 a[66:67], v3 offset:128
    v_mfma_f32_16x16x32_bf16 v[40:43], a[100:103], v[136:139], v[40:43]
    s_mov_b32 s45, 512
    s_waitcnt lgkmcnt(10)
    buffer_load_dwordx4 v7, s[28:31], s45 offen offset:0 lds
    v_mfma_f32_16x16x32_bf16 v[40:43], a[104:107], v[144:147], v[40:43]
    s_add_u32 m0, s44, 73632
    ds_read_b64_tr_b16 a[68:69], v3 offset:256
    ds_read_b64_tr_b16 a[70:71], v3 offset:384
    v_mfma_f32_16x16x32_bf16 v[40:43], a[108:111], v[152:155], v[40:43]
    s_waitcnt lgkmcnt(8)
    buffer_load_dwordx4 v7, s[28:31], s45 offen offset:1152 lds
    v_mfma_f32_16x16x32_bf16 v[40:43], a[112:115], v[192:195], v[40:43]
    s_add_u32 m0, s44, 73536
    ds_read_b64_tr_b16 a[72:73], v3 offset:512
    ds_read_b64_tr_b16 a[74:75], v3 offset:640
    v_mfma_f32_16x16x32_bf16 v[40:43], a[116:119], v[200:203], v[40:43]
    s_waitcnt lgkmcnt(6)
    buffer_load_dwordx4 v7, s[28:31], s45 offen offset:2304 lds
    v_mfma_f32_16x16x32_bf16 v[40:43], a[120:123], v[208:211], v[40:43]
    s_add_u32 m0, s44, 73440
    ds_read_b64_tr_b16 a[76:77], v3 offset:768
    ds_read_b64_tr_b16 a[78:79], v3 offset:896
    v_mfma_f32_16x16x32_bf16 v[40:43], a[124:127], v[216:219], v[40:43]
    buffer_load_dwordx4 v7, s[28:31], s45 offen offset:3456 lds
    v_mfma_f32_16x16x32_bf16 v[44:47], a[96:99], v[160:163], 0
    s_add_u32 m0, s44, 90624
    ds_read_b64_tr_b16 a[80:81], v3 offset:16896
    ds_read_b64_tr_b16 a[82:83], v3 offset:17024
    v_mfma_f32_16x16x32_bf16 v[44:47], a[100:103], v[168:171], v[44:47]
    s_mov_b32 s45, 147968
    buffer_load_dwordx4 v7, s[28:31], s45 offen offset:0 lds
    v_mfma_f32_16x16x32_bf16 v[44:47], a[104:107], v[176:179], v[44:47]
    s_add_u32 m0, s44, 90528
    ds_read_b64_tr_b16 a[84:85], v3 offset:17152
    ds_read_b64_tr_b16 a[86:87], v3 offset:17280
    v_mfma_f32_16x16x32_bf16 v[44:47], a[108:111], v[184:187], v[44:47]
    buffer_load_dwordx4 v7, s[28:31], s45 offen offset:1152 lds
    v_mfma_f32_16x16x32_bf16 v[44:47], a[112:115], v[224:227], v[44:47]
    s_add_u32 m0, s44, 90432
    ds_read_b64_tr_b16 a[88:89], v3 offset:17408
    ds_read_b64_tr_b16 a[90:91], v3 offset:17536
    v_mfma_f32_16x16x32_bf16 v[44:47], a[116:119], v[232:235], v[44:47]
    buffer_load_dwordx4 v7, s[28:31], s45 offen offset:2304 lds
    v_mfma_f32_16x16x32_bf16 v[44:47], a[120:123], v[240:243], v[44:47]
    s_add_u32 m0, s44, 90336
    ds_read_b64_tr_b16 a[92:93], v3 offset:17664
    ds_read_b64_tr_b16 a[94:95], v3 offset:17792
    v_mfma_f32_16x16x32_bf16 v[44:47], a[124:127], v[248:251], v[44:47]
    s_waitcnt lgkmcnt(12)
    buffer_load_dwordx4 v7, s[28:31], s45 offen offset:3456 lds
    v_mfma_f32_16x16x32_bf16 v[16:19], a[64:67], v[128:131], 0
    ds_read_b64_tr_b16 a[96:97], v3 offset:32
    v_cvt_pk_bf16_f32 v48, v32, v33
    v_mfma_f32_16x16x32_bf16 v[16:19], a[68:71], v[136:139], v[16:19]
    s_waitcnt lgkmcnt(9)
    ds_read_b64_tr_b16 a[98:99], v3 offset:160
    v_cvt_pk_bf16_f32 v49, v34, v35
    v_mfma_f32_16x16x32_bf16 v[16:19], a[72:75], v[144:147], v[16:19]
    ds_read_b64_tr_b16 a[100:101], v3 offset:288
    v_cvt_pk_bf16_f32 v50, v40, v41
    v_mfma_f32_16x16x32_bf16 v[16:19], a[76:79], v[152:155], v[16:19]
    s_waitcnt lgkmcnt(7)
    ds_read_b64_tr_b16 a[102:103], v3 offset:416
    v_cvt_pk_bf16_f32 v51, v42, v43
    v_mfma_f32_16x16x32_bf16 v[16:19], a[80:83], v[192:195], v[16:19]
    s_mov_b32 s54, 1024
    ds_read_b64_tr_b16 a[104:105], v3 offset:544
    ds_read_b64_tr_b16 a[106:107], v3 offset:672
    v_mfma_f32_16x16x32_bf16 v[16:19], a[84:87], v[200:203], v[16:19]
    s_waitcnt lgkmcnt(6)
    v_permlane32_swap_b32 v48, v50
    v_mfma_f32_16x16x32_bf16 v[16:19], a[88:91], v[208:211], v[16:19]
    v_permlane32_swap_b32 v49, v51
    v_mfma_f32_16x16x32_bf16 v[16:19], a[92:95], v[216:219], v[16:19]
    ds_read_b64_tr_b16 a[108:109], v3 offset:800
    ds_read_b64_tr_b16 a[110:111], v3 offset:928
    buffer_store_dwordx4 v[48:51], v10, s[40:43], s54 offen offset:512 sc1
    v_mfma_f32_16x16x32_bf16 v[20:23], a[64:67], v[160:163], 0
    ds_read_b64_tr_b16 a[112:113], v3 offset:16928
    v_cvt_pk_bf16_f32 v52, v36, v37
    v_mfma_f32_16x16x32_bf16 v[20:23], a[68:71], v[168:171], v[20:23]
    ds_read_b64_tr_b16 a[114:115], v3 offset:17056
    v_cvt_pk_bf16_f32 v53, v38, v39
    v_mfma_f32_16x16x32_bf16 v[20:23], a[72:75], v[176:179], v[20:23]
    ds_read_b64_tr_b16 a[116:117], v3 offset:17184
    v_cvt_pk_bf16_f32 v54, v44, v45
    v_mfma_f32_16x16x32_bf16 v[20:23], a[76:79], v[184:187], v[20:23]
    ds_read_b64_tr_b16 a[118:119], v3 offset:17312
    v_cvt_pk_bf16_f32 v55, v46, v47
    v_mfma_f32_16x16x32_bf16 v[20:23], a[80:83], v[224:227], v[20:23]
    s_mov_b32 s54, 295936
    ds_read_b64_tr_b16 a[120:121], v3 offset:17440
    ds_read_b64_tr_b16 a[122:123], v3 offset:17568
    v_mfma_f32_16x16x32_bf16 v[20:23], a[84:87], v[232:235], v[20:23]
    v_permlane32_swap_b32 v52, v54
    v_mfma_f32_16x16x32_bf16 v[20:23], a[88:91], v[240:243], v[20:23]
    v_permlane32_swap_b32 v53, v55
    v_mfma_f32_16x16x32_bf16 v[20:23], a[92:95], v[248:251], v[20:23]
    s_waitcnt lgkmcnt(10)
    ds_read_b64_tr_b16 a[124:125], v3 offset:17696
    ds_read_b64_tr_b16 a[126:127], v3 offset:17824
    buffer_store_dwordx4 v[52:55], v10, s[40:43], s54 offen offset:512 sc1
    v_mfma_f32_16x16x32_bf16 v[24:27], a[96:99], v[128:131], 0
    ds_read_b64_tr_b16 a[64:65], v3 offset:64
    v_add_u32 v104, s14, v8
    v_mfma_f32_16x16x32_bf16 v[24:27], a[100:103], v[136:139], v[24:27]
    s_waitcnt lgkmcnt(9)
    ds_read_b64_tr_b16 a[66:67], v3 offset:192
    v_and_b32 v14, 32, v0
    v_mfma_f32_16x16x32_bf16 v[24:27], a[104:107], v[144:147], v[24:27]
    ds_read_b64_tr_b16 a[68:69], v3 offset:320
    v_xor_b32 v105, v14, v104
    v_mfma_f32_16x16x32_bf16 v[24:27], a[108:111], v[152:155], v[24:27]
    s_waitcnt lgkmcnt(7)
    ds_read_b64_tr_b16 a[70:71], v3 offset:448
    v_add_u32 v106, 73728, v105
    v_mfma_f32_16x16x32_bf16 v[24:27], a[112:115], v[192:195], v[24:27]
    ds_read_b64_tr_b16 a[72:73], v3 offset:576
    v_lshrrev_b32 v110, 4, v0
    v_mfma_f32_16x16x32_bf16 v[24:27], a[116:119], v[200:203], v[24:27]
    s_waitcnt lgkmcnt(5)
    ds_read_b64_tr_b16 a[74:75], v3 offset:704
    v_bfe_u32 v14, v0, 2, 2
    v_mfma_f32_16x16x32_bf16 v[24:27], a[120:123], v[208:211], v[24:27]
    ds_read_b64_tr_b16 a[76:77], v3 offset:832
    v_lshl_add_u32 v110, v110, 3, v14
    v_mfma_f32_16x16x32_bf16 v[24:27], a[124:127], v[216:219], v[24:27]
    ds_read_b64_tr_b16 a[78:79], v3 offset:960
    v_and_b32 v14, 3, v0
    v_mfma_f32_16x16x32_bf16 v[28:31], a[96:99], v[160:163], 0
    ds_read_b64_tr_b16 a[80:81], v3 offset:16960
    v_mul_u32_u24 v111, 1152, v110
    v_mfma_f32_16x16x32_bf16 v[28:31], a[100:103], v[168:171], v[28:31]
    ds_read_b64_tr_b16 a[82:83], v3 offset:17088
    v_lshlrev_b32 v110, 6, v110
    v_mfma_f32_16x16x32_bf16 v[28:31], a[104:107], v[176:179], v[28:31]
    ds_read_b64_tr_b16 a[84:85], v3 offset:17216
    v_lshl_add_u32 v110, v14, 3, v110
    v_mfma_f32_16x16x32_bf16 v[28:31], a[108:111], v[184:187], v[28:31]
    ds_read_b64_tr_b16 a[86:87], v3 offset:17344
    v_lshl_add_u32 v111, v14, 3, v111
    v_mfma_f32_16x16x32_bf16 v[28:31], a[112:115], v[224:227], v[28:31]
    s_lshr_b32 s3, s51, 1
    s_xor_b32 s3, s3, 1
    s_mul_i32 s3, s3, 110592
    s_and_b32 s14, s51, 1
    s_lshl_b32 s14, s14, 5
    s_add_u32 s3, s3, s14
    s_add_u32 s3, s3, 16384
    ds_read_b64_tr_b16 a[88:89], v3 offset:17472
    v_add_u32 v110, s3, v110
    v_mfma_f32_16x16x32_bf16 v[28:31], a[116:119], v[232:235], v[28:31]
    ds_read_b64_tr_b16 a[90:91], v3 offset:17600
    v_and_b32 v14, 16, v0
    v_mfma_f32_16x16x32_bf16 v[28:31], a[120:123], v[240:243], v[28:31]
    ds_read_b64_tr_b16 a[92:93], v3 offset:17728
    v_lshlrev_b32 v14, 1, v14
    v_mfma_f32_16x16x32_bf16 v[28:31], a[124:127], v[248:251], v[28:31]
    s_waitcnt lgkmcnt(11)
    ds_read_b64_tr_b16 a[94:95], v3 offset:17856
    v_xor_b32 v110, v14, v110
    v_mfma_f32_16x16x32_bf16 v[32:35], a[64:67], v[128:131], 0
    s_mul_i32 s3, s51, 288
    s_add_u32 s3, s3, 53248
    ds_read_b64_tr_b16 a[96:97], v3 offset:96
    v_cvt_pk_bf16_f32 v48, v16, v17
    v_mfma_f32_16x16x32_bf16 v[32:35], a[68:71], v[136:139], v[32:35]
    s_waitcnt lgkmcnt(9)
    ds_read_b64_tr_b16 a[98:99], v3 offset:224
    v_cvt_pk_bf16_f32 v49, v18, v19
    v_mfma_f32_16x16x32_bf16 v[32:35], a[72:75], v[144:147], v[32:35]
    ds_read_b64_tr_b16 a[100:101], v3 offset:352
    v_cvt_pk_bf16_f32 v50, v24, v25
    v_mfma_f32_16x16x32_bf16 v[32:35], a[76:79], v[152:155], v[32:35]
    s_waitcnt lgkmcnt(7)
    ds_read_b64_tr_b16 a[102:103], v3 offset:480
    v_cvt_pk_bf16_f32 v51, v26, v27
    v_mfma_f32_16x16x32_bf16 v[32:35], a[80:83], v[192:195], v[32:35]
    s_mov_b32 s54, 2048
    ds_read_b64_tr_b16 a[104:105], v3 offset:608
    ds_read_b64_tr_b16 a[106:107], v3 offset:736
    v_mfma_f32_16x16x32_bf16 v[32:35], a[84:87], v[200:203], v[32:35]
    s_waitcnt lgkmcnt(6)
    v_permlane32_swap_b32 v48, v50
    v_mfma_f32_16x16x32_bf16 v[32:35], a[88:91], v[208:211], v[32:35]
L2_pad11:
    s_cbranch_execz L2_pad15
    v_permlane32_swap_b32 v49, v51
    v_mfma_f32_16x16x32_bf16 v[32:35], a[92:95], v[216:219], v[32:35]
    ds_read_b64_tr_b16 a[108:109], v3 offset:864
    ds_read_b64_tr_b16 a[110:111], v3 offset:992
    buffer_store_dwordx4 v[48:51], v10, s[40:43], s54 offen offset:0 sc1
    v_mfma_f32_16x16x32_bf16 v[36:39], a[64:67], v[160:163], 0
    ds_read_b64_tr_b16 a[112:113], v3 offset:16992
    v_cvt_pk_bf16_f32 v52, v20, v21
    v_mfma_f32_16x16x32_bf16 v[36:39], a[68:71], v[168:171], v[36:39]
    ds_read_b64_tr_b16 a[114:115], v3 offset:17120
    v_cvt_pk_bf16_f32 v53, v22, v23
    v_mfma_f32_16x16x32_bf16 v[36:39], a[72:75], v[176:179], v[36:39]
    ds_read_b64_tr_b16 a[116:117], v3 offset:17248
    v_cvt_pk_bf16_f32 v54, v28, v29
    v_mfma_f32_16x16x32_bf16 v[36:39], a[76:79], v[184:187], v[36:39]
    ds_read_b64_tr_b16 a[118:119], v3 offset:17376
    v_cvt_pk_bf16_f32 v55, v30, v31
    v_mfma_f32_16x16x32_bf16 v[36:39], a[80:83], v[224:227], v[36:39]
    s_mov_b32 s54, 296960
    ds_read_b64_tr_b16 a[120:121], v3 offset:17504
    ds_read_b64_tr_b16 a[122:123], v3 offset:17632
    v_mfma_f32_16x16x32_bf16 v[36:39], a[84:87], v[232:235], v[36:39]
    v_permlane32_swap_b32 v52, v54
    v_mfma_f32_16x16x32_bf16 v[36:39], a[88:91], v[240:243], v[36:39]
    v_permlane32_swap_b32 v53, v55
    v_mfma_f32_16x16x32_bf16 v[36:39], a[92:95], v[248:251], v[36:39]
    s_waitcnt vmcnt(15)
    s_barrier
    s_waitcnt lgkmcnt(10)
    ds_read_b64_tr_b16 a[124:125], v3 offset:17760
    ds_read_b64_tr_b16 a[126:127], v3 offset:17888
    buffer_store_dwordx4 v[52:55], v10, s[40:43], s54 offen offset:0 sc1
    v_mfma_f32_16x16x32_bf16 v[40:43], a[96:99], v[128:131], 0
    s_add_u32 m0, s44, 110592
    ds_read_b64_tr_b16 a[64:65], v3 offset:36864
    ds_read_b64_tr_b16 a[66:67], v3 offset:36992
    v_mfma_f32_16x16x32_bf16 v[40:43], a[100:103], v[136:139], v[40:43]
    s_mov_b32 s45, 640
    s_waitcnt lgkmcnt(10)
    buffer_load_dwordx4 v7, s[28:31], s45 offen offset:0 lds
    v_mfma_f32_16x16x32_bf16 v[40:43], a[104:107], v[144:147], v[40:43]
    s_add_u32 m0, s44, 110496
    ds_read_b64_tr_b16 a[68:69], v3 offset:37120
    ds_read_b64_tr_b16 a[70:71], v3 offset:37248
    v_mfma_f32_16x16x32_bf16 v[40:43], a[108:111], v[152:155], v[40:43]
    s_waitcnt lgkmcnt(8)
    buffer_load_dwordx4 v7, s[28:31], s45 offen offset:1152 lds
    v_mfma_f32_16x16x32_bf16 v[40:43], a[112:115], v[192:195], v[40:43]
    s_add_u32 m0, s44, 110400
    ds_read_b64_tr_b16 a[72:73], v3 offset:37376
    ds_read_b64_tr_b16 a[74:75], v3 offset:37504
    v_mfma_f32_16x16x32_bf16 v[40:43], a[116:119], v[200:203], v[40:43]
    s_waitcnt lgkmcnt(6)
    buffer_load_dwordx4 v7, s[28:31], s45 offen offset:2304 lds
    v_mfma_f32_16x16x32_bf16 v[40:43], a[120:123], v[208:211], v[40:43]
    s_add_u32 m0, s44, 110304
    ds_read_b64_tr_b16 a[76:77], v3 offset:37632
    ds_read_b64_tr_b16 a[78:79], v3 offset:37760
    v_mfma_f32_16x16x32_bf16 v[40:43], a[124:127], v[216:219], v[40:43]
    buffer_load_dwordx4 v7, s[28:31], s45 offen offset:3456 lds
    v_mfma_f32_16x16x32_bf16 v[44:47], a[96:99], v[160:163], 0
    s_add_u32 m0, s44, 127488
    ds_read_b64_tr_b16 a[80:81], v3 offset:53760
    ds_read_b64_tr_b16 a[82:83], v3 offset:53888
    v_mfma_f32_16x16x32_bf16 v[44:47], a[100:103], v[168:171], v[44:47]
    s_mov_b32 s45, 148096
    buffer_load_dwordx4 v7, s[28:31], s45 offen offset:0 lds
    v_mfma_f32_16x16x32_bf16 v[44:47], a[104:107], v[176:179], v[44:47]
    s_add_u32 m0, s44, 127392
    ds_read_b64_tr_b16 a[84:85], v3 offset:54016
    ds_read_b64_tr_b16 a[86:87], v3 offset:54144
    v_mfma_f32_16x16x32_bf16 v[44:47], a[108:111], v[184:187], v[44:47]
    buffer_load_dwordx4 v7, s[28:31], s45 offen offset:1152 lds
    v_mfma_f32_16x16x32_bf16 v[44:47], a[112:115], v[224:227], v[44:47]
    s_add_u32 m0, s44, 127296
    ds_read_b64_tr_b16 a[88:89], v3 offset:54272
    ds_read_b64_tr_b16 a[90:91], v3 offset:54400
    v_mfma_f32_16x16x32_bf16 v[44:47], a[116:119], v[232:235], v[44:47]
    buffer_load_dwordx4 v7, s[28:31], s45 offen offset:2304 lds
    v_mfma_f32_16x16x32_bf16 v[44:47], a[120:123], v[240:243], v[44:47]
    s_add_u32 m0, s44, 127200
    ds_read_b64_tr_b16 a[92:93], v3 offset:54528
    ds_read_b64_tr_b16 a[94:95], v3 offset:54656
    v_mfma_f32_16x16x32_bf16 v[44:47], a[124:127], v[248:251], v[44:47]
    s_waitcnt lgkmcnt(12)
    buffer_load_dwordx4 v7, s[28:31], s45 offen offset:3456 lds
    v_mfma_f32_16x16x32_bf16 v[16:19], a[64:67], v[128:131], 0
    ds_read_b64_tr_b16 a[96:97], v3 offset:36896
    v_cvt_pk_bf16_f32 v48, v32, v33
    v_mfma_f32_16x16x32_bf16 v[16:19], a[68:71], v[136:139], v[16:19]
    s_waitcnt lgkmcnt(9)
    ds_read_b64_tr_b16 a[98:99], v3 offset:37024
    v_cvt_pk_bf16_f32 v49, v34, v35
    v_mfma_f32_16x16x32_bf16 v[16:19], a[72:75], v[144:147], v[16:19]
    ds_read_b64_tr_b16 a[100:101], v3 offset:37152
    v_cvt_pk_bf16_f32 v50, v40, v41
    v_mfma_f32_16x16x32_bf16 v[16:19], a[76:79], v[152:155], v[16:19]
    s_waitcnt lgkmcnt(7)
    ds_read_b64_tr_b16 a[102:103], v3 offset:37280
    v_cvt_pk_bf16_f32 v51, v42, v43
    v_mfma_f32_16x16x32_bf16 v[16:19], a[80:83], v[192:195], v[16:19]
    s_mov_b32 s54, 2048
    ds_read_b64_tr_b16 a[104:105], v3 offset:37408
    ds_read_b64_tr_b16 a[106:107], v3 offset:37536
    v_mfma_f32_16x16x32_bf16 v[16:19], a[84:87], v[200:203], v[16:19]
    s_waitcnt lgkmcnt(6)
    v_permlane32_swap_b32 v48, v50
    v_mfma_f32_16x16x32_bf16 v[16:19], a[88:91], v[208:211], v[16:19]
    v_permlane32_swap_b32 v49, v51
    v_mfma_f32_16x16x32_bf16 v[16:19], a[92:95], v[216:219], v[16:19]
    ds_read_b64_tr_b16 a[108:109], v3 offset:37664
    ds_read_b64_tr_b16 a[110:111], v3 offset:37792
    buffer_store_dwordx4 v[48:51], v10, s[40:43], s54 offen offset:512 sc1
    v_mfma_f32_16x16x32_bf16 v[20:23], a[64:67], v[160:163], 0
    ds_read_b64_tr_b16 a[112:113], v3 offset:53792
    v_cvt_pk_bf16_f32 v52, v36, v37
    v_mfma_f32_16x16x32_bf16 v[20:23], a[68:71], v[168:171], v[20:23]
    ds_read_b64_tr_b16 a[114:115], v3 offset:53920
    v_cvt_pk_bf16_f32 v53, v38, v39
    v_mfma_f32_16x16x32_bf16 v[20:23], a[72:75], v[176:179], v[20:23]
    ds_read_b64_tr_b16 a[116:117], v3 offset:54048
    v_cvt_pk_bf16_f32 v54, v44, v45
    v_mfma_f32_16x16x32_bf16 v[20:23], a[76:79], v[184:187], v[20:23]
    ds_read_b64_tr_b16 a[118:119], v3 offset:54176
    v_cvt_pk_bf16_f32 v55, v46, v47
    v_mfma_f32_16x16x32_bf16 v[20:23], a[80:83], v[224:227], v[20:23]
    s_mov_b32 s54, 296960
    ds_read_b64_tr_b16 a[120:121], v3 offset:54304
    ds_read_b64_tr_b16 a[122:123], v3 offset:54432
    v_mfma_f32_16x16x32_bf16 v[20:23], a[84:87], v[232:235], v[20:23]
    v_permlane32_swap_b32 v52, v54
    v_mfma_f32_16x16x32_bf16 v[20:23], a[88:91], v[240:243], v[20:23]
    v_permlane32_swap_b32 v53, v55
    v_mfma_f32_16x16x32_bf16 v[20:23], a[92:95], v[248:251], v[20:23]
    s_waitcnt lgkmcnt(10)
    ds_read_b64_tr_b16 a[124:125], v3 offset:54560
    ds_read_b64_tr_b16 a[126:127], v3 offset:54688
    buffer_store_dwordx4 v[52:55], v10, s[40:43], s54 offen offset:512 sc1
    v_mfma_f32_16x16x32_bf16 v[24:27], a[96:99], v[128:131], 0
    ds_read_b64_tr_b16 a[64:65], v3 offset:36928
    v_add_u32 v111, s3, v111
    v_mfma_f32_16x16x32_bf16 v[24:27], a[100:103], v[136:139], v[24:27]
    s_waitcnt lgkmcnt(9)
    ds_read_b64_tr_b16 a[66:67], v3 offset:37056
    v_mfma_f32_16x16x32_bf16 v[24:27], a[104:107], v[144:147], v[24:27]
    ds_read_b64_tr_b16 a[68:69], v3 offset:37184
    v_mfma_f32_16x16x32_bf16 v[24:27], a[108:111], v[152:155], v[24:27]
    s_waitcnt lgkmcnt(7)
    ds_read_b64_tr_b16 a[70:71], v3 offset:37312
    v_mfma_f32_16x16x32_bf16 v[24:27], a[112:115], v[192:195], v[24:27]
    ds_read_b64_tr_b16 a[72:73], v3 offset:37440
    v_mfma_f32_16x16x32_bf16 v[24:27], a[116:119], v[200:203], v[24:27]
    s_waitcnt lgkmcnt(5)
    ds_read_b64_tr_b16 a[74:75], v3 offset:37568
    v_mfma_f32_16x16x32_bf16 v[24:27], a[120:123], v[208:211], v[24:27]
    ds_read_b64_tr_b16 a[76:77], v3 offset:37696
    v_mfma_f32_16x16x32_bf16 v[24:27], a[124:127], v[216:219], v[24:27]
    ds_read_b64_tr_b16 a[78:79], v3 offset:37824
    v_mfma_f32_16x16x32_bf16 v[28:31], a[96:99], v[160:163], 0
    ds_read_b64_tr_b16 a[80:81], v3 offset:53824
    v_mfma_f32_16x16x32_bf16 v[28:31], a[100:103], v[168:171], v[28:31]
    ds_read_b64_tr_b16 a[82:83], v3 offset:53952
    v_mfma_f32_16x16x32_bf16 v[28:31], a[104:107], v[176:179], v[28:31]
    ds_read_b64_tr_b16 a[84:85], v3 offset:54080
    v_mfma_f32_16x16x32_bf16 v[28:31], a[108:111], v[184:187], v[28:31]
    ds_read_b64_tr_b16 a[86:87], v3 offset:54208
    v_mfma_f32_16x16x32_bf16 v[28:31], a[112:115], v[224:227], v[28:31]
    ds_read_b64_tr_b16 a[88:89], v3 offset:54336
    v_mfma_f32_16x16x32_bf16 v[28:31], a[116:119], v[232:235], v[28:31]
    ds_read_b64_tr_b16 a[90:91], v3 offset:54464
    v_mfma_f32_16x16x32_bf16 v[28:31], a[120:123], v[240:243], v[28:31]
    ds_read_b64_tr_b16 a[92:93], v3 offset:54592
    v_mfma_f32_16x16x32_bf16 v[28:31], a[124:127], v[248:251], v[28:31]
    s_waitcnt lgkmcnt(11)
    ds_read_b64_tr_b16 a[94:95], v3 offset:54720
    v_mfma_f32_16x16x32_bf16 v[32:35], a[64:67], v[128:131], 0
    ds_read_b64_tr_b16 a[96:97], v3 offset:36960
    v_cvt_pk_bf16_f32 v48, v16, v17
    v_mfma_f32_16x16x32_bf16 v[32:35], a[68:71], v[136:139], v[32:35]
    s_waitcnt lgkmcnt(9)
    ds_read_b64_tr_b16 a[98:99], v3 offset:37088
    v_cvt_pk_bf16_f32 v49, v18, v19
    v_mfma_f32_16x16x32_bf16 v[32:35], a[72:75], v[144:147], v[32:35]
    ds_read_b64_tr_b16 a[100:101], v3 offset:37216
    v_cvt_pk_bf16_f32 v50, v24, v25
    v_mfma_f32_16x16x32_bf16 v[32:35], a[76:79], v[152:155], v[32:35]
    s_waitcnt lgkmcnt(7)
    ds_read_b64_tr_b16 a[102:103], v3 offset:37344
    v_cvt_pk_bf16_f32 v51, v26, v27
    v_mfma_f32_16x16x32_bf16 v[32:35], a[80:83], v[192:195], v[32:35]
    s_mov_b32 s54, 3072
    ds_read_b64_tr_b16 a[104:105], v3 offset:37472
    ds_read_b64_tr_b16 a[106:107], v3 offset:37600
    v_mfma_f32_16x16x32_bf16 v[32:35], a[84:87], v[200:203], v[32:35]
    s_waitcnt lgkmcnt(6)
    v_permlane32_swap_b32 v48, v50
    v_mfma_f32_16x16x32_bf16 v[32:35], a[88:91], v[208:211], v[32:35]
    v_permlane32_swap_b32 v49, v51
    v_mfma_f32_16x16x32_bf16 v[32:35], a[92:95], v[216:219], v[32:35]
    ds_read_b64_tr_b16 a[108:109], v3 offset:37728
    ds_read_b64_tr_b16 a[110:111], v3 offset:37856
    buffer_store_dwordx4 v[48:51], v10, s[40:43], s54 offen offset:0 sc1
    v_mfma_f32_16x16x32_bf16 v[36:39], a[64:67], v[160:163], 0
    ds_read_b64_tr_b16 a[112:113], v3 offset:53856
    v_cvt_pk_bf16_f32 v52, v20, v21
    v_mfma_f32_16x16x32_bf16 v[36:39], a[68:71], v[168:171], v[36:39]
    ds_read_b64_tr_b16 a[114:115], v3 offset:53984
    v_cvt_pk_bf16_f32 v53, v22, v23
    v_mfma_f32_16x16x32_bf16 v[36:39], a[72:75], v[176:179], v[36:39]
    ds_read_b64_tr_b16 a[116:117], v3 offset:54112
    v_cvt_pk_bf16_f32 v54, v28, v29
    v_mfma_f32_16x16x32_bf16 v[36:39], a[76:79], v[184:187], v[36:39]
    ds_read_b64_tr_b16 a[118:119], v3 offset:54240
    v_cvt_pk_bf16_f32 v55, v30, v31
    v_mfma_f32_16x16x32_bf16 v[36:39], a[80:83], v[224:227], v[36:39]
    s_mov_b32 s54, 297984
    ds_read_b64_tr_b16 a[120:121], v3 offset:54368
    ds_read_b64_tr_b16 a[122:123], v3 offset:54496
    v_mfma_f32_16x16x32_bf16 v[36:39], a[84:87], v[232:235], v[36:39]
    v_permlane32_swap_b32 v52, v54
    v_mfma_f32_16x16x32_bf16 v[36:39], a[88:91], v[240:243], v[36:39]
    v_permlane32_swap_b32 v53, v55
    v_mfma_f32_16x16x32_bf16 v[36:39], a[92:95], v[248:251], v[36:39]
    s_waitcnt vmcnt(15)
    s_barrier
    s_waitcnt lgkmcnt(10)
    ds_read_b64_tr_b16 a[124:125], v3 offset:54624
    ds_read_b64_tr_b16 a[126:127], v3 offset:54752
    buffer_store_dwordx4 v[52:55], v10, s[40:43], s54 offen offset:0 sc1
    v_mfma_f32_16x16x32_bf16 v[40:43], a[96:99], v[128:131], 0
    s_add_u32 m0, s44, 0
    ds_read_b64_tr_b16 a[64:65], v4 offset:0
    ds_read_b64_tr_b16 a[66:67], v4 offset:128
    v_mfma_f32_16x16x32_bf16 v[40:43], a[100:103], v[136:139], v[40:43]
    s_mov_b32 s45, 768
    s_waitcnt lgkmcnt(10)
    buffer_load_dwordx4 v7, s[28:31], s45 offen offset:0 lds
    v_mfma_f32_16x16x32_bf16 v[40:43], a[104:107], v[144:147], v[40:43]
    s_add_u32 m0, s44, -96
    ds_read_b64_tr_b16 a[68:69], v4 offset:256
    ds_read_b64_tr_b16 a[70:71], v4 offset:384
    v_mfma_f32_16x16x32_bf16 v[40:43], a[108:111], v[152:155], v[40:43]
    s_waitcnt lgkmcnt(8)
    buffer_load_dwordx4 v7, s[28:31], s45 offen offset:1152 lds
    v_mfma_f32_16x16x32_bf16 v[40:43], a[112:115], v[192:195], v[40:43]
    s_add_u32 m0, s44, -192
    ds_read_b64_tr_b16 a[72:73], v4 offset:512
    ds_read_b64_tr_b16 a[74:75], v4 offset:640
    v_mfma_f32_16x16x32_bf16 v[40:43], a[116:119], v[200:203], v[40:43]
    s_waitcnt lgkmcnt(6)
    buffer_load_dwordx4 v7, s[28:31], s45 offen offset:2304 lds
    v_mfma_f32_16x16x32_bf16 v[40:43], a[120:123], v[208:211], v[40:43]
    s_add_u32 m0, s44, -288
    ds_read_b64_tr_b16 a[76:77], v4 offset:768
    ds_read_b64_tr_b16 a[78:79], v4 offset:896
    v_mfma_f32_16x16x32_bf16 v[40:43], a[124:127], v[216:219], v[40:43]
    buffer_load_dwordx4 v7, s[28:31], s45 offen offset:3456 lds
    v_mfma_f32_16x16x32_bf16 v[44:47], a[96:99], v[160:163], 0
    s_add_u32 m0, s44, 16896
    ds_read_b64_tr_b16 a[80:81], v4 offset:16896
    ds_read_b64_tr_b16 a[82:83], v4 offset:17024
    v_mfma_f32_16x16x32_bf16 v[44:47], a[100:103], v[168:171], v[44:47]
    s_mov_b32 s45, 148224
    buffer_load_dwordx4 v7, s[28:31], s45 offen offset:0 lds
    v_mfma_f32_16x16x32_bf16 v[44:47], a[104:107], v[176:179], v[44:47]
    s_add_u32 m0, s44, 16800
    ds_read_b64_tr_b16 a[84:85], v4 offset:17152
    ds_read_b64_tr_b16 a[86:87], v4 offset:17280
    v_mfma_f32_16x16x32_bf16 v[44:47], a[108:111], v[184:187], v[44:47]
    buffer_load_dwordx4 v7, s[28:31], s45 offen offset:1152 lds
    v_mfma_f32_16x16x32_bf16 v[44:47], a[112:115], v[224:227], v[44:47]
    s_add_u32 m0, s44, 16704
    ds_read_b64_tr_b16 a[88:89], v4 offset:17408
    ds_read_b64_tr_b16 a[90:91], v4 offset:17536
    v_mfma_f32_16x16x32_bf16 v[44:47], a[116:119], v[232:235], v[44:47]
    buffer_load_dwordx4 v7, s[28:31], s45 offen offset:2304 lds
    v_mfma_f32_16x16x32_bf16 v[44:47], a[120:123], v[240:243], v[44:47]
    s_add_u32 m0, s44, 16608
    ds_read_b64_tr_b16 a[92:93], v4 offset:17664
    ds_read_b64_tr_b16 a[94:95], v4 offset:17792
    v_mfma_f32_16x16x32_bf16 v[44:47], a[124:127], v[248:251], v[44:47]
    s_waitcnt lgkmcnt(12)
    buffer_load_dwordx4 v7, s[28:31], s45 offen offset:3456 lds
    v_mfma_f32_16x16x32_bf16 v[16:19], a[64:67], v[128:131], 0
    ds_read_b64_tr_b16 a[96:97], v4 offset:32
    v_cvt_pk_bf16_f32 v48, v32, v33
    v_mfma_f32_16x16x32_bf16 v[16:19], a[68:71], v[136:139], v[16:19]
    s_waitcnt lgkmcnt(9)
    ds_read_b64_tr_b16 a[98:99], v4 offset:160
    v_cvt_pk_bf16_f32 v49, v34, v35
    v_mfma_f32_16x16x32_bf16 v[16:19], a[72:75], v[144:147], v[16:19]
    ds_read_b64_tr_b16 a[100:101], v4 offset:288
    v_cvt_pk_bf16_f32 v50, v40, v41
    v_mfma_f32_16x16x32_bf16 v[16:19], a[76:79], v[152:155], v[16:19]
    s_waitcnt lgkmcnt(7)
    ds_read_b64_tr_b16 a[102:103], v4 offset:416
    v_cvt_pk_bf16_f32 v51, v42, v43
    v_mfma_f32_16x16x32_bf16 v[16:19], a[80:83], v[192:195], v[16:19]
    s_mov_b32 s54, 3072
    ds_read_b64_tr_b16 a[104:105], v4 offset:544
    ds_read_b64_tr_b16 a[106:107], v4 offset:672
    v_mfma_f32_16x16x32_bf16 v[16:19], a[84:87], v[200:203], v[16:19]
    s_waitcnt lgkmcnt(6)
    v_permlane32_swap_b32 v48, v50
    v_mfma_f32_16x16x32_bf16 v[16:19], a[88:91], v[208:211], v[16:19]
    v_permlane32_swap_b32 v49, v51
    v_mfma_f32_16x16x32_bf16 v[16:19], a[92:95], v[216:219], v[16:19]
    ds_read_b64_tr_b16 a[108:109], v4 offset:800
    ds_read_b64_tr_b16 a[110:111], v4 offset:928
    buffer_store_dwordx4 v[48:51], v10, s[40:43], s54 offen offset:512 sc1
    v_mfma_f32_16x16x32_bf16 v[20:23], a[64:67], v[160:163], 0
    ds_read_b64_tr_b16 a[112:113], v4 offset:16928
    v_cvt_pk_bf16_f32 v52, v36, v37
    v_mfma_f32_16x16x32_bf16 v[20:23], a[68:71], v[168:171], v[20:23]
    ds_read_b64_tr_b16 a[114:115], v4 offset:17056
    v_cvt_pk_bf16_f32 v53, v38, v39
    v_mfma_f32_16x16x32_bf16 v[20:23], a[72:75], v[176:179], v[20:23]
    ds_read_b64_tr_b16 a[116:117], v4 offset:17184
    v_cvt_pk_bf16_f32 v54, v44, v45
    v_mfma_f32_16x16x32_bf16 v[20:23], a[76:79], v[184:187], v[20:23]
    ds_read_b64_tr_b16 a[118:119], v4 offset:17312
    v_cvt_pk_bf16_f32 v55, v46, v47
    v_mfma_f32_16x16x32_bf16 v[20:23], a[80:83], v[224:227], v[20:23]
    s_mov_b32 s54, 297984
    ds_read_b64_tr_b16 a[120:121], v4 offset:17440
    ds_read_b64_tr_b16 a[122:123], v4 offset:17568
    v_mfma_f32_16x16x32_bf16 v[20:23], a[84:87], v[232:235], v[20:23]
    v_permlane32_swap_b32 v52, v54
    v_mfma_f32_16x16x32_bf16 v[20:23], a[88:91], v[240:243], v[20:23]
    v_permlane32_swap_b32 v53, v55
    v_mfma_f32_16x16x32_bf16 v[20:23], a[92:95], v[248:251], v[20:23]
    s_waitcnt lgkmcnt(10)
    ds_read_b64_tr_b16 a[124:125], v4 offset:17696
    ds_read_b64_tr_b16 a[126:127], v4 offset:17824
    buffer_store_dwordx4 v[52:55], v10, s[40:43], s54 offen offset:512 sc1
    v_mfma_f32_16x16x32_bf16 v[24:27], a[96:99], v[128:131], 0
    ds_read_b64_tr_b16 a[64:65], v4 offset:64
    v_mfma_f32_16x16x32_bf16 v[24:27], a[100:103], v[136:139], v[24:27]
    s_waitcnt lgkmcnt(9)
    ds_read_b64_tr_b16 a[66:67], v4 offset:192
    v_mfma_f32_16x16x32_bf16 v[24:27], a[104:107], v[144:147], v[24:27]
    ds_read_b64_tr_b16 a[68:69], v4 offset:320
    v_mfma_f32_16x16x32_bf16 v[24:27], a[108:111], v[152:155], v[24:27]
    s_waitcnt lgkmcnt(7)
    ds_read_b64_tr_b16 a[70:71], v4 offset:448
    v_mfma_f32_16x16x32_bf16 v[24:27], a[112:115], v[192:195], v[24:27]
    ds_read_b64_tr_b16 a[72:73], v4 offset:576
    v_mfma_f32_16x16x32_bf16 v[24:27], a[116:119], v[200:203], v[24:27]
    s_waitcnt lgkmcnt(5)
    ds_read_b64_tr_b16 a[74:75], v4 offset:704
    v_mfma_f32_16x16x32_bf16 v[24:27], a[120:123], v[208:211], v[24:27]
    ds_read_b64_tr_b16 a[76:77], v4 offset:832
    v_mfma_f32_16x16x32_bf16 v[24:27], a[124:127], v[216:219], v[24:27]
    ds_read_b64_tr_b16 a[78:79], v4 offset:960
    v_mfma_f32_16x16x32_bf16 v[28:31], a[96:99], v[160:163], 0
    ds_read_b64_tr_b16 a[80:81], v4 offset:16960
    v_mfma_f32_16x16x32_bf16 v[28:31], a[100:103], v[168:171], v[28:31]
    ds_read_b64_tr_b16 a[82:83], v4 offset:17088
    v_mfma_f32_16x16x32_bf16 v[28:31], a[104:107], v[176:179], v[28:31]
    ds_read_b64_tr_b16 a[84:85], v4 offset:17216
    v_mfma_f32_16x16x32_bf16 v[28:31], a[108:111], v[184:187], v[28:31]
    ds_read_b64_tr_b16 a[86:87], v4 offset:17344
    v_mfma_f32_16x16x32_bf16 v[28:31], a[112:115], v[224:227], v[28:31]
    ds_read_b64_tr_b16 a[88:89], v4 offset:17472
    v_mfma_f32_16x16x32_bf16 v[28:31], a[116:119], v[232:235], v[28:31]
    ds_read_b64_tr_b16 a[90:91], v4 offset:17600
    v_mfma_f32_16x16x32_bf16 v[28:31], a[120:123], v[240:243], v[28:31]
    ds_read_b64_tr_b16 a[92:93], v4 offset:17728
    v_mfma_f32_16x16x32_bf16 v[28:31], a[124:127], v[248:251], v[28:31]
    s_waitcnt lgkmcnt(11)
    ds_read_b64_tr_b16 a[94:95], v4 offset:17856
    v_mfma_f32_16x16x32_bf16 v[32:35], a[64:67], v[128:131], 0
    ds_read_b64_tr_b16 a[96:97], v4 offset:96
    v_cvt_pk_bf16_f32 v48, v16, v17
    v_mfma_f32_16x16x32_bf16 v[32:35], a[68:71], v[136:139], v[32:35]
    s_waitcnt lgkmcnt(9)
    ds_read_b64_tr_b16 a[98:99], v4 offset:224
    v_cvt_pk_bf16_f32 v49, v18, v19
    v_mfma_f32_16x16x32_bf16 v[32:35], a[72:75], v[144:147], v[32:35]
    ds_read_b64_tr_b16 a[100:101], v4 offset:352
    v_cvt_pk_bf16_f32 v50, v24, v25
    v_mfma_f32_16x16x32_bf16 v[32:35], a[76:79], v[152:155], v[32:35]
    s_waitcnt lgkmcnt(7)
    ds_read_b64_tr_b16 a[102:103], v4 offset:480
    v_cvt_pk_bf16_f32 v51, v26, v27
    v_mfma_f32_16x16x32_bf16 v[32:35], a[80:83], v[192:195], v[32:35]
    s_mov_b32 s54, 4096
    ds_read_b64_tr_b16 a[104:105], v4 offset:608
    ds_read_b64_tr_b16 a[106:107], v4 offset:736
    v_mfma_f32_16x16x32_bf16 v[32:35], a[84:87], v[200:203], v[32:35]
    s_waitcnt lgkmcnt(6)
    v_permlane32_swap_b32 v48, v50
    v_mfma_f32_16x16x32_bf16 v[32:35], a[88:91], v[208:211], v[32:35]
    v_permlane32_swap_b32 v49, v51
    v_mfma_f32_16x16x32_bf16 v[32:35], a[92:95], v[216:219], v[32:35]
    ds_read_b64_tr_b16 a[108:109], v4 offset:864
    ds_read_b64_tr_b16 a[110:111], v4 offset:992
    buffer_store_dwordx4 v[48:51], v10, s[40:43], s54 offen offset:0 sc1
    v_mfma_f32_16x16x32_bf16 v[36:39], a[64:67], v[160:163], 0
    ds_read_b64_tr_b16 a[112:113], v4 offset:16992
    v_cvt_pk_bf16_f32 v52, v20, v21
    v_mfma_f32_16x16x32_bf16 v[36:39], a[68:71], v[168:171], v[36:39]
    ds_read_b64_tr_b16 a[114:115], v4 offset:17120
    v_cvt_pk_bf16_f32 v53, v22, v23
    v_mfma_f32_16x16x32_bf16 v[36:39], a[72:75], v[176:179], v[36:39]
    ds_read_b64_tr_b16 a[116:117], v4 offset:17248
    v_cvt_pk_bf16_f32 v54, v28, v29
    v_mfma_f32_16x16x32_bf16 v[36:39], a[76:79], v[184:187], v[36:39]
    ds_read_b64_tr_b16 a[118:119], v4 offset:17376
    v_cvt_pk_bf16_f32 v55, v30, v31
    v_mfma_f32_16x16x32_bf16 v[36:39], a[80:83], v[224:227], v[36:39]
    s_mov_b32 s54, 299008
    ds_read_b64_tr_b16 a[120:121], v4 offset:17504
    ds_read_b64_tr_b16 a[122:123], v4 offset:17632
    v_mfma_f32_16x16x32_bf16 v[36:39], a[84:87], v[232:235], v[36:39]
    v_permlane32_swap_b32 v52, v54
    v_mfma_f32_16x16x32_bf16 v[36:39], a[88:91], v[240:243], v[36:39]
    v_permlane32_swap_b32 v53, v55
    v_mfma_f32_16x16x32_bf16 v[36:39], a[92:95], v[248:251], v[36:39]
    s_waitcnt vmcnt(15)
    s_barrier
    s_waitcnt lgkmcnt(10)
    ds_read_b64_tr_b16 a[124:125], v4 offset:17760
    ds_read_b64_tr_b16 a[126:127], v4 offset:17888
    buffer_store_dwordx4 v[52:55], v10, s[40:43], s54 offen offset:0 sc1
    v_mfma_f32_16x16x32_bf16 v[40:43], a[96:99], v[128:131], 0
    s_add_u32 m0, s44, 36864
    ds_read_b64_tr_b16 a[64:65], v4 offset:36864
    ds_read_b64_tr_b16 a[66:67], v4 offset:36992
    v_mfma_f32_16x16x32_bf16 v[40:43], a[100:103], v[136:139], v[40:43]
    s_mov_b32 s45, 896
    s_waitcnt lgkmcnt(10)
    buffer_load_dwordx4 v7, s[28:31], s45 offen offset:0 lds
    v_mfma_f32_16x16x32_bf16 v[40:43], a[104:107], v[144:147], v[40:43]
    s_add_u32 m0, s44, 36768
    ds_read_b64_tr_b16 a[68:69], v4 offset:37120
    ds_read_b64_tr_b16 a[70:71], v4 offset:37248
    v_mfma_f32_16x16x32_bf16 v[40:43], a[108:111], v[152:155], v[40:43]
    s_waitcnt lgkmcnt(8)
    buffer_load_dwordx4 v7, s[28:31], s45 offen offset:1152 lds
    v_mfma_f32_16x16x32_bf16 v[40:43], a[112:115], v[192:195], v[40:43]
    s_add_u32 m0, s44, 36672
    ds_read_b64_tr_b16 a[72:73], v4 offset:37376
    ds_read_b64_tr_b16 a[74:75], v4 offset:37504
    v_mfma_f32_16x16x32_bf16 v[40:43], a[116:119], v[200:203], v[40:43]
    s_waitcnt lgkmcnt(6)
    buffer_load_dwordx4 v7, s[28:31], s45 offen offset:2304 lds
    v_mfma_f32_16x16x32_bf16 v[40:43], a[120:123], v[208:211], v[40:43]
    s_add_u32 m0, s44, 36576
    ds_read_b64_tr_b16 a[76:77], v4 offset:37632
    ds_read_b64_tr_b16 a[78:79], v4 offset:37760
    v_mfma_f32_16x16x32_bf16 v[40:43], a[124:127], v[216:219], v[40:43]
    buffer_load_dwordx4 v7, s[28:31], s45 offen offset:3456 lds
    v_mfma_f32_16x16x32_bf16 v[44:47], a[96:99], v[160:163], 0
    s_add_u32 m0, s44, 53760
    ds_read_b64_tr_b16 a[80:81], v4 offset:53760
    ds_read_b64_tr_b16 a[82:83], v4 offset:53888
    v_mfma_f32_16x16x32_bf16 v[44:47], a[100:103], v[168:171], v[44:47]
    s_mov_b32 s45, 148352
    buffer_load_dwordx4 v7, s[28:31], s45 offen offset:0 lds
    v_mfma_f32_16x16x32_bf16 v[44:47], a[104:107], v[176:179], v[44:47]
    s_add_u32 m0, s44, 53664
    ds_read_b64_tr_b16 a[84:85], v4 offset:54016
    ds_read_b64_tr_b16 a[86:87], v4 offset:54144
    v_mfma_f32_16x16x32_bf16 v[44:47], a[108:111], v[184:187], v[44:47]
    buffer_load_dwordx4 v7, s[28:31], s45 offen offset:1152 lds
    v_mfma_f32_16x16x32_bf16 v[44:47], a[112:115], v[224:227], v[44:47]
    s_add_u32 m0, s44, 53568
    ds_read_b64_tr_b16 a[88:89], v4 offset:54272
    ds_read_b64_tr_b16 a[90:91], v4 offset:54400
    v_mfma_f32_16x16x32_bf16 v[44:47], a[116:119], v[232:235], v[44:47]
    buffer_load_dwordx4 v7, s[28:31], s45 offen offset:2304 lds
    v_mfma_f32_16x16x32_bf16 v[44:47], a[120:123], v[240:243], v[44:47]
    s_add_u32 m0, s44, 53472
    ds_read_b64_tr_b16 a[92:93], v4 offset:54528
    ds_read_b64_tr_b16 a[94:95], v4 offset:54656
    v_mfma_f32_16x16x32_bf16 v[44:47], a[124:127], v[248:251], v[44:47]
    s_waitcnt lgkmcnt(12)
    buffer_load_dwordx4 v7, s[28:31], s45 offen offset:3456 lds
    v_mfma_f32_16x16x32_bf16 v[16:19], a[64:67], v[128:131], 0
    ds_read_b64_tr_b16 a[96:97], v4 offset:36896
    v_cvt_pk_bf16_f32 v48, v32, v33
    v_mfma_f32_16x16x32_bf16 v[16:19], a[68:71], v[136:139], v[16:19]
    s_waitcnt lgkmcnt(9)
    ds_read_b64_tr_b16 a[98:99], v4 offset:37024
    v_cvt_pk_bf16_f32 v49, v34, v35
    v_mfma_f32_16x16x32_bf16 v[16:19], a[72:75], v[144:147], v[16:19]
    ds_read_b64_tr_b16 a[100:101], v4 offset:37152
    v_cvt_pk_bf16_f32 v50, v40, v41
    v_mfma_f32_16x16x32_bf16 v[16:19], a[76:79], v[152:155], v[16:19]
    s_waitcnt lgkmcnt(7)
    ds_read_b64_tr_b16 a[102:103], v4 offset:37280
    v_cvt_pk_bf16_f32 v51, v42, v43
    v_mfma_f32_16x16x32_bf16 v[16:19], a[80:83], v[192:195], v[16:19]
    s_mov_b32 s54, 4096
    ds_read_b64_tr_b16 a[104:105], v4 offset:37408
    ds_read_b64_tr_b16 a[106:107], v4 offset:37536
    v_mfma_f32_16x16x32_bf16 v[16:19], a[84:87], v[200:203], v[16:19]
    s_waitcnt lgkmcnt(6)
    v_permlane32_swap_b32 v48, v50
    v_mfma_f32_16x16x32_bf16 v[16:19], a[88:91], v[208:211], v[16:19]
    v_permlane32_swap_b32 v49, v51
    v_mfma_f32_16x16x32_bf16 v[16:19], a[92:95], v[216:219], v[16:19]
    ds_read_b64_tr_b16 a[108:109], v4 offset:37664
    ds_read_b64_tr_b16 a[110:111], v4 offset:37792
    buffer_store_dwordx4 v[48:51], v10, s[40:43], s54 offen offset:512 sc1
    v_mfma_f32_16x16x32_bf16 v[20:23], a[64:67], v[160:163], 0
    ds_read_b64_tr_b16 a[112:113], v4 offset:53792
    v_cvt_pk_bf16_f32 v52, v36, v37
    v_mfma_f32_16x16x32_bf16 v[20:23], a[68:71], v[168:171], v[20:23]
    ds_read_b64_tr_b16 a[114:115], v4 offset:53920
    v_cvt_pk_bf16_f32 v53, v38, v39
    v_mfma_f32_16x16x32_bf16 v[20:23], a[72:75], v[176:179], v[20:23]
    ds_read_b64_tr_b16 a[116:117], v4 offset:54048
    v_cvt_pk_bf16_f32 v54, v44, v45
    v_mfma_f32_16x16x32_bf16 v[20:23], a[76:79], v[184:187], v[20:23]
    ds_read_b64_tr_b16 a[118:119], v4 offset:54176
    v_cvt_pk_bf16_f32 v55, v46, v47
    v_mfma_f32_16x16x32_bf16 v[20:23], a[80:83], v[224:227], v[20:23]
    s_mov_b32 s54, 299008
    ds_read_b64_tr_b16 a[120:121], v4 offset:54304
    ds_read_b64_tr_b16 a[122:123], v4 offset:54432
    v_mfma_f32_16x16x32_bf16 v[20:23], a[84:87], v[232:235], v[20:23]
    v_permlane32_swap_b32 v52, v54
    v_mfma_f32_16x16x32_bf16 v[20:23], a[88:91], v[240:243], v[20:23]
    v_permlane32_swap_b32 v53, v55
    v_mfma_f32_16x16x32_bf16 v[20:23], a[92:95], v[248:251], v[20:23]
    s_waitcnt lgkmcnt(10)
    ds_read_b64_tr_b16 a[124:125], v4 offset:54560
    ds_read_b64_tr_b16 a[126:127], v4 offset:54688
    buffer_store_dwordx4 v[52:55], v10, s[40:43], s54 offen offset:512 sc1
    v_mfma_f32_16x16x32_bf16 v[24:27], a[96:99], v[128:131], 0
    ds_read_b64_tr_b16 a[64:65], v4 offset:36928
    v_mfma_f32_16x16x32_bf16 v[24:27], a[100:103], v[136:139], v[24:27]
    s_waitcnt lgkmcnt(9)
    ds_read_b64_tr_b16 a[66:67], v4 offset:37056
    v_mfma_f32_16x16x32_bf16 v[24:27], a[104:107], v[144:147], v[24:27]
    ds_read_b64_tr_b16 a[68:69], v4 offset:37184
    v_mfma_f32_16x16x32_bf16 v[24:27], a[108:111], v[152:155], v[24:27]
    s_waitcnt lgkmcnt(7)
    ds_read_b64_tr_b16 a[70:71], v4 offset:37312
    v_mfma_f32_16x16x32_bf16 v[24:27], a[112:115], v[192:195], v[24:27]
    ds_read_b64_tr_b16 a[72:73], v4 offset:37440
    v_mfma_f32_16x16x32_bf16 v[24:27], a[116:119], v[200:203], v[24:27]
    s_waitcnt lgkmcnt(5)
    ds_read_b64_tr_b16 a[74:75], v4 offset:37568
    v_mfma_f32_16x16x32_bf16 v[24:27], a[120:123], v[208:211], v[24:27]
L2_pad12:
    s_cbranch_execz L2_walkret
    ds_read_b64_tr_b16 a[76:77], v4 offset:37696
    v_mfma_f32_16x16x32_bf16 v[24:27], a[124:127], v[216:219], v[24:27]
    ds_read_b64_tr_b16 a[78:79], v4 offset:37824
    v_mfma_f32_16x16x32_bf16 v[28:31], a[96:99], v[160:163], 0
    ds_read_b64_tr_b16 a[80:81], v4 offset:53824
    v_mfma_f32_16x16x32_bf16 v[28:31], a[100:103], v[168:171], v[28:31]
    ds_read_b64_tr_b16 a[82:83], v4 offset:53952
    v_mfma_f32_16x16x32_bf16 v[28:31], a[104:107], v[176:179], v[28:31]
    ds_read_b64_tr_b16 a[84:85], v4 offset:54080
    v_mfma_f32_16x16x32_bf16 v[28:31], a[108:111], v[184:187], v[28:31]
    ds_read_b64_tr_b16 a[86:87], v4 offset:54208
    v_mfma_f32_16x16x32_bf16 v[28:31], a[112:115], v[224:227], v[28:31]
    ds_read_b64_tr_b16 a[88:89], v4 offset:54336
    v_mfma_f32_16x16x32_bf16 v[28:31], a[116:119], v[232:235], v[28:31]
    ds_read_b64_tr_b16 a[90:91], v4 offset:54464
    v_mfma_f32_16x16x32_bf16 v[28:31], a[120:123], v[240:243], v[28:31]
    ds_read_b64_tr_b16 a[92:93], v4 offset:54592
    v_mfma_f32_16x16x32_bf16 v[28:31], a[124:127], v[248:251], v[28:31]
    s_waitcnt lgkmcnt(11)
    ds_read_b64_tr_b16 a[94:95], v4 offset:54720
    v_mfma_f32_16x16x32_bf16 v[32:35], a[64:67], v[128:131], 0
    ds_read_b64_tr_b16 a[96:97], v4 offset:36960
    v_cvt_pk_bf16_f32 v48, v16, v17
    v_mfma_f32_16x16x32_bf16 v[32:35], a[68:71], v[136:139], v[32:35]
    s_waitcnt lgkmcnt(9)
    ds_read_b64_tr_b16 a[98:99], v4 offset:37088
    v_cvt_pk_bf16_f32 v49, v18, v19
    v_mfma_f32_16x16x32_bf16 v[32:35], a[72:75], v[144:147], v[32:35]
    ds_read_b64_tr_b16 a[100:101], v4 offset:37216
    v_cvt_pk_bf16_f32 v50, v24, v25
    v_mfma_f32_16x16x32_bf16 v[32:35], a[76:79], v[152:155], v[32:35]
    s_waitcnt lgkmcnt(7)
    ds_read_b64_tr_b16 a[102:103], v4 offset:37344
    v_cvt_pk_bf16_f32 v51, v26, v27
    v_mfma_f32_16x16x32_bf16 v[32:35], a[80:83], v[192:195], v[32:35]
    s_mov_b32 s54, 5120
    ds_read_b64_tr_b16 a[104:105], v4 offset:37472
    ds_read_b64_tr_b16 a[106:107], v4 offset:37600
    v_mfma_f32_16x16x32_bf16 v[32:35], a[84:87], v[200:203], v[32:35]
    s_waitcnt lgkmcnt(6)
    v_permlane32_swap_b32 v48, v50
    v_mfma_f32_16x16x32_bf16 v[32:35], a[88:91], v[208:211], v[32:35]
    v_permlane32_swap_b32 v49, v51
    v_mfma_f32_16x16x32_bf16 v[32:35], a[92:95], v[216:219], v[32:35]
    ds_read_b64_tr_b16 a[108:109], v4 offset:37728
    ds_read_b64_tr_b16 a[110:111], v4 offset:37856
    buffer_store_dwordx4 v[48:51], v10, s[40:43], s54 offen offset:0 sc1
    v_mfma_f32_16x16x32_bf16 v[36:39], a[64:67], v[160:163], 0
    ds_read_b64_tr_b16 a[112:113], v4 offset:53856
    v_cvt_pk_bf16_f32 v52, v20, v21
    v_mfma_f32_16x16x32_bf16 v[36:39], a[68:71], v[168:171], v[36:39]
    ds_read_b64_tr_b16 a[114:115], v4 offset:53984
    v_cvt_pk_bf16_f32 v53, v22, v23
    v_mfma_f32_16x16x32_bf16 v[36:39], a[72:75], v[176:179], v[36:39]
    ds_read_b64_tr_b16 a[116:117], v4 offset:54112
    v_cvt_pk_bf16_f32 v54, v28, v29
    v_mfma_f32_16x16x32_bf16 v[36:39], a[76:79], v[184:187], v[36:39]
    ds_read_b64_tr_b16 a[118:119], v4 offset:54240
    v_cvt_pk_bf16_f32 v55, v30, v31
    v_mfma_f32_16x16x32_bf16 v[36:39], a[80:83], v[224:227], v[36:39]
    s_mov_b32 s54, 300032
    ds_read_b64_tr_b16 a[120:121], v4 offset:54368
    ds_read_b64_tr_b16 a[122:123], v4 offset:54496
    v_mfma_f32_16x16x32_bf16 v[36:39], a[84:87], v[232:235], v[36:39]
    v_permlane32_swap_b32 v52, v54
    v_mfma_f32_16x16x32_bf16 v[36:39], a[88:91], v[240:243], v[36:39]
    v_permlane32_swap_b32 v53, v55
    v_mfma_f32_16x16x32_bf16 v[36:39], a[92:95], v[248:251], v[36:39]
    s_waitcnt vmcnt(15)
    s_barrier
    s_waitcnt lgkmcnt(10)
    ds_read_b64_tr_b16 a[124:125], v4 offset:54624
    ds_read_b64_tr_b16 a[126:127], v4 offset:54752
    buffer_store_dwordx4 v[52:55], v10, s[40:43], s54 offen offset:0 sc1
    v_mfma_f32_16x16x32_bf16 v[40:43], a[96:99], v[128:131], 0
    s_add_u32 m0, s44, 73728
    ds_read_b64_tr_b16 a[64:65], v3 offset:0
    ds_read_b64_tr_b16 a[66:67], v3 offset:128
    v_mfma_f32_16x16x32_bf16 v[40:43], a[100:103], v[136:139], v[40:43]
    s_mov_b32 s45, 1024
    s_waitcnt lgkmcnt(10)
    buffer_load_dwordx4 v7, s[28:31], s45 offen offset:0 lds
    v_mfma_f32_16x16x32_bf16 v[40:43], a[104:107], v[144:147], v[40:43]
    s_add_u32 m0, s44, 73632
    ds_read_b64_tr_b16 a[68:69], v3 offset:256
    ds_read_b64_tr_b16 a[70:71], v3 offset:384
    v_mfma_f32_16x16x32_bf16 v[40:43], a[108:111], v[152:155], v[40:43]
    s_waitcnt lgkmcnt(8)
    buffer_load_dwordx4 v7, s[28:31], s45 offen offset:1152 lds
    v_mfma_f32_16x16x32_bf16 v[40:43], a[112:115], v[192:195], v[40:43]
    s_add_u32 m0, s44, 73536
    ds_read_b64_tr_b16 a[72:73], v3 offset:512
    ds_read_b64_tr_b16 a[74:75], v3 offset:640
    v_mfma_f32_16x16x32_bf16 v[40:43], a[116:119], v[200:203], v[40:43]
    s_waitcnt lgkmcnt(6)
    buffer_load_dwordx4 v7, s[28:31], s45 offen offset:2304 lds
    v_mfma_f32_16x16x32_bf16 v[40:43], a[120:123], v[208:211], v[40:43]
    s_add_u32 m0, s44, 73440
    ds_read_b64_tr_b16 a[76:77], v3 offset:768
    ds_read_b64_tr_b16 a[78:79], v3 offset:896
    v_mfma_f32_16x16x32_bf16 v[40:43], a[124:127], v[216:219], v[40:43]
    buffer_load_dwordx4 v7, s[28:31], s45 offen offset:3456 lds
    v_mfma_f32_16x16x32_bf16 v[44:47], a[96:99], v[160:163], 0
    s_add_u32 m0, s44, 90624
    ds_read_b64_tr_b16 a[80:81], v3 offset:16896
    ds_read_b64_tr_b16 a[82:83], v3 offset:17024
    v_mfma_f32_16x16x32_bf16 v[44:47], a[100:103], v[168:171], v[44:47]
    s_mov_b32 s45, 148480
    buffer_load_dwordx4 v7, s[28:31], s45 offen offset:0 lds
    v_mfma_f32_16x16x32_bf16 v[44:47], a[104:107], v[176:179], v[44:47]
    s_add_u32 m0, s44, 90528
    ds_read_b64_tr_b16 a[84:85], v3 offset:17152
    ds_read_b64_tr_b16 a[86:87], v3 offset:17280
    v_mfma_f32_16x16x32_bf16 v[44:47], a[108:111], v[184:187], v[44:47]
    buffer_load_dwordx4 v7, s[28:31], s45 offen offset:1152 lds
    v_mfma_f32_16x16x32_bf16 v[44:47], a[112:115], v[224:227], v[44:47]
    s_add_u32 m0, s44, 90432
    ds_read_b64_tr_b16 a[88:89], v3 offset:17408
    ds_read_b64_tr_b16 a[90:91], v3 offset:17536
    v_mfma_f32_16x16x32_bf16 v[44:47], a[116:119], v[232:235], v[44:47]
    buffer_load_dwordx4 v7, s[28:31], s45 offen offset:2304 lds
    v_mfma_f32_16x16x32_bf16 v[44:47], a[120:123], v[240:243], v[44:47]
    s_add_u32 m0, s44, 90336
    ds_read_b64_tr_b16 a[92:93], v3 offset:17664
    ds_read_b64_tr_b16 a[94:95], v3 offset:17792
    v_mfma_f32_16x16x32_bf16 v[44:47], a[124:127], v[248:251], v[44:47]
    s_waitcnt lgkmcnt(12)
    buffer_load_dwordx4 v7, s[28:31], s45 offen offset:3456 lds
    v_mfma_f32_16x16x32_bf16 v[16:19], a[64:67], v[128:131], 0
    ds_read_b64_tr_b16 a[96:97], v3 offset:32
    v_cvt_pk_bf16_f32 v48, v32, v33
    v_mfma_f32_16x16x32_bf16 v[16:19], a[68:71], v[136:139], v[16:19]
    s_waitcnt lgkmcnt(9)
    ds_read_b64_tr_b16 a[98:99], v3 offset:160
    v_cvt_pk_bf16_f32 v49, v34, v35
    v_mfma_f32_16x16x32_bf16 v[16:19], a[72:75], v[144:147], v[16:19]
    ds_read_b64_tr_b16 a[100:101], v3 offset:288
    v_cvt_pk_bf16_f32 v50, v40, v41
    v_mfma_f32_16x16x32_bf16 v[16:19], a[76:79], v[152:155], v[16:19]
    s_waitcnt lgkmcnt(7)
    ds_read_b64_tr_b16 a[102:103], v3 offset:416
    v_cvt_pk_bf16_f32 v51, v42, v43
    v_mfma_f32_16x16x32_bf16 v[16:19], a[80:83], v[192:195], v[16:19]
    s_mov_b32 s54, 5120
    ds_read_b64_tr_b16 a[104:105], v3 offset:544
    ds_read_b64_tr_b16 a[106:107], v3 offset:672
    v_mfma_f32_16x16x32_bf16 v[16:19], a[84:87], v[200:203], v[16:19]
    s_waitcnt lgkmcnt(6)
    v_permlane32_swap_b32 v48, v50
    v_mfma_f32_16x16x32_bf16 v[16:19], a[88:91], v[208:211], v[16:19]
    v_permlane32_swap_b32 v49, v51
    v_mfma_f32_16x16x32_bf16 v[16:19], a[92:95], v[216:219], v[16:19]
    ds_read_b64_tr_b16 a[108:109], v3 offset:800
    ds_read_b64_tr_b16 a[110:111], v3 offset:928
    buffer_store_dwordx4 v[48:51], v10, s[40:43], s54 offen offset:512 sc1
    v_mfma_f32_16x16x32_bf16 v[20:23], a[64:67], v[160:163], 0
    ds_read_b64_tr_b16 a[112:113], v3 offset:16928
    v_cvt_pk_bf16_f32 v52, v36, v37
    v_mfma_f32_16x16x32_bf16 v[20:23], a[68:71], v[168:171], v[20:23]
    ds_read_b64_tr_b16 a[114:115], v3 offset:17056
    v_cvt_pk_bf16_f32 v53, v38, v39
    v_mfma_f32_16x16x32_bf16 v[20:23], a[72:75], v[176:179], v[20:23]
    ds_read_b64_tr_b16 a[116:117], v3 offset:17184
    v_cvt_pk_bf16_f32 v54, v44, v45
    v_mfma_f32_16x16x32_bf16 v[20:23], a[76:79], v[184:187], v[20:23]
    ds_read_b64_tr_b16 a[118:119], v3 offset:17312
    v_cvt_pk_bf16_f32 v55, v46, v47
    v_mfma_f32_16x16x32_bf16 v[20:23], a[80:83], v[224:227], v[20:23]
    s_mov_b32 s54, 300032
    ds_read_b64_tr_b16 a[120:121], v3 offset:17440
    ds_read_b64_tr_b16 a[122:123], v3 offset:17568
    v_mfma_f32_16x16x32_bf16 v[20:23], a[84:87], v[232:235], v[20:23]
    v_permlane32_swap_b32 v52, v54
    v_mfma_f32_16x16x32_bf16 v[20:23], a[88:91], v[240:243], v[20:23]
    v_permlane32_swap_b32 v53, v55
    v_mfma_f32_16x16x32_bf16 v[20:23], a[92:95], v[248:251], v[20:23]
    s_waitcnt lgkmcnt(10)
    ds_read_b64_tr_b16 a[124:125], v3 offset:17696
    ds_read_b64_tr_b16 a[126:127], v3 offset:17824
    buffer_store_dwordx4 v[52:55], v10, s[40:43], s54 offen offset:512 sc1
    v_mfma_f32_16x16x32_bf16 v[24:27], a[96:99], v[128:131], 0
    ds_read_b64_tr_b16 a[64:65], v3 offset:64
    v_mfma_f32_16x16x32_bf16 v[24:27], a[100:103], v[136:139], v[24:27]
    s_waitcnt lgkmcnt(9)
    ds_read_b64_tr_b16 a[66:67], v3 offset:192
    v_mfma_f32_16x16x32_bf16 v[24:27], a[104:107], v[144:147], v[24:27]
    ds_read_b64_tr_b16 a[68:69], v3 offset:320
    v_mfma_f32_16x16x32_bf16 v[24:27], a[108:111], v[152:155], v[24:27]
    s_waitcnt lgkmcnt(7)
    ds_read_b64_tr_b16 a[70:71], v3 offset:448
    v_mfma_f32_16x16x32_bf16 v[24:27], a[112:115], v[192:195], v[24:27]
    ds_read_b64_tr_b16 a[72:73], v3 offset:576
    v_mfma_f32_16x16x32_bf16 v[24:27], a[116:119], v[200:203], v[24:27]
    s_waitcnt lgkmcnt(5)
    ds_read_b64_tr_b16 a[74:75], v3 offset:704
    v_mfma_f32_16x16x32_bf16 v[24:27], a[120:123], v[208:211], v[24:27]
    ds_read_b64_tr_b16 a[76:77], v3 offset:832
    v_mfma_f32_16x16x32_bf16 v[24:27], a[124:127], v[216:219], v[24:27]
    ds_read_b64_tr_b16 a[78:79], v3 offset:960
    v_mfma_f32_16x16x32_bf16 v[28:31], a[96:99], v[160:163], 0
    ds_read_b64_tr_b16 a[80:81], v3 offset:16960
    v_mfma_f32_16x16x32_bf16 v[28:31], a[100:103], v[168:171], v[28:31]
    ds_read_b64_tr_b16 a[82:83], v3 offset:17088
    v_mfma_f32_16x16x32_bf16 v[28:31], a[104:107], v[176:179], v[28:31]
    ds_read_b64_tr_b16 a[84:85], v3 offset:17216
    v_mfma_f32_16x16x32_bf16 v[28:31], a[108:111], v[184:187], v[28:31]
    ds_read_b64_tr_b16 a[86:87], v3 offset:17344
    v_mfma_f32_16x16x32_bf16 v[28:31], a[112:115], v[224:227], v[28:31]
    ds_read_b64_tr_b16 a[88:89], v3 offset:17472
    v_mfma_f32_16x16x32_bf16 v[28:31], a[116:119], v[232:235], v[28:31]
    ds_read_b64_tr_b16 a[90:91], v3 offset:17600
    v_mfma_f32_16x16x32_bf16 v[28:31], a[120:123], v[240:243], v[28:31]
    ds_read_b64_tr_b16 a[92:93], v3 offset:17728
    v_mfma_f32_16x16x32_bf16 v[28:31], a[124:127], v[248:251], v[28:31]
    s_waitcnt lgkmcnt(11)
    ds_read_b64_tr_b16 a[94:95], v3 offset:17856
    v_mfma_f32_16x16x32_bf16 v[32:35], a[64:67], v[128:131], 0
    ds_read_b64_tr_b16 a[96:97], v3 offset:96
    v_cvt_pk_bf16_f32 v48, v16, v17
    v_mfma_f32_16x16x32_bf16 v[32:35], a[68:71], v[136:139], v[32:35]
    s_waitcnt lgkmcnt(9)
    ds_read_b64_tr_b16 a[98:99], v3 offset:224
    v_cvt_pk_bf16_f32 v49, v18, v19
    v_mfma_f32_16x16x32_bf16 v[32:35], a[72:75], v[144:147], v[32:35]
    ds_read_b64_tr_b16 a[100:101], v3 offset:352
    v_cvt_pk_bf16_f32 v50, v24, v25
    v_mfma_f32_16x16x32_bf16 v[32:35], a[76:79], v[152:155], v[32:35]
    s_waitcnt lgkmcnt(7)
    ds_read_b64_tr_b16 a[102:103], v3 offset:480
    v_cvt_pk_bf16_f32 v51, v26, v27
    v_mfma_f32_16x16x32_bf16 v[32:35], a[80:83], v[192:195], v[32:35]
    s_mov_b32 s54, 6144
    ds_read_b64_tr_b16 a[104:105], v3 offset:608
    ds_read_b64_tr_b16 a[106:107], v3 offset:736
    v_mfma_f32_16x16x32_bf16 v[32:35], a[84:87], v[200:203], v[32:35]
    s_waitcnt lgkmcnt(6)
    v_permlane32_swap_b32 v48, v50
    v_mfma_f32_16x16x32_bf16 v[32:35], a[88:91], v[208:211], v[32:35]
    v_permlane32_swap_b32 v49, v51
    v_mfma_f32_16x16x32_bf16 v[32:35], a[92:95], v[216:219], v[32:35]
    ds_read_b64_tr_b16 a[108:109], v3 offset:864
    ds_read_b64_tr_b16 a[110:111], v3 offset:992
    buffer_store_dwordx4 v[48:51], v10, s[40:43], s54 offen offset:0 sc1
    v_mfma_f32_16x16x32_bf16 v[36:39], a[64:67], v[160:163], 0
    ds_read_b64_tr_b16 a[112:113], v3 offset:16992
    v_cvt_pk_bf16_f32 v52, v20, v21
    v_mfma_f32_16x16x32_bf16 v[36:39], a[68:71], v[168:171], v[36:39]
    ds_read_b64_tr_b16 a[114:115], v3 offset:17120
    v_cvt_pk_bf16_f32 v53, v22, v23
    v_mfma_f32_16x16x32_bf16 v[36:39], a[72:75], v[176:179], v[36:39]
    ds_read_b64_tr_b16 a[116:117], v3 offset:17248
    v_cvt_pk_bf16_f32 v54, v28, v29
    v_mfma_f32_16x16x32_bf16 v[36:39], a[76:79], v[184:187], v[36:39]
    ds_read_b64_tr_b16 a[118:119], v3 offset:17376
    v_cvt_pk_bf16_f32 v55, v30, v31
    v_mfma_f32_16x16x32_bf16 v[36:39], a[80:83], v[224:227], v[36:39]
    s_mov_b32 s54, 301056
    ds_read_b64_tr_b16 a[120:121], v3 offset:17504
    ds_read_b64_tr_b16 a[122:123], v3 offset:17632
    v_mfma_f32_16x16x32_bf16 v[36:39], a[84:87], v[232:235], v[36:39]
    v_permlane32_swap_b32 v52, v54
    v_mfma_f32_16x16x32_bf16 v[36:39], a[88:91], v[240:243], v[36:39]
    v_permlane32_swap_b32 v53, v55
    v_mfma_f32_16x16x32_bf16 v[36:39], a[92:95], v[248:251], v[36:39]
    s_waitcnt vmcnt(15)
    s_barrier
    s_waitcnt lgkmcnt(10)
    ds_read_b64_tr_b16 a[124:125], v3 offset:17760
    ds_read_b64_tr_b16 a[126:127], v3 offset:17888
    buffer_store_dwordx4 v[52:55], v10, s[40:43], s54 offen offset:0 sc1
    v_mfma_f32_16x16x32_bf16 v[40:43], a[96:99], v[128:131], 0
    ds_read_b64_tr_b16 a[64:65], v3 offset:36864
    v_mfma_f32_16x16x32_bf16 v[40:43], a[100:103], v[136:139], v[40:43]
    s_waitcnt lgkmcnt(9)
    ds_read_b64_tr_b16 a[66:67], v3 offset:36992
    v_mfma_f32_16x16x32_bf16 v[40:43], a[104:107], v[144:147], v[40:43]
    ds_read_b64_tr_b16 a[68:69], v3 offset:37120
    v_mfma_f32_16x16x32_bf16 v[40:43], a[108:111], v[152:155], v[40:43]
    s_waitcnt lgkmcnt(7)
    ds_read_b64_tr_b16 a[70:71], v3 offset:37248
    v_mfma_f32_16x16x32_bf16 v[40:43], a[112:115], v[192:195], v[40:43]
    ds_read_b64_tr_b16 a[72:73], v3 offset:37376
    v_mfma_f32_16x16x32_bf16 v[40:43], a[116:119], v[200:203], v[40:43]
    s_waitcnt lgkmcnt(5)
    ds_read_b64_tr_b16 a[74:75], v3 offset:37504
    v_mfma_f32_16x16x32_bf16 v[40:43], a[120:123], v[208:211], v[40:43]
    ds_read_b64_tr_b16 a[76:77], v3 offset:37632
    v_mfma_f32_16x16x32_bf16 v[40:43], a[124:127], v[216:219], v[40:43]
    ds_read_b64_tr_b16 a[78:79], v3 offset:37760
    v_mfma_f32_16x16x32_bf16 v[44:47], a[96:99], v[160:163], 0
    s_sub_u32 s28, s88, 4096
    s_subb_u32 s29, s89, 0
    ds_read_b64_tr_b16 a[80:81], v3 offset:53760
    v_mfma_f32_16x16x32_bf16 v[44:47], a[100:103], v[168:171], v[44:47]
    s_mov_b32 s30, 147456
    ds_read_b64_tr_b16 a[82:83], v3 offset:53888
    v_mfma_f32_16x16x32_bf16 v[44:47], a[104:107], v[176:179], v[44:47]
    ds_read_b64_tr_b16 a[84:85], v3 offset:54016
    v_mfma_f32_16x16x32_bf16 v[44:47], a[108:111], v[184:187], v[44:47]
    ds_read_b64_tr_b16 a[86:87], v3 offset:54144
    v_mfma_f32_16x16x32_bf16 v[44:47], a[112:115], v[224:227], v[44:47]
    ds_read_b64_tr_b16 a[88:89], v3 offset:54272
    v_mfma_f32_16x16x32_bf16 v[44:47], a[116:119], v[232:235], v[44:47]
    ds_read_b64_tr_b16 a[90:91], v3 offset:54400
    v_mfma_f32_16x16x32_bf16 v[44:47], a[120:123], v[240:243], v[44:47]
    ds_read_b64_tr_b16 a[92:93], v3 offset:54528
    v_mfma_f32_16x16x32_bf16 v[44:47], a[124:127], v[248:251], v[44:47]
    s_waitcnt lgkmcnt(11)
    ds_read_b64_tr_b16 a[94:95], v3 offset:54656
    v_mfma_f32_16x16x32_bf16 v[16:19], a[64:67], v[128:131], 0
    ds_read_b64_tr_b16 a[96:97], v3 offset:36896
    v_cvt_pk_bf16_f32 v48, v32, v33
    v_mfma_f32_16x16x32_bf16 v[16:19], a[68:71], v[136:139], v[16:19]
    s_waitcnt lgkmcnt(9)
    ds_read_b64_tr_b16 a[98:99], v3 offset:37024
    v_cvt_pk_bf16_f32 v49, v34, v35
    v_mfma_f32_16x16x32_bf16 v[16:19], a[72:75], v[144:147], v[16:19]
    ds_read_b64_tr_b16 a[100:101], v3 offset:37152
    v_cvt_pk_bf16_f32 v50, v40, v41
    v_mfma_f32_16x16x32_bf16 v[16:19], a[76:79], v[152:155], v[16:19]
    s_waitcnt lgkmcnt(7)
    ds_read_b64_tr_b16 a[102:103], v3 offset:37280
    v_cvt_pk_bf16_f32 v51, v42, v43
    v_mfma_f32_16x16x32_bf16 v[16:19], a[80:83], v[192:195], v[16:19]
    s_mov_b32 s54, 6144
    ds_read_b64_tr_b16 a[104:105], v3 offset:37408
    ds_read_b64_tr_b16 a[106:107], v3 offset:37536
    v_mfma_f32_16x16x32_bf16 v[16:19], a[84:87], v[200:203], v[16:19]
    s_waitcnt lgkmcnt(6)
    v_permlane32_swap_b32 v48, v50
    v_mfma_f32_16x16x32_bf16 v[16:19], a[88:91], v[208:211], v[16:19]
    v_permlane32_swap_b32 v49, v51
    v_mfma_f32_16x16x32_bf16 v[16:19], a[92:95], v[216:219], v[16:19]
    ds_read_b64_tr_b16 a[108:109], v3 offset:37664
    ds_read_b64_tr_b16 a[110:111], v3 offset:37792
    buffer_store_dwordx4 v[48:51], v10, s[40:43], s54 offen offset:512 sc1
    v_mfma_f32_16x16x32_bf16 v[20:23], a[64:67], v[160:163], 0
    ds_read_b64_tr_b16 a[112:113], v3 offset:53792
    v_cvt_pk_bf16_f32 v52, v36, v37
    v_mfma_f32_16x16x32_bf16 v[20:23], a[68:71], v[168:171], v[20:23]
    ds_read_b64_tr_b16 a[114:115], v3 offset:53920
    v_cvt_pk_bf16_f32 v53, v38, v39
    v_mfma_f32_16x16x32_bf16 v[20:23], a[72:75], v[176:179], v[20:23]
    ds_read_b64_tr_b16 a[116:117], v3 offset:54048
    v_cvt_pk_bf16_f32 v54, v44, v45
    v_mfma_f32_16x16x32_bf16 v[20:23], a[76:79], v[184:187], v[20:23]
    ds_read_b64_tr_b16 a[118:119], v3 offset:54176
    v_cvt_pk_bf16_f32 v55, v46, v47
    v_mfma_f32_16x16x32_bf16 v[20:23], a[80:83], v[224:227], v[20:23]
    s_mov_b32 s54, 301056
    ds_read_b64_tr_b16 a[120:121], v3 offset:54304
    ds_read_b64_tr_b16 a[122:123], v3 offset:54432
    v_mfma_f32_16x16x32_bf16 v[20:23], a[84:87], v[232:235], v[20:23]
    v_permlane32_swap_b32 v52, v54
    v_mfma_f32_16x16x32_bf16 v[20:23], a[88:91], v[240:243], v[20:23]
    v_permlane32_swap_b32 v53, v55
    v_mfma_f32_16x16x32_bf16 v[20:23], a[92:95], v[248:251], v[20:23]
    s_waitcnt lgkmcnt(10)
    ds_read_b64_tr_b16 a[124:125], v3 offset:54560
    ds_read_b64_tr_b16 a[126:127], v3 offset:54688
    buffer_store_dwordx4 v[52:55], v10, s[40:43], s54 offen offset:512 sc1
    v_mfma_f32_16x16x32_bf16 v[24:27], a[96:99], v[128:131], 0
    ds_read_b64_tr_b16 a[64:65], v3 offset:36928
    v_mfma_f32_16x16x32_bf16 v[24:27], a[100:103], v[136:139], v[24:27]
    s_waitcnt lgkmcnt(9)
    ds_read_b64_tr_b16 a[66:67], v3 offset:37056
    v_mfma_f32_16x16x32_bf16 v[24:27], a[104:107], v[144:147], v[24:27]
    ds_read_b64_tr_b16 a[68:69], v3 offset:37184
    v_mfma_f32_16x16x32_bf16 v[24:27], a[108:111], v[152:155], v[24:27]
    s_waitcnt lgkmcnt(7)
    ds_read_b64_tr_b16 a[70:71], v3 offset:37312
    v_mfma_f32_16x16x32_bf16 v[24:27], a[112:115], v[192:195], v[24:27]
    ds_read_b64_tr_b16 a[72:73], v3 offset:37440
    v_mfma_f32_16x16x32_bf16 v[24:27], a[116:119], v[200:203], v[24:27]
    s_waitcnt lgkmcnt(5)
    ds_read_b64_tr_b16 a[74:75], v3 offset:37568
    v_mfma_f32_16x16x32_bf16 v[24:27], a[120:123], v[208:211], v[24:27]
    ds_read_b64_tr_b16 a[76:77], v3 offset:37696
    v_mfma_f32_16x16x32_bf16 v[24:27], a[124:127], v[216:219], v[24:27]
    ds_read_b64_tr_b16 a[78:79], v3 offset:37824
    v_mfma_f32_16x16x32_bf16 v[28:31], a[96:99], v[160:163], 0
    ds_read_b64_tr_b16 a[80:81], v3 offset:53824
    v_mfma_f32_16x16x32_bf16 v[28:31], a[100:103], v[168:171], v[28:31]
    ds_read_b64_tr_b16 a[82:83], v3 offset:53952
    v_mfma_f32_16x16x32_bf16 v[28:31], a[104:107], v[176:179], v[28:31]
    ds_read_b64_tr_b16 a[84:85], v3 offset:54080
    v_mfma_f32_16x16x32_bf16 v[28:31], a[108:111], v[184:187], v[28:31]
    ds_read_b64_tr_b16 a[86:87], v3 offset:54208
    v_mfma_f32_16x16x32_bf16 v[28:31], a[112:115], v[224:227], v[28:31]
    ds_read_b64_tr_b16 a[88:89], v3 offset:54336
    v_mfma_f32_16x16x32_bf16 v[28:31], a[116:119], v[232:235], v[28:31]
    ds_read_b64_tr_b16 a[90:91], v3 offset:54464
    v_mfma_f32_16x16x32_bf16 v[28:31], a[120:123], v[240:243], v[28:31]
    ds_read_b64_tr_b16 a[92:93], v3 offset:54592
    v_mfma_f32_16x16x32_bf16 v[28:31], a[124:127], v[248:251], v[28:31]
    s_waitcnt lgkmcnt(11)
    ds_read_b64_tr_b16 a[94:95], v3 offset:54720
    v_mfma_f32_16x16x32_bf16 v[32:35], a[64:67], v[128:131], 0
    ds_read_b64_tr_b16 a[96:97], v3 offset:36960
    v_cvt_pk_bf16_f32 v48, v16, v17
    v_mfma_f32_16x16x32_bf16 v[32:35], a[68:71], v[136:139], v[32:35]
    s_waitcnt lgkmcnt(9)
    ds_read_b64_tr_b16 a[98:99], v3 offset:37088
    v_cvt_pk_bf16_f32 v49, v18, v19
    v_mfma_f32_16x16x32_bf16 v[32:35], a[72:75], v[144:147], v[32:35]
    ds_read_b64_tr_b16 a[100:101], v3 offset:37216
    v_cvt_pk_bf16_f32 v50, v24, v25
    v_mfma_f32_16x16x32_bf16 v[32:35], a[76:79], v[152:155], v[32:35]
    s_waitcnt lgkmcnt(7)
    ds_read_b64_tr_b16 a[102:103], v3 offset:37344
    v_cvt_pk_bf16_f32 v51, v26, v27
    v_mfma_f32_16x16x32_bf16 v[32:35], a[80:83], v[192:195], v[32:35]
    s_mov_b32 s54, 7168
    ds_read_b64_tr_b16 a[104:105], v3 offset:37472
    ds_read_b64_tr_b16 a[106:107], v3 offset:37600
    v_mfma_f32_16x16x32_bf16 v[32:35], a[84:87], v[200:203], v[32:35]
    s_waitcnt lgkmcnt(6)
    v_permlane32_swap_b32 v48, v50
    v_mfma_f32_16x16x32_bf16 v[32:35], a[88:91], v[208:211], v[32:35]
    v_permlane32_swap_b32 v49, v51
    v_mfma_f32_16x16x32_bf16 v[32:35], a[92:95], v[216:219], v[32:35]
    ds_read_b64_tr_b16 a[108:109], v3 offset:37728
    ds_read_b64_tr_b16 a[110:111], v3 offset:37856
    buffer_store_dwordx4 v[48:51], v10, s[40:43], s54 offen offset:0 sc1
    v_mfma_f32_16x16x32_bf16 v[36:39], a[64:67], v[160:163], 0
    ds_read_b64_tr_b16 a[112:113], v3 offset:53856
    v_cvt_pk_bf16_f32 v52, v20, v21
    v_mfma_f32_16x16x32_bf16 v[36:39], a[68:71], v[168:171], v[36:39]
    ds_read_b64_tr_b16 a[114:115], v3 offset:53984
    v_cvt_pk_bf16_f32 v53, v22, v23
    v_mfma_f32_16x16x32_bf16 v[36:39], a[72:75], v[176:179], v[36:39]
    ds_read_b64_tr_b16 a[116:117], v3 offset:54112
    v_cvt_pk_bf16_f32 v54, v28, v29
    v_mfma_f32_16x16x32_bf16 v[36:39], a[76:79], v[184:187], v[36:39]
    ds_read_b64_tr_b16 a[118:119], v3 offset:54240
    v_cvt_pk_bf16_f32 v55, v30, v31
    v_mfma_f32_16x16x32_bf16 v[36:39], a[80:83], v[224:227], v[36:39]
    s_mov_b32 s54, 302080
    ds_read_b64_tr_b16 a[120:121], v3 offset:54368
    ds_read_b64_tr_b16 a[122:123], v3 offset:54496
    v_mfma_f32_16x16x32_bf16 v[36:39], a[84:87], v[232:235], v[36:39]
    v_permlane32_swap_b32 v52, v54
    v_mfma_f32_16x16x32_bf16 v[36:39], a[88:91], v[240:243], v[36:39]
    v_permlane32_swap_b32 v53, v55
    v_mfma_f32_16x16x32_bf16 v[36:39], a[92:95], v[248:251], v[36:39]
    s_waitcnt vmcnt(7)
    s_barrier
    s_waitcnt lgkmcnt(10)
    ds_read_b64_tr_b16 a[124:125], v3 offset:54624
    ds_read_b64_tr_b16 a[126:127], v3 offset:54752
    buffer_store_dwordx4 v[52:55], v10, s[40:43], s54 offen offset:0 sc1
    v_mfma_f32_16x16x32_bf16 v[40:43], a[96:99], v[128:131], 0
    ds_read_b64_tr_b16 a[64:65], v4 offset:0
    v_mfma_f32_16x16x32_bf16 v[40:43], a[100:103], v[136:139], v[40:43]
    s_waitcnt lgkmcnt(9)
    ds_read_b64_tr_b16 a[66:67], v4 offset:128
    v_mfma_f32_16x16x32_bf16 v[40:43], a[104:107], v[144:147], v[40:43]
    ds_read_b64_tr_b16 a[68:69], v4 offset:256
    v_mfma_f32_16x16x32_bf16 v[40:43], a[108:111], v[152:155], v[40:43]
    s_waitcnt lgkmcnt(7)
    ds_read_b64_tr_b16 a[70:71], v4 offset:384
    v_mfma_f32_16x16x32_bf16 v[40:43], a[112:115], v[192:195], v[40:43]
    ds_read_b64_tr_b16 a[72:73], v4 offset:512
    v_mfma_f32_16x16x32_bf16 v[40:43], a[116:119], v[200:203], v[40:43]
    s_waitcnt lgkmcnt(5)
    ds_read_b64_tr_b16 a[74:75], v4 offset:640
    v_mfma_f32_16x16x32_bf16 v[40:43], a[120:123], v[208:211], v[40:43]
    ds_read_b64_tr_b16 a[76:77], v4 offset:768
    v_mfma_f32_16x16x32_bf16 v[40:43], a[124:127], v[216:219], v[40:43]
    ds_read_b64_tr_b16 a[78:79], v4 offset:896
    v_mfma_f32_16x16x32_bf16 v[44:47], a[96:99], v[160:163], 0
    ds_read_b64_tr_b16 a[80:81], v4 offset:16896
    v_mfma_f32_16x16x32_bf16 v[44:47], a[100:103], v[168:171], v[44:47]
    ds_read_b64_tr_b16 a[82:83], v4 offset:17024
    v_mfma_f32_16x16x32_bf16 v[44:47], a[104:107], v[176:179], v[44:47]
    ds_read_b64_tr_b16 a[84:85], v4 offset:17152
    v_mfma_f32_16x16x32_bf16 v[44:47], a[108:111], v[184:187], v[44:47]
    ds_read_b64_tr_b16 a[86:87], v4 offset:17280
    v_mfma_f32_16x16x32_bf16 v[44:47], a[112:115], v[224:227], v[44:47]
    ds_read_b64_tr_b16 a[88:89], v4 offset:17408
    v_mfma_f32_16x16x32_bf16 v[44:47], a[116:119], v[232:235], v[44:47]
    ds_read_b64_tr_b16 a[90:91], v4 offset:17536
    v_mfma_f32_16x16x32_bf16 v[44:47], a[120:123], v[240:243], v[44:47]
    ds_read_b64_tr_b16 a[92:93], v4 offset:17664
    v_mfma_f32_16x16x32_bf16 v[44:47], a[124:127], v[248:251], v[44:47]
    s_waitcnt lgkmcnt(11)
    ds_read_b64_tr_b16 a[94:95], v4 offset:17792
    v_mfma_f32_16x16x32_bf16 v[16:19], a[64:67], v[128:131], 0
    ds_read_b64_tr_b16 a[96:97], v4 offset:32
    v_cvt_pk_bf16_f32 v48, v32, v33
    v_mfma_f32_16x16x32_bf16 v[16:19], a[68:71], v[136:139], v[16:19]
    s_waitcnt lgkmcnt(9)
    ds_read_b64_tr_b16 a[98:99], v4 offset:160
    v_cvt_pk_bf16_f32 v49, v34, v35
    v_mfma_f32_16x16x32_bf16 v[16:19], a[72:75], v[144:147], v[16:19]
    ds_read_b64_tr_b16 a[100:101], v4 offset:288
    v_cvt_pk_bf16_f32 v50, v40, v41
    v_mfma_f32_16x16x32_bf16 v[16:19], a[76:79], v[152:155], v[16:19]
    s_waitcnt lgkmcnt(7)
    ds_read_b64_tr_b16 a[102:103], v4 offset:416
    v_cvt_pk_bf16_f32 v51, v42, v43
    v_mfma_f32_16x16x32_bf16 v[16:19], a[80:83], v[192:195], v[16:19]
    s_mov_b32 s54, 7168
    ds_read_b64_tr_b16 a[104:105], v4 offset:544
    ds_read_b64_tr_b16 a[106:107], v4 offset:672
    v_mfma_f32_16x16x32_bf16 v[16:19], a[84:87], v[200:203], v[16:19]
    s_waitcnt lgkmcnt(6)
    v_permlane32_swap_b32 v48, v50
    v_mfma_f32_16x16x32_bf16 v[16:19], a[88:91], v[208:211], v[16:19]
    v_permlane32_swap_b32 v49, v51
    v_mfma_f32_16x16x32_bf16 v[16:19], a[92:95], v[216:219], v[16:19]
    ds_read_b64_tr_b16 a[108:109], v4 offset:800
    ds_read_b64_tr_b16 a[110:111], v4 offset:928
    buffer_store_dwordx4 v[48:51], v10, s[40:43], s54 offen offset:512 sc1
    v_mfma_f32_16x16x32_bf16 v[20:23], a[64:67], v[160:163], 0
    ds_read_b64_tr_b16 a[112:113], v4 offset:16928
    v_cvt_pk_bf16_f32 v52, v36, v37
    v_mfma_f32_16x16x32_bf16 v[20:23], a[68:71], v[168:171], v[20:23]
    ds_read_b64_tr_b16 a[114:115], v4 offset:17056
    v_cvt_pk_bf16_f32 v53, v38, v39
    v_mfma_f32_16x16x32_bf16 v[20:23], a[72:75], v[176:179], v[20:23]
    ds_read_b64_tr_b16 a[116:117], v4 offset:17184
    v_cvt_pk_bf16_f32 v54, v44, v45
    v_mfma_f32_16x16x32_bf16 v[20:23], a[76:79], v[184:187], v[20:23]
    ds_read_b64_tr_b16 a[118:119], v4 offset:17312
    v_cvt_pk_bf16_f32 v55, v46, v47
    v_mfma_f32_16x16x32_bf16 v[20:23], a[80:83], v[224:227], v[20:23]
    s_mov_b32 s54, 302080
    ds_read_b64_tr_b16 a[120:121], v4 offset:17440
    ds_read_b64_tr_b16 a[122:123], v4 offset:17568
    v_mfma_f32_16x16x32_bf16 v[20:23], a[84:87], v[232:235], v[20:23]
    v_permlane32_swap_b32 v52, v54
    v_mfma_f32_16x16x32_bf16 v[20:23], a[88:91], v[240:243], v[20:23]
    v_permlane32_swap_b32 v53, v55
    v_mfma_f32_16x16x32_bf16 v[20:23], a[92:95], v[248:251], v[20:23]
    s_waitcnt lgkmcnt(10)
    ds_read_b64_tr_b16 a[124:125], v4 offset:17696
    ds_read_b64_tr_b16 a[126:127], v4 offset:17824
    buffer_store_dwordx4 v[52:55], v10, s[40:43], s54 offen offset:512 sc1
    v_mfma_f32_16x16x32_bf16 v[24:27], a[96:99], v[128:131], 0
    ds_read_b64_tr_b16 a[64:65], v4 offset:64
    v_mfma_f32_16x16x32_bf16 v[24:27], a[100:103], v[136:139], v[24:27]
    s_waitcnt lgkmcnt(9)
    ds_read_b64_tr_b16 a[66:67], v4 offset:192
    v_mfma_f32_16x16x32_bf16 v[24:27], a[104:107], v[144:147], v[24:27]
    ds_read_b64_tr_b16 a[68:69], v4 offset:320
    v_mfma_f32_16x16x32_bf16 v[24:27], a[108:111], v[152:155], v[24:27]
    s_waitcnt lgkmcnt(7)
    ds_read_b64_tr_b16 a[70:71], v4 offset:448
    v_mfma_f32_16x16x32_bf16 v[24:27], a[112:115], v[192:195], v[24:27]
L2_pad13:
    s_cbranch_execz L2_walkret
    ds_read_b64_tr_b16 a[72:73], v4 offset:576
    v_mfma_f32_16x16x32_bf16 v[24:27], a[116:119], v[200:203], v[24:27]
    s_waitcnt lgkmcnt(5)
    ds_read_b64_tr_b16 a[74:75], v4 offset:704
    v_mfma_f32_16x16x32_bf16 v[24:27], a[120:123], v[208:211], v[24:27]
    ds_read_b64_tr_b16 a[76:77], v4 offset:832
    v_mfma_f32_16x16x32_bf16 v[24:27], a[124:127], v[216:219], v[24:27]
    ds_read_b64_tr_b16 a[78:79], v4 offset:960
    v_mfma_f32_16x16x32_bf16 v[28:31], a[96:99], v[160:163], 0
    ds_read_b64_tr_b16 a[80:81], v4 offset:16960
    v_mfma_f32_16x16x32_bf16 v[28:31], a[100:103], v[168:171], v[28:31]
    ds_read_b64_tr_b16 a[82:83], v4 offset:17088
    v_mfma_f32_16x16x32_bf16 v[28:31], a[104:107], v[176:179], v[28:31]
    ds_read_b64_tr_b16 a[84:85], v4 offset:17216
    v_mfma_f32_16x16x32_bf16 v[28:31], a[108:111], v[184:187], v[28:31]
    ds_read_b64_tr_b16 a[86:87], v4 offset:17344
    v_mfma_f32_16x16x32_bf16 v[28:31], a[112:115], v[224:227], v[28:31]
    ds_read_b64_tr_b16 a[88:89], v4 offset:17472
    v_mfma_f32_16x16x32_bf16 v[28:31], a[116:119], v[232:235], v[28:31]
    ds_read_b64_tr_b16 a[90:91], v4 offset:17600
    v_mfma_f32_16x16x32_bf16 v[28:31], a[120:123], v[240:243], v[28:31]
    ds_read_b64_tr_b16 a[92:93], v4 offset:17728
    v_mfma_f32_16x16x32_bf16 v[28:31], a[124:127], v[248:251], v[28:31]
    s_waitcnt lgkmcnt(11)
    ds_read_b64_tr_b16 a[94:95], v4 offset:17856
    v_mfma_f32_16x16x32_bf16 v[32:35], a[64:67], v[128:131], 0
    ds_read_b64_tr_b16 a[96:97], v4 offset:96
    v_cvt_pk_bf16_f32 v48, v16, v17
    v_mfma_f32_16x16x32_bf16 v[32:35], a[68:71], v[136:139], v[32:35]
    s_waitcnt lgkmcnt(9)
    ds_read_b64_tr_b16 a[98:99], v4 offset:224
    v_cvt_pk_bf16_f32 v49, v18, v19
    v_mfma_f32_16x16x32_bf16 v[32:35], a[72:75], v[144:147], v[32:35]
    ds_read_b64_tr_b16 a[100:101], v4 offset:352
    v_cvt_pk_bf16_f32 v50, v24, v25
    v_mfma_f32_16x16x32_bf16 v[32:35], a[76:79], v[152:155], v[32:35]
    s_waitcnt lgkmcnt(7)
    ds_read_b64_tr_b16 a[102:103], v4 offset:480
    v_cvt_pk_bf16_f32 v51, v26, v27
    v_mfma_f32_16x16x32_bf16 v[32:35], a[80:83], v[192:195], v[32:35]
    s_mov_b32 s54, 8192
    ds_read_b64_tr_b16 a[104:105], v4 offset:608
    ds_read_b64_tr_b16 a[106:107], v4 offset:736
    v_mfma_f32_16x16x32_bf16 v[32:35], a[84:87], v[200:203], v[32:35]
    s_waitcnt lgkmcnt(6)
    v_permlane32_swap_b32 v48, v50
    v_mfma_f32_16x16x32_bf16 v[32:35], a[88:91], v[208:211], v[32:35]
    v_permlane32_swap_b32 v49, v51
    v_mfma_f32_16x16x32_bf16 v[32:35], a[92:95], v[216:219], v[32:35]
    ds_read_b64_tr_b16 a[108:109], v4 offset:864
    ds_read_b64_tr_b16 a[110:111], v4 offset:992
    buffer_store_dwordx4 v[48:51], v10, s[40:43], s54 offen offset:0 sc1
    v_mfma_f32_16x16x32_bf16 v[36:39], a[64:67], v[160:163], 0
    ds_read_b64_tr_b16 a[112:113], v4 offset:16992
    v_cvt_pk_bf16_f32 v52, v20, v21
    v_mfma_f32_16x16x32_bf16 v[36:39], a[68:71], v[168:171], v[36:39]
    ds_read_b64_tr_b16 a[114:115], v4 offset:17120
    v_cvt_pk_bf16_f32 v53, v22, v23
    v_mfma_f32_16x16x32_bf16 v[36:39], a[72:75], v[176:179], v[36:39]
    ds_read_b64_tr_b16 a[116:117], v4 offset:17248
    v_cvt_pk_bf16_f32 v54, v28, v29
    v_mfma_f32_16x16x32_bf16 v[36:39], a[76:79], v[184:187], v[36:39]
    ds_read_b64_tr_b16 a[118:119], v4 offset:17376
    v_cvt_pk_bf16_f32 v55, v30, v31
    v_mfma_f32_16x16x32_bf16 v[36:39], a[80:83], v[224:227], v[36:39]
    s_mov_b32 s54, 303104
    ds_read_b64_tr_b16 a[120:121], v4 offset:17504
    ds_read_b64_tr_b16 a[122:123], v4 offset:17632
    v_mfma_f32_16x16x32_bf16 v[36:39], a[84:87], v[232:235], v[36:39]
    v_permlane32_swap_b32 v52, v54
    v_mfma_f32_16x16x32_bf16 v[36:39], a[88:91], v[240:243], v[36:39]
    v_permlane32_swap_b32 v53, v55
    v_mfma_f32_16x16x32_bf16 v[36:39], a[92:95], v[248:251], v[36:39]
    s_waitcnt lgkmcnt(10)
    ds_read_b64_tr_b16 a[124:125], v4 offset:17760
    ds_read_b64_tr_b16 a[126:127], v4 offset:17888
    buffer_store_dwordx4 v[52:55], v10, s[40:43], s54 offen offset:0 sc1
    v_mfma_f32_16x16x32_bf16 v[40:43], a[96:99], v[128:131], 0
    v_mfma_f32_16x16x32_bf16 v[40:43], a[100:103], v[136:139], v[40:43]
    s_waitcnt lgkmcnt(8)
    v_mfma_f32_16x16x32_bf16 v[40:43], a[104:107], v[144:147], v[40:43]
    v_mfma_f32_16x16x32_bf16 v[40:43], a[108:111], v[152:155], v[40:43]
    s_waitcnt lgkmcnt(4)
    v_mfma_f32_16x16x32_bf16 v[40:43], a[112:115], v[192:195], v[40:43]
    v_mfma_f32_16x16x32_bf16 v[40:43], a[116:119], v[200:203], v[40:43]
    s_waitcnt lgkmcnt(0)
    v_mfma_f32_16x16x32_bf16 v[40:43], a[120:123], v[208:211], v[40:43]
    v_mfma_f32_16x16x32_bf16 v[40:43], a[124:127], v[216:219], v[40:43]
    v_mfma_f32_16x16x32_bf16 v[44:47], a[96:99], v[160:163], 0
    v_mfma_f32_16x16x32_bf16 v[44:47], a[100:103], v[168:171], v[44:47]
    v_mfma_f32_16x16x32_bf16 v[44:47], a[104:107], v[176:179], v[44:47]
    v_mfma_f32_16x16x32_bf16 v[44:47], a[108:111], v[184:187], v[44:47]
    v_mfma_f32_16x16x32_bf16 v[44:47], a[112:115], v[224:227], v[44:47]
    v_mfma_f32_16x16x32_bf16 v[44:47], a[116:119], v[232:235], v[44:47]
    v_mfma_f32_16x16x32_bf16 v[44:47], a[120:123], v[240:243], v[44:47]
    v_mfma_f32_16x16x32_bf16 v[44:47], a[124:127], v[248:251], v[44:47]
    s_nop 7
    v_cvt_pk_bf16_f32 v48, v32, v33
    v_cvt_pk_bf16_f32 v49, v34, v35
    v_cvt_pk_bf16_f32 v50, v40, v41
    v_cvt_pk_bf16_f32 v51, v42, v43
    s_nop 1
    v_permlane32_swap_b32 v48, v50
    v_permlane32_swap_b32 v49, v51
    s_mov_b32 s54, 8192
    buffer_store_dwordx4 v[48:51], v10, s[40:43], s54 offen offset:512 sc1
    v_cvt_pk_bf16_f32 v52, v36, v37
    v_cvt_pk_bf16_f32 v53, v38, v39
    v_cvt_pk_bf16_f32 v54, v44, v45
    v_cvt_pk_bf16_f32 v55, v46, v47
    s_nop 1
    v_permlane32_swap_b32 v52, v54
    v_permlane32_swap_b32 v53, v55
    s_mov_b32 s54, 303104
    buffer_store_dwordx4 v[52:55], v10, s[40:43], s54 offen offset:512 sc1
    buffer_load_dword v9, v6, s[84:87], s47 offen sc1
    s_movk_i32 s45, 4608
    buffer_load_dwordx4 v[76:79], v5, s[84:87], s45 offen sc1
    s_movk_i32 s45, 18432
    buffer_load_dwordx4 v[88:91], v5, s[84:87], s45 offen sc1
    s_movk_i32 s45, 8704
    buffer_load_dwordx4 v[80:83], v5, s[84:87], s45 offen sc1
    s_movk_i32 s45, 22528
    buffer_load_dwordx4 v[92:95], v5, s[84:87], s45 offen sc1
    s_movk_i32 s45, 12800
    buffer_load_dwordx4 v[84:87], v59, s[84:87], s45 offen sc1
    s_movk_i32 s45, 26624
    buffer_load_dwordx4 v[96:99], v59, s[84:87], s45 offen sc1
    buffer_load_dwordx4 v[224:227], v12, s[36:39], 0 offen offset:0
    buffer_load_dwordx4 v[232:235], v12, s[36:39], 0 offen offset:512
    buffer_load_dwordx4 v[240:243], v13, s[36:39], 0 offen offset:1024
    buffer_load_dwordx4 v[64:67], v1, s[76:79], 0 offen offset:0
    buffer_load_dwordx4 v[68:71], v1, s[76:79], 0 offen offset:512
    buffer_load_dwordx4 v[72:75], v2, s[76:79], 0 offen offset:0
    s_waitcnt vmcnt(13)
    buffer_store_dword v3, v15, s[84:87], s56 offen sc1
    s_movk_i32 s48, 0x1111
    v_lshrrev_b32 v15, 4, v0
    v_mul_u32_u24 v15, 9216, v15
    v_add_u32 v15, 4096, v15
    v_add_u32 v7, v59, v15
    s_waitcnt vmcnt(13)
    v_cmp_ne_u32 vcc, 0, v9
    s_nop 0
    s_lshr_b32 s3, vcc_lo, 1
    s_and_b32 s3, s3, vcc_lo
    s_lshr_b32 s14, s3, 2
    s_and_b32 s3, s3, s14
    s_and_b32 s3, s3, s48
    s_cbranch_scc0 L2_g0s
L2_g0r:
    s_ff1_i32_b32 s3, s3
    s_bitset0_b32 s48, s3
    s_mul_i32 s46, s3, 9216
    buffer_load_dwordx4 v[112:115], v7, s[88:91], s46 offen sc1
    buffer_load_dwordx4 v[116:119], v5, s[88:91], s46 offen sc1
    buffer_load_dwordx4 v[120:123], v5, s[28:31], s46 offen sc1
    s_add_u32 s46, s46, 9216
    buffer_load_dwordx4 v[124:127], v5, s[88:91], s46 offen sc1
    buffer_load_dwordx4 v[128:131], v5, s[28:31], s46 offen sc1
    s_add_u32 s46, s46, 9216
    buffer_load_dwordx4 v[132:135], v5, s[88:91], s46 offen sc1
    buffer_load_dwordx4 v[136:139], v5, s[28:31], s46 offen sc1
    s_add_u32 s46, s46, 9216
    buffer_load_dwordx4 v[140:143], v5, s[88:91], s46 offen sc1
    buffer_load_dwordx4 v[144:147], v5, s[28:31], s46 offen sc1
    v_cmp_ne_u32 vcc, 0, v9
    s_nop 0
    s_lshr_b32 s3, vcc_lo, 1
    s_and_b32 s3, s3, vcc_lo
    s_lshr_b32 s14, s3, 2
    s_and_b32 s3, s3, s14
    s_and_b32 s3, s3, s48
    s_cbranch_scc0 L2_g1s
L2_g1r:
    s_ff1_i32_b32 s3, s3
    s_bitset0_b32 s48, s3
    s_mul_i32 s46, s3, 9216
    buffer_load_dword v9, v6, s[84:87], s47 offen sc1
    buffer_load_dwordx4 v[148:151], v7, s[88:91], s46 offen sc1
    buffer_load_dwordx4 v[152:155], v5, s[88:91], s46 offen sc1
    buffer_load_dwordx4 v[156:159], v5, s[28:31], s46 offen sc1
    s_add_u32 s46, s46, 9216
    buffer_load_dwordx4 v[160:163], v5, s[88:91], s46 offen sc1
    buffer_load_dwordx4 v[164:167], v5, s[28:31], s46 offen sc1
    s_add_u32 s46, s46, 9216
    buffer_load_dwordx4 v[168:171], v5, s[88:91], s46 offen sc1
    buffer_load_dwordx4 v[172:175], v5, s[28:31], s46 offen sc1
    s_add_u32 s46, s46, 9216
    buffer_load_dwordx4 v[176:179], v5, s[88:91], s46 offen sc1
    buffer_load_dwordx4 v[180:183], v5, s[28:31], s46 offen sc1
    s_waitcnt vmcnt(20)
    v_mov_b32 v14, v13
    v_max_u32 v13, v76, v77
    v_max3_u32 v13, v13, v78, v79
    v_max3_u32 v13, v13, v88, v89
    v_max3_u32 v13, v13, v90, v91
    v_max3_u32 v13, v13, v80, v81
    v_max3_u32 v13, v13, v82, v83
    v_max3_u32 v13, v13, v92, v93
    v_max3_u32 v13, v13, v94, v95
    v_max3_u32 v13, v13, v84, v85
    v_max3_u32 v13, v13, v86, v87
    v_max3_u32 v13, v13, v96, v97
    v_max3_u32 v13, v13, v98, v99
    v_cmp_eq_u32 vcc, -1, v13
    s_nop 0
    s_cmp_lg_u64 vcc, 0
    s_cbranch_scc1 L2_pns
L2_pnr:
    v_pk_add_f32 v[76:77], v[76:77], v[88:89]
    v_pk_add_f32 v[78:79], v[78:79], v[90:91]
    ds_write_b128 v5, v[76:79] offset:0
    v_pk_add_f32 v[80:81], v[80:81], v[92:93]
    v_pk_add_f32 v[82:83], v[82:83], v[94:95]
    ds_write_b128 v5, v[80:83] offset:4096
    v_pk_add_f32 v[84:85], v[84:85], v[96:97]
    v_pk_add_f32 v[86:87], v[86:87], v[98:99]
    ds_write_b128 v59, v[84:87] offset:8192
    s_waitcnt lgkmcnt(0)
    s_barrier
    v_lshlrev_b32 v3, 1, v12
    v_lshlrev_b32 v4, 1, v14
    ds_read_b128 v[76:79], v3 offset:4608
    ds_read_b128 v[80:83], v3 offset:4624
    ds_read_b128 v[84:87], v3 offset:5632
    ds_read_b128 v[88:91], v3 offset:5648
    ds_read_b128 v[92:95], v4 offset:6656
    ds_read_b128 v[96:99], v4 offset:6672
    ds_read_b128 v[40:43], v3 offset:2304
    ds_read_b128 v[44:47], v3 offset:2320
    ds_read_b128 v[48:51], v3 offset:3328
    ds_read_b128 v[52:55], v3 offset:3344
    ds_read_b128 v[56:59], v4 offset:4352
    ds_read_b128 v[60:63], v4 offset:4368
    ds_write_b128 v106, a[20:23] offset:36864
    ds_write_b128 v106, a[24:27] offset:37888
    s_waitcnt lgkmcnt(2)
    v_lshlrev_b32 v12, 16, v224
    v_and_b32 v13, 0xffff0000, v224
    v_pk_mul_f32 v[76:77], v[76:77], v[12:13]
    v_pk_mul_f32 v[40:41], v[40:41], v[12:13]
    v_lshlrev_b32 v14, 16, v225
    v_and_b32 v15, 0xffff0000, v225
    v_pk_mul_f32 v[78:79], v[78:79], v[14:15]
    v_pk_mul_f32 v[42:43], v[42:43], v[14:15]
    v_lshlrev_b32 v12, 16, v226
    v_and_b32 v13, 0xffff0000, v226
    v_pk_mul_f32 v[80:81], v[80:81], v[12:13]
    v_pk_mul_f32 v[44:45], v[44:45], v[12:13]
    v_lshlrev_b32 v14, 16, v227
    v_and_b32 v15, 0xffff0000, v227
    v_pk_mul_f32 v[82:83], v[82:83], v[14:15]
    v_pk_mul_f32 v[46:47], v[46:47], v[14:15]
    v_lshlrev_b32 v12, 16, v232
    v_and_b32 v13, 0xffff0000, v232
    v_pk_mul_f32 v[84:85], v[84:85], v[12:13]
    v_pk_mul_f32 v[48:49], v[48:49], v[12:13]
    v_lshlrev_b32 v14, 16, v233
    v_and_b32 v15, 0xffff0000, v233
    v_pk_mul_f32 v[86:87], v[86:87], v[14:15]
    v_pk_mul_f32 v[50:51], v[50:51], v[14:15]
    ds_write_b128 v106, a[28:31] offset:38912
    ds_write_b128 v106, a[32:35] offset:39936
    v_lshlrev_b32 v12, 16, v234
    v_and_b32 v13, 0xffff0000, v234
    v_pk_mul_f32 v[88:89], v[88:89], v[12:13]
    v_pk_mul_f32 v[52:53], v[52:53], v[12:13]
    v_lshlrev_b32 v14, 16, v235
    v_and_b32 v15, 0xffff0000, v235
    v_pk_mul_f32 v[90:91], v[90:91], v[14:15]
    v_pk_mul_f32 v[54:55], v[54:55], v[14:15]
    v_lshlrev_b32 v12, 16, v240
    v_and_b32 v13, 0xffff0000, v240
    v_pk_mul_f32 v[92:93], v[92:93], v[12:13]
    v_pk_mul_f32 v[56:57], v[56:57], v[12:13]
    v_lshlrev_b32 v14, 16, v241
    v_and_b32 v15, 0xffff0000, v241
    v_pk_mul_f32 v[94:95], v[94:95], v[14:15]
    v_pk_mul_f32 v[58:59], v[58:59], v[14:15]
    v_lshlrev_b32 v12, 16, v242
    v_and_b32 v13, 0xffff0000, v242
    v_pk_mul_f32 v[96:97], v[96:97], v[12:13]
    v_pk_mul_f32 v[60:61], v[60:61], v[12:13]
    v_lshlrev_b32 v14, 16, v243
    v_and_b32 v15, 0xffff0000, v243
    v_pk_mul_f32 v[98:99], v[98:99], v[14:15]
    v_pk_mul_f32 v[62:63], v[62:63], v[14:15]
    ds_write_b128 v106, a[36:39] offset:40960
    ds_write_b128 v106, a[40:43] offset:41984
    v_pk_add_f32 v[12:13], v[76:77], v[78:79]
    v_pk_add_f32 v[12:13], v[12:13], v[80:81]
    v_pk_add_f32 v[12:13], v[12:13], v[82:83]
    v_pk_add_f32 v[12:13], v[12:13], v[84:85]
    v_pk_add_f32 v[12:13], v[12:13], v[86:87]
    v_pk_add_f32 v[12:13], v[12:13], v[88:89]
    v_pk_add_f32 v[12:13], v[12:13], v[90:91]
    v_pk_add_f32 v[14:15], v[92:93], v[94:95]
    v_pk_add_f32 v[14:15], v[14:15], v[96:97]
    v_pk_add_f32 v[14:15], v[14:15], v[98:99]
    v_add_f32 v100, v12, v13
    v_add_f32 v14, v14, v15
    v_fmac_f32 v100, 0x3e800000, v14
    v_pk_add_f32 v[12:13], v[40:41], v[42:43]
    v_pk_add_f32 v[12:13], v[12:13], v[44:45]
    v_pk_add_f32 v[12:13], v[12:13], v[46:47]
    v_pk_add_f32 v[12:13], v[12:13], v[48:49]
    v_pk_add_f32 v[12:13], v[12:13], v[50:51]
    v_pk_add_f32 v[12:13], v[12:13], v[52:53]
    v_pk_add_f32 v[12:13], v[12:13], v[54:55]
    v_pk_add_f32 v[14:15], v[56:57], v[58:59]
    v_pk_add_f32 v[14:15], v[14:15], v[60:61]
    v_pk_add_f32 v[14:15], v[14:15], v[62:63]
    v_add_f32 v101, v12, v13
    v_add_f32 v14, v14, v15
    v_fmac_f32 v101, 0x3e800000, v14
    ds_read_b128 v[40:43], v3 offset:0
    ds_read_b128 v[44:47], v3 offset:16
    ds_read_b128 v[48:51], v3 offset:1024
    ds_read_b128 v[52:55], v3 offset:1040
    ds_read_b128 v[56:59], v4 offset:2048
    ds_read_b128 v[60:63], v4 offset:2064
    ds_write_b128 v106, a[44:47] offset:43008
    ds_write_b128 v106, a[48:51] offset:44032
    s_nop 1
    v_add_f32_dpp v100, v100, v100 row_ror:8 row_mask:0xf bank_mask:0xf
    v_add_f32_dpp v101, v101, v101 row_ror:8 row_mask:0xf bank_mask:0xf
    v_mov_b32 v102, v100
    v_mov_b32 v103, v101
    s_nop 0
    v_permlane16_swap_b32 v102, v100
    v_permlane16_swap_b32 v103, v101
    v_add_f32 v100, v100, v102
    v_add_f32 v101, v101, v103
    v_mov_b32 v102, v100
    v_mov_b32 v103, v101
    s_nop 0
    v_permlane32_swap_b32 v102, v100
    v_permlane32_swap_b32 v103, v101
    v_add_f32 v100, v100, v102
    v_add_f32 v101, v101, v103
    v_and_b32 v14, 7, v0
    v_lshlrev_b32 v11, 4, v14
    v_add_u32 v11, 14080, v11
    s_lshl_b32 s3, s51, 2
    v_add_u32 v10, s3, v11
    ds_write_b32 v10, v100 offset:384
    ds_write_b32 v10, v101 offset:512
    v_lshl_add_u32 v1, v14, 4, v1
    v_lshl_add_u32 v2, v14, 4, v2
    v_add_u32 v1, 90112, v1
    v_add_u32 v2, 90112, v2
    s_and_b32 s14, s51, 1
    s_mul_i32 s14, s14, 9344
    s_add_u32 s14, s14, 90112
    v_add_u32 v107, s14, v8
    v_lshrrev_b32 v15, 3, v0
    v_mul_u32_u24 v12, 1024, v15
    v_add_u32 v109, v12, v8
    v_lshl_add_u32 v12, v15, 4, v12
    v_add_u32 v108, v12, v107
    s_mul_i32 s3, s96, 9216
    s_cmp_eq_u32 s51, 3
    s_cselect_b32 s3, 0, s3
    s_cselect_b64 s[24:25], s[32:33], s[80:81]
    s_add_u32 s24, s24, s3
    s_addc_u32 s25, s25, 0
    s_mov_b32 s26, 9216
    s_mov_b32 s27, 0x20000
    ds_write_b128 v106, a[52:55] offset:45056
    ds_write_b128 v105, a[128:131] offset:0
    s_waitcnt lgkmcnt(2)
    s_waitcnt vmcnt(18)
    ds_write_b128 v105, a[132:135] offset:1024
    ds_write_b128 v105, a[136:139] offset:2048
    v_lshlrev_b32 v32, 16, v112
    v_and_b32 v33, 0xffff0000, v112
    v_lshlrev_b32 v34, 16, v113
    v_and_b32 v35, 0xffff0000, v113
    v_lshlrev_b32 v36, 16, v114
    v_and_b32 v37, 0xffff0000, v114
    v_lshlrev_b32 v38, 16, v115
    v_and_b32 v39, 0xffff0000, v115
    s_waitcnt vmcnt(17)
    ds_write_b128 v105, a[140:143] offset:3072
    ds_write_b128 v105, a[144:147] offset:4096
    v_lshlrev_b32 v24, 16, v116
    v_and_b32 v25, 0xffff0000, v116
    v_lshlrev_b32 v26, 16, v117
    v_and_b32 v27, 0xffff0000, v117
    v_lshlrev_b32 v28, 16, v118
    v_and_b32 v29, 0xffff0000, v118
    v_lshlrev_b32 v30, 16, v119
    v_and_b32 v31, 0xffff0000, v119
    s_waitcnt vmcnt(16)
    v_lshlrev_b32 v16, 16, v120
    v_and_b32 v17, 0xffff0000, v120
    v_lshlrev_b32 v18, 16, v121
    v_and_b32 v19, 0xffff0000, v121
    v_lshlrev_b32 v20, 16, v122
    v_and_b32 v21, 0xffff0000, v122
    v_lshlrev_b32 v22, 16, v123
    v_and_b32 v23, 0xffff0000, v123
    s_waitcnt vmcnt(15)
    ds_write_b128 v105, a[148:151] offset:5120
    ds_write_b128 v105, a[152:155] offset:6144
    v_lshlrev_b32 v100, 16, v124
    v_and_b32 v101, 0xffff0000, v124
    v_pk_add_f32 v[24:25], v[24:25], v[100:101]
    v_lshlrev_b32 v102, 16, v125
    v_and_b32 v103, 0xffff0000, v125
    v_pk_add_f32 v[26:27], v[26:27], v[102:103]
    v_lshlrev_b32 v100, 16, v126
    v_and_b32 v101, 0xffff0000, v126
    v_pk_add_f32 v[28:29], v[28:29], v[100:101]
    v_lshlrev_b32 v102, 16, v127
    v_and_b32 v103, 0xffff0000, v127
    v_pk_add_f32 v[30:31], v[30:31], v[102:103]
    s_waitcnt vmcnt(14)
    v_lshlrev_b32 v100, 16, v128
    v_and_b32 v101, 0xffff0000, v128
    v_pk_add_f32 v[16:17], v[16:17], v[100:101]
    v_lshlrev_b32 v102, 16, v129
    v_and_b32 v103, 0xffff0000, v129
    v_pk_add_f32 v[18:19], v[18:19], v[102:103]
    v_lshlrev_b32 v100, 16, v130
    v_and_b32 v101, 0xffff0000, v130
    v_pk_add_f32 v[20:21], v[20:21], v[100:101]
    v_lshlrev_b32 v102, 16, v131
    v_and_b32 v103, 0xffff0000, v131
    v_pk_add_f32 v[22:23], v[22:23], v[102:103]
    s_waitcnt vmcnt(13)
    ds_write_b128 v105, a[156:159] offset:7168
    ds_write_b128 v105, a[160:163] offset:8192
    v_lshlrev_b32 v100, 16, v132
    v_and_b32 v101, 0xffff0000, v132
    v_pk_add_f32 v[24:25], v[24:25], v[100:101]
    v_lshlrev_b32 v102, 16, v133
    v_and_b32 v103, 0xffff0000, v133
    v_pk_add_f32 v[26:27], v[26:27], v[102:103]
    v_lshlrev_b32 v100, 16, v134
    v_and_b32 v101, 0xffff0000, v134
    v_pk_add_f32 v[28:29], v[28:29], v[100:101]
    v_lshlrev_b32 v102, 16, v135
    v_and_b32 v103, 0xffff0000, v135
    v_pk_add_f32 v[30:31], v[30:31], v[102:103]
    s_waitcnt vmcnt(12)
    v_lshlrev_b32 v100, 16, v136
    v_and_b32 v101, 0xffff0000, v136
    v_pk_add_f32 v[16:17], v[16:17], v[100:101]
    v_lshlrev_b32 v102, 16, v137
    v_and_b32 v103, 0xffff0000, v137
    v_pk_add_f32 v[18:19], v[18:19], v[102:103]
    v_lshlrev_b32 v100, 16, v138
    v_and_b32 v101, 0xffff0000, v138
    v_pk_add_f32 v[20:21], v[20:21], v[100:101]
    v_lshlrev_b32 v102, 16, v139
    v_and_b32 v103, 0xffff0000, v139
    v_pk_add_f32 v[22:23], v[22:23], v[102:103]
    s_waitcnt vmcnt(11)
    ds_write_b128 v104, a[164:167] offset:36864
    ds_write_b128 v104, a[168:171] offset:37888
    v_lshlrev_b32 v100, 16, v140
    v_and_b32 v101, 0xffff0000, v140
    v_pk_add_f32 v[24:25], v[24:25], v[100:101]
    v_lshlrev_b32 v102, 16, v141
    v_and_b32 v103, 0xffff0000, v141
    v_pk_add_f32 v[26:27], v[26:27], v[102:103]
    v_lshlrev_b32 v100, 16, v142
    v_and_b32 v101, 0xffff0000, v142
    v_pk_add_f32 v[28:29], v[28:29], v[100:101]
    v_lshlrev_b32 v102, 16, v143
    v_and_b32 v103, 0xffff0000, v143
    v_pk_add_f32 v[30:31], v[30:31], v[102:103]
    s_waitcnt vmcnt(10)
    v_lshlrev_b32 v100, 16, v144
    v_and_b32 v101, 0xffff0000, v144
    v_pk_add_f32 v[16:17], v[16:17], v[100:101]
    v_lshlrev_b32 v102, 16, v145
    v_and_b32 v103, 0xffff0000, v145
    v_pk_add_f32 v[18:19], v[18:19], v[102:103]
    v_lshlrev_b32 v100, 16, v146
    v_and_b32 v101, 0xffff0000, v146
    v_pk_add_f32 v[20:21], v[20:21], v[100:101]
    v_lshlrev_b32 v102, 16, v147
    v_and_b32 v103, 0xffff0000, v147
    v_pk_add_f32 v[22:23], v[22:23], v[102:103]
    s_waitcnt vmcnt(8)
    ds_write_b128 v104, a[172:175] offset:38912
    ds_write_b128 v104, a[176:179] offset:39936
    v_lshlrev_b32 v100, 16, v148
    v_and_b32 v101, 0xffff0000, v148
    v_pk_add_f32 v[32:33], v[32:33], v[100:101]
    v_lshlrev_b32 v102, 16, v149
    v_and_b32 v103, 0xffff0000, v149
    v_pk_add_f32 v[34:35], v[34:35], v[102:103]
    v_lshlrev_b32 v100, 16, v150
    v_and_b32 v101, 0xffff0000, v150
    v_pk_add_f32 v[36:37], v[36:37], v[100:101]
    v_lshlrev_b32 v102, 16, v151
    v_and_b32 v103, 0xffff0000, v151
    v_pk_add_f32 v[38:39], v[38:39], v[102:103]
    s_waitcnt vmcnt(7)
    ds_write_b128 v104, a[180:183] offset:40960
    ds_write_b128 v104, a[184:187] offset:41984
    v_lshlrev_b32 v100, 16, v152
    v_and_b32 v101, 0xffff0000, v152
    v_pk_add_f32 v[24:25], v[24:25], v[100:101]
    v_lshlrev_b32 v102, 16, v153
    v_and_b32 v103, 0xffff0000, v153
    v_pk_add_f32 v[26:27], v[26:27], v[102:103]
    v_lshlrev_b32 v100, 16, v154
    v_and_b32 v101, 0xffff0000, v154
    v_pk_add_f32 v[28:29], v[28:29], v[100:101]
    v_lshlrev_b32 v102, 16, v155
    v_and_b32 v103, 0xffff0000, v155
    v_pk_add_f32 v[30:31], v[30:31], v[102:103]
    s_waitcnt vmcnt(6)
    v_lshlrev_b32 v100, 16, v156
    v_and_b32 v101, 0xffff0000, v156
    v_pk_add_f32 v[16:17], v[16:17], v[100:101]
    v_lshlrev_b32 v102, 16, v157
    v_and_b32 v103, 0xffff0000, v157
    v_pk_add_f32 v[18:19], v[18:19], v[102:103]
    v_lshlrev_b32 v100, 16, v158
    v_and_b32 v101, 0xffff0000, v158
    v_pk_add_f32 v[20:21], v[20:21], v[100:101]
    v_lshlrev_b32 v102, 16, v159
    v_and_b32 v103, 0xffff0000, v159
    v_pk_add_f32 v[22:23], v[22:23], v[102:103]
    s_waitcnt vmcnt(5)
    v_cmp_ne_u32 vcc, 0, v9
    s_nop 0
    s_lshr_b32 s3, vcc_lo, 1
    s_and_b32 s3, s3, vcc_lo
    s_lshr_b32 s14, s3, 2
    s_and_b32 s3, s3, s14
    s_and_b32 s3, s3, s48
    s_cbranch_scc0 L2_g2s
L2_g2r:
    s_ff1_i32_b32 s3, s3
    s_bitset0_b32 s48, s3
    s_mul_i32 s46, s3, 9216
    buffer_load_dword v9, v6, s[84:87], s47 offen sc1
    buffer_load_dwordx4 v[184:187], v7, s[88:91], s46 offen sc1
    ds_write_b128 v104, a[188:191] offset:43008
    ds_write_b128 v104, a[192:195] offset:44032
    v_lshlrev_b32 v100, 16, v160
    v_and_b32 v101, 0xffff0000, v160
    v_pk_add_f32 v[24:25], v[24:25], v[100:101]
    v_lshlrev_b32 v102, 16, v161
    v_and_b32 v103, 0xffff0000, v161
    v_pk_add_f32 v[26:27], v[26:27], v[102:103]
    v_lshlrev_b32 v100, 16, v162
    v_and_b32 v101, 0xffff0000, v162
    v_pk_add_f32 v[28:29], v[28:29], v[100:101]
    v_lshlrev_b32 v102, 16, v163
    v_and_b32 v103, 0xffff0000, v163
    v_pk_add_f32 v[30:31], v[30:31], v[102:103]
    s_waitcnt vmcnt(6)
    v_lshlrev_b32 v100, 16, v164
    v_and_b32 v101, 0xffff0000, v164
    v_pk_add_f32 v[16:17], v[16:17], v[100:101]
    v_lshlrev_b32 v102, 16, v165
    v_and_b32 v103, 0xffff0000, v165
    v_pk_add_f32 v[18:19], v[18:19], v[102:103]
    v_lshlrev_b32 v100, 16, v166
    v_and_b32 v101, 0xffff0000, v166
    v_pk_add_f32 v[20:21], v[20:21], v[100:101]
    v_lshlrev_b32 v102, 16, v167
    v_and_b32 v103, 0xffff0000, v167
    v_pk_add_f32 v[22:23], v[22:23], v[102:103]
    s_waitcnt vmcnt(5)
    buffer_load_dwordx4 v[188:191], v5, s[88:91], s46 offen sc1
    buffer_load_dwordx4 v[192:195], v5, s[28:31], s46 offen sc1
    ds_write_b128 v104, a[196:199] offset:45056
    v_lshlrev_b32 v100, 16, v168
    v_and_b32 v101, 0xffff0000, v168
    v_pk_add_f32 v[24:25], v[24:25], v[100:101]
    v_lshlrev_b32 v102, 16, v169
    v_and_b32 v103, 0xffff0000, v169
    v_pk_add_f32 v[26:27], v[26:27], v[102:103]
    v_lshlrev_b32 v100, 16, v170
    v_and_b32 v101, 0xffff0000, v170
    v_pk_add_f32 v[28:29], v[28:29], v[100:101]
    v_lshlrev_b32 v102, 16, v171
    v_and_b32 v103, 0xffff0000, v171
    v_pk_add_f32 v[30:31], v[30:31], v[102:103]
    s_waitcnt vmcnt(6)
    v_lshlrev_b32 v100, 16, v172
    v_and_b32 v101, 0xffff0000, v172
    v_pk_add_f32 v[16:17], v[16:17], v[100:101]
    v_lshlrev_b32 v102, 16, v173
    v_and_b32 v103, 0xffff0000, v173
    v_pk_add_f32 v[18:19], v[18:19], v[102:103]
    v_lshlrev_b32 v100, 16, v174
    v_and_b32 v101, 0xffff0000, v174
    v_pk_add_f32 v[20:21], v[20:21], v[100:101]
    v_lshlrev_b32 v102, 16, v175
    v_and_b32 v103, 0xffff0000, v175
    v_pk_add_f32 v[22:23], v[22:23], v[102:103]
    s_waitcnt vmcnt(5)
    s_add_u32 s46, s46, 9216
    buffer_load_dwordx4 v[196:199], v5, s[88:91], s46 offen sc1
    buffer_load_dwordx4 v[200:203], v5, s[28:31], s46 offen sc1
    v_lshlrev_b32 v100, 16, v176
    v_and_b32 v101, 0xffff0000, v176
    v_pk_add_f32 v[24:25], v[24:25], v[100:101]
    v_lshlrev_b32 v102, 16, v177
    v_and_b32 v103, 0xffff0000, v177
    v_pk_add_f32 v[26:27], v[26:27], v[102:103]
    v_lshlrev_b32 v100, 16, v178
    v_and_b32 v101, 0xffff0000, v178
    v_pk_add_f32 v[28:29], v[28:29], v[100:101]
    v_lshlrev_b32 v102, 16, v179
    v_and_b32 v103, 0xffff0000, v179
    v_pk_add_f32 v[30:31], v[30:31], v[102:103]
    s_waitcnt vmcnt(6)
    v_lshlrev_b32 v100, 16, v180
    v_and_b32 v101, 0xffff0000, v180
    v_pk_add_f32 v[16:17], v[16:17], v[100:101]
    v_lshlrev_b32 v102, 16, v181
    v_and_b32 v103, 0xffff0000, v181
L2_pad14:
    s_cbranch_execz L2_walkret
    v_pk_add_f32 v[18:19], v[18:19], v[102:103]
    v_lshlrev_b32 v100, 16, v182
    v_and_b32 v101, 0xffff0000, v182
    v_pk_add_f32 v[20:21], v[20:21], v[100:101]
    v_lshlrev_b32 v102, 16, v183
    v_and_b32 v103, 0xffff0000, v183
    v_pk_add_f32 v[22:23], v[22:23], v[102:103]
    s_waitcnt vmcnt(4)
    s_add_u32 s46, s46, 9216
    buffer_load_dwordx4 v[204:207], v5, s[88:91], s46 offen sc1
    buffer_load_dwordx4 v[208:211], v5, s[28:31], s46 offen sc1
    v_lshlrev_b32 v100, 16, v184
    v_and_b32 v101, 0xffff0000, v184
    v_pk_add_f32 v[32:33], v[32:33], v[100:101]
    v_lshlrev_b32 v102, 16, v185
    v_and_b32 v103, 0xffff0000, v185
    v_pk_add_f32 v[34:35], v[34:35], v[102:103]
    v_lshlrev_b32 v100, 16, v186
    v_and_b32 v101, 0xffff0000, v186
    v_pk_add_f32 v[36:37], v[36:37], v[100:101]
    v_lshlrev_b32 v102, 16, v187
    v_and_b32 v103, 0xffff0000, v187
    v_pk_add_f32 v[38:39], v[38:39], v[102:103]
    ds_read_b128 v[112:115], v3 offset:4608
    ds_read_b128 v[116:119], v3 offset:4624
    ds_read_b128 v[120:123], v3 offset:5632
    ds_read_b128 v[124:127], v3 offset:5648
    ds_read_b128 v[128:131], v4 offset:6656
    ds_read_b128 v[132:135], v4 offset:6672
    ds_read_b128 v[136:139], v3 offset:2304
    ds_read_b128 v[140:143], v3 offset:2320
    ds_read_b128 v[144:147], v3 offset:3328
    ds_read_b128 v[148:151], v3 offset:3344
    ds_read_b128 v[152:155], v4 offset:4352
    ds_read_b128 v[156:159], v4 offset:4368
    ds_read_b128 v[160:163], v3 offset:6912
    ds_read_b128 v[164:167], v3 offset:6928
    ds_read_b128 v[168:171], v3 offset:7936
    ds_read_b128 v[172:175], v3 offset:7952
    ds_read_b128 v[176:179], v4 offset:8960
    ds_read_b128 v[180:183], v4 offset:8976
    s_waitcnt vmcnt(5)
    s_add_u32 s46, s46, 9216
    buffer_load_dwordx4 v[212:215], v5, s[88:91], s46 offen sc1
    buffer_load_dwordx4 v[216:219], v5, s[28:31], s46 offen sc1
    v_lshlrev_b32 v100, 16, v188
    v_and_b32 v101, 0xffff0000, v188
    v_pk_add_f32 v[24:25], v[24:25], v[100:101]
    v_lshlrev_b32 v102, 16, v189
    v_and_b32 v103, 0xffff0000, v189
    v_pk_add_f32 v[26:27], v[26:27], v[102:103]
    v_lshlrev_b32 v100, 16, v190
    v_and_b32 v101, 0xffff0000, v190
    v_pk_add_f32 v[28:29], v[28:29], v[100:101]
    v_lshlrev_b32 v102, 16, v191
    v_and_b32 v103, 0xffff0000, v191
    v_pk_add_f32 v[30:31], v[30:31], v[102:103]
    s_waitcnt vmcnt(6)
    v_lshlrev_b32 v100, 16, v192
    v_and_b32 v101, 0xffff0000, v192
    v_pk_add_f32 v[16:17], v[16:17], v[100:101]
    v_lshlrev_b32 v102, 16, v193
    v_and_b32 v103, 0xffff0000, v193
    v_pk_add_f32 v[18:19], v[18:19], v[102:103]
    v_lshlrev_b32 v100, 16, v194
    v_and_b32 v101, 0xffff0000, v194
    v_pk_add_f32 v[20:21], v[20:21], v[100:101]
    v_lshlrev_b32 v102, 16, v195
    v_and_b32 v103, 0xffff0000, v195
    v_pk_add_f32 v[22:23], v[22:23], v[102:103]
    s_waitcnt vmcnt(5)
    v_cmp_ne_u32 vcc, 0, v9
    s_nop 0
    s_lshr_b32 s3, vcc_lo, 1
    s_and_b32 s3, s3, vcc_lo
    s_lshr_b32 s14, s3, 2
    s_and_b32 s3, s3, s14
    s_and_b32 s3, s3, s48
    s_cbranch_scc0 L2_g3s
L2_g3r:
    s_ff1_i32_b32 s3, s3
    s_bitset0_b32 s48, s3
    s_mul_i32 s46, s3, 9216
    buffer_load_dwordx4 v[220:223], v7, s[88:91], s46 offen sc1
    v_lshlrev_b32 v100, 16, v196
    v_and_b32 v101, 0xffff0000, v196
    v_pk_add_f32 v[24:25], v[24:25], v[100:101]
    v_lshlrev_b32 v102, 16, v197
    v_and_b32 v103, 0xffff0000, v197
    v_pk_add_f32 v[26:27], v[26:27], v[102:103]
    v_lshlrev_b32 v100, 16, v198
    v_and_b32 v101, 0xffff0000, v198
    v_pk_add_f32 v[28:29], v[28:29], v[100:101]
    v_lshlrev_b32 v102, 16, v199
    v_and_b32 v103, 0xffff0000, v199
    v_pk_add_f32 v[30:31], v[30:31], v[102:103]
    s_waitcnt vmcnt(5)
    v_lshlrev_b32 v100, 16, v200
    v_and_b32 v101, 0xffff0000, v200
    v_pk_add_f32 v[16:17], v[16:17], v[100:101]
    v_lshlrev_b32 v102, 16, v201
    v_and_b32 v103, 0xffff0000, v201
    v_pk_add_f32 v[18:19], v[18:19], v[102:103]
    v_lshlrev_b32 v100, 16, v202
    v_and_b32 v101, 0xffff0000, v202
    v_pk_add_f32 v[20:21], v[20:21], v[100:101]
    v_lshlrev_b32 v102, 16, v203
    v_and_b32 v103, 0xffff0000, v203
    v_pk_add_f32 v[22:23], v[22:23], v[102:103]
    s_waitcnt vmcnt(4)
    buffer_load_dwordx4 v[224:227], v5, s[88:91], s46 offen sc1
    buffer_load_dwordx4 v[228:231], v5, s[28:31], s46 offen sc1
    v_lshlrev_b32 v100, 16, v204
    v_and_b32 v101, 0xffff0000, v204
    v_pk_add_f32 v[24:25], v[24:25], v[100:101]
    v_lshlrev_b32 v102, 16, v205
    v_and_b32 v103, 0xffff0000, v205
    v_pk_add_f32 v[26:27], v[26:27], v[102:103]
    v_lshlrev_b32 v100, 16, v206
    v_and_b32 v101, 0xffff0000, v206
    v_pk_add_f32 v[28:29], v[28:29], v[100:101]
    v_lshlrev_b32 v102, 16, v207
    v_and_b32 v103, 0xffff0000, v207
    v_pk_add_f32 v[30:31], v[30:31], v[102:103]
    s_waitcnt vmcnt(5)
    v_lshlrev_b32 v100, 16, v208
    v_and_b32 v101, 0xffff0000, v208
    v_pk_add_f32 v[16:17], v[16:17], v[100:101]
    v_lshlrev_b32 v102, 16, v209
    v_and_b32 v103, 0xffff0000, v209
    v_pk_add_f32 v[18:19], v[18:19], v[102:103]
    v_lshlrev_b32 v100, 16, v210
    v_and_b32 v101, 0xffff0000, v210
    v_pk_add_f32 v[20:21], v[20:21], v[100:101]
    v_lshlrev_b32 v102, 16, v211
    v_and_b32 v103, 0xffff0000, v211
    v_pk_add_f32 v[22:23], v[22:23], v[102:103]
    s_waitcnt vmcnt(4)
    s_add_u32 s46, s46, 9216
    buffer_load_dwordx4 v[232:235], v5, s[88:91], s46 offen sc1
    buffer_load_dwordx4 v[236:239], v5, s[28:31], s46 offen sc1
    v_lshlrev_b32 v100, 16, v212
    v_and_b32 v101, 0xffff0000, v212
    v_pk_add_f32 v[24:25], v[24:25], v[100:101]
    v_lshlrev_b32 v102, 16, v213
    v_and_b32 v103, 0xffff0000, v213
    v_pk_add_f32 v[26:27], v[26:27], v[102:103]
    v_lshlrev_b32 v100, 16, v214
    v_and_b32 v101, 0xffff0000, v214
    v_pk_add_f32 v[28:29], v[28:29], v[100:101]
    v_lshlrev_b32 v102, 16, v215
    v_and_b32 v103, 0xffff0000, v215
    v_pk_add_f32 v[30:31], v[30:31], v[102:103]
    s_waitcnt vmcnt(5)
    v_lshlrev_b32 v100, 16, v216
    v_and_b32 v101, 0xffff0000, v216
    v_pk_add_f32 v[16:17], v[16:17], v[100:101]
    v_lshlrev_b32 v102, 16, v217
    v_and_b32 v103, 0xffff0000, v217
    v_pk_add_f32 v[18:19], v[18:19], v[102:103]
    v_lshlrev_b32 v100, 16, v218
    v_and_b32 v101, 0xffff0000, v218
    v_pk_add_f32 v[20:21], v[20:21], v[100:101]
    v_lshlrev_b32 v102, 16, v219
    v_and_b32 v103, 0xffff0000, v219
    v_pk_add_f32 v[22:23], v[22:23], v[102:103]
    s_waitcnt vmcnt(4)
    s_add_u32 s46, s46, 9216
    buffer_load_dwordx4 v[240:243], v5, s[88:91], s46 offen sc1
    buffer_load_dwordx4 v[244:247], v5, s[28:31], s46 offen sc1
    v_lshlrev_b32 v100, 16, v220
    v_and_b32 v101, 0xffff0000, v220
    v_pk_add_f32 v[32:33], v[32:33], v[100:101]
    v_lshlrev_b32 v102, 16, v221
    v_and_b32 v103, 0xffff0000, v221
    v_pk_add_f32 v[34:35], v[34:35], v[102:103]
    v_lshlrev_b32 v100, 16, v222
    v_and_b32 v101, 0xffff0000, v222
    v_pk_add_f32 v[36:37], v[36:37], v[100:101]
    v_lshlrev_b32 v102, 16, v223
    v_and_b32 v103, 0xffff0000, v223
    v_pk_add_f32 v[38:39], v[38:39], v[102:103]
    s_lshl_b32 s3, s96, 3
    s_sub_u32 s3, 0xfff, s3
    v_and_b32 v6, 7, v0
    v_sub_u32 v6, s3, v6
    s_mov_b32 s57, 0xfffff000
    s_mul_i32 s58, s96, 128
    s_add_u32 s58, s58, 6815744
    s_xor_b32 s3, s51, 2
    v_or_b32 v9, s3, v0
    v_min_u32 v9, 1, v9
    v_lshlrev_b32 v9, 30, v9
    v_mov_b32 v208, v32
    v_mov_b32 v209, v33
    v_mov_b32 v210, v34
    v_mov_b32 v211, v35
    v_mov_b32 v212, v36
    v_mov_b32 v213, v37
    v_mov_b32 v214, v38
    v_mov_b32 v215, v39
    v_permlane16_swap_b32 v208, v32
    v_permlane16_swap_b32 v209, v33
    v_permlane16_swap_b32 v210, v34
    v_permlane16_swap_b32 v211, v35
    v_permlane16_swap_b32 v212, v36
    v_permlane16_swap_b32 v213, v37
    v_permlane16_swap_b32 v214, v38
    v_permlane16_swap_b32 v215, v39
    v_add_f32 v32, v32, v208
    v_add_f32 v33, v33, v209
    v_add_f32 v34, v34, v210
    v_add_f32 v35, v35, v211
    v_add_f32 v36, v36, v212
    v_add_f32 v37, v37, v213
    v_add_f32 v38, v38, v214
    v_add_f32 v39, v39, v215
    v_mov_b32 v208, v32
    v_mov_b32 v209, v33
    v_mov_b32 v210, v34
    v_mov_b32 v211, v35
    v_mov_b32 v212, v36
    v_mov_b32 v213, v37
    v_mov_b32 v214, v38
    v_mov_b32 v215, v39
    v_permlane32_swap_b32 v208, v32
    v_permlane32_swap_b32 v209, v33
    v_permlane32_swap_b32 v210, v34
    v_permlane32_swap_b32 v211, v35
    v_permlane32_swap_b32 v212, v36
    v_permlane32_swap_b32 v213, v37
    v_permlane32_swap_b32 v214, v38
    v_permlane32_swap_b32 v215, v39
    v_add_f32 v32, v32, v208
    v_add_f32 v33, v33, v209
    v_add_f32 v34, v34, v210
    v_add_f32 v35, v35, v211
    v_add_f32 v36, v36, v212
    v_add_f32 v37, v37, v213
    v_add_f32 v38, v38, v214
    v_add_f32 v39, v39, v215
    v_lshlrev_b32 v184, 16, v64
    v_and_b32 v185, 0xffff0000, v64
    v_lshlrev_b32 v186, 16, v65
    v_and_b32 v187, 0xffff0000, v65
    v_lshlrev_b32 v188, 16, v66
    v_and_b32 v189, 0xffff0000, v66
    v_lshlrev_b32 v190, 16, v67
    v_and_b32 v191, 0xffff0000, v67
    v_lshlrev_b32 v192, 16, v68
    v_and_b32 v193, 0xffff0000, v68
    v_lshlrev_b32 v194, 16, v69
    v_and_b32 v195, 0xffff0000, v69
    v_lshlrev_b32 v196, 16, v70
    v_and_b32 v197, 0xffff0000, v70
    v_lshlrev_b32 v198, 16, v71
    v_and_b32 v199, 0xffff0000, v71
    v_lshlrev_b32 v200, 16, v72
    v_and_b32 v201, 0xffff0000, v72
    v_lshlrev_b32 v202, 16, v73
    v_and_b32 v203, 0xffff0000, v73
    v_lshlrev_b32 v204, 16, v74
    v_and_b32 v205, 0xffff0000, v74
    v_lshlrev_b32 v206, 16, v75
    v_and_b32 v207, 0xffff0000, v75
    s_cmp_lt_u32 s2, 180
    s_cselect_b32 s3, 2, 0
    s_cmp_lt_u32 s51, s3
    s_cselect_b32 s3, 0, 0x40000000
    v_mul_u32_u24 v68, 128, v0
    v_or_b32 v68, s3, v68
    s_mul_i32 s15, s51, 16384
    s_add_u32 s15, s15, 6815744
    s_add_u32 s59, s15, 8192
    s_lshl_b32 s3, s51, 7
    s_sub_u32 s3, s96, s3
    v_cmp_eq_u32 s[60:61], s3, v0
    s_sub_u32 s3, s3, 64
    v_cmp_eq_u32 s[62:63], s3, v0
    s_waitcnt vmcnt(5)
    s_add_u32 s46, s46, 9216
    buffer_load_dwordx4 v[248:251], v5, s[88:91], s46 offen sc1
    buffer_load_dwordx4 v[252:255], v5, s[28:31], s46 offen sc1
    v_lshlrev_b32 v100, 16, v224
    v_and_b32 v101, 0xffff0000, v224
    v_pk_add_f32 v[24:25], v[24:25], v[100:101]
    v_lshlrev_b32 v102, 16, v225
    v_and_b32 v103, 0xffff0000, v225
    v_pk_add_f32 v[26:27], v[26:27], v[102:103]
    v_lshlrev_b32 v100, 16, v226
    v_and_b32 v101, 0xffff0000, v226
    v_pk_add_f32 v[28:29], v[28:29], v[100:101]
    v_lshlrev_b32 v102, 16, v227
    v_and_b32 v103, 0xffff0000, v227
    v_pk_add_f32 v[30:31], v[30:31], v[102:103]
    s_waitcnt vmcnt(6)
    v_lshlrev_b32 v100, 16, v228
    v_and_b32 v101, 0xffff0000, v228
    v_pk_add_f32 v[16:17], v[16:17], v[100:101]
    v_lshlrev_b32 v102, 16, v229
    v_and_b32 v103, 0xffff0000, v229
    v_pk_add_f32 v[18:19], v[18:19], v[102:103]
    v_lshlrev_b32 v100, 16, v230
    v_and_b32 v101, 0xffff0000, v230
    v_pk_add_f32 v[20:21], v[20:21], v[100:101]
    v_lshlrev_b32 v102, 16, v231
    v_and_b32 v103, 0xffff0000, v231
    v_pk_add_f32 v[22:23], v[22:23], v[102:103]
    s_waitcnt vmcnt(5)
    v_lshlrev_b32 v100, 16, v232
    v_and_b32 v101, 0xffff0000, v232
    v_pk_add_f32 v[24:25], v[24:25], v[100:101]
    v_lshlrev_b32 v102, 16, v233
    v_and_b32 v103, 0xffff0000, v233
    v_pk_add_f32 v[26:27], v[26:27], v[102:103]
    v_lshlrev_b32 v100, 16, v234
    v_and_b32 v101, 0xffff0000, v234
    v_pk_add_f32 v[28:29], v[28:29], v[100:101]
    v_lshlrev_b32 v102, 16, v235
    v_and_b32 v103, 0xffff0000, v235
    v_pk_add_f32 v[30:31], v[30:31], v[102:103]
    s_waitcnt vmcnt(4)
    v_lshlrev_b32 v100, 16, v236
    v_and_b32 v101, 0xffff0000, v236
    v_pk_add_f32 v[16:17], v[16:17], v[100:101]
    v_lshlrev_b32 v102, 16, v237
    v_and_b32 v103, 0xffff0000, v237
    v_pk_add_f32 v[18:19], v[18:19], v[102:103]
    v_lshlrev_b32 v100, 16, v238
    v_and_b32 v101, 0xffff0000, v238
    v_pk_add_f32 v[20:21], v[20:21], v[100:101]
    v_lshlrev_b32 v102, 16, v239
    v_and_b32 v103, 0xffff0000, v239
    v_pk_add_f32 v[22:23], v[22:23], v[102:103]
    s_waitcnt vmcnt(3)
    v_lshlrev_b32 v100, 16, v240
    v_and_b32 v101, 0xffff0000, v240
    v_pk_add_f32 v[24:25], v[24:25], v[100:101]
    v_lshlrev_b32 v102, 16, v241
    v_and_b32 v103, 0xffff0000, v241
    v_pk_add_f32 v[26:27], v[26:27], v[102:103]
    v_lshlrev_b32 v100, 16, v242
    v_and_b32 v101, 0xffff0000, v242
    v_pk_add_f32 v[28:29], v[28:29], v[100:101]
    v_lshlrev_b32 v102, 16, v243
    v_and_b32 v103, 0xffff0000, v243
    v_pk_add_f32 v[30:31], v[30:31], v[102:103]
    s_waitcnt vmcnt(2)
    v_lshlrev_b32 v100, 16, v244
    v_and_b32 v101, 0xffff0000, v244
    v_pk_add_f32 v[16:17], v[16:17], v[100:101]
    v_lshlrev_b32 v102, 16, v245
    v_and_b32 v103, 0xffff0000, v245
    v_pk_add_f32 v[18:19], v[18:19], v[102:103]
    v_lshlrev_b32 v100, 16, v246
    v_and_b32 v101, 0xffff0000, v246
    v_pk_add_f32 v[20:21], v[20:21], v[100:101]
    v_lshlrev_b32 v102, 16, v247
    v_and_b32 v103, 0xffff0000, v247
    v_pk_add_f32 v[22:23], v[22:23], v[102:103]
    s_waitcnt vmcnt(1)
    v_lshlrev_b32 v100, 16, v248
    v_and_b32 v101, 0xffff0000, v248
    v_pk_add_f32 v[24:25], v[24:25], v[100:101]
    v_lshlrev_b32 v102, 16, v249
    v_and_b32 v103, 0xffff0000, v249
    v_pk_add_f32 v[26:27], v[26:27], v[102:103]
    v_lshlrev_b32 v100, 16, v250
    v_and_b32 v101, 0xffff0000, v250
    v_pk_add_f32 v[28:29], v[28:29], v[100:101]
    v_lshlrev_b32 v102, 16, v251
    v_and_b32 v103, 0xffff0000, v251
    v_pk_add_f32 v[30:31], v[30:31], v[102:103]
    s_waitcnt vmcnt(0)
    v_lshlrev_b32 v100, 16, v252
    v_and_b32 v101, 0xffff0000, v252
    v_pk_add_f32 v[16:17], v[16:17], v[100:101]
    v_lshlrev_b32 v102, 16, v253
    v_and_b32 v103, 0xffff0000, v253
    v_pk_add_f32 v[18:19], v[18:19], v[102:103]
    v_lshlrev_b32 v100, 16, v254
    v_and_b32 v101, 0xffff0000, v254
    v_pk_add_f32 v[20:21], v[20:21], v[100:101]
    v_lshlrev_b32 v102, 16, v255
    v_and_b32 v103, 0xffff0000, v255
    v_pk_add_f32 v[22:23], v[22:23], v[102:103]
    v_pk_fma_f32 v[16:17], v[16:17], v[40:41], v[184:185]
    v_pk_fma_f32 v[18:19], v[18:19], v[42:43], v[186:187]
    v_pk_fma_f32 v[20:21], v[20:21], v[44:45], v[188:189]
    v_pk_fma_f32 v[22:23], v[22:23], v[46:47], v[190:191]
    v_pk_fma_f32 v[24:25], v[24:25], v[48:49], v[192:193]
    v_pk_fma_f32 v[26:27], v[26:27], v[50:51], v[194:195]
    v_pk_fma_f32 v[28:29], v[28:29], v[52:53], v[196:197]
    v_pk_fma_f32 v[30:31], v[30:31], v[54:55], v[198:199]
    v_pk_fma_f32 v[32:33], v[32:33], v[56:57], v[200:201]
    v_pk_fma_f32 v[34:35], v[34:35], v[58:59], v[202:203]
    v_pk_fma_f32 v[36:37], v[36:37], v[60:61], v[204:205]
    v_pk_fma_f32 v[38:39], v[38:39], v[62:63], v[206:207]
    v_pk_add_f32 v[12:13], v[16:17], v[18:19]
    v_pk_add_f32 v[12:13], v[12:13], v[20:21]
    v_pk_add_f32 v[12:13], v[12:13], v[22:23]
    v_pk_add_f32 v[12:13], v[12:13], v[24:25]
    v_pk_add_f32 v[12:13], v[12:13], v[26:27]
    v_pk_add_f32 v[12:13], v[12:13], v[28:29]
    v_pk_add_f32 v[12:13], v[12:13], v[30:31]
    v_pk_add_f32 v[14:15], v[32:33], v[34:35]
    v_pk_add_f32 v[14:15], v[14:15], v[36:37]
    v_pk_add_f32 v[14:15], v[14:15], v[38:39]
    v_add_f32 v100, v12, v13
    v_add_f32 v14, v14, v15
    v_fmac_f32 v100, 0x3e800000, v14
    s_nop 1
    v_add_f32_dpp v100, v100, v100 row_ror:8 row_mask:0xf bank_mask:0xf
    v_mov_b32 v103, v100
    s_nop 1
    v_permlane16_swap_b32 v103, v100
    v_add_f32 v100, v100, v103
    v_mov_b32 v103, v100
    s_nop 1
    v_permlane32_swap_b32 v103, v100
    v_add_f32 v100, v100, v103
    v_mul_f32 v100, 0x3be38e39, v100
    v_pk_add_f32 v[184:185], v[16:17], v[100:101] op_sel_hi:[1,0] neg_lo:[0,1] neg_hi:[0,1]
    v_pk_add_f32 v[186:187], v[18:19], v[100:101] op_sel_hi:[1,0] neg_lo:[0,1] neg_hi:[0,1]
    v_pk_add_f32 v[188:189], v[20:21], v[100:101] op_sel_hi:[1,0] neg_lo:[0,1] neg_hi:[0,1]
    v_pk_add_f32 v[190:191], v[22:23], v[100:101] op_sel_hi:[1,0] neg_lo:[0,1] neg_hi:[0,1]
    v_pk_add_f32 v[192:193], v[24:25], v[100:101] op_sel_hi:[1,0] neg_lo:[0,1] neg_hi:[0,1]
    v_pk_add_f32 v[194:195], v[26:27], v[100:101] op_sel_hi:[1,0] neg_lo:[0,1] neg_hi:[0,1]
    v_pk_add_f32 v[196:197], v[28:29], v[100:101] op_sel_hi:[1,0] neg_lo:[0,1] neg_hi:[0,1]
    v_pk_add_f32 v[198:199], v[30:31], v[100:101] op_sel_hi:[1,0] neg_lo:[0,1] neg_hi:[0,1]
    v_pk_add_f32 v[200:201], v[32:33], v[100:101] op_sel_hi:[1,0] neg_lo:[0,1] neg_hi:[0,1]
    v_pk_add_f32 v[202:203], v[34:35], v[100:101] op_sel_hi:[1,0] neg_lo:[0,1] neg_hi:[0,1]
    v_pk_add_f32 v[204:205], v[36:37], v[100:101] op_sel_hi:[1,0] neg_lo:[0,1] neg_hi:[0,1]
    v_pk_add_f32 v[206:207], v[38:39], v[100:101] op_sel_hi:[1,0] neg_lo:[0,1] neg_hi:[0,1]
    v_pk_mul_f32 v[12:13], v[184:185], v[184:185]
    v_pk_fma_f32 v[12:13], v[186:187], v[186:187], v[12:13]
    v_pk_fma_f32 v[12:13], v[188:189], v[188:189], v[12:13]
    v_pk_fma_f32 v[12:13], v[190:191], v[190:191], v[12:13]
    v_pk_fma_f32 v[12:13], v[192:193], v[192:193], v[12:13]
    v_pk_fma_f32 v[12:13], v[194:195], v[194:195], v[12:13]
    v_pk_fma_f32 v[12:13], v[196:197], v[196:197], v[12:13]
    v_pk_fma_f32 v[12:13], v[198:199], v[198:199], v[12:13]
    v_pk_mul_f32 v[14:15], v[200:201], v[200:201]
    v_pk_fma_f32 v[14:15], v[202:203], v[202:203], v[14:15]
    v_pk_fma_f32 v[14:15], v[204:205], v[204:205], v[14:15]
    v_pk_fma_f32 v[14:15], v[206:207], v[206:207], v[14:15]
    v_add_f32 v101, v12, v13
    v_add_f32 v14, v14, v15
    v_fmac_f32 v101, 0x3e800000, v14
    v_pk_mul_f32 v[12:13], v[184:185], v[76:77]
    v_pk_fma_f32 v[12:13], v[186:187], v[78:79], v[12:13]
    v_pk_fma_f32 v[12:13], v[188:189], v[80:81], v[12:13]
    v_pk_fma_f32 v[12:13], v[190:191], v[82:83], v[12:13]
    v_pk_fma_f32 v[12:13], v[192:193], v[84:85], v[12:13]
    v_pk_fma_f32 v[12:13], v[194:195], v[86:87], v[12:13]
    v_pk_fma_f32 v[12:13], v[196:197], v[88:89], v[12:13]
    v_pk_fma_f32 v[12:13], v[198:199], v[90:91], v[12:13]
    v_pk_mul_f32 v[14:15], v[200:201], v[92:93]
    v_pk_fma_f32 v[14:15], v[202:203], v[94:95], v[14:15]
    v_pk_fma_f32 v[14:15], v[204:205], v[96:97], v[14:15]
    v_pk_fma_f32 v[14:15], v[206:207], v[98:99], v[14:15]
    v_add_f32 v102, v12, v13
    v_add_f32 v14, v14, v15
    v_fmac_f32 v102, 0x3e800000, v14
    s_nop 1
    v_add_f32_dpp v101, v101, v101 row_ror:8 row_mask:0xf bank_mask:0xf
    v_add_f32_dpp v102, v102, v102 row_ror:8 row_mask:0xf bank_mask:0xf
    v_mov_b32 v103, v101
    v_mov_b32 v104, v102
    s_nop 0
    v_permlane16_swap_b32 v103, v101
    v_permlane16_swap_b32 v104, v102
    v_add_f32 v101, v101, v103
    v_add_f32 v102, v102, v104
    v_mov_b32 v103, v101
    v_mov_b32 v104, v102
    s_nop 0
    v_permlane32_swap_b32 v103, v101
    v_permlane32_swap_b32 v104, v102
    v_add_f32 v101, v101, v103
    v_add_f32 v102, v102, v104
    ds_write_b32 v10, v100 offset:0
    ds_write_b32 v10, v101 offset:128
    ds_write_b32 v10, v102 offset:256
    s_waitcnt lgkmcnt(0)
    s_barrier
    ds_read_b128 v[40:43], v11 offset:0
    ds_read_b128 v[44:47], v11 offset:128
    ds_read_b128 v[48:51], v11 offset:256
    ds_read_b128 v[52:55], v11 offset:384
    ds_read_b128 v[56:59], v11 offset:512
    s_waitcnt lgkmcnt(4)
    v_add_f32 v12, v40, v41
    v_add_f32 v13, v42, v43
    v_add_f32 v12, v12, v13
    v_mul_f32 v12, 0x3e800000, v12
    v_sub_f32 v40, v40, v12
    v_sub_f32 v41, v41, v12
    v_sub_f32 v42, v42, v12
    v_sub_f32 v43, v43, v12
    v_sub_f32 v100, v100, v12
    v_mul_f32 v13, v40, v40
    v_fmac_f32 v13, v41, v41
    v_fmac_f32 v13, v42, v42
    v_fmac_f32 v13, v43, v43
    s_waitcnt lgkmcnt(3)
    v_add_f32 v14, v44, v45
    v_add_f32 v15, v46, v47
    v_add_f32 v14, v14, v15
    v_fmac_f32 v14, 0x43100000, v13
    v_mov_b32 v13, 0x3727c5ac
    v_fmac_f32 v13, 0x3ae38e39, v14
    v_rsq_f32 v13, v13
    s_waitcnt lgkmcnt(0)
    v_pk_fma_f32 v[48:49], v[40:41], v[52:53], v[48:49]
    v_pk_fma_f32 v[50:51], v[42:43], v[54:55], v[50:51]
    v_pk_add_f32 v[48:49], v[48:49], v[50:51]
    v_pk_add_f32 v[56:57], v[56:57], v[58:59]
    v_add_f32 v14, v48, v49
    v_add_f32 v15, v56, v57
    v_fmac_f32 v15, v14, v13
    v_ashrrev_i32 v12, 31, v15
    v_or_b32 v12, 0x80000000, v12
    v_xor_b32 v12, v12, v15
    v_and_or_b32 v44, v12, s57, v6
    v_mov_b32 v45, 0
    s_nop 1
    v_mov_b32_dpp v14, v44 row_ror:1 row_mask:0xf bank_mask:0xf
    v_mov_b32_dpp v15, v45 row_ror:1 row_mask:0xf bank_mask:0xf
    v_max_u32 v45, v45, v15
    v_med3_u32 v45, v44, v14, v45
    v_max_u32 v44, v44, v14
    s_nop 1
    v_mov_b32_dpp v14, v44 row_ror:2 row_mask:0xf bank_mask:0xf
    v_mov_b32_dpp v15, v45 row_ror:2 row_mask:0xf bank_mask:0xf
    v_max_u32 v45, v45, v15
    v_med3_u32 v45, v44, v14, v45
    v_max_u32 v44, v44, v14
    s_nop 1
    v_mov_b32_dpp v14, v44 row_ror:4 row_mask:0xf bank_mask:0xf
    v_mov_b32_dpp v15, v45 row_ror:4 row_mask:0xf bank_mask:0xf
    v_max_u32 v45, v45, v15
    v_med3_u32 v45, v44, v14, v45
    v_max_u32 v44, v44, v14
    buffer_store_dwordx2 v[44:45], v9, s[84:87], s58 offen offset:8 sc1
    v_mul_f32 v100, v100, v13
    v_pk_fma_f32 v[184:185], v[184:185], v[12:13], v[100:101] op_sel:[0,1,0] op_sel_hi:[1,1,0]
    v_pk_fma_f32 v[186:187], v[186:187], v[12:13], v[100:101] op_sel:[0,1,0] op_sel_hi:[1,1,0]
    v_pk_fma_f32 v[188:189], v[188:189], v[12:13], v[100:101] op_sel:[0,1,0] op_sel_hi:[1,1,0]
    v_pk_fma_f32 v[190:191], v[190:191], v[12:13], v[100:101] op_sel:[0,1,0] op_sel_hi:[1,1,0]
    v_pk_fma_f32 v[192:193], v[192:193], v[12:13], v[100:101] op_sel:[0,1,0] op_sel_hi:[1,1,0]
    v_pk_fma_f32 v[194:195], v[194:195], v[12:13], v[100:101] op_sel:[0,1,0] op_sel_hi:[1,1,0]
    v_pk_fma_f32 v[196:197], v[196:197], v[12:13], v[100:101] op_sel:[0,1,0] op_sel_hi:[1,1,0]
    v_pk_fma_f32 v[198:199], v[198:199], v[12:13], v[100:101] op_sel:[0,1,0] op_sel_hi:[1,1,0]
    v_pk_fma_f32 v[200:201], v[200:201], v[12:13], v[100:101] op_sel:[0,1,0] op_sel_hi:[1,1,0]
    v_pk_fma_f32 v[202:203], v[202:203], v[12:13], v[100:101] op_sel:[0,1,0] op_sel_hi:[1,1,0]
    v_pk_fma_f32 v[204:205], v[204:205], v[12:13], v[100:101] op_sel:[0,1,0] op_sel_hi:[1,1,0]
    v_pk_fma_f32 v[206:207], v[206:207], v[12:13], v[100:101] op_sel:[0,1,0] op_sel_hi:[1,1,0]
    v_pk_fma_f32 v[184:185], v[184:185], v[112:113], v[136:137]
    v_pk_fma_f32 v[186:187], v[186:187], v[114:115], v[138:139]
    v_pk_fma_f32 v[188:189], v[188:189], v[116:117], v[140:141]
    v_pk_fma_f32 v[190:191], v[190:191], v[118:119], v[142:143]
    v_pk_fma_f32 v[192:193], v[192:193], v[120:121], v[144:145]
    v_pk_fma_f32 v[194:195], v[194:195], v[122:123], v[146:147]
    v_pk_fma_f32 v[196:197], v[196:197], v[124:125], v[148:149]
    v_pk_fma_f32 v[198:199], v[198:199], v[126:127], v[150:151]
    v_pk_fma_f32 v[200:201], v[200:201], v[128:129], v[152:153]
    v_pk_fma_f32 v[202:203], v[202:203], v[130:131], v[154:155]
    v_pk_fma_f32 v[204:205], v[204:205], v[132:133], v[156:157]
    v_pk_fma_f32 v[206:207], v[206:207], v[134:135], v[158:159]
    v_cvt_pk_bf16_f32 v124, v184, v185
    v_cvt_pk_bf16_f32 v125, v186, v187
    v_cvt_pk_bf16_f32 v126, v188, v189
    v_cvt_pk_bf16_f32 v127, v190, v191
    v_min_u32 v124, -2, v124
    v_min_u32 v125, -2, v125
    v_min_u32 v126, -2, v126
    v_min_u32 v127, -2, v127
    ds_write_b128 v1, v[124:127] offset:9344
    v_cvt_pk_bf16_f32 v128, v192, v193
    v_cvt_pk_bf16_f32 v129, v194, v195
    v_cvt_pk_bf16_f32 v130, v196, v197
    v_cvt_pk_bf16_f32 v131, v198, v199
    v_min_u32 v128, -2, v128
    v_min_u32 v129, -2, v129
    v_min_u32 v130, -2, v130
    v_min_u32 v131, -2, v131
    ds_write_b128 v1, v[128:131] offset:9856
    v_cvt_pk_bf16_f32 v132, v200, v201
    v_cvt_pk_bf16_f32 v133, v202, v203
    v_cvt_pk_bf16_f32 v134, v204, v205
    v_cvt_pk_bf16_f32 v135, v206, v207
    v_min_u32 v132, -2, v132
    v_min_u32 v133, -2, v133
    v_min_u32 v134, -2, v134
    v_min_u32 v135, -2, v135
    ds_write_b128 v2, v[132:135] offset:9344
    v_pk_fma_f32 v[16:17], v[184:185], v[160:161], v[16:17]
    v_pk_fma_f32 v[18:19], v[186:187], v[162:163], v[18:19]
    v_pk_fma_f32 v[20:21], v[188:189], v[164:165], v[20:21]
    v_pk_fma_f32 v[22:23], v[190:191], v[166:167], v[22:23]
    v_pk_fma_f32 v[24:25], v[192:193], v[168:169], v[24:25]
    v_pk_fma_f32 v[26:27], v[194:195], v[170:171], v[26:27]
    v_pk_fma_f32 v[28:29], v[196:197], v[172:173], v[28:29]
    v_pk_fma_f32 v[30:31], v[198:199], v[174:175], v[30:31]
    v_pk_fma_f32 v[32:33], v[200:201], v[176:177], v[32:33]
    v_pk_fma_f32 v[34:35], v[202:203], v[178:179], v[34:35]
    v_pk_fma_f32 v[36:37], v[204:205], v[180:181], v[36:37]
    v_pk_fma_f32 v[38:39], v[206:207], v[182:183], v[38:39]
    v_cvt_pk_bf16_f32 v112, v16, v17
    v_cvt_pk_bf16_f32 v113, v18, v19
    v_cvt_pk_bf16_f32 v114, v20, v21
    v_cvt_pk_bf16_f32 v115, v22, v23
    ds_write_b128 v1, v[112:115] offset:0
    v_cvt_pk_bf16_f32 v116, v24, v25
    v_cvt_pk_bf16_f32 v117, v26, v27
    v_cvt_pk_bf16_f32 v118, v28, v29
    v_cvt_pk_bf16_f32 v119, v30, v31
    ds_write_b128 v1, v[116:119] offset:512
    v_cvt_pk_bf16_f32 v120, v32, v33
    v_cvt_pk_bf16_f32 v121, v34, v35
    v_cvt_pk_bf16_f32 v122, v36, v37
    v_cvt_pk_bf16_f32 v123, v38, v39
    ds_write_b128 v2, v[120:123] offset:0
    v_lshrrev_b32 v7, 4, v0
    v_and_b32 v6, 1, v0
    v_bfe_u32 v5, v0, 2, 2
    v_lshlrev_b32 v5, 6, v5
    v_lshl_add_u32 v5, v7, 4, v5
    v_mov_b32 v14, 15616
    s_waitcnt lgkmcnt(0)
    s_barrier
    s_cmp_lt_u32 s51, 2
    s_cbranch_scc1 L2_keys
    ds_read_b128 v[136:139], v107 offset:0
    ds_read_b128 v[140:143], v107 offset:1168
    ds_read_b128 v[144:147], v107 offset:2336
    ds_read_b128 v[148:151], v107 offset:3504
    ds_read_b128 v[152:155], v107 offset:4672
    ds_read_b128 v[156:159], v107 offset:5840
    ds_read_b128 v[160:163], v107 offset:7008
    ds_read_b128 v[164:167], v107 offset:8176
    ds_read_b128 v[168:171], v108 offset:1024
    s_movk_i32 s3, 0
L2_pad15:
    s_cbranch_execz L2_walkret
    s_waitcnt lgkmcnt(8)
    buffer_store_dwordx4 v[136:139], v8, s[24:27], s3 offen offset:0 sc1
    s_waitcnt lgkmcnt(7)
    buffer_store_dwordx4 v[140:143], v8, s[24:27], s3 offen offset:1152 sc1
    s_waitcnt lgkmcnt(6)
    buffer_store_dwordx4 v[144:147], v8, s[24:27], s3 offen offset:2304 sc1
    s_waitcnt lgkmcnt(5)
    buffer_store_dwordx4 v[148:151], v8, s[24:27], s3 offen offset:3456 sc1
    s_movk_i32 s3, 4608
    s_waitcnt lgkmcnt(4)
    buffer_store_dwordx4 v[152:155], v8, s[24:27], s3 offen offset:0 sc1
    s_waitcnt lgkmcnt(3)
    buffer_store_dwordx4 v[156:159], v8, s[24:27], s3 offen offset:1152 sc1
    s_waitcnt lgkmcnt(2)
    buffer_store_dwordx4 v[160:163], v8, s[24:27], s3 offen offset:2304 sc1
    s_waitcnt lgkmcnt(1)
    buffer_store_dwordx4 v[164:167], v8, s[24:27], s3 offen offset:3456 sc1
    s_waitcnt lgkmcnt(0)
    buffer_store_dwordx4 v[168:171], v109, s[24:27], 0 offen offset:1024 sc1
    ds_read_b64_tr_b16 a[64:65], v110 offset:0
    ds_read_b64_tr_b16 a[66:67], v110 offset:256
    ds_read_b64_tr_b16 a[68:69], v110 offset:2048
    ds_read_b64_tr_b16 a[70:71], v110 offset:2304
    ds_read_b64_tr_b16 a[72:73], v110 offset:4096
    ds_read_b64_tr_b16 a[74:75], v110 offset:4352
    ds_read_b64_tr_b16 a[76:77], v110 offset:6144
    ds_read_b64_tr_b16 a[78:79], v110 offset:6400
    ds_read_b64_tr_b16 a[80:81], v110 offset:8192
    ds_read_b64_tr_b16 a[82:83], v110 offset:8448
    ds_read_b64_tr_b16 a[84:85], v110 offset:10240
    ds_read_b64_tr_b16 a[86:87], v110 offset:10496
    ds_read_b64_tr_b16 a[88:89], v110 offset:12288
    ds_read_b64_tr_b16 a[90:91], v110 offset:12544
    ds_read_b64_tr_b16 a[92:93], v110 offset:14336
    ds_read_b64_tr_b16 a[94:95], v110 offset:14592
    ds_read_b64_tr_b16 a[96:97], v110 offset:16384
    ds_read_b64_tr_b16 a[98:99], v110 offset:16640
    ds_read_b64_tr_b16 a[100:101], v110 offset:18432
    ds_read_b64_tr_b16 a[102:103], v110 offset:18688
    ds_read_b64_tr_b16 a[104:105], v110 offset:20480
    ds_read_b64_tr_b16 a[106:107], v110 offset:20736
    ds_read_b64_tr_b16 a[108:109], v110 offset:22528
    ds_read_b64_tr_b16 a[110:111], v110 offset:22784
    ds_read_b64_tr_b16 a[112:113], v110 offset:24576
    ds_read_b64_tr_b16 a[114:115], v110 offset:24832
    ds_read_b64_tr_b16 a[116:117], v110 offset:26624
    ds_read_b64_tr_b16 a[118:119], v110 offset:26880
    ds_read_b64_tr_b16 a[120:121], v110 offset:28672
    ds_read_b64_tr_b16 a[122:123], v110 offset:28928
    ds_read_b64_tr_b16 a[124:125], v110 offset:30720
    ds_read_b64_tr_b16 a[126:127], v110 offset:30976
    ds_read_b64_tr_b16 a[128:129], v110 offset:32768
    ds_read_b64_tr_b16 a[130:131], v110 offset:33024
    ds_read_b64_tr_b16 a[132:133], v110 offset:34816
    ds_read_b64_tr_b16 a[134:135], v110 offset:35072
    ds_read_b64_tr_b16 a[136:137], v111 offset:0
    ds_read_b64_tr_b16 a[138:139], v111 offset:4608
    ds_read_b64_tr_b16 a[140:141], v111 offset:32
    ds_read_b64_tr_b16 a[142:143], v111 offset:4640
    ds_read_b64_tr_b16 a[144:145], v111 offset:64
    ds_read_b64_tr_b16 a[146:147], v111 offset:4672
    ds_read_b64_tr_b16 a[148:149], v111 offset:96
    ds_read_b64_tr_b16 a[150:151], v111 offset:4704
    ds_read_b64_tr_b16 a[152:153], v111 offset:128
    ds_read_b64_tr_b16 a[154:155], v111 offset:4736
    ds_read_b64_tr_b16 a[156:157], v111 offset:160
    ds_read_b64_tr_b16 a[158:159], v111 offset:4768
    ds_read_b64_tr_b16 a[160:161], v111 offset:192
    ds_read_b64_tr_b16 a[162:163], v111 offset:4800
    ds_read_b64_tr_b16 a[164:165], v111 offset:224
    ds_read_b64_tr_b16 a[166:167], v111 offset:4832
    ds_read_b64_tr_b16 a[168:169], v111 offset:256
    ds_read_b64_tr_b16 a[170:171], v111 offset:4864
    s_cmp_lt_u32 s2, 144
    s_cbranch_scc1 L2_join
    s_waitcnt vmcnt(0)
    buffer_store_dword v14, v9, s[84:87], s56 offen offset:128 sc1
    s_cmp_lt_u32 s2, 180
    s_cbranch_scc1 L2_join
    s_branch L2_fin
L2_keys:
    s_cmp_ge_u32 s2, 180
    s_cbranch_scc1 L2_fin
    buffer_load_dwordx2 v[64:65], v68, s[84:87], s15 offen offset:8 sc1
    buffer_load_dwordx2 v[66:67], v68, s[84:87], s59 offen offset:8 sc1
    ds_read_b64_tr_b16 a[64:65], v110 offset:0
    ds_read_b64_tr_b16 a[66:67], v110 offset:256
    ds_read_b64_tr_b16 a[68:69], v110 offset:2048
    ds_read_b64_tr_b16 a[70:71], v110 offset:2304
    ds_read_b64_tr_b16 a[72:73], v110 offset:4096
    ds_read_b64_tr_b16 a[74:75], v110 offset:4352
    ds_read_b64_tr_b16 a[76:77], v110 offset:6144
    ds_read_b64_tr_b16 a[78:79], v110 offset:6400
    ds_read_b64_tr_b16 a[80:81], v110 offset:8192
    ds_read_b64_tr_b16 a[82:83], v110 offset:8448
    ds_read_b64_tr_b16 a[84:85], v110 offset:10240
    ds_read_b64_tr_b16 a[86:87], v110 offset:10496
    ds_read_b64_tr_b16 a[88:89], v110 offset:12288
    ds_read_b64_tr_b16 a[90:91], v110 offset:12544
    ds_read_b64_tr_b16 a[92:93], v110 offset:14336
    ds_read_b64_tr_b16 a[94:95], v110 offset:14592
    ds_read_b64_tr_b16 a[96:97], v110 offset:16384
    ds_read_b64_tr_b16 a[98:99], v110 offset:16640
    ds_read_b64_tr_b16 a[100:101], v110 offset:18432
    ds_read_b64_tr_b16 a[102:103], v110 offset:18688
    ds_read_b64_tr_b16 a[104:105], v110 offset:20480
    ds_read_b64_tr_b16 a[106:107], v110 offset:20736
    ds_read_b64_tr_b16 a[108:109], v110 offset:22528
    ds_read_b64_tr_b16 a[110:111], v110 offset:22784
    ds_read_b64_tr_b16 a[112:113], v110 offset:24576
    ds_read_b64_tr_b16 a[114:115], v110 offset:24832
    ds_read_b64_tr_b16 a[116:117], v110 offset:26624
    ds_read_b64_tr_b16 a[118:119], v110 offset:26880
    ds_read_b64_tr_b16 a[120:121], v110 offset:28672
    ds_read_b64_tr_b16 a[122:123], v110 offset:28928
    ds_read_b64_tr_b16 a[124:125], v110 offset:30720
    ds_read_b64_tr_b16 a[126:127], v110 offset:30976
    ds_read_b64_tr_b16 a[128:129], v110 offset:32768
    ds_read_b64_tr_b16 a[130:131], v110 offset:33024
    ds_read_b64_tr_b16 a[132:133], v110 offset:34816
    ds_read_b64_tr_b16 a[134:135], v110 offset:35072
    ds_read_b64_tr_b16 a[136:137], v111 offset:0
    ds_read_b64_tr_b16 a[138:139], v111 offset:4608
    ds_read_b64_tr_b16 a[140:141], v111 offset:32
    ds_read_b64_tr_b16 a[142:143], v111 offset:4640
    ds_read_b64_tr_b16 a[144:145], v111 offset:64
    ds_read_b64_tr_b16 a[146:147], v111 offset:4672
    ds_read_b64_tr_b16 a[148:149], v111 offset:96
    ds_read_b64_tr_b16 a[150:151], v111 offset:4704
    ds_read_b64_tr_b16 a[152:153], v111 offset:128
    ds_read_b64_tr_b16 a[154:155], v111 offset:4736
    ds_read_b64_tr_b16 a[156:157], v111 offset:160
    ds_read_b64_tr_b16 a[158:159], v111 offset:4768
    ds_read_b64_tr_b16 a[160:161], v111 offset:192
    ds_read_b64_tr_b16 a[162:163], v111 offset:4800
    ds_read_b64_tr_b16 a[164:165], v111 offset:224
    ds_read_b64_tr_b16 a[166:167], v111 offset:4832
    ds_read_b64_tr_b16 a[168:169], v111 offset:256
    ds_read_b64_tr_b16 a[170:171], v111 offset:4864
    s_waitcnt vmcnt(0)
    v_cndmask_b32 v64, v64, v44, s[60:61]
    v_cndmask_b32 v65, v65, v45, s[60:61]
    v_cndmask_b32 v66, v66, v44, s[62:63]
    v_cndmask_b32 v67, v67, v45, s[62:63]
    v_min_u32 v12, v64, v65
    v_min_u32 v13, v66, v67
    v_cmp_eq_u32 s[4:5], 0, v12
    v_cmp_eq_u32 s[6:7], 0, v13
    s_nop 0
    s_or_b64 vcc, s[4:5], s[6:7]
    s_cbranch_scc0 L2_p2_ok
    s_mov_b32 s97, 0x20000
L2_p2:
    s_or_b64 exec, s[4:5], 1
    buffer_load_dwordx2 v[64:65], v68, s[84:87], s15 offen offset:8 sc1
    s_or_b64 exec, s[6:7], 1
    buffer_load_dwordx2 v[66:67], v68, s[84:87], s59 offen offset:8 sc1
    s_mov_b64 exec, -1
    s_waitcnt vmcnt(0)
    v_cndmask_b32 v64, v64, v44, s[60:61]
    v_cndmask_b32 v65, v65, v45, s[60:61]
    v_cndmask_b32 v66, v66, v44, s[62:63]
    v_cndmask_b32 v67, v67, v45, s[62:63]
    v_min_u32 v12, v64, v65
    v_min_u32 v13, v66, v67
    v_cmp_eq_u32 s[4:5], 0, v12
    v_cmp_eq_u32 s[6:7], 0, v13
    s_nop 0
    s_or_b64 vcc, s[4:5], s[6:7]
    s_sub_u32 s97, s97, 1
    s_cselect_b64 vcc, 0, vcc
    s_cmp_eq_u64 vcc, 0
    s_cbranch_scc1 L2_p2_ok
    s_sleep 1
    s_branch L2_p2
L2_p2_ok:
    v_max_u32 v65, v65, v67
    v_med3_u32 v65, v64, v66, v65
    v_max_u32 v64, v64, v66
    s_nop 1
    v_mov_b32_dpp v12, v64 row_ror:1 row_mask:0xf bank_mask:0xf
    v_mov_b32_dpp v13, v65 row_ror:1 row_mask:0xf bank_mask:0xf
    v_max_u32 v65, v65, v13
    v_med3_u32 v65, v64, v12, v65
    v_max_u32 v64, v64, v12
    s_nop 1
    v_mov_b32_dpp v12, v64 row_ror:2 row_mask:0xf bank_mask:0xf
    v_mov_b32_dpp v13, v65 row_ror:2 row_mask:0xf bank_mask:0xf
    v_max_u32 v65, v65, v13
    v_med3_u32 v65, v64, v12, v65
    v_max_u32 v64, v64, v12
    s_nop 1
    v_mov_b32_dpp v12, v64 row_ror:4 row_mask:0xf bank_mask:0xf
    v_mov_b32_dpp v13, v65 row_ror:4 row_mask:0xf bank_mask:0xf
    v_max_u32 v65, v65, v13
    v_med3_u32 v65, v64, v12, v65
    v_max_u32 v64, v64, v12
    s_nop 1
    v_mov_b32_dpp v12, v64 row_ror:8 row_mask:0xf bank_mask:0xf
    v_mov_b32_dpp v13, v65 row_ror:8 row_mask:0xf bank_mask:0xf
    v_max_u32 v65, v65, v13
    v_med3_u32 v65, v64, v12, v65
    v_max_u32 v64, v64, v12
    v_mov_b32 v12, v64
    v_mov_b32 v13, v65
    s_nop 0
    v_permlane16_swap_b32 v12, v64
    v_permlane16_swap_b32 v13, v65
    v_max_u32 v65, v65, v13
    v_med3_u32 v65, v64, v12, v65
    v_max_u32 v64, v64, v12
    v_mov_b32 v12, v64
    v_mov_b32 v13, v65
    s_nop 0
    v_permlane32_swap_b32 v12, v64
    v_permlane32_swap_b32 v13, v65
    v_max_u32 v65, v65, v13
    v_med3_u32 v65, v64, v12, v65
    v_max_u32 v64, v64, v12
    s_lshl3_add_u32 s3, s51, 15616
    v_mov_b32 v12, s3
    ds_write_b64 v12, v[64:65]
    s_waitcnt lgkmcnt(0)
L2_join:
    s_barrier
    ds_read_b128 v[16:19], v14
    v_cmp_eq_u32 vcc, 0, v6
    s_waitcnt lgkmcnt(0)
    v_max_u32 v17, v17, v19
    v_med3_u32 v17, v16, v18, v17
    v_max_u32 v16, v16, v18
    v_cndmask_b32 v16, v17, v16, vcc
    v_and_b32 v3, 0x7ff, v16
    v_sub_u32 v3, 2047, v3
    v_mul_u32_u24 v4, 1152, v3
    s_cmp_ge_u32 s2, 144
    s_cbranch_scc1 L2_red
    v_add_u32 v5, v5, v4
    s_mov_b32 s59, 4194304
    v_and_b32 v12, 8, v0
    v_lshlrev_b32 v12, 4, v12
    v_sub_u32 v3, v5, v12
    buffer_load_dwordx4 v[128:131], v5, s[84:87], s59 offen offset:0 sc1
    buffer_load_dwordx4 v[132:135], v5, s[84:87], s59 offen offset:256 sc1
    buffer_load_dwordx4 v[136:139], v5, s[84:87], s59 offen offset:512 sc1
    buffer_load_dwordx4 v[140:143], v5, s[84:87], s59 offen offset:768 sc1
    buffer_load_dwordx4 v[144:147], v3, s[84:87], s59 offen offset:1024 sc1
    v_lshlrev_b32 v11, 7, v6
    v_lshl_add_u32 v13, v7, 5, v11
    v_add_u32 v13, 14848, v13
    v_lshl_add_u32 v11, v7, 4, v11
    s_lshr_b32 s3, s51, 1
    s_lshl_b32 s3, s3, 8
    s_and_b32 s14, s51, 1
    s_lshl_b32 s14, s14, 6
    s_add_u32 s3, s3, s14
    s_add_u32 s3, s3, 14848
    v_add_u32 v11, s3, v11
    s_mul_i32 s14, s51, 1152
    s_mul_i32 s15, s2, 4608
    s_add_u32 s15, s15, s14
    s_add_u32 s15, s15, 98304
    v_lshlrev_b32 v10, 3, v0
    s_waitcnt vmcnt(0)
    buffer_store_dword v14, v9, s[84:87], s56 offen offset:128 sc1
L2_hr:
    v_mfma_f32_16x16x32_bf16 v[88:91], a[64:67], v[128:131], 0
    v_max_u32 v12, v128, v129
    v_mfma_f32_16x16x32_bf16 v[92:95], a[68:71], v[128:131], 0
    v_max3_u32 v12, v12, v130, v131
    v_mfma_f32_16x16x32_bf16 v[96:99], a[72:75], v[128:131], 0
    v_max3_u32 v12, v12, v132, v133
    v_mfma_f32_16x16x32_bf16 v[100:103], a[76:79], v[128:131], 0
    v_max3_u32 v12, v12, v134, v135
    v_mfma_f32_16x16x32_bf16 v[88:91], a[80:83], v[132:135], v[88:91]
    v_max3_u32 v12, v12, v136, v137
    v_mfma_f32_16x16x32_bf16 v[92:95], a[84:87], v[132:135], v[92:95]
    v_max3_u32 v12, v12, v138, v139
    v_mfma_f32_16x16x32_bf16 v[96:99], a[88:91], v[132:135], v[96:99]
    v_max3_u32 v12, v12, v140, v141
    v_mfma_f32_16x16x32_bf16 v[100:103], a[92:95], v[132:135], v[100:103]
    v_max3_u32 v12, v12, v142, v143
    v_mfma_f32_16x16x32_bf16 v[88:91], a[96:99], v[136:139], v[88:91]
    v_max3_u32 v12, v12, v144, v145
    v_mfma_f32_16x16x32_bf16 v[92:95], a[100:103], v[136:139], v[92:95]
    v_max3_u32 v12, v12, v146, v147
    v_mfma_f32_16x16x32_bf16 v[96:99], a[104:107], v[136:139], v[96:99]
    v_cmp_eq_u32 vcc, -1, v12
    v_mfma_f32_16x16x32_bf16 v[100:103], a[108:111], v[136:139], v[100:103]
    v_mfma_f32_16x16x32_bf16 v[96:99], a[120:123], v[140:143], v[96:99]
    v_mfma_f32_16x16x32_bf16 v[100:103], a[124:127], v[140:143], v[100:103]
    v_mfma_f32_16x16x32_bf16 v[88:91], a[112:115], v[140:143], v[88:91]
    v_mfma_f32_16x16x32_bf16 v[92:95], a[116:119], v[140:143], v[92:95]
    v_mfma_f32_16x16x32_bf16 v[92:95], a[132:135], v[144:147], v[92:95]
    v_mfma_f32_16x16x32_bf16 v[88:91], a[128:131], v[144:147], v[88:91]
    s_cmp_lg_u64 vcc, 0
    s_cbranch_scc1 L2_hs
    s_nop 1
    v_add_f32_dpp v96, v100, v96 row_shl:4 row_mask:0xf bank_mask:0xf bound_ctrl:1
    v_add_f32_dpp v97, v101, v97 row_shl:4 row_mask:0xf bank_mask:0xf bound_ctrl:1
    v_add_f32_dpp v98, v102, v98 row_shl:4 row_mask:0xf bank_mask:0xf bound_ctrl:1
    v_add_f32_dpp v99, v103, v99 row_shl:4 row_mask:0xf bank_mask:0xf bound_ctrl:1
    v_add_f32_dpp v88, v92, v88 row_shl:4 row_mask:0xf bank_mask:0xf bound_ctrl:1
    v_add_f32_dpp v89, v93, v89 row_shl:4 row_mask:0xf bank_mask:0xf bound_ctrl:1
    v_add_f32_dpp v90, v94, v90 row_shl:4 row_mask:0xf bank_mask:0xf bound_ctrl:1
    v_add_f32_dpp v91, v95, v91 row_shl:4 row_mask:0xf bank_mask:0xf bound_ctrl:1
    v_add_f32_dpp v88, v96, v88 row_shl:8 row_mask:0xf bank_mask:0xf bound_ctrl:1
    v_add_f32_dpp v89, v97, v89 row_shl:8 row_mask:0xf bank_mask:0xf bound_ctrl:1
    v_add_f32_dpp v90, v98, v90 row_shl:8 row_mask:0xf bank_mask:0xf bound_ctrl:1
    v_add_f32_dpp v91, v99, v91 row_shl:8 row_mask:0xf bank_mask:0xf bound_ctrl:1
    s_mov_b32 exec_lo, 0x30003
    s_mov_b32 exec_hi, 0x30003
    ds_write_b128 v11, v[88:91]
    s_mov_b64 exec, -1
    s_waitcnt lgkmcnt(0)
    s_barrier
    ds_read_b128 v[16:19], v13 offset:0
    ds_read_b128 v[20:23], v13 offset:16
    ds_read_b128 v[24:27], v13 offset:256
    ds_read_b128 v[28:31], v13 offset:272
    v_mov_b32 v12, 0xbfb8aa3b
    s_waitcnt lgkmcnt(2)
    v_pk_mul_f32 v[32:33], v[16:17], v[12:13] op_sel_hi:[1,0]
    v_pk_mul_f32 v[34:35], v[18:19], v[12:13] op_sel_hi:[1,0]
    v_pk_mul_f32 v[36:37], v[20:21], v[12:13] op_sel_hi:[1,0]
    v_pk_mul_f32 v[38:39], v[22:23], v[12:13] op_sel_hi:[1,0]
    v_exp_f32 v32, v32
    v_exp_f32 v33, v33
    v_exp_f32 v34, v34
    v_exp_f32 v35, v35
    v_exp_f32 v36, v36
    v_exp_f32 v37, v37
    v_exp_f32 v38, v38
    v_exp_f32 v39, v39
    v_pk_add_f32 v[32:33], v[32:33], 1.0 op_sel_hi:[1,0]
    v_pk_add_f32 v[34:35], v[34:35], 1.0 op_sel_hi:[1,0]
    v_pk_add_f32 v[36:37], v[36:37], 1.0 op_sel_hi:[1,0]
    v_pk_add_f32 v[38:39], v[38:39], 1.0 op_sel_hi:[1,0]
    v_rcp_f32 v32, v32
    v_rcp_f32 v33, v33
    v_rcp_f32 v34, v34
    v_rcp_f32 v35, v35
    v_rcp_f32 v36, v36
    v_rcp_f32 v37, v37
    v_rcp_f32 v38, v38
    v_rcp_f32 v39, v39
    s_waitcnt lgkmcnt(0)
    v_pk_mul_f32 v[16:17], v[16:17], v[32:33]
    v_pk_mul_f32 v[18:19], v[18:19], v[34:35]
    v_pk_mul_f32 v[20:21], v[20:21], v[36:37]
    v_pk_mul_f32 v[22:23], v[22:23], v[38:39]
    v_pk_mul_f32 v[16:17], v[16:17], v[24:25]
    v_pk_mul_f32 v[18:19], v[18:19], v[26:27]
    v_pk_mul_f32 v[20:21], v[20:21], v[28:29]
    v_pk_mul_f32 v[22:23], v[22:23], v[30:31]
    v_cvt_pk_bf16_f32 v40, v16, v17
    v_cvt_pk_bf16_f32 v41, v18, v19
    v_cvt_pk_bf16_f32 v42, v20, v21
    v_cvt_pk_bf16_f32 v43, v22, v23
    s_nop 1
    v_mfma_f32_16x16x32_bf16 v[48:51], v[40:43], a[136:139], 0
    v_mfma_f32_16x16x32_bf16 v[52:55], v[40:43], a[140:143], 0
    v_mfma_f32_16x16x32_bf16 v[56:59], v[40:43], a[144:147], 0
    v_mfma_f32_16x16x32_bf16 v[60:63], v[40:43], a[148:151], 0
    v_mfma_f32_16x16x32_bf16 v[64:67], v[40:43], a[152:155], 0
    v_mfma_f32_16x16x32_bf16 v[68:71], v[40:43], a[156:159], 0
    v_mfma_f32_16x16x32_bf16 v[72:75], v[40:43], a[160:163], 0
    v_mfma_f32_16x16x32_bf16 v[76:79], v[40:43], a[164:167], 0
    v_mfma_f32_16x16x32_bf16 v[80:83], v[40:43], a[168:171], 0
    s_nop 0
    v_mov_b32_dpp v48, v52 quad_perm:[0,1,2,3] row_mask:0x2 bank_mask:0xf
    v_mov_b32_dpp v49, v53 quad_perm:[0,1,2,3] row_mask:0x2 bank_mask:0xf
    s_nop 0
    v_mov_b32_dpp v48, v56 quad_perm:[0,1,2,3] row_mask:0x4 bank_mask:0xf
    v_mov_b32_dpp v49, v57 quad_perm:[0,1,2,3] row_mask:0x4 bank_mask:0xf
    s_nop 0
    v_mov_b32_dpp v48, v60 quad_perm:[0,1,2,3] row_mask:0x8 bank_mask:0xf
    v_mov_b32_dpp v49, v61 quad_perm:[0,1,2,3] row_mask:0x8 bank_mask:0xf
    v_mov_b32_dpp v50, v64 quad_perm:[0,1,2,3] row_mask:0x1 bank_mask:0xf
    v_mov_b32_dpp v51, v65 quad_perm:[0,1,2,3] row_mask:0x1 bank_mask:0xf
    s_nop 0
    v_mov_b32_dpp v50, v68 quad_perm:[0,1,2,3] row_mask:0x2 bank_mask:0xf
    v_mov_b32_dpp v51, v69 quad_perm:[0,1,2,3] row_mask:0x2 bank_mask:0xf
    s_nop 0
    v_mov_b32_dpp v50, v72 quad_perm:[0,1,2,3] row_mask:0x4 bank_mask:0xf
    v_mov_b32_dpp v51, v73 quad_perm:[0,1,2,3] row_mask:0x4 bank_mask:0xf
    s_nop 0
    v_mov_b32_dpp v50, v76 quad_perm:[0,1,2,3] row_mask:0x8 bank_mask:0xf
    v_mov_b32_dpp v51, v77 quad_perm:[0,1,2,3] row_mask:0x8 bank_mask:0xf
    v_min_u32 v48, -2, v48
    v_min_u32 v49, -2, v49
    v_min_u32 v50, -2, v50
    v_min_u32 v51, -2, v51
    v_min_u32 v80, -2, v80
    v_min_u32 v81, -2, v81
    buffer_store_dwordx4 v[48:51], v8, s[84:87], s15 offen sc1
    s_mov_b64 exec, 0xffff
    buffer_store_dwordx2 v[80:81], v10, s[84:87], s15 offen offset:1024 sc1
    s_branch L2_fin
L2_red:
    s_mov_b32 s3, 98304
    s_add_u32 s32, s84, s3
    s_addc_u32 s33, s85, 0
    s_mov_b32 s34, 663552
    s_mov_b32 s35, 0x20000
    s_sub_u32 s3, s2, 144
    s_mul_i32 s14, s3, 7282
    s_lshr_b32 s14, s14, 16
    s_mul_i32 s15, s14, 9
    s_sub_u32 s15, s3, s15
    s_mul_i32 s14, s14, 144
    s_cmp_eq_u32 s15, 8
    s_cselect_b32 s56, 1, 64
    s_cselect_b32 s57, 2, 1
    s_cselect_b32 s15, 16, s15
    s_lshl3_add_u32 s14, s15, s14
    v_bfe_u32 v7, v0, 2, 3
    v_mul_u32_u24 v7, s57, v7
    v_bfe_u32 v9, v0, 1, 1
    v_mul_u32_u24 v9, s56, v9
    v_add3_u32 v7, v7, v9, s14
    v_lshl_add_u32 v9, v7, 1, v4
    v_lshlrev_b32 v7, 2, v7
    v_lshrrev_b32 v12, 7, v3
    v_bfe_u32 v13, v3, 3, 4
    v_lshl_add_u32 v13, v12, 6, v13
    v_lshlrev_b32 v13, 8, v13
    s_mov_b32 s59, 794624
    s_mov_b32 s97, 0x20000
L2_r:
    buffer_load_dword v12, v13, s[84:87], s59 offen offset:128 sc1
    s_waitcnt vmcnt(0)
    v_cmp_eq_u32 vcc, 0, v12
    s_sub_u32 s97, s97, 1
    s_cselect_b64 vcc, 0, vcc
    s_cmp_eq_u64 vcc, 0
    s_cbranch_scc1 L2_r_ok
    s_sleep 1
    s_branch L2_r
L2_r_ok:
    buffer_load_ushort v18, v9, s[80:83], 0 offen sc1
    ds_read_b32 v20, v7 offset:6912
    v_and_b32 v6, 7, v0
    v_lshrrev_b32 v10, 3, v0
    s_lshl_b32 s14, s51, 3
    v_add_u32 v10, s14, v10
    v_mul_u32_u24 v10, 4608, v10
    v_lshl_add_u32 v10, v6, 4, v10
    s_lshl_b32 s3, s3, 7
    v_add_u32 v24, s3, v10
    v_add_u32 v25, 147456, v24
    v_add_u32 v26, 294912, v24
    v_add_u32 v27, 442368, v24
    v_add_u32 v28, 589824, v24
    v_and_b32 v16, 0xfffff800, v16
    v_not_b32 v12, v16
    v_ashrrev_i32 v12, 31, v12
    v_or_b32 v12, 0x80000000, v12
    v_xor_b32 v16, v16, v12
    v_mul_f32 v16, 0xbfb8aa3b, v16
    v_exp_f32 v16, v16
    s_nop 0
    v_add_f32 v16, 1.0, v16
    v_rcp_f32 v16, v16
    s_waitcnt lgkmcnt(0)
    v_mul_f32 v20, v20, v16
    s_lshl_b32 s14, s51, 7
    s_add_u32 s14, s14, 15872
    v_lshl_add_u32 v10, v6, 4, s14
    v_and_b32 v11, 31, v0
    v_lshlrev_b32 v11, 2, v11
    s_mov_b32 s97, 0x20000
L2_p3:
    buffer_load_dwordx4 v[32:35], v24, s[32:35], 0 offen sc1
    buffer_load_dwordx4 v[36:39], v25, s[32:35], 0 offen sc1
    buffer_load_dwordx4 v[40:43], v26, s[32:35], 0 offen sc1
    buffer_load_dwordx4 v[44:47], v27, s[32:35], 0 offen sc1
    buffer_load_dwordx4 v[48:51], v28, s[32:35], 0 offen sc1
    s_waitcnt vmcnt(0)
    v_max3_u32 v12, v32, v33, v34
    v_max3_u32 v12, v12, v35, v36
    v_max3_u32 v12, v12, v37, v38
    v_max3_u32 v12, v12, v39, v40
    v_max3_u32 v12, v12, v41, v42
    v_max3_u32 v12, v12, v43, v44
    v_max3_u32 v12, v12, v45, v46
    v_max3_u32 v12, v12, v47, v48
    v_max3_u32 v12, v12, v49, v50
    v_max_u32 v12, v12, v51
    v_cmp_eq_u32 vcc, -1, v12
    s_sub_u32 s97, s97, 1
    s_cselect_b64 vcc, 0, vcc
    s_cmp_eq_u64 vcc, 0
    s_cbranch_scc1 L2_p3_ok
    s_branch L2_p3
L2_p3_ok:
    v_pk_add_f32 v[32:33], v[32:33], v[36:37]
    v_pk_add_f32 v[40:41], v[40:41], v[44:45]
    v_pk_add_f32 v[32:33], v[32:33], v[48:49]
    v_pk_add_f32 v[32:33], v[32:33], v[40:41]
    v_pk_add_f32 v[34:35], v[34:35], v[38:39]
    v_pk_add_f32 v[42:43], v[42:43], v[46:47]
    v_pk_add_f32 v[34:35], v[34:35], v[50:51]
    v_pk_add_f32 v[34:35], v[34:35], v[42:43]
    s_nop 1
    v_add_f32_dpp v32, v32, v32 row_ror:8 row_mask:0xf bank_mask:0xf
    v_add_f32_dpp v33, v33, v33 row_ror:8 row_mask:0xf bank_mask:0xf
    v_add_f32_dpp v34, v34, v34 row_ror:8 row_mask:0xf bank_mask:0xf
    v_add_f32_dpp v35, v35, v35 row_ror:8 row_mask:0xf bank_mask:0xf
    v_mov_b32 v12, v32
    v_mov_b32 v13, v33
    v_mov_b32 v14, v34
    v_mov_b32 v15, v35
    v_permlane16_swap_b32 v12, v32
    v_permlane16_swap_b32 v13, v33
    v_permlane16_swap_b32 v14, v34
    v_permlane16_swap_b32 v15, v35
    v_add_f32 v32, v32, v12
    v_add_f32 v33, v33, v13
    v_add_f32 v34, v34, v14
    v_add_f32 v35, v35, v15
    v_mov_b32 v12, v32
    v_mov_b32 v13, v33
    v_mov_b32 v14, v34
    v_mov_b32 v15, v35
    v_permlane32_swap_b32 v12, v32
    v_permlane32_swap_b32 v13, v33
    v_permlane32_swap_b32 v14, v34
    v_permlane32_swap_b32 v15, v35
    v_add_f32 v32, v32, v12
    v_add_f32 v33, v33, v13
    v_add_f32 v34, v34, v14
    v_add_f32 v35, v35, v15
    ds_write_b128 v10, v[32:35]
    s_waitcnt lgkmcnt(0)
    s_barrier
    s_cmp_lg_u32 s51, 0
    s_cbranch_scc1 L2_fin
    ds_read_b32 v32, v11 offset:15872
    ds_read_b32 v33, v11 offset:16000
    ds_read_b32 v34, v11 offset:16128
    ds_read_b32 v35, v11 offset:16256
    v_lshlrev_b32 v12, 16, v18
    s_mov_b32 exec_hi, 0
    s_waitcnt lgkmcnt(0)
    v_pk_add_f32 v[32:33], v[32:33], v[34:35]
    v_add_f32 v32, v32, v33
    v_fmac_f32 v12, v32, v20
    v_cvt_pk_bf16_f32 v12, v12, v12
    buffer_store_short v12, v9, s[80:83], 0 offen sc1
L2_fin:
L2_end:
    s_endpgm
L2_p0s:
    s_mov_b32 s97, 0x20000
L2_p0:
    buffer_load_dword v51, v156, s[60:63], 0 offen sc1
    s_waitcnt vmcnt(0)
    v_cmp_eq_u32 vcc, 0, v51
    s_sub_u32 s97, s97, 1
    s_cselect_b64 vcc, 0, vcc
    s_cmp_eq_u64 vcc, 0
    s_cbranch_scc1 L2_p0_ok
    s_sleep 1
    s_branch L2_p0
L2_p0_ok:
    s_branch L2_p0r
L2_pms:
    s_mov_b32 s97, 0x20000
L2_pm:
    buffer_load_dwordx4 v[168:171], v166, s[84:87], 0 offen sc1
    buffer_load_dwordx4 v[176:179], v166, s[84:87], s14 offen sc1
    s_mov_b64 exec, 0xff
    buffer_load_dwordx4 v[172:175], v166, s[84:87], 0 offen offset:1024 sc1
    buffer_load_dwordx4 v[180:183], v166, s[84:87], s14 offen offset:1024 sc1
    s_mov_b64 exec, -1
    s_waitcnt vmcnt(0)
    v_max_u32 v13, v168, v169
    v_max3_u32 v13, v13, v170, v171
    v_max3_u32 v13, v13, v172, v173
    v_max3_u32 v13, v13, v174, v175
    v_max3_u32 v13, v13, v176, v177
    v_max3_u32 v13, v13, v178, v179
    v_max3_u32 v13, v13, v180, v181
    v_max3_u32 v13, v13, v182, v183
    v_cmp_eq_u32 vcc, -1, v13
    s_sub_u32 s97, s97, 1
    s_cselect_b64 vcc, 0, vcc
    s_cmp_eq_u64 vcc, 0
    s_cbranch_scc1 L2_pm_ok
    s_sleep 1
    s_branch L2_pm
L2_pm_ok:
    s_branch L2_pmr
L2_g0s:
    s_mov_b32 s97, 0x20000
L2_g0:
    buffer_load_dword v9, v6, s[84:87], s47 offen sc1
    s_waitcnt vmcnt(0)
    v_cmp_ne_u32 vcc, 0, v9
    s_nop 0
    s_lshr_b32 s3, vcc_lo, 1
    s_and_b32 s3, s3, vcc_lo
    s_lshr_b32 s14, s3, 2
    s_and_b32 s3, s3, s14
    s_and_b32 s3, s3, s48
    s_cselect_b64 vcc, 0, -1
    s_sub_u32 s97, s97, 1
    s_cselect_b64 vcc, 0, vcc
    s_cmp_eq_u64 vcc, 0
    s_cbranch_scc1 L2_g0_ok
    s_sleep 1
    s_branch L2_g0
L2_g0_ok:
    s_cmp_eq_u32 s3, 0
    s_cselect_b32 s3, s48, s3
    s_branch L2_g0r
L2_g1s:
    s_mov_b32 s97, 0x20000
L2_g1:
    buffer_load_dword v9, v6, s[84:87], s47 offen sc1
    s_waitcnt vmcnt(0)
    v_cmp_ne_u32 vcc, 0, v9
    s_nop 0
    s_lshr_b32 s3, vcc_lo, 1
    s_and_b32 s3, s3, vcc_lo
    s_lshr_b32 s14, s3, 2
    s_and_b32 s3, s3, s14
    s_and_b32 s3, s3, s48
    s_cselect_b64 vcc, 0, -1
    s_sub_u32 s97, s97, 1
    s_cselect_b64 vcc, 0, vcc
    s_cmp_eq_u64 vcc, 0
    s_cbranch_scc1 L2_g1_ok
    s_sleep 1
    s_branch L2_g1
L2_g1_ok:
    s_cmp_eq_u32 s3, 0
    s_cselect_b32 s3, s48, s3
    s_branch L2_g1r
L2_pns:
    s_mov_b32 s97, 0x20000
L2_pn:
    s_movk_i32 s45, 4608
    buffer_load_dwordx4 v[76:79], v5, s[84:87], s45 offen sc1
    s_movk_i32 s45, 18432
    buffer_load_dwordx4 v[88:91], v5, s[84:87], s45 offen sc1
    s_movk_i32 s45, 8704
    buffer_load_dwordx4 v[80:83], v5, s[84:87], s45 offen sc1
    s_movk_i32 s45, 22528
    buffer_load_dwordx4 v[92:95], v5, s[84:87], s45 offen sc1
    s_movk_i32 s45, 12800
    buffer_load_dwordx4 v[84:87], v59, s[84:87], s45 offen sc1
    s_movk_i32 s45, 26624
    buffer_load_dwordx4 v[96:99], v59, s[84:87], s45 offen sc1
    s_waitcnt vmcnt(0)
    v_max_u32 v13, v76, v77
    v_max3_u32 v13, v13, v78, v79
    v_max3_u32 v13, v13, v88, v89
    v_max3_u32 v13, v13, v90, v91
    v_max3_u32 v13, v13, v80, v81
    v_max3_u32 v13, v13, v82, v83
    v_max3_u32 v13, v13, v92, v93
    v_max3_u32 v13, v13, v94, v95
    v_max3_u32 v13, v13, v84, v85
    v_max3_u32 v13, v13, v86, v87
    v_max3_u32 v13, v13, v96, v97
    v_max3_u32 v13, v13, v98, v99
    v_cmp_eq_u32 vcc, -1, v13
    s_sub_u32 s97, s97, 1
    s_cselect_b64 vcc, 0, vcc
    s_cmp_eq_u64 vcc, 0
    s_cbranch_scc1 L2_pn_ok
    s_sleep 1
    s_branch L2_pn
L2_pn_ok:
    s_branch L2_pnr
L2_g2s:
    s_mov_b32 s97, 0x20000
L2_g2:
    buffer_load_dword v9, v6, s[84:87], s47 offen sc1
    s_waitcnt vmcnt(0)
    v_cmp_ne_u32 vcc, 0, v9
    s_nop 0
    s_lshr_b32 s3, vcc_lo, 1
    s_and_b32 s3, s3, vcc_lo
    s_lshr_b32 s14, s3, 2
    s_and_b32 s3, s3, s14
    s_and_b32 s3, s3, s48
    s_cselect_b64 vcc, 0, -1
    s_sub_u32 s97, s97, 1
    s_cselect_b64 vcc, 0, vcc
    s_cmp_eq_u64 vcc, 0
    s_cbranch_scc1 L2_g2_ok
    s_sleep 1
    s_branch L2_g2
L2_g2_ok:
    s_cmp_eq_u32 s3, 0
    s_cselect_b32 s3, s48, s3
    s_branch L2_g2r
L2_g3s:
    s_mov_b32 s97, 0x20000
L2_g3:
    buffer_load_dword v9, v6, s[84:87], s47 offen sc1
    s_waitcnt vmcnt(0)
    v_cmp_ne_u32 vcc, 0, v9
    s_nop 0
    s_lshr_b32 s3, vcc_lo, 1
    s_and_b32 s3, s3, vcc_lo
    s_lshr_b32 s14, s3, 2
    s_and_b32 s3, s3, s14
    s_and_b32 s3, s3, s48
    s_cselect_b64 vcc, 0, -1
    s_sub_u32 s97, s97, 1
    s_cselect_b64 vcc, 0, vcc
    s_cmp_eq_u64 vcc, 0
    s_cbranch_scc1 L2_g3_ok
    s_sleep 1
    s_branch L2_g3
L2_g3_ok:
    s_cmp_eq_u32 s3, 0
    s_cselect_b32 s3, s48, s3
    s_branch L2_g3r
L2_hs:
    s_mov_b32 s97, 0x20000
L2_h:
    buffer_load_dwordx4 v[128:131], v5, s[84:87], s59 offen offset:0 sc1
    buffer_load_dwordx4 v[132:135], v5, s[84:87], s59 offen offset:256 sc1
    buffer_load_dwordx4 v[136:139], v5, s[84:87], s59 offen offset:512 sc1
    buffer_load_dwordx4 v[140:143], v5, s[84:87], s59 offen offset:768 sc1
    buffer_load_dwordx4 v[144:147], v3, s[84:87], s59 offen offset:1024 sc1
    s_waitcnt vmcnt(0)
    v_max_u32 v12, v128, v129
    v_max3_u32 v12, v12, v130, v131
    v_max3_u32 v12, v12, v132, v133
    v_max3_u32 v12, v12, v134, v135
    v_max3_u32 v12, v12, v136, v137
    v_max3_u32 v12, v12, v138, v139
    v_max3_u32 v12, v12, v140, v141
    v_max3_u32 v12, v12, v142, v143
    v_max3_u32 v12, v12, v144, v145
    v_max3_u32 v12, v12, v146, v147
    v_cmp_eq_u32 vcc, -1, v12
    s_sub_u32 s97, s97, 1
    s_cselect_b64 vcc, 0, vcc
    s_cmp_eq_u64 vcc, 0
    s_cbranch_scc1 L2_h_ok
    s_sleep 1
    s_branch L2_h
L2_h_ok:
    v_min_u32 v128, -2, v128
    v_min_u32 v129, -2, v129
    v_min_u32 v130, -2, v130
    v_min_u32 v131, -2, v131
    v_min_u32 v132, -2, v132
    v_min_u32 v133, -2, v133
    v_min_u32 v134, -2, v134
    v_min_u32 v135, -2, v135
    v_min_u32 v136, -2, v136
    v_min_u32 v137, -2, v137
    v_min_u32 v138, -2, v138
    v_min_u32 v139, -2, v139
    v_min_u32 v140, -2, v140
    v_min_u32 v141, -2, v141
    v_min_u32 v142, -2, v142
    v_min_u32 v143, -2, v143
    v_min_u32 v144, -2, v144
    v_min_u32 v145, -2, v145
    v_min_u32 v146, -2, v146
    v_min_u32 v147, -2, v147
    s_nop 1
    s_branch L2_hr
L2_fallback:
    s_waitcnt vmcnt(0) lgkmcnt(0)
    s_nop 7
    s_barrier
    s_lshl_b32 s3, s51, 12
    v_add_u32 v5, s3, v8
    v_lshrrev_b32 v14, 2, v0
    v_mul_u32_u24 v14, 1056, v14
    v_and_b32 v15, 3, v0
    v_lshl_add_u32 v14, v15, 3, v14
    v_add_u32 v2, 107008, v14
    v_and_b32 v14, 15, v0
    v_mul_u32_u24 v14, 1056, v14
    v_lshrrev_b32 v15, 4, v0
    v_lshl_add_u32 v14, v15, 4, v14
    v_add_u32 v1, 90112, v14
    v_mov_b32 v32, 0xff800000
    v_mov_b32 v33, 0xff800000
    v_mov_b32 v34, 0xff800000
    v_mov_b32 v35, 0xff800000
    s_mov_b32 s50, 1
    s_mov_b32 s46, 0
L2_fb_loop:
    s_add_u32 m0, s44, 73728
    s_nop 0
    buffer_load_dwordx4 v5, s[16:19], s46 offen offset:0 lds
    s_add_u32 m0, s44, 73760
    s_nop 0
    buffer_load_dwordx4 v5, s[16:19], s46 offen offset:1024 lds
    s_add_u32 m0, s44, 73792
    s_nop 0
    buffer_load_dwordx4 v5, s[16:19], s46 offen offset:2048 lds
    s_add_u32 m0, s44, 73824
    s_nop 0
    buffer_load_dwordx4 v5, s[16:19], s46 offen offset:3072 lds
    s_waitcnt vmcnt(0) lgkmcnt(0)
    s_barrier
    ds_read_b128 a[64:67], v1 offset:0
    ds_read_b128 a[68:71], v1 offset:64
    ds_read_b128 a[72:75], v1 offset:128
    ds_read_b128 a[76:79], v1 offset:192
    ds_read_b128 a[80:83], v1 offset:256
    ds_read_b128 a[84:87], v1 offset:320
    ds_read_b128 a[88:91], v1 offset:384
    ds_read_b128 a[92:95], v1 offset:448
    ds_read_b128 a[96:99], v1 offset:512
    ds_read_b128 a[100:103], v1 offset:576
    ds_read_b128 a[104:107], v1 offset:640
    ds_read_b128 a[108:111], v1 offset:704
    ds_read_b128 a[112:115], v1 offset:768
    ds_read_b128 a[116:119], v1 offset:832
    ds_read_b128 a[120:123], v1 offset:896
    ds_read_b128 a[124:127], v1 offset:960
    s_waitcnt vmcnt(0) lgkmcnt(0)
    s_barrier
    v_mfma_f32_16x16x32_bf16 v[16:19], a[64:67], v[64:67], 0
    v_mfma_f32_16x16x32_bf16 v[16:19], a[68:71], v[68:71], v[16:19]
    v_mfma_f32_16x16x32_bf16 v[16:19], a[72:75], v[72:75], v[16:19]
    v_mfma_f32_16x16x32_bf16 v[16:19], a[76:79], v[76:79], v[16:19]
    v_mfma_f32_16x16x32_bf16 v[20:23], a[80:83], v[64:67], 0
    v_mfma_f32_16x16x32_bf16 v[20:23], a[84:87], v[68:71], v[20:23]
    v_mfma_f32_16x16x32_bf16 v[20:23], a[88:91], v[72:75], v[20:23]
    v_mfma_f32_16x16x32_bf16 v[20:23], a[92:95], v[76:79], v[20:23]
    v_mfma_f32_16x16x32_bf16 v[24:27], a[96:99], v[64:67], 0
    v_mfma_f32_16x16x32_bf16 v[24:27], a[100:103], v[68:71], v[24:27]
    v_mfma_f32_16x16x32_bf16 v[24:27], a[104:107], v[72:75], v[24:27]
    v_mfma_f32_16x16x32_bf16 v[24:27], a[108:111], v[76:79], v[24:27]
    v_mfma_f32_16x16x32_bf16 v[28:31], a[112:115], v[64:67], 0
    v_mfma_f32_16x16x32_bf16 v[28:31], a[116:119], v[68:71], v[28:31]
    v_mfma_f32_16x16x32_bf16 v[28:31], a[120:123], v[72:75], v[28:31]
    v_mfma_f32_16x16x32_bf16 v[28:31], a[124:127], v[76:79], v[28:31]
    s_nop 7
    v_max3_f32 v32, v32, v16, v17
    v_max3_f32 v32, v32, v18, v19
    v_max3_f32 v32, v32, v20, v21
    v_max3_f32 v32, v32, v22, v23
    v_max3_f32 v32, v32, v24, v25
    v_max3_f32 v32, v32, v26, v27
    v_max3_f32 v32, v32, v28, v29
    v_max3_f32 v32, v32, v30, v31
    v_mfma_f32_16x16x32_bf16 v[16:19], a[64:67], v[80:83], 0
    v_mfma_f32_16x16x32_bf16 v[16:19], a[68:71], v[84:87], v[16:19]
    v_mfma_f32_16x16x32_bf16 v[16:19], a[72:75], v[88:91], v[16:19]
    v_mfma_f32_16x16x32_bf16 v[16:19], a[76:79], v[92:95], v[16:19]
    v_mfma_f32_16x16x32_bf16 v[20:23], a[80:83], v[80:83], 0
    v_mfma_f32_16x16x32_bf16 v[20:23], a[84:87], v[84:87], v[20:23]
    v_mfma_f32_16x16x32_bf16 v[20:23], a[88:91], v[88:91], v[20:23]
    v_mfma_f32_16x16x32_bf16 v[20:23], a[92:95], v[92:95], v[20:23]
    v_mfma_f32_16x16x32_bf16 v[24:27], a[96:99], v[80:83], 0
    v_mfma_f32_16x16x32_bf16 v[24:27], a[100:103], v[84:87], v[24:27]
    v_mfma_f32_16x16x32_bf16 v[24:27], a[104:107], v[88:91], v[24:27]
    v_mfma_f32_16x16x32_bf16 v[24:27], a[108:111], v[92:95], v[24:27]
    v_mfma_f32_16x16x32_bf16 v[28:31], a[112:115], v[80:83], 0
    v_mfma_f32_16x16x32_bf16 v[28:31], a[116:119], v[84:87], v[28:31]
    v_mfma_f32_16x16x32_bf16 v[28:31], a[120:123], v[88:91], v[28:31]
    v_mfma_f32_16x16x32_bf16 v[28:31], a[124:127], v[92:95], v[28:31]
    s_nop 7
    v_max3_f32 v33, v33, v16, v17
    v_max3_f32 v33, v33, v18, v19
    v_max3_f32 v33, v33, v20, v21
    v_max3_f32 v33, v33, v22, v23
    v_max3_f32 v33, v33, v24, v25
    v_max3_f32 v33, v33, v26, v27
    v_max3_f32 v33, v33, v28, v29
    v_max3_f32 v33, v33, v30, v31
    v_mfma_f32_16x16x32_bf16 v[16:19], a[64:67], v[96:99], 0
    v_mfma_f32_16x16x32_bf16 v[16:19], a[68:71], v[100:103], v[16:19]
    v_mfma_f32_16x16x32_bf16 v[16:19], a[72:75], v[104:107], v[16:19]
    v_mfma_f32_16x16x32_bf16 v[16:19], a[76:79], v[108:111], v[16:19]
    v_mfma_f32_16x16x32_bf16 v[20:23], a[80:83], v[96:99], 0
    v_mfma_f32_16x16x32_bf16 v[20:23], a[84:87], v[100:103], v[20:23]
    v_mfma_f32_16x16x32_bf16 v[20:23], a[88:91], v[104:107], v[20:23]
    v_mfma_f32_16x16x32_bf16 v[20:23], a[92:95], v[108:111], v[20:23]
    v_mfma_f32_16x16x32_bf16 v[24:27], a[96:99], v[96:99], 0
    v_mfma_f32_16x16x32_bf16 v[24:27], a[100:103], v[100:103], v[24:27]
    v_mfma_f32_16x16x32_bf16 v[24:27], a[104:107], v[104:107], v[24:27]
    v_mfma_f32_16x16x32_bf16 v[24:27], a[108:111], v[108:111], v[24:27]
    v_mfma_f32_16x16x32_bf16 v[28:31], a[112:115], v[96:99], 0
    v_mfma_f32_16x16x32_bf16 v[28:31], a[116:119], v[100:103], v[28:31]
    v_mfma_f32_16x16x32_bf16 v[28:31], a[120:123], v[104:107], v[28:31]
    v_mfma_f32_16x16x32_bf16 v[28:31], a[124:127], v[108:111], v[28:31]
    s_nop 7
    v_max3_f32 v34, v34, v16, v17
    v_max3_f32 v34, v34, v18, v19
    v_max3_f32 v34, v34, v20, v21
    v_max3_f32 v34, v34, v22, v23
    v_max3_f32 v34, v34, v24, v25
    v_max3_f32 v34, v34, v26, v27
    v_max3_f32 v34, v34, v28, v29
    v_max3_f32 v34, v34, v30, v31
    v_mfma_f32_16x16x32_bf16 v[16:19], a[64:67], v[112:115], 0
    v_mfma_f32_16x16x32_bf16 v[16:19], a[68:71], v[116:119], v[16:19]
    v_mfma_f32_16x16x32_bf16 v[16:19], a[72:75], v[120:123], v[16:19]
    v_mfma_f32_16x16x32_bf16 v[16:19], a[76:79], v[124:127], v[16:19]
    v_mfma_f32_16x16x32_bf16 v[20:23], a[80:83], v[112:115], 0
    v_mfma_f32_16x16x32_bf16 v[20:23], a[84:87], v[116:119], v[20:23]
    v_mfma_f32_16x16x32_bf16 v[20:23], a[88:91], v[120:123], v[20:23]
    v_mfma_f32_16x16x32_bf16 v[20:23], a[92:95], v[124:127], v[20:23]
    v_mfma_f32_16x16x32_bf16 v[24:27], a[96:99], v[112:115], 0
    v_mfma_f32_16x16x32_bf16 v[24:27], a[100:103], v[116:119], v[24:27]
    v_mfma_f32_16x16x32_bf16 v[24:27], a[104:107], v[120:123], v[24:27]
    v_mfma_f32_16x16x32_bf16 v[24:27], a[108:111], v[124:127], v[24:27]
    v_mfma_f32_16x16x32_bf16 v[28:31], a[112:115], v[112:115], 0
    v_mfma_f32_16x16x32_bf16 v[28:31], a[116:119], v[116:119], v[28:31]
    v_mfma_f32_16x16x32_bf16 v[28:31], a[120:123], v[120:123], v[28:31]
    v_mfma_f32_16x16x32_bf16 v[28:31], a[124:127], v[124:127], v[28:31]
    s_nop 7
    v_max3_f32 v35, v35, v16, v17
    v_max3_f32 v35, v35, v18, v19
    v_max3_f32 v35, v35, v20, v21
    v_max3_f32 v35, v35, v22, v23
    v_max3_f32 v35, v35, v24, v25
    v_max3_f32 v35, v35, v26, v27
    v_max3_f32 v35, v35, v28, v29
    v_max3_f32 v35, v35, v30, v31
    s_add_u32 s46, s46, 16384
    s_cmp_lt_u32 s46, 524288
    s_cbranch_scc1 L2_fb_loop
    v_mov_b32 v40, v32
    v_mov_b32 v41, v33
    v_mov_b32 v42, v34
    v_mov_b32 v43, v35
    v_permlane16_swap_b32 v40, v32
    v_permlane16_swap_b32 v41, v33
    v_permlane16_swap_b32 v42, v34
    v_permlane16_swap_b32 v43, v35
    v_max_f32 v32, v32, v40
    v_max_f32 v33, v33, v41
    v_max_f32 v34, v34, v42
    v_max_f32 v35, v35, v43
    v_mov_b32 v40, v32
    v_mov_b32 v41, v33
    v_mov_b32 v42, v34
    v_mov_b32 v43, v35
    v_permlane32_swap_b32 v40, v32
    v_permlane32_swap_b32 v41, v33
    v_permlane32_swap_b32 v42, v34
    v_permlane32_swap_b32 v43, v35
    v_max_f32 v32, v32, v40
    v_max_f32 v33, v33, v41
    v_max_f32 v34, v34, v42
    v_max_f32 v35, v35, v43
    v_sub_f32 v48, 0x80000000, v32
    v_sub_f32 v49, 0x80000000, v32
    v_sub_f32 v50, 0x80000000, v32
    v_sub_f32 v51, 0x80000000, v32
    v_sub_f32 v52, 0x80000000, v33
    v_sub_f32 v53, 0x80000000, v33
    v_sub_f32 v54, 0x80000000, v33
    v_sub_f32 v55, 0x80000000, v33
    v_sub_f32 v56, 0x80000000, v34
    v_sub_f32 v57, 0x80000000, v34
    v_sub_f32 v58, 0x80000000, v34
    v_sub_f32 v59, 0x80000000, v34
    v_sub_f32 v60, 0x80000000, v35
    v_sub_f32 v61, 0x80000000, v35
    v_sub_f32 v62, 0x80000000, v35
    v_sub_f32 v63, 0x80000000, v35
    s_add_u32 m0, s44, 73728
    s_mov_b32 s46, 0
    buffer_load_dwordx4 v5, s[16:19], s46 offen offset:0 lds
    s_add_u32 m0, s44, 73760
    s_nop 0
    buffer_load_dwordx4 v5, s[16:19], s46 offen offset:1024 lds
    s_add_u32 m0, s44, 73792
    s_nop 0
    buffer_load_dwordx4 v5, s[16:19], s46 offen offset:2048 lds
    s_add_u32 m0, s44, 73824
    s_nop 0
    buffer_load_dwordx4 v5, s[16:19], s46 offen offset:3072 lds
    s_add_u32 m0, s44, 90624
    s_nop 0
    buffer_load_dwordx4 v5, s[20:23], s46 offen offset:0 lds
    s_add_u32 m0, s44, 90656
    s_nop 0
    buffer_load_dwordx4 v5, s[20:23], s46 offen offset:1024 lds
    s_add_u32 m0, s44, 90688
    s_nop 0
    buffer_load_dwordx4 v5, s[20:23], s46 offen offset:2048 lds
    s_add_u32 m0, s44, 90720
    s_nop 0
    buffer_load_dwordx4 v5, s[20:23], s46 offen offset:3072 lds
    s_add_u32 m0, s44, 110592
    s_mov_b32 s46, 16384
    buffer_load_dwordx4 v5, s[16:19], s46 offen offset:0 lds
    s_add_u32 m0, s44, 110624
    s_nop 0
    buffer_load_dwordx4 v5, s[16:19], s46 offen offset:1024 lds
    s_add_u32 m0, s44, 110656
    s_nop 0
    buffer_load_dwordx4 v5, s[16:19], s46 offen offset:2048 lds
    s_add_u32 m0, s44, 110688
    s_nop 0
    buffer_load_dwordx4 v5, s[16:19], s46 offen offset:3072 lds
    s_add_u32 m0, s44, 127488
    s_nop 0
    buffer_load_dwordx4 v5, s[20:23], s46 offen offset:0 lds
    s_add_u32 m0, s44, 127520
    s_nop 0
    buffer_load_dwordx4 v5, s[20:23], s46 offen offset:1024 lds
    s_add_u32 m0, s44, 127552
    s_nop 0
    buffer_load_dwordx4 v5, s[20:23], s46 offen offset:2048 lds
    s_add_u32 m0, s44, 127584
    s_nop 0
    buffer_load_dwordx4 v5, s[20:23], s46 offen offset:3072 lds
    s_add_u32 m0, s44, 0
    s_mov_b32 s46, 32768
    buffer_load_dwordx4 v5, s[16:19], s46 offen offset:0 lds
    s_add_u32 m0, s44, 32
    s_nop 0
    buffer_load_dwordx4 v5, s[16:19], s46 offen offset:1024 lds
    s_add_u32 m0, s44, 64
    s_nop 0
    buffer_load_dwordx4 v5, s[16:19], s46 offen offset:2048 lds
    s_add_u32 m0, s44, 96
    s_nop 0
    buffer_load_dwordx4 v5, s[16:19], s46 offen offset:3072 lds
    s_add_u32 m0, s44, 16896
    s_nop 0
    buffer_load_dwordx4 v5, s[20:23], s46 offen offset:0 lds
    s_add_u32 m0, s44, 16928
    s_nop 0
    buffer_load_dwordx4 v5, s[20:23], s46 offen offset:1024 lds
    s_add_u32 m0, s44, 16960
    s_nop 0
    buffer_load_dwordx4 v5, s[20:23], s46 offen offset:2048 lds
    s_add_u32 m0, s44, 16992
    s_nop 0
    buffer_load_dwordx4 v5, s[20:23], s46 offen offset:3072 lds
    s_waitcnt vmcnt(0) lgkmcnt(0)
    s_barrier
    ds_read_b128 a[64:67], v1 offset:0
    ds_read_b128 a[68:71], v1 offset:64
    ds_read_b128 a[72:75], v1 offset:128
    ds_read_b128 a[76:79], v1 offset:192
    ds_read_b128 a[80:83], v1 offset:256
    ds_read_b128 a[84:87], v1 offset:320
    ds_read_b128 a[88:91], v1 offset:384
    ds_read_b128 a[92:95], v1 offset:448
    ds_read_b128 a[96:99], v1 offset:512
    ds_read_b128 a[100:103], v1 offset:576
    ds_read_b128 a[104:107], v1 offset:640
    ds_read_b128 a[108:111], v1 offset:704
    ds_read_b128 a[112:115], v1 offset:768
    ds_read_b128 a[116:119], v1 offset:832
    ds_read_b128 a[120:123], v1 offset:896
    ds_read_b128 a[124:127], v1 offset:960
    v_lshrrev_b32 v14, 2, v0
    s_mul_i32 s3, s51, 144
    v_add_u32 v14, s3, v14
    v_mul_u32_u24 v14, 9216, v14
    v_and_b32 v15, 3, v0
    v_lshl_add_u32 v6, v15, 4, v14
    s_lshr_b32 s3, s2, 3
    s_lshl2_add_u32 s3, s3, s51
    s_and_b32 s15, s2, 7
    v_lshlrev_b32 v9, 7, v0
    s_mul_i32 s14, s3, 9
    s_lshr_b32 s14, s14, 1
    v_min_u32 v15, 44, v0
    v_mul_u32_u24 v12, 7282, v15
    v_lshrrev_b32 v12, 16, v12
    v_mul_u32_u24 v13, 63, v12
    v_add_u32 v12, v15, v13
    s_mul_i32 s14, s14, 72
    s_mul_i32 s56, s15, 9
    s_add_u32 s14, s14, s56
    v_add_lshl_u32 v12, s14, v12, 7
    s_mul_i32 s14, s3, 81
    s_lshr_b32 s14, s14, 1
    s_mul_i32 s56, s15, 5184
    s_add_u32 s14, s14, s56
    v_min_u32 v13, 40, v0
    v_add_lshl_u32 v13, s14, v13, 7
    s_mul_i32 s14, s3, 72
    s_andn2_b32 s56, s52, 3
    s_mul_i32 s56, s56, 2304
    s_add_u32 s14, s14, s56
    v_min_u32 v14, 35, v0
    v_add_lshl_u32 v14, s14, v14, 7
    v_add_u32 v15, 4608, v14
    v_accvgpr_write_b32 a0, 0
    v_accvgpr_write_b32 a1, 0
    v_accvgpr_write_b32 a2, 0
    v_accvgpr_write_b32 a3, 0
    v_accvgpr_write_b32 a4, 0
    v_accvgpr_write_b32 a5, 0
    v_accvgpr_write_b32 a6, 0
    v_accvgpr_write_b32 a7, 0
    v_accvgpr_write_b32 a8, 0
    v_accvgpr_write_b32 a9, 0
    v_accvgpr_write_b32 a10, 0
    v_accvgpr_write_b32 a11, 0
    v_accvgpr_write_b32 a12, 0
    v_accvgpr_write_b32 a13, 0
    v_accvgpr_write_b32 a14, 0
    v_accvgpr_write_b32 a15, 0
    s_waitcnt vmcnt(0) lgkmcnt(0)
    s_branch L2_entry
L2_codeend:

.section .rodata,"a"
.p2align 6
.amdhsa_kernel adaLN_cond__gqa_block_cached__moe_arch_mod__prompt_kernel
  .amdhsa_next_free_vgpr 512
  .amdhsa_next_free_sgpr 102
  .amdhsa_accum_offset 256
  .amdhsa_group_segment_fixed_size 0
  .amdhsa_kernarg_size 120
  .amdhsa_user_sgpr_count 2
  .amdhsa_user_sgpr_kernarg_segment_ptr 1
  .amdhsa_system_sgpr_workgroup_id_x 1
  .amdhsa_float_denorm_mode_32 3
.end_amdhsa_kernel
```

```asm
; @launch grid=(256,1,1) block=(256,1,1) lds=163840
.amdgcn_target "amdgcn-amd-amdhsa--gfx950"
.text
.globl adaLN_cond__gqa_block_cached__moe_arch_mod__prompt_kernel
.p2align 8
.type adaLN_cond__gqa_block_cached__moe_arch_mod__prompt_kernel,@function
adaLN_cond__gqa_block_cached__moe_arch_mod__prompt_kernel:
L2_begin:
    s_getpc_b64 s[98:99]
    s_cmp_ge_u32 s2, 256
    s_cbranch_scc1 L2_end
    s_load_dwordx2 s[76:77], s[0:1], 0
    s_load_dwordx2 s[16:17], s[0:1], 80
    s_load_dwordx2 s[88:89], s[0:1], 88
    s_load_dwordx2 s[12:13], s[0:1], 112
    s_load_dwordx2 s[60:61], s[0:1], 104
    s_and_b32 s3, s2, 7
    s_lshr_b32 s14, s2, 3
    v_mov_b32 v155, v0
    v_lshrrev_b32 v10, 6, v0
    v_and_b32 v0, 63, v0
    s_lshl_b32 s15, s14, 9
    v_lshl_add_u32 v13, v10, 7, s15
    v_lshl_add_u32 v13, v0, 14, v13
    v_min_u32 v13, L2_codeend-L2_begin-8, v13
    s_mov_b64 exec, 31
    global_load_dword a63, v13, s[98:99]
    s_mov_b64 exec, -1
    v_readfirstlane_b32 s51, v10
    s_and_b32 s52, s3, 3
    s_and_b32 s15, s14, 3
    s_lshl2_add_u32 s52, s52, s15
    s_lshr_b32 s53, s3, 2
    s_lshr_b32 s15, s14, 2
    s_lshl3_add_u32 s53, s53, s15
    s_lshl4_add_u32 s96, s53, s52
    s_mul_i32 s49, s3, 27
    s_max_u32 s14, s14, 5
    s_add_u32 s49, s49, s14
    s_sub_u32 s49, s49, 5
    s_lshr_b32 s55, s3, 2
    s_mul_i32 s15, s55, 108
    s_sub_u32 s50, s49, s15
    s_mul_i32 s3, s51, 288
    v_lshrrev_b32 v14, 3, v0
    v_lshl_add_u32 v12, v14, 4, s3
    v_and_b32 v14, 1, v14
    v_lshl_add_u32 v13, v14, 4, s3
    v_and_b32 v14, 7, v0
    v_mul_u32_u24 v14, 1152, v14
    v_add_u32 v1, v14, v12
    v_add_u32 v2, v14, v13
    v_add_u32 v2, 256, v2
    v_and_b32 v4, 0xfc, v155
    v_and_b32 v7, 3, v0
    v_mul_u32_u24 v3, 6912, v4
    v_lshl_add_u32 v153, v7, 4, v3
    s_mul_i32 s3, s96, 9216
    s_movk_i32 s78, 9216
    s_mov_b32 s79, 0x20000
    s_mov_b32 s91, s79
    v_lshlrev_b32 v8, 4, v0
    s_mov_b32 s86, 8388608
    s_mov_b32 s87, s79
    s_movk_i32 s62, 256
    s_mov_b32 s63, s79
    s_lshl_b32 s14, s50, 6
    s_sub_u32 s90, 1990656, s14
    s_cmp_ge_u32 s2, 40
    s_cselect_b32 s90, s90, 0
    s_mul_i32 s15, s55, 1990656
    s_add_u32 s14, s14, s15
    s_waitcnt lgkmcnt(0)
    s_add_u32 s76, s76, s3
    s_addc_u32 s77, s77, 0
    buffer_load_dwordx4 v[64:67], v1, s[76:79], 0 offen offset:0
    buffer_load_dwordx4 v[68:71], v1, s[76:79], 0 offen offset:128
    buffer_load_dwordx4 v[72:75], v2, s[76:79], 0 offen offset:0
    s_add_u32 s88, s88, s14
    s_addc_u32 s89, s89, 0
    s_mov_b64 s[84:85], s[12:13]
    s_cmp_ge_u32 s2, 8
    s_cbranch_scc1 L2_noclr
    v_mov_b32 v52, -1
    v_mov_b32 v56, 0
    v_mov_b32 v53, -1
    v_mov_b32 v57, 0
    v_mov_b32 v54, -1
    v_mov_b32 v58, 0
    v_mov_b32 v55, -1
    v_mov_b32 v59, 0
    s_lshl2_add_u32 s15, s2, s51
    s_lshl_b32 s3, s15, 10
    buffer_store_dwordx4 v[52:55], v8, s[84:87], s3 offen sc1
    v_lshrrev_b32 v13, 3, v0
    v_mul_u32_u24 v13, 0, v13
    v_add_u32 v13, v13, v8
    s_mul_i32 s3, s15, 1024
    s_add_u32 s3, s3, 6815744
    buffer_store_dwordx4 v[56:59], v13, s[84:87], s3 offen sc1
L2_noclr:
    buffer_load_dwordx4 v[128:131], v153, s[88:91], 0 offen
    s_movk_i32 s3, 6912
    buffer_load_dwordx4 v[132:135], v153, s[88:91], s3 offen
    s_movk_i32 s3, 13824
    buffer_load_dwordx4 v[136:139], v153, s[88:91], s3 offen
    s_movk_i32 s3, 20736
    buffer_load_dwordx4 v[140:143], v153, s[88:91], s3 offen
    v_lshrrev_b32 v3, 2, v3
    v_lshl_add_u32 v3, v7, 4, v3
    v_add_u32 v154, 1769472, v3
    v_lshrrev_b32 v3, 1, v4
    v_lshlrev_b32 v4, 1, v4
    s_mul_i32 s3, s55, 576
    s_add_u32 s16, s16, s3
    s_addc_u32 s17, s17, 0
    s_mov_b32 s18, 576
    s_mov_b32 s19, 0x20000
    buffer_load_dwordx2 v[148:149], v4, s[16:19], 0 offen
    v_mov_b32 v144, 0
    v_mov_b32 v145, 0
    v_mov_b32 v146, 0
    v_mov_b32 v147, 0
    v_mov_b32 v150, 0
    s_cmp_ge_u32 s51, 2
    s_cbranch_scc1 L2_w23
    buffer_load_dwordx4 v[144:147], v154, s[88:91], 0 offen
    buffer_load_ushort v150, v3, s[16:19], 0 offen offset:512
L2_w23:
    s_load_dwordx8 s[4:11], s[0:1], 8
    s_load_dwordx2 s[64:65], s[0:1], 56
    s_load_dwordx2 s[68:69], s[0:1], 64
    s_load_dwordx2 s[72:73], s[0:1], 72
    s_load_dwordx2 s[80:81], s[0:1], 96
    s_load_dwordx2 s[36:37], s[0:1], 48
    s_cmp_eq_u32 s51, 0
    s_cselect_b32 s3, 0, 0x40000000
    v_mul_u32_u24 v156, 32, v0
    v_or_b32 v156, s3, v156
    s_mul_i32 s44, s51, 4224
    s_add_u32 s44, s44, 16384
    v_lshl_add_u32 v5, v10, 12, v8
    v_lshrrev_b32 v13, 5, v0
    v_lshl_add_u32 v13, v10, 1, v13
    v_lshlrev_b32 v13, 15, v13
    v_and_b32 v14, 31, v0
    v_lshl_add_u32 v6, v14, 4, v13
    v_mov_b32 v56, 0
    v_mov_b32 v60, -1
    v_mov_b32 v57, 0
    v_mov_b32 v61, -1
    v_mov_b32 v58, 0
    v_mov_b32 v62, -1
    v_mov_b32 v59, 0
    v_mov_b32 v63, -1
    s_and_b32 s14, s53, 7
    s_lshl2_add_u32 s14, s14, s51
    v_lshrrev_b32 v13, 2, v0
    v_lshl_add_u32 v13, v13, 5, s14
    v_lshlrev_b32 v13, 13, v13
    v_lshl_add_u32 v13, v7, 7, v13
    s_waitcnt lgkmcnt(0)
    s_lshl_b32 s3, s52, 9
    s_add_u32 s24, s8, s3
    s_addc_u32 s25, s9, 0
    s_mov_b32 s26, 0
    s_mov_b32 s27, 0x20000
    s_sub_u32 s26, 4718592, s3
    s_mov_b64 exec, 0xffff
    buffer_load_dword a63, v13, s[24:27], 0 offen
    s_mov_b64 exec, -1
    s_mov_b32 s38, 1152
    s_mov_b32 s39, 0x20000
    v_and_b32 v14, 7, v0
    v_lshlrev_b32 v157, 4, v14
    v_add_u32 v157, 14080, v157
    v_lshl_add_u32 v158, v10, 2, v157
    s_mul_i32 s3, s51, 4608
    v_lshl_add_u32 v14, v14, 4, s3
    v_lshrrev_b32 v15, 3, v0
    v_lshl_add_u32 v159, v15, 8, v14
    s_lshr_b32 s3, s96, 1
    s_mul_i32 s3, s3, 18432
    s_and_b32 s14, s96, 1
    s_lshl_b32 s14, s14, 7
    s_add_u32 s3, s3, s14
    s_add_u32 s58, s3, 1048576
    s_lshl_b32 s3, s53, 2
    s_add_u32 s3, s3, s51
    s_lshl_b32 s14, s3, 4
    s_add_u32 s14, s14, s52
    s_lshl_b32 s14, s14, 8
    s_add_u32 s56, s14, 786432
    s_mul_i32 s14, s3, 512
    s_add_u32 s59, s14, 6815744
    v_and_b32 v14, 3, v0
    v_mul_u32_u24 v163, 128, v14
    s_mul_i32 s14, s3, 36864
    s_add_u32 s14, s14, 1048576
    s_add_u32 s32, s12, s14
    s_addc_u32 s33, s13, 0
    s_mov_b32 s34, 36864
    s_mov_b32 s35, 0x20000
    s_mul_i32 s15, s2, 4608
    s_mul_i32 s14, s51, 1152
    s_add_u32 s15, s15, s14
    s_add_u32 s57, s15, 98304
    s_cmp_ge_u32 s2, 144
    s_cselect_b32 s14, 0x40000000, 0
    v_or_b32 v160, s14, v8
    v_lshrrev_b32 v12, 4, v155
    v_lshlrev_b32 v12, 7, v12
    v_lshl_add_u32 v161, v7, 5, v12
    v_lshlrev_b32 v162, 2, v0
    s_mul_i32 s3, s50, 3641
    s_lshr_b32 s3, s3, 16
    s_mov_b32 s47, 1.0
    s_mov_b32 s48, 0
    s_cmp_lt_u32 s3, 2
    s_cselect_b32 s47, 0x3e0293ee, s47
    s_cmp_eq_u32 s3, 1
    s_cselect_b32 s48, 0x3e0293ee, s48
    s_cmp_eq_u32 s3, 4
    s_cselect_b32 s48, 1.0, s48
    s_cmp_eq_u32 s55, 0
    s_cselect_b32 s48, s48, 0
    s_lshl_b32 s100, s49, 7
    s_mul_i32 s14, s96, 128
    s_add_u32 s101, s14, 6815744
    s_mul_i32 s3, s51, 1152
    v_add_u32 v166, s3, v8
    s_and_b32 s3, s51, 1
    s_mul_i32 s3, s3, 2304
    s_cmp_lt_u32 s51, 2
    s_cselect_b32 s14, 32, 0
    s_add_u32 s3, s3, s14
    s_add_u32 s3, s3, 9216
    v_lshrrev_b32 v14, 1, v0
    v_lshl_add_u32 v14, v14, 6, s3
    v_and_b32 v15, 1, v0
    v_lshl_add_u32 v167, v15, 4, v14
    s_cmp_eq_u32 s51, 1
    s_cselect_b32 s3, 40, 256
    s_cmp_ge_u32 s2, s3
    s_cselect_b32 s3, 0, 0x40000000
    v_or_b32 v164, s3, v162
    v_mov_b32 v172, 0
    v_mov_b32 v180, 0
    v_mov_b32 v173, 0
    v_mov_b32 v181, 0
    v_mov_b32 v174, 0
    v_mov_b32 v182, 0
    v_mov_b32 v175, 0
    v_mov_b32 v183, 0
    s_lshl_b32 s3, s53, 2
    s_add_u32 s3, s3, s51
    v_mov_b32 v12, v10
    s_mul_i32 s14, s3, 589824
    s_mul_i32 s15, s52, 9216
    s_add_u32 s14, s14, s15
    s_add_u32 s14, s14, 8388608
    s_add_u32 s40, s12, s14
    s_addc_u32 s41, s13, 0
    s_mov_b32 s42, 0
    s_mov_b32 s43, 0x20000
    s_sub_u32 s42, 589824, s15
    s_lshl_b32 s3, s52, 19
    s_add_u32 s16, s4, s3
    s_addc_u32 s17, s5, 0
    s_mov_b32 s18, 524288
    s_mov_b32 s19, 0x20000
    s_add_u32 s20, s6, s3
    s_addc_u32 s21, s7, 0
    s_mov_b32 s22, 524288
    s_mov_b32 s23, 0x20000
    s_mul_i32 s3, s52, 294912
    s_add_u32 s28, s10, s3
    s_addc_u32 s29, s11, 0
    s_mov_b32 s30, 294912
    s_mov_b32 s31, 0x20000
    s_mov_b64 s[4:5], s[64:65]
    s_mov_b64 s[6:7], s[68:69]
    s_mov_b64 s[8:9], s[72:73]
    s_mov_b32 s50, 0
    s_mul_i32 s55, s51, 9216
    s_min_u32 s15, s2, 143
    s_and_b32 s3, s15, 7
    s_mul_i32 s3, s3, 18
    s_lshr_b32 s15, s15, 3
    s_add_u32 s15, s15, s3
    s_lshl_b32 s3, s15, 6
    s_add_u32 s64, s64, s3
    s_addc_u32 s65, s65, 0
    s_mov_b32 s66, 0
    s_mov_b32 s67, 0x20000
    s_add_u32 s68, s68, s3
    s_addc_u32 s69, s69, 0
    s_mov_b32 s70, 0
    s_mov_b32 s71, 0x20000
    s_sub_u32 s14, 5308416, s3
    s_mul_i32 s3, s15, 36864
    s_add_u32 s72, s72, s3
    s_addc_u32 s73, s73, 0
    s_mov_b32 s74, 0
    s_mov_b32 s75, 0x20000
    s_cmp_lt_u32 s2, 144
    s_cselect_b32 s66, s14, 0
    s_cselect_b32 s70, s14, 0
    s_cselect_b32 s74, 36864, 0
    s_mov_b32 s82, 2359296
    s_mov_b32 s83, 0x20000
    v_lshrrev_b32 v13, 4, v0
    v_lshlrev_b32 v9, 6, v13
    v_lshrrev_b32 v14, 2, v0
    v_mul_u32_u24 v14, 1056, v14
    v_add_u32 v14, 16384, v14
    v_and_b32 v15, 1, v0
    v_lshlrev_b32 v15, 4, v15
    v_add_u32 v3, v14, v15
    v_and_b32 v15, 2, v0
    v_lshl_add_u32 v3, v15, 2, v3
    v_add_u32 v4, 73728, v3
    v_lshrrev_b32 v14, 3, v0
    v_lshlrev_b32 v14, 2, v14
    v_add_u32 v14, v14, v12
    v_mul_u32_u24 v14, 4608, v14
    v_and_b32 v15, 7, v0
    v_lshl_add_u32 v7, v15, 4, v14
    v_lshlrev_b32 v10, 4, v15
    v_lshl_add_u32 v10, v13, 7, v10
    v_bfe_u32 v14, v0, 3, 1
    v_mul_u32_u24 v14, 147456, v14
    v_add_u32 v10, v10, v14
    v_lshrrev_b32 v14, 2, v0
    v_mul_u32_u24 v14, 1056, v14
    v_and_b32 v15, 3, v0
    v_lshl_add_u32 v14, v15, 3, v14
    v_add_u32 v2, 107008, v14
    v_and_b32 v14, 15, v0
    v_mul_u32_u24 v14, 1056, v14
    v_lshrrev_b32 v15, 4, v0
    v_lshl_add_u32 v14, v15, 4, v14
    v_add_u32 v1, 90112, v14
    v_and_b32 v14, 1, v0
    v_cmp_eq_u32 vcc, 0, v14
    v_mov_b32 v11, 0xeeeeeeee
    v_mov_b32 v15, 0x44444444
    v_cndmask_b32 v11, v11, v15, vcc
    v_and_b32 v14, 2, v0
    v_cmp_eq_u32 vcc, 0, v14
    v_mov_b32 v15, 0x3f803f80
    s_nop 0
    v_cndmask_b32 v15, 0, v15, vcc
    v_accvgpr_write_b32 a16, v15
    v_accvgpr_write_b32 a56, -1
    v_accvgpr_write_b32 a17, v15
    v_accvgpr_write_b32 a57, -1
    v_accvgpr_write_b32 a18, v15
    v_accvgpr_write_b32 a58, -1
    v_accvgpr_write_b32 a19, v15
    v_accvgpr_write_b32 a59, -1
    v_accvgpr_write_b32 a0, 0
    v_accvgpr_write_b32 a1, 0
    v_accvgpr_write_b32 a2, 0
    v_accvgpr_write_b32 a3, 0
    v_accvgpr_write_b32 a4, 0
    v_accvgpr_write_b32 a5, 0
    v_accvgpr_write_b32 a6, 0
    v_accvgpr_write_b32 a7, 0
    v_accvgpr_write_b32 a8, 0
    v_accvgpr_write_b32 a9, 0
    v_accvgpr_write_b32 a10, 0
    v_accvgpr_write_b32 a11, 0
    v_accvgpr_write_b32 a12, 0
    v_accvgpr_write_b32 a13, 0
    v_accvgpr_write_b32 a14, 0
    v_accvgpr_write_b32 a15, 0
    s_cmp_ge_u32 s2, 8
    s_cbranch_scc1 L2_noclr2
    s_mul_i32 s14, s2, 32
    s_mov_b64 exec, 1
    s_waitcnt vmcnt(6)
    s_barrier
    buffer_store_dword v60, v156, s[60:63], s14 offen sc1
    s_mov_b64 exec, -1
L2_noclr2:
    s_waitcnt vmcnt(6)
    v_lshlrev_b32 v24, 16, v64
    v_and_b32 v25, 0xffff0000, v64
    v_lshlrev_b32 v26, 16, v65
    v_and_b32 v27, 0xffff0000, v65
    v_lshlrev_b32 v28, 16, v66
    v_and_b32 v29, 0xffff0000, v66
    v_lshlrev_b32 v30, 16, v67
    v_and_b32 v31, 0xffff0000, v67
    v_lshlrev_b32 v32, 16, v68
    v_and_b32 v33, 0xffff0000, v68
    v_lshlrev_b32 v34, 16, v69
    v_and_b32 v35, 0xffff0000, v69
    v_lshlrev_b32 v36, 16, v70
    v_and_b32 v37, 0xffff0000, v70
    v_lshlrev_b32 v38, 16, v71
    v_and_b32 v39, 0xffff0000, v71
    v_lshlrev_b32 v40, 16, v72
    v_and_b32 v41, 0xffff0000, v72
    v_lshlrev_b32 v42, 16, v73
    v_and_b32 v43, 0xffff0000, v73
    v_lshlrev_b32 v44, 16, v74
    v_and_b32 v45, 0xffff0000, v74
    v_lshlrev_b32 v46, 16, v75
    v_and_b32 v47, 0xffff0000, v75
    v_pk_add_f32 v[12:13], v[24:25], v[26:27]
    v_pk_add_f32 v[12:13], v[12:13], v[28:29]
    v_pk_add_f32 v[12:13], v[12:13], v[30:31]
    v_pk_add_f32 v[12:13], v[12:13], v[32:33]
    v_pk_add_f32 v[12:13], v[12:13], v[34:35]
    v_pk_add_f32 v[12:13], v[12:13], v[36:37]
    v_pk_add_f32 v[12:13], v[12:13], v[38:39]
    v_pk_add_f32 v[14:15], v[40:41], v[42:43]
    v_pk_add_f32 v[14:15], v[14:15], v[44:45]
    v_pk_add_f32 v[14:15], v[14:15], v[46:47]
    v_add_f32 v48, v12, v13
    v_add_f32 v14, v14, v15
    v_fmac_f32 v48, 0x3e800000, v14
    s_nop 1
    v_add_f32_dpp v48, v48, v48 row_ror:8 row_mask:0xf bank_mask:0xf
    v_mov_b32 v50, v48
    s_nop 1
    v_permlane16_swap_b32 v50, v48
    v_add_f32 v48, v48, v50
    v_mov_b32 v50, v48
    s_nop 1
    v_permlane32_swap_b32 v50, v48
    v_add_f32 v48, v48, v50
    v_mul_f32 v48, 0x3be38e39, v48
    v_pk_add_f32 v[24:25], v[24:25], v[48:49] op_sel_hi:[1,0] neg_lo:[0,1] neg_hi:[0,1]
    v_pk_add_f32 v[26:27], v[26:27], v[48:49] op_sel_hi:[1,0] neg_lo:[0,1] neg_hi:[0,1]
    v_pk_add_f32 v[28:29], v[28:29], v[48:49] op_sel_hi:[1,0] neg_lo:[0,1] neg_hi:[0,1]
    v_pk_add_f32 v[30:31], v[30:31], v[48:49] op_sel_hi:[1,0] neg_lo:[0,1] neg_hi:[0,1]
    v_pk_add_f32 v[32:33], v[32:33], v[48:49] op_sel_hi:[1,0] neg_lo:[0,1] neg_hi:[0,1]
    v_pk_add_f32 v[34:35], v[34:35], v[48:49] op_sel_hi:[1,0] neg_lo:[0,1] neg_hi:[0,1]
    v_pk_add_f32 v[36:37], v[36:37], v[48:49] op_sel_hi:[1,0] neg_lo:[0,1] neg_hi:[0,1]
    v_pk_add_f32 v[38:39], v[38:39], v[48:49] op_sel_hi:[1,0] neg_lo:[0,1] neg_hi:[0,1]
    v_pk_add_f32 v[40:41], v[40:41], v[48:49] op_sel_hi:[1,0] neg_lo:[0,1] neg_hi:[0,1]
    v_pk_add_f32 v[42:43], v[42:43], v[48:49] op_sel_hi:[1,0] neg_lo:[0,1] neg_hi:[0,1]
    v_pk_add_f32 v[44:45], v[44:45], v[48:49] op_sel_hi:[1,0] neg_lo:[0,1] neg_hi:[0,1]
    v_pk_add_f32 v[46:47], v[46:47], v[48:49] op_sel_hi:[1,0] neg_lo:[0,1] neg_hi:[0,1]
    v_pk_mul_f32 v[12:13], v[24:25], v[24:25]
    v_pk_fma_f32 v[12:13], v[26:27], v[26:27], v[12:13]
    v_pk_fma_f32 v[12:13], v[28:29], v[28:29], v[12:13]
    v_pk_fma_f32 v[12:13], v[30:31], v[30:31], v[12:13]
    v_pk_fma_f32 v[12:13], v[32:33], v[32:33], v[12:13]
    v_pk_fma_f32 v[12:13], v[34:35], v[34:35], v[12:13]
    v_pk_fma_f32 v[12:13], v[36:37], v[36:37], v[12:13]
    v_pk_fma_f32 v[12:13], v[38:39], v[38:39], v[12:13]
    v_pk_mul_f32 v[14:15], v[40:41], v[40:41]
    v_pk_fma_f32 v[14:15], v[42:43], v[42:43], v[14:15]
    v_pk_fma_f32 v[14:15], v[44:45], v[44:45], v[14:15]
    v_pk_fma_f32 v[14:15], v[46:47], v[46:47], v[14:15]
    v_add_f32 v49, v12, v13
    v_add_f32 v14, v14, v15
    v_fmac_f32 v49, 0x3e800000, v14
    s_nop 1
    v_add_f32_dpp v49, v49, v49 row_ror:8 row_mask:0xf bank_mask:0xf
    v_mov_b32 v50, v49
    s_nop 1
    v_permlane16_swap_b32 v50, v49
    v_add_f32 v49, v49, v50
    v_mov_b32 v50, v49
    s_nop 1
    v_permlane32_swap_b32 v50, v49
    v_add_f32 v49, v49, v50
    ds_write_b32 v158, v48
    ds_write_b32 v158, v49 offset:128
    s_waitcnt lgkmcnt(0)
    s_barrier
    ds_read_b128 v[16:19], v157
    ds_read_b128 v[20:23], v157 offset:128
    s_add_u32 s14, s58, 4096
    s_waitcnt lgkmcnt(1)
    v_add_f32 v12, v16, v17
    v_add_f32 v13, v18, v19
    v_add_f32 v12, v12, v13
    v_mul_f32 v12, 0x3e800000, v12
    v_sub_f32 v16, v16, v12
    v_sub_f32 v17, v17, v12
    v_sub_f32 v18, v18, v12
    v_sub_f32 v19, v19, v12
    v_sub_f32 v48, v48, v12
    v_mul_f32 v13, v16, v16
    v_fmac_f32 v13, v17, v17
    v_fmac_f32 v13, v18, v18
    v_fmac_f32 v13, v19, v19
    s_waitcnt lgkmcnt(0)
    v_add_f32 v14, v20, v21
    v_add_f32 v15, v22, v23
    v_add_f32 v14, v14, v15
    v_fmac_f32 v14, 0x43100000, v13
    v_mov_b32 v12, 0x3727c5ac
    v_fmac_f32 v12, 0x3ae38e39, v14
    v_rsq_f32 v12, v12
    s_nop 0
    v_mul_f32 v48, v48, v12
    v_pk_fma_f32 v[24:25], v[24:25], v[12:13], v[48:49] op_sel_hi:[1,0,0]
    v_pk_fma_f32 v[26:27], v[26:27], v[12:13], v[48:49] op_sel_hi:[1,0,0]
    v_pk_fma_f32 v[28:29], v[28:29], v[12:13], v[48:49] op_sel_hi:[1,0,0]
    v_pk_fma_f32 v[30:31], v[30:31], v[12:13], v[48:49] op_sel_hi:[1,0,0]
    v_cvt_pk_f16_f32 v64, v24, v25
    v_cvt_pk_f16_f32 v65, v26, v27
    v_cvt_pk_f16_f32 v66, v28, v29
    v_cvt_pk_f16_f32 v67, v30, v31
    buffer_store_dwordx4 v[64:67], v159, s[84:87], s58 offen offset:0 sc1
    v_pk_fma_f32 v[32:33], v[32:33], v[12:13], v[48:49] op_sel_hi:[1,0,0]
    v_pk_fma_f32 v[34:35], v[34:35], v[12:13], v[48:49] op_sel_hi:[1,0,0]
    v_pk_fma_f32 v[36:37], v[36:37], v[12:13], v[48:49] op_sel_hi:[1,0,0]
    v_pk_fma_f32 v[38:39], v[38:39], v[12:13], v[48:49] op_sel_hi:[1,0,0]
    v_cvt_pk_f16_f32 v68, v32, v33
    v_cvt_pk_f16_f32 v69, v34, v35
    v_cvt_pk_f16_f32 v70, v36, v37
    v_cvt_pk_f16_f32 v71, v38, v39
    buffer_store_dwordx4 v[68:71], v159, s[84:87], s58 offen offset:2048 sc1
    v_pk_fma_f32 v[40:41], v[40:41], v[12:13], v[48:49] op_sel_hi:[1,0,0]
    v_pk_fma_f32 v[42:43], v[42:43], v[12:13], v[48:49] op_sel_hi:[1,0,0]
    v_pk_fma_f32 v[44:45], v[44:45], v[12:13], v[48:49] op_sel_hi:[1,0,0]
    v_pk_fma_f32 v[46:47], v[46:47], v[12:13], v[48:49] op_sel_hi:[1,0,0]
    v_cvt_pk_f16_f32 v72, v40, v41
    v_cvt_pk_f16_f32 v73, v42, v43
    v_cvt_pk_f16_f32 v74, v44, v45
    v_cvt_pk_f16_f32 v75, v46, v47
    s_mov_b64 exec, 0xffff
    buffer_store_dwordx4 v[72:75], v159, s[84:87], s14 offen offset:0 sc1
    buffer_store_dwordx4 v[56:59], v8, s[84:87], s56 offen sc1
    s_mov_b64 exec, 0xff
    buffer_store_dwordx4 v[60:63], v160, s[84:87], s57 offen offset:1024 sc1
    s_mov_b64 exec, -1
    buffer_store_dwordx4 v[60:63], v160, s[84:87], s57 offen sc1
    s_mov_b64 exec, 255
    buffer_load_dword v51, v156, s[60:63], 0 offen sc1
    s_mov_b64 exec, -1
    s_mul_i32 s3, s96, 147456
    s_add_u32 s3, s3, 8392704
    s_add_u32 s88, s12, s3
    s_addc_u32 s89, s13, 0
    s_mov_b32 s90, 143360
    s_mov_b32 s91, 0x20000
    s_waitcnt vmcnt(7)
    v_lshlrev_b32 v40, 16, v148
    v_and_b32 v41, 0xffff0000, v148
    v_lshlrev_b32 v42, 16, v149
    v_and_b32 v43, 0xffff0000, v149
    v_lshlrev_b32 v44, 16, v150
    v_mul_f32 v16, 0xbfb8aa3b, v40
    v_mul_f32 v17, 0xbfb8aa3b, v41
    v_mul_f32 v18, 0xbfb8aa3b, v42
    v_mul_f32 v19, 0xbfb8aa3b, v43
    v_mul_f32 v20, 0xbfb8aa3b, v44
    v_exp_f32 v16, v16
    v_exp_f32 v17, v17
    v_exp_f32 v18, v18
    v_exp_f32 v19, v19
    v_exp_f32 v20, v20
    v_add_f32 v16, 1.0, v16
    v_add_f32 v17, 1.0, v17
    v_add_f32 v18, 1.0, v18
    v_add_f32 v19, 1.0, v19
    v_add_f32 v20, 1.0, v20
    v_rcp_f32 v16, v16
    v_rcp_f32 v17, v17
    v_rcp_f32 v18, v18
    v_rcp_f32 v19, v19
    v_rcp_f32 v20, v20
    v_mul_f32 v24, v40, v16
    v_mul_f32 v26, v41, v17
    v_mul_f32 v28, v42, v18
    v_mul_f32 v30, v43, v19
    v_mul_f32 v32, v44, v20
    v_lshlrev_b32 v12, 16, v128
    v_and_b32 v13, 0xffff0000, v128
    v_pk_mul_f32 v[16:17], v[12:13], v[24:25] op_sel_hi:[1,0]
    v_lshlrev_b32 v14, 16, v129
    v_and_b32 v15, 0xffff0000, v129
    v_pk_mul_f32 v[18:19], v[14:15], v[24:25] op_sel_hi:[1,0]
    v_lshlrev_b32 v12, 16, v130
    v_and_b32 v13, 0xffff0000, v130
    v_pk_mul_f32 v[20:21], v[12:13], v[24:25] op_sel_hi:[1,0]
    v_lshlrev_b32 v14, 16, v131
    v_and_b32 v15, 0xffff0000, v131
    v_pk_mul_f32 v[22:23], v[14:15], v[24:25] op_sel_hi:[1,0]
    v_lshlrev_b32 v12, 16, v132
    v_and_b32 v13, 0xffff0000, v132
    v_pk_fma_f32 v[16:17], v[12:13], v[26:27], v[16:17] op_sel_hi:[1,0,1]
    v_lshlrev_b32 v14, 16, v133
    v_and_b32 v15, 0xffff0000, v133
    v_pk_fma_f32 v[18:19], v[14:15], v[26:27], v[18:19] op_sel_hi:[1,0,1]
    v_lshlrev_b32 v12, 16, v134
    v_and_b32 v13, 0xffff0000, v134
    v_pk_fma_f32 v[20:21], v[12:13], v[26:27], v[20:21] op_sel_hi:[1,0,1]
    v_lshlrev_b32 v14, 16, v135
    v_and_b32 v15, 0xffff0000, v135
    v_pk_fma_f32 v[22:23], v[14:15], v[26:27], v[22:23] op_sel_hi:[1,0,1]
    v_lshlrev_b32 v12, 16, v136
    v_and_b32 v13, 0xffff0000, v136
    v_pk_fma_f32 v[16:17], v[12:13], v[28:29], v[16:17] op_sel_hi:[1,0,1]
    v_lshlrev_b32 v14, 16, v137
    v_and_b32 v15, 0xffff0000, v137
    v_pk_fma_f32 v[18:19], v[14:15], v[28:29], v[18:19] op_sel_hi:[1,0,1]
    v_lshlrev_b32 v12, 16, v138
    v_and_b32 v13, 0xffff0000, v138
    v_pk_fma_f32 v[20:21], v[12:13], v[28:29], v[20:21] op_sel_hi:[1,0,1]
    v_lshlrev_b32 v14, 16, v139
    v_and_b32 v15, 0xffff0000, v139
    v_pk_fma_f32 v[22:23], v[14:15], v[28:29], v[22:23] op_sel_hi:[1,0,1]
    v_lshlrev_b32 v12, 16, v140
    v_and_b32 v13, 0xffff0000, v140
    v_pk_fma_f32 v[16:17], v[12:13], v[30:31], v[16:17] op_sel_hi:[1,0,1]
    v_lshlrev_b32 v14, 16, v141
    v_and_b32 v15, 0xffff0000, v141
    v_pk_fma_f32 v[18:19], v[14:15], v[30:31], v[18:19] op_sel_hi:[1,0,1]
    v_lshlrev_b32 v12, 16, v142
    v_and_b32 v13, 0xffff0000, v142
    v_pk_fma_f32 v[20:21], v[12:13], v[30:31], v[20:21] op_sel_hi:[1,0,1]
    v_lshlrev_b32 v14, 16, v143
    v_and_b32 v15, 0xffff0000, v143
    v_pk_fma_f32 v[22:23], v[14:15], v[30:31], v[22:23] op_sel_hi:[1,0,1]
    v_lshlrev_b32 v12, 16, v144
    v_and_b32 v13, 0xffff0000, v144
    v_pk_fma_f32 v[16:17], v[12:13], v[32:33], v[16:17] op_sel_hi:[1,0,1]
    v_lshlrev_b32 v14, 16, v145
    v_and_b32 v15, 0xffff0000, v145
    v_pk_fma_f32 v[18:19], v[14:15], v[32:33], v[18:19] op_sel_hi:[1,0,1]
    v_lshlrev_b32 v12, 16, v146
    v_and_b32 v13, 0xffff0000, v146
    v_pk_fma_f32 v[20:21], v[12:13], v[32:33], v[20:21] op_sel_hi:[1,0,1]
    v_lshlrev_b32 v14, 16, v147
    v_and_b32 v15, 0xffff0000, v147
    v_pk_fma_f32 v[22:23], v[14:15], v[32:33], v[22:23] op_sel_hi:[1,0,1]
    v_add_f32_dpp v16, v16, v16 row_ror:4 row_mask:0xf bank_mask:0xf
    v_add_f32_dpp v17, v17, v17 row_ror:4 row_mask:0xf bank_mask:0xf
    v_add_f32_dpp v18, v18, v18 row_ror:4 row_mask:0xf bank_mask:0xf
    v_add_f32_dpp v19, v19, v19 row_ror:4 row_mask:0xf bank_mask:0xf
    v_add_f32_dpp v20, v20, v20 row_ror:4 row_mask:0xf bank_mask:0xf
    v_add_f32_dpp v21, v21, v21 row_ror:4 row_mask:0xf bank_mask:0xf
    v_add_f32_dpp v22, v22, v22 row_ror:4 row_mask:0xf bank_mask:0xf
    v_add_f32_dpp v23, v23, v23 row_ror:4 row_mask:0xf bank_mask:0xf
    v_add_f32_dpp v16, v16, v16 row_ror:8 row_mask:0xf bank_mask:0xf
    v_add_f32_dpp v17, v17, v17 row_ror:8 row_mask:0xf bank_mask:0xf
    v_add_f32_dpp v18, v18, v18 row_ror:8 row_mask:0xf bank_mask:0xf
    v_add_f32_dpp v19, v19, v19 row_ror:8 row_mask:0xf bank_mask:0xf
    v_add_f32_dpp v20, v20, v20 row_ror:8 row_mask:0xf bank_mask:0xf
    v_add_f32_dpp v21, v21, v21 row_ror:8 row_mask:0xf bank_mask:0xf
    v_add_f32_dpp v22, v22, v22 row_ror:8 row_mask:0xf bank_mask:0xf
    v_add_f32_dpp v23, v23, v23 row_ror:8 row_mask:0xf bank_mask:0xf
    s_mov_b32 exec_lo, 0xf000f
    s_mov_b32 exec_hi, 0xf000f
    ds_write_b128 v161, v[16:19] offset:16384
    ds_write_b128 v161, v[20:23] offset:16400
    s_mov_b64 exec, 255
    s_waitcnt vmcnt(0)
    v_cmp_eq_u32 vcc, s51, v51
    s_nop 0
    s_cmp_lg_u64 vcc, 0
    s_cbranch_scc1 L2_p0s
L2_p0r:
    s_mov_b64 exec, 1
    s_waitcnt lgkmcnt(0)
    s_barrier
    buffer_store_dword v60, v156, s[84:87], s101 offen sc1
    s_mov_b64 exec, -1
    ds_read_b32 v24, v162 offset:16384
    ds_read_b32 v25, v162 offset:16640
    ds_read_b32 v26, v162 offset:16896
    ds_read_b32 v27, v162 offset:17152
    ds_read_b32 v28, v162 offset:17408
    ds_read_b32 v29, v162 offset:17664
    ds_read_b32 v30, v162 offset:17920
    ds_read_b32 v31, v162 offset:18176
    s_waitcnt lgkmcnt(0)
    v_pk_add_f32 v[24:25], v[24:25], v[26:27]
    v_pk_add_f32 v[28:29], v[28:29], v[30:31]
    v_pk_add_f32 v[24:25], v[24:25], v[28:29]
    v_add_f32 v52, v24, v25
    v_mov_b32 v53, v52
    v_mov_b32 v54, s48
    s_nop 0
    v_permlane32_swap_b32 v53, v52
    v_add_f32 v52, v52, v53
    v_fma_f32 v52, v52, s47, v54
    v_min_u32 v52, -2, v52
    s_mov_b32 exec_hi, 0
    buffer_store_dword v52, v164, s[84:87], s100 offen sc1
    s_mov_b64 exec, -1
    s_add_u32 m0, s44, 36864
    s_mov_b32 s45, 0
    buffer_load_dwordx4 v6, s[24:27], s45 offen lds
    s_add_u32 m0, s44, 37920
    s_mov_b32 s45, 8192
    buffer_load_dwordx4 v6, s[24:27], s45 offen lds
    s_add_u32 m0, s44, 38976
    s_mov_b32 s45, 16384
    buffer_load_dwordx4 v6, s[24:27], s45 offen lds
    s_add_u32 m0, s44, 40032
    s_mov_b32 s45, 24576
    buffer_load_dwordx4 v6, s[24:27], s45 offen lds
    s_add_u32 m0, s44, 53760
    s_mov_b32 s45, 262144
    buffer_load_dwordx4 v6, s[24:27], s45 offen lds
    s_add_u32 m0, s44, 54816
    s_mov_b32 s45, 270336
    buffer_load_dwordx4 v6, s[24:27], s45 offen lds
    s_add_u32 m0, s44, 55872
    s_mov_b32 s45, 278528
    buffer_load_dwordx4 v6, s[24:27], s45 offen lds
    s_add_u32 m0, s44, 56928
    s_mov_b32 s45, 286720
    buffer_load_dwordx4 v6, s[24:27], s45 offen lds
    s_add_u32 m0, s44, 73728
    s_mov_b32 s45, 524288
    buffer_load_dwordx4 v6, s[24:27], s45 offen lds
    s_add_u32 m0, s44, 74784
    s_mov_b32 s45, 532480
    buffer_load_dwordx4 v6, s[24:27], s45 offen lds
    s_add_u32 m0, s44, 75840
    s_mov_b32 s45, 540672
    buffer_load_dwordx4 v6, s[24:27], s45 offen lds
    s_add_u32 m0, s44, 76896
    s_mov_b32 s45, 548864
    buffer_load_dwordx4 v6, s[24:27], s45 offen lds
    s_add_u32 m0, s44, 90624
    s_mov_b32 s45, 786432
    buffer_load_dwordx4 v6, s[24:27], s45 offen lds
    s_add_u32 m0, s44, 91680
    s_mov_b32 s45, 794624
    buffer_load_dwordx4 v6, s[24:27], s45 offen lds
    s_add_u32 m0, s44, 92736
    s_mov_b32 s45, 802816
    buffer_load_dwordx4 v6, s[24:27], s45 offen lds
    s_add_u32 m0, s44, 93792
    s_mov_b32 s45, 811008
    buffer_load_dwordx4 v6, s[24:27], s45 offen lds
    s_mov_b64 exec, 0
    s_cmp_eq_u32 s51, 0
    s_cbranch_scc1 L2_pad0
    s_cmp_eq_u32 s51, 1
    s_cbranch_scc1 L2_pad1
    s_cmp_eq_u32 s51, 2
    s_cbranch_scc1 L2_pad2
    s_branch L2_pad3
.p2align 12
L2_walkret:
    s_mov_b64 exec, 15
    s_mov_b32 s97, 0x20000
L2_px:
    buffer_load_dword v13, v163, s[84:87], s59 offen sc1
    s_waitcnt vmcnt(0)
    v_cmp_eq_u32 vcc, 0, v13
    s_sub_u32 s97, s97, 1
    s_cselect_b64 vcc, 0, vcc
    s_cmp_eq_u64 vcc, 0
    s_cbranch_scc1 L2_px_ok
    s_sleep 1
    s_branch L2_px
L2_px_ok:
    s_mov_b64 exec, -1
    s_movk_i32 s14, 13824
    buffer_load_dwordx4 v[168:171], v166, s[84:87], 0 offen sc1
    buffer_load_dwordx4 v[176:179], v166, s[84:87], s14 offen sc1
    s_mov_b64 exec, 0xff
    buffer_load_dwordx4 v[172:175], v166, s[84:87], 0 offen offset:1024 sc1
    buffer_load_dwordx4 v[180:183], v166, s[84:87], s14 offen offset:1024 sc1
    s_mov_b64 exec, -1
    s_mov_b32 s54, 0
    buffer_load_dwordx4 v[80:83], v8, s[32:35], s54 offen sc1
    s_mov_b32 s54, 1024
    buffer_load_dwordx4 v[84:87], v8, s[32:35], s54 offen sc1
    s_mov_b32 s54, 18432
    buffer_load_dwordx4 v[88:91], v8, s[32:35], s54 offen sc1
    s_mov_b32 s54, 19456
    buffer_load_dwordx4 v[92:95], v8, s[32:35], s54 offen sc1
    s_mov_b32 s54, 2048
    buffer_load_dwordx4 v[96:99], v8, s[32:35], s54 offen sc1
    s_mov_b32 s54, 3072
    buffer_load_dwordx4 v[100:103], v8, s[32:35], s54 offen sc1
    s_mov_b32 s54, 20480
    buffer_load_dwordx4 v[104:107], v8, s[32:35], s54 offen sc1
    s_mov_b32 s54, 21504
    buffer_load_dwordx4 v[108:111], v8, s[32:35], s54 offen sc1
    s_waitcnt vmcnt(8)
    v_max_u32 v13, v168, v169
    v_max3_u32 v13, v13, v170, v171
    v_max3_u32 v13, v13, v172, v173
    v_max3_u32 v13, v13, v174, v175
    v_max3_u32 v13, v13, v176, v177
    v_max3_u32 v13, v13, v178, v179
    v_max3_u32 v13, v13, v180, v181
    v_max3_u32 v13, v13, v182, v183
    v_cmp_eq_u32 vcc, -1, v13
    s_nop 0
    s_cmp_lg_u64 vcc, 0
    s_cbranch_scc1 L2_pms
L2_pmr:
    v_pk_add_f32 v[168:169], v[168:169], v[176:177]
    v_pk_add_f32 v[170:171], v[170:171], v[178:179]
    v_pk_add_f32 v[172:173], v[172:173], v[180:181]
    v_pk_add_f32 v[174:175], v[174:175], v[182:183]
    ds_write_b128 v167, v[168:171]
    s_mov_b64 exec, 0xff
    ds_write_b128 v167, v[172:175] offset:2048
    s_mov_b64 exec, -1
    s_mov_b32 s54, 4096
    buffer_load_dwordx4 v[112:115], v8, s[32:35], s54 offen sc1
    s_mov_b32 s54, 5120
    buffer_load_dwordx4 v[116:119], v8, s[32:35], s54 offen sc1
    s_mov_b32 s54, 22528
    buffer_load_dwordx4 v[120:123], v8, s[32:35], s54 offen sc1
    s_mov_b32 s54, 23552
    buffer_load_dwordx4 v[124:127], v8, s[32:35], s54 offen sc1
    s_waitcnt lgkmcnt(0)
    s_barrier
    ds_read_b128 v[16:19], v9 offset:9216
    ds_read_b128 v[20:23], v9 offset:9248
    ds_read_b128 v[24:27], v9 offset:9232
    ds_read_b128 v[28:31], v9 offset:9264
    s_waitcnt vmcnt(8)
    s_waitcnt lgkmcnt(2)
    v_fma_mix_f32 v32, v80, v16, v20 op_sel:[0,0,0] op_sel_hi:[1,0,0]
    v_fma_mix_f32 v33, v80, v17, v21 op_sel:[1,0,0] op_sel_hi:[1,0,0]
    v_fma_mix_f32 v34, v81, v18, v22 op_sel:[0,0,0] op_sel_hi:[1,0,0]
    v_fma_mix_f32 v35, v81, v19, v23 op_sel:[1,0,0] op_sel_hi:[1,0,0]
    v_cvt_pk_bf16_f32 v80, v32, v33
    v_cvt_pk_bf16_f32 v81, v34, v35
    v_fma_mix_f32 v36, v88, v16, v20 op_sel:[0,0,0] op_sel_hi:[1,0,0]
    v_fma_mix_f32 v37, v88, v17, v21 op_sel:[1,0,0] op_sel_hi:[1,0,0]
    v_fma_mix_f32 v38, v89, v18, v22 op_sel:[0,0,0] op_sel_hi:[1,0,0]
    v_fma_mix_f32 v39, v89, v19, v23 op_sel:[1,0,0] op_sel_hi:[1,0,0]
    v_cvt_pk_bf16_f32 v88, v36, v37
    v_cvt_pk_bf16_f32 v89, v38, v39
    ds_read_b128 v[16:19], v9 offset:9472
    ds_read_b128 v[20:23], v9 offset:9504
    s_waitcnt lgkmcnt(2)
    v_fma_mix_f32 v32, v82, v24, v28 op_sel:[0,0,0] op_sel_hi:[1,0,0]
    v_fma_mix_f32 v33, v82, v25, v29 op_sel:[1,0,0] op_sel_hi:[1,0,0]
    v_fma_mix_f32 v34, v83, v26, v30 op_sel:[0,0,0] op_sel_hi:[1,0,0]
    v_fma_mix_f32 v35, v83, v27, v31 op_sel:[1,0,0] op_sel_hi:[1,0,0]
    v_cvt_pk_bf16_f32 v82, v32, v33
    v_cvt_pk_bf16_f32 v83, v34, v35
    v_fma_mix_f32 v36, v90, v24, v28 op_sel:[0,0,0] op_sel_hi:[1,0,0]
    v_fma_mix_f32 v37, v90, v25, v29 op_sel:[1,0,0] op_sel_hi:[1,0,0]
    v_fma_mix_f32 v38, v91, v26, v30 op_sel:[0,0,0] op_sel_hi:[1,0,0]
    v_fma_mix_f32 v39, v91, v27, v31 op_sel:[1,0,0] op_sel_hi:[1,0,0]
    v_cvt_pk_bf16_f32 v90, v36, v37
    v_cvt_pk_bf16_f32 v91, v38, v39
    ds_read_b128 v[24:27], v9 offset:9488
    ds_read_b128 v[28:31], v9 offset:9520
    s_waitcnt lgkmcnt(2)
    v_fma_mix_f32 v32, v84, v16, v20 op_sel:[0,0,0] op_sel_hi:[1,0,0]
    v_fma_mix_f32 v33, v84, v17, v21 op_sel:[1,0,0] op_sel_hi:[1,0,0]
    v_fma_mix_f32 v34, v85, v18, v22 op_sel:[0,0,0] op_sel_hi:[1,0,0]
    v_fma_mix_f32 v35, v85, v19, v23 op_sel:[1,0,0] op_sel_hi:[1,0,0]
    v_cvt_pk_bf16_f32 v84, v32, v33
    v_cvt_pk_bf16_f32 v85, v34, v35
    v_fma_mix_f32 v36, v92, v16, v20 op_sel:[0,0,0] op_sel_hi:[1,0,0]
    v_fma_mix_f32 v37, v92, v17, v21 op_sel:[1,0,0] op_sel_hi:[1,0,0]
    v_fma_mix_f32 v38, v93, v18, v22 op_sel:[0,0,0] op_sel_hi:[1,0,0]
    v_fma_mix_f32 v39, v93, v19, v23 op_sel:[1,0,0] op_sel_hi:[1,0,0]
    v_cvt_pk_bf16_f32 v92, v36, v37
    v_cvt_pk_bf16_f32 v93, v38, v39
    ds_read_b128 v[16:19], v9 offset:9728
    ds_read_b128 v[20:23], v9 offset:9760
    ds_read_b64_tr_b16 a[192:193], v3 offset:36864
    ds_read_b64_tr_b16 a[194:195], v3 offset:37376
    ds_read_b64_tr_b16 a[196:197], v3 offset:53760
    ds_read_b64_tr_b16 a[198:199], v3 offset:54272
    ds_read_b64_tr_b16 a[200:201], v3 offset:36896
    ds_read_b64_tr_b16 a[202:203], v3 offset:37408
    ds_read_b64_tr_b16 a[204:205], v3 offset:53792
    ds_read_b64_tr_b16 a[206:207], v3 offset:54304
    ds_read_b64_tr_b16 a[208:209], v3 offset:36928
    ds_read_b64_tr_b16 a[210:211], v3 offset:37440
    ds_read_b64_tr_b16 a[212:213], v3 offset:53824
    ds_read_b64_tr_b16 a[214:215], v3 offset:54336
    s_waitcnt lgkmcnt(14)
    v_fma_mix_f32 v32, v86, v24, v28 op_sel:[0,0,0] op_sel_hi:[1,0,0]
    v_fma_mix_f32 v33, v86, v25, v29 op_sel:[1,0,0] op_sel_hi:[1,0,0]
    v_fma_mix_f32 v34, v87, v26, v30 op_sel:[0,0,0] op_sel_hi:[1,0,0]
    v_fma_mix_f32 v35, v87, v27, v31 op_sel:[1,0,0] op_sel_hi:[1,0,0]
    v_cvt_pk_bf16_f32 v86, v32, v33
    v_cvt_pk_bf16_f32 v87, v34, v35
    v_fma_mix_f32 v36, v94, v24, v28 op_sel:[0,0,0] op_sel_hi:[1,0,0]
    v_fma_mix_f32 v37, v94, v25, v29 op_sel:[1,0,0] op_sel_hi:[1,0,0]
    v_fma_mix_f32 v38, v95, v26, v30 op_sel:[0,0,0] op_sel_hi:[1,0,0]
    v_fma_mix_f32 v39, v95, v27, v31 op_sel:[1,0,0] op_sel_hi:[1,0,0]
    v_cvt_pk_bf16_f32 v94, v36, v37
    v_cvt_pk_bf16_f32 v95, v38, v39
    s_waitcnt lgkmcnt(8)
    v_mfma_f32_16x16x32_bf16 v[128:131], a[192:195], v[80:83], 0
    s_waitcnt vmcnt(4)
    ds_read_b64_tr_b16 a[216:217], v3 offset:36960
    ds_read_b128 v[24:27], v9 offset:9744
    v_mfma_f32_16x16x32_bf16 v[128:131], a[196:199], v[84:87], v[128:131]
    ds_read_b64_tr_b16 a[218:219], v3 offset:37472
    ds_read_b64_tr_b16 a[220:221], v3 offset:53856
    v_fma_mix_f32 v32, v96, v16, v20 op_sel:[0,0,0] op_sel_hi:[1,0,0]
    v_mfma_f32_16x16x32_bf16 v[160:163], a[192:195], v[88:91], 0
    s_add_u32 m0, s44, 110592
    ds_read_b64_tr_b16 a[222:223], v3 offset:54368
    ds_read_b128 v[28:31], v9 offset:9776
    v_mfma_f32_16x16x32_bf16 v[160:163], a[196:199], v[92:95], v[160:163]
    s_mov_b32 s45, 1048576
    s_waitcnt lgkmcnt(10)
    buffer_load_dwordx4 v6, s[24:27], s45 offen lds
    v_mfma_f32_16x16x32_bf16 v[132:135], a[200:203], v[80:83], 0
    ds_read_b64_tr_b16 a[224:225], v3 offset:36992
    v_fma_mix_f32 v33, v96, v17, v21 op_sel:[1,0,0] op_sel_hi:[1,0,0]
    v_mfma_f32_16x16x32_bf16 v[132:135], a[204:207], v[84:87], v[132:135]
    ds_read_b64_tr_b16 a[226:227], v3 offset:37504
    ds_read_b64_tr_b16 a[228:229], v3 offset:53888
    v_fma_mix_f32 v34, v97, v18, v22 op_sel:[0,0,0] op_sel_hi:[1,0,0]
    v_mfma_f32_16x16x32_bf16 v[164:167], a[200:203], v[88:91], 0
    s_add_u32 m0, s44, 111648
    ds_read_b64_tr_b16 a[230:231], v3 offset:54400
    v_fma_mix_f32 v35, v97, v19, v23 op_sel:[1,0,0] op_sel_hi:[1,0,0]
    v_mfma_f32_16x16x32_bf16 v[164:167], a[204:207], v[92:95], v[164:167]
    s_mov_b32 s45, 1056768
    s_waitcnt lgkmcnt(10)
    buffer_load_dwordx4 v6, s[24:27], s45 offen lds
    v_mfma_f32_16x16x32_bf16 v[136:139], a[208:211], v[80:83], 0
    ds_read_b64_tr_b16 a[232:233], v3 offset:37024
    v_cvt_pk_bf16_f32 v96, v32, v33
    v_mfma_f32_16x16x32_bf16 v[136:139], a[212:215], v[84:87], v[136:139]
    ds_read_b64_tr_b16 a[234:235], v3 offset:37536
    ds_read_b64_tr_b16 a[236:237], v3 offset:53920
    v_cvt_pk_bf16_f32 v97, v34, v35
    v_mfma_f32_16x16x32_bf16 v[168:171], a[208:211], v[88:91], 0
    s_add_u32 m0, s44, 112704
    ds_read_b64_tr_b16 a[238:239], v3 offset:54432
    v_fma_mix_f32 v36, v104, v16, v20 op_sel:[0,0,0] op_sel_hi:[1,0,0]
    v_mfma_f32_16x16x32_bf16 v[168:171], a[212:215], v[92:95], v[168:171]
    s_mov_b32 s45, 1064960
    s_waitcnt lgkmcnt(9)
    buffer_load_dwordx4 v6, s[24:27], s45 offen lds
    v_fma_mix_f32 v37, v104, v17, v21 op_sel:[1,0,0] op_sel_hi:[1,0,0]
    v_mfma_f32_16x16x32_bf16 v[140:143], a[216:219], v[80:83], 0
    ds_read_b64_tr_b16 a[240:241], v3 offset:37056
    v_fma_mix_f32 v38, v105, v18, v22 op_sel:[0,0,0] op_sel_hi:[1,0,0]
    v_mfma_f32_16x16x32_bf16 v[140:143], a[220:223], v[84:87], v[140:143]
    ds_read_b64_tr_b16 a[242:243], v3 offset:37568
    ds_read_b64_tr_b16 a[244:245], v3 offset:53952
    v_fma_mix_f32 v39, v105, v19, v23 op_sel:[1,0,0] op_sel_hi:[1,0,0]
    v_mfma_f32_16x16x32_bf16 v[172:175], a[216:219], v[88:91], 0
    s_add_u32 m0, s44, 113760
    ds_read_b64_tr_b16 a[246:247], v3 offset:54464
    v_cvt_pk_bf16_f32 v104, v36, v37
    v_mfma_f32_16x16x32_bf16 v[172:175], a[220:223], v[92:95], v[172:175]
    s_mov_b32 s45, 1073152
    s_waitcnt lgkmcnt(8)
    buffer_load_dwordx4 v6, s[24:27], s45 offen lds
    v_cvt_pk_bf16_f32 v105, v38, v39
    v_mfma_f32_16x16x32_bf16 v[144:147], a[224:227], v[80:83], 0
    ds_read_b64_tr_b16 a[248:249], v3 offset:37088
    ds_read_b128 v[16:19], v9 offset:9984
    v_mfma_f32_16x16x32_bf16 v[144:147], a[228:231], v[84:87], v[144:147]
    ds_read_b64_tr_b16 a[250:251], v3 offset:37600
    ds_read_b64_tr_b16 a[252:253], v3 offset:53984
    v_fma_mix_f32 v32, v98, v24, v28 op_sel:[0,0,0] op_sel_hi:[1,0,0]
    v_mfma_f32_16x16x32_bf16 v[176:179], a[224:227], v[88:91], 0
    s_add_u32 m0, s44, 127488
    ds_read_b64_tr_b16 a[254:255], v3 offset:54496
    ds_read_b128 v[20:23], v9 offset:10016
    v_mfma_f32_16x16x32_bf16 v[176:179], a[228:231], v[92:95], v[176:179]
    s_mov_b32 s45, 1310720
    s_waitcnt lgkmcnt(10)
    buffer_load_dwordx4 v6, s[24:27], s45 offen lds
    v_mfma_f32_16x16x32_bf16 v[148:151], a[232:235], v[80:83], 0
    ds_read_b64_tr_b16 a[192:193], v3 offset:37120
    v_fma_mix_f32 v33, v98, v25, v29 op_sel:[1,0,0] op_sel_hi:[1,0,0]
    v_mfma_f32_16x16x32_bf16 v[148:151], a[236:239], v[84:87], v[148:151]
    ds_read_b64_tr_b16 a[194:195], v3 offset:37632
    ds_read_b64_tr_b16 a[196:197], v3 offset:54016
    v_fma_mix_f32 v34, v99, v26, v30 op_sel:[0,0,0] op_sel_hi:[1,0,0]
    v_mfma_f32_16x16x32_bf16 v[180:183], a[232:235], v[88:91], 0
    s_add_u32 m0, s44, 128544
    ds_read_b64_tr_b16 a[198:199], v3 offset:54528
    v_fma_mix_f32 v35, v99, v27, v31 op_sel:[1,0,0] op_sel_hi:[1,0,0]
    v_mfma_f32_16x16x32_bf16 v[180:183], a[236:239], v[92:95], v[180:183]
    s_mov_b32 s45, 1318912
    s_waitcnt lgkmcnt(10)
    buffer_load_dwordx4 v6, s[24:27], s45 offen lds
    v_mfma_f32_16x16x32_bf16 v[152:155], a[240:243], v[80:83], 0
    ds_read_b64_tr_b16 a[200:201], v3 offset:37152
    v_cvt_pk_bf16_f32 v98, v32, v33
    v_mfma_f32_16x16x32_bf16 v[152:155], a[244:247], v[84:87], v[152:155]
    ds_read_b64_tr_b16 a[202:203], v3 offset:37664
    ds_read_b64_tr_b16 a[204:205], v3 offset:54048
    v_cvt_pk_bf16_f32 v99, v34, v35
    v_mfma_f32_16x16x32_bf16 v[184:187], a[240:243], v[88:91], 0
    s_add_u32 m0, s44, 129600
    ds_read_b64_tr_b16 a[206:207], v3 offset:54560
    v_fma_mix_f32 v36, v106, v24, v28 op_sel:[0,0,0] op_sel_hi:[1,0,0]
    v_mfma_f32_16x16x32_bf16 v[184:187], a[244:247], v[92:95], v[184:187]
    s_mov_b32 s45, 1327104
    s_waitcnt lgkmcnt(9)
    buffer_load_dwordx4 v6, s[24:27], s45 offen lds
    v_fma_mix_f32 v37, v106, v25, v29 op_sel:[1,0,0] op_sel_hi:[1,0,0]
    v_mfma_f32_16x16x32_bf16 v[156:159], a[248:251], v[80:83], 0
    ds_read_b64_tr_b16 a[208:209], v3 offset:37184
    v_fma_mix_f32 v38, v107, v26, v30 op_sel:[0,0,0] op_sel_hi:[1,0,0]
    v_mfma_f32_16x16x32_bf16 v[156:159], a[252:255], v[84:87], v[156:159]
    ds_read_b64_tr_b16 a[210:211], v3 offset:37696
    ds_read_b64_tr_b16 a[212:213], v3 offset:54080
    v_fma_mix_f32 v39, v107, v27, v31 op_sel:[1,0,0] op_sel_hi:[1,0,0]
    v_mfma_f32_16x16x32_bf16 v[188:191], a[248:251], v[88:91], 0
    s_add_u32 m0, s44, 130656
    ds_read_b64_tr_b16 a[214:215], v3 offset:54592
    v_cvt_pk_bf16_f32 v106, v36, v37
    v_mfma_f32_16x16x32_bf16 v[188:191], a[252:255], v[92:95], v[188:191]
    s_mov_b32 s45, 1335296
    s_waitcnt lgkmcnt(8)
    buffer_load_dwordx4 v6, s[24:27], s45 offen lds
    v_cvt_pk_bf16_f32 v107, v38, v39
    v_mfma_f32_16x16x32_bf16 v[192:195], a[192:195], v[80:83], 0
    ds_read_b64_tr_b16 a[216:217], v3 offset:37216
    ds_read_b128 v[24:27], v9 offset:10000
    v_mfma_f32_16x16x32_bf16 v[192:195], a[196:199], v[84:87], v[192:195]
    ds_read_b64_tr_b16 a[218:219], v3 offset:37728
    ds_read_b64_tr_b16 a[220:221], v3 offset:54112
    v_fma_mix_f32 v32, v100, v16, v20 op_sel:[0,0,0] op_sel_hi:[1,0,0]
    v_mfma_f32_16x16x32_bf16 v[224:227], a[192:195], v[88:91], 0
    s_mov_b32 s54, 6144
    ds_read_b64_tr_b16 a[222:223], v3 offset:54624
    ds_read_b128 v[28:31], v9 offset:10032
    v_mfma_f32_16x16x32_bf16 v[224:227], a[196:199], v[92:95], v[224:227]
    s_waitcnt lgkmcnt(10)
    buffer_load_dwordx4 v[48:51], v8, s[32:35], s54 offen sc1
    v_mfma_f32_16x16x32_bf16 v[196:199], a[200:203], v[80:83], 0
    ds_read_b64_tr_b16 a[224:225], v3 offset:37248
    v_fma_mix_f32 v33, v100, v17, v21 op_sel:[1,0,0] op_sel_hi:[1,0,0]
    v_mfma_f32_16x16x32_bf16 v[196:199], a[204:207], v[84:87], v[196:199]
    ds_read_b64_tr_b16 a[226:227], v3 offset:37760
    ds_read_b64_tr_b16 a[228:229], v3 offset:54144
    v_fma_mix_f32 v34, v101, v18, v22 op_sel:[0,0,0] op_sel_hi:[1,0,0]
    v_mfma_f32_16x16x32_bf16 v[228:231], a[200:203], v[88:91], 0
    s_mov_b32 s54, 7168
    ds_read_b64_tr_b16 a[230:231], v3 offset:54656
    v_fma_mix_f32 v35, v101, v19, v23 op_sel:[1,0,0] op_sel_hi:[1,0,0]
    v_mfma_f32_16x16x32_bf16 v[228:231], a[204:207], v[92:95], v[228:231]
    s_waitcnt lgkmcnt(10)
    buffer_load_dwordx4 v[52:55], v8, s[32:35], s54 offen sc1
    v_mfma_f32_16x16x32_bf16 v[200:203], a[208:211], v[80:83], 0
    ds_read_b64_tr_b16 a[232:233], v3 offset:37280
    v_cvt_pk_bf16_f32 v100, v32, v33
    v_mfma_f32_16x16x32_bf16 v[200:203], a[212:215], v[84:87], v[200:203]
    ds_read_b64_tr_b16 a[234:235], v3 offset:37792
    ds_read_b64_tr_b16 a[236:237], v3 offset:54176
    v_cvt_pk_bf16_f32 v101, v34, v35
    v_mfma_f32_16x16x32_bf16 v[232:235], a[208:211], v[88:91], 0
    s_mov_b32 s54, 24576
    ds_read_b64_tr_b16 a[238:239], v3 offset:54688
    v_fma_mix_f32 v36, v108, v16, v20 op_sel:[0,0,0] op_sel_hi:[1,0,0]
    v_mfma_f32_16x16x32_bf16 v[232:235], a[212:215], v[92:95], v[232:235]
    s_waitcnt lgkmcnt(9)
    buffer_load_dwordx4 v[56:59], v8, s[32:35], s54 offen sc1
    v_fma_mix_f32 v37, v108, v17, v21 op_sel:[1,0,0] op_sel_hi:[1,0,0]
    v_mfma_f32_16x16x32_bf16 v[204:207], a[216:219], v[80:83], 0
    ds_read_b64_tr_b16 a[240:241], v3 offset:37312
    v_fma_mix_f32 v38, v109, v18, v22 op_sel:[0,0,0] op_sel_hi:[1,0,0]
    v_mfma_f32_16x16x32_bf16 v[204:207], a[220:223], v[84:87], v[204:207]
    ds_read_b64_tr_b16 a[242:243], v3 offset:37824
    ds_read_b64_tr_b16 a[244:245], v3 offset:54208
    v_fma_mix_f32 v39, v109, v19, v23 op_sel:[1,0,0] op_sel_hi:[1,0,0]
    v_mfma_f32_16x16x32_bf16 v[236:239], a[216:219], v[88:91], 0
    s_mov_b32 s54, 25600
    ds_read_b64_tr_b16 a[246:247], v3 offset:54720
    v_cvt_pk_bf16_f32 v108, v36, v37
    v_mfma_f32_16x16x32_bf16 v[236:239], a[220:223], v[92:95], v[236:239]
    s_waitcnt lgkmcnt(8)
    buffer_load_dwordx4 v[60:63], v8, s[32:35], s54 offen sc1
    v_cvt_pk_bf16_f32 v109, v38, v39
    v_mfma_f32_16x16x32_bf16 v[208:211], a[224:227], v[80:83], 0
    ds_read_b64_tr_b16 a[248:249], v3 offset:37344
    ds_read_b128 v[16:19], v9 offset:10240
    v_mfma_f32_16x16x32_bf16 v[208:211], a[228:231], v[84:87], v[208:211]
    ds_read_b64_tr_b16 a[250:251], v3 offset:37856
    ds_read_b128 v[20:23], v9 offset:10272
    v_mfma_f32_16x16x32_bf16 v[240:243], a[224:227], v[88:91], 0
    ds_read_b64_tr_b16 a[252:253], v3 offset:54240
    v_fma_mix_f32 v32, v102, v24, v28 op_sel:[0,0,0] op_sel_hi:[1,0,0]
    v_mfma_f32_16x16x32_bf16 v[240:243], a[228:231], v[92:95], v[240:243]
    s_barrier
    s_waitcnt lgkmcnt(9)
    ds_read_b64_tr_b16 a[254:255], v3 offset:54752
    v_fma_mix_f32 v33, v102, v25, v29 op_sel:[1,0,0] op_sel_hi:[1,0,0]
    v_fma_mix_f32 v34, v103, v26, v30 op_sel:[0,0,0] op_sel_hi:[1,0,0]
    v_mfma_f32_16x16x32_bf16 v[212:215], a[232:235], v[80:83], 0
    ds_read_b64_tr_b16 a[192:193], v4 offset:0
    v_fma_mix_f32 v35, v103, v27, v31 op_sel:[1,0,0] op_sel_hi:[1,0,0]
    v_mfma_f32_16x16x32_bf16 v[212:215], a[236:239], v[84:87], v[212:215]
    ds_read_b64_tr_b16 a[194:195], v4 offset:512
    ds_read_b64_tr_b16 a[196:197], v4 offset:16896
    v_cvt_pk_bf16_f32 v102, v32, v33
    v_mfma_f32_16x16x32_bf16 v[244:247], a[232:235], v[88:91], 0
    s_add_u32 m0, s44, 0
    ds_read_b64_tr_b16 a[198:199], v4 offset:17408
    v_cvt_pk_bf16_f32 v103, v34, v35
    v_mfma_f32_16x16x32_bf16 v[244:247], a[236:239], v[92:95], v[244:247]
    s_mov_b32 s45, 1572864
    s_waitcnt lgkmcnt(10)
    buffer_load_dwordx4 v6, s[24:27], s45 offen lds
    v_mfma_f32_16x16x32_bf16 v[216:219], a[240:243], v[80:83], 0
    ds_read_b64_tr_b16 a[200:201], v4 offset:32
    v_fma_mix_f32 v36, v110, v24, v28 op_sel:[0,0,0] op_sel_hi:[1,0,0]
    v_mfma_f32_16x16x32_bf16 v[216:219], a[244:247], v[84:87], v[216:219]
    ds_read_b64_tr_b16 a[202:203], v4 offset:544
    ds_read_b64_tr_b16 a[204:205], v4 offset:16928
    v_fma_mix_f32 v37, v110, v25, v29 op_sel:[1,0,0] op_sel_hi:[1,0,0]
    v_mfma_f32_16x16x32_bf16 v[248:251], a[240:243], v[88:91], 0
    s_add_u32 m0, s44, 1056
    ds_read_b64_tr_b16 a[206:207], v4 offset:17440
    v_fma_mix_f32 v38, v111, v26, v30 op_sel:[0,0,0] op_sel_hi:[1,0,0]
    v_mfma_f32_16x16x32_bf16 v[248:251], a[244:247], v[92:95], v[248:251]
    s_mov_b32 s45, 1581056
    s_waitcnt lgkmcnt(8)
    buffer_load_dwordx4 v6, s[24:27], s45 offen lds
    v_mfma_f32_16x16x32_bf16 v[220:223], a[248:251], v[80:83], 0
    ds_read_b64_tr_b16 a[208:209], v4 offset:64
    v_fma_mix_f32 v39, v111, v27, v31 op_sel:[1,0,0] op_sel_hi:[1,0,0]
    v_mfma_f32_16x16x32_bf16 v[220:223], a[252:255], v[84:87], v[220:223]
    ds_read_b64_tr_b16 a[210:211], v4 offset:576
    ds_read_b64_tr_b16 a[212:213], v4 offset:16960
    v_cvt_pk_bf16_f32 v110, v36, v37
    v_mfma_f32_16x16x32_bf16 v[252:255], a[248:251], v[88:91], 0
    s_add_u32 m0, s44, 2112
    ds_read_b64_tr_b16 a[214:215], v4 offset:17472
    v_cvt_pk_bf16_f32 v111, v38, v39
    v_mfma_f32_16x16x32_bf16 v[252:255], a[252:255], v[92:95], v[252:255]
    s_mov_b32 s45, 1589248
    s_waitcnt lgkmcnt(8)
    buffer_load_dwordx4 v6, s[24:27], s45 offen lds
    v_mfma_f32_16x16x32_bf16 v[128:131], a[192:195], v[96:99], v[128:131]
    s_waitcnt vmcnt(15)
    ds_read_b64_tr_b16 a[216:217], v4 offset:96
    ds_read_b128 v[24:27], v9 offset:10256
    v_mfma_f32_16x16x32_bf16 v[128:131], a[196:199], v[100:103], v[128:131]
    ds_read_b64_tr_b16 a[218:219], v4 offset:608
    ds_read_b64_tr_b16 a[220:221], v4 offset:16992
    v_fma_mix_f32 v32, v112, v16, v20 op_sel:[0,0,0] op_sel_hi:[1,0,0]
    v_mfma_f32_16x16x32_bf16 v[160:163], a[192:195], v[104:107], v[160:163]
    s_add_u32 m0, s44, 3168
    ds_read_b64_tr_b16 a[222:223], v4 offset:17504
    ds_read_b128 v[28:31], v9 offset:10288
    v_mfma_f32_16x16x32_bf16 v[160:163], a[196:199], v[108:111], v[160:163]
    s_mov_b32 s45, 1597440
    s_waitcnt lgkmcnt(10)
    buffer_load_dwordx4 v6, s[24:27], s45 offen lds
    v_mfma_f32_16x16x32_bf16 v[132:135], a[200:203], v[96:99], v[132:135]
    ds_read_b64_tr_b16 a[224:225], v4 offset:128
    v_fma_mix_f32 v33, v112, v17, v21 op_sel:[1,0,0] op_sel_hi:[1,0,0]
    v_mfma_f32_16x16x32_bf16 v[132:135], a[204:207], v[100:103], v[132:135]
    ds_read_b64_tr_b16 a[226:227], v4 offset:640
    ds_read_b64_tr_b16 a[228:229], v4 offset:17024
    v_fma_mix_f32 v34, v113, v18, v22 op_sel:[0,0,0] op_sel_hi:[1,0,0]
    v_mfma_f32_16x16x32_bf16 v[164:167], a[200:203], v[104:107], v[164:167]
    s_add_u32 m0, s44, 16896
    ds_read_b64_tr_b16 a[230:231], v4 offset:17536
    v_fma_mix_f32 v35, v113, v19, v23 op_sel:[1,0,0] op_sel_hi:[1,0,0]
    v_mfma_f32_16x16x32_bf16 v[164:167], a[204:207], v[108:111], v[164:167]
    s_mov_b32 s45, 1835008
    s_waitcnt lgkmcnt(10)
    buffer_load_dwordx4 v6, s[24:27], s45 offen lds
    v_mfma_f32_16x16x32_bf16 v[136:139], a[208:211], v[96:99], v[136:139]
    ds_read_b64_tr_b16 a[232:233], v4 offset:160
    v_cvt_pk_bf16_f32 v112, v32, v33
    v_mfma_f32_16x16x32_bf16 v[136:139], a[212:215], v[100:103], v[136:139]
    ds_read_b64_tr_b16 a[234:235], v4 offset:672
    ds_read_b64_tr_b16 a[236:237], v4 offset:17056
    v_cvt_pk_bf16_f32 v113, v34, v35
    v_mfma_f32_16x16x32_bf16 v[168:171], a[208:211], v[104:107], v[168:171]
    s_add_u32 m0, s44, 17952
    ds_read_b64_tr_b16 a[238:239], v4 offset:17568
    v_fma_mix_f32 v36, v120, v16, v20 op_sel:[0,0,0] op_sel_hi:[1,0,0]
    v_mfma_f32_16x16x32_bf16 v[168:171], a[212:215], v[108:111], v[168:171]
    s_mov_b32 s45, 1843200
    s_waitcnt lgkmcnt(9)
    buffer_load_dwordx4 v6, s[24:27], s45 offen lds
    v_fma_mix_f32 v37, v120, v17, v21 op_sel:[1,0,0] op_sel_hi:[1,0,0]
    v_mfma_f32_16x16x32_bf16 v[140:143], a[216:219], v[96:99], v[140:143]
    ds_read_b64_tr_b16 a[240:241], v4 offset:192
    v_fma_mix_f32 v38, v121, v18, v22 op_sel:[0,0,0] op_sel_hi:[1,0,0]
    v_mfma_f32_16x16x32_bf16 v[140:143], a[220:223], v[100:103], v[140:143]
    ds_read_b64_tr_b16 a[242:243], v4 offset:704
    ds_read_b64_tr_b16 a[244:245], v4 offset:17088
    v_fma_mix_f32 v39, v121, v19, v23 op_sel:[1,0,0] op_sel_hi:[1,0,0]
    v_mfma_f32_16x16x32_bf16 v[172:175], a[216:219], v[104:107], v[172:175]
    s_add_u32 m0, s44, 19008
    ds_read_b64_tr_b16 a[246:247], v4 offset:17600
    v_cvt_pk_bf16_f32 v120, v36, v37
    v_mfma_f32_16x16x32_bf16 v[172:175], a[220:223], v[108:111], v[172:175]
    s_mov_b32 s45, 1851392
    s_waitcnt lgkmcnt(8)
    buffer_load_dwordx4 v6, s[24:27], s45 offen lds
    v_cvt_pk_bf16_f32 v121, v38, v39
    v_mfma_f32_16x16x32_bf16 v[144:147], a[224:227], v[96:99], v[144:147]
    ds_read_b64_tr_b16 a[248:249], v4 offset:224
    ds_read_b128 v[16:19], v9 offset:10496
    v_mfma_f32_16x16x32_bf16 v[144:147], a[228:231], v[100:103], v[144:147]
    ds_read_b64_tr_b16 a[250:251], v4 offset:736
    ds_read_b64_tr_b16 a[252:253], v4 offset:17120
    v_mfma_f32_16x16x32_bf16 v[176:179], a[224:227], v[104:107], v[176:179]
    s_add_u32 m0, s44, 20064
    ds_read_b64_tr_b16 a[254:255], v4 offset:17632
    ds_read_b128 v[20:23], v9 offset:10528
    v_mfma_f32_16x16x32_bf16 v[176:179], a[228:231], v[108:111], v[176:179]
    s_mov_b32 s45, 1859584
    s_waitcnt lgkmcnt(10)
    buffer_load_dwordx4 v6, s[24:27], s45 offen lds
    v_mfma_f32_16x16x32_bf16 v[148:151], a[232:235], v[96:99], v[148:151]
    ds_read_b64_tr_b16 a[192:193], v4 offset:256
    v_fma_mix_f32 v32, v114, v24, v28 op_sel:[0,0,0] op_sel_hi:[1,0,0]
    v_mfma_f32_16x16x32_bf16 v[148:151], a[236:239], v[100:103], v[148:151]
    ds_read_b64_tr_b16 a[194:195], v4 offset:768
    v_fma_mix_f32 v33, v114, v25, v29 op_sel:[1,0,0] op_sel_hi:[1,0,0]
    v_mfma_f32_16x16x32_bf16 v[180:183], a[232:235], v[104:107], v[180:183]
    ds_read_b64_tr_b16 a[196:197], v4 offset:17152
    v_fma_mix_f32 v34, v115, v26, v30 op_sel:[0,0,0] op_sel_hi:[1,0,0]
    v_mfma_f32_16x16x32_bf16 v[180:183], a[236:239], v[108:111], v[180:183]
    s_waitcnt lgkmcnt(9)
    ds_read_b64_tr_b16 a[198:199], v4 offset:17664
    v_fma_mix_f32 v35, v115, v27, v31 op_sel:[1,0,0] op_sel_hi:[1,0,0]
    v_mfma_f32_16x16x32_bf16 v[152:155], a[240:243], v[96:99], v[152:155]
    ds_read_b64_tr_b16 a[200:201], v4 offset:288
    v_cvt_pk_bf16_f32 v114, v32, v33
    v_mfma_f32_16x16x32_bf16 v[152:155], a[244:247], v[100:103], v[152:155]
    ds_read_b64_tr_b16 a[202:203], v4 offset:800
    v_cvt_pk_bf16_f32 v115, v34, v35
    v_mfma_f32_16x16x32_bf16 v[184:187], a[240:243], v[104:107], v[184:187]
    ds_read_b64_tr_b16 a[204:205], v4 offset:17184
    v_fma_mix_f32 v36, v122, v24, v28 op_sel:[0,0,0] op_sel_hi:[1,0,0]
    v_mfma_f32_16x16x32_bf16 v[184:187], a[244:247], v[108:111], v[184:187]
    s_waitcnt lgkmcnt(8)
    ds_read_b64_tr_b16 a[206:207], v4 offset:17696
    v_fma_mix_f32 v37, v122, v25, v29 op_sel:[1,0,0] op_sel_hi:[1,0,0]
    v_mfma_f32_16x16x32_bf16 v[156:159], a[248:251], v[96:99], v[156:159]
    ds_read_b64_tr_b16 a[208:209], v4 offset:320
    v_fma_mix_f32 v38, v123, v26, v30 op_sel:[0,0,0] op_sel_hi:[1,0,0]
    v_mfma_f32_16x16x32_bf16 v[156:159], a[252:255], v[100:103], v[156:159]
    ds_read_b64_tr_b16 a[210:211], v4 offset:832
    v_fma_mix_f32 v39, v123, v27, v31 op_sel:[1,0,0] op_sel_hi:[1,0,0]
    v_mfma_f32_16x16x32_bf16 v[188:191], a[248:251], v[104:107], v[188:191]
    ds_read_b64_tr_b16 a[212:213], v4 offset:17216
    v_cvt_pk_bf16_f32 v122, v36, v37
    v_mfma_f32_16x16x32_bf16 v[188:191], a[252:255], v[108:111], v[188:191]
    s_waitcnt lgkmcnt(7)
    ds_read_b64_tr_b16 a[214:215], v4 offset:17728
    v_cvt_pk_bf16_f32 v123, v38, v39
    v_mfma_f32_16x16x32_bf16 v[192:195], a[192:195], v[96:99], v[192:195]
    ds_read_b64_tr_b16 a[216:217], v4 offset:352
    ds_read_b128 v[24:27], v9 offset:10512
    v_mfma_f32_16x16x32_bf16 v[192:195], a[196:199], v[100:103], v[192:195]
    ds_read_b64_tr_b16 a[218:219], v4 offset:864
    ds_read_b64_tr_b16 a[220:221], v4 offset:17248
    v_fma_mix_f32 v32, v116, v16, v20 op_sel:[0,0,0] op_sel_hi:[1,0,0]
    v_mfma_f32_16x16x32_bf16 v[224:227], a[192:195], v[104:107], v[224:227]
    s_mov_b32 s54, 8192
    ds_read_b64_tr_b16 a[222:223], v4 offset:17760
    ds_read_b128 v[28:31], v9 offset:10544
    v_mfma_f32_16x16x32_bf16 v[224:227], a[196:199], v[108:111], v[224:227]
    s_waitcnt lgkmcnt(10)
    buffer_load_dwordx4 v[64:67], v8, s[32:35], s54 offen sc1
    v_mfma_f32_16x16x32_bf16 v[196:199], a[200:203], v[96:99], v[196:199]
    ds_read_b64_tr_b16 a[224:225], v4 offset:384
    v_fma_mix_f32 v33, v116, v17, v21 op_sel:[1,0,0] op_sel_hi:[1,0,0]
    v_mfma_f32_16x16x32_bf16 v[196:199], a[204:207], v[100:103], v[196:199]
    ds_read_b64_tr_b16 a[226:227], v4 offset:896
    ds_read_b64_tr_b16 a[228:229], v4 offset:17280
    v_fma_mix_f32 v34, v117, v18, v22 op_sel:[0,0,0] op_sel_hi:[1,0,0]
    v_mfma_f32_16x16x32_bf16 v[228:231], a[200:203], v[104:107], v[228:231]
    s_mov_b32 s54, 9216
    ds_read_b64_tr_b16 a[230:231], v4 offset:17792
    v_fma_mix_f32 v35, v117, v19, v23 op_sel:[1,0,0] op_sel_hi:[1,0,0]
    v_mfma_f32_16x16x32_bf16 v[228:231], a[204:207], v[108:111], v[228:231]
    s_waitcnt lgkmcnt(10)
    buffer_load_dwordx4 v[68:71], v8, s[32:35], s54 offen sc1
    v_mfma_f32_16x16x32_bf16 v[200:203], a[208:211], v[96:99], v[200:203]
    ds_read_b64_tr_b16 a[232:233], v4 offset:416
    v_cvt_pk_bf16_f32 v116, v32, v33
    v_mfma_f32_16x16x32_bf16 v[200:203], a[212:215], v[100:103], v[200:203]
    ds_read_b64_tr_b16 a[234:235], v4 offset:928
    ds_read_b64_tr_b16 a[236:237], v4 offset:17312
    v_cvt_pk_bf16_f32 v117, v34, v35
    v_mfma_f32_16x16x32_bf16 v[232:235], a[208:211], v[104:107], v[232:235]
    s_mov_b32 s54, 26624
    ds_read_b64_tr_b16 a[238:239], v4 offset:17824
    v_fma_mix_f32 v36, v124, v16, v20 op_sel:[0,0,0] op_sel_hi:[1,0,0]
    v_mfma_f32_16x16x32_bf16 v[232:235], a[212:215], v[108:111], v[232:235]
    s_waitcnt lgkmcnt(9)
    buffer_load_dwordx4 v[72:75], v8, s[32:35], s54 offen sc1
    v_fma_mix_f32 v37, v124, v17, v21 op_sel:[1,0,0] op_sel_hi:[1,0,0]
    v_mfma_f32_16x16x32_bf16 v[204:207], a[216:219], v[96:99], v[204:207]
L2_pad0:
    s_cbranch_execz L2_pad4
    ds_read_b64_tr_b16 a[240:241], v4 offset:448
    v_fma_mix_f32 v38, v125, v18, v22 op_sel:[0,0,0] op_sel_hi:[1,0,0]
    v_mfma_f32_16x16x32_bf16 v[204:207], a[220:223], v[100:103], v[204:207]
    ds_read_b64_tr_b16 a[242:243], v4 offset:960
    ds_read_b64_tr_b16 a[244:245], v4 offset:17344
    v_fma_mix_f32 v39, v125, v19, v23 op_sel:[1,0,0] op_sel_hi:[1,0,0]
    v_mfma_f32_16x16x32_bf16 v[236:239], a[216:219], v[104:107], v[236:239]
    s_mov_b32 s54, 27648
    ds_read_b64_tr_b16 a[246:247], v4 offset:17856
    v_cvt_pk_bf16_f32 v124, v36, v37
    v_mfma_f32_16x16x32_bf16 v[236:239], a[220:223], v[108:111], v[236:239]
    s_waitcnt lgkmcnt(8)
    buffer_load_dwordx4 v[76:79], v8, s[32:35], s54 offen sc1
    v_cvt_pk_bf16_f32 v125, v38, v39
    v_mfma_f32_16x16x32_bf16 v[208:211], a[224:227], v[96:99], v[208:211]
    ds_read_b64_tr_b16 a[248:249], v4 offset:480
    ds_read_b128 v[16:19], v9 offset:10752
    v_mfma_f32_16x16x32_bf16 v[208:211], a[228:231], v[100:103], v[208:211]
    ds_read_b64_tr_b16 a[250:251], v4 offset:992
    ds_read_b128 v[20:23], v9 offset:10784
    v_mfma_f32_16x16x32_bf16 v[240:243], a[224:227], v[104:107], v[240:243]
    ds_read_b64_tr_b16 a[252:253], v4 offset:17376
    v_fma_mix_f32 v32, v118, v24, v28 op_sel:[0,0,0] op_sel_hi:[1,0,0]
    v_mfma_f32_16x16x32_bf16 v[240:243], a[228:231], v[108:111], v[240:243]
    s_waitcnt vmcnt(16)
    s_barrier
    s_waitcnt lgkmcnt(9)
    ds_read_b64_tr_b16 a[254:255], v4 offset:17888
    v_fma_mix_f32 v33, v118, v25, v29 op_sel:[1,0,0] op_sel_hi:[1,0,0]
    v_fma_mix_f32 v34, v119, v26, v30 op_sel:[0,0,0] op_sel_hi:[1,0,0]
    v_mfma_f32_16x16x32_bf16 v[212:215], a[232:235], v[96:99], v[212:215]
    ds_read_b64_tr_b16 a[192:193], v4 offset:36864
    v_fma_mix_f32 v35, v119, v27, v31 op_sel:[1,0,0] op_sel_hi:[1,0,0]
    v_mfma_f32_16x16x32_bf16 v[212:215], a[236:239], v[100:103], v[212:215]
    ds_read_b64_tr_b16 a[194:195], v4 offset:37376
    ds_read_b64_tr_b16 a[196:197], v4 offset:53760
    v_cvt_pk_bf16_f32 v118, v32, v33
    v_mfma_f32_16x16x32_bf16 v[244:247], a[232:235], v[104:107], v[244:247]
    s_add_u32 m0, s44, 36864
    ds_read_b64_tr_b16 a[198:199], v4 offset:54272
    v_cvt_pk_bf16_f32 v119, v34, v35
    v_mfma_f32_16x16x32_bf16 v[244:247], a[236:239], v[108:111], v[244:247]
    s_mov_b32 s45, 2097152
    s_waitcnt lgkmcnt(10)
    buffer_load_dwordx4 v6, s[24:27], s45 offen lds
    v_mfma_f32_16x16x32_bf16 v[216:219], a[240:243], v[96:99], v[216:219]
    ds_read_b64_tr_b16 a[200:201], v4 offset:36896
    v_fma_mix_f32 v36, v126, v24, v28 op_sel:[0,0,0] op_sel_hi:[1,0,0]
    v_mfma_f32_16x16x32_bf16 v[216:219], a[244:247], v[100:103], v[216:219]
    ds_read_b64_tr_b16 a[202:203], v4 offset:37408
    ds_read_b64_tr_b16 a[204:205], v4 offset:53792
    v_fma_mix_f32 v37, v126, v25, v29 op_sel:[1,0,0] op_sel_hi:[1,0,0]
    v_mfma_f32_16x16x32_bf16 v[248:251], a[240:243], v[104:107], v[248:251]
    s_add_u32 m0, s44, 37920
    ds_read_b64_tr_b16 a[206:207], v4 offset:54304
    v_fma_mix_f32 v38, v127, v26, v30 op_sel:[0,0,0] op_sel_hi:[1,0,0]
    v_mfma_f32_16x16x32_bf16 v[248:251], a[244:247], v[108:111], v[248:251]
    s_mov_b32 s45, 2105344
    s_waitcnt lgkmcnt(8)
    buffer_load_dwordx4 v6, s[24:27], s45 offen lds
    v_mfma_f32_16x16x32_bf16 v[220:223], a[248:251], v[96:99], v[220:223]
    ds_read_b64_tr_b16 a[208:209], v4 offset:36928
    v_fma_mix_f32 v39, v127, v27, v31 op_sel:[1,0,0] op_sel_hi:[1,0,0]
    v_mfma_f32_16x16x32_bf16 v[220:223], a[252:255], v[100:103], v[220:223]
    ds_read_b64_tr_b16 a[210:211], v4 offset:37440
    ds_read_b64_tr_b16 a[212:213], v4 offset:53824
    v_cvt_pk_bf16_f32 v126, v36, v37
    v_mfma_f32_16x16x32_bf16 v[252:255], a[248:251], v[104:107], v[252:255]
    s_add_u32 m0, s44, 38976
    ds_read_b64_tr_b16 a[214:215], v4 offset:54336
    v_cvt_pk_bf16_f32 v127, v38, v39
    v_mfma_f32_16x16x32_bf16 v[252:255], a[252:255], v[108:111], v[252:255]
    s_mov_b32 s45, 2113536
    s_waitcnt lgkmcnt(8)
    buffer_load_dwordx4 v6, s[24:27], s45 offen lds
    v_mfma_f32_16x16x32_bf16 v[128:131], a[192:195], v[112:115], v[128:131]
    s_waitcnt vmcnt(15)
    ds_read_b64_tr_b16 a[216:217], v4 offset:36960
    ds_read_b128 v[24:27], v9 offset:10768
    v_mfma_f32_16x16x32_bf16 v[128:131], a[196:199], v[116:119], v[128:131]
    ds_read_b64_tr_b16 a[218:219], v4 offset:37472
    ds_read_b64_tr_b16 a[220:221], v4 offset:53856
    v_fma_mix_f32 v32, v48, v16, v20 op_sel:[0,0,0] op_sel_hi:[1,0,0]
    v_mfma_f32_16x16x32_bf16 v[160:163], a[192:195], v[120:123], v[160:163]
    s_add_u32 m0, s44, 40032
    ds_read_b64_tr_b16 a[222:223], v4 offset:54368
    ds_read_b128 v[28:31], v9 offset:10800
    v_mfma_f32_16x16x32_bf16 v[160:163], a[196:199], v[124:127], v[160:163]
    s_mov_b32 s45, 2121728
    s_waitcnt lgkmcnt(10)
    buffer_load_dwordx4 v6, s[24:27], s45 offen lds
    v_mfma_f32_16x16x32_bf16 v[132:135], a[200:203], v[112:115], v[132:135]
    ds_read_b64_tr_b16 a[224:225], v4 offset:36992
    v_fma_mix_f32 v33, v48, v17, v21 op_sel:[1,0,0] op_sel_hi:[1,0,0]
    v_mfma_f32_16x16x32_bf16 v[132:135], a[204:207], v[116:119], v[132:135]
    ds_read_b64_tr_b16 a[226:227], v4 offset:37504
    ds_read_b64_tr_b16 a[228:229], v4 offset:53888
    v_fma_mix_f32 v34, v49, v18, v22 op_sel:[0,0,0] op_sel_hi:[1,0,0]
    v_mfma_f32_16x16x32_bf16 v[164:167], a[200:203], v[120:123], v[164:167]
    s_add_u32 m0, s44, 53760
    ds_read_b64_tr_b16 a[230:231], v4 offset:54400
    v_fma_mix_f32 v35, v49, v19, v23 op_sel:[1,0,0] op_sel_hi:[1,0,0]
    v_mfma_f32_16x16x32_bf16 v[164:167], a[204:207], v[124:127], v[164:167]
    s_mov_b32 s45, 2359296
    s_waitcnt lgkmcnt(10)
    buffer_load_dwordx4 v6, s[24:27], s45 offen lds
    v_mfma_f32_16x16x32_bf16 v[136:139], a[208:211], v[112:115], v[136:139]
    ds_read_b64_tr_b16 a[232:233], v4 offset:37024
    v_cvt_pk_bf16_f32 v48, v32, v33
    v_mfma_f32_16x16x32_bf16 v[136:139], a[212:215], v[116:119], v[136:139]
    ds_read_b64_tr_b16 a[234:235], v4 offset:37536
    ds_read_b64_tr_b16 a[236:237], v4 offset:53920
    v_cvt_pk_bf16_f32 v49, v34, v35
    v_mfma_f32_16x16x32_bf16 v[168:171], a[208:211], v[120:123], v[168:171]
    s_add_u32 m0, s44, 54816
    ds_read_b64_tr_b16 a[238:239], v4 offset:54432
    v_fma_mix_f32 v36, v56, v16, v20 op_sel:[0,0,0] op_sel_hi:[1,0,0]
    v_mfma_f32_16x16x32_bf16 v[168:171], a[212:215], v[124:127], v[168:171]
    s_mov_b32 s45, 2367488
    s_waitcnt lgkmcnt(9)
    buffer_load_dwordx4 v6, s[24:27], s45 offen lds
    v_fma_mix_f32 v37, v56, v17, v21 op_sel:[1,0,0] op_sel_hi:[1,0,0]
    v_mfma_f32_16x16x32_bf16 v[140:143], a[216:219], v[112:115], v[140:143]
    ds_read_b64_tr_b16 a[240:241], v4 offset:37056
    v_fma_mix_f32 v38, v57, v18, v22 op_sel:[0,0,0] op_sel_hi:[1,0,0]
    v_mfma_f32_16x16x32_bf16 v[140:143], a[220:223], v[116:119], v[140:143]
    ds_read_b64_tr_b16 a[242:243], v4 offset:37568
    ds_read_b64_tr_b16 a[244:245], v4 offset:53952
    v_fma_mix_f32 v39, v57, v19, v23 op_sel:[1,0,0] op_sel_hi:[1,0,0]
    v_mfma_f32_16x16x32_bf16 v[172:175], a[216:219], v[120:123], v[172:175]
    s_add_u32 m0, s44, 55872
    ds_read_b64_tr_b16 a[246:247], v4 offset:54464
    v_cvt_pk_bf16_f32 v56, v36, v37
    v_mfma_f32_16x16x32_bf16 v[172:175], a[220:223], v[124:127], v[172:175]
    s_mov_b32 s45, 2375680
    s_waitcnt lgkmcnt(8)
    buffer_load_dwordx4 v6, s[24:27], s45 offen lds
    v_cvt_pk_bf16_f32 v57, v38, v39
    v_mfma_f32_16x16x32_bf16 v[144:147], a[224:227], v[112:115], v[144:147]
    ds_read_b64_tr_b16 a[248:249], v4 offset:37088
    ds_read_b128 v[16:19], v9 offset:11008
    v_mfma_f32_16x16x32_bf16 v[144:147], a[228:231], v[116:119], v[144:147]
    ds_read_b64_tr_b16 a[250:251], v4 offset:37600
    ds_read_b64_tr_b16 a[252:253], v4 offset:53984
    v_mfma_f32_16x16x32_bf16 v[176:179], a[224:227], v[120:123], v[176:179]
    s_add_u32 m0, s44, 56928
    ds_read_b64_tr_b16 a[254:255], v4 offset:54496
    ds_read_b128 v[20:23], v9 offset:11040
    v_mfma_f32_16x16x32_bf16 v[176:179], a[228:231], v[124:127], v[176:179]
    s_mov_b32 s45, 2383872
    s_waitcnt lgkmcnt(10)
    buffer_load_dwordx4 v6, s[24:27], s45 offen lds
    v_mfma_f32_16x16x32_bf16 v[148:151], a[232:235], v[112:115], v[148:151]
    ds_read_b64_tr_b16 a[192:193], v4 offset:37120
    v_fma_mix_f32 v32, v50, v24, v28 op_sel:[0,0,0] op_sel_hi:[1,0,0]
    v_mfma_f32_16x16x32_bf16 v[148:151], a[236:239], v[116:119], v[148:151]
    ds_read_b64_tr_b16 a[194:195], v4 offset:37632
    v_fma_mix_f32 v33, v50, v25, v29 op_sel:[1,0,0] op_sel_hi:[1,0,0]
    v_mfma_f32_16x16x32_bf16 v[180:183], a[232:235], v[120:123], v[180:183]
    ds_read_b64_tr_b16 a[196:197], v4 offset:54016
    v_fma_mix_f32 v34, v51, v26, v30 op_sel:[0,0,0] op_sel_hi:[1,0,0]
    v_mfma_f32_16x16x32_bf16 v[180:183], a[236:239], v[124:127], v[180:183]
    s_waitcnt lgkmcnt(9)
    ds_read_b64_tr_b16 a[198:199], v4 offset:54528
    v_fma_mix_f32 v35, v51, v27, v31 op_sel:[1,0,0] op_sel_hi:[1,0,0]
    v_mfma_f32_16x16x32_bf16 v[152:155], a[240:243], v[112:115], v[152:155]
    ds_read_b64_tr_b16 a[200:201], v4 offset:37152
    v_cvt_pk_bf16_f32 v50, v32, v33
    v_mfma_f32_16x16x32_bf16 v[152:155], a[244:247], v[116:119], v[152:155]
    ds_read_b64_tr_b16 a[202:203], v4 offset:37664
    v_cvt_pk_bf16_f32 v51, v34, v35
    v_mfma_f32_16x16x32_bf16 v[184:187], a[240:243], v[120:123], v[184:187]
    ds_read_b64_tr_b16 a[204:205], v4 offset:54048
    v_fma_mix_f32 v36, v58, v24, v28 op_sel:[0,0,0] op_sel_hi:[1,0,0]
    v_mfma_f32_16x16x32_bf16 v[184:187], a[244:247], v[124:127], v[184:187]
    s_waitcnt lgkmcnt(8)
    ds_read_b64_tr_b16 a[206:207], v4 offset:54560
    v_fma_mix_f32 v37, v58, v25, v29 op_sel:[1,0,0] op_sel_hi:[1,0,0]
    v_mfma_f32_16x16x32_bf16 v[156:159], a[248:251], v[112:115], v[156:159]
    ds_read_b64_tr_b16 a[208:209], v4 offset:37184
    v_fma_mix_f32 v38, v59, v26, v30 op_sel:[0,0,0] op_sel_hi:[1,0,0]
    v_mfma_f32_16x16x32_bf16 v[156:159], a[252:255], v[116:119], v[156:159]
    ds_read_b64_tr_b16 a[210:211], v4 offset:37696
    v_fma_mix_f32 v39, v59, v27, v31 op_sel:[1,0,0] op_sel_hi:[1,0,0]
    v_mfma_f32_16x16x32_bf16 v[188:191], a[248:251], v[120:123], v[188:191]
    ds_read_b64_tr_b16 a[212:213], v4 offset:54080
    v_cvt_pk_bf16_f32 v58, v36, v37
    v_mfma_f32_16x16x32_bf16 v[188:191], a[252:255], v[124:127], v[188:191]
    s_waitcnt lgkmcnt(7)
    ds_read_b64_tr_b16 a[214:215], v4 offset:54592
    v_cvt_pk_bf16_f32 v59, v38, v39
    v_mfma_f32_16x16x32_bf16 v[192:195], a[192:195], v[112:115], v[192:195]
    ds_read_b64_tr_b16 a[216:217], v4 offset:37216
    ds_read_b128 v[24:27], v9 offset:11024
    v_mfma_f32_16x16x32_bf16 v[192:195], a[196:199], v[116:119], v[192:195]
    ds_read_b64_tr_b16 a[218:219], v4 offset:37728
    ds_read_b64_tr_b16 a[220:221], v4 offset:54112
    v_fma_mix_f32 v32, v52, v16, v20 op_sel:[0,0,0] op_sel_hi:[1,0,0]
    v_mfma_f32_16x16x32_bf16 v[224:227], a[192:195], v[120:123], v[224:227]
    s_mov_b32 s54, 10240
    ds_read_b64_tr_b16 a[222:223], v4 offset:54624
    ds_read_b128 v[28:31], v9 offset:11056
    v_mfma_f32_16x16x32_bf16 v[224:227], a[196:199], v[124:127], v[224:227]
    s_waitcnt lgkmcnt(10)
    buffer_load_dwordx4 v[80:83], v8, s[32:35], s54 offen sc1
    v_mfma_f32_16x16x32_bf16 v[196:199], a[200:203], v[112:115], v[196:199]
    ds_read_b64_tr_b16 a[224:225], v4 offset:37248
    v_fma_mix_f32 v33, v52, v17, v21 op_sel:[1,0,0] op_sel_hi:[1,0,0]
    v_mfma_f32_16x16x32_bf16 v[196:199], a[204:207], v[116:119], v[196:199]
    ds_read_b64_tr_b16 a[226:227], v4 offset:37760
    ds_read_b64_tr_b16 a[228:229], v4 offset:54144
    v_fma_mix_f32 v34, v53, v18, v22 op_sel:[0,0,0] op_sel_hi:[1,0,0]
    v_mfma_f32_16x16x32_bf16 v[228:231], a[200:203], v[120:123], v[228:231]
    s_mov_b32 s54, 11264
    ds_read_b64_tr_b16 a[230:231], v4 offset:54656
    v_fma_mix_f32 v35, v53, v19, v23 op_sel:[1,0,0] op_sel_hi:[1,0,0]
    v_mfma_f32_16x16x32_bf16 v[228:231], a[204:207], v[124:127], v[228:231]
    s_waitcnt lgkmcnt(10)
    buffer_load_dwordx4 v[84:87], v8, s[32:35], s54 offen sc1
    v_mfma_f32_16x16x32_bf16 v[200:203], a[208:211], v[112:115], v[200:203]
    ds_read_b64_tr_b16 a[232:233], v4 offset:37280
    v_cvt_pk_bf16_f32 v52, v32, v33
    v_mfma_f32_16x16x32_bf16 v[200:203], a[212:215], v[116:119], v[200:203]
    ds_read_b64_tr_b16 a[234:235], v4 offset:37792
    ds_read_b64_tr_b16 a[236:237], v4 offset:54176
    v_cvt_pk_bf16_f32 v53, v34, v35
    v_mfma_f32_16x16x32_bf16 v[232:235], a[208:211], v[120:123], v[232:235]
    s_mov_b32 s54, 28672
    ds_read_b64_tr_b16 a[238:239], v4 offset:54688
    v_fma_mix_f32 v36, v60, v16, v20 op_sel:[0,0,0] op_sel_hi:[1,0,0]
    v_mfma_f32_16x16x32_bf16 v[232:235], a[212:215], v[124:127], v[232:235]
    s_waitcnt lgkmcnt(9)
    buffer_load_dwordx4 v[88:91], v8, s[32:35], s54 offen sc1
    v_fma_mix_f32 v37, v60, v17, v21 op_sel:[1,0,0] op_sel_hi:[1,0,0]
    v_mfma_f32_16x16x32_bf16 v[204:207], a[216:219], v[112:115], v[204:207]
    ds_read_b64_tr_b16 a[240:241], v4 offset:37312
    v_fma_mix_f32 v38, v61, v18, v22 op_sel:[0,0,0] op_sel_hi:[1,0,0]
    v_mfma_f32_16x16x32_bf16 v[204:207], a[220:223], v[116:119], v[204:207]
    ds_read_b64_tr_b16 a[242:243], v4 offset:37824
    ds_read_b64_tr_b16 a[244:245], v4 offset:54208
    v_fma_mix_f32 v39, v61, v19, v23 op_sel:[1,0,0] op_sel_hi:[1,0,0]
    v_mfma_f32_16x16x32_bf16 v[236:239], a[216:219], v[120:123], v[236:239]
    s_mov_b32 s54, 29696
    ds_read_b64_tr_b16 a[246:247], v4 offset:54720
    v_cvt_pk_bf16_f32 v60, v36, v37
    v_mfma_f32_16x16x32_bf16 v[236:239], a[220:223], v[124:127], v[236:239]
    s_waitcnt lgkmcnt(8)
    buffer_load_dwordx4 v[92:95], v8, s[32:35], s54 offen sc1
    v_cvt_pk_bf16_f32 v61, v38, v39
    v_mfma_f32_16x16x32_bf16 v[208:211], a[224:227], v[112:115], v[208:211]
    ds_read_b64_tr_b16 a[248:249], v4 offset:37344
    ds_read_b128 v[16:19], v9 offset:11264
    v_mfma_f32_16x16x32_bf16 v[208:211], a[228:231], v[116:119], v[208:211]
    ds_read_b64_tr_b16 a[250:251], v4 offset:37856
    ds_read_b128 v[20:23], v9 offset:11296
    v_mfma_f32_16x16x32_bf16 v[240:243], a[224:227], v[120:123], v[240:243]
    ds_read_b64_tr_b16 a[252:253], v4 offset:54240
    v_fma_mix_f32 v32, v54, v24, v28 op_sel:[0,0,0] op_sel_hi:[1,0,0]
    v_mfma_f32_16x16x32_bf16 v[240:243], a[228:231], v[124:127], v[240:243]
    s_waitcnt vmcnt(16)
    s_barrier
    s_waitcnt lgkmcnt(9)
    ds_read_b64_tr_b16 a[254:255], v4 offset:54752
    v_fma_mix_f32 v33, v54, v25, v29 op_sel:[1,0,0] op_sel_hi:[1,0,0]
    v_fma_mix_f32 v34, v55, v26, v30 op_sel:[0,0,0] op_sel_hi:[1,0,0]
    v_mfma_f32_16x16x32_bf16 v[212:215], a[232:235], v[112:115], v[212:215]
    ds_read_b64_tr_b16 a[192:193], v3 offset:0
    v_fma_mix_f32 v35, v55, v27, v31 op_sel:[1,0,0] op_sel_hi:[1,0,0]
    v_mfma_f32_16x16x32_bf16 v[212:215], a[236:239], v[116:119], v[212:215]
    ds_read_b64_tr_b16 a[194:195], v3 offset:512
    ds_read_b64_tr_b16 a[196:197], v3 offset:16896
    v_cvt_pk_bf16_f32 v54, v32, v33
    v_mfma_f32_16x16x32_bf16 v[244:247], a[232:235], v[120:123], v[244:247]
    s_add_u32 m0, s44, 73728
    ds_read_b64_tr_b16 a[198:199], v3 offset:17408
    v_cvt_pk_bf16_f32 v55, v34, v35
    v_mfma_f32_16x16x32_bf16 v[244:247], a[236:239], v[124:127], v[244:247]
    s_mov_b32 s45, 2621440
    s_waitcnt lgkmcnt(10)
    buffer_load_dwordx4 v6, s[24:27], s45 offen lds
    v_mfma_f32_16x16x32_bf16 v[216:219], a[240:243], v[112:115], v[216:219]
    ds_read_b64_tr_b16 a[200:201], v3 offset:32
    v_fma_mix_f32 v36, v62, v24, v28 op_sel:[0,0,0] op_sel_hi:[1,0,0]
    v_mfma_f32_16x16x32_bf16 v[216:219], a[244:247], v[116:119], v[216:219]
    ds_read_b64_tr_b16 a[202:203], v3 offset:544
    ds_read_b64_tr_b16 a[204:205], v3 offset:16928
    v_fma_mix_f32 v37, v62, v25, v29 op_sel:[1,0,0] op_sel_hi:[1,0,0]
    v_mfma_f32_16x16x32_bf16 v[248:251], a[240:243], v[120:123], v[248:251]
    s_add_u32 m0, s44, 74784
    ds_read_b64_tr_b16 a[206:207], v3 offset:17440
    v_fma_mix_f32 v38, v63, v26, v30 op_sel:[0,0,0] op_sel_hi:[1,0,0]
    v_mfma_f32_16x16x32_bf16 v[248:251], a[244:247], v[124:127], v[248:251]
    s_mov_b32 s45, 2629632
    s_waitcnt lgkmcnt(8)
    buffer_load_dwordx4 v6, s[24:27], s45 offen lds
    v_mfma_f32_16x16x32_bf16 v[220:223], a[248:251], v[112:115], v[220:223]
    ds_read_b64_tr_b16 a[208:209], v3 offset:64
    v_fma_mix_f32 v39, v63, v27, v31 op_sel:[1,0,0] op_sel_hi:[1,0,0]
    v_mfma_f32_16x16x32_bf16 v[220:223], a[252:255], v[116:119], v[220:223]
    ds_read_b64_tr_b16 a[210:211], v3 offset:576
    ds_read_b64_tr_b16 a[212:213], v3 offset:16960
    v_cvt_pk_bf16_f32 v62, v36, v37
    v_mfma_f32_16x16x32_bf16 v[252:255], a[248:251], v[120:123], v[252:255]
    s_add_u32 m0, s44, 75840
    ds_read_b64_tr_b16 a[214:215], v3 offset:17472
    v_cvt_pk_bf16_f32 v63, v38, v39
    v_mfma_f32_16x16x32_bf16 v[252:255], a[252:255], v[124:127], v[252:255]
    s_mov_b32 s45, 2637824
    s_waitcnt lgkmcnt(8)
    buffer_load_dwordx4 v6, s[24:27], s45 offen lds
    v_mfma_f32_16x16x32_bf16 v[128:131], a[192:195], v[48:51], v[128:131]
    s_waitcnt vmcnt(15)
    ds_read_b64_tr_b16 a[216:217], v3 offset:96
    ds_read_b128 v[24:27], v9 offset:11280
    v_mfma_f32_16x16x32_bf16 v[128:131], a[196:199], v[52:55], v[128:131]
    ds_read_b64_tr_b16 a[218:219], v3 offset:608
    ds_read_b64_tr_b16 a[220:221], v3 offset:16992
    v_fma_mix_f32 v32, v64, v16, v20 op_sel:[0,0,0] op_sel_hi:[1,0,0]
    v_mfma_f32_16x16x32_bf16 v[160:163], a[192:195], v[56:59], v[160:163]
    s_add_u32 m0, s44, 76896
    ds_read_b64_tr_b16 a[222:223], v3 offset:17504
    ds_read_b128 v[28:31], v9 offset:11312
    v_mfma_f32_16x16x32_bf16 v[160:163], a[196:199], v[60:63], v[160:163]
    s_mov_b32 s45, 2646016
    s_waitcnt lgkmcnt(10)
    buffer_load_dwordx4 v6, s[24:27], s45 offen lds
    v_mfma_f32_16x16x32_bf16 v[132:135], a[200:203], v[48:51], v[132:135]
    ds_read_b64_tr_b16 a[224:225], v3 offset:128
    v_fma_mix_f32 v33, v64, v17, v21 op_sel:[1,0,0] op_sel_hi:[1,0,0]
    v_mfma_f32_16x16x32_bf16 v[132:135], a[204:207], v[52:55], v[132:135]
    ds_read_b64_tr_b16 a[226:227], v3 offset:640
    ds_read_b64_tr_b16 a[228:229], v3 offset:17024
    v_fma_mix_f32 v34, v65, v18, v22 op_sel:[0,0,0] op_sel_hi:[1,0,0]
    v_mfma_f32_16x16x32_bf16 v[164:167], a[200:203], v[56:59], v[164:167]
    s_add_u32 m0, s44, 90624
    ds_read_b64_tr_b16 a[230:231], v3 offset:17536
    v_fma_mix_f32 v35, v65, v19, v23 op_sel:[1,0,0] op_sel_hi:[1,0,0]
    v_mfma_f32_16x16x32_bf16 v[164:167], a[204:207], v[60:63], v[164:167]
    s_mov_b32 s45, 2883584
    s_waitcnt lgkmcnt(10)
    buffer_load_dwordx4 v6, s[24:27], s45 offen lds
    v_mfma_f32_16x16x32_bf16 v[136:139], a[208:211], v[48:51], v[136:139]
    ds_read_b64_tr_b16 a[232:233], v3 offset:160
    v_cvt_pk_bf16_f32 v64, v32, v33
    v_mfma_f32_16x16x32_bf16 v[136:139], a[212:215], v[52:55], v[136:139]
    ds_read_b64_tr_b16 a[234:235], v3 offset:672
    ds_read_b64_tr_b16 a[236:237], v3 offset:17056
    v_cvt_pk_bf16_f32 v65, v34, v35
    v_mfma_f32_16x16x32_bf16 v[168:171], a[208:211], v[56:59], v[168:171]
    s_add_u32 m0, s44, 91680
    ds_read_b64_tr_b16 a[238:239], v3 offset:17568
    v_fma_mix_f32 v36, v72, v16, v20 op_sel:[0,0,0] op_sel_hi:[1,0,0]
    v_mfma_f32_16x16x32_bf16 v[168:171], a[212:215], v[60:63], v[168:171]
    s_mov_b32 s45, 2891776
    s_waitcnt lgkmcnt(9)
    buffer_load_dwordx4 v6, s[24:27], s45 offen lds
    v_fma_mix_f32 v37, v72, v17, v21 op_sel:[1,0,0] op_sel_hi:[1,0,0]
    v_mfma_f32_16x16x32_bf16 v[140:143], a[216:219], v[48:51], v[140:143]
    ds_read_b64_tr_b16 a[240:241], v3 offset:192
    v_fma_mix_f32 v38, v73, v18, v22 op_sel:[0,0,0] op_sel_hi:[1,0,0]
    v_mfma_f32_16x16x32_bf16 v[140:143], a[220:223], v[52:55], v[140:143]
    ds_read_b64_tr_b16 a[242:243], v3 offset:704
    ds_read_b64_tr_b16 a[244:245], v3 offset:17088
    v_fma_mix_f32 v39, v73, v19, v23 op_sel:[1,0,0] op_sel_hi:[1,0,0]
    v_mfma_f32_16x16x32_bf16 v[172:175], a[216:219], v[56:59], v[172:175]
    s_add_u32 m0, s44, 92736
    ds_read_b64_tr_b16 a[246:247], v3 offset:17600
    v_cvt_pk_bf16_f32 v72, v36, v37
    v_mfma_f32_16x16x32_bf16 v[172:175], a[220:223], v[60:63], v[172:175]
    s_mov_b32 s45, 2899968
    s_waitcnt lgkmcnt(8)
    buffer_load_dwordx4 v6, s[24:27], s45 offen lds
    v_cvt_pk_bf16_f32 v73, v38, v39
    v_mfma_f32_16x16x32_bf16 v[144:147], a[224:227], v[48:51], v[144:147]
    ds_read_b64_tr_b16 a[248:249], v3 offset:224
    ds_read_b128 v[16:19], v9 offset:11520
    v_mfma_f32_16x16x32_bf16 v[144:147], a[228:231], v[52:55], v[144:147]
    ds_read_b64_tr_b16 a[250:251], v3 offset:736
    ds_read_b64_tr_b16 a[252:253], v3 offset:17120
    v_mfma_f32_16x16x32_bf16 v[176:179], a[224:227], v[56:59], v[176:179]
    s_add_u32 m0, s44, 93792
    ds_read_b64_tr_b16 a[254:255], v3 offset:17632
    ds_read_b128 v[20:23], v9 offset:11552
    v_mfma_f32_16x16x32_bf16 v[176:179], a[228:231], v[60:63], v[176:179]
    s_mov_b32 s45, 2908160
    s_waitcnt lgkmcnt(10)
    buffer_load_dwordx4 v6, s[24:27], s45 offen lds
    v_mfma_f32_16x16x32_bf16 v[148:151], a[232:235], v[48:51], v[148:151]
    ds_read_b64_tr_b16 a[192:193], v3 offset:256
    v_fma_mix_f32 v32, v66, v24, v28 op_sel:[0,0,0] op_sel_hi:[1,0,0]
    v_mfma_f32_16x16x32_bf16 v[148:151], a[236:239], v[52:55], v[148:151]
    ds_read_b64_tr_b16 a[194:195], v3 offset:768
    v_fma_mix_f32 v33, v66, v25, v29 op_sel:[1,0,0] op_sel_hi:[1,0,0]
    v_mfma_f32_16x16x32_bf16 v[180:183], a[232:235], v[56:59], v[180:183]
    ds_read_b64_tr_b16 a[196:197], v3 offset:17152
    v_fma_mix_f32 v34, v67, v26, v30 op_sel:[0,0,0] op_sel_hi:[1,0,0]
    v_mfma_f32_16x16x32_bf16 v[180:183], a[236:239], v[60:63], v[180:183]
    s_waitcnt lgkmcnt(9)
    ds_read_b64_tr_b16 a[198:199], v3 offset:17664
    v_fma_mix_f32 v35, v67, v27, v31 op_sel:[1,0,0] op_sel_hi:[1,0,0]
    v_mfma_f32_16x16x32_bf16 v[152:155], a[240:243], v[48:51], v[152:155]
    ds_read_b64_tr_b16 a[200:201], v3 offset:288
    v_cvt_pk_bf16_f32 v66, v32, v33
    v_mfma_f32_16x16x32_bf16 v[152:155], a[244:247], v[52:55], v[152:155]
    ds_read_b64_tr_b16 a[202:203], v3 offset:800
    v_cvt_pk_bf16_f32 v67, v34, v35
    v_mfma_f32_16x16x32_bf16 v[184:187], a[240:243], v[56:59], v[184:187]
    ds_read_b64_tr_b16 a[204:205], v3 offset:17184
    v_fma_mix_f32 v36, v74, v24, v28 op_sel:[0,0,0] op_sel_hi:[1,0,0]
    v_mfma_f32_16x16x32_bf16 v[184:187], a[244:247], v[60:63], v[184:187]
    s_waitcnt lgkmcnt(8)
    ds_read_b64_tr_b16 a[206:207], v3 offset:17696
    v_fma_mix_f32 v37, v74, v25, v29 op_sel:[1,0,0] op_sel_hi:[1,0,0]
    v_mfma_f32_16x16x32_bf16 v[156:159], a[248:251], v[48:51], v[156:159]
    ds_read_b64_tr_b16 a[208:209], v3 offset:320
    v_fma_mix_f32 v38, v75, v26, v30 op_sel:[0,0,0] op_sel_hi:[1,0,0]
    v_mfma_f32_16x16x32_bf16 v[156:159], a[252:255], v[52:55], v[156:159]
    ds_read_b64_tr_b16 a[210:211], v3 offset:832
    v_fma_mix_f32 v39, v75, v27, v31 op_sel:[1,0,0] op_sel_hi:[1,0,0]
    v_mfma_f32_16x16x32_bf16 v[188:191], a[248:251], v[56:59], v[188:191]
    ds_read_b64_tr_b16 a[212:213], v3 offset:17216
    v_cvt_pk_bf16_f32 v74, v36, v37
    v_mfma_f32_16x16x32_bf16 v[188:191], a[252:255], v[60:63], v[188:191]
    s_waitcnt lgkmcnt(7)
    ds_read_b64_tr_b16 a[214:215], v3 offset:17728
    v_cvt_pk_bf16_f32 v75, v38, v39
    v_mfma_f32_16x16x32_bf16 v[192:195], a[192:195], v[48:51], v[192:195]
    ds_read_b64_tr_b16 a[216:217], v3 offset:352
    ds_read_b128 v[24:27], v9 offset:11536
    v_mfma_f32_16x16x32_bf16 v[192:195], a[196:199], v[52:55], v[192:195]
    ds_read_b64_tr_b16 a[218:219], v3 offset:864
    ds_read_b64_tr_b16 a[220:221], v3 offset:17248
    v_fma_mix_f32 v32, v68, v16, v20 op_sel:[0,0,0] op_sel_hi:[1,0,0]
    v_mfma_f32_16x16x32_bf16 v[224:227], a[192:195], v[56:59], v[224:227]
    s_mov_b32 s54, 12288
    ds_read_b64_tr_b16 a[222:223], v3 offset:17760
    ds_read_b128 v[28:31], v9 offset:11568
    v_mfma_f32_16x16x32_bf16 v[224:227], a[196:199], v[60:63], v[224:227]
    s_waitcnt lgkmcnt(10)
    buffer_load_dwordx4 v[96:99], v8, s[32:35], s54 offen sc1
    v_mfma_f32_16x16x32_bf16 v[196:199], a[200:203], v[48:51], v[196:199]
    ds_read_b64_tr_b16 a[224:225], v3 offset:384
    v_fma_mix_f32 v33, v68, v17, v21 op_sel:[1,0,0] op_sel_hi:[1,0,0]
    v_mfma_f32_16x16x32_bf16 v[196:199], a[204:207], v[52:55], v[196:199]
    ds_read_b64_tr_b16 a[226:227], v3 offset:896
    ds_read_b64_tr_b16 a[228:229], v3 offset:17280
    v_fma_mix_f32 v34, v69, v18, v22 op_sel:[0,0,0] op_sel_hi:[1,0,0]
    v_mfma_f32_16x16x32_bf16 v[228:231], a[200:203], v[56:59], v[228:231]
    s_mov_b32 s54, 13312
    ds_read_b64_tr_b16 a[230:231], v3 offset:17792
    v_fma_mix_f32 v35, v69, v19, v23 op_sel:[1,0,0] op_sel_hi:[1,0,0]
    v_mfma_f32_16x16x32_bf16 v[228:231], a[204:207], v[60:63], v[228:231]
    s_waitcnt lgkmcnt(10)
    buffer_load_dwordx4 v[100:103], v8, s[32:35], s54 offen sc1
    v_mfma_f32_16x16x32_bf16 v[200:203], a[208:211], v[48:51], v[200:203]
    ds_read_b64_tr_b16 a[232:233], v3 offset:416
    v_cvt_pk_bf16_f32 v68, v32, v33
    v_mfma_f32_16x16x32_bf16 v[200:203], a[212:215], v[52:55], v[200:203]
    ds_read_b64_tr_b16 a[234:235], v3 offset:928
    ds_read_b64_tr_b16 a[236:237], v3 offset:17312
    v_cvt_pk_bf16_f32 v69, v34, v35
    v_mfma_f32_16x16x32_bf16 v[232:235], a[208:211], v[56:59], v[232:235]
    s_mov_b32 s54, 30720
    ds_read_b64_tr_b16 a[238:239], v3 offset:17824
    v_fma_mix_f32 v36, v76, v16, v20 op_sel:[0,0,0] op_sel_hi:[1,0,0]
    v_mfma_f32_16x16x32_bf16 v[232:235], a[212:215], v[60:63], v[232:235]
    s_waitcnt lgkmcnt(9)
    buffer_load_dwordx4 v[104:107], v8, s[32:35], s54 offen sc1
    v_fma_mix_f32 v37, v76, v17, v21 op_sel:[1,0,0] op_sel_hi:[1,0,0]
    v_mfma_f32_16x16x32_bf16 v[204:207], a[216:219], v[48:51], v[204:207]
    ds_read_b64_tr_b16 a[240:241], v3 offset:448
    v_fma_mix_f32 v38, v77, v18, v22 op_sel:[0,0,0] op_sel_hi:[1,0,0]
    v_mfma_f32_16x16x32_bf16 v[204:207], a[220:223], v[52:55], v[204:207]
    ds_read_b64_tr_b16 a[242:243], v3 offset:960
    ds_read_b64_tr_b16 a[244:245], v3 offset:17344
    v_fma_mix_f32 v39, v77, v19, v23 op_sel:[1,0,0] op_sel_hi:[1,0,0]
    v_mfma_f32_16x16x32_bf16 v[236:239], a[216:219], v[56:59], v[236:239]
    s_mov_b32 s54, 31744
    ds_read_b64_tr_b16 a[246:247], v3 offset:17856
    v_cvt_pk_bf16_f32 v76, v36, v37
    v_mfma_f32_16x16x32_bf16 v[236:239], a[220:223], v[60:63], v[236:239]
    s_waitcnt lgkmcnt(8)
    buffer_load_dwordx4 v[108:111], v8, s[32:35], s54 offen sc1
    v_cvt_pk_bf16_f32 v77, v38, v39
    v_mfma_f32_16x16x32_bf16 v[208:211], a[224:227], v[48:51], v[208:211]
    ds_read_b64_tr_b16 a[248:249], v3 offset:480
    ds_read_b128 v[16:19], v9 offset:11776
    v_mfma_f32_16x16x32_bf16 v[208:211], a[228:231], v[52:55], v[208:211]
    ds_read_b64_tr_b16 a[250:251], v3 offset:992
    ds_read_b128 v[20:23], v9 offset:11808
    v_mfma_f32_16x16x32_bf16 v[240:243], a[224:227], v[56:59], v[240:243]
    ds_read_b64_tr_b16 a[252:253], v3 offset:17376
    v_fma_mix_f32 v32, v70, v24, v28 op_sel:[0,0,0] op_sel_hi:[1,0,0]
    v_mfma_f32_16x16x32_bf16 v[240:243], a[228:231], v[60:63], v[240:243]
    s_waitcnt vmcnt(16)
    s_barrier
    s_waitcnt lgkmcnt(9)
    ds_read_b64_tr_b16 a[254:255], v3 offset:17888
    v_fma_mix_f32 v33, v70, v25, v29 op_sel:[1,0,0] op_sel_hi:[1,0,0]
    v_fma_mix_f32 v34, v71, v26, v30 op_sel:[0,0,0] op_sel_hi:[1,0,0]
    v_mfma_f32_16x16x32_bf16 v[212:215], a[232:235], v[48:51], v[212:215]
    ds_read_b64_tr_b16 a[192:193], v3 offset:36864
    v_fma_mix_f32 v35, v71, v27, v31 op_sel:[1,0,0] op_sel_hi:[1,0,0]
    v_mfma_f32_16x16x32_bf16 v[212:215], a[236:239], v[52:55], v[212:215]
    ds_read_b64_tr_b16 a[194:195], v3 offset:37376
    ds_read_b64_tr_b16 a[196:197], v3 offset:53760
    v_cvt_pk_bf16_f32 v70, v32, v33
    v_mfma_f32_16x16x32_bf16 v[244:247], a[232:235], v[56:59], v[244:247]
    s_add_u32 m0, s44, 110592
    ds_read_b64_tr_b16 a[198:199], v3 offset:54272
    v_cvt_pk_bf16_f32 v71, v34, v35
    v_mfma_f32_16x16x32_bf16 v[244:247], a[236:239], v[60:63], v[244:247]
    s_mov_b32 s45, 3145728
    s_waitcnt lgkmcnt(10)
    buffer_load_dwordx4 v6, s[24:27], s45 offen lds
    v_mfma_f32_16x16x32_bf16 v[216:219], a[240:243], v[48:51], v[216:219]
    ds_read_b64_tr_b16 a[200:201], v3 offset:36896
    v_fma_mix_f32 v36, v78, v24, v28 op_sel:[0,0,0] op_sel_hi:[1,0,0]
    v_mfma_f32_16x16x32_bf16 v[216:219], a[244:247], v[52:55], v[216:219]
    ds_read_b64_tr_b16 a[202:203], v3 offset:37408
    ds_read_b64_tr_b16 a[204:205], v3 offset:53792
    v_fma_mix_f32 v37, v78, v25, v29 op_sel:[1,0,0] op_sel_hi:[1,0,0]
    v_mfma_f32_16x16x32_bf16 v[248:251], a[240:243], v[56:59], v[248:251]
    s_add_u32 m0, s44, 111648
    ds_read_b64_tr_b16 a[206:207], v3 offset:54304
    v_fma_mix_f32 v38, v79, v26, v30 op_sel:[0,0,0] op_sel_hi:[1,0,0]
    v_mfma_f32_16x16x32_bf16 v[248:251], a[244:247], v[60:63], v[248:251]
    s_mov_b32 s45, 3153920
    s_waitcnt lgkmcnt(8)
    buffer_load_dwordx4 v6, s[24:27], s45 offen lds
    v_mfma_f32_16x16x32_bf16 v[220:223], a[248:251], v[48:51], v[220:223]
L2_pad1:
    s_cbranch_execz L2_pad5
    ds_read_b64_tr_b16 a[208:209], v3 offset:36928
    v_fma_mix_f32 v39, v79, v27, v31 op_sel:[1,0,0] op_sel_hi:[1,0,0]
    v_mfma_f32_16x16x32_bf16 v[220:223], a[252:255], v[52:55], v[220:223]
    ds_read_b64_tr_b16 a[210:211], v3 offset:37440
    ds_read_b64_tr_b16 a[212:213], v3 offset:53824
    v_cvt_pk_bf16_f32 v78, v36, v37
    v_mfma_f32_16x16x32_bf16 v[252:255], a[248:251], v[56:59], v[252:255]
    s_add_u32 m0, s44, 112704
    ds_read_b64_tr_b16 a[214:215], v3 offset:54336
    v_cvt_pk_bf16_f32 v79, v38, v39
    v_mfma_f32_16x16x32_bf16 v[252:255], a[252:255], v[60:63], v[252:255]
    s_mov_b32 s45, 3162112
    s_waitcnt lgkmcnt(8)
    buffer_load_dwordx4 v6, s[24:27], s45 offen lds
    v_mfma_f32_16x16x32_bf16 v[128:131], a[192:195], v[64:67], v[128:131]
    s_waitcnt vmcnt(15)
    ds_read_b64_tr_b16 a[216:217], v3 offset:36960
    ds_read_b128 v[24:27], v9 offset:11792
    v_mfma_f32_16x16x32_bf16 v[128:131], a[196:199], v[68:71], v[128:131]
    ds_read_b64_tr_b16 a[218:219], v3 offset:37472
    ds_read_b64_tr_b16 a[220:221], v3 offset:53856
    v_fma_mix_f32 v32, v80, v16, v20 op_sel:[0,0,0] op_sel_hi:[1,0,0]
    v_mfma_f32_16x16x32_bf16 v[160:163], a[192:195], v[72:75], v[160:163]
    s_add_u32 m0, s44, 113760
    ds_read_b64_tr_b16 a[222:223], v3 offset:54368
    ds_read_b128 v[28:31], v9 offset:11824
    v_mfma_f32_16x16x32_bf16 v[160:163], a[196:199], v[76:79], v[160:163]
    s_mov_b32 s45, 3170304
    s_waitcnt lgkmcnt(10)
    buffer_load_dwordx4 v6, s[24:27], s45 offen lds
    v_mfma_f32_16x16x32_bf16 v[132:135], a[200:203], v[64:67], v[132:135]
    ds_read_b64_tr_b16 a[224:225], v3 offset:36992
    v_fma_mix_f32 v33, v80, v17, v21 op_sel:[1,0,0] op_sel_hi:[1,0,0]
    v_mfma_f32_16x16x32_bf16 v[132:135], a[204:207], v[68:71], v[132:135]
    ds_read_b64_tr_b16 a[226:227], v3 offset:37504
    ds_read_b64_tr_b16 a[228:229], v3 offset:53888
    v_fma_mix_f32 v34, v81, v18, v22 op_sel:[0,0,0] op_sel_hi:[1,0,0]
    v_mfma_f32_16x16x32_bf16 v[164:167], a[200:203], v[72:75], v[164:167]
    s_add_u32 m0, s44, 127488
    ds_read_b64_tr_b16 a[230:231], v3 offset:54400
    v_fma_mix_f32 v35, v81, v19, v23 op_sel:[1,0,0] op_sel_hi:[1,0,0]
    v_mfma_f32_16x16x32_bf16 v[164:167], a[204:207], v[76:79], v[164:167]
    s_mov_b32 s45, 3407872
    s_waitcnt lgkmcnt(10)
    buffer_load_dwordx4 v6, s[24:27], s45 offen lds
    v_mfma_f32_16x16x32_bf16 v[136:139], a[208:211], v[64:67], v[136:139]
    ds_read_b64_tr_b16 a[232:233], v3 offset:37024
    v_cvt_pk_bf16_f32 v80, v32, v33
    v_mfma_f32_16x16x32_bf16 v[136:139], a[212:215], v[68:71], v[136:139]
    ds_read_b64_tr_b16 a[234:235], v3 offset:37536
    ds_read_b64_tr_b16 a[236:237], v3 offset:53920
    v_cvt_pk_bf16_f32 v81, v34, v35
    v_mfma_f32_16x16x32_bf16 v[168:171], a[208:211], v[72:75], v[168:171]
    s_add_u32 m0, s44, 128544
    ds_read_b64_tr_b16 a[238:239], v3 offset:54432
    v_fma_mix_f32 v36, v88, v16, v20 op_sel:[0,0,0] op_sel_hi:[1,0,0]
    v_mfma_f32_16x16x32_bf16 v[168:171], a[212:215], v[76:79], v[168:171]
    s_mov_b32 s45, 3416064
    s_waitcnt lgkmcnt(9)
    buffer_load_dwordx4 v6, s[24:27], s45 offen lds
    v_fma_mix_f32 v37, v88, v17, v21 op_sel:[1,0,0] op_sel_hi:[1,0,0]
    v_mfma_f32_16x16x32_bf16 v[140:143], a[216:219], v[64:67], v[140:143]
    ds_read_b64_tr_b16 a[240:241], v3 offset:37056
    v_fma_mix_f32 v38, v89, v18, v22 op_sel:[0,0,0] op_sel_hi:[1,0,0]
    v_mfma_f32_16x16x32_bf16 v[140:143], a[220:223], v[68:71], v[140:143]
    ds_read_b64_tr_b16 a[242:243], v3 offset:37568
    ds_read_b64_tr_b16 a[244:245], v3 offset:53952
    v_fma_mix_f32 v39, v89, v19, v23 op_sel:[1,0,0] op_sel_hi:[1,0,0]
    v_mfma_f32_16x16x32_bf16 v[172:175], a[216:219], v[72:75], v[172:175]
    s_add_u32 m0, s44, 129600
    ds_read_b64_tr_b16 a[246:247], v3 offset:54464
    v_cvt_pk_bf16_f32 v88, v36, v37
    v_mfma_f32_16x16x32_bf16 v[172:175], a[220:223], v[76:79], v[172:175]
    s_mov_b32 s45, 3424256
    s_waitcnt lgkmcnt(8)
    buffer_load_dwordx4 v6, s[24:27], s45 offen lds
    v_cvt_pk_bf16_f32 v89, v38, v39
    v_mfma_f32_16x16x32_bf16 v[144:147], a[224:227], v[64:67], v[144:147]
    ds_read_b64_tr_b16 a[248:249], v3 offset:37088
    ds_read_b128 v[16:19], v9 offset:12032
    v_mfma_f32_16x16x32_bf16 v[144:147], a[228:231], v[68:71], v[144:147]
    ds_read_b64_tr_b16 a[250:251], v3 offset:37600
    ds_read_b64_tr_b16 a[252:253], v3 offset:53984
    v_mfma_f32_16x16x32_bf16 v[176:179], a[224:227], v[72:75], v[176:179]
    s_add_u32 m0, s44, 130656
    ds_read_b64_tr_b16 a[254:255], v3 offset:54496
    ds_read_b128 v[20:23], v9 offset:12064
    v_mfma_f32_16x16x32_bf16 v[176:179], a[228:231], v[76:79], v[176:179]
    s_mov_b32 s45, 3432448
    s_waitcnt lgkmcnt(10)
    buffer_load_dwordx4 v6, s[24:27], s45 offen lds
    v_mfma_f32_16x16x32_bf16 v[148:151], a[232:235], v[64:67], v[148:151]
    ds_read_b64_tr_b16 a[192:193], v3 offset:37120
    v_fma_mix_f32 v32, v82, v24, v28 op_sel:[0,0,0] op_sel_hi:[1,0,0]
    v_mfma_f32_16x16x32_bf16 v[148:151], a[236:239], v[68:71], v[148:151]
    ds_read_b64_tr_b16 a[194:195], v3 offset:37632
    v_fma_mix_f32 v33, v82, v25, v29 op_sel:[1,0,0] op_sel_hi:[1,0,0]
    v_mfma_f32_16x16x32_bf16 v[180:183], a[232:235], v[72:75], v[180:183]
    ds_read_b64_tr_b16 a[196:197], v3 offset:54016
    v_fma_mix_f32 v34, v83, v26, v30 op_sel:[0,0,0] op_sel_hi:[1,0,0]
    v_mfma_f32_16x16x32_bf16 v[180:183], a[236:239], v[76:79], v[180:183]
    s_waitcnt lgkmcnt(9)
    ds_read_b64_tr_b16 a[198:199], v3 offset:54528
    v_fma_mix_f32 v35, v83, v27, v31 op_sel:[1,0,0] op_sel_hi:[1,0,0]
    v_mfma_f32_16x16x32_bf16 v[152:155], a[240:243], v[64:67], v[152:155]
    ds_read_b64_tr_b16 a[200:201], v3 offset:37152
    v_cvt_pk_bf16_f32 v82, v32, v33
    v_mfma_f32_16x16x32_bf16 v[152:155], a[244:247], v[68:71], v[152:155]
    ds_read_b64_tr_b16 a[202:203], v3 offset:37664
    v_cvt_pk_bf16_f32 v83, v34, v35
    v_mfma_f32_16x16x32_bf16 v[184:187], a[240:243], v[72:75], v[184:187]
    ds_read_b64_tr_b16 a[204:205], v3 offset:54048
    v_fma_mix_f32 v36, v90, v24, v28 op_sel:[0,0,0] op_sel_hi:[1,0,0]
    v_mfma_f32_16x16x32_bf16 v[184:187], a[244:247], v[76:79], v[184:187]
    s_waitcnt lgkmcnt(8)
    ds_read_b64_tr_b16 a[206:207], v3 offset:54560
    v_fma_mix_f32 v37, v90, v25, v29 op_sel:[1,0,0] op_sel_hi:[1,0,0]
    v_mfma_f32_16x16x32_bf16 v[156:159], a[248:251], v[64:67], v[156:159]
    ds_read_b64_tr_b16 a[208:209], v3 offset:37184
    v_fma_mix_f32 v38, v91, v26, v30 op_sel:[0,0,0] op_sel_hi:[1,0,0]
    v_mfma_f32_16x16x32_bf16 v[156:159], a[252:255], v[68:71], v[156:159]
    ds_read_b64_tr_b16 a[210:211], v3 offset:37696
    v_fma_mix_f32 v39, v91, v27, v31 op_sel:[1,0,0] op_sel_hi:[1,0,0]
    v_mfma_f32_16x16x32_bf16 v[188:191], a[248:251], v[72:75], v[188:191]
    ds_read_b64_tr_b16 a[212:213], v3 offset:54080
    v_cvt_pk_bf16_f32 v90, v36, v37
    v_mfma_f32_16x16x32_bf16 v[188:191], a[252:255], v[76:79], v[188:191]
    s_waitcnt lgkmcnt(7)
    ds_read_b64_tr_b16 a[214:215], v3 offset:54592
    v_cvt_pk_bf16_f32 v91, v38, v39
    v_mfma_f32_16x16x32_bf16 v[192:195], a[192:195], v[64:67], v[192:195]
    ds_read_b64_tr_b16 a[216:217], v3 offset:37216
    ds_read_b128 v[24:27], v9 offset:12048
    v_mfma_f32_16x16x32_bf16 v[192:195], a[196:199], v[68:71], v[192:195]
    ds_read_b64_tr_b16 a[218:219], v3 offset:37728
    ds_read_b64_tr_b16 a[220:221], v3 offset:54112
    v_fma_mix_f32 v32, v84, v16, v20 op_sel:[0,0,0] op_sel_hi:[1,0,0]
    v_mfma_f32_16x16x32_bf16 v[224:227], a[192:195], v[72:75], v[224:227]
    s_mov_b32 s54, 14336
    ds_read_b64_tr_b16 a[222:223], v3 offset:54624
    ds_read_b128 v[28:31], v9 offset:12080
    v_mfma_f32_16x16x32_bf16 v[224:227], a[196:199], v[76:79], v[224:227]
    s_waitcnt lgkmcnt(10)
    buffer_load_dwordx4 v[112:115], v8, s[32:35], s54 offen sc1
    v_mfma_f32_16x16x32_bf16 v[196:199], a[200:203], v[64:67], v[196:199]
    ds_read_b64_tr_b16 a[224:225], v3 offset:37248
    v_fma_mix_f32 v33, v84, v17, v21 op_sel:[1,0,0] op_sel_hi:[1,0,0]
    v_mfma_f32_16x16x32_bf16 v[196:199], a[204:207], v[68:71], v[196:199]
    ds_read_b64_tr_b16 a[226:227], v3 offset:37760
    ds_read_b64_tr_b16 a[228:229], v3 offset:54144
    v_fma_mix_f32 v34, v85, v18, v22 op_sel:[0,0,0] op_sel_hi:[1,0,0]
    v_mfma_f32_16x16x32_bf16 v[228:231], a[200:203], v[72:75], v[228:231]
    s_mov_b32 s54, 15360
    ds_read_b64_tr_b16 a[230:231], v3 offset:54656
    v_fma_mix_f32 v35, v85, v19, v23 op_sel:[1,0,0] op_sel_hi:[1,0,0]
    v_mfma_f32_16x16x32_bf16 v[228:231], a[204:207], v[76:79], v[228:231]
    s_waitcnt lgkmcnt(10)
    buffer_load_dwordx4 v[116:119], v8, s[32:35], s54 offen sc1
    v_mfma_f32_16x16x32_bf16 v[200:203], a[208:211], v[64:67], v[200:203]
    ds_read_b64_tr_b16 a[232:233], v3 offset:37280
    v_cvt_pk_bf16_f32 v84, v32, v33
    v_mfma_f32_16x16x32_bf16 v[200:203], a[212:215], v[68:71], v[200:203]
    ds_read_b64_tr_b16 a[234:235], v3 offset:37792
    ds_read_b64_tr_b16 a[236:237], v3 offset:54176
    v_cvt_pk_bf16_f32 v85, v34, v35
    v_mfma_f32_16x16x32_bf16 v[232:235], a[208:211], v[72:75], v[232:235]
    s_mov_b32 s54, 32768
    ds_read_b64_tr_b16 a[238:239], v3 offset:54688
    v_fma_mix_f32 v36, v92, v16, v20 op_sel:[0,0,0] op_sel_hi:[1,0,0]
    v_mfma_f32_16x16x32_bf16 v[232:235], a[212:215], v[76:79], v[232:235]
    s_waitcnt lgkmcnt(9)
    buffer_load_dwordx4 v[120:123], v8, s[32:35], s54 offen sc1
    v_fma_mix_f32 v37, v92, v17, v21 op_sel:[1,0,0] op_sel_hi:[1,0,0]
    v_mfma_f32_16x16x32_bf16 v[204:207], a[216:219], v[64:67], v[204:207]
    ds_read_b64_tr_b16 a[240:241], v3 offset:37312
    v_fma_mix_f32 v38, v93, v18, v22 op_sel:[0,0,0] op_sel_hi:[1,0,0]
    v_mfma_f32_16x16x32_bf16 v[204:207], a[220:223], v[68:71], v[204:207]
    ds_read_b64_tr_b16 a[242:243], v3 offset:37824
    ds_read_b64_tr_b16 a[244:245], v3 offset:54208
    v_fma_mix_f32 v39, v93, v19, v23 op_sel:[1,0,0] op_sel_hi:[1,0,0]
    v_mfma_f32_16x16x32_bf16 v[236:239], a[216:219], v[72:75], v[236:239]
    s_mov_b32 s54, 33792
    ds_read_b64_tr_b16 a[246:247], v3 offset:54720
    v_cvt_pk_bf16_f32 v92, v36, v37
    v_mfma_f32_16x16x32_bf16 v[236:239], a[220:223], v[76:79], v[236:239]
    s_waitcnt lgkmcnt(8)
    buffer_load_dwordx4 v[124:127], v8, s[32:35], s54 offen sc1
    v_cvt_pk_bf16_f32 v93, v38, v39
    v_mfma_f32_16x16x32_bf16 v[208:211], a[224:227], v[64:67], v[208:211]
    ds_read_b64_tr_b16 a[248:249], v3 offset:37344
    ds_read_b128 v[16:19], v9 offset:12288
    v_mfma_f32_16x16x32_bf16 v[208:211], a[228:231], v[68:71], v[208:211]
    ds_read_b64_tr_b16 a[250:251], v3 offset:37856
    ds_read_b128 v[20:23], v9 offset:12320
    v_mfma_f32_16x16x32_bf16 v[240:243], a[224:227], v[72:75], v[240:243]
    ds_read_b64_tr_b16 a[252:253], v3 offset:54240
    v_fma_mix_f32 v32, v86, v24, v28 op_sel:[0,0,0] op_sel_hi:[1,0,0]
    v_mfma_f32_16x16x32_bf16 v[240:243], a[228:231], v[76:79], v[240:243]
    s_waitcnt vmcnt(16)
    s_barrier
    s_waitcnt lgkmcnt(9)
    ds_read_b64_tr_b16 a[254:255], v3 offset:54752
    v_fma_mix_f32 v33, v86, v25, v29 op_sel:[1,0,0] op_sel_hi:[1,0,0]
    v_fma_mix_f32 v34, v87, v26, v30 op_sel:[0,0,0] op_sel_hi:[1,0,0]
    v_mfma_f32_16x16x32_bf16 v[212:215], a[232:235], v[64:67], v[212:215]
    ds_read_b64_tr_b16 a[192:193], v4 offset:0
    v_fma_mix_f32 v35, v87, v27, v31 op_sel:[1,0,0] op_sel_hi:[1,0,0]
    v_mfma_f32_16x16x32_bf16 v[212:215], a[236:239], v[68:71], v[212:215]
    ds_read_b64_tr_b16 a[194:195], v4 offset:512
    ds_read_b64_tr_b16 a[196:197], v4 offset:16896
    v_cvt_pk_bf16_f32 v86, v32, v33
    v_mfma_f32_16x16x32_bf16 v[244:247], a[232:235], v[72:75], v[244:247]
    s_add_u32 m0, s44, 0
    ds_read_b64_tr_b16 a[198:199], v4 offset:17408
    v_cvt_pk_bf16_f32 v87, v34, v35
    v_mfma_f32_16x16x32_bf16 v[244:247], a[236:239], v[76:79], v[244:247]
    s_mov_b32 s45, 3670016
    s_waitcnt lgkmcnt(10)
    buffer_load_dwordx4 v6, s[24:27], s45 offen lds
    v_mfma_f32_16x16x32_bf16 v[216:219], a[240:243], v[64:67], v[216:219]
    ds_read_b64_tr_b16 a[200:201], v4 offset:32
    v_fma_mix_f32 v36, v94, v24, v28 op_sel:[0,0,0] op_sel_hi:[1,0,0]
    v_mfma_f32_16x16x32_bf16 v[216:219], a[244:247], v[68:71], v[216:219]
    ds_read_b64_tr_b16 a[202:203], v4 offset:544
    ds_read_b64_tr_b16 a[204:205], v4 offset:16928
    v_fma_mix_f32 v37, v94, v25, v29 op_sel:[1,0,0] op_sel_hi:[1,0,0]
    v_mfma_f32_16x16x32_bf16 v[248:251], a[240:243], v[72:75], v[248:251]
    s_add_u32 m0, s44, 1056
    ds_read_b64_tr_b16 a[206:207], v4 offset:17440
    v_fma_mix_f32 v38, v95, v26, v30 op_sel:[0,0,0] op_sel_hi:[1,0,0]
    v_mfma_f32_16x16x32_bf16 v[248:251], a[244:247], v[76:79], v[248:251]
    s_mov_b32 s45, 3678208
    s_waitcnt lgkmcnt(8)
    buffer_load_dwordx4 v6, s[24:27], s45 offen lds
    v_mfma_f32_16x16x32_bf16 v[220:223], a[248:251], v[64:67], v[220:223]
    ds_read_b64_tr_b16 a[208:209], v4 offset:64
    v_fma_mix_f32 v39, v95, v27, v31 op_sel:[1,0,0] op_sel_hi:[1,0,0]
    v_mfma_f32_16x16x32_bf16 v[220:223], a[252:255], v[68:71], v[220:223]
    ds_read_b64_tr_b16 a[210:211], v4 offset:576
    ds_read_b64_tr_b16 a[212:213], v4 offset:16960
    v_cvt_pk_bf16_f32 v94, v36, v37
    v_mfma_f32_16x16x32_bf16 v[252:255], a[248:251], v[72:75], v[252:255]
    s_add_u32 m0, s44, 2112
    ds_read_b64_tr_b16 a[214:215], v4 offset:17472
    v_cvt_pk_bf16_f32 v95, v38, v39
    v_mfma_f32_16x16x32_bf16 v[252:255], a[252:255], v[76:79], v[252:255]
    s_mov_b32 s45, 3686400
    s_waitcnt lgkmcnt(8)
    buffer_load_dwordx4 v6, s[24:27], s45 offen lds
    v_mfma_f32_16x16x32_bf16 v[128:131], a[192:195], v[80:83], v[128:131]
    s_waitcnt vmcnt(15)
    ds_read_b64_tr_b16 a[216:217], v4 offset:96
    ds_read_b128 v[24:27], v9 offset:12304
    v_mfma_f32_16x16x32_bf16 v[128:131], a[196:199], v[84:87], v[128:131]
    ds_read_b64_tr_b16 a[218:219], v4 offset:608
    ds_read_b64_tr_b16 a[220:221], v4 offset:16992
    v_fma_mix_f32 v32, v96, v16, v20 op_sel:[0,0,0] op_sel_hi:[1,0,0]
    v_mfma_f32_16x16x32_bf16 v[160:163], a[192:195], v[88:91], v[160:163]
    s_add_u32 m0, s44, 3168
    ds_read_b64_tr_b16 a[222:223], v4 offset:17504
    ds_read_b128 v[28:31], v9 offset:12336
    v_mfma_f32_16x16x32_bf16 v[160:163], a[196:199], v[92:95], v[160:163]
    s_mov_b32 s45, 3694592
    s_waitcnt lgkmcnt(10)
    buffer_load_dwordx4 v6, s[24:27], s45 offen lds
    v_mfma_f32_16x16x32_bf16 v[132:135], a[200:203], v[80:83], v[132:135]
    ds_read_b64_tr_b16 a[224:225], v4 offset:128
    v_fma_mix_f32 v33, v96, v17, v21 op_sel:[1,0,0] op_sel_hi:[1,0,0]
    v_mfma_f32_16x16x32_bf16 v[132:135], a[204:207], v[84:87], v[132:135]
    ds_read_b64_tr_b16 a[226:227], v4 offset:640
    ds_read_b64_tr_b16 a[228:229], v4 offset:17024
    v_fma_mix_f32 v34, v97, v18, v22 op_sel:[0,0,0] op_sel_hi:[1,0,0]
    v_mfma_f32_16x16x32_bf16 v[164:167], a[200:203], v[88:91], v[164:167]
    s_add_u32 m0, s44, 16896
    ds_read_b64_tr_b16 a[230:231], v4 offset:17536
    v_fma_mix_f32 v35, v97, v19, v23 op_sel:[1,0,0] op_sel_hi:[1,0,0]
    v_mfma_f32_16x16x32_bf16 v[164:167], a[204:207], v[92:95], v[164:167]
    s_mov_b32 s45, 3932160
    s_waitcnt lgkmcnt(10)
    buffer_load_dwordx4 v6, s[24:27], s45 offen lds
    v_mfma_f32_16x16x32_bf16 v[136:139], a[208:211], v[80:83], v[136:139]
    ds_read_b64_tr_b16 a[232:233], v4 offset:160
    v_cvt_pk_bf16_f32 v96, v32, v33
    v_mfma_f32_16x16x32_bf16 v[136:139], a[212:215], v[84:87], v[136:139]
    ds_read_b64_tr_b16 a[234:235], v4 offset:672
    ds_read_b64_tr_b16 a[236:237], v4 offset:17056
    v_cvt_pk_bf16_f32 v97, v34, v35
    v_mfma_f32_16x16x32_bf16 v[168:171], a[208:211], v[88:91], v[168:171]
    s_add_u32 m0, s44, 17952
    ds_read_b64_tr_b16 a[238:239], v4 offset:17568
    v_fma_mix_f32 v36, v104, v16, v20 op_sel:[0,0,0] op_sel_hi:[1,0,0]
    v_mfma_f32_16x16x32_bf16 v[168:171], a[212:215], v[92:95], v[168:171]
    s_mov_b32 s45, 3940352
    s_waitcnt lgkmcnt(9)
    buffer_load_dwordx4 v6, s[24:27], s45 offen lds
    v_fma_mix_f32 v37, v104, v17, v21 op_sel:[1,0,0] op_sel_hi:[1,0,0]
    v_mfma_f32_16x16x32_bf16 v[140:143], a[216:219], v[80:83], v[140:143]
    ds_read_b64_tr_b16 a[240:241], v4 offset:192
    v_fma_mix_f32 v38, v105, v18, v22 op_sel:[0,0,0] op_sel_hi:[1,0,0]
    v_mfma_f32_16x16x32_bf16 v[140:143], a[220:223], v[84:87], v[140:143]
    ds_read_b64_tr_b16 a[242:243], v4 offset:704
    ds_read_b64_tr_b16 a[244:245], v4 offset:17088
    v_fma_mix_f32 v39, v105, v19, v23 op_sel:[1,0,0] op_sel_hi:[1,0,0]
    v_mfma_f32_16x16x32_bf16 v[172:175], a[216:219], v[88:91], v[172:175]
    s_add_u32 m0, s44, 19008
    ds_read_b64_tr_b16 a[246:247], v4 offset:17600
    v_cvt_pk_bf16_f32 v104, v36, v37
    v_mfma_f32_16x16x32_bf16 v[172:175], a[220:223], v[92:95], v[172:175]
    s_mov_b32 s45, 3948544
    s_waitcnt lgkmcnt(8)
    buffer_load_dwordx4 v6, s[24:27], s45 offen lds
    v_cvt_pk_bf16_f32 v105, v38, v39
    v_mfma_f32_16x16x32_bf16 v[144:147], a[224:227], v[80:83], v[144:147]
    ds_read_b64_tr_b16 a[248:249], v4 offset:224
    ds_read_b128 v[16:19], v9 offset:12544
    v_mfma_f32_16x16x32_bf16 v[144:147], a[228:231], v[84:87], v[144:147]
    ds_read_b64_tr_b16 a[250:251], v4 offset:736
    ds_read_b64_tr_b16 a[252:253], v4 offset:17120
    v_mfma_f32_16x16x32_bf16 v[176:179], a[224:227], v[88:91], v[176:179]
    s_add_u32 m0, s44, 20064
    ds_read_b64_tr_b16 a[254:255], v4 offset:17632
    ds_read_b128 v[20:23], v9 offset:12576
    v_mfma_f32_16x16x32_bf16 v[176:179], a[228:231], v[92:95], v[176:179]
    s_mov_b32 s45, 3956736
    s_waitcnt lgkmcnt(10)
    buffer_load_dwordx4 v6, s[24:27], s45 offen lds
    v_mfma_f32_16x16x32_bf16 v[148:151], a[232:235], v[80:83], v[148:151]
    ds_read_b64_tr_b16 a[192:193], v4 offset:256
    v_fma_mix_f32 v32, v98, v24, v28 op_sel:[0,0,0] op_sel_hi:[1,0,0]
    v_mfma_f32_16x16x32_bf16 v[148:151], a[236:239], v[84:87], v[148:151]
    ds_read_b64_tr_b16 a[194:195], v4 offset:768
    v_fma_mix_f32 v33, v98, v25, v29 op_sel:[1,0,0] op_sel_hi:[1,0,0]
    v_mfma_f32_16x16x32_bf16 v[180:183], a[232:235], v[88:91], v[180:183]
    ds_read_b64_tr_b16 a[196:197], v4 offset:17152
    v_fma_mix_f32 v34, v99, v26, v30 op_sel:[0,0,0] op_sel_hi:[1,0,0]
    v_mfma_f32_16x16x32_bf16 v[180:183], a[236:239], v[92:95], v[180:183]
    s_waitcnt lgkmcnt(9)
    ds_read_b64_tr_b16 a[198:199], v4 offset:17664
    v_fma_mix_f32 v35, v99, v27, v31 op_sel:[1,0,0] op_sel_hi:[1,0,0]
    v_mfma_f32_16x16x32_bf16 v[152:155], a[240:243], v[80:83], v[152:155]
    ds_read_b64_tr_b16 a[200:201], v4 offset:288
    v_cvt_pk_bf16_f32 v98, v32, v33
    v_mfma_f32_16x16x32_bf16 v[152:155], a[244:247], v[84:87], v[152:155]
    ds_read_b64_tr_b16 a[202:203], v4 offset:800
    v_cvt_pk_bf16_f32 v99, v34, v35
    v_mfma_f32_16x16x32_bf16 v[184:187], a[240:243], v[88:91], v[184:187]
    ds_read_b64_tr_b16 a[204:205], v4 offset:17184
    v_fma_mix_f32 v36, v106, v24, v28 op_sel:[0,0,0] op_sel_hi:[1,0,0]
    v_mfma_f32_16x16x32_bf16 v[184:187], a[244:247], v[92:95], v[184:187]
    s_waitcnt lgkmcnt(8)
    ds_read_b64_tr_b16 a[206:207], v4 offset:17696
    v_fma_mix_f32 v37, v106, v25, v29 op_sel:[1,0,0] op_sel_hi:[1,0,0]
    v_mfma_f32_16x16x32_bf16 v[156:159], a[248:251], v[80:83], v[156:159]
    ds_read_b64_tr_b16 a[208:209], v4 offset:320
    v_fma_mix_f32 v38, v107, v26, v30 op_sel:[0,0,0] op_sel_hi:[1,0,0]
    v_mfma_f32_16x16x32_bf16 v[156:159], a[252:255], v[84:87], v[156:159]
    ds_read_b64_tr_b16 a[210:211], v4 offset:832
    v_fma_mix_f32 v39, v107, v27, v31 op_sel:[1,0,0] op_sel_hi:[1,0,0]
    v_mfma_f32_16x16x32_bf16 v[188:191], a[248:251], v[88:91], v[188:191]
    ds_read_b64_tr_b16 a[212:213], v4 offset:17216
    v_cvt_pk_bf16_f32 v106, v36, v37
    v_mfma_f32_16x16x32_bf16 v[188:191], a[252:255], v[92:95], v[188:191]
    s_waitcnt lgkmcnt(7)
    ds_read_b64_tr_b16 a[214:215], v4 offset:17728
    v_cvt_pk_bf16_f32 v107, v38, v39
    v_mfma_f32_16x16x32_bf16 v[192:195], a[192:195], v[80:83], v[192:195]
    ds_read_b64_tr_b16 a[216:217], v4 offset:352
    ds_read_b128 v[24:27], v9 offset:12560
    v_mfma_f32_16x16x32_bf16 v[192:195], a[196:199], v[84:87], v[192:195]
    ds_read_b64_tr_b16 a[218:219], v4 offset:864
    ds_read_b64_tr_b16 a[220:221], v4 offset:17248
    v_fma_mix_f32 v32, v100, v16, v20 op_sel:[0,0,0] op_sel_hi:[1,0,0]
    v_mfma_f32_16x16x32_bf16 v[224:227], a[192:195], v[88:91], v[224:227]
    s_mov_b32 s54, 16384
    ds_read_b64_tr_b16 a[222:223], v4 offset:17760
    ds_read_b128 v[28:31], v9 offset:12592
    v_mfma_f32_16x16x32_bf16 v[224:227], a[196:199], v[92:95], v[224:227]
    s_waitcnt lgkmcnt(10)
    buffer_load_dwordx4 v[48:51], v8, s[32:35], s54 offen sc1
    v_mfma_f32_16x16x32_bf16 v[196:199], a[200:203], v[80:83], v[196:199]
    ds_read_b64_tr_b16 a[224:225], v4 offset:384
    v_fma_mix_f32 v33, v100, v17, v21 op_sel:[1,0,0] op_sel_hi:[1,0,0]
    v_mfma_f32_16x16x32_bf16 v[196:199], a[204:207], v[84:87], v[196:199]
    ds_read_b64_tr_b16 a[226:227], v4 offset:896
    ds_read_b64_tr_b16 a[228:229], v4 offset:17280
    v_fma_mix_f32 v34, v101, v18, v22 op_sel:[0,0,0] op_sel_hi:[1,0,0]
    v_mfma_f32_16x16x32_bf16 v[228:231], a[200:203], v[88:91], v[228:231]
    s_mov_b32 s54, 17408
    ds_read_b64_tr_b16 a[230:231], v4 offset:17792
    v_fma_mix_f32 v35, v101, v19, v23 op_sel:[1,0,0] op_sel_hi:[1,0,0]
    v_mfma_f32_16x16x32_bf16 v[228:231], a[204:207], v[92:95], v[228:231]
    s_waitcnt lgkmcnt(10)
    buffer_load_dwordx4 v[52:55], v8, s[32:35], s54 offen sc1
    v_mfma_f32_16x16x32_bf16 v[200:203], a[208:211], v[80:83], v[200:203]
    ds_read_b64_tr_b16 a[232:233], v4 offset:416
    v_cvt_pk_bf16_f32 v100, v32, v33
    v_mfma_f32_16x16x32_bf16 v[200:203], a[212:215], v[84:87], v[200:203]
    ds_read_b64_tr_b16 a[234:235], v4 offset:928
    ds_read_b64_tr_b16 a[236:237], v4 offset:17312
    v_cvt_pk_bf16_f32 v101, v34, v35
    v_mfma_f32_16x16x32_bf16 v[232:235], a[208:211], v[88:91], v[232:235]
    s_mov_b32 s54, 34816
    ds_read_b64_tr_b16 a[238:239], v4 offset:17824
    v_fma_mix_f32 v36, v108, v16, v20 op_sel:[0,0,0] op_sel_hi:[1,0,0]
    v_mfma_f32_16x16x32_bf16 v[232:235], a[212:215], v[92:95], v[232:235]
    s_waitcnt lgkmcnt(9)
    buffer_load_dwordx4 v[56:59], v8, s[32:35], s54 offen sc1
    v_fma_mix_f32 v37, v108, v17, v21 op_sel:[1,0,0] op_sel_hi:[1,0,0]
    v_mfma_f32_16x16x32_bf16 v[204:207], a[216:219], v[80:83], v[204:207]
    ds_read_b64_tr_b16 a[240:241], v4 offset:448
    v_fma_mix_f32 v38, v109, v18, v22 op_sel:[0,0,0] op_sel_hi:[1,0,0]
    v_mfma_f32_16x16x32_bf16 v[204:207], a[220:223], v[84:87], v[204:207]
    ds_read_b64_tr_b16 a[242:243], v4 offset:960
    ds_read_b64_tr_b16 a[244:245], v4 offset:17344
    v_fma_mix_f32 v39, v109, v19, v23 op_sel:[1,0,0] op_sel_hi:[1,0,0]
    v_mfma_f32_16x16x32_bf16 v[236:239], a[216:219], v[88:91], v[236:239]
    s_mov_b32 s54, 35840
    ds_read_b64_tr_b16 a[246:247], v4 offset:17856
    v_cvt_pk_bf16_f32 v108, v36, v37
    v_mfma_f32_16x16x32_bf16 v[236:239], a[220:223], v[92:95], v[236:239]
    s_waitcnt lgkmcnt(8)
    buffer_load_dwordx4 v[60:63], v8, s[32:35], s54 offen sc1
    v_cvt_pk_bf16_f32 v109, v38, v39
    v_mfma_f32_16x16x32_bf16 v[208:211], a[224:227], v[80:83], v[208:211]
    ds_read_b64_tr_b16 a[248:249], v4 offset:480
    ds_read_b128 v[16:19], v9 offset:12800
    v_mfma_f32_16x16x32_bf16 v[208:211], a[228:231], v[84:87], v[208:211]
    ds_read_b64_tr_b16 a[250:251], v4 offset:992
    ds_read_b128 v[20:23], v9 offset:12832
    v_mfma_f32_16x16x32_bf16 v[240:243], a[224:227], v[88:91], v[240:243]
    ds_read_b64_tr_b16 a[252:253], v4 offset:17376
    v_fma_mix_f32 v32, v102, v24, v28 op_sel:[0,0,0] op_sel_hi:[1,0,0]
    v_mfma_f32_16x16x32_bf16 v[240:243], a[228:231], v[92:95], v[240:243]
    s_waitcnt vmcnt(16)
    s_barrier
    s_waitcnt lgkmcnt(9)
    ds_read_b64_tr_b16 a[254:255], v4 offset:17888
    v_fma_mix_f32 v33, v102, v25, v29 op_sel:[1,0,0] op_sel_hi:[1,0,0]
    v_fma_mix_f32 v34, v103, v26, v30 op_sel:[0,0,0] op_sel_hi:[1,0,0]
    v_mfma_f32_16x16x32_bf16 v[212:215], a[232:235], v[80:83], v[212:215]
    ds_read_b64_tr_b16 a[192:193], v4 offset:36864
    v_fma_mix_f32 v35, v103, v27, v31 op_sel:[1,0,0] op_sel_hi:[1,0,0]
    v_mfma_f32_16x16x32_bf16 v[212:215], a[236:239], v[84:87], v[212:215]
    ds_read_b64_tr_b16 a[194:195], v4 offset:37376
    ds_read_b64_tr_b16 a[196:197], v4 offset:53760
    v_cvt_pk_bf16_f32 v102, v32, v33
    v_mfma_f32_16x16x32_bf16 v[244:247], a[232:235], v[88:91], v[244:247]
    s_add_u32 m0, s44, 36864
    ds_read_b64_tr_b16 a[198:199], v4 offset:54272
    v_cvt_pk_bf16_f32 v103, v34, v35
    v_mfma_f32_16x16x32_bf16 v[244:247], a[236:239], v[92:95], v[244:247]
    s_mov_b32 s45, 4194304
    s_waitcnt lgkmcnt(10)
    buffer_load_dwordx4 v6, s[24:27], s45 offen lds
    v_mfma_f32_16x16x32_bf16 v[216:219], a[240:243], v[80:83], v[216:219]
    ds_read_b64_tr_b16 a[200:201], v4 offset:36896
    v_fma_mix_f32 v36, v110, v24, v28 op_sel:[0,0,0] op_sel_hi:[1,0,0]
    v_mfma_f32_16x16x32_bf16 v[216:219], a[244:247], v[84:87], v[216:219]
    ds_read_b64_tr_b16 a[202:203], v4 offset:37408
    ds_read_b64_tr_b16 a[204:205], v4 offset:53792
    v_fma_mix_f32 v37, v110, v25, v29 op_sel:[1,0,0] op_sel_hi:[1,0,0]
    v_mfma_f32_16x16x32_bf16 v[248:251], a[240:243], v[88:91], v[248:251]
    s_add_u32 m0, s44, 37920
    ds_read_b64_tr_b16 a[206:207], v4 offset:54304
    v_fma_mix_f32 v38, v111, v26, v30 op_sel:[0,0,0] op_sel_hi:[1,0,0]
    v_mfma_f32_16x16x32_bf16 v[248:251], a[244:247], v[92:95], v[248:251]
    s_mov_b32 s45, 4202496
    s_waitcnt lgkmcnt(8)
    buffer_load_dwordx4 v6, s[24:27], s45 offen lds
    v_mfma_f32_16x16x32_bf16 v[220:223], a[248:251], v[80:83], v[220:223]
    ds_read_b64_tr_b16 a[208:209], v4 offset:36928
    v_fma_mix_f32 v39, v111, v27, v31 op_sel:[1,0,0] op_sel_hi:[1,0,0]
    v_mfma_f32_16x16x32_bf16 v[220:223], a[252:255], v[84:87], v[220:223]
    ds_read_b64_tr_b16 a[210:211], v4 offset:37440
    ds_read_b64_tr_b16 a[212:213], v4 offset:53824
    v_cvt_pk_bf16_f32 v110, v36, v37
    v_mfma_f32_16x16x32_bf16 v[252:255], a[248:251], v[88:91], v[252:255]
    s_add_u32 m0, s44, 38976
    ds_read_b64_tr_b16 a[214:215], v4 offset:54336
    v_cvt_pk_bf16_f32 v111, v38, v39
    v_mfma_f32_16x16x32_bf16 v[252:255], a[252:255], v[92:95], v[252:255]
    s_mov_b32 s45, 4210688
    s_waitcnt lgkmcnt(8)
    buffer_load_dwordx4 v6, s[24:27], s45 offen lds
    v_mfma_f32_16x16x32_bf16 v[128:131], a[192:195], v[96:99], v[128:131]
    s_waitcnt vmcnt(15)
    ds_read_b64_tr_b16 a[216:217], v4 offset:36960
    ds_read_b128 v[24:27], v9 offset:12816
    v_mfma_f32_16x16x32_bf16 v[128:131], a[196:199], v[100:103], v[128:131]
    ds_read_b64_tr_b16 a[218:219], v4 offset:37472
    ds_read_b64_tr_b16 a[220:221], v4 offset:53856
    v_fma_mix_f32 v32, v112, v16, v20 op_sel:[0,0,0] op_sel_hi:[1,0,0]
    v_mfma_f32_16x16x32_bf16 v[160:163], a[192:195], v[104:107], v[160:163]
    s_add_u32 m0, s44, 40032
    ds_read_b64_tr_b16 a[222:223], v4 offset:54368
    ds_read_b128 v[28:31], v9 offset:12848
    v_mfma_f32_16x16x32_bf16 v[160:163], a[196:199], v[108:111], v[160:163]
    s_mov_b32 s45, 4218880
    s_waitcnt lgkmcnt(10)
    buffer_load_dwordx4 v6, s[24:27], s45 offen lds
    v_mfma_f32_16x16x32_bf16 v[132:135], a[200:203], v[96:99], v[132:135]
    ds_read_b64_tr_b16 a[224:225], v4 offset:36992
    v_fma_mix_f32 v33, v112, v17, v21 op_sel:[1,0,0] op_sel_hi:[1,0,0]
    v_mfma_f32_16x16x32_bf16 v[132:135], a[204:207], v[100:103], v[132:135]
    ds_read_b64_tr_b16 a[226:227], v4 offset:37504
    ds_read_b64_tr_b16 a[228:229], v4 offset:53888
    v_fma_mix_f32 v34, v113, v18, v22 op_sel:[0,0,0] op_sel_hi:[1,0,0]
    v_mfma_f32_16x16x32_bf16 v[164:167], a[200:203], v[104:107], v[164:167]
    s_add_u32 m0, s44, 53760
    ds_read_b64_tr_b16 a[230:231], v4 offset:54400
    v_fma_mix_f32 v35, v113, v19, v23 op_sel:[1,0,0] op_sel_hi:[1,0,0]
    v_mfma_f32_16x16x32_bf16 v[164:167], a[204:207], v[108:111], v[164:167]
    s_mov_b32 s45, 4456448
    s_waitcnt lgkmcnt(10)
    buffer_load_dwordx4 v6, s[24:27], s45 offen lds
    v_mfma_f32_16x16x32_bf16 v[136:139], a[208:211], v[96:99], v[136:139]
    ds_read_b64_tr_b16 a[232:233], v4 offset:37024
    v_cvt_pk_bf16_f32 v112, v32, v33
    v_mfma_f32_16x16x32_bf16 v[136:139], a[212:215], v[100:103], v[136:139]
    ds_read_b64_tr_b16 a[234:235], v4 offset:37536
    ds_read_b64_tr_b16 a[236:237], v4 offset:53920
    v_cvt_pk_bf16_f32 v113, v34, v35
    v_mfma_f32_16x16x32_bf16 v[168:171], a[208:211], v[104:107], v[168:171]
    s_add_u32 m0, s44, 54816
    ds_read_b64_tr_b16 a[238:239], v4 offset:54432
    v_fma_mix_f32 v36, v120, v16, v20 op_sel:[0,0,0] op_sel_hi:[1,0,0]
    v_mfma_f32_16x16x32_bf16 v[168:171], a[212:215], v[108:111], v[168:171]
    s_mov_b32 s45, 4464640
    s_waitcnt lgkmcnt(9)
    buffer_load_dwordx4 v6, s[24:27], s45 offen lds
    v_fma_mix_f32 v37, v120, v17, v21 op_sel:[1,0,0] op_sel_hi:[1,0,0]
    v_mfma_f32_16x16x32_bf16 v[140:143], a[216:219], v[96:99], v[140:143]
    ds_read_b64_tr_b16 a[240:241], v4 offset:37056
    v_fma_mix_f32 v38, v121, v18, v22 op_sel:[0,0,0] op_sel_hi:[1,0,0]
    v_mfma_f32_16x16x32_bf16 v[140:143], a[220:223], v[100:103], v[140:143]
L2_pad2:
    s_cbranch_execz L2_pad6
    ds_read_b64_tr_b16 a[242:243], v4 offset:37568
    ds_read_b64_tr_b16 a[244:245], v4 offset:53952
    v_fma_mix_f32 v39, v121, v19, v23 op_sel:[1,0,0] op_sel_hi:[1,0,0]
    v_mfma_f32_16x16x32_bf16 v[172:175], a[216:219], v[104:107], v[172:175]
    s_add_u32 m0, s44, 55872
    ds_read_b64_tr_b16 a[246:247], v4 offset:54464
    v_cvt_pk_bf16_f32 v120, v36, v37
    v_mfma_f32_16x16x32_bf16 v[172:175], a[220:223], v[108:111], v[172:175]
    s_mov_b32 s45, 4472832
    s_waitcnt lgkmcnt(8)
    buffer_load_dwordx4 v6, s[24:27], s45 offen lds
    v_cvt_pk_bf16_f32 v121, v38, v39
    v_mfma_f32_16x16x32_bf16 v[144:147], a[224:227], v[96:99], v[144:147]
    ds_read_b64_tr_b16 a[248:249], v4 offset:37088
    ds_read_b128 v[16:19], v9 offset:13056
    v_mfma_f32_16x16x32_bf16 v[144:147], a[228:231], v[100:103], v[144:147]
    ds_read_b64_tr_b16 a[250:251], v4 offset:37600
    ds_read_b64_tr_b16 a[252:253], v4 offset:53984
    v_mfma_f32_16x16x32_bf16 v[176:179], a[224:227], v[104:107], v[176:179]
    s_add_u32 m0, s44, 56928
    ds_read_b64_tr_b16 a[254:255], v4 offset:54496
    ds_read_b128 v[20:23], v9 offset:13088
    v_mfma_f32_16x16x32_bf16 v[176:179], a[228:231], v[108:111], v[176:179]
    s_mov_b32 s45, 4481024
    s_waitcnt lgkmcnt(10)
    buffer_load_dwordx4 v6, s[24:27], s45 offen lds
    v_mfma_f32_16x16x32_bf16 v[148:151], a[232:235], v[96:99], v[148:151]
    ds_read_b64_tr_b16 a[192:193], v4 offset:37120
    v_fma_mix_f32 v32, v114, v24, v28 op_sel:[0,0,0] op_sel_hi:[1,0,0]
    v_mfma_f32_16x16x32_bf16 v[148:151], a[236:239], v[100:103], v[148:151]
    ds_read_b64_tr_b16 a[194:195], v4 offset:37632
    v_fma_mix_f32 v33, v114, v25, v29 op_sel:[1,0,0] op_sel_hi:[1,0,0]
    v_mfma_f32_16x16x32_bf16 v[180:183], a[232:235], v[104:107], v[180:183]
    ds_read_b64_tr_b16 a[196:197], v4 offset:54016
    v_fma_mix_f32 v34, v115, v26, v30 op_sel:[0,0,0] op_sel_hi:[1,0,0]
    v_mfma_f32_16x16x32_bf16 v[180:183], a[236:239], v[108:111], v[180:183]
    s_waitcnt lgkmcnt(9)
    ds_read_b64_tr_b16 a[198:199], v4 offset:54528
    v_fma_mix_f32 v35, v115, v27, v31 op_sel:[1,0,0] op_sel_hi:[1,0,0]
    v_mfma_f32_16x16x32_bf16 v[152:155], a[240:243], v[96:99], v[152:155]
    ds_read_b64_tr_b16 a[200:201], v4 offset:37152
    v_cvt_pk_bf16_f32 v114, v32, v33
    v_mfma_f32_16x16x32_bf16 v[152:155], a[244:247], v[100:103], v[152:155]
    ds_read_b64_tr_b16 a[202:203], v4 offset:37664
    v_cvt_pk_bf16_f32 v115, v34, v35
    v_mfma_f32_16x16x32_bf16 v[184:187], a[240:243], v[104:107], v[184:187]
    ds_read_b64_tr_b16 a[204:205], v4 offset:54048
    v_fma_mix_f32 v36, v122, v24, v28 op_sel:[0,0,0] op_sel_hi:[1,0,0]
    v_mfma_f32_16x16x32_bf16 v[184:187], a[244:247], v[108:111], v[184:187]
    s_waitcnt lgkmcnt(8)
    ds_read_b64_tr_b16 a[206:207], v4 offset:54560
    v_fma_mix_f32 v37, v122, v25, v29 op_sel:[1,0,0] op_sel_hi:[1,0,0]
    v_mfma_f32_16x16x32_bf16 v[156:159], a[248:251], v[96:99], v[156:159]
    ds_read_b64_tr_b16 a[208:209], v4 offset:37184
    v_fma_mix_f32 v38, v123, v26, v30 op_sel:[0,0,0] op_sel_hi:[1,0,0]
    v_mfma_f32_16x16x32_bf16 v[156:159], a[252:255], v[100:103], v[156:159]
    ds_read_b64_tr_b16 a[210:211], v4 offset:37696
    v_fma_mix_f32 v39, v123, v27, v31 op_sel:[1,0,0] op_sel_hi:[1,0,0]
    v_mfma_f32_16x16x32_bf16 v[188:191], a[248:251], v[104:107], v[188:191]
    ds_read_b64_tr_b16 a[212:213], v4 offset:54080
    v_cvt_pk_bf16_f32 v122, v36, v37
    v_mfma_f32_16x16x32_bf16 v[188:191], a[252:255], v[108:111], v[188:191]
    s_waitcnt lgkmcnt(7)
    ds_read_b64_tr_b16 a[214:215], v4 offset:54592
    v_cvt_pk_bf16_f32 v123, v38, v39
    v_mfma_f32_16x16x32_bf16 v[192:195], a[192:195], v[96:99], v[192:195]
    ds_read_b64_tr_b16 a[216:217], v4 offset:37216
    ds_read_b128 v[24:27], v9 offset:13072
    v_mfma_f32_16x16x32_bf16 v[192:195], a[196:199], v[100:103], v[192:195]
    ds_read_b64_tr_b16 a[218:219], v4 offset:37728
    ds_read_b128 v[28:31], v9 offset:13104
    v_mfma_f32_16x16x32_bf16 v[224:227], a[192:195], v[104:107], v[224:227]
    ds_read_b64_tr_b16 a[220:221], v4 offset:54112
    v_fma_mix_f32 v32, v116, v16, v20 op_sel:[0,0,0] op_sel_hi:[1,0,0]
    v_mfma_f32_16x16x32_bf16 v[224:227], a[196:199], v[108:111], v[224:227]
    s_waitcnt lgkmcnt(9)
    ds_read_b64_tr_b16 a[222:223], v4 offset:54624
    v_fma_mix_f32 v33, v116, v17, v21 op_sel:[1,0,0] op_sel_hi:[1,0,0]
    v_mfma_f32_16x16x32_bf16 v[196:199], a[200:203], v[96:99], v[196:199]
    ds_read_b64_tr_b16 a[224:225], v4 offset:37248
    v_fma_mix_f32 v34, v117, v18, v22 op_sel:[0,0,0] op_sel_hi:[1,0,0]
    v_mfma_f32_16x16x32_bf16 v[196:199], a[204:207], v[100:103], v[196:199]
    ds_read_b64_tr_b16 a[226:227], v4 offset:37760
    v_fma_mix_f32 v35, v117, v19, v23 op_sel:[1,0,0] op_sel_hi:[1,0,0]
    v_mfma_f32_16x16x32_bf16 v[228:231], a[200:203], v[104:107], v[228:231]
    ds_read_b64_tr_b16 a[228:229], v4 offset:54144
    v_cvt_pk_bf16_f32 v116, v32, v33
    v_mfma_f32_16x16x32_bf16 v[228:231], a[204:207], v[108:111], v[228:231]
    s_waitcnt lgkmcnt(9)
    ds_read_b64_tr_b16 a[230:231], v4 offset:54656
    v_cvt_pk_bf16_f32 v117, v34, v35
    v_mfma_f32_16x16x32_bf16 v[200:203], a[208:211], v[96:99], v[200:203]
    ds_read_b64_tr_b16 a[232:233], v4 offset:37280
    v_fma_mix_f32 v36, v124, v16, v20 op_sel:[0,0,0] op_sel_hi:[1,0,0]
    v_mfma_f32_16x16x32_bf16 v[200:203], a[212:215], v[100:103], v[200:203]
    ds_read_b64_tr_b16 a[234:235], v4 offset:37792
    v_fma_mix_f32 v37, v124, v17, v21 op_sel:[1,0,0] op_sel_hi:[1,0,0]
    v_mfma_f32_16x16x32_bf16 v[232:235], a[208:211], v[104:107], v[232:235]
    ds_read_b64_tr_b16 a[236:237], v4 offset:54176
    v_fma_mix_f32 v38, v125, v18, v22 op_sel:[0,0,0] op_sel_hi:[1,0,0]
    v_mfma_f32_16x16x32_bf16 v[232:235], a[212:215], v[108:111], v[232:235]
    s_waitcnt lgkmcnt(7)
    ds_read_b64_tr_b16 a[238:239], v4 offset:54688
    v_fma_mix_f32 v39, v125, v19, v23 op_sel:[1,0,0] op_sel_hi:[1,0,0]
    v_mfma_f32_16x16x32_bf16 v[204:207], a[216:219], v[96:99], v[204:207]
    ds_read_b64_tr_b16 a[240:241], v4 offset:37312
    v_cvt_pk_bf16_f32 v124, v36, v37
    v_mfma_f32_16x16x32_bf16 v[204:207], a[220:223], v[100:103], v[204:207]
    ds_read_b64_tr_b16 a[242:243], v4 offset:37824
    v_cvt_pk_bf16_f32 v125, v38, v39
    v_mfma_f32_16x16x32_bf16 v[236:239], a[216:219], v[104:107], v[236:239]
    ds_read_b64_tr_b16 a[244:245], v4 offset:54208
    v_mfma_f32_16x16x32_bf16 v[236:239], a[220:223], v[108:111], v[236:239]
    s_waitcnt lgkmcnt(7)
    ds_read_b64_tr_b16 a[246:247], v4 offset:54720
    v_mfma_f32_16x16x32_bf16 v[208:211], a[224:227], v[96:99], v[208:211]
    ds_read_b64_tr_b16 a[248:249], v4 offset:37344
    ds_read_b128 v[16:19], v9 offset:13312
    v_mfma_f32_16x16x32_bf16 v[208:211], a[228:231], v[100:103], v[208:211]
    ds_read_b64_tr_b16 a[250:251], v4 offset:37856
    ds_read_b128 v[20:23], v9 offset:13344
    v_mfma_f32_16x16x32_bf16 v[240:243], a[224:227], v[104:107], v[240:243]
    ds_read_b64_tr_b16 a[252:253], v4 offset:54240
    v_fma_mix_f32 v32, v118, v24, v28 op_sel:[0,0,0] op_sel_hi:[1,0,0]
    v_mfma_f32_16x16x32_bf16 v[240:243], a[228:231], v[108:111], v[240:243]
    s_waitcnt vmcnt(12)
    s_barrier
    s_waitcnt lgkmcnt(9)
    ds_read_b64_tr_b16 a[254:255], v4 offset:54752
    v_fma_mix_f32 v33, v118, v25, v29 op_sel:[1,0,0] op_sel_hi:[1,0,0]
    v_fma_mix_f32 v34, v119, v26, v30 op_sel:[0,0,0] op_sel_hi:[1,0,0]
    v_mfma_f32_16x16x32_bf16 v[212:215], a[232:235], v[96:99], v[212:215]
    ds_read_b64_tr_b16 a[192:193], v3 offset:0
    v_fma_mix_f32 v35, v119, v27, v31 op_sel:[1,0,0] op_sel_hi:[1,0,0]
    v_mfma_f32_16x16x32_bf16 v[212:215], a[236:239], v[100:103], v[212:215]
    ds_read_b64_tr_b16 a[194:195], v3 offset:512
    ds_read_b64_tr_b16 a[196:197], v3 offset:16896
    v_cvt_pk_bf16_f32 v118, v32, v33
    v_mfma_f32_16x16x32_bf16 v[244:247], a[232:235], v[104:107], v[244:247]
    s_add_u32 m0, s44, 73728
    ds_read_b64_tr_b16 a[198:199], v3 offset:17408
    v_cvt_pk_bf16_f32 v119, v34, v35
    v_mfma_f32_16x16x32_bf16 v[244:247], a[236:239], v[108:111], v[244:247]
    s_mov_b32 s46, 0
    s_waitcnt lgkmcnt(10)
    buffer_load_dwordx4 v5, s[16:19], s46 offen offset:0 lds
    v_mfma_f32_16x16x32_bf16 v[216:219], a[240:243], v[96:99], v[216:219]
    ds_read_b64_tr_b16 a[200:201], v3 offset:32
    v_fma_mix_f32 v36, v126, v24, v28 op_sel:[0,0,0] op_sel_hi:[1,0,0]
    v_mfma_f32_16x16x32_bf16 v[216:219], a[244:247], v[100:103], v[216:219]
    ds_read_b64_tr_b16 a[202:203], v3 offset:544
    ds_read_b64_tr_b16 a[204:205], v3 offset:16928
    v_fma_mix_f32 v37, v126, v25, v29 op_sel:[1,0,0] op_sel_hi:[1,0,0]
    v_mfma_f32_16x16x32_bf16 v[248:251], a[240:243], v[104:107], v[248:251]
    s_add_u32 m0, s44, 73760
    ds_read_b64_tr_b16 a[206:207], v3 offset:17440
    v_fma_mix_f32 v38, v127, v26, v30 op_sel:[0,0,0] op_sel_hi:[1,0,0]
    v_mfma_f32_16x16x32_bf16 v[248:251], a[244:247], v[108:111], v[248:251]
    s_waitcnt lgkmcnt(8)
    buffer_load_dwordx4 v5, s[16:19], s46 offen offset:1024 lds
    v_mfma_f32_16x16x32_bf16 v[220:223], a[248:251], v[96:99], v[220:223]
    ds_read_b64_tr_b16 a[208:209], v3 offset:64
    v_fma_mix_f32 v39, v127, v27, v31 op_sel:[1,0,0] op_sel_hi:[1,0,0]
    v_mfma_f32_16x16x32_bf16 v[220:223], a[252:255], v[100:103], v[220:223]
    ds_read_b64_tr_b16 a[210:211], v3 offset:576
    ds_read_b64_tr_b16 a[212:213], v3 offset:16960
    v_cvt_pk_bf16_f32 v126, v36, v37
    v_mfma_f32_16x16x32_bf16 v[252:255], a[248:251], v[104:107], v[252:255]
    s_add_u32 m0, s44, 73792
    ds_read_b64_tr_b16 a[214:215], v3 offset:17472
    v_cvt_pk_bf16_f32 v127, v38, v39
    v_mfma_f32_16x16x32_bf16 v[252:255], a[252:255], v[108:111], v[252:255]
    s_waitcnt lgkmcnt(8)
    buffer_load_dwordx4 v5, s[16:19], s46 offen offset:2048 lds
    v_mfma_f32_16x16x32_bf16 v[128:131], a[192:195], v[112:115], v[128:131]
    s_waitcnt vmcnt(11)
    ds_read_b64_tr_b16 a[216:217], v3 offset:96
    ds_read_b128 v[24:27], v9 offset:13328
    v_mfma_f32_16x16x32_bf16 v[128:131], a[196:199], v[116:119], v[128:131]
    ds_read_b64_tr_b16 a[218:219], v3 offset:608
    ds_read_b64_tr_b16 a[220:221], v3 offset:16992
    v_fma_mix_f32 v32, v48, v16, v20 op_sel:[0,0,0] op_sel_hi:[1,0,0]
    v_mfma_f32_16x16x32_bf16 v[160:163], a[192:195], v[120:123], v[160:163]
    s_add_u32 m0, s44, 73824
    ds_read_b64_tr_b16 a[222:223], v3 offset:17504
    ds_read_b128 v[28:31], v9 offset:13360
    v_mfma_f32_16x16x32_bf16 v[160:163], a[196:199], v[124:127], v[160:163]
    s_waitcnt lgkmcnt(10)
    buffer_load_dwordx4 v5, s[16:19], s46 offen offset:3072 lds
    v_mfma_f32_16x16x32_bf16 v[132:135], a[200:203], v[112:115], v[132:135]
    ds_read_b64_tr_b16 a[224:225], v3 offset:128
    v_fma_mix_f32 v33, v48, v17, v21 op_sel:[1,0,0] op_sel_hi:[1,0,0]
    v_mfma_f32_16x16x32_bf16 v[132:135], a[204:207], v[116:119], v[132:135]
    ds_read_b64_tr_b16 a[226:227], v3 offset:640
    ds_read_b64_tr_b16 a[228:229], v3 offset:17024
    v_fma_mix_f32 v34, v49, v18, v22 op_sel:[0,0,0] op_sel_hi:[1,0,0]
    v_mfma_f32_16x16x32_bf16 v[164:167], a[200:203], v[120:123], v[164:167]
    s_add_u32 m0, s44, 90624
    ds_read_b64_tr_b16 a[230:231], v3 offset:17536
    v_fma_mix_f32 v35, v49, v19, v23 op_sel:[1,0,0] op_sel_hi:[1,0,0]
    v_mfma_f32_16x16x32_bf16 v[164:167], a[204:207], v[124:127], v[164:167]
    s_waitcnt lgkmcnt(10)
    buffer_load_dwordx4 v5, s[20:23], s46 offen offset:0 lds
    v_mfma_f32_16x16x32_bf16 v[136:139], a[208:211], v[112:115], v[136:139]
    ds_read_b64_tr_b16 a[232:233], v3 offset:160
    v_cvt_pk_bf16_f32 v48, v32, v33
    v_mfma_f32_16x16x32_bf16 v[136:139], a[212:215], v[116:119], v[136:139]
    ds_read_b64_tr_b16 a[234:235], v3 offset:672
    ds_read_b64_tr_b16 a[236:237], v3 offset:17056
    v_cvt_pk_bf16_f32 v49, v34, v35
    v_mfma_f32_16x16x32_bf16 v[168:171], a[208:211], v[120:123], v[168:171]
    s_add_u32 m0, s44, 90656
    ds_read_b64_tr_b16 a[238:239], v3 offset:17568
    v_fma_mix_f32 v36, v56, v16, v20 op_sel:[0,0,0] op_sel_hi:[1,0,0]
    v_mfma_f32_16x16x32_bf16 v[168:171], a[212:215], v[124:127], v[168:171]
    s_waitcnt lgkmcnt(9)
    buffer_load_dwordx4 v5, s[20:23], s46 offen offset:1024 lds
    v_fma_mix_f32 v37, v56, v17, v21 op_sel:[1,0,0] op_sel_hi:[1,0,0]
    v_mfma_f32_16x16x32_bf16 v[140:143], a[216:219], v[112:115], v[140:143]
    ds_read_b64_tr_b16 a[240:241], v3 offset:192
    v_fma_mix_f32 v38, v57, v18, v22 op_sel:[0,0,0] op_sel_hi:[1,0,0]
    v_mfma_f32_16x16x32_bf16 v[140:143], a[220:223], v[116:119], v[140:143]
    ds_read_b64_tr_b16 a[242:243], v3 offset:704
    ds_read_b64_tr_b16 a[244:245], v3 offset:17088
    v_fma_mix_f32 v39, v57, v19, v23 op_sel:[1,0,0] op_sel_hi:[1,0,0]
    v_mfma_f32_16x16x32_bf16 v[172:175], a[216:219], v[120:123], v[172:175]
    s_add_u32 m0, s44, 90688
    ds_read_b64_tr_b16 a[246:247], v3 offset:17600
    v_cvt_pk_bf16_f32 v56, v36, v37
    v_mfma_f32_16x16x32_bf16 v[172:175], a[220:223], v[124:127], v[172:175]
    s_waitcnt lgkmcnt(8)
    buffer_load_dwordx4 v5, s[20:23], s46 offen offset:2048 lds
    v_cvt_pk_bf16_f32 v57, v38, v39
    v_mfma_f32_16x16x32_bf16 v[144:147], a[224:227], v[112:115], v[144:147]
    ds_read_b64_tr_b16 a[248:249], v3 offset:224
    ds_read_b128 v[16:19], v9 offset:13568
    v_mfma_f32_16x16x32_bf16 v[144:147], a[228:231], v[116:119], v[144:147]
    ds_read_b64_tr_b16 a[250:251], v3 offset:736
    ds_read_b64_tr_b16 a[252:253], v3 offset:17120
    v_mfma_f32_16x16x32_bf16 v[176:179], a[224:227], v[120:123], v[176:179]
    s_add_u32 m0, s44, 90720
    ds_read_b64_tr_b16 a[254:255], v3 offset:17632
    ds_read_b128 v[20:23], v9 offset:13600
    v_mfma_f32_16x16x32_bf16 v[176:179], a[228:231], v[124:127], v[176:179]
    s_waitcnt lgkmcnt(10)
    buffer_load_dwordx4 v5, s[20:23], s46 offen offset:3072 lds
    v_mfma_f32_16x16x32_bf16 v[148:151], a[232:235], v[112:115], v[148:151]
    ds_read_b64_tr_b16 a[192:193], v3 offset:256
    v_fma_mix_f32 v32, v50, v24, v28 op_sel:[0,0,0] op_sel_hi:[1,0,0]
    v_mfma_f32_16x16x32_bf16 v[148:151], a[236:239], v[116:119], v[148:151]
    ds_read_b64_tr_b16 a[194:195], v3 offset:768
    v_fma_mix_f32 v33, v50, v25, v29 op_sel:[1,0,0] op_sel_hi:[1,0,0]
    v_mfma_f32_16x16x32_bf16 v[180:183], a[232:235], v[120:123], v[180:183]
    ds_read_b64_tr_b16 a[196:197], v3 offset:17152
    v_fma_mix_f32 v34, v51, v26, v30 op_sel:[0,0,0] op_sel_hi:[1,0,0]
    v_mfma_f32_16x16x32_bf16 v[180:183], a[236:239], v[124:127], v[180:183]
    s_waitcnt lgkmcnt(9)
    ds_read_b64_tr_b16 a[198:199], v3 offset:17664
    v_fma_mix_f32 v35, v51, v27, v31 op_sel:[1,0,0] op_sel_hi:[1,0,0]
    v_mfma_f32_16x16x32_bf16 v[152:155], a[240:243], v[112:115], v[152:155]
    ds_read_b64_tr_b16 a[200:201], v3 offset:288
    v_cvt_pk_bf16_f32 v50, v32, v33
    v_mfma_f32_16x16x32_bf16 v[152:155], a[244:247], v[116:119], v[152:155]
    ds_read_b64_tr_b16 a[202:203], v3 offset:800
    v_cvt_pk_bf16_f32 v51, v34, v35
    v_mfma_f32_16x16x32_bf16 v[184:187], a[240:243], v[120:123], v[184:187]
    ds_read_b64_tr_b16 a[204:205], v3 offset:17184
    v_fma_mix_f32 v36, v58, v24, v28 op_sel:[0,0,0] op_sel_hi:[1,0,0]
    v_mfma_f32_16x16x32_bf16 v[184:187], a[244:247], v[124:127], v[184:187]
    s_waitcnt lgkmcnt(8)
    ds_read_b64_tr_b16 a[206:207], v3 offset:17696
    v_fma_mix_f32 v37, v58, v25, v29 op_sel:[1,0,0] op_sel_hi:[1,0,0]
    v_mfma_f32_16x16x32_bf16 v[156:159], a[248:251], v[112:115], v[156:159]
    ds_read_b64_tr_b16 a[208:209], v3 offset:320
    v_fma_mix_f32 v38, v59, v26, v30 op_sel:[0,0,0] op_sel_hi:[1,0,0]
    v_mfma_f32_16x16x32_bf16 v[156:159], a[252:255], v[116:119], v[156:159]
    ds_read_b64_tr_b16 a[210:211], v3 offset:832
    v_fma_mix_f32 v39, v59, v27, v31 op_sel:[1,0,0] op_sel_hi:[1,0,0]
    v_mfma_f32_16x16x32_bf16 v[188:191], a[248:251], v[120:123], v[188:191]
    ds_read_b64_tr_b16 a[212:213], v3 offset:17216
    v_cvt_pk_bf16_f32 v58, v36, v37
    v_mfma_f32_16x16x32_bf16 v[188:191], a[252:255], v[124:127], v[188:191]
    s_waitcnt lgkmcnt(7)
    ds_read_b64_tr_b16 a[214:215], v3 offset:17728
    v_cvt_pk_bf16_f32 v59, v38, v39
    v_mfma_f32_16x16x32_bf16 v[192:195], a[192:195], v[112:115], v[192:195]
    ds_read_b64_tr_b16 a[216:217], v3 offset:352
    ds_read_b128 v[24:27], v9 offset:13584
    v_mfma_f32_16x16x32_bf16 v[192:195], a[196:199], v[116:119], v[192:195]
    ds_read_b64_tr_b16 a[218:219], v3 offset:864
    ds_read_b128 v[28:31], v9 offset:13616
    v_mfma_f32_16x16x32_bf16 v[224:227], a[192:195], v[120:123], v[224:227]
    ds_read_b64_tr_b16 a[220:221], v3 offset:17248
    v_fma_mix_f32 v32, v52, v16, v20 op_sel:[0,0,0] op_sel_hi:[1,0,0]
    v_mfma_f32_16x16x32_bf16 v[224:227], a[196:199], v[124:127], v[224:227]
    s_waitcnt lgkmcnt(9)
    ds_read_b64_tr_b16 a[222:223], v3 offset:17760
    v_fma_mix_f32 v33, v52, v17, v21 op_sel:[1,0,0] op_sel_hi:[1,0,0]
    v_mfma_f32_16x16x32_bf16 v[196:199], a[200:203], v[112:115], v[196:199]
    ds_read_b64_tr_b16 a[224:225], v3 offset:384
    v_fma_mix_f32 v34, v53, v18, v22 op_sel:[0,0,0] op_sel_hi:[1,0,0]
    v_mfma_f32_16x16x32_bf16 v[196:199], a[204:207], v[116:119], v[196:199]
    ds_read_b64_tr_b16 a[226:227], v3 offset:896
    v_fma_mix_f32 v35, v53, v19, v23 op_sel:[1,0,0] op_sel_hi:[1,0,0]
    v_mfma_f32_16x16x32_bf16 v[228:231], a[200:203], v[120:123], v[228:231]
    ds_read_b64_tr_b16 a[228:229], v3 offset:17280
    v_cvt_pk_bf16_f32 v52, v32, v33
    v_mfma_f32_16x16x32_bf16 v[228:231], a[204:207], v[124:127], v[228:231]
    s_waitcnt lgkmcnt(9)
    ds_read_b64_tr_b16 a[230:231], v3 offset:17792
    v_cvt_pk_bf16_f32 v53, v34, v35
    v_mfma_f32_16x16x32_bf16 v[200:203], a[208:211], v[112:115], v[200:203]
    ds_read_b64_tr_b16 a[232:233], v3 offset:416
    v_fma_mix_f32 v36, v60, v16, v20 op_sel:[0,0,0] op_sel_hi:[1,0,0]
    v_mfma_f32_16x16x32_bf16 v[200:203], a[212:215], v[116:119], v[200:203]
    ds_read_b64_tr_b16 a[234:235], v3 offset:928
    v_fma_mix_f32 v37, v60, v17, v21 op_sel:[1,0,0] op_sel_hi:[1,0,0]
    v_mfma_f32_16x16x32_bf16 v[232:235], a[208:211], v[120:123], v[232:235]
    ds_read_b64_tr_b16 a[236:237], v3 offset:17312
    v_fma_mix_f32 v38, v61, v18, v22 op_sel:[0,0,0] op_sel_hi:[1,0,0]
    v_mfma_f32_16x16x32_bf16 v[232:235], a[212:215], v[124:127], v[232:235]
    s_waitcnt lgkmcnt(7)
    ds_read_b64_tr_b16 a[238:239], v3 offset:17824
    v_fma_mix_f32 v39, v61, v19, v23 op_sel:[1,0,0] op_sel_hi:[1,0,0]
    v_mfma_f32_16x16x32_bf16 v[204:207], a[216:219], v[112:115], v[204:207]
    ds_read_b64_tr_b16 a[240:241], v3 offset:448
    v_cvt_pk_bf16_f32 v60, v36, v37
    v_mfma_f32_16x16x32_bf16 v[204:207], a[220:223], v[116:119], v[204:207]
    ds_read_b64_tr_b16 a[242:243], v3 offset:960
    v_cvt_pk_bf16_f32 v61, v38, v39
    v_mfma_f32_16x16x32_bf16 v[236:239], a[216:219], v[120:123], v[236:239]
    ds_read_b64_tr_b16 a[244:245], v3 offset:17344
    v_mfma_f32_16x16x32_bf16 v[236:239], a[220:223], v[124:127], v[236:239]
    s_waitcnt lgkmcnt(7)
    ds_read_b64_tr_b16 a[246:247], v3 offset:17856
    v_mfma_f32_16x16x32_bf16 v[208:211], a[224:227], v[112:115], v[208:211]
    ds_read_b64_tr_b16 a[248:249], v3 offset:480
    v_fma_mix_f32 v32, v54, v24, v28 op_sel:[0,0,0] op_sel_hi:[1,0,0]
    v_mfma_f32_16x16x32_bf16 v[208:211], a[228:231], v[116:119], v[208:211]
    ds_read_b64_tr_b16 a[250:251], v3 offset:992
    v_fma_mix_f32 v33, v54, v25, v29 op_sel:[1,0,0] op_sel_hi:[1,0,0]
    v_mfma_f32_16x16x32_bf16 v[240:243], a[224:227], v[120:123], v[240:243]
    ds_read_b64_tr_b16 a[252:253], v3 offset:17376
    v_fma_mix_f32 v34, v55, v26, v30 op_sel:[0,0,0] op_sel_hi:[1,0,0]
    v_mfma_f32_16x16x32_bf16 v[240:243], a[228:231], v[124:127], v[240:243]
    s_waitcnt vmcnt(8)
    s_barrier
    s_waitcnt lgkmcnt(7)
    ds_read_b64_tr_b16 a[254:255], v3 offset:17888
    v_fma_mix_f32 v35, v55, v27, v31 op_sel:[1,0,0] op_sel_hi:[1,0,0]
    v_mfma_f32_16x16x32_bf16 v[212:215], a[232:235], v[112:115], v[212:215]
    ds_read_b64_tr_b16 a[192:193], v3 offset:36864
    v_cvt_pk_bf16_f32 v54, v32, v33
    v_mfma_f32_16x16x32_bf16 v[212:215], a[236:239], v[116:119], v[212:215]
    ds_read_b64_tr_b16 a[194:195], v3 offset:37376
    ds_read_b64_tr_b16 a[196:197], v3 offset:53760
    v_mfma_f32_16x16x32_bf16 v[244:247], a[232:235], v[120:123], v[244:247]
    s_add_u32 m0, s44, 110592
    ds_read_b64_tr_b16 a[198:199], v3 offset:54272
    v_cvt_pk_bf16_f32 v55, v34, v35
    v_mfma_f32_16x16x32_bf16 v[244:247], a[236:239], v[124:127], v[244:247]
    s_mov_b32 s46, 16384
    s_waitcnt lgkmcnt(8)
    buffer_load_dwordx4 v5, s[16:19], s46 offen offset:0 lds
    v_mfma_f32_16x16x32_bf16 v[216:219], a[240:243], v[112:115], v[216:219]
    ds_read_b64_tr_b16 a[200:201], v3 offset:36896
    v_fma_mix_f32 v36, v62, v24, v28 op_sel:[0,0,0] op_sel_hi:[1,0,0]
    v_mfma_f32_16x16x32_bf16 v[216:219], a[244:247], v[116:119], v[216:219]
    ds_read_b64_tr_b16 a[202:203], v3 offset:37408
    ds_read_b64_tr_b16 a[204:205], v3 offset:53792
    v_fma_mix_f32 v37, v62, v25, v29 op_sel:[1,0,0] op_sel_hi:[1,0,0]
    v_mfma_f32_16x16x32_bf16 v[248:251], a[240:243], v[120:123], v[248:251]
    s_add_u32 m0, s44, 110624
    ds_read_b64_tr_b16 a[206:207], v3 offset:54304
    v_fma_mix_f32 v38, v63, v26, v30 op_sel:[0,0,0] op_sel_hi:[1,0,0]
    v_mfma_f32_16x16x32_bf16 v[248:251], a[244:247], v[124:127], v[248:251]
    s_waitcnt lgkmcnt(8)
    buffer_load_dwordx4 v5, s[16:19], s46 offen offset:1024 lds
    v_mfma_f32_16x16x32_bf16 v[220:223], a[248:251], v[112:115], v[220:223]
    ds_read_b64_tr_b16 a[208:209], v3 offset:36928
    v_fma_mix_f32 v39, v63, v27, v31 op_sel:[1,0,0] op_sel_hi:[1,0,0]
    v_mfma_f32_16x16x32_bf16 v[220:223], a[252:255], v[116:119], v[220:223]
    ds_read_b64_tr_b16 a[210:211], v3 offset:37440
    ds_read_b64_tr_b16 a[212:213], v3 offset:53824
    v_cvt_pk_bf16_f32 v62, v36, v37
    v_mfma_f32_16x16x32_bf16 v[252:255], a[248:251], v[120:123], v[252:255]
    s_add_u32 m0, s44, 110656
    ds_read_b64_tr_b16 a[214:215], v3 offset:54336
    v_cvt_pk_bf16_f32 v63, v38, v39
    v_mfma_f32_16x16x32_bf16 v[252:255], a[252:255], v[124:127], v[252:255]
    s_waitcnt lgkmcnt(8)
    buffer_load_dwordx4 v5, s[16:19], s46 offen offset:2048 lds
    v_mfma_f32_16x16x32_bf16 v[128:131], a[192:195], v[48:51], v[128:131]
    ds_read_b64_tr_b16 a[216:217], v3 offset:36960
    v_lshrrev_b32 v14, 2, v0
    v_mfma_f32_16x16x32_bf16 v[128:131], a[196:199], v[52:55], v[128:131]
    s_mul_i32 s3, s51, 144
    ds_read_b64_tr_b16 a[218:219], v3 offset:37472
    ds_read_b64_tr_b16 a[220:221], v3 offset:53856
    v_mfma_f32_16x16x32_bf16 v[160:163], a[192:195], v[56:59], v[160:163]
    s_add_u32 m0, s44, 110688
    ds_read_b64_tr_b16 a[222:223], v3 offset:54368
    v_add_u32 v14, s3, v14
    v_mfma_f32_16x16x32_bf16 v[160:163], a[196:199], v[60:63], v[160:163]
    s_waitcnt lgkmcnt(8)
    buffer_load_dwordx4 v5, s[16:19], s46 offen offset:3072 lds
    v_mfma_f32_16x16x32_bf16 v[132:135], a[200:203], v[48:51], v[132:135]
    ds_read_b64_tr_b16 a[224:225], v3 offset:36992
    v_mul_u32_u24 v14, 9216, v14
    v_mfma_f32_16x16x32_bf16 v[132:135], a[204:207], v[52:55], v[132:135]
    ds_read_b64_tr_b16 a[226:227], v3 offset:37504
    ds_read_b64_tr_b16 a[228:229], v3 offset:53888
    v_mfma_f32_16x16x32_bf16 v[164:167], a[200:203], v[56:59], v[164:167]
    s_add_u32 m0, s44, 127488
    ds_read_b64_tr_b16 a[230:231], v3 offset:54400
    v_and_b32 v15, 3, v0
    v_mfma_f32_16x16x32_bf16 v[164:167], a[204:207], v[60:63], v[164:167]
    s_waitcnt lgkmcnt(8)
    buffer_load_dwordx4 v5, s[20:23], s46 offen offset:0 lds
    v_mfma_f32_16x16x32_bf16 v[136:139], a[208:211], v[48:51], v[136:139]
    ds_read_b64_tr_b16 a[232:233], v3 offset:37024
    v_lshl_add_u32 v6, v15, 4, v14
    v_mfma_f32_16x16x32_bf16 v[136:139], a[212:215], v[52:55], v[136:139]
    s_lshr_b32 s3, s2, 3
    s_lshl2_add_u32 s3, s3, s51
    s_and_b32 s15, s2, 7
    ds_read_b64_tr_b16 a[234:235], v3 offset:37536
    ds_read_b64_tr_b16 a[236:237], v3 offset:53920
    v_mfma_f32_16x16x32_bf16 v[168:171], a[208:211], v[56:59], v[168:171]
    s_add_u32 m0, s44, 127520
    ds_read_b64_tr_b16 a[238:239], v3 offset:54432
    v_lshlrev_b32 v9, 7, v0
    v_mfma_f32_16x16x32_bf16 v[168:171], a[212:215], v[60:63], v[168:171]
    s_waitcnt lgkmcnt(8)
    s_mul_i32 s14, s3, 9
    s_lshr_b32 s14, s14, 1
    buffer_load_dwordx4 v5, s[20:23], s46 offen offset:1024 lds
    v_mfma_f32_16x16x32_bf16 v[140:143], a[216:219], v[48:51], v[140:143]
    ds_read_b64_tr_b16 a[240:241], v3 offset:37056
    v_min_u32 v15, 44, v0
    v_mfma_f32_16x16x32_bf16 v[140:143], a[220:223], v[52:55], v[140:143]
    ds_read_b64_tr_b16 a[242:243], v3 offset:37568
    ds_read_b64_tr_b16 a[244:245], v3 offset:53952
    v_mfma_f32_16x16x32_bf16 v[172:175], a[216:219], v[56:59], v[172:175]
    s_add_u32 m0, s44, 127552
    ds_read_b64_tr_b16 a[246:247], v3 offset:54464
    v_mul_u32_u24 v12, 7282, v15
    v_mfma_f32_16x16x32_bf16 v[172:175], a[220:223], v[60:63], v[172:175]
    s_waitcnt lgkmcnt(8)
    buffer_load_dwordx4 v5, s[20:23], s46 offen offset:2048 lds
    v_mfma_f32_16x16x32_bf16 v[144:147], a[224:227], v[48:51], v[144:147]
    ds_read_b64_tr_b16 a[248:249], v3 offset:37088
    v_lshrrev_b32 v12, 16, v12
    v_mfma_f32_16x16x32_bf16 v[144:147], a[228:231], v[52:55], v[144:147]
    ds_read_b64_tr_b16 a[250:251], v3 offset:37600
    ds_read_b64_tr_b16 a[252:253], v3 offset:53984
    v_mfma_f32_16x16x32_bf16 v[176:179], a[224:227], v[56:59], v[176:179]
    s_add_u32 m0, s44, 127584
    ds_read_b64_tr_b16 a[254:255], v3 offset:54496
    v_mul_u32_u24 v13, 63, v12
    v_mfma_f32_16x16x32_bf16 v[176:179], a[228:231], v[60:63], v[176:179]
    s_waitcnt lgkmcnt(8)
    buffer_load_dwordx4 v5, s[20:23], s46 offen offset:3072 lds
    v_mfma_f32_16x16x32_bf16 v[148:151], a[232:235], v[48:51], v[148:151]
    ds_read_b64_tr_b16 a[192:193], v3 offset:37120
    v_add_u32 v12, v15, v13
    v_mfma_f32_16x16x32_bf16 v[148:151], a[236:239], v[52:55], v[148:151]
    s_mul_i32 s14, s14, 72
    s_mul_i32 s56, s15, 9
    s_add_u32 s14, s14, s56
    ds_read_b64_tr_b16 a[194:195], v3 offset:37632
    v_add_lshl_u32 v12, s14, v12, 7
    v_mfma_f32_16x16x32_bf16 v[180:183], a[232:235], v[56:59], v[180:183]
    s_mul_i32 s14, s3, 81
    s_lshr_b32 s14, s14, 1
    s_mul_i32 s56, s15, 5184
    s_add_u32 s14, s14, s56
    ds_read_b64_tr_b16 a[196:197], v3 offset:54016
    v_min_u32 v13, 40, v0
    v_mfma_f32_16x16x32_bf16 v[180:183], a[236:239], v[60:63], v[180:183]
    s_waitcnt lgkmcnt(7)
    ds_read_b64_tr_b16 a[198:199], v3 offset:54528
    v_add_lshl_u32 v13, s14, v13, 7
    v_mfma_f32_16x16x32_bf16 v[152:155], a[240:243], v[48:51], v[152:155]
    s_mul_i32 s14, s3, 72
    s_andn2_b32 s56, s52, 3
    s_mul_i32 s56, s56, 2304
    s_add_u32 s14, s14, s56
    ds_read_b64_tr_b16 a[200:201], v3 offset:37152
    v_min_u32 v14, 35, v0
    v_mfma_f32_16x16x32_bf16 v[152:155], a[244:247], v[52:55], v[152:155]
    ds_read_b64_tr_b16 a[202:203], v3 offset:37664
    v_add_lshl_u32 v14, s14, v14, 7
    v_mfma_f32_16x16x32_bf16 v[184:187], a[240:243], v[56:59], v[184:187]
    ds_read_b64_tr_b16 a[204:205], v3 offset:54048
    v_add_u32 v15, 4608, v14
    v_mfma_f32_16x16x32_bf16 v[184:187], a[244:247], v[60:63], v[184:187]
    s_waitcnt lgkmcnt(7)
    ds_read_b64_tr_b16 a[206:207], v3 offset:54560
    v_cvt_pk_bf16_f32 v64, v128, v129
    v_mfma_f32_16x16x32_bf16 v[156:159], a[248:251], v[48:51], v[156:159]
    ds_read_b64_tr_b16 a[208:209], v3 offset:37184
    v_cvt_pk_bf16_f32 v65, v130, v131
    v_mfma_f32_16x16x32_bf16 v[156:159], a[252:255], v[52:55], v[156:159]
    ds_read_b64_tr_b16 a[210:211], v3 offset:37696
    v_cvt_pk_bf16_f32 v66, v132, v133
    v_mfma_f32_16x16x32_bf16 v[188:191], a[248:251], v[56:59], v[188:191]
    ds_read_b64_tr_b16 a[212:213], v3 offset:54080
    v_cvt_pk_bf16_f32 v67, v134, v135
    v_mfma_f32_16x16x32_bf16 v[188:191], a[252:255], v[60:63], v[188:191]
    s_waitcnt lgkmcnt(7)
    ds_read_b64_tr_b16 a[214:215], v3 offset:54592
    v_cvt_pk_bf16_f32 v80, v160, v161
    v_mfma_f32_16x16x32_bf16 v[192:195], a[192:195], v[48:51], v[192:195]
    ds_read_b64_tr_b16 a[216:217], v3 offset:37216
    v_cvt_pk_bf16_f32 v81, v162, v163
    v_mfma_f32_16x16x32_bf16 v[192:195], a[196:199], v[52:55], v[192:195]
    ds_read_b64_tr_b16 a[218:219], v3 offset:37728
    v_cvt_pk_bf16_f32 v82, v164, v165
    v_mfma_f32_16x16x32_bf16 v[224:227], a[192:195], v[56:59], v[224:227]
    ds_read_b64_tr_b16 a[220:221], v3 offset:54112
    v_cvt_pk_bf16_f32 v83, v166, v167
    v_mfma_f32_16x16x32_bf16 v[224:227], a[196:199], v[60:63], v[224:227]
    s_waitcnt lgkmcnt(7)
    ds_read_b64_tr_b16 a[222:223], v3 offset:54624
    v_cvt_pk_bf16_f32 v68, v136, v137
    v_mfma_f32_16x16x32_bf16 v[196:199], a[200:203], v[48:51], v[196:199]
    ds_read_b64_tr_b16 a[224:225], v3 offset:37248
    v_cvt_pk_bf16_f32 v69, v138, v139
    v_mfma_f32_16x16x32_bf16 v[196:199], a[204:207], v[52:55], v[196:199]
    ds_read_b64_tr_b16 a[226:227], v3 offset:37760
    v_cvt_pk_bf16_f32 v70, v140, v141
    v_mfma_f32_16x16x32_bf16 v[228:231], a[200:203], v[56:59], v[228:231]
    ds_read_b64_tr_b16 a[228:229], v3 offset:54144
    v_cvt_pk_bf16_f32 v71, v142, v143
    v_mfma_f32_16x16x32_bf16 v[228:231], a[204:207], v[60:63], v[228:231]
    s_waitcnt vmcnt(8)
    s_barrier
    s_waitcnt lgkmcnt(7)
    ds_read_b64_tr_b16 a[230:231], v3 offset:54656
    v_cvt_pk_bf16_f32 v84, v168, v169
    v_mfma_f32_16x16x32_bf16 v[200:203], a[208:211], v[48:51], v[200:203]
    ds_read_b64_tr_b16 a[232:233], v3 offset:37280
    v_cvt_pk_bf16_f32 v85, v170, v171
    v_mfma_f32_16x16x32_bf16 v[200:203], a[212:215], v[52:55], v[200:203]
L2_pad3:
    s_cbranch_execz L2_pad7
    ds_read_b64_tr_b16 a[234:235], v3 offset:37792
    ds_read_b64_tr_b16 a[236:237], v3 offset:54176
    v_mfma_f32_16x16x32_bf16 v[232:235], a[208:211], v[56:59], v[232:235]
    s_add_u32 m0, s44, 0
    ds_read_b64_tr_b16 a[238:239], v3 offset:54688
    v_cvt_pk_bf16_f32 v86, v172, v173
    v_mfma_f32_16x16x32_bf16 v[232:235], a[212:215], v[60:63], v[232:235]
    s_mov_b32 s46, 32768
    s_waitcnt lgkmcnt(8)
    buffer_load_dwordx4 v5, s[16:19], s46 offen offset:0 lds
    v_mfma_f32_16x16x32_bf16 v[204:207], a[216:219], v[48:51], v[204:207]
    ds_read_b64_tr_b16 a[240:241], v3 offset:37312
    v_cvt_pk_bf16_f32 v87, v174, v175
    v_mfma_f32_16x16x32_bf16 v[204:207], a[220:223], v[52:55], v[204:207]
    ds_read_b64_tr_b16 a[242:243], v3 offset:37824
    ds_read_b64_tr_b16 a[244:245], v3 offset:54208
    v_mfma_f32_16x16x32_bf16 v[236:239], a[216:219], v[56:59], v[236:239]
    s_add_u32 m0, s44, 32
    ds_read_b64_tr_b16 a[246:247], v3 offset:54720
    v_cvt_pk_bf16_f32 v72, v144, v145
    v_mfma_f32_16x16x32_bf16 v[236:239], a[220:223], v[60:63], v[236:239]
    s_waitcnt lgkmcnt(8)
    buffer_load_dwordx4 v5, s[16:19], s46 offen offset:1024 lds
    v_mfma_f32_16x16x32_bf16 v[208:211], a[224:227], v[48:51], v[208:211]
    ds_read_b64_tr_b16 a[248:249], v3 offset:37344
    v_cvt_pk_bf16_f32 v73, v146, v147
    v_mfma_f32_16x16x32_bf16 v[208:211], a[228:231], v[52:55], v[208:211]
    ds_read_b64_tr_b16 a[250:251], v3 offset:37856
    ds_read_b64_tr_b16 a[252:253], v3 offset:54240
    v_mfma_f32_16x16x32_bf16 v[240:243], a[224:227], v[56:59], v[240:243]
    s_add_u32 m0, s44, 64
    ds_read_b64_tr_b16 a[254:255], v3 offset:54752
    v_cvt_pk_bf16_f32 v74, v148, v149
    v_mfma_f32_16x16x32_bf16 v[240:243], a[228:231], v[60:63], v[240:243]
    s_waitcnt lgkmcnt(8)
    buffer_load_dwordx4 v5, s[16:19], s46 offen offset:2048 lds
    v_mfma_f32_16x16x32_bf16 v[212:215], a[232:235], v[48:51], v[212:215]
    ds_read_b128 a[64:67], v1 offset:0
    ds_read_b128 a[68:71], v1 offset:64
    v_mfma_f32_16x16x32_bf16 v[212:215], a[236:239], v[52:55], v[212:215]
    ds_read_b128 a[72:75], v1 offset:128
    ds_read_b128 a[76:79], v1 offset:192
    v_mfma_f32_16x16x32_bf16 v[244:247], a[232:235], v[56:59], v[244:247]
    s_add_u32 m0, s44, 96
    ds_read_b128 a[80:83], v1 offset:256
    ds_read_b128 a[84:87], v1 offset:320
    v_mfma_f32_16x16x32_bf16 v[244:247], a[236:239], v[60:63], v[244:247]
    s_waitcnt lgkmcnt(10)
    buffer_load_dwordx4 v5, s[16:19], s46 offen offset:3072 lds
    v_mfma_f32_16x16x32_bf16 v[216:219], a[240:243], v[48:51], v[216:219]
    ds_read_b128 a[88:91], v1 offset:384
    ds_read_b128 a[92:95], v1 offset:448
    v_mfma_f32_16x16x32_bf16 v[216:219], a[244:247], v[52:55], v[216:219]
    ds_read_b128 a[96:99], v1 offset:512
    ds_read_b128 a[100:103], v1 offset:576
    v_mfma_f32_16x16x32_bf16 v[248:251], a[240:243], v[56:59], v[248:251]
    s_add_u32 m0, s44, 16896
    ds_read_b128 a[104:107], v1 offset:640
    ds_read_b128 a[108:111], v1 offset:704
    v_mfma_f32_16x16x32_bf16 v[248:251], a[244:247], v[60:63], v[248:251]
    s_waitcnt lgkmcnt(12)
    buffer_load_dwordx4 v5, s[20:23], s46 offen offset:0 lds
    v_mfma_f32_16x16x32_bf16 v[220:223], a[248:251], v[48:51], v[220:223]
    ds_read_b128 a[112:115], v1 offset:768
    ds_read_b128 a[116:119], v1 offset:832
    v_mfma_f32_16x16x32_bf16 v[220:223], a[252:255], v[52:55], v[220:223]
    ds_read_b128 a[120:123], v1 offset:896
    ds_read_b128 a[124:127], v1 offset:960
    v_mfma_f32_16x16x32_bf16 v[252:255], a[248:251], v[56:59], v[252:255]
    s_add_u32 m0, s44, 16928
    v_cvt_pk_bf16_f32 v75, v150, v151
    v_cvt_pk_bf16_f32 v88, v176, v177
    v_mfma_f32_16x16x32_bf16 v[252:255], a[252:255], v[60:63], v[252:255]
    buffer_load_dwordx4 v5, s[20:23], s46 offen offset:1024 lds
    s_mul_i32 s3, s96, 9216
    s_add_u32 s3, s3, 4194304
    s_add_u32 s32, s84, s3
    s_addc_u32 s33, s85, 0
    s_mov_b32 s34, 9216
    s_mov_b32 s35, 0x20000
    s_add_u32 m0, s44, 16960
    s_nop 0
    buffer_load_dwordx4 v5, s[20:23], s46 offen offset:2048 lds
    s_add_u32 m0, s44, 16992
    s_nop 0
    buffer_load_dwordx4 v5, s[20:23], s46 offen offset:3072 lds
    v_cvt_pk_bf16_f32 v89, v178, v179
    v_cvt_pk_bf16_f32 v90, v180, v181
    v_cvt_pk_bf16_f32 v91, v182, v183
    v_cvt_pk_bf16_f32 v76, v152, v153
    v_cvt_pk_bf16_f32 v77, v154, v155
    v_cvt_pk_bf16_f32 v78, v156, v157
    v_cvt_pk_bf16_f32 v79, v158, v159
    v_cvt_pk_bf16_f32 v92, v184, v185
    v_cvt_pk_bf16_f32 v93, v186, v187
    v_cvt_pk_bf16_f32 v94, v188, v189
    v_cvt_pk_bf16_f32 v95, v190, v191
    v_permlane32_swap_b32 v64, v66
    v_permlane32_swap_b32 v65, v67
    v_permlane32_swap_b32 v80, v82
    v_permlane32_swap_b32 v81, v83
    v_permlane32_swap_b32 v68, v70
    v_permlane32_swap_b32 v69, v71
    v_permlane32_swap_b32 v84, v86
    v_permlane32_swap_b32 v85, v87
    v_permlane32_swap_b32 v72, v74
    v_permlane32_swap_b32 v73, v75
    v_permlane32_swap_b32 v88, v90
    v_permlane32_swap_b32 v89, v91
    v_permlane32_swap_b32 v76, v78
    v_permlane32_swap_b32 v77, v79
    v_permlane32_swap_b32 v92, v94
    v_permlane32_swap_b32 v93, v95
    v_cvt_pk_bf16_f32 v96, v192, v193
    v_cvt_pk_bf16_f32 v97, v194, v195
    v_cvt_pk_bf16_f32 v98, v196, v197
    v_cvt_pk_bf16_f32 v99, v198, v199
    v_cvt_pk_bf16_f32 v112, v224, v225
    v_cvt_pk_bf16_f32 v113, v226, v227
    v_cvt_pk_bf16_f32 v114, v228, v229
    v_cvt_pk_bf16_f32 v115, v230, v231
    v_cvt_pk_bf16_f32 v100, v200, v201
    v_cvt_pk_bf16_f32 v101, v202, v203
    v_cvt_pk_bf16_f32 v102, v204, v205
    v_cvt_pk_bf16_f32 v103, v206, v207
    v_cvt_pk_bf16_f32 v116, v232, v233
    v_cvt_pk_bf16_f32 v117, v234, v235
    v_cvt_pk_bf16_f32 v118, v236, v237
    v_cvt_pk_bf16_f32 v119, v238, v239
    v_cvt_pk_bf16_f32 v104, v208, v209
    v_cvt_pk_bf16_f32 v105, v210, v211
    v_cvt_pk_bf16_f32 v106, v212, v213
    v_cvt_pk_bf16_f32 v107, v214, v215
    v_cvt_pk_bf16_f32 v120, v240, v241
    v_cvt_pk_bf16_f32 v121, v242, v243
    v_cvt_pk_bf16_f32 v122, v244, v245
    v_cvt_pk_bf16_f32 v123, v246, v247
    v_cvt_pk_bf16_f32 v108, v216, v217
    v_cvt_pk_bf16_f32 v109, v218, v219
    v_cvt_pk_bf16_f32 v110, v220, v221
    v_cvt_pk_bf16_f32 v111, v222, v223
    v_cvt_pk_bf16_f32 v124, v248, v249
    v_cvt_pk_bf16_f32 v125, v250, v251
    v_cvt_pk_bf16_f32 v126, v252, v253
    v_cvt_pk_bf16_f32 v127, v254, v255
    s_nop 0
    v_permlane32_swap_b32 v96, v98
    v_permlane32_swap_b32 v97, v99
    v_permlane32_swap_b32 v112, v114
    v_permlane32_swap_b32 v113, v115
    v_permlane32_swap_b32 v100, v102
    v_permlane32_swap_b32 v101, v103
    v_permlane32_swap_b32 v116, v118
    v_permlane32_swap_b32 v117, v119
    v_permlane32_swap_b32 v104, v106
    v_permlane32_swap_b32 v105, v107
    v_permlane32_swap_b32 v120, v122
    v_permlane32_swap_b32 v121, v123
    v_permlane32_swap_b32 v108, v110
    v_permlane32_swap_b32 v109, v111
    v_permlane32_swap_b32 v124, v126
    v_permlane32_swap_b32 v125, v127
    s_waitcnt lgkmcnt(12)
    v_mfma_f32_16x16x32_bf16 v[16:19], a[64:67], v[64:67], 0
    v_mfma_f32_16x16x32_bf16 v[16:19], a[68:71], v[68:71], v[16:19]
    v_mfma_f32_16x16x32_bf16 v[16:19], a[72:75], v[72:75], v[16:19]
    v_mfma_f32_16x16x32_bf16 v[16:19], a[76:79], v[76:79], v[16:19]
    v_mfma_f32_16x16x32_bf16 v[20:23], a[64:67], v[80:83], 0
    v_mfma_f32_16x16x32_bf16 v[20:23], a[68:71], v[84:87], v[20:23]
    v_mfma_f32_16x16x32_bf16 v[20:23], a[72:75], v[88:91], v[20:23]
    v_mfma_f32_16x16x32_bf16 v[20:23], a[76:79], v[92:95], v[20:23]
    v_mfma_f32_16x16x32_bf16 v[24:27], a[64:67], v[96:99], 0
    v_mfma_f32_16x16x32_bf16 v[24:27], a[68:71], v[100:103], v[24:27]
    v_mfma_f32_16x16x32_bf16 v[24:27], a[72:75], v[104:107], v[24:27]
    v_mfma_f32_16x16x32_bf16 v[24:27], a[76:79], v[108:111], v[24:27]
    v_mfma_f32_16x16x32_bf16 v[28:31], a[64:67], v[112:115], 0
    v_mfma_f32_16x16x32_bf16 v[28:31], a[68:71], v[116:119], v[28:31]
    v_mfma_f32_16x16x32_bf16 v[28:31], a[72:75], v[120:123], v[28:31]
    v_mfma_f32_16x16x32_bf16 v[28:31], a[76:79], v[124:127], v[28:31]
    s_nop 1
    v_max3_f32 v16, v16, v17, v18
    v_max_f32 v16, v16, v19
    v_max3_f32 v20, v20, v21, v22
    v_max_f32 v20, v20, v23
    v_max3_f32 v24, v24, v25, v26
    v_max_f32 v24, v24, v27
    v_max3_f32 v28, v28, v29, v30
    v_max_f32 v28, v28, v31
    v_mov_b32 v40, v16
    v_mov_b32 v41, v20
    v_mov_b32 v42, v24
    v_mov_b32 v43, v28
    v_permlane16_swap_b32 v40, v16
    v_permlane16_swap_b32 v41, v20
    v_permlane16_swap_b32 v42, v24
    v_permlane16_swap_b32 v43, v28
    v_max_f32 v16, v16, v40
    v_max_f32 v20, v20, v41
    v_max_f32 v24, v24, v42
    v_max_f32 v28, v28, v43
    v_mov_b32 v40, v16
    v_mov_b32 v41, v20
    v_mov_b32 v42, v24
    v_mov_b32 v43, v28
    v_permlane32_swap_b32 v40, v16
    v_permlane32_swap_b32 v41, v20
    v_permlane32_swap_b32 v42, v24
    v_permlane32_swap_b32 v43, v28
    v_max_f32 v16, v16, v40
    v_max_f32 v20, v20, v41
    v_max_f32 v24, v24, v42
    v_max_f32 v28, v28, v43
    v_sub_f32 v48, 0xc2800000, v16
    v_sub_f32 v49, 0xc2800000, v16
    v_sub_f32 v50, 0xc2800000, v16
    v_sub_f32 v51, 0xc2800000, v16
    v_sub_f32 v52, 0xc2800000, v20
    v_sub_f32 v53, 0xc2800000, v20
    v_sub_f32 v54, 0xc2800000, v20
    v_sub_f32 v55, 0xc2800000, v20
    v_sub_f32 v56, 0xc2800000, v24
    v_sub_f32 v57, 0xc2800000, v24
    v_sub_f32 v58, 0xc2800000, v24
    v_sub_f32 v59, 0xc2800000, v24
    v_sub_f32 v60, 0xc2800000, v28
    v_sub_f32 v61, 0xc2800000, v28
    v_sub_f32 v62, 0xc2800000, v28
    v_sub_f32 v63, 0xc2800000, v28
L2_entry:
    s_mov_b32 s47, s44
    s_mov_b32 s48, -73728
    s_mov_b32 s49, 11
    s_mov_b32 s46, 32768
    s_mov_b32 s100, 0x07060302
    s_waitcnt vmcnt(8)
    s_barrier
    v_mfma_f32_16x16x32_bf16 v[16:19], a[64:67], v[64:67], v[48:51]
    ds_read_b64_tr_b16 a[128:129], v2 offset:0
    ds_read_b64_tr_b16 a[130:131], v2 offset:256
    v_mfma_f32_16x16x32_bf16 v[16:19], a[68:71], v[68:71], v[16:19]
    ds_read_b64_tr_b16 a[132:133], v2 offset:512
    ds_read_b64_tr_b16 a[134:135], v2 offset:768
    v_mfma_f32_16x16x32_bf16 v[16:19], a[72:75], v[72:75], v[16:19]
    s_add_u32 m0, s47, 36864
    ds_read_b64_tr_b16 a[136:137], v2 offset:32
    ds_read_b64_tr_b16 a[138:139], v2 offset:288
    v_mfma_f32_16x16x32_bf16 v[16:19], a[76:79], v[76:79], v[16:19]
    s_waitcnt lgkmcnt(14)
    s_add_u32 s46, s46, 16384
    buffer_load_dwordx4 v5, s[16:19], s46 offen offset:0 lds
    v_mfma_f32_16x16x32_bf16 v[20:23], a[80:83], v[64:67], v[48:51]
    ds_read_b64_tr_b16 a[140:141], v2 offset:544
    ds_read_b64_tr_b16 a[142:143], v2 offset:800
    v_mfma_f32_16x16x32_bf16 v[20:23], a[84:87], v[68:71], v[20:23]
    ds_read_b64_tr_b16 a[144:145], v2 offset:64
    ds_read_b64_tr_b16 a[146:147], v2 offset:320
    v_mfma_f32_16x16x32_bf16 v[20:23], a[88:91], v[72:75], v[20:23]
    s_add_u32 m0, s47, 36896
    ds_read_b64_tr_b16 a[148:149], v2 offset:576
    ds_read_b64_tr_b16 a[150:151], v2 offset:832
    v_mfma_f32_16x16x32_bf16 v[20:23], a[92:95], v[76:79], v[20:23]
    s_waitcnt lgkmcnt(15)
    buffer_load_dwordx4 v5, s[16:19], s46 offen offset:1024 lds
    v_mfma_f32_16x16x32_bf16 v[24:27], a[96:99], v[64:67], v[48:51]
    s_nop 1
    v_exp_f32 v16, v16
    v_mfma_f32_16x16x32_bf16 v[24:27], a[100:103], v[68:71], v[24:27]
    ds_read_b64_tr_b16 a[152:153], v2 offset:96
    ds_read_b64_tr_b16 a[154:155], v2 offset:352
    v_mfma_f32_16x16x32_bf16 v[24:27], a[104:107], v[72:75], v[24:27]
    s_add_u32 m0, s47, 36928
    v_exp_f32 v17, v17
    v_mfma_f32_16x16x32_bf16 v[24:27], a[108:111], v[76:79], v[24:27]
    s_waitcnt lgkmcnt(14)
    buffer_load_dwordx4 v5, s[16:19], s46 offen offset:2048 lds
    v_mfma_f32_16x16x32_bf16 v[28:31], a[112:115], v[64:67], v[48:51]
    v_exp_f32 v18, v18
    v_mfma_f32_16x16x32_bf16 v[28:31], a[116:119], v[68:71], v[28:31]
    ds_read_b64_tr_b16 a[156:157], v2 offset:608
    v_perm_b32 v32, v17, v16, s100
    v_mfma_f32_16x16x32_bf16 v[28:31], a[120:123], v[72:75], v[28:31]
    s_add_u32 m0, s47, 36960
    v_exp_f32 v19, v19
    v_mfma_f32_16x16x32_bf16 v[28:31], a[124:127], v[76:79], v[28:31]
    buffer_load_dwordx4 v5, s[16:19], s46 offen offset:3072 lds
    s_nop 3
    ds_read_b64_tr_b16 a[158:159], v2 offset:864
    ds_read_b64_tr_b16 a[160:161], v2 offset:128
    ds_read_b64_tr_b16 a[162:163], v2 offset:384
    ds_read_b64_tr_b16 a[164:165], v2 offset:640
    ds_read_b64_tr_b16 a[166:167], v2 offset:896
    ds_read_b64_tr_b16 a[168:169], v2 offset:160
    ds_read_b64_tr_b16 a[170:171], v2 offset:416
    ds_read_b64_tr_b16 a[172:173], v2 offset:672
    ds_read_b64_tr_b16 a[174:175], v2 offset:928
    ds_read_b64_tr_b16 a[176:177], v2 offset:192
    ds_read_b64_tr_b16 a[178:179], v2 offset:448
    ds_read_b64_tr_b16 a[180:181], v2 offset:704
    ds_read_b64_tr_b16 a[182:183], v2 offset:960
    ds_read_b64_tr_b16 a[184:185], v2 offset:224
    ds_read_b64_tr_b16 a[186:187], v2 offset:480
    ds_read_b64_tr_b16 a[188:189], v2 offset:736
    ds_read_b64_tr_b16 a[190:191], v2 offset:992
    v_exp_f32 v20, v20
    s_nop 0
    ds_read_b64_tr_b16 a[192:193], v2 offset:36864
    v_perm_b32 v33, v19, v18, s100
    s_add_u32 m0, s47, 53760
    v_exp_f32 v21, v21
    s_nop 0
    buffer_load_dwordx4 v5, s[20:23], s46 offen offset:0 lds
    v_exp_f32 v22, v22
    s_nop 0
    ds_read_b64_tr_b16 a[194:195], v2 offset:37120
    v_perm_b32 v34, v21, v20, s100
    s_add_u32 m0, s47, 53792
    v_exp_f32 v23, v23
    s_nop 0
    buffer_load_dwordx4 v5, s[20:23], s46 offen offset:1024 lds
    v_exp_f32 v24, v24
    s_nop 0
    ds_read_b64_tr_b16 a[196:197], v2 offset:37376
    v_perm_b32 v35, v23, v22, s100
    s_add_u32 m0, s47, 53824
    v_exp_f32 v25, v25
    s_nop 0
    buffer_load_dwordx4 v5, s[20:23], s46 offen offset:2048 lds
    v_exp_f32 v26, v26
    s_nop 0
    ds_read_b64_tr_b16 a[198:199], v2 offset:37632
    v_perm_b32 v36, v25, v24, s100
    s_add_u32 m0, s47, 53856
    v_exp_f32 v27, v27
    s_nop 0
    buffer_load_dwordx4 v5, s[20:23], s46 offen offset:3072 lds
    ds_read_b64_tr_b16 a[200:201], v2 offset:36896
    s_nop 0
    v_mfma_f32_16x16x32_bf16 v[16:19], a[64:67], v[80:83], v[52:55]
    v_exp_f32 v28, v28
    v_mfma_f32_16x16x32_bf16 v[16:19], a[68:71], v[84:87], v[16:19]
    ds_read_b64_tr_b16 a[202:203], v2 offset:37152
    v_perm_b32 v37, v27, v26, s100
    v_mfma_f32_16x16x32_bf16 v[16:19], a[72:75], v[88:91], v[16:19]
    v_exp_f32 v29, v29
    v_mfma_f32_16x16x32_bf16 v[16:19], a[76:79], v[92:95], v[16:19]
    ds_read_b64_tr_b16 a[204:205], v2 offset:37408
    v_mov_b32 v224, 0
    v_mfma_f32_16x16x32_bf16 v[20:23], a[80:83], v[80:83], v[52:55]
    v_exp_f32 v30, v30
    v_mfma_f32_16x16x32_bf16 v[20:23], a[84:87], v[84:87], v[20:23]
    ds_read_b64_tr_b16 a[206:207], v2 offset:37664
    v_perm_b32 v38, v29, v28, s100
    v_mfma_f32_16x16x32_bf16 v[20:23], a[88:91], v[88:91], v[20:23]
    v_exp_f32 v31, v31
    v_mfma_f32_16x16x32_bf16 v[20:23], a[92:95], v[92:95], v[20:23]
    ds_read_b64_tr_b16 a[208:209], v2 offset:36928
    v_mov_b32 v225, 0
    v_mfma_f32_16x16x32_bf16 v[24:27], a[96:99], v[80:83], v[52:55]
    v_exp_f32 v16, v16
    v_mfma_f32_16x16x32_bf16 v[24:27], a[100:103], v[84:87], v[24:27]
    ds_read_b64_tr_b16 a[210:211], v2 offset:37184
    v_perm_b32 v39, v31, v30, s100
    v_mfma_f32_16x16x32_bf16 v[24:27], a[104:107], v[88:91], v[24:27]
    v_exp_f32 v17, v17
    v_mfma_f32_16x16x32_bf16 v[24:27], a[108:111], v[92:95], v[24:27]
    ds_read_b64_tr_b16 a[212:213], v2 offset:37440
    v_mov_b32 v226, 0
    v_mfma_f32_16x16x32_bf16 v[28:31], a[112:115], v[80:83], v[52:55]
    v_exp_f32 v18, v18
    v_mfma_f32_16x16x32_bf16 v[28:31], a[116:119], v[84:87], v[28:31]
    ds_read_b64_tr_b16 a[214:215], v2 offset:37696
    v_perm_b32 v40, v17, v16, s100
    v_mfma_f32_16x16x32_bf16 v[28:31], a[120:123], v[88:91], v[28:31]
    s_waitcnt lgkmcnt(12)
    v_exp_f32 v19, v19
    v_mfma_f32_16x16x32_bf16 v[28:31], a[124:127], v[92:95], v[28:31]
    ds_read_b64_tr_b16 a[216:217], v2 offset:36960
    v_mov_b32 v227, 0
    v_mfma_f32_16x16x32_bf16 v[128:131], a[128:131], v[32:35], 0
    v_exp_f32 v20, v20
    v_mfma_f32_16x16x32_bf16 v[128:131], a[132:135], v[36:39], v[128:131]
    ds_read_b64_tr_b16 a[218:219], v2 offset:37216
    v_perm_b32 v41, v19, v18, s100
    v_mfma_f32_16x16x32_bf16 v[132:135], a[136:139], v[32:35], 0
    v_exp_f32 v21, v21
    v_mfma_f32_16x16x32_bf16 v[132:135], a[140:143], v[36:39], v[132:135]
    ds_read_b64_tr_b16 a[220:221], v2 offset:37472
    v_mov_b32 v228, 0
    v_mfma_f32_16x16x32_bf16 v[136:139], a[144:147], v[32:35], 0
    v_exp_f32 v22, v22
    v_mfma_f32_16x16x32_bf16 v[136:139], a[148:151], v[36:39], v[136:139]
    ds_read_b64_tr_b16 a[222:223], v2 offset:37728
    v_perm_b32 v42, v21, v20, s100
    v_mfma_f32_16x16x32_bf16 v[140:143], a[152:155], v[32:35], 0
    v_exp_f32 v23, v23
    v_mfma_f32_16x16x32_bf16 v[140:143], a[156:159], v[36:39], v[140:143]
    ds_read_b64_tr_b16 a[224:225], v2 offset:36992
    v_mov_b32 v229, 0
    v_mfma_f32_16x16x32_bf16 v[144:147], a[160:163], v[32:35], 0
    v_exp_f32 v24, v24
    v_mfma_f32_16x16x32_bf16 v[144:147], a[164:167], v[36:39], v[144:147]
    ds_read_b64_tr_b16 a[226:227], v2 offset:37248
    v_perm_b32 v43, v23, v22, s100
    v_mfma_f32_16x16x32_bf16 v[148:151], a[168:171], v[32:35], 0
    v_exp_f32 v25, v25
    v_mfma_f32_16x16x32_bf16 v[148:151], a[172:175], v[36:39], v[148:151]
    ds_read_b64_tr_b16 a[228:229], v2 offset:37504
    v_mov_b32 v230, 0
    v_mfma_f32_16x16x32_bf16 v[152:155], a[176:179], v[32:35], 0
    v_exp_f32 v26, v26
    v_mfma_f32_16x16x32_bf16 v[152:155], a[180:183], v[36:39], v[152:155]
    ds_read_b64_tr_b16 a[230:231], v2 offset:37760
    v_perm_b32 v44, v25, v24, s100
    v_mfma_f32_16x16x32_bf16 v[156:159], a[184:187], v[32:35], 0
    v_exp_f32 v27, v27
    v_mfma_f32_16x16x32_bf16 v[156:159], a[188:191], v[36:39], v[156:159]
    ds_read_b64_tr_b16 a[232:233], v2 offset:37024
    v_mov_b32 v231, 0
    v_smfmac_f32_16x16x64_bf16 a[0:3], a[16:19], v[32:39], v11
    ds_read_b64_tr_b16 a[234:235], v2 offset:37280
    v_mov_b32 v232, 0
    v_mfma_f32_16x16x32_bf16 v[16:19], a[64:67], v[96:99], v[56:59]
    v_exp_f32 v28, v28
    v_mfma_f32_16x16x32_bf16 v[16:19], a[68:71], v[100:103], v[16:19]
    ds_read_b64_tr_b16 a[236:237], v2 offset:37536
    v_perm_b32 v45, v27, v26, s100
    v_mfma_f32_16x16x32_bf16 v[16:19], a[72:75], v[104:107], v[16:19]
    v_exp_f32 v29, v29
    v_mfma_f32_16x16x32_bf16 v[16:19], a[76:79], v[108:111], v[16:19]
    ds_read_b64_tr_b16 a[238:239], v2 offset:37792
    v_mov_b32 v233, 0
    v_mfma_f32_16x16x32_bf16 v[20:23], a[80:83], v[96:99], v[56:59]
    v_exp_f32 v30, v30
    v_mfma_f32_16x16x32_bf16 v[20:23], a[84:87], v[100:103], v[20:23]
    ds_read_b64_tr_b16 a[240:241], v2 offset:37056
    v_perm_b32 v46, v29, v28, s100
    v_mfma_f32_16x16x32_bf16 v[20:23], a[88:91], v[104:107], v[20:23]
    v_exp_f32 v31, v31
    v_mfma_f32_16x16x32_bf16 v[20:23], a[92:95], v[108:111], v[20:23]
    ds_read_b64_tr_b16 a[242:243], v2 offset:37312
    v_mov_b32 v234, 0
    v_mfma_f32_16x16x32_bf16 v[24:27], a[96:99], v[96:99], v[56:59]
    v_exp_f32 v16, v16
    v_mfma_f32_16x16x32_bf16 v[24:27], a[100:103], v[100:103], v[24:27]
    ds_read_b64_tr_b16 a[244:245], v2 offset:37568
    v_perm_b32 v47, v31, v30, s100
    v_mfma_f32_16x16x32_bf16 v[24:27], a[104:107], v[104:107], v[24:27]
    v_exp_f32 v17, v17
    v_mfma_f32_16x16x32_bf16 v[24:27], a[108:111], v[108:111], v[24:27]
    ds_read_b64_tr_b16 a[246:247], v2 offset:37824
    v_mov_b32 v235, 0
    v_mfma_f32_16x16x32_bf16 v[28:31], a[112:115], v[96:99], v[56:59]
    v_exp_f32 v18, v18
    v_mfma_f32_16x16x32_bf16 v[28:31], a[116:119], v[100:103], v[28:31]
    ds_read_b64_tr_b16 a[248:249], v2 offset:37088
    v_perm_b32 v32, v17, v16, s100
    v_mfma_f32_16x16x32_bf16 v[28:31], a[120:123], v[104:107], v[28:31]
    v_exp_f32 v19, v19
    v_mfma_f32_16x16x32_bf16 v[28:31], a[124:127], v[108:111], v[28:31]
    ds_read_b64_tr_b16 a[250:251], v2 offset:37344
    v_mov_b32 v236, 0
    v_mfma_f32_16x16x32_bf16 v[160:163], a[128:131], v[40:43], 0
    v_exp_f32 v20, v20
    v_mfma_f32_16x16x32_bf16 v[160:163], a[132:135], v[44:47], v[160:163]
    ds_read_b64_tr_b16 a[252:253], v2 offset:37600
    v_perm_b32 v33, v19, v18, s100
    v_mfma_f32_16x16x32_bf16 v[164:167], a[136:139], v[40:43], 0
    v_exp_f32 v21, v21
    v_mfma_f32_16x16x32_bf16 v[164:167], a[140:143], v[44:47], v[164:167]
    ds_read_b64_tr_b16 a[254:255], v2 offset:37856
    v_mov_b32 v237, 0
    v_mfma_f32_16x16x32_bf16 v[168:171], a[144:147], v[40:43], 0
    v_exp_f32 v22, v22
    v_mfma_f32_16x16x32_bf16 v[168:171], a[148:151], v[44:47], v[168:171]
    v_perm_b32 v34, v21, v20, s100
    v_mov_b32 v238, 0
    v_mfma_f32_16x16x32_bf16 v[172:175], a[152:155], v[40:43], 0
    v_exp_f32 v23, v23
    v_mfma_f32_16x16x32_bf16 v[172:175], a[156:159], v[44:47], v[172:175]
    v_mov_b32 v239, 0
    v_mov_b32 v240, 0
    v_mfma_f32_16x16x32_bf16 v[176:179], a[160:163], v[40:43], 0
    v_exp_f32 v24, v24
    v_mfma_f32_16x16x32_bf16 v[176:179], a[164:167], v[44:47], v[176:179]
    v_perm_b32 v35, v23, v22, s100
    v_mov_b32 v241, 0
    v_mfma_f32_16x16x32_bf16 v[180:183], a[168:171], v[40:43], 0
    v_exp_f32 v25, v25
    v_mfma_f32_16x16x32_bf16 v[180:183], a[172:175], v[44:47], v[180:183]
    v_mov_b32 v242, 0
    v_mov_b32 v243, 0
    v_mfma_f32_16x16x32_bf16 v[184:187], a[176:179], v[40:43], 0
    v_exp_f32 v26, v26
    v_mfma_f32_16x16x32_bf16 v[184:187], a[180:183], v[44:47], v[184:187]
    v_perm_b32 v36, v25, v24, s100
    v_mov_b32 v244, 0
    v_mfma_f32_16x16x32_bf16 v[188:191], a[184:187], v[40:43], 0
    v_exp_f32 v27, v27
    v_mfma_f32_16x16x32_bf16 v[188:191], a[188:191], v[44:47], v[188:191]
    v_mov_b32 v245, 0
    v_mov_b32 v246, 0
    v_smfmac_f32_16x16x64_bf16 a[4:7], a[16:19], v[40:47], v11
    v_mov_b32 v247, 0
    v_mov_b32 v248, 0
    v_mfma_f32_16x16x32_bf16 v[16:19], a[64:67], v[112:115], v[60:63]
    v_exp_f32 v28, v28
    v_mfma_f32_16x16x32_bf16 v[16:19], a[68:71], v[116:119], v[16:19]
    ds_read_b128 a[64:67], v1 offset:36864
    v_perm_b32 v37, v27, v26, s100
    v_mfma_f32_16x16x32_bf16 v[16:19], a[72:75], v[120:123], v[16:19]
    v_exp_f32 v29, v29
    v_mfma_f32_16x16x32_bf16 v[16:19], a[76:79], v[124:127], v[16:19]
    ds_read_b128 a[68:71], v1 offset:36928
    v_mov_b32 v249, 0
    v_mfma_f32_16x16x32_bf16 v[20:23], a[80:83], v[112:115], v[60:63]
    v_exp_f32 v30, v30
    v_mfma_f32_16x16x32_bf16 v[20:23], a[84:87], v[116:119], v[20:23]
    ds_read_b128 a[72:75], v1 offset:36992
    v_perm_b32 v38, v29, v28, s100
    v_mfma_f32_16x16x32_bf16 v[20:23], a[88:91], v[120:123], v[20:23]
    v_exp_f32 v31, v31
    v_mfma_f32_16x16x32_bf16 v[20:23], a[92:95], v[124:127], v[20:23]
    ds_read_b128 a[76:79], v1 offset:37056
    v_mov_b32 v250, 0
    v_mfma_f32_16x16x32_bf16 v[24:27], a[96:99], v[112:115], v[60:63]
    v_exp_f32 v16, v16
    v_mfma_f32_16x16x32_bf16 v[24:27], a[100:103], v[116:119], v[24:27]
    ds_read_b128 a[80:83], v1 offset:37120
    v_perm_b32 v39, v31, v30, s100
    v_mfma_f32_16x16x32_bf16 v[24:27], a[104:107], v[120:123], v[24:27]
    v_exp_f32 v17, v17
    v_mfma_f32_16x16x32_bf16 v[24:27], a[108:111], v[124:127], v[24:27]
    ds_read_b128 a[84:87], v1 offset:37184
    v_mov_b32 v251, 0
    v_mfma_f32_16x16x32_bf16 v[28:31], a[112:115], v[112:115], v[60:63]
    v_exp_f32 v18, v18
    v_mfma_f32_16x16x32_bf16 v[28:31], a[116:119], v[116:119], v[28:31]
    ds_read_b128 a[88:91], v1 offset:37248
    v_perm_b32 v40, v17, v16, s100
    v_mfma_f32_16x16x32_bf16 v[28:31], a[120:123], v[120:123], v[28:31]
    v_exp_f32 v19, v19
    v_mfma_f32_16x16x32_bf16 v[28:31], a[124:127], v[124:127], v[28:31]
    ds_read_b128 a[92:95], v1 offset:37312
    v_mov_b32 v252, 0
    v_mfma_f32_16x16x32_bf16 v[192:195], a[128:131], v[32:35], 0
    v_exp_f32 v20, v20
    v_mfma_f32_16x16x32_bf16 v[192:195], a[132:135], v[36:39], v[192:195]
    ds_read_b128 a[96:99], v1 offset:37376
    v_perm_b32 v41, v19, v18, s100
    v_mfma_f32_16x16x32_bf16 v[196:199], a[136:139], v[32:35], 0
    v_exp_f32 v21, v21
    v_mfma_f32_16x16x32_bf16 v[196:199], a[140:143], v[36:39], v[196:199]
    ds_read_b128 a[100:103], v1 offset:37440
    v_mov_b32 v253, 0
    v_mfma_f32_16x16x32_bf16 v[200:203], a[144:147], v[32:35], 0
    v_exp_f32 v22, v22
    v_mfma_f32_16x16x32_bf16 v[200:203], a[148:151], v[36:39], v[200:203]
    ds_read_b128 a[104:107], v1 offset:37504
    v_perm_b32 v42, v21, v20, s100
    v_mfma_f32_16x16x32_bf16 v[204:207], a[152:155], v[32:35], 0
    v_exp_f32 v23, v23
    v_mfma_f32_16x16x32_bf16 v[204:207], a[156:159], v[36:39], v[204:207]
    ds_read_b128 a[108:111], v1 offset:37568
    v_mov_b32 v254, 0
    v_mfma_f32_16x16x32_bf16 v[208:211], a[160:163], v[32:35], 0
    v_exp_f32 v24, v24
    v_mfma_f32_16x16x32_bf16 v[208:211], a[164:167], v[36:39], v[208:211]
    ds_read_b128 a[112:115], v1 offset:37632
    v_perm_b32 v43, v23, v22, s100
    v_mfma_f32_16x16x32_bf16 v[212:215], a[168:171], v[32:35], 0
    v_exp_f32 v25, v25
    v_mfma_f32_16x16x32_bf16 v[212:215], a[172:175], v[36:39], v[212:215]
    ds_read_b128 a[116:119], v1 offset:37696
    v_mov_b32 v255, 0
    v_mfma_f32_16x16x32_bf16 v[216:219], a[176:179], v[32:35], 0
    v_exp_f32 v26, v26
    v_mfma_f32_16x16x32_bf16 v[216:219], a[180:183], v[36:39], v[216:219]
    ds_read_b128 a[120:123], v1 offset:37760
    v_perm_b32 v44, v25, v24, s100
    v_mfma_f32_16x16x32_bf16 v[220:223], a[184:187], v[32:35], 0
    v_exp_f32 v27, v27
    v_mfma_f32_16x16x32_bf16 v[220:223], a[188:191], v[36:39], v[220:223]
    ds_read_b128 a[124:127], v1 offset:37824
    v_smfmac_f32_16x16x64_bf16 a[8:11], a[16:19], v[32:39], v11
    s_waitcnt lgkmcnt(12)
.p2align 5
L2_loop:
    v_mfma_f32_16x16x32_bf16 v[16:19], a[64:67], v[64:67], v[48:51]
    s_sub_u32 s47, s47, s48
    v_exp_f32 v28, v28
    v_mfma_f32_16x16x32_bf16 v[16:19], a[68:71], v[68:71], v[16:19]
    v_perm_b32 v45, v27, v26, s100
    v_add_u32 v1, s48, v1
    v_mfma_f32_16x16x32_bf16 v[16:19], a[72:75], v[72:75], v[16:19]
    v_exp_f32 v29, v29
    v_mfma_f32_16x16x32_bf16 v[16:19], a[76:79], v[76:79], v[16:19]
    s_waitcnt lgkmcnt(8)
    v_mfma_f32_16x16x32_bf16 v[20:23], a[80:83], v[64:67], v[48:51]
    v_exp_f32 v30, v30
    v_mfma_f32_16x16x32_bf16 v[20:23], a[84:87], v[68:71], v[20:23]
    v_perm_b32 v46, v29, v28, s100
    v_add_u32 v2, s48, v2
    v_mfma_f32_16x16x32_bf16 v[20:23], a[88:91], v[72:75], v[20:23]
    v_exp_f32 v31, v31
    v_mfma_f32_16x16x32_bf16 v[20:23], a[92:95], v[76:79], v[20:23]
    s_waitcnt lgkmcnt(4)
    v_mfma_f32_16x16x32_bf16 v[24:27], a[96:99], v[64:67], v[48:51]
    s_sub_u32 s48, 0, s48
    v_exp_f32 v16, v16
    v_mfma_f32_16x16x32_bf16 v[24:27], a[100:103], v[68:71], v[24:27]
L2_pad4:
    s_cbranch_execz L2_pad8
    v_perm_b32 v47, v31, v30, s100
    v_mfma_f32_16x16x32_bf16 v[24:27], a[104:107], v[72:75], v[24:27]
    v_exp_f32 v17, v17
    v_mfma_f32_16x16x32_bf16 v[24:27], a[108:111], v[76:79], v[24:27]
    s_waitcnt lgkmcnt(0)
    v_mfma_f32_16x16x32_bf16 v[28:31], a[112:115], v[64:67], v[48:51]
    v_exp_f32 v18, v18
    v_mfma_f32_16x16x32_bf16 v[28:31], a[116:119], v[68:71], v[28:31]
    v_perm_b32 v32, v17, v16, s100
    v_mfma_f32_16x16x32_bf16 v[28:31], a[120:123], v[72:75], v[28:31]
    v_exp_f32 v19, v19
    v_mfma_f32_16x16x32_bf16 v[28:31], a[124:127], v[76:79], v[28:31]
    s_waitcnt vmcnt(0)
    s_barrier
    v_mfma_f32_16x16x32_bf16 v[224:227], a[128:131], v[40:43], v[224:227]
    v_exp_f32 v20, v20
    v_mfma_f32_16x16x32_bf16 v[224:227], a[132:135], v[44:47], v[224:227]
    ds_read_b64_tr_b16 a[128:129], v2 offset:0
    v_perm_b32 v33, v19, v18, s100
    v_mfma_f32_16x16x32_bf16 v[228:231], a[136:139], v[40:43], v[228:231]
    s_add_u32 m0, s47, 0
    v_exp_f32 v21, v21
    v_mfma_f32_16x16x32_bf16 v[228:231], a[140:143], v[44:47], v[228:231]
    s_add_u32 s46, s46, 16384
    buffer_load_dwordx4 v5, s[16:19], s46 offen offset:0 lds
    v_mfma_f32_16x16x32_bf16 v[232:235], a[144:147], v[40:43], v[232:235]
    v_exp_f32 v22, v22
    v_mfma_f32_16x16x32_bf16 v[232:235], a[148:151], v[44:47], v[232:235]
    ds_read_b64_tr_b16 a[130:131], v2 offset:256
    v_perm_b32 v34, v21, v20, s100
    v_mfma_f32_16x16x32_bf16 v[236:239], a[152:155], v[40:43], v[236:239]
    s_add_u32 m0, s47, 32
    v_exp_f32 v23, v23
    v_mfma_f32_16x16x32_bf16 v[236:239], a[156:159], v[44:47], v[236:239]
    buffer_load_dwordx4 v5, s[16:19], s46 offen offset:1024 lds
    v_mfma_f32_16x16x32_bf16 v[240:243], a[160:163], v[40:43], v[240:243]
    v_exp_f32 v24, v24
    v_mfma_f32_16x16x32_bf16 v[240:243], a[164:167], v[44:47], v[240:243]
    ds_read_b64_tr_b16 a[132:133], v2 offset:512
    v_perm_b32 v35, v23, v22, s100
    v_mfma_f32_16x16x32_bf16 v[244:247], a[168:171], v[40:43], v[244:247]
    s_add_u32 m0, s47, 64
    v_exp_f32 v25, v25
    v_mfma_f32_16x16x32_bf16 v[244:247], a[172:175], v[44:47], v[244:247]
    buffer_load_dwordx4 v5, s[16:19], s46 offen offset:2048 lds
    v_mfma_f32_16x16x32_bf16 v[248:251], a[176:179], v[40:43], v[248:251]
    v_exp_f32 v26, v26
    v_mfma_f32_16x16x32_bf16 v[248:251], a[180:183], v[44:47], v[248:251]
    ds_read_b64_tr_b16 a[134:135], v2 offset:768
    v_perm_b32 v36, v25, v24, s100
    v_mfma_f32_16x16x32_bf16 v[252:255], a[184:187], v[40:43], v[252:255]
    s_add_u32 m0, s47, 96
    v_exp_f32 v27, v27
    v_mfma_f32_16x16x32_bf16 v[252:255], a[188:191], v[44:47], v[252:255]
    buffer_load_dwordx4 v5, s[16:19], s46 offen offset:3072 lds
    v_smfmac_f32_16x16x64_bf16 a[12:15], a[16:19], v[40:47], v11
    ds_read_b64_tr_b16 a[136:137], v2 offset:32
    v_mfma_f32_16x16x32_bf16 v[16:19], a[64:67], v[80:83], v[52:55]
    v_exp_f32 v28, v28
    v_mfma_f32_16x16x32_bf16 v[16:19], a[68:71], v[84:87], v[16:19]
    ds_read_b64_tr_b16 a[138:139], v2 offset:288
    v_perm_b32 v37, v27, v26, s100
    v_mfma_f32_16x16x32_bf16 v[16:19], a[72:75], v[88:91], v[16:19]
    s_add_u32 m0, s47, 16896
    v_exp_f32 v29, v29
    v_mfma_f32_16x16x32_bf16 v[16:19], a[76:79], v[92:95], v[16:19]
    buffer_load_dwordx4 v5, s[20:23], s46 offen offset:0 lds
    v_mfma_f32_16x16x32_bf16 v[20:23], a[80:83], v[80:83], v[52:55]
    v_exp_f32 v30, v30
    v_mfma_f32_16x16x32_bf16 v[20:23], a[84:87], v[84:87], v[20:23]
    ds_read_b64_tr_b16 a[140:141], v2 offset:544
    v_perm_b32 v38, v29, v28, s100
    v_mfma_f32_16x16x32_bf16 v[20:23], a[88:91], v[88:91], v[20:23]
    s_add_u32 m0, s47, 16928
    v_exp_f32 v31, v31
    v_mfma_f32_16x16x32_bf16 v[20:23], a[92:95], v[92:95], v[20:23]
    buffer_load_dwordx4 v5, s[20:23], s46 offen offset:1024 lds
    v_mfma_f32_16x16x32_bf16 v[24:27], a[96:99], v[80:83], v[52:55]
    v_exp_f32 v16, v16
    v_mfma_f32_16x16x32_bf16 v[24:27], a[100:103], v[84:87], v[24:27]
    ds_read_b64_tr_b16 a[142:143], v2 offset:800
    v_perm_b32 v39, v31, v30, s100
    v_mfma_f32_16x16x32_bf16 v[24:27], a[104:107], v[88:91], v[24:27]
    s_add_u32 m0, s47, 16960
    v_exp_f32 v17, v17
    v_mfma_f32_16x16x32_bf16 v[24:27], a[108:111], v[92:95], v[24:27]
    buffer_load_dwordx4 v5, s[20:23], s46 offen offset:2048 lds
    v_mfma_f32_16x16x32_bf16 v[28:31], a[112:115], v[80:83], v[52:55]
    v_exp_f32 v18, v18
    v_mfma_f32_16x16x32_bf16 v[28:31], a[116:119], v[84:87], v[28:31]
    ds_read_b64_tr_b16 a[144:145], v2 offset:64
    v_perm_b32 v40, v17, v16, s100
    v_mfma_f32_16x16x32_bf16 v[28:31], a[120:123], v[88:91], v[28:31]
    s_add_u32 m0, s47, 16992
    v_exp_f32 v19, v19
    v_mfma_f32_16x16x32_bf16 v[28:31], a[124:127], v[92:95], v[28:31]
    buffer_load_dwordx4 v5, s[20:23], s46 offen offset:3072 lds
    v_mfma_f32_16x16x32_bf16 v[128:131], a[192:195], v[32:35], v[128:131]
    v_exp_f32 v20, v20
    v_mfma_f32_16x16x32_bf16 v[128:131], a[196:199], v[36:39], v[128:131]
    ds_read_b64_tr_b16 a[146:147], v2 offset:320
    v_perm_b32 v41, v19, v18, s100
    v_mfma_f32_16x16x32_bf16 v[132:135], a[200:203], v[32:35], v[132:135]
    v_exp_f32 v21, v21
    v_mfma_f32_16x16x32_bf16 v[132:135], a[204:207], v[36:39], v[132:135]
    ds_read_b64_tr_b16 a[148:149], v2 offset:576
    v_mfma_f32_16x16x32_bf16 v[136:139], a[208:211], v[32:35], v[136:139]
    v_exp_f32 v22, v22
    v_mfma_f32_16x16x32_bf16 v[136:139], a[212:215], v[36:39], v[136:139]
    ds_read_b64_tr_b16 a[150:151], v2 offset:832
    v_perm_b32 v42, v21, v20, s100
    v_mfma_f32_16x16x32_bf16 v[140:143], a[216:219], v[32:35], v[140:143]
    v_exp_f32 v23, v23
    v_mfma_f32_16x16x32_bf16 v[140:143], a[220:223], v[36:39], v[140:143]
    ds_read_b64_tr_b16 a[152:153], v2 offset:96
    ds_read_b64_tr_b16 a[154:155], v2 offset:352
    v_mfma_f32_16x16x32_bf16 v[144:147], a[224:227], v[32:35], v[144:147]
    v_exp_f32 v24, v24
    v_mfma_f32_16x16x32_bf16 v[144:147], a[228:231], v[36:39], v[144:147]
    ds_read_b64_tr_b16 a[156:157], v2 offset:608
    v_perm_b32 v43, v23, v22, s100
    v_mfma_f32_16x16x32_bf16 v[148:151], a[232:235], v[32:35], v[148:151]
    v_exp_f32 v25, v25
    v_mfma_f32_16x16x32_bf16 v[148:151], a[236:239], v[36:39], v[148:151]
    ds_read_b64_tr_b16 a[158:159], v2 offset:864
    ds_read_b64_tr_b16 a[160:161], v2 offset:128
    v_mfma_f32_16x16x32_bf16 v[152:155], a[240:243], v[32:35], v[152:155]
    v_exp_f32 v26, v26
    v_mfma_f32_16x16x32_bf16 v[152:155], a[244:247], v[36:39], v[152:155]
    ds_read_b64_tr_b16 a[162:163], v2 offset:384
    v_perm_b32 v44, v25, v24, s100
    v_mfma_f32_16x16x32_bf16 v[156:159], a[248:251], v[32:35], v[156:159]
    v_exp_f32 v27, v27
    v_mfma_f32_16x16x32_bf16 v[156:159], a[252:255], v[36:39], v[156:159]
    ds_read_b64_tr_b16 a[164:165], v2 offset:640
    ds_read_b64_tr_b16 a[166:167], v2 offset:896
    v_smfmac_f32_16x16x64_bf16 a[0:3], a[16:19], v[32:39], v11
    ds_read_b64_tr_b16 a[168:169], v2 offset:160
    ds_read_b64_tr_b16 a[170:171], v2 offset:416
    v_mfma_f32_16x16x32_bf16 v[16:19], a[64:67], v[96:99], v[56:59]
    v_exp_f32 v28, v28
    v_mfma_f32_16x16x32_bf16 v[16:19], a[68:71], v[100:103], v[16:19]
    ds_read_b64_tr_b16 a[172:173], v2 offset:672
    v_perm_b32 v45, v27, v26, s100
    v_mfma_f32_16x16x32_bf16 v[16:19], a[72:75], v[104:107], v[16:19]
    s_add_u32 m0, s47, 36864
    v_exp_f32 v29, v29
    v_mfma_f32_16x16x32_bf16 v[16:19], a[76:79], v[108:111], v[16:19]
    s_add_u32 s46, s46, 16384
    buffer_load_dwordx4 v5, s[16:19], s46 offen offset:0 lds
    v_mfma_f32_16x16x32_bf16 v[20:23], a[80:83], v[96:99], v[56:59]
    v_exp_f32 v30, v30
    v_mfma_f32_16x16x32_bf16 v[20:23], a[84:87], v[100:103], v[20:23]
    ds_read_b64_tr_b16 a[174:175], v2 offset:928
    v_perm_b32 v46, v29, v28, s100
    v_mfma_f32_16x16x32_bf16 v[20:23], a[88:91], v[104:107], v[20:23]
    s_add_u32 m0, s47, 36896
    v_exp_f32 v31, v31
    v_mfma_f32_16x16x32_bf16 v[20:23], a[92:95], v[108:111], v[20:23]
    buffer_load_dwordx4 v5, s[16:19], s46 offen offset:1024 lds
    v_mfma_f32_16x16x32_bf16 v[24:27], a[96:99], v[96:99], v[56:59]
    v_exp_f32 v16, v16
    v_mfma_f32_16x16x32_bf16 v[24:27], a[100:103], v[100:103], v[24:27]
    ds_read_b64_tr_b16 a[176:177], v2 offset:192
    v_perm_b32 v47, v31, v30, s100
    v_mfma_f32_16x16x32_bf16 v[24:27], a[104:107], v[104:107], v[24:27]
    s_add_u32 m0, s47, 36928
    v_exp_f32 v17, v17
    v_mfma_f32_16x16x32_bf16 v[24:27], a[108:111], v[108:111], v[24:27]
    buffer_load_dwordx4 v5, s[16:19], s46 offen offset:2048 lds
    v_mfma_f32_16x16x32_bf16 v[28:31], a[112:115], v[96:99], v[56:59]
    v_exp_f32 v18, v18
    v_mfma_f32_16x16x32_bf16 v[28:31], a[116:119], v[100:103], v[28:31]
    ds_read_b64_tr_b16 a[178:179], v2 offset:448
    v_perm_b32 v32, v17, v16, s100
    v_mfma_f32_16x16x32_bf16 v[28:31], a[120:123], v[104:107], v[28:31]
    s_add_u32 m0, s47, 36960
    v_exp_f32 v19, v19
    v_mfma_f32_16x16x32_bf16 v[28:31], a[124:127], v[108:111], v[28:31]
    buffer_load_dwordx4 v5, s[16:19], s46 offen offset:3072 lds
    v_mfma_f32_16x16x32_bf16 v[160:163], a[192:195], v[40:43], v[160:163]
    v_exp_f32 v20, v20
    v_mfma_f32_16x16x32_bf16 v[160:163], a[196:199], v[44:47], v[160:163]
    ds_read_b64_tr_b16 a[180:181], v2 offset:704
    v_perm_b32 v33, v19, v18, s100
    v_mfma_f32_16x16x32_bf16 v[164:167], a[200:203], v[40:43], v[164:167]
    s_add_u32 m0, s47, 53760
    v_exp_f32 v21, v21
    v_mfma_f32_16x16x32_bf16 v[164:167], a[204:207], v[44:47], v[164:167]
    buffer_load_dwordx4 v5, s[20:23], s46 offen offset:0 lds
    v_mfma_f32_16x16x32_bf16 v[168:171], a[208:211], v[40:43], v[168:171]
    v_exp_f32 v22, v22
    v_mfma_f32_16x16x32_bf16 v[168:171], a[212:215], v[44:47], v[168:171]
    ds_read_b64_tr_b16 a[182:183], v2 offset:960
    v_perm_b32 v34, v21, v20, s100
    v_mfma_f32_16x16x32_bf16 v[172:175], a[216:219], v[40:43], v[172:175]
    s_add_u32 m0, s47, 53792
    v_exp_f32 v23, v23
    v_mfma_f32_16x16x32_bf16 v[172:175], a[220:223], v[44:47], v[172:175]
    buffer_load_dwordx4 v5, s[20:23], s46 offen offset:1024 lds
    v_mfma_f32_16x16x32_bf16 v[176:179], a[224:227], v[40:43], v[176:179]
    v_exp_f32 v24, v24
    v_mfma_f32_16x16x32_bf16 v[176:179], a[228:231], v[44:47], v[176:179]
    ds_read_b64_tr_b16 a[184:185], v2 offset:224
    v_perm_b32 v35, v23, v22, s100
    v_mfma_f32_16x16x32_bf16 v[180:183], a[232:235], v[40:43], v[180:183]
    s_add_u32 m0, s47, 53824
    v_exp_f32 v25, v25
    v_mfma_f32_16x16x32_bf16 v[180:183], a[236:239], v[44:47], v[180:183]
    buffer_load_dwordx4 v5, s[20:23], s46 offen offset:2048 lds
    v_mfma_f32_16x16x32_bf16 v[184:187], a[240:243], v[40:43], v[184:187]
    v_exp_f32 v26, v26
    v_mfma_f32_16x16x32_bf16 v[184:187], a[244:247], v[44:47], v[184:187]
    ds_read_b64_tr_b16 a[186:187], v2 offset:480
    v_perm_b32 v36, v25, v24, s100
    v_mfma_f32_16x16x32_bf16 v[188:191], a[248:251], v[40:43], v[188:191]
    s_add_u32 m0, s47, 53856
    v_exp_f32 v27, v27
    v_mfma_f32_16x16x32_bf16 v[188:191], a[252:255], v[44:47], v[188:191]
    buffer_load_dwordx4 v5, s[20:23], s46 offen offset:3072 lds
    v_smfmac_f32_16x16x64_bf16 a[4:7], a[16:19], v[40:47], v11
    ds_read_b64_tr_b16 a[188:189], v2 offset:736
    ds_read_b64_tr_b16 a[190:191], v2 offset:992
    v_mfma_f32_16x16x32_bf16 v[16:19], a[64:67], v[112:115], v[60:63]
    v_exp_f32 v28, v28
    v_mfma_f32_16x16x32_bf16 v[16:19], a[68:71], v[116:119], v[16:19]
    ds_read_b128 a[64:67], v1 offset:0
    v_perm_b32 v37, v27, v26, s100
    v_mfma_f32_16x16x32_bf16 v[16:19], a[72:75], v[120:123], v[16:19]
    v_exp_f32 v29, v29
    v_mfma_f32_16x16x32_bf16 v[16:19], a[76:79], v[124:127], v[16:19]
    ds_read_b128 a[68:71], v1 offset:64
    v_mfma_f32_16x16x32_bf16 v[20:23], a[80:83], v[112:115], v[60:63]
    v_exp_f32 v30, v30
    v_mfma_f32_16x16x32_bf16 v[20:23], a[84:87], v[116:119], v[20:23]
    ds_read_b128 a[72:75], v1 offset:128
    v_perm_b32 v38, v29, v28, s100
    v_mfma_f32_16x16x32_bf16 v[20:23], a[88:91], v[120:123], v[20:23]
    v_exp_f32 v31, v31
    v_mfma_f32_16x16x32_bf16 v[20:23], a[92:95], v[124:127], v[20:23]
    ds_read_b128 a[76:79], v1 offset:192
    v_mfma_f32_16x16x32_bf16 v[24:27], a[96:99], v[112:115], v[60:63]
    v_exp_f32 v16, v16
    v_mfma_f32_16x16x32_bf16 v[24:27], a[100:103], v[116:119], v[24:27]
    ds_read_b128 a[80:83], v1 offset:256
    v_perm_b32 v39, v31, v30, s100
    v_mfma_f32_16x16x32_bf16 v[24:27], a[104:107], v[120:123], v[24:27]
    v_exp_f32 v17, v17
    v_mfma_f32_16x16x32_bf16 v[24:27], a[108:111], v[124:127], v[24:27]
    ds_read_b128 a[84:87], v1 offset:320
    v_mfma_f32_16x16x32_bf16 v[28:31], a[112:115], v[112:115], v[60:63]
    v_exp_f32 v18, v18
    v_mfma_f32_16x16x32_bf16 v[28:31], a[116:119], v[116:119], v[28:31]
    ds_read_b128 a[88:91], v1 offset:384
    v_perm_b32 v40, v17, v16, s100
    v_mfma_f32_16x16x32_bf16 v[28:31], a[120:123], v[120:123], v[28:31]
    v_exp_f32 v19, v19
    v_mfma_f32_16x16x32_bf16 v[28:31], a[124:127], v[124:127], v[28:31]
    ds_read_b128 a[92:95], v1 offset:448
    v_mfma_f32_16x16x32_bf16 v[192:195], a[192:195], v[32:35], v[192:195]
    v_exp_f32 v20, v20
    v_mfma_f32_16x16x32_bf16 v[192:195], a[196:199], v[36:39], v[192:195]
    ds_read_b128 a[96:99], v1 offset:512
    v_perm_b32 v41, v19, v18, s100
    v_mfma_f32_16x16x32_bf16 v[196:199], a[200:203], v[32:35], v[196:199]
    v_exp_f32 v21, v21
    v_mfma_f32_16x16x32_bf16 v[196:199], a[204:207], v[36:39], v[196:199]
    ds_read_b128 a[100:103], v1 offset:576
    v_mfma_f32_16x16x32_bf16 v[200:203], a[208:211], v[32:35], v[200:203]
    v_exp_f32 v22, v22
    v_mfma_f32_16x16x32_bf16 v[200:203], a[212:215], v[36:39], v[200:203]
    ds_read_b128 a[104:107], v1 offset:640
    v_perm_b32 v42, v21, v20, s100
    v_mfma_f32_16x16x32_bf16 v[204:207], a[216:219], v[32:35], v[204:207]
    v_exp_f32 v23, v23
    v_mfma_f32_16x16x32_bf16 v[204:207], a[220:223], v[36:39], v[204:207]
    ds_read_b128 a[108:111], v1 offset:704
    v_mfma_f32_16x16x32_bf16 v[208:211], a[224:227], v[32:35], v[208:211]
    v_exp_f32 v24, v24
    v_mfma_f32_16x16x32_bf16 v[208:211], a[228:231], v[36:39], v[208:211]
    ds_read_b128 a[112:115], v1 offset:768
    v_perm_b32 v43, v23, v22, s100
    v_mfma_f32_16x16x32_bf16 v[212:215], a[232:235], v[32:35], v[212:215]
    v_exp_f32 v25, v25
    v_mfma_f32_16x16x32_bf16 v[212:215], a[236:239], v[36:39], v[212:215]
    ds_read_b128 a[116:119], v1 offset:832
    v_mfma_f32_16x16x32_bf16 v[216:219], a[240:243], v[32:35], v[216:219]
    v_exp_f32 v26, v26
    v_mfma_f32_16x16x32_bf16 v[216:219], a[244:247], v[36:39], v[216:219]
    ds_read_b128 a[120:123], v1 offset:896
    v_perm_b32 v44, v25, v24, s100
    v_mfma_f32_16x16x32_bf16 v[220:223], a[248:251], v[32:35], v[220:223]
    v_exp_f32 v27, v27
    v_mfma_f32_16x16x32_bf16 v[220:223], a[252:255], v[36:39], v[220:223]
    ds_read_b128 a[124:127], v1 offset:960
    v_smfmac_f32_16x16x64_bf16 a[8:11], a[16:19], v[32:39], v11
    s_waitcnt lgkmcnt(12)
    v_mfma_f32_16x16x32_bf16 v[16:19], a[64:67], v[64:67], v[48:51]
    v_exp_f32 v28, v28
    v_mfma_f32_16x16x32_bf16 v[16:19], a[68:71], v[68:71], v[16:19]
    v_perm_b32 v45, v27, v26, s100
    v_mfma_f32_16x16x32_bf16 v[16:19], a[72:75], v[72:75], v[16:19]
    v_exp_f32 v29, v29
    v_mfma_f32_16x16x32_bf16 v[16:19], a[76:79], v[76:79], v[16:19]
    s_waitcnt lgkmcnt(8)
    v_mfma_f32_16x16x32_bf16 v[20:23], a[80:83], v[64:67], v[48:51]
    v_exp_f32 v30, v30
    v_mfma_f32_16x16x32_bf16 v[20:23], a[84:87], v[68:71], v[20:23]
    v_perm_b32 v46, v29, v28, s100
    v_mfma_f32_16x16x32_bf16 v[20:23], a[88:91], v[72:75], v[20:23]
    v_exp_f32 v31, v31
    v_mfma_f32_16x16x32_bf16 v[20:23], a[92:95], v[76:79], v[20:23]
    s_waitcnt lgkmcnt(4)
    v_mfma_f32_16x16x32_bf16 v[24:27], a[96:99], v[64:67], v[48:51]
    v_exp_f32 v16, v16
    v_mfma_f32_16x16x32_bf16 v[24:27], a[100:103], v[68:71], v[24:27]
    v_perm_b32 v47, v31, v30, s100
    v_mfma_f32_16x16x32_bf16 v[24:27], a[104:107], v[72:75], v[24:27]
    v_exp_f32 v17, v17
    v_mfma_f32_16x16x32_bf16 v[24:27], a[108:111], v[76:79], v[24:27]
    s_waitcnt lgkmcnt(0)
    v_mfma_f32_16x16x32_bf16 v[28:31], a[112:115], v[64:67], v[48:51]
    v_exp_f32 v18, v18
    v_mfma_f32_16x16x32_bf16 v[28:31], a[116:119], v[68:71], v[28:31]
    v_perm_b32 v32, v17, v16, s100
    v_mfma_f32_16x16x32_bf16 v[28:31], a[120:123], v[72:75], v[28:31]
    v_exp_f32 v19, v19
    v_mfma_f32_16x16x32_bf16 v[28:31], a[124:127], v[76:79], v[28:31]
    v_mfma_f32_16x16x32_bf16 v[224:227], a[192:195], v[40:43], v[224:227]
    v_exp_f32 v20, v20
    v_mfma_f32_16x16x32_bf16 v[224:227], a[196:199], v[44:47], v[224:227]
    ds_read_b64_tr_b16 a[192:193], v2 offset:36864
    v_perm_b32 v33, v19, v18, s100
    v_mfma_f32_16x16x32_bf16 v[228:231], a[200:203], v[40:43], v[228:231]
    v_exp_f32 v21, v21
    v_mfma_f32_16x16x32_bf16 v[228:231], a[204:207], v[44:47], v[228:231]
    ds_read_b64_tr_b16 a[194:195], v2 offset:37120
    v_mfma_f32_16x16x32_bf16 v[232:235], a[208:211], v[40:43], v[232:235]
    v_exp_f32 v22, v22
    v_mfma_f32_16x16x32_bf16 v[232:235], a[212:215], v[44:47], v[232:235]
    ds_read_b64_tr_b16 a[196:197], v2 offset:37376
    v_perm_b32 v34, v21, v20, s100
    v_mfma_f32_16x16x32_bf16 v[236:239], a[216:219], v[40:43], v[236:239]
    v_exp_f32 v23, v23
    v_mfma_f32_16x16x32_bf16 v[236:239], a[220:223], v[44:47], v[236:239]
    ds_read_b64_tr_b16 a[198:199], v2 offset:37632
    v_mfma_f32_16x16x32_bf16 v[240:243], a[224:227], v[40:43], v[240:243]
    v_exp_f32 v24, v24
    v_mfma_f32_16x16x32_bf16 v[240:243], a[228:231], v[44:47], v[240:243]
    ds_read_b64_tr_b16 a[200:201], v2 offset:36896
    v_perm_b32 v35, v23, v22, s100
    v_mfma_f32_16x16x32_bf16 v[244:247], a[232:235], v[40:43], v[244:247]
    v_exp_f32 v25, v25
    v_mfma_f32_16x16x32_bf16 v[244:247], a[236:239], v[44:47], v[244:247]
    ds_read_b64_tr_b16 a[202:203], v2 offset:37152
    v_mfma_f32_16x16x32_bf16 v[248:251], a[240:243], v[40:43], v[248:251]
    v_exp_f32 v26, v26
    v_mfma_f32_16x16x32_bf16 v[248:251], a[244:247], v[44:47], v[248:251]
    ds_read_b64_tr_b16 a[204:205], v2 offset:37408
    v_perm_b32 v36, v25, v24, s100
    v_mfma_f32_16x16x32_bf16 v[252:255], a[248:251], v[40:43], v[252:255]
    v_exp_f32 v27, v27
    v_mfma_f32_16x16x32_bf16 v[252:255], a[252:255], v[44:47], v[252:255]
    ds_read_b64_tr_b16 a[206:207], v2 offset:37664
    v_smfmac_f32_16x16x64_bf16 a[12:15], a[16:19], v[40:47], v11
    ds_read_b64_tr_b16 a[208:209], v2 offset:36928
    v_mfma_f32_16x16x32_bf16 v[16:19], a[64:67], v[80:83], v[52:55]
    v_exp_f32 v28, v28
    v_mfma_f32_16x16x32_bf16 v[16:19], a[68:71], v[84:87], v[16:19]
    ds_read_b64_tr_b16 a[210:211], v2 offset:37184
    v_perm_b32 v37, v27, v26, s100
    v_mfma_f32_16x16x32_bf16 v[16:19], a[72:75], v[88:91], v[16:19]
    v_exp_f32 v29, v29
    v_mfma_f32_16x16x32_bf16 v[16:19], a[76:79], v[92:95], v[16:19]
    ds_read_b64_tr_b16 a[212:213], v2 offset:37440
    v_mfma_f32_16x16x32_bf16 v[20:23], a[80:83], v[80:83], v[52:55]
    v_exp_f32 v30, v30
    v_mfma_f32_16x16x32_bf16 v[20:23], a[84:87], v[84:87], v[20:23]
    ds_read_b64_tr_b16 a[214:215], v2 offset:37696
    v_perm_b32 v38, v29, v28, s100
    v_mfma_f32_16x16x32_bf16 v[20:23], a[88:91], v[88:91], v[20:23]
    v_exp_f32 v31, v31
    v_mfma_f32_16x16x32_bf16 v[20:23], a[92:95], v[92:95], v[20:23]
    ds_read_b64_tr_b16 a[216:217], v2 offset:36960
    v_mfma_f32_16x16x32_bf16 v[24:27], a[96:99], v[80:83], v[52:55]
    v_exp_f32 v16, v16
    v_mfma_f32_16x16x32_bf16 v[24:27], a[100:103], v[84:87], v[24:27]
    ds_read_b64_tr_b16 a[218:219], v2 offset:37216
    v_perm_b32 v39, v31, v30, s100
    v_mfma_f32_16x16x32_bf16 v[24:27], a[104:107], v[88:91], v[24:27]
    v_exp_f32 v17, v17
    v_mfma_f32_16x16x32_bf16 v[24:27], a[108:111], v[92:95], v[24:27]
    ds_read_b64_tr_b16 a[220:221], v2 offset:37472
    v_mfma_f32_16x16x32_bf16 v[28:31], a[112:115], v[80:83], v[52:55]
    v_exp_f32 v18, v18
    v_mfma_f32_16x16x32_bf16 v[28:31], a[116:119], v[84:87], v[28:31]
    ds_read_b64_tr_b16 a[222:223], v2 offset:37728
    v_perm_b32 v40, v17, v16, s100
    v_mfma_f32_16x16x32_bf16 v[28:31], a[120:123], v[88:91], v[28:31]
    v_exp_f32 v19, v19
    v_mfma_f32_16x16x32_bf16 v[28:31], a[124:127], v[92:95], v[28:31]
    ds_read_b64_tr_b16 a[224:225], v2 offset:36992
    v_mfma_f32_16x16x32_bf16 v[128:131], a[128:131], v[32:35], v[128:131]
    v_exp_f32 v20, v20
    v_mfma_f32_16x16x32_bf16 v[128:131], a[132:135], v[36:39], v[128:131]
    ds_read_b64_tr_b16 a[226:227], v2 offset:37248
    v_perm_b32 v41, v19, v18, s100
    v_mfma_f32_16x16x32_bf16 v[132:135], a[136:139], v[32:35], v[132:135]
    v_exp_f32 v21, v21
    v_mfma_f32_16x16x32_bf16 v[132:135], a[140:143], v[36:39], v[132:135]
    ds_read_b64_tr_b16 a[228:229], v2 offset:37504
    v_mfma_f32_16x16x32_bf16 v[136:139], a[144:147], v[32:35], v[136:139]
    v_exp_f32 v22, v22
    v_mfma_f32_16x16x32_bf16 v[136:139], a[148:151], v[36:39], v[136:139]
    ds_read_b64_tr_b16 a[230:231], v2 offset:37760
    v_perm_b32 v42, v21, v20, s100
    v_mfma_f32_16x16x32_bf16 v[140:143], a[152:155], v[32:35], v[140:143]
    v_exp_f32 v23, v23
    v_mfma_f32_16x16x32_bf16 v[140:143], a[156:159], v[36:39], v[140:143]
    ds_read_b64_tr_b16 a[232:233], v2 offset:37024
    v_mfma_f32_16x16x32_bf16 v[144:147], a[160:163], v[32:35], v[144:147]
    v_exp_f32 v24, v24
    v_mfma_f32_16x16x32_bf16 v[144:147], a[164:167], v[36:39], v[144:147]
    ds_read_b64_tr_b16 a[234:235], v2 offset:37280
    v_perm_b32 v43, v23, v22, s100
    v_mfma_f32_16x16x32_bf16 v[148:151], a[168:171], v[32:35], v[148:151]
    v_exp_f32 v25, v25
    v_mfma_f32_16x16x32_bf16 v[148:151], a[172:175], v[36:39], v[148:151]
    ds_read_b64_tr_b16 a[236:237], v2 offset:37536
    v_mfma_f32_16x16x32_bf16 v[152:155], a[176:179], v[32:35], v[152:155]
    v_exp_f32 v26, v26
    v_mfma_f32_16x16x32_bf16 v[152:155], a[180:183], v[36:39], v[152:155]
    ds_read_b64_tr_b16 a[238:239], v2 offset:37792
    v_perm_b32 v44, v25, v24, s100
    v_mfma_f32_16x16x32_bf16 v[156:159], a[184:187], v[32:35], v[156:159]
    v_exp_f32 v27, v27
    v_mfma_f32_16x16x32_bf16 v[156:159], a[188:191], v[36:39], v[156:159]
    ds_read_b64_tr_b16 a[240:241], v2 offset:37056
    v_smfmac_f32_16x16x64_bf16 a[0:3], a[16:19], v[32:39], v11
    ds_read_b64_tr_b16 a[242:243], v2 offset:37312
    v_mfma_f32_16x16x32_bf16 v[16:19], a[64:67], v[96:99], v[56:59]
    v_exp_f32 v28, v28
    v_mfma_f32_16x16x32_bf16 v[16:19], a[68:71], v[100:103], v[16:19]
    ds_read_b64_tr_b16 a[244:245], v2 offset:37568
    v_perm_b32 v45, v27, v26, s100
    v_mfma_f32_16x16x32_bf16 v[16:19], a[72:75], v[104:107], v[16:19]
    v_exp_f32 v29, v29
    v_mfma_f32_16x16x32_bf16 v[16:19], a[76:79], v[108:111], v[16:19]
    ds_read_b64_tr_b16 a[246:247], v2 offset:37824
    v_mfma_f32_16x16x32_bf16 v[20:23], a[80:83], v[96:99], v[56:59]
    v_exp_f32 v30, v30
    v_mfma_f32_16x16x32_bf16 v[20:23], a[84:87], v[100:103], v[20:23]
    ds_read_b64_tr_b16 a[248:249], v2 offset:37088
    v_perm_b32 v46, v29, v28, s100
    v_mfma_f32_16x16x32_bf16 v[20:23], a[88:91], v[104:107], v[20:23]
    v_exp_f32 v31, v31
    v_mfma_f32_16x16x32_bf16 v[20:23], a[92:95], v[108:111], v[20:23]
    ds_read_b64_tr_b16 a[250:251], v2 offset:37344
    v_mfma_f32_16x16x32_bf16 v[24:27], a[96:99], v[96:99], v[56:59]
    v_exp_f32 v16, v16
    v_mfma_f32_16x16x32_bf16 v[24:27], a[100:103], v[100:103], v[24:27]
    ds_read_b64_tr_b16 a[252:253], v2 offset:37600
    v_perm_b32 v47, v31, v30, s100
    v_mfma_f32_16x16x32_bf16 v[24:27], a[104:107], v[104:107], v[24:27]
    v_exp_f32 v17, v17
    v_mfma_f32_16x16x32_bf16 v[24:27], a[108:111], v[108:111], v[24:27]
    ds_read_b64_tr_b16 a[254:255], v2 offset:37856
    v_mfma_f32_16x16x32_bf16 v[28:31], a[112:115], v[96:99], v[56:59]
    v_exp_f32 v18, v18
    v_mfma_f32_16x16x32_bf16 v[28:31], a[116:119], v[100:103], v[28:31]
    v_perm_b32 v32, v17, v16, s100
    v_mfma_f32_16x16x32_bf16 v[28:31], a[120:123], v[104:107], v[28:31]
    v_exp_f32 v19, v19
    v_mfma_f32_16x16x32_bf16 v[28:31], a[124:127], v[108:111], v[28:31]
    v_mfma_f32_16x16x32_bf16 v[160:163], a[128:131], v[40:43], v[160:163]
    v_exp_f32 v20, v20
    v_mfma_f32_16x16x32_bf16 v[160:163], a[132:135], v[44:47], v[160:163]
    v_perm_b32 v33, v19, v18, s100
    v_mfma_f32_16x16x32_bf16 v[164:167], a[136:139], v[40:43], v[164:167]
    v_exp_f32 v21, v21
    v_mfma_f32_16x16x32_bf16 v[164:167], a[140:143], v[44:47], v[164:167]
    v_mfma_f32_16x16x32_bf16 v[168:171], a[144:147], v[40:43], v[168:171]
    v_exp_f32 v22, v22
    v_mfma_f32_16x16x32_bf16 v[168:171], a[148:151], v[44:47], v[168:171]
    v_perm_b32 v34, v21, v20, s100
    v_mfma_f32_16x16x32_bf16 v[172:175], a[152:155], v[40:43], v[172:175]
    v_exp_f32 v23, v23
    v_mfma_f32_16x16x32_bf16 v[172:175], a[156:159], v[44:47], v[172:175]
    v_mfma_f32_16x16x32_bf16 v[176:179], a[160:163], v[40:43], v[176:179]
    v_exp_f32 v24, v24
    v_mfma_f32_16x16x32_bf16 v[176:179], a[164:167], v[44:47], v[176:179]
    v_perm_b32 v35, v23, v22, s100
    v_mfma_f32_16x16x32_bf16 v[180:183], a[168:171], v[40:43], v[180:183]
    v_exp_f32 v25, v25
    v_mfma_f32_16x16x32_bf16 v[180:183], a[172:175], v[44:47], v[180:183]
    v_mfma_f32_16x16x32_bf16 v[184:187], a[176:179], v[40:43], v[184:187]
    v_exp_f32 v26, v26
    v_mfma_f32_16x16x32_bf16 v[184:187], a[180:183], v[44:47], v[184:187]
    v_perm_b32 v36, v25, v24, s100
    v_mfma_f32_16x16x32_bf16 v[188:191], a[184:187], v[40:43], v[188:191]
    v_exp_f32 v27, v27
    v_mfma_f32_16x16x32_bf16 v[188:191], a[188:191], v[44:47], v[188:191]
    v_smfmac_f32_16x16x64_bf16 a[4:7], a[16:19], v[40:47], v11
    v_mfma_f32_16x16x32_bf16 v[16:19], a[64:67], v[112:115], v[60:63]
    v_exp_f32 v28, v28
    v_mfma_f32_16x16x32_bf16 v[16:19], a[68:71], v[116:119], v[16:19]
    ds_read_b128 a[64:67], v1 offset:36864
    v_perm_b32 v37, v27, v26, s100
    v_mfma_f32_16x16x32_bf16 v[16:19], a[72:75], v[120:123], v[16:19]
    v_exp_f32 v29, v29
    v_mfma_f32_16x16x32_bf16 v[16:19], a[76:79], v[124:127], v[16:19]
    ds_read_b128 a[68:71], v1 offset:36928
    v_mfma_f32_16x16x32_bf16 v[20:23], a[80:83], v[112:115], v[60:63]
    v_exp_f32 v30, v30
    v_mfma_f32_16x16x32_bf16 v[20:23], a[84:87], v[116:119], v[20:23]
    ds_read_b128 a[72:75], v1 offset:36992
    v_perm_b32 v38, v29, v28, s100
    v_mfma_f32_16x16x32_bf16 v[20:23], a[88:91], v[120:123], v[20:23]
    v_exp_f32 v31, v31
    v_mfma_f32_16x16x32_bf16 v[20:23], a[92:95], v[124:127], v[20:23]
    ds_read_b128 a[76:79], v1 offset:37056
    v_mfma_f32_16x16x32_bf16 v[24:27], a[96:99], v[112:115], v[60:63]
    v_exp_f32 v16, v16
    v_mfma_f32_16x16x32_bf16 v[24:27], a[100:103], v[116:119], v[24:27]
    ds_read_b128 a[80:83], v1 offset:37120
    v_perm_b32 v39, v31, v30, s100
    v_mfma_f32_16x16x32_bf16 v[24:27], a[104:107], v[120:123], v[24:27]
    v_exp_f32 v17, v17
    v_mfma_f32_16x16x32_bf16 v[24:27], a[108:111], v[124:127], v[24:27]
    ds_read_b128 a[84:87], v1 offset:37184
    v_mfma_f32_16x16x32_bf16 v[28:31], a[112:115], v[112:115], v[60:63]
    v_exp_f32 v18, v18
    v_mfma_f32_16x16x32_bf16 v[28:31], a[116:119], v[116:119], v[28:31]
    ds_read_b128 a[88:91], v1 offset:37248
    v_perm_b32 v40, v17, v16, s100
    v_mfma_f32_16x16x32_bf16 v[28:31], a[120:123], v[120:123], v[28:31]
    v_exp_f32 v19, v19
    v_mfma_f32_16x16x32_bf16 v[28:31], a[124:127], v[124:127], v[28:31]
    ds_read_b128 a[92:95], v1 offset:37312
    v_mfma_f32_16x16x32_bf16 v[192:195], a[128:131], v[32:35], v[192:195]
    v_exp_f32 v20, v20
    v_mfma_f32_16x16x32_bf16 v[192:195], a[132:135], v[36:39], v[192:195]
    ds_read_b128 a[96:99], v1 offset:37376
    v_perm_b32 v41, v19, v18, s100
    v_mfma_f32_16x16x32_bf16 v[196:199], a[136:139], v[32:35], v[196:199]
    v_exp_f32 v21, v21
    v_mfma_f32_16x16x32_bf16 v[196:199], a[140:143], v[36:39], v[196:199]
    ds_read_b128 a[100:103], v1 offset:37440
    v_mfma_f32_16x16x32_bf16 v[200:203], a[144:147], v[32:35], v[200:203]
    v_exp_f32 v22, v22
    v_mfma_f32_16x16x32_bf16 v[200:203], a[148:151], v[36:39], v[200:203]
    ds_read_b128 a[104:107], v1 offset:37504
    v_perm_b32 v42, v21, v20, s100
    v_mfma_f32_16x16x32_bf16 v[204:207], a[152:155], v[32:35], v[204:207]
    v_exp_f32 v23, v23
    v_mfma_f32_16x16x32_bf16 v[204:207], a[156:159], v[36:39], v[204:207]
    ds_read_b128 a[108:111], v1 offset:37568
    v_mfma_f32_16x16x32_bf16 v[208:211], a[160:163], v[32:35], v[208:211]
    v_exp_f32 v24, v24
    v_mfma_f32_16x16x32_bf16 v[208:211], a[164:167], v[36:39], v[208:211]
    ds_read_b128 a[112:115], v1 offset:37632
    v_perm_b32 v43, v23, v22, s100
    v_mfma_f32_16x16x32_bf16 v[212:215], a[168:171], v[32:35], v[212:215]
    v_exp_f32 v25, v25
    v_mfma_f32_16x16x32_bf16 v[212:215], a[172:175], v[36:39], v[212:215]
    ds_read_b128 a[116:119], v1 offset:37696
    v_mfma_f32_16x16x32_bf16 v[216:219], a[176:179], v[32:35], v[216:219]
    v_exp_f32 v26, v26
    v_mfma_f32_16x16x32_bf16 v[216:219], a[180:183], v[36:39], v[216:219]
    s_sub_u32 s49, s49, 1
    ds_read_b128 a[120:123], v1 offset:37760
    v_perm_b32 v44, v25, v24, s100
    v_mfma_f32_16x16x32_bf16 v[220:223], a[184:187], v[32:35], v[220:223]
    s_cmp_lg_u32 s49, 0
    v_exp_f32 v27, v27
    v_mfma_f32_16x16x32_bf16 v[220:223], a[188:191], v[36:39], v[220:223]
    ds_read_b128 a[124:127], v1 offset:37824
    v_smfmac_f32_16x16x64_bf16 a[8:11], a[16:19], v[32:39], v11
    s_waitcnt lgkmcnt(12)
    s_cbranch_scc1 L2_loop
    v_mfma_f32_16x16x32_bf16 v[16:19], a[64:67], v[64:67], v[48:51]
    s_sub_u32 s47, s47, s48
    v_exp_f32 v28, v28
    v_mfma_f32_16x16x32_bf16 v[16:19], a[68:71], v[68:71], v[16:19]
L2_pad5:
    s_cbranch_execz L2_pad9
    v_perm_b32 v45, v27, v26, s100
    v_add_u32 v1, s48, v1
    v_mfma_f32_16x16x32_bf16 v[16:19], a[72:75], v[72:75], v[16:19]
    v_exp_f32 v29, v29
    v_mfma_f32_16x16x32_bf16 v[16:19], a[76:79], v[76:79], v[16:19]
    s_waitcnt lgkmcnt(8)
    v_mfma_f32_16x16x32_bf16 v[20:23], a[80:83], v[64:67], v[48:51]
    v_exp_f32 v30, v30
    v_mfma_f32_16x16x32_bf16 v[20:23], a[84:87], v[68:71], v[20:23]
    v_perm_b32 v46, v29, v28, s100
    v_add_u32 v2, s48, v2
    v_mfma_f32_16x16x32_bf16 v[20:23], a[88:91], v[72:75], v[20:23]
    v_exp_f32 v31, v31
    v_mfma_f32_16x16x32_bf16 v[20:23], a[92:95], v[76:79], v[20:23]
    s_waitcnt lgkmcnt(4)
    v_mfma_f32_16x16x32_bf16 v[24:27], a[96:99], v[64:67], v[48:51]
    s_sub_u32 s48, 0, s48
    v_exp_f32 v16, v16
    v_mfma_f32_16x16x32_bf16 v[24:27], a[100:103], v[68:71], v[24:27]
    v_perm_b32 v47, v31, v30, s100
    v_mfma_f32_16x16x32_bf16 v[24:27], a[104:107], v[72:75], v[24:27]
    v_exp_f32 v17, v17
    v_mfma_f32_16x16x32_bf16 v[24:27], a[108:111], v[76:79], v[24:27]
    s_waitcnt lgkmcnt(0)
    v_mfma_f32_16x16x32_bf16 v[28:31], a[112:115], v[64:67], v[48:51]
    v_exp_f32 v18, v18
    v_mfma_f32_16x16x32_bf16 v[28:31], a[116:119], v[68:71], v[28:31]
    v_perm_b32 v32, v17, v16, s100
    v_mfma_f32_16x16x32_bf16 v[28:31], a[120:123], v[72:75], v[28:31]
    v_exp_f32 v19, v19
    v_mfma_f32_16x16x32_bf16 v[28:31], a[124:127], v[76:79], v[28:31]
    s_waitcnt vmcnt(0)
    s_barrier
    v_mfma_f32_16x16x32_bf16 v[224:227], a[128:131], v[40:43], v[224:227]
    v_exp_f32 v20, v20
    v_mfma_f32_16x16x32_bf16 v[224:227], a[132:135], v[44:47], v[224:227]
    ds_read_b64_tr_b16 a[128:129], v2 offset:0
    v_perm_b32 v33, v19, v18, s100
    v_mfma_f32_16x16x32_bf16 v[228:231], a[136:139], v[40:43], v[228:231]
    s_add_u32 m0, s47, 0
    v_exp_f32 v21, v21
    v_mfma_f32_16x16x32_bf16 v[228:231], a[140:143], v[44:47], v[228:231]
    s_add_u32 s46, s46, 16384
    buffer_load_dwordx4 v5, s[16:19], s46 offen offset:0 lds
    v_mfma_f32_16x16x32_bf16 v[232:235], a[144:147], v[40:43], v[232:235]
    v_exp_f32 v22, v22
    v_mfma_f32_16x16x32_bf16 v[232:235], a[148:151], v[44:47], v[232:235]
    ds_read_b64_tr_b16 a[130:131], v2 offset:256
    v_perm_b32 v34, v21, v20, s100
    v_mfma_f32_16x16x32_bf16 v[236:239], a[152:155], v[40:43], v[236:239]
    s_add_u32 m0, s47, 32
    v_exp_f32 v23, v23
    v_mfma_f32_16x16x32_bf16 v[236:239], a[156:159], v[44:47], v[236:239]
    buffer_load_dwordx4 v5, s[16:19], s46 offen offset:1024 lds
    v_mfma_f32_16x16x32_bf16 v[240:243], a[160:163], v[40:43], v[240:243]
    v_exp_f32 v24, v24
    v_mfma_f32_16x16x32_bf16 v[240:243], a[164:167], v[44:47], v[240:243]
    ds_read_b64_tr_b16 a[132:133], v2 offset:512
    v_perm_b32 v35, v23, v22, s100
    v_mfma_f32_16x16x32_bf16 v[244:247], a[168:171], v[40:43], v[244:247]
    s_add_u32 m0, s47, 64
    v_exp_f32 v25, v25
    v_mfma_f32_16x16x32_bf16 v[244:247], a[172:175], v[44:47], v[244:247]
    buffer_load_dwordx4 v5, s[16:19], s46 offen offset:2048 lds
    v_mfma_f32_16x16x32_bf16 v[248:251], a[176:179], v[40:43], v[248:251]
    v_exp_f32 v26, v26
    v_mfma_f32_16x16x32_bf16 v[248:251], a[180:183], v[44:47], v[248:251]
    ds_read_b64_tr_b16 a[134:135], v2 offset:768
    v_perm_b32 v36, v25, v24, s100
    v_mfma_f32_16x16x32_bf16 v[252:255], a[184:187], v[40:43], v[252:255]
    s_add_u32 m0, s47, 96
    v_exp_f32 v27, v27
    v_mfma_f32_16x16x32_bf16 v[252:255], a[188:191], v[44:47], v[252:255]
    buffer_load_dwordx4 v5, s[16:19], s46 offen offset:3072 lds
    v_smfmac_f32_16x16x64_bf16 a[12:15], a[16:19], v[40:47], v11
    ds_read_b64_tr_b16 a[136:137], v2 offset:32
    v_mfma_f32_16x16x32_bf16 v[16:19], a[64:67], v[80:83], v[52:55]
    v_exp_f32 v28, v28
    v_mfma_f32_16x16x32_bf16 v[16:19], a[68:71], v[84:87], v[16:19]
    ds_read_b64_tr_b16 a[138:139], v2 offset:288
    v_perm_b32 v37, v27, v26, s100
    v_mfma_f32_16x16x32_bf16 v[16:19], a[72:75], v[88:91], v[16:19]
    s_add_u32 m0, s47, 16896
    v_exp_f32 v29, v29
    v_mfma_f32_16x16x32_bf16 v[16:19], a[76:79], v[92:95], v[16:19]
    buffer_load_dwordx4 v5, s[20:23], s46 offen offset:0 lds
    v_mfma_f32_16x16x32_bf16 v[20:23], a[80:83], v[80:83], v[52:55]
    v_exp_f32 v30, v30
    v_mfma_f32_16x16x32_bf16 v[20:23], a[84:87], v[84:87], v[20:23]
    ds_read_b64_tr_b16 a[140:141], v2 offset:544
    v_perm_b32 v38, v29, v28, s100
    v_mfma_f32_16x16x32_bf16 v[20:23], a[88:91], v[88:91], v[20:23]
    s_add_u32 m0, s47, 16928
    v_exp_f32 v31, v31
    v_mfma_f32_16x16x32_bf16 v[20:23], a[92:95], v[92:95], v[20:23]
    buffer_load_dwordx4 v5, s[20:23], s46 offen offset:1024 lds
    v_mfma_f32_16x16x32_bf16 v[24:27], a[96:99], v[80:83], v[52:55]
    v_exp_f32 v16, v16
    v_mfma_f32_16x16x32_bf16 v[24:27], a[100:103], v[84:87], v[24:27]
    ds_read_b64_tr_b16 a[142:143], v2 offset:800
    v_perm_b32 v39, v31, v30, s100
    v_mfma_f32_16x16x32_bf16 v[24:27], a[104:107], v[88:91], v[24:27]
    s_add_u32 m0, s47, 16960
    v_exp_f32 v17, v17
    v_mfma_f32_16x16x32_bf16 v[24:27], a[108:111], v[92:95], v[24:27]
    buffer_load_dwordx4 v5, s[20:23], s46 offen offset:2048 lds
    v_mfma_f32_16x16x32_bf16 v[28:31], a[112:115], v[80:83], v[52:55]
    v_exp_f32 v18, v18
    v_mfma_f32_16x16x32_bf16 v[28:31], a[116:119], v[84:87], v[28:31]
    ds_read_b64_tr_b16 a[144:145], v2 offset:64
    v_perm_b32 v40, v17, v16, s100
    v_mfma_f32_16x16x32_bf16 v[28:31], a[120:123], v[88:91], v[28:31]
    s_add_u32 m0, s47, 16992
    v_exp_f32 v19, v19
    v_mfma_f32_16x16x32_bf16 v[28:31], a[124:127], v[92:95], v[28:31]
    buffer_load_dwordx4 v5, s[20:23], s46 offen offset:3072 lds
    v_mfma_f32_16x16x32_bf16 v[128:131], a[192:195], v[32:35], v[128:131]
    v_exp_f32 v20, v20
    v_mfma_f32_16x16x32_bf16 v[128:131], a[196:199], v[36:39], v[128:131]
    ds_read_b64_tr_b16 a[146:147], v2 offset:320
    v_perm_b32 v41, v19, v18, s100
    v_mfma_f32_16x16x32_bf16 v[132:135], a[200:203], v[32:35], v[132:135]
    v_exp_f32 v21, v21
    v_mfma_f32_16x16x32_bf16 v[132:135], a[204:207], v[36:39], v[132:135]
    ds_read_b64_tr_b16 a[148:149], v2 offset:576
    v_mfma_f32_16x16x32_bf16 v[136:139], a[208:211], v[32:35], v[136:139]
    v_exp_f32 v22, v22
    v_mfma_f32_16x16x32_bf16 v[136:139], a[212:215], v[36:39], v[136:139]
    ds_read_b64_tr_b16 a[150:151], v2 offset:832
    v_perm_b32 v42, v21, v20, s100
    v_mfma_f32_16x16x32_bf16 v[140:143], a[216:219], v[32:35], v[140:143]
    v_exp_f32 v23, v23
    v_mfma_f32_16x16x32_bf16 v[140:143], a[220:223], v[36:39], v[140:143]
    ds_read_b64_tr_b16 a[152:153], v2 offset:96
    ds_read_b64_tr_b16 a[154:155], v2 offset:352
    v_mfma_f32_16x16x32_bf16 v[144:147], a[224:227], v[32:35], v[144:147]
    v_exp_f32 v24, v24
    v_mfma_f32_16x16x32_bf16 v[144:147], a[228:231], v[36:39], v[144:147]
    ds_read_b64_tr_b16 a[156:157], v2 offset:608
    v_perm_b32 v43, v23, v22, s100
    v_mfma_f32_16x16x32_bf16 v[148:151], a[232:235], v[32:35], v[148:151]
    v_exp_f32 v25, v25
    v_mfma_f32_16x16x32_bf16 v[148:151], a[236:239], v[36:39], v[148:151]
    ds_read_b64_tr_b16 a[158:159], v2 offset:864
    ds_read_b64_tr_b16 a[160:161], v2 offset:128
    v_mfma_f32_16x16x32_bf16 v[152:155], a[240:243], v[32:35], v[152:155]
    v_exp_f32 v26, v26
    v_mfma_f32_16x16x32_bf16 v[152:155], a[244:247], v[36:39], v[152:155]
    ds_read_b64_tr_b16 a[162:163], v2 offset:384
    v_perm_b32 v44, v25, v24, s100
    v_mfma_f32_16x16x32_bf16 v[156:159], a[248:251], v[32:35], v[156:159]
    v_exp_f32 v27, v27
    v_mfma_f32_16x16x32_bf16 v[156:159], a[252:255], v[36:39], v[156:159]
    ds_read_b64_tr_b16 a[164:165], v2 offset:640
    ds_read_b64_tr_b16 a[166:167], v2 offset:896
    v_smfmac_f32_16x16x64_bf16 a[0:3], a[16:19], v[32:39], v11
    ds_read_b64_tr_b16 a[168:169], v2 offset:160
    ds_read_b64_tr_b16 a[170:171], v2 offset:416
    v_mfma_f32_16x16x32_bf16 v[16:19], a[64:67], v[96:99], v[56:59]
    v_exp_f32 v28, v28
    v_mfma_f32_16x16x32_bf16 v[16:19], a[68:71], v[100:103], v[16:19]
    ds_read_b64_tr_b16 a[172:173], v2 offset:672
    v_perm_b32 v45, v27, v26, s100
    v_mfma_f32_16x16x32_bf16 v[16:19], a[72:75], v[104:107], v[16:19]
    s_add_u32 m0, s47, 36864
    v_exp_f32 v29, v29
    v_mfma_f32_16x16x32_bf16 v[16:19], a[76:79], v[108:111], v[16:19]
    s_add_u32 s46, s46, 16384
    buffer_load_dwordx4 v5, s[16:19], s46 offen offset:0 lds
    v_mfma_f32_16x16x32_bf16 v[20:23], a[80:83], v[96:99], v[56:59]
    v_exp_f32 v30, v30
    v_mfma_f32_16x16x32_bf16 v[20:23], a[84:87], v[100:103], v[20:23]
    ds_read_b64_tr_b16 a[174:175], v2 offset:928
    v_perm_b32 v46, v29, v28, s100
    v_mfma_f32_16x16x32_bf16 v[20:23], a[88:91], v[104:107], v[20:23]
    s_add_u32 m0, s47, 36896
    v_exp_f32 v31, v31
    v_mfma_f32_16x16x32_bf16 v[20:23], a[92:95], v[108:111], v[20:23]
    buffer_load_dwordx4 v5, s[16:19], s46 offen offset:1024 lds
    v_mfma_f32_16x16x32_bf16 v[24:27], a[96:99], v[96:99], v[56:59]
    v_exp_f32 v16, v16
    v_mfma_f32_16x16x32_bf16 v[24:27], a[100:103], v[100:103], v[24:27]
    ds_read_b64_tr_b16 a[176:177], v2 offset:192
    v_perm_b32 v47, v31, v30, s100
    v_mfma_f32_16x16x32_bf16 v[24:27], a[104:107], v[104:107], v[24:27]
    s_add_u32 m0, s47, 36928
    v_exp_f32 v17, v17
    v_mfma_f32_16x16x32_bf16 v[24:27], a[108:111], v[108:111], v[24:27]
    buffer_load_dwordx4 v5, s[16:19], s46 offen offset:2048 lds
    v_mfma_f32_16x16x32_bf16 v[28:31], a[112:115], v[96:99], v[56:59]
    v_exp_f32 v18, v18
    v_mfma_f32_16x16x32_bf16 v[28:31], a[116:119], v[100:103], v[28:31]
    ds_read_b64_tr_b16 a[178:179], v2 offset:448
    v_perm_b32 v32, v17, v16, s100
    v_mfma_f32_16x16x32_bf16 v[28:31], a[120:123], v[104:107], v[28:31]
    s_add_u32 m0, s47, 36960
    v_exp_f32 v19, v19
    v_mfma_f32_16x16x32_bf16 v[28:31], a[124:127], v[108:111], v[28:31]
    buffer_load_dwordx4 v5, s[16:19], s46 offen offset:3072 lds
    v_mfma_f32_16x16x32_bf16 v[160:163], a[192:195], v[40:43], v[160:163]
    v_exp_f32 v20, v20
    v_mfma_f32_16x16x32_bf16 v[160:163], a[196:199], v[44:47], v[160:163]
    ds_read_b64_tr_b16 a[180:181], v2 offset:704
    v_perm_b32 v33, v19, v18, s100
    v_mfma_f32_16x16x32_bf16 v[164:167], a[200:203], v[40:43], v[164:167]
    s_add_u32 m0, s47, 53760
    v_exp_f32 v21, v21
    v_mfma_f32_16x16x32_bf16 v[164:167], a[204:207], v[44:47], v[164:167]
    buffer_load_dwordx4 v5, s[20:23], s46 offen offset:0 lds
    v_mfma_f32_16x16x32_bf16 v[168:171], a[208:211], v[40:43], v[168:171]
    v_exp_f32 v22, v22
    v_mfma_f32_16x16x32_bf16 v[168:171], a[212:215], v[44:47], v[168:171]
    ds_read_b64_tr_b16 a[182:183], v2 offset:960
    v_perm_b32 v34, v21, v20, s100
    v_mfma_f32_16x16x32_bf16 v[172:175], a[216:219], v[40:43], v[172:175]
    s_add_u32 m0, s47, 53792
    v_exp_f32 v23, v23
    v_mfma_f32_16x16x32_bf16 v[172:175], a[220:223], v[44:47], v[172:175]
    buffer_load_dwordx4 v5, s[20:23], s46 offen offset:1024 lds
    v_mfma_f32_16x16x32_bf16 v[176:179], a[224:227], v[40:43], v[176:179]
    v_exp_f32 v24, v24
    v_mfma_f32_16x16x32_bf16 v[176:179], a[228:231], v[44:47], v[176:179]
    ds_read_b64_tr_b16 a[184:185], v2 offset:224
    v_perm_b32 v35, v23, v22, s100
    v_mfma_f32_16x16x32_bf16 v[180:183], a[232:235], v[40:43], v[180:183]
    s_add_u32 m0, s47, 53824
    v_exp_f32 v25, v25
    v_mfma_f32_16x16x32_bf16 v[180:183], a[236:239], v[44:47], v[180:183]
    buffer_load_dwordx4 v5, s[20:23], s46 offen offset:2048 lds
    v_mfma_f32_16x16x32_bf16 v[184:187], a[240:243], v[40:43], v[184:187]
    v_exp_f32 v26, v26
    v_mfma_f32_16x16x32_bf16 v[184:187], a[244:247], v[44:47], v[184:187]
    ds_read_b64_tr_b16 a[186:187], v2 offset:480
    v_perm_b32 v36, v25, v24, s100
    v_mfma_f32_16x16x32_bf16 v[188:191], a[248:251], v[40:43], v[188:191]
    s_add_u32 m0, s47, 53856
    v_exp_f32 v27, v27
    v_mfma_f32_16x16x32_bf16 v[188:191], a[252:255], v[44:47], v[188:191]
    buffer_load_dwordx4 v5, s[20:23], s46 offen offset:3072 lds
    v_smfmac_f32_16x16x64_bf16 a[4:7], a[16:19], v[40:47], v11
    ds_read_b64_tr_b16 a[188:189], v2 offset:736
    ds_read_b64_tr_b16 a[190:191], v2 offset:992
    v_mfma_f32_16x16x32_bf16 v[16:19], a[64:67], v[112:115], v[60:63]
    v_exp_f32 v28, v28
    v_mfma_f32_16x16x32_bf16 v[16:19], a[68:71], v[116:119], v[16:19]
    ds_read_b128 a[64:67], v1 offset:0
    v_perm_b32 v37, v27, v26, s100
    v_mfma_f32_16x16x32_bf16 v[16:19], a[72:75], v[120:123], v[16:19]
    v_exp_f32 v29, v29
    v_mfma_f32_16x16x32_bf16 v[16:19], a[76:79], v[124:127], v[16:19]
    ds_read_b128 a[68:71], v1 offset:64
    v_mfma_f32_16x16x32_bf16 v[20:23], a[80:83], v[112:115], v[60:63]
    v_exp_f32 v30, v30
    v_mfma_f32_16x16x32_bf16 v[20:23], a[84:87], v[116:119], v[20:23]
    ds_read_b128 a[72:75], v1 offset:128
    v_perm_b32 v38, v29, v28, s100
    v_mfma_f32_16x16x32_bf16 v[20:23], a[88:91], v[120:123], v[20:23]
    v_exp_f32 v31, v31
    v_mfma_f32_16x16x32_bf16 v[20:23], a[92:95], v[124:127], v[20:23]
    ds_read_b128 a[76:79], v1 offset:192
    v_mfma_f32_16x16x32_bf16 v[24:27], a[96:99], v[112:115], v[60:63]
    v_exp_f32 v16, v16
    v_mfma_f32_16x16x32_bf16 v[24:27], a[100:103], v[116:119], v[24:27]
    ds_read_b128 a[80:83], v1 offset:256
    v_perm_b32 v39, v31, v30, s100
    v_mfma_f32_16x16x32_bf16 v[24:27], a[104:107], v[120:123], v[24:27]
    v_exp_f32 v17, v17
    v_mfma_f32_16x16x32_bf16 v[24:27], a[108:111], v[124:127], v[24:27]
    ds_read_b128 a[84:87], v1 offset:320
    v_mfma_f32_16x16x32_bf16 v[28:31], a[112:115], v[112:115], v[60:63]
    v_exp_f32 v18, v18
    v_mfma_f32_16x16x32_bf16 v[28:31], a[116:119], v[116:119], v[28:31]
    ds_read_b128 a[88:91], v1 offset:384
    v_perm_b32 v40, v17, v16, s100
    v_mfma_f32_16x16x32_bf16 v[28:31], a[120:123], v[120:123], v[28:31]
    v_exp_f32 v19, v19
    v_mfma_f32_16x16x32_bf16 v[28:31], a[124:127], v[124:127], v[28:31]
    ds_read_b128 a[92:95], v1 offset:448
    v_mfma_f32_16x16x32_bf16 v[192:195], a[192:195], v[32:35], v[192:195]
    v_exp_f32 v20, v20
    v_mfma_f32_16x16x32_bf16 v[192:195], a[196:199], v[36:39], v[192:195]
    ds_read_b128 a[96:99], v1 offset:512
    v_perm_b32 v41, v19, v18, s100
    v_mfma_f32_16x16x32_bf16 v[196:199], a[200:203], v[32:35], v[196:199]
    v_exp_f32 v21, v21
    v_mfma_f32_16x16x32_bf16 v[196:199], a[204:207], v[36:39], v[196:199]
    ds_read_b128 a[100:103], v1 offset:576
    v_mfma_f32_16x16x32_bf16 v[200:203], a[208:211], v[32:35], v[200:203]
    v_exp_f32 v22, v22
    v_mfma_f32_16x16x32_bf16 v[200:203], a[212:215], v[36:39], v[200:203]
    ds_read_b128 a[104:107], v1 offset:640
    v_perm_b32 v42, v21, v20, s100
    v_mfma_f32_16x16x32_bf16 v[204:207], a[216:219], v[32:35], v[204:207]
    v_exp_f32 v23, v23
    v_mfma_f32_16x16x32_bf16 v[204:207], a[220:223], v[36:39], v[204:207]
    ds_read_b128 a[108:111], v1 offset:704
    v_mfma_f32_16x16x32_bf16 v[208:211], a[224:227], v[32:35], v[208:211]
    v_exp_f32 v24, v24
    v_mfma_f32_16x16x32_bf16 v[208:211], a[228:231], v[36:39], v[208:211]
    ds_read_b128 a[112:115], v1 offset:768
    v_perm_b32 v43, v23, v22, s100
    v_mfma_f32_16x16x32_bf16 v[212:215], a[232:235], v[32:35], v[212:215]
    v_exp_f32 v25, v25
    v_mfma_f32_16x16x32_bf16 v[212:215], a[236:239], v[36:39], v[212:215]
    ds_read_b128 a[116:119], v1 offset:832
    v_mfma_f32_16x16x32_bf16 v[216:219], a[240:243], v[32:35], v[216:219]
    v_exp_f32 v26, v26
    v_mfma_f32_16x16x32_bf16 v[216:219], a[244:247], v[36:39], v[216:219]
    ds_read_b128 a[120:123], v1 offset:896
    v_perm_b32 v44, v25, v24, s100
    v_mfma_f32_16x16x32_bf16 v[220:223], a[248:251], v[32:35], v[220:223]
    v_exp_f32 v27, v27
    v_mfma_f32_16x16x32_bf16 v[220:223], a[252:255], v[36:39], v[220:223]
    ds_read_b128 a[124:127], v1 offset:960
    v_smfmac_f32_16x16x64_bf16 a[8:11], a[16:19], v[32:39], v11
    s_waitcnt lgkmcnt(12)
    v_mfma_f32_16x16x32_bf16 v[16:19], a[64:67], v[64:67], v[48:51]
    v_exp_f32 v28, v28
    v_mfma_f32_16x16x32_bf16 v[16:19], a[68:71], v[68:71], v[16:19]
    v_perm_b32 v45, v27, v26, s100
    v_mfma_f32_16x16x32_bf16 v[16:19], a[72:75], v[72:75], v[16:19]
    v_exp_f32 v29, v29
    v_mfma_f32_16x16x32_bf16 v[16:19], a[76:79], v[76:79], v[16:19]
    s_waitcnt lgkmcnt(8)
    global_load_dword a63, v12, s[4:5]
    v_mfma_f32_16x16x32_bf16 v[20:23], a[80:83], v[64:67], v[48:51]
    v_exp_f32 v30, v30
    v_mfma_f32_16x16x32_bf16 v[20:23], a[84:87], v[68:71], v[20:23]
    v_perm_b32 v46, v29, v28, s100
    v_mfma_f32_16x16x32_bf16 v[20:23], a[88:91], v[72:75], v[20:23]
    v_exp_f32 v31, v31
    v_mfma_f32_16x16x32_bf16 v[20:23], a[92:95], v[76:79], v[20:23]
    s_waitcnt lgkmcnt(4)
    v_mfma_f32_16x16x32_bf16 v[24:27], a[96:99], v[64:67], v[48:51]
    v_exp_f32 v16, v16
    v_mfma_f32_16x16x32_bf16 v[24:27], a[100:103], v[68:71], v[24:27]
    v_perm_b32 v47, v31, v30, s100
    v_mfma_f32_16x16x32_bf16 v[24:27], a[104:107], v[72:75], v[24:27]
    v_exp_f32 v17, v17
    v_mfma_f32_16x16x32_bf16 v[24:27], a[108:111], v[76:79], v[24:27]
    s_waitcnt lgkmcnt(0)
    global_load_dword a63, v14, s[10:11]
    v_mfma_f32_16x16x32_bf16 v[28:31], a[112:115], v[64:67], v[48:51]
    v_exp_f32 v18, v18
    v_mfma_f32_16x16x32_bf16 v[28:31], a[116:119], v[68:71], v[28:31]
    v_perm_b32 v32, v17, v16, s100
    v_mfma_f32_16x16x32_bf16 v[28:31], a[120:123], v[72:75], v[28:31]
    v_exp_f32 v19, v19
    v_mfma_f32_16x16x32_bf16 v[28:31], a[124:127], v[76:79], v[28:31]
    v_mfma_f32_16x16x32_bf16 v[224:227], a[192:195], v[40:43], v[224:227]
    v_exp_f32 v20, v20
    v_mfma_f32_16x16x32_bf16 v[224:227], a[196:199], v[44:47], v[224:227]
    ds_read_b64_tr_b16 a[192:193], v2 offset:36864
    v_perm_b32 v33, v19, v18, s100
    v_mfma_f32_16x16x32_bf16 v[228:231], a[200:203], v[40:43], v[228:231]
    v_exp_f32 v21, v21
    v_mfma_f32_16x16x32_bf16 v[228:231], a[204:207], v[44:47], v[228:231]
    ds_read_b64_tr_b16 a[194:195], v2 offset:37120
    v_mfma_f32_16x16x32_bf16 v[232:235], a[208:211], v[40:43], v[232:235]
    v_exp_f32 v22, v22
    v_mfma_f32_16x16x32_bf16 v[232:235], a[212:215], v[44:47], v[232:235]
    ds_read_b64_tr_b16 a[196:197], v2 offset:37376
    v_perm_b32 v34, v21, v20, s100
    v_mfma_f32_16x16x32_bf16 v[236:239], a[216:219], v[40:43], v[236:239]
    v_exp_f32 v23, v23
    v_mfma_f32_16x16x32_bf16 v[236:239], a[220:223], v[44:47], v[236:239]
    ds_read_b64_tr_b16 a[198:199], v2 offset:37632
    v_mfma_f32_16x16x32_bf16 v[240:243], a[224:227], v[40:43], v[240:243]
    v_exp_f32 v24, v24
    v_mfma_f32_16x16x32_bf16 v[240:243], a[228:231], v[44:47], v[240:243]
    ds_read_b64_tr_b16 a[200:201], v2 offset:36896
    v_perm_b32 v35, v23, v22, s100
    v_mfma_f32_16x16x32_bf16 v[244:247], a[232:235], v[40:43], v[244:247]
    v_exp_f32 v25, v25
    v_mfma_f32_16x16x32_bf16 v[244:247], a[236:239], v[44:47], v[244:247]
    ds_read_b64_tr_b16 a[202:203], v2 offset:37152
    v_mfma_f32_16x16x32_bf16 v[248:251], a[240:243], v[40:43], v[248:251]
    v_exp_f32 v26, v26
    v_mfma_f32_16x16x32_bf16 v[248:251], a[244:247], v[44:47], v[248:251]
    ds_read_b64_tr_b16 a[204:205], v2 offset:37408
    v_perm_b32 v36, v25, v24, s100
    v_mfma_f32_16x16x32_bf16 v[252:255], a[248:251], v[40:43], v[252:255]
    v_exp_f32 v27, v27
    v_mfma_f32_16x16x32_bf16 v[252:255], a[252:255], v[44:47], v[252:255]
    ds_read_b64_tr_b16 a[206:207], v2 offset:37664
    v_smfmac_f32_16x16x64_bf16 a[12:15], a[16:19], v[40:47], v11
    ds_read_b64_tr_b16 a[208:209], v2 offset:36928
    v_mfma_f32_16x16x32_bf16 v[16:19], a[64:67], v[80:83], v[52:55]
    v_exp_f32 v28, v28
    v_mfma_f32_16x16x32_bf16 v[16:19], a[68:71], v[84:87], v[16:19]
    ds_read_b64_tr_b16 a[210:211], v2 offset:37184
    v_perm_b32 v37, v27, v26, s100
    v_mfma_f32_16x16x32_bf16 v[16:19], a[72:75], v[88:91], v[16:19]
    v_exp_f32 v29, v29
    v_mfma_f32_16x16x32_bf16 v[16:19], a[76:79], v[92:95], v[16:19]
    ds_read_b64_tr_b16 a[212:213], v2 offset:37440
    v_mfma_f32_16x16x32_bf16 v[20:23], a[80:83], v[80:83], v[52:55]
    v_exp_f32 v30, v30
    v_mfma_f32_16x16x32_bf16 v[20:23], a[84:87], v[84:87], v[20:23]
    ds_read_b64_tr_b16 a[214:215], v2 offset:37696
    v_perm_b32 v38, v29, v28, s100
    v_mfma_f32_16x16x32_bf16 v[20:23], a[88:91], v[88:91], v[20:23]
    v_exp_f32 v31, v31
    v_mfma_f32_16x16x32_bf16 v[20:23], a[92:95], v[92:95], v[20:23]
    ds_read_b64_tr_b16 a[216:217], v2 offset:36960
    v_mfma_f32_16x16x32_bf16 v[24:27], a[96:99], v[80:83], v[52:55]
    v_exp_f32 v16, v16
    v_mfma_f32_16x16x32_bf16 v[24:27], a[100:103], v[84:87], v[24:27]
    ds_read_b64_tr_b16 a[218:219], v2 offset:37216
    v_perm_b32 v39, v31, v30, s100
    v_mfma_f32_16x16x32_bf16 v[24:27], a[104:107], v[88:91], v[24:27]
    v_exp_f32 v17, v17
    v_mfma_f32_16x16x32_bf16 v[24:27], a[108:111], v[92:95], v[24:27]
    ds_read_b64_tr_b16 a[220:221], v2 offset:37472
    v_mfma_f32_16x16x32_bf16 v[28:31], a[112:115], v[80:83], v[52:55]
    v_exp_f32 v18, v18
    v_mfma_f32_16x16x32_bf16 v[28:31], a[116:119], v[84:87], v[28:31]
    ds_read_b64_tr_b16 a[222:223], v2 offset:37728
    v_perm_b32 v40, v17, v16, s100
    v_mfma_f32_16x16x32_bf16 v[28:31], a[120:123], v[88:91], v[28:31]
    v_exp_f32 v19, v19
    v_mfma_f32_16x16x32_bf16 v[28:31], a[124:127], v[92:95], v[28:31]
    ds_read_b64_tr_b16 a[224:225], v2 offset:36992
    v_mfma_f32_16x16x32_bf16 v[128:131], a[128:131], v[32:35], v[128:131]
    v_exp_f32 v20, v20
    v_mfma_f32_16x16x32_bf16 v[128:131], a[132:135], v[36:39], v[128:131]
    ds_read_b64_tr_b16 a[226:227], v2 offset:37248
    v_perm_b32 v41, v19, v18, s100
    v_mfma_f32_16x16x32_bf16 v[132:135], a[136:139], v[32:35], v[132:135]
    v_exp_f32 v21, v21
    v_mfma_f32_16x16x32_bf16 v[132:135], a[140:143], v[36:39], v[132:135]
    ds_read_b64_tr_b16 a[228:229], v2 offset:37504
    v_mfma_f32_16x16x32_bf16 v[136:139], a[144:147], v[32:35], v[136:139]
    v_exp_f32 v22, v22
    v_mfma_f32_16x16x32_bf16 v[136:139], a[148:151], v[36:39], v[136:139]
    ds_read_b64_tr_b16 a[230:231], v2 offset:37760
    v_perm_b32 v42, v21, v20, s100
    v_mfma_f32_16x16x32_bf16 v[140:143], a[152:155], v[32:35], v[140:143]
    v_exp_f32 v23, v23
    v_mfma_f32_16x16x32_bf16 v[140:143], a[156:159], v[36:39], v[140:143]
    ds_read_b64_tr_b16 a[232:233], v2 offset:37024
    v_mfma_f32_16x16x32_bf16 v[144:147], a[160:163], v[32:35], v[144:147]
    v_exp_f32 v24, v24
    v_mfma_f32_16x16x32_bf16 v[144:147], a[164:167], v[36:39], v[144:147]
    ds_read_b64_tr_b16 a[234:235], v2 offset:37280
    v_perm_b32 v43, v23, v22, s100
    v_mfma_f32_16x16x32_bf16 v[148:151], a[168:171], v[32:35], v[148:151]
    v_exp_f32 v25, v25
    v_mfma_f32_16x16x32_bf16 v[148:151], a[172:175], v[36:39], v[148:151]
    ds_read_b64_tr_b16 a[236:237], v2 offset:37536
    v_mfma_f32_16x16x32_bf16 v[152:155], a[176:179], v[32:35], v[152:155]
    v_exp_f32 v26, v26
    v_mfma_f32_16x16x32_bf16 v[152:155], a[180:183], v[36:39], v[152:155]
    ds_read_b64_tr_b16 a[238:239], v2 offset:37792
    v_perm_b32 v44, v25, v24, s100
    v_mfma_f32_16x16x32_bf16 v[156:159], a[184:187], v[32:35], v[156:159]
    v_exp_f32 v27, v27
    v_mfma_f32_16x16x32_bf16 v[156:159], a[188:191], v[36:39], v[156:159]
    ds_read_b64_tr_b16 a[240:241], v2 offset:37056
    v_smfmac_f32_16x16x64_bf16 a[0:3], a[16:19], v[32:39], v11
    ds_read_b64_tr_b16 a[242:243], v2 offset:37312
    v_mfma_f32_16x16x32_bf16 v[16:19], a[64:67], v[96:99], v[56:59]
    v_exp_f32 v28, v28
    v_mfma_f32_16x16x32_bf16 v[16:19], a[68:71], v[100:103], v[16:19]
    ds_read_b64_tr_b16 a[244:245], v2 offset:37568
    v_perm_b32 v45, v27, v26, s100
    v_mfma_f32_16x16x32_bf16 v[16:19], a[72:75], v[104:107], v[16:19]
    v_exp_f32 v29, v29
    v_mfma_f32_16x16x32_bf16 v[16:19], a[76:79], v[108:111], v[16:19]
    ds_read_b64_tr_b16 a[246:247], v2 offset:37824
    v_mfma_f32_16x16x32_bf16 v[20:23], a[80:83], v[96:99], v[56:59]
    v_exp_f32 v30, v30
    v_mfma_f32_16x16x32_bf16 v[20:23], a[84:87], v[100:103], v[20:23]
    ds_read_b64_tr_b16 a[248:249], v2 offset:37088
    v_perm_b32 v46, v29, v28, s100
    v_mfma_f32_16x16x32_bf16 v[20:23], a[88:91], v[104:107], v[20:23]
    v_exp_f32 v31, v31
    v_mfma_f32_16x16x32_bf16 v[20:23], a[92:95], v[108:111], v[20:23]
    ds_read_b64_tr_b16 a[250:251], v2 offset:37344
    v_mfma_f32_16x16x32_bf16 v[24:27], a[96:99], v[96:99], v[56:59]
    v_exp_f32 v16, v16
    v_mfma_f32_16x16x32_bf16 v[24:27], a[100:103], v[100:103], v[24:27]
    ds_read_b64_tr_b16 a[252:253], v2 offset:37600
    v_perm_b32 v47, v31, v30, s100
    v_mfma_f32_16x16x32_bf16 v[24:27], a[104:107], v[104:107], v[24:27]
    v_exp_f32 v17, v17
    v_mfma_f32_16x16x32_bf16 v[24:27], a[108:111], v[108:111], v[24:27]
    ds_read_b64_tr_b16 a[254:255], v2 offset:37856
    v_mfma_f32_16x16x32_bf16 v[28:31], a[112:115], v[96:99], v[56:59]
    v_exp_f32 v18, v18
    v_mfma_f32_16x16x32_bf16 v[28:31], a[116:119], v[100:103], v[28:31]
    v_perm_b32 v32, v17, v16, s100
    v_mfma_f32_16x16x32_bf16 v[28:31], a[120:123], v[104:107], v[28:31]
    v_exp_f32 v19, v19
    v_mfma_f32_16x16x32_bf16 v[28:31], a[124:127], v[108:111], v[28:31]
    v_mfma_f32_16x16x32_bf16 v[160:163], a[128:131], v[40:43], v[160:163]
    v_exp_f32 v20, v20
    v_mfma_f32_16x16x32_bf16 v[160:163], a[132:135], v[44:47], v[160:163]
    v_perm_b32 v33, v19, v18, s100
    v_mfma_f32_16x16x32_bf16 v[164:167], a[136:139], v[40:43], v[164:167]
    v_exp_f32 v21, v21
    v_mfma_f32_16x16x32_bf16 v[164:167], a[140:143], v[44:47], v[164:167]
    v_mfma_f32_16x16x32_bf16 v[168:171], a[144:147], v[40:43], v[168:171]
    v_exp_f32 v22, v22
    v_mfma_f32_16x16x32_bf16 v[168:171], a[148:151], v[44:47], v[168:171]
    v_perm_b32 v34, v21, v20, s100
    v_mfma_f32_16x16x32_bf16 v[172:175], a[152:155], v[40:43], v[172:175]
    v_exp_f32 v23, v23
    v_mfma_f32_16x16x32_bf16 v[172:175], a[156:159], v[44:47], v[172:175]
    v_mfma_f32_16x16x32_bf16 v[176:179], a[160:163], v[40:43], v[176:179]
    v_exp_f32 v24, v24
    v_mfma_f32_16x16x32_bf16 v[176:179], a[164:167], v[44:47], v[176:179]
    v_perm_b32 v35, v23, v22, s100
    v_mfma_f32_16x16x32_bf16 v[180:183], a[168:171], v[40:43], v[180:183]
    v_exp_f32 v25, v25
    v_mfma_f32_16x16x32_bf16 v[180:183], a[172:175], v[44:47], v[180:183]
    v_mfma_f32_16x16x32_bf16 v[184:187], a[176:179], v[40:43], v[184:187]
    v_exp_f32 v26, v26
    v_mfma_f32_16x16x32_bf16 v[184:187], a[180:183], v[44:47], v[184:187]
    v_perm_b32 v36, v25, v24, s100
    v_mfma_f32_16x16x32_bf16 v[188:191], a[184:187], v[40:43], v[188:191]
    v_exp_f32 v27, v27
    v_mfma_f32_16x16x32_bf16 v[188:191], a[188:191], v[44:47], v[188:191]
    v_smfmac_f32_16x16x64_bf16 a[4:7], a[16:19], v[40:47], v11
    v_mfma_f32_16x16x32_bf16 v[16:19], a[64:67], v[112:115], v[60:63]
    v_exp_f32 v28, v28
    v_mfma_f32_16x16x32_bf16 v[16:19], a[68:71], v[116:119], v[16:19]
    ds_read_b128 a[64:67], v1 offset:36864
    v_perm_b32 v37, v27, v26, s100
    v_mfma_f32_16x16x32_bf16 v[16:19], a[72:75], v[120:123], v[16:19]
    v_exp_f32 v29, v29
    v_mfma_f32_16x16x32_bf16 v[16:19], a[76:79], v[124:127], v[16:19]
    ds_read_b128 a[68:71], v1 offset:36928
    v_mfma_f32_16x16x32_bf16 v[20:23], a[80:83], v[112:115], v[60:63]
    v_exp_f32 v30, v30
    v_mfma_f32_16x16x32_bf16 v[20:23], a[84:87], v[116:119], v[20:23]
    ds_read_b128 a[72:75], v1 offset:36992
    v_perm_b32 v38, v29, v28, s100
    v_mfma_f32_16x16x32_bf16 v[20:23], a[88:91], v[120:123], v[20:23]
    v_exp_f32 v31, v31
    v_mfma_f32_16x16x32_bf16 v[20:23], a[92:95], v[124:127], v[20:23]
    ds_read_b128 a[76:79], v1 offset:37056
    v_mfma_f32_16x16x32_bf16 v[24:27], a[96:99], v[112:115], v[60:63]
    v_exp_f32 v16, v16
    v_mfma_f32_16x16x32_bf16 v[24:27], a[100:103], v[116:119], v[24:27]
    ds_read_b128 a[80:83], v1 offset:37120
    v_perm_b32 v39, v31, v30, s100
    v_mfma_f32_16x16x32_bf16 v[24:27], a[104:107], v[120:123], v[24:27]
    v_exp_f32 v17, v17
    v_mfma_f32_16x16x32_bf16 v[24:27], a[108:111], v[124:127], v[24:27]
    ds_read_b128 a[84:87], v1 offset:37184
    v_mfma_f32_16x16x32_bf16 v[28:31], a[112:115], v[112:115], v[60:63]
    v_exp_f32 v18, v18
    v_mfma_f32_16x16x32_bf16 v[28:31], a[116:119], v[116:119], v[28:31]
    ds_read_b128 a[88:91], v1 offset:37248
    v_perm_b32 v40, v17, v16, s100
    v_mfma_f32_16x16x32_bf16 v[28:31], a[120:123], v[120:123], v[28:31]
    v_exp_f32 v19, v19
    v_mfma_f32_16x16x32_bf16 v[28:31], a[124:127], v[124:127], v[28:31]
    ds_read_b128 a[92:95], v1 offset:37312
    v_mfma_f32_16x16x32_bf16 v[192:195], a[128:131], v[32:35], v[192:195]
    v_exp_f32 v20, v20
    v_mfma_f32_16x16x32_bf16 v[192:195], a[132:135], v[36:39], v[192:195]
    ds_read_b128 a[96:99], v1 offset:37376
    v_perm_b32 v41, v19, v18, s100
    v_mfma_f32_16x16x32_bf16 v[196:199], a[136:139], v[32:35], v[196:199]
    v_exp_f32 v21, v21
    v_mfma_f32_16x16x32_bf16 v[196:199], a[140:143], v[36:39], v[196:199]
    ds_read_b128 a[100:103], v1 offset:37440
    v_mfma_f32_16x16x32_bf16 v[200:203], a[144:147], v[32:35], v[200:203]
    v_exp_f32 v22, v22
    v_mfma_f32_16x16x32_bf16 v[200:203], a[148:151], v[36:39], v[200:203]
    ds_read_b128 a[104:107], v1 offset:37504
    v_perm_b32 v42, v21, v20, s100
    v_mfma_f32_16x16x32_bf16 v[204:207], a[152:155], v[32:35], v[204:207]
    v_exp_f32 v23, v23
    v_mfma_f32_16x16x32_bf16 v[204:207], a[156:159], v[36:39], v[204:207]
L2_pad6:
    s_cbranch_execz L2_pad10
    ds_read_b128 a[108:111], v1 offset:37568
    v_mfma_f32_16x16x32_bf16 v[208:211], a[160:163], v[32:35], v[208:211]
    v_exp_f32 v24, v24
    v_mfma_f32_16x16x32_bf16 v[208:211], a[164:167], v[36:39], v[208:211]
    ds_read_b128 a[112:115], v1 offset:37632
    v_perm_b32 v43, v23, v22, s100
    v_mfma_f32_16x16x32_bf16 v[212:215], a[168:171], v[32:35], v[212:215]
    v_exp_f32 v25, v25
    v_mfma_f32_16x16x32_bf16 v[212:215], a[172:175], v[36:39], v[212:215]
    ds_read_b128 a[116:119], v1 offset:37696
    v_mfma_f32_16x16x32_bf16 v[216:219], a[176:179], v[32:35], v[216:219]
    v_exp_f32 v26, v26
    v_mfma_f32_16x16x32_bf16 v[216:219], a[180:183], v[36:39], v[216:219]
    ds_read_b128 a[120:123], v1 offset:37760
    v_perm_b32 v44, v25, v24, s100
    v_mfma_f32_16x16x32_bf16 v[220:223], a[184:187], v[32:35], v[220:223]
    v_exp_f32 v27, v27
    v_mfma_f32_16x16x32_bf16 v[220:223], a[188:191], v[36:39], v[220:223]
    ds_read_b128 a[124:127], v1 offset:37824
    v_smfmac_f32_16x16x64_bf16 a[8:11], a[16:19], v[32:39], v11
    s_waitcnt lgkmcnt(12)
    v_mfma_f32_16x16x32_bf16 v[16:19], a[64:67], v[64:67], v[48:51]
    s_sub_u32 s47, s47, s48
    v_exp_f32 v28, v28
    v_mfma_f32_16x16x32_bf16 v[16:19], a[68:71], v[68:71], v[16:19]
    v_perm_b32 v45, v27, v26, s100
    v_add_u32 v1, s48, v1
    v_mfma_f32_16x16x32_bf16 v[16:19], a[72:75], v[72:75], v[16:19]
    v_exp_f32 v29, v29
    v_mfma_f32_16x16x32_bf16 v[16:19], a[76:79], v[76:79], v[16:19]
    s_waitcnt lgkmcnt(8)
    v_mfma_f32_16x16x32_bf16 v[20:23], a[80:83], v[64:67], v[48:51]
    v_exp_f32 v30, v30
    v_mfma_f32_16x16x32_bf16 v[20:23], a[84:87], v[68:71], v[20:23]
    v_perm_b32 v46, v29, v28, s100
    v_add_u32 v2, s48, v2
    v_mfma_f32_16x16x32_bf16 v[20:23], a[88:91], v[72:75], v[20:23]
    v_exp_f32 v31, v31
    v_mfma_f32_16x16x32_bf16 v[20:23], a[92:95], v[76:79], v[20:23]
    s_waitcnt lgkmcnt(4)
    v_mfma_f32_16x16x32_bf16 v[24:27], a[96:99], v[64:67], v[48:51]
    s_sub_u32 s48, 0, s48
    v_exp_f32 v16, v16
    v_mfma_f32_16x16x32_bf16 v[24:27], a[100:103], v[68:71], v[24:27]
    v_perm_b32 v47, v31, v30, s100
    v_mfma_f32_16x16x32_bf16 v[24:27], a[104:107], v[72:75], v[24:27]
    v_exp_f32 v17, v17
    v_mfma_f32_16x16x32_bf16 v[24:27], a[108:111], v[76:79], v[24:27]
    s_waitcnt lgkmcnt(0)
    v_mfma_f32_16x16x32_bf16 v[28:31], a[112:115], v[64:67], v[48:51]
    v_exp_f32 v18, v18
    v_mfma_f32_16x16x32_bf16 v[28:31], a[116:119], v[68:71], v[28:31]
    v_perm_b32 v32, v17, v16, s100
    v_mfma_f32_16x16x32_bf16 v[28:31], a[120:123], v[72:75], v[28:31]
    v_exp_f32 v19, v19
    v_mfma_f32_16x16x32_bf16 v[28:31], a[124:127], v[76:79], v[28:31]
    s_waitcnt vmcnt(2)
    s_barrier
    v_mfma_f32_16x16x32_bf16 v[224:227], a[128:131], v[40:43], v[224:227]
    v_exp_f32 v20, v20
    v_mfma_f32_16x16x32_bf16 v[224:227], a[132:135], v[44:47], v[224:227]
    ds_read_b64_tr_b16 a[128:129], v2 offset:0
    v_perm_b32 v33, v19, v18, s100
    v_mfma_f32_16x16x32_bf16 v[228:231], a[136:139], v[40:43], v[228:231]
    s_add_u32 m0, s47, 0
    v_exp_f32 v21, v21
    v_mfma_f32_16x16x32_bf16 v[228:231], a[140:143], v[44:47], v[228:231]
    s_add_u32 s46, s46, 16384
    buffer_load_dwordx4 v5, s[16:19], s46 offen offset:0 lds
    v_mfma_f32_16x16x32_bf16 v[232:235], a[144:147], v[40:43], v[232:235]
    v_exp_f32 v22, v22
    v_mfma_f32_16x16x32_bf16 v[232:235], a[148:151], v[44:47], v[232:235]
    ds_read_b64_tr_b16 a[130:131], v2 offset:256
    v_perm_b32 v34, v21, v20, s100
    v_mfma_f32_16x16x32_bf16 v[236:239], a[152:155], v[40:43], v[236:239]
    s_add_u32 m0, s47, 32
    v_exp_f32 v23, v23
    v_mfma_f32_16x16x32_bf16 v[236:239], a[156:159], v[44:47], v[236:239]
    buffer_load_dwordx4 v5, s[16:19], s46 offen offset:1024 lds
    v_mfma_f32_16x16x32_bf16 v[240:243], a[160:163], v[40:43], v[240:243]
    v_exp_f32 v24, v24
    v_mfma_f32_16x16x32_bf16 v[240:243], a[164:167], v[44:47], v[240:243]
    ds_read_b64_tr_b16 a[132:133], v2 offset:512
    v_perm_b32 v35, v23, v22, s100
    v_mfma_f32_16x16x32_bf16 v[244:247], a[168:171], v[40:43], v[244:247]
    s_add_u32 m0, s47, 64
    v_exp_f32 v25, v25
    v_mfma_f32_16x16x32_bf16 v[244:247], a[172:175], v[44:47], v[244:247]
    buffer_load_dwordx4 v5, s[16:19], s46 offen offset:2048 lds
    v_mfma_f32_16x16x32_bf16 v[248:251], a[176:179], v[40:43], v[248:251]
    v_exp_f32 v26, v26
    v_mfma_f32_16x16x32_bf16 v[248:251], a[180:183], v[44:47], v[248:251]
    ds_read_b64_tr_b16 a[134:135], v2 offset:768
    v_perm_b32 v36, v25, v24, s100
    v_mfma_f32_16x16x32_bf16 v[252:255], a[184:187], v[40:43], v[252:255]
    s_add_u32 m0, s47, 96
    v_exp_f32 v27, v27
    v_mfma_f32_16x16x32_bf16 v[252:255], a[188:191], v[44:47], v[252:255]
    buffer_load_dwordx4 v5, s[16:19], s46 offen offset:3072 lds
    v_smfmac_f32_16x16x64_bf16 a[12:15], a[16:19], v[40:47], v11
    ds_read_b64_tr_b16 a[136:137], v2 offset:32
    v_mfma_f32_16x16x32_bf16 v[16:19], a[64:67], v[80:83], v[52:55]
    v_exp_f32 v28, v28
    v_mfma_f32_16x16x32_bf16 v[16:19], a[68:71], v[84:87], v[16:19]
    ds_read_b64_tr_b16 a[138:139], v2 offset:288
    v_perm_b32 v37, v27, v26, s100
    v_mfma_f32_16x16x32_bf16 v[16:19], a[72:75], v[88:91], v[16:19]
    s_add_u32 m0, s47, 16896
    v_exp_f32 v29, v29
    v_mfma_f32_16x16x32_bf16 v[16:19], a[76:79], v[92:95], v[16:19]
    buffer_load_dwordx4 v5, s[20:23], s46 offen offset:0 lds
    v_mfma_f32_16x16x32_bf16 v[20:23], a[80:83], v[80:83], v[52:55]
    v_exp_f32 v30, v30
    v_mfma_f32_16x16x32_bf16 v[20:23], a[84:87], v[84:87], v[20:23]
    ds_read_b64_tr_b16 a[140:141], v2 offset:544
    v_perm_b32 v38, v29, v28, s100
    v_mfma_f32_16x16x32_bf16 v[20:23], a[88:91], v[88:91], v[20:23]
    s_add_u32 m0, s47, 16928
    v_exp_f32 v31, v31
    v_mfma_f32_16x16x32_bf16 v[20:23], a[92:95], v[92:95], v[20:23]
    buffer_load_dwordx4 v5, s[20:23], s46 offen offset:1024 lds
    v_mfma_f32_16x16x32_bf16 v[24:27], a[96:99], v[80:83], v[52:55]
    v_exp_f32 v16, v16
    v_mfma_f32_16x16x32_bf16 v[24:27], a[100:103], v[84:87], v[24:27]
    ds_read_b64_tr_b16 a[142:143], v2 offset:800
    v_perm_b32 v39, v31, v30, s100
    v_mfma_f32_16x16x32_bf16 v[24:27], a[104:107], v[88:91], v[24:27]
    s_add_u32 m0, s47, 16960
    v_exp_f32 v17, v17
    v_mfma_f32_16x16x32_bf16 v[24:27], a[108:111], v[92:95], v[24:27]
    buffer_load_dwordx4 v5, s[20:23], s46 offen offset:2048 lds
    v_mfma_f32_16x16x32_bf16 v[28:31], a[112:115], v[80:83], v[52:55]
    v_exp_f32 v18, v18
    v_mfma_f32_16x16x32_bf16 v[28:31], a[116:119], v[84:87], v[28:31]
    ds_read_b64_tr_b16 a[144:145], v2 offset:64
    v_perm_b32 v40, v17, v16, s100
    v_mfma_f32_16x16x32_bf16 v[28:31], a[120:123], v[88:91], v[28:31]
    s_add_u32 m0, s47, 16992
    v_exp_f32 v19, v19
    v_mfma_f32_16x16x32_bf16 v[28:31], a[124:127], v[92:95], v[28:31]
    buffer_load_dwordx4 v5, s[20:23], s46 offen offset:3072 lds
    v_mfma_f32_16x16x32_bf16 v[128:131], a[192:195], v[32:35], v[128:131]
    v_exp_f32 v20, v20
    v_mfma_f32_16x16x32_bf16 v[128:131], a[196:199], v[36:39], v[128:131]
    ds_read_b64_tr_b16 a[146:147], v2 offset:320
    v_perm_b32 v41, v19, v18, s100
    v_mfma_f32_16x16x32_bf16 v[132:135], a[200:203], v[32:35], v[132:135]
    v_exp_f32 v21, v21
    v_mfma_f32_16x16x32_bf16 v[132:135], a[204:207], v[36:39], v[132:135]
    ds_read_b64_tr_b16 a[148:149], v2 offset:576
    v_mfma_f32_16x16x32_bf16 v[136:139], a[208:211], v[32:35], v[136:139]
    v_exp_f32 v22, v22
    v_mfma_f32_16x16x32_bf16 v[136:139], a[212:215], v[36:39], v[136:139]
    ds_read_b64_tr_b16 a[150:151], v2 offset:832
    v_perm_b32 v42, v21, v20, s100
    v_mfma_f32_16x16x32_bf16 v[140:143], a[216:219], v[32:35], v[140:143]
    v_exp_f32 v23, v23
    v_mfma_f32_16x16x32_bf16 v[140:143], a[220:223], v[36:39], v[140:143]
    ds_read_b64_tr_b16 a[152:153], v2 offset:96
    ds_read_b64_tr_b16 a[154:155], v2 offset:352
    v_mfma_f32_16x16x32_bf16 v[144:147], a[224:227], v[32:35], v[144:147]
    v_exp_f32 v24, v24
    v_mfma_f32_16x16x32_bf16 v[144:147], a[228:231], v[36:39], v[144:147]
    ds_read_b64_tr_b16 a[156:157], v2 offset:608
    v_perm_b32 v43, v23, v22, s100
    v_mfma_f32_16x16x32_bf16 v[148:151], a[232:235], v[32:35], v[148:151]
    v_exp_f32 v25, v25
    v_mfma_f32_16x16x32_bf16 v[148:151], a[236:239], v[36:39], v[148:151]
    ds_read_b64_tr_b16 a[158:159], v2 offset:864
    ds_read_b64_tr_b16 a[160:161], v2 offset:128
    v_mfma_f32_16x16x32_bf16 v[152:155], a[240:243], v[32:35], v[152:155]
    v_exp_f32 v26, v26
    v_mfma_f32_16x16x32_bf16 v[152:155], a[244:247], v[36:39], v[152:155]
    ds_read_b64_tr_b16 a[162:163], v2 offset:384
    v_perm_b32 v44, v25, v24, s100
    v_mfma_f32_16x16x32_bf16 v[156:159], a[248:251], v[32:35], v[156:159]
    v_exp_f32 v27, v27
    v_mfma_f32_16x16x32_bf16 v[156:159], a[252:255], v[36:39], v[156:159]
    ds_read_b64_tr_b16 a[164:165], v2 offset:640
    ds_read_b64_tr_b16 a[166:167], v2 offset:896
    v_smfmac_f32_16x16x64_bf16 a[0:3], a[16:19], v[32:39], v11
    ds_read_b64_tr_b16 a[168:169], v2 offset:160
    ds_read_b64_tr_b16 a[170:171], v2 offset:416
    v_mfma_f32_16x16x32_bf16 v[16:19], a[64:67], v[96:99], v[56:59]
    v_exp_f32 v28, v28
    v_mfma_f32_16x16x32_bf16 v[16:19], a[68:71], v[100:103], v[16:19]
    ds_read_b64_tr_b16 a[172:173], v2 offset:672
    v_perm_b32 v45, v27, v26, s100
    v_mfma_f32_16x16x32_bf16 v[16:19], a[72:75], v[104:107], v[16:19]
    s_add_u32 m0, s47, 36864
    v_exp_f32 v29, v29
    v_mfma_f32_16x16x32_bf16 v[16:19], a[76:79], v[108:111], v[16:19]
    s_add_u32 s46, s46, 16384
    buffer_load_dwordx4 v5, s[16:19], s46 offen offset:0 lds
    v_mfma_f32_16x16x32_bf16 v[20:23], a[80:83], v[96:99], v[56:59]
    v_exp_f32 v30, v30
    v_mfma_f32_16x16x32_bf16 v[20:23], a[84:87], v[100:103], v[20:23]
    ds_read_b64_tr_b16 a[174:175], v2 offset:928
    v_perm_b32 v46, v29, v28, s100
    v_mfma_f32_16x16x32_bf16 v[20:23], a[88:91], v[104:107], v[20:23]
    s_add_u32 m0, s47, 36896
    v_exp_f32 v31, v31
    v_mfma_f32_16x16x32_bf16 v[20:23], a[92:95], v[108:111], v[20:23]
    buffer_load_dwordx4 v5, s[16:19], s46 offen offset:1024 lds
    v_mfma_f32_16x16x32_bf16 v[24:27], a[96:99], v[96:99], v[56:59]
    v_exp_f32 v16, v16
    v_mfma_f32_16x16x32_bf16 v[24:27], a[100:103], v[100:103], v[24:27]
    ds_read_b64_tr_b16 a[176:177], v2 offset:192
    v_perm_b32 v47, v31, v30, s100
    v_mfma_f32_16x16x32_bf16 v[24:27], a[104:107], v[104:107], v[24:27]
    s_add_u32 m0, s47, 36928
    v_exp_f32 v17, v17
    v_mfma_f32_16x16x32_bf16 v[24:27], a[108:111], v[108:111], v[24:27]
    buffer_load_dwordx4 v5, s[16:19], s46 offen offset:2048 lds
    v_mfma_f32_16x16x32_bf16 v[28:31], a[112:115], v[96:99], v[56:59]
    v_exp_f32 v18, v18
    v_mfma_f32_16x16x32_bf16 v[28:31], a[116:119], v[100:103], v[28:31]
    ds_read_b64_tr_b16 a[178:179], v2 offset:448
    v_perm_b32 v32, v17, v16, s100
    v_mfma_f32_16x16x32_bf16 v[28:31], a[120:123], v[104:107], v[28:31]
    s_add_u32 m0, s47, 36960
    v_exp_f32 v19, v19
    v_mfma_f32_16x16x32_bf16 v[28:31], a[124:127], v[108:111], v[28:31]
    buffer_load_dwordx4 v5, s[16:19], s46 offen offset:3072 lds
    v_mfma_f32_16x16x32_bf16 v[160:163], a[192:195], v[40:43], v[160:163]
    v_exp_f32 v20, v20
    v_mfma_f32_16x16x32_bf16 v[160:163], a[196:199], v[44:47], v[160:163]
    ds_read_b64_tr_b16 a[180:181], v2 offset:704
    v_perm_b32 v33, v19, v18, s100
    v_mfma_f32_16x16x32_bf16 v[164:167], a[200:203], v[40:43], v[164:167]
    s_add_u32 m0, s47, 53760
    v_exp_f32 v21, v21
    v_mfma_f32_16x16x32_bf16 v[164:167], a[204:207], v[44:47], v[164:167]
    buffer_load_dwordx4 v5, s[20:23], s46 offen offset:0 lds
    v_mfma_f32_16x16x32_bf16 v[168:171], a[208:211], v[40:43], v[168:171]
    v_exp_f32 v22, v22
    v_mfma_f32_16x16x32_bf16 v[168:171], a[212:215], v[44:47], v[168:171]
    ds_read_b64_tr_b16 a[182:183], v2 offset:960
    v_perm_b32 v34, v21, v20, s100
    v_mfma_f32_16x16x32_bf16 v[172:175], a[216:219], v[40:43], v[172:175]
    s_add_u32 m0, s47, 53792
    v_exp_f32 v23, v23
    v_mfma_f32_16x16x32_bf16 v[172:175], a[220:223], v[44:47], v[172:175]
    buffer_load_dwordx4 v5, s[20:23], s46 offen offset:1024 lds
    v_mfma_f32_16x16x32_bf16 v[176:179], a[224:227], v[40:43], v[176:179]
    v_exp_f32 v24, v24
    v_mfma_f32_16x16x32_bf16 v[176:179], a[228:231], v[44:47], v[176:179]
    ds_read_b64_tr_b16 a[184:185], v2 offset:224
    v_perm_b32 v35, v23, v22, s100
    v_mfma_f32_16x16x32_bf16 v[180:183], a[232:235], v[40:43], v[180:183]
    s_add_u32 m0, s47, 53824
    v_exp_f32 v25, v25
    v_mfma_f32_16x16x32_bf16 v[180:183], a[236:239], v[44:47], v[180:183]
    buffer_load_dwordx4 v5, s[20:23], s46 offen offset:2048 lds
    v_mfma_f32_16x16x32_bf16 v[184:187], a[240:243], v[40:43], v[184:187]
    v_exp_f32 v26, v26
    v_mfma_f32_16x16x32_bf16 v[184:187], a[244:247], v[44:47], v[184:187]
    ds_read_b64_tr_b16 a[186:187], v2 offset:480
    v_perm_b32 v36, v25, v24, s100
    v_mfma_f32_16x16x32_bf16 v[188:191], a[248:251], v[40:43], v[188:191]
    s_add_u32 m0, s47, 53856
    v_exp_f32 v27, v27
    v_mfma_f32_16x16x32_bf16 v[188:191], a[252:255], v[44:47], v[188:191]
    buffer_load_dwordx4 v5, s[20:23], s46 offen offset:3072 lds
    v_smfmac_f32_16x16x64_bf16 a[4:7], a[16:19], v[40:47], v11
    ds_read_b64_tr_b16 a[188:189], v2 offset:736
    ds_read_b64_tr_b16 a[190:191], v2 offset:992
    v_mfma_f32_16x16x32_bf16 v[16:19], a[64:67], v[112:115], v[60:63]
    v_exp_f32 v28, v28
    v_mfma_f32_16x16x32_bf16 v[16:19], a[68:71], v[116:119], v[16:19]
    ds_read_b128 a[64:67], v1 offset:0
    v_perm_b32 v37, v27, v26, s100
    v_mfma_f32_16x16x32_bf16 v[16:19], a[72:75], v[120:123], v[16:19]
    v_exp_f32 v29, v29
    v_mfma_f32_16x16x32_bf16 v[16:19], a[76:79], v[124:127], v[16:19]
    ds_read_b128 a[68:71], v1 offset:64
    v_mfma_f32_16x16x32_bf16 v[20:23], a[80:83], v[112:115], v[60:63]
    v_exp_f32 v30, v30
    v_mfma_f32_16x16x32_bf16 v[20:23], a[84:87], v[116:119], v[20:23]
    ds_read_b128 a[72:75], v1 offset:128
    v_perm_b32 v38, v29, v28, s100
    v_mfma_f32_16x16x32_bf16 v[20:23], a[88:91], v[120:123], v[20:23]
    v_exp_f32 v31, v31
    v_mfma_f32_16x16x32_bf16 v[20:23], a[92:95], v[124:127], v[20:23]
    ds_read_b128 a[76:79], v1 offset:192
    v_mfma_f32_16x16x32_bf16 v[24:27], a[96:99], v[112:115], v[60:63]
    v_exp_f32 v16, v16
    v_mfma_f32_16x16x32_bf16 v[24:27], a[100:103], v[116:119], v[24:27]
    ds_read_b128 a[80:83], v1 offset:256
    v_perm_b32 v39, v31, v30, s100
    v_mfma_f32_16x16x32_bf16 v[24:27], a[104:107], v[120:123], v[24:27]
    v_exp_f32 v17, v17
    v_mfma_f32_16x16x32_bf16 v[24:27], a[108:111], v[124:127], v[24:27]
    ds_read_b128 a[84:87], v1 offset:320
    v_mfma_f32_16x16x32_bf16 v[28:31], a[112:115], v[112:115], v[60:63]
    v_exp_f32 v18, v18
    v_mfma_f32_16x16x32_bf16 v[28:31], a[116:119], v[116:119], v[28:31]
    ds_read_b128 a[88:91], v1 offset:384
    v_perm_b32 v40, v17, v16, s100
    v_mfma_f32_16x16x32_bf16 v[28:31], a[120:123], v[120:123], v[28:31]
    v_exp_f32 v19, v19
    v_mfma_f32_16x16x32_bf16 v[28:31], a[124:127], v[124:127], v[28:31]
    ds_read_b128 a[92:95], v1 offset:448
    v_mfma_f32_16x16x32_bf16 v[192:195], a[192:195], v[32:35], v[192:195]
    v_exp_f32 v20, v20
    v_mfma_f32_16x16x32_bf16 v[192:195], a[196:199], v[36:39], v[192:195]
    ds_read_b128 a[96:99], v1 offset:512
    v_perm_b32 v41, v19, v18, s100
    v_mfma_f32_16x16x32_bf16 v[196:199], a[200:203], v[32:35], v[196:199]
    v_exp_f32 v21, v21
    v_mfma_f32_16x16x32_bf16 v[196:199], a[204:207], v[36:39], v[196:199]
    ds_read_b128 a[100:103], v1 offset:576
    v_mfma_f32_16x16x32_bf16 v[200:203], a[208:211], v[32:35], v[200:203]
    v_exp_f32 v22, v22
    v_mfma_f32_16x16x32_bf16 v[200:203], a[212:215], v[36:39], v[200:203]
    ds_read_b128 a[104:107], v1 offset:640
    v_perm_b32 v42, v21, v20, s100
    v_mfma_f32_16x16x32_bf16 v[204:207], a[216:219], v[32:35], v[204:207]
    v_exp_f32 v23, v23
    v_mfma_f32_16x16x32_bf16 v[204:207], a[220:223], v[36:39], v[204:207]
    ds_read_b128 a[108:111], v1 offset:704
    v_mfma_f32_16x16x32_bf16 v[208:211], a[224:227], v[32:35], v[208:211]
    v_exp_f32 v24, v24
    v_mfma_f32_16x16x32_bf16 v[208:211], a[228:231], v[36:39], v[208:211]
    ds_read_b128 a[112:115], v1 offset:768
    v_perm_b32 v43, v23, v22, s100
    v_mfma_f32_16x16x32_bf16 v[212:215], a[232:235], v[32:35], v[212:215]
    v_exp_f32 v25, v25
    v_mfma_f32_16x16x32_bf16 v[212:215], a[236:239], v[36:39], v[212:215]
    ds_read_b128 a[116:119], v1 offset:832
    v_mfma_f32_16x16x32_bf16 v[216:219], a[240:243], v[32:35], v[216:219]
    v_exp_f32 v26, v26
    v_mfma_f32_16x16x32_bf16 v[216:219], a[244:247], v[36:39], v[216:219]
    ds_read_b128 a[120:123], v1 offset:896
    v_perm_b32 v44, v25, v24, s100
    v_mfma_f32_16x16x32_bf16 v[220:223], a[248:251], v[32:35], v[220:223]
    v_exp_f32 v27, v27
    v_mfma_f32_16x16x32_bf16 v[220:223], a[252:255], v[36:39], v[220:223]
    ds_read_b128 a[124:127], v1 offset:960
    v_smfmac_f32_16x16x64_bf16 a[8:11], a[16:19], v[32:39], v11
    s_waitcnt lgkmcnt(12)
    v_mfma_f32_16x16x32_bf16 v[16:19], a[64:67], v[64:67], v[48:51]
    v_exp_f32 v28, v28
    v_mfma_f32_16x16x32_bf16 v[16:19], a[68:71], v[68:71], v[16:19]
    v_perm_b32 v45, v27, v26, s100
    v_mfma_f32_16x16x32_bf16 v[16:19], a[72:75], v[72:75], v[16:19]
    v_exp_f32 v29, v29
    v_mfma_f32_16x16x32_bf16 v[16:19], a[76:79], v[76:79], v[16:19]
    s_waitcnt lgkmcnt(8)
    global_load_dword a63, v15, s[10:11]
    v_mfma_f32_16x16x32_bf16 v[20:23], a[80:83], v[64:67], v[48:51]
    v_exp_f32 v30, v30
    v_mfma_f32_16x16x32_bf16 v[20:23], a[84:87], v[68:71], v[20:23]
    v_perm_b32 v46, v29, v28, s100
    v_mfma_f32_16x16x32_bf16 v[20:23], a[88:91], v[72:75], v[20:23]
    v_exp_f32 v31, v31
    v_mfma_f32_16x16x32_bf16 v[20:23], a[92:95], v[76:79], v[20:23]
    s_waitcnt lgkmcnt(4)
    v_mfma_f32_16x16x32_bf16 v[24:27], a[96:99], v[64:67], v[48:51]
    v_exp_f32 v16, v16
    v_mfma_f32_16x16x32_bf16 v[24:27], a[100:103], v[68:71], v[24:27]
    v_perm_b32 v47, v31, v30, s100
    v_mfma_f32_16x16x32_bf16 v[24:27], a[104:107], v[72:75], v[24:27]
    v_exp_f32 v17, v17
    v_mfma_f32_16x16x32_bf16 v[24:27], a[108:111], v[76:79], v[24:27]
    s_waitcnt lgkmcnt(0)
    global_load_dword a63, v12, s[6:7]
    v_mfma_f32_16x16x32_bf16 v[28:31], a[112:115], v[64:67], v[48:51]
    v_exp_f32 v18, v18
    v_mfma_f32_16x16x32_bf16 v[28:31], a[116:119], v[68:71], v[28:31]
    v_perm_b32 v32, v17, v16, s100
    v_mfma_f32_16x16x32_bf16 v[28:31], a[120:123], v[72:75], v[28:31]
    v_exp_f32 v19, v19
    v_mfma_f32_16x16x32_bf16 v[28:31], a[124:127], v[76:79], v[28:31]
    v_mfma_f32_16x16x32_bf16 v[224:227], a[192:195], v[40:43], v[224:227]
    v_exp_f32 v20, v20
    v_mfma_f32_16x16x32_bf16 v[224:227], a[196:199], v[44:47], v[224:227]
    ds_read_b64_tr_b16 a[192:193], v2 offset:36864
    v_perm_b32 v33, v19, v18, s100
    v_mfma_f32_16x16x32_bf16 v[228:231], a[200:203], v[40:43], v[228:231]
    v_exp_f32 v21, v21
    v_mfma_f32_16x16x32_bf16 v[228:231], a[204:207], v[44:47], v[228:231]
    ds_read_b64_tr_b16 a[194:195], v2 offset:37120
    v_mfma_f32_16x16x32_bf16 v[232:235], a[208:211], v[40:43], v[232:235]
    v_exp_f32 v22, v22
    v_mfma_f32_16x16x32_bf16 v[232:235], a[212:215], v[44:47], v[232:235]
    ds_read_b64_tr_b16 a[196:197], v2 offset:37376
    v_perm_b32 v34, v21, v20, s100
    v_mfma_f32_16x16x32_bf16 v[236:239], a[216:219], v[40:43], v[236:239]
    v_exp_f32 v23, v23
    v_mfma_f32_16x16x32_bf16 v[236:239], a[220:223], v[44:47], v[236:239]
    ds_read_b64_tr_b16 a[198:199], v2 offset:37632
    v_mfma_f32_16x16x32_bf16 v[240:243], a[224:227], v[40:43], v[240:243]
    v_exp_f32 v24, v24
    v_mfma_f32_16x16x32_bf16 v[240:243], a[228:231], v[44:47], v[240:243]
    ds_read_b64_tr_b16 a[200:201], v2 offset:36896
    v_perm_b32 v35, v23, v22, s100
    v_mfma_f32_16x16x32_bf16 v[244:247], a[232:235], v[40:43], v[244:247]
    v_exp_f32 v25, v25
    v_mfma_f32_16x16x32_bf16 v[244:247], a[236:239], v[44:47], v[244:247]
    ds_read_b64_tr_b16 a[202:203], v2 offset:37152
    v_mfma_f32_16x16x32_bf16 v[248:251], a[240:243], v[40:43], v[248:251]
    v_exp_f32 v26, v26
    v_mfma_f32_16x16x32_bf16 v[248:251], a[244:247], v[44:47], v[248:251]
    ds_read_b64_tr_b16 a[204:205], v2 offset:37408
    v_perm_b32 v36, v25, v24, s100
    v_mfma_f32_16x16x32_bf16 v[252:255], a[248:251], v[40:43], v[252:255]
    v_exp_f32 v27, v27
    v_mfma_f32_16x16x32_bf16 v[252:255], a[252:255], v[44:47], v[252:255]
    ds_read_b64_tr_b16 a[206:207], v2 offset:37664
    v_smfmac_f32_16x16x64_bf16 a[12:15], a[16:19], v[40:47], v11
    ds_read_b64_tr_b16 a[208:209], v2 offset:36928
    v_mfma_f32_16x16x32_bf16 v[16:19], a[64:67], v[80:83], v[52:55]
    v_exp_f32 v28, v28
    v_mfma_f32_16x16x32_bf16 v[16:19], a[68:71], v[84:87], v[16:19]
    ds_read_b64_tr_b16 a[210:211], v2 offset:37184
    v_perm_b32 v37, v27, v26, s100
    v_mfma_f32_16x16x32_bf16 v[16:19], a[72:75], v[88:91], v[16:19]
    v_exp_f32 v29, v29
    v_mfma_f32_16x16x32_bf16 v[16:19], a[76:79], v[92:95], v[16:19]
    ds_read_b64_tr_b16 a[212:213], v2 offset:37440
    v_mfma_f32_16x16x32_bf16 v[20:23], a[80:83], v[80:83], v[52:55]
    v_exp_f32 v30, v30
    v_mfma_f32_16x16x32_bf16 v[20:23], a[84:87], v[84:87], v[20:23]
    ds_read_b64_tr_b16 a[214:215], v2 offset:37696
    v_perm_b32 v38, v29, v28, s100
    v_mfma_f32_16x16x32_bf16 v[20:23], a[88:91], v[88:91], v[20:23]
    v_exp_f32 v31, v31
    v_mfma_f32_16x16x32_bf16 v[20:23], a[92:95], v[92:95], v[20:23]
    ds_read_b64_tr_b16 a[216:217], v2 offset:36960
    v_mfma_f32_16x16x32_bf16 v[24:27], a[96:99], v[80:83], v[52:55]
    v_exp_f32 v16, v16
    v_mfma_f32_16x16x32_bf16 v[24:27], a[100:103], v[84:87], v[24:27]
    ds_read_b64_tr_b16 a[218:219], v2 offset:37216
    v_perm_b32 v39, v31, v30, s100
    v_mfma_f32_16x16x32_bf16 v[24:27], a[104:107], v[88:91], v[24:27]
    v_exp_f32 v17, v17
    v_mfma_f32_16x16x32_bf16 v[24:27], a[108:111], v[92:95], v[24:27]
    ds_read_b64_tr_b16 a[220:221], v2 offset:37472
    v_mfma_f32_16x16x32_bf16 v[28:31], a[112:115], v[80:83], v[52:55]
    v_exp_f32 v18, v18
    v_mfma_f32_16x16x32_bf16 v[28:31], a[116:119], v[84:87], v[28:31]
    ds_read_b64_tr_b16 a[222:223], v2 offset:37728
    v_perm_b32 v40, v17, v16, s100
    v_mfma_f32_16x16x32_bf16 v[28:31], a[120:123], v[88:91], v[28:31]
    v_exp_f32 v19, v19
    v_mfma_f32_16x16x32_bf16 v[28:31], a[124:127], v[92:95], v[28:31]
    ds_read_b64_tr_b16 a[224:225], v2 offset:36992
    v_mfma_f32_16x16x32_bf16 v[128:131], a[128:131], v[32:35], v[128:131]
    v_exp_f32 v20, v20
    v_mfma_f32_16x16x32_bf16 v[128:131], a[132:135], v[36:39], v[128:131]
    ds_read_b64_tr_b16 a[226:227], v2 offset:37248
    v_perm_b32 v41, v19, v18, s100
    v_mfma_f32_16x16x32_bf16 v[132:135], a[136:139], v[32:35], v[132:135]
    v_exp_f32 v21, v21
    v_mfma_f32_16x16x32_bf16 v[132:135], a[140:143], v[36:39], v[132:135]
    ds_read_b64_tr_b16 a[228:229], v2 offset:37504
    v_mfma_f32_16x16x32_bf16 v[136:139], a[144:147], v[32:35], v[136:139]
    v_exp_f32 v22, v22
    v_mfma_f32_16x16x32_bf16 v[136:139], a[148:151], v[36:39], v[136:139]
    ds_read_b64_tr_b16 a[230:231], v2 offset:37760
    v_perm_b32 v42, v21, v20, s100
    v_mfma_f32_16x16x32_bf16 v[140:143], a[152:155], v[32:35], v[140:143]
    v_exp_f32 v23, v23
    v_mfma_f32_16x16x32_bf16 v[140:143], a[156:159], v[36:39], v[140:143]
    ds_read_b64_tr_b16 a[232:233], v2 offset:37024
    v_mfma_f32_16x16x32_bf16 v[144:147], a[160:163], v[32:35], v[144:147]
    v_exp_f32 v24, v24
    v_mfma_f32_16x16x32_bf16 v[144:147], a[164:167], v[36:39], v[144:147]
    ds_read_b64_tr_b16 a[234:235], v2 offset:37280
    v_perm_b32 v43, v23, v22, s100
    v_mfma_f32_16x16x32_bf16 v[148:151], a[168:171], v[32:35], v[148:151]
    v_exp_f32 v25, v25
    v_mfma_f32_16x16x32_bf16 v[148:151], a[172:175], v[36:39], v[148:151]
    ds_read_b64_tr_b16 a[236:237], v2 offset:37536
    v_mfma_f32_16x16x32_bf16 v[152:155], a[176:179], v[32:35], v[152:155]
    v_exp_f32 v26, v26
    v_mfma_f32_16x16x32_bf16 v[152:155], a[180:183], v[36:39], v[152:155]
    ds_read_b64_tr_b16 a[238:239], v2 offset:37792
    v_perm_b32 v44, v25, v24, s100
    v_mfma_f32_16x16x32_bf16 v[156:159], a[184:187], v[32:35], v[156:159]
    v_exp_f32 v27, v27
    v_mfma_f32_16x16x32_bf16 v[156:159], a[188:191], v[36:39], v[156:159]
    ds_read_b64_tr_b16 a[240:241], v2 offset:37056
    v_smfmac_f32_16x16x64_bf16 a[0:3], a[16:19], v[32:39], v11
    ds_read_b64_tr_b16 a[242:243], v2 offset:37312
    v_mfma_f32_16x16x32_bf16 v[16:19], a[64:67], v[96:99], v[56:59]
    v_exp_f32 v28, v28
    v_mfma_f32_16x16x32_bf16 v[16:19], a[68:71], v[100:103], v[16:19]
    ds_read_b64_tr_b16 a[244:245], v2 offset:37568
    v_perm_b32 v45, v27, v26, s100
    v_mfma_f32_16x16x32_bf16 v[16:19], a[72:75], v[104:107], v[16:19]
    v_exp_f32 v29, v29
    v_mfma_f32_16x16x32_bf16 v[16:19], a[76:79], v[108:111], v[16:19]
    ds_read_b64_tr_b16 a[246:247], v2 offset:37824
    v_mfma_f32_16x16x32_bf16 v[20:23], a[80:83], v[96:99], v[56:59]
    v_exp_f32 v30, v30
    v_mfma_f32_16x16x32_bf16 v[20:23], a[84:87], v[100:103], v[20:23]
    ds_read_b64_tr_b16 a[248:249], v2 offset:37088
    v_perm_b32 v46, v29, v28, s100
    v_mfma_f32_16x16x32_bf16 v[20:23], a[88:91], v[104:107], v[20:23]
    v_exp_f32 v31, v31
    v_mfma_f32_16x16x32_bf16 v[20:23], a[92:95], v[108:111], v[20:23]
    ds_read_b64_tr_b16 a[250:251], v2 offset:37344
    v_mfma_f32_16x16x32_bf16 v[24:27], a[96:99], v[96:99], v[56:59]
    v_exp_f32 v16, v16
    v_mfma_f32_16x16x32_bf16 v[24:27], a[100:103], v[100:103], v[24:27]
    ds_read_b64_tr_b16 a[252:253], v2 offset:37600
    v_perm_b32 v47, v31, v30, s100
    v_mfma_f32_16x16x32_bf16 v[24:27], a[104:107], v[104:107], v[24:27]
    v_exp_f32 v17, v17
    v_mfma_f32_16x16x32_bf16 v[24:27], a[108:111], v[108:111], v[24:27]
    ds_read_b64_tr_b16 a[254:255], v2 offset:37856
    v_mfma_f32_16x16x32_bf16 v[28:31], a[112:115], v[96:99], v[56:59]
    v_exp_f32 v18, v18
    v_mfma_f32_16x16x32_bf16 v[28:31], a[116:119], v[100:103], v[28:31]
    v_perm_b32 v32, v17, v16, s100
    v_mfma_f32_16x16x32_bf16 v[28:31], a[120:123], v[104:107], v[28:31]
    v_exp_f32 v19, v19
    v_mfma_f32_16x16x32_bf16 v[28:31], a[124:127], v[108:111], v[28:31]
    v_mfma_f32_16x16x32_bf16 v[160:163], a[128:131], v[40:43], v[160:163]
    v_exp_f32 v20, v20
    v_mfma_f32_16x16x32_bf16 v[160:163], a[132:135], v[44:47], v[160:163]
    v_perm_b32 v33, v19, v18, s100
    v_mfma_f32_16x16x32_bf16 v[164:167], a[136:139], v[40:43], v[164:167]
    v_exp_f32 v21, v21
    v_mfma_f32_16x16x32_bf16 v[164:167], a[140:143], v[44:47], v[164:167]
    v_mfma_f32_16x16x32_bf16 v[168:171], a[144:147], v[40:43], v[168:171]
    v_exp_f32 v22, v22
    v_mfma_f32_16x16x32_bf16 v[168:171], a[148:151], v[44:47], v[168:171]
    v_perm_b32 v34, v21, v20, s100
    v_mfma_f32_16x16x32_bf16 v[172:175], a[152:155], v[40:43], v[172:175]
    v_exp_f32 v23, v23
    v_mfma_f32_16x16x32_bf16 v[172:175], a[156:159], v[44:47], v[172:175]
    v_mfma_f32_16x16x32_bf16 v[176:179], a[160:163], v[40:43], v[176:179]
    v_exp_f32 v24, v24
    v_mfma_f32_16x16x32_bf16 v[176:179], a[164:167], v[44:47], v[176:179]
    v_perm_b32 v35, v23, v22, s100
    v_mfma_f32_16x16x32_bf16 v[180:183], a[168:171], v[40:43], v[180:183]
    v_exp_f32 v25, v25
    v_mfma_f32_16x16x32_bf16 v[180:183], a[172:175], v[44:47], v[180:183]
    v_mfma_f32_16x16x32_bf16 v[184:187], a[176:179], v[40:43], v[184:187]
    v_exp_f32 v26, v26
    v_mfma_f32_16x16x32_bf16 v[184:187], a[180:183], v[44:47], v[184:187]
    v_perm_b32 v36, v25, v24, s100
    v_mfma_f32_16x16x32_bf16 v[188:191], a[184:187], v[40:43], v[188:191]
    v_exp_f32 v27, v27
    v_mfma_f32_16x16x32_bf16 v[188:191], a[188:191], v[44:47], v[188:191]
    v_smfmac_f32_16x16x64_bf16 a[4:7], a[16:19], v[40:47], v11
    v_mfma_f32_16x16x32_bf16 v[16:19], a[64:67], v[112:115], v[60:63]
    v_exp_f32 v28, v28
    v_mfma_f32_16x16x32_bf16 v[16:19], a[68:71], v[116:119], v[16:19]
    ds_read_b128 a[64:67], v1 offset:36864
    v_perm_b32 v37, v27, v26, s100
    v_mfma_f32_16x16x32_bf16 v[16:19], a[72:75], v[120:123], v[16:19]
    v_exp_f32 v29, v29
    v_mfma_f32_16x16x32_bf16 v[16:19], a[76:79], v[124:127], v[16:19]
    ds_read_b128 a[68:71], v1 offset:36928
    v_mfma_f32_16x16x32_bf16 v[20:23], a[80:83], v[112:115], v[60:63]
    v_exp_f32 v30, v30
    v_mfma_f32_16x16x32_bf16 v[20:23], a[84:87], v[116:119], v[20:23]
    ds_read_b128 a[72:75], v1 offset:36992
    v_perm_b32 v38, v29, v28, s100
    v_mfma_f32_16x16x32_bf16 v[20:23], a[88:91], v[120:123], v[20:23]
    v_exp_f32 v31, v31
    v_mfma_f32_16x16x32_bf16 v[20:23], a[92:95], v[124:127], v[20:23]
    ds_read_b128 a[76:79], v1 offset:37056
    v_mfma_f32_16x16x32_bf16 v[24:27], a[96:99], v[112:115], v[60:63]
    v_exp_f32 v16, v16
    v_mfma_f32_16x16x32_bf16 v[24:27], a[100:103], v[116:119], v[24:27]
    ds_read_b128 a[80:83], v1 offset:37120
    v_perm_b32 v39, v31, v30, s100
    v_mfma_f32_16x16x32_bf16 v[24:27], a[104:107], v[120:123], v[24:27]
    v_exp_f32 v17, v17
    v_mfma_f32_16x16x32_bf16 v[24:27], a[108:111], v[124:127], v[24:27]
    ds_read_b128 a[84:87], v1 offset:37184
    v_mfma_f32_16x16x32_bf16 v[28:31], a[112:115], v[112:115], v[60:63]
    v_exp_f32 v18, v18
    v_mfma_f32_16x16x32_bf16 v[28:31], a[116:119], v[116:119], v[28:31]
    ds_read_b128 a[88:91], v1 offset:37248
    v_perm_b32 v40, v17, v16, s100
    v_mfma_f32_16x16x32_bf16 v[28:31], a[120:123], v[120:123], v[28:31]
L2_pad7:
    s_cbranch_execz L2_pad11
    v_exp_f32 v19, v19
    v_mfma_f32_16x16x32_bf16 v[28:31], a[124:127], v[124:127], v[28:31]
    ds_read_b128 a[92:95], v1 offset:37312
    v_mfma_f32_16x16x32_bf16 v[192:195], a[128:131], v[32:35], v[192:195]
    v_exp_f32 v20, v20
    v_mfma_f32_16x16x32_bf16 v[192:195], a[132:135], v[36:39], v[192:195]
    ds_read_b128 a[96:99], v1 offset:37376
    v_perm_b32 v41, v19, v18, s100
    v_mfma_f32_16x16x32_bf16 v[196:199], a[136:139], v[32:35], v[196:199]
    v_exp_f32 v21, v21
    v_mfma_f32_16x16x32_bf16 v[196:199], a[140:143], v[36:39], v[196:199]
    ds_read_b128 a[100:103], v1 offset:37440
    v_mfma_f32_16x16x32_bf16 v[200:203], a[144:147], v[32:35], v[200:203]
    v_exp_f32 v22, v22
    v_mfma_f32_16x16x32_bf16 v[200:203], a[148:151], v[36:39], v[200:203]
    ds_read_b128 a[104:107], v1 offset:37504
    v_perm_b32 v42, v21, v20, s100
    v_mfma_f32_16x16x32_bf16 v[204:207], a[152:155], v[32:35], v[204:207]
    v_exp_f32 v23, v23
    v_mfma_f32_16x16x32_bf16 v[204:207], a[156:159], v[36:39], v[204:207]
    ds_read_b128 a[108:111], v1 offset:37568
    v_mfma_f32_16x16x32_bf16 v[208:211], a[160:163], v[32:35], v[208:211]
    v_exp_f32 v24, v24
    v_mfma_f32_16x16x32_bf16 v[208:211], a[164:167], v[36:39], v[208:211]
    ds_read_b128 a[112:115], v1 offset:37632
    v_perm_b32 v43, v23, v22, s100
    v_mfma_f32_16x16x32_bf16 v[212:215], a[168:171], v[32:35], v[212:215]
    v_exp_f32 v25, v25
    v_mfma_f32_16x16x32_bf16 v[212:215], a[172:175], v[36:39], v[212:215]
    ds_read_b128 a[116:119], v1 offset:37696
    v_mfma_f32_16x16x32_bf16 v[216:219], a[176:179], v[32:35], v[216:219]
    v_exp_f32 v26, v26
    v_mfma_f32_16x16x32_bf16 v[216:219], a[180:183], v[36:39], v[216:219]
    ds_read_b128 a[120:123], v1 offset:37760
    v_perm_b32 v44, v25, v24, s100
    v_mfma_f32_16x16x32_bf16 v[220:223], a[184:187], v[32:35], v[220:223]
    v_exp_f32 v27, v27
    v_mfma_f32_16x16x32_bf16 v[220:223], a[188:191], v[36:39], v[220:223]
    ds_read_b128 a[124:127], v1 offset:37824
    v_smfmac_f32_16x16x64_bf16 a[8:11], a[16:19], v[32:39], v11
    s_waitcnt lgkmcnt(12)
    v_mfma_f32_16x16x32_bf16 v[16:19], a[64:67], v[64:67], v[48:51]
    s_sub_u32 s47, s47, s48
    v_exp_f32 v28, v28
    v_mfma_f32_16x16x32_bf16 v[16:19], a[68:71], v[68:71], v[16:19]
    v_perm_b32 v45, v27, v26, s100
    v_add_u32 v1, s48, v1
    v_mfma_f32_16x16x32_bf16 v[16:19], a[72:75], v[72:75], v[16:19]
    v_exp_f32 v29, v29
    v_mfma_f32_16x16x32_bf16 v[16:19], a[76:79], v[76:79], v[16:19]
    s_waitcnt lgkmcnt(8)
    v_mfma_f32_16x16x32_bf16 v[20:23], a[80:83], v[64:67], v[48:51]
    v_exp_f32 v30, v30
    v_mfma_f32_16x16x32_bf16 v[20:23], a[84:87], v[68:71], v[20:23]
    v_perm_b32 v46, v29, v28, s100
    v_add_u32 v2, s48, v2
    v_mfma_f32_16x16x32_bf16 v[20:23], a[88:91], v[72:75], v[20:23]
    v_exp_f32 v31, v31
    v_mfma_f32_16x16x32_bf16 v[20:23], a[92:95], v[76:79], v[20:23]
    s_waitcnt lgkmcnt(4)
    v_mfma_f32_16x16x32_bf16 v[24:27], a[96:99], v[64:67], v[48:51]
    s_sub_u32 s48, 0, s48
    v_exp_f32 v16, v16
    v_mfma_f32_16x16x32_bf16 v[24:27], a[100:103], v[68:71], v[24:27]
    v_perm_b32 v47, v31, v30, s100
    v_mfma_f32_16x16x32_bf16 v[24:27], a[104:107], v[72:75], v[24:27]
    v_exp_f32 v17, v17
    v_mfma_f32_16x16x32_bf16 v[24:27], a[108:111], v[76:79], v[24:27]
    s_waitcnt lgkmcnt(0)
    v_mfma_f32_16x16x32_bf16 v[28:31], a[112:115], v[64:67], v[48:51]
    v_exp_f32 v18, v18
    v_mfma_f32_16x16x32_bf16 v[28:31], a[116:119], v[68:71], v[28:31]
    v_perm_b32 v32, v17, v16, s100
    v_mfma_f32_16x16x32_bf16 v[28:31], a[120:123], v[72:75], v[28:31]
    v_exp_f32 v19, v19
    v_mfma_f32_16x16x32_bf16 v[28:31], a[124:127], v[76:79], v[28:31]
    s_waitcnt vmcnt(2)
    s_barrier
    v_mfma_f32_16x16x32_bf16 v[224:227], a[128:131], v[40:43], v[224:227]
    v_exp_f32 v20, v20
    v_mfma_f32_16x16x32_bf16 v[224:227], a[132:135], v[44:47], v[224:227]
    ds_read_b64_tr_b16 a[128:129], v2 offset:0
    v_perm_b32 v33, v19, v18, s100
    v_mfma_f32_16x16x32_bf16 v[228:231], a[136:139], v[40:43], v[228:231]
    s_add_u32 m0, s47, 0
    v_exp_f32 v21, v21
    v_mfma_f32_16x16x32_bf16 v[228:231], a[140:143], v[44:47], v[228:231]
    s_add_u32 s46, s46, 16384
    buffer_load_dwordx4 v5, s[16:19], s46 offen offset:0 lds
    v_mfma_f32_16x16x32_bf16 v[232:235], a[144:147], v[40:43], v[232:235]
    v_exp_f32 v22, v22
    v_mfma_f32_16x16x32_bf16 v[232:235], a[148:151], v[44:47], v[232:235]
    ds_read_b64_tr_b16 a[130:131], v2 offset:256
    v_perm_b32 v34, v21, v20, s100
    v_mfma_f32_16x16x32_bf16 v[236:239], a[152:155], v[40:43], v[236:239]
    s_add_u32 m0, s47, 32
    v_exp_f32 v23, v23
    v_mfma_f32_16x16x32_bf16 v[236:239], a[156:159], v[44:47], v[236:239]
    buffer_load_dwordx4 v5, s[16:19], s46 offen offset:1024 lds
    v_mfma_f32_16x16x32_bf16 v[240:243], a[160:163], v[40:43], v[240:243]
    v_exp_f32 v24, v24
    v_mfma_f32_16x16x32_bf16 v[240:243], a[164:167], v[44:47], v[240:243]
    ds_read_b64_tr_b16 a[132:133], v2 offset:512
    v_perm_b32 v35, v23, v22, s100
    v_mfma_f32_16x16x32_bf16 v[244:247], a[168:171], v[40:43], v[244:247]
    s_add_u32 m0, s47, 64
    v_exp_f32 v25, v25
    v_mfma_f32_16x16x32_bf16 v[244:247], a[172:175], v[44:47], v[244:247]
    buffer_load_dwordx4 v5, s[16:19], s46 offen offset:2048 lds
    v_mfma_f32_16x16x32_bf16 v[248:251], a[176:179], v[40:43], v[248:251]
    v_exp_f32 v26, v26
    v_mfma_f32_16x16x32_bf16 v[248:251], a[180:183], v[44:47], v[248:251]
    ds_read_b64_tr_b16 a[134:135], v2 offset:768
    v_perm_b32 v36, v25, v24, s100
    v_mfma_f32_16x16x32_bf16 v[252:255], a[184:187], v[40:43], v[252:255]
    s_add_u32 m0, s47, 96
    v_exp_f32 v27, v27
    v_mfma_f32_16x16x32_bf16 v[252:255], a[188:191], v[44:47], v[252:255]
    buffer_load_dwordx4 v5, s[16:19], s46 offen offset:3072 lds
    v_smfmac_f32_16x16x64_bf16 a[12:15], a[16:19], v[40:47], v11
    ds_read_b64_tr_b16 a[136:137], v2 offset:32
    v_mfma_f32_16x16x32_bf16 v[16:19], a[64:67], v[80:83], v[52:55]
    v_exp_f32 v28, v28
    v_mfma_f32_16x16x32_bf16 v[16:19], a[68:71], v[84:87], v[16:19]
    ds_read_b64_tr_b16 a[138:139], v2 offset:288
    v_perm_b32 v37, v27, v26, s100
    v_mfma_f32_16x16x32_bf16 v[16:19], a[72:75], v[88:91], v[16:19]
    s_add_u32 m0, s47, 16896
    v_exp_f32 v29, v29
    v_mfma_f32_16x16x32_bf16 v[16:19], a[76:79], v[92:95], v[16:19]
    buffer_load_dwordx4 v5, s[20:23], s46 offen offset:0 lds
    v_mfma_f32_16x16x32_bf16 v[20:23], a[80:83], v[80:83], v[52:55]
    v_exp_f32 v30, v30
    v_mfma_f32_16x16x32_bf16 v[20:23], a[84:87], v[84:87], v[20:23]
    ds_read_b64_tr_b16 a[140:141], v2 offset:544
    v_perm_b32 v38, v29, v28, s100
    v_mfma_f32_16x16x32_bf16 v[20:23], a[88:91], v[88:91], v[20:23]
    s_add_u32 m0, s47, 16928
    v_exp_f32 v31, v31
    v_mfma_f32_16x16x32_bf16 v[20:23], a[92:95], v[92:95], v[20:23]
    buffer_load_dwordx4 v5, s[20:23], s46 offen offset:1024 lds
    v_mfma_f32_16x16x32_bf16 v[24:27], a[96:99], v[80:83], v[52:55]
    v_exp_f32 v16, v16
    v_mfma_f32_16x16x32_bf16 v[24:27], a[100:103], v[84:87], v[24:27]
    ds_read_b64_tr_b16 a[142:143], v2 offset:800
    v_perm_b32 v39, v31, v30, s100
    v_mfma_f32_16x16x32_bf16 v[24:27], a[104:107], v[88:91], v[24:27]
    s_add_u32 m0, s47, 16960
    v_exp_f32 v17, v17
    v_mfma_f32_16x16x32_bf16 v[24:27], a[108:111], v[92:95], v[24:27]
    buffer_load_dwordx4 v5, s[20:23], s46 offen offset:2048 lds
    v_mfma_f32_16x16x32_bf16 v[28:31], a[112:115], v[80:83], v[52:55]
    v_exp_f32 v18, v18
    v_mfma_f32_16x16x32_bf16 v[28:31], a[116:119], v[84:87], v[28:31]
    ds_read_b64_tr_b16 a[144:145], v2 offset:64
    v_perm_b32 v40, v17, v16, s100
    v_mfma_f32_16x16x32_bf16 v[28:31], a[120:123], v[88:91], v[28:31]
    s_add_u32 m0, s47, 16992
    v_exp_f32 v19, v19
    v_mfma_f32_16x16x32_bf16 v[28:31], a[124:127], v[92:95], v[28:31]
    buffer_load_dwordx4 v5, s[20:23], s46 offen offset:3072 lds
    v_mfma_f32_16x16x32_bf16 v[128:131], a[192:195], v[32:35], v[128:131]
    v_exp_f32 v20, v20
    v_mfma_f32_16x16x32_bf16 v[128:131], a[196:199], v[36:39], v[128:131]
    ds_read_b64_tr_b16 a[146:147], v2 offset:320
    v_perm_b32 v41, v19, v18, s100
    v_mfma_f32_16x16x32_bf16 v[132:135], a[200:203], v[32:35], v[132:135]
    v_exp_f32 v21, v21
    v_mfma_f32_16x16x32_bf16 v[132:135], a[204:207], v[36:39], v[132:135]
    ds_read_b64_tr_b16 a[148:149], v2 offset:576
    v_mfma_f32_16x16x32_bf16 v[136:139], a[208:211], v[32:35], v[136:139]
    v_exp_f32 v22, v22
    v_mfma_f32_16x16x32_bf16 v[136:139], a[212:215], v[36:39], v[136:139]
    ds_read_b64_tr_b16 a[150:151], v2 offset:832
    v_perm_b32 v42, v21, v20, s100
    v_mfma_f32_16x16x32_bf16 v[140:143], a[216:219], v[32:35], v[140:143]
    v_exp_f32 v23, v23
    v_mfma_f32_16x16x32_bf16 v[140:143], a[220:223], v[36:39], v[140:143]
    ds_read_b64_tr_b16 a[152:153], v2 offset:96
    ds_read_b64_tr_b16 a[154:155], v2 offset:352
    v_mfma_f32_16x16x32_bf16 v[144:147], a[224:227], v[32:35], v[144:147]
    v_exp_f32 v24, v24
    v_mfma_f32_16x16x32_bf16 v[144:147], a[228:231], v[36:39], v[144:147]
    ds_read_b64_tr_b16 a[156:157], v2 offset:608
    v_perm_b32 v43, v23, v22, s100
    v_mfma_f32_16x16x32_bf16 v[148:151], a[232:235], v[32:35], v[148:151]
    v_exp_f32 v25, v25
    v_mfma_f32_16x16x32_bf16 v[148:151], a[236:239], v[36:39], v[148:151]
    ds_read_b64_tr_b16 a[158:159], v2 offset:864
    ds_read_b64_tr_b16 a[160:161], v2 offset:128
    v_mfma_f32_16x16x32_bf16 v[152:155], a[240:243], v[32:35], v[152:155]
    v_exp_f32 v26, v26
    v_mfma_f32_16x16x32_bf16 v[152:155], a[244:247], v[36:39], v[152:155]
    ds_read_b64_tr_b16 a[162:163], v2 offset:384
    v_perm_b32 v44, v25, v24, s100
    v_mfma_f32_16x16x32_bf16 v[156:159], a[248:251], v[32:35], v[156:159]
    v_exp_f32 v27, v27
    v_mfma_f32_16x16x32_bf16 v[156:159], a[252:255], v[36:39], v[156:159]
    ds_read_b64_tr_b16 a[164:165], v2 offset:640
    ds_read_b64_tr_b16 a[166:167], v2 offset:896
    v_smfmac_f32_16x16x64_bf16 a[0:3], a[16:19], v[32:39], v11
    ds_read_b64_tr_b16 a[168:169], v2 offset:160
    ds_read_b64_tr_b16 a[170:171], v2 offset:416
    v_mfma_f32_16x16x32_bf16 v[16:19], a[64:67], v[96:99], v[56:59]
    v_exp_f32 v28, v28
    v_mfma_f32_16x16x32_bf16 v[16:19], a[68:71], v[100:103], v[16:19]
    ds_read_b64_tr_b16 a[172:173], v2 offset:672
    v_perm_b32 v45, v27, v26, s100
    v_mfma_f32_16x16x32_bf16 v[16:19], a[72:75], v[104:107], v[16:19]
    s_add_u32 m0, s47, 36864
    v_exp_f32 v29, v29
    v_mfma_f32_16x16x32_bf16 v[16:19], a[76:79], v[108:111], v[16:19]
    s_add_u32 s46, s46, 16384
    buffer_load_dwordx4 v5, s[16:19], s46 offen offset:0 lds
    v_mfma_f32_16x16x32_bf16 v[20:23], a[80:83], v[96:99], v[56:59]
    v_exp_f32 v30, v30
    v_mfma_f32_16x16x32_bf16 v[20:23], a[84:87], v[100:103], v[20:23]
    ds_read_b64_tr_b16 a[174:175], v2 offset:928
    v_perm_b32 v46, v29, v28, s100
    v_mfma_f32_16x16x32_bf16 v[20:23], a[88:91], v[104:107], v[20:23]
    s_add_u32 m0, s47, 36896
    v_exp_f32 v31, v31
    v_mfma_f32_16x16x32_bf16 v[20:23], a[92:95], v[108:111], v[20:23]
    buffer_load_dwordx4 v5, s[16:19], s46 offen offset:1024 lds
    v_mfma_f32_16x16x32_bf16 v[24:27], a[96:99], v[96:99], v[56:59]
    v_exp_f32 v16, v16
    v_mfma_f32_16x16x32_bf16 v[24:27], a[100:103], v[100:103], v[24:27]
    ds_read_b64_tr_b16 a[176:177], v2 offset:192
    v_perm_b32 v47, v31, v30, s100
    v_mfma_f32_16x16x32_bf16 v[24:27], a[104:107], v[104:107], v[24:27]
    s_add_u32 m0, s47, 36928
    v_exp_f32 v17, v17
    v_mfma_f32_16x16x32_bf16 v[24:27], a[108:111], v[108:111], v[24:27]
    buffer_load_dwordx4 v5, s[16:19], s46 offen offset:2048 lds
    v_mfma_f32_16x16x32_bf16 v[28:31], a[112:115], v[96:99], v[56:59]
    v_exp_f32 v18, v18
    v_mfma_f32_16x16x32_bf16 v[28:31], a[116:119], v[100:103], v[28:31]
    ds_read_b64_tr_b16 a[178:179], v2 offset:448
    v_perm_b32 v32, v17, v16, s100
    v_mfma_f32_16x16x32_bf16 v[28:31], a[120:123], v[104:107], v[28:31]
    s_add_u32 m0, s47, 36960
    v_exp_f32 v19, v19
    v_mfma_f32_16x16x32_bf16 v[28:31], a[124:127], v[108:111], v[28:31]
    buffer_load_dwordx4 v5, s[16:19], s46 offen offset:3072 lds
    v_mfma_f32_16x16x32_bf16 v[160:163], a[192:195], v[40:43], v[160:163]
    v_exp_f32 v20, v20
    v_mfma_f32_16x16x32_bf16 v[160:163], a[196:199], v[44:47], v[160:163]
    ds_read_b64_tr_b16 a[180:181], v2 offset:704
    v_perm_b32 v33, v19, v18, s100
    v_mfma_f32_16x16x32_bf16 v[164:167], a[200:203], v[40:43], v[164:167]
    s_add_u32 m0, s47, 53760
    v_exp_f32 v21, v21
    v_mfma_f32_16x16x32_bf16 v[164:167], a[204:207], v[44:47], v[164:167]
    buffer_load_dwordx4 v5, s[20:23], s46 offen offset:0 lds
    v_mfma_f32_16x16x32_bf16 v[168:171], a[208:211], v[40:43], v[168:171]
    v_exp_f32 v22, v22
    v_mfma_f32_16x16x32_bf16 v[168:171], a[212:215], v[44:47], v[168:171]
    ds_read_b64_tr_b16 a[182:183], v2 offset:960
    v_perm_b32 v34, v21, v20, s100
    v_mfma_f32_16x16x32_bf16 v[172:175], a[216:219], v[40:43], v[172:175]
    s_add_u32 m0, s47, 53792
    v_exp_f32 v23, v23
    v_mfma_f32_16x16x32_bf16 v[172:175], a[220:223], v[44:47], v[172:175]
    buffer_load_dwordx4 v5, s[20:23], s46 offen offset:1024 lds
    v_mfma_f32_16x16x32_bf16 v[176:179], a[224:227], v[40:43], v[176:179]
    v_exp_f32 v24, v24
    v_mfma_f32_16x16x32_bf16 v[176:179], a[228:231], v[44:47], v[176:179]
    ds_read_b64_tr_b16 a[184:185], v2 offset:224
    v_perm_b32 v35, v23, v22, s100
    v_mfma_f32_16x16x32_bf16 v[180:183], a[232:235], v[40:43], v[180:183]
    s_add_u32 m0, s47, 53824
    v_exp_f32 v25, v25
    v_mfma_f32_16x16x32_bf16 v[180:183], a[236:239], v[44:47], v[180:183]
    buffer_load_dwordx4 v5, s[20:23], s46 offen offset:2048 lds
    v_mfma_f32_16x16x32_bf16 v[184:187], a[240:243], v[40:43], v[184:187]
    v_exp_f32 v26, v26
    v_mfma_f32_16x16x32_bf16 v[184:187], a[244:247], v[44:47], v[184:187]
    ds_read_b64_tr_b16 a[186:187], v2 offset:480
    v_perm_b32 v36, v25, v24, s100
    v_mfma_f32_16x16x32_bf16 v[188:191], a[248:251], v[40:43], v[188:191]
    s_add_u32 m0, s47, 53856
    v_exp_f32 v27, v27
    v_mfma_f32_16x16x32_bf16 v[188:191], a[252:255], v[44:47], v[188:191]
    buffer_load_dwordx4 v5, s[20:23], s46 offen offset:3072 lds
    v_smfmac_f32_16x16x64_bf16 a[4:7], a[16:19], v[40:47], v11
    ds_read_b64_tr_b16 a[188:189], v2 offset:736
    ds_read_b64_tr_b16 a[190:191], v2 offset:992
    v_mfma_f32_16x16x32_bf16 v[16:19], a[64:67], v[112:115], v[60:63]
    v_exp_f32 v28, v28
    v_mfma_f32_16x16x32_bf16 v[16:19], a[68:71], v[116:119], v[16:19]
    ds_read_b128 a[64:67], v1 offset:0
    v_perm_b32 v37, v27, v26, s100
    v_mfma_f32_16x16x32_bf16 v[16:19], a[72:75], v[120:123], v[16:19]
    v_exp_f32 v29, v29
    v_mfma_f32_16x16x32_bf16 v[16:19], a[76:79], v[124:127], v[16:19]
    ds_read_b128 a[68:71], v1 offset:64
    v_mfma_f32_16x16x32_bf16 v[20:23], a[80:83], v[112:115], v[60:63]
    v_exp_f32 v30, v30
    v_mfma_f32_16x16x32_bf16 v[20:23], a[84:87], v[116:119], v[20:23]
    ds_read_b128 a[72:75], v1 offset:128
    v_perm_b32 v38, v29, v28, s100
    v_mfma_f32_16x16x32_bf16 v[20:23], a[88:91], v[120:123], v[20:23]
    v_exp_f32 v31, v31
    v_mfma_f32_16x16x32_bf16 v[20:23], a[92:95], v[124:127], v[20:23]
    ds_read_b128 a[76:79], v1 offset:192
    v_mfma_f32_16x16x32_bf16 v[24:27], a[96:99], v[112:115], v[60:63]
    v_exp_f32 v16, v16
    v_mfma_f32_16x16x32_bf16 v[24:27], a[100:103], v[116:119], v[24:27]
    ds_read_b128 a[80:83], v1 offset:256
    v_perm_b32 v39, v31, v30, s100
    v_mfma_f32_16x16x32_bf16 v[24:27], a[104:107], v[120:123], v[24:27]
    v_exp_f32 v17, v17
    v_mfma_f32_16x16x32_bf16 v[24:27], a[108:111], v[124:127], v[24:27]
    ds_read_b128 a[84:87], v1 offset:320
    v_mfma_f32_16x16x32_bf16 v[28:31], a[112:115], v[112:115], v[60:63]
    v_exp_f32 v18, v18
    v_mfma_f32_16x16x32_bf16 v[28:31], a[116:119], v[116:119], v[28:31]
    ds_read_b128 a[88:91], v1 offset:384
    v_perm_b32 v40, v17, v16, s100
    v_mfma_f32_16x16x32_bf16 v[28:31], a[120:123], v[120:123], v[28:31]
    v_exp_f32 v19, v19
    v_mfma_f32_16x16x32_bf16 v[28:31], a[124:127], v[124:127], v[28:31]
    ds_read_b128 a[92:95], v1 offset:448
    v_mfma_f32_16x16x32_bf16 v[192:195], a[192:195], v[32:35], v[192:195]
    v_exp_f32 v20, v20
    v_mfma_f32_16x16x32_bf16 v[192:195], a[196:199], v[36:39], v[192:195]
    ds_read_b128 a[96:99], v1 offset:512
    v_perm_b32 v41, v19, v18, s100
    v_mfma_f32_16x16x32_bf16 v[196:199], a[200:203], v[32:35], v[196:199]
    v_exp_f32 v21, v21
    v_mfma_f32_16x16x32_bf16 v[196:199], a[204:207], v[36:39], v[196:199]
    ds_read_b128 a[100:103], v1 offset:576
    v_mfma_f32_16x16x32_bf16 v[200:203], a[208:211], v[32:35], v[200:203]
    v_exp_f32 v22, v22
    v_mfma_f32_16x16x32_bf16 v[200:203], a[212:215], v[36:39], v[200:203]
    ds_read_b128 a[104:107], v1 offset:640
    v_perm_b32 v42, v21, v20, s100
    v_mfma_f32_16x16x32_bf16 v[204:207], a[216:219], v[32:35], v[204:207]
    v_exp_f32 v23, v23
    v_mfma_f32_16x16x32_bf16 v[204:207], a[220:223], v[36:39], v[204:207]
    ds_read_b128 a[108:111], v1 offset:704
    v_mfma_f32_16x16x32_bf16 v[208:211], a[224:227], v[32:35], v[208:211]
    v_exp_f32 v24, v24
    v_mfma_f32_16x16x32_bf16 v[208:211], a[228:231], v[36:39], v[208:211]
    ds_read_b128 a[112:115], v1 offset:768
    v_perm_b32 v43, v23, v22, s100
    v_mfma_f32_16x16x32_bf16 v[212:215], a[232:235], v[32:35], v[212:215]
    v_exp_f32 v25, v25
    v_mfma_f32_16x16x32_bf16 v[212:215], a[236:239], v[36:39], v[212:215]
    ds_read_b128 a[116:119], v1 offset:832
    v_mfma_f32_16x16x32_bf16 v[216:219], a[240:243], v[32:35], v[216:219]
    v_exp_f32 v26, v26
    v_mfma_f32_16x16x32_bf16 v[216:219], a[244:247], v[36:39], v[216:219]
    ds_read_b128 a[120:123], v1 offset:896
    v_perm_b32 v44, v25, v24, s100
    v_mfma_f32_16x16x32_bf16 v[220:223], a[248:251], v[32:35], v[220:223]
    v_exp_f32 v27, v27
    v_mfma_f32_16x16x32_bf16 v[220:223], a[252:255], v[36:39], v[220:223]
    ds_read_b128 a[124:127], v1 offset:960
    v_smfmac_f32_16x16x64_bf16 a[8:11], a[16:19], v[32:39], v11
    s_waitcnt lgkmcnt(12)
    v_mfma_f32_16x16x32_bf16 v[16:19], a[64:67], v[64:67], v[48:51]
    v_exp_f32 v28, v28
    v_mfma_f32_16x16x32_bf16 v[16:19], a[68:71], v[68:71], v[16:19]
    v_perm_b32 v45, v27, v26, s100
    v_mfma_f32_16x16x32_bf16 v[16:19], a[72:75], v[72:75], v[16:19]
    v_exp_f32 v29, v29
    v_mfma_f32_16x16x32_bf16 v[16:19], a[76:79], v[76:79], v[16:19]
    s_waitcnt lgkmcnt(8)
    global_load_dword a63, v13, s[8:9]
    v_mfma_f32_16x16x32_bf16 v[20:23], a[80:83], v[64:67], v[48:51]
    v_exp_f32 v30, v30
    v_mfma_f32_16x16x32_bf16 v[20:23], a[84:87], v[68:71], v[20:23]
    v_perm_b32 v46, v29, v28, s100
    v_mfma_f32_16x16x32_bf16 v[20:23], a[88:91], v[72:75], v[20:23]
    v_exp_f32 v31, v31
    v_mfma_f32_16x16x32_bf16 v[20:23], a[92:95], v[76:79], v[20:23]
    s_waitcnt lgkmcnt(4)
    v_mfma_f32_16x16x32_bf16 v[24:27], a[96:99], v[64:67], v[48:51]
    v_exp_f32 v16, v16
    v_mfma_f32_16x16x32_bf16 v[24:27], a[100:103], v[68:71], v[24:27]
    v_perm_b32 v47, v31, v30, s100
    v_mfma_f32_16x16x32_bf16 v[24:27], a[104:107], v[72:75], v[24:27]
    v_exp_f32 v17, v17
    v_mfma_f32_16x16x32_bf16 v[24:27], a[108:111], v[76:79], v[24:27]
    s_waitcnt lgkmcnt(0)
    buffer_load_dword a63, v9, s[36:39], 0 offen
    v_mfma_f32_16x16x32_bf16 v[28:31], a[112:115], v[64:67], v[48:51]
    v_exp_f32 v18, v18
    v_mfma_f32_16x16x32_bf16 v[28:31], a[116:119], v[68:71], v[28:31]
    v_perm_b32 v32, v17, v16, s100
    v_mfma_f32_16x16x32_bf16 v[28:31], a[120:123], v[72:75], v[28:31]
    v_exp_f32 v19, v19
    v_mfma_f32_16x16x32_bf16 v[28:31], a[124:127], v[76:79], v[28:31]
    v_mfma_f32_16x16x32_bf16 v[224:227], a[192:195], v[40:43], v[224:227]
    v_exp_f32 v20, v20
    v_mfma_f32_16x16x32_bf16 v[224:227], a[196:199], v[44:47], v[224:227]
    ds_read_b64_tr_b16 a[192:193], v2 offset:36864
    v_perm_b32 v33, v19, v18, s100
    v_mfma_f32_16x16x32_bf16 v[228:231], a[200:203], v[40:43], v[228:231]
    s_mov_b32 s54, 0
    v_exp_f32 v21, v21
    v_mfma_f32_16x16x32_bf16 v[228:231], a[204:207], v[44:47], v[228:231]
    buffer_load_dwordx4 a[20:23], v6, s[64:67], s54 offen
    v_mfma_f32_16x16x32_bf16 v[232:235], a[208:211], v[40:43], v[232:235]
    v_exp_f32 v22, v22
    v_mfma_f32_16x16x32_bf16 v[232:235], a[212:215], v[44:47], v[232:235]
    ds_read_b64_tr_b16 a[194:195], v2 offset:37120
    v_perm_b32 v34, v21, v20, s100
    v_mfma_f32_16x16x32_bf16 v[236:239], a[216:219], v[40:43], v[236:239]
    v_exp_f32 v23, v23
    v_mfma_f32_16x16x32_bf16 v[236:239], a[220:223], v[44:47], v[236:239]
    ds_read_b64_tr_b16 a[196:197], v2 offset:37376
    v_mfma_f32_16x16x32_bf16 v[240:243], a[224:227], v[40:43], v[240:243]
    v_exp_f32 v24, v24
    v_mfma_f32_16x16x32_bf16 v[240:243], a[228:231], v[44:47], v[240:243]
    ds_read_b64_tr_b16 a[198:199], v2 offset:37632
    v_perm_b32 v35, v23, v22, s100
    v_mfma_f32_16x16x32_bf16 v[244:247], a[232:235], v[40:43], v[244:247]
    s_mov_b32 s54, 147456
    v_exp_f32 v25, v25
    v_mfma_f32_16x16x32_bf16 v[244:247], a[236:239], v[44:47], v[244:247]
    buffer_load_dwordx4 a[24:27], v6, s[64:67], s54 offen
    v_mfma_f32_16x16x32_bf16 v[248:251], a[240:243], v[40:43], v[248:251]
    v_exp_f32 v26, v26
    v_mfma_f32_16x16x32_bf16 v[248:251], a[244:247], v[44:47], v[248:251]
    ds_read_b64_tr_b16 a[200:201], v2 offset:36896
    v_perm_b32 v36, v25, v24, s100
    v_mfma_f32_16x16x32_bf16 v[252:255], a[248:251], v[40:43], v[252:255]
    v_exp_f32 v27, v27
    v_mfma_f32_16x16x32_bf16 v[252:255], a[252:255], v[44:47], v[252:255]
    ds_read_b64_tr_b16 a[202:203], v2 offset:37152
    v_smfmac_f32_16x16x64_bf16 a[12:15], a[16:19], v[40:47], v11
    ds_read_b64_tr_b16 a[204:205], v2 offset:37408
    v_mfma_f32_16x16x32_bf16 v[16:19], a[64:67], v[80:83], v[52:55]
    v_exp_f32 v28, v28
    v_mfma_f32_16x16x32_bf16 v[16:19], a[68:71], v[84:87], v[16:19]
    ds_read_b64_tr_b16 a[206:207], v2 offset:37664
    v_perm_b32 v37, v27, v26, s100
    v_mfma_f32_16x16x32_bf16 v[16:19], a[72:75], v[88:91], v[16:19]
    s_mov_b32 s54, 294912
    v_exp_f32 v29, v29
    v_mfma_f32_16x16x32_bf16 v[16:19], a[76:79], v[92:95], v[16:19]
    buffer_load_dwordx4 a[28:31], v6, s[64:67], s54 offen
    v_mfma_f32_16x16x32_bf16 v[20:23], a[80:83], v[80:83], v[52:55]
    v_exp_f32 v30, v30
    v_mfma_f32_16x16x32_bf16 v[20:23], a[84:87], v[84:87], v[20:23]
    ds_read_b64_tr_b16 a[208:209], v2 offset:36928
    v_perm_b32 v38, v29, v28, s100
    v_mfma_f32_16x16x32_bf16 v[20:23], a[88:91], v[88:91], v[20:23]
    v_exp_f32 v31, v31
    v_mfma_f32_16x16x32_bf16 v[20:23], a[92:95], v[92:95], v[20:23]
    ds_read_b64_tr_b16 a[210:211], v2 offset:37184
    v_mfma_f32_16x16x32_bf16 v[24:27], a[96:99], v[80:83], v[52:55]
    v_exp_f32 v16, v16
    v_mfma_f32_16x16x32_bf16 v[24:27], a[100:103], v[84:87], v[24:27]
    ds_read_b64_tr_b16 a[212:213], v2 offset:37440
    v_perm_b32 v39, v31, v30, s100
    v_mfma_f32_16x16x32_bf16 v[24:27], a[104:107], v[88:91], v[24:27]
    s_mov_b32 s54, 442368
    v_exp_f32 v17, v17
    v_mfma_f32_16x16x32_bf16 v[24:27], a[108:111], v[92:95], v[24:27]
    buffer_load_dwordx4 a[32:35], v6, s[64:67], s54 offen
    v_mfma_f32_16x16x32_bf16 v[28:31], a[112:115], v[80:83], v[52:55]
    v_exp_f32 v18, v18
    v_mfma_f32_16x16x32_bf16 v[28:31], a[116:119], v[84:87], v[28:31]
    ds_read_b64_tr_b16 a[214:215], v2 offset:37696
    v_perm_b32 v40, v17, v16, s100
    v_mfma_f32_16x16x32_bf16 v[28:31], a[120:123], v[88:91], v[28:31]
    v_exp_f32 v19, v19
    v_mfma_f32_16x16x32_bf16 v[28:31], a[124:127], v[92:95], v[28:31]
    ds_read_b64_tr_b16 a[216:217], v2 offset:36960
    v_mfma_f32_16x16x32_bf16 v[128:131], a[128:131], v[32:35], v[128:131]
    v_exp_f32 v20, v20
    v_mfma_f32_16x16x32_bf16 v[128:131], a[132:135], v[36:39], v[128:131]
    ds_read_b64_tr_b16 a[218:219], v2 offset:37216
    v_perm_b32 v41, v19, v18, s100
    v_mfma_f32_16x16x32_bf16 v[132:135], a[136:139], v[32:35], v[132:135]
    s_mov_b32 s54, 589824
    v_exp_f32 v21, v21
    v_mfma_f32_16x16x32_bf16 v[132:135], a[140:143], v[36:39], v[132:135]
    buffer_load_dwordx4 a[36:39], v6, s[64:67], s54 offen
    v_mfma_f32_16x16x32_bf16 v[136:139], a[144:147], v[32:35], v[136:139]
    v_exp_f32 v22, v22
    v_mfma_f32_16x16x32_bf16 v[136:139], a[148:151], v[36:39], v[136:139]
    ds_read_b64_tr_b16 a[220:221], v2 offset:37472
    v_perm_b32 v42, v21, v20, s100
    v_mfma_f32_16x16x32_bf16 v[140:143], a[152:155], v[32:35], v[140:143]
    v_exp_f32 v23, v23
    v_mfma_f32_16x16x32_bf16 v[140:143], a[156:159], v[36:39], v[140:143]
    ds_read_b64_tr_b16 a[222:223], v2 offset:37728
    v_mfma_f32_16x16x32_bf16 v[144:147], a[160:163], v[32:35], v[144:147]
    v_exp_f32 v24, v24
    v_mfma_f32_16x16x32_bf16 v[144:147], a[164:167], v[36:39], v[144:147]
    ds_read_b64_tr_b16 a[224:225], v2 offset:36992
    v_perm_b32 v43, v23, v22, s100
    v_mfma_f32_16x16x32_bf16 v[148:151], a[168:171], v[32:35], v[148:151]
    v_exp_f32 v25, v25
    v_mfma_f32_16x16x32_bf16 v[148:151], a[172:175], v[36:39], v[148:151]
    ds_read_b64_tr_b16 a[226:227], v2 offset:37248
    v_mfma_f32_16x16x32_bf16 v[152:155], a[176:179], v[32:35], v[152:155]
    v_exp_f32 v26, v26
    v_mfma_f32_16x16x32_bf16 v[152:155], a[180:183], v[36:39], v[152:155]
    ds_read_b64_tr_b16 a[228:229], v2 offset:37504
    v_perm_b32 v44, v25, v24, s100
    v_mfma_f32_16x16x32_bf16 v[156:159], a[184:187], v[32:35], v[156:159]
    v_exp_f32 v27, v27
    v_mfma_f32_16x16x32_bf16 v[156:159], a[188:191], v[36:39], v[156:159]
    ds_read_b64_tr_b16 a[230:231], v2 offset:37760
    v_smfmac_f32_16x16x64_bf16 a[0:3], a[16:19], v[32:39], v11
    ds_read_b64_tr_b16 a[232:233], v2 offset:37024
    v_mfma_f32_16x16x32_bf16 v[16:19], a[64:67], v[96:99], v[56:59]
    v_exp_f32 v28, v28
    v_mfma_f32_16x16x32_bf16 v[16:19], a[68:71], v[100:103], v[16:19]
    ds_read_b64_tr_b16 a[234:235], v2 offset:37280
    v_perm_b32 v45, v27, v26, s100
    v_mfma_f32_16x16x32_bf16 v[16:19], a[72:75], v[104:107], v[16:19]
    v_exp_f32 v29, v29
    v_mfma_f32_16x16x32_bf16 v[16:19], a[76:79], v[108:111], v[16:19]
    ds_read_b64_tr_b16 a[236:237], v2 offset:37536
    v_mfma_f32_16x16x32_bf16 v[20:23], a[80:83], v[96:99], v[56:59]
    v_exp_f32 v30, v30
    v_mfma_f32_16x16x32_bf16 v[20:23], a[84:87], v[100:103], v[20:23]
    ds_read_b64_tr_b16 a[238:239], v2 offset:37792
    v_perm_b32 v46, v29, v28, s100
    v_mfma_f32_16x16x32_bf16 v[20:23], a[88:91], v[104:107], v[20:23]
    v_exp_f32 v31, v31
    v_mfma_f32_16x16x32_bf16 v[20:23], a[92:95], v[108:111], v[20:23]
    ds_read_b64_tr_b16 a[240:241], v2 offset:37056
    v_mfma_f32_16x16x32_bf16 v[24:27], a[96:99], v[96:99], v[56:59]
    v_exp_f32 v16, v16
    v_mfma_f32_16x16x32_bf16 v[24:27], a[100:103], v[100:103], v[24:27]
    ds_read_b64_tr_b16 a[242:243], v2 offset:37312
    v_perm_b32 v47, v31, v30, s100
    v_mfma_f32_16x16x32_bf16 v[24:27], a[104:107], v[104:107], v[24:27]
    v_exp_f32 v17, v17
    v_mfma_f32_16x16x32_bf16 v[24:27], a[108:111], v[108:111], v[24:27]
    ds_read_b64_tr_b16 a[244:245], v2 offset:37568
    v_mfma_f32_16x16x32_bf16 v[28:31], a[112:115], v[96:99], v[56:59]
    v_exp_f32 v18, v18
    v_mfma_f32_16x16x32_bf16 v[28:31], a[116:119], v[100:103], v[28:31]
    ds_read_b64_tr_b16 a[246:247], v2 offset:37824
    v_perm_b32 v32, v17, v16, s100
    v_mfma_f32_16x16x32_bf16 v[28:31], a[120:123], v[104:107], v[28:31]
    v_exp_f32 v19, v19
    v_mfma_f32_16x16x32_bf16 v[28:31], a[124:127], v[108:111], v[28:31]
    ds_read_b64_tr_b16 a[248:249], v2 offset:37088
    v_mfma_f32_16x16x32_bf16 v[160:163], a[128:131], v[40:43], v[160:163]
    v_exp_f32 v20, v20
    v_mfma_f32_16x16x32_bf16 v[160:163], a[132:135], v[44:47], v[160:163]
    ds_read_b64_tr_b16 a[250:251], v2 offset:37344
    v_perm_b32 v33, v19, v18, s100
    v_mfma_f32_16x16x32_bf16 v[164:167], a[136:139], v[40:43], v[164:167]
    v_exp_f32 v21, v21
    v_mfma_f32_16x16x32_bf16 v[164:167], a[140:143], v[44:47], v[164:167]
    ds_read_b64_tr_b16 a[252:253], v2 offset:37600
    v_mfma_f32_16x16x32_bf16 v[168:171], a[144:147], v[40:43], v[168:171]
    v_exp_f32 v22, v22
    v_mfma_f32_16x16x32_bf16 v[168:171], a[148:151], v[44:47], v[168:171]
    ds_read_b64_tr_b16 a[254:255], v2 offset:37856
    v_perm_b32 v34, v21, v20, s100
    v_mfma_f32_16x16x32_bf16 v[172:175], a[152:155], v[40:43], v[172:175]
    v_exp_f32 v23, v23
    v_mfma_f32_16x16x32_bf16 v[172:175], a[156:159], v[44:47], v[172:175]
    v_mfma_f32_16x16x32_bf16 v[176:179], a[160:163], v[40:43], v[176:179]
    v_exp_f32 v24, v24
    v_mfma_f32_16x16x32_bf16 v[176:179], a[164:167], v[44:47], v[176:179]
    v_perm_b32 v35, v23, v22, s100
    v_mfma_f32_16x16x32_bf16 v[180:183], a[168:171], v[40:43], v[180:183]
    v_exp_f32 v25, v25
    v_mfma_f32_16x16x32_bf16 v[180:183], a[172:175], v[44:47], v[180:183]
    v_mfma_f32_16x16x32_bf16 v[184:187], a[176:179], v[40:43], v[184:187]
    v_exp_f32 v26, v26
    v_mfma_f32_16x16x32_bf16 v[184:187], a[180:183], v[44:47], v[184:187]
    v_perm_b32 v36, v25, v24, s100
    v_mfma_f32_16x16x32_bf16 v[188:191], a[184:187], v[40:43], v[188:191]
    v_exp_f32 v27, v27
    v_mfma_f32_16x16x32_bf16 v[188:191], a[188:191], v[44:47], v[188:191]
    v_smfmac_f32_16x16x64_bf16 a[4:7], a[16:19], v[40:47], v11
    v_mfma_f32_16x16x32_bf16 v[16:19], a[64:67], v[112:115], v[60:63]
L2_pad8:
    s_cbranch_execz L2_pad12
    v_exp_f32 v28, v28
    v_mfma_f32_16x16x32_bf16 v[16:19], a[68:71], v[116:119], v[16:19]
    ds_read_b128 a[64:67], v1 offset:36864
    v_perm_b32 v37, v27, v26, s100
    v_mfma_f32_16x16x32_bf16 v[16:19], a[72:75], v[120:123], v[16:19]
    v_exp_f32 v29, v29
    v_mfma_f32_16x16x32_bf16 v[16:19], a[76:79], v[124:127], v[16:19]
    ds_read_b128 a[68:71], v1 offset:36928
    v_mfma_f32_16x16x32_bf16 v[20:23], a[80:83], v[112:115], v[60:63]
    v_exp_f32 v30, v30
    v_mfma_f32_16x16x32_bf16 v[20:23], a[84:87], v[116:119], v[20:23]
    ds_read_b128 a[72:75], v1 offset:36992
    v_perm_b32 v38, v29, v28, s100
    v_mfma_f32_16x16x32_bf16 v[20:23], a[88:91], v[120:123], v[20:23]
    v_exp_f32 v31, v31
    v_mfma_f32_16x16x32_bf16 v[20:23], a[92:95], v[124:127], v[20:23]
    ds_read_b128 a[76:79], v1 offset:37056
    v_mfma_f32_16x16x32_bf16 v[24:27], a[96:99], v[112:115], v[60:63]
    v_exp_f32 v16, v16
    v_mfma_f32_16x16x32_bf16 v[24:27], a[100:103], v[116:119], v[24:27]
    ds_read_b128 a[80:83], v1 offset:37120
    v_perm_b32 v39, v31, v30, s100
    v_mfma_f32_16x16x32_bf16 v[24:27], a[104:107], v[120:123], v[24:27]
    v_exp_f32 v17, v17
    v_mfma_f32_16x16x32_bf16 v[24:27], a[108:111], v[124:127], v[24:27]
    ds_read_b128 a[84:87], v1 offset:37184
    v_mfma_f32_16x16x32_bf16 v[28:31], a[112:115], v[112:115], v[60:63]
    v_exp_f32 v18, v18
    v_mfma_f32_16x16x32_bf16 v[28:31], a[116:119], v[116:119], v[28:31]
    ds_read_b128 a[88:91], v1 offset:37248
    v_perm_b32 v40, v17, v16, s100
    v_mfma_f32_16x16x32_bf16 v[28:31], a[120:123], v[120:123], v[28:31]
    v_exp_f32 v19, v19
    v_mfma_f32_16x16x32_bf16 v[28:31], a[124:127], v[124:127], v[28:31]
    ds_read_b128 a[92:95], v1 offset:37312
    v_mfma_f32_16x16x32_bf16 v[192:195], a[128:131], v[32:35], v[192:195]
    v_exp_f32 v20, v20
    v_mfma_f32_16x16x32_bf16 v[192:195], a[132:135], v[36:39], v[192:195]
    ds_read_b128 a[96:99], v1 offset:37376
    v_perm_b32 v41, v19, v18, s100
    v_mfma_f32_16x16x32_bf16 v[196:199], a[136:139], v[32:35], v[196:199]
    v_exp_f32 v21, v21
    v_mfma_f32_16x16x32_bf16 v[196:199], a[140:143], v[36:39], v[196:199]
    ds_read_b128 a[100:103], v1 offset:37440
    v_mfma_f32_16x16x32_bf16 v[200:203], a[144:147], v[32:35], v[200:203]
    v_exp_f32 v22, v22
    v_mfma_f32_16x16x32_bf16 v[200:203], a[148:151], v[36:39], v[200:203]
    ds_read_b128 a[104:107], v1 offset:37504
    v_perm_b32 v42, v21, v20, s100
    v_mfma_f32_16x16x32_bf16 v[204:207], a[152:155], v[32:35], v[204:207]
    v_exp_f32 v23, v23
    v_mfma_f32_16x16x32_bf16 v[204:207], a[156:159], v[36:39], v[204:207]
    ds_read_b128 a[108:111], v1 offset:37568
    v_mfma_f32_16x16x32_bf16 v[208:211], a[160:163], v[32:35], v[208:211]
    v_exp_f32 v24, v24
    v_mfma_f32_16x16x32_bf16 v[208:211], a[164:167], v[36:39], v[208:211]
    ds_read_b128 a[112:115], v1 offset:37632
    v_perm_b32 v43, v23, v22, s100
    v_mfma_f32_16x16x32_bf16 v[212:215], a[168:171], v[32:35], v[212:215]
    v_exp_f32 v25, v25
    v_mfma_f32_16x16x32_bf16 v[212:215], a[172:175], v[36:39], v[212:215]
    ds_read_b128 a[116:119], v1 offset:37696
    v_mfma_f32_16x16x32_bf16 v[216:219], a[176:179], v[32:35], v[216:219]
    v_exp_f32 v26, v26
    v_mfma_f32_16x16x32_bf16 v[216:219], a[180:183], v[36:39], v[216:219]
    ds_read_b128 a[120:123], v1 offset:37760
    v_perm_b32 v44, v25, v24, s100
    v_mfma_f32_16x16x32_bf16 v[220:223], a[184:187], v[32:35], v[220:223]
    v_exp_f32 v27, v27
    v_mfma_f32_16x16x32_bf16 v[220:223], a[188:191], v[36:39], v[220:223]
    ds_read_b128 a[124:127], v1 offset:37824
    v_smfmac_f32_16x16x64_bf16 a[8:11], a[16:19], v[32:39], v11
    s_waitcnt lgkmcnt(12)
    v_mfma_f32_16x16x32_bf16 v[16:19], a[64:67], v[64:67], v[48:51]
    s_sub_u32 s47, s47, s48
    v_exp_f32 v28, v28
    v_mfma_f32_16x16x32_bf16 v[16:19], a[68:71], v[68:71], v[16:19]
    v_perm_b32 v45, v27, v26, s100
    v_add_u32 v1, s48, v1
    v_mfma_f32_16x16x32_bf16 v[16:19], a[72:75], v[72:75], v[16:19]
    v_exp_f32 v29, v29
    v_mfma_f32_16x16x32_bf16 v[16:19], a[76:79], v[76:79], v[16:19]
    s_waitcnt lgkmcnt(8)
    v_mfma_f32_16x16x32_bf16 v[20:23], a[80:83], v[64:67], v[48:51]
    v_exp_f32 v30, v30
    v_mfma_f32_16x16x32_bf16 v[20:23], a[84:87], v[68:71], v[20:23]
    v_perm_b32 v46, v29, v28, s100
    v_add_u32 v2, s48, v2
    v_mfma_f32_16x16x32_bf16 v[20:23], a[88:91], v[72:75], v[20:23]
    v_exp_f32 v31, v31
    v_mfma_f32_16x16x32_bf16 v[20:23], a[92:95], v[76:79], v[20:23]
    s_waitcnt lgkmcnt(4)
    v_mfma_f32_16x16x32_bf16 v[24:27], a[96:99], v[64:67], v[48:51]
    s_sub_u32 s48, 0, s48
    v_exp_f32 v16, v16
    v_mfma_f32_16x16x32_bf16 v[24:27], a[100:103], v[68:71], v[24:27]
    v_perm_b32 v47, v31, v30, s100
    v_mfma_f32_16x16x32_bf16 v[24:27], a[104:107], v[72:75], v[24:27]
    v_exp_f32 v17, v17
    v_mfma_f32_16x16x32_bf16 v[24:27], a[108:111], v[76:79], v[24:27]
    s_waitcnt lgkmcnt(0)
    v_mfma_f32_16x16x32_bf16 v[28:31], a[112:115], v[64:67], v[48:51]
    v_exp_f32 v18, v18
    v_mfma_f32_16x16x32_bf16 v[28:31], a[116:119], v[68:71], v[28:31]
    v_perm_b32 v32, v17, v16, s100
    v_mfma_f32_16x16x32_bf16 v[28:31], a[120:123], v[72:75], v[28:31]
    v_exp_f32 v19, v19
    v_mfma_f32_16x16x32_bf16 v[28:31], a[124:127], v[76:79], v[28:31]
    s_waitcnt vmcnt(7)
    s_barrier
    v_mfma_f32_16x16x32_bf16 v[224:227], a[128:131], v[40:43], v[224:227]
    v_exp_f32 v20, v20
    v_mfma_f32_16x16x32_bf16 v[224:227], a[132:135], v[44:47], v[224:227]
    ds_read_b64_tr_b16 a[128:129], v2 offset:0
    v_perm_b32 v33, v19, v18, s100
    v_mfma_f32_16x16x32_bf16 v[228:231], a[136:139], v[40:43], v[228:231]
    s_add_u32 m0, s44, 73728
    v_exp_f32 v21, v21
    v_mfma_f32_16x16x32_bf16 v[228:231], a[140:143], v[44:47], v[228:231]
    s_mov_b32 s45, 0
    buffer_load_dwordx4 v7, s[28:31], s45 offen offset:0 lds
    v_mfma_f32_16x16x32_bf16 v[232:235], a[144:147], v[40:43], v[232:235]
    v_exp_f32 v22, v22
    v_mfma_f32_16x16x32_bf16 v[232:235], a[148:151], v[44:47], v[232:235]
    ds_read_b64_tr_b16 a[130:131], v2 offset:256
    v_perm_b32 v34, v21, v20, s100
    v_mfma_f32_16x16x32_bf16 v[236:239], a[152:155], v[40:43], v[236:239]
    s_add_u32 m0, s44, 73632
    v_exp_f32 v23, v23
    v_mfma_f32_16x16x32_bf16 v[236:239], a[156:159], v[44:47], v[236:239]
    buffer_load_dwordx4 v7, s[28:31], s45 offen offset:1152 lds
    v_mfma_f32_16x16x32_bf16 v[240:243], a[160:163], v[40:43], v[240:243]
    v_exp_f32 v24, v24
    v_mfma_f32_16x16x32_bf16 v[240:243], a[164:167], v[44:47], v[240:243]
    ds_read_b64_tr_b16 a[132:133], v2 offset:512
    v_perm_b32 v35, v23, v22, s100
    v_mfma_f32_16x16x32_bf16 v[244:247], a[168:171], v[40:43], v[244:247]
    s_add_u32 m0, s44, 73536
    v_exp_f32 v25, v25
    v_mfma_f32_16x16x32_bf16 v[244:247], a[172:175], v[44:47], v[244:247]
    buffer_load_dwordx4 v7, s[28:31], s45 offen offset:2304 lds
    v_mfma_f32_16x16x32_bf16 v[248:251], a[176:179], v[40:43], v[248:251]
    v_exp_f32 v26, v26
    v_mfma_f32_16x16x32_bf16 v[248:251], a[180:183], v[44:47], v[248:251]
    ds_read_b64_tr_b16 a[134:135], v2 offset:768
    v_perm_b32 v36, v25, v24, s100
    v_mfma_f32_16x16x32_bf16 v[252:255], a[184:187], v[40:43], v[252:255]
    s_add_u32 m0, s44, 73440
    v_exp_f32 v27, v27
    v_mfma_f32_16x16x32_bf16 v[252:255], a[188:191], v[44:47], v[252:255]
    buffer_load_dwordx4 v7, s[28:31], s45 offen offset:3456 lds
    v_smfmac_f32_16x16x64_bf16 a[12:15], a[16:19], v[40:47], v11
    ds_read_b64_tr_b16 a[136:137], v2 offset:32
    v_mfma_f32_16x16x32_bf16 v[16:19], a[64:67], v[80:83], v[52:55]
    v_exp_f32 v28, v28
    v_mfma_f32_16x16x32_bf16 v[16:19], a[68:71], v[84:87], v[16:19]
    ds_read_b64_tr_b16 a[138:139], v2 offset:288
    v_perm_b32 v37, v27, v26, s100
    v_mfma_f32_16x16x32_bf16 v[16:19], a[72:75], v[88:91], v[16:19]
    s_add_u32 m0, s44, 90624
    v_exp_f32 v29, v29
    v_mfma_f32_16x16x32_bf16 v[16:19], a[76:79], v[92:95], v[16:19]
    s_mov_b32 s45, 147456
    buffer_load_dwordx4 v7, s[28:31], s45 offen offset:0 lds
    v_mfma_f32_16x16x32_bf16 v[20:23], a[80:83], v[80:83], v[52:55]
    v_exp_f32 v30, v30
    v_mfma_f32_16x16x32_bf16 v[20:23], a[84:87], v[84:87], v[20:23]
    ds_read_b64_tr_b16 a[140:141], v2 offset:544
    v_perm_b32 v38, v29, v28, s100
    v_mfma_f32_16x16x32_bf16 v[20:23], a[88:91], v[88:91], v[20:23]
    s_add_u32 m0, s44, 90528
    v_exp_f32 v31, v31
    v_mfma_f32_16x16x32_bf16 v[20:23], a[92:95], v[92:95], v[20:23]
    buffer_load_dwordx4 v7, s[28:31], s45 offen offset:1152 lds
    v_mfma_f32_16x16x32_bf16 v[24:27], a[96:99], v[80:83], v[52:55]
    v_exp_f32 v16, v16
    v_mfma_f32_16x16x32_bf16 v[24:27], a[100:103], v[84:87], v[24:27]
    ds_read_b64_tr_b16 a[142:143], v2 offset:800
    v_perm_b32 v39, v31, v30, s100
    v_mfma_f32_16x16x32_bf16 v[24:27], a[104:107], v[88:91], v[24:27]
    s_add_u32 m0, s44, 90432
    v_exp_f32 v17, v17
    v_mfma_f32_16x16x32_bf16 v[24:27], a[108:111], v[92:95], v[24:27]
    buffer_load_dwordx4 v7, s[28:31], s45 offen offset:2304 lds
    v_mfma_f32_16x16x32_bf16 v[28:31], a[112:115], v[80:83], v[52:55]
    v_exp_f32 v18, v18
    v_mfma_f32_16x16x32_bf16 v[28:31], a[116:119], v[84:87], v[28:31]
    ds_read_b64_tr_b16 a[144:145], v2 offset:64
    v_perm_b32 v40, v17, v16, s100
    v_mfma_f32_16x16x32_bf16 v[28:31], a[120:123], v[88:91], v[28:31]
    s_add_u32 m0, s44, 90336
    v_exp_f32 v19, v19
    v_mfma_f32_16x16x32_bf16 v[28:31], a[124:127], v[92:95], v[28:31]
    buffer_load_dwordx4 v7, s[28:31], s45 offen offset:3456 lds
    v_mfma_f32_16x16x32_bf16 v[128:131], a[192:195], v[32:35], v[128:131]
    v_exp_f32 v20, v20
    v_mfma_f32_16x16x32_bf16 v[128:131], a[196:199], v[36:39], v[128:131]
    ds_read_b64_tr_b16 a[146:147], v2 offset:320
    v_perm_b32 v41, v19, v18, s100
    v_mfma_f32_16x16x32_bf16 v[132:135], a[200:203], v[32:35], v[132:135]
    v_exp_f32 v21, v21
    v_mfma_f32_16x16x32_bf16 v[132:135], a[204:207], v[36:39], v[132:135]
    ds_read_b64_tr_b16 a[148:149], v2 offset:576
    v_mfma_f32_16x16x32_bf16 v[136:139], a[208:211], v[32:35], v[136:139]
    v_exp_f32 v22, v22
    v_mfma_f32_16x16x32_bf16 v[136:139], a[212:215], v[36:39], v[136:139]
    ds_read_b64_tr_b16 a[150:151], v2 offset:832
    v_perm_b32 v42, v21, v20, s100
    v_mfma_f32_16x16x32_bf16 v[140:143], a[216:219], v[32:35], v[140:143]
    v_exp_f32 v23, v23
    v_mfma_f32_16x16x32_bf16 v[140:143], a[220:223], v[36:39], v[140:143]
    ds_read_b64_tr_b16 a[152:153], v2 offset:96
    ds_read_b64_tr_b16 a[154:155], v2 offset:352
    v_mfma_f32_16x16x32_bf16 v[144:147], a[224:227], v[32:35], v[144:147]
    v_exp_f32 v24, v24
    v_mfma_f32_16x16x32_bf16 v[144:147], a[228:231], v[36:39], v[144:147]
    ds_read_b64_tr_b16 a[156:157], v2 offset:608
    v_perm_b32 v43, v23, v22, s100
    v_mfma_f32_16x16x32_bf16 v[148:151], a[232:235], v[32:35], v[148:151]
    v_exp_f32 v25, v25
    v_mfma_f32_16x16x32_bf16 v[148:151], a[236:239], v[36:39], v[148:151]
    ds_read_b64_tr_b16 a[158:159], v2 offset:864
    ds_read_b64_tr_b16 a[160:161], v2 offset:128
    v_mfma_f32_16x16x32_bf16 v[152:155], a[240:243], v[32:35], v[152:155]
    v_exp_f32 v26, v26
    v_mfma_f32_16x16x32_bf16 v[152:155], a[244:247], v[36:39], v[152:155]
    ds_read_b64_tr_b16 a[162:163], v2 offset:384
    v_perm_b32 v44, v25, v24, s100
    v_mfma_f32_16x16x32_bf16 v[156:159], a[248:251], v[32:35], v[156:159]
    v_exp_f32 v27, v27
    v_mfma_f32_16x16x32_bf16 v[156:159], a[252:255], v[36:39], v[156:159]
    ds_read_b64_tr_b16 a[164:165], v2 offset:640
    ds_read_b64_tr_b16 a[166:167], v2 offset:896
    v_smfmac_f32_16x16x64_bf16 a[0:3], a[16:19], v[32:39], v11
    ds_read_b64_tr_b16 a[168:169], v2 offset:160
    ds_read_b64_tr_b16 a[170:171], v2 offset:416
    v_mfma_f32_16x16x32_bf16 v[16:19], a[64:67], v[96:99], v[56:59]
    v_exp_f32 v28, v28
    v_mfma_f32_16x16x32_bf16 v[16:19], a[68:71], v[100:103], v[16:19]
    ds_read_b64_tr_b16 a[172:173], v2 offset:672
    v_perm_b32 v45, v27, v26, s100
    v_mfma_f32_16x16x32_bf16 v[16:19], a[72:75], v[104:107], v[16:19]
    s_add_u32 m0, s44, 110592
    v_exp_f32 v29, v29
    v_mfma_f32_16x16x32_bf16 v[16:19], a[76:79], v[108:111], v[16:19]
    s_mov_b32 s45, 128
    buffer_load_dwordx4 v7, s[28:31], s45 offen offset:0 lds
    v_mfma_f32_16x16x32_bf16 v[20:23], a[80:83], v[96:99], v[56:59]
    v_exp_f32 v30, v30
    v_mfma_f32_16x16x32_bf16 v[20:23], a[84:87], v[100:103], v[20:23]
    ds_read_b64_tr_b16 a[174:175], v2 offset:928
    v_perm_b32 v46, v29, v28, s100
    v_mfma_f32_16x16x32_bf16 v[20:23], a[88:91], v[104:107], v[20:23]
    s_add_u32 m0, s44, 110496
    v_exp_f32 v31, v31
    v_mfma_f32_16x16x32_bf16 v[20:23], a[92:95], v[108:111], v[20:23]
    buffer_load_dwordx4 v7, s[28:31], s45 offen offset:1152 lds
    v_mfma_f32_16x16x32_bf16 v[24:27], a[96:99], v[96:99], v[56:59]
    v_exp_f32 v16, v16
    v_mfma_f32_16x16x32_bf16 v[24:27], a[100:103], v[100:103], v[24:27]
    ds_read_b64_tr_b16 a[176:177], v2 offset:192
    v_perm_b32 v47, v31, v30, s100
    v_mfma_f32_16x16x32_bf16 v[24:27], a[104:107], v[104:107], v[24:27]
    s_add_u32 m0, s44, 110400
    v_exp_f32 v17, v17
    v_mfma_f32_16x16x32_bf16 v[24:27], a[108:111], v[108:111], v[24:27]
    buffer_load_dwordx4 v7, s[28:31], s45 offen offset:2304 lds
    v_mfma_f32_16x16x32_bf16 v[28:31], a[112:115], v[96:99], v[56:59]
    v_exp_f32 v18, v18
    v_mfma_f32_16x16x32_bf16 v[28:31], a[116:119], v[100:103], v[28:31]
    ds_read_b64_tr_b16 a[178:179], v2 offset:448
    v_perm_b32 v32, v17, v16, s100
    v_mfma_f32_16x16x32_bf16 v[28:31], a[120:123], v[104:107], v[28:31]
    s_add_u32 m0, s44, 110304
    v_exp_f32 v19, v19
    v_mfma_f32_16x16x32_bf16 v[28:31], a[124:127], v[108:111], v[28:31]
    buffer_load_dwordx4 v7, s[28:31], s45 offen offset:3456 lds
    v_mfma_f32_16x16x32_bf16 v[160:163], a[192:195], v[40:43], v[160:163]
    v_exp_f32 v20, v20
    v_mfma_f32_16x16x32_bf16 v[160:163], a[196:199], v[44:47], v[160:163]
    ds_read_b64_tr_b16 a[180:181], v2 offset:704
    v_perm_b32 v33, v19, v18, s100
    v_mfma_f32_16x16x32_bf16 v[164:167], a[200:203], v[40:43], v[164:167]
    s_add_u32 m0, s44, 127488
    v_exp_f32 v21, v21
    v_mfma_f32_16x16x32_bf16 v[164:167], a[204:207], v[44:47], v[164:167]
    s_mov_b32 s45, 147584
    buffer_load_dwordx4 v7, s[28:31], s45 offen offset:0 lds
    v_mfma_f32_16x16x32_bf16 v[168:171], a[208:211], v[40:43], v[168:171]
    v_exp_f32 v22, v22
    v_mfma_f32_16x16x32_bf16 v[168:171], a[212:215], v[44:47], v[168:171]
    ds_read_b64_tr_b16 a[182:183], v2 offset:960
    v_perm_b32 v34, v21, v20, s100
    v_mfma_f32_16x16x32_bf16 v[172:175], a[216:219], v[40:43], v[172:175]
    s_add_u32 m0, s44, 127392
    v_exp_f32 v23, v23
    v_mfma_f32_16x16x32_bf16 v[172:175], a[220:223], v[44:47], v[172:175]
    buffer_load_dwordx4 v7, s[28:31], s45 offen offset:1152 lds
    v_mfma_f32_16x16x32_bf16 v[176:179], a[224:227], v[40:43], v[176:179]
    v_exp_f32 v24, v24
    v_mfma_f32_16x16x32_bf16 v[176:179], a[228:231], v[44:47], v[176:179]
    ds_read_b64_tr_b16 a[184:185], v2 offset:224
    v_perm_b32 v35, v23, v22, s100
    v_mfma_f32_16x16x32_bf16 v[180:183], a[232:235], v[40:43], v[180:183]
    s_add_u32 m0, s44, 127296
    v_exp_f32 v25, v25
    v_mfma_f32_16x16x32_bf16 v[180:183], a[236:239], v[44:47], v[180:183]
    buffer_load_dwordx4 v7, s[28:31], s45 offen offset:2304 lds
    v_mfma_f32_16x16x32_bf16 v[184:187], a[240:243], v[40:43], v[184:187]
    v_exp_f32 v26, v26
    v_mfma_f32_16x16x32_bf16 v[184:187], a[244:247], v[44:47], v[184:187]
    ds_read_b64_tr_b16 a[186:187], v2 offset:480
    v_perm_b32 v36, v25, v24, s100
    v_mfma_f32_16x16x32_bf16 v[188:191], a[248:251], v[40:43], v[188:191]
    s_add_u32 m0, s44, 127200
    v_exp_f32 v27, v27
    v_mfma_f32_16x16x32_bf16 v[188:191], a[252:255], v[44:47], v[188:191]
    buffer_load_dwordx4 v7, s[28:31], s45 offen offset:3456 lds
    v_smfmac_f32_16x16x64_bf16 a[4:7], a[16:19], v[40:47], v11
    ds_read_b64_tr_b16 a[188:189], v2 offset:736
    ds_read_b64_tr_b16 a[190:191], v2 offset:992
    v_mfma_f32_16x16x32_bf16 v[16:19], a[64:67], v[112:115], v[60:63]
    v_exp_f32 v28, v28
    v_mfma_f32_16x16x32_bf16 v[16:19], a[68:71], v[116:119], v[16:19]
    ds_read_b128 a[64:67], v1 offset:0
    v_perm_b32 v37, v27, v26, s100
    v_mfma_f32_16x16x32_bf16 v[16:19], a[72:75], v[120:123], v[16:19]
    v_exp_f32 v29, v29
    v_mfma_f32_16x16x32_bf16 v[16:19], a[76:79], v[124:127], v[16:19]
    ds_read_b128 a[68:71], v1 offset:64
    v_mfma_f32_16x16x32_bf16 v[20:23], a[80:83], v[112:115], v[60:63]
    v_exp_f32 v30, v30
    v_mfma_f32_16x16x32_bf16 v[20:23], a[84:87], v[116:119], v[20:23]
    ds_read_b128 a[72:75], v1 offset:128
    v_perm_b32 v38, v29, v28, s100
    v_mfma_f32_16x16x32_bf16 v[20:23], a[88:91], v[120:123], v[20:23]
    v_exp_f32 v31, v31
    v_mfma_f32_16x16x32_bf16 v[20:23], a[92:95], v[124:127], v[20:23]
    ds_read_b128 a[76:79], v1 offset:192
    v_mfma_f32_16x16x32_bf16 v[24:27], a[96:99], v[112:115], v[60:63]
    v_exp_f32 v16, v16
    v_mfma_f32_16x16x32_bf16 v[24:27], a[100:103], v[116:119], v[24:27]
    ds_read_b128 a[80:83], v1 offset:256
    v_perm_b32 v39, v31, v30, s100
    v_mfma_f32_16x16x32_bf16 v[24:27], a[104:107], v[120:123], v[24:27]
    v_exp_f32 v17, v17
    v_mfma_f32_16x16x32_bf16 v[24:27], a[108:111], v[124:127], v[24:27]
    ds_read_b128 a[84:87], v1 offset:320
    v_mfma_f32_16x16x32_bf16 v[28:31], a[112:115], v[112:115], v[60:63]
    v_exp_f32 v18, v18
    v_mfma_f32_16x16x32_bf16 v[28:31], a[116:119], v[116:119], v[28:31]
    ds_read_b128 a[88:91], v1 offset:384
    v_perm_b32 v40, v17, v16, s100
    v_mfma_f32_16x16x32_bf16 v[28:31], a[120:123], v[120:123], v[28:31]
    v_exp_f32 v19, v19
    v_mfma_f32_16x16x32_bf16 v[28:31], a[124:127], v[124:127], v[28:31]
    ds_read_b128 a[92:95], v1 offset:448
    v_mfma_f32_16x16x32_bf16 v[192:195], a[192:195], v[32:35], v[192:195]
    v_exp_f32 v20, v20
    v_mfma_f32_16x16x32_bf16 v[192:195], a[196:199], v[36:39], v[192:195]
    ds_read_b128 a[96:99], v1 offset:512
    v_perm_b32 v41, v19, v18, s100
    v_mfma_f32_16x16x32_bf16 v[196:199], a[200:203], v[32:35], v[196:199]
    v_exp_f32 v21, v21
    v_mfma_f32_16x16x32_bf16 v[196:199], a[204:207], v[36:39], v[196:199]
    ds_read_b128 a[100:103], v1 offset:576
    v_mfma_f32_16x16x32_bf16 v[200:203], a[208:211], v[32:35], v[200:203]
    v_exp_f32 v22, v22
    v_mfma_f32_16x16x32_bf16 v[200:203], a[212:215], v[36:39], v[200:203]
    ds_read_b128 a[104:107], v1 offset:640
    v_perm_b32 v42, v21, v20, s100
    v_mfma_f32_16x16x32_bf16 v[204:207], a[216:219], v[32:35], v[204:207]
    v_exp_f32 v23, v23
    v_mfma_f32_16x16x32_bf16 v[204:207], a[220:223], v[36:39], v[204:207]
    ds_read_b128 a[108:111], v1 offset:704
    v_mfma_f32_16x16x32_bf16 v[208:211], a[224:227], v[32:35], v[208:211]
    v_exp_f32 v24, v24
    v_mfma_f32_16x16x32_bf16 v[208:211], a[228:231], v[36:39], v[208:211]
    ds_read_b128 a[112:115], v1 offset:768
    v_perm_b32 v43, v23, v22, s100
    v_mfma_f32_16x16x32_bf16 v[212:215], a[232:235], v[32:35], v[212:215]
    v_exp_f32 v25, v25
    v_mfma_f32_16x16x32_bf16 v[212:215], a[236:239], v[36:39], v[212:215]
    ds_read_b128 a[116:119], v1 offset:832
    v_mfma_f32_16x16x32_bf16 v[216:219], a[240:243], v[32:35], v[216:219]
    v_exp_f32 v26, v26
    v_mfma_f32_16x16x32_bf16 v[216:219], a[244:247], v[36:39], v[216:219]
    ds_read_b128 a[120:123], v1 offset:896
    v_perm_b32 v44, v25, v24, s100
    v_mfma_f32_16x16x32_bf16 v[220:223], a[248:251], v[32:35], v[220:223]
    v_exp_f32 v27, v27
    v_mfma_f32_16x16x32_bf16 v[220:223], a[252:255], v[36:39], v[220:223]
    ds_read_b128 a[124:127], v1 offset:960
    v_smfmac_f32_16x16x64_bf16 a[8:11], a[16:19], v[32:39], v11
    s_waitcnt lgkmcnt(12)
    v_mfma_f32_16x16x32_bf16 v[16:19], a[64:67], v[64:67], v[48:51]
    v_exp_f32 v28, v28
    v_mfma_f32_16x16x32_bf16 v[16:19], a[68:71], v[68:71], v[16:19]
    v_perm_b32 v45, v27, v26, s100
    v_mfma_f32_16x16x32_bf16 v[16:19], a[72:75], v[72:75], v[16:19]
    s_mov_b32 s54, 737280
    v_exp_f32 v29, v29
    v_mfma_f32_16x16x32_bf16 v[16:19], a[76:79], v[76:79], v[16:19]
    s_waitcnt lgkmcnt(8)
    buffer_load_dwordx4 a[40:43], v6, s[64:67], s54 offen
    v_mfma_f32_16x16x32_bf16 v[20:23], a[80:83], v[64:67], v[48:51]
    v_exp_f32 v30, v30
    v_mfma_f32_16x16x32_bf16 v[20:23], a[84:87], v[68:71], v[20:23]
    v_perm_b32 v46, v29, v28, s100
    v_mfma_f32_16x16x32_bf16 v[20:23], a[88:91], v[72:75], v[20:23]
    v_exp_f32 v31, v31
    v_mfma_f32_16x16x32_bf16 v[20:23], a[92:95], v[76:79], v[20:23]
    s_waitcnt lgkmcnt(4)
    v_mfma_f32_16x16x32_bf16 v[24:27], a[96:99], v[64:67], v[48:51]
    v_exp_f32 v16, v16
    v_mfma_f32_16x16x32_bf16 v[24:27], a[100:103], v[68:71], v[24:27]
    v_perm_b32 v47, v31, v30, s100
    v_mfma_f32_16x16x32_bf16 v[24:27], a[104:107], v[72:75], v[24:27]
    s_mov_b32 s54, 884736
    v_exp_f32 v17, v17
    v_mfma_f32_16x16x32_bf16 v[24:27], a[108:111], v[76:79], v[24:27]
    s_waitcnt lgkmcnt(0)
    buffer_load_dwordx4 a[44:47], v6, s[64:67], s54 offen
    v_mfma_f32_16x16x32_bf16 v[28:31], a[112:115], v[64:67], v[48:51]
    v_exp_f32 v18, v18
    v_mfma_f32_16x16x32_bf16 v[28:31], a[116:119], v[68:71], v[28:31]
    v_perm_b32 v32, v17, v16, s100
    v_mfma_f32_16x16x32_bf16 v[28:31], a[120:123], v[72:75], v[28:31]
    v_exp_f32 v19, v19
    v_mfma_f32_16x16x32_bf16 v[28:31], a[124:127], v[76:79], v[28:31]
    v_mfma_f32_16x16x32_bf16 v[224:227], a[192:195], v[40:43], v[224:227]
    v_exp_f32 v20, v20
    v_mfma_f32_16x16x32_bf16 v[224:227], a[196:199], v[44:47], v[224:227]
    ds_read_b64_tr_b16 a[192:193], v2 offset:36864
    v_perm_b32 v33, v19, v18, s100
    v_mfma_f32_16x16x32_bf16 v[228:231], a[200:203], v[40:43], v[228:231]
    s_mov_b32 s54, 1032192
    v_exp_f32 v21, v21
    v_mfma_f32_16x16x32_bf16 v[228:231], a[204:207], v[44:47], v[228:231]
    buffer_load_dwordx4 a[48:51], v6, s[64:67], s54 offen
    v_mfma_f32_16x16x32_bf16 v[232:235], a[208:211], v[40:43], v[232:235]
    v_exp_f32 v22, v22
    v_mfma_f32_16x16x32_bf16 v[232:235], a[212:215], v[44:47], v[232:235]
    ds_read_b64_tr_b16 a[194:195], v2 offset:37120
    v_perm_b32 v34, v21, v20, s100
    v_mfma_f32_16x16x32_bf16 v[236:239], a[216:219], v[40:43], v[236:239]
    v_exp_f32 v23, v23
    v_mfma_f32_16x16x32_bf16 v[236:239], a[220:223], v[44:47], v[236:239]
    ds_read_b64_tr_b16 a[196:197], v2 offset:37376
    v_mfma_f32_16x16x32_bf16 v[240:243], a[224:227], v[40:43], v[240:243]
    v_exp_f32 v24, v24
    v_mfma_f32_16x16x32_bf16 v[240:243], a[228:231], v[44:47], v[240:243]
    ds_read_b64_tr_b16 a[198:199], v2 offset:37632
    v_perm_b32 v35, v23, v22, s100
    v_mfma_f32_16x16x32_bf16 v[244:247], a[232:235], v[40:43], v[244:247]
    s_mov_b32 s54, 1179648
    v_exp_f32 v25, v25
    v_mfma_f32_16x16x32_bf16 v[244:247], a[236:239], v[44:47], v[244:247]
    buffer_load_dwordx4 a[52:55], v6, s[64:67], s54 offen
    v_mfma_f32_16x16x32_bf16 v[248:251], a[240:243], v[40:43], v[248:251]
    v_exp_f32 v26, v26
    v_mfma_f32_16x16x32_bf16 v[248:251], a[244:247], v[44:47], v[248:251]
    ds_read_b64_tr_b16 a[200:201], v2 offset:36896
    v_perm_b32 v36, v25, v24, s100
    v_mfma_f32_16x16x32_bf16 v[252:255], a[248:251], v[40:43], v[252:255]
    v_exp_f32 v27, v27
    v_mfma_f32_16x16x32_bf16 v[252:255], a[252:255], v[44:47], v[252:255]
    ds_read_b64_tr_b16 a[202:203], v2 offset:37152
    v_smfmac_f32_16x16x64_bf16 a[12:15], a[16:19], v[40:47], v11
    ds_read_b64_tr_b16 a[204:205], v2 offset:37408
    v_mfma_f32_16x16x32_bf16 v[16:19], a[64:67], v[80:83], v[52:55]
    v_exp_f32 v28, v28
    v_mfma_f32_16x16x32_bf16 v[16:19], a[68:71], v[84:87], v[16:19]
    ds_read_b64_tr_b16 a[206:207], v2 offset:37664
    v_perm_b32 v37, v27, v26, s100
    v_mfma_f32_16x16x32_bf16 v[16:19], a[72:75], v[88:91], v[16:19]
    v_exp_f32 v29, v29
    v_mfma_f32_16x16x32_bf16 v[16:19], a[76:79], v[92:95], v[16:19]
    buffer_store_dwordx4 a[56:59], v5, s[32:35], 0 offen offset:0 sc1
    v_mfma_f32_16x16x32_bf16 v[20:23], a[80:83], v[80:83], v[52:55]
    v_exp_f32 v30, v30
    v_mfma_f32_16x16x32_bf16 v[20:23], a[84:87], v[84:87], v[20:23]
    ds_read_b64_tr_b16 a[208:209], v2 offset:36928
    v_perm_b32 v38, v29, v28, s100
    v_mfma_f32_16x16x32_bf16 v[20:23], a[88:91], v[88:91], v[20:23]
    v_exp_f32 v31, v31
    v_mfma_f32_16x16x32_bf16 v[20:23], a[92:95], v[92:95], v[20:23]
    ds_read_b64_tr_b16 a[210:211], v2 offset:37184
    v_mfma_f32_16x16x32_bf16 v[24:27], a[96:99], v[80:83], v[52:55]
    v_exp_f32 v16, v16
    v_mfma_f32_16x16x32_bf16 v[24:27], a[100:103], v[84:87], v[24:27]
    ds_read_b64_tr_b16 a[212:213], v2 offset:37440
    v_perm_b32 v39, v31, v30, s100
    v_mfma_f32_16x16x32_bf16 v[24:27], a[104:107], v[88:91], v[24:27]
    v_exp_f32 v17, v17
    v_mfma_f32_16x16x32_bf16 v[24:27], a[108:111], v[92:95], v[24:27]
    buffer_store_dwordx4 a[56:59], v5, s[32:35], 0 offen offset:1024 sc1
    v_mfma_f32_16x16x32_bf16 v[28:31], a[112:115], v[80:83], v[52:55]
    v_exp_f32 v18, v18
    v_mfma_f32_16x16x32_bf16 v[28:31], a[116:119], v[84:87], v[28:31]
    ds_read_b64_tr_b16 a[214:215], v2 offset:37696
    v_perm_b32 v40, v17, v16, s100
    v_mfma_f32_16x16x32_bf16 v[28:31], a[120:123], v[88:91], v[28:31]
    v_exp_f32 v19, v19
    v_mfma_f32_16x16x32_bf16 v[28:31], a[124:127], v[92:95], v[28:31]
    ds_read_b64_tr_b16 a[216:217], v2 offset:36960
    v_mfma_f32_16x16x32_bf16 v[128:131], a[128:131], v[32:35], v[128:131]
    v_exp_f32 v20, v20
    v_mfma_f32_16x16x32_bf16 v[128:131], a[132:135], v[36:39], v[128:131]
    ds_read_b64_tr_b16 a[218:219], v2 offset:37216
    v_perm_b32 v41, v19, v18, s100
    v_mfma_f32_16x16x32_bf16 v[132:135], a[136:139], v[32:35], v[132:135]
    v_exp_f32 v21, v21
    v_mfma_f32_16x16x32_bf16 v[132:135], a[140:143], v[36:39], v[132:135]
    buffer_store_dwordx4 a[56:59], v5, s[32:35], 0 offen offset:2048 sc1
    v_mfma_f32_16x16x32_bf16 v[136:139], a[144:147], v[32:35], v[136:139]
    v_exp_f32 v22, v22
    v_mfma_f32_16x16x32_bf16 v[136:139], a[148:151], v[36:39], v[136:139]
    ds_read_b64_tr_b16 a[220:221], v2 offset:37472
    v_perm_b32 v42, v21, v20, s100
    v_mfma_f32_16x16x32_bf16 v[140:143], a[152:155], v[32:35], v[140:143]
    v_exp_f32 v23, v23
    v_mfma_f32_16x16x32_bf16 v[140:143], a[156:159], v[36:39], v[140:143]
    ds_read_b64_tr_b16 a[222:223], v2 offset:37728
    v_mfma_f32_16x16x32_bf16 v[144:147], a[160:163], v[32:35], v[144:147]
    v_exp_f32 v24, v24
    v_mfma_f32_16x16x32_bf16 v[144:147], a[164:167], v[36:39], v[144:147]
    ds_read_b64_tr_b16 a[224:225], v2 offset:36992
    v_perm_b32 v43, v23, v22, s100
    v_mfma_f32_16x16x32_bf16 v[148:151], a[168:171], v[32:35], v[148:151]
    v_exp_f32 v25, v25
    v_mfma_f32_16x16x32_bf16 v[148:151], a[172:175], v[36:39], v[148:151]
    buffer_store_dwordx4 a[56:59], v5, s[32:35], 0 offen offset:3072 sc1
    v_mfma_f32_16x16x32_bf16 v[152:155], a[176:179], v[32:35], v[152:155]
    v_exp_f32 v26, v26
    v_mfma_f32_16x16x32_bf16 v[152:155], a[180:183], v[36:39], v[152:155]
    ds_read_b64_tr_b16 a[226:227], v2 offset:37248
    v_perm_b32 v44, v25, v24, s100
    v_mfma_f32_16x16x32_bf16 v[156:159], a[184:187], v[32:35], v[156:159]
    v_exp_f32 v27, v27
    v_mfma_f32_16x16x32_bf16 v[156:159], a[188:191], v[36:39], v[156:159]
    ds_read_b64_tr_b16 a[228:229], v2 offset:37504
    v_smfmac_f32_16x16x64_bf16 a[0:3], a[16:19], v[32:39], v11
    ds_read_b64_tr_b16 a[230:231], v2 offset:37760
    v_mfma_f32_16x16x32_bf16 v[16:19], a[64:67], v[96:99], v[56:59]
    v_exp_f32 v28, v28
    v_mfma_f32_16x16x32_bf16 v[16:19], a[68:71], v[100:103], v[16:19]
    ds_read_b64_tr_b16 a[232:233], v2 offset:37024
    v_perm_b32 v45, v27, v26, s100
    v_mfma_f32_16x16x32_bf16 v[16:19], a[72:75], v[104:107], v[16:19]
    v_exp_f32 v29, v29
    v_mfma_f32_16x16x32_bf16 v[16:19], a[76:79], v[108:111], v[16:19]
    ds_read_b64_tr_b16 a[234:235], v2 offset:37280
    v_mfma_f32_16x16x32_bf16 v[20:23], a[80:83], v[96:99], v[56:59]
    v_exp_f32 v30, v30
    v_mfma_f32_16x16x32_bf16 v[20:23], a[84:87], v[100:103], v[20:23]
    ds_read_b64_tr_b16 a[236:237], v2 offset:37536
    v_perm_b32 v46, v29, v28, s100
    v_mfma_f32_16x16x32_bf16 v[20:23], a[88:91], v[104:107], v[20:23]
    v_exp_f32 v31, v31
    v_mfma_f32_16x16x32_bf16 v[20:23], a[92:95], v[108:111], v[20:23]
    ds_read_b64_tr_b16 a[238:239], v2 offset:37792
    v_mfma_f32_16x16x32_bf16 v[24:27], a[96:99], v[96:99], v[56:59]
    v_exp_f32 v16, v16
    v_mfma_f32_16x16x32_bf16 v[24:27], a[100:103], v[100:103], v[24:27]
    ds_read_b64_tr_b16 a[240:241], v2 offset:37056
    v_perm_b32 v47, v31, v30, s100
    v_mfma_f32_16x16x32_bf16 v[24:27], a[104:107], v[104:107], v[24:27]
    v_exp_f32 v17, v17
    v_mfma_f32_16x16x32_bf16 v[24:27], a[108:111], v[108:111], v[24:27]
    ds_read_b64_tr_b16 a[242:243], v2 offset:37312
    v_mfma_f32_16x16x32_bf16 v[28:31], a[112:115], v[96:99], v[56:59]
    v_exp_f32 v18, v18
    v_mfma_f32_16x16x32_bf16 v[28:31], a[116:119], v[100:103], v[28:31]
    ds_read_b64_tr_b16 a[244:245], v2 offset:37568
    v_perm_b32 v32, v17, v16, s100
    v_mfma_f32_16x16x32_bf16 v[28:31], a[120:123], v[104:107], v[28:31]
    v_exp_f32 v19, v19
    v_mfma_f32_16x16x32_bf16 v[28:31], a[124:127], v[108:111], v[28:31]
L2_pad9:
    s_cbranch_execz L2_pad13
    ds_read_b64_tr_b16 a[246:247], v2 offset:37824
    v_mfma_f32_16x16x32_bf16 v[160:163], a[128:131], v[40:43], v[160:163]
    v_exp_f32 v20, v20
    v_mfma_f32_16x16x32_bf16 v[160:163], a[132:135], v[44:47], v[160:163]
    ds_read_b64_tr_b16 a[248:249], v2 offset:37088
    v_perm_b32 v33, v19, v18, s100
    v_mfma_f32_16x16x32_bf16 v[164:167], a[136:139], v[40:43], v[164:167]
    v_exp_f32 v21, v21
    v_mfma_f32_16x16x32_bf16 v[164:167], a[140:143], v[44:47], v[164:167]
    ds_read_b64_tr_b16 a[250:251], v2 offset:37344
    v_mfma_f32_16x16x32_bf16 v[168:171], a[144:147], v[40:43], v[168:171]
    v_exp_f32 v22, v22
    v_mfma_f32_16x16x32_bf16 v[168:171], a[148:151], v[44:47], v[168:171]
    ds_read_b64_tr_b16 a[252:253], v2 offset:37600
    v_perm_b32 v34, v21, v20, s100
    v_mfma_f32_16x16x32_bf16 v[172:175], a[152:155], v[40:43], v[172:175]
    v_exp_f32 v23, v23
    v_mfma_f32_16x16x32_bf16 v[172:175], a[156:159], v[44:47], v[172:175]
    ds_read_b64_tr_b16 a[254:255], v2 offset:37856
    v_mfma_f32_16x16x32_bf16 v[176:179], a[160:163], v[40:43], v[176:179]
    v_exp_f32 v24, v24
    v_mfma_f32_16x16x32_bf16 v[176:179], a[164:167], v[44:47], v[176:179]
    v_perm_b32 v35, v23, v22, s100
    v_mfma_f32_16x16x32_bf16 v[180:183], a[168:171], v[40:43], v[180:183]
    v_exp_f32 v25, v25
    v_mfma_f32_16x16x32_bf16 v[180:183], a[172:175], v[44:47], v[180:183]
    v_mfma_f32_16x16x32_bf16 v[184:187], a[176:179], v[40:43], v[184:187]
    v_exp_f32 v26, v26
    v_mfma_f32_16x16x32_bf16 v[184:187], a[180:183], v[44:47], v[184:187]
    v_perm_b32 v36, v25, v24, s100
    v_mfma_f32_16x16x32_bf16 v[188:191], a[184:187], v[40:43], v[188:191]
    v_exp_f32 v27, v27
    v_mfma_f32_16x16x32_bf16 v[188:191], a[188:191], v[44:47], v[188:191]
    v_smfmac_f32_16x16x64_bf16 a[4:7], a[16:19], v[40:47], v11
    v_mfma_f32_16x16x32_bf16 v[16:19], a[64:67], v[112:115], v[60:63]
    v_exp_f32 v28, v28
    v_mfma_f32_16x16x32_bf16 v[16:19], a[68:71], v[116:119], v[16:19]
    ds_read_b128 a[64:67], v1 offset:36864
    v_perm_b32 v37, v27, v26, s100
    v_mfma_f32_16x16x32_bf16 v[16:19], a[72:75], v[120:123], v[16:19]
    v_exp_f32 v29, v29
    v_mfma_f32_16x16x32_bf16 v[16:19], a[76:79], v[124:127], v[16:19]
    ds_read_b128 a[68:71], v1 offset:36928
    v_mfma_f32_16x16x32_bf16 v[20:23], a[80:83], v[112:115], v[60:63]
    v_exp_f32 v30, v30
    v_mfma_f32_16x16x32_bf16 v[20:23], a[84:87], v[116:119], v[20:23]
    ds_read_b128 a[72:75], v1 offset:36992
    v_perm_b32 v38, v29, v28, s100
    v_mfma_f32_16x16x32_bf16 v[20:23], a[88:91], v[120:123], v[20:23]
    v_exp_f32 v31, v31
    v_mfma_f32_16x16x32_bf16 v[20:23], a[92:95], v[124:127], v[20:23]
    ds_read_b128 a[76:79], v1 offset:37056
    v_mfma_f32_16x16x32_bf16 v[24:27], a[96:99], v[112:115], v[60:63]
    v_exp_f32 v16, v16
    v_mfma_f32_16x16x32_bf16 v[24:27], a[100:103], v[116:119], v[24:27]
    ds_read_b128 a[80:83], v1 offset:37120
    v_perm_b32 v39, v31, v30, s100
    v_mfma_f32_16x16x32_bf16 v[24:27], a[104:107], v[120:123], v[24:27]
    v_exp_f32 v17, v17
    v_mfma_f32_16x16x32_bf16 v[24:27], a[108:111], v[124:127], v[24:27]
    ds_read_b128 a[84:87], v1 offset:37184
    v_mfma_f32_16x16x32_bf16 v[28:31], a[112:115], v[112:115], v[60:63]
    v_exp_f32 v18, v18
    v_mfma_f32_16x16x32_bf16 v[28:31], a[116:119], v[116:119], v[28:31]
    ds_read_b128 a[88:91], v1 offset:37248
    v_perm_b32 v40, v17, v16, s100
    v_mfma_f32_16x16x32_bf16 v[28:31], a[120:123], v[120:123], v[28:31]
    v_exp_f32 v19, v19
    v_mfma_f32_16x16x32_bf16 v[28:31], a[124:127], v[124:127], v[28:31]
    ds_read_b128 a[92:95], v1 offset:37312
    v_mfma_f32_16x16x32_bf16 v[192:195], a[128:131], v[32:35], v[192:195]
    v_exp_f32 v20, v20
    v_mfma_f32_16x16x32_bf16 v[192:195], a[132:135], v[36:39], v[192:195]
    ds_read_b128 a[96:99], v1 offset:37376
    v_perm_b32 v41, v19, v18, s100
    v_mfma_f32_16x16x32_bf16 v[196:199], a[136:139], v[32:35], v[196:199]
    v_exp_f32 v21, v21
    v_mfma_f32_16x16x32_bf16 v[196:199], a[140:143], v[36:39], v[196:199]
    ds_read_b128 a[100:103], v1 offset:37440
    v_mfma_f32_16x16x32_bf16 v[200:203], a[144:147], v[32:35], v[200:203]
    v_exp_f32 v22, v22
    v_mfma_f32_16x16x32_bf16 v[200:203], a[148:151], v[36:39], v[200:203]
    ds_read_b128 a[104:107], v1 offset:37504
    v_perm_b32 v42, v21, v20, s100
    v_mfma_f32_16x16x32_bf16 v[204:207], a[152:155], v[32:35], v[204:207]
    v_exp_f32 v23, v23
    v_mfma_f32_16x16x32_bf16 v[204:207], a[156:159], v[36:39], v[204:207]
    ds_read_b128 a[108:111], v1 offset:37568
    v_mfma_f32_16x16x32_bf16 v[208:211], a[160:163], v[32:35], v[208:211]
    v_exp_f32 v24, v24
    v_mfma_f32_16x16x32_bf16 v[208:211], a[164:167], v[36:39], v[208:211]
    ds_read_b128 a[112:115], v1 offset:37632
    v_perm_b32 v43, v23, v22, s100
    v_mfma_f32_16x16x32_bf16 v[212:215], a[168:171], v[32:35], v[212:215]
    v_exp_f32 v25, v25
    v_mfma_f32_16x16x32_bf16 v[212:215], a[172:175], v[36:39], v[212:215]
    ds_read_b128 a[116:119], v1 offset:37696
    v_mfma_f32_16x16x32_bf16 v[216:219], a[176:179], v[32:35], v[216:219]
    v_exp_f32 v26, v26
    v_mfma_f32_16x16x32_bf16 v[216:219], a[180:183], v[36:39], v[216:219]
    ds_read_b128 a[120:123], v1 offset:37760
    v_perm_b32 v44, v25, v24, s100
    v_mfma_f32_16x16x32_bf16 v[220:223], a[184:187], v[32:35], v[220:223]
    v_exp_f32 v27, v27
    v_mfma_f32_16x16x32_bf16 v[220:223], a[188:191], v[36:39], v[220:223]
    ds_read_b128 a[124:127], v1 offset:37824
    v_smfmac_f32_16x16x64_bf16 a[8:11], a[16:19], v[32:39], v11
    s_waitcnt lgkmcnt(12)
    v_mfma_f32_16x16x32_bf16 v[16:19], a[64:67], v[64:67], v[48:51]
    v_exp_f32 v28, v28
    v_mfma_f32_16x16x32_bf16 v[16:19], a[68:71], v[68:71], v[16:19]
    v_perm_b32 v45, v27, v26, s100
    v_mfma_f32_16x16x32_bf16 v[16:19], a[72:75], v[72:75], v[16:19]
    v_exp_f32 v29, v29
    v_mfma_f32_16x16x32_bf16 v[16:19], a[76:79], v[76:79], v[16:19]
    s_waitcnt lgkmcnt(8)
    v_mfma_f32_16x16x32_bf16 v[20:23], a[80:83], v[64:67], v[48:51]
    v_exp_f32 v30, v30
    v_mfma_f32_16x16x32_bf16 v[20:23], a[84:87], v[68:71], v[20:23]
    v_perm_b32 v46, v29, v28, s100
    v_mfma_f32_16x16x32_bf16 v[20:23], a[88:91], v[72:75], v[20:23]
    v_exp_f32 v31, v31
    v_mfma_f32_16x16x32_bf16 v[20:23], a[92:95], v[76:79], v[20:23]
    s_waitcnt lgkmcnt(4)
    v_mfma_f32_16x16x32_bf16 v[24:27], a[96:99], v[64:67], v[48:51]
    v_exp_f32 v16, v16
    v_mfma_f32_16x16x32_bf16 v[24:27], a[100:103], v[68:71], v[24:27]
    v_perm_b32 v47, v31, v30, s100
    v_mfma_f32_16x16x32_bf16 v[24:27], a[104:107], v[72:75], v[24:27]
    v_exp_f32 v17, v17
    v_mfma_f32_16x16x32_bf16 v[24:27], a[108:111], v[76:79], v[24:27]
    s_waitcnt lgkmcnt(0)
    v_mfma_f32_16x16x32_bf16 v[28:31], a[112:115], v[64:67], v[48:51]
    v_exp_f32 v18, v18
    v_mfma_f32_16x16x32_bf16 v[28:31], a[116:119], v[68:71], v[28:31]
    v_perm_b32 v32, v17, v16, s100
    v_mfma_f32_16x16x32_bf16 v[28:31], a[120:123], v[72:75], v[28:31]
    v_exp_f32 v19, v19
    v_mfma_f32_16x16x32_bf16 v[28:31], a[124:127], v[76:79], v[28:31]
    s_waitcnt vmcnt(8)
    s_barrier
    v_mfma_f32_16x16x32_bf16 v[224:227], a[128:131], v[40:43], v[224:227]
    v_exp_f32 v20, v20
    v_mfma_f32_16x16x32_bf16 v[224:227], a[132:135], v[44:47], v[224:227]
    v_perm_b32 v33, v19, v18, s100
    v_mfma_f32_16x16x32_bf16 v[228:231], a[136:139], v[40:43], v[228:231]
    s_add_u32 m0, s44, 0
    v_exp_f32 v21, v21
    v_mfma_f32_16x16x32_bf16 v[228:231], a[140:143], v[44:47], v[228:231]
    s_mov_b32 s45, 256
    buffer_load_dwordx4 v7, s[28:31], s45 offen offset:0 lds
    v_mfma_f32_16x16x32_bf16 v[232:235], a[144:147], v[40:43], v[232:235]
    v_exp_f32 v22, v22
    v_mfma_f32_16x16x32_bf16 v[232:235], a[148:151], v[44:47], v[232:235]
    v_perm_b32 v34, v21, v20, s100
    v_mfma_f32_16x16x32_bf16 v[236:239], a[152:155], v[40:43], v[236:239]
    s_add_u32 m0, s44, -96
    v_exp_f32 v23, v23
    v_mfma_f32_16x16x32_bf16 v[236:239], a[156:159], v[44:47], v[236:239]
    buffer_load_dwordx4 v7, s[28:31], s45 offen offset:1152 lds
    v_mfma_f32_16x16x32_bf16 v[240:243], a[160:163], v[40:43], v[240:243]
    v_exp_f32 v24, v24
    v_mfma_f32_16x16x32_bf16 v[240:243], a[164:167], v[44:47], v[240:243]
    v_perm_b32 v35, v23, v22, s100
    v_mfma_f32_16x16x32_bf16 v[244:247], a[168:171], v[40:43], v[244:247]
    s_add_u32 m0, s44, -192
    v_exp_f32 v25, v25
    v_mfma_f32_16x16x32_bf16 v[244:247], a[172:175], v[44:47], v[244:247]
    buffer_load_dwordx4 v7, s[28:31], s45 offen offset:2304 lds
    v_mfma_f32_16x16x32_bf16 v[248:251], a[176:179], v[40:43], v[248:251]
    v_exp_f32 v26, v26
    v_mfma_f32_16x16x32_bf16 v[248:251], a[180:183], v[44:47], v[248:251]
    v_perm_b32 v36, v25, v24, s100
    v_mfma_f32_16x16x32_bf16 v[252:255], a[184:187], v[40:43], v[252:255]
    s_add_u32 m0, s44, -288
    v_exp_f32 v27, v27
    v_mfma_f32_16x16x32_bf16 v[252:255], a[188:191], v[44:47], v[252:255]
    buffer_load_dwordx4 v7, s[28:31], s45 offen offset:3456 lds
    v_smfmac_f32_16x16x64_bf16 a[12:15], a[16:19], v[40:47], v11
    v_mfma_f32_16x16x32_bf16 v[16:19], a[64:67], v[80:83], v[52:55]
    v_exp_f32 v28, v28
    v_mfma_f32_16x16x32_bf16 v[16:19], a[68:71], v[84:87], v[16:19]
    v_perm_b32 v37, v27, v26, s100
    v_mfma_f32_16x16x32_bf16 v[16:19], a[72:75], v[88:91], v[16:19]
    s_add_u32 m0, s44, 16896
    v_exp_f32 v29, v29
    v_mfma_f32_16x16x32_bf16 v[16:19], a[76:79], v[92:95], v[16:19]
    s_mov_b32 s45, 147712
    buffer_load_dwordx4 v7, s[28:31], s45 offen offset:0 lds
    v_mfma_f32_16x16x32_bf16 v[20:23], a[80:83], v[80:83], v[52:55]
    v_exp_f32 v30, v30
    v_mfma_f32_16x16x32_bf16 v[20:23], a[84:87], v[84:87], v[20:23]
    v_perm_b32 v38, v29, v28, s100
    v_mfma_f32_16x16x32_bf16 v[20:23], a[88:91], v[88:91], v[20:23]
    s_add_u32 m0, s44, 16800
    v_exp_f32 v31, v31
    v_mfma_f32_16x16x32_bf16 v[20:23], a[92:95], v[92:95], v[20:23]
    s_mov_b32 s15, 0x3f800000
    buffer_load_dwordx4 v7, s[28:31], s45 offen offset:1152 lds
    v_mfma_f32_16x16x32_bf16 v[24:27], a[96:99], v[80:83], v[52:55]
    v_exp_f32 v16, v16
    v_mfma_f32_16x16x32_bf16 v[24:27], a[100:103], v[84:87], v[24:27]
    v_perm_b32 v39, v31, v30, s100
    v_mfma_f32_16x16x32_bf16 v[24:27], a[104:107], v[88:91], v[24:27]
    s_add_u32 m0, s44, 16704
    v_exp_f32 v17, v17
    v_mfma_f32_16x16x32_bf16 v[24:27], a[108:111], v[92:95], v[24:27]
    buffer_load_dwordx4 v7, s[28:31], s45 offen offset:2304 lds
    v_mfma_f32_16x16x32_bf16 v[28:31], a[112:115], v[80:83], v[52:55]
    v_exp_f32 v18, v18
    v_mfma_f32_16x16x32_bf16 v[28:31], a[116:119], v[84:87], v[28:31]
    v_perm_b32 v40, v17, v16, s100
    v_mfma_f32_16x16x32_bf16 v[28:31], a[120:123], v[88:91], v[28:31]
    s_add_u32 m0, s44, 16608
    v_exp_f32 v19, v19
    v_mfma_f32_16x16x32_bf16 v[28:31], a[124:127], v[92:95], v[28:31]
    buffer_load_dwordx4 v7, s[28:31], s45 offen offset:3456 lds
    v_mfma_f32_16x16x32_bf16 v[128:131], a[192:195], v[32:35], v[128:131]
    v_exp_f32 v20, v20
    v_mfma_f32_16x16x32_bf16 v[128:131], a[196:199], v[36:39], v[128:131]
    v_perm_b32 v41, v19, v18, s100
    v_mfma_f32_16x16x32_bf16 v[132:135], a[200:203], v[32:35], v[132:135]
    s_mov_b32 s54, 0
    v_exp_f32 v21, v21
    v_mfma_f32_16x16x32_bf16 v[132:135], a[204:207], v[36:39], v[132:135]
    buffer_load_dwordx4 a[128:131], v6, s[68:71], s54 offen
    v_mfma_f32_16x16x32_bf16 v[136:139], a[208:211], v[32:35], v[136:139]
    v_exp_f32 v22, v22
    v_mfma_f32_16x16x32_bf16 v[136:139], a[212:215], v[36:39], v[136:139]
    v_perm_b32 v42, v21, v20, s100
    v_mfma_f32_16x16x32_bf16 v[140:143], a[216:219], v[32:35], v[140:143]
    s_add_u32 s54, s55, 0
    v_exp_f32 v23, v23
    v_mfma_f32_16x16x32_bf16 v[140:143], a[220:223], v[36:39], v[140:143]
    buffer_load_dwordx4 a[164:167], v8, s[72:75], s54 offen
    v_mfma_f32_16x16x32_bf16 v[144:147], a[224:227], v[32:35], v[144:147]
    v_exp_f32 v24, v24
    v_mfma_f32_16x16x32_bf16 v[144:147], a[228:231], v[36:39], v[144:147]
    v_perm_b32 v43, v23, v22, s100
    v_mfma_f32_16x16x32_bf16 v[148:151], a[232:235], v[32:35], v[148:151]
    s_mov_b32 s54, 147456
    v_exp_f32 v25, v25
    v_mfma_f32_16x16x32_bf16 v[148:151], a[236:239], v[36:39], v[148:151]
    buffer_load_dwordx4 a[132:135], v6, s[68:71], s54 offen
    v_mfma_f32_16x16x32_bf16 v[152:155], a[240:243], v[32:35], v[152:155]
    v_exp_f32 v26, v26
    v_mfma_f32_16x16x32_bf16 v[152:155], a[244:247], v[36:39], v[152:155]
    v_perm_b32 v44, v25, v24, s100
    v_mfma_f32_16x16x32_bf16 v[156:159], a[248:251], v[32:35], v[156:159]
    s_add_u32 s54, s55, 1024
    v_exp_f32 v27, v27
    v_mfma_f32_16x16x32_bf16 v[156:159], a[252:255], v[36:39], v[156:159]
    buffer_load_dwordx4 a[168:171], v8, s[72:75], s54 offen
    v_smfmac_f32_16x16x64_bf16 a[0:3], a[16:19], v[32:39], v11
    v_mfma_f32_16x16x32_bf16 v[16:19], a[64:67], v[96:99], v[56:59]
    v_exp_f32 v28, v28
    v_mfma_f32_16x16x32_bf16 v[16:19], a[68:71], v[100:103], v[16:19]
    v_perm_b32 v45, v27, v26, s100
    v_mfma_f32_16x16x32_bf16 v[16:19], a[72:75], v[104:107], v[16:19]
    s_mov_b32 s54, 294912
    v_exp_f32 v29, v29
    v_mfma_f32_16x16x32_bf16 v[16:19], a[76:79], v[108:111], v[16:19]
    buffer_load_dwordx4 a[136:139], v6, s[68:71], s54 offen
    v_mfma_f32_16x16x32_bf16 v[20:23], a[80:83], v[96:99], v[56:59]
    v_exp_f32 v30, v30
    v_mfma_f32_16x16x32_bf16 v[20:23], a[84:87], v[100:103], v[20:23]
    v_perm_b32 v46, v29, v28, s100
    v_accvgpr_read_b32 v12, a0
    v_mfma_f32_16x16x32_bf16 v[20:23], a[88:91], v[104:107], v[20:23]
    s_add_u32 s54, s55, 2048
    v_exp_f32 v31, v31
    v_mfma_f32_16x16x32_bf16 v[20:23], a[92:95], v[108:111], v[20:23]
    buffer_load_dwordx4 a[172:175], v8, s[72:75], s54 offen
    v_mfma_f32_16x16x32_bf16 v[24:27], a[96:99], v[96:99], v[56:59]
    v_exp_f32 v16, v16
    v_mfma_f32_16x16x32_bf16 v[24:27], a[100:103], v[100:103], v[24:27]
    v_perm_b32 v47, v31, v30, s100
    v_accvgpr_read_b32 v13, a1
    v_mfma_f32_16x16x32_bf16 v[24:27], a[104:107], v[104:107], v[24:27]
    s_mov_b32 s54, 442368
    v_exp_f32 v17, v17
    v_mfma_f32_16x16x32_bf16 v[24:27], a[108:111], v[108:111], v[24:27]
    buffer_load_dwordx4 a[140:143], v6, s[68:71], s54 offen
    v_mfma_f32_16x16x32_bf16 v[28:31], a[112:115], v[96:99], v[56:59]
    v_exp_f32 v18, v18
    v_mfma_f32_16x16x32_bf16 v[28:31], a[116:119], v[100:103], v[28:31]
    v_perm_b32 v32, v17, v16, s100
    v_add_f32 v12, v12, v13
    v_mfma_f32_16x16x32_bf16 v[28:31], a[120:123], v[104:107], v[28:31]
    s_add_u32 s54, s55, 3072
    v_exp_f32 v19, v19
    v_mfma_f32_16x16x32_bf16 v[28:31], a[124:127], v[108:111], v[28:31]
    buffer_load_dwordx4 a[176:179], v8, s[72:75], s54 offen
    v_mfma_f32_16x16x32_bf16 v[160:163], a[192:195], v[40:43], v[160:163]
    v_exp_f32 v20, v20
    v_mfma_f32_16x16x32_bf16 v[160:163], a[196:199], v[44:47], v[160:163]
    v_perm_b32 v33, v19, v18, s100
    v_subrev_u32 v13, 0x1e000000, v12
    v_mfma_f32_16x16x32_bf16 v[164:167], a[200:203], v[40:43], v[164:167]
    s_mov_b32 s54, 589824
    v_exp_f32 v21, v21
    v_mfma_f32_16x16x32_bf16 v[164:167], a[204:207], v[44:47], v[164:167]
    buffer_load_dwordx4 a[144:147], v6, s[68:71], s54 offen
    v_mfma_f32_16x16x32_bf16 v[168:171], a[208:211], v[40:43], v[168:171]
    v_exp_f32 v22, v22
    v_mfma_f32_16x16x32_bf16 v[168:171], a[212:215], v[44:47], v[168:171]
    v_perm_b32 v34, v21, v20, s100
    v_cmp_gt_u32 s[56:57], v13, s15
    v_mfma_f32_16x16x32_bf16 v[172:175], a[216:219], v[40:43], v[172:175]
    s_add_u32 s54, s55, 4096
    v_exp_f32 v23, v23
    v_mfma_f32_16x16x32_bf16 v[172:175], a[220:223], v[44:47], v[172:175]
    buffer_load_dwordx4 a[180:183], v8, s[72:75], s54 offen
    v_mfma_f32_16x16x32_bf16 v[176:179], a[224:227], v[40:43], v[176:179]
    v_exp_f32 v24, v24
    v_mfma_f32_16x16x32_bf16 v[176:179], a[228:231], v[44:47], v[176:179]
    v_perm_b32 v35, v23, v22, s100
    v_mfma_f32_16x16x32_bf16 v[180:183], a[232:235], v[40:43], v[180:183]
    s_mov_b32 s54, 737280
    v_exp_f32 v25, v25
    v_mfma_f32_16x16x32_bf16 v[180:183], a[236:239], v[44:47], v[180:183]
    buffer_load_dwordx4 a[148:151], v6, s[68:71], s54 offen
    v_mfma_f32_16x16x32_bf16 v[184:187], a[240:243], v[40:43], v[184:187]
    v_exp_f32 v26, v26
    v_mfma_f32_16x16x32_bf16 v[184:187], a[244:247], v[44:47], v[184:187]
    v_perm_b32 v36, v25, v24, s100
    v_mfma_f32_16x16x32_bf16 v[188:191], a[248:251], v[40:43], v[188:191]
    s_add_u32 s54, s55, 5120
    v_exp_f32 v27, v27
    v_mfma_f32_16x16x32_bf16 v[188:191], a[252:255], v[44:47], v[188:191]
    buffer_load_dwordx4 a[184:187], v8, s[72:75], s54 offen
    v_smfmac_f32_16x16x64_bf16 a[4:7], a[16:19], v[40:47], v11
    v_rcp_f32 v12, v12
    v_mfma_f32_16x16x32_bf16 v[16:19], a[64:67], v[112:115], v[60:63]
    v_exp_f32 v28, v28
    v_mfma_f32_16x16x32_bf16 v[16:19], a[68:71], v[116:119], v[16:19]
    v_perm_b32 v37, v27, v26, s100
    v_mul_f32 v128, v128, v12
    v_mfma_f32_16x16x32_bf16 v[16:19], a[72:75], v[120:123], v[16:19]
    s_mov_b32 s54, 884736
    v_exp_f32 v29, v29
    v_mfma_f32_16x16x32_bf16 v[16:19], a[76:79], v[124:127], v[16:19]
    buffer_load_dwordx4 a[152:155], v6, s[68:71], s54 offen
    v_mfma_f32_16x16x32_bf16 v[20:23], a[80:83], v[112:115], v[60:63]
    v_exp_f32 v30, v30
    v_mfma_f32_16x16x32_bf16 v[20:23], a[84:87], v[116:119], v[20:23]
    v_perm_b32 v38, v29, v28, s100
    v_mul_f32 v129, v129, v12
    v_mfma_f32_16x16x32_bf16 v[20:23], a[88:91], v[120:123], v[20:23]
    s_add_u32 s54, s55, 6144
    v_exp_f32 v31, v31
    v_mfma_f32_16x16x32_bf16 v[20:23], a[92:95], v[124:127], v[20:23]
    buffer_load_dwordx4 a[188:191], v8, s[72:75], s54 offen
    v_mfma_f32_16x16x32_bf16 v[24:27], a[96:99], v[112:115], v[60:63]
    v_exp_f32 v16, v16
    v_mfma_f32_16x16x32_bf16 v[24:27], a[100:103], v[116:119], v[24:27]
    v_perm_b32 v39, v31, v30, s100
    v_mul_f32 v130, v130, v12
    v_mfma_f32_16x16x32_bf16 v[24:27], a[104:107], v[120:123], v[24:27]
    s_mov_b32 s54, 1032192
    v_exp_f32 v17, v17
    v_mfma_f32_16x16x32_bf16 v[24:27], a[108:111], v[124:127], v[24:27]
    buffer_load_dwordx4 a[156:159], v6, s[68:71], s54 offen
    v_mfma_f32_16x16x32_bf16 v[28:31], a[112:115], v[112:115], v[60:63]
    v_exp_f32 v18, v18
    v_mfma_f32_16x16x32_bf16 v[28:31], a[116:119], v[116:119], v[28:31]
    v_perm_b32 v40, v17, v16, s100
    v_mul_f32 v131, v131, v12
    v_mfma_f32_16x16x32_bf16 v[28:31], a[120:123], v[120:123], v[28:31]
    s_mov_b32 s54, 1179648
    v_exp_f32 v19, v19
    v_mfma_f32_16x16x32_bf16 v[28:31], a[124:127], v[124:127], v[28:31]
    buffer_load_dwordx4 a[160:163], v6, s[68:71], s54 offen
    v_mfma_f32_16x16x32_bf16 v[192:195], a[192:195], v[32:35], v[192:195]
    v_exp_f32 v20, v20
    v_mfma_f32_16x16x32_bf16 v[192:195], a[196:199], v[36:39], v[192:195]
    v_perm_b32 v41, v19, v18, s100
    v_mul_f32 v132, v132, v12
    v_mfma_f32_16x16x32_bf16 v[196:199], a[200:203], v[32:35], v[196:199]
    v_exp_f32 v21, v21
    v_mfma_f32_16x16x32_bf16 v[196:199], a[204:207], v[36:39], v[196:199]
    v_mul_f32 v133, v133, v12
    v_mul_f32 v134, v134, v12
    v_mfma_f32_16x16x32_bf16 v[200:203], a[208:211], v[32:35], v[200:203]
    v_exp_f32 v22, v22
    v_mfma_f32_16x16x32_bf16 v[200:203], a[212:215], v[36:39], v[200:203]
    v_perm_b32 v42, v21, v20, s100
    v_mul_f32 v135, v135, v12
    v_mfma_f32_16x16x32_bf16 v[204:207], a[216:219], v[32:35], v[204:207]
    v_exp_f32 v23, v23
    v_mfma_f32_16x16x32_bf16 v[204:207], a[220:223], v[36:39], v[204:207]
    v_cvt_pk_bf16_f32 v128, v128, v129
    v_cvt_pk_bf16_f32 v129, v130, v131
    v_mfma_f32_16x16x32_bf16 v[208:211], a[224:227], v[32:35], v[208:211]
    v_exp_f32 v24, v24
    v_mfma_f32_16x16x32_bf16 v[208:211], a[228:231], v[36:39], v[208:211]
    v_perm_b32 v43, v23, v22, s100
    v_cvt_pk_bf16_f32 v130, v132, v133
    v_mfma_f32_16x16x32_bf16 v[212:215], a[232:235], v[32:35], v[212:215]
    v_exp_f32 v25, v25
    v_mfma_f32_16x16x32_bf16 v[212:215], a[236:239], v[36:39], v[212:215]
    v_cvt_pk_bf16_f32 v131, v134, v135
    v_mul_f32 v136, v136, v12
    v_mfma_f32_16x16x32_bf16 v[216:219], a[240:243], v[32:35], v[216:219]
    v_exp_f32 v26, v26
    v_mfma_f32_16x16x32_bf16 v[216:219], a[244:247], v[36:39], v[216:219]
    v_perm_b32 v44, v25, v24, s100
    v_mul_f32 v137, v137, v12
    v_mfma_f32_16x16x32_bf16 v[220:223], a[248:251], v[32:35], v[220:223]
    v_exp_f32 v27, v27
    v_mfma_f32_16x16x32_bf16 v[220:223], a[252:255], v[36:39], v[220:223]
    v_mul_f32 v138, v138, v12
    v_mul_f32 v139, v139, v12
    v_smfmac_f32_16x16x64_bf16 a[8:11], a[16:19], v[32:39], v11
    v_mul_f32 v140, v140, v12
    v_mul_f32 v141, v141, v12
    v_exp_f32 v28, v28
    s_nop 0
    v_perm_b32 v45, v27, v26, s100
    v_exp_f32 v29, v29
    s_nop 0
    v_exp_f32 v30, v30
    s_nop 0
    v_perm_b32 v46, v29, v28, s100
    v_exp_f32 v31, v31
    s_nop 0
    v_perm_b32 v47, v31, v30, s100
    s_nop 1
    v_mfma_f32_16x16x32_bf16 v[224:227], a[192:195], v[40:43], v[224:227]
    v_mul_f32 v142, v142, v12
    v_mul_f32 v143, v143, v12
    v_mfma_f32_16x16x32_bf16 v[224:227], a[196:199], v[44:47], v[224:227]
    ds_read_b64_tr_b16 a[64:65], v4 offset:0
    ds_read_b64_tr_b16 a[66:67], v4 offset:128
    v_mfma_f32_16x16x32_bf16 v[228:231], a[200:203], v[40:43], v[228:231]
    ds_read_b64_tr_b16 a[68:69], v4 offset:256
    ds_read_b64_tr_b16 a[70:71], v4 offset:384
    v_mfma_f32_16x16x32_bf16 v[228:231], a[204:207], v[44:47], v[228:231]
    ds_read_b64_tr_b16 a[72:73], v4 offset:512
    ds_read_b64_tr_b16 a[74:75], v4 offset:640
    v_mfma_f32_16x16x32_bf16 v[232:235], a[208:211], v[40:43], v[232:235]
    ds_read_b64_tr_b16 a[76:77], v4 offset:768
    ds_read_b64_tr_b16 a[78:79], v4 offset:896
    v_mfma_f32_16x16x32_bf16 v[232:235], a[212:215], v[44:47], v[232:235]
    ds_read_b64_tr_b16 a[80:81], v4 offset:16896
    ds_read_b64_tr_b16 a[82:83], v4 offset:17024
    v_mfma_f32_16x16x32_bf16 v[236:239], a[216:219], v[40:43], v[236:239]
    ds_read_b64_tr_b16 a[84:85], v4 offset:17152
    ds_read_b64_tr_b16 a[86:87], v4 offset:17280
    v_mfma_f32_16x16x32_bf16 v[236:239], a[220:223], v[44:47], v[236:239]
    ds_read_b64_tr_b16 a[88:89], v4 offset:17408
    ds_read_b64_tr_b16 a[90:91], v4 offset:17536
    v_mfma_f32_16x16x32_bf16 v[240:243], a[224:227], v[40:43], v[240:243]
    ds_read_b64_tr_b16 a[92:93], v4 offset:17664
    ds_read_b64_tr_b16 a[94:95], v4 offset:17792
    v_mfma_f32_16x16x32_bf16 v[240:243], a[228:231], v[44:47], v[240:243]
    v_cvt_pk_bf16_f32 v136, v136, v137
    v_cvt_pk_bf16_f32 v137, v138, v139
    v_mfma_f32_16x16x32_bf16 v[244:247], a[232:235], v[40:43], v[244:247]
    v_cvt_pk_bf16_f32 v138, v140, v141
    v_cvt_pk_bf16_f32 v139, v142, v143
    v_mfma_f32_16x16x32_bf16 v[244:247], a[236:239], v[44:47], v[244:247]
    v_mul_f32 v144, v144, v12
    v_mul_f32 v145, v145, v12
    v_mfma_f32_16x16x32_bf16 v[248:251], a[240:243], v[40:43], v[248:251]
    v_mul_f32 v146, v146, v12
    v_mul_f32 v147, v147, v12
    v_mfma_f32_16x16x32_bf16 v[248:251], a[244:247], v[44:47], v[248:251]
    v_mul_f32 v148, v148, v12
    v_mul_f32 v149, v149, v12
    v_mfma_f32_16x16x32_bf16 v[252:255], a[248:251], v[40:43], v[252:255]
    v_mul_f32 v150, v150, v12
    v_mul_f32 v151, v151, v12
    v_mfma_f32_16x16x32_bf16 v[252:255], a[252:255], v[44:47], v[252:255]
    v_cvt_pk_bf16_f32 v144, v144, v145
    v_cvt_pk_bf16_f32 v145, v146, v147
    v_smfmac_f32_16x16x64_bf16 a[12:15], a[16:19], v[40:47], v11
    v_cvt_pk_bf16_f32 v146, v148, v149
    v_cvt_pk_bf16_f32 v147, v150, v151
    v_mul_f32 v152, v152, v12
    v_mul_f32 v153, v153, v12
    v_mul_f32 v154, v154, v12
    v_mul_f32 v155, v155, v12
    v_mul_f32 v156, v156, v12
    v_mul_f32 v157, v157, v12
    v_mul_f32 v158, v158, v12
    v_mul_f32 v159, v159, v12
    v_cvt_pk_bf16_f32 v152, v152, v153
    v_cvt_pk_bf16_f32 v153, v154, v155
    v_cvt_pk_bf16_f32 v154, v156, v157
    v_cvt_pk_bf16_f32 v155, v158, v159
    v_accvgpr_read_b32 v14, a4
    v_accvgpr_read_b32 v15, a5
    v_add_f32 v14, v14, v15
    v_subrev_u32 v15, 0x1e000000, v14
    v_cmp_gt_u32 s[58:59], v15, s15
    v_rcp_f32 v14, v14
    v_accvgpr_read_b32 v12, a8
    v_accvgpr_read_b32 v13, a9
    v_add_f32 v12, v12, v13
    v_subrev_u32 v13, 0x1e000000, v12
    v_cmp_gt_u32 s[60:61], v13, s15
    v_rcp_f32 v12, v12
    v_pk_mul_f32 v[160:161], v[160:161], v[14:15] op_sel_hi:[1,0]
    v_pk_mul_f32 v[162:163], v[162:163], v[14:15] op_sel_hi:[1,0]
    v_pk_mul_f32 v[164:165], v[164:165], v[14:15] op_sel_hi:[1,0]
    v_pk_mul_f32 v[166:167], v[166:167], v[14:15] op_sel_hi:[1,0]
    v_cvt_pk_bf16_f32 v160, v160, v161
    v_cvt_pk_bf16_f32 v161, v162, v163
    v_cvt_pk_bf16_f32 v162, v164, v165
    v_cvt_pk_bf16_f32 v163, v166, v167
    v_pk_mul_f32 v[168:169], v[168:169], v[14:15] op_sel_hi:[1,0]
    v_pk_mul_f32 v[170:171], v[170:171], v[14:15] op_sel_hi:[1,0]
    v_pk_mul_f32 v[172:173], v[172:173], v[14:15] op_sel_hi:[1,0]
    v_pk_mul_f32 v[174:175], v[174:175], v[14:15] op_sel_hi:[1,0]
    v_cvt_pk_bf16_f32 v168, v168, v169
    v_cvt_pk_bf16_f32 v169, v170, v171
    v_cvt_pk_bf16_f32 v170, v172, v173
    v_cvt_pk_bf16_f32 v171, v174, v175
    v_pk_mul_f32 v[176:177], v[176:177], v[14:15] op_sel_hi:[1,0]
    v_pk_mul_f32 v[178:179], v[178:179], v[14:15] op_sel_hi:[1,0]
    v_pk_mul_f32 v[180:181], v[180:181], v[14:15] op_sel_hi:[1,0]
    v_pk_mul_f32 v[182:183], v[182:183], v[14:15] op_sel_hi:[1,0]
    v_cvt_pk_bf16_f32 v176, v176, v177
    v_cvt_pk_bf16_f32 v177, v178, v179
    v_cvt_pk_bf16_f32 v178, v180, v181
    v_cvt_pk_bf16_f32 v179, v182, v183
    v_pk_mul_f32 v[184:185], v[184:185], v[14:15] op_sel_hi:[1,0]
    v_pk_mul_f32 v[186:187], v[186:187], v[14:15] op_sel_hi:[1,0]
    v_pk_mul_f32 v[188:189], v[188:189], v[14:15] op_sel_hi:[1,0]
    v_pk_mul_f32 v[190:191], v[190:191], v[14:15] op_sel_hi:[1,0]
    v_cvt_pk_bf16_f32 v184, v184, v185
    v_cvt_pk_bf16_f32 v185, v186, v187
    v_cvt_pk_bf16_f32 v186, v188, v189
    v_cvt_pk_bf16_f32 v187, v190, v191
    v_accvgpr_read_b32 v14, a12
    v_accvgpr_read_b32 v15, a13
    v_add_f32 v14, v14, v15
    v_subrev_u32 v15, 0x1e000000, v14
    v_cmp_gt_u32 s[62:63], v15, s15
    s_or_b64 s[56:57], s[56:57], s[58:59]
    v_rcp_f32 v14, v14
    s_or_b64 s[60:61], s[60:61], s[62:63]
    s_or_b64 s[56:57], s[56:57], s[60:61]
    s_lshl2_add_u32 s14, s51, 13824
    v_mov_b32 v57, s14
    v_mov_b32 v58, 13824
    v_pk_mul_f32 v[192:193], v[192:193], v[12:13] op_sel_hi:[1,0]
    v_pk_mul_f32 v[194:195], v[194:195], v[12:13] op_sel_hi:[1,0]
    v_pk_mul_f32 v[196:197], v[196:197], v[12:13] op_sel_hi:[1,0]
    v_pk_mul_f32 v[198:199], v[198:199], v[12:13] op_sel_hi:[1,0]
    v_cvt_pk_bf16_f32 v192, v192, v193
    v_cvt_pk_bf16_f32 v193, v194, v195
    v_cvt_pk_bf16_f32 v194, v196, v197
    v_cvt_pk_bf16_f32 v195, v198, v199
    v_pk_mul_f32 v[200:201], v[200:201], v[12:13] op_sel_hi:[1,0]
    v_pk_mul_f32 v[202:203], v[202:203], v[12:13] op_sel_hi:[1,0]
    v_pk_mul_f32 v[204:205], v[204:205], v[12:13] op_sel_hi:[1,0]
    v_pk_mul_f32 v[206:207], v[206:207], v[12:13] op_sel_hi:[1,0]
    v_cvt_pk_bf16_f32 v200, v200, v201
    v_cvt_pk_bf16_f32 v201, v202, v203
    v_cvt_pk_bf16_f32 v202, v204, v205
    v_cvt_pk_bf16_f32 v203, v206, v207
    v_pk_mul_f32 v[208:209], v[208:209], v[12:13] op_sel_hi:[1,0]
    v_pk_mul_f32 v[210:211], v[210:211], v[12:13] op_sel_hi:[1,0]
    v_pk_mul_f32 v[212:213], v[212:213], v[12:13] op_sel_hi:[1,0]
    v_pk_mul_f32 v[214:215], v[214:215], v[12:13] op_sel_hi:[1,0]
    v_cvt_pk_bf16_f32 v208, v208, v209
    v_cvt_pk_bf16_f32 v209, v210, v211
    v_cvt_pk_bf16_f32 v210, v212, v213
    v_cvt_pk_bf16_f32 v211, v214, v215
    v_pk_mul_f32 v[216:217], v[216:217], v[12:13] op_sel_hi:[1,0]
    v_pk_mul_f32 v[218:219], v[218:219], v[12:13] op_sel_hi:[1,0]
    v_pk_mul_f32 v[220:221], v[220:221], v[12:13] op_sel_hi:[1,0]
    v_pk_mul_f32 v[222:223], v[222:223], v[12:13] op_sel_hi:[1,0]
    v_cvt_pk_bf16_f32 v216, v216, v217
    v_cvt_pk_bf16_f32 v217, v218, v219
    v_cvt_pk_bf16_f32 v218, v220, v221
    v_cvt_pk_bf16_f32 v219, v222, v223
    v_pk_mul_f32 v[224:225], v[224:225], v[14:15] op_sel_hi:[1,0]
    v_pk_mul_f32 v[226:227], v[226:227], v[14:15] op_sel_hi:[1,0]
    v_pk_mul_f32 v[228:229], v[228:229], v[14:15] op_sel_hi:[1,0]
    v_pk_mul_f32 v[230:231], v[230:231], v[14:15] op_sel_hi:[1,0]
    v_cvt_pk_bf16_f32 v224, v224, v225
    v_cvt_pk_bf16_f32 v225, v226, v227
    v_cvt_pk_bf16_f32 v226, v228, v229
    v_cvt_pk_bf16_f32 v227, v230, v231
    v_pk_mul_f32 v[232:233], v[232:233], v[14:15] op_sel_hi:[1,0]
    v_pk_mul_f32 v[234:235], v[234:235], v[14:15] op_sel_hi:[1,0]
    v_pk_mul_f32 v[236:237], v[236:237], v[14:15] op_sel_hi:[1,0]
    v_pk_mul_f32 v[238:239], v[238:239], v[14:15] op_sel_hi:[1,0]
    v_cvt_pk_bf16_f32 v232, v232, v233
    v_cvt_pk_bf16_f32 v233, v234, v235
L2_pad10:
    s_cbranch_execz L2_pad14
    v_cvt_pk_bf16_f32 v234, v236, v237
    v_cvt_pk_bf16_f32 v235, v238, v239
    v_pk_mul_f32 v[240:241], v[240:241], v[14:15] op_sel_hi:[1,0]
    v_pk_mul_f32 v[242:243], v[242:243], v[14:15] op_sel_hi:[1,0]
    v_pk_mul_f32 v[244:245], v[244:245], v[14:15] op_sel_hi:[1,0]
    v_pk_mul_f32 v[246:247], v[246:247], v[14:15] op_sel_hi:[1,0]
    v_cvt_pk_bf16_f32 v240, v240, v241
    v_cvt_pk_bf16_f32 v241, v242, v243
    v_cvt_pk_bf16_f32 v242, v244, v245
    v_cvt_pk_bf16_f32 v243, v246, v247
    v_pk_mul_f32 v[248:249], v[248:249], v[14:15] op_sel_hi:[1,0]
    v_pk_mul_f32 v[250:251], v[250:251], v[14:15] op_sel_hi:[1,0]
    v_pk_mul_f32 v[252:253], v[252:253], v[14:15] op_sel_hi:[1,0]
    v_pk_mul_f32 v[254:255], v[254:255], v[14:15] op_sel_hi:[1,0]
    v_cvt_pk_bf16_f32 v248, v248, v249
    v_cvt_pk_bf16_f32 v249, v250, v251
    v_cvt_pk_bf16_f32 v250, v252, v253
    v_cvt_pk_bf16_f32 v251, v254, v255
    s_waitcnt lgkmcnt(12)
    v_mfma_f32_16x16x32_bf16 v[16:19], a[64:67], v[128:131], 0
    ds_read_b64_tr_b16 a[96:97], v4 offset:32
    ds_read_b64_tr_b16 a[98:99], v4 offset:160
    v_mfma_f32_16x16x32_bf16 v[16:19], a[68:71], v[136:139], v[16:19]
    s_waitcnt lgkmcnt(10)
    ds_read_b64_tr_b16 a[100:101], v4 offset:288
    ds_read_b64_tr_b16 a[102:103], v4 offset:416
    v_mfma_f32_16x16x32_bf16 v[16:19], a[72:75], v[144:147], v[16:19]
    s_add_u32 s54, s55, 7168
    s_cmp_lg_u64 s[56:57], 0
    s_cselect_b32 s3, 1, 0
    ds_read_b64_tr_b16 a[104:105], v4 offset:544
    v_mfma_f32_16x16x32_bf16 v[16:19], a[76:79], v[152:155], v[16:19]
    s_waitcnt lgkmcnt(9)
    buffer_load_dwordx4 a[192:195], v8, s[72:75], s54 offen
    v_mfma_f32_16x16x32_bf16 v[16:19], a[80:83], v[192:195], v[16:19]
    s_andn2_b32 s3, s3, s50
    ds_read_b64_tr_b16 a[106:107], v4 offset:672
    v_mfma_f32_16x16x32_bf16 v[16:19], a[84:87], v[200:203], v[16:19]
    s_waitcnt lgkmcnt(6)
    ds_read_b64_tr_b16 a[108:109], v4 offset:800
    v_mfma_f32_16x16x32_bf16 v[16:19], a[88:91], v[208:211], v[16:19]
    s_add_u32 s54, s55, 8192
    ds_read_b64_tr_b16 a[110:111], v4 offset:928
    v_mfma_f32_16x16x32_bf16 v[16:19], a[92:95], v[216:219], v[16:19]
    buffer_load_dwordx4 a[196:199], v8, s[72:75], s54 offen
    v_mfma_f32_16x16x32_bf16 v[20:23], a[64:67], v[160:163], 0
    ds_read_b64_tr_b16 a[112:113], v4 offset:16928
    v_mfma_f32_16x16x32_bf16 v[20:23], a[68:71], v[168:171], v[20:23]
    ds_read_b64_tr_b16 a[114:115], v4 offset:17056
    v_mov_b32 v56, s3
    v_mfma_f32_16x16x32_bf16 v[20:23], a[72:75], v[176:179], v[20:23]
    ds_read_b64_tr_b16 a[116:117], v4 offset:17184
    v_mfma_f32_16x16x32_bf16 v[20:23], a[76:79], v[184:187], v[20:23]
    ds_read_b64_tr_b16 a[118:119], v4 offset:17312
    v_mfma_f32_16x16x32_bf16 v[20:23], a[80:83], v[224:227], v[20:23]
    ds_read_b64_tr_b16 a[120:121], v4 offset:17440
    v_mfma_f32_16x16x32_bf16 v[20:23], a[84:87], v[232:235], v[20:23]
    ds_read_b64_tr_b16 a[122:123], v4 offset:17568
    v_mfma_f32_16x16x32_bf16 v[20:23], a[88:91], v[240:243], v[20:23]
    ds_read_b64_tr_b16 a[124:125], v4 offset:17696
    v_mfma_f32_16x16x32_bf16 v[20:23], a[92:95], v[248:251], v[20:23]
    s_waitcnt lgkmcnt(11)
    ds_read_b64_tr_b16 a[126:127], v4 offset:17824
    ds_write_b32 v57, v56
    v_mfma_f32_16x16x32_bf16 v[24:27], a[96:99], v[128:131], 0
    ds_read_b64_tr_b16 a[64:65], v4 offset:64
    v_mfma_f32_16x16x32_bf16 v[24:27], a[100:103], v[136:139], v[24:27]
    s_waitcnt lgkmcnt(10)
    ds_read_b64_tr_b16 a[66:67], v4 offset:192
    v_mfma_f32_16x16x32_bf16 v[24:27], a[104:107], v[144:147], v[24:27]
    ds_read_b64_tr_b16 a[68:69], v4 offset:320
    v_mfma_f32_16x16x32_bf16 v[24:27], a[108:111], v[152:155], v[24:27]
    s_waitcnt lgkmcnt(8)
    ds_read_b64_tr_b16 a[70:71], v4 offset:448
    v_mfma_f32_16x16x32_bf16 v[24:27], a[112:115], v[192:195], v[24:27]
    ds_read_b64_tr_b16 a[72:73], v4 offset:576
    v_mfma_f32_16x16x32_bf16 v[24:27], a[116:119], v[200:203], v[24:27]
    s_waitcnt lgkmcnt(6)
    ds_read_b64_tr_b16 a[74:75], v4 offset:704
    v_mfma_f32_16x16x32_bf16 v[24:27], a[120:123], v[208:211], v[24:27]
    ds_read_b64_tr_b16 a[76:77], v4 offset:832
    v_mfma_f32_16x16x32_bf16 v[24:27], a[124:127], v[216:219], v[24:27]
    ds_read_b64_tr_b16 a[78:79], v4 offset:960
    v_mfma_f32_16x16x32_bf16 v[28:31], a[96:99], v[160:163], 0
    ds_read_b64_tr_b16 a[80:81], v4 offset:16960
    v_mfma_f32_16x16x32_bf16 v[28:31], a[100:103], v[168:171], v[28:31]
    ds_read_b64_tr_b16 a[82:83], v4 offset:17088
    v_mfma_f32_16x16x32_bf16 v[28:31], a[104:107], v[176:179], v[28:31]
    ds_read_b64_tr_b16 a[84:85], v4 offset:17216
    v_mfma_f32_16x16x32_bf16 v[28:31], a[108:111], v[184:187], v[28:31]
    ds_read_b64_tr_b16 a[86:87], v4 offset:17344
    v_mfma_f32_16x16x32_bf16 v[28:31], a[112:115], v[224:227], v[28:31]
    ds_read_b64_tr_b16 a[88:89], v4 offset:17472
    v_mfma_f32_16x16x32_bf16 v[28:31], a[116:119], v[232:235], v[28:31]
    ds_read_b64_tr_b16 a[90:91], v4 offset:17600
    v_mfma_f32_16x16x32_bf16 v[28:31], a[120:123], v[240:243], v[28:31]
    ds_read_b64_tr_b16 a[92:93], v4 offset:17728
    v_mfma_f32_16x16x32_bf16 v[28:31], a[124:127], v[248:251], v[28:31]
    s_waitcnt lgkmcnt(11)
    ds_read_b64_tr_b16 a[94:95], v4 offset:17856
    v_mfma_f32_16x16x32_bf16 v[32:35], a[64:67], v[128:131], 0
    ds_read_b64_tr_b16 a[96:97], v4 offset:96
    v_cvt_pk_bf16_f32 v48, v16, v17
    v_mfma_f32_16x16x32_bf16 v[32:35], a[68:71], v[136:139], v[32:35]
    s_waitcnt lgkmcnt(9)
    ds_read_b64_tr_b16 a[98:99], v4 offset:224
    v_cvt_pk_bf16_f32 v49, v18, v19
    v_mfma_f32_16x16x32_bf16 v[32:35], a[72:75], v[144:147], v[32:35]
    ds_read_b64_tr_b16 a[100:101], v4 offset:352
    v_cvt_pk_bf16_f32 v50, v24, v25
    v_mfma_f32_16x16x32_bf16 v[32:35], a[76:79], v[152:155], v[32:35]
    s_waitcnt lgkmcnt(7)
    ds_read_b64_tr_b16 a[102:103], v4 offset:480
    v_cvt_pk_bf16_f32 v51, v26, v27
    v_mfma_f32_16x16x32_bf16 v[32:35], a[80:83], v[192:195], v[32:35]
    s_mov_b32 s54, 0
    ds_read_b64_tr_b16 a[104:105], v4 offset:608
    ds_read_b64_tr_b16 a[106:107], v4 offset:736
    v_mfma_f32_16x16x32_bf16 v[32:35], a[84:87], v[200:203], v[32:35]
    s_waitcnt lgkmcnt(6)
    v_permlane32_swap_b32 v48, v50
    v_mfma_f32_16x16x32_bf16 v[32:35], a[88:91], v[208:211], v[32:35]
    v_permlane32_swap_b32 v49, v51
    v_mfma_f32_16x16x32_bf16 v[32:35], a[92:95], v[216:219], v[32:35]
    ds_read_b64_tr_b16 a[108:109], v4 offset:864
    ds_read_b64_tr_b16 a[110:111], v4 offset:992
    buffer_store_dwordx4 v[48:51], v10, s[40:43], s54 offen offset:0 sc1
    v_mfma_f32_16x16x32_bf16 v[36:39], a[64:67], v[160:163], 0
    ds_read_b64_tr_b16 a[112:113], v4 offset:16992
    v_cvt_pk_bf16_f32 v52, v20, v21
    v_mfma_f32_16x16x32_bf16 v[36:39], a[68:71], v[168:171], v[36:39]
    ds_read_b64_tr_b16 a[114:115], v4 offset:17120
    v_cvt_pk_bf16_f32 v53, v22, v23
    v_mfma_f32_16x16x32_bf16 v[36:39], a[72:75], v[176:179], v[36:39]
    ds_read_b64_tr_b16 a[116:117], v4 offset:17248
    v_cvt_pk_bf16_f32 v54, v28, v29
    v_mfma_f32_16x16x32_bf16 v[36:39], a[76:79], v[184:187], v[36:39]
    ds_read_b64_tr_b16 a[118:119], v4 offset:17376
    v_cvt_pk_bf16_f32 v55, v30, v31
    v_mfma_f32_16x16x32_bf16 v[36:39], a[80:83], v[224:227], v[36:39]
    s_mov_b32 s54, 294912
    ds_read_b64_tr_b16 a[120:121], v4 offset:17504
    ds_read_b64_tr_b16 a[122:123], v4 offset:17632
    v_mfma_f32_16x16x32_bf16 v[36:39], a[84:87], v[232:235], v[36:39]
    v_permlane32_swap_b32 v52, v54
    v_mfma_f32_16x16x32_bf16 v[36:39], a[88:91], v[240:243], v[36:39]
    v_permlane32_swap_b32 v53, v55
    v_mfma_f32_16x16x32_bf16 v[36:39], a[92:95], v[248:251], v[36:39]
    s_barrier
    s_waitcnt lgkmcnt(10)
    ds_read_b64_tr_b16 a[124:125], v4 offset:17760
    ds_read_b64_tr_b16 a[126:127], v4 offset:17888
    ds_read_b128 v[60:63], v58
    buffer_store_dwordx4 v[52:55], v10, s[40:43], s54 offen offset:0 sc1
    v_mfma_f32_16x16x32_bf16 v[40:43], a[96:99], v[128:131], 0
    s_add_u32 m0, s44, 36864
    ds_read_b64_tr_b16 a[64:65], v4 offset:36864
    ds_read_b64_tr_b16 a[66:67], v4 offset:36992
    v_mfma_f32_16x16x32_bf16 v[40:43], a[100:103], v[136:139], v[40:43]
    s_mov_b32 s45, 384
    s_waitcnt lgkmcnt(11)
    buffer_load_dwordx4 v7, s[28:31], s45 offen offset:0 lds
    v_mfma_f32_16x16x32_bf16 v[40:43], a[104:107], v[144:147], v[40:43]
    s_add_u32 m0, s44, 36768
    ds_read_b64_tr_b16 a[68:69], v4 offset:37120
    ds_read_b64_tr_b16 a[70:71], v4 offset:37248
    v_mfma_f32_16x16x32_bf16 v[40:43], a[108:111], v[152:155], v[40:43]
    s_waitcnt lgkmcnt(9)
    buffer_load_dwordx4 v7, s[28:31], s45 offen offset:1152 lds
    v_mfma_f32_16x16x32_bf16 v[40:43], a[112:115], v[192:195], v[40:43]
    s_add_u32 m0, s44, 36672
    ds_read_b64_tr_b16 a[72:73], v4 offset:37376
    ds_read_b64_tr_b16 a[74:75], v4 offset:37504
    v_mfma_f32_16x16x32_bf16 v[40:43], a[116:119], v[200:203], v[40:43]
    s_waitcnt lgkmcnt(7)
    buffer_load_dwordx4 v7, s[28:31], s45 offen offset:2304 lds
    v_mfma_f32_16x16x32_bf16 v[40:43], a[120:123], v[208:211], v[40:43]
    s_add_u32 m0, s44, 36576
    ds_read_b64_tr_b16 a[76:77], v4 offset:37632
    ds_read_b64_tr_b16 a[78:79], v4 offset:37760
    v_mfma_f32_16x16x32_bf16 v[40:43], a[124:127], v[216:219], v[40:43]
    s_waitcnt lgkmcnt(8)
    buffer_load_dwordx4 v7, s[28:31], s45 offen offset:3456 lds
    v_or3_b32 v60, v60, v61, v62
    v_or_b32 v60, v60, v63
    v_mfma_f32_16x16x32_bf16 v[44:47], a[96:99], v[160:163], 0
    s_add_u32 m0, s44, 53760
    ds_read_b64_tr_b16 a[80:81], v4 offset:53760
    ds_read_b64_tr_b16 a[82:83], v4 offset:53888
    v_mfma_f32_16x16x32_bf16 v[44:47], a[100:103], v[168:171], v[44:47]
    s_mov_b32 s45, 147840
    buffer_load_dwordx4 v7, s[28:31], s45 offen offset:0 lds
    v_mfma_f32_16x16x32_bf16 v[44:47], a[104:107], v[176:179], v[44:47]
    s_add_u32 m0, s44, 53664
    ds_read_b64_tr_b16 a[84:85], v4 offset:54016
    ds_read_b64_tr_b16 a[86:87], v4 offset:54144
    v_mfma_f32_16x16x32_bf16 v[44:47], a[108:111], v[184:187], v[44:47]
    buffer_load_dwordx4 v7, s[28:31], s45 offen offset:1152 lds
    v_mfma_f32_16x16x32_bf16 v[44:47], a[112:115], v[224:227], v[44:47]
    s_add_u32 m0, s44, 53568
    ds_read_b64_tr_b16 a[88:89], v4 offset:54272
    ds_read_b64_tr_b16 a[90:91], v4 offset:54400
    v_mfma_f32_16x16x32_bf16 v[44:47], a[116:119], v[232:235], v[44:47]
    buffer_load_dwordx4 v7, s[28:31], s45 offen offset:2304 lds
    v_mfma_f32_16x16x32_bf16 v[44:47], a[120:123], v[240:243], v[44:47]
    s_add_u32 m0, s44, 53472
    ds_read_b64_tr_b16 a[92:93], v4 offset:54528
    ds_read_b64_tr_b16 a[94:95], v4 offset:54656
    v_mfma_f32_16x16x32_bf16 v[44:47], a[124:127], v[248:251], v[44:47]
    s_waitcnt lgkmcnt(12)
    buffer_load_dwordx4 v7, s[28:31], s45 offen offset:3456 lds
    v_readfirstlane_b32 s3, v60
    v_mfma_f32_16x16x32_bf16 v[16:19], a[64:67], v[128:131], 0
    ds_read_b64_tr_b16 a[96:97], v4 offset:36896
    v_cvt_pk_bf16_f32 v48, v32, v33
    v_mfma_f32_16x16x32_bf16 v[16:19], a[68:71], v[136:139], v[16:19]
    s_waitcnt lgkmcnt(9)
    s_cmp_lg_u32 s3, 0
    ds_read_b64_tr_b16 a[98:99], v4 offset:37024
    v_cvt_pk_bf16_f32 v49, v34, v35
    v_mfma_f32_16x16x32_bf16 v[16:19], a[72:75], v[144:147], v[16:19]
    s_cbranch_scc1 L2_fallback
    ds_read_b64_tr_b16 a[100:101], v4 offset:37152
    v_cvt_pk_bf16_f32 v50, v40, v41
    v_mfma_f32_16x16x32_bf16 v[16:19], a[76:79], v[152:155], v[16:19]
    s_waitcnt lgkmcnt(7)
    ds_read_b64_tr_b16 a[102:103], v4 offset:37280
    v_cvt_pk_bf16_f32 v51, v42, v43
    v_mfma_f32_16x16x32_bf16 v[16:19], a[80:83], v[192:195], v[16:19]
    s_mov_b32 s54, 0
    ds_read_b64_tr_b16 a[104:105], v4 offset:37408
    ds_read_b64_tr_b16 a[106:107], v4 offset:37536
    v_mfma_f32_16x16x32_bf16 v[16:19], a[84:87], v[200:203], v[16:19]
    s_waitcnt lgkmcnt(6)
    v_permlane32_swap_b32 v48, v50
    v_mfma_f32_16x16x32_bf16 v[16:19], a[88:91], v[208:211], v[16:19]
    v_permlane32_swap_b32 v49, v51
    v_mfma_f32_16x16x32_bf16 v[16:19], a[92:95], v[216:219], v[16:19]
    ds_read_b64_tr_b16 a[108:109], v4 offset:37664
    ds_read_b64_tr_b16 a[110:111], v4 offset:37792
    buffer_store_dwordx4 v[48:51], v10, s[40:43], s54 offen offset:512 sc1
    v_mfma_f32_16x16x32_bf16 v[20:23], a[64:67], v[160:163], 0
    ds_read_b64_tr_b16 a[112:113], v4 offset:53792
    v_cvt_pk_bf16_f32 v52, v36, v37
    v_mfma_f32_16x16x32_bf16 v[20:23], a[68:71], v[168:171], v[20:23]
    ds_read_b64_tr_b16 a[114:115], v4 offset:53920
    v_cvt_pk_bf16_f32 v53, v38, v39
    v_mfma_f32_16x16x32_bf16 v[20:23], a[72:75], v[176:179], v[20:23]
    ds_read_b64_tr_b16 a[116:117], v4 offset:54048
    v_cvt_pk_bf16_f32 v54, v44, v45
    v_mfma_f32_16x16x32_bf16 v[20:23], a[76:79], v[184:187], v[20:23]
    ds_read_b64_tr_b16 a[118:119], v4 offset:54176
    v_cvt_pk_bf16_f32 v55, v46, v47
    v_mfma_f32_16x16x32_bf16 v[20:23], a[80:83], v[224:227], v[20:23]
    s_mov_b32 s54, 294912
    ds_read_b64_tr_b16 a[120:121], v4 offset:54304
    ds_read_b64_tr_b16 a[122:123], v4 offset:54432
    v_mfma_f32_16x16x32_bf16 v[20:23], a[84:87], v[232:235], v[20:23]
    v_permlane32_swap_b32 v52, v54
    v_mfma_f32_16x16x32_bf16 v[20:23], a[88:91], v[240:243], v[20:23]
    v_permlane32_swap_b32 v53, v55
    v_mfma_f32_16x16x32_bf16 v[20:23], a[92:95], v[248:251], v[20:23]
    s_waitcnt lgkmcnt(10)
    ds_read_b64_tr_b16 a[124:125], v4 offset:54560
    ds_read_b64_tr_b16 a[126:127], v4 offset:54688
    buffer_store_dwordx4 v[52:55], v10, s[40:43], s54 offen offset:512 sc1
    v_mfma_f32_16x16x32_bf16 v[24:27], a[96:99], v[128:131], 0
    s_mul_i32 s3, s51, 128
    ds_read_b64_tr_b16 a[64:65], v4 offset:36928
    v_lshrrev_b32 v14, 3, v0
    v_mfma_f32_16x16x32_bf16 v[24:27], a[100:103], v[136:139], v[24:27]
    s_waitcnt lgkmcnt(9)
    ds_read_b64_tr_b16 a[66:67], v4 offset:37056
    v_lshl_add_u32 v12, v14, 4, s3
    v_mfma_f32_16x16x32_bf16 v[24:27], a[104:107], v[144:147], v[24:27]
    ds_read_b64_tr_b16 a[68:69], v4 offset:37184
    v_and_b32 v14, 1, v14
    v_mfma_f32_16x16x32_bf16 v[24:27], a[108:111], v[152:155], v[24:27]
    s_waitcnt lgkmcnt(7)
    s_mul_i32 s3, s51, 32
    ds_read_b64_tr_b16 a[70:71], v4 offset:37312
    v_lshl_add_u32 v13, v14, 4, s3
    v_mfma_f32_16x16x32_bf16 v[24:27], a[112:115], v[192:195], v[24:27]
    ds_read_b64_tr_b16 a[72:73], v4 offset:37440
    v_and_b32 v14, 7, v0
    v_mfma_f32_16x16x32_bf16 v[24:27], a[116:119], v[200:203], v[24:27]
    s_waitcnt lgkmcnt(5)
    ds_read_b64_tr_b16 a[74:75], v4 offset:37568
    v_mul_u32_u24 v14, 1152, v14
    v_mfma_f32_16x16x32_bf16 v[24:27], a[120:123], v[208:211], v[24:27]
    ds_read_b64_tr_b16 a[76:77], v4 offset:37696
    v_add_u32 v1, v14, v12
    v_mfma_f32_16x16x32_bf16 v[24:27], a[124:127], v[216:219], v[24:27]
    ds_read_b64_tr_b16 a[78:79], v4 offset:37824
    v_add_u32 v2, v14, v13
    v_mfma_f32_16x16x32_bf16 v[28:31], a[96:99], v[160:163], 0
    ds_read_b64_tr_b16 a[80:81], v4 offset:53824
    v_add_u32 v2, 1024, v2
    v_mfma_f32_16x16x32_bf16 v[28:31], a[100:103], v[168:171], v[28:31]
    s_lshl_b32 s14, s51, 10
    ds_read_b64_tr_b16 a[82:83], v4 offset:53952
    v_add_u32 v5, s14, v8
    v_mfma_f32_16x16x32_bf16 v[28:31], a[104:107], v[176:179], v[28:31]
    ds_read_b64_tr_b16 a[84:85], v4 offset:54080
    v_and_b32 v59, 0xf0, v8
    v_mfma_f32_16x16x32_bf16 v[28:31], a[108:111], v[184:187], v[28:31]
    s_lshl_b32 s14, s51, 8
    ds_read_b64_tr_b16 a[86:87], v4 offset:54208
    v_add_u32 v59, s14, v59
    v_mfma_f32_16x16x32_bf16 v[28:31], a[112:115], v[224:227], v[28:31]
    ds_read_b64_tr_b16 a[88:89], v4 offset:54336
    v_and_b32 v6, 15, v0
    v_mfma_f32_16x16x32_bf16 v[28:31], a[116:119], v[232:235], v[28:31]
    ds_read_b64_tr_b16 a[90:91], v4 offset:54464
    v_lshlrev_b32 v6, 8, v6
    v_mfma_f32_16x16x32_bf16 v[28:31], a[120:123], v[240:243], v[28:31]
    ds_read_b64_tr_b16 a[92:93], v4 offset:54592
    v_min_u32 v15, 1, v0
    v_mfma_f32_16x16x32_bf16 v[28:31], a[124:127], v[248:251], v[28:31]
    s_waitcnt lgkmcnt(11)
    ds_read_b64_tr_b16 a[94:95], v4 offset:54720
    v_lshlrev_b32 v15, 30, v15
    v_mfma_f32_16x16x32_bf16 v[32:35], a[64:67], v[128:131], 0
    s_lshl_b32 s15, s53, 14
    s_add_u32 s15, s15, 786432
    s_and_b32 s14, s52, 12
    s_lshl_b32 s14, s14, 10
    s_add_u32 s47, s15, s14
    s_lshl4_add_u32 s3, s51, s52
    s_lshl_b32 s3, s3, 8
    s_add_u32 s56, s3, s15
    s_add_u32 s14, s55, 16384
    ds_read_b64_tr_b16 a[96:97], v4 offset:36960
    v_cvt_pk_bf16_f32 v48, v16, v17
    v_mfma_f32_16x16x32_bf16 v[32:35], a[68:71], v[136:139], v[32:35]
    s_waitcnt lgkmcnt(9)
    ds_read_b64_tr_b16 a[98:99], v4 offset:37088
    v_cvt_pk_bf16_f32 v49, v18, v19
    v_mfma_f32_16x16x32_bf16 v[32:35], a[72:75], v[144:147], v[32:35]
    ds_read_b64_tr_b16 a[100:101], v4 offset:37216
    v_cvt_pk_bf16_f32 v50, v24, v25
    v_mfma_f32_16x16x32_bf16 v[32:35], a[76:79], v[152:155], v[32:35]
    s_waitcnt lgkmcnt(7)
    ds_read_b64_tr_b16 a[102:103], v4 offset:37344
    v_cvt_pk_bf16_f32 v51, v26, v27
    v_mfma_f32_16x16x32_bf16 v[32:35], a[80:83], v[192:195], v[32:35]
    s_mov_b32 s54, 1024
    ds_read_b64_tr_b16 a[104:105], v4 offset:37472
    ds_read_b64_tr_b16 a[106:107], v4 offset:37600
    v_mfma_f32_16x16x32_bf16 v[32:35], a[84:87], v[200:203], v[32:35]
    s_waitcnt lgkmcnt(6)
    v_permlane32_swap_b32 v48, v50
    v_mfma_f32_16x16x32_bf16 v[32:35], a[88:91], v[208:211], v[32:35]
    v_permlane32_swap_b32 v49, v51
    v_mfma_f32_16x16x32_bf16 v[32:35], a[92:95], v[216:219], v[32:35]
    ds_read_b64_tr_b16 a[108:109], v4 offset:37728
    ds_read_b64_tr_b16 a[110:111], v4 offset:37856
    buffer_store_dwordx4 v[48:51], v10, s[40:43], s54 offen offset:0 sc1
    v_mfma_f32_16x16x32_bf16 v[36:39], a[64:67], v[160:163], 0
    ds_read_b64_tr_b16 a[112:113], v4 offset:53856
    v_cvt_pk_bf16_f32 v52, v20, v21
    v_mfma_f32_16x16x32_bf16 v[36:39], a[68:71], v[168:171], v[36:39]
    ds_read_b64_tr_b16 a[114:115], v4 offset:53984
    v_cvt_pk_bf16_f32 v53, v22, v23
    v_mfma_f32_16x16x32_bf16 v[36:39], a[72:75], v[176:179], v[36:39]
    ds_read_b64_tr_b16 a[116:117], v4 offset:54112
    v_cvt_pk_bf16_f32 v54, v28, v29
    v_mfma_f32_16x16x32_bf16 v[36:39], a[76:79], v[184:187], v[36:39]
    ds_read_b64_tr_b16 a[118:119], v4 offset:54240
    v_cvt_pk_bf16_f32 v55, v30, v31
    v_mfma_f32_16x16x32_bf16 v[36:39], a[80:83], v[224:227], v[36:39]
    s_mov_b32 s54, 295936
    ds_read_b64_tr_b16 a[120:121], v4 offset:54368
    ds_read_b64_tr_b16 a[122:123], v4 offset:54496
    v_mfma_f32_16x16x32_bf16 v[36:39], a[84:87], v[232:235], v[36:39]
    v_permlane32_swap_b32 v52, v54
    v_mfma_f32_16x16x32_bf16 v[36:39], a[88:91], v[240:243], v[36:39]
    v_permlane32_swap_b32 v53, v55
    v_mfma_f32_16x16x32_bf16 v[36:39], a[92:95], v[248:251], v[36:39]
    s_waitcnt vmcnt(31)
    s_barrier
    s_waitcnt lgkmcnt(10)
    ds_read_b64_tr_b16 a[124:125], v4 offset:54624
    ds_read_b64_tr_b16 a[126:127], v4 offset:54752
    buffer_store_dwordx4 v[52:55], v10, s[40:43], s54 offen offset:0 sc1
    v_mfma_f32_16x16x32_bf16 v[40:43], a[96:99], v[128:131], 0
    s_add_u32 m0, s44, 73728
    ds_read_b64_tr_b16 a[64:65], v3 offset:0
    ds_read_b64_tr_b16 a[66:67], v3 offset:128
    v_mfma_f32_16x16x32_bf16 v[40:43], a[100:103], v[136:139], v[40:43]
    s_mov_b32 s45, 512
    s_waitcnt lgkmcnt(10)
    buffer_load_dwordx4 v7, s[28:31], s45 offen offset:0 lds
    v_mfma_f32_16x16x32_bf16 v[40:43], a[104:107], v[144:147], v[40:43]
    s_add_u32 m0, s44, 73632
    ds_read_b64_tr_b16 a[68:69], v3 offset:256
    ds_read_b64_tr_b16 a[70:71], v3 offset:384
    v_mfma_f32_16x16x32_bf16 v[40:43], a[108:111], v[152:155], v[40:43]
    s_waitcnt lgkmcnt(8)
    buffer_load_dwordx4 v7, s[28:31], s45 offen offset:1152 lds
    v_mfma_f32_16x16x32_bf16 v[40:43], a[112:115], v[192:195], v[40:43]
    s_add_u32 m0, s44, 73536
    ds_read_b64_tr_b16 a[72:73], v3 offset:512
    ds_read_b64_tr_b16 a[74:75], v3 offset:640
    v_mfma_f32_16x16x32_bf16 v[40:43], a[116:119], v[200:203], v[40:43]
    s_waitcnt lgkmcnt(6)
    buffer_load_dwordx4 v7, s[28:31], s45 offen offset:2304 lds
    v_mfma_f32_16x16x32_bf16 v[40:43], a[120:123], v[208:211], v[40:43]
    s_add_u32 m0, s44, 73440
    ds_read_b64_tr_b16 a[76:77], v3 offset:768
    ds_read_b64_tr_b16 a[78:79], v3 offset:896
    v_mfma_f32_16x16x32_bf16 v[40:43], a[124:127], v[216:219], v[40:43]
    buffer_load_dwordx4 v7, s[28:31], s45 offen offset:3456 lds
    v_mfma_f32_16x16x32_bf16 v[44:47], a[96:99], v[160:163], 0
    s_add_u32 m0, s44, 90624
    ds_read_b64_tr_b16 a[80:81], v3 offset:16896
    ds_read_b64_tr_b16 a[82:83], v3 offset:17024
    v_mfma_f32_16x16x32_bf16 v[44:47], a[100:103], v[168:171], v[44:47]
    s_mov_b32 s45, 147968
    buffer_load_dwordx4 v7, s[28:31], s45 offen offset:0 lds
    v_mfma_f32_16x16x32_bf16 v[44:47], a[104:107], v[176:179], v[44:47]
    s_add_u32 m0, s44, 90528
    ds_read_b64_tr_b16 a[84:85], v3 offset:17152
    ds_read_b64_tr_b16 a[86:87], v3 offset:17280
    v_mfma_f32_16x16x32_bf16 v[44:47], a[108:111], v[184:187], v[44:47]
    buffer_load_dwordx4 v7, s[28:31], s45 offen offset:1152 lds
    v_mfma_f32_16x16x32_bf16 v[44:47], a[112:115], v[224:227], v[44:47]
    s_add_u32 m0, s44, 90432
    ds_read_b64_tr_b16 a[88:89], v3 offset:17408
    ds_read_b64_tr_b16 a[90:91], v3 offset:17536
    v_mfma_f32_16x16x32_bf16 v[44:47], a[116:119], v[232:235], v[44:47]
    buffer_load_dwordx4 v7, s[28:31], s45 offen offset:2304 lds
    v_mfma_f32_16x16x32_bf16 v[44:47], a[120:123], v[240:243], v[44:47]
    s_add_u32 m0, s44, 90336
    ds_read_b64_tr_b16 a[92:93], v3 offset:17664
    ds_read_b64_tr_b16 a[94:95], v3 offset:17792
    v_mfma_f32_16x16x32_bf16 v[44:47], a[124:127], v[248:251], v[44:47]
    s_waitcnt lgkmcnt(12)
    buffer_load_dwordx4 v7, s[28:31], s45 offen offset:3456 lds
    v_mfma_f32_16x16x32_bf16 v[16:19], a[64:67], v[128:131], 0
    ds_read_b64_tr_b16 a[96:97], v3 offset:32
    v_cvt_pk_bf16_f32 v48, v32, v33
    v_mfma_f32_16x16x32_bf16 v[16:19], a[68:71], v[136:139], v[16:19]
    s_waitcnt lgkmcnt(9)
    ds_read_b64_tr_b16 a[98:99], v3 offset:160
    v_cvt_pk_bf16_f32 v49, v34, v35
    v_mfma_f32_16x16x32_bf16 v[16:19], a[72:75], v[144:147], v[16:19]
    ds_read_b64_tr_b16 a[100:101], v3 offset:288
    v_cvt_pk_bf16_f32 v50, v40, v41
    v_mfma_f32_16x16x32_bf16 v[16:19], a[76:79], v[152:155], v[16:19]
    s_waitcnt lgkmcnt(7)
    ds_read_b64_tr_b16 a[102:103], v3 offset:416
    v_cvt_pk_bf16_f32 v51, v42, v43
    v_mfma_f32_16x16x32_bf16 v[16:19], a[80:83], v[192:195], v[16:19]
    s_mov_b32 s54, 1024
    ds_read_b64_tr_b16 a[104:105], v3 offset:544
    ds_read_b64_tr_b16 a[106:107], v3 offset:672
    v_mfma_f32_16x16x32_bf16 v[16:19], a[84:87], v[200:203], v[16:19]
    s_waitcnt lgkmcnt(6)
    v_permlane32_swap_b32 v48, v50
    v_mfma_f32_16x16x32_bf16 v[16:19], a[88:91], v[208:211], v[16:19]
    v_permlane32_swap_b32 v49, v51
    v_mfma_f32_16x16x32_bf16 v[16:19], a[92:95], v[216:219], v[16:19]
    ds_read_b64_tr_b16 a[108:109], v3 offset:800
    ds_read_b64_tr_b16 a[110:111], v3 offset:928
    buffer_store_dwordx4 v[48:51], v10, s[40:43], s54 offen offset:512 sc1
    v_mfma_f32_16x16x32_bf16 v[20:23], a[64:67], v[160:163], 0
    ds_read_b64_tr_b16 a[112:113], v3 offset:16928
    v_cvt_pk_bf16_f32 v52, v36, v37
    v_mfma_f32_16x16x32_bf16 v[20:23], a[68:71], v[168:171], v[20:23]
    ds_read_b64_tr_b16 a[114:115], v3 offset:17056
    v_cvt_pk_bf16_f32 v53, v38, v39
    v_mfma_f32_16x16x32_bf16 v[20:23], a[72:75], v[176:179], v[20:23]
    ds_read_b64_tr_b16 a[116:117], v3 offset:17184
    v_cvt_pk_bf16_f32 v54, v44, v45
    v_mfma_f32_16x16x32_bf16 v[20:23], a[76:79], v[184:187], v[20:23]
    ds_read_b64_tr_b16 a[118:119], v3 offset:17312
    v_cvt_pk_bf16_f32 v55, v46, v47
    v_mfma_f32_16x16x32_bf16 v[20:23], a[80:83], v[224:227], v[20:23]
    s_mov_b32 s54, 295936
    ds_read_b64_tr_b16 a[120:121], v3 offset:17440
    ds_read_b64_tr_b16 a[122:123], v3 offset:17568
    v_mfma_f32_16x16x32_bf16 v[20:23], a[84:87], v[232:235], v[20:23]
    v_permlane32_swap_b32 v52, v54
    v_mfma_f32_16x16x32_bf16 v[20:23], a[88:91], v[240:243], v[20:23]
    v_permlane32_swap_b32 v53, v55
    v_mfma_f32_16x16x32_bf16 v[20:23], a[92:95], v[248:251], v[20:23]
    s_waitcnt lgkmcnt(10)
    ds_read_b64_tr_b16 a[124:125], v3 offset:17696
    ds_read_b64_tr_b16 a[126:127], v3 offset:17824
    buffer_store_dwordx4 v[52:55], v10, s[40:43], s54 offen offset:512 sc1
    v_mfma_f32_16x16x32_bf16 v[24:27], a[96:99], v[128:131], 0
    ds_read_b64_tr_b16 a[64:65], v3 offset:64
    v_add_u32 v104, s14, v8
    v_mfma_f32_16x16x32_bf16 v[24:27], a[100:103], v[136:139], v[24:27]
    s_waitcnt lgkmcnt(9)
    ds_read_b64_tr_b16 a[66:67], v3 offset:192
    v_and_b32 v14, 32, v0
    v_mfma_f32_16x16x32_bf16 v[24:27], a[104:107], v[144:147], v[24:27]
    ds_read_b64_tr_b16 a[68:69], v3 offset:320
    v_xor_b32 v105, v14, v104
    v_mfma_f32_16x16x32_bf16 v[24:27], a[108:111], v[152:155], v[24:27]
    s_waitcnt lgkmcnt(7)
    ds_read_b64_tr_b16 a[70:71], v3 offset:448
    v_add_u32 v106, 73728, v105
    v_mfma_f32_16x16x32_bf16 v[24:27], a[112:115], v[192:195], v[24:27]
    ds_read_b64_tr_b16 a[72:73], v3 offset:576
    v_lshrrev_b32 v110, 4, v0
    v_mfma_f32_16x16x32_bf16 v[24:27], a[116:119], v[200:203], v[24:27]
    s_waitcnt lgkmcnt(5)
    ds_read_b64_tr_b16 a[74:75], v3 offset:704
    v_bfe_u32 v14, v0, 2, 2
    v_mfma_f32_16x16x32_bf16 v[24:27], a[120:123], v[208:211], v[24:27]
    ds_read_b64_tr_b16 a[76:77], v3 offset:832
    v_lshl_add_u32 v110, v110, 3, v14
    v_mfma_f32_16x16x32_bf16 v[24:27], a[124:127], v[216:219], v[24:27]
    ds_read_b64_tr_b16 a[78:79], v3 offset:960
    v_and_b32 v14, 3, v0
    v_mfma_f32_16x16x32_bf16 v[28:31], a[96:99], v[160:163], 0
    ds_read_b64_tr_b16 a[80:81], v3 offset:16960
    v_mul_u32_u24 v111, 1152, v110
    v_mfma_f32_16x16x32_bf16 v[28:31], a[100:103], v[168:171], v[28:31]
    ds_read_b64_tr_b16 a[82:83], v3 offset:17088
    v_lshlrev_b32 v110, 6, v110
    v_mfma_f32_16x16x32_bf16 v[28:31], a[104:107], v[176:179], v[28:31]
    ds_read_b64_tr_b16 a[84:85], v3 offset:17216
    v_lshl_add_u32 v110, v14, 3, v110
    v_mfma_f32_16x16x32_bf16 v[28:31], a[108:111], v[184:187], v[28:31]
    ds_read_b64_tr_b16 a[86:87], v3 offset:17344
    v_lshl_add_u32 v111, v14, 3, v111
    v_mfma_f32_16x16x32_bf16 v[28:31], a[112:115], v[224:227], v[28:31]
    s_lshr_b32 s3, s51, 1
    s_xor_b32 s3, s3, 1
    s_mul_i32 s3, s3, 110592
    s_and_b32 s14, s51, 1
    s_lshl_b32 s14, s14, 5
    s_add_u32 s3, s3, s14
    s_add_u32 s3, s3, 16384
    ds_read_b64_tr_b16 a[88:89], v3 offset:17472
    v_add_u32 v110, s3, v110
    v_mfma_f32_16x16x32_bf16 v[28:31], a[116:119], v[232:235], v[28:31]
    ds_read_b64_tr_b16 a[90:91], v3 offset:17600
    v_and_b32 v14, 16, v0
    v_mfma_f32_16x16x32_bf16 v[28:31], a[120:123], v[240:243], v[28:31]
    ds_read_b64_tr_b16 a[92:93], v3 offset:17728
    v_lshlrev_b32 v14, 1, v14
    v_mfma_f32_16x16x32_bf16 v[28:31], a[124:127], v[248:251], v[28:31]
    s_waitcnt lgkmcnt(11)
    ds_read_b64_tr_b16 a[94:95], v3 offset:17856
    v_xor_b32 v110, v14, v110
    v_mfma_f32_16x16x32_bf16 v[32:35], a[64:67], v[128:131], 0
    s_mul_i32 s3, s51, 288
    s_add_u32 s3, s3, 53248
    ds_read_b64_tr_b16 a[96:97], v3 offset:96
    v_cvt_pk_bf16_f32 v48, v16, v17
    v_mfma_f32_16x16x32_bf16 v[32:35], a[68:71], v[136:139], v[32:35]
    s_waitcnt lgkmcnt(9)
    ds_read_b64_tr_b16 a[98:99], v3 offset:224
    v_cvt_pk_bf16_f32 v49, v18, v19
    v_mfma_f32_16x16x32_bf16 v[32:35], a[72:75], v[144:147], v[32:35]
L2_pad11:
    s_cbranch_execz L2_pad15
    ds_read_b64_tr_b16 a[100:101], v3 offset:352
    v_cvt_pk_bf16_f32 v50, v24, v25
    v_mfma_f32_16x16x32_bf16 v[32:35], a[76:79], v[152:155], v[32:35]
    s_waitcnt lgkmcnt(7)
    ds_read_b64_tr_b16 a[102:103], v3 offset:480
    v_cvt_pk_bf16_f32 v51, v26, v27
    v_mfma_f32_16x16x32_bf16 v[32:35], a[80:83], v[192:195], v[32:35]
    s_mov_b32 s54, 2048
    ds_read_b64_tr_b16 a[104:105], v3 offset:608
    ds_read_b64_tr_b16 a[106:107], v3 offset:736
    v_mfma_f32_16x16x32_bf16 v[32:35], a[84:87], v[200:203], v[32:35]
    s_waitcnt lgkmcnt(6)
    v_permlane32_swap_b32 v48, v50
    v_mfma_f32_16x16x32_bf16 v[32:35], a[88:91], v[208:211], v[32:35]
    v_permlane32_swap_b32 v49, v51
    v_mfma_f32_16x16x32_bf16 v[32:35], a[92:95], v[216:219], v[32:35]
    ds_read_b64_tr_b16 a[108:109], v3 offset:864
    ds_read_b64_tr_b16 a[110:111], v3 offset:992
    buffer_store_dwordx4 v[48:51], v10, s[40:43], s54 offen offset:0 sc1
    v_mfma_f32_16x16x32_bf16 v[36:39], a[64:67], v[160:163], 0
    ds_read_b64_tr_b16 a[112:113], v3 offset:16992
    v_cvt_pk_bf16_f32 v52, v20, v21
    v_mfma_f32_16x16x32_bf16 v[36:39], a[68:71], v[168:171], v[36:39]
    ds_read_b64_tr_b16 a[114:115], v3 offset:17120
    v_cvt_pk_bf16_f32 v53, v22, v23
    v_mfma_f32_16x16x32_bf16 v[36:39], a[72:75], v[176:179], v[36:39]
    ds_read_b64_tr_b16 a[116:117], v3 offset:17248
    v_cvt_pk_bf16_f32 v54, v28, v29
    v_mfma_f32_16x16x32_bf16 v[36:39], a[76:79], v[184:187], v[36:39]
    ds_read_b64_tr_b16 a[118:119], v3 offset:17376
    v_cvt_pk_bf16_f32 v55, v30, v31
    v_mfma_f32_16x16x32_bf16 v[36:39], a[80:83], v[224:227], v[36:39]
    s_mov_b32 s54, 296960
    ds_read_b64_tr_b16 a[120:121], v3 offset:17504
    ds_read_b64_tr_b16 a[122:123], v3 offset:17632
    v_mfma_f32_16x16x32_bf16 v[36:39], a[84:87], v[232:235], v[36:39]
    v_permlane32_swap_b32 v52, v54
    v_mfma_f32_16x16x32_bf16 v[36:39], a[88:91], v[240:243], v[36:39]
    v_permlane32_swap_b32 v53, v55
    v_mfma_f32_16x16x32_bf16 v[36:39], a[92:95], v[248:251], v[36:39]
    s_waitcnt vmcnt(15)
    s_barrier
    s_waitcnt lgkmcnt(10)
    ds_read_b64_tr_b16 a[124:125], v3 offset:17760
    ds_read_b64_tr_b16 a[126:127], v3 offset:17888
    buffer_store_dwordx4 v[52:55], v10, s[40:43], s54 offen offset:0 sc1
    v_mfma_f32_16x16x32_bf16 v[40:43], a[96:99], v[128:131], 0
    s_add_u32 m0, s44, 110592
    ds_read_b64_tr_b16 a[64:65], v3 offset:36864
    ds_read_b64_tr_b16 a[66:67], v3 offset:36992
    v_mfma_f32_16x16x32_bf16 v[40:43], a[100:103], v[136:139], v[40:43]
    s_mov_b32 s45, 640
    s_waitcnt lgkmcnt(10)
    buffer_load_dwordx4 v7, s[28:31], s45 offen offset:0 lds
    v_mfma_f32_16x16x32_bf16 v[40:43], a[104:107], v[144:147], v[40:43]
    s_add_u32 m0, s44, 110496
    ds_read_b64_tr_b16 a[68:69], v3 offset:37120
    ds_read_b64_tr_b16 a[70:71], v3 offset:37248
    v_mfma_f32_16x16x32_bf16 v[40:43], a[108:111], v[152:155], v[40:43]
    s_waitcnt lgkmcnt(8)
    buffer_load_dwordx4 v7, s[28:31], s45 offen offset:1152 lds
    v_mfma_f32_16x16x32_bf16 v[40:43], a[112:115], v[192:195], v[40:43]
    s_add_u32 m0, s44, 110400
    ds_read_b64_tr_b16 a[72:73], v3 offset:37376
    ds_read_b64_tr_b16 a[74:75], v3 offset:37504
    v_mfma_f32_16x16x32_bf16 v[40:43], a[116:119], v[200:203], v[40:43]
    s_waitcnt lgkmcnt(6)
    buffer_load_dwordx4 v7, s[28:31], s45 offen offset:2304 lds
    v_mfma_f32_16x16x32_bf16 v[40:43], a[120:123], v[208:211], v[40:43]
    s_add_u32 m0, s44, 110304
    ds_read_b64_tr_b16 a[76:77], v3 offset:37632
    ds_read_b64_tr_b16 a[78:79], v3 offset:37760
    v_mfma_f32_16x16x32_bf16 v[40:43], a[124:127], v[216:219], v[40:43]
    buffer_load_dwordx4 v7, s[28:31], s45 offen offset:3456 lds
    v_mfma_f32_16x16x32_bf16 v[44:47], a[96:99], v[160:163], 0
    s_add_u32 m0, s44, 127488
    ds_read_b64_tr_b16 a[80:81], v3 offset:53760
    ds_read_b64_tr_b16 a[82:83], v3 offset:53888
    v_mfma_f32_16x16x32_bf16 v[44:47], a[100:103], v[168:171], v[44:47]
    s_mov_b32 s45, 148096
    buffer_load_dwordx4 v7, s[28:31], s45 offen offset:0 lds
    v_mfma_f32_16x16x32_bf16 v[44:47], a[104:107], v[176:179], v[44:47]
    s_add_u32 m0, s44, 127392
    ds_read_b64_tr_b16 a[84:85], v3 offset:54016
    ds_read_b64_tr_b16 a[86:87], v3 offset:54144
    v_mfma_f32_16x16x32_bf16 v[44:47], a[108:111], v[184:187], v[44:47]
    buffer_load_dwordx4 v7, s[28:31], s45 offen offset:1152 lds
    v_mfma_f32_16x16x32_bf16 v[44:47], a[112:115], v[224:227], v[44:47]
    s_add_u32 m0, s44, 127296
    ds_read_b64_tr_b16 a[88:89], v3 offset:54272
    ds_read_b64_tr_b16 a[90:91], v3 offset:54400
    v_mfma_f32_16x16x32_bf16 v[44:47], a[116:119], v[232:235], v[44:47]
    buffer_load_dwordx4 v7, s[28:31], s45 offen offset:2304 lds
    v_mfma_f32_16x16x32_bf16 v[44:47], a[120:123], v[240:243], v[44:47]
    s_add_u32 m0, s44, 127200
    ds_read_b64_tr_b16 a[92:93], v3 offset:54528
    ds_read_b64_tr_b16 a[94:95], v3 offset:54656
    v_mfma_f32_16x16x32_bf16 v[44:47], a[124:127], v[248:251], v[44:47]
    s_waitcnt lgkmcnt(12)
    buffer_load_dwordx4 v7, s[28:31], s45 offen offset:3456 lds
    v_mfma_f32_16x16x32_bf16 v[16:19], a[64:67], v[128:131], 0
    ds_read_b64_tr_b16 a[96:97], v3 offset:36896
    v_cvt_pk_bf16_f32 v48, v32, v33
    v_mfma_f32_16x16x32_bf16 v[16:19], a[68:71], v[136:139], v[16:19]
    s_waitcnt lgkmcnt(9)
    ds_read_b64_tr_b16 a[98:99], v3 offset:37024
    v_cvt_pk_bf16_f32 v49, v34, v35
    v_mfma_f32_16x16x32_bf16 v[16:19], a[72:75], v[144:147], v[16:19]
    ds_read_b64_tr_b16 a[100:101], v3 offset:37152
    v_cvt_pk_bf16_f32 v50, v40, v41
    v_mfma_f32_16x16x32_bf16 v[16:19], a[76:79], v[152:155], v[16:19]
    s_waitcnt lgkmcnt(7)
    ds_read_b64_tr_b16 a[102:103], v3 offset:37280
    v_cvt_pk_bf16_f32 v51, v42, v43
    v_mfma_f32_16x16x32_bf16 v[16:19], a[80:83], v[192:195], v[16:19]
    s_mov_b32 s54, 2048
    ds_read_b64_tr_b16 a[104:105], v3 offset:37408
    ds_read_b64_tr_b16 a[106:107], v3 offset:37536
    v_mfma_f32_16x16x32_bf16 v[16:19], a[84:87], v[200:203], v[16:19]
    s_waitcnt lgkmcnt(6)
    v_permlane32_swap_b32 v48, v50
    v_mfma_f32_16x16x32_bf16 v[16:19], a[88:91], v[208:211], v[16:19]
    v_permlane32_swap_b32 v49, v51
    v_mfma_f32_16x16x32_bf16 v[16:19], a[92:95], v[216:219], v[16:19]
    ds_read_b64_tr_b16 a[108:109], v3 offset:37664
    ds_read_b64_tr_b16 a[110:111], v3 offset:37792
    buffer_store_dwordx4 v[48:51], v10, s[40:43], s54 offen offset:512 sc1
    v_mfma_f32_16x16x32_bf16 v[20:23], a[64:67], v[160:163], 0
    ds_read_b64_tr_b16 a[112:113], v3 offset:53792
    v_cvt_pk_bf16_f32 v52, v36, v37
    v_mfma_f32_16x16x32_bf16 v[20:23], a[68:71], v[168:171], v[20:23]
    ds_read_b64_tr_b16 a[114:115], v3 offset:53920
    v_cvt_pk_bf16_f32 v53, v38, v39
    v_mfma_f32_16x16x32_bf16 v[20:23], a[72:75], v[176:179], v[20:23]
    ds_read_b64_tr_b16 a[116:117], v3 offset:54048
    v_cvt_pk_bf16_f32 v54, v44, v45
    v_mfma_f32_16x16x32_bf16 v[20:23], a[76:79], v[184:187], v[20:23]
    ds_read_b64_tr_b16 a[118:119], v3 offset:54176
    v_cvt_pk_bf16_f32 v55, v46, v47
    v_mfma_f32_16x16x32_bf16 v[20:23], a[80:83], v[224:227], v[20:23]
    s_mov_b32 s54, 296960
    ds_read_b64_tr_b16 a[120:121], v3 offset:54304
    ds_read_b64_tr_b16 a[122:123], v3 offset:54432
    v_mfma_f32_16x16x32_bf16 v[20:23], a[84:87], v[232:235], v[20:23]
    v_permlane32_swap_b32 v52, v54
    v_mfma_f32_16x16x32_bf16 v[20:23], a[88:91], v[240:243], v[20:23]
    v_permlane32_swap_b32 v53, v55
    v_mfma_f32_16x16x32_bf16 v[20:23], a[92:95], v[248:251], v[20:23]
    s_waitcnt lgkmcnt(10)
    ds_read_b64_tr_b16 a[124:125], v3 offset:54560
    ds_read_b64_tr_b16 a[126:127], v3 offset:54688
    buffer_store_dwordx4 v[52:55], v10, s[40:43], s54 offen offset:512 sc1
    v_mfma_f32_16x16x32_bf16 v[24:27], a[96:99], v[128:131], 0
    ds_read_b64_tr_b16 a[64:65], v3 offset:36928
    v_add_u32 v111, s3, v111
    v_mfma_f32_16x16x32_bf16 v[24:27], a[100:103], v[136:139], v[24:27]
    s_waitcnt lgkmcnt(9)
    ds_read_b64_tr_b16 a[66:67], v3 offset:37056
    v_mfma_f32_16x16x32_bf16 v[24:27], a[104:107], v[144:147], v[24:27]
    ds_read_b64_tr_b16 a[68:69], v3 offset:37184
    v_mfma_f32_16x16x32_bf16 v[24:27], a[108:111], v[152:155], v[24:27]
    s_waitcnt lgkmcnt(7)
    ds_read_b64_tr_b16 a[70:71], v3 offset:37312
    v_mfma_f32_16x16x32_bf16 v[24:27], a[112:115], v[192:195], v[24:27]
    ds_read_b64_tr_b16 a[72:73], v3 offset:37440
    v_mfma_f32_16x16x32_bf16 v[24:27], a[116:119], v[200:203], v[24:27]
    s_waitcnt lgkmcnt(5)
    ds_read_b64_tr_b16 a[74:75], v3 offset:37568
    v_mfma_f32_16x16x32_bf16 v[24:27], a[120:123], v[208:211], v[24:27]
    ds_read_b64_tr_b16 a[76:77], v3 offset:37696
    v_mfma_f32_16x16x32_bf16 v[24:27], a[124:127], v[216:219], v[24:27]
    ds_read_b64_tr_b16 a[78:79], v3 offset:37824
    v_mfma_f32_16x16x32_bf16 v[28:31], a[96:99], v[160:163], 0
    ds_read_b64_tr_b16 a[80:81], v3 offset:53824
    v_mfma_f32_16x16x32_bf16 v[28:31], a[100:103], v[168:171], v[28:31]
    ds_read_b64_tr_b16 a[82:83], v3 offset:53952
    v_mfma_f32_16x16x32_bf16 v[28:31], a[104:107], v[176:179], v[28:31]
    ds_read_b64_tr_b16 a[84:85], v3 offset:54080
    v_mfma_f32_16x16x32_bf16 v[28:31], a[108:111], v[184:187], v[28:31]
    ds_read_b64_tr_b16 a[86:87], v3 offset:54208
    v_mfma_f32_16x16x32_bf16 v[28:31], a[112:115], v[224:227], v[28:31]
    ds_read_b64_tr_b16 a[88:89], v3 offset:54336
    v_mfma_f32_16x16x32_bf16 v[28:31], a[116:119], v[232:235], v[28:31]
    ds_read_b64_tr_b16 a[90:91], v3 offset:54464
    v_mfma_f32_16x16x32_bf16 v[28:31], a[120:123], v[240:243], v[28:31]
    ds_read_b64_tr_b16 a[92:93], v3 offset:54592
    v_mfma_f32_16x16x32_bf16 v[28:31], a[124:127], v[248:251], v[28:31]
    s_waitcnt lgkmcnt(11)
    ds_read_b64_tr_b16 a[94:95], v3 offset:54720
    v_mfma_f32_16x16x32_bf16 v[32:35], a[64:67], v[128:131], 0
    ds_read_b64_tr_b16 a[96:97], v3 offset:36960
    v_cvt_pk_bf16_f32 v48, v16, v17
    v_mfma_f32_16x16x32_bf16 v[32:35], a[68:71], v[136:139], v[32:35]
    s_waitcnt lgkmcnt(9)
    ds_read_b64_tr_b16 a[98:99], v3 offset:37088
    v_cvt_pk_bf16_f32 v49, v18, v19
    v_mfma_f32_16x16x32_bf16 v[32:35], a[72:75], v[144:147], v[32:35]
    ds_read_b64_tr_b16 a[100:101], v3 offset:37216
    v_cvt_pk_bf16_f32 v50, v24, v25
    v_mfma_f32_16x16x32_bf16 v[32:35], a[76:79], v[152:155], v[32:35]
    s_waitcnt lgkmcnt(7)
    ds_read_b64_tr_b16 a[102:103], v3 offset:37344
    v_cvt_pk_bf16_f32 v51, v26, v27
    v_mfma_f32_16x16x32_bf16 v[32:35], a[80:83], v[192:195], v[32:35]
    s_mov_b32 s54, 3072
    ds_read_b64_tr_b16 a[104:105], v3 offset:37472
    ds_read_b64_tr_b16 a[106:107], v3 offset:37600
    v_mfma_f32_16x16x32_bf16 v[32:35], a[84:87], v[200:203], v[32:35]
    s_waitcnt lgkmcnt(6)
    v_permlane32_swap_b32 v48, v50
    v_mfma_f32_16x16x32_bf16 v[32:35], a[88:91], v[208:211], v[32:35]
    v_permlane32_swap_b32 v49, v51
    v_mfma_f32_16x16x32_bf16 v[32:35], a[92:95], v[216:219], v[32:35]
    ds_read_b64_tr_b16 a[108:109], v3 offset:37728
    ds_read_b64_tr_b16 a[110:111], v3 offset:37856
    buffer_store_dwordx4 v[48:51], v10, s[40:43], s54 offen offset:0 sc1
    v_mfma_f32_16x16x32_bf16 v[36:39], a[64:67], v[160:163], 0
    ds_read_b64_tr_b16 a[112:113], v3 offset:53856
    v_cvt_pk_bf16_f32 v52, v20, v21
    v_mfma_f32_16x16x32_bf16 v[36:39], a[68:71], v[168:171], v[36:39]
    ds_read_b64_tr_b16 a[114:115], v3 offset:53984
    v_cvt_pk_bf16_f32 v53, v22, v23
    v_mfma_f32_16x16x32_bf16 v[36:39], a[72:75], v[176:179], v[36:39]
    ds_read_b64_tr_b16 a[116:117], v3 offset:54112
    v_cvt_pk_bf16_f32 v54, v28, v29
    v_mfma_f32_16x16x32_bf16 v[36:39], a[76:79], v[184:187], v[36:39]
    ds_read_b64_tr_b16 a[118:119], v3 offset:54240
    v_cvt_pk_bf16_f32 v55, v30, v31
    v_mfma_f32_16x16x32_bf16 v[36:39], a[80:83], v[224:227], v[36:39]
    s_mov_b32 s54, 297984
    ds_read_b64_tr_b16 a[120:121], v3 offset:54368
    ds_read_b64_tr_b16 a[122:123], v3 offset:54496
    v_mfma_f32_16x16x32_bf16 v[36:39], a[84:87], v[232:235], v[36:39]
    v_permlane32_swap_b32 v52, v54
    v_mfma_f32_16x16x32_bf16 v[36:39], a[88:91], v[240:243], v[36:39]
    v_permlane32_swap_b32 v53, v55
    v_mfma_f32_16x16x32_bf16 v[36:39], a[92:95], v[248:251], v[36:39]
    s_waitcnt vmcnt(15)
    s_barrier
    s_waitcnt lgkmcnt(10)
    ds_read_b64_tr_b16 a[124:125], v3 offset:54624
    ds_read_b64_tr_b16 a[126:127], v3 offset:54752
    buffer_store_dwordx4 v[52:55], v10, s[40:43], s54 offen offset:0 sc1
    v_mfma_f32_16x16x32_bf16 v[40:43], a[96:99], v[128:131], 0
    s_add_u32 m0, s44, 0
    ds_read_b64_tr_b16 a[64:65], v4 offset:0
    ds_read_b64_tr_b16 a[66:67], v4 offset:128
    v_mfma_f32_16x16x32_bf16 v[40:43], a[100:103], v[136:139], v[40:43]
    s_mov_b32 s45, 768
    s_waitcnt lgkmcnt(10)
    buffer_load_dwordx4 v7, s[28:31], s45 offen offset:0 lds
    v_mfma_f32_16x16x32_bf16 v[40:43], a[104:107], v[144:147], v[40:43]
    s_add_u32 m0, s44, -96
    ds_read_b64_tr_b16 a[68:69], v4 offset:256
    ds_read_b64_tr_b16 a[70:71], v4 offset:384
    v_mfma_f32_16x16x32_bf16 v[40:43], a[108:111], v[152:155], v[40:43]
    s_waitcnt lgkmcnt(8)
    buffer_load_dwordx4 v7, s[28:31], s45 offen offset:1152 lds
    v_mfma_f32_16x16x32_bf16 v[40:43], a[112:115], v[192:195], v[40:43]
    s_add_u32 m0, s44, -192
    ds_read_b64_tr_b16 a[72:73], v4 offset:512
    ds_read_b64_tr_b16 a[74:75], v4 offset:640
    v_mfma_f32_16x16x32_bf16 v[40:43], a[116:119], v[200:203], v[40:43]
    s_waitcnt lgkmcnt(6)
    buffer_load_dwordx4 v7, s[28:31], s45 offen offset:2304 lds
    v_mfma_f32_16x16x32_bf16 v[40:43], a[120:123], v[208:211], v[40:43]
    s_add_u32 m0, s44, -288
    ds_read_b64_tr_b16 a[76:77], v4 offset:768
    ds_read_b64_tr_b16 a[78:79], v4 offset:896
    v_mfma_f32_16x16x32_bf16 v[40:43], a[124:127], v[216:219], v[40:43]
    buffer_load_dwordx4 v7, s[28:31], s45 offen offset:3456 lds
    v_mfma_f32_16x16x32_bf16 v[44:47], a[96:99], v[160:163], 0
    s_add_u32 m0, s44, 16896
    ds_read_b64_tr_b16 a[80:81], v4 offset:16896
    ds_read_b64_tr_b16 a[82:83], v4 offset:17024
    v_mfma_f32_16x16x32_bf16 v[44:47], a[100:103], v[168:171], v[44:47]
    s_mov_b32 s45, 148224
    buffer_load_dwordx4 v7, s[28:31], s45 offen offset:0 lds
    v_mfma_f32_16x16x32_bf16 v[44:47], a[104:107], v[176:179], v[44:47]
    s_add_u32 m0, s44, 16800
    ds_read_b64_tr_b16 a[84:85], v4 offset:17152
    ds_read_b64_tr_b16 a[86:87], v4 offset:17280
    v_mfma_f32_16x16x32_bf16 v[44:47], a[108:111], v[184:187], v[44:47]
    buffer_load_dwordx4 v7, s[28:31], s45 offen offset:1152 lds
    v_mfma_f32_16x16x32_bf16 v[44:47], a[112:115], v[224:227], v[44:47]
    s_add_u32 m0, s44, 16704
    ds_read_b64_tr_b16 a[88:89], v4 offset:17408
    ds_read_b64_tr_b16 a[90:91], v4 offset:17536
    v_mfma_f32_16x16x32_bf16 v[44:47], a[116:119], v[232:235], v[44:47]
    buffer_load_dwordx4 v7, s[28:31], s45 offen offset:2304 lds
    v_mfma_f32_16x16x32_bf16 v[44:47], a[120:123], v[240:243], v[44:47]
    s_add_u32 m0, s44, 16608
    ds_read_b64_tr_b16 a[92:93], v4 offset:17664
    ds_read_b64_tr_b16 a[94:95], v4 offset:17792
    v_mfma_f32_16x16x32_bf16 v[44:47], a[124:127], v[248:251], v[44:47]
    s_waitcnt lgkmcnt(12)
    buffer_load_dwordx4 v7, s[28:31], s45 offen offset:3456 lds
    v_mfma_f32_16x16x32_bf16 v[16:19], a[64:67], v[128:131], 0
    ds_read_b64_tr_b16 a[96:97], v4 offset:32
    v_cvt_pk_bf16_f32 v48, v32, v33
    v_mfma_f32_16x16x32_bf16 v[16:19], a[68:71], v[136:139], v[16:19]
    s_waitcnt lgkmcnt(9)
    ds_read_b64_tr_b16 a[98:99], v4 offset:160
    v_cvt_pk_bf16_f32 v49, v34, v35
    v_mfma_f32_16x16x32_bf16 v[16:19], a[72:75], v[144:147], v[16:19]
    ds_read_b64_tr_b16 a[100:101], v4 offset:288
    v_cvt_pk_bf16_f32 v50, v40, v41
    v_mfma_f32_16x16x32_bf16 v[16:19], a[76:79], v[152:155], v[16:19]
    s_waitcnt lgkmcnt(7)
    ds_read_b64_tr_b16 a[102:103], v4 offset:416
    v_cvt_pk_bf16_f32 v51, v42, v43
    v_mfma_f32_16x16x32_bf16 v[16:19], a[80:83], v[192:195], v[16:19]
    s_mov_b32 s54, 3072
    ds_read_b64_tr_b16 a[104:105], v4 offset:544
    ds_read_b64_tr_b16 a[106:107], v4 offset:672
    v_mfma_f32_16x16x32_bf16 v[16:19], a[84:87], v[200:203], v[16:19]
    s_waitcnt lgkmcnt(6)
    v_permlane32_swap_b32 v48, v50
    v_mfma_f32_16x16x32_bf16 v[16:19], a[88:91], v[208:211], v[16:19]
    v_permlane32_swap_b32 v49, v51
    v_mfma_f32_16x16x32_bf16 v[16:19], a[92:95], v[216:219], v[16:19]
    ds_read_b64_tr_b16 a[108:109], v4 offset:800
    ds_read_b64_tr_b16 a[110:111], v4 offset:928
    buffer_store_dwordx4 v[48:51], v10, s[40:43], s54 offen offset:512 sc1
    v_mfma_f32_16x16x32_bf16 v[20:23], a[64:67], v[160:163], 0
    ds_read_b64_tr_b16 a[112:113], v4 offset:16928
    v_cvt_pk_bf16_f32 v52, v36, v37
    v_mfma_f32_16x16x32_bf16 v[20:23], a[68:71], v[168:171], v[20:23]
    ds_read_b64_tr_b16 a[114:115], v4 offset:17056
    v_cvt_pk_bf16_f32 v53, v38, v39
    v_mfma_f32_16x16x32_bf16 v[20:23], a[72:75], v[176:179], v[20:23]
    ds_read_b64_tr_b16 a[116:117], v4 offset:17184
    v_cvt_pk_bf16_f32 v54, v44, v45
    v_mfma_f32_16x16x32_bf16 v[20:23], a[76:79], v[184:187], v[20:23]
    ds_read_b64_tr_b16 a[118:119], v4 offset:17312
    v_cvt_pk_bf16_f32 v55, v46, v47
    v_mfma_f32_16x16x32_bf16 v[20:23], a[80:83], v[224:227], v[20:23]
    s_mov_b32 s54, 297984
    ds_read_b64_tr_b16 a[120:121], v4 offset:17440
    ds_read_b64_tr_b16 a[122:123], v4 offset:17568
    v_mfma_f32_16x16x32_bf16 v[20:23], a[84:87], v[232:235], v[20:23]
    v_permlane32_swap_b32 v52, v54
    v_mfma_f32_16x16x32_bf16 v[20:23], a[88:91], v[240:243], v[20:23]
    v_permlane32_swap_b32 v53, v55
    v_mfma_f32_16x16x32_bf16 v[20:23], a[92:95], v[248:251], v[20:23]
    s_waitcnt lgkmcnt(10)
    ds_read_b64_tr_b16 a[124:125], v4 offset:17696
    ds_read_b64_tr_b16 a[126:127], v4 offset:17824
    buffer_store_dwordx4 v[52:55], v10, s[40:43], s54 offen offset:512 sc1
    v_mfma_f32_16x16x32_bf16 v[24:27], a[96:99], v[128:131], 0
    ds_read_b64_tr_b16 a[64:65], v4 offset:64
    v_mfma_f32_16x16x32_bf16 v[24:27], a[100:103], v[136:139], v[24:27]
    s_waitcnt lgkmcnt(9)
    ds_read_b64_tr_b16 a[66:67], v4 offset:192
    v_mfma_f32_16x16x32_bf16 v[24:27], a[104:107], v[144:147], v[24:27]
    ds_read_b64_tr_b16 a[68:69], v4 offset:320
    v_mfma_f32_16x16x32_bf16 v[24:27], a[108:111], v[152:155], v[24:27]
    s_waitcnt lgkmcnt(7)
    ds_read_b64_tr_b16 a[70:71], v4 offset:448
    v_mfma_f32_16x16x32_bf16 v[24:27], a[112:115], v[192:195], v[24:27]
    ds_read_b64_tr_b16 a[72:73], v4 offset:576
    v_mfma_f32_16x16x32_bf16 v[24:27], a[116:119], v[200:203], v[24:27]
    s_waitcnt lgkmcnt(5)
    ds_read_b64_tr_b16 a[74:75], v4 offset:704
    v_mfma_f32_16x16x32_bf16 v[24:27], a[120:123], v[208:211], v[24:27]
    ds_read_b64_tr_b16 a[76:77], v4 offset:832
    v_mfma_f32_16x16x32_bf16 v[24:27], a[124:127], v[216:219], v[24:27]
    ds_read_b64_tr_b16 a[78:79], v4 offset:960
    v_mfma_f32_16x16x32_bf16 v[28:31], a[96:99], v[160:163], 0
    ds_read_b64_tr_b16 a[80:81], v4 offset:16960
    v_mfma_f32_16x16x32_bf16 v[28:31], a[100:103], v[168:171], v[28:31]
    ds_read_b64_tr_b16 a[82:83], v4 offset:17088
    v_mfma_f32_16x16x32_bf16 v[28:31], a[104:107], v[176:179], v[28:31]
    ds_read_b64_tr_b16 a[84:85], v4 offset:17216
    v_mfma_f32_16x16x32_bf16 v[28:31], a[108:111], v[184:187], v[28:31]
    ds_read_b64_tr_b16 a[86:87], v4 offset:17344
    v_mfma_f32_16x16x32_bf16 v[28:31], a[112:115], v[224:227], v[28:31]
    ds_read_b64_tr_b16 a[88:89], v4 offset:17472
    v_mfma_f32_16x16x32_bf16 v[28:31], a[116:119], v[232:235], v[28:31]
    ds_read_b64_tr_b16 a[90:91], v4 offset:17600
    v_mfma_f32_16x16x32_bf16 v[28:31], a[120:123], v[240:243], v[28:31]
    ds_read_b64_tr_b16 a[92:93], v4 offset:17728
    v_mfma_f32_16x16x32_bf16 v[28:31], a[124:127], v[248:251], v[28:31]
    s_waitcnt lgkmcnt(11)
    ds_read_b64_tr_b16 a[94:95], v4 offset:17856
    v_mfma_f32_16x16x32_bf16 v[32:35], a[64:67], v[128:131], 0
    ds_read_b64_tr_b16 a[96:97], v4 offset:96
    v_cvt_pk_bf16_f32 v48, v16, v17
    v_mfma_f32_16x16x32_bf16 v[32:35], a[68:71], v[136:139], v[32:35]
    s_waitcnt lgkmcnt(9)
    ds_read_b64_tr_b16 a[98:99], v4 offset:224
    v_cvt_pk_bf16_f32 v49, v18, v19
    v_mfma_f32_16x16x32_bf16 v[32:35], a[72:75], v[144:147], v[32:35]
    ds_read_b64_tr_b16 a[100:101], v4 offset:352
    v_cvt_pk_bf16_f32 v50, v24, v25
    v_mfma_f32_16x16x32_bf16 v[32:35], a[76:79], v[152:155], v[32:35]
    s_waitcnt lgkmcnt(7)
    ds_read_b64_tr_b16 a[102:103], v4 offset:480
    v_cvt_pk_bf16_f32 v51, v26, v27
    v_mfma_f32_16x16x32_bf16 v[32:35], a[80:83], v[192:195], v[32:35]
    s_mov_b32 s54, 4096
    ds_read_b64_tr_b16 a[104:105], v4 offset:608
    ds_read_b64_tr_b16 a[106:107], v4 offset:736
    v_mfma_f32_16x16x32_bf16 v[32:35], a[84:87], v[200:203], v[32:35]
    s_waitcnt lgkmcnt(6)
    v_permlane32_swap_b32 v48, v50
    v_mfma_f32_16x16x32_bf16 v[32:35], a[88:91], v[208:211], v[32:35]
    v_permlane32_swap_b32 v49, v51
    v_mfma_f32_16x16x32_bf16 v[32:35], a[92:95], v[216:219], v[32:35]
    ds_read_b64_tr_b16 a[108:109], v4 offset:864
    ds_read_b64_tr_b16 a[110:111], v4 offset:992
    buffer_store_dwordx4 v[48:51], v10, s[40:43], s54 offen offset:0 sc1
    v_mfma_f32_16x16x32_bf16 v[36:39], a[64:67], v[160:163], 0
    ds_read_b64_tr_b16 a[112:113], v4 offset:16992
    v_cvt_pk_bf16_f32 v52, v20, v21
    v_mfma_f32_16x16x32_bf16 v[36:39], a[68:71], v[168:171], v[36:39]
    ds_read_b64_tr_b16 a[114:115], v4 offset:17120
    v_cvt_pk_bf16_f32 v53, v22, v23
    v_mfma_f32_16x16x32_bf16 v[36:39], a[72:75], v[176:179], v[36:39]
    ds_read_b64_tr_b16 a[116:117], v4 offset:17248
    v_cvt_pk_bf16_f32 v54, v28, v29
    v_mfma_f32_16x16x32_bf16 v[36:39], a[76:79], v[184:187], v[36:39]
    ds_read_b64_tr_b16 a[118:119], v4 offset:17376
    v_cvt_pk_bf16_f32 v55, v30, v31
    v_mfma_f32_16x16x32_bf16 v[36:39], a[80:83], v[224:227], v[36:39]
    s_mov_b32 s54, 299008
    ds_read_b64_tr_b16 a[120:121], v4 offset:17504
    ds_read_b64_tr_b16 a[122:123], v4 offset:17632
    v_mfma_f32_16x16x32_bf16 v[36:39], a[84:87], v[232:235], v[36:39]
    v_permlane32_swap_b32 v52, v54
    v_mfma_f32_16x16x32_bf16 v[36:39], a[88:91], v[240:243], v[36:39]
    v_permlane32_swap_b32 v53, v55
    v_mfma_f32_16x16x32_bf16 v[36:39], a[92:95], v[248:251], v[36:39]
    s_waitcnt vmcnt(15)
    s_barrier
    s_waitcnt lgkmcnt(10)
    ds_read_b64_tr_b16 a[124:125], v4 offset:17760
    ds_read_b64_tr_b16 a[126:127], v4 offset:17888
    buffer_store_dwordx4 v[52:55], v10, s[40:43], s54 offen offset:0 sc1
    v_mfma_f32_16x16x32_bf16 v[40:43], a[96:99], v[128:131], 0
    s_add_u32 m0, s44, 36864
    ds_read_b64_tr_b16 a[64:65], v4 offset:36864
    ds_read_b64_tr_b16 a[66:67], v4 offset:36992
    v_mfma_f32_16x16x32_bf16 v[40:43], a[100:103], v[136:139], v[40:43]
    s_mov_b32 s45, 896
    s_waitcnt lgkmcnt(10)
    buffer_load_dwordx4 v7, s[28:31], s45 offen offset:0 lds
    v_mfma_f32_16x16x32_bf16 v[40:43], a[104:107], v[144:147], v[40:43]
    s_add_u32 m0, s44, 36768
    ds_read_b64_tr_b16 a[68:69], v4 offset:37120
    ds_read_b64_tr_b16 a[70:71], v4 offset:37248
    v_mfma_f32_16x16x32_bf16 v[40:43], a[108:111], v[152:155], v[40:43]
    s_waitcnt lgkmcnt(8)
    buffer_load_dwordx4 v7, s[28:31], s45 offen offset:1152 lds
    v_mfma_f32_16x16x32_bf16 v[40:43], a[112:115], v[192:195], v[40:43]
    s_add_u32 m0, s44, 36672
    ds_read_b64_tr_b16 a[72:73], v4 offset:37376
    ds_read_b64_tr_b16 a[74:75], v4 offset:37504
    v_mfma_f32_16x16x32_bf16 v[40:43], a[116:119], v[200:203], v[40:43]
    s_waitcnt lgkmcnt(6)
    buffer_load_dwordx4 v7, s[28:31], s45 offen offset:2304 lds
    v_mfma_f32_16x16x32_bf16 v[40:43], a[120:123], v[208:211], v[40:43]
    s_add_u32 m0, s44, 36576
    ds_read_b64_tr_b16 a[76:77], v4 offset:37632
    ds_read_b64_tr_b16 a[78:79], v4 offset:37760
    v_mfma_f32_16x16x32_bf16 v[40:43], a[124:127], v[216:219], v[40:43]
    buffer_load_dwordx4 v7, s[28:31], s45 offen offset:3456 lds
    v_mfma_f32_16x16x32_bf16 v[44:47], a[96:99], v[160:163], 0
    s_add_u32 m0, s44, 53760
    ds_read_b64_tr_b16 a[80:81], v4 offset:53760
    ds_read_b64_tr_b16 a[82:83], v4 offset:53888
    v_mfma_f32_16x16x32_bf16 v[44:47], a[100:103], v[168:171], v[44:47]
    s_mov_b32 s45, 148352
    buffer_load_dwordx4 v7, s[28:31], s45 offen offset:0 lds
    v_mfma_f32_16x16x32_bf16 v[44:47], a[104:107], v[176:179], v[44:47]
    s_add_u32 m0, s44, 53664
    ds_read_b64_tr_b16 a[84:85], v4 offset:54016
    ds_read_b64_tr_b16 a[86:87], v4 offset:54144
    v_mfma_f32_16x16x32_bf16 v[44:47], a[108:111], v[184:187], v[44:47]
    buffer_load_dwordx4 v7, s[28:31], s45 offen offset:1152 lds
    v_mfma_f32_16x16x32_bf16 v[44:47], a[112:115], v[224:227], v[44:47]
    s_add_u32 m0, s44, 53568
    ds_read_b64_tr_b16 a[88:89], v4 offset:54272
    ds_read_b64_tr_b16 a[90:91], v4 offset:54400
    v_mfma_f32_16x16x32_bf16 v[44:47], a[116:119], v[232:235], v[44:47]
    buffer_load_dwordx4 v7, s[28:31], s45 offen offset:2304 lds
    v_mfma_f32_16x16x32_bf16 v[44:47], a[120:123], v[240:243], v[44:47]
    s_add_u32 m0, s44, 53472
    ds_read_b64_tr_b16 a[92:93], v4 offset:54528
    ds_read_b64_tr_b16 a[94:95], v4 offset:54656
    v_mfma_f32_16x16x32_bf16 v[44:47], a[124:127], v[248:251], v[44:47]
    s_waitcnt lgkmcnt(12)
    buffer_load_dwordx4 v7, s[28:31], s45 offen offset:3456 lds
    v_mfma_f32_16x16x32_bf16 v[16:19], a[64:67], v[128:131], 0
    ds_read_b64_tr_b16 a[96:97], v4 offset:36896
    v_cvt_pk_bf16_f32 v48, v32, v33
    v_mfma_f32_16x16x32_bf16 v[16:19], a[68:71], v[136:139], v[16:19]
    s_waitcnt lgkmcnt(9)
    ds_read_b64_tr_b16 a[98:99], v4 offset:37024
    v_cvt_pk_bf16_f32 v49, v34, v35
    v_mfma_f32_16x16x32_bf16 v[16:19], a[72:75], v[144:147], v[16:19]
    ds_read_b64_tr_b16 a[100:101], v4 offset:37152
    v_cvt_pk_bf16_f32 v50, v40, v41
    v_mfma_f32_16x16x32_bf16 v[16:19], a[76:79], v[152:155], v[16:19]
    s_waitcnt lgkmcnt(7)
    ds_read_b64_tr_b16 a[102:103], v4 offset:37280
    v_cvt_pk_bf16_f32 v51, v42, v43
    v_mfma_f32_16x16x32_bf16 v[16:19], a[80:83], v[192:195], v[16:19]
    s_mov_b32 s54, 4096
    ds_read_b64_tr_b16 a[104:105], v4 offset:37408
    ds_read_b64_tr_b16 a[106:107], v4 offset:37536
    v_mfma_f32_16x16x32_bf16 v[16:19], a[84:87], v[200:203], v[16:19]
    s_waitcnt lgkmcnt(6)
    v_permlane32_swap_b32 v48, v50
    v_mfma_f32_16x16x32_bf16 v[16:19], a[88:91], v[208:211], v[16:19]
    v_permlane32_swap_b32 v49, v51
    v_mfma_f32_16x16x32_bf16 v[16:19], a[92:95], v[216:219], v[16:19]
    ds_read_b64_tr_b16 a[108:109], v4 offset:37664
    ds_read_b64_tr_b16 a[110:111], v4 offset:37792
    buffer_store_dwordx4 v[48:51], v10, s[40:43], s54 offen offset:512 sc1
    v_mfma_f32_16x16x32_bf16 v[20:23], a[64:67], v[160:163], 0
    ds_read_b64_tr_b16 a[112:113], v4 offset:53792
    v_cvt_pk_bf16_f32 v52, v36, v37
    v_mfma_f32_16x16x32_bf16 v[20:23], a[68:71], v[168:171], v[20:23]
    ds_read_b64_tr_b16 a[114:115], v4 offset:53920
    v_cvt_pk_bf16_f32 v53, v38, v39
    v_mfma_f32_16x16x32_bf16 v[20:23], a[72:75], v[176:179], v[20:23]
    ds_read_b64_tr_b16 a[116:117], v4 offset:54048
    v_cvt_pk_bf16_f32 v54, v44, v45
    v_mfma_f32_16x16x32_bf16 v[20:23], a[76:79], v[184:187], v[20:23]
    ds_read_b64_tr_b16 a[118:119], v4 offset:54176
    v_cvt_pk_bf16_f32 v55, v46, v47
    v_mfma_f32_16x16x32_bf16 v[20:23], a[80:83], v[224:227], v[20:23]
    s_mov_b32 s54, 299008
    ds_read_b64_tr_b16 a[120:121], v4 offset:54304
    ds_read_b64_tr_b16 a[122:123], v4 offset:54432
    v_mfma_f32_16x16x32_bf16 v[20:23], a[84:87], v[232:235], v[20:23]
    v_permlane32_swap_b32 v52, v54
    v_mfma_f32_16x16x32_bf16 v[20:23], a[88:91], v[240:243], v[20:23]
    v_permlane32_swap_b32 v53, v55
    v_mfma_f32_16x16x32_bf16 v[20:23], a[92:95], v[248:251], v[20:23]
    s_waitcnt lgkmcnt(10)
    ds_read_b64_tr_b16 a[124:125], v4 offset:54560
    ds_read_b64_tr_b16 a[126:127], v4 offset:54688
    buffer_store_dwordx4 v[52:55], v10, s[40:43], s54 offen offset:512 sc1
    v_mfma_f32_16x16x32_bf16 v[24:27], a[96:99], v[128:131], 0
    ds_read_b64_tr_b16 a[64:65], v4 offset:36928
    v_mfma_f32_16x16x32_bf16 v[24:27], a[100:103], v[136:139], v[24:27]
    s_waitcnt lgkmcnt(9)
    ds_read_b64_tr_b16 a[66:67], v4 offset:37056
    v_mfma_f32_16x16x32_bf16 v[24:27], a[104:107], v[144:147], v[24:27]
L2_pad12:
    s_cbranch_execz L2_walkret
    ds_read_b64_tr_b16 a[68:69], v4 offset:37184
    v_mfma_f32_16x16x32_bf16 v[24:27], a[108:111], v[152:155], v[24:27]
    s_waitcnt lgkmcnt(7)
    ds_read_b64_tr_b16 a[70:71], v4 offset:37312
    v_mfma_f32_16x16x32_bf16 v[24:27], a[112:115], v[192:195], v[24:27]
    ds_read_b64_tr_b16 a[72:73], v4 offset:37440
    v_mfma_f32_16x16x32_bf16 v[24:27], a[116:119], v[200:203], v[24:27]
    s_waitcnt lgkmcnt(5)
    ds_read_b64_tr_b16 a[74:75], v4 offset:37568
    v_mfma_f32_16x16x32_bf16 v[24:27], a[120:123], v[208:211], v[24:27]
    ds_read_b64_tr_b16 a[76:77], v4 offset:37696
    v_mfma_f32_16x16x32_bf16 v[24:27], a[124:127], v[216:219], v[24:27]
    ds_read_b64_tr_b16 a[78:79], v4 offset:37824
    v_mfma_f32_16x16x32_bf16 v[28:31], a[96:99], v[160:163], 0
    ds_read_b64_tr_b16 a[80:81], v4 offset:53824
    v_mfma_f32_16x16x32_bf16 v[28:31], a[100:103], v[168:171], v[28:31]
    ds_read_b64_tr_b16 a[82:83], v4 offset:53952
    v_mfma_f32_16x16x32_bf16 v[28:31], a[104:107], v[176:179], v[28:31]
    ds_read_b64_tr_b16 a[84:85], v4 offset:54080
    v_mfma_f32_16x16x32_bf16 v[28:31], a[108:111], v[184:187], v[28:31]
    ds_read_b64_tr_b16 a[86:87], v4 offset:54208
    v_mfma_f32_16x16x32_bf16 v[28:31], a[112:115], v[224:227], v[28:31]
    ds_read_b64_tr_b16 a[88:89], v4 offset:54336
    v_mfma_f32_16x16x32_bf16 v[28:31], a[116:119], v[232:235], v[28:31]
    ds_read_b64_tr_b16 a[90:91], v4 offset:54464
    v_mfma_f32_16x16x32_bf16 v[28:31], a[120:123], v[240:243], v[28:31]
    ds_read_b64_tr_b16 a[92:93], v4 offset:54592
    v_mfma_f32_16x16x32_bf16 v[28:31], a[124:127], v[248:251], v[28:31]
    s_waitcnt lgkmcnt(11)
    ds_read_b64_tr_b16 a[94:95], v4 offset:54720
    v_mfma_f32_16x16x32_bf16 v[32:35], a[64:67], v[128:131], 0
    ds_read_b64_tr_b16 a[96:97], v4 offset:36960
    v_cvt_pk_bf16_f32 v48, v16, v17
    v_mfma_f32_16x16x32_bf16 v[32:35], a[68:71], v[136:139], v[32:35]
    s_waitcnt lgkmcnt(9)
    ds_read_b64_tr_b16 a[98:99], v4 offset:37088
    v_cvt_pk_bf16_f32 v49, v18, v19
    v_mfma_f32_16x16x32_bf16 v[32:35], a[72:75], v[144:147], v[32:35]
    ds_read_b64_tr_b16 a[100:101], v4 offset:37216
    v_cvt_pk_bf16_f32 v50, v24, v25
    v_mfma_f32_16x16x32_bf16 v[32:35], a[76:79], v[152:155], v[32:35]
    s_waitcnt lgkmcnt(7)
    ds_read_b64_tr_b16 a[102:103], v4 offset:37344
    v_cvt_pk_bf16_f32 v51, v26, v27
    v_mfma_f32_16x16x32_bf16 v[32:35], a[80:83], v[192:195], v[32:35]
    s_mov_b32 s54, 5120
    ds_read_b64_tr_b16 a[104:105], v4 offset:37472
    ds_read_b64_tr_b16 a[106:107], v4 offset:37600
    v_mfma_f32_16x16x32_bf16 v[32:35], a[84:87], v[200:203], v[32:35]
    s_waitcnt lgkmcnt(6)
    v_permlane32_swap_b32 v48, v50
    v_mfma_f32_16x16x32_bf16 v[32:35], a[88:91], v[208:211], v[32:35]
    v_permlane32_swap_b32 v49, v51
    v_mfma_f32_16x16x32_bf16 v[32:35], a[92:95], v[216:219], v[32:35]
    ds_read_b64_tr_b16 a[108:109], v4 offset:37728
    ds_read_b64_tr_b16 a[110:111], v4 offset:37856
    buffer_store_dwordx4 v[48:51], v10, s[40:43], s54 offen offset:0 sc1
    v_mfma_f32_16x16x32_bf16 v[36:39], a[64:67], v[160:163], 0
    ds_read_b64_tr_b16 a[112:113], v4 offset:53856
    v_cvt_pk_bf16_f32 v52, v20, v21
    v_mfma_f32_16x16x32_bf16 v[36:39], a[68:71], v[168:171], v[36:39]
    ds_read_b64_tr_b16 a[114:115], v4 offset:53984
    v_cvt_pk_bf16_f32 v53, v22, v23
    v_mfma_f32_16x16x32_bf16 v[36:39], a[72:75], v[176:179], v[36:39]
    ds_read_b64_tr_b16 a[116:117], v4 offset:54112
    v_cvt_pk_bf16_f32 v54, v28, v29
    v_mfma_f32_16x16x32_bf16 v[36:39], a[76:79], v[184:187], v[36:39]
    ds_read_b64_tr_b16 a[118:119], v4 offset:54240
    v_cvt_pk_bf16_f32 v55, v30, v31
    v_mfma_f32_16x16x32_bf16 v[36:39], a[80:83], v[224:227], v[36:39]
    s_mov_b32 s54, 300032
    ds_read_b64_tr_b16 a[120:121], v4 offset:54368
    ds_read_b64_tr_b16 a[122:123], v4 offset:54496
    v_mfma_f32_16x16x32_bf16 v[36:39], a[84:87], v[232:235], v[36:39]
    v_permlane32_swap_b32 v52, v54
    v_mfma_f32_16x16x32_bf16 v[36:39], a[88:91], v[240:243], v[36:39]
    v_permlane32_swap_b32 v53, v55
    v_mfma_f32_16x16x32_bf16 v[36:39], a[92:95], v[248:251], v[36:39]
    s_waitcnt vmcnt(15)
    s_barrier
    s_waitcnt lgkmcnt(10)
    ds_read_b64_tr_b16 a[124:125], v4 offset:54624
    ds_read_b64_tr_b16 a[126:127], v4 offset:54752
    buffer_store_dwordx4 v[52:55], v10, s[40:43], s54 offen offset:0 sc1
    v_mfma_f32_16x16x32_bf16 v[40:43], a[96:99], v[128:131], 0
    s_add_u32 m0, s44, 73728
    ds_read_b64_tr_b16 a[64:65], v3 offset:0
    ds_read_b64_tr_b16 a[66:67], v3 offset:128
    v_mfma_f32_16x16x32_bf16 v[40:43], a[100:103], v[136:139], v[40:43]
    s_mov_b32 s45, 1024
    s_waitcnt lgkmcnt(10)
    buffer_load_dwordx4 v7, s[28:31], s45 offen offset:0 lds
    v_mfma_f32_16x16x32_bf16 v[40:43], a[104:107], v[144:147], v[40:43]
    s_add_u32 m0, s44, 73632
    ds_read_b64_tr_b16 a[68:69], v3 offset:256
    ds_read_b64_tr_b16 a[70:71], v3 offset:384
    v_mfma_f32_16x16x32_bf16 v[40:43], a[108:111], v[152:155], v[40:43]
    s_waitcnt lgkmcnt(8)
    buffer_load_dwordx4 v7, s[28:31], s45 offen offset:1152 lds
    v_mfma_f32_16x16x32_bf16 v[40:43], a[112:115], v[192:195], v[40:43]
    s_add_u32 m0, s44, 73536
    ds_read_b64_tr_b16 a[72:73], v3 offset:512
    ds_read_b64_tr_b16 a[74:75], v3 offset:640
    v_mfma_f32_16x16x32_bf16 v[40:43], a[116:119], v[200:203], v[40:43]
    s_waitcnt lgkmcnt(6)
    buffer_load_dwordx4 v7, s[28:31], s45 offen offset:2304 lds
    v_mfma_f32_16x16x32_bf16 v[40:43], a[120:123], v[208:211], v[40:43]
    s_add_u32 m0, s44, 73440
    ds_read_b64_tr_b16 a[76:77], v3 offset:768
    ds_read_b64_tr_b16 a[78:79], v3 offset:896
    v_mfma_f32_16x16x32_bf16 v[40:43], a[124:127], v[216:219], v[40:43]
    buffer_load_dwordx4 v7, s[28:31], s45 offen offset:3456 lds
    v_mfma_f32_16x16x32_bf16 v[44:47], a[96:99], v[160:163], 0
    s_add_u32 m0, s44, 90624
    ds_read_b64_tr_b16 a[80:81], v3 offset:16896
    ds_read_b64_tr_b16 a[82:83], v3 offset:17024
    v_mfma_f32_16x16x32_bf16 v[44:47], a[100:103], v[168:171], v[44:47]
    s_mov_b32 s45, 148480
    buffer_load_dwordx4 v7, s[28:31], s45 offen offset:0 lds
    v_mfma_f32_16x16x32_bf16 v[44:47], a[104:107], v[176:179], v[44:47]
    s_add_u32 m0, s44, 90528
    ds_read_b64_tr_b16 a[84:85], v3 offset:17152
    ds_read_b64_tr_b16 a[86:87], v3 offset:17280
    v_mfma_f32_16x16x32_bf16 v[44:47], a[108:111], v[184:187], v[44:47]
    buffer_load_dwordx4 v7, s[28:31], s45 offen offset:1152 lds
    v_mfma_f32_16x16x32_bf16 v[44:47], a[112:115], v[224:227], v[44:47]
    s_add_u32 m0, s44, 90432
    ds_read_b64_tr_b16 a[88:89], v3 offset:17408
    ds_read_b64_tr_b16 a[90:91], v3 offset:17536
    v_mfma_f32_16x16x32_bf16 v[44:47], a[116:119], v[232:235], v[44:47]
    buffer_load_dwordx4 v7, s[28:31], s45 offen offset:2304 lds
    v_mfma_f32_16x16x32_bf16 v[44:47], a[120:123], v[240:243], v[44:47]
    s_add_u32 m0, s44, 90336
    ds_read_b64_tr_b16 a[92:93], v3 offset:17664
    ds_read_b64_tr_b16 a[94:95], v3 offset:17792
    v_mfma_f32_16x16x32_bf16 v[44:47], a[124:127], v[248:251], v[44:47]
    s_waitcnt lgkmcnt(12)
    buffer_load_dwordx4 v7, s[28:31], s45 offen offset:3456 lds
    v_mfma_f32_16x16x32_bf16 v[16:19], a[64:67], v[128:131], 0
    ds_read_b64_tr_b16 a[96:97], v3 offset:32
    v_cvt_pk_bf16_f32 v48, v32, v33
    v_mfma_f32_16x16x32_bf16 v[16:19], a[68:71], v[136:139], v[16:19]
    s_waitcnt lgkmcnt(9)
    ds_read_b64_tr_b16 a[98:99], v3 offset:160
    v_cvt_pk_bf16_f32 v49, v34, v35
    v_mfma_f32_16x16x32_bf16 v[16:19], a[72:75], v[144:147], v[16:19]
    ds_read_b64_tr_b16 a[100:101], v3 offset:288
    v_cvt_pk_bf16_f32 v50, v40, v41
    v_mfma_f32_16x16x32_bf16 v[16:19], a[76:79], v[152:155], v[16:19]
    s_waitcnt lgkmcnt(7)
    ds_read_b64_tr_b16 a[102:103], v3 offset:416
    v_cvt_pk_bf16_f32 v51, v42, v43
    v_mfma_f32_16x16x32_bf16 v[16:19], a[80:83], v[192:195], v[16:19]
    s_mov_b32 s54, 5120
    ds_read_b64_tr_b16 a[104:105], v3 offset:544
    ds_read_b64_tr_b16 a[106:107], v3 offset:672
    v_mfma_f32_16x16x32_bf16 v[16:19], a[84:87], v[200:203], v[16:19]
    s_waitcnt lgkmcnt(6)
    v_permlane32_swap_b32 v48, v50
    v_mfma_f32_16x16x32_bf16 v[16:19], a[88:91], v[208:211], v[16:19]
    v_permlane32_swap_b32 v49, v51
    v_mfma_f32_16x16x32_bf16 v[16:19], a[92:95], v[216:219], v[16:19]
    ds_read_b64_tr_b16 a[108:109], v3 offset:800
    ds_read_b64_tr_b16 a[110:111], v3 offset:928
    buffer_store_dwordx4 v[48:51], v10, s[40:43], s54 offen offset:512 sc1
    v_mfma_f32_16x16x32_bf16 v[20:23], a[64:67], v[160:163], 0
    ds_read_b64_tr_b16 a[112:113], v3 offset:16928
    v_cvt_pk_bf16_f32 v52, v36, v37
    v_mfma_f32_16x16x32_bf16 v[20:23], a[68:71], v[168:171], v[20:23]
    ds_read_b64_tr_b16 a[114:115], v3 offset:17056
    v_cvt_pk_bf16_f32 v53, v38, v39
    v_mfma_f32_16x16x32_bf16 v[20:23], a[72:75], v[176:179], v[20:23]
    ds_read_b64_tr_b16 a[116:117], v3 offset:17184
    v_cvt_pk_bf16_f32 v54, v44, v45
    v_mfma_f32_16x16x32_bf16 v[20:23], a[76:79], v[184:187], v[20:23]
    ds_read_b64_tr_b16 a[118:119], v3 offset:17312
    v_cvt_pk_bf16_f32 v55, v46, v47
    v_mfma_f32_16x16x32_bf16 v[20:23], a[80:83], v[224:227], v[20:23]
    s_mov_b32 s54, 300032
    ds_read_b64_tr_b16 a[120:121], v3 offset:17440
    ds_read_b64_tr_b16 a[122:123], v3 offset:17568
    v_mfma_f32_16x16x32_bf16 v[20:23], a[84:87], v[232:235], v[20:23]
    v_permlane32_swap_b32 v52, v54
    v_mfma_f32_16x16x32_bf16 v[20:23], a[88:91], v[240:243], v[20:23]
    v_permlane32_swap_b32 v53, v55
    v_mfma_f32_16x16x32_bf16 v[20:23], a[92:95], v[248:251], v[20:23]
    s_waitcnt lgkmcnt(10)
    ds_read_b64_tr_b16 a[124:125], v3 offset:17696
    ds_read_b64_tr_b16 a[126:127], v3 offset:17824
    buffer_store_dwordx4 v[52:55], v10, s[40:43], s54 offen offset:512 sc1
    v_mfma_f32_16x16x32_bf16 v[24:27], a[96:99], v[128:131], 0
    ds_read_b64_tr_b16 a[64:65], v3 offset:64
    v_mfma_f32_16x16x32_bf16 v[24:27], a[100:103], v[136:139], v[24:27]
    s_waitcnt lgkmcnt(9)
    ds_read_b64_tr_b16 a[66:67], v3 offset:192
    v_mfma_f32_16x16x32_bf16 v[24:27], a[104:107], v[144:147], v[24:27]
    ds_read_b64_tr_b16 a[68:69], v3 offset:320
    v_mfma_f32_16x16x32_bf16 v[24:27], a[108:111], v[152:155], v[24:27]
    s_waitcnt lgkmcnt(7)
    ds_read_b64_tr_b16 a[70:71], v3 offset:448
    v_mfma_f32_16x16x32_bf16 v[24:27], a[112:115], v[192:195], v[24:27]
    ds_read_b64_tr_b16 a[72:73], v3 offset:576
    v_mfma_f32_16x16x32_bf16 v[24:27], a[116:119], v[200:203], v[24:27]
    s_waitcnt lgkmcnt(5)
    ds_read_b64_tr_b16 a[74:75], v3 offset:704
    v_mfma_f32_16x16x32_bf16 v[24:27], a[120:123], v[208:211], v[24:27]
    ds_read_b64_tr_b16 a[76:77], v3 offset:832
    v_mfma_f32_16x16x32_bf16 v[24:27], a[124:127], v[216:219], v[24:27]
    ds_read_b64_tr_b16 a[78:79], v3 offset:960
    v_mfma_f32_16x16x32_bf16 v[28:31], a[96:99], v[160:163], 0
    ds_read_b64_tr_b16 a[80:81], v3 offset:16960
    v_mfma_f32_16x16x32_bf16 v[28:31], a[100:103], v[168:171], v[28:31]
    ds_read_b64_tr_b16 a[82:83], v3 offset:17088
    v_mfma_f32_16x16x32_bf16 v[28:31], a[104:107], v[176:179], v[28:31]
    ds_read_b64_tr_b16 a[84:85], v3 offset:17216
    v_mfma_f32_16x16x32_bf16 v[28:31], a[108:111], v[184:187], v[28:31]
    ds_read_b64_tr_b16 a[86:87], v3 offset:17344
    v_mfma_f32_16x16x32_bf16 v[28:31], a[112:115], v[224:227], v[28:31]
    ds_read_b64_tr_b16 a[88:89], v3 offset:17472
    v_mfma_f32_16x16x32_bf16 v[28:31], a[116:119], v[232:235], v[28:31]
    ds_read_b64_tr_b16 a[90:91], v3 offset:17600
    v_mfma_f32_16x16x32_bf16 v[28:31], a[120:123], v[240:243], v[28:31]
    ds_read_b64_tr_b16 a[92:93], v3 offset:17728
    v_mfma_f32_16x16x32_bf16 v[28:31], a[124:127], v[248:251], v[28:31]
    s_waitcnt lgkmcnt(11)
    ds_read_b64_tr_b16 a[94:95], v3 offset:17856
    v_mfma_f32_16x16x32_bf16 v[32:35], a[64:67], v[128:131], 0
    ds_read_b64_tr_b16 a[96:97], v3 offset:96
    v_cvt_pk_bf16_f32 v48, v16, v17
    v_mfma_f32_16x16x32_bf16 v[32:35], a[68:71], v[136:139], v[32:35]
    s_waitcnt lgkmcnt(9)
    ds_read_b64_tr_b16 a[98:99], v3 offset:224
    v_cvt_pk_bf16_f32 v49, v18, v19
    v_mfma_f32_16x16x32_bf16 v[32:35], a[72:75], v[144:147], v[32:35]
    ds_read_b64_tr_b16 a[100:101], v3 offset:352
    v_cvt_pk_bf16_f32 v50, v24, v25
    v_mfma_f32_16x16x32_bf16 v[32:35], a[76:79], v[152:155], v[32:35]
    s_waitcnt lgkmcnt(7)
    ds_read_b64_tr_b16 a[102:103], v3 offset:480
    v_cvt_pk_bf16_f32 v51, v26, v27
    v_mfma_f32_16x16x32_bf16 v[32:35], a[80:83], v[192:195], v[32:35]
    s_mov_b32 s54, 6144
    ds_read_b64_tr_b16 a[104:105], v3 offset:608
    ds_read_b64_tr_b16 a[106:107], v3 offset:736
    v_mfma_f32_16x16x32_bf16 v[32:35], a[84:87], v[200:203], v[32:35]
    s_waitcnt lgkmcnt(6)
    v_permlane32_swap_b32 v48, v50
    v_mfma_f32_16x16x32_bf16 v[32:35], a[88:91], v[208:211], v[32:35]
    v_permlane32_swap_b32 v49, v51
    v_mfma_f32_16x16x32_bf16 v[32:35], a[92:95], v[216:219], v[32:35]
    ds_read_b64_tr_b16 a[108:109], v3 offset:864
    ds_read_b64_tr_b16 a[110:111], v3 offset:992
    buffer_store_dwordx4 v[48:51], v10, s[40:43], s54 offen offset:0 sc1
    v_mfma_f32_16x16x32_bf16 v[36:39], a[64:67], v[160:163], 0
    ds_read_b64_tr_b16 a[112:113], v3 offset:16992
    v_cvt_pk_bf16_f32 v52, v20, v21
    v_mfma_f32_16x16x32_bf16 v[36:39], a[68:71], v[168:171], v[36:39]
    ds_read_b64_tr_b16 a[114:115], v3 offset:17120
    v_cvt_pk_bf16_f32 v53, v22, v23
    v_mfma_f32_16x16x32_bf16 v[36:39], a[72:75], v[176:179], v[36:39]
    ds_read_b64_tr_b16 a[116:117], v3 offset:17248
    v_cvt_pk_bf16_f32 v54, v28, v29
    v_mfma_f32_16x16x32_bf16 v[36:39], a[76:79], v[184:187], v[36:39]
    ds_read_b64_tr_b16 a[118:119], v3 offset:17376
    v_cvt_pk_bf16_f32 v55, v30, v31
    v_mfma_f32_16x16x32_bf16 v[36:39], a[80:83], v[224:227], v[36:39]
    s_mov_b32 s54, 301056
    ds_read_b64_tr_b16 a[120:121], v3 offset:17504
    ds_read_b64_tr_b16 a[122:123], v3 offset:17632
    v_mfma_f32_16x16x32_bf16 v[36:39], a[84:87], v[232:235], v[36:39]
    v_permlane32_swap_b32 v52, v54
    v_mfma_f32_16x16x32_bf16 v[36:39], a[88:91], v[240:243], v[36:39]
    v_permlane32_swap_b32 v53, v55
    v_mfma_f32_16x16x32_bf16 v[36:39], a[92:95], v[248:251], v[36:39]
    s_waitcnt vmcnt(15)
    s_barrier
    s_waitcnt lgkmcnt(10)
    ds_read_b64_tr_b16 a[124:125], v3 offset:17760
    ds_read_b64_tr_b16 a[126:127], v3 offset:17888
    buffer_store_dwordx4 v[52:55], v10, s[40:43], s54 offen offset:0 sc1
    v_mfma_f32_16x16x32_bf16 v[40:43], a[96:99], v[128:131], 0
    ds_read_b64_tr_b16 a[64:65], v3 offset:36864
    v_mfma_f32_16x16x32_bf16 v[40:43], a[100:103], v[136:139], v[40:43]
    s_waitcnt lgkmcnt(9)
    ds_read_b64_tr_b16 a[66:67], v3 offset:36992
    v_mfma_f32_16x16x32_bf16 v[40:43], a[104:107], v[144:147], v[40:43]
    ds_read_b64_tr_b16 a[68:69], v3 offset:37120
    v_mfma_f32_16x16x32_bf16 v[40:43], a[108:111], v[152:155], v[40:43]
    s_waitcnt lgkmcnt(7)
    ds_read_b64_tr_b16 a[70:71], v3 offset:37248
    v_mfma_f32_16x16x32_bf16 v[40:43], a[112:115], v[192:195], v[40:43]
    ds_read_b64_tr_b16 a[72:73], v3 offset:37376
    v_mfma_f32_16x16x32_bf16 v[40:43], a[116:119], v[200:203], v[40:43]
    s_waitcnt lgkmcnt(5)
    ds_read_b64_tr_b16 a[74:75], v3 offset:37504
    v_mfma_f32_16x16x32_bf16 v[40:43], a[120:123], v[208:211], v[40:43]
    ds_read_b64_tr_b16 a[76:77], v3 offset:37632
    v_mfma_f32_16x16x32_bf16 v[40:43], a[124:127], v[216:219], v[40:43]
    ds_read_b64_tr_b16 a[78:79], v3 offset:37760
    v_mfma_f32_16x16x32_bf16 v[44:47], a[96:99], v[160:163], 0
    s_sub_u32 s28, s88, 4096
    s_subb_u32 s29, s89, 0
    ds_read_b64_tr_b16 a[80:81], v3 offset:53760
    v_mfma_f32_16x16x32_bf16 v[44:47], a[100:103], v[168:171], v[44:47]
    s_mov_b32 s30, 147456
    ds_read_b64_tr_b16 a[82:83], v3 offset:53888
    v_mfma_f32_16x16x32_bf16 v[44:47], a[104:107], v[176:179], v[44:47]
    ds_read_b64_tr_b16 a[84:85], v3 offset:54016
    v_mfma_f32_16x16x32_bf16 v[44:47], a[108:111], v[184:187], v[44:47]
    ds_read_b64_tr_b16 a[86:87], v3 offset:54144
    v_mfma_f32_16x16x32_bf16 v[44:47], a[112:115], v[224:227], v[44:47]
    ds_read_b64_tr_b16 a[88:89], v3 offset:54272
    v_mfma_f32_16x16x32_bf16 v[44:47], a[116:119], v[232:235], v[44:47]
    ds_read_b64_tr_b16 a[90:91], v3 offset:54400
    v_mfma_f32_16x16x32_bf16 v[44:47], a[120:123], v[240:243], v[44:47]
    ds_read_b64_tr_b16 a[92:93], v3 offset:54528
    v_mfma_f32_16x16x32_bf16 v[44:47], a[124:127], v[248:251], v[44:47]
    s_waitcnt lgkmcnt(11)
    ds_read_b64_tr_b16 a[94:95], v3 offset:54656
    v_mfma_f32_16x16x32_bf16 v[16:19], a[64:67], v[128:131], 0
    ds_read_b64_tr_b16 a[96:97], v3 offset:36896
    v_cvt_pk_bf16_f32 v48, v32, v33
    v_mfma_f32_16x16x32_bf16 v[16:19], a[68:71], v[136:139], v[16:19]
    s_waitcnt lgkmcnt(9)
    ds_read_b64_tr_b16 a[98:99], v3 offset:37024
    v_cvt_pk_bf16_f32 v49, v34, v35
    v_mfma_f32_16x16x32_bf16 v[16:19], a[72:75], v[144:147], v[16:19]
    ds_read_b64_tr_b16 a[100:101], v3 offset:37152
    v_cvt_pk_bf16_f32 v50, v40, v41
    v_mfma_f32_16x16x32_bf16 v[16:19], a[76:79], v[152:155], v[16:19]
    s_waitcnt lgkmcnt(7)
    ds_read_b64_tr_b16 a[102:103], v3 offset:37280
    v_cvt_pk_bf16_f32 v51, v42, v43
    v_mfma_f32_16x16x32_bf16 v[16:19], a[80:83], v[192:195], v[16:19]
    s_mov_b32 s54, 6144
    ds_read_b64_tr_b16 a[104:105], v3 offset:37408
    ds_read_b64_tr_b16 a[106:107], v3 offset:37536
    v_mfma_f32_16x16x32_bf16 v[16:19], a[84:87], v[200:203], v[16:19]
    s_waitcnt lgkmcnt(6)
    v_permlane32_swap_b32 v48, v50
    v_mfma_f32_16x16x32_bf16 v[16:19], a[88:91], v[208:211], v[16:19]
    v_permlane32_swap_b32 v49, v51
    v_mfma_f32_16x16x32_bf16 v[16:19], a[92:95], v[216:219], v[16:19]
    ds_read_b64_tr_b16 a[108:109], v3 offset:37664
    ds_read_b64_tr_b16 a[110:111], v3 offset:37792
    buffer_store_dwordx4 v[48:51], v10, s[40:43], s54 offen offset:512 sc1
    v_mfma_f32_16x16x32_bf16 v[20:23], a[64:67], v[160:163], 0
    ds_read_b64_tr_b16 a[112:113], v3 offset:53792
    v_cvt_pk_bf16_f32 v52, v36, v37
    v_mfma_f32_16x16x32_bf16 v[20:23], a[68:71], v[168:171], v[20:23]
    ds_read_b64_tr_b16 a[114:115], v3 offset:53920
    v_cvt_pk_bf16_f32 v53, v38, v39
    v_mfma_f32_16x16x32_bf16 v[20:23], a[72:75], v[176:179], v[20:23]
    ds_read_b64_tr_b16 a[116:117], v3 offset:54048
    v_cvt_pk_bf16_f32 v54, v44, v45
    v_mfma_f32_16x16x32_bf16 v[20:23], a[76:79], v[184:187], v[20:23]
    ds_read_b64_tr_b16 a[118:119], v3 offset:54176
    v_cvt_pk_bf16_f32 v55, v46, v47
    v_mfma_f32_16x16x32_bf16 v[20:23], a[80:83], v[224:227], v[20:23]
    s_mov_b32 s54, 301056
    ds_read_b64_tr_b16 a[120:121], v3 offset:54304
    ds_read_b64_tr_b16 a[122:123], v3 offset:54432
    v_mfma_f32_16x16x32_bf16 v[20:23], a[84:87], v[232:235], v[20:23]
    v_permlane32_swap_b32 v52, v54
    v_mfma_f32_16x16x32_bf16 v[20:23], a[88:91], v[240:243], v[20:23]
    v_permlane32_swap_b32 v53, v55
    v_mfma_f32_16x16x32_bf16 v[20:23], a[92:95], v[248:251], v[20:23]
    s_waitcnt lgkmcnt(10)
    ds_read_b64_tr_b16 a[124:125], v3 offset:54560
    ds_read_b64_tr_b16 a[126:127], v3 offset:54688
    buffer_store_dwordx4 v[52:55], v10, s[40:43], s54 offen offset:512 sc1
    v_mfma_f32_16x16x32_bf16 v[24:27], a[96:99], v[128:131], 0
    ds_read_b64_tr_b16 a[64:65], v3 offset:36928
    v_mfma_f32_16x16x32_bf16 v[24:27], a[100:103], v[136:139], v[24:27]
    s_waitcnt lgkmcnt(9)
    ds_read_b64_tr_b16 a[66:67], v3 offset:37056
    v_mfma_f32_16x16x32_bf16 v[24:27], a[104:107], v[144:147], v[24:27]
    ds_read_b64_tr_b16 a[68:69], v3 offset:37184
    v_mfma_f32_16x16x32_bf16 v[24:27], a[108:111], v[152:155], v[24:27]
    s_waitcnt lgkmcnt(7)
    ds_read_b64_tr_b16 a[70:71], v3 offset:37312
    v_mfma_f32_16x16x32_bf16 v[24:27], a[112:115], v[192:195], v[24:27]
    ds_read_b64_tr_b16 a[72:73], v3 offset:37440
    v_mfma_f32_16x16x32_bf16 v[24:27], a[116:119], v[200:203], v[24:27]
    s_waitcnt lgkmcnt(5)
    ds_read_b64_tr_b16 a[74:75], v3 offset:37568
    v_mfma_f32_16x16x32_bf16 v[24:27], a[120:123], v[208:211], v[24:27]
    ds_read_b64_tr_b16 a[76:77], v3 offset:37696
    v_mfma_f32_16x16x32_bf16 v[24:27], a[124:127], v[216:219], v[24:27]
    ds_read_b64_tr_b16 a[78:79], v3 offset:37824
    v_mfma_f32_16x16x32_bf16 v[28:31], a[96:99], v[160:163], 0
    ds_read_b64_tr_b16 a[80:81], v3 offset:53824
    v_mfma_f32_16x16x32_bf16 v[28:31], a[100:103], v[168:171], v[28:31]
    ds_read_b64_tr_b16 a[82:83], v3 offset:53952
    v_mfma_f32_16x16x32_bf16 v[28:31], a[104:107], v[176:179], v[28:31]
    ds_read_b64_tr_b16 a[84:85], v3 offset:54080
    v_mfma_f32_16x16x32_bf16 v[28:31], a[108:111], v[184:187], v[28:31]
    ds_read_b64_tr_b16 a[86:87], v3 offset:54208
    v_mfma_f32_16x16x32_bf16 v[28:31], a[112:115], v[224:227], v[28:31]
    ds_read_b64_tr_b16 a[88:89], v3 offset:54336
    v_mfma_f32_16x16x32_bf16 v[28:31], a[116:119], v[232:235], v[28:31]
    ds_read_b64_tr_b16 a[90:91], v3 offset:54464
    v_mfma_f32_16x16x32_bf16 v[28:31], a[120:123], v[240:243], v[28:31]
    ds_read_b64_tr_b16 a[92:93], v3 offset:54592
    v_mfma_f32_16x16x32_bf16 v[28:31], a[124:127], v[248:251], v[28:31]
    s_waitcnt lgkmcnt(11)
    ds_read_b64_tr_b16 a[94:95], v3 offset:54720
    v_mfma_f32_16x16x32_bf16 v[32:35], a[64:67], v[128:131], 0
    ds_read_b64_tr_b16 a[96:97], v3 offset:36960
    v_cvt_pk_bf16_f32 v48, v16, v17
    v_mfma_f32_16x16x32_bf16 v[32:35], a[68:71], v[136:139], v[32:35]
    s_waitcnt lgkmcnt(9)
    ds_read_b64_tr_b16 a[98:99], v3 offset:37088
    v_cvt_pk_bf16_f32 v49, v18, v19
    v_mfma_f32_16x16x32_bf16 v[32:35], a[72:75], v[144:147], v[32:35]
    ds_read_b64_tr_b16 a[100:101], v3 offset:37216
    v_cvt_pk_bf16_f32 v50, v24, v25
    v_mfma_f32_16x16x32_bf16 v[32:35], a[76:79], v[152:155], v[32:35]
    s_waitcnt lgkmcnt(7)
    ds_read_b64_tr_b16 a[102:103], v3 offset:37344
    v_cvt_pk_bf16_f32 v51, v26, v27
    v_mfma_f32_16x16x32_bf16 v[32:35], a[80:83], v[192:195], v[32:35]
    s_mov_b32 s54, 7168
    ds_read_b64_tr_b16 a[104:105], v3 offset:37472
    ds_read_b64_tr_b16 a[106:107], v3 offset:37600
    v_mfma_f32_16x16x32_bf16 v[32:35], a[84:87], v[200:203], v[32:35]
    s_waitcnt lgkmcnt(6)
    v_permlane32_swap_b32 v48, v50
    v_mfma_f32_16x16x32_bf16 v[32:35], a[88:91], v[208:211], v[32:35]
    v_permlane32_swap_b32 v49, v51
    v_mfma_f32_16x16x32_bf16 v[32:35], a[92:95], v[216:219], v[32:35]
    ds_read_b64_tr_b16 a[108:109], v3 offset:37728
    ds_read_b64_tr_b16 a[110:111], v3 offset:37856
    buffer_store_dwordx4 v[48:51], v10, s[40:43], s54 offen offset:0 sc1
    v_mfma_f32_16x16x32_bf16 v[36:39], a[64:67], v[160:163], 0
    ds_read_b64_tr_b16 a[112:113], v3 offset:53856
    v_cvt_pk_bf16_f32 v52, v20, v21
    v_mfma_f32_16x16x32_bf16 v[36:39], a[68:71], v[168:171], v[36:39]
    ds_read_b64_tr_b16 a[114:115], v3 offset:53984
    v_cvt_pk_bf16_f32 v53, v22, v23
    v_mfma_f32_16x16x32_bf16 v[36:39], a[72:75], v[176:179], v[36:39]
    ds_read_b64_tr_b16 a[116:117], v3 offset:54112
    v_cvt_pk_bf16_f32 v54, v28, v29
    v_mfma_f32_16x16x32_bf16 v[36:39], a[76:79], v[184:187], v[36:39]
    ds_read_b64_tr_b16 a[118:119], v3 offset:54240
    v_cvt_pk_bf16_f32 v55, v30, v31
    v_mfma_f32_16x16x32_bf16 v[36:39], a[80:83], v[224:227], v[36:39]
    s_mov_b32 s54, 302080
    ds_read_b64_tr_b16 a[120:121], v3 offset:54368
    ds_read_b64_tr_b16 a[122:123], v3 offset:54496
    v_mfma_f32_16x16x32_bf16 v[36:39], a[84:87], v[232:235], v[36:39]
    v_permlane32_swap_b32 v52, v54
    v_mfma_f32_16x16x32_bf16 v[36:39], a[88:91], v[240:243], v[36:39]
    v_permlane32_swap_b32 v53, v55
    v_mfma_f32_16x16x32_bf16 v[36:39], a[92:95], v[248:251], v[36:39]
    s_waitcnt vmcnt(7)
    s_barrier
    s_waitcnt lgkmcnt(10)
    ds_read_b64_tr_b16 a[124:125], v3 offset:54624
    ds_read_b64_tr_b16 a[126:127], v3 offset:54752
    buffer_store_dwordx4 v[52:55], v10, s[40:43], s54 offen offset:0 sc1
    v_mfma_f32_16x16x32_bf16 v[40:43], a[96:99], v[128:131], 0
    ds_read_b64_tr_b16 a[64:65], v4 offset:0
    v_mfma_f32_16x16x32_bf16 v[40:43], a[100:103], v[136:139], v[40:43]
    s_waitcnt lgkmcnt(9)
    ds_read_b64_tr_b16 a[66:67], v4 offset:128
    v_mfma_f32_16x16x32_bf16 v[40:43], a[104:107], v[144:147], v[40:43]
    ds_read_b64_tr_b16 a[68:69], v4 offset:256
    v_mfma_f32_16x16x32_bf16 v[40:43], a[108:111], v[152:155], v[40:43]
    s_waitcnt lgkmcnt(7)
    ds_read_b64_tr_b16 a[70:71], v4 offset:384
    v_mfma_f32_16x16x32_bf16 v[40:43], a[112:115], v[192:195], v[40:43]
    ds_read_b64_tr_b16 a[72:73], v4 offset:512
    v_mfma_f32_16x16x32_bf16 v[40:43], a[116:119], v[200:203], v[40:43]
    s_waitcnt lgkmcnt(5)
    ds_read_b64_tr_b16 a[74:75], v4 offset:640
    v_mfma_f32_16x16x32_bf16 v[40:43], a[120:123], v[208:211], v[40:43]
    ds_read_b64_tr_b16 a[76:77], v4 offset:768
    v_mfma_f32_16x16x32_bf16 v[40:43], a[124:127], v[216:219], v[40:43]
    ds_read_b64_tr_b16 a[78:79], v4 offset:896
    v_mfma_f32_16x16x32_bf16 v[44:47], a[96:99], v[160:163], 0
    ds_read_b64_tr_b16 a[80:81], v4 offset:16896
    v_mfma_f32_16x16x32_bf16 v[44:47], a[100:103], v[168:171], v[44:47]
    ds_read_b64_tr_b16 a[82:83], v4 offset:17024
    v_mfma_f32_16x16x32_bf16 v[44:47], a[104:107], v[176:179], v[44:47]
    ds_read_b64_tr_b16 a[84:85], v4 offset:17152
    v_mfma_f32_16x16x32_bf16 v[44:47], a[108:111], v[184:187], v[44:47]
    ds_read_b64_tr_b16 a[86:87], v4 offset:17280
    v_mfma_f32_16x16x32_bf16 v[44:47], a[112:115], v[224:227], v[44:47]
    ds_read_b64_tr_b16 a[88:89], v4 offset:17408
    v_mfma_f32_16x16x32_bf16 v[44:47], a[116:119], v[232:235], v[44:47]
    ds_read_b64_tr_b16 a[90:91], v4 offset:17536
    v_mfma_f32_16x16x32_bf16 v[44:47], a[120:123], v[240:243], v[44:47]
    ds_read_b64_tr_b16 a[92:93], v4 offset:17664
    v_mfma_f32_16x16x32_bf16 v[44:47], a[124:127], v[248:251], v[44:47]
    s_waitcnt lgkmcnt(11)
    ds_read_b64_tr_b16 a[94:95], v4 offset:17792
    v_mfma_f32_16x16x32_bf16 v[16:19], a[64:67], v[128:131], 0
    ds_read_b64_tr_b16 a[96:97], v4 offset:32
    v_cvt_pk_bf16_f32 v48, v32, v33
    v_mfma_f32_16x16x32_bf16 v[16:19], a[68:71], v[136:139], v[16:19]
    s_waitcnt lgkmcnt(9)
    ds_read_b64_tr_b16 a[98:99], v4 offset:160
    v_cvt_pk_bf16_f32 v49, v34, v35
    v_mfma_f32_16x16x32_bf16 v[16:19], a[72:75], v[144:147], v[16:19]
    ds_read_b64_tr_b16 a[100:101], v4 offset:288
    v_cvt_pk_bf16_f32 v50, v40, v41
    v_mfma_f32_16x16x32_bf16 v[16:19], a[76:79], v[152:155], v[16:19]
    s_waitcnt lgkmcnt(7)
    ds_read_b64_tr_b16 a[102:103], v4 offset:416
    v_cvt_pk_bf16_f32 v51, v42, v43
    v_mfma_f32_16x16x32_bf16 v[16:19], a[80:83], v[192:195], v[16:19]
    s_mov_b32 s54, 7168
    ds_read_b64_tr_b16 a[104:105], v4 offset:544
    ds_read_b64_tr_b16 a[106:107], v4 offset:672
    v_mfma_f32_16x16x32_bf16 v[16:19], a[84:87], v[200:203], v[16:19]
    s_waitcnt lgkmcnt(6)
    v_permlane32_swap_b32 v48, v50
    v_mfma_f32_16x16x32_bf16 v[16:19], a[88:91], v[208:211], v[16:19]
    v_permlane32_swap_b32 v49, v51
    v_mfma_f32_16x16x32_bf16 v[16:19], a[92:95], v[216:219], v[16:19]
    ds_read_b64_tr_b16 a[108:109], v4 offset:800
    ds_read_b64_tr_b16 a[110:111], v4 offset:928
    buffer_store_dwordx4 v[48:51], v10, s[40:43], s54 offen offset:512 sc1
    v_mfma_f32_16x16x32_bf16 v[20:23], a[64:67], v[160:163], 0
    ds_read_b64_tr_b16 a[112:113], v4 offset:16928
    v_cvt_pk_bf16_f32 v52, v36, v37
    v_mfma_f32_16x16x32_bf16 v[20:23], a[68:71], v[168:171], v[20:23]
    ds_read_b64_tr_b16 a[114:115], v4 offset:17056
    v_cvt_pk_bf16_f32 v53, v38, v39
    v_mfma_f32_16x16x32_bf16 v[20:23], a[72:75], v[176:179], v[20:23]
    ds_read_b64_tr_b16 a[116:117], v4 offset:17184
    v_cvt_pk_bf16_f32 v54, v44, v45
    v_mfma_f32_16x16x32_bf16 v[20:23], a[76:79], v[184:187], v[20:23]
    ds_read_b64_tr_b16 a[118:119], v4 offset:17312
    v_cvt_pk_bf16_f32 v55, v46, v47
    v_mfma_f32_16x16x32_bf16 v[20:23], a[80:83], v[224:227], v[20:23]
    s_mov_b32 s54, 302080
    ds_read_b64_tr_b16 a[120:121], v4 offset:17440
    ds_read_b64_tr_b16 a[122:123], v4 offset:17568
    v_mfma_f32_16x16x32_bf16 v[20:23], a[84:87], v[232:235], v[20:23]
    v_permlane32_swap_b32 v52, v54
    v_mfma_f32_16x16x32_bf16 v[20:23], a[88:91], v[240:243], v[20:23]
    v_permlane32_swap_b32 v53, v55
    v_mfma_f32_16x16x32_bf16 v[20:23], a[92:95], v[248:251], v[20:23]
    s_waitcnt lgkmcnt(10)
    ds_read_b64_tr_b16 a[124:125], v4 offset:17696
    ds_read_b64_tr_b16 a[126:127], v4 offset:17824
    buffer_store_dwordx4 v[52:55], v10, s[40:43], s54 offen offset:512 sc1
    v_mfma_f32_16x16x32_bf16 v[24:27], a[96:99], v[128:131], 0
L2_pad13:
    s_cbranch_execz L2_walkret
    ds_read_b64_tr_b16 a[64:65], v4 offset:64
    v_mfma_f32_16x16x32_bf16 v[24:27], a[100:103], v[136:139], v[24:27]
    s_waitcnt lgkmcnt(9)
    ds_read_b64_tr_b16 a[66:67], v4 offset:192
    v_mfma_f32_16x16x32_bf16 v[24:27], a[104:107], v[144:147], v[24:27]
    ds_read_b64_tr_b16 a[68:69], v4 offset:320
    v_mfma_f32_16x16x32_bf16 v[24:27], a[108:111], v[152:155], v[24:27]
    s_waitcnt lgkmcnt(7)
    ds_read_b64_tr_b16 a[70:71], v4 offset:448
    v_mfma_f32_16x16x32_bf16 v[24:27], a[112:115], v[192:195], v[24:27]
    ds_read_b64_tr_b16 a[72:73], v4 offset:576
    v_mfma_f32_16x16x32_bf16 v[24:27], a[116:119], v[200:203], v[24:27]
    s_waitcnt lgkmcnt(5)
    ds_read_b64_tr_b16 a[74:75], v4 offset:704
    v_mfma_f32_16x16x32_bf16 v[24:27], a[120:123], v[208:211], v[24:27]
    ds_read_b64_tr_b16 a[76:77], v4 offset:832
    v_mfma_f32_16x16x32_bf16 v[24:27], a[124:127], v[216:219], v[24:27]
    ds_read_b64_tr_b16 a[78:79], v4 offset:960
    v_mfma_f32_16x16x32_bf16 v[28:31], a[96:99], v[160:163], 0
    ds_read_b64_tr_b16 a[80:81], v4 offset:16960
    v_mfma_f32_16x16x32_bf16 v[28:31], a[100:103], v[168:171], v[28:31]
    ds_read_b64_tr_b16 a[82:83], v4 offset:17088
    v_mfma_f32_16x16x32_bf16 v[28:31], a[104:107], v[176:179], v[28:31]
    ds_read_b64_tr_b16 a[84:85], v4 offset:17216
    v_mfma_f32_16x16x32_bf16 v[28:31], a[108:111], v[184:187], v[28:31]
    ds_read_b64_tr_b16 a[86:87], v4 offset:17344
    v_mfma_f32_16x16x32_bf16 v[28:31], a[112:115], v[224:227], v[28:31]
    ds_read_b64_tr_b16 a[88:89], v4 offset:17472
    v_mfma_f32_16x16x32_bf16 v[28:31], a[116:119], v[232:235], v[28:31]
    ds_read_b64_tr_b16 a[90:91], v4 offset:17600
    v_mfma_f32_16x16x32_bf16 v[28:31], a[120:123], v[240:243], v[28:31]
    ds_read_b64_tr_b16 a[92:93], v4 offset:17728
    v_mfma_f32_16x16x32_bf16 v[28:31], a[124:127], v[248:251], v[28:31]
    s_waitcnt lgkmcnt(11)
    ds_read_b64_tr_b16 a[94:95], v4 offset:17856
    v_mfma_f32_16x16x32_bf16 v[32:35], a[64:67], v[128:131], 0
    ds_read_b64_tr_b16 a[96:97], v4 offset:96
    v_cvt_pk_bf16_f32 v48, v16, v17
    v_mfma_f32_16x16x32_bf16 v[32:35], a[68:71], v[136:139], v[32:35]
    s_waitcnt lgkmcnt(9)
    ds_read_b64_tr_b16 a[98:99], v4 offset:224
    v_cvt_pk_bf16_f32 v49, v18, v19
    v_mfma_f32_16x16x32_bf16 v[32:35], a[72:75], v[144:147], v[32:35]
    ds_read_b64_tr_b16 a[100:101], v4 offset:352
    v_cvt_pk_bf16_f32 v50, v24, v25
    v_mfma_f32_16x16x32_bf16 v[32:35], a[76:79], v[152:155], v[32:35]
    s_waitcnt lgkmcnt(7)
    ds_read_b64_tr_b16 a[102:103], v4 offset:480
    v_cvt_pk_bf16_f32 v51, v26, v27
    v_mfma_f32_16x16x32_bf16 v[32:35], a[80:83], v[192:195], v[32:35]
    s_mov_b32 s54, 8192
    ds_read_b64_tr_b16 a[104:105], v4 offset:608
    ds_read_b64_tr_b16 a[106:107], v4 offset:736
    v_mfma_f32_16x16x32_bf16 v[32:35], a[84:87], v[200:203], v[32:35]
    s_waitcnt lgkmcnt(6)
    v_permlane32_swap_b32 v48, v50
    v_mfma_f32_16x16x32_bf16 v[32:35], a[88:91], v[208:211], v[32:35]
    v_permlane32_swap_b32 v49, v51
    v_mfma_f32_16x16x32_bf16 v[32:35], a[92:95], v[216:219], v[32:35]
    ds_read_b64_tr_b16 a[108:109], v4 offset:864
    ds_read_b64_tr_b16 a[110:111], v4 offset:992
    buffer_store_dwordx4 v[48:51], v10, s[40:43], s54 offen offset:0 sc1
    v_mfma_f32_16x16x32_bf16 v[36:39], a[64:67], v[160:163], 0
    ds_read_b64_tr_b16 a[112:113], v4 offset:16992
    v_cvt_pk_bf16_f32 v52, v20, v21
    v_mfma_f32_16x16x32_bf16 v[36:39], a[68:71], v[168:171], v[36:39]
    ds_read_b64_tr_b16 a[114:115], v4 offset:17120
    v_cvt_pk_bf16_f32 v53, v22, v23
    v_mfma_f32_16x16x32_bf16 v[36:39], a[72:75], v[176:179], v[36:39]
    ds_read_b64_tr_b16 a[116:117], v4 offset:17248
    v_cvt_pk_bf16_f32 v54, v28, v29
    v_mfma_f32_16x16x32_bf16 v[36:39], a[76:79], v[184:187], v[36:39]
    ds_read_b64_tr_b16 a[118:119], v4 offset:17376
    v_cvt_pk_bf16_f32 v55, v30, v31
    v_mfma_f32_16x16x32_bf16 v[36:39], a[80:83], v[224:227], v[36:39]
    s_mov_b32 s54, 303104
    ds_read_b64_tr_b16 a[120:121], v4 offset:17504
    ds_read_b64_tr_b16 a[122:123], v4 offset:17632
    v_mfma_f32_16x16x32_bf16 v[36:39], a[84:87], v[232:235], v[36:39]
    v_permlane32_swap_b32 v52, v54
    v_mfma_f32_16x16x32_bf16 v[36:39], a[88:91], v[240:243], v[36:39]
    v_permlane32_swap_b32 v53, v55
    v_mfma_f32_16x16x32_bf16 v[36:39], a[92:95], v[248:251], v[36:39]
    s_waitcnt lgkmcnt(10)
    ds_read_b64_tr_b16 a[124:125], v4 offset:17760
    ds_read_b64_tr_b16 a[126:127], v4 offset:17888
    buffer_store_dwordx4 v[52:55], v10, s[40:43], s54 offen offset:0 sc1
    v_mfma_f32_16x16x32_bf16 v[40:43], a[96:99], v[128:131], 0
    v_mfma_f32_16x16x32_bf16 v[40:43], a[100:103], v[136:139], v[40:43]
    s_waitcnt lgkmcnt(8)
    v_mfma_f32_16x16x32_bf16 v[40:43], a[104:107], v[144:147], v[40:43]
    v_mfma_f32_16x16x32_bf16 v[40:43], a[108:111], v[152:155], v[40:43]
    s_waitcnt lgkmcnt(4)
    v_mfma_f32_16x16x32_bf16 v[40:43], a[112:115], v[192:195], v[40:43]
    v_mfma_f32_16x16x32_bf16 v[40:43], a[116:119], v[200:203], v[40:43]
    s_waitcnt lgkmcnt(0)
    v_mfma_f32_16x16x32_bf16 v[40:43], a[120:123], v[208:211], v[40:43]
    v_mfma_f32_16x16x32_bf16 v[40:43], a[124:127], v[216:219], v[40:43]
    v_mfma_f32_16x16x32_bf16 v[44:47], a[96:99], v[160:163], 0
    v_mfma_f32_16x16x32_bf16 v[44:47], a[100:103], v[168:171], v[44:47]
    v_mfma_f32_16x16x32_bf16 v[44:47], a[104:107], v[176:179], v[44:47]
    v_mfma_f32_16x16x32_bf16 v[44:47], a[108:111], v[184:187], v[44:47]
    v_mfma_f32_16x16x32_bf16 v[44:47], a[112:115], v[224:227], v[44:47]
    v_mfma_f32_16x16x32_bf16 v[44:47], a[116:119], v[232:235], v[44:47]
    v_mfma_f32_16x16x32_bf16 v[44:47], a[120:123], v[240:243], v[44:47]
    v_mfma_f32_16x16x32_bf16 v[44:47], a[124:127], v[248:251], v[44:47]
    s_nop 7
    v_cvt_pk_bf16_f32 v48, v32, v33
    v_cvt_pk_bf16_f32 v49, v34, v35
    v_cvt_pk_bf16_f32 v50, v40, v41
    v_cvt_pk_bf16_f32 v51, v42, v43
    s_nop 1
    v_permlane32_swap_b32 v48, v50
    v_permlane32_swap_b32 v49, v51
    s_mov_b32 s54, 8192
    buffer_store_dwordx4 v[48:51], v10, s[40:43], s54 offen offset:512 sc1
    v_cvt_pk_bf16_f32 v52, v36, v37
    v_cvt_pk_bf16_f32 v53, v38, v39
    v_cvt_pk_bf16_f32 v54, v44, v45
    v_cvt_pk_bf16_f32 v55, v46, v47
    s_nop 1
    v_permlane32_swap_b32 v52, v54
    v_permlane32_swap_b32 v53, v55
    s_mov_b32 s54, 303104
    buffer_store_dwordx4 v[52:55], v10, s[40:43], s54 offen offset:512 sc1
    buffer_load_dword v9, v6, s[84:87], s47 offen sc1
    s_movk_i32 s45, 4608
    buffer_load_dwordx4 v[76:79], v5, s[84:87], s45 offen sc1
    s_movk_i32 s45, 18432
    buffer_load_dwordx4 v[88:91], v5, s[84:87], s45 offen sc1
    s_movk_i32 s45, 8704
    buffer_load_dwordx4 v[80:83], v5, s[84:87], s45 offen sc1
    s_movk_i32 s45, 22528
    buffer_load_dwordx4 v[92:95], v5, s[84:87], s45 offen sc1
    s_movk_i32 s45, 12800
    buffer_load_dwordx4 v[84:87], v59, s[84:87], s45 offen sc1
    s_movk_i32 s45, 26624
    buffer_load_dwordx4 v[96:99], v59, s[84:87], s45 offen sc1
    buffer_load_dwordx4 v[224:227], v12, s[36:39], 0 offen offset:0
    buffer_load_dwordx4 v[232:235], v12, s[36:39], 0 offen offset:512
    buffer_load_dwordx4 v[240:243], v13, s[36:39], 0 offen offset:1024
    buffer_load_dwordx4 v[64:67], v1, s[76:79], 0 offen offset:0
    buffer_load_dwordx4 v[68:71], v1, s[76:79], 0 offen offset:512
    buffer_load_dwordx4 v[72:75], v2, s[76:79], 0 offen offset:0
    s_waitcnt vmcnt(13)
    buffer_store_dword v3, v15, s[84:87], s56 offen sc1
    s_movk_i32 s48, 0x1111
    v_lshrrev_b32 v15, 4, v0
    v_mul_u32_u24 v15, 9216, v15
    v_add_u32 v15, 4096, v15
    v_add_u32 v7, v59, v15
    s_waitcnt vmcnt(13)
    v_cmp_ne_u32 vcc, 0, v9
    s_nop 0
    s_lshr_b32 s3, vcc_lo, 1
    s_and_b32 s3, s3, vcc_lo
    s_lshr_b32 s14, s3, 2
    s_and_b32 s3, s3, s14
    s_and_b32 s3, s3, s48
    s_cbranch_scc0 L2_g0s
L2_g0r:
    s_ff1_i32_b32 s3, s3
    s_bitset0_b32 s48, s3
    s_mul_i32 s46, s3, 9216
    buffer_load_dwordx4 v[112:115], v7, s[88:91], s46 offen sc1
    buffer_load_dwordx4 v[116:119], v5, s[88:91], s46 offen sc1
    buffer_load_dwordx4 v[120:123], v5, s[28:31], s46 offen sc1
    s_add_u32 s46, s46, 9216
    buffer_load_dwordx4 v[124:127], v5, s[88:91], s46 offen sc1
    buffer_load_dwordx4 v[128:131], v5, s[28:31], s46 offen sc1
    s_add_u32 s46, s46, 9216
    buffer_load_dwordx4 v[132:135], v5, s[88:91], s46 offen sc1
    buffer_load_dwordx4 v[136:139], v5, s[28:31], s46 offen sc1
    s_add_u32 s46, s46, 9216
    buffer_load_dwordx4 v[140:143], v5, s[88:91], s46 offen sc1
    buffer_load_dwordx4 v[144:147], v5, s[28:31], s46 offen sc1
    v_cmp_ne_u32 vcc, 0, v9
    s_nop 0
    s_lshr_b32 s3, vcc_lo, 1
    s_and_b32 s3, s3, vcc_lo
    s_lshr_b32 s14, s3, 2
    s_and_b32 s3, s3, s14
    s_and_b32 s3, s3, s48
    s_cbranch_scc0 L2_g1s
L2_g1r:
    s_ff1_i32_b32 s3, s3
    s_bitset0_b32 s48, s3
    s_mul_i32 s46, s3, 9216
    buffer_load_dword v9, v6, s[84:87], s47 offen sc1
    buffer_load_dwordx4 v[148:151], v7, s[88:91], s46 offen sc1
    buffer_load_dwordx4 v[152:155], v5, s[88:91], s46 offen sc1
    buffer_load_dwordx4 v[156:159], v5, s[28:31], s46 offen sc1
    s_add_u32 s46, s46, 9216
    buffer_load_dwordx4 v[160:163], v5, s[88:91], s46 offen sc1
    buffer_load_dwordx4 v[164:167], v5, s[28:31], s46 offen sc1
    s_add_u32 s46, s46, 9216
    buffer_load_dwordx4 v[168:171], v5, s[88:91], s46 offen sc1
    buffer_load_dwordx4 v[172:175], v5, s[28:31], s46 offen sc1
    s_add_u32 s46, s46, 9216
    buffer_load_dwordx4 v[176:179], v5, s[88:91], s46 offen sc1
    buffer_load_dwordx4 v[180:183], v5, s[28:31], s46 offen sc1
    s_waitcnt vmcnt(20)
    v_mov_b32 v14, v13
    v_max_u32 v13, v76, v77
    v_max3_u32 v13, v13, v78, v79
    v_max3_u32 v13, v13, v88, v89
    v_max3_u32 v13, v13, v90, v91
    v_max3_u32 v13, v13, v80, v81
    v_max3_u32 v13, v13, v82, v83
    v_max3_u32 v13, v13, v92, v93
    v_max3_u32 v13, v13, v94, v95
    v_max3_u32 v13, v13, v84, v85
    v_max3_u32 v13, v13, v86, v87
    v_max3_u32 v13, v13, v96, v97
    v_max3_u32 v13, v13, v98, v99
    v_cmp_eq_u32 vcc, -1, v13
    s_nop 0
    s_cmp_lg_u64 vcc, 0
    s_cbranch_scc1 L2_pns
L2_pnr:
    v_pk_add_f32 v[76:77], v[76:77], v[88:89]
    v_pk_add_f32 v[78:79], v[78:79], v[90:91]
    ds_write_b128 v5, v[76:79] offset:0
    v_pk_add_f32 v[80:81], v[80:81], v[92:93]
    v_pk_add_f32 v[82:83], v[82:83], v[94:95]
    ds_write_b128 v5, v[80:83] offset:4096
    v_pk_add_f32 v[84:85], v[84:85], v[96:97]
    v_pk_add_f32 v[86:87], v[86:87], v[98:99]
    ds_write_b128 v59, v[84:87] offset:8192
    s_waitcnt lgkmcnt(0)
    s_barrier
    v_lshlrev_b32 v3, 1, v12
    v_lshlrev_b32 v4, 1, v14
    ds_read_b128 v[76:79], v3 offset:4608
    ds_read_b128 v[80:83], v3 offset:4624
    ds_read_b128 v[84:87], v3 offset:5632
    ds_read_b128 v[88:91], v3 offset:5648
    ds_read_b128 v[92:95], v4 offset:6656
    ds_read_b128 v[96:99], v4 offset:6672
    ds_read_b128 v[40:43], v3 offset:2304
    ds_read_b128 v[44:47], v3 offset:2320
    ds_read_b128 v[48:51], v3 offset:3328
    ds_read_b128 v[52:55], v3 offset:3344
    ds_read_b128 v[56:59], v4 offset:4352
    ds_read_b128 v[60:63], v4 offset:4368
    ds_write_b128 v106, a[20:23] offset:36864
    ds_write_b128 v106, a[24:27] offset:37888
    s_waitcnt lgkmcnt(2)
    v_lshlrev_b32 v12, 16, v224
    v_and_b32 v13, 0xffff0000, v224
    v_pk_mul_f32 v[76:77], v[76:77], v[12:13]
    v_pk_mul_f32 v[40:41], v[40:41], v[12:13]
    v_lshlrev_b32 v14, 16, v225
    v_and_b32 v15, 0xffff0000, v225
    v_pk_mul_f32 v[78:79], v[78:79], v[14:15]
    v_pk_mul_f32 v[42:43], v[42:43], v[14:15]
    v_lshlrev_b32 v12, 16, v226
    v_and_b32 v13, 0xffff0000, v226
    v_pk_mul_f32 v[80:81], v[80:81], v[12:13]
    v_pk_mul_f32 v[44:45], v[44:45], v[12:13]
    v_lshlrev_b32 v14, 16, v227
    v_and_b32 v15, 0xffff0000, v227
    v_pk_mul_f32 v[82:83], v[82:83], v[14:15]
    v_pk_mul_f32 v[46:47], v[46:47], v[14:15]
    v_lshlrev_b32 v12, 16, v232
    v_and_b32 v13, 0xffff0000, v232
    v_pk_mul_f32 v[84:85], v[84:85], v[12:13]
    v_pk_mul_f32 v[48:49], v[48:49], v[12:13]
    v_lshlrev_b32 v14, 16, v233
    v_and_b32 v15, 0xffff0000, v233
    v_pk_mul_f32 v[86:87], v[86:87], v[14:15]
    v_pk_mul_f32 v[50:51], v[50:51], v[14:15]
    ds_write_b128 v106, a[28:31] offset:38912
    ds_write_b128 v106, a[32:35] offset:39936
    v_lshlrev_b32 v12, 16, v234
    v_and_b32 v13, 0xffff0000, v234
    v_pk_mul_f32 v[88:89], v[88:89], v[12:13]
    v_pk_mul_f32 v[52:53], v[52:53], v[12:13]
    v_lshlrev_b32 v14, 16, v235
    v_and_b32 v15, 0xffff0000, v235
    v_pk_mul_f32 v[90:91], v[90:91], v[14:15]
    v_pk_mul_f32 v[54:55], v[54:55], v[14:15]
    v_lshlrev_b32 v12, 16, v240
    v_and_b32 v13, 0xffff0000, v240
    v_pk_mul_f32 v[92:93], v[92:93], v[12:13]
    v_pk_mul_f32 v[56:57], v[56:57], v[12:13]
    v_lshlrev_b32 v14, 16, v241
    v_and_b32 v15, 0xffff0000, v241
    v_pk_mul_f32 v[94:95], v[94:95], v[14:15]
    v_pk_mul_f32 v[58:59], v[58:59], v[14:15]
    v_lshlrev_b32 v12, 16, v242
    v_and_b32 v13, 0xffff0000, v242
    v_pk_mul_f32 v[96:97], v[96:97], v[12:13]
    v_pk_mul_f32 v[60:61], v[60:61], v[12:13]
    v_lshlrev_b32 v14, 16, v243
    v_and_b32 v15, 0xffff0000, v243
    v_pk_mul_f32 v[98:99], v[98:99], v[14:15]
    v_pk_mul_f32 v[62:63], v[62:63], v[14:15]
    ds_write_b128 v106, a[36:39] offset:40960
    ds_write_b128 v106, a[40:43] offset:41984
    v_pk_add_f32 v[12:13], v[76:77], v[78:79]
    v_pk_add_f32 v[12:13], v[12:13], v[80:81]
    v_pk_add_f32 v[12:13], v[12:13], v[82:83]
    v_pk_add_f32 v[12:13], v[12:13], v[84:85]
    v_pk_add_f32 v[12:13], v[12:13], v[86:87]
    v_pk_add_f32 v[12:13], v[12:13], v[88:89]
    v_pk_add_f32 v[12:13], v[12:13], v[90:91]
    v_pk_add_f32 v[14:15], v[92:93], v[94:95]
    v_pk_add_f32 v[14:15], v[14:15], v[96:97]
    v_pk_add_f32 v[14:15], v[14:15], v[98:99]
    v_add_f32 v100, v12, v13
    v_add_f32 v14, v14, v15
    v_fmac_f32 v100, 0x3e800000, v14
    v_pk_add_f32 v[12:13], v[40:41], v[42:43]
    v_pk_add_f32 v[12:13], v[12:13], v[44:45]
    v_pk_add_f32 v[12:13], v[12:13], v[46:47]
    v_pk_add_f32 v[12:13], v[12:13], v[48:49]
    v_pk_add_f32 v[12:13], v[12:13], v[50:51]
    v_pk_add_f32 v[12:13], v[12:13], v[52:53]
    v_pk_add_f32 v[12:13], v[12:13], v[54:55]
    v_pk_add_f32 v[14:15], v[56:57], v[58:59]
    v_pk_add_f32 v[14:15], v[14:15], v[60:61]
    v_pk_add_f32 v[14:15], v[14:15], v[62:63]
    v_add_f32 v101, v12, v13
    v_add_f32 v14, v14, v15
    v_fmac_f32 v101, 0x3e800000, v14
    ds_read_b128 v[40:43], v3 offset:0
    ds_read_b128 v[44:47], v3 offset:16
    ds_read_b128 v[48:51], v3 offset:1024
    ds_read_b128 v[52:55], v3 offset:1040
    ds_read_b128 v[56:59], v4 offset:2048
    ds_read_b128 v[60:63], v4 offset:2064
    ds_write_b128 v106, a[44:47] offset:43008
    ds_write_b128 v106, a[48:51] offset:44032
    s_nop 1
    v_add_f32_dpp v100, v100, v100 row_ror:8 row_mask:0xf bank_mask:0xf
    v_add_f32_dpp v101, v101, v101 row_ror:8 row_mask:0xf bank_mask:0xf
    v_mov_b32 v102, v100
    v_mov_b32 v103, v101
    s_nop 0
    v_permlane16_swap_b32 v102, v100
    v_permlane16_swap_b32 v103, v101
    v_add_f32 v100, v100, v102
    v_add_f32 v101, v101, v103
    v_mov_b32 v102, v100
    v_mov_b32 v103, v101
    s_nop 0
    v_permlane32_swap_b32 v102, v100
    v_permlane32_swap_b32 v103, v101
    v_add_f32 v100, v100, v102
    v_add_f32 v101, v101, v103
    v_and_b32 v14, 7, v0
    v_lshlrev_b32 v11, 4, v14
    v_add_u32 v11, 14080, v11
    s_lshl_b32 s3, s51, 2
    v_add_u32 v10, s3, v11
    ds_write_b32 v10, v100 offset:384
    ds_write_b32 v10, v101 offset:512
    v_lshl_add_u32 v1, v14, 4, v1
    v_lshl_add_u32 v2, v14, 4, v2
    v_add_u32 v1, 90112, v1
    v_add_u32 v2, 90112, v2
    s_and_b32 s14, s51, 1
    s_mul_i32 s14, s14, 9344
    s_add_u32 s14, s14, 90112
    v_add_u32 v107, s14, v8
    v_lshrrev_b32 v15, 3, v0
    v_mul_u32_u24 v12, 1024, v15
    v_add_u32 v109, v12, v8
    v_lshl_add_u32 v12, v15, 4, v12
    v_add_u32 v108, v12, v107
    s_mul_i32 s3, s96, 9216
    s_cmp_eq_u32 s51, 3
    s_cselect_b32 s3, 0, s3
    s_cselect_b64 s[24:25], s[32:33], s[80:81]
    s_add_u32 s24, s24, s3
    s_addc_u32 s25, s25, 0
    s_mov_b32 s26, 9216
    s_mov_b32 s27, 0x20000
    ds_write_b128 v106, a[52:55] offset:45056
    ds_write_b128 v105, a[128:131] offset:0
    s_waitcnt lgkmcnt(2)
    s_waitcnt vmcnt(18)
    ds_write_b128 v105, a[132:135] offset:1024
    ds_write_b128 v105, a[136:139] offset:2048
    v_lshlrev_b32 v32, 16, v112
    v_and_b32 v33, 0xffff0000, v112
    v_lshlrev_b32 v34, 16, v113
    v_and_b32 v35, 0xffff0000, v113
    v_lshlrev_b32 v36, 16, v114
    v_and_b32 v37, 0xffff0000, v114
    v_lshlrev_b32 v38, 16, v115
    v_and_b32 v39, 0xffff0000, v115
    s_waitcnt vmcnt(17)
    ds_write_b128 v105, a[140:143] offset:3072
    ds_write_b128 v105, a[144:147] offset:4096
    v_lshlrev_b32 v24, 16, v116
    v_and_b32 v25, 0xffff0000, v116
    v_lshlrev_b32 v26, 16, v117
    v_and_b32 v27, 0xffff0000, v117
    v_lshlrev_b32 v28, 16, v118
    v_and_b32 v29, 0xffff0000, v118
    v_lshlrev_b32 v30, 16, v119
    v_and_b32 v31, 0xffff0000, v119
    s_waitcnt vmcnt(16)
    v_lshlrev_b32 v16, 16, v120
    v_and_b32 v17, 0xffff0000, v120
    v_lshlrev_b32 v18, 16, v121
    v_and_b32 v19, 0xffff0000, v121
    v_lshlrev_b32 v20, 16, v122
    v_and_b32 v21, 0xffff0000, v122
    v_lshlrev_b32 v22, 16, v123
    v_and_b32 v23, 0xffff0000, v123
    s_waitcnt vmcnt(15)
    ds_write_b128 v105, a[148:151] offset:5120
    ds_write_b128 v105, a[152:155] offset:6144
    v_lshlrev_b32 v100, 16, v124
    v_and_b32 v101, 0xffff0000, v124
    v_pk_add_f32 v[24:25], v[24:25], v[100:101]
    v_lshlrev_b32 v102, 16, v125
    v_and_b32 v103, 0xffff0000, v125
    v_pk_add_f32 v[26:27], v[26:27], v[102:103]
    v_lshlrev_b32 v100, 16, v126
    v_and_b32 v101, 0xffff0000, v126
    v_pk_add_f32 v[28:29], v[28:29], v[100:101]
    v_lshlrev_b32 v102, 16, v127
    v_and_b32 v103, 0xffff0000, v127
    v_pk_add_f32 v[30:31], v[30:31], v[102:103]
    s_waitcnt vmcnt(14)
    v_lshlrev_b32 v100, 16, v128
    v_and_b32 v101, 0xffff0000, v128
    v_pk_add_f32 v[16:17], v[16:17], v[100:101]
    v_lshlrev_b32 v102, 16, v129
    v_and_b32 v103, 0xffff0000, v129
    v_pk_add_f32 v[18:19], v[18:19], v[102:103]
    v_lshlrev_b32 v100, 16, v130
    v_and_b32 v101, 0xffff0000, v130
    v_pk_add_f32 v[20:21], v[20:21], v[100:101]
    v_lshlrev_b32 v102, 16, v131
    v_and_b32 v103, 0xffff0000, v131
    v_pk_add_f32 v[22:23], v[22:23], v[102:103]
    s_waitcnt vmcnt(13)
    ds_write_b128 v105, a[156:159] offset:7168
    ds_write_b128 v105, a[160:163] offset:8192
    v_lshlrev_b32 v100, 16, v132
    v_and_b32 v101, 0xffff0000, v132
    v_pk_add_f32 v[24:25], v[24:25], v[100:101]
    v_lshlrev_b32 v102, 16, v133
    v_and_b32 v103, 0xffff0000, v133
    v_pk_add_f32 v[26:27], v[26:27], v[102:103]
    v_lshlrev_b32 v100, 16, v134
    v_and_b32 v101, 0xffff0000, v134
    v_pk_add_f32 v[28:29], v[28:29], v[100:101]
    v_lshlrev_b32 v102, 16, v135
    v_and_b32 v103, 0xffff0000, v135
    v_pk_add_f32 v[30:31], v[30:31], v[102:103]
    s_waitcnt vmcnt(12)
    v_lshlrev_b32 v100, 16, v136
    v_and_b32 v101, 0xffff0000, v136
    v_pk_add_f32 v[16:17], v[16:17], v[100:101]
    v_lshlrev_b32 v102, 16, v137
    v_and_b32 v103, 0xffff0000, v137
    v_pk_add_f32 v[18:19], v[18:19], v[102:103]
    v_lshlrev_b32 v100, 16, v138
    v_and_b32 v101, 0xffff0000, v138
    v_pk_add_f32 v[20:21], v[20:21], v[100:101]
    v_lshlrev_b32 v102, 16, v139
    v_and_b32 v103, 0xffff0000, v139
    v_pk_add_f32 v[22:23], v[22:23], v[102:103]
    s_waitcnt vmcnt(11)
    ds_write_b128 v104, a[164:167] offset:36864
    ds_write_b128 v104, a[168:171] offset:37888
    v_lshlrev_b32 v100, 16, v140
    v_and_b32 v101, 0xffff0000, v140
    v_pk_add_f32 v[24:25], v[24:25], v[100:101]
    v_lshlrev_b32 v102, 16, v141
    v_and_b32 v103, 0xffff0000, v141
    v_pk_add_f32 v[26:27], v[26:27], v[102:103]
    v_lshlrev_b32 v100, 16, v142
    v_and_b32 v101, 0xffff0000, v142
    v_pk_add_f32 v[28:29], v[28:29], v[100:101]
    v_lshlrev_b32 v102, 16, v143
    v_and_b32 v103, 0xffff0000, v143
    v_pk_add_f32 v[30:31], v[30:31], v[102:103]
    s_waitcnt vmcnt(10)
    v_lshlrev_b32 v100, 16, v144
    v_and_b32 v101, 0xffff0000, v144
    v_pk_add_f32 v[16:17], v[16:17], v[100:101]
    v_lshlrev_b32 v102, 16, v145
    v_and_b32 v103, 0xffff0000, v145
    v_pk_add_f32 v[18:19], v[18:19], v[102:103]
    v_lshlrev_b32 v100, 16, v146
    v_and_b32 v101, 0xffff0000, v146
    v_pk_add_f32 v[20:21], v[20:21], v[100:101]
    v_lshlrev_b32 v102, 16, v147
    v_and_b32 v103, 0xffff0000, v147
    v_pk_add_f32 v[22:23], v[22:23], v[102:103]
    s_waitcnt vmcnt(8)
    ds_write_b128 v104, a[172:175] offset:38912
    ds_write_b128 v104, a[176:179] offset:39936
    v_lshlrev_b32 v100, 16, v148
    v_and_b32 v101, 0xffff0000, v148
    v_pk_add_f32 v[32:33], v[32:33], v[100:101]
    v_lshlrev_b32 v102, 16, v149
    v_and_b32 v103, 0xffff0000, v149
    v_pk_add_f32 v[34:35], v[34:35], v[102:103]
    v_lshlrev_b32 v100, 16, v150
    v_and_b32 v101, 0xffff0000, v150
    v_pk_add_f32 v[36:37], v[36:37], v[100:101]
    v_lshlrev_b32 v102, 16, v151
    v_and_b32 v103, 0xffff0000, v151
    v_pk_add_f32 v[38:39], v[38:39], v[102:103]
    s_waitcnt vmcnt(7)
    ds_write_b128 v104, a[180:183] offset:40960
    ds_write_b128 v104, a[184:187] offset:41984
    v_lshlrev_b32 v100, 16, v152
    v_and_b32 v101, 0xffff0000, v152
    v_pk_add_f32 v[24:25], v[24:25], v[100:101]
    v_lshlrev_b32 v102, 16, v153
    v_and_b32 v103, 0xffff0000, v153
    v_pk_add_f32 v[26:27], v[26:27], v[102:103]
    v_lshlrev_b32 v100, 16, v154
    v_and_b32 v101, 0xffff0000, v154
    v_pk_add_f32 v[28:29], v[28:29], v[100:101]
    v_lshlrev_b32 v102, 16, v155
    v_and_b32 v103, 0xffff0000, v155
    v_pk_add_f32 v[30:31], v[30:31], v[102:103]
    s_waitcnt vmcnt(6)
    v_lshlrev_b32 v100, 16, v156
    v_and_b32 v101, 0xffff0000, v156
    v_pk_add_f32 v[16:17], v[16:17], v[100:101]
    v_lshlrev_b32 v102, 16, v157
    v_and_b32 v103, 0xffff0000, v157
    v_pk_add_f32 v[18:19], v[18:19], v[102:103]
    v_lshlrev_b32 v100, 16, v158
    v_and_b32 v101, 0xffff0000, v158
    v_pk_add_f32 v[20:21], v[20:21], v[100:101]
    v_lshlrev_b32 v102, 16, v159
    v_and_b32 v103, 0xffff0000, v159
    v_pk_add_f32 v[22:23], v[22:23], v[102:103]
    s_waitcnt vmcnt(5)
    v_cmp_ne_u32 vcc, 0, v9
    s_nop 0
    s_lshr_b32 s3, vcc_lo, 1
    s_and_b32 s3, s3, vcc_lo
    s_lshr_b32 s14, s3, 2
    s_and_b32 s3, s3, s14
    s_and_b32 s3, s3, s48
    s_cbranch_scc0 L2_g2s
L2_g2r:
    s_ff1_i32_b32 s3, s3
    s_bitset0_b32 s48, s3
    s_mul_i32 s46, s3, 9216
    buffer_load_dword v9, v6, s[84:87], s47 offen sc1
    buffer_load_dwordx4 v[184:187], v7, s[88:91], s46 offen sc1
    ds_write_b128 v104, a[188:191] offset:43008
    ds_write_b128 v104, a[192:195] offset:44032
    v_lshlrev_b32 v100, 16, v160
    v_and_b32 v101, 0xffff0000, v160
    v_pk_add_f32 v[24:25], v[24:25], v[100:101]
    v_lshlrev_b32 v102, 16, v161
    v_and_b32 v103, 0xffff0000, v161
    v_pk_add_f32 v[26:27], v[26:27], v[102:103]
    v_lshlrev_b32 v100, 16, v162
    v_and_b32 v101, 0xffff0000, v162
    v_pk_add_f32 v[28:29], v[28:29], v[100:101]
    v_lshlrev_b32 v102, 16, v163
    v_and_b32 v103, 0xffff0000, v163
    v_pk_add_f32 v[30:31], v[30:31], v[102:103]
    s_waitcnt vmcnt(6)
    v_lshlrev_b32 v100, 16, v164
    v_and_b32 v101, 0xffff0000, v164
    v_pk_add_f32 v[16:17], v[16:17], v[100:101]
    v_lshlrev_b32 v102, 16, v165
    v_and_b32 v103, 0xffff0000, v165
    v_pk_add_f32 v[18:19], v[18:19], v[102:103]
    v_lshlrev_b32 v100, 16, v166
    v_and_b32 v101, 0xffff0000, v166
    v_pk_add_f32 v[20:21], v[20:21], v[100:101]
    v_lshlrev_b32 v102, 16, v167
    v_and_b32 v103, 0xffff0000, v167
    v_pk_add_f32 v[22:23], v[22:23], v[102:103]
    s_waitcnt vmcnt(5)
    buffer_load_dwordx4 v[188:191], v5, s[88:91], s46 offen sc1
    buffer_load_dwordx4 v[192:195], v5, s[28:31], s46 offen sc1
    ds_write_b128 v104, a[196:199] offset:45056
    v_lshlrev_b32 v100, 16, v168
    v_and_b32 v101, 0xffff0000, v168
    v_pk_add_f32 v[24:25], v[24:25], v[100:101]
    v_lshlrev_b32 v102, 16, v169
    v_and_b32 v103, 0xffff0000, v169
    v_pk_add_f32 v[26:27], v[26:27], v[102:103]
    v_lshlrev_b32 v100, 16, v170
    v_and_b32 v101, 0xffff0000, v170
    v_pk_add_f32 v[28:29], v[28:29], v[100:101]
    v_lshlrev_b32 v102, 16, v171
    v_and_b32 v103, 0xffff0000, v171
    v_pk_add_f32 v[30:31], v[30:31], v[102:103]
    s_waitcnt vmcnt(6)
    v_lshlrev_b32 v100, 16, v172
    v_and_b32 v101, 0xffff0000, v172
    v_pk_add_f32 v[16:17], v[16:17], v[100:101]
    v_lshlrev_b32 v102, 16, v173
    v_and_b32 v103, 0xffff0000, v173
    v_pk_add_f32 v[18:19], v[18:19], v[102:103]
    v_lshlrev_b32 v100, 16, v174
    v_and_b32 v101, 0xffff0000, v174
    v_pk_add_f32 v[20:21], v[20:21], v[100:101]
    v_lshlrev_b32 v102, 16, v175
    v_and_b32 v103, 0xffff0000, v175
    v_pk_add_f32 v[22:23], v[22:23], v[102:103]
    s_waitcnt vmcnt(5)
    s_add_u32 s46, s46, 9216
    buffer_load_dwordx4 v[196:199], v5, s[88:91], s46 offen sc1
    buffer_load_dwordx4 v[200:203], v5, s[28:31], s46 offen sc1
    v_lshlrev_b32 v100, 16, v176
    v_and_b32 v101, 0xffff0000, v176
    v_pk_add_f32 v[24:25], v[24:25], v[100:101]
    v_lshlrev_b32 v102, 16, v177
    v_and_b32 v103, 0xffff0000, v177
    v_pk_add_f32 v[26:27], v[26:27], v[102:103]
    v_lshlrev_b32 v100, 16, v178
    v_and_b32 v101, 0xffff0000, v178
L2_pad14:
    s_cbranch_execz L2_walkret
    v_pk_add_f32 v[28:29], v[28:29], v[100:101]
    v_lshlrev_b32 v102, 16, v179
    v_and_b32 v103, 0xffff0000, v179
    v_pk_add_f32 v[30:31], v[30:31], v[102:103]
    s_waitcnt vmcnt(6)
    v_lshlrev_b32 v100, 16, v180
    v_and_b32 v101, 0xffff0000, v180
    v_pk_add_f32 v[16:17], v[16:17], v[100:101]
    v_lshlrev_b32 v102, 16, v181
    v_and_b32 v103, 0xffff0000, v181
    v_pk_add_f32 v[18:19], v[18:19], v[102:103]
    v_lshlrev_b32 v100, 16, v182
    v_and_b32 v101, 0xffff0000, v182
    v_pk_add_f32 v[20:21], v[20:21], v[100:101]
    v_lshlrev_b32 v102, 16, v183
    v_and_b32 v103, 0xffff0000, v183
    v_pk_add_f32 v[22:23], v[22:23], v[102:103]
    s_waitcnt vmcnt(4)
    s_add_u32 s46, s46, 9216
    buffer_load_dwordx4 v[204:207], v5, s[88:91], s46 offen sc1
    buffer_load_dwordx4 v[208:211], v5, s[28:31], s46 offen sc1
    v_lshlrev_b32 v100, 16, v184
    v_and_b32 v101, 0xffff0000, v184
    v_pk_add_f32 v[32:33], v[32:33], v[100:101]
    v_lshlrev_b32 v102, 16, v185
    v_and_b32 v103, 0xffff0000, v185
    v_pk_add_f32 v[34:35], v[34:35], v[102:103]
    v_lshlrev_b32 v100, 16, v186
    v_and_b32 v101, 0xffff0000, v186
    v_pk_add_f32 v[36:37], v[36:37], v[100:101]
    v_lshlrev_b32 v102, 16, v187
    v_and_b32 v103, 0xffff0000, v187
    v_pk_add_f32 v[38:39], v[38:39], v[102:103]
    ds_read_b128 v[112:115], v3 offset:4608
    ds_read_b128 v[116:119], v3 offset:4624
    ds_read_b128 v[120:123], v3 offset:5632
    ds_read_b128 v[124:127], v3 offset:5648
    ds_read_b128 v[128:131], v4 offset:6656
    ds_read_b128 v[132:135], v4 offset:6672
    ds_read_b128 v[136:139], v3 offset:2304
    ds_read_b128 v[140:143], v3 offset:2320
    ds_read_b128 v[144:147], v3 offset:3328
    ds_read_b128 v[148:151], v3 offset:3344
    ds_read_b128 v[152:155], v4 offset:4352
    ds_read_b128 v[156:159], v4 offset:4368
    ds_read_b128 v[160:163], v3 offset:6912
    ds_read_b128 v[164:167], v3 offset:6928
    ds_read_b128 v[168:171], v3 offset:7936
    ds_read_b128 v[172:175], v3 offset:7952
    ds_read_b128 v[176:179], v4 offset:8960
    ds_read_b128 v[180:183], v4 offset:8976
    s_waitcnt vmcnt(5)
    s_add_u32 s46, s46, 9216
    buffer_load_dwordx4 v[212:215], v5, s[88:91], s46 offen sc1
    buffer_load_dwordx4 v[216:219], v5, s[28:31], s46 offen sc1
    v_lshlrev_b32 v100, 16, v188
    v_and_b32 v101, 0xffff0000, v188
    v_pk_add_f32 v[24:25], v[24:25], v[100:101]
    v_lshlrev_b32 v102, 16, v189
    v_and_b32 v103, 0xffff0000, v189
    v_pk_add_f32 v[26:27], v[26:27], v[102:103]
    v_lshlrev_b32 v100, 16, v190
    v_and_b32 v101, 0xffff0000, v190
    v_pk_add_f32 v[28:29], v[28:29], v[100:101]
    v_lshlrev_b32 v102, 16, v191
    v_and_b32 v103, 0xffff0000, v191
    v_pk_add_f32 v[30:31], v[30:31], v[102:103]
    s_waitcnt vmcnt(6)
    v_lshlrev_b32 v100, 16, v192
    v_and_b32 v101, 0xffff0000, v192
    v_pk_add_f32 v[16:17], v[16:17], v[100:101]
    v_lshlrev_b32 v102, 16, v193
    v_and_b32 v103, 0xffff0000, v193
    v_pk_add_f32 v[18:19], v[18:19], v[102:103]
    v_lshlrev_b32 v100, 16, v194
    v_and_b32 v101, 0xffff0000, v194
    v_pk_add_f32 v[20:21], v[20:21], v[100:101]
    v_lshlrev_b32 v102, 16, v195
    v_and_b32 v103, 0xffff0000, v195
    v_pk_add_f32 v[22:23], v[22:23], v[102:103]
    s_waitcnt vmcnt(5)
    v_cmp_ne_u32 vcc, 0, v9
    s_nop 0
    s_lshr_b32 s3, vcc_lo, 1
    s_and_b32 s3, s3, vcc_lo
    s_lshr_b32 s14, s3, 2
    s_and_b32 s3, s3, s14
    s_and_b32 s3, s3, s48
    s_cbranch_scc0 L2_g3s
L2_g3r:
    s_ff1_i32_b32 s3, s3
    s_bitset0_b32 s48, s3
    s_mul_i32 s46, s3, 9216
    buffer_load_dwordx4 v[220:223], v7, s[88:91], s46 offen sc1
    v_lshlrev_b32 v100, 16, v196
    v_and_b32 v101, 0xffff0000, v196
    v_pk_add_f32 v[24:25], v[24:25], v[100:101]
    v_lshlrev_b32 v102, 16, v197
    v_and_b32 v103, 0xffff0000, v197
    v_pk_add_f32 v[26:27], v[26:27], v[102:103]
    v_lshlrev_b32 v100, 16, v198
    v_and_b32 v101, 0xffff0000, v198
    v_pk_add_f32 v[28:29], v[28:29], v[100:101]
    v_lshlrev_b32 v102, 16, v199
    v_and_b32 v103, 0xffff0000, v199
    v_pk_add_f32 v[30:31], v[30:31], v[102:103]
    s_waitcnt vmcnt(5)
    v_lshlrev_b32 v100, 16, v200
    v_and_b32 v101, 0xffff0000, v200
    v_pk_add_f32 v[16:17], v[16:17], v[100:101]
    v_lshlrev_b32 v102, 16, v201
    v_and_b32 v103, 0xffff0000, v201
    v_pk_add_f32 v[18:19], v[18:19], v[102:103]
    v_lshlrev_b32 v100, 16, v202
    v_and_b32 v101, 0xffff0000, v202
    v_pk_add_f32 v[20:21], v[20:21], v[100:101]
    v_lshlrev_b32 v102, 16, v203
    v_and_b32 v103, 0xffff0000, v203
    v_pk_add_f32 v[22:23], v[22:23], v[102:103]
    s_waitcnt vmcnt(4)
    buffer_load_dwordx4 v[224:227], v5, s[88:91], s46 offen sc1
    buffer_load_dwordx4 v[228:231], v5, s[28:31], s46 offen sc1
    v_lshlrev_b32 v100, 16, v204
    v_and_b32 v101, 0xffff0000, v204
    v_pk_add_f32 v[24:25], v[24:25], v[100:101]
    v_lshlrev_b32 v102, 16, v205
    v_and_b32 v103, 0xffff0000, v205
    v_pk_add_f32 v[26:27], v[26:27], v[102:103]
    v_lshlrev_b32 v100, 16, v206
    v_and_b32 v101, 0xffff0000, v206
    v_pk_add_f32 v[28:29], v[28:29], v[100:101]
    v_lshlrev_b32 v102, 16, v207
    v_and_b32 v103, 0xffff0000, v207
    v_pk_add_f32 v[30:31], v[30:31], v[102:103]
    s_waitcnt vmcnt(5)
    v_lshlrev_b32 v100, 16, v208
    v_and_b32 v101, 0xffff0000, v208
    v_pk_add_f32 v[16:17], v[16:17], v[100:101]
    v_lshlrev_b32 v102, 16, v209
    v_and_b32 v103, 0xffff0000, v209
    v_pk_add_f32 v[18:19], v[18:19], v[102:103]
    v_lshlrev_b32 v100, 16, v210
    v_and_b32 v101, 0xffff0000, v210
    v_pk_add_f32 v[20:21], v[20:21], v[100:101]
    v_lshlrev_b32 v102, 16, v211
    v_and_b32 v103, 0xffff0000, v211
    v_pk_add_f32 v[22:23], v[22:23], v[102:103]
    s_waitcnt vmcnt(4)
    s_add_u32 s46, s46, 9216
    buffer_load_dwordx4 v[232:235], v5, s[88:91], s46 offen sc1
    buffer_load_dwordx4 v[236:239], v5, s[28:31], s46 offen sc1
    v_lshlrev_b32 v100, 16, v212
    v_and_b32 v101, 0xffff0000, v212
    v_pk_add_f32 v[24:25], v[24:25], v[100:101]
    v_lshlrev_b32 v102, 16, v213
    v_and_b32 v103, 0xffff0000, v213
    v_pk_add_f32 v[26:27], v[26:27], v[102:103]
    v_lshlrev_b32 v100, 16, v214
    v_and_b32 v101, 0xffff0000, v214
    v_pk_add_f32 v[28:29], v[28:29], v[100:101]
    v_lshlrev_b32 v102, 16, v215
    v_and_b32 v103, 0xffff0000, v215
    v_pk_add_f32 v[30:31], v[30:31], v[102:103]
    s_waitcnt vmcnt(5)
    v_lshlrev_b32 v100, 16, v216
    v_and_b32 v101, 0xffff0000, v216
    v_pk_add_f32 v[16:17], v[16:17], v[100:101]
    v_lshlrev_b32 v102, 16, v217
    v_and_b32 v103, 0xffff0000, v217
    v_pk_add_f32 v[18:19], v[18:19], v[102:103]
    v_lshlrev_b32 v100, 16, v218
    v_and_b32 v101, 0xffff0000, v218
    v_pk_add_f32 v[20:21], v[20:21], v[100:101]
    v_lshlrev_b32 v102, 16, v219
    v_and_b32 v103, 0xffff0000, v219
    v_pk_add_f32 v[22:23], v[22:23], v[102:103]
    s_waitcnt vmcnt(4)
    s_add_u32 s46, s46, 9216
    buffer_load_dwordx4 v[240:243], v5, s[88:91], s46 offen sc1
    buffer_load_dwordx4 v[244:247], v5, s[28:31], s46 offen sc1
    v_lshlrev_b32 v100, 16, v220
    v_and_b32 v101, 0xffff0000, v220
    v_pk_add_f32 v[32:33], v[32:33], v[100:101]
    v_lshlrev_b32 v102, 16, v221
    v_and_b32 v103, 0xffff0000, v221
    v_pk_add_f32 v[34:35], v[34:35], v[102:103]
    v_lshlrev_b32 v100, 16, v222
    v_and_b32 v101, 0xffff0000, v222
    v_pk_add_f32 v[36:37], v[36:37], v[100:101]
    v_lshlrev_b32 v102, 16, v223
    v_and_b32 v103, 0xffff0000, v223
    v_pk_add_f32 v[38:39], v[38:39], v[102:103]
    s_lshl_b32 s3, s96, 3
    s_sub_u32 s3, 0xfff, s3
    v_and_b32 v6, 7, v0
    v_sub_u32 v6, s3, v6
    s_mov_b32 s57, 0xfffff000
    s_mul_i32 s58, s96, 128
    s_add_u32 s58, s58, 6815744
    s_xor_b32 s3, s51, 2
    v_or_b32 v9, s3, v0
    v_min_u32 v9, 1, v9
    v_lshlrev_b32 v9, 30, v9
    v_mov_b32 v208, v32
    v_mov_b32 v209, v33
    v_mov_b32 v210, v34
    v_mov_b32 v211, v35
    v_mov_b32 v212, v36
    v_mov_b32 v213, v37
    v_mov_b32 v214, v38
    v_mov_b32 v215, v39
    v_permlane16_swap_b32 v208, v32
    v_permlane16_swap_b32 v209, v33
    v_permlane16_swap_b32 v210, v34
    v_permlane16_swap_b32 v211, v35
    v_permlane16_swap_b32 v212, v36
    v_permlane16_swap_b32 v213, v37
    v_permlane16_swap_b32 v214, v38
    v_permlane16_swap_b32 v215, v39
    v_add_f32 v32, v32, v208
    v_add_f32 v33, v33, v209
    v_add_f32 v34, v34, v210
    v_add_f32 v35, v35, v211
    v_add_f32 v36, v36, v212
    v_add_f32 v37, v37, v213
    v_add_f32 v38, v38, v214
    v_add_f32 v39, v39, v215
    v_mov_b32 v208, v32
    v_mov_b32 v209, v33
    v_mov_b32 v210, v34
    v_mov_b32 v211, v35
    v_mov_b32 v212, v36
    v_mov_b32 v213, v37
    v_mov_b32 v214, v38
    v_mov_b32 v215, v39
    v_permlane32_swap_b32 v208, v32
    v_permlane32_swap_b32 v209, v33
    v_permlane32_swap_b32 v210, v34
    v_permlane32_swap_b32 v211, v35
    v_permlane32_swap_b32 v212, v36
    v_permlane32_swap_b32 v213, v37
    v_permlane32_swap_b32 v214, v38
    v_permlane32_swap_b32 v215, v39
    v_add_f32 v32, v32, v208
    v_add_f32 v33, v33, v209
    v_add_f32 v34, v34, v210
    v_add_f32 v35, v35, v211
    v_add_f32 v36, v36, v212
    v_add_f32 v37, v37, v213
    v_add_f32 v38, v38, v214
    v_add_f32 v39, v39, v215
    v_lshlrev_b32 v184, 16, v64
    v_and_b32 v185, 0xffff0000, v64
    v_lshlrev_b32 v186, 16, v65
    v_and_b32 v187, 0xffff0000, v65
    v_lshlrev_b32 v188, 16, v66
    v_and_b32 v189, 0xffff0000, v66
    v_lshlrev_b32 v190, 16, v67
    v_and_b32 v191, 0xffff0000, v67
    v_lshlrev_b32 v192, 16, v68
    v_and_b32 v193, 0xffff0000, v68
    v_lshlrev_b32 v194, 16, v69
    v_and_b32 v195, 0xffff0000, v69
    v_lshlrev_b32 v196, 16, v70
    v_and_b32 v197, 0xffff0000, v70
    v_lshlrev_b32 v198, 16, v71
    v_and_b32 v199, 0xffff0000, v71
    v_lshlrev_b32 v200, 16, v72
    v_and_b32 v201, 0xffff0000, v72
    v_lshlrev_b32 v202, 16, v73
    v_and_b32 v203, 0xffff0000, v73
    v_lshlrev_b32 v204, 16, v74
    v_and_b32 v205, 0xffff0000, v74
    v_lshlrev_b32 v206, 16, v75
    v_and_b32 v207, 0xffff0000, v75
    s_cmp_lt_u32 s2, 180
    s_cselect_b32 s3, 2, 0
    s_cmp_lt_u32 s51, s3
    s_cselect_b32 s3, 0, 0x40000000
    v_mul_u32_u24 v68, 128, v0
    v_or_b32 v68, s3, v68
    s_mul_i32 s15, s51, 16384
    s_add_u32 s15, s15, 6815744
    s_add_u32 s59, s15, 8192
    s_lshl_b32 s3, s51, 7
    s_sub_u32 s3, s96, s3
    v_cmp_eq_u32 s[60:61], s3, v0
    s_sub_u32 s3, s3, 64
    v_cmp_eq_u32 s[62:63], s3, v0
    s_waitcnt vmcnt(5)
    s_add_u32 s46, s46, 9216
    buffer_load_dwordx4 v[248:251], v5, s[88:91], s46 offen sc1
    buffer_load_dwordx4 v[252:255], v5, s[28:31], s46 offen sc1
    v_lshlrev_b32 v100, 16, v224
    v_and_b32 v101, 0xffff0000, v224
    v_pk_add_f32 v[24:25], v[24:25], v[100:101]
    v_lshlrev_b32 v102, 16, v225
    v_and_b32 v103, 0xffff0000, v225
    v_pk_add_f32 v[26:27], v[26:27], v[102:103]
    v_lshlrev_b32 v100, 16, v226
    v_and_b32 v101, 0xffff0000, v226
    v_pk_add_f32 v[28:29], v[28:29], v[100:101]
    v_lshlrev_b32 v102, 16, v227
    v_and_b32 v103, 0xffff0000, v227
    v_pk_add_f32 v[30:31], v[30:31], v[102:103]
    s_waitcnt vmcnt(6)
    v_lshlrev_b32 v100, 16, v228
    v_and_b32 v101, 0xffff0000, v228
    v_pk_add_f32 v[16:17], v[16:17], v[100:101]
    v_lshlrev_b32 v102, 16, v229
    v_and_b32 v103, 0xffff0000, v229
    v_pk_add_f32 v[18:19], v[18:19], v[102:103]
    v_lshlrev_b32 v100, 16, v230
    v_and_b32 v101, 0xffff0000, v230
    v_pk_add_f32 v[20:21], v[20:21], v[100:101]
    v_lshlrev_b32 v102, 16, v231
    v_and_b32 v103, 0xffff0000, v231
    v_pk_add_f32 v[22:23], v[22:23], v[102:103]
    s_waitcnt vmcnt(5)
    v_lshlrev_b32 v100, 16, v232
    v_and_b32 v101, 0xffff0000, v232
    v_pk_add_f32 v[24:25], v[24:25], v[100:101]
    v_lshlrev_b32 v102, 16, v233
    v_and_b32 v103, 0xffff0000, v233
    v_pk_add_f32 v[26:27], v[26:27], v[102:103]
    v_lshlrev_b32 v100, 16, v234
    v_and_b32 v101, 0xffff0000, v234
    v_pk_add_f32 v[28:29], v[28:29], v[100:101]
    v_lshlrev_b32 v102, 16, v235
    v_and_b32 v103, 0xffff0000, v235
    v_pk_add_f32 v[30:31], v[30:31], v[102:103]
    s_waitcnt vmcnt(4)
    v_lshlrev_b32 v100, 16, v236
    v_and_b32 v101, 0xffff0000, v236
    v_pk_add_f32 v[16:17], v[16:17], v[100:101]
    v_lshlrev_b32 v102, 16, v237
    v_and_b32 v103, 0xffff0000, v237
    v_pk_add_f32 v[18:19], v[18:19], v[102:103]
    v_lshlrev_b32 v100, 16, v238
    v_and_b32 v101, 0xffff0000, v238
    v_pk_add_f32 v[20:21], v[20:21], v[100:101]
    v_lshlrev_b32 v102, 16, v239
    v_and_b32 v103, 0xffff0000, v239
    v_pk_add_f32 v[22:23], v[22:23], v[102:103]
    s_waitcnt vmcnt(3)
    v_lshlrev_b32 v100, 16, v240
    v_and_b32 v101, 0xffff0000, v240
    v_pk_add_f32 v[24:25], v[24:25], v[100:101]
    v_lshlrev_b32 v102, 16, v241
    v_and_b32 v103, 0xffff0000, v241
    v_pk_add_f32 v[26:27], v[26:27], v[102:103]
    v_lshlrev_b32 v100, 16, v242
    v_and_b32 v101, 0xffff0000, v242
    v_pk_add_f32 v[28:29], v[28:29], v[100:101]
    v_lshlrev_b32 v102, 16, v243
    v_and_b32 v103, 0xffff0000, v243
    v_pk_add_f32 v[30:31], v[30:31], v[102:103]
    s_waitcnt vmcnt(2)
    v_lshlrev_b32 v100, 16, v244
    v_and_b32 v101, 0xffff0000, v244
    v_pk_add_f32 v[16:17], v[16:17], v[100:101]
    v_lshlrev_b32 v102, 16, v245
    v_and_b32 v103, 0xffff0000, v245
    v_pk_add_f32 v[18:19], v[18:19], v[102:103]
    v_lshlrev_b32 v100, 16, v246
    v_and_b32 v101, 0xffff0000, v246
    v_pk_add_f32 v[20:21], v[20:21], v[100:101]
    v_lshlrev_b32 v102, 16, v247
    v_and_b32 v103, 0xffff0000, v247
    v_pk_add_f32 v[22:23], v[22:23], v[102:103]
    s_waitcnt vmcnt(1)
    v_lshlrev_b32 v100, 16, v248
    v_and_b32 v101, 0xffff0000, v248
    v_pk_add_f32 v[24:25], v[24:25], v[100:101]
    v_lshlrev_b32 v102, 16, v249
    v_and_b32 v103, 0xffff0000, v249
    v_pk_add_f32 v[26:27], v[26:27], v[102:103]
    v_lshlrev_b32 v100, 16, v250
    v_and_b32 v101, 0xffff0000, v250
    v_pk_add_f32 v[28:29], v[28:29], v[100:101]
    v_lshlrev_b32 v102, 16, v251
    v_and_b32 v103, 0xffff0000, v251
    v_pk_add_f32 v[30:31], v[30:31], v[102:103]
    s_waitcnt vmcnt(0)
    v_lshlrev_b32 v100, 16, v252
    v_and_b32 v101, 0xffff0000, v252
    v_pk_add_f32 v[16:17], v[16:17], v[100:101]
    v_lshlrev_b32 v102, 16, v253
    v_and_b32 v103, 0xffff0000, v253
    v_pk_add_f32 v[18:19], v[18:19], v[102:103]
    v_lshlrev_b32 v100, 16, v254
    v_and_b32 v101, 0xffff0000, v254
    v_pk_add_f32 v[20:21], v[20:21], v[100:101]
    v_lshlrev_b32 v102, 16, v255
    v_and_b32 v103, 0xffff0000, v255
    v_pk_add_f32 v[22:23], v[22:23], v[102:103]
    v_pk_fma_f32 v[16:17], v[16:17], v[40:41], v[184:185]
    v_pk_fma_f32 v[18:19], v[18:19], v[42:43], v[186:187]
    v_pk_fma_f32 v[20:21], v[20:21], v[44:45], v[188:189]
    v_pk_fma_f32 v[22:23], v[22:23], v[46:47], v[190:191]
    v_pk_fma_f32 v[24:25], v[24:25], v[48:49], v[192:193]
    v_pk_fma_f32 v[26:27], v[26:27], v[50:51], v[194:195]
    v_pk_fma_f32 v[28:29], v[28:29], v[52:53], v[196:197]
    v_pk_fma_f32 v[30:31], v[30:31], v[54:55], v[198:199]
    v_pk_fma_f32 v[32:33], v[32:33], v[56:57], v[200:201]
    v_pk_fma_f32 v[34:35], v[34:35], v[58:59], v[202:203]
    v_pk_fma_f32 v[36:37], v[36:37], v[60:61], v[204:205]
    v_pk_fma_f32 v[38:39], v[38:39], v[62:63], v[206:207]
    v_pk_add_f32 v[12:13], v[16:17], v[18:19]
    v_pk_add_f32 v[12:13], v[12:13], v[20:21]
    v_pk_add_f32 v[12:13], v[12:13], v[22:23]
    v_pk_add_f32 v[12:13], v[12:13], v[24:25]
    v_pk_add_f32 v[12:13], v[12:13], v[26:27]
    v_pk_add_f32 v[12:13], v[12:13], v[28:29]
    v_pk_add_f32 v[12:13], v[12:13], v[30:31]
    v_pk_add_f32 v[14:15], v[32:33], v[34:35]
    v_pk_add_f32 v[14:15], v[14:15], v[36:37]
    v_pk_add_f32 v[14:15], v[14:15], v[38:39]
    v_add_f32 v100, v12, v13
    v_add_f32 v14, v14, v15
    v_fmac_f32 v100, 0x3e800000, v14
    s_nop 1
    v_add_f32_dpp v100, v100, v100 row_ror:8 row_mask:0xf bank_mask:0xf
    v_mov_b32 v103, v100
    s_nop 1
    v_permlane16_swap_b32 v103, v100
    v_add_f32 v100, v100, v103
    v_mov_b32 v103, v100
    s_nop 1
    v_permlane32_swap_b32 v103, v100
    v_add_f32 v100, v100, v103
    v_mul_f32 v100, 0x3be38e39, v100
    v_pk_add_f32 v[184:185], v[16:17], v[100:101] op_sel_hi:[1,0] neg_lo:[0,1] neg_hi:[0,1]
    v_pk_add_f32 v[186:187], v[18:19], v[100:101] op_sel_hi:[1,0] neg_lo:[0,1] neg_hi:[0,1]
    v_pk_add_f32 v[188:189], v[20:21], v[100:101] op_sel_hi:[1,0] neg_lo:[0,1] neg_hi:[0,1]
    v_pk_add_f32 v[190:191], v[22:23], v[100:101] op_sel_hi:[1,0] neg_lo:[0,1] neg_hi:[0,1]
    v_pk_add_f32 v[192:193], v[24:25], v[100:101] op_sel_hi:[1,0] neg_lo:[0,1] neg_hi:[0,1]
    v_pk_add_f32 v[194:195], v[26:27], v[100:101] op_sel_hi:[1,0] neg_lo:[0,1] neg_hi:[0,1]
    v_pk_add_f32 v[196:197], v[28:29], v[100:101] op_sel_hi:[1,0] neg_lo:[0,1] neg_hi:[0,1]
    v_pk_add_f32 v[198:199], v[30:31], v[100:101] op_sel_hi:[1,0] neg_lo:[0,1] neg_hi:[0,1]
    v_pk_add_f32 v[200:201], v[32:33], v[100:101] op_sel_hi:[1,0] neg_lo:[0,1] neg_hi:[0,1]
    v_pk_add_f32 v[202:203], v[34:35], v[100:101] op_sel_hi:[1,0] neg_lo:[0,1] neg_hi:[0,1]
    v_pk_add_f32 v[204:205], v[36:37], v[100:101] op_sel_hi:[1,0] neg_lo:[0,1] neg_hi:[0,1]
    v_pk_add_f32 v[206:207], v[38:39], v[100:101] op_sel_hi:[1,0] neg_lo:[0,1] neg_hi:[0,1]
    v_pk_mul_f32 v[12:13], v[184:185], v[184:185]
    v_pk_fma_f32 v[12:13], v[186:187], v[186:187], v[12:13]
    v_pk_fma_f32 v[12:13], v[188:189], v[188:189], v[12:13]
    v_pk_fma_f32 v[12:13], v[190:191], v[190:191], v[12:13]
    v_pk_fma_f32 v[12:13], v[192:193], v[192:193], v[12:13]
    v_pk_fma_f32 v[12:13], v[194:195], v[194:195], v[12:13]
    v_pk_fma_f32 v[12:13], v[196:197], v[196:197], v[12:13]
    v_pk_fma_f32 v[12:13], v[198:199], v[198:199], v[12:13]
    v_pk_mul_f32 v[14:15], v[200:201], v[200:201]
    v_pk_fma_f32 v[14:15], v[202:203], v[202:203], v[14:15]
    v_pk_fma_f32 v[14:15], v[204:205], v[204:205], v[14:15]
    v_pk_fma_f32 v[14:15], v[206:207], v[206:207], v[14:15]
    v_add_f32 v101, v12, v13
    v_add_f32 v14, v14, v15
    v_fmac_f32 v101, 0x3e800000, v14
    v_pk_mul_f32 v[12:13], v[184:185], v[76:77]
    v_pk_fma_f32 v[12:13], v[186:187], v[78:79], v[12:13]
    v_pk_fma_f32 v[12:13], v[188:189], v[80:81], v[12:13]
    v_pk_fma_f32 v[12:13], v[190:191], v[82:83], v[12:13]
    v_pk_fma_f32 v[12:13], v[192:193], v[84:85], v[12:13]
    v_pk_fma_f32 v[12:13], v[194:195], v[86:87], v[12:13]
    v_pk_fma_f32 v[12:13], v[196:197], v[88:89], v[12:13]
    v_pk_fma_f32 v[12:13], v[198:199], v[90:91], v[12:13]
    v_pk_mul_f32 v[14:15], v[200:201], v[92:93]
    v_pk_fma_f32 v[14:15], v[202:203], v[94:95], v[14:15]
    v_pk_fma_f32 v[14:15], v[204:205], v[96:97], v[14:15]
    v_pk_fma_f32 v[14:15], v[206:207], v[98:99], v[14:15]
    v_add_f32 v102, v12, v13
    v_add_f32 v14, v14, v15
    v_fmac_f32 v102, 0x3e800000, v14
    s_nop 1
    v_add_f32_dpp v101, v101, v101 row_ror:8 row_mask:0xf bank_mask:0xf
    v_add_f32_dpp v102, v102, v102 row_ror:8 row_mask:0xf bank_mask:0xf
    v_mov_b32 v103, v101
    v_mov_b32 v104, v102
    s_nop 0
    v_permlane16_swap_b32 v103, v101
    v_permlane16_swap_b32 v104, v102
    v_add_f32 v101, v101, v103
    v_add_f32 v102, v102, v104
    v_mov_b32 v103, v101
    v_mov_b32 v104, v102
    s_nop 0
    v_permlane32_swap_b32 v103, v101
    v_permlane32_swap_b32 v104, v102
    v_add_f32 v101, v101, v103
    v_add_f32 v102, v102, v104
    ds_write_b32 v10, v100 offset:0
    ds_write_b32 v10, v101 offset:128
    ds_write_b32 v10, v102 offset:256
    s_waitcnt lgkmcnt(0)
    s_barrier
    ds_read_b128 v[40:43], v11 offset:0
    ds_read_b128 v[44:47], v11 offset:128
    ds_read_b128 v[48:51], v11 offset:256
    ds_read_b128 v[52:55], v11 offset:384
    ds_read_b128 v[56:59], v11 offset:512
    s_waitcnt lgkmcnt(4)
    v_add_f32 v12, v40, v41
    v_add_f32 v13, v42, v43
    v_add_f32 v12, v12, v13
    v_mul_f32 v12, 0x3e800000, v12
    v_sub_f32 v40, v40, v12
    v_sub_f32 v41, v41, v12
    v_sub_f32 v42, v42, v12
    v_sub_f32 v43, v43, v12
    v_sub_f32 v100, v100, v12
    v_mul_f32 v13, v40, v40
    v_fmac_f32 v13, v41, v41
    v_fmac_f32 v13, v42, v42
    v_fmac_f32 v13, v43, v43
    s_waitcnt lgkmcnt(3)
    v_add_f32 v14, v44, v45
    v_add_f32 v15, v46, v47
    v_add_f32 v14, v14, v15
    v_fmac_f32 v14, 0x43100000, v13
    v_mov_b32 v13, 0x3727c5ac
    v_fmac_f32 v13, 0x3ae38e39, v14
    v_rsq_f32 v13, v13
    s_waitcnt lgkmcnt(0)
    v_pk_fma_f32 v[48:49], v[40:41], v[52:53], v[48:49]
    v_pk_fma_f32 v[50:51], v[42:43], v[54:55], v[50:51]
    v_pk_add_f32 v[48:49], v[48:49], v[50:51]
    v_pk_add_f32 v[56:57], v[56:57], v[58:59]
    v_add_f32 v14, v48, v49
    v_add_f32 v15, v56, v57
    v_fmac_f32 v15, v14, v13
    v_ashrrev_i32 v12, 31, v15
    v_or_b32 v12, 0x80000000, v12
    v_xor_b32 v12, v12, v15
    v_and_or_b32 v44, v12, s57, v6
    v_mov_b32 v45, 0
    s_nop 1
    v_mov_b32_dpp v14, v44 row_ror:1 row_mask:0xf bank_mask:0xf
    v_mov_b32_dpp v15, v45 row_ror:1 row_mask:0xf bank_mask:0xf
    v_max_u32 v45, v45, v15
    v_med3_u32 v45, v44, v14, v45
    v_max_u32 v44, v44, v14
    s_nop 1
    v_mov_b32_dpp v14, v44 row_ror:2 row_mask:0xf bank_mask:0xf
    v_mov_b32_dpp v15, v45 row_ror:2 row_mask:0xf bank_mask:0xf
    v_max_u32 v45, v45, v15
    v_med3_u32 v45, v44, v14, v45
    v_max_u32 v44, v44, v14
    s_nop 1
    v_mov_b32_dpp v14, v44 row_ror:4 row_mask:0xf bank_mask:0xf
    v_mov_b32_dpp v15, v45 row_ror:4 row_mask:0xf bank_mask:0xf
    v_max_u32 v45, v45, v15
    v_med3_u32 v45, v44, v14, v45
    v_max_u32 v44, v44, v14
    buffer_store_dwordx2 v[44:45], v9, s[84:87], s58 offen offset:8 sc1
    v_mul_f32 v100, v100, v13
    v_pk_fma_f32 v[184:185], v[184:185], v[12:13], v[100:101] op_sel:[0,1,0] op_sel_hi:[1,1,0]
    v_pk_fma_f32 v[186:187], v[186:187], v[12:13], v[100:101] op_sel:[0,1,0] op_sel_hi:[1,1,0]
    v_pk_fma_f32 v[188:189], v[188:189], v[12:13], v[100:101] op_sel:[0,1,0] op_sel_hi:[1,1,0]
    v_pk_fma_f32 v[190:191], v[190:191], v[12:13], v[100:101] op_sel:[0,1,0] op_sel_hi:[1,1,0]
    v_pk_fma_f32 v[192:193], v[192:193], v[12:13], v[100:101] op_sel:[0,1,0] op_sel_hi:[1,1,0]
    v_pk_fma_f32 v[194:195], v[194:195], v[12:13], v[100:101] op_sel:[0,1,0] op_sel_hi:[1,1,0]
    v_pk_fma_f32 v[196:197], v[196:197], v[12:13], v[100:101] op_sel:[0,1,0] op_sel_hi:[1,1,0]
    v_pk_fma_f32 v[198:199], v[198:199], v[12:13], v[100:101] op_sel:[0,1,0] op_sel_hi:[1,1,0]
    v_pk_fma_f32 v[200:201], v[200:201], v[12:13], v[100:101] op_sel:[0,1,0] op_sel_hi:[1,1,0]
    v_pk_fma_f32 v[202:203], v[202:203], v[12:13], v[100:101] op_sel:[0,1,0] op_sel_hi:[1,1,0]
    v_pk_fma_f32 v[204:205], v[204:205], v[12:13], v[100:101] op_sel:[0,1,0] op_sel_hi:[1,1,0]
    v_pk_fma_f32 v[206:207], v[206:207], v[12:13], v[100:101] op_sel:[0,1,0] op_sel_hi:[1,1,0]
    v_pk_fma_f32 v[184:185], v[184:185], v[112:113], v[136:137]
    v_pk_fma_f32 v[186:187], v[186:187], v[114:115], v[138:139]
    v_pk_fma_f32 v[188:189], v[188:189], v[116:117], v[140:141]
    v_pk_fma_f32 v[190:191], v[190:191], v[118:119], v[142:143]
    v_pk_fma_f32 v[192:193], v[192:193], v[120:121], v[144:145]
    v_pk_fma_f32 v[194:195], v[194:195], v[122:123], v[146:147]
    v_pk_fma_f32 v[196:197], v[196:197], v[124:125], v[148:149]
    v_pk_fma_f32 v[198:199], v[198:199], v[126:127], v[150:151]
    v_pk_fma_f32 v[200:201], v[200:201], v[128:129], v[152:153]
    v_pk_fma_f32 v[202:203], v[202:203], v[130:131], v[154:155]
    v_pk_fma_f32 v[204:205], v[204:205], v[132:133], v[156:157]
    v_pk_fma_f32 v[206:207], v[206:207], v[134:135], v[158:159]
    v_cvt_pk_bf16_f32 v124, v184, v185
    v_cvt_pk_bf16_f32 v125, v186, v187
    v_cvt_pk_bf16_f32 v126, v188, v189
    v_cvt_pk_bf16_f32 v127, v190, v191
    v_min_u32 v124, -2, v124
    v_min_u32 v125, -2, v125
    v_min_u32 v126, -2, v126
    v_min_u32 v127, -2, v127
    ds_write_b128 v1, v[124:127] offset:9344
    v_cvt_pk_bf16_f32 v128, v192, v193
    v_cvt_pk_bf16_f32 v129, v194, v195
    v_cvt_pk_bf16_f32 v130, v196, v197
    v_cvt_pk_bf16_f32 v131, v198, v199
    v_min_u32 v128, -2, v128
    v_min_u32 v129, -2, v129
    v_min_u32 v130, -2, v130
    v_min_u32 v131, -2, v131
    ds_write_b128 v1, v[128:131] offset:9856
    v_cvt_pk_bf16_f32 v132, v200, v201
    v_cvt_pk_bf16_f32 v133, v202, v203
    v_cvt_pk_bf16_f32 v134, v204, v205
    v_cvt_pk_bf16_f32 v135, v206, v207
    v_min_u32 v132, -2, v132
    v_min_u32 v133, -2, v133
    v_min_u32 v134, -2, v134
    v_min_u32 v135, -2, v135
    ds_write_b128 v2, v[132:135] offset:9344
    v_pk_fma_f32 v[16:17], v[184:185], v[160:161], v[16:17]
    v_pk_fma_f32 v[18:19], v[186:187], v[162:163], v[18:19]
    v_pk_fma_f32 v[20:21], v[188:189], v[164:165], v[20:21]
    v_pk_fma_f32 v[22:23], v[190:191], v[166:167], v[22:23]
    v_pk_fma_f32 v[24:25], v[192:193], v[168:169], v[24:25]
    v_pk_fma_f32 v[26:27], v[194:195], v[170:171], v[26:27]
    v_pk_fma_f32 v[28:29], v[196:197], v[172:173], v[28:29]
    v_pk_fma_f32 v[30:31], v[198:199], v[174:175], v[30:31]
    v_pk_fma_f32 v[32:33], v[200:201], v[176:177], v[32:33]
    v_pk_fma_f32 v[34:35], v[202:203], v[178:179], v[34:35]
    v_pk_fma_f32 v[36:37], v[204:205], v[180:181], v[36:37]
    v_pk_fma_f32 v[38:39], v[206:207], v[182:183], v[38:39]
    v_cvt_pk_bf16_f32 v112, v16, v17
    v_cvt_pk_bf16_f32 v113, v18, v19
    v_cvt_pk_bf16_f32 v114, v20, v21
    v_cvt_pk_bf16_f32 v115, v22, v23
    ds_write_b128 v1, v[112:115] offset:0
    v_cvt_pk_bf16_f32 v116, v24, v25
    v_cvt_pk_bf16_f32 v117, v26, v27
    v_cvt_pk_bf16_f32 v118, v28, v29
    v_cvt_pk_bf16_f32 v119, v30, v31
    ds_write_b128 v1, v[116:119] offset:512
    v_cvt_pk_bf16_f32 v120, v32, v33
    v_cvt_pk_bf16_f32 v121, v34, v35
    v_cvt_pk_bf16_f32 v122, v36, v37
    v_cvt_pk_bf16_f32 v123, v38, v39
    ds_write_b128 v2, v[120:123] offset:0
    v_lshrrev_b32 v7, 4, v0
    v_and_b32 v6, 1, v0
    v_bfe_u32 v5, v0, 2, 2
    v_lshlrev_b32 v5, 6, v5
    v_lshl_add_u32 v5, v7, 4, v5
    v_mov_b32 v14, 15616
    s_movk_i32 s57, 1168
    s_waitcnt lgkmcnt(0)
    s_barrier
    s_cmp_lt_u32 s51, 2
    s_cbranch_scc1 L2_keys
    s_cmp_eq_u32 s51, 2
    s_cbranch_scc1 L2_rows
L2_pad15:
    s_cbranch_execz L2_walkret
    v_not_b32 v12, v44
    v_not_b32 v13, v45
    v_and_b32 v12, 7, v12
    v_and_b32 v13, 7, v13
    v_cmp_gt_u32 vcc, 8, v0
    v_mul_u32_u24 v148, 1168, v12
    v_mul_u32_u24 v149, 1168, v13
    v_cndmask_b32 v15, v13, v12, vcc
    v_add_u32 v148, v148, v107
    v_add_u32 v149, v149, v107
    ds_read_b128 v[136:139], v148
    ds_read_b128 v[140:143], v149
    v_lshrrev_b32 v150, 3, v0
    v_sub_u32 v15, v15, v150
    v_mad_i32_i24 v150, v15, s57, v108
    ds_read_b128 v[144:147], v150 offset:1024
    s_movk_i32 s3, 1152
    v_mad_u32_u24 v12, v12, s3, v8
    v_mad_u32_u24 v13, v13, s3, v8
    v_mad_i32_i24 v15, v15, s3, v109
    s_waitcnt lgkmcnt(2)
    buffer_store_dwordx4 v[136:139], v12, s[24:27], 0 offen sc1
    s_waitcnt lgkmcnt(1)
    buffer_store_dwordx4 v[140:143], v13, s[24:27], 0 offen sc1
    s_mov_b64 exec, 0xffff
    s_waitcnt lgkmcnt(0)
    buffer_store_dwordx4 v[144:147], v15, s[24:27], 0 offen offset:1024 sc1
    s_mov_b64 exec, -1
    s_branch L2_rowsdone
L2_rows:
    ds_read_b128 v[136:139], v107 offset:0
    ds_read_b128 v[140:143], v107 offset:1168
    ds_read_b128 v[144:147], v107 offset:2336
    ds_read_b128 v[148:151], v107 offset:3504
    ds_read_b128 v[152:155], v107 offset:4672
    ds_read_b128 v[156:159], v107 offset:5840
    ds_read_b128 v[160:163], v107 offset:7008
    ds_read_b128 v[164:167], v107 offset:8176
    ds_read_b128 v[168:171], v108 offset:1024
    s_movk_i32 s3, 0
    s_waitcnt lgkmcnt(8)
    buffer_store_dwordx4 v[136:139], v8, s[24:27], s3 offen offset:0 sc1
    s_waitcnt lgkmcnt(7)
    buffer_store_dwordx4 v[140:143], v8, s[24:27], s3 offen offset:1152 sc1
    s_waitcnt lgkmcnt(6)
    buffer_store_dwordx4 v[144:147], v8, s[24:27], s3 offen offset:2304 sc1
    s_waitcnt lgkmcnt(5)
    buffer_store_dwordx4 v[148:151], v8, s[24:27], s3 offen offset:3456 sc1
    s_movk_i32 s3, 4608
    s_waitcnt lgkmcnt(4)
    buffer_store_dwordx4 v[152:155], v8, s[24:27], s3 offen offset:0 sc1
    s_waitcnt lgkmcnt(3)
    buffer_store_dwordx4 v[156:159], v8, s[24:27], s3 offen offset:1152 sc1
    s_waitcnt lgkmcnt(2)
    buffer_store_dwordx4 v[160:163], v8, s[24:27], s3 offen offset:2304 sc1
    s_waitcnt lgkmcnt(1)
    buffer_store_dwordx4 v[164:167], v8, s[24:27], s3 offen offset:3456 sc1
    s_waitcnt lgkmcnt(0)
    buffer_store_dwordx4 v[168:171], v109, s[24:27], 0 offen offset:1024 sc1
L2_rowsdone:
    ds_read_b64_tr_b16 a[64:65], v110 offset:0
    ds_read_b64_tr_b16 a[66:67], v110 offset:256
    ds_read_b64_tr_b16 a[68:69], v110 offset:2048
    ds_read_b64_tr_b16 a[70:71], v110 offset:2304
    ds_read_b64_tr_b16 a[72:73], v110 offset:4096
    ds_read_b64_tr_b16 a[74:75], v110 offset:4352
    ds_read_b64_tr_b16 a[76:77], v110 offset:6144
    ds_read_b64_tr_b16 a[78:79], v110 offset:6400
    ds_read_b64_tr_b16 a[80:81], v110 offset:8192
    ds_read_b64_tr_b16 a[82:83], v110 offset:8448
    ds_read_b64_tr_b16 a[84:85], v110 offset:10240
    ds_read_b64_tr_b16 a[86:87], v110 offset:10496
    ds_read_b64_tr_b16 a[88:89], v110 offset:12288
    ds_read_b64_tr_b16 a[90:91], v110 offset:12544
    ds_read_b64_tr_b16 a[92:93], v110 offset:14336
    ds_read_b64_tr_b16 a[94:95], v110 offset:14592
    ds_read_b64_tr_b16 a[96:97], v110 offset:16384
    ds_read_b64_tr_b16 a[98:99], v110 offset:16640
    ds_read_b64_tr_b16 a[100:101], v110 offset:18432
    ds_read_b64_tr_b16 a[102:103], v110 offset:18688
    ds_read_b64_tr_b16 a[104:105], v110 offset:20480
    ds_read_b64_tr_b16 a[106:107], v110 offset:20736
    ds_read_b64_tr_b16 a[108:109], v110 offset:22528
    ds_read_b64_tr_b16 a[110:111], v110 offset:22784
    ds_read_b64_tr_b16 a[112:113], v110 offset:24576
    ds_read_b64_tr_b16 a[114:115], v110 offset:24832
    ds_read_b64_tr_b16 a[116:117], v110 offset:26624
    ds_read_b64_tr_b16 a[118:119], v110 offset:26880
    ds_read_b64_tr_b16 a[120:121], v110 offset:28672
    ds_read_b64_tr_b16 a[122:123], v110 offset:28928
    ds_read_b64_tr_b16 a[124:125], v110 offset:30720
    ds_read_b64_tr_b16 a[126:127], v110 offset:30976
    ds_read_b64_tr_b16 a[128:129], v110 offset:32768
    ds_read_b64_tr_b16 a[130:131], v110 offset:33024
    ds_read_b64_tr_b16 a[132:133], v110 offset:34816
    ds_read_b64_tr_b16 a[134:135], v110 offset:35072
    ds_read_b64_tr_b16 a[136:137], v111 offset:0
    ds_read_b64_tr_b16 a[138:139], v111 offset:4608
    ds_read_b64_tr_b16 a[140:141], v111 offset:32
    ds_read_b64_tr_b16 a[142:143], v111 offset:4640
    ds_read_b64_tr_b16 a[144:145], v111 offset:64
    ds_read_b64_tr_b16 a[146:147], v111 offset:4672
    ds_read_b64_tr_b16 a[148:149], v111 offset:96
    ds_read_b64_tr_b16 a[150:151], v111 offset:4704
    ds_read_b64_tr_b16 a[152:153], v111 offset:128
    ds_read_b64_tr_b16 a[154:155], v111 offset:4736
    ds_read_b64_tr_b16 a[156:157], v111 offset:160
    ds_read_b64_tr_b16 a[158:159], v111 offset:4768
    ds_read_b64_tr_b16 a[160:161], v111 offset:192
    ds_read_b64_tr_b16 a[162:163], v111 offset:4800
    ds_read_b64_tr_b16 a[164:165], v111 offset:224
    ds_read_b64_tr_b16 a[166:167], v111 offset:4832
    ds_read_b64_tr_b16 a[168:169], v111 offset:256
    ds_read_b64_tr_b16 a[170:171], v111 offset:4864
    s_cmp_lt_u32 s2, 144
    s_cbranch_scc1 L2_join
    s_waitcnt vmcnt(0)
    buffer_store_dword v14, v9, s[84:87], s56 offen offset:128 sc1
    s_cmp_lt_u32 s2, 180
    s_cbranch_scc1 L2_join
    s_branch L2_fin
L2_keys:
    s_cmp_ge_u32 s2, 180
    s_cbranch_scc1 L2_fin
    buffer_load_dwordx2 v[64:65], v68, s[84:87], s15 offen offset:8 sc1
    buffer_load_dwordx2 v[66:67], v68, s[84:87], s59 offen offset:8 sc1
    ds_read_b64_tr_b16 a[64:65], v110 offset:0
    ds_read_b64_tr_b16 a[66:67], v110 offset:256
    ds_read_b64_tr_b16 a[68:69], v110 offset:2048
    ds_read_b64_tr_b16 a[70:71], v110 offset:2304
    ds_read_b64_tr_b16 a[72:73], v110 offset:4096
    ds_read_b64_tr_b16 a[74:75], v110 offset:4352
    ds_read_b64_tr_b16 a[76:77], v110 offset:6144
    ds_read_b64_tr_b16 a[78:79], v110 offset:6400
    ds_read_b64_tr_b16 a[80:81], v110 offset:8192
    ds_read_b64_tr_b16 a[82:83], v110 offset:8448
    ds_read_b64_tr_b16 a[84:85], v110 offset:10240
    ds_read_b64_tr_b16 a[86:87], v110 offset:10496
    ds_read_b64_tr_b16 a[88:89], v110 offset:12288
    ds_read_b64_tr_b16 a[90:91], v110 offset:12544
    ds_read_b64_tr_b16 a[92:93], v110 offset:14336
    ds_read_b64_tr_b16 a[94:95], v110 offset:14592
    ds_read_b64_tr_b16 a[96:97], v110 offset:16384
    ds_read_b64_tr_b16 a[98:99], v110 offset:16640
    ds_read_b64_tr_b16 a[100:101], v110 offset:18432
    ds_read_b64_tr_b16 a[102:103], v110 offset:18688
    ds_read_b64_tr_b16 a[104:105], v110 offset:20480
    ds_read_b64_tr_b16 a[106:107], v110 offset:20736
    ds_read_b64_tr_b16 a[108:109], v110 offset:22528
    ds_read_b64_tr_b16 a[110:111], v110 offset:22784
    ds_read_b64_tr_b16 a[112:113], v110 offset:24576
    ds_read_b64_tr_b16 a[114:115], v110 offset:24832
    ds_read_b64_tr_b16 a[116:117], v110 offset:26624
    ds_read_b64_tr_b16 a[118:119], v110 offset:26880
    ds_read_b64_tr_b16 a[120:121], v110 offset:28672
    ds_read_b64_tr_b16 a[122:123], v110 offset:28928
    ds_read_b64_tr_b16 a[124:125], v110 offset:30720
    ds_read_b64_tr_b16 a[126:127], v110 offset:30976
    ds_read_b64_tr_b16 a[128:129], v110 offset:32768
    ds_read_b64_tr_b16 a[130:131], v110 offset:33024
    ds_read_b64_tr_b16 a[132:133], v110 offset:34816
    ds_read_b64_tr_b16 a[134:135], v110 offset:35072
    ds_read_b64_tr_b16 a[136:137], v111 offset:0
    ds_read_b64_tr_b16 a[138:139], v111 offset:4608
    ds_read_b64_tr_b16 a[140:141], v111 offset:32
    ds_read_b64_tr_b16 a[142:143], v111 offset:4640
    ds_read_b64_tr_b16 a[144:145], v111 offset:64
    ds_read_b64_tr_b16 a[146:147], v111 offset:4672
    ds_read_b64_tr_b16 a[148:149], v111 offset:96
    ds_read_b64_tr_b16 a[150:151], v111 offset:4704
    ds_read_b64_tr_b16 a[152:153], v111 offset:128
    ds_read_b64_tr_b16 a[154:155], v111 offset:4736
    ds_read_b64_tr_b16 a[156:157], v111 offset:160
    ds_read_b64_tr_b16 a[158:159], v111 offset:4768
    ds_read_b64_tr_b16 a[160:161], v111 offset:192
    ds_read_b64_tr_b16 a[162:163], v111 offset:4800
    ds_read_b64_tr_b16 a[164:165], v111 offset:224
    ds_read_b64_tr_b16 a[166:167], v111 offset:4832
    ds_read_b64_tr_b16 a[168:169], v111 offset:256
    ds_read_b64_tr_b16 a[170:171], v111 offset:4864
    s_waitcnt vmcnt(0)
    v_cndmask_b32 v64, v64, v44, s[60:61]
    v_cndmask_b32 v65, v65, v45, s[60:61]
    v_cndmask_b32 v66, v66, v44, s[62:63]
    v_cndmask_b32 v67, v67, v45, s[62:63]
    v_min_u32 v12, v64, v65
    v_min_u32 v13, v66, v67
    v_cmp_eq_u32 s[4:5], 0, v12
    v_cmp_eq_u32 s[6:7], 0, v13
    s_nop 0
    s_or_b64 vcc, s[4:5], s[6:7]
    s_cbranch_scc0 L2_p2_ok
    s_mov_b32 s97, 0x20000
L2_p2:
    s_or_b64 exec, s[4:5], 1
    buffer_load_dwordx2 v[64:65], v68, s[84:87], s15 offen offset:8 sc1
    s_or_b64 exec, s[6:7], 1
    buffer_load_dwordx2 v[66:67], v68, s[84:87], s59 offen offset:8 sc1
    s_mov_b64 exec, -1
    s_waitcnt vmcnt(0)
    v_cndmask_b32 v64, v64, v44, s[60:61]
    v_cndmask_b32 v65, v65, v45, s[60:61]
    v_cndmask_b32 v66, v66, v44, s[62:63]
    v_cndmask_b32 v67, v67, v45, s[62:63]
    v_min_u32 v12, v64, v65
    v_min_u32 v13, v66, v67
    v_cmp_eq_u32 s[4:5], 0, v12
    v_cmp_eq_u32 s[6:7], 0, v13
    s_nop 0
    s_or_b64 vcc, s[4:5], s[6:7]
    s_sub_u32 s97, s97, 1
    s_cselect_b64 vcc, 0, vcc
    s_cmp_eq_u64 vcc, 0
    s_cbranch_scc1 L2_p2_ok
    s_sleep 1
    s_branch L2_p2
L2_p2_ok:
    v_max_u32 v65, v65, v67
    v_med3_u32 v65, v64, v66, v65
    v_max_u32 v64, v64, v66
    s_nop 1
    v_mov_b32_dpp v12, v64 row_ror:1 row_mask:0xf bank_mask:0xf
    v_mov_b32_dpp v13, v65 row_ror:1 row_mask:0xf bank_mask:0xf
    v_max_u32 v65, v65, v13
    v_med3_u32 v65, v64, v12, v65
    v_max_u32 v64, v64, v12
    s_nop 1
    v_mov_b32_dpp v12, v64 row_ror:2 row_mask:0xf bank_mask:0xf
    v_mov_b32_dpp v13, v65 row_ror:2 row_mask:0xf bank_mask:0xf
    v_max_u32 v65, v65, v13
    v_med3_u32 v65, v64, v12, v65
    v_max_u32 v64, v64, v12
    s_nop 1
    v_mov_b32_dpp v12, v64 row_ror:4 row_mask:0xf bank_mask:0xf
    v_mov_b32_dpp v13, v65 row_ror:4 row_mask:0xf bank_mask:0xf
    v_max_u32 v65, v65, v13
    v_med3_u32 v65, v64, v12, v65
    v_max_u32 v64, v64, v12
    s_nop 1
    v_mov_b32_dpp v12, v64 row_ror:8 row_mask:0xf bank_mask:0xf
    v_mov_b32_dpp v13, v65 row_ror:8 row_mask:0xf bank_mask:0xf
    v_max_u32 v65, v65, v13
    v_med3_u32 v65, v64, v12, v65
    v_max_u32 v64, v64, v12
    v_mov_b32 v12, v64
    v_mov_b32 v13, v65
    s_nop 0
    v_permlane16_swap_b32 v12, v64
    v_permlane16_swap_b32 v13, v65
    v_max_u32 v65, v65, v13
    v_med3_u32 v65, v64, v12, v65
    v_max_u32 v64, v64, v12
    v_mov_b32 v12, v64
    v_mov_b32 v13, v65
    s_nop 0
    v_permlane32_swap_b32 v12, v64
    v_permlane32_swap_b32 v13, v65
    v_max_u32 v65, v65, v13
    v_med3_u32 v65, v64, v12, v65
    v_max_u32 v64, v64, v12
    s_lshl3_add_u32 s3, s51, 15616
    v_mov_b32 v12, s3
    ds_write_b64 v12, v[64:65]
    s_waitcnt lgkmcnt(0)
L2_join:
    s_barrier
    ds_read_b128 v[16:19], v14
    v_cmp_eq_u32 vcc, 0, v6
    s_waitcnt lgkmcnt(0)
    v_max_u32 v17, v17, v19
    v_med3_u32 v17, v16, v18, v17
    v_max_u32 v16, v16, v18
    v_cndmask_b32 v16, v17, v16, vcc
    v_and_b32 v3, 0x7ff, v16
    v_sub_u32 v3, 2047, v3
    v_mul_u32_u24 v4, 1152, v3
    s_cmp_ge_u32 s2, 144
    s_cbranch_scc1 L2_red
    v_add_u32 v5, v5, v4
    s_mov_b32 s59, 4194304
    v_and_b32 v12, 8, v0
    v_lshlrev_b32 v12, 4, v12
    v_sub_u32 v3, v5, v12
    buffer_load_dwordx4 v[128:131], v5, s[84:87], s59 offen offset:0 sc1
    buffer_load_dwordx4 v[132:135], v5, s[84:87], s59 offen offset:256 sc1
    buffer_load_dwordx4 v[136:139], v5, s[84:87], s59 offen offset:512 sc1
    buffer_load_dwordx4 v[140:143], v5, s[84:87], s59 offen offset:768 sc1
    buffer_load_dwordx4 v[144:147], v3, s[84:87], s59 offen offset:1024 sc1
    v_lshlrev_b32 v11, 7, v6
    v_lshl_add_u32 v13, v7, 5, v11
    v_add_u32 v13, 14848, v13
    v_lshl_add_u32 v11, v7, 4, v11
    s_lshr_b32 s3, s51, 1
    s_lshl_b32 s3, s3, 8
    s_and_b32 s14, s51, 1
    s_lshl_b32 s14, s14, 6
    s_add_u32 s3, s3, s14
    s_add_u32 s3, s3, 14848
    v_add_u32 v11, s3, v11
    s_mul_i32 s14, s51, 1152
    s_mul_i32 s15, s2, 4608
    s_add_u32 s15, s15, s14
    s_add_u32 s15, s15, 98304
    v_lshlrev_b32 v10, 3, v0
    s_waitcnt vmcnt(0)
    buffer_store_dword v14, v9, s[84:87], s56 offen offset:128 sc1
L2_hr:
    v_mfma_f32_16x16x32_bf16 v[88:91], a[64:67], v[128:131], 0
    v_max_u32 v12, v128, v129
    v_mfma_f32_16x16x32_bf16 v[92:95], a[68:71], v[128:131], 0
    v_max3_u32 v12, v12, v130, v131
    v_mfma_f32_16x16x32_bf16 v[96:99], a[72:75], v[128:131], 0
    v_max3_u32 v12, v12, v132, v133
    v_mfma_f32_16x16x32_bf16 v[100:103], a[76:79], v[128:131], 0
    v_max3_u32 v12, v12, v134, v135
    v_mfma_f32_16x16x32_bf16 v[88:91], a[80:83], v[132:135], v[88:91]
    v_max3_u32 v12, v12, v136, v137
    v_mfma_f32_16x16x32_bf16 v[92:95], a[84:87], v[132:135], v[92:95]
    v_max3_u32 v12, v12, v138, v139
    v_mfma_f32_16x16x32_bf16 v[96:99], a[88:91], v[132:135], v[96:99]
    v_max3_u32 v12, v12, v140, v141
    v_mfma_f32_16x16x32_bf16 v[100:103], a[92:95], v[132:135], v[100:103]
    v_max3_u32 v12, v12, v142, v143
    v_mfma_f32_16x16x32_bf16 v[88:91], a[96:99], v[136:139], v[88:91]
    v_max3_u32 v12, v12, v144, v145
    v_mfma_f32_16x16x32_bf16 v[92:95], a[100:103], v[136:139], v[92:95]
    v_max3_u32 v12, v12, v146, v147
    v_mfma_f32_16x16x32_bf16 v[96:99], a[104:107], v[136:139], v[96:99]
    v_cmp_eq_u32 vcc, -1, v12
    v_mfma_f32_16x16x32_bf16 v[100:103], a[108:111], v[136:139], v[100:103]
    v_mfma_f32_16x16x32_bf16 v[96:99], a[120:123], v[140:143], v[96:99]
    v_mfma_f32_16x16x32_bf16 v[100:103], a[124:127], v[140:143], v[100:103]
    v_mfma_f32_16x16x32_bf16 v[88:91], a[112:115], v[140:143], v[88:91]
    v_mfma_f32_16x16x32_bf16 v[92:95], a[116:119], v[140:143], v[92:95]
    v_mfma_f32_16x16x32_bf16 v[92:95], a[132:135], v[144:147], v[92:95]
    v_mfma_f32_16x16x32_bf16 v[88:91], a[128:131], v[144:147], v[88:91]
    s_cmp_lg_u64 vcc, 0
    s_cbranch_scc1 L2_hs
    s_nop 1
    v_add_f32_dpp v96, v100, v96 row_shl:4 row_mask:0xf bank_mask:0xf bound_ctrl:1
    v_add_f32_dpp v97, v101, v97 row_shl:4 row_mask:0xf bank_mask:0xf bound_ctrl:1
    v_add_f32_dpp v98, v102, v98 row_shl:4 row_mask:0xf bank_mask:0xf bound_ctrl:1
    v_add_f32_dpp v99, v103, v99 row_shl:4 row_mask:0xf bank_mask:0xf bound_ctrl:1
    v_add_f32_dpp v88, v92, v88 row_shl:4 row_mask:0xf bank_mask:0xf bound_ctrl:1
    v_add_f32_dpp v89, v93, v89 row_shl:4 row_mask:0xf bank_mask:0xf bound_ctrl:1
    v_add_f32_dpp v90, v94, v90 row_shl:4 row_mask:0xf bank_mask:0xf bound_ctrl:1
    v_add_f32_dpp v91, v95, v91 row_shl:4 row_mask:0xf bank_mask:0xf bound_ctrl:1
    v_add_f32_dpp v88, v96, v88 row_shl:8 row_mask:0xf bank_mask:0xf bound_ctrl:1
    v_add_f32_dpp v89, v97, v89 row_shl:8 row_mask:0xf bank_mask:0xf bound_ctrl:1
    v_add_f32_dpp v90, v98, v90 row_shl:8 row_mask:0xf bank_mask:0xf bound_ctrl:1
    v_add_f32_dpp v91, v99, v91 row_shl:8 row_mask:0xf bank_mask:0xf bound_ctrl:1
    s_mov_b32 exec_lo, 0x30003
    s_mov_b32 exec_hi, 0x30003
    ds_write_b128 v11, v[88:91]
    s_mov_b64 exec, -1
    s_waitcnt lgkmcnt(0)
    s_barrier
    ds_read_b128 v[16:19], v13 offset:0
    ds_read_b128 v[20:23], v13 offset:16
    ds_read_b128 v[24:27], v13 offset:256
    ds_read_b128 v[28:31], v13 offset:272
    v_mov_b32 v12, 0xbfb8aa3b
    s_waitcnt lgkmcnt(2)
    v_pk_mul_f32 v[32:33], v[16:17], v[12:13] op_sel_hi:[1,0]
    v_pk_mul_f32 v[34:35], v[18:19], v[12:13] op_sel_hi:[1,0]
    v_pk_mul_f32 v[36:37], v[20:21], v[12:13] op_sel_hi:[1,0]
    v_pk_mul_f32 v[38:39], v[22:23], v[12:13] op_sel_hi:[1,0]
    v_exp_f32 v32, v32
    v_exp_f32 v33, v33
    v_exp_f32 v34, v34
    v_exp_f32 v35, v35
    v_exp_f32 v36, v36
    v_exp_f32 v37, v37
    v_exp_f32 v38, v38
    v_exp_f32 v39, v39
    v_pk_add_f32 v[32:33], v[32:33], 1.0 op_sel_hi:[1,0]
    v_pk_add_f32 v[34:35], v[34:35], 1.0 op_sel_hi:[1,0]
    v_pk_add_f32 v[36:37], v[36:37], 1.0 op_sel_hi:[1,0]
    v_pk_add_f32 v[38:39], v[38:39], 1.0 op_sel_hi:[1,0]
    v_rcp_f32 v32, v32
    v_rcp_f32 v33, v33
    v_rcp_f32 v34, v34
    v_rcp_f32 v35, v35
    v_rcp_f32 v36, v36
    v_rcp_f32 v37, v37
    v_rcp_f32 v38, v38
    v_rcp_f32 v39, v39
    s_waitcnt lgkmcnt(0)
    v_pk_mul_f32 v[16:17], v[16:17], v[32:33]
    v_pk_mul_f32 v[18:19], v[18:19], v[34:35]
    v_pk_mul_f32 v[20:21], v[20:21], v[36:37]
    v_pk_mul_f32 v[22:23], v[22:23], v[38:39]
    v_pk_mul_f32 v[16:17], v[16:17], v[24:25]
    v_pk_mul_f32 v[18:19], v[18:19], v[26:27]
    v_pk_mul_f32 v[20:21], v[20:21], v[28:29]
    v_pk_mul_f32 v[22:23], v[22:23], v[30:31]
    v_cvt_pk_bf16_f32 v40, v16, v17
    v_cvt_pk_bf16_f32 v41, v18, v19
    v_cvt_pk_bf16_f32 v42, v20, v21
    v_cvt_pk_bf16_f32 v43, v22, v23
    s_nop 1
    v_mfma_f32_16x16x32_bf16 v[48:51], v[40:43], a[136:139], 0
    v_mfma_f32_16x16x32_bf16 v[52:55], v[40:43], a[140:143], 0
    v_mfma_f32_16x16x32_bf16 v[56:59], v[40:43], a[144:147], 0
    v_mfma_f32_16x16x32_bf16 v[60:63], v[40:43], a[148:151], 0
    v_mfma_f32_16x16x32_bf16 v[64:67], v[40:43], a[152:155], 0
    v_mfma_f32_16x16x32_bf16 v[68:71], v[40:43], a[156:159], 0
    v_mfma_f32_16x16x32_bf16 v[72:75], v[40:43], a[160:163], 0
    v_mfma_f32_16x16x32_bf16 v[76:79], v[40:43], a[164:167], 0
    v_mfma_f32_16x16x32_bf16 v[80:83], v[40:43], a[168:171], 0
    s_nop 0
    v_mov_b32_dpp v48, v52 quad_perm:[0,1,2,3] row_mask:0x2 bank_mask:0xf
    v_mov_b32_dpp v49, v53 quad_perm:[0,1,2,3] row_mask:0x2 bank_mask:0xf
    s_nop 0
    v_mov_b32_dpp v48, v56 quad_perm:[0,1,2,3] row_mask:0x4 bank_mask:0xf
    v_mov_b32_dpp v49, v57 quad_perm:[0,1,2,3] row_mask:0x4 bank_mask:0xf
    s_nop 0
    v_mov_b32_dpp v48, v60 quad_perm:[0,1,2,3] row_mask:0x8 bank_mask:0xf
    v_mov_b32_dpp v49, v61 quad_perm:[0,1,2,3] row_mask:0x8 bank_mask:0xf
    v_mov_b32_dpp v50, v64 quad_perm:[0,1,2,3] row_mask:0x1 bank_mask:0xf
    v_mov_b32_dpp v51, v65 quad_perm:[0,1,2,3] row_mask:0x1 bank_mask:0xf
    s_nop 0
    v_mov_b32_dpp v50, v68 quad_perm:[0,1,2,3] row_mask:0x2 bank_mask:0xf
    v_mov_b32_dpp v51, v69 quad_perm:[0,1,2,3] row_mask:0x2 bank_mask:0xf
    s_nop 0
    v_mov_b32_dpp v50, v72 quad_perm:[0,1,2,3] row_mask:0x4 bank_mask:0xf
    v_mov_b32_dpp v51, v73 quad_perm:[0,1,2,3] row_mask:0x4 bank_mask:0xf
    s_nop 0
    v_mov_b32_dpp v50, v76 quad_perm:[0,1,2,3] row_mask:0x8 bank_mask:0xf
    v_mov_b32_dpp v51, v77 quad_perm:[0,1,2,3] row_mask:0x8 bank_mask:0xf
    v_min_u32 v48, -2, v48
    v_min_u32 v49, -2, v49
    v_min_u32 v50, -2, v50
    v_min_u32 v51, -2, v51
    v_min_u32 v80, -2, v80
    v_min_u32 v81, -2, v81
    buffer_store_dwordx4 v[48:51], v8, s[84:87], s15 offen sc1
    s_mov_b64 exec, 0xffff
    buffer_store_dwordx2 v[80:81], v10, s[84:87], s15 offen offset:1024 sc1
    s_branch L2_fin
L2_red:
    s_mov_b32 s3, 98304
    s_add_u32 s32, s84, s3
    s_addc_u32 s33, s85, 0
    s_mov_b32 s34, 663552
    s_mov_b32 s35, 0x20000
    s_sub_u32 s3, s2, 144
    s_mul_i32 s14, s3, 7282
    s_lshr_b32 s14, s14, 16
    s_mul_i32 s15, s14, 9
    s_sub_u32 s15, s3, s15
    s_mul_i32 s14, s14, 144
    s_cmp_eq_u32 s15, 8
    s_cselect_b32 s56, 1, 64
    s_cselect_b32 s57, 2, 1
    s_cselect_b32 s15, 16, s15
    s_lshl3_add_u32 s14, s15, s14
    v_bfe_u32 v7, v0, 2, 3
    v_mul_u32_u24 v7, s57, v7
    v_bfe_u32 v9, v0, 1, 1
    v_mul_u32_u24 v9, s56, v9
    v_add3_u32 v7, v7, v9, s14
    v_lshl_add_u32 v9, v7, 1, v4
    v_lshlrev_b32 v7, 2, v7
    v_lshrrev_b32 v12, 7, v3
    v_bfe_u32 v13, v3, 3, 4
    v_lshl_add_u32 v13, v12, 6, v13
    v_lshlrev_b32 v13, 8, v13
    s_mov_b32 s59, 794624
    s_mov_b32 s97, 0x20000
L2_r:
    buffer_load_dword v12, v13, s[84:87], s59 offen offset:128 sc1
    s_waitcnt vmcnt(0)
    v_cmp_eq_u32 vcc, 0, v12
    s_sub_u32 s97, s97, 1
    s_cselect_b64 vcc, 0, vcc
    s_cmp_eq_u64 vcc, 0
    s_cbranch_scc1 L2_r_ok
    s_sleep 1
    s_branch L2_r
L2_r_ok:
    buffer_load_ushort v18, v9, s[80:83], 0 offen sc1
    ds_read_b32 v20, v7 offset:6912
    v_and_b32 v6, 7, v0
    v_lshrrev_b32 v10, 3, v0
    s_lshl_b32 s14, s51, 3
    v_add_u32 v10, s14, v10
    v_mul_u32_u24 v10, 4608, v10
    v_lshl_add_u32 v10, v6, 4, v10
    s_lshl_b32 s3, s3, 7
    v_add_u32 v24, s3, v10
    v_add_u32 v25, 147456, v24
    v_add_u32 v26, 294912, v24
    v_add_u32 v27, 442368, v24
    v_add_u32 v28, 589824, v24
    v_and_b32 v16, 0xfffff800, v16
    v_not_b32 v12, v16
    v_ashrrev_i32 v12, 31, v12
    v_or_b32 v12, 0x80000000, v12
    v_xor_b32 v16, v16, v12
    v_mul_f32 v16, 0xbfb8aa3b, v16
    v_exp_f32 v16, v16
    s_nop 0
    v_add_f32 v16, 1.0, v16
    v_rcp_f32 v16, v16
    s_waitcnt lgkmcnt(0)
    v_mul_f32 v20, v20, v16
    s_lshl_b32 s14, s51, 7
    s_add_u32 s14, s14, 15872
    v_lshl_add_u32 v10, v6, 4, s14
    v_and_b32 v11, 31, v0
    v_lshlrev_b32 v11, 2, v11
    s_mov_b32 s97, 0x20000
L2_p3:
    buffer_load_dwordx4 v[32:35], v24, s[32:35], 0 offen sc1
    buffer_load_dwordx4 v[36:39], v25, s[32:35], 0 offen sc1
    buffer_load_dwordx4 v[40:43], v26, s[32:35], 0 offen sc1
    buffer_load_dwordx4 v[44:47], v27, s[32:35], 0 offen sc1
    buffer_load_dwordx4 v[48:51], v28, s[32:35], 0 offen sc1
    s_waitcnt vmcnt(0)
    v_max3_u32 v12, v32, v33, v34
    v_max3_u32 v12, v12, v35, v36
    v_max3_u32 v12, v12, v37, v38
    v_max3_u32 v12, v12, v39, v40
    v_max3_u32 v12, v12, v41, v42
    v_max3_u32 v12, v12, v43, v44
    v_max3_u32 v12, v12, v45, v46
    v_max3_u32 v12, v12, v47, v48
    v_max3_u32 v12, v12, v49, v50
    v_max_u32 v12, v12, v51
    v_cmp_eq_u32 vcc, -1, v12
    s_sub_u32 s97, s97, 1
    s_cselect_b64 vcc, 0, vcc
    s_cmp_eq_u64 vcc, 0
    s_cbranch_scc1 L2_p3_ok
    s_branch L2_p3
L2_p3_ok:
    v_pk_add_f32 v[32:33], v[32:33], v[36:37]
    v_pk_add_f32 v[40:41], v[40:41], v[44:45]
    v_pk_add_f32 v[32:33], v[32:33], v[48:49]
    v_pk_add_f32 v[32:33], v[32:33], v[40:41]
    v_pk_add_f32 v[34:35], v[34:35], v[38:39]
    v_pk_add_f32 v[42:43], v[42:43], v[46:47]
    v_pk_add_f32 v[34:35], v[34:35], v[50:51]
    v_pk_add_f32 v[34:35], v[34:35], v[42:43]
    s_nop 1
    v_add_f32_dpp v32, v32, v32 row_ror:8 row_mask:0xf bank_mask:0xf
    v_add_f32_dpp v33, v33, v33 row_ror:8 row_mask:0xf bank_mask:0xf
    v_add_f32_dpp v34, v34, v34 row_ror:8 row_mask:0xf bank_mask:0xf
    v_add_f32_dpp v35, v35, v35 row_ror:8 row_mask:0xf bank_mask:0xf
    v_mov_b32 v12, v32
    v_mov_b32 v13, v33
    v_mov_b32 v14, v34
    v_mov_b32 v15, v35
    v_permlane16_swap_b32 v12, v32
    v_permlane16_swap_b32 v13, v33
    v_permlane16_swap_b32 v14, v34
    v_permlane16_swap_b32 v15, v35
    v_add_f32 v32, v32, v12
    v_add_f32 v33, v33, v13
    v_add_f32 v34, v34, v14
    v_add_f32 v35, v35, v15
    v_mov_b32 v12, v32
    v_mov_b32 v13, v33
    v_mov_b32 v14, v34
    v_mov_b32 v15, v35
    v_permlane32_swap_b32 v12, v32
    v_permlane32_swap_b32 v13, v33
    v_permlane32_swap_b32 v14, v34
    v_permlane32_swap_b32 v15, v35
    v_add_f32 v32, v32, v12
    v_add_f32 v33, v33, v13
    v_add_f32 v34, v34, v14
    v_add_f32 v35, v35, v15
    ds_write_b128 v10, v[32:35]
    s_waitcnt lgkmcnt(0)
    s_barrier
    s_cmp_lg_u32 s51, 0
    s_cbranch_scc1 L2_fin
    ds_read_b32 v32, v11 offset:15872
    ds_read_b32 v33, v11 offset:16000
    ds_read_b32 v34, v11 offset:16128
    ds_read_b32 v35, v11 offset:16256
    v_lshlrev_b32 v12, 16, v18
    s_mov_b32 exec_hi, 0
    s_waitcnt lgkmcnt(0)
    v_pk_add_f32 v[32:33], v[32:33], v[34:35]
    v_add_f32 v32, v32, v33
    v_fmac_f32 v12, v32, v20
    v_cvt_pk_bf16_f32 v12, v12, v12
    buffer_store_short v12, v9, s[80:83], 0 offen sc1
L2_fin:
L2_end:
    s_endpgm
L2_p0s:
    s_mov_b32 s97, 0x20000
L2_p0:
    buffer_load_dword v51, v156, s[60:63], 0 offen sc1
    s_waitcnt vmcnt(0)
    v_cmp_eq_u32 vcc, 0, v51
    s_sub_u32 s97, s97, 1
    s_cselect_b64 vcc, 0, vcc
    s_cmp_eq_u64 vcc, 0
    s_cbranch_scc1 L2_p0_ok
    s_sleep 1
    s_branch L2_p0
L2_p0_ok:
    s_branch L2_p0r
L2_pms:
    s_mov_b32 s97, 0x20000
L2_pm:
    buffer_load_dwordx4 v[168:171], v166, s[84:87], 0 offen sc1
    buffer_load_dwordx4 v[176:179], v166, s[84:87], s14 offen sc1
    s_mov_b64 exec, 0xff
    buffer_load_dwordx4 v[172:175], v166, s[84:87], 0 offen offset:1024 sc1
    buffer_load_dwordx4 v[180:183], v166, s[84:87], s14 offen offset:1024 sc1
    s_mov_b64 exec, -1
    s_waitcnt vmcnt(0)
    v_max_u32 v13, v168, v169
    v_max3_u32 v13, v13, v170, v171
    v_max3_u32 v13, v13, v172, v173
    v_max3_u32 v13, v13, v174, v175
    v_max3_u32 v13, v13, v176, v177
    v_max3_u32 v13, v13, v178, v179
    v_max3_u32 v13, v13, v180, v181
    v_max3_u32 v13, v13, v182, v183
    v_cmp_eq_u32 vcc, -1, v13
    s_sub_u32 s97, s97, 1
    s_cselect_b64 vcc, 0, vcc
    s_cmp_eq_u64 vcc, 0
    s_cbranch_scc1 L2_pm_ok
    s_sleep 1
    s_branch L2_pm
L2_pm_ok:
    s_branch L2_pmr
L2_g0s:
    s_mov_b32 s97, 0x20000
L2_g0:
    buffer_load_dword v9, v6, s[84:87], s47 offen sc1
    s_waitcnt vmcnt(0)
    v_cmp_ne_u32 vcc, 0, v9
    s_nop 0
    s_lshr_b32 s3, vcc_lo, 1
    s_and_b32 s3, s3, vcc_lo
    s_lshr_b32 s14, s3, 2
    s_and_b32 s3, s3, s14
    s_and_b32 s3, s3, s48
    s_cselect_b64 vcc, 0, -1
    s_sub_u32 s97, s97, 1
    s_cselect_b64 vcc, 0, vcc
    s_cmp_eq_u64 vcc, 0
    s_cbranch_scc1 L2_g0_ok
    s_sleep 1
    s_branch L2_g0
L2_g0_ok:
    s_cmp_eq_u32 s3, 0
    s_cselect_b32 s3, s48, s3
    s_branch L2_g0r
L2_g1s:
    s_mov_b32 s97, 0x20000
L2_g1:
    buffer_load_dword v9, v6, s[84:87], s47 offen sc1
    s_waitcnt vmcnt(0)
    v_cmp_ne_u32 vcc, 0, v9
    s_nop 0
    s_lshr_b32 s3, vcc_lo, 1
    s_and_b32 s3, s3, vcc_lo
    s_lshr_b32 s14, s3, 2
    s_and_b32 s3, s3, s14
    s_and_b32 s3, s3, s48
    s_cselect_b64 vcc, 0, -1
    s_sub_u32 s97, s97, 1
    s_cselect_b64 vcc, 0, vcc
    s_cmp_eq_u64 vcc, 0
    s_cbranch_scc1 L2_g1_ok
    s_sleep 1
    s_branch L2_g1
L2_g1_ok:
    s_cmp_eq_u32 s3, 0
    s_cselect_b32 s3, s48, s3
    s_branch L2_g1r
L2_pns:
    s_mov_b32 s97, 0x20000
L2_pn:
    s_movk_i32 s45, 4608
    buffer_load_dwordx4 v[76:79], v5, s[84:87], s45 offen sc1
    s_movk_i32 s45, 18432
    buffer_load_dwordx4 v[88:91], v5, s[84:87], s45 offen sc1
    s_movk_i32 s45, 8704
    buffer_load_dwordx4 v[80:83], v5, s[84:87], s45 offen sc1
    s_movk_i32 s45, 22528
    buffer_load_dwordx4 v[92:95], v5, s[84:87], s45 offen sc1
    s_movk_i32 s45, 12800
    buffer_load_dwordx4 v[84:87], v59, s[84:87], s45 offen sc1
    s_movk_i32 s45, 26624
    buffer_load_dwordx4 v[96:99], v59, s[84:87], s45 offen sc1
    s_waitcnt vmcnt(0)
    v_max_u32 v13, v76, v77
    v_max3_u32 v13, v13, v78, v79
    v_max3_u32 v13, v13, v88, v89
    v_max3_u32 v13, v13, v90, v91
    v_max3_u32 v13, v13, v80, v81
    v_max3_u32 v13, v13, v82, v83
    v_max3_u32 v13, v13, v92, v93
    v_max3_u32 v13, v13, v94, v95
    v_max3_u32 v13, v13, v84, v85
    v_max3_u32 v13, v13, v86, v87
    v_max3_u32 v13, v13, v96, v97
    v_max3_u32 v13, v13, v98, v99
    v_cmp_eq_u32 vcc, -1, v13
    s_sub_u32 s97, s97, 1
    s_cselect_b64 vcc, 0, vcc
    s_cmp_eq_u64 vcc, 0
    s_cbranch_scc1 L2_pn_ok
    s_sleep 1
    s_branch L2_pn
L2_pn_ok:
    s_branch L2_pnr
L2_g2s:
    s_mov_b32 s97, 0x20000
L2_g2:
    buffer_load_dword v9, v6, s[84:87], s47 offen sc1
    s_waitcnt vmcnt(0)
    v_cmp_ne_u32 vcc, 0, v9
    s_nop 0
    s_lshr_b32 s3, vcc_lo, 1
    s_and_b32 s3, s3, vcc_lo
    s_lshr_b32 s14, s3, 2
    s_and_b32 s3, s3, s14
    s_and_b32 s3, s3, s48
    s_cselect_b64 vcc, 0, -1
    s_sub_u32 s97, s97, 1
    s_cselect_b64 vcc, 0, vcc
    s_cmp_eq_u64 vcc, 0
    s_cbranch_scc1 L2_g2_ok
    s_sleep 1
    s_branch L2_g2
L2_g2_ok:
    s_cmp_eq_u32 s3, 0
    s_cselect_b32 s3, s48, s3
    s_branch L2_g2r
L2_g3s:
    s_mov_b32 s97, 0x20000
L2_g3:
    buffer_load_dword v9, v6, s[84:87], s47 offen sc1
    s_waitcnt vmcnt(0)
    v_cmp_ne_u32 vcc, 0, v9
    s_nop 0
    s_lshr_b32 s3, vcc_lo, 1
    s_and_b32 s3, s3, vcc_lo
    s_lshr_b32 s14, s3, 2
    s_and_b32 s3, s3, s14
    s_and_b32 s3, s3, s48
    s_cselect_b64 vcc, 0, -1
    s_sub_u32 s97, s97, 1
    s_cselect_b64 vcc, 0, vcc
    s_cmp_eq_u64 vcc, 0
    s_cbranch_scc1 L2_g3_ok
    s_sleep 1
    s_branch L2_g3
L2_g3_ok:
    s_cmp_eq_u32 s3, 0
    s_cselect_b32 s3, s48, s3
    s_branch L2_g3r
L2_hs:
    s_mov_b32 s97, 0x20000
L2_h:
    buffer_load_dwordx4 v[128:131], v5, s[84:87], s59 offen offset:0 sc1
    buffer_load_dwordx4 v[132:135], v5, s[84:87], s59 offen offset:256 sc1
    buffer_load_dwordx4 v[136:139], v5, s[84:87], s59 offen offset:512 sc1
    buffer_load_dwordx4 v[140:143], v5, s[84:87], s59 offen offset:768 sc1
    buffer_load_dwordx4 v[144:147], v3, s[84:87], s59 offen offset:1024 sc1
    s_waitcnt vmcnt(0)
    v_max_u32 v12, v128, v129
    v_max3_u32 v12, v12, v130, v131
    v_max3_u32 v12, v12, v132, v133
    v_max3_u32 v12, v12, v134, v135
    v_max3_u32 v12, v12, v136, v137
    v_max3_u32 v12, v12, v138, v139
    v_max3_u32 v12, v12, v140, v141
    v_max3_u32 v12, v12, v142, v143
    v_max3_u32 v12, v12, v144, v145
    v_max3_u32 v12, v12, v146, v147
    v_cmp_eq_u32 vcc, -1, v12
    s_sub_u32 s97, s97, 1
    s_cselect_b64 vcc, 0, vcc
    s_cmp_eq_u64 vcc, 0
    s_cbranch_scc1 L2_h_ok
    s_sleep 1
    s_branch L2_h
L2_h_ok:
    v_min_u32 v128, -2, v128
    v_min_u32 v129, -2, v129
    v_min_u32 v130, -2, v130
    v_min_u32 v131, -2, v131
    v_min_u32 v132, -2, v132
    v_min_u32 v133, -2, v133
    v_min_u32 v134, -2, v134
    v_min_u32 v135, -2, v135
    v_min_u32 v136, -2, v136
    v_min_u32 v137, -2, v137
    v_min_u32 v138, -2, v138
    v_min_u32 v139, -2, v139
    v_min_u32 v140, -2, v140
    v_min_u32 v141, -2, v141
    v_min_u32 v142, -2, v142
    v_min_u32 v143, -2, v143
    v_min_u32 v144, -2, v144
    v_min_u32 v145, -2, v145
    v_min_u32 v146, -2, v146
    v_min_u32 v147, -2, v147
    s_nop 1
    s_branch L2_hr
L2_fallback:
    s_waitcnt vmcnt(0) lgkmcnt(0)
    s_nop 7
    s_barrier
    s_lshl_b32 s3, s51, 12
    v_add_u32 v5, s3, v8
    v_lshrrev_b32 v14, 2, v0
    v_mul_u32_u24 v14, 1056, v14
    v_and_b32 v15, 3, v0
    v_lshl_add_u32 v14, v15, 3, v14
    v_add_u32 v2, 107008, v14
    v_and_b32 v14, 15, v0
    v_mul_u32_u24 v14, 1056, v14
    v_lshrrev_b32 v15, 4, v0
    v_lshl_add_u32 v14, v15, 4, v14
    v_add_u32 v1, 90112, v14
    v_mov_b32 v32, 0xff800000
    v_mov_b32 v33, 0xff800000
    v_mov_b32 v34, 0xff800000
    v_mov_b32 v35, 0xff800000
    s_mov_b32 s50, 1
    s_mov_b32 s46, 0
L2_fb_loop:
    s_add_u32 m0, s44, 73728
    s_nop 0
    buffer_load_dwordx4 v5, s[16:19], s46 offen offset:0 lds
    s_add_u32 m0, s44, 73760
    s_nop 0
    buffer_load_dwordx4 v5, s[16:19], s46 offen offset:1024 lds
    s_add_u32 m0, s44, 73792
    s_nop 0
    buffer_load_dwordx4 v5, s[16:19], s46 offen offset:2048 lds
    s_add_u32 m0, s44, 73824
    s_nop 0
    buffer_load_dwordx4 v5, s[16:19], s46 offen offset:3072 lds
    s_waitcnt vmcnt(0) lgkmcnt(0)
    s_barrier
    ds_read_b128 a[64:67], v1 offset:0
    ds_read_b128 a[68:71], v1 offset:64
    ds_read_b128 a[72:75], v1 offset:128
    ds_read_b128 a[76:79], v1 offset:192
    ds_read_b128 a[80:83], v1 offset:256
    ds_read_b128 a[84:87], v1 offset:320
    ds_read_b128 a[88:91], v1 offset:384
    ds_read_b128 a[92:95], v1 offset:448
    ds_read_b128 a[96:99], v1 offset:512
    ds_read_b128 a[100:103], v1 offset:576
    ds_read_b128 a[104:107], v1 offset:640
    ds_read_b128 a[108:111], v1 offset:704
    ds_read_b128 a[112:115], v1 offset:768
    ds_read_b128 a[116:119], v1 offset:832
    ds_read_b128 a[120:123], v1 offset:896
    ds_read_b128 a[124:127], v1 offset:960
    s_waitcnt vmcnt(0) lgkmcnt(0)
    s_barrier
    v_mfma_f32_16x16x32_bf16 v[16:19], a[64:67], v[64:67], 0
    v_mfma_f32_16x16x32_bf16 v[16:19], a[68:71], v[68:71], v[16:19]
    v_mfma_f32_16x16x32_bf16 v[16:19], a[72:75], v[72:75], v[16:19]
    v_mfma_f32_16x16x32_bf16 v[16:19], a[76:79], v[76:79], v[16:19]
    v_mfma_f32_16x16x32_bf16 v[20:23], a[80:83], v[64:67], 0
    v_mfma_f32_16x16x32_bf16 v[20:23], a[84:87], v[68:71], v[20:23]
    v_mfma_f32_16x16x32_bf16 v[20:23], a[88:91], v[72:75], v[20:23]
    v_mfma_f32_16x16x32_bf16 v[20:23], a[92:95], v[76:79], v[20:23]
    v_mfma_f32_16x16x32_bf16 v[24:27], a[96:99], v[64:67], 0
    v_mfma_f32_16x16x32_bf16 v[24:27], a[100:103], v[68:71], v[24:27]
    v_mfma_f32_16x16x32_bf16 v[24:27], a[104:107], v[72:75], v[24:27]
    v_mfma_f32_16x16x32_bf16 v[24:27], a[108:111], v[76:79], v[24:27]
    v_mfma_f32_16x16x32_bf16 v[28:31], a[112:115], v[64:67], 0
    v_mfma_f32_16x16x32_bf16 v[28:31], a[116:119], v[68:71], v[28:31]
    v_mfma_f32_16x16x32_bf16 v[28:31], a[120:123], v[72:75], v[28:31]
    v_mfma_f32_16x16x32_bf16 v[28:31], a[124:127], v[76:79], v[28:31]
    s_nop 7
    v_max3_f32 v32, v32, v16, v17
    v_max3_f32 v32, v32, v18, v19
    v_max3_f32 v32, v32, v20, v21
    v_max3_f32 v32, v32, v22, v23
    v_max3_f32 v32, v32, v24, v25
    v_max3_f32 v32, v32, v26, v27
    v_max3_f32 v32, v32, v28, v29
    v_max3_f32 v32, v32, v30, v31
    v_mfma_f32_16x16x32_bf16 v[16:19], a[64:67], v[80:83], 0
    v_mfma_f32_16x16x32_bf16 v[16:19], a[68:71], v[84:87], v[16:19]
    v_mfma_f32_16x16x32_bf16 v[16:19], a[72:75], v[88:91], v[16:19]
    v_mfma_f32_16x16x32_bf16 v[16:19], a[76:79], v[92:95], v[16:19]
    v_mfma_f32_16x16x32_bf16 v[20:23], a[80:83], v[80:83], 0
    v_mfma_f32_16x16x32_bf16 v[20:23], a[84:87], v[84:87], v[20:23]
    v_mfma_f32_16x16x32_bf16 v[20:23], a[88:91], v[88:91], v[20:23]
    v_mfma_f32_16x16x32_bf16 v[20:23], a[92:95], v[92:95], v[20:23]
    v_mfma_f32_16x16x32_bf16 v[24:27], a[96:99], v[80:83], 0
    v_mfma_f32_16x16x32_bf16 v[24:27], a[100:103], v[84:87], v[24:27]
    v_mfma_f32_16x16x32_bf16 v[24:27], a[104:107], v[88:91], v[24:27]
    v_mfma_f32_16x16x32_bf16 v[24:27], a[108:111], v[92:95], v[24:27]
    v_mfma_f32_16x16x32_bf16 v[28:31], a[112:115], v[80:83], 0
    v_mfma_f32_16x16x32_bf16 v[28:31], a[116:119], v[84:87], v[28:31]
    v_mfma_f32_16x16x32_bf16 v[28:31], a[120:123], v[88:91], v[28:31]
    v_mfma_f32_16x16x32_bf16 v[28:31], a[124:127], v[92:95], v[28:31]
    s_nop 7
    v_max3_f32 v33, v33, v16, v17
    v_max3_f32 v33, v33, v18, v19
    v_max3_f32 v33, v33, v20, v21
    v_max3_f32 v33, v33, v22, v23
    v_max3_f32 v33, v33, v24, v25
    v_max3_f32 v33, v33, v26, v27
    v_max3_f32 v33, v33, v28, v29
    v_max3_f32 v33, v33, v30, v31
    v_mfma_f32_16x16x32_bf16 v[16:19], a[64:67], v[96:99], 0
    v_mfma_f32_16x16x32_bf16 v[16:19], a[68:71], v[100:103], v[16:19]
    v_mfma_f32_16x16x32_bf16 v[16:19], a[72:75], v[104:107], v[16:19]
    v_mfma_f32_16x16x32_bf16 v[16:19], a[76:79], v[108:111], v[16:19]
    v_mfma_f32_16x16x32_bf16 v[20:23], a[80:83], v[96:99], 0
    v_mfma_f32_16x16x32_bf16 v[20:23], a[84:87], v[100:103], v[20:23]
    v_mfma_f32_16x16x32_bf16 v[20:23], a[88:91], v[104:107], v[20:23]
    v_mfma_f32_16x16x32_bf16 v[20:23], a[92:95], v[108:111], v[20:23]
    v_mfma_f32_16x16x32_bf16 v[24:27], a[96:99], v[96:99], 0
    v_mfma_f32_16x16x32_bf16 v[24:27], a[100:103], v[100:103], v[24:27]
    v_mfma_f32_16x16x32_bf16 v[24:27], a[104:107], v[104:107], v[24:27]
    v_mfma_f32_16x16x32_bf16 v[24:27], a[108:111], v[108:111], v[24:27]
    v_mfma_f32_16x16x32_bf16 v[28:31], a[112:115], v[96:99], 0
    v_mfma_f32_16x16x32_bf16 v[28:31], a[116:119], v[100:103], v[28:31]
    v_mfma_f32_16x16x32_bf16 v[28:31], a[120:123], v[104:107], v[28:31]
    v_mfma_f32_16x16x32_bf16 v[28:31], a[124:127], v[108:111], v[28:31]
    s_nop 7
    v_max3_f32 v34, v34, v16, v17
    v_max3_f32 v34, v34, v18, v19
    v_max3_f32 v34, v34, v20, v21
    v_max3_f32 v34, v34, v22, v23
    v_max3_f32 v34, v34, v24, v25
    v_max3_f32 v34, v34, v26, v27
    v_max3_f32 v34, v34, v28, v29
    v_max3_f32 v34, v34, v30, v31
    v_mfma_f32_16x16x32_bf16 v[16:19], a[64:67], v[112:115], 0
    v_mfma_f32_16x16x32_bf16 v[16:19], a[68:71], v[116:119], v[16:19]
    v_mfma_f32_16x16x32_bf16 v[16:19], a[72:75], v[120:123], v[16:19]
    v_mfma_f32_16x16x32_bf16 v[16:19], a[76:79], v[124:127], v[16:19]
    v_mfma_f32_16x16x32_bf16 v[20:23], a[80:83], v[112:115], 0
    v_mfma_f32_16x16x32_bf16 v[20:23], a[84:87], v[116:119], v[20:23]
    v_mfma_f32_16x16x32_bf16 v[20:23], a[88:91], v[120:123], v[20:23]
    v_mfma_f32_16x16x32_bf16 v[20:23], a[92:95], v[124:127], v[20:23]
    v_mfma_f32_16x16x32_bf16 v[24:27], a[96:99], v[112:115], 0
    v_mfma_f32_16x16x32_bf16 v[24:27], a[100:103], v[116:119], v[24:27]
    v_mfma_f32_16x16x32_bf16 v[24:27], a[104:107], v[120:123], v[24:27]
    v_mfma_f32_16x16x32_bf16 v[24:27], a[108:111], v[124:127], v[24:27]
    v_mfma_f32_16x16x32_bf16 v[28:31], a[112:115], v[112:115], 0
    v_mfma_f32_16x16x32_bf16 v[28:31], a[116:119], v[116:119], v[28:31]
    v_mfma_f32_16x16x32_bf16 v[28:31], a[120:123], v[120:123], v[28:31]
    v_mfma_f32_16x16x32_bf16 v[28:31], a[124:127], v[124:127], v[28:31]
    s_nop 7
    v_max3_f32 v35, v35, v16, v17
    v_max3_f32 v35, v35, v18, v19
    v_max3_f32 v35, v35, v20, v21
    v_max3_f32 v35, v35, v22, v23
    v_max3_f32 v35, v35, v24, v25
    v_max3_f32 v35, v35, v26, v27
    v_max3_f32 v35, v35, v28, v29
    v_max3_f32 v35, v35, v30, v31
    s_add_u32 s46, s46, 16384
    s_cmp_lt_u32 s46, 524288
    s_cbranch_scc1 L2_fb_loop
    v_mov_b32 v40, v32
    v_mov_b32 v41, v33
    v_mov_b32 v42, v34
    v_mov_b32 v43, v35
    v_permlane16_swap_b32 v40, v32
    v_permlane16_swap_b32 v41, v33
    v_permlane16_swap_b32 v42, v34
    v_permlane16_swap_b32 v43, v35
    v_max_f32 v32, v32, v40
    v_max_f32 v33, v33, v41
    v_max_f32 v34, v34, v42
    v_max_f32 v35, v35, v43
    v_mov_b32 v40, v32
    v_mov_b32 v41, v33
    v_mov_b32 v42, v34
    v_mov_b32 v43, v35
    v_permlane32_swap_b32 v40, v32
    v_permlane32_swap_b32 v41, v33
    v_permlane32_swap_b32 v42, v34
    v_permlane32_swap_b32 v43, v35
    v_max_f32 v32, v32, v40
    v_max_f32 v33, v33, v41
    v_max_f32 v34, v34, v42
    v_max_f32 v35, v35, v43
    v_sub_f32 v48, 0x80000000, v32
    v_sub_f32 v49, 0x80000000, v32
    v_sub_f32 v50, 0x80000000, v32
    v_sub_f32 v51, 0x80000000, v32
    v_sub_f32 v52, 0x80000000, v33
    v_sub_f32 v53, 0x80000000, v33
    v_sub_f32 v54, 0x80000000, v33
    v_sub_f32 v55, 0x80000000, v33
    v_sub_f32 v56, 0x80000000, v34
    v_sub_f32 v57, 0x80000000, v34
    v_sub_f32 v58, 0x80000000, v34
    v_sub_f32 v59, 0x80000000, v34
    v_sub_f32 v60, 0x80000000, v35
    v_sub_f32 v61, 0x80000000, v35
    v_sub_f32 v62, 0x80000000, v35
    v_sub_f32 v63, 0x80000000, v35
    s_add_u32 m0, s44, 73728
    s_mov_b32 s46, 0
    buffer_load_dwordx4 v5, s[16:19], s46 offen offset:0 lds
    s_add_u32 m0, s44, 73760
    s_nop 0
    buffer_load_dwordx4 v5, s[16:19], s46 offen offset:1024 lds
    s_add_u32 m0, s44, 73792
    s_nop 0
    buffer_load_dwordx4 v5, s[16:19], s46 offen offset:2048 lds
    s_add_u32 m0, s44, 73824
    s_nop 0
    buffer_load_dwordx4 v5, s[16:19], s46 offen offset:3072 lds
    s_add_u32 m0, s44, 90624
    s_nop 0
    buffer_load_dwordx4 v5, s[20:23], s46 offen offset:0 lds
    s_add_u32 m0, s44, 90656
    s_nop 0
    buffer_load_dwordx4 v5, s[20:23], s46 offen offset:1024 lds
    s_add_u32 m0, s44, 90688
    s_nop 0
    buffer_load_dwordx4 v5, s[20:23], s46 offen offset:2048 lds
    s_add_u32 m0, s44, 90720
    s_nop 0
    buffer_load_dwordx4 v5, s[20:23], s46 offen offset:3072 lds
    s_add_u32 m0, s44, 110592
    s_mov_b32 s46, 16384
    buffer_load_dwordx4 v5, s[16:19], s46 offen offset:0 lds
    s_add_u32 m0, s44, 110624
    s_nop 0
    buffer_load_dwordx4 v5, s[16:19], s46 offen offset:1024 lds
    s_add_u32 m0, s44, 110656
    s_nop 0
    buffer_load_dwordx4 v5, s[16:19], s46 offen offset:2048 lds
    s_add_u32 m0, s44, 110688
    s_nop 0
    buffer_load_dwordx4 v5, s[16:19], s46 offen offset:3072 lds
    s_add_u32 m0, s44, 127488
    s_nop 0
    buffer_load_dwordx4 v5, s[20:23], s46 offen offset:0 lds
    s_add_u32 m0, s44, 127520
    s_nop 0
    buffer_load_dwordx4 v5, s[20:23], s46 offen offset:1024 lds
    s_add_u32 m0, s44, 127552
    s_nop 0
    buffer_load_dwordx4 v5, s[20:23], s46 offen offset:2048 lds
    s_add_u32 m0, s44, 127584
    s_nop 0
    buffer_load_dwordx4 v5, s[20:23], s46 offen offset:3072 lds
    s_add_u32 m0, s44, 0
    s_mov_b32 s46, 32768
    buffer_load_dwordx4 v5, s[16:19], s46 offen offset:0 lds
    s_add_u32 m0, s44, 32
    s_nop 0
    buffer_load_dwordx4 v5, s[16:19], s46 offen offset:1024 lds
    s_add_u32 m0, s44, 64
    s_nop 0
    buffer_load_dwordx4 v5, s[16:19], s46 offen offset:2048 lds
    s_add_u32 m0, s44, 96
    s_nop 0
    buffer_load_dwordx4 v5, s[16:19], s46 offen offset:3072 lds
    s_add_u32 m0, s44, 16896
    s_nop 0
    buffer_load_dwordx4 v5, s[20:23], s46 offen offset:0 lds
    s_add_u32 m0, s44, 16928
    s_nop 0
    buffer_load_dwordx4 v5, s[20:23], s46 offen offset:1024 lds
    s_add_u32 m0, s44, 16960
    s_nop 0
    buffer_load_dwordx4 v5, s[20:23], s46 offen offset:2048 lds
    s_add_u32 m0, s44, 16992
    s_nop 0
    buffer_load_dwordx4 v5, s[20:23], s46 offen offset:3072 lds
    s_waitcnt vmcnt(0) lgkmcnt(0)
    s_barrier
    ds_read_b128 a[64:67], v1 offset:0
    ds_read_b128 a[68:71], v1 offset:64
    ds_read_b128 a[72:75], v1 offset:128
    ds_read_b128 a[76:79], v1 offset:192
    ds_read_b128 a[80:83], v1 offset:256
    ds_read_b128 a[84:87], v1 offset:320
    ds_read_b128 a[88:91], v1 offset:384
    ds_read_b128 a[92:95], v1 offset:448
    ds_read_b128 a[96:99], v1 offset:512
    ds_read_b128 a[100:103], v1 offset:576
    ds_read_b128 a[104:107], v1 offset:640
    ds_read_b128 a[108:111], v1 offset:704
    ds_read_b128 a[112:115], v1 offset:768
    ds_read_b128 a[116:119], v1 offset:832
    ds_read_b128 a[120:123], v1 offset:896
    ds_read_b128 a[124:127], v1 offset:960
    v_lshrrev_b32 v14, 2, v0
    s_mul_i32 s3, s51, 144
    v_add_u32 v14, s3, v14
    v_mul_u32_u24 v14, 9216, v14
    v_and_b32 v15, 3, v0
    v_lshl_add_u32 v6, v15, 4, v14
    s_lshr_b32 s3, s2, 3
    s_lshl2_add_u32 s3, s3, s51
    s_and_b32 s15, s2, 7
    v_lshlrev_b32 v9, 7, v0
    s_mul_i32 s14, s3, 9
    s_lshr_b32 s14, s14, 1
    v_min_u32 v15, 44, v0
    v_mul_u32_u24 v12, 7282, v15
    v_lshrrev_b32 v12, 16, v12
    v_mul_u32_u24 v13, 63, v12
    v_add_u32 v12, v15, v13
    s_mul_i32 s14, s14, 72
    s_mul_i32 s56, s15, 9
    s_add_u32 s14, s14, s56
    v_add_lshl_u32 v12, s14, v12, 7
    s_mul_i32 s14, s3, 81
    s_lshr_b32 s14, s14, 1
    s_mul_i32 s56, s15, 5184
    s_add_u32 s14, s14, s56
    v_min_u32 v13, 40, v0
    v_add_lshl_u32 v13, s14, v13, 7
    s_mul_i32 s14, s3, 72
    s_andn2_b32 s56, s52, 3
    s_mul_i32 s56, s56, 2304
    s_add_u32 s14, s14, s56
    v_min_u32 v14, 35, v0
    v_add_lshl_u32 v14, s14, v14, 7
    v_add_u32 v15, 4608, v14
    v_accvgpr_write_b32 a0, 0
    v_accvgpr_write_b32 a1, 0
    v_accvgpr_write_b32 a2, 0
    v_accvgpr_write_b32 a3, 0
    v_accvgpr_write_b32 a4, 0
    v_accvgpr_write_b32 a5, 0
    v_accvgpr_write_b32 a6, 0
    v_accvgpr_write_b32 a7, 0
    v_accvgpr_write_b32 a8, 0
    v_accvgpr_write_b32 a9, 0
    v_accvgpr_write_b32 a10, 0
    v_accvgpr_write_b32 a11, 0
    v_accvgpr_write_b32 a12, 0
    v_accvgpr_write_b32 a13, 0
    v_accvgpr_write_b32 a14, 0
    v_accvgpr_write_b32 a15, 0
    s_waitcnt vmcnt(0) lgkmcnt(0)
    s_branch L2_entry
L2_codeend:

.section .rodata,"a"
.p2align 6
.amdhsa_kernel adaLN_cond__gqa_block_cached__moe_arch_mod__prompt_kernel
  .amdhsa_next_free_vgpr 512
  .amdhsa_next_free_sgpr 102
  .amdhsa_accum_offset 256
  .amdhsa_group_segment_fixed_size 0
  .amdhsa_kernarg_size 120
  .amdhsa_user_sgpr_count 2
  .amdhsa_user_sgpr_kernarg_segment_ptr 1
  .amdhsa_system_sgpr_workgroup_id_x 1
  .amdhsa_float_denorm_mode_32 3
.end_amdhsa_kernel
```

```asm
; @launch grid=(256,1,1) block=(256,1,1) lds=163840
.amdgcn_target "amdgcn-amd-amdhsa--gfx950"
.text
.globl adaLN_cond__gqa_block_cached__moe_arch_mod__prompt_kernel
.p2align 8
.type adaLN_cond__gqa_block_cached__moe_arch_mod__prompt_kernel,@function
adaLN_cond__gqa_block_cached__moe_arch_mod__prompt_kernel:
L2_begin:
    s_getpc_b64 s[98:99]
    s_cmp_ge_u32 s2, 256
    s_cbranch_scc1 L2_end
    s_load_dwordx2 s[76:77], s[0:1], 0
    s_load_dwordx2 s[16:17], s[0:1], 80
    s_load_dwordx2 s[88:89], s[0:1], 88
    s_load_dwordx2 s[12:13], s[0:1], 112
    s_load_dwordx2 s[60:61], s[0:1], 104
    s_and_b32 s3, s2, 7
    s_lshr_b32 s14, s2, 3
    v_mov_b32 v155, v0
    v_lshrrev_b32 v10, 6, v0
    v_and_b32 v0, 63, v0
    s_lshl_b32 s15, s14, 9
    v_lshl_add_u32 v13, v10, 7, s15
    v_lshl_add_u32 v13, v0, 14, v13
    v_min_u32 v13, L2_codeend-L2_begin-8, v13
    s_mov_b64 exec, 31
    global_load_dword a63, v13, s[98:99]
    s_mov_b64 exec, -1
    v_readfirstlane_b32 s51, v10
    s_and_b32 s52, s3, 3
    s_and_b32 s15, s14, 3
    s_lshl2_add_u32 s52, s52, s15
    s_lshr_b32 s53, s3, 2
    s_lshr_b32 s15, s14, 2
    s_lshl3_add_u32 s53, s53, s15
    s_lshl4_add_u32 s96, s53, s52
    s_mul_i32 s49, s3, 27
    s_max_u32 s14, s14, 5
    s_add_u32 s49, s49, s14
    s_sub_u32 s49, s49, 5
    s_lshr_b32 s55, s3, 2
    s_mul_i32 s15, s55, 108
    s_sub_u32 s50, s49, s15
    s_mul_i32 s3, s51, 288
    v_lshrrev_b32 v14, 3, v0
    v_lshl_add_u32 v12, v14, 4, s3
    v_and_b32 v14, 1, v14
    v_lshl_add_u32 v13, v14, 4, s3
    v_and_b32 v14, 7, v0
    v_mul_u32_u24 v14, 1152, v14
    v_add_u32 v1, v14, v12
    v_add_u32 v2, v14, v13
    v_add_u32 v2, 256, v2
    v_and_b32 v4, 0xfc, v155
    v_and_b32 v7, 3, v0
    v_mul_u32_u24 v3, 6912, v4
    v_lshl_add_u32 v153, v7, 4, v3
    s_mul_i32 s3, s96, 9216
    s_movk_i32 s78, 9216
    s_mov_b32 s79, 0x20000
    s_mov_b32 s91, s79
    v_lshlrev_b32 v8, 4, v0
    s_mov_b32 s86, 8388608
    s_mov_b32 s87, s79
    s_movk_i32 s62, 256
    s_mov_b32 s63, s79
    s_lshl_b32 s14, s50, 6
    s_sub_u32 s90, 1990656, s14
    s_cmp_ge_u32 s2, 40
    s_cselect_b32 s90, s90, 0
    s_mul_i32 s15, s55, 1990656
    s_add_u32 s14, s14, s15
    s_waitcnt lgkmcnt(0)
    s_add_u32 s76, s76, s3
    s_addc_u32 s77, s77, 0
    buffer_load_dwordx4 v[64:67], v1, s[76:79], 0 offen offset:0
    buffer_load_dwordx4 v[68:71], v1, s[76:79], 0 offen offset:128
    buffer_load_dwordx4 v[72:75], v2, s[76:79], 0 offen offset:0
    s_add_u32 s88, s88, s14
    s_addc_u32 s89, s89, 0
    s_mov_b64 s[84:85], s[12:13]
    s_cmp_ge_u32 s2, 8
    s_cbranch_scc1 L2_noclr
    v_mov_b32 v52, -1
    v_mov_b32 v56, 0
    v_mov_b32 v53, -1
    v_mov_b32 v57, 0
    v_mov_b32 v54, -1
    v_mov_b32 v58, 0
    v_mov_b32 v55, -1
    v_mov_b32 v59, 0
    s_lshl2_add_u32 s15, s2, s51
    s_lshl_b32 s3, s15, 10
    buffer_store_dwordx4 v[52:55], v8, s[84:87], s3 offen sc1
    v_lshrrev_b32 v13, 3, v0
    v_mul_u32_u24 v13, 0, v13
    v_add_u32 v13, v13, v8
    s_mul_i32 s3, s15, 1024
    s_add_u32 s3, s3, 6815744
    buffer_store_dwordx4 v[56:59], v13, s[84:87], s3 offen sc1
L2_noclr:
    buffer_load_dwordx4 v[128:131], v153, s[88:91], 0 offen
    s_movk_i32 s3, 6912
    buffer_load_dwordx4 v[132:135], v153, s[88:91], s3 offen
    s_movk_i32 s3, 13824
    buffer_load_dwordx4 v[136:139], v153, s[88:91], s3 offen
    s_movk_i32 s3, 20736
    buffer_load_dwordx4 v[140:143], v153, s[88:91], s3 offen
    v_lshrrev_b32 v3, 2, v3
    v_lshl_add_u32 v3, v7, 4, v3
    v_add_u32 v154, 1769472, v3
    v_lshrrev_b32 v3, 1, v4
    v_lshlrev_b32 v4, 1, v4
    s_mul_i32 s3, s55, 576
    s_add_u32 s16, s16, s3
    s_addc_u32 s17, s17, 0
    s_mov_b32 s18, 576
    s_mov_b32 s19, 0x20000
    buffer_load_dwordx2 v[148:149], v4, s[16:19], 0 offen
    v_mov_b32 v144, 0
    v_mov_b32 v145, 0
    v_mov_b32 v146, 0
    v_mov_b32 v147, 0
    v_mov_b32 v150, 0
    s_cmp_ge_u32 s51, 2
    s_cbranch_scc1 L2_w23
    buffer_load_dwordx4 v[144:147], v154, s[88:91], 0 offen
    buffer_load_ushort v150, v3, s[16:19], 0 offen offset:512
L2_w23:
    s_load_dwordx8 s[4:11], s[0:1], 8
    s_load_dwordx2 s[64:65], s[0:1], 56
    s_load_dwordx2 s[68:69], s[0:1], 64
    s_load_dwordx2 s[72:73], s[0:1], 72
    s_load_dwordx2 s[80:81], s[0:1], 96
    s_load_dwordx2 s[36:37], s[0:1], 48
    s_cmp_eq_u32 s51, 0
    s_cselect_b32 s3, 0, 0x40000000
    v_mul_u32_u24 v156, 32, v0
    v_or_b32 v156, s3, v156
    s_mul_i32 s44, s51, 4224
    s_add_u32 s44, s44, 16384
    v_lshl_add_u32 v5, v10, 12, v8
    v_lshrrev_b32 v13, 5, v0
    v_lshl_add_u32 v13, v10, 1, v13
    v_lshlrev_b32 v13, 15, v13
    v_and_b32 v14, 31, v0
    v_lshl_add_u32 v6, v14, 4, v13
    v_mov_b32 v56, 0
    v_mov_b32 v60, -1
    v_mov_b32 v57, 0
    v_mov_b32 v61, -1
    v_mov_b32 v58, 0
    v_mov_b32 v62, -1
    v_mov_b32 v59, 0
    v_mov_b32 v63, -1
    s_and_b32 s14, s53, 7
    s_lshl2_add_u32 s14, s14, s51
    v_lshrrev_b32 v13, 2, v0
    v_lshl_add_u32 v13, v13, 5, s14
    v_lshlrev_b32 v13, 13, v13
    v_lshl_add_u32 v13, v7, 7, v13
    s_waitcnt lgkmcnt(0)
    s_lshl_b32 s3, s52, 9
    s_add_u32 s24, s8, s3
    s_addc_u32 s25, s9, 0
    s_mov_b32 s26, 0
    s_mov_b32 s27, 0x20000
    s_sub_u32 s26, 4718592, s3
    s_mov_b64 exec, 0xffff
    buffer_load_dword a63, v13, s[24:27], 0 offen
    s_mov_b64 exec, -1
    s_mov_b32 s38, 1152
    s_mov_b32 s39, 0x20000
    v_and_b32 v14, 7, v0
    v_lshlrev_b32 v157, 4, v14
    v_add_u32 v157, 14080, v157
    v_lshl_add_u32 v158, v10, 2, v157
    s_mul_i32 s3, s51, 4608
    v_lshl_add_u32 v14, v14, 4, s3
    v_lshrrev_b32 v15, 3, v0
    v_lshl_add_u32 v159, v15, 8, v14
    s_lshr_b32 s3, s96, 1
    s_mul_i32 s3, s3, 18432
    s_and_b32 s14, s96, 1
    s_lshl_b32 s14, s14, 7
    s_add_u32 s3, s3, s14
    s_add_u32 s58, s3, 1048576
    s_lshl_b32 s3, s53, 2
    s_add_u32 s3, s3, s51
    s_lshl_b32 s14, s3, 4
    s_add_u32 s14, s14, s52
    s_lshl_b32 s14, s14, 8
    s_add_u32 s56, s14, 786432
    s_mul_i32 s14, s3, 512
    s_add_u32 s59, s14, 6815744
    v_and_b32 v14, 3, v0
    v_mul_u32_u24 v163, 128, v14
    s_mul_i32 s14, s3, 36864
    s_add_u32 s14, s14, 1048576
    s_add_u32 s32, s12, s14
    s_addc_u32 s33, s13, 0
    s_mov_b32 s34, 36864
    s_mov_b32 s35, 0x20000
    s_mul_i32 s15, s2, 4608
    s_mul_i32 s14, s51, 1152
    s_add_u32 s15, s15, s14
    s_add_u32 s57, s15, 98304
    s_cmp_ge_u32 s2, 144
    s_cselect_b32 s14, 0x40000000, 0
    v_or_b32 v160, s14, v8
    v_lshrrev_b32 v12, 4, v155
    v_lshlrev_b32 v12, 7, v12
    v_lshl_add_u32 v161, v7, 5, v12
    v_lshlrev_b32 v162, 2, v0
    s_mul_i32 s3, s50, 3641
    s_lshr_b32 s3, s3, 16
    s_mov_b32 s47, 1.0
    s_mov_b32 s48, 0
    s_cmp_lt_u32 s3, 2
    s_cselect_b32 s47, 0x3e0293ee, s47
    s_cmp_eq_u32 s3, 1
    s_cselect_b32 s48, 0x3e0293ee, s48
    s_cmp_eq_u32 s3, 4
    s_cselect_b32 s48, 1.0, s48
    s_cmp_eq_u32 s55, 0
    s_cselect_b32 s48, s48, 0
    s_lshl_b32 s100, s49, 7
    s_mul_i32 s14, s96, 128
    s_add_u32 s101, s14, 6815744
    s_mul_i32 s3, s51, 1152
    v_add_u32 v166, s3, v8
    s_and_b32 s3, s51, 1
    s_mul_i32 s3, s3, 2304
    s_cmp_lt_u32 s51, 2
    s_cselect_b32 s14, 32, 0
    s_add_u32 s3, s3, s14
    s_add_u32 s3, s3, 9216
    v_lshrrev_b32 v14, 1, v0
    v_lshl_add_u32 v14, v14, 6, s3
    v_and_b32 v15, 1, v0
    v_lshl_add_u32 v167, v15, 4, v14
    s_cmp_eq_u32 s51, 1
    s_cselect_b32 s3, 40, 256
    s_cmp_ge_u32 s2, s3
    s_cselect_b32 s3, 0, 0x40000000
    v_or_b32 v164, s3, v162
    v_mov_b32 v172, 0
    v_mov_b32 v180, 0
    v_mov_b32 v173, 0
    v_mov_b32 v181, 0
    v_mov_b32 v174, 0
    v_mov_b32 v182, 0
    v_mov_b32 v175, 0
    v_mov_b32 v183, 0
    s_lshl_b32 s3, s53, 2
    s_add_u32 s3, s3, s51
    v_mov_b32 v12, v10
    s_mul_i32 s14, s3, 589824
    s_mul_i32 s15, s52, 9216
    s_add_u32 s14, s14, s15
    s_add_u32 s14, s14, 8388608
    s_add_u32 s40, s12, s14
    s_addc_u32 s41, s13, 0
    s_mov_b32 s42, 0
    s_mov_b32 s43, 0x20000
    s_sub_u32 s42, 589824, s15
    s_lshl_b32 s3, s52, 19
    s_add_u32 s16, s4, s3
    s_addc_u32 s17, s5, 0
    s_mov_b32 s18, 524288
    s_mov_b32 s19, 0x20000
    s_add_u32 s20, s6, s3
    s_addc_u32 s21, s7, 0
    s_mov_b32 s22, 524288
    s_mov_b32 s23, 0x20000
    s_lshl_b32 s3, s51, 12
    s_add_u32 s16, s16, s3
    s_addc_u32 s17, s17, 0x100000
    s_mov_b32 s18, 32768
    s_mov_b32 s19, 0x800000
    s_add_u32 s20, s20, s3
    s_addc_u32 s21, s21, 0x100000
    s_mov_b32 s22, 32768
    s_mov_b32 s23, 0x800000
    s_mul_i32 s3, s52, 294912
    s_add_u32 s28, s10, s3
    s_addc_u32 s29, s11, 0
    s_mov_b32 s30, 294912
    s_mov_b32 s31, 0x20000
    s_mov_b64 s[4:5], s[64:65]
    s_mov_b64 s[6:7], s[68:69]
    s_mov_b64 s[8:9], s[72:73]
    s_mov_b32 s50, 0
    s_mul_i32 s55, s51, 9216
    s_min_u32 s15, s2, 143
    s_and_b32 s3, s15, 7
    s_mul_i32 s3, s3, 18
    s_lshr_b32 s15, s15, 3
    s_add_u32 s15, s15, s3
    s_lshl_b32 s3, s15, 6
    s_add_u32 s64, s64, s3
    s_addc_u32 s65, s65, 0
    s_mov_b32 s66, 0
    s_mov_b32 s67, 0x20000
    s_add_u32 s68, s68, s3
    s_addc_u32 s69, s69, 0
    s_mov_b32 s70, 0
    s_mov_b32 s71, 0x20000
    s_sub_u32 s14, 5308416, s3
    s_mul_i32 s3, s15, 36864
    s_add_u32 s72, s72, s3
    s_addc_u32 s73, s73, 0
    s_mov_b32 s74, 0
    s_mov_b32 s75, 0x20000
    s_cmp_lt_u32 s2, 144
    s_cselect_b32 s66, s14, 0
    s_cselect_b32 s70, s14, 0
    s_cselect_b32 s74, 36864, 0
    s_mov_b32 s82, 2359296
    s_mov_b32 s83, 0x20000
    v_lshrrev_b32 v13, 4, v0
    v_lshlrev_b32 v9, 6, v13
    v_lshrrev_b32 v14, 2, v0
    v_mul_u32_u24 v14, 1056, v14
    v_add_u32 v14, 16384, v14
    v_and_b32 v15, 1, v0
    v_lshlrev_b32 v15, 4, v15
    v_add_u32 v3, v14, v15
    v_and_b32 v15, 2, v0
    v_lshl_add_u32 v3, v15, 2, v3
    v_add_u32 v4, 73728, v3
    v_lshrrev_b32 v14, 3, v0
    v_lshlrev_b32 v14, 2, v14
    v_add_u32 v14, v14, v12
    v_mul_u32_u24 v14, 4608, v14
    v_and_b32 v15, 7, v0
    v_lshl_add_u32 v7, v15, 4, v14
    v_lshlrev_b32 v10, 4, v15
    v_lshl_add_u32 v10, v13, 7, v10
    v_bfe_u32 v14, v0, 3, 1
    v_mul_u32_u24 v14, 147456, v14
    v_add_u32 v10, v10, v14
    v_lshrrev_b32 v14, 2, v0
    v_mul_u32_u24 v14, 1056, v14
    v_and_b32 v15, 3, v0
    v_lshl_add_u32 v14, v15, 3, v14
    v_add_u32 v2, 107008, v14
    v_and_b32 v14, 15, v0
    v_mul_u32_u24 v14, 1056, v14
    v_lshrrev_b32 v15, 4, v0
    v_lshl_add_u32 v14, v15, 4, v14
    v_add_u32 v1, 90112, v14
    v_and_b32 v14, 1, v0
    v_cmp_eq_u32 vcc, 0, v14
    v_mov_b32 v11, 0xeeeeeeee
    v_mov_b32 v15, 0x44444444
    v_cndmask_b32 v11, v11, v15, vcc
    v_and_b32 v14, 2, v0
    v_cmp_eq_u32 vcc, 0, v14
    v_mov_b32 v15, 0x3f803f80
    s_nop 0
    v_cndmask_b32 v15, 0, v15, vcc
    v_accvgpr_write_b32 a16, v15
    v_accvgpr_write_b32 a56, -1
    v_accvgpr_write_b32 a17, v15
    v_accvgpr_write_b32 a57, -1
    v_accvgpr_write_b32 a18, v15
    v_accvgpr_write_b32 a58, -1
    v_accvgpr_write_b32 a19, v15
    v_accvgpr_write_b32 a59, -1
    v_accvgpr_write_b32 a0, 0
    v_accvgpr_write_b32 a1, 0
    v_accvgpr_write_b32 a2, 0
    v_accvgpr_write_b32 a3, 0
    v_accvgpr_write_b32 a4, 0
    v_accvgpr_write_b32 a5, 0
    v_accvgpr_write_b32 a6, 0
    v_accvgpr_write_b32 a7, 0
    v_accvgpr_write_b32 a8, 0
    v_accvgpr_write_b32 a9, 0
    v_accvgpr_write_b32 a10, 0
    v_accvgpr_write_b32 a11, 0
    v_accvgpr_write_b32 a12, 0
    v_accvgpr_write_b32 a13, 0
    v_accvgpr_write_b32 a14, 0
    v_accvgpr_write_b32 a15, 0
    s_cmp_ge_u32 s2, 8
    s_cbranch_scc1 L2_noclr2
    s_mul_i32 s14, s2, 32
    s_mov_b64 exec, 1
    s_waitcnt vmcnt(6)
    s_barrier
    buffer_store_dword v60, v156, s[60:63], s14 offen sc1
    s_mov_b64 exec, -1
L2_noclr2:
    s_waitcnt vmcnt(6)
    v_lshlrev_b32 v24, 16, v64
    v_and_b32 v25, 0xffff0000, v64
    v_lshlrev_b32 v26, 16, v65
    v_and_b32 v27, 0xffff0000, v65
    v_lshlrev_b32 v28, 16, v66
    v_and_b32 v29, 0xffff0000, v66
    v_lshlrev_b32 v30, 16, v67
    v_and_b32 v31, 0xffff0000, v67
    v_lshlrev_b32 v32, 16, v68
    v_and_b32 v33, 0xffff0000, v68
    v_lshlrev_b32 v34, 16, v69
    v_and_b32 v35, 0xffff0000, v69
    v_lshlrev_b32 v36, 16, v70
    v_and_b32 v37, 0xffff0000, v70
    v_lshlrev_b32 v38, 16, v71
    v_and_b32 v39, 0xffff0000, v71
    v_lshlrev_b32 v40, 16, v72
    v_and_b32 v41, 0xffff0000, v72
    v_lshlrev_b32 v42, 16, v73
    v_and_b32 v43, 0xffff0000, v73
    v_lshlrev_b32 v44, 16, v74
    v_and_b32 v45, 0xffff0000, v74
    v_lshlrev_b32 v46, 16, v75
    v_and_b32 v47, 0xffff0000, v75
    v_pk_add_f32 v[12:13], v[24:25], v[26:27]
    v_pk_add_f32 v[12:13], v[12:13], v[28:29]
    v_pk_add_f32 v[12:13], v[12:13], v[30:31]
    v_pk_add_f32 v[12:13], v[12:13], v[32:33]
    v_pk_add_f32 v[12:13], v[12:13], v[34:35]
    v_pk_add_f32 v[12:13], v[12:13], v[36:37]
    v_pk_add_f32 v[12:13], v[12:13], v[38:39]
    v_pk_add_f32 v[14:15], v[40:41], v[42:43]
    v_pk_add_f32 v[14:15], v[14:15], v[44:45]
    v_pk_add_f32 v[14:15], v[14:15], v[46:47]
    v_add_f32 v48, v12, v13
    v_add_f32 v14, v14, v15
    v_fmac_f32 v48, 0x3e800000, v14
    s_nop 1
    v_add_f32_dpp v48, v48, v48 row_ror:8 row_mask:0xf bank_mask:0xf
    v_mov_b32 v50, v48
    s_nop 1
    v_permlane16_swap_b32 v50, v48
    v_add_f32 v48, v48, v50
    v_mov_b32 v50, v48
    s_nop 1
    v_permlane32_swap_b32 v50, v48
    v_add_f32 v48, v48, v50
    v_mul_f32 v48, 0x3be38e39, v48
    v_pk_add_f32 v[24:25], v[24:25], v[48:49] op_sel_hi:[1,0] neg_lo:[0,1] neg_hi:[0,1]
    v_pk_add_f32 v[26:27], v[26:27], v[48:49] op_sel_hi:[1,0] neg_lo:[0,1] neg_hi:[0,1]
    v_pk_add_f32 v[28:29], v[28:29], v[48:49] op_sel_hi:[1,0] neg_lo:[0,1] neg_hi:[0,1]
    v_pk_add_f32 v[30:31], v[30:31], v[48:49] op_sel_hi:[1,0] neg_lo:[0,1] neg_hi:[0,1]
    v_pk_add_f32 v[32:33], v[32:33], v[48:49] op_sel_hi:[1,0] neg_lo:[0,1] neg_hi:[0,1]
    v_pk_add_f32 v[34:35], v[34:35], v[48:49] op_sel_hi:[1,0] neg_lo:[0,1] neg_hi:[0,1]
    v_pk_add_f32 v[36:37], v[36:37], v[48:49] op_sel_hi:[1,0] neg_lo:[0,1] neg_hi:[0,1]
    v_pk_add_f32 v[38:39], v[38:39], v[48:49] op_sel_hi:[1,0] neg_lo:[0,1] neg_hi:[0,1]
    v_pk_add_f32 v[40:41], v[40:41], v[48:49] op_sel_hi:[1,0] neg_lo:[0,1] neg_hi:[0,1]
    v_pk_add_f32 v[42:43], v[42:43], v[48:49] op_sel_hi:[1,0] neg_lo:[0,1] neg_hi:[0,1]
    v_pk_add_f32 v[44:45], v[44:45], v[48:49] op_sel_hi:[1,0] neg_lo:[0,1] neg_hi:[0,1]
    v_pk_add_f32 v[46:47], v[46:47], v[48:49] op_sel_hi:[1,0] neg_lo:[0,1] neg_hi:[0,1]
    v_pk_mul_f32 v[12:13], v[24:25], v[24:25]
    v_pk_fma_f32 v[12:13], v[26:27], v[26:27], v[12:13]
    v_pk_fma_f32 v[12:13], v[28:29], v[28:29], v[12:13]
    v_pk_fma_f32 v[12:13], v[30:31], v[30:31], v[12:13]
    v_pk_fma_f32 v[12:13], v[32:33], v[32:33], v[12:13]
    v_pk_fma_f32 v[12:13], v[34:35], v[34:35], v[12:13]
    v_pk_fma_f32 v[12:13], v[36:37], v[36:37], v[12:13]
    v_pk_fma_f32 v[12:13], v[38:39], v[38:39], v[12:13]
    v_pk_mul_f32 v[14:15], v[40:41], v[40:41]
    v_pk_fma_f32 v[14:15], v[42:43], v[42:43], v[14:15]
    v_pk_fma_f32 v[14:15], v[44:45], v[44:45], v[14:15]
    v_pk_fma_f32 v[14:15], v[46:47], v[46:47], v[14:15]
    v_add_f32 v49, v12, v13
    v_add_f32 v14, v14, v15
    v_fmac_f32 v49, 0x3e800000, v14
    s_nop 1
    v_add_f32_dpp v49, v49, v49 row_ror:8 row_mask:0xf bank_mask:0xf
    v_mov_b32 v50, v49
    s_nop 1
    v_permlane16_swap_b32 v50, v49
    v_add_f32 v49, v49, v50
    v_mov_b32 v50, v49
    s_nop 1
    v_permlane32_swap_b32 v50, v49
    v_add_f32 v49, v49, v50
    ds_write_b32 v158, v48
    ds_write_b32 v158, v49 offset:128
    s_waitcnt lgkmcnt(0)
    s_barrier
    ds_read_b128 v[16:19], v157
    ds_read_b128 v[20:23], v157 offset:128
    s_add_u32 s14, s58, 4096
    s_waitcnt lgkmcnt(1)
    v_add_f32 v12, v16, v17
    v_add_f32 v13, v18, v19
    v_add_f32 v12, v12, v13
    v_mul_f32 v12, 0x3e800000, v12
    v_sub_f32 v16, v16, v12
    v_sub_f32 v17, v17, v12
    v_sub_f32 v18, v18, v12
    v_sub_f32 v19, v19, v12
    v_sub_f32 v48, v48, v12
    v_mul_f32 v13, v16, v16
    v_fmac_f32 v13, v17, v17
    v_fmac_f32 v13, v18, v18
    v_fmac_f32 v13, v19, v19
    s_waitcnt lgkmcnt(0)
    v_add_f32 v14, v20, v21
    v_add_f32 v15, v22, v23
    v_add_f32 v14, v14, v15
    v_fmac_f32 v14, 0x43100000, v13
    v_mov_b32 v12, 0x3727c5ac
    v_fmac_f32 v12, 0x3ae38e39, v14
    v_rsq_f32 v12, v12
    s_nop 0
    v_mul_f32 v48, v48, v12
    v_pk_fma_f32 v[24:25], v[24:25], v[12:13], v[48:49] op_sel_hi:[1,0,0]
    v_pk_fma_f32 v[26:27], v[26:27], v[12:13], v[48:49] op_sel_hi:[1,0,0]
    v_pk_fma_f32 v[28:29], v[28:29], v[12:13], v[48:49] op_sel_hi:[1,0,0]
    v_pk_fma_f32 v[30:31], v[30:31], v[12:13], v[48:49] op_sel_hi:[1,0,0]
    v_cvt_pk_f16_f32 v64, v24, v25
    v_cvt_pk_f16_f32 v65, v26, v27
    v_cvt_pk_f16_f32 v66, v28, v29
    v_cvt_pk_f16_f32 v67, v30, v31
    buffer_store_dwordx4 v[64:67], v159, s[84:87], s58 offen offset:0 sc1
    v_pk_fma_f32 v[32:33], v[32:33], v[12:13], v[48:49] op_sel_hi:[1,0,0]
    v_pk_fma_f32 v[34:35], v[34:35], v[12:13], v[48:49] op_sel_hi:[1,0,0]
    v_pk_fma_f32 v[36:37], v[36:37], v[12:13], v[48:49] op_sel_hi:[1,0,0]
    v_pk_fma_f32 v[38:39], v[38:39], v[12:13], v[48:49] op_sel_hi:[1,0,0]
    v_cvt_pk_f16_f32 v68, v32, v33
    v_cvt_pk_f16_f32 v69, v34, v35
    v_cvt_pk_f16_f32 v70, v36, v37
    v_cvt_pk_f16_f32 v71, v38, v39
    buffer_store_dwordx4 v[68:71], v159, s[84:87], s58 offen offset:2048 sc1
    v_pk_fma_f32 v[40:41], v[40:41], v[12:13], v[48:49] op_sel_hi:[1,0,0]
    v_pk_fma_f32 v[42:43], v[42:43], v[12:13], v[48:49] op_sel_hi:[1,0,0]
    v_pk_fma_f32 v[44:45], v[44:45], v[12:13], v[48:49] op_sel_hi:[1,0,0]
    v_pk_fma_f32 v[46:47], v[46:47], v[12:13], v[48:49] op_sel_hi:[1,0,0]
    v_cvt_pk_f16_f32 v72, v40, v41
    v_cvt_pk_f16_f32 v73, v42, v43
    v_cvt_pk_f16_f32 v74, v44, v45
    v_cvt_pk_f16_f32 v75, v46, v47
    s_mov_b64 exec, 0xffff
    buffer_store_dwordx4 v[72:75], v159, s[84:87], s14 offen offset:0 sc1
    buffer_store_dwordx4 v[56:59], v8, s[84:87], s56 offen sc1
    s_mov_b64 exec, 0xff
    buffer_store_dwordx4 v[60:63], v160, s[84:87], s57 offen offset:1024 sc1
    s_mov_b64 exec, -1
    buffer_store_dwordx4 v[60:63], v160, s[84:87], s57 offen sc1
    s_mov_b64 exec, 255
    buffer_load_dword v51, v156, s[60:63], 0 offen sc1
    s_mov_b64 exec, -1
    s_mul_i32 s3, s96, 147456
    s_add_u32 s3, s3, 8392704
    s_add_u32 s88, s12, s3
    s_addc_u32 s89, s13, 0
    s_mov_b32 s90, 143360
    s_mov_b32 s91, 0x20000
    s_waitcnt vmcnt(7)
    v_lshlrev_b32 v40, 16, v148
    v_and_b32 v41, 0xffff0000, v148
    v_lshlrev_b32 v42, 16, v149
    v_and_b32 v43, 0xffff0000, v149
    v_lshlrev_b32 v44, 16, v150
    v_mul_f32 v16, 0xbfb8aa3b, v40
    v_mul_f32 v17, 0xbfb8aa3b, v41
    v_mul_f32 v18, 0xbfb8aa3b, v42
    v_mul_f32 v19, 0xbfb8aa3b, v43
    v_mul_f32 v20, 0xbfb8aa3b, v44
    v_exp_f32 v16, v16
    v_exp_f32 v17, v17
    v_exp_f32 v18, v18
    v_exp_f32 v19, v19
    v_exp_f32 v20, v20
    v_add_f32 v16, 1.0, v16
    v_add_f32 v17, 1.0, v17
    v_add_f32 v18, 1.0, v18
    v_add_f32 v19, 1.0, v19
    v_add_f32 v20, 1.0, v20
    v_rcp_f32 v16, v16
    v_rcp_f32 v17, v17
    v_rcp_f32 v18, v18
    v_rcp_f32 v19, v19
    v_rcp_f32 v20, v20
    v_mul_f32 v24, v40, v16
    v_mul_f32 v26, v41, v17
    v_mul_f32 v28, v42, v18
    v_mul_f32 v30, v43, v19
    v_mul_f32 v32, v44, v20
    v_lshlrev_b32 v12, 16, v128
    v_and_b32 v13, 0xffff0000, v128
    v_pk_mul_f32 v[16:17], v[12:13], v[24:25] op_sel_hi:[1,0]
    v_lshlrev_b32 v14, 16, v129
    v_and_b32 v15, 0xffff0000, v129
    v_pk_mul_f32 v[18:19], v[14:15], v[24:25] op_sel_hi:[1,0]
    v_lshlrev_b32 v12, 16, v130
    v_and_b32 v13, 0xffff0000, v130
    v_pk_mul_f32 v[20:21], v[12:13], v[24:25] op_sel_hi:[1,0]
    v_lshlrev_b32 v14, 16, v131
    v_and_b32 v15, 0xffff0000, v131
    v_pk_mul_f32 v[22:23], v[14:15], v[24:25] op_sel_hi:[1,0]
    v_lshlrev_b32 v12, 16, v132
    v_and_b32 v13, 0xffff0000, v132
    v_pk_fma_f32 v[16:17], v[12:13], v[26:27], v[16:17] op_sel_hi:[1,0,1]
    v_lshlrev_b32 v14, 16, v133
    v_and_b32 v15, 0xffff0000, v133
    v_pk_fma_f32 v[18:19], v[14:15], v[26:27], v[18:19] op_sel_hi:[1,0,1]
    v_lshlrev_b32 v12, 16, v134
    v_and_b32 v13, 0xffff0000, v134
    v_pk_fma_f32 v[20:21], v[12:13], v[26:27], v[20:21] op_sel_hi:[1,0,1]
    v_lshlrev_b32 v14, 16, v135
    v_and_b32 v15, 0xffff0000, v135
    v_pk_fma_f32 v[22:23], v[14:15], v[26:27], v[22:23] op_sel_hi:[1,0,1]
    v_lshlrev_b32 v12, 16, v136
    v_and_b32 v13, 0xffff0000, v136
    v_pk_fma_f32 v[16:17], v[12:13], v[28:29], v[16:17] op_sel_hi:[1,0,1]
    v_lshlrev_b32 v14, 16, v137
    v_and_b32 v15, 0xffff0000, v137
    v_pk_fma_f32 v[18:19], v[14:15], v[28:29], v[18:19] op_sel_hi:[1,0,1]
    v_lshlrev_b32 v12, 16, v138
    v_and_b32 v13, 0xffff0000, v138
    v_pk_fma_f32 v[20:21], v[12:13], v[28:29], v[20:21] op_sel_hi:[1,0,1]
    v_lshlrev_b32 v14, 16, v139
    v_and_b32 v15, 0xffff0000, v139
    v_pk_fma_f32 v[22:23], v[14:15], v[28:29], v[22:23] op_sel_hi:[1,0,1]
    v_lshlrev_b32 v12, 16, v140
    v_and_b32 v13, 0xffff0000, v140
    v_pk_fma_f32 v[16:17], v[12:13], v[30:31], v[16:17] op_sel_hi:[1,0,1]
    v_lshlrev_b32 v14, 16, v141
    v_and_b32 v15, 0xffff0000, v141
    v_pk_fma_f32 v[18:19], v[14:15], v[30:31], v[18:19] op_sel_hi:[1,0,1]
    v_lshlrev_b32 v12, 16, v142
    v_and_b32 v13, 0xffff0000, v142
    v_pk_fma_f32 v[20:21], v[12:13], v[30:31], v[20:21] op_sel_hi:[1,0,1]
    v_lshlrev_b32 v14, 16, v143
    v_and_b32 v15, 0xffff0000, v143
    v_pk_fma_f32 v[22:23], v[14:15], v[30:31], v[22:23] op_sel_hi:[1,0,1]
    v_lshlrev_b32 v12, 16, v144
    v_and_b32 v13, 0xffff0000, v144
    v_pk_fma_f32 v[16:17], v[12:13], v[32:33], v[16:17] op_sel_hi:[1,0,1]
    v_lshlrev_b32 v14, 16, v145
    v_and_b32 v15, 0xffff0000, v145
    v_pk_fma_f32 v[18:19], v[14:15], v[32:33], v[18:19] op_sel_hi:[1,0,1]
    v_lshlrev_b32 v12, 16, v146
    v_and_b32 v13, 0xffff0000, v146
    v_pk_fma_f32 v[20:21], v[12:13], v[32:33], v[20:21] op_sel_hi:[1,0,1]
    v_lshlrev_b32 v14, 16, v147
    v_and_b32 v15, 0xffff0000, v147
    v_pk_fma_f32 v[22:23], v[14:15], v[32:33], v[22:23] op_sel_hi:[1,0,1]
    v_add_f32_dpp v16, v16, v16 row_ror:4 row_mask:0xf bank_mask:0xf
    v_add_f32_dpp v17, v17, v17 row_ror:4 row_mask:0xf bank_mask:0xf
    v_add_f32_dpp v18, v18, v18 row_ror:4 row_mask:0xf bank_mask:0xf
    v_add_f32_dpp v19, v19, v19 row_ror:4 row_mask:0xf bank_mask:0xf
    v_add_f32_dpp v20, v20, v20 row_ror:4 row_mask:0xf bank_mask:0xf
    v_add_f32_dpp v21, v21, v21 row_ror:4 row_mask:0xf bank_mask:0xf
    v_add_f32_dpp v22, v22, v22 row_ror:4 row_mask:0xf bank_mask:0xf
    v_add_f32_dpp v23, v23, v23 row_ror:4 row_mask:0xf bank_mask:0xf
    v_add_f32_dpp v16, v16, v16 row_ror:8 row_mask:0xf bank_mask:0xf
    v_add_f32_dpp v17, v17, v17 row_ror:8 row_mask:0xf bank_mask:0xf
    v_add_f32_dpp v18, v18, v18 row_ror:8 row_mask:0xf bank_mask:0xf
    v_add_f32_dpp v19, v19, v19 row_ror:8 row_mask:0xf bank_mask:0xf
    v_add_f32_dpp v20, v20, v20 row_ror:8 row_mask:0xf bank_mask:0xf
    v_add_f32_dpp v21, v21, v21 row_ror:8 row_mask:0xf bank_mask:0xf
    v_add_f32_dpp v22, v22, v22 row_ror:8 row_mask:0xf bank_mask:0xf
    v_add_f32_dpp v23, v23, v23 row_ror:8 row_mask:0xf bank_mask:0xf
    s_mov_b32 exec_lo, 0xf000f
    s_mov_b32 exec_hi, 0xf000f
    ds_write_b128 v161, v[16:19] offset:16384
    ds_write_b128 v161, v[20:23] offset:16400
    s_mov_b64 exec, 255
    s_waitcnt vmcnt(0)
    v_cmp_eq_u32 vcc, s51, v51
    s_nop 0
    s_cmp_lg_u64 vcc, 0
    s_cbranch_scc1 L2_p0s
L2_p0r:
    s_mov_b64 exec, 1
    s_waitcnt lgkmcnt(0)
    s_barrier
    buffer_store_dword v60, v156, s[84:87], s101 offen sc1
    s_mov_b64 exec, -1
    ds_read_b32 v24, v162 offset:16384
    ds_read_b32 v25, v162 offset:16640
    ds_read_b32 v26, v162 offset:16896
    ds_read_b32 v27, v162 offset:17152
    ds_read_b32 v28, v162 offset:17408
    ds_read_b32 v29, v162 offset:17664
    ds_read_b32 v30, v162 offset:17920
    ds_read_b32 v31, v162 offset:18176
    s_waitcnt lgkmcnt(0)
    v_pk_add_f32 v[24:25], v[24:25], v[26:27]
    v_pk_add_f32 v[28:29], v[28:29], v[30:31]
    v_pk_add_f32 v[24:25], v[24:25], v[28:29]
    v_add_f32 v52, v24, v25
    v_mov_b32 v53, v52
    v_mov_b32 v54, s48
    s_nop 0
    v_permlane32_swap_b32 v53, v52
    v_add_f32 v52, v52, v53
    v_fma_f32 v52, v52, s47, v54
    v_min_u32 v52, -2, v52
    s_mov_b32 exec_hi, 0
    buffer_store_dword v52, v164, s[84:87], s100 offen sc1
    s_mov_b64 exec, -1
    s_add_u32 m0, s44, 36864
    s_mov_b32 s45, 0
    buffer_load_dwordx4 v6, s[24:27], s45 offen lds
    s_add_u32 m0, s44, 37920
    s_mov_b32 s45, 8192
    buffer_load_dwordx4 v6, s[24:27], s45 offen lds
    s_add_u32 m0, s44, 38976
    s_mov_b32 s45, 16384
    buffer_load_dwordx4 v6, s[24:27], s45 offen lds
    s_add_u32 m0, s44, 40032
    s_mov_b32 s45, 24576
    buffer_load_dwordx4 v6, s[24:27], s45 offen lds
    s_add_u32 m0, s44, 53760
    s_mov_b32 s45, 262144
    buffer_load_dwordx4 v6, s[24:27], s45 offen lds
    s_add_u32 m0, s44, 54816
    s_mov_b32 s45, 270336
    buffer_load_dwordx4 v6, s[24:27], s45 offen lds
    s_add_u32 m0, s44, 55872
    s_mov_b32 s45, 278528
    buffer_load_dwordx4 v6, s[24:27], s45 offen lds
    s_add_u32 m0, s44, 56928
    s_mov_b32 s45, 286720
    buffer_load_dwordx4 v6, s[24:27], s45 offen lds
    s_add_u32 m0, s44, 73728
    s_mov_b32 s45, 524288
    buffer_load_dwordx4 v6, s[24:27], s45 offen lds
    s_add_u32 m0, s44, 74784
    s_mov_b32 s45, 532480
    buffer_load_dwordx4 v6, s[24:27], s45 offen lds
    s_add_u32 m0, s44, 75840
    s_mov_b32 s45, 540672
    buffer_load_dwordx4 v6, s[24:27], s45 offen lds
    s_add_u32 m0, s44, 76896
    s_mov_b32 s45, 548864
    buffer_load_dwordx4 v6, s[24:27], s45 offen lds
    s_add_u32 m0, s44, 90624
    s_mov_b32 s45, 786432
    buffer_load_dwordx4 v6, s[24:27], s45 offen lds
    s_add_u32 m0, s44, 91680
    s_mov_b32 s45, 794624
    buffer_load_dwordx4 v6, s[24:27], s45 offen lds
    s_add_u32 m0, s44, 92736
    s_mov_b32 s45, 802816
    buffer_load_dwordx4 v6, s[24:27], s45 offen lds
    s_add_u32 m0, s44, 93792
    s_mov_b32 s45, 811008
    buffer_load_dwordx4 v6, s[24:27], s45 offen lds
    s_mov_b64 exec, 0
    s_cmp_eq_u32 s51, 0
    s_cbranch_scc1 L2_pad0
    s_cmp_eq_u32 s51, 1
    s_cbranch_scc1 L2_pad1
    s_cmp_eq_u32 s51, 2
    s_cbranch_scc1 L2_pad2
    s_branch L2_pad3
.p2align 12
L2_walkret:
    s_mov_b64 exec, 15
    s_mov_b32 s97, 0x20000
L2_px:
    buffer_load_dword v13, v163, s[84:87], s59 offen sc1
    s_waitcnt vmcnt(0)
    v_cmp_eq_u32 vcc, 0, v13
    s_sub_u32 s97, s97, 1
    s_cselect_b64 vcc, 0, vcc
    s_cmp_eq_u64 vcc, 0
    s_cbranch_scc1 L2_px_ok
    s_sleep 1
    s_branch L2_px
L2_px_ok:
    s_mov_b64 exec, -1
    s_movk_i32 s14, 13824
    buffer_load_dwordx4 v[168:171], v166, s[84:87], 0 offen sc1
    buffer_load_dwordx4 v[176:179], v166, s[84:87], s14 offen sc1
    s_mov_b64 exec, 0xff
    buffer_load_dwordx4 v[172:175], v166, s[84:87], 0 offen offset:1024 sc1
    buffer_load_dwordx4 v[180:183], v166, s[84:87], s14 offen offset:1024 sc1
    s_mov_b64 exec, -1
    s_mov_b32 s54, 0
    buffer_load_dwordx4 v[80:83], v8, s[32:35], s54 offen sc1
    s_mov_b32 s54, 1024
    buffer_load_dwordx4 v[84:87], v8, s[32:35], s54 offen sc1
    s_mov_b32 s54, 18432
    buffer_load_dwordx4 v[88:91], v8, s[32:35], s54 offen sc1
    s_mov_b32 s54, 19456
    buffer_load_dwordx4 v[92:95], v8, s[32:35], s54 offen sc1
    s_mov_b32 s54, 2048
    buffer_load_dwordx4 v[96:99], v8, s[32:35], s54 offen sc1
    s_mov_b32 s54, 3072
    buffer_load_dwordx4 v[100:103], v8, s[32:35], s54 offen sc1
    s_mov_b32 s54, 20480
    buffer_load_dwordx4 v[104:107], v8, s[32:35], s54 offen sc1
    s_mov_b32 s54, 21504
    buffer_load_dwordx4 v[108:111], v8, s[32:35], s54 offen sc1
    s_waitcnt vmcnt(8)
    v_max_u32 v13, v168, v169
    v_max3_u32 v13, v13, v170, v171
    v_max3_u32 v13, v13, v172, v173
    v_max3_u32 v13, v13, v174, v175
    v_max3_u32 v13, v13, v176, v177
    v_max3_u32 v13, v13, v178, v179
    v_max3_u32 v13, v13, v180, v181
    v_max3_u32 v13, v13, v182, v183
    v_cmp_eq_u32 vcc, -1, v13
    s_nop 0
    s_cmp_lg_u64 vcc, 0
    s_cbranch_scc1 L2_pms
L2_pmr:
    v_pk_add_f32 v[168:169], v[168:169], v[176:177]
    v_pk_add_f32 v[170:171], v[170:171], v[178:179]
    v_pk_add_f32 v[172:173], v[172:173], v[180:181]
    v_pk_add_f32 v[174:175], v[174:175], v[182:183]
    ds_write_b128 v167, v[168:171]
    s_mov_b64 exec, 0xff
    ds_write_b128 v167, v[172:175] offset:2048
    s_mov_b64 exec, -1
    s_mov_b32 s54, 4096
    buffer_load_dwordx4 v[112:115], v8, s[32:35], s54 offen sc1
    s_mov_b32 s54, 5120
    buffer_load_dwordx4 v[116:119], v8, s[32:35], s54 offen sc1
    s_mov_b32 s54, 22528
    buffer_load_dwordx4 v[120:123], v8, s[32:35], s54 offen sc1
    s_mov_b32 s54, 23552
    buffer_load_dwordx4 v[124:127], v8, s[32:35], s54 offen sc1
    s_waitcnt lgkmcnt(0)
    s_barrier
    ds_read_b128 v[16:19], v9 offset:9216
    ds_read_b128 v[20:23], v9 offset:9248
    ds_read_b128 v[24:27], v9 offset:9232
    ds_read_b128 v[28:31], v9 offset:9264
    s_waitcnt vmcnt(8)
    s_waitcnt lgkmcnt(2)
    v_fma_mix_f32 v32, v80, v16, v20 op_sel:[0,0,0] op_sel_hi:[1,0,0]
    v_fma_mix_f32 v33, v80, v17, v21 op_sel:[1,0,0] op_sel_hi:[1,0,0]
    v_fma_mix_f32 v34, v81, v18, v22 op_sel:[0,0,0] op_sel_hi:[1,0,0]
    v_fma_mix_f32 v35, v81, v19, v23 op_sel:[1,0,0] op_sel_hi:[1,0,0]
    v_cvt_pk_bf16_f32 v80, v32, v33
    v_cvt_pk_bf16_f32 v81, v34, v35
    v_fma_mix_f32 v36, v88, v16, v20 op_sel:[0,0,0] op_sel_hi:[1,0,0]
    v_fma_mix_f32 v37, v88, v17, v21 op_sel:[1,0,0] op_sel_hi:[1,0,0]
    v_fma_mix_f32 v38, v89, v18, v22 op_sel:[0,0,0] op_sel_hi:[1,0,0]
    v_fma_mix_f32 v39, v89, v19, v23 op_sel:[1,0,0] op_sel_hi:[1,0,0]
    v_cvt_pk_bf16_f32 v88, v36, v37
    v_cvt_pk_bf16_f32 v89, v38, v39
    ds_read_b128 v[16:19], v9 offset:9472
    ds_read_b128 v[20:23], v9 offset:9504
    s_waitcnt lgkmcnt(2)
    v_fma_mix_f32 v32, v82, v24, v28 op_sel:[0,0,0] op_sel_hi:[1,0,0]
    v_fma_mix_f32 v33, v82, v25, v29 op_sel:[1,0,0] op_sel_hi:[1,0,0]
    v_fma_mix_f32 v34, v83, v26, v30 op_sel:[0,0,0] op_sel_hi:[1,0,0]
    v_fma_mix_f32 v35, v83, v27, v31 op_sel:[1,0,0] op_sel_hi:[1,0,0]
    v_cvt_pk_bf16_f32 v82, v32, v33
    v_cvt_pk_bf16_f32 v83, v34, v35
    v_fma_mix_f32 v36, v90, v24, v28 op_sel:[0,0,0] op_sel_hi:[1,0,0]
    v_fma_mix_f32 v37, v90, v25, v29 op_sel:[1,0,0] op_sel_hi:[1,0,0]
    v_fma_mix_f32 v38, v91, v26, v30 op_sel:[0,0,0] op_sel_hi:[1,0,0]
    v_fma_mix_f32 v39, v91, v27, v31 op_sel:[1,0,0] op_sel_hi:[1,0,0]
    v_cvt_pk_bf16_f32 v90, v36, v37
    v_cvt_pk_bf16_f32 v91, v38, v39
    ds_read_b128 v[24:27], v9 offset:9488
    ds_read_b128 v[28:31], v9 offset:9520
    s_waitcnt lgkmcnt(2)
    v_fma_mix_f32 v32, v84, v16, v20 op_sel:[0,0,0] op_sel_hi:[1,0,0]
    v_fma_mix_f32 v33, v84, v17, v21 op_sel:[1,0,0] op_sel_hi:[1,0,0]
    v_fma_mix_f32 v34, v85, v18, v22 op_sel:[0,0,0] op_sel_hi:[1,0,0]
    v_fma_mix_f32 v35, v85, v19, v23 op_sel:[1,0,0] op_sel_hi:[1,0,0]
    v_cvt_pk_bf16_f32 v84, v32, v33
    v_cvt_pk_bf16_f32 v85, v34, v35
    v_fma_mix_f32 v36, v92, v16, v20 op_sel:[0,0,0] op_sel_hi:[1,0,0]
    v_fma_mix_f32 v37, v92, v17, v21 op_sel:[1,0,0] op_sel_hi:[1,0,0]
    v_fma_mix_f32 v38, v93, v18, v22 op_sel:[0,0,0] op_sel_hi:[1,0,0]
    v_fma_mix_f32 v39, v93, v19, v23 op_sel:[1,0,0] op_sel_hi:[1,0,0]
    v_cvt_pk_bf16_f32 v92, v36, v37
    v_cvt_pk_bf16_f32 v93, v38, v39
    ds_read_b128 v[16:19], v9 offset:9728
    ds_read_b128 v[20:23], v9 offset:9760
    ds_read_b64_tr_b16 a[192:193], v3 offset:36864
    ds_read_b64_tr_b16 a[194:195], v3 offset:37376
    ds_read_b64_tr_b16 a[196:197], v3 offset:53760
    ds_read_b64_tr_b16 a[198:199], v3 offset:54272
    ds_read_b64_tr_b16 a[200:201], v3 offset:36896
    ds_read_b64_tr_b16 a[202:203], v3 offset:37408
    ds_read_b64_tr_b16 a[204:205], v3 offset:53792
    ds_read_b64_tr_b16 a[206:207], v3 offset:54304
    ds_read_b64_tr_b16 a[208:209], v3 offset:36928
    ds_read_b64_tr_b16 a[210:211], v3 offset:37440
    ds_read_b64_tr_b16 a[212:213], v3 offset:53824
    ds_read_b64_tr_b16 a[214:215], v3 offset:54336
    s_waitcnt lgkmcnt(14)
    v_fma_mix_f32 v32, v86, v24, v28 op_sel:[0,0,0] op_sel_hi:[1,0,0]
    v_fma_mix_f32 v33, v86, v25, v29 op_sel:[1,0,0] op_sel_hi:[1,0,0]
    v_fma_mix_f32 v34, v87, v26, v30 op_sel:[0,0,0] op_sel_hi:[1,0,0]
    v_fma_mix_f32 v35, v87, v27, v31 op_sel:[1,0,0] op_sel_hi:[1,0,0]
    v_cvt_pk_bf16_f32 v86, v32, v33
    v_cvt_pk_bf16_f32 v87, v34, v35
    v_fma_mix_f32 v36, v94, v24, v28 op_sel:[0,0,0] op_sel_hi:[1,0,0]
    v_fma_mix_f32 v37, v94, v25, v29 op_sel:[1,0,0] op_sel_hi:[1,0,0]
    v_fma_mix_f32 v38, v95, v26, v30 op_sel:[0,0,0] op_sel_hi:[1,0,0]
    v_fma_mix_f32 v39, v95, v27, v31 op_sel:[1,0,0] op_sel_hi:[1,0,0]
    v_cvt_pk_bf16_f32 v94, v36, v37
    v_cvt_pk_bf16_f32 v95, v38, v39
    s_waitcnt lgkmcnt(8)
    v_mfma_f32_16x16x32_bf16 v[128:131], a[192:195], v[80:83], 0
    s_waitcnt vmcnt(4)
    ds_read_b64_tr_b16 a[216:217], v3 offset:36960
    ds_read_b128 v[24:27], v9 offset:9744
    v_mfma_f32_16x16x32_bf16 v[128:131], a[196:199], v[84:87], v[128:131]
    ds_read_b64_tr_b16 a[218:219], v3 offset:37472
    ds_read_b64_tr_b16 a[220:221], v3 offset:53856
    v_fma_mix_f32 v32, v96, v16, v20 op_sel:[0,0,0] op_sel_hi:[1,0,0]
    v_mfma_f32_16x16x32_bf16 v[160:163], a[192:195], v[88:91], 0
    s_add_u32 m0, s44, 110592
    ds_read_b64_tr_b16 a[222:223], v3 offset:54368
    ds_read_b128 v[28:31], v9 offset:9776
    v_mfma_f32_16x16x32_bf16 v[160:163], a[196:199], v[92:95], v[160:163]
    s_mov_b32 s45, 1048576
    s_waitcnt lgkmcnt(10)
    buffer_load_dwordx4 v6, s[24:27], s45 offen lds
    v_mfma_f32_16x16x32_bf16 v[132:135], a[200:203], v[80:83], 0
    ds_read_b64_tr_b16 a[224:225], v3 offset:36992
    v_fma_mix_f32 v33, v96, v17, v21 op_sel:[1,0,0] op_sel_hi:[1,0,0]
    v_mfma_f32_16x16x32_bf16 v[132:135], a[204:207], v[84:87], v[132:135]
    ds_read_b64_tr_b16 a[226:227], v3 offset:37504
    ds_read_b64_tr_b16 a[228:229], v3 offset:53888
    v_fma_mix_f32 v34, v97, v18, v22 op_sel:[0,0,0] op_sel_hi:[1,0,0]
    v_mfma_f32_16x16x32_bf16 v[164:167], a[200:203], v[88:91], 0
    s_add_u32 m0, s44, 111648
    ds_read_b64_tr_b16 a[230:231], v3 offset:54400
    v_fma_mix_f32 v35, v97, v19, v23 op_sel:[1,0,0] op_sel_hi:[1,0,0]
    v_mfma_f32_16x16x32_bf16 v[164:167], a[204:207], v[92:95], v[164:167]
    s_mov_b32 s45, 1056768
    s_waitcnt lgkmcnt(10)
    buffer_load_dwordx4 v6, s[24:27], s45 offen lds
    v_mfma_f32_16x16x32_bf16 v[136:139], a[208:211], v[80:83], 0
    ds_read_b64_tr_b16 a[232:233], v3 offset:37024
    v_cvt_pk_bf16_f32 v96, v32, v33
    v_mfma_f32_16x16x32_bf16 v[136:139], a[212:215], v[84:87], v[136:139]
    ds_read_b64_tr_b16 a[234:235], v3 offset:37536
    ds_read_b64_tr_b16 a[236:237], v3 offset:53920
    v_cvt_pk_bf16_f32 v97, v34, v35
    v_mfma_f32_16x16x32_bf16 v[168:171], a[208:211], v[88:91], 0
    s_add_u32 m0, s44, 112704
    ds_read_b64_tr_b16 a[238:239], v3 offset:54432
    v_fma_mix_f32 v36, v104, v16, v20 op_sel:[0,0,0] op_sel_hi:[1,0,0]
    v_mfma_f32_16x16x32_bf16 v[168:171], a[212:215], v[92:95], v[168:171]
    s_mov_b32 s45, 1064960
    s_waitcnt lgkmcnt(9)
    buffer_load_dwordx4 v6, s[24:27], s45 offen lds
    v_fma_mix_f32 v37, v104, v17, v21 op_sel:[1,0,0] op_sel_hi:[1,0,0]
    v_mfma_f32_16x16x32_bf16 v[140:143], a[216:219], v[80:83], 0
    ds_read_b64_tr_b16 a[240:241], v3 offset:37056
    v_fma_mix_f32 v38, v105, v18, v22 op_sel:[0,0,0] op_sel_hi:[1,0,0]
    v_mfma_f32_16x16x32_bf16 v[140:143], a[220:223], v[84:87], v[140:143]
    ds_read_b64_tr_b16 a[242:243], v3 offset:37568
    ds_read_b64_tr_b16 a[244:245], v3 offset:53952
    v_fma_mix_f32 v39, v105, v19, v23 op_sel:[1,0,0] op_sel_hi:[1,0,0]
    v_mfma_f32_16x16x32_bf16 v[172:175], a[216:219], v[88:91], 0
    s_add_u32 m0, s44, 113760
    ds_read_b64_tr_b16 a[246:247], v3 offset:54464
    v_cvt_pk_bf16_f32 v104, v36, v37
    v_mfma_f32_16x16x32_bf16 v[172:175], a[220:223], v[92:95], v[172:175]
    s_mov_b32 s45, 1073152
    s_waitcnt lgkmcnt(8)
    buffer_load_dwordx4 v6, s[24:27], s45 offen lds
    v_cvt_pk_bf16_f32 v105, v38, v39
    v_mfma_f32_16x16x32_bf16 v[144:147], a[224:227], v[80:83], 0
    ds_read_b64_tr_b16 a[248:249], v3 offset:37088
    ds_read_b128 v[16:19], v9 offset:9984
    v_mfma_f32_16x16x32_bf16 v[144:147], a[228:231], v[84:87], v[144:147]
    ds_read_b64_tr_b16 a[250:251], v3 offset:37600
    ds_read_b64_tr_b16 a[252:253], v3 offset:53984
    v_fma_mix_f32 v32, v98, v24, v28 op_sel:[0,0,0] op_sel_hi:[1,0,0]
    v_mfma_f32_16x16x32_bf16 v[176:179], a[224:227], v[88:91], 0
    s_add_u32 m0, s44, 127488
    ds_read_b64_tr_b16 a[254:255], v3 offset:54496
    ds_read_b128 v[20:23], v9 offset:10016
    v_mfma_f32_16x16x32_bf16 v[176:179], a[228:231], v[92:95], v[176:179]
    s_mov_b32 s45, 1310720
    s_waitcnt lgkmcnt(10)
    buffer_load_dwordx4 v6, s[24:27], s45 offen lds
    v_mfma_f32_16x16x32_bf16 v[148:151], a[232:235], v[80:83], 0
    ds_read_b64_tr_b16 a[192:193], v3 offset:37120
    v_fma_mix_f32 v33, v98, v25, v29 op_sel:[1,0,0] op_sel_hi:[1,0,0]
    v_mfma_f32_16x16x32_bf16 v[148:151], a[236:239], v[84:87], v[148:151]
    ds_read_b64_tr_b16 a[194:195], v3 offset:37632
    ds_read_b64_tr_b16 a[196:197], v3 offset:54016
    v_fma_mix_f32 v34, v99, v26, v30 op_sel:[0,0,0] op_sel_hi:[1,0,0]
    v_mfma_f32_16x16x32_bf16 v[180:183], a[232:235], v[88:91], 0
    s_add_u32 m0, s44, 128544
    ds_read_b64_tr_b16 a[198:199], v3 offset:54528
    v_fma_mix_f32 v35, v99, v27, v31 op_sel:[1,0,0] op_sel_hi:[1,0,0]
    v_mfma_f32_16x16x32_bf16 v[180:183], a[236:239], v[92:95], v[180:183]
    s_mov_b32 s45, 1318912
    s_waitcnt lgkmcnt(10)
    buffer_load_dwordx4 v6, s[24:27], s45 offen lds
    v_mfma_f32_16x16x32_bf16 v[152:155], a[240:243], v[80:83], 0
    ds_read_b64_tr_b16 a[200:201], v3 offset:37152
    v_cvt_pk_bf16_f32 v98, v32, v33
    v_mfma_f32_16x16x32_bf16 v[152:155], a[244:247], v[84:87], v[152:155]
    ds_read_b64_tr_b16 a[202:203], v3 offset:37664
    ds_read_b64_tr_b16 a[204:205], v3 offset:54048
    v_cvt_pk_bf16_f32 v99, v34, v35
    v_mfma_f32_16x16x32_bf16 v[184:187], a[240:243], v[88:91], 0
    s_add_u32 m0, s44, 129600
    ds_read_b64_tr_b16 a[206:207], v3 offset:54560
    v_fma_mix_f32 v36, v106, v24, v28 op_sel:[0,0,0] op_sel_hi:[1,0,0]
    v_mfma_f32_16x16x32_bf16 v[184:187], a[244:247], v[92:95], v[184:187]
    s_mov_b32 s45, 1327104
    s_waitcnt lgkmcnt(9)
    buffer_load_dwordx4 v6, s[24:27], s45 offen lds
    v_fma_mix_f32 v37, v106, v25, v29 op_sel:[1,0,0] op_sel_hi:[1,0,0]
    v_mfma_f32_16x16x32_bf16 v[156:159], a[248:251], v[80:83], 0
    ds_read_b64_tr_b16 a[208:209], v3 offset:37184
    v_fma_mix_f32 v38, v107, v26, v30 op_sel:[0,0,0] op_sel_hi:[1,0,0]
    v_mfma_f32_16x16x32_bf16 v[156:159], a[252:255], v[84:87], v[156:159]
    ds_read_b64_tr_b16 a[210:211], v3 offset:37696
    ds_read_b64_tr_b16 a[212:213], v3 offset:54080
    v_fma_mix_f32 v39, v107, v27, v31 op_sel:[1,0,0] op_sel_hi:[1,0,0]
    v_mfma_f32_16x16x32_bf16 v[188:191], a[248:251], v[88:91], 0
    s_add_u32 m0, s44, 130656
    ds_read_b64_tr_b16 a[214:215], v3 offset:54592
    v_cvt_pk_bf16_f32 v106, v36, v37
    v_mfma_f32_16x16x32_bf16 v[188:191], a[252:255], v[92:95], v[188:191]
    s_mov_b32 s45, 1335296
    s_waitcnt lgkmcnt(8)
    buffer_load_dwordx4 v6, s[24:27], s45 offen lds
    v_cvt_pk_bf16_f32 v107, v38, v39
    v_mfma_f32_16x16x32_bf16 v[192:195], a[192:195], v[80:83], 0
    ds_read_b64_tr_b16 a[216:217], v3 offset:37216
    ds_read_b128 v[24:27], v9 offset:10000
    v_mfma_f32_16x16x32_bf16 v[192:195], a[196:199], v[84:87], v[192:195]
    ds_read_b64_tr_b16 a[218:219], v3 offset:37728
    ds_read_b64_tr_b16 a[220:221], v3 offset:54112
    v_fma_mix_f32 v32, v100, v16, v20 op_sel:[0,0,0] op_sel_hi:[1,0,0]
    v_mfma_f32_16x16x32_bf16 v[224:227], a[192:195], v[88:91], 0
    s_mov_b32 s54, 6144
    ds_read_b64_tr_b16 a[222:223], v3 offset:54624
    ds_read_b128 v[28:31], v9 offset:10032
    v_mfma_f32_16x16x32_bf16 v[224:227], a[196:199], v[92:95], v[224:227]
    s_waitcnt lgkmcnt(10)
    buffer_load_dwordx4 v[48:51], v8, s[32:35], s54 offen sc1
    v_mfma_f32_16x16x32_bf16 v[196:199], a[200:203], v[80:83], 0
    ds_read_b64_tr_b16 a[224:225], v3 offset:37248
    v_fma_mix_f32 v33, v100, v17, v21 op_sel:[1,0,0] op_sel_hi:[1,0,0]
    v_mfma_f32_16x16x32_bf16 v[196:199], a[204:207], v[84:87], v[196:199]
    ds_read_b64_tr_b16 a[226:227], v3 offset:37760
    ds_read_b64_tr_b16 a[228:229], v3 offset:54144
    v_fma_mix_f32 v34, v101, v18, v22 op_sel:[0,0,0] op_sel_hi:[1,0,0]
    v_mfma_f32_16x16x32_bf16 v[228:231], a[200:203], v[88:91], 0
    s_mov_b32 s54, 7168
    ds_read_b64_tr_b16 a[230:231], v3 offset:54656
    v_fma_mix_f32 v35, v101, v19, v23 op_sel:[1,0,0] op_sel_hi:[1,0,0]
    v_mfma_f32_16x16x32_bf16 v[228:231], a[204:207], v[92:95], v[228:231]
    s_waitcnt lgkmcnt(10)
    buffer_load_dwordx4 v[52:55], v8, s[32:35], s54 offen sc1
    v_mfma_f32_16x16x32_bf16 v[200:203], a[208:211], v[80:83], 0
    ds_read_b64_tr_b16 a[232:233], v3 offset:37280
    v_cvt_pk_bf16_f32 v100, v32, v33
    v_mfma_f32_16x16x32_bf16 v[200:203], a[212:215], v[84:87], v[200:203]
    ds_read_b64_tr_b16 a[234:235], v3 offset:37792
    ds_read_b64_tr_b16 a[236:237], v3 offset:54176
    v_cvt_pk_bf16_f32 v101, v34, v35
    v_mfma_f32_16x16x32_bf16 v[232:235], a[208:211], v[88:91], 0
    s_mov_b32 s54, 24576
    ds_read_b64_tr_b16 a[238:239], v3 offset:54688
    v_fma_mix_f32 v36, v108, v16, v20 op_sel:[0,0,0] op_sel_hi:[1,0,0]
    v_mfma_f32_16x16x32_bf16 v[232:235], a[212:215], v[92:95], v[232:235]
    s_waitcnt lgkmcnt(9)
    buffer_load_dwordx4 v[56:59], v8, s[32:35], s54 offen sc1
    v_fma_mix_f32 v37, v108, v17, v21 op_sel:[1,0,0] op_sel_hi:[1,0,0]
    v_mfma_f32_16x16x32_bf16 v[204:207], a[216:219], v[80:83], 0
    ds_read_b64_tr_b16 a[240:241], v3 offset:37312
    v_fma_mix_f32 v38, v109, v18, v22 op_sel:[0,0,0] op_sel_hi:[1,0,0]
    v_mfma_f32_16x16x32_bf16 v[204:207], a[220:223], v[84:87], v[204:207]
    ds_read_b64_tr_b16 a[242:243], v3 offset:37824
    ds_read_b64_tr_b16 a[244:245], v3 offset:54208
    v_fma_mix_f32 v39, v109, v19, v23 op_sel:[1,0,0] op_sel_hi:[1,0,0]
    v_mfma_f32_16x16x32_bf16 v[236:239], a[216:219], v[88:91], 0
    s_mov_b32 s54, 25600
    ds_read_b64_tr_b16 a[246:247], v3 offset:54720
    v_cvt_pk_bf16_f32 v108, v36, v37
    v_mfma_f32_16x16x32_bf16 v[236:239], a[220:223], v[92:95], v[236:239]
    s_waitcnt lgkmcnt(8)
    buffer_load_dwordx4 v[60:63], v8, s[32:35], s54 offen sc1
    v_cvt_pk_bf16_f32 v109, v38, v39
    v_mfma_f32_16x16x32_bf16 v[208:211], a[224:227], v[80:83], 0
    ds_read_b64_tr_b16 a[248:249], v3 offset:37344
    ds_read_b128 v[16:19], v9 offset:10240
    v_mfma_f32_16x16x32_bf16 v[208:211], a[228:231], v[84:87], v[208:211]
    ds_read_b64_tr_b16 a[250:251], v3 offset:37856
    ds_read_b128 v[20:23], v9 offset:10272
    v_mfma_f32_16x16x32_bf16 v[240:243], a[224:227], v[88:91], 0
    ds_read_b64_tr_b16 a[252:253], v3 offset:54240
    v_fma_mix_f32 v32, v102, v24, v28 op_sel:[0,0,0] op_sel_hi:[1,0,0]
    v_mfma_f32_16x16x32_bf16 v[240:243], a[228:231], v[92:95], v[240:243]
    s_barrier
    s_waitcnt lgkmcnt(9)
    ds_read_b64_tr_b16 a[254:255], v3 offset:54752
    v_fma_mix_f32 v33, v102, v25, v29 op_sel:[1,0,0] op_sel_hi:[1,0,0]
    v_fma_mix_f32 v34, v103, v26, v30 op_sel:[0,0,0] op_sel_hi:[1,0,0]
    v_mfma_f32_16x16x32_bf16 v[212:215], a[232:235], v[80:83], 0
    ds_read_b64_tr_b16 a[192:193], v4 offset:0
    v_fma_mix_f32 v35, v103, v27, v31 op_sel:[1,0,0] op_sel_hi:[1,0,0]
    v_mfma_f32_16x16x32_bf16 v[212:215], a[236:239], v[84:87], v[212:215]
    ds_read_b64_tr_b16 a[194:195], v4 offset:512
    ds_read_b64_tr_b16 a[196:197], v4 offset:16896
    v_cvt_pk_bf16_f32 v102, v32, v33
    v_mfma_f32_16x16x32_bf16 v[244:247], a[232:235], v[88:91], 0
    s_add_u32 m0, s44, 0
    ds_read_b64_tr_b16 a[198:199], v4 offset:17408
    v_cvt_pk_bf16_f32 v103, v34, v35
    v_mfma_f32_16x16x32_bf16 v[244:247], a[236:239], v[92:95], v[244:247]
    s_mov_b32 s45, 1572864
    s_waitcnt lgkmcnt(10)
    buffer_load_dwordx4 v6, s[24:27], s45 offen lds
    v_mfma_f32_16x16x32_bf16 v[216:219], a[240:243], v[80:83], 0
    ds_read_b64_tr_b16 a[200:201], v4 offset:32
    v_fma_mix_f32 v36, v110, v24, v28 op_sel:[0,0,0] op_sel_hi:[1,0,0]
    v_mfma_f32_16x16x32_bf16 v[216:219], a[244:247], v[84:87], v[216:219]
    ds_read_b64_tr_b16 a[202:203], v4 offset:544
    ds_read_b64_tr_b16 a[204:205], v4 offset:16928
    v_fma_mix_f32 v37, v110, v25, v29 op_sel:[1,0,0] op_sel_hi:[1,0,0]
    v_mfma_f32_16x16x32_bf16 v[248:251], a[240:243], v[88:91], 0
    s_add_u32 m0, s44, 1056
    ds_read_b64_tr_b16 a[206:207], v4 offset:17440
    v_fma_mix_f32 v38, v111, v26, v30 op_sel:[0,0,0] op_sel_hi:[1,0,0]
    v_mfma_f32_16x16x32_bf16 v[248:251], a[244:247], v[92:95], v[248:251]
    s_mov_b32 s45, 1581056
    s_waitcnt lgkmcnt(8)
    buffer_load_dwordx4 v6, s[24:27], s45 offen lds
    v_mfma_f32_16x16x32_bf16 v[220:223], a[248:251], v[80:83], 0
    ds_read_b64_tr_b16 a[208:209], v4 offset:64
    v_fma_mix_f32 v39, v111, v27, v31 op_sel:[1,0,0] op_sel_hi:[1,0,0]
    v_mfma_f32_16x16x32_bf16 v[220:223], a[252:255], v[84:87], v[220:223]
    ds_read_b64_tr_b16 a[210:211], v4 offset:576
    ds_read_b64_tr_b16 a[212:213], v4 offset:16960
    v_cvt_pk_bf16_f32 v110, v36, v37
    v_mfma_f32_16x16x32_bf16 v[252:255], a[248:251], v[88:91], 0
    s_add_u32 m0, s44, 2112
    ds_read_b64_tr_b16 a[214:215], v4 offset:17472
    v_cvt_pk_bf16_f32 v111, v38, v39
    v_mfma_f32_16x16x32_bf16 v[252:255], a[252:255], v[92:95], v[252:255]
    s_mov_b32 s45, 1589248
    s_waitcnt lgkmcnt(8)
    buffer_load_dwordx4 v6, s[24:27], s45 offen lds
    v_mfma_f32_16x16x32_bf16 v[128:131], a[192:195], v[96:99], v[128:131]
    s_waitcnt vmcnt(15)
    ds_read_b64_tr_b16 a[216:217], v4 offset:96
    ds_read_b128 v[24:27], v9 offset:10256
    v_mfma_f32_16x16x32_bf16 v[128:131], a[196:199], v[100:103], v[128:131]
    ds_read_b64_tr_b16 a[218:219], v4 offset:608
    ds_read_b64_tr_b16 a[220:221], v4 offset:16992
    v_fma_mix_f32 v32, v112, v16, v20 op_sel:[0,0,0] op_sel_hi:[1,0,0]
    v_mfma_f32_16x16x32_bf16 v[160:163], a[192:195], v[104:107], v[160:163]
    s_add_u32 m0, s44, 3168
    ds_read_b64_tr_b16 a[222:223], v4 offset:17504
    ds_read_b128 v[28:31], v9 offset:10288
    v_mfma_f32_16x16x32_bf16 v[160:163], a[196:199], v[108:111], v[160:163]
    s_mov_b32 s45, 1597440
    s_waitcnt lgkmcnt(10)
    buffer_load_dwordx4 v6, s[24:27], s45 offen lds
    v_mfma_f32_16x16x32_bf16 v[132:135], a[200:203], v[96:99], v[132:135]
    ds_read_b64_tr_b16 a[224:225], v4 offset:128
    v_fma_mix_f32 v33, v112, v17, v21 op_sel:[1,0,0] op_sel_hi:[1,0,0]
    v_mfma_f32_16x16x32_bf16 v[132:135], a[204:207], v[100:103], v[132:135]
    ds_read_b64_tr_b16 a[226:227], v4 offset:640
    ds_read_b64_tr_b16 a[228:229], v4 offset:17024
    v_fma_mix_f32 v34, v113, v18, v22 op_sel:[0,0,0] op_sel_hi:[1,0,0]
    v_mfma_f32_16x16x32_bf16 v[164:167], a[200:203], v[104:107], v[164:167]
    s_add_u32 m0, s44, 16896
    ds_read_b64_tr_b16 a[230:231], v4 offset:17536
    v_fma_mix_f32 v35, v113, v19, v23 op_sel:[1,0,0] op_sel_hi:[1,0,0]
    v_mfma_f32_16x16x32_bf16 v[164:167], a[204:207], v[108:111], v[164:167]
    s_mov_b32 s45, 1835008
    s_waitcnt lgkmcnt(10)
    buffer_load_dwordx4 v6, s[24:27], s45 offen lds
    v_mfma_f32_16x16x32_bf16 v[136:139], a[208:211], v[96:99], v[136:139]
    ds_read_b64_tr_b16 a[232:233], v4 offset:160
    v_cvt_pk_bf16_f32 v112, v32, v33
    v_mfma_f32_16x16x32_bf16 v[136:139], a[212:215], v[100:103], v[136:139]
    ds_read_b64_tr_b16 a[234:235], v4 offset:672
    ds_read_b64_tr_b16 a[236:237], v4 offset:17056
    v_cvt_pk_bf16_f32 v113, v34, v35
    v_mfma_f32_16x16x32_bf16 v[168:171], a[208:211], v[104:107], v[168:171]
    s_add_u32 m0, s44, 17952
    ds_read_b64_tr_b16 a[238:239], v4 offset:17568
    v_fma_mix_f32 v36, v120, v16, v20 op_sel:[0,0,0] op_sel_hi:[1,0,0]
    v_mfma_f32_16x16x32_bf16 v[168:171], a[212:215], v[108:111], v[168:171]
    s_mov_b32 s45, 1843200
    s_waitcnt lgkmcnt(9)
    buffer_load_dwordx4 v6, s[24:27], s45 offen lds
    v_fma_mix_f32 v37, v120, v17, v21 op_sel:[1,0,0] op_sel_hi:[1,0,0]
    v_mfma_f32_16x16x32_bf16 v[140:143], a[216:219], v[96:99], v[140:143]
    ds_read_b64_tr_b16 a[240:241], v4 offset:192
    v_fma_mix_f32 v38, v121, v18, v22 op_sel:[0,0,0] op_sel_hi:[1,0,0]
    v_mfma_f32_16x16x32_bf16 v[140:143], a[220:223], v[100:103], v[140:143]
    ds_read_b64_tr_b16 a[242:243], v4 offset:704
    ds_read_b64_tr_b16 a[244:245], v4 offset:17088
    v_fma_mix_f32 v39, v121, v19, v23 op_sel:[1,0,0] op_sel_hi:[1,0,0]
    v_mfma_f32_16x16x32_bf16 v[172:175], a[216:219], v[104:107], v[172:175]
    s_add_u32 m0, s44, 19008
    ds_read_b64_tr_b16 a[246:247], v4 offset:17600
    v_cvt_pk_bf16_f32 v120, v36, v37
    v_mfma_f32_16x16x32_bf16 v[172:175], a[220:223], v[108:111], v[172:175]
    s_mov_b32 s45, 1851392
    s_waitcnt lgkmcnt(8)
    buffer_load_dwordx4 v6, s[24:27], s45 offen lds
    v_cvt_pk_bf16_f32 v121, v38, v39
    v_mfma_f32_16x16x32_bf16 v[144:147], a[224:227], v[96:99], v[144:147]
    ds_read_b64_tr_b16 a[248:249], v4 offset:224
    ds_read_b128 v[16:19], v9 offset:10496
    v_mfma_f32_16x16x32_bf16 v[144:147], a[228:231], v[100:103], v[144:147]
    ds_read_b64_tr_b16 a[250:251], v4 offset:736
    ds_read_b64_tr_b16 a[252:253], v4 offset:17120
    v_mfma_f32_16x16x32_bf16 v[176:179], a[224:227], v[104:107], v[176:179]
    s_add_u32 m0, s44, 20064
    ds_read_b64_tr_b16 a[254:255], v4 offset:17632
    ds_read_b128 v[20:23], v9 offset:10528
    v_mfma_f32_16x16x32_bf16 v[176:179], a[228:231], v[108:111], v[176:179]
    s_mov_b32 s45, 1859584
    s_waitcnt lgkmcnt(10)
    buffer_load_dwordx4 v6, s[24:27], s45 offen lds
    v_mfma_f32_16x16x32_bf16 v[148:151], a[232:235], v[96:99], v[148:151]
    ds_read_b64_tr_b16 a[192:193], v4 offset:256
    v_fma_mix_f32 v32, v114, v24, v28 op_sel:[0,0,0] op_sel_hi:[1,0,0]
    v_mfma_f32_16x16x32_bf16 v[148:151], a[236:239], v[100:103], v[148:151]
    ds_read_b64_tr_b16 a[194:195], v4 offset:768
    v_fma_mix_f32 v33, v114, v25, v29 op_sel:[1,0,0] op_sel_hi:[1,0,0]
    v_mfma_f32_16x16x32_bf16 v[180:183], a[232:235], v[104:107], v[180:183]
    ds_read_b64_tr_b16 a[196:197], v4 offset:17152
    v_fma_mix_f32 v34, v115, v26, v30 op_sel:[0,0,0] op_sel_hi:[1,0,0]
    v_mfma_f32_16x16x32_bf16 v[180:183], a[236:239], v[108:111], v[180:183]
    s_waitcnt lgkmcnt(9)
    ds_read_b64_tr_b16 a[198:199], v4 offset:17664
    v_fma_mix_f32 v35, v115, v27, v31 op_sel:[1,0,0] op_sel_hi:[1,0,0]
    v_mfma_f32_16x16x32_bf16 v[152:155], a[240:243], v[96:99], v[152:155]
    ds_read_b64_tr_b16 a[200:201], v4 offset:288
    v_cvt_pk_bf16_f32 v114, v32, v33
    v_mfma_f32_16x16x32_bf16 v[152:155], a[244:247], v[100:103], v[152:155]
    ds_read_b64_tr_b16 a[202:203], v4 offset:800
    v_cvt_pk_bf16_f32 v115, v34, v35
    v_mfma_f32_16x16x32_bf16 v[184:187], a[240:243], v[104:107], v[184:187]
    ds_read_b64_tr_b16 a[204:205], v4 offset:17184
    v_fma_mix_f32 v36, v122, v24, v28 op_sel:[0,0,0] op_sel_hi:[1,0,0]
    v_mfma_f32_16x16x32_bf16 v[184:187], a[244:247], v[108:111], v[184:187]
    s_waitcnt lgkmcnt(8)
    ds_read_b64_tr_b16 a[206:207], v4 offset:17696
    v_fma_mix_f32 v37, v122, v25, v29 op_sel:[1,0,0] op_sel_hi:[1,0,0]
    v_mfma_f32_16x16x32_bf16 v[156:159], a[248:251], v[96:99], v[156:159]
    ds_read_b64_tr_b16 a[208:209], v4 offset:320
    v_fma_mix_f32 v38, v123, v26, v30 op_sel:[0,0,0] op_sel_hi:[1,0,0]
    v_mfma_f32_16x16x32_bf16 v[156:159], a[252:255], v[100:103], v[156:159]
    ds_read_b64_tr_b16 a[210:211], v4 offset:832
    v_fma_mix_f32 v39, v123, v27, v31 op_sel:[1,0,0] op_sel_hi:[1,0,0]
    v_mfma_f32_16x16x32_bf16 v[188:191], a[248:251], v[104:107], v[188:191]
    ds_read_b64_tr_b16 a[212:213], v4 offset:17216
    v_cvt_pk_bf16_f32 v122, v36, v37
    v_mfma_f32_16x16x32_bf16 v[188:191], a[252:255], v[108:111], v[188:191]
    s_waitcnt lgkmcnt(7)
    ds_read_b64_tr_b16 a[214:215], v4 offset:17728
    v_cvt_pk_bf16_f32 v123, v38, v39
    v_mfma_f32_16x16x32_bf16 v[192:195], a[192:195], v[96:99], v[192:195]
    ds_read_b64_tr_b16 a[216:217], v4 offset:352
    ds_read_b128 v[24:27], v9 offset:10512
    v_mfma_f32_16x16x32_bf16 v[192:195], a[196:199], v[100:103], v[192:195]
    ds_read_b64_tr_b16 a[218:219], v4 offset:864
    ds_read_b64_tr_b16 a[220:221], v4 offset:17248
    v_fma_mix_f32 v32, v116, v16, v20 op_sel:[0,0,0] op_sel_hi:[1,0,0]
    v_mfma_f32_16x16x32_bf16 v[224:227], a[192:195], v[104:107], v[224:227]
    s_mov_b32 s54, 8192
    ds_read_b64_tr_b16 a[222:223], v4 offset:17760
    ds_read_b128 v[28:31], v9 offset:10544
    v_mfma_f32_16x16x32_bf16 v[224:227], a[196:199], v[108:111], v[224:227]
    s_waitcnt lgkmcnt(10)
    buffer_load_dwordx4 v[64:67], v8, s[32:35], s54 offen sc1
    v_mfma_f32_16x16x32_bf16 v[196:199], a[200:203], v[96:99], v[196:199]
    ds_read_b64_tr_b16 a[224:225], v4 offset:384
    v_fma_mix_f32 v33, v116, v17, v21 op_sel:[1,0,0] op_sel_hi:[1,0,0]
    v_mfma_f32_16x16x32_bf16 v[196:199], a[204:207], v[100:103], v[196:199]
    ds_read_b64_tr_b16 a[226:227], v4 offset:896
    ds_read_b64_tr_b16 a[228:229], v4 offset:17280
    v_fma_mix_f32 v34, v117, v18, v22 op_sel:[0,0,0] op_sel_hi:[1,0,0]
    v_mfma_f32_16x16x32_bf16 v[228:231], a[200:203], v[104:107], v[228:231]
    s_mov_b32 s54, 9216
    ds_read_b64_tr_b16 a[230:231], v4 offset:17792
    v_fma_mix_f32 v35, v117, v19, v23 op_sel:[1,0,0] op_sel_hi:[1,0,0]
    v_mfma_f32_16x16x32_bf16 v[228:231], a[204:207], v[108:111], v[228:231]
    s_waitcnt lgkmcnt(10)
    buffer_load_dwordx4 v[68:71], v8, s[32:35], s54 offen sc1
    v_mfma_f32_16x16x32_bf16 v[200:203], a[208:211], v[96:99], v[200:203]
    ds_read_b64_tr_b16 a[232:233], v4 offset:416
    v_cvt_pk_bf16_f32 v116, v32, v33
    v_mfma_f32_16x16x32_bf16 v[200:203], a[212:215], v[100:103], v[200:203]
    ds_read_b64_tr_b16 a[234:235], v4 offset:928
    ds_read_b64_tr_b16 a[236:237], v4 offset:17312
    v_cvt_pk_bf16_f32 v117, v34, v35
    v_mfma_f32_16x16x32_bf16 v[232:235], a[208:211], v[104:107], v[232:235]
    s_mov_b32 s54, 26624
    ds_read_b64_tr_b16 a[238:239], v4 offset:17824
    v_fma_mix_f32 v36, v124, v16, v20 op_sel:[0,0,0] op_sel_hi:[1,0,0]
    v_mfma_f32_16x16x32_bf16 v[232:235], a[212:215], v[108:111], v[232:235]
    s_waitcnt lgkmcnt(9)
    buffer_load_dwordx4 v[72:75], v8, s[32:35], s54 offen sc1
    v_fma_mix_f32 v37, v124, v17, v21 op_sel:[1,0,0] op_sel_hi:[1,0,0]
    v_mfma_f32_16x16x32_bf16 v[204:207], a[216:219], v[96:99], v[204:207]
L2_pad0:
    s_cbranch_execz L2_pad4
    ds_read_b64_tr_b16 a[240:241], v4 offset:448
    v_fma_mix_f32 v38, v125, v18, v22 op_sel:[0,0,0] op_sel_hi:[1,0,0]
    v_mfma_f32_16x16x32_bf16 v[204:207], a[220:223], v[100:103], v[204:207]
    ds_read_b64_tr_b16 a[242:243], v4 offset:960
    ds_read_b64_tr_b16 a[244:245], v4 offset:17344
    v_fma_mix_f32 v39, v125, v19, v23 op_sel:[1,0,0] op_sel_hi:[1,0,0]
    v_mfma_f32_16x16x32_bf16 v[236:239], a[216:219], v[104:107], v[236:239]
    s_mov_b32 s54, 27648
    ds_read_b64_tr_b16 a[246:247], v4 offset:17856
    v_cvt_pk_bf16_f32 v124, v36, v37
    v_mfma_f32_16x16x32_bf16 v[236:239], a[220:223], v[108:111], v[236:239]
    s_waitcnt lgkmcnt(8)
    buffer_load_dwordx4 v[76:79], v8, s[32:35], s54 offen sc1
    v_cvt_pk_bf16_f32 v125, v38, v39
    v_mfma_f32_16x16x32_bf16 v[208:211], a[224:227], v[96:99], v[208:211]
    ds_read_b64_tr_b16 a[248:249], v4 offset:480
    ds_read_b128 v[16:19], v9 offset:10752
    v_mfma_f32_16x16x32_bf16 v[208:211], a[228:231], v[100:103], v[208:211]
    ds_read_b64_tr_b16 a[250:251], v4 offset:992
    ds_read_b128 v[20:23], v9 offset:10784
    v_mfma_f32_16x16x32_bf16 v[240:243], a[224:227], v[104:107], v[240:243]
    ds_read_b64_tr_b16 a[252:253], v4 offset:17376
    v_fma_mix_f32 v32, v118, v24, v28 op_sel:[0,0,0] op_sel_hi:[1,0,0]
    v_mfma_f32_16x16x32_bf16 v[240:243], a[228:231], v[108:111], v[240:243]
    s_waitcnt vmcnt(16)
    s_barrier
    s_waitcnt lgkmcnt(9)
    ds_read_b64_tr_b16 a[254:255], v4 offset:17888
    v_fma_mix_f32 v33, v118, v25, v29 op_sel:[1,0,0] op_sel_hi:[1,0,0]
    v_fma_mix_f32 v34, v119, v26, v30 op_sel:[0,0,0] op_sel_hi:[1,0,0]
    v_mfma_f32_16x16x32_bf16 v[212:215], a[232:235], v[96:99], v[212:215]
    ds_read_b64_tr_b16 a[192:193], v4 offset:36864
    v_fma_mix_f32 v35, v119, v27, v31 op_sel:[1,0,0] op_sel_hi:[1,0,0]
    v_mfma_f32_16x16x32_bf16 v[212:215], a[236:239], v[100:103], v[212:215]
    ds_read_b64_tr_b16 a[194:195], v4 offset:37376
    ds_read_b64_tr_b16 a[196:197], v4 offset:53760
    v_cvt_pk_bf16_f32 v118, v32, v33
    v_mfma_f32_16x16x32_bf16 v[244:247], a[232:235], v[104:107], v[244:247]
    s_add_u32 m0, s44, 36864
    ds_read_b64_tr_b16 a[198:199], v4 offset:54272
    v_cvt_pk_bf16_f32 v119, v34, v35
    v_mfma_f32_16x16x32_bf16 v[244:247], a[236:239], v[108:111], v[244:247]
    s_mov_b32 s45, 2097152
    s_waitcnt lgkmcnt(10)
    buffer_load_dwordx4 v6, s[24:27], s45 offen lds
    v_mfma_f32_16x16x32_bf16 v[216:219], a[240:243], v[96:99], v[216:219]
    ds_read_b64_tr_b16 a[200:201], v4 offset:36896
    v_fma_mix_f32 v36, v126, v24, v28 op_sel:[0,0,0] op_sel_hi:[1,0,0]
    v_mfma_f32_16x16x32_bf16 v[216:219], a[244:247], v[100:103], v[216:219]
    ds_read_b64_tr_b16 a[202:203], v4 offset:37408
    ds_read_b64_tr_b16 a[204:205], v4 offset:53792
    v_fma_mix_f32 v37, v126, v25, v29 op_sel:[1,0,0] op_sel_hi:[1,0,0]
    v_mfma_f32_16x16x32_bf16 v[248:251], a[240:243], v[104:107], v[248:251]
    s_add_u32 m0, s44, 37920
    ds_read_b64_tr_b16 a[206:207], v4 offset:54304
    v_fma_mix_f32 v38, v127, v26, v30 op_sel:[0,0,0] op_sel_hi:[1,0,0]
    v_mfma_f32_16x16x32_bf16 v[248:251], a[244:247], v[108:111], v[248:251]
    s_mov_b32 s45, 2105344
    s_waitcnt lgkmcnt(8)
    buffer_load_dwordx4 v6, s[24:27], s45 offen lds
    v_mfma_f32_16x16x32_bf16 v[220:223], a[248:251], v[96:99], v[220:223]
    ds_read_b64_tr_b16 a[208:209], v4 offset:36928
    v_fma_mix_f32 v39, v127, v27, v31 op_sel:[1,0,0] op_sel_hi:[1,0,0]
    v_mfma_f32_16x16x32_bf16 v[220:223], a[252:255], v[100:103], v[220:223]
    ds_read_b64_tr_b16 a[210:211], v4 offset:37440
    ds_read_b64_tr_b16 a[212:213], v4 offset:53824
    v_cvt_pk_bf16_f32 v126, v36, v37
    v_mfma_f32_16x16x32_bf16 v[252:255], a[248:251], v[104:107], v[252:255]
    s_add_u32 m0, s44, 38976
    ds_read_b64_tr_b16 a[214:215], v4 offset:54336
    v_cvt_pk_bf16_f32 v127, v38, v39
    v_mfma_f32_16x16x32_bf16 v[252:255], a[252:255], v[108:111], v[252:255]
    s_mov_b32 s45, 2113536
    s_waitcnt lgkmcnt(8)
    buffer_load_dwordx4 v6, s[24:27], s45 offen lds
    v_mfma_f32_16x16x32_bf16 v[128:131], a[192:195], v[112:115], v[128:131]
    s_waitcnt vmcnt(15)
    ds_read_b64_tr_b16 a[216:217], v4 offset:36960
    ds_read_b128 v[24:27], v9 offset:10768
    v_mfma_f32_16x16x32_bf16 v[128:131], a[196:199], v[116:119], v[128:131]
    ds_read_b64_tr_b16 a[218:219], v4 offset:37472
    ds_read_b64_tr_b16 a[220:221], v4 offset:53856
    v_fma_mix_f32 v32, v48, v16, v20 op_sel:[0,0,0] op_sel_hi:[1,0,0]
    v_mfma_f32_16x16x32_bf16 v[160:163], a[192:195], v[120:123], v[160:163]
    s_add_u32 m0, s44, 40032
    ds_read_b64_tr_b16 a[222:223], v4 offset:54368
    ds_read_b128 v[28:31], v9 offset:10800
    v_mfma_f32_16x16x32_bf16 v[160:163], a[196:199], v[124:127], v[160:163]
    s_mov_b32 s45, 2121728
    s_waitcnt lgkmcnt(10)
    buffer_load_dwordx4 v6, s[24:27], s45 offen lds
    v_mfma_f32_16x16x32_bf16 v[132:135], a[200:203], v[112:115], v[132:135]
    ds_read_b64_tr_b16 a[224:225], v4 offset:36992
    v_fma_mix_f32 v33, v48, v17, v21 op_sel:[1,0,0] op_sel_hi:[1,0,0]
    v_mfma_f32_16x16x32_bf16 v[132:135], a[204:207], v[116:119], v[132:135]
    ds_read_b64_tr_b16 a[226:227], v4 offset:37504
    ds_read_b64_tr_b16 a[228:229], v4 offset:53888
    v_fma_mix_f32 v34, v49, v18, v22 op_sel:[0,0,0] op_sel_hi:[1,0,0]
    v_mfma_f32_16x16x32_bf16 v[164:167], a[200:203], v[120:123], v[164:167]
    s_add_u32 m0, s44, 53760
    ds_read_b64_tr_b16 a[230:231], v4 offset:54400
    v_fma_mix_f32 v35, v49, v19, v23 op_sel:[1,0,0] op_sel_hi:[1,0,0]
    v_mfma_f32_16x16x32_bf16 v[164:167], a[204:207], v[124:127], v[164:167]
    s_mov_b32 s45, 2359296
    s_waitcnt lgkmcnt(10)
    buffer_load_dwordx4 v6, s[24:27], s45 offen lds
    v_mfma_f32_16x16x32_bf16 v[136:139], a[208:211], v[112:115], v[136:139]
    ds_read_b64_tr_b16 a[232:233], v4 offset:37024
    v_cvt_pk_bf16_f32 v48, v32, v33
    v_mfma_f32_16x16x32_bf16 v[136:139], a[212:215], v[116:119], v[136:139]
    ds_read_b64_tr_b16 a[234:235], v4 offset:37536
    ds_read_b64_tr_b16 a[236:237], v4 offset:53920
    v_cvt_pk_bf16_f32 v49, v34, v35
    v_mfma_f32_16x16x32_bf16 v[168:171], a[208:211], v[120:123], v[168:171]
    s_add_u32 m0, s44, 54816
    ds_read_b64_tr_b16 a[238:239], v4 offset:54432
    v_fma_mix_f32 v36, v56, v16, v20 op_sel:[0,0,0] op_sel_hi:[1,0,0]
    v_mfma_f32_16x16x32_bf16 v[168:171], a[212:215], v[124:127], v[168:171]
    s_mov_b32 s45, 2367488
    s_waitcnt lgkmcnt(9)
    buffer_load_dwordx4 v6, s[24:27], s45 offen lds
    v_fma_mix_f32 v37, v56, v17, v21 op_sel:[1,0,0] op_sel_hi:[1,0,0]
    v_mfma_f32_16x16x32_bf16 v[140:143], a[216:219], v[112:115], v[140:143]
    ds_read_b64_tr_b16 a[240:241], v4 offset:37056
    v_fma_mix_f32 v38, v57, v18, v22 op_sel:[0,0,0] op_sel_hi:[1,0,0]
    v_mfma_f32_16x16x32_bf16 v[140:143], a[220:223], v[116:119], v[140:143]
    ds_read_b64_tr_b16 a[242:243], v4 offset:37568
    ds_read_b64_tr_b16 a[244:245], v4 offset:53952
    v_fma_mix_f32 v39, v57, v19, v23 op_sel:[1,0,0] op_sel_hi:[1,0,0]
    v_mfma_f32_16x16x32_bf16 v[172:175], a[216:219], v[120:123], v[172:175]
    s_add_u32 m0, s44, 55872
    ds_read_b64_tr_b16 a[246:247], v4 offset:54464
    v_cvt_pk_bf16_f32 v56, v36, v37
    v_mfma_f32_16x16x32_bf16 v[172:175], a[220:223], v[124:127], v[172:175]
    s_mov_b32 s45, 2375680
    s_waitcnt lgkmcnt(8)
    buffer_load_dwordx4 v6, s[24:27], s45 offen lds
    v_cvt_pk_bf16_f32 v57, v38, v39
    v_mfma_f32_16x16x32_bf16 v[144:147], a[224:227], v[112:115], v[144:147]
    ds_read_b64_tr_b16 a[248:249], v4 offset:37088
    ds_read_b128 v[16:19], v9 offset:11008
    v_mfma_f32_16x16x32_bf16 v[144:147], a[228:231], v[116:119], v[144:147]
    ds_read_b64_tr_b16 a[250:251], v4 offset:37600
    ds_read_b64_tr_b16 a[252:253], v4 offset:53984
    v_mfma_f32_16x16x32_bf16 v[176:179], a[224:227], v[120:123], v[176:179]
    s_add_u32 m0, s44, 56928
    ds_read_b64_tr_b16 a[254:255], v4 offset:54496
    ds_read_b128 v[20:23], v9 offset:11040
    v_mfma_f32_16x16x32_bf16 v[176:179], a[228:231], v[124:127], v[176:179]
    s_mov_b32 s45, 2383872
    s_waitcnt lgkmcnt(10)
    buffer_load_dwordx4 v6, s[24:27], s45 offen lds
    v_mfma_f32_16x16x32_bf16 v[148:151], a[232:235], v[112:115], v[148:151]
    ds_read_b64_tr_b16 a[192:193], v4 offset:37120
    v_fma_mix_f32 v32, v50, v24, v28 op_sel:[0,0,0] op_sel_hi:[1,0,0]
    v_mfma_f32_16x16x32_bf16 v[148:151], a[236:239], v[116:119], v[148:151]
    ds_read_b64_tr_b16 a[194:195], v4 offset:37632
    v_fma_mix_f32 v33, v50, v25, v29 op_sel:[1,0,0] op_sel_hi:[1,0,0]
    v_mfma_f32_16x16x32_bf16 v[180:183], a[232:235], v[120:123], v[180:183]
    ds_read_b64_tr_b16 a[196:197], v4 offset:54016
    v_fma_mix_f32 v34, v51, v26, v30 op_sel:[0,0,0] op_sel_hi:[1,0,0]
    v_mfma_f32_16x16x32_bf16 v[180:183], a[236:239], v[124:127], v[180:183]
    s_waitcnt lgkmcnt(9)
    ds_read_b64_tr_b16 a[198:199], v4 offset:54528
    v_fma_mix_f32 v35, v51, v27, v31 op_sel:[1,0,0] op_sel_hi:[1,0,0]
    v_mfma_f32_16x16x32_bf16 v[152:155], a[240:243], v[112:115], v[152:155]
    ds_read_b64_tr_b16 a[200:201], v4 offset:37152
    v_cvt_pk_bf16_f32 v50, v32, v33
    v_mfma_f32_16x16x32_bf16 v[152:155], a[244:247], v[116:119], v[152:155]
    ds_read_b64_tr_b16 a[202:203], v4 offset:37664
    v_cvt_pk_bf16_f32 v51, v34, v35
    v_mfma_f32_16x16x32_bf16 v[184:187], a[240:243], v[120:123], v[184:187]
    ds_read_b64_tr_b16 a[204:205], v4 offset:54048
    v_fma_mix_f32 v36, v58, v24, v28 op_sel:[0,0,0] op_sel_hi:[1,0,0]
    v_mfma_f32_16x16x32_bf16 v[184:187], a[244:247], v[124:127], v[184:187]
    s_waitcnt lgkmcnt(8)
    ds_read_b64_tr_b16 a[206:207], v4 offset:54560
    v_fma_mix_f32 v37, v58, v25, v29 op_sel:[1,0,0] op_sel_hi:[1,0,0]
    v_mfma_f32_16x16x32_bf16 v[156:159], a[248:251], v[112:115], v[156:159]
    ds_read_b64_tr_b16 a[208:209], v4 offset:37184
    v_fma_mix_f32 v38, v59, v26, v30 op_sel:[0,0,0] op_sel_hi:[1,0,0]
    v_mfma_f32_16x16x32_bf16 v[156:159], a[252:255], v[116:119], v[156:159]
    ds_read_b64_tr_b16 a[210:211], v4 offset:37696
    v_fma_mix_f32 v39, v59, v27, v31 op_sel:[1,0,0] op_sel_hi:[1,0,0]
    v_mfma_f32_16x16x32_bf16 v[188:191], a[248:251], v[120:123], v[188:191]
    ds_read_b64_tr_b16 a[212:213], v4 offset:54080
    v_cvt_pk_bf16_f32 v58, v36, v37
    v_mfma_f32_16x16x32_bf16 v[188:191], a[252:255], v[124:127], v[188:191]
    s_waitcnt lgkmcnt(7)
    ds_read_b64_tr_b16 a[214:215], v4 offset:54592
    v_cvt_pk_bf16_f32 v59, v38, v39
    v_mfma_f32_16x16x32_bf16 v[192:195], a[192:195], v[112:115], v[192:195]
    ds_read_b64_tr_b16 a[216:217], v4 offset:37216
    ds_read_b128 v[24:27], v9 offset:11024
    v_mfma_f32_16x16x32_bf16 v[192:195], a[196:199], v[116:119], v[192:195]
    ds_read_b64_tr_b16 a[218:219], v4 offset:37728
    ds_read_b64_tr_b16 a[220:221], v4 offset:54112
    v_fma_mix_f32 v32, v52, v16, v20 op_sel:[0,0,0] op_sel_hi:[1,0,0]
    v_mfma_f32_16x16x32_bf16 v[224:227], a[192:195], v[120:123], v[224:227]
    s_mov_b32 s54, 10240
    ds_read_b64_tr_b16 a[222:223], v4 offset:54624
    ds_read_b128 v[28:31], v9 offset:11056
    v_mfma_f32_16x16x32_bf16 v[224:227], a[196:199], v[124:127], v[224:227]
    s_waitcnt lgkmcnt(10)
    buffer_load_dwordx4 v[80:83], v8, s[32:35], s54 offen sc1
    v_mfma_f32_16x16x32_bf16 v[196:199], a[200:203], v[112:115], v[196:199]
    ds_read_b64_tr_b16 a[224:225], v4 offset:37248
    v_fma_mix_f32 v33, v52, v17, v21 op_sel:[1,0,0] op_sel_hi:[1,0,0]
    v_mfma_f32_16x16x32_bf16 v[196:199], a[204:207], v[116:119], v[196:199]
    ds_read_b64_tr_b16 a[226:227], v4 offset:37760
    ds_read_b64_tr_b16 a[228:229], v4 offset:54144
    v_fma_mix_f32 v34, v53, v18, v22 op_sel:[0,0,0] op_sel_hi:[1,0,0]
    v_mfma_f32_16x16x32_bf16 v[228:231], a[200:203], v[120:123], v[228:231]
    s_mov_b32 s54, 11264
    ds_read_b64_tr_b16 a[230:231], v4 offset:54656
    v_fma_mix_f32 v35, v53, v19, v23 op_sel:[1,0,0] op_sel_hi:[1,0,0]
    v_mfma_f32_16x16x32_bf16 v[228:231], a[204:207], v[124:127], v[228:231]
    s_waitcnt lgkmcnt(10)
    buffer_load_dwordx4 v[84:87], v8, s[32:35], s54 offen sc1
    v_mfma_f32_16x16x32_bf16 v[200:203], a[208:211], v[112:115], v[200:203]
    ds_read_b64_tr_b16 a[232:233], v4 offset:37280
    v_cvt_pk_bf16_f32 v52, v32, v33
    v_mfma_f32_16x16x32_bf16 v[200:203], a[212:215], v[116:119], v[200:203]
    ds_read_b64_tr_b16 a[234:235], v4 offset:37792
    ds_read_b64_tr_b16 a[236:237], v4 offset:54176
    v_cvt_pk_bf16_f32 v53, v34, v35
    v_mfma_f32_16x16x32_bf16 v[232:235], a[208:211], v[120:123], v[232:235]
    s_mov_b32 s54, 28672
    ds_read_b64_tr_b16 a[238:239], v4 offset:54688
    v_fma_mix_f32 v36, v60, v16, v20 op_sel:[0,0,0] op_sel_hi:[1,0,0]
    v_mfma_f32_16x16x32_bf16 v[232:235], a[212:215], v[124:127], v[232:235]
    s_waitcnt lgkmcnt(9)
    buffer_load_dwordx4 v[88:91], v8, s[32:35], s54 offen sc1
    v_fma_mix_f32 v37, v60, v17, v21 op_sel:[1,0,0] op_sel_hi:[1,0,0]
    v_mfma_f32_16x16x32_bf16 v[204:207], a[216:219], v[112:115], v[204:207]
    ds_read_b64_tr_b16 a[240:241], v4 offset:37312
    v_fma_mix_f32 v38, v61, v18, v22 op_sel:[0,0,0] op_sel_hi:[1,0,0]
    v_mfma_f32_16x16x32_bf16 v[204:207], a[220:223], v[116:119], v[204:207]
    ds_read_b64_tr_b16 a[242:243], v4 offset:37824
    ds_read_b64_tr_b16 a[244:245], v4 offset:54208
    v_fma_mix_f32 v39, v61, v19, v23 op_sel:[1,0,0] op_sel_hi:[1,0,0]
    v_mfma_f32_16x16x32_bf16 v[236:239], a[216:219], v[120:123], v[236:239]
    s_mov_b32 s54, 29696
    ds_read_b64_tr_b16 a[246:247], v4 offset:54720
    v_cvt_pk_bf16_f32 v60, v36, v37
    v_mfma_f32_16x16x32_bf16 v[236:239], a[220:223], v[124:127], v[236:239]
    s_waitcnt lgkmcnt(8)
    buffer_load_dwordx4 v[92:95], v8, s[32:35], s54 offen sc1
    v_cvt_pk_bf16_f32 v61, v38, v39
    v_mfma_f32_16x16x32_bf16 v[208:211], a[224:227], v[112:115], v[208:211]
    ds_read_b64_tr_b16 a[248:249], v4 offset:37344
    ds_read_b128 v[16:19], v9 offset:11264
    v_mfma_f32_16x16x32_bf16 v[208:211], a[228:231], v[116:119], v[208:211]
    ds_read_b64_tr_b16 a[250:251], v4 offset:37856
    ds_read_b128 v[20:23], v9 offset:11296
    v_mfma_f32_16x16x32_bf16 v[240:243], a[224:227], v[120:123], v[240:243]
    ds_read_b64_tr_b16 a[252:253], v4 offset:54240
    v_fma_mix_f32 v32, v54, v24, v28 op_sel:[0,0,0] op_sel_hi:[1,0,0]
    v_mfma_f32_16x16x32_bf16 v[240:243], a[228:231], v[124:127], v[240:243]
    s_waitcnt vmcnt(16)
    s_barrier
    s_waitcnt lgkmcnt(9)
    ds_read_b64_tr_b16 a[254:255], v4 offset:54752
    v_fma_mix_f32 v33, v54, v25, v29 op_sel:[1,0,0] op_sel_hi:[1,0,0]
    v_fma_mix_f32 v34, v55, v26, v30 op_sel:[0,0,0] op_sel_hi:[1,0,0]
    v_mfma_f32_16x16x32_bf16 v[212:215], a[232:235], v[112:115], v[212:215]
    ds_read_b64_tr_b16 a[192:193], v3 offset:0
    v_fma_mix_f32 v35, v55, v27, v31 op_sel:[1,0,0] op_sel_hi:[1,0,0]
    v_mfma_f32_16x16x32_bf16 v[212:215], a[236:239], v[116:119], v[212:215]
    ds_read_b64_tr_b16 a[194:195], v3 offset:512
    ds_read_b64_tr_b16 a[196:197], v3 offset:16896
    v_cvt_pk_bf16_f32 v54, v32, v33
    v_mfma_f32_16x16x32_bf16 v[244:247], a[232:235], v[120:123], v[244:247]
    s_add_u32 m0, s44, 73728
    ds_read_b64_tr_b16 a[198:199], v3 offset:17408
    v_cvt_pk_bf16_f32 v55, v34, v35
    v_mfma_f32_16x16x32_bf16 v[244:247], a[236:239], v[124:127], v[244:247]
    s_mov_b32 s45, 2621440
    s_waitcnt lgkmcnt(10)
    buffer_load_dwordx4 v6, s[24:27], s45 offen lds
    v_mfma_f32_16x16x32_bf16 v[216:219], a[240:243], v[112:115], v[216:219]
    ds_read_b64_tr_b16 a[200:201], v3 offset:32
    v_fma_mix_f32 v36, v62, v24, v28 op_sel:[0,0,0] op_sel_hi:[1,0,0]
    v_mfma_f32_16x16x32_bf16 v[216:219], a[244:247], v[116:119], v[216:219]
    ds_read_b64_tr_b16 a[202:203], v3 offset:544
    ds_read_b64_tr_b16 a[204:205], v3 offset:16928
    v_fma_mix_f32 v37, v62, v25, v29 op_sel:[1,0,0] op_sel_hi:[1,0,0]
    v_mfma_f32_16x16x32_bf16 v[248:251], a[240:243], v[120:123], v[248:251]
    s_add_u32 m0, s44, 74784
    ds_read_b64_tr_b16 a[206:207], v3 offset:17440
    v_fma_mix_f32 v38, v63, v26, v30 op_sel:[0,0,0] op_sel_hi:[1,0,0]
    v_mfma_f32_16x16x32_bf16 v[248:251], a[244:247], v[124:127], v[248:251]
    s_mov_b32 s45, 2629632
    s_waitcnt lgkmcnt(8)
    buffer_load_dwordx4 v6, s[24:27], s45 offen lds
    v_mfma_f32_16x16x32_bf16 v[220:223], a[248:251], v[112:115], v[220:223]
    ds_read_b64_tr_b16 a[208:209], v3 offset:64
    v_fma_mix_f32 v39, v63, v27, v31 op_sel:[1,0,0] op_sel_hi:[1,0,0]
    v_mfma_f32_16x16x32_bf16 v[220:223], a[252:255], v[116:119], v[220:223]
    ds_read_b64_tr_b16 a[210:211], v3 offset:576
    ds_read_b64_tr_b16 a[212:213], v3 offset:16960
    v_cvt_pk_bf16_f32 v62, v36, v37
    v_mfma_f32_16x16x32_bf16 v[252:255], a[248:251], v[120:123], v[252:255]
    s_add_u32 m0, s44, 75840
    ds_read_b64_tr_b16 a[214:215], v3 offset:17472
    v_cvt_pk_bf16_f32 v63, v38, v39
    v_mfma_f32_16x16x32_bf16 v[252:255], a[252:255], v[124:127], v[252:255]
    s_mov_b32 s45, 2637824
    s_waitcnt lgkmcnt(8)
    buffer_load_dwordx4 v6, s[24:27], s45 offen lds
    v_mfma_f32_16x16x32_bf16 v[128:131], a[192:195], v[48:51], v[128:131]
    s_waitcnt vmcnt(15)
    ds_read_b64_tr_b16 a[216:217], v3 offset:96
    ds_read_b128 v[24:27], v9 offset:11280
    v_mfma_f32_16x16x32_bf16 v[128:131], a[196:199], v[52:55], v[128:131]
    ds_read_b64_tr_b16 a[218:219], v3 offset:608
    ds_read_b64_tr_b16 a[220:221], v3 offset:16992
    v_fma_mix_f32 v32, v64, v16, v20 op_sel:[0,0,0] op_sel_hi:[1,0,0]
    v_mfma_f32_16x16x32_bf16 v[160:163], a[192:195], v[56:59], v[160:163]
    s_add_u32 m0, s44, 76896
    ds_read_b64_tr_b16 a[222:223], v3 offset:17504
    ds_read_b128 v[28:31], v9 offset:11312
    v_mfma_f32_16x16x32_bf16 v[160:163], a[196:199], v[60:63], v[160:163]
    s_mov_b32 s45, 2646016
    s_waitcnt lgkmcnt(10)
    buffer_load_dwordx4 v6, s[24:27], s45 offen lds
    v_mfma_f32_16x16x32_bf16 v[132:135], a[200:203], v[48:51], v[132:135]
    ds_read_b64_tr_b16 a[224:225], v3 offset:128
    v_fma_mix_f32 v33, v64, v17, v21 op_sel:[1,0,0] op_sel_hi:[1,0,0]
    v_mfma_f32_16x16x32_bf16 v[132:135], a[204:207], v[52:55], v[132:135]
    ds_read_b64_tr_b16 a[226:227], v3 offset:640
    ds_read_b64_tr_b16 a[228:229], v3 offset:17024
    v_fma_mix_f32 v34, v65, v18, v22 op_sel:[0,0,0] op_sel_hi:[1,0,0]
    v_mfma_f32_16x16x32_bf16 v[164:167], a[200:203], v[56:59], v[164:167]
    s_add_u32 m0, s44, 90624
    ds_read_b64_tr_b16 a[230:231], v3 offset:17536
    v_fma_mix_f32 v35, v65, v19, v23 op_sel:[1,0,0] op_sel_hi:[1,0,0]
    v_mfma_f32_16x16x32_bf16 v[164:167], a[204:207], v[60:63], v[164:167]
    s_mov_b32 s45, 2883584
    s_waitcnt lgkmcnt(10)
    buffer_load_dwordx4 v6, s[24:27], s45 offen lds
    v_mfma_f32_16x16x32_bf16 v[136:139], a[208:211], v[48:51], v[136:139]
    ds_read_b64_tr_b16 a[232:233], v3 offset:160
    v_cvt_pk_bf16_f32 v64, v32, v33
    v_mfma_f32_16x16x32_bf16 v[136:139], a[212:215], v[52:55], v[136:139]
    ds_read_b64_tr_b16 a[234:235], v3 offset:672
    ds_read_b64_tr_b16 a[236:237], v3 offset:17056
    v_cvt_pk_bf16_f32 v65, v34, v35
    v_mfma_f32_16x16x32_bf16 v[168:171], a[208:211], v[56:59], v[168:171]
    s_add_u32 m0, s44, 91680
    ds_read_b64_tr_b16 a[238:239], v3 offset:17568
    v_fma_mix_f32 v36, v72, v16, v20 op_sel:[0,0,0] op_sel_hi:[1,0,0]
    v_mfma_f32_16x16x32_bf16 v[168:171], a[212:215], v[60:63], v[168:171]
    s_mov_b32 s45, 2891776
    s_waitcnt lgkmcnt(9)
    buffer_load_dwordx4 v6, s[24:27], s45 offen lds
    v_fma_mix_f32 v37, v72, v17, v21 op_sel:[1,0,0] op_sel_hi:[1,0,0]
    v_mfma_f32_16x16x32_bf16 v[140:143], a[216:219], v[48:51], v[140:143]
    ds_read_b64_tr_b16 a[240:241], v3 offset:192
    v_fma_mix_f32 v38, v73, v18, v22 op_sel:[0,0,0] op_sel_hi:[1,0,0]
    v_mfma_f32_16x16x32_bf16 v[140:143], a[220:223], v[52:55], v[140:143]
    ds_read_b64_tr_b16 a[242:243], v3 offset:704
    ds_read_b64_tr_b16 a[244:245], v3 offset:17088
    v_fma_mix_f32 v39, v73, v19, v23 op_sel:[1,0,0] op_sel_hi:[1,0,0]
    v_mfma_f32_16x16x32_bf16 v[172:175], a[216:219], v[56:59], v[172:175]
    s_add_u32 m0, s44, 92736
    ds_read_b64_tr_b16 a[246:247], v3 offset:17600
    v_cvt_pk_bf16_f32 v72, v36, v37
    v_mfma_f32_16x16x32_bf16 v[172:175], a[220:223], v[60:63], v[172:175]
    s_mov_b32 s45, 2899968
    s_waitcnt lgkmcnt(8)
    buffer_load_dwordx4 v6, s[24:27], s45 offen lds
    v_cvt_pk_bf16_f32 v73, v38, v39
    v_mfma_f32_16x16x32_bf16 v[144:147], a[224:227], v[48:51], v[144:147]
    ds_read_b64_tr_b16 a[248:249], v3 offset:224
    ds_read_b128 v[16:19], v9 offset:11520
    v_mfma_f32_16x16x32_bf16 v[144:147], a[228:231], v[52:55], v[144:147]
    ds_read_b64_tr_b16 a[250:251], v3 offset:736
    ds_read_b64_tr_b16 a[252:253], v3 offset:17120
    v_mfma_f32_16x16x32_bf16 v[176:179], a[224:227], v[56:59], v[176:179]
    s_add_u32 m0, s44, 93792
    ds_read_b64_tr_b16 a[254:255], v3 offset:17632
    ds_read_b128 v[20:23], v9 offset:11552
    v_mfma_f32_16x16x32_bf16 v[176:179], a[228:231], v[60:63], v[176:179]
    s_mov_b32 s45, 2908160
    s_waitcnt lgkmcnt(10)
    buffer_load_dwordx4 v6, s[24:27], s45 offen lds
    v_mfma_f32_16x16x32_bf16 v[148:151], a[232:235], v[48:51], v[148:151]
    ds_read_b64_tr_b16 a[192:193], v3 offset:256
    v_fma_mix_f32 v32, v66, v24, v28 op_sel:[0,0,0] op_sel_hi:[1,0,0]
    v_mfma_f32_16x16x32_bf16 v[148:151], a[236:239], v[52:55], v[148:151]
    ds_read_b64_tr_b16 a[194:195], v3 offset:768
    v_fma_mix_f32 v33, v66, v25, v29 op_sel:[1,0,0] op_sel_hi:[1,0,0]
    v_mfma_f32_16x16x32_bf16 v[180:183], a[232:235], v[56:59], v[180:183]
    ds_read_b64_tr_b16 a[196:197], v3 offset:17152
    v_fma_mix_f32 v34, v67, v26, v30 op_sel:[0,0,0] op_sel_hi:[1,0,0]
    v_mfma_f32_16x16x32_bf16 v[180:183], a[236:239], v[60:63], v[180:183]
    s_waitcnt lgkmcnt(9)
    ds_read_b64_tr_b16 a[198:199], v3 offset:17664
    v_fma_mix_f32 v35, v67, v27, v31 op_sel:[1,0,0] op_sel_hi:[1,0,0]
    v_mfma_f32_16x16x32_bf16 v[152:155], a[240:243], v[48:51], v[152:155]
    ds_read_b64_tr_b16 a[200:201], v3 offset:288
    v_cvt_pk_bf16_f32 v66, v32, v33
    v_mfma_f32_16x16x32_bf16 v[152:155], a[244:247], v[52:55], v[152:155]
    ds_read_b64_tr_b16 a[202:203], v3 offset:800
    v_cvt_pk_bf16_f32 v67, v34, v35
    v_mfma_f32_16x16x32_bf16 v[184:187], a[240:243], v[56:59], v[184:187]
    ds_read_b64_tr_b16 a[204:205], v3 offset:17184
    v_fma_mix_f32 v36, v74, v24, v28 op_sel:[0,0,0] op_sel_hi:[1,0,0]
    v_mfma_f32_16x16x32_bf16 v[184:187], a[244:247], v[60:63], v[184:187]
    s_waitcnt lgkmcnt(8)
    ds_read_b64_tr_b16 a[206:207], v3 offset:17696
    v_fma_mix_f32 v37, v74, v25, v29 op_sel:[1,0,0] op_sel_hi:[1,0,0]
    v_mfma_f32_16x16x32_bf16 v[156:159], a[248:251], v[48:51], v[156:159]
    ds_read_b64_tr_b16 a[208:209], v3 offset:320
    v_fma_mix_f32 v38, v75, v26, v30 op_sel:[0,0,0] op_sel_hi:[1,0,0]
    v_mfma_f32_16x16x32_bf16 v[156:159], a[252:255], v[52:55], v[156:159]
    ds_read_b64_tr_b16 a[210:211], v3 offset:832
    v_fma_mix_f32 v39, v75, v27, v31 op_sel:[1,0,0] op_sel_hi:[1,0,0]
    v_mfma_f32_16x16x32_bf16 v[188:191], a[248:251], v[56:59], v[188:191]
    ds_read_b64_tr_b16 a[212:213], v3 offset:17216
    v_cvt_pk_bf16_f32 v74, v36, v37
    v_mfma_f32_16x16x32_bf16 v[188:191], a[252:255], v[60:63], v[188:191]
    s_waitcnt lgkmcnt(7)
    ds_read_b64_tr_b16 a[214:215], v3 offset:17728
    v_cvt_pk_bf16_f32 v75, v38, v39
    v_mfma_f32_16x16x32_bf16 v[192:195], a[192:195], v[48:51], v[192:195]
    ds_read_b64_tr_b16 a[216:217], v3 offset:352
    ds_read_b128 v[24:27], v9 offset:11536
    v_mfma_f32_16x16x32_bf16 v[192:195], a[196:199], v[52:55], v[192:195]
    ds_read_b64_tr_b16 a[218:219], v3 offset:864
    ds_read_b64_tr_b16 a[220:221], v3 offset:17248
    v_fma_mix_f32 v32, v68, v16, v20 op_sel:[0,0,0] op_sel_hi:[1,0,0]
    v_mfma_f32_16x16x32_bf16 v[224:227], a[192:195], v[56:59], v[224:227]
    s_mov_b32 s54, 12288
    ds_read_b64_tr_b16 a[222:223], v3 offset:17760
    ds_read_b128 v[28:31], v9 offset:11568
    v_mfma_f32_16x16x32_bf16 v[224:227], a[196:199], v[60:63], v[224:227]
    s_waitcnt lgkmcnt(10)
    buffer_load_dwordx4 v[96:99], v8, s[32:35], s54 offen sc1
    v_mfma_f32_16x16x32_bf16 v[196:199], a[200:203], v[48:51], v[196:199]
    ds_read_b64_tr_b16 a[224:225], v3 offset:384
    v_fma_mix_f32 v33, v68, v17, v21 op_sel:[1,0,0] op_sel_hi:[1,0,0]
    v_mfma_f32_16x16x32_bf16 v[196:199], a[204:207], v[52:55], v[196:199]
    ds_read_b64_tr_b16 a[226:227], v3 offset:896
    ds_read_b64_tr_b16 a[228:229], v3 offset:17280
    v_fma_mix_f32 v34, v69, v18, v22 op_sel:[0,0,0] op_sel_hi:[1,0,0]
    v_mfma_f32_16x16x32_bf16 v[228:231], a[200:203], v[56:59], v[228:231]
    s_mov_b32 s54, 13312
    ds_read_b64_tr_b16 a[230:231], v3 offset:17792
    v_fma_mix_f32 v35, v69, v19, v23 op_sel:[1,0,0] op_sel_hi:[1,0,0]
    v_mfma_f32_16x16x32_bf16 v[228:231], a[204:207], v[60:63], v[228:231]
    s_waitcnt lgkmcnt(10)
    buffer_load_dwordx4 v[100:103], v8, s[32:35], s54 offen sc1
    v_mfma_f32_16x16x32_bf16 v[200:203], a[208:211], v[48:51], v[200:203]
    ds_read_b64_tr_b16 a[232:233], v3 offset:416
    v_cvt_pk_bf16_f32 v68, v32, v33
    v_mfma_f32_16x16x32_bf16 v[200:203], a[212:215], v[52:55], v[200:203]
    ds_read_b64_tr_b16 a[234:235], v3 offset:928
    ds_read_b64_tr_b16 a[236:237], v3 offset:17312
    v_cvt_pk_bf16_f32 v69, v34, v35
    v_mfma_f32_16x16x32_bf16 v[232:235], a[208:211], v[56:59], v[232:235]
    s_mov_b32 s54, 30720
    ds_read_b64_tr_b16 a[238:239], v3 offset:17824
    v_fma_mix_f32 v36, v76, v16, v20 op_sel:[0,0,0] op_sel_hi:[1,0,0]
    v_mfma_f32_16x16x32_bf16 v[232:235], a[212:215], v[60:63], v[232:235]
    s_waitcnt lgkmcnt(9)
    buffer_load_dwordx4 v[104:107], v8, s[32:35], s54 offen sc1
    v_fma_mix_f32 v37, v76, v17, v21 op_sel:[1,0,0] op_sel_hi:[1,0,0]
    v_mfma_f32_16x16x32_bf16 v[204:207], a[216:219], v[48:51], v[204:207]
    ds_read_b64_tr_b16 a[240:241], v3 offset:448
    v_fma_mix_f32 v38, v77, v18, v22 op_sel:[0,0,0] op_sel_hi:[1,0,0]
    v_mfma_f32_16x16x32_bf16 v[204:207], a[220:223], v[52:55], v[204:207]
    ds_read_b64_tr_b16 a[242:243], v3 offset:960
    ds_read_b64_tr_b16 a[244:245], v3 offset:17344
    v_fma_mix_f32 v39, v77, v19, v23 op_sel:[1,0,0] op_sel_hi:[1,0,0]
    v_mfma_f32_16x16x32_bf16 v[236:239], a[216:219], v[56:59], v[236:239]
    s_mov_b32 s54, 31744
    ds_read_b64_tr_b16 a[246:247], v3 offset:17856
    v_cvt_pk_bf16_f32 v76, v36, v37
    v_mfma_f32_16x16x32_bf16 v[236:239], a[220:223], v[60:63], v[236:239]
    s_waitcnt lgkmcnt(8)
    buffer_load_dwordx4 v[108:111], v8, s[32:35], s54 offen sc1
    v_cvt_pk_bf16_f32 v77, v38, v39
    v_mfma_f32_16x16x32_bf16 v[208:211], a[224:227], v[48:51], v[208:211]
    ds_read_b64_tr_b16 a[248:249], v3 offset:480
    ds_read_b128 v[16:19], v9 offset:11776
    v_mfma_f32_16x16x32_bf16 v[208:211], a[228:231], v[52:55], v[208:211]
    ds_read_b64_tr_b16 a[250:251], v3 offset:992
    ds_read_b128 v[20:23], v9 offset:11808
    v_mfma_f32_16x16x32_bf16 v[240:243], a[224:227], v[56:59], v[240:243]
    ds_read_b64_tr_b16 a[252:253], v3 offset:17376
    v_fma_mix_f32 v32, v70, v24, v28 op_sel:[0,0,0] op_sel_hi:[1,0,0]
    v_mfma_f32_16x16x32_bf16 v[240:243], a[228:231], v[60:63], v[240:243]
    s_waitcnt vmcnt(16)
    s_barrier
    s_waitcnt lgkmcnt(9)
    ds_read_b64_tr_b16 a[254:255], v3 offset:17888
    v_fma_mix_f32 v33, v70, v25, v29 op_sel:[1,0,0] op_sel_hi:[1,0,0]
    v_fma_mix_f32 v34, v71, v26, v30 op_sel:[0,0,0] op_sel_hi:[1,0,0]
    v_mfma_f32_16x16x32_bf16 v[212:215], a[232:235], v[48:51], v[212:215]
    ds_read_b64_tr_b16 a[192:193], v3 offset:36864
    v_fma_mix_f32 v35, v71, v27, v31 op_sel:[1,0,0] op_sel_hi:[1,0,0]
    v_mfma_f32_16x16x32_bf16 v[212:215], a[236:239], v[52:55], v[212:215]
    ds_read_b64_tr_b16 a[194:195], v3 offset:37376
    ds_read_b64_tr_b16 a[196:197], v3 offset:53760
    v_cvt_pk_bf16_f32 v70, v32, v33
    v_mfma_f32_16x16x32_bf16 v[244:247], a[232:235], v[56:59], v[244:247]
    s_add_u32 m0, s44, 110592
    ds_read_b64_tr_b16 a[198:199], v3 offset:54272
    v_cvt_pk_bf16_f32 v71, v34, v35
    v_mfma_f32_16x16x32_bf16 v[244:247], a[236:239], v[60:63], v[244:247]
    s_mov_b32 s45, 3145728
    s_waitcnt lgkmcnt(10)
    buffer_load_dwordx4 v6, s[24:27], s45 offen lds
    v_mfma_f32_16x16x32_bf16 v[216:219], a[240:243], v[48:51], v[216:219]
    ds_read_b64_tr_b16 a[200:201], v3 offset:36896
    v_fma_mix_f32 v36, v78, v24, v28 op_sel:[0,0,0] op_sel_hi:[1,0,0]
    v_mfma_f32_16x16x32_bf16 v[216:219], a[244:247], v[52:55], v[216:219]
    ds_read_b64_tr_b16 a[202:203], v3 offset:37408
    ds_read_b64_tr_b16 a[204:205], v3 offset:53792
    v_fma_mix_f32 v37, v78, v25, v29 op_sel:[1,0,0] op_sel_hi:[1,0,0]
    v_mfma_f32_16x16x32_bf16 v[248:251], a[240:243], v[56:59], v[248:251]
    s_add_u32 m0, s44, 111648
    ds_read_b64_tr_b16 a[206:207], v3 offset:54304
    v_fma_mix_f32 v38, v79, v26, v30 op_sel:[0,0,0] op_sel_hi:[1,0,0]
    v_mfma_f32_16x16x32_bf16 v[248:251], a[244:247], v[60:63], v[248:251]
    s_mov_b32 s45, 3153920
    s_waitcnt lgkmcnt(8)
    buffer_load_dwordx4 v6, s[24:27], s45 offen lds
    v_mfma_f32_16x16x32_bf16 v[220:223], a[248:251], v[48:51], v[220:223]
L2_pad1:
    s_cbranch_execz L2_pad5
    ds_read_b64_tr_b16 a[208:209], v3 offset:36928
    v_fma_mix_f32 v39, v79, v27, v31 op_sel:[1,0,0] op_sel_hi:[1,0,0]
    v_mfma_f32_16x16x32_bf16 v[220:223], a[252:255], v[52:55], v[220:223]
    ds_read_b64_tr_b16 a[210:211], v3 offset:37440
    ds_read_b64_tr_b16 a[212:213], v3 offset:53824
    v_cvt_pk_bf16_f32 v78, v36, v37
    v_mfma_f32_16x16x32_bf16 v[252:255], a[248:251], v[56:59], v[252:255]
    s_add_u32 m0, s44, 112704
    ds_read_b64_tr_b16 a[214:215], v3 offset:54336
    v_cvt_pk_bf16_f32 v79, v38, v39
    v_mfma_f32_16x16x32_bf16 v[252:255], a[252:255], v[60:63], v[252:255]
    s_mov_b32 s45, 3162112
    s_waitcnt lgkmcnt(8)
    buffer_load_dwordx4 v6, s[24:27], s45 offen lds
    v_mfma_f32_16x16x32_bf16 v[128:131], a[192:195], v[64:67], v[128:131]
    s_waitcnt vmcnt(15)
    ds_read_b64_tr_b16 a[216:217], v3 offset:36960
    ds_read_b128 v[24:27], v9 offset:11792
    v_mfma_f32_16x16x32_bf16 v[128:131], a[196:199], v[68:71], v[128:131]
    ds_read_b64_tr_b16 a[218:219], v3 offset:37472
    ds_read_b64_tr_b16 a[220:221], v3 offset:53856
    v_fma_mix_f32 v32, v80, v16, v20 op_sel:[0,0,0] op_sel_hi:[1,0,0]
    v_mfma_f32_16x16x32_bf16 v[160:163], a[192:195], v[72:75], v[160:163]
    s_add_u32 m0, s44, 113760
    ds_read_b64_tr_b16 a[222:223], v3 offset:54368
    ds_read_b128 v[28:31], v9 offset:11824
    v_mfma_f32_16x16x32_bf16 v[160:163], a[196:199], v[76:79], v[160:163]
    s_mov_b32 s45, 3170304
    s_waitcnt lgkmcnt(10)
    buffer_load_dwordx4 v6, s[24:27], s45 offen lds
    v_mfma_f32_16x16x32_bf16 v[132:135], a[200:203], v[64:67], v[132:135]
    ds_read_b64_tr_b16 a[224:225], v3 offset:36992
    v_fma_mix_f32 v33, v80, v17, v21 op_sel:[1,0,0] op_sel_hi:[1,0,0]
    v_mfma_f32_16x16x32_bf16 v[132:135], a[204:207], v[68:71], v[132:135]
    ds_read_b64_tr_b16 a[226:227], v3 offset:37504
    ds_read_b64_tr_b16 a[228:229], v3 offset:53888
    v_fma_mix_f32 v34, v81, v18, v22 op_sel:[0,0,0] op_sel_hi:[1,0,0]
    v_mfma_f32_16x16x32_bf16 v[164:167], a[200:203], v[72:75], v[164:167]
    s_add_u32 m0, s44, 127488
    ds_read_b64_tr_b16 a[230:231], v3 offset:54400
    v_fma_mix_f32 v35, v81, v19, v23 op_sel:[1,0,0] op_sel_hi:[1,0,0]
    v_mfma_f32_16x16x32_bf16 v[164:167], a[204:207], v[76:79], v[164:167]
    s_mov_b32 s45, 3407872
    s_waitcnt lgkmcnt(10)
    buffer_load_dwordx4 v6, s[24:27], s45 offen lds
    v_mfma_f32_16x16x32_bf16 v[136:139], a[208:211], v[64:67], v[136:139]
    ds_read_b64_tr_b16 a[232:233], v3 offset:37024
    v_cvt_pk_bf16_f32 v80, v32, v33
    v_mfma_f32_16x16x32_bf16 v[136:139], a[212:215], v[68:71], v[136:139]
    ds_read_b64_tr_b16 a[234:235], v3 offset:37536
    ds_read_b64_tr_b16 a[236:237], v3 offset:53920
    v_cvt_pk_bf16_f32 v81, v34, v35
    v_mfma_f32_16x16x32_bf16 v[168:171], a[208:211], v[72:75], v[168:171]
    s_add_u32 m0, s44, 128544
    ds_read_b64_tr_b16 a[238:239], v3 offset:54432
    v_fma_mix_f32 v36, v88, v16, v20 op_sel:[0,0,0] op_sel_hi:[1,0,0]
    v_mfma_f32_16x16x32_bf16 v[168:171], a[212:215], v[76:79], v[168:171]
    s_mov_b32 s45, 3416064
    s_waitcnt lgkmcnt(9)
    buffer_load_dwordx4 v6, s[24:27], s45 offen lds
    v_fma_mix_f32 v37, v88, v17, v21 op_sel:[1,0,0] op_sel_hi:[1,0,0]
    v_mfma_f32_16x16x32_bf16 v[140:143], a[216:219], v[64:67], v[140:143]
    ds_read_b64_tr_b16 a[240:241], v3 offset:37056
    v_fma_mix_f32 v38, v89, v18, v22 op_sel:[0,0,0] op_sel_hi:[1,0,0]
    v_mfma_f32_16x16x32_bf16 v[140:143], a[220:223], v[68:71], v[140:143]
    ds_read_b64_tr_b16 a[242:243], v3 offset:37568
    ds_read_b64_tr_b16 a[244:245], v3 offset:53952
    v_fma_mix_f32 v39, v89, v19, v23 op_sel:[1,0,0] op_sel_hi:[1,0,0]
    v_mfma_f32_16x16x32_bf16 v[172:175], a[216:219], v[72:75], v[172:175]
    s_add_u32 m0, s44, 129600
    ds_read_b64_tr_b16 a[246:247], v3 offset:54464
    v_cvt_pk_bf16_f32 v88, v36, v37
    v_mfma_f32_16x16x32_bf16 v[172:175], a[220:223], v[76:79], v[172:175]
    s_mov_b32 s45, 3424256
    s_waitcnt lgkmcnt(8)
    buffer_load_dwordx4 v6, s[24:27], s45 offen lds
    v_cvt_pk_bf16_f32 v89, v38, v39
    v_mfma_f32_16x16x32_bf16 v[144:147], a[224:227], v[64:67], v[144:147]
    ds_read_b64_tr_b16 a[248:249], v3 offset:37088
    ds_read_b128 v[16:19], v9 offset:12032
    v_mfma_f32_16x16x32_bf16 v[144:147], a[228:231], v[68:71], v[144:147]
    ds_read_b64_tr_b16 a[250:251], v3 offset:37600
    ds_read_b64_tr_b16 a[252:253], v3 offset:53984
    v_mfma_f32_16x16x32_bf16 v[176:179], a[224:227], v[72:75], v[176:179]
    s_add_u32 m0, s44, 130656
    ds_read_b64_tr_b16 a[254:255], v3 offset:54496
    ds_read_b128 v[20:23], v9 offset:12064
    v_mfma_f32_16x16x32_bf16 v[176:179], a[228:231], v[76:79], v[176:179]
    s_mov_b32 s45, 3432448
    s_waitcnt lgkmcnt(10)
    buffer_load_dwordx4 v6, s[24:27], s45 offen lds
    v_mfma_f32_16x16x32_bf16 v[148:151], a[232:235], v[64:67], v[148:151]
    ds_read_b64_tr_b16 a[192:193], v3 offset:37120
    v_fma_mix_f32 v32, v82, v24, v28 op_sel:[0,0,0] op_sel_hi:[1,0,0]
    v_mfma_f32_16x16x32_bf16 v[148:151], a[236:239], v[68:71], v[148:151]
    ds_read_b64_tr_b16 a[194:195], v3 offset:37632
    v_fma_mix_f32 v33, v82, v25, v29 op_sel:[1,0,0] op_sel_hi:[1,0,0]
    v_mfma_f32_16x16x32_bf16 v[180:183], a[232:235], v[72:75], v[180:183]
    ds_read_b64_tr_b16 a[196:197], v3 offset:54016
    v_fma_mix_f32 v34, v83, v26, v30 op_sel:[0,0,0] op_sel_hi:[1,0,0]
    v_mfma_f32_16x16x32_bf16 v[180:183], a[236:239], v[76:79], v[180:183]
    s_waitcnt lgkmcnt(9)
    ds_read_b64_tr_b16 a[198:199], v3 offset:54528
    v_fma_mix_f32 v35, v83, v27, v31 op_sel:[1,0,0] op_sel_hi:[1,0,0]
    v_mfma_f32_16x16x32_bf16 v[152:155], a[240:243], v[64:67], v[152:155]
    ds_read_b64_tr_b16 a[200:201], v3 offset:37152
    v_cvt_pk_bf16_f32 v82, v32, v33
    v_mfma_f32_16x16x32_bf16 v[152:155], a[244:247], v[68:71], v[152:155]
    ds_read_b64_tr_b16 a[202:203], v3 offset:37664
    v_cvt_pk_bf16_f32 v83, v34, v35
    v_mfma_f32_16x16x32_bf16 v[184:187], a[240:243], v[72:75], v[184:187]
    ds_read_b64_tr_b16 a[204:205], v3 offset:54048
    v_fma_mix_f32 v36, v90, v24, v28 op_sel:[0,0,0] op_sel_hi:[1,0,0]
    v_mfma_f32_16x16x32_bf16 v[184:187], a[244:247], v[76:79], v[184:187]
    s_waitcnt lgkmcnt(8)
    ds_read_b64_tr_b16 a[206:207], v3 offset:54560
    v_fma_mix_f32 v37, v90, v25, v29 op_sel:[1,0,0] op_sel_hi:[1,0,0]
    v_mfma_f32_16x16x32_bf16 v[156:159], a[248:251], v[64:67], v[156:159]
    ds_read_b64_tr_b16 a[208:209], v3 offset:37184
    v_fma_mix_f32 v38, v91, v26, v30 op_sel:[0,0,0] op_sel_hi:[1,0,0]
    v_mfma_f32_16x16x32_bf16 v[156:159], a[252:255], v[68:71], v[156:159]
    ds_read_b64_tr_b16 a[210:211], v3 offset:37696
    v_fma_mix_f32 v39, v91, v27, v31 op_sel:[1,0,0] op_sel_hi:[1,0,0]
    v_mfma_f32_16x16x32_bf16 v[188:191], a[248:251], v[72:75], v[188:191]
    ds_read_b64_tr_b16 a[212:213], v3 offset:54080
    v_cvt_pk_bf16_f32 v90, v36, v37
    v_mfma_f32_16x16x32_bf16 v[188:191], a[252:255], v[76:79], v[188:191]
    s_waitcnt lgkmcnt(7)
    ds_read_b64_tr_b16 a[214:215], v3 offset:54592
    v_cvt_pk_bf16_f32 v91, v38, v39
    v_mfma_f32_16x16x32_bf16 v[192:195], a[192:195], v[64:67], v[192:195]
    ds_read_b64_tr_b16 a[216:217], v3 offset:37216
    ds_read_b128 v[24:27], v9 offset:12048
    v_mfma_f32_16x16x32_bf16 v[192:195], a[196:199], v[68:71], v[192:195]
    ds_read_b64_tr_b16 a[218:219], v3 offset:37728
    ds_read_b64_tr_b16 a[220:221], v3 offset:54112
    v_fma_mix_f32 v32, v84, v16, v20 op_sel:[0,0,0] op_sel_hi:[1,0,0]
    v_mfma_f32_16x16x32_bf16 v[224:227], a[192:195], v[72:75], v[224:227]
    s_mov_b32 s54, 14336
    ds_read_b64_tr_b16 a[222:223], v3 offset:54624
    ds_read_b128 v[28:31], v9 offset:12080
    v_mfma_f32_16x16x32_bf16 v[224:227], a[196:199], v[76:79], v[224:227]
    s_waitcnt lgkmcnt(10)
    buffer_load_dwordx4 v[112:115], v8, s[32:35], s54 offen sc1
    v_mfma_f32_16x16x32_bf16 v[196:199], a[200:203], v[64:67], v[196:199]
    ds_read_b64_tr_b16 a[224:225], v3 offset:37248
    v_fma_mix_f32 v33, v84, v17, v21 op_sel:[1,0,0] op_sel_hi:[1,0,0]
    v_mfma_f32_16x16x32_bf16 v[196:199], a[204:207], v[68:71], v[196:199]
    ds_read_b64_tr_b16 a[226:227], v3 offset:37760
    ds_read_b64_tr_b16 a[228:229], v3 offset:54144
    v_fma_mix_f32 v34, v85, v18, v22 op_sel:[0,0,0] op_sel_hi:[1,0,0]
    v_mfma_f32_16x16x32_bf16 v[228:231], a[200:203], v[72:75], v[228:231]
    s_mov_b32 s54, 15360
    ds_read_b64_tr_b16 a[230:231], v3 offset:54656
    v_fma_mix_f32 v35, v85, v19, v23 op_sel:[1,0,0] op_sel_hi:[1,0,0]
    v_mfma_f32_16x16x32_bf16 v[228:231], a[204:207], v[76:79], v[228:231]
    s_waitcnt lgkmcnt(10)
    buffer_load_dwordx4 v[116:119], v8, s[32:35], s54 offen sc1
    v_mfma_f32_16x16x32_bf16 v[200:203], a[208:211], v[64:67], v[200:203]
    ds_read_b64_tr_b16 a[232:233], v3 offset:37280
    v_cvt_pk_bf16_f32 v84, v32, v33
    v_mfma_f32_16x16x32_bf16 v[200:203], a[212:215], v[68:71], v[200:203]
    ds_read_b64_tr_b16 a[234:235], v3 offset:37792
    ds_read_b64_tr_b16 a[236:237], v3 offset:54176
    v_cvt_pk_bf16_f32 v85, v34, v35
    v_mfma_f32_16x16x32_bf16 v[232:235], a[208:211], v[72:75], v[232:235]
    s_mov_b32 s54, 32768
    ds_read_b64_tr_b16 a[238:239], v3 offset:54688
    v_fma_mix_f32 v36, v92, v16, v20 op_sel:[0,0,0] op_sel_hi:[1,0,0]
    v_mfma_f32_16x16x32_bf16 v[232:235], a[212:215], v[76:79], v[232:235]
    s_waitcnt lgkmcnt(9)
    buffer_load_dwordx4 v[120:123], v8, s[32:35], s54 offen sc1
    v_fma_mix_f32 v37, v92, v17, v21 op_sel:[1,0,0] op_sel_hi:[1,0,0]
    v_mfma_f32_16x16x32_bf16 v[204:207], a[216:219], v[64:67], v[204:207]
    ds_read_b64_tr_b16 a[240:241], v3 offset:37312
    v_fma_mix_f32 v38, v93, v18, v22 op_sel:[0,0,0] op_sel_hi:[1,0,0]
    v_mfma_f32_16x16x32_bf16 v[204:207], a[220:223], v[68:71], v[204:207]
    ds_read_b64_tr_b16 a[242:243], v3 offset:37824
    ds_read_b64_tr_b16 a[244:245], v3 offset:54208
    v_fma_mix_f32 v39, v93, v19, v23 op_sel:[1,0,0] op_sel_hi:[1,0,0]
    v_mfma_f32_16x16x32_bf16 v[236:239], a[216:219], v[72:75], v[236:239]
    s_mov_b32 s54, 33792
    ds_read_b64_tr_b16 a[246:247], v3 offset:54720
    v_cvt_pk_bf16_f32 v92, v36, v37
    v_mfma_f32_16x16x32_bf16 v[236:239], a[220:223], v[76:79], v[236:239]
    s_waitcnt lgkmcnt(8)
    buffer_load_dwordx4 v[124:127], v8, s[32:35], s54 offen sc1
    v_cvt_pk_bf16_f32 v93, v38, v39
    v_mfma_f32_16x16x32_bf16 v[208:211], a[224:227], v[64:67], v[208:211]
    ds_read_b64_tr_b16 a[248:249], v3 offset:37344
    ds_read_b128 v[16:19], v9 offset:12288
    v_mfma_f32_16x16x32_bf16 v[208:211], a[228:231], v[68:71], v[208:211]
    ds_read_b64_tr_b16 a[250:251], v3 offset:37856
    ds_read_b128 v[20:23], v9 offset:12320
    v_mfma_f32_16x16x32_bf16 v[240:243], a[224:227], v[72:75], v[240:243]
    ds_read_b64_tr_b16 a[252:253], v3 offset:54240
    v_fma_mix_f32 v32, v86, v24, v28 op_sel:[0,0,0] op_sel_hi:[1,0,0]
    v_mfma_f32_16x16x32_bf16 v[240:243], a[228:231], v[76:79], v[240:243]
    s_waitcnt vmcnt(16)
    s_barrier
    s_waitcnt lgkmcnt(9)
    ds_read_b64_tr_b16 a[254:255], v3 offset:54752
    v_fma_mix_f32 v33, v86, v25, v29 op_sel:[1,0,0] op_sel_hi:[1,0,0]
    v_fma_mix_f32 v34, v87, v26, v30 op_sel:[0,0,0] op_sel_hi:[1,0,0]
    v_mfma_f32_16x16x32_bf16 v[212:215], a[232:235], v[64:67], v[212:215]
    ds_read_b64_tr_b16 a[192:193], v4 offset:0
    v_fma_mix_f32 v35, v87, v27, v31 op_sel:[1,0,0] op_sel_hi:[1,0,0]
    v_mfma_f32_16x16x32_bf16 v[212:215], a[236:239], v[68:71], v[212:215]
    ds_read_b64_tr_b16 a[194:195], v4 offset:512
    ds_read_b64_tr_b16 a[196:197], v4 offset:16896
    v_cvt_pk_bf16_f32 v86, v32, v33
    v_mfma_f32_16x16x32_bf16 v[244:247], a[232:235], v[72:75], v[244:247]
    s_add_u32 m0, s44, 0
    ds_read_b64_tr_b16 a[198:199], v4 offset:17408
    v_cvt_pk_bf16_f32 v87, v34, v35
    v_mfma_f32_16x16x32_bf16 v[244:247], a[236:239], v[76:79], v[244:247]
    s_mov_b32 s45, 3670016
    s_waitcnt lgkmcnt(10)
    buffer_load_dwordx4 v6, s[24:27], s45 offen lds
    v_mfma_f32_16x16x32_bf16 v[216:219], a[240:243], v[64:67], v[216:219]
    ds_read_b64_tr_b16 a[200:201], v4 offset:32
    v_fma_mix_f32 v36, v94, v24, v28 op_sel:[0,0,0] op_sel_hi:[1,0,0]
    v_mfma_f32_16x16x32_bf16 v[216:219], a[244:247], v[68:71], v[216:219]
    ds_read_b64_tr_b16 a[202:203], v4 offset:544
    ds_read_b64_tr_b16 a[204:205], v4 offset:16928
    v_fma_mix_f32 v37, v94, v25, v29 op_sel:[1,0,0] op_sel_hi:[1,0,0]
    v_mfma_f32_16x16x32_bf16 v[248:251], a[240:243], v[72:75], v[248:251]
    s_add_u32 m0, s44, 1056
    ds_read_b64_tr_b16 a[206:207], v4 offset:17440
    v_fma_mix_f32 v38, v95, v26, v30 op_sel:[0,0,0] op_sel_hi:[1,0,0]
    v_mfma_f32_16x16x32_bf16 v[248:251], a[244:247], v[76:79], v[248:251]
    s_mov_b32 s45, 3678208
    s_waitcnt lgkmcnt(8)
    buffer_load_dwordx4 v6, s[24:27], s45 offen lds
    v_mfma_f32_16x16x32_bf16 v[220:223], a[248:251], v[64:67], v[220:223]
    ds_read_b64_tr_b16 a[208:209], v4 offset:64
    v_fma_mix_f32 v39, v95, v27, v31 op_sel:[1,0,0] op_sel_hi:[1,0,0]
    v_mfma_f32_16x16x32_bf16 v[220:223], a[252:255], v[68:71], v[220:223]
    ds_read_b64_tr_b16 a[210:211], v4 offset:576
    ds_read_b64_tr_b16 a[212:213], v4 offset:16960
    v_cvt_pk_bf16_f32 v94, v36, v37
    v_mfma_f32_16x16x32_bf16 v[252:255], a[248:251], v[72:75], v[252:255]
    s_add_u32 m0, s44, 2112
    ds_read_b64_tr_b16 a[214:215], v4 offset:17472
    v_cvt_pk_bf16_f32 v95, v38, v39
    v_mfma_f32_16x16x32_bf16 v[252:255], a[252:255], v[76:79], v[252:255]
    s_mov_b32 s45, 3686400
    s_waitcnt lgkmcnt(8)
    buffer_load_dwordx4 v6, s[24:27], s45 offen lds
    v_mfma_f32_16x16x32_bf16 v[128:131], a[192:195], v[80:83], v[128:131]
    s_waitcnt vmcnt(15)
    ds_read_b64_tr_b16 a[216:217], v4 offset:96
    ds_read_b128 v[24:27], v9 offset:12304
    v_mfma_f32_16x16x32_bf16 v[128:131], a[196:199], v[84:87], v[128:131]
    ds_read_b64_tr_b16 a[218:219], v4 offset:608
    ds_read_b64_tr_b16 a[220:221], v4 offset:16992
    v_fma_mix_f32 v32, v96, v16, v20 op_sel:[0,0,0] op_sel_hi:[1,0,0]
    v_mfma_f32_16x16x32_bf16 v[160:163], a[192:195], v[88:91], v[160:163]
    s_add_u32 m0, s44, 3168
    ds_read_b64_tr_b16 a[222:223], v4 offset:17504
    ds_read_b128 v[28:31], v9 offset:12336
    v_mfma_f32_16x16x32_bf16 v[160:163], a[196:199], v[92:95], v[160:163]
    s_mov_b32 s45, 3694592
    s_waitcnt lgkmcnt(10)
    buffer_load_dwordx4 v6, s[24:27], s45 offen lds
    v_mfma_f32_16x16x32_bf16 v[132:135], a[200:203], v[80:83], v[132:135]
    ds_read_b64_tr_b16 a[224:225], v4 offset:128
    v_fma_mix_f32 v33, v96, v17, v21 op_sel:[1,0,0] op_sel_hi:[1,0,0]
    v_mfma_f32_16x16x32_bf16 v[132:135], a[204:207], v[84:87], v[132:135]
    ds_read_b64_tr_b16 a[226:227], v4 offset:640
    ds_read_b64_tr_b16 a[228:229], v4 offset:17024
    v_fma_mix_f32 v34, v97, v18, v22 op_sel:[0,0,0] op_sel_hi:[1,0,0]
    v_mfma_f32_16x16x32_bf16 v[164:167], a[200:203], v[88:91], v[164:167]
    s_add_u32 m0, s44, 16896
    ds_read_b64_tr_b16 a[230:231], v4 offset:17536
    v_fma_mix_f32 v35, v97, v19, v23 op_sel:[1,0,0] op_sel_hi:[1,0,0]
    v_mfma_f32_16x16x32_bf16 v[164:167], a[204:207], v[92:95], v[164:167]
    s_mov_b32 s45, 3932160
    s_waitcnt lgkmcnt(10)
    buffer_load_dwordx4 v6, s[24:27], s45 offen lds
    v_mfma_f32_16x16x32_bf16 v[136:139], a[208:211], v[80:83], v[136:139]
    ds_read_b64_tr_b16 a[232:233], v4 offset:160
    v_cvt_pk_bf16_f32 v96, v32, v33
    v_mfma_f32_16x16x32_bf16 v[136:139], a[212:215], v[84:87], v[136:139]
    ds_read_b64_tr_b16 a[234:235], v4 offset:672
    ds_read_b64_tr_b16 a[236:237], v4 offset:17056
    v_cvt_pk_bf16_f32 v97, v34, v35
    v_mfma_f32_16x16x32_bf16 v[168:171], a[208:211], v[88:91], v[168:171]
    s_add_u32 m0, s44, 17952
    ds_read_b64_tr_b16 a[238:239], v4 offset:17568
    v_fma_mix_f32 v36, v104, v16, v20 op_sel:[0,0,0] op_sel_hi:[1,0,0]
    v_mfma_f32_16x16x32_bf16 v[168:171], a[212:215], v[92:95], v[168:171]
    s_mov_b32 s45, 3940352
    s_waitcnt lgkmcnt(9)
    buffer_load_dwordx4 v6, s[24:27], s45 offen lds
    v_fma_mix_f32 v37, v104, v17, v21 op_sel:[1,0,0] op_sel_hi:[1,0,0]
    v_mfma_f32_16x16x32_bf16 v[140:143], a[216:219], v[80:83], v[140:143]
    ds_read_b64_tr_b16 a[240:241], v4 offset:192
    v_fma_mix_f32 v38, v105, v18, v22 op_sel:[0,0,0] op_sel_hi:[1,0,0]
    v_mfma_f32_16x16x32_bf16 v[140:143], a[220:223], v[84:87], v[140:143]
    ds_read_b64_tr_b16 a[242:243], v4 offset:704
    ds_read_b64_tr_b16 a[244:245], v4 offset:17088
    v_fma_mix_f32 v39, v105, v19, v23 op_sel:[1,0,0] op_sel_hi:[1,0,0]
    v_mfma_f32_16x16x32_bf16 v[172:175], a[216:219], v[88:91], v[172:175]
    s_add_u32 m0, s44, 19008
    ds_read_b64_tr_b16 a[246:247], v4 offset:17600
    v_cvt_pk_bf16_f32 v104, v36, v37
    v_mfma_f32_16x16x32_bf16 v[172:175], a[220:223], v[92:95], v[172:175]
    s_mov_b32 s45, 3948544
    s_waitcnt lgkmcnt(8)
    buffer_load_dwordx4 v6, s[24:27], s45 offen lds
    v_cvt_pk_bf16_f32 v105, v38, v39
    v_mfma_f32_16x16x32_bf16 v[144:147], a[224:227], v[80:83], v[144:147]
    ds_read_b64_tr_b16 a[248:249], v4 offset:224
    ds_read_b128 v[16:19], v9 offset:12544
    v_mfma_f32_16x16x32_bf16 v[144:147], a[228:231], v[84:87], v[144:147]
    ds_read_b64_tr_b16 a[250:251], v4 offset:736
    ds_read_b64_tr_b16 a[252:253], v4 offset:17120
    v_mfma_f32_16x16x32_bf16 v[176:179], a[224:227], v[88:91], v[176:179]
    s_add_u32 m0, s44, 20064
    ds_read_b64_tr_b16 a[254:255], v4 offset:17632
    ds_read_b128 v[20:23], v9 offset:12576
    v_mfma_f32_16x16x32_bf16 v[176:179], a[228:231], v[92:95], v[176:179]
    s_mov_b32 s45, 3956736
    s_waitcnt lgkmcnt(10)
    buffer_load_dwordx4 v6, s[24:27], s45 offen lds
    v_mfma_f32_16x16x32_bf16 v[148:151], a[232:235], v[80:83], v[148:151]
    ds_read_b64_tr_b16 a[192:193], v4 offset:256
    v_fma_mix_f32 v32, v98, v24, v28 op_sel:[0,0,0] op_sel_hi:[1,0,0]
    v_mfma_f32_16x16x32_bf16 v[148:151], a[236:239], v[84:87], v[148:151]
    ds_read_b64_tr_b16 a[194:195], v4 offset:768
    v_fma_mix_f32 v33, v98, v25, v29 op_sel:[1,0,0] op_sel_hi:[1,0,0]
    v_mfma_f32_16x16x32_bf16 v[180:183], a[232:235], v[88:91], v[180:183]
    ds_read_b64_tr_b16 a[196:197], v4 offset:17152
    v_fma_mix_f32 v34, v99, v26, v30 op_sel:[0,0,0] op_sel_hi:[1,0,0]
    v_mfma_f32_16x16x32_bf16 v[180:183], a[236:239], v[92:95], v[180:183]
    s_waitcnt lgkmcnt(9)
    ds_read_b64_tr_b16 a[198:199], v4 offset:17664
    v_fma_mix_f32 v35, v99, v27, v31 op_sel:[1,0,0] op_sel_hi:[1,0,0]
    v_mfma_f32_16x16x32_bf16 v[152:155], a[240:243], v[80:83], v[152:155]
    ds_read_b64_tr_b16 a[200:201], v4 offset:288
    v_cvt_pk_bf16_f32 v98, v32, v33
    v_mfma_f32_16x16x32_bf16 v[152:155], a[244:247], v[84:87], v[152:155]
    ds_read_b64_tr_b16 a[202:203], v4 offset:800
    v_cvt_pk_bf16_f32 v99, v34, v35
    v_mfma_f32_16x16x32_bf16 v[184:187], a[240:243], v[88:91], v[184:187]
    ds_read_b64_tr_b16 a[204:205], v4 offset:17184
    v_fma_mix_f32 v36, v106, v24, v28 op_sel:[0,0,0] op_sel_hi:[1,0,0]
    v_mfma_f32_16x16x32_bf16 v[184:187], a[244:247], v[92:95], v[184:187]
    s_waitcnt lgkmcnt(8)
    ds_read_b64_tr_b16 a[206:207], v4 offset:17696
    v_fma_mix_f32 v37, v106, v25, v29 op_sel:[1,0,0] op_sel_hi:[1,0,0]
    v_mfma_f32_16x16x32_bf16 v[156:159], a[248:251], v[80:83], v[156:159]
    ds_read_b64_tr_b16 a[208:209], v4 offset:320
    v_fma_mix_f32 v38, v107, v26, v30 op_sel:[0,0,0] op_sel_hi:[1,0,0]
    v_mfma_f32_16x16x32_bf16 v[156:159], a[252:255], v[84:87], v[156:159]
    ds_read_b64_tr_b16 a[210:211], v4 offset:832
    v_fma_mix_f32 v39, v107, v27, v31 op_sel:[1,0,0] op_sel_hi:[1,0,0]
    v_mfma_f32_16x16x32_bf16 v[188:191], a[248:251], v[88:91], v[188:191]
    ds_read_b64_tr_b16 a[212:213], v4 offset:17216
    v_cvt_pk_bf16_f32 v106, v36, v37
    v_mfma_f32_16x16x32_bf16 v[188:191], a[252:255], v[92:95], v[188:191]
    s_waitcnt lgkmcnt(7)
    ds_read_b64_tr_b16 a[214:215], v4 offset:17728
    v_cvt_pk_bf16_f32 v107, v38, v39
    v_mfma_f32_16x16x32_bf16 v[192:195], a[192:195], v[80:83], v[192:195]
    ds_read_b64_tr_b16 a[216:217], v4 offset:352
    ds_read_b128 v[24:27], v9 offset:12560
    v_mfma_f32_16x16x32_bf16 v[192:195], a[196:199], v[84:87], v[192:195]
    ds_read_b64_tr_b16 a[218:219], v4 offset:864
    ds_read_b64_tr_b16 a[220:221], v4 offset:17248
    v_fma_mix_f32 v32, v100, v16, v20 op_sel:[0,0,0] op_sel_hi:[1,0,0]
    v_mfma_f32_16x16x32_bf16 v[224:227], a[192:195], v[88:91], v[224:227]
    s_mov_b32 s54, 16384
    ds_read_b64_tr_b16 a[222:223], v4 offset:17760
    ds_read_b128 v[28:31], v9 offset:12592
    v_mfma_f32_16x16x32_bf16 v[224:227], a[196:199], v[92:95], v[224:227]
    s_waitcnt lgkmcnt(10)
    buffer_load_dwordx4 v[48:51], v8, s[32:35], s54 offen sc1
    v_mfma_f32_16x16x32_bf16 v[196:199], a[200:203], v[80:83], v[196:199]
    ds_read_b64_tr_b16 a[224:225], v4 offset:384
    v_fma_mix_f32 v33, v100, v17, v21 op_sel:[1,0,0] op_sel_hi:[1,0,0]
    v_mfma_f32_16x16x32_bf16 v[196:199], a[204:207], v[84:87], v[196:199]
    ds_read_b64_tr_b16 a[226:227], v4 offset:896
    ds_read_b64_tr_b16 a[228:229], v4 offset:17280
    v_fma_mix_f32 v34, v101, v18, v22 op_sel:[0,0,0] op_sel_hi:[1,0,0]
    v_mfma_f32_16x16x32_bf16 v[228:231], a[200:203], v[88:91], v[228:231]
    s_mov_b32 s54, 17408
    ds_read_b64_tr_b16 a[230:231], v4 offset:17792
    v_fma_mix_f32 v35, v101, v19, v23 op_sel:[1,0,0] op_sel_hi:[1,0,0]
    v_mfma_f32_16x16x32_bf16 v[228:231], a[204:207], v[92:95], v[228:231]
    s_waitcnt lgkmcnt(10)
    buffer_load_dwordx4 v[52:55], v8, s[32:35], s54 offen sc1
    v_mfma_f32_16x16x32_bf16 v[200:203], a[208:211], v[80:83], v[200:203]
    ds_read_b64_tr_b16 a[232:233], v4 offset:416
    v_cvt_pk_bf16_f32 v100, v32, v33
    v_mfma_f32_16x16x32_bf16 v[200:203], a[212:215], v[84:87], v[200:203]
    ds_read_b64_tr_b16 a[234:235], v4 offset:928
    ds_read_b64_tr_b16 a[236:237], v4 offset:17312
    v_cvt_pk_bf16_f32 v101, v34, v35
    v_mfma_f32_16x16x32_bf16 v[232:235], a[208:211], v[88:91], v[232:235]
    s_mov_b32 s54, 34816
    ds_read_b64_tr_b16 a[238:239], v4 offset:17824
    v_fma_mix_f32 v36, v108, v16, v20 op_sel:[0,0,0] op_sel_hi:[1,0,0]
    v_mfma_f32_16x16x32_bf16 v[232:235], a[212:215], v[92:95], v[232:235]
    s_waitcnt lgkmcnt(9)
    buffer_load_dwordx4 v[56:59], v8, s[32:35], s54 offen sc1
    v_fma_mix_f32 v37, v108, v17, v21 op_sel:[1,0,0] op_sel_hi:[1,0,0]
    v_mfma_f32_16x16x32_bf16 v[204:207], a[216:219], v[80:83], v[204:207]
    ds_read_b64_tr_b16 a[240:241], v4 offset:448
    v_fma_mix_f32 v38, v109, v18, v22 op_sel:[0,0,0] op_sel_hi:[1,0,0]
    v_mfma_f32_16x16x32_bf16 v[204:207], a[220:223], v[84:87], v[204:207]
    ds_read_b64_tr_b16 a[242:243], v4 offset:960
    ds_read_b64_tr_b16 a[244:245], v4 offset:17344
    v_fma_mix_f32 v39, v109, v19, v23 op_sel:[1,0,0] op_sel_hi:[1,0,0]
    v_mfma_f32_16x16x32_bf16 v[236:239], a[216:219], v[88:91], v[236:239]
    s_mov_b32 s54, 35840
    ds_read_b64_tr_b16 a[246:247], v4 offset:17856
    v_cvt_pk_bf16_f32 v108, v36, v37
    v_mfma_f32_16x16x32_bf16 v[236:239], a[220:223], v[92:95], v[236:239]
    s_waitcnt lgkmcnt(8)
    buffer_load_dwordx4 v[60:63], v8, s[32:35], s54 offen sc1
    v_cvt_pk_bf16_f32 v109, v38, v39
    v_mfma_f32_16x16x32_bf16 v[208:211], a[224:227], v[80:83], v[208:211]
    ds_read_b64_tr_b16 a[248:249], v4 offset:480
    ds_read_b128 v[16:19], v9 offset:12800
    v_mfma_f32_16x16x32_bf16 v[208:211], a[228:231], v[84:87], v[208:211]
    ds_read_b64_tr_b16 a[250:251], v4 offset:992
    ds_read_b128 v[20:23], v9 offset:12832
    v_mfma_f32_16x16x32_bf16 v[240:243], a[224:227], v[88:91], v[240:243]
    ds_read_b64_tr_b16 a[252:253], v4 offset:17376
    v_fma_mix_f32 v32, v102, v24, v28 op_sel:[0,0,0] op_sel_hi:[1,0,0]
    v_mfma_f32_16x16x32_bf16 v[240:243], a[228:231], v[92:95], v[240:243]
    s_waitcnt vmcnt(16)
    s_barrier
    s_waitcnt lgkmcnt(9)
    ds_read_b64_tr_b16 a[254:255], v4 offset:17888
    v_fma_mix_f32 v33, v102, v25, v29 op_sel:[1,0,0] op_sel_hi:[1,0,0]
    v_fma_mix_f32 v34, v103, v26, v30 op_sel:[0,0,0] op_sel_hi:[1,0,0]
    v_mfma_f32_16x16x32_bf16 v[212:215], a[232:235], v[80:83], v[212:215]
    ds_read_b64_tr_b16 a[192:193], v4 offset:36864
    v_fma_mix_f32 v35, v103, v27, v31 op_sel:[1,0,0] op_sel_hi:[1,0,0]
    v_mfma_f32_16x16x32_bf16 v[212:215], a[236:239], v[84:87], v[212:215]
    ds_read_b64_tr_b16 a[194:195], v4 offset:37376
    ds_read_b64_tr_b16 a[196:197], v4 offset:53760
    v_cvt_pk_bf16_f32 v102, v32, v33
    v_mfma_f32_16x16x32_bf16 v[244:247], a[232:235], v[88:91], v[244:247]
    s_add_u32 m0, s44, 36864
    ds_read_b64_tr_b16 a[198:199], v4 offset:54272
    v_cvt_pk_bf16_f32 v103, v34, v35
    v_mfma_f32_16x16x32_bf16 v[244:247], a[236:239], v[92:95], v[244:247]
    s_mov_b32 s45, 4194304
    s_waitcnt lgkmcnt(10)
    buffer_load_dwordx4 v6, s[24:27], s45 offen lds
    v_mfma_f32_16x16x32_bf16 v[216:219], a[240:243], v[80:83], v[216:219]
    ds_read_b64_tr_b16 a[200:201], v4 offset:36896
    v_fma_mix_f32 v36, v110, v24, v28 op_sel:[0,0,0] op_sel_hi:[1,0,0]
    v_mfma_f32_16x16x32_bf16 v[216:219], a[244:247], v[84:87], v[216:219]
    ds_read_b64_tr_b16 a[202:203], v4 offset:37408
    ds_read_b64_tr_b16 a[204:205], v4 offset:53792
    v_fma_mix_f32 v37, v110, v25, v29 op_sel:[1,0,0] op_sel_hi:[1,0,0]
    v_mfma_f32_16x16x32_bf16 v[248:251], a[240:243], v[88:91], v[248:251]
    s_add_u32 m0, s44, 37920
    ds_read_b64_tr_b16 a[206:207], v4 offset:54304
    v_fma_mix_f32 v38, v111, v26, v30 op_sel:[0,0,0] op_sel_hi:[1,0,0]
    v_mfma_f32_16x16x32_bf16 v[248:251], a[244:247], v[92:95], v[248:251]
    s_mov_b32 s45, 4202496
    s_waitcnt lgkmcnt(8)
    buffer_load_dwordx4 v6, s[24:27], s45 offen lds
    v_mfma_f32_16x16x32_bf16 v[220:223], a[248:251], v[80:83], v[220:223]
    ds_read_b64_tr_b16 a[208:209], v4 offset:36928
    v_fma_mix_f32 v39, v111, v27, v31 op_sel:[1,0,0] op_sel_hi:[1,0,0]
    v_mfma_f32_16x16x32_bf16 v[220:223], a[252:255], v[84:87], v[220:223]
    ds_read_b64_tr_b16 a[210:211], v4 offset:37440
    ds_read_b64_tr_b16 a[212:213], v4 offset:53824
    v_cvt_pk_bf16_f32 v110, v36, v37
    v_mfma_f32_16x16x32_bf16 v[252:255], a[248:251], v[88:91], v[252:255]
    s_add_u32 m0, s44, 38976
    ds_read_b64_tr_b16 a[214:215], v4 offset:54336
    v_cvt_pk_bf16_f32 v111, v38, v39
    v_mfma_f32_16x16x32_bf16 v[252:255], a[252:255], v[92:95], v[252:255]
    s_mov_b32 s45, 4210688
    s_waitcnt lgkmcnt(8)
    buffer_load_dwordx4 v6, s[24:27], s45 offen lds
    v_mfma_f32_16x16x32_bf16 v[128:131], a[192:195], v[96:99], v[128:131]
    s_waitcnt vmcnt(15)
    ds_read_b64_tr_b16 a[216:217], v4 offset:36960
    ds_read_b128 v[24:27], v9 offset:12816
    v_mfma_f32_16x16x32_bf16 v[128:131], a[196:199], v[100:103], v[128:131]
    ds_read_b64_tr_b16 a[218:219], v4 offset:37472
    ds_read_b64_tr_b16 a[220:221], v4 offset:53856
    v_fma_mix_f32 v32, v112, v16, v20 op_sel:[0,0,0] op_sel_hi:[1,0,0]
    v_mfma_f32_16x16x32_bf16 v[160:163], a[192:195], v[104:107], v[160:163]
    s_add_u32 m0, s44, 40032
    ds_read_b64_tr_b16 a[222:223], v4 offset:54368
    ds_read_b128 v[28:31], v9 offset:12848
    v_mfma_f32_16x16x32_bf16 v[160:163], a[196:199], v[108:111], v[160:163]
    s_mov_b32 s45, 4218880
    s_waitcnt lgkmcnt(10)
    buffer_load_dwordx4 v6, s[24:27], s45 offen lds
    v_mfma_f32_16x16x32_bf16 v[132:135], a[200:203], v[96:99], v[132:135]
    ds_read_b64_tr_b16 a[224:225], v4 offset:36992
    v_fma_mix_f32 v33, v112, v17, v21 op_sel:[1,0,0] op_sel_hi:[1,0,0]
    v_mfma_f32_16x16x32_bf16 v[132:135], a[204:207], v[100:103], v[132:135]
    ds_read_b64_tr_b16 a[226:227], v4 offset:37504
    ds_read_b64_tr_b16 a[228:229], v4 offset:53888
    v_fma_mix_f32 v34, v113, v18, v22 op_sel:[0,0,0] op_sel_hi:[1,0,0]
    v_mfma_f32_16x16x32_bf16 v[164:167], a[200:203], v[104:107], v[164:167]
    s_add_u32 m0, s44, 53760
    ds_read_b64_tr_b16 a[230:231], v4 offset:54400
    v_fma_mix_f32 v35, v113, v19, v23 op_sel:[1,0,0] op_sel_hi:[1,0,0]
    v_mfma_f32_16x16x32_bf16 v[164:167], a[204:207], v[108:111], v[164:167]
    s_mov_b32 s45, 4456448
    s_waitcnt lgkmcnt(10)
    buffer_load_dwordx4 v6, s[24:27], s45 offen lds
    v_mfma_f32_16x16x32_bf16 v[136:139], a[208:211], v[96:99], v[136:139]
    ds_read_b64_tr_b16 a[232:233], v4 offset:37024
    v_cvt_pk_bf16_f32 v112, v32, v33
    v_mfma_f32_16x16x32_bf16 v[136:139], a[212:215], v[100:103], v[136:139]
    ds_read_b64_tr_b16 a[234:235], v4 offset:37536
    ds_read_b64_tr_b16 a[236:237], v4 offset:53920
    v_cvt_pk_bf16_f32 v113, v34, v35
    v_mfma_f32_16x16x32_bf16 v[168:171], a[208:211], v[104:107], v[168:171]
    s_add_u32 m0, s44, 54816
    ds_read_b64_tr_b16 a[238:239], v4 offset:54432
    v_fma_mix_f32 v36, v120, v16, v20 op_sel:[0,0,0] op_sel_hi:[1,0,0]
    v_mfma_f32_16x16x32_bf16 v[168:171], a[212:215], v[108:111], v[168:171]
    s_mov_b32 s45, 4464640
    s_waitcnt lgkmcnt(9)
    buffer_load_dwordx4 v6, s[24:27], s45 offen lds
    v_fma_mix_f32 v37, v120, v17, v21 op_sel:[1,0,0] op_sel_hi:[1,0,0]
    v_mfma_f32_16x16x32_bf16 v[140:143], a[216:219], v[96:99], v[140:143]
    ds_read_b64_tr_b16 a[240:241], v4 offset:37056
    v_fma_mix_f32 v38, v121, v18, v22 op_sel:[0,0,0] op_sel_hi:[1,0,0]
    v_mfma_f32_16x16x32_bf16 v[140:143], a[220:223], v[100:103], v[140:143]
L2_pad2:
    s_cbranch_execz L2_pad6
    ds_read_b64_tr_b16 a[242:243], v4 offset:37568
    ds_read_b64_tr_b16 a[244:245], v4 offset:53952
    v_fma_mix_f32 v39, v121, v19, v23 op_sel:[1,0,0] op_sel_hi:[1,0,0]
    v_mfma_f32_16x16x32_bf16 v[172:175], a[216:219], v[104:107], v[172:175]
    s_add_u32 m0, s44, 55872
    ds_read_b64_tr_b16 a[246:247], v4 offset:54464
    v_cvt_pk_bf16_f32 v120, v36, v37
    v_mfma_f32_16x16x32_bf16 v[172:175], a[220:223], v[108:111], v[172:175]
    s_mov_b32 s45, 4472832
    s_waitcnt lgkmcnt(8)
    buffer_load_dwordx4 v6, s[24:27], s45 offen lds
    v_cvt_pk_bf16_f32 v121, v38, v39
    v_mfma_f32_16x16x32_bf16 v[144:147], a[224:227], v[96:99], v[144:147]
    ds_read_b64_tr_b16 a[248:249], v4 offset:37088
    ds_read_b128 v[16:19], v9 offset:13056
    v_mfma_f32_16x16x32_bf16 v[144:147], a[228:231], v[100:103], v[144:147]
    ds_read_b64_tr_b16 a[250:251], v4 offset:37600
    ds_read_b64_tr_b16 a[252:253], v4 offset:53984
    v_mfma_f32_16x16x32_bf16 v[176:179], a[224:227], v[104:107], v[176:179]
    s_add_u32 m0, s44, 56928
    ds_read_b64_tr_b16 a[254:255], v4 offset:54496
    ds_read_b128 v[20:23], v9 offset:13088
    v_mfma_f32_16x16x32_bf16 v[176:179], a[228:231], v[108:111], v[176:179]
    s_mov_b32 s45, 4481024
    s_waitcnt lgkmcnt(10)
    buffer_load_dwordx4 v6, s[24:27], s45 offen lds
    v_mfma_f32_16x16x32_bf16 v[148:151], a[232:235], v[96:99], v[148:151]
    ds_read_b64_tr_b16 a[192:193], v4 offset:37120
    v_fma_mix_f32 v32, v114, v24, v28 op_sel:[0,0,0] op_sel_hi:[1,0,0]
    v_mfma_f32_16x16x32_bf16 v[148:151], a[236:239], v[100:103], v[148:151]
    ds_read_b64_tr_b16 a[194:195], v4 offset:37632
    v_fma_mix_f32 v33, v114, v25, v29 op_sel:[1,0,0] op_sel_hi:[1,0,0]
    v_mfma_f32_16x16x32_bf16 v[180:183], a[232:235], v[104:107], v[180:183]
    ds_read_b64_tr_b16 a[196:197], v4 offset:54016
    v_fma_mix_f32 v34, v115, v26, v30 op_sel:[0,0,0] op_sel_hi:[1,0,0]
    v_mfma_f32_16x16x32_bf16 v[180:183], a[236:239], v[108:111], v[180:183]
    s_waitcnt lgkmcnt(9)
    ds_read_b64_tr_b16 a[198:199], v4 offset:54528
    v_fma_mix_f32 v35, v115, v27, v31 op_sel:[1,0,0] op_sel_hi:[1,0,0]
    v_mfma_f32_16x16x32_bf16 v[152:155], a[240:243], v[96:99], v[152:155]
    ds_read_b64_tr_b16 a[200:201], v4 offset:37152
    v_cvt_pk_bf16_f32 v114, v32, v33
    v_mfma_f32_16x16x32_bf16 v[152:155], a[244:247], v[100:103], v[152:155]
    ds_read_b64_tr_b16 a[202:203], v4 offset:37664
    v_cvt_pk_bf16_f32 v115, v34, v35
    v_mfma_f32_16x16x32_bf16 v[184:187], a[240:243], v[104:107], v[184:187]
    ds_read_b64_tr_b16 a[204:205], v4 offset:54048
    v_fma_mix_f32 v36, v122, v24, v28 op_sel:[0,0,0] op_sel_hi:[1,0,0]
    v_mfma_f32_16x16x32_bf16 v[184:187], a[244:247], v[108:111], v[184:187]
    s_waitcnt lgkmcnt(8)
    ds_read_b64_tr_b16 a[206:207], v4 offset:54560
    v_fma_mix_f32 v37, v122, v25, v29 op_sel:[1,0,0] op_sel_hi:[1,0,0]
    v_mfma_f32_16x16x32_bf16 v[156:159], a[248:251], v[96:99], v[156:159]
    ds_read_b64_tr_b16 a[208:209], v4 offset:37184
    v_fma_mix_f32 v38, v123, v26, v30 op_sel:[0,0,0] op_sel_hi:[1,0,0]
    v_mfma_f32_16x16x32_bf16 v[156:159], a[252:255], v[100:103], v[156:159]
    ds_read_b64_tr_b16 a[210:211], v4 offset:37696
    v_fma_mix_f32 v39, v123, v27, v31 op_sel:[1,0,0] op_sel_hi:[1,0,0]
    v_mfma_f32_16x16x32_bf16 v[188:191], a[248:251], v[104:107], v[188:191]
    ds_read_b64_tr_b16 a[212:213], v4 offset:54080
    v_cvt_pk_bf16_f32 v122, v36, v37
    v_mfma_f32_16x16x32_bf16 v[188:191], a[252:255], v[108:111], v[188:191]
    s_waitcnt lgkmcnt(7)
    ds_read_b64_tr_b16 a[214:215], v4 offset:54592
    v_cvt_pk_bf16_f32 v123, v38, v39
    v_mfma_f32_16x16x32_bf16 v[192:195], a[192:195], v[96:99], v[192:195]
    ds_read_b64_tr_b16 a[216:217], v4 offset:37216
    ds_read_b128 v[24:27], v9 offset:13072
    v_mfma_f32_16x16x32_bf16 v[192:195], a[196:199], v[100:103], v[192:195]
    ds_read_b64_tr_b16 a[218:219], v4 offset:37728
    ds_read_b128 v[28:31], v9 offset:13104
    v_mfma_f32_16x16x32_bf16 v[224:227], a[192:195], v[104:107], v[224:227]
    ds_read_b64_tr_b16 a[220:221], v4 offset:54112
    v_fma_mix_f32 v32, v116, v16, v20 op_sel:[0,0,0] op_sel_hi:[1,0,0]
    v_mfma_f32_16x16x32_bf16 v[224:227], a[196:199], v[108:111], v[224:227]
    s_waitcnt lgkmcnt(9)
    ds_read_b64_tr_b16 a[222:223], v4 offset:54624
    v_fma_mix_f32 v33, v116, v17, v21 op_sel:[1,0,0] op_sel_hi:[1,0,0]
    v_mfma_f32_16x16x32_bf16 v[196:199], a[200:203], v[96:99], v[196:199]
    ds_read_b64_tr_b16 a[224:225], v4 offset:37248
    v_fma_mix_f32 v34, v117, v18, v22 op_sel:[0,0,0] op_sel_hi:[1,0,0]
    v_mfma_f32_16x16x32_bf16 v[196:199], a[204:207], v[100:103], v[196:199]
    ds_read_b64_tr_b16 a[226:227], v4 offset:37760
    v_fma_mix_f32 v35, v117, v19, v23 op_sel:[1,0,0] op_sel_hi:[1,0,0]
    v_mfma_f32_16x16x32_bf16 v[228:231], a[200:203], v[104:107], v[228:231]
    ds_read_b64_tr_b16 a[228:229], v4 offset:54144
    v_cvt_pk_bf16_f32 v116, v32, v33
    v_mfma_f32_16x16x32_bf16 v[228:231], a[204:207], v[108:111], v[228:231]
    s_waitcnt lgkmcnt(9)
    ds_read_b64_tr_b16 a[230:231], v4 offset:54656
    v_cvt_pk_bf16_f32 v117, v34, v35
    v_mfma_f32_16x16x32_bf16 v[200:203], a[208:211], v[96:99], v[200:203]
    ds_read_b64_tr_b16 a[232:233], v4 offset:37280
    v_fma_mix_f32 v36, v124, v16, v20 op_sel:[0,0,0] op_sel_hi:[1,0,0]
    v_mfma_f32_16x16x32_bf16 v[200:203], a[212:215], v[100:103], v[200:203]
    ds_read_b64_tr_b16 a[234:235], v4 offset:37792
    v_fma_mix_f32 v37, v124, v17, v21 op_sel:[1,0,0] op_sel_hi:[1,0,0]
    v_mfma_f32_16x16x32_bf16 v[232:235], a[208:211], v[104:107], v[232:235]
    ds_read_b64_tr_b16 a[236:237], v4 offset:54176
    v_fma_mix_f32 v38, v125, v18, v22 op_sel:[0,0,0] op_sel_hi:[1,0,0]
    v_mfma_f32_16x16x32_bf16 v[232:235], a[212:215], v[108:111], v[232:235]
    s_waitcnt lgkmcnt(7)
    ds_read_b64_tr_b16 a[238:239], v4 offset:54688
    v_fma_mix_f32 v39, v125, v19, v23 op_sel:[1,0,0] op_sel_hi:[1,0,0]
    v_mfma_f32_16x16x32_bf16 v[204:207], a[216:219], v[96:99], v[204:207]
    ds_read_b64_tr_b16 a[240:241], v4 offset:37312
    v_cvt_pk_bf16_f32 v124, v36, v37
    v_mfma_f32_16x16x32_bf16 v[204:207], a[220:223], v[100:103], v[204:207]
    ds_read_b64_tr_b16 a[242:243], v4 offset:37824
    v_cvt_pk_bf16_f32 v125, v38, v39
    v_mfma_f32_16x16x32_bf16 v[236:239], a[216:219], v[104:107], v[236:239]
    ds_read_b64_tr_b16 a[244:245], v4 offset:54208
    v_mfma_f32_16x16x32_bf16 v[236:239], a[220:223], v[108:111], v[236:239]
    s_waitcnt lgkmcnt(7)
    ds_read_b64_tr_b16 a[246:247], v4 offset:54720
    v_mfma_f32_16x16x32_bf16 v[208:211], a[224:227], v[96:99], v[208:211]
    ds_read_b64_tr_b16 a[248:249], v4 offset:37344
    ds_read_b128 v[16:19], v9 offset:13312
    v_mfma_f32_16x16x32_bf16 v[208:211], a[228:231], v[100:103], v[208:211]
    ds_read_b64_tr_b16 a[250:251], v4 offset:37856
    ds_read_b128 v[20:23], v9 offset:13344
    v_mfma_f32_16x16x32_bf16 v[240:243], a[224:227], v[104:107], v[240:243]
    ds_read_b64_tr_b16 a[252:253], v4 offset:54240
    v_fma_mix_f32 v32, v118, v24, v28 op_sel:[0,0,0] op_sel_hi:[1,0,0]
    v_mfma_f32_16x16x32_bf16 v[240:243], a[228:231], v[108:111], v[240:243]
    s_waitcnt vmcnt(12)
    s_barrier
    s_waitcnt lgkmcnt(9)
    ds_read_b64_tr_b16 a[254:255], v4 offset:54752
    v_fma_mix_f32 v33, v118, v25, v29 op_sel:[1,0,0] op_sel_hi:[1,0,0]
    v_fma_mix_f32 v34, v119, v26, v30 op_sel:[0,0,0] op_sel_hi:[1,0,0]
    v_mfma_f32_16x16x32_bf16 v[212:215], a[232:235], v[96:99], v[212:215]
    ds_read_b64_tr_b16 a[192:193], v3 offset:0
    v_fma_mix_f32 v35, v119, v27, v31 op_sel:[1,0,0] op_sel_hi:[1,0,0]
    v_mfma_f32_16x16x32_bf16 v[212:215], a[236:239], v[100:103], v[212:215]
    ds_read_b64_tr_b16 a[194:195], v3 offset:512
    ds_read_b64_tr_b16 a[196:197], v3 offset:16896
    v_cvt_pk_bf16_f32 v118, v32, v33
    v_mfma_f32_16x16x32_bf16 v[244:247], a[232:235], v[104:107], v[244:247]
    s_add_u32 m0, s44, 73728
    ds_read_b64_tr_b16 a[198:199], v3 offset:17408
    v_cvt_pk_bf16_f32 v119, v34, v35
    v_mfma_f32_16x16x32_bf16 v[244:247], a[236:239], v[108:111], v[244:247]
    s_mov_b32 s46, 0
    s_waitcnt lgkmcnt(10)
    buffer_load_dwordx4 off, s[16:19], s46 offset:0 lds
    v_mfma_f32_16x16x32_bf16 v[216:219], a[240:243], v[96:99], v[216:219]
    ds_read_b64_tr_b16 a[200:201], v3 offset:32
    v_fma_mix_f32 v36, v126, v24, v28 op_sel:[0,0,0] op_sel_hi:[1,0,0]
    v_mfma_f32_16x16x32_bf16 v[216:219], a[244:247], v[100:103], v[216:219]
    ds_read_b64_tr_b16 a[202:203], v3 offset:544
    ds_read_b64_tr_b16 a[204:205], v3 offset:16928
    v_fma_mix_f32 v37, v126, v25, v29 op_sel:[1,0,0] op_sel_hi:[1,0,0]
    v_mfma_f32_16x16x32_bf16 v[248:251], a[240:243], v[104:107], v[248:251]
    s_add_u32 m0, s44, 73760
    ds_read_b64_tr_b16 a[206:207], v3 offset:17440
    v_fma_mix_f32 v38, v127, v26, v30 op_sel:[0,0,0] op_sel_hi:[1,0,0]
    v_mfma_f32_16x16x32_bf16 v[248:251], a[244:247], v[108:111], v[248:251]
    s_waitcnt lgkmcnt(8)
    buffer_load_dwordx4 off, s[16:19], s46 offset:1024 lds
    v_mfma_f32_16x16x32_bf16 v[220:223], a[248:251], v[96:99], v[220:223]
    ds_read_b64_tr_b16 a[208:209], v3 offset:64
    v_fma_mix_f32 v39, v127, v27, v31 op_sel:[1,0,0] op_sel_hi:[1,0,0]
    v_mfma_f32_16x16x32_bf16 v[220:223], a[252:255], v[100:103], v[220:223]
    ds_read_b64_tr_b16 a[210:211], v3 offset:576
    ds_read_b64_tr_b16 a[212:213], v3 offset:16960
    v_cvt_pk_bf16_f32 v126, v36, v37
    v_mfma_f32_16x16x32_bf16 v[252:255], a[248:251], v[104:107], v[252:255]
    s_add_u32 m0, s44, 73792
    ds_read_b64_tr_b16 a[214:215], v3 offset:17472
    v_cvt_pk_bf16_f32 v127, v38, v39
    v_mfma_f32_16x16x32_bf16 v[252:255], a[252:255], v[108:111], v[252:255]
    s_waitcnt lgkmcnt(8)
    buffer_load_dwordx4 off, s[16:19], s46 offset:2048 lds
    v_mfma_f32_16x16x32_bf16 v[128:131], a[192:195], v[112:115], v[128:131]
    s_waitcnt vmcnt(11)
    ds_read_b64_tr_b16 a[216:217], v3 offset:96
    ds_read_b128 v[24:27], v9 offset:13328
    v_mfma_f32_16x16x32_bf16 v[128:131], a[196:199], v[116:119], v[128:131]
    ds_read_b64_tr_b16 a[218:219], v3 offset:608
    ds_read_b64_tr_b16 a[220:221], v3 offset:16992
    v_fma_mix_f32 v32, v48, v16, v20 op_sel:[0,0,0] op_sel_hi:[1,0,0]
    v_mfma_f32_16x16x32_bf16 v[160:163], a[192:195], v[120:123], v[160:163]
    s_add_u32 m0, s44, 73824
    ds_read_b64_tr_b16 a[222:223], v3 offset:17504
    ds_read_b128 v[28:31], v9 offset:13360
    v_mfma_f32_16x16x32_bf16 v[160:163], a[196:199], v[124:127], v[160:163]
    s_waitcnt lgkmcnt(10)
    buffer_load_dwordx4 off, s[16:19], s46 offset:3072 lds
    v_mfma_f32_16x16x32_bf16 v[132:135], a[200:203], v[112:115], v[132:135]
    ds_read_b64_tr_b16 a[224:225], v3 offset:128
    v_fma_mix_f32 v33, v48, v17, v21 op_sel:[1,0,0] op_sel_hi:[1,0,0]
    v_mfma_f32_16x16x32_bf16 v[132:135], a[204:207], v[116:119], v[132:135]
    ds_read_b64_tr_b16 a[226:227], v3 offset:640
    ds_read_b64_tr_b16 a[228:229], v3 offset:17024
    v_fma_mix_f32 v34, v49, v18, v22 op_sel:[0,0,0] op_sel_hi:[1,0,0]
    v_mfma_f32_16x16x32_bf16 v[164:167], a[200:203], v[120:123], v[164:167]
    s_add_u32 m0, s44, 90624
    ds_read_b64_tr_b16 a[230:231], v3 offset:17536
    v_fma_mix_f32 v35, v49, v19, v23 op_sel:[1,0,0] op_sel_hi:[1,0,0]
    v_mfma_f32_16x16x32_bf16 v[164:167], a[204:207], v[124:127], v[164:167]
    s_waitcnt lgkmcnt(10)
    buffer_load_dwordx4 off, s[20:23], s46 offset:0 lds
    v_mfma_f32_16x16x32_bf16 v[136:139], a[208:211], v[112:115], v[136:139]
    ds_read_b64_tr_b16 a[232:233], v3 offset:160
    v_cvt_pk_bf16_f32 v48, v32, v33
    v_mfma_f32_16x16x32_bf16 v[136:139], a[212:215], v[116:119], v[136:139]
    ds_read_b64_tr_b16 a[234:235], v3 offset:672
    ds_read_b64_tr_b16 a[236:237], v3 offset:17056
    v_cvt_pk_bf16_f32 v49, v34, v35
    v_mfma_f32_16x16x32_bf16 v[168:171], a[208:211], v[120:123], v[168:171]
    s_add_u32 m0, s44, 90656
    ds_read_b64_tr_b16 a[238:239], v3 offset:17568
    v_fma_mix_f32 v36, v56, v16, v20 op_sel:[0,0,0] op_sel_hi:[1,0,0]
    v_mfma_f32_16x16x32_bf16 v[168:171], a[212:215], v[124:127], v[168:171]
    s_waitcnt lgkmcnt(9)
    buffer_load_dwordx4 off, s[20:23], s46 offset:1024 lds
    v_fma_mix_f32 v37, v56, v17, v21 op_sel:[1,0,0] op_sel_hi:[1,0,0]
    v_mfma_f32_16x16x32_bf16 v[140:143], a[216:219], v[112:115], v[140:143]
    ds_read_b64_tr_b16 a[240:241], v3 offset:192
    v_fma_mix_f32 v38, v57, v18, v22 op_sel:[0,0,0] op_sel_hi:[1,0,0]
    v_mfma_f32_16x16x32_bf16 v[140:143], a[220:223], v[116:119], v[140:143]
    ds_read_b64_tr_b16 a[242:243], v3 offset:704
    ds_read_b64_tr_b16 a[244:245], v3 offset:17088
    v_fma_mix_f32 v39, v57, v19, v23 op_sel:[1,0,0] op_sel_hi:[1,0,0]
    v_mfma_f32_16x16x32_bf16 v[172:175], a[216:219], v[120:123], v[172:175]
    s_add_u32 m0, s44, 90688
    ds_read_b64_tr_b16 a[246:247], v3 offset:17600
    v_cvt_pk_bf16_f32 v56, v36, v37
    v_mfma_f32_16x16x32_bf16 v[172:175], a[220:223], v[124:127], v[172:175]
    s_waitcnt lgkmcnt(8)
    buffer_load_dwordx4 off, s[20:23], s46 offset:2048 lds
    v_cvt_pk_bf16_f32 v57, v38, v39
    v_mfma_f32_16x16x32_bf16 v[144:147], a[224:227], v[112:115], v[144:147]
    ds_read_b64_tr_b16 a[248:249], v3 offset:224
    ds_read_b128 v[16:19], v9 offset:13568
    v_mfma_f32_16x16x32_bf16 v[144:147], a[228:231], v[116:119], v[144:147]
    ds_read_b64_tr_b16 a[250:251], v3 offset:736
    ds_read_b64_tr_b16 a[252:253], v3 offset:17120
    v_mfma_f32_16x16x32_bf16 v[176:179], a[224:227], v[120:123], v[176:179]
    s_add_u32 m0, s44, 90720
    ds_read_b64_tr_b16 a[254:255], v3 offset:17632
    ds_read_b128 v[20:23], v9 offset:13600
    v_mfma_f32_16x16x32_bf16 v[176:179], a[228:231], v[124:127], v[176:179]
    s_waitcnt lgkmcnt(10)
    buffer_load_dwordx4 off, s[20:23], s46 offset:3072 lds
    v_mfma_f32_16x16x32_bf16 v[148:151], a[232:235], v[112:115], v[148:151]
    ds_read_b64_tr_b16 a[192:193], v3 offset:256
    v_fma_mix_f32 v32, v50, v24, v28 op_sel:[0,0,0] op_sel_hi:[1,0,0]
    v_mfma_f32_16x16x32_bf16 v[148:151], a[236:239], v[116:119], v[148:151]
    ds_read_b64_tr_b16 a[194:195], v3 offset:768
    v_fma_mix_f32 v33, v50, v25, v29 op_sel:[1,0,0] op_sel_hi:[1,0,0]
    v_mfma_f32_16x16x32_bf16 v[180:183], a[232:235], v[120:123], v[180:183]
    ds_read_b64_tr_b16 a[196:197], v3 offset:17152
    v_fma_mix_f32 v34, v51, v26, v30 op_sel:[0,0,0] op_sel_hi:[1,0,0]
    v_mfma_f32_16x16x32_bf16 v[180:183], a[236:239], v[124:127], v[180:183]
    s_waitcnt lgkmcnt(9)
    ds_read_b64_tr_b16 a[198:199], v3 offset:17664
    v_fma_mix_f32 v35, v51, v27, v31 op_sel:[1,0,0] op_sel_hi:[1,0,0]
    v_mfma_f32_16x16x32_bf16 v[152:155], a[240:243], v[112:115], v[152:155]
    ds_read_b64_tr_b16 a[200:201], v3 offset:288
    v_cvt_pk_bf16_f32 v50, v32, v33
    v_mfma_f32_16x16x32_bf16 v[152:155], a[244:247], v[116:119], v[152:155]
    ds_read_b64_tr_b16 a[202:203], v3 offset:800
    v_cvt_pk_bf16_f32 v51, v34, v35
    v_mfma_f32_16x16x32_bf16 v[184:187], a[240:243], v[120:123], v[184:187]
    ds_read_b64_tr_b16 a[204:205], v3 offset:17184
    v_fma_mix_f32 v36, v58, v24, v28 op_sel:[0,0,0] op_sel_hi:[1,0,0]
    v_mfma_f32_16x16x32_bf16 v[184:187], a[244:247], v[124:127], v[184:187]
    s_waitcnt lgkmcnt(8)
    ds_read_b64_tr_b16 a[206:207], v3 offset:17696
    v_fma_mix_f32 v37, v58, v25, v29 op_sel:[1,0,0] op_sel_hi:[1,0,0]
    v_mfma_f32_16x16x32_bf16 v[156:159], a[248:251], v[112:115], v[156:159]
    ds_read_b64_tr_b16 a[208:209], v3 offset:320
    v_fma_mix_f32 v38, v59, v26, v30 op_sel:[0,0,0] op_sel_hi:[1,0,0]
    v_mfma_f32_16x16x32_bf16 v[156:159], a[252:255], v[116:119], v[156:159]
    ds_read_b64_tr_b16 a[210:211], v3 offset:832
    v_fma_mix_f32 v39, v59, v27, v31 op_sel:[1,0,0] op_sel_hi:[1,0,0]
    v_mfma_f32_16x16x32_bf16 v[188:191], a[248:251], v[120:123], v[188:191]
    ds_read_b64_tr_b16 a[212:213], v3 offset:17216
    v_cvt_pk_bf16_f32 v58, v36, v37
    v_mfma_f32_16x16x32_bf16 v[188:191], a[252:255], v[124:127], v[188:191]
    s_waitcnt lgkmcnt(7)
    ds_read_b64_tr_b16 a[214:215], v3 offset:17728
    v_cvt_pk_bf16_f32 v59, v38, v39
    v_mfma_f32_16x16x32_bf16 v[192:195], a[192:195], v[112:115], v[192:195]
    ds_read_b64_tr_b16 a[216:217], v3 offset:352
    ds_read_b128 v[24:27], v9 offset:13584
    v_mfma_f32_16x16x32_bf16 v[192:195], a[196:199], v[116:119], v[192:195]
    ds_read_b64_tr_b16 a[218:219], v3 offset:864
    ds_read_b128 v[28:31], v9 offset:13616
    v_mfma_f32_16x16x32_bf16 v[224:227], a[192:195], v[120:123], v[224:227]
    ds_read_b64_tr_b16 a[220:221], v3 offset:17248
    v_fma_mix_f32 v32, v52, v16, v20 op_sel:[0,0,0] op_sel_hi:[1,0,0]
    v_mfma_f32_16x16x32_bf16 v[224:227], a[196:199], v[124:127], v[224:227]
    s_waitcnt lgkmcnt(9)
    ds_read_b64_tr_b16 a[222:223], v3 offset:17760
    v_fma_mix_f32 v33, v52, v17, v21 op_sel:[1,0,0] op_sel_hi:[1,0,0]
    v_mfma_f32_16x16x32_bf16 v[196:199], a[200:203], v[112:115], v[196:199]
    ds_read_b64_tr_b16 a[224:225], v3 offset:384
    v_fma_mix_f32 v34, v53, v18, v22 op_sel:[0,0,0] op_sel_hi:[1,0,0]
    v_mfma_f32_16x16x32_bf16 v[196:199], a[204:207], v[116:119], v[196:199]
    ds_read_b64_tr_b16 a[226:227], v3 offset:896
    v_fma_mix_f32 v35, v53, v19, v23 op_sel:[1,0,0] op_sel_hi:[1,0,0]
    v_mfma_f32_16x16x32_bf16 v[228:231], a[200:203], v[120:123], v[228:231]
    ds_read_b64_tr_b16 a[228:229], v3 offset:17280
    v_cvt_pk_bf16_f32 v52, v32, v33
    v_mfma_f32_16x16x32_bf16 v[228:231], a[204:207], v[124:127], v[228:231]
    s_waitcnt lgkmcnt(9)
    ds_read_b64_tr_b16 a[230:231], v3 offset:17792
    v_cvt_pk_bf16_f32 v53, v34, v35
    v_mfma_f32_16x16x32_bf16 v[200:203], a[208:211], v[112:115], v[200:203]
    ds_read_b64_tr_b16 a[232:233], v3 offset:416
    v_fma_mix_f32 v36, v60, v16, v20 op_sel:[0,0,0] op_sel_hi:[1,0,0]
    v_mfma_f32_16x16x32_bf16 v[200:203], a[212:215], v[116:119], v[200:203]
    ds_read_b64_tr_b16 a[234:235], v3 offset:928
    v_fma_mix_f32 v37, v60, v17, v21 op_sel:[1,0,0] op_sel_hi:[1,0,0]
    v_mfma_f32_16x16x32_bf16 v[232:235], a[208:211], v[120:123], v[232:235]
    ds_read_b64_tr_b16 a[236:237], v3 offset:17312
    v_fma_mix_f32 v38, v61, v18, v22 op_sel:[0,0,0] op_sel_hi:[1,0,0]
    v_mfma_f32_16x16x32_bf16 v[232:235], a[212:215], v[124:127], v[232:235]
    s_waitcnt lgkmcnt(7)
    ds_read_b64_tr_b16 a[238:239], v3 offset:17824
    v_fma_mix_f32 v39, v61, v19, v23 op_sel:[1,0,0] op_sel_hi:[1,0,0]
    v_mfma_f32_16x16x32_bf16 v[204:207], a[216:219], v[112:115], v[204:207]
    ds_read_b64_tr_b16 a[240:241], v3 offset:448
    v_cvt_pk_bf16_f32 v60, v36, v37
    v_mfma_f32_16x16x32_bf16 v[204:207], a[220:223], v[116:119], v[204:207]
    ds_read_b64_tr_b16 a[242:243], v3 offset:960
    v_cvt_pk_bf16_f32 v61, v38, v39
    v_mfma_f32_16x16x32_bf16 v[236:239], a[216:219], v[120:123], v[236:239]
    ds_read_b64_tr_b16 a[244:245], v3 offset:17344
    v_mfma_f32_16x16x32_bf16 v[236:239], a[220:223], v[124:127], v[236:239]
    s_waitcnt lgkmcnt(7)
    ds_read_b64_tr_b16 a[246:247], v3 offset:17856
    v_mfma_f32_16x16x32_bf16 v[208:211], a[224:227], v[112:115], v[208:211]
    ds_read_b64_tr_b16 a[248:249], v3 offset:480
    v_fma_mix_f32 v32, v54, v24, v28 op_sel:[0,0,0] op_sel_hi:[1,0,0]
    v_mfma_f32_16x16x32_bf16 v[208:211], a[228:231], v[116:119], v[208:211]
    ds_read_b64_tr_b16 a[250:251], v3 offset:992
    v_fma_mix_f32 v33, v54, v25, v29 op_sel:[1,0,0] op_sel_hi:[1,0,0]
    v_mfma_f32_16x16x32_bf16 v[240:243], a[224:227], v[120:123], v[240:243]
    ds_read_b64_tr_b16 a[252:253], v3 offset:17376
    v_fma_mix_f32 v34, v55, v26, v30 op_sel:[0,0,0] op_sel_hi:[1,0,0]
    v_mfma_f32_16x16x32_bf16 v[240:243], a[228:231], v[124:127], v[240:243]
    s_waitcnt vmcnt(8)
    s_barrier
    s_waitcnt lgkmcnt(7)
    ds_read_b64_tr_b16 a[254:255], v3 offset:17888
    v_fma_mix_f32 v35, v55, v27, v31 op_sel:[1,0,0] op_sel_hi:[1,0,0]
    v_mfma_f32_16x16x32_bf16 v[212:215], a[232:235], v[112:115], v[212:215]
    ds_read_b64_tr_b16 a[192:193], v3 offset:36864
    v_cvt_pk_bf16_f32 v54, v32, v33
    v_mfma_f32_16x16x32_bf16 v[212:215], a[236:239], v[116:119], v[212:215]
    ds_read_b64_tr_b16 a[194:195], v3 offset:37376
    ds_read_b64_tr_b16 a[196:197], v3 offset:53760
    v_mfma_f32_16x16x32_bf16 v[244:247], a[232:235], v[120:123], v[244:247]
    s_add_u32 m0, s44, 110592
    ds_read_b64_tr_b16 a[198:199], v3 offset:54272
    v_cvt_pk_bf16_f32 v55, v34, v35
    v_mfma_f32_16x16x32_bf16 v[244:247], a[236:239], v[124:127], v[244:247]
    s_mov_b32 s46, 16384
    s_waitcnt lgkmcnt(8)
    buffer_load_dwordx4 off, s[16:19], s46 offset:0 lds
    v_mfma_f32_16x16x32_bf16 v[216:219], a[240:243], v[112:115], v[216:219]
    ds_read_b64_tr_b16 a[200:201], v3 offset:36896
    v_fma_mix_f32 v36, v62, v24, v28 op_sel:[0,0,0] op_sel_hi:[1,0,0]
    v_mfma_f32_16x16x32_bf16 v[216:219], a[244:247], v[116:119], v[216:219]
    ds_read_b64_tr_b16 a[202:203], v3 offset:37408
    ds_read_b64_tr_b16 a[204:205], v3 offset:53792
    v_fma_mix_f32 v37, v62, v25, v29 op_sel:[1,0,0] op_sel_hi:[1,0,0]
    v_mfma_f32_16x16x32_bf16 v[248:251], a[240:243], v[120:123], v[248:251]
    s_add_u32 m0, s44, 110624
    ds_read_b64_tr_b16 a[206:207], v3 offset:54304
    v_fma_mix_f32 v38, v63, v26, v30 op_sel:[0,0,0] op_sel_hi:[1,0,0]
    v_mfma_f32_16x16x32_bf16 v[248:251], a[244:247], v[124:127], v[248:251]
    s_waitcnt lgkmcnt(8)
    buffer_load_dwordx4 off, s[16:19], s46 offset:1024 lds
    v_mfma_f32_16x16x32_bf16 v[220:223], a[248:251], v[112:115], v[220:223]
    ds_read_b64_tr_b16 a[208:209], v3 offset:36928
    v_fma_mix_f32 v39, v63, v27, v31 op_sel:[1,0,0] op_sel_hi:[1,0,0]
    v_mfma_f32_16x16x32_bf16 v[220:223], a[252:255], v[116:119], v[220:223]
    ds_read_b64_tr_b16 a[210:211], v3 offset:37440
    ds_read_b64_tr_b16 a[212:213], v3 offset:53824
    v_cvt_pk_bf16_f32 v62, v36, v37
    v_mfma_f32_16x16x32_bf16 v[252:255], a[248:251], v[120:123], v[252:255]
    s_add_u32 m0, s44, 110656
    ds_read_b64_tr_b16 a[214:215], v3 offset:54336
    v_cvt_pk_bf16_f32 v63, v38, v39
    v_mfma_f32_16x16x32_bf16 v[252:255], a[252:255], v[124:127], v[252:255]
    s_waitcnt lgkmcnt(8)
    buffer_load_dwordx4 off, s[16:19], s46 offset:2048 lds
    v_mfma_f32_16x16x32_bf16 v[128:131], a[192:195], v[48:51], v[128:131]
    ds_read_b64_tr_b16 a[216:217], v3 offset:36960
    v_lshrrev_b32 v14, 2, v0
    v_mfma_f32_16x16x32_bf16 v[128:131], a[196:199], v[52:55], v[128:131]
    s_mul_i32 s3, s51, 144
    ds_read_b64_tr_b16 a[218:219], v3 offset:37472
    ds_read_b64_tr_b16 a[220:221], v3 offset:53856
    v_mfma_f32_16x16x32_bf16 v[160:163], a[192:195], v[56:59], v[160:163]
    s_add_u32 m0, s44, 110688
    ds_read_b64_tr_b16 a[222:223], v3 offset:54368
    v_add_u32 v14, s3, v14
    v_mfma_f32_16x16x32_bf16 v[160:163], a[196:199], v[60:63], v[160:163]
    s_waitcnt lgkmcnt(8)
    buffer_load_dwordx4 off, s[16:19], s46 offset:3072 lds
    v_mfma_f32_16x16x32_bf16 v[132:135], a[200:203], v[48:51], v[132:135]
    ds_read_b64_tr_b16 a[224:225], v3 offset:36992
    v_mul_u32_u24 v14, 9216, v14
    v_mfma_f32_16x16x32_bf16 v[132:135], a[204:207], v[52:55], v[132:135]
    ds_read_b64_tr_b16 a[226:227], v3 offset:37504
    ds_read_b64_tr_b16 a[228:229], v3 offset:53888
    v_mfma_f32_16x16x32_bf16 v[164:167], a[200:203], v[56:59], v[164:167]
    s_add_u32 m0, s44, 127488
    ds_read_b64_tr_b16 a[230:231], v3 offset:54400
    v_and_b32 v15, 3, v0
    v_mfma_f32_16x16x32_bf16 v[164:167], a[204:207], v[60:63], v[164:167]
    s_waitcnt lgkmcnt(8)
    buffer_load_dwordx4 off, s[20:23], s46 offset:0 lds
    v_mfma_f32_16x16x32_bf16 v[136:139], a[208:211], v[48:51], v[136:139]
    ds_read_b64_tr_b16 a[232:233], v3 offset:37024
    v_lshl_add_u32 v6, v15, 4, v14
    v_mfma_f32_16x16x32_bf16 v[136:139], a[212:215], v[52:55], v[136:139]
    s_lshr_b32 s3, s2, 3
    s_lshl2_add_u32 s3, s3, s51
    s_and_b32 s15, s2, 7
    ds_read_b64_tr_b16 a[234:235], v3 offset:37536
    ds_read_b64_tr_b16 a[236:237], v3 offset:53920
    v_mfma_f32_16x16x32_bf16 v[168:171], a[208:211], v[56:59], v[168:171]
    s_add_u32 m0, s44, 127520
    ds_read_b64_tr_b16 a[238:239], v3 offset:54432
    v_lshlrev_b32 v9, 7, v0
    v_mfma_f32_16x16x32_bf16 v[168:171], a[212:215], v[60:63], v[168:171]
    s_waitcnt lgkmcnt(8)
    s_mul_i32 s14, s3, 9
    s_lshr_b32 s14, s14, 1
    buffer_load_dwordx4 off, s[20:23], s46 offset:1024 lds
    v_mfma_f32_16x16x32_bf16 v[140:143], a[216:219], v[48:51], v[140:143]
    ds_read_b64_tr_b16 a[240:241], v3 offset:37056
    v_min_u32 v15, 44, v0
    v_mfma_f32_16x16x32_bf16 v[140:143], a[220:223], v[52:55], v[140:143]
    ds_read_b64_tr_b16 a[242:243], v3 offset:37568
    ds_read_b64_tr_b16 a[244:245], v3 offset:53952
    v_mfma_f32_16x16x32_bf16 v[172:175], a[216:219], v[56:59], v[172:175]
    s_add_u32 m0, s44, 127552
    ds_read_b64_tr_b16 a[246:247], v3 offset:54464
    v_mul_u32_u24 v12, 7282, v15
    v_mfma_f32_16x16x32_bf16 v[172:175], a[220:223], v[60:63], v[172:175]
    s_waitcnt lgkmcnt(8)
    buffer_load_dwordx4 off, s[20:23], s46 offset:2048 lds
    v_mfma_f32_16x16x32_bf16 v[144:147], a[224:227], v[48:51], v[144:147]
    ds_read_b64_tr_b16 a[248:249], v3 offset:37088
    v_lshrrev_b32 v12, 16, v12
    v_mfma_f32_16x16x32_bf16 v[144:147], a[228:231], v[52:55], v[144:147]
    ds_read_b64_tr_b16 a[250:251], v3 offset:37600
    ds_read_b64_tr_b16 a[252:253], v3 offset:53984
    v_mfma_f32_16x16x32_bf16 v[176:179], a[224:227], v[56:59], v[176:179]
    s_add_u32 m0, s44, 127584
    ds_read_b64_tr_b16 a[254:255], v3 offset:54496
    v_mul_u32_u24 v13, 63, v12
    v_mfma_f32_16x16x32_bf16 v[176:179], a[228:231], v[60:63], v[176:179]
    s_waitcnt lgkmcnt(8)
    buffer_load_dwordx4 off, s[20:23], s46 offset:3072 lds
    v_mfma_f32_16x16x32_bf16 v[148:151], a[232:235], v[48:51], v[148:151]
    ds_read_b64_tr_b16 a[192:193], v3 offset:37120
    v_add_u32 v12, v15, v13
    v_mfma_f32_16x16x32_bf16 v[148:151], a[236:239], v[52:55], v[148:151]
    s_mul_i32 s14, s14, 72
    s_mul_i32 s56, s15, 9
    s_add_u32 s14, s14, s56
    ds_read_b64_tr_b16 a[194:195], v3 offset:37632
    v_add_lshl_u32 v12, s14, v12, 7
    v_mfma_f32_16x16x32_bf16 v[180:183], a[232:235], v[56:59], v[180:183]
    s_mul_i32 s14, s3, 81
    s_lshr_b32 s14, s14, 1
    s_mul_i32 s56, s15, 5184
    s_add_u32 s14, s14, s56
    ds_read_b64_tr_b16 a[196:197], v3 offset:54016
    v_min_u32 v13, 40, v0
    v_mfma_f32_16x16x32_bf16 v[180:183], a[236:239], v[60:63], v[180:183]
    s_waitcnt lgkmcnt(7)
    ds_read_b64_tr_b16 a[198:199], v3 offset:54528
    v_add_lshl_u32 v13, s14, v13, 7
    v_mfma_f32_16x16x32_bf16 v[152:155], a[240:243], v[48:51], v[152:155]
    s_mul_i32 s14, s3, 72
    s_andn2_b32 s56, s52, 3
    s_mul_i32 s56, s56, 2304
    s_add_u32 s14, s14, s56
    ds_read_b64_tr_b16 a[200:201], v3 offset:37152
    v_min_u32 v14, 35, v0
    v_mfma_f32_16x16x32_bf16 v[152:155], a[244:247], v[52:55], v[152:155]
    ds_read_b64_tr_b16 a[202:203], v3 offset:37664
    v_add_lshl_u32 v14, s14, v14, 7
    v_mfma_f32_16x16x32_bf16 v[184:187], a[240:243], v[56:59], v[184:187]
    ds_read_b64_tr_b16 a[204:205], v3 offset:54048
    v_add_u32 v15, 4608, v14
    v_mfma_f32_16x16x32_bf16 v[184:187], a[244:247], v[60:63], v[184:187]
    s_waitcnt lgkmcnt(7)
    ds_read_b64_tr_b16 a[206:207], v3 offset:54560
    v_cvt_pk_bf16_f32 v64, v128, v129
    v_mfma_f32_16x16x32_bf16 v[156:159], a[248:251], v[48:51], v[156:159]
    ds_read_b64_tr_b16 a[208:209], v3 offset:37184
    v_cvt_pk_bf16_f32 v65, v130, v131
    v_mfma_f32_16x16x32_bf16 v[156:159], a[252:255], v[52:55], v[156:159]
    ds_read_b64_tr_b16 a[210:211], v3 offset:37696
    v_cvt_pk_bf16_f32 v66, v132, v133
    v_mfma_f32_16x16x32_bf16 v[188:191], a[248:251], v[56:59], v[188:191]
    ds_read_b64_tr_b16 a[212:213], v3 offset:54080
    v_cvt_pk_bf16_f32 v67, v134, v135
    v_mfma_f32_16x16x32_bf16 v[188:191], a[252:255], v[60:63], v[188:191]
    s_waitcnt lgkmcnt(7)
    ds_read_b64_tr_b16 a[214:215], v3 offset:54592
    v_cvt_pk_bf16_f32 v80, v160, v161
    v_mfma_f32_16x16x32_bf16 v[192:195], a[192:195], v[48:51], v[192:195]
    ds_read_b64_tr_b16 a[216:217], v3 offset:37216
    v_cvt_pk_bf16_f32 v81, v162, v163
    v_mfma_f32_16x16x32_bf16 v[192:195], a[196:199], v[52:55], v[192:195]
    ds_read_b64_tr_b16 a[218:219], v3 offset:37728
    v_cvt_pk_bf16_f32 v82, v164, v165
    v_mfma_f32_16x16x32_bf16 v[224:227], a[192:195], v[56:59], v[224:227]
    ds_read_b64_tr_b16 a[220:221], v3 offset:54112
    v_cvt_pk_bf16_f32 v83, v166, v167
    v_mfma_f32_16x16x32_bf16 v[224:227], a[196:199], v[60:63], v[224:227]
    s_waitcnt lgkmcnt(7)
    ds_read_b64_tr_b16 a[222:223], v3 offset:54624
    v_cvt_pk_bf16_f32 v68, v136, v137
    v_mfma_f32_16x16x32_bf16 v[196:199], a[200:203], v[48:51], v[196:199]
    ds_read_b64_tr_b16 a[224:225], v3 offset:37248
    v_cvt_pk_bf16_f32 v69, v138, v139
    v_mfma_f32_16x16x32_bf16 v[196:199], a[204:207], v[52:55], v[196:199]
    ds_read_b64_tr_b16 a[226:227], v3 offset:37760
    v_cvt_pk_bf16_f32 v70, v140, v141
    v_mfma_f32_16x16x32_bf16 v[228:231], a[200:203], v[56:59], v[228:231]
    ds_read_b64_tr_b16 a[228:229], v3 offset:54144
    v_cvt_pk_bf16_f32 v71, v142, v143
    v_mfma_f32_16x16x32_bf16 v[228:231], a[204:207], v[60:63], v[228:231]
    s_waitcnt vmcnt(8)
    s_barrier
    s_waitcnt lgkmcnt(7)
    ds_read_b64_tr_b16 a[230:231], v3 offset:54656
    v_cvt_pk_bf16_f32 v84, v168, v169
    v_mfma_f32_16x16x32_bf16 v[200:203], a[208:211], v[48:51], v[200:203]
    ds_read_b64_tr_b16 a[232:233], v3 offset:37280
    v_cvt_pk_bf16_f32 v85, v170, v171
    v_mfma_f32_16x16x32_bf16 v[200:203], a[212:215], v[52:55], v[200:203]
L2_pad3:
    s_cbranch_execz L2_pad7
    ds_read_b64_tr_b16 a[234:235], v3 offset:37792
    ds_read_b64_tr_b16 a[236:237], v3 offset:54176
    v_mfma_f32_16x16x32_bf16 v[232:235], a[208:211], v[56:59], v[232:235]
    s_add_u32 m0, s44, 0
    ds_read_b64_tr_b16 a[238:239], v3 offset:54688
    v_cvt_pk_bf16_f32 v86, v172, v173
    v_mfma_f32_16x16x32_bf16 v[232:235], a[212:215], v[60:63], v[232:235]
    s_mov_b32 s46, 32768
    s_waitcnt lgkmcnt(8)
    buffer_load_dwordx4 off, s[16:19], s46 offset:0 lds
    v_mfma_f32_16x16x32_bf16 v[204:207], a[216:219], v[48:51], v[204:207]
    ds_read_b64_tr_b16 a[240:241], v3 offset:37312
    v_cvt_pk_bf16_f32 v87, v174, v175
    v_mfma_f32_16x16x32_bf16 v[204:207], a[220:223], v[52:55], v[204:207]
    ds_read_b64_tr_b16 a[242:243], v3 offset:37824
    ds_read_b64_tr_b16 a[244:245], v3 offset:54208
    v_mfma_f32_16x16x32_bf16 v[236:239], a[216:219], v[56:59], v[236:239]
    s_add_u32 m0, s44, 32
    ds_read_b64_tr_b16 a[246:247], v3 offset:54720
    v_cvt_pk_bf16_f32 v72, v144, v145
    v_mfma_f32_16x16x32_bf16 v[236:239], a[220:223], v[60:63], v[236:239]
    s_waitcnt lgkmcnt(8)
    buffer_load_dwordx4 off, s[16:19], s46 offset:1024 lds
    v_mfma_f32_16x16x32_bf16 v[208:211], a[224:227], v[48:51], v[208:211]
    ds_read_b64_tr_b16 a[248:249], v3 offset:37344
    v_cvt_pk_bf16_f32 v73, v146, v147
    v_mfma_f32_16x16x32_bf16 v[208:211], a[228:231], v[52:55], v[208:211]
    ds_read_b64_tr_b16 a[250:251], v3 offset:37856
    ds_read_b64_tr_b16 a[252:253], v3 offset:54240
    v_mfma_f32_16x16x32_bf16 v[240:243], a[224:227], v[56:59], v[240:243]
    s_add_u32 m0, s44, 64
    ds_read_b64_tr_b16 a[254:255], v3 offset:54752
    v_cvt_pk_bf16_f32 v74, v148, v149
    v_mfma_f32_16x16x32_bf16 v[240:243], a[228:231], v[60:63], v[240:243]
    s_waitcnt lgkmcnt(8)
    buffer_load_dwordx4 off, s[16:19], s46 offset:2048 lds
    v_mfma_f32_16x16x32_bf16 v[212:215], a[232:235], v[48:51], v[212:215]
    ds_read_b128 a[64:67], v1 offset:0
    ds_read_b128 a[68:71], v1 offset:64
    v_mfma_f32_16x16x32_bf16 v[212:215], a[236:239], v[52:55], v[212:215]
    ds_read_b128 a[72:75], v1 offset:128
    ds_read_b128 a[76:79], v1 offset:192
    v_mfma_f32_16x16x32_bf16 v[244:247], a[232:235], v[56:59], v[244:247]
    s_add_u32 m0, s44, 96
    ds_read_b128 a[80:83], v1 offset:256
    ds_read_b128 a[84:87], v1 offset:320
    v_mfma_f32_16x16x32_bf16 v[244:247], a[236:239], v[60:63], v[244:247]
    s_waitcnt lgkmcnt(10)
    buffer_load_dwordx4 off, s[16:19], s46 offset:3072 lds
    v_mfma_f32_16x16x32_bf16 v[216:219], a[240:243], v[48:51], v[216:219]
    ds_read_b128 a[88:91], v1 offset:384
    ds_read_b128 a[92:95], v1 offset:448
    v_mfma_f32_16x16x32_bf16 v[216:219], a[244:247], v[52:55], v[216:219]
    ds_read_b128 a[96:99], v1 offset:512
    ds_read_b128 a[100:103], v1 offset:576
    v_mfma_f32_16x16x32_bf16 v[248:251], a[240:243], v[56:59], v[248:251]
    s_add_u32 m0, s44, 16896
    ds_read_b128 a[104:107], v1 offset:640
    ds_read_b128 a[108:111], v1 offset:704
    v_mfma_f32_16x16x32_bf16 v[248:251], a[244:247], v[60:63], v[248:251]
    s_waitcnt lgkmcnt(12)
    buffer_load_dwordx4 off, s[20:23], s46 offset:0 lds
    v_mfma_f32_16x16x32_bf16 v[220:223], a[248:251], v[48:51], v[220:223]
    ds_read_b128 a[112:115], v1 offset:768
    ds_read_b128 a[116:119], v1 offset:832
    v_mfma_f32_16x16x32_bf16 v[220:223], a[252:255], v[52:55], v[220:223]
    ds_read_b128 a[120:123], v1 offset:896
    ds_read_b128 a[124:127], v1 offset:960
    v_mfma_f32_16x16x32_bf16 v[252:255], a[248:251], v[56:59], v[252:255]
    s_add_u32 m0, s44, 16928
    v_cvt_pk_bf16_f32 v75, v150, v151
    v_cvt_pk_bf16_f32 v88, v176, v177
    v_mfma_f32_16x16x32_bf16 v[252:255], a[252:255], v[60:63], v[252:255]
    buffer_load_dwordx4 off, s[20:23], s46 offset:1024 lds
    s_mul_i32 s3, s96, 9216
    s_add_u32 s3, s3, 4194304
    s_add_u32 s32, s84, s3
    s_addc_u32 s33, s85, 0
    s_mov_b32 s34, 9216
    s_mov_b32 s35, 0x20000
    s_add_u32 m0, s44, 16960
    s_nop 0
    buffer_load_dwordx4 off, s[20:23], s46 offset:2048 lds
    s_add_u32 m0, s44, 16992
    s_nop 0
    buffer_load_dwordx4 off, s[20:23], s46 offset:3072 lds
    v_cvt_pk_bf16_f32 v89, v178, v179
    v_cvt_pk_bf16_f32 v90, v180, v181
    v_cvt_pk_bf16_f32 v91, v182, v183
    v_cvt_pk_bf16_f32 v76, v152, v153
    v_cvt_pk_bf16_f32 v77, v154, v155
    v_cvt_pk_bf16_f32 v78, v156, v157
    v_cvt_pk_bf16_f32 v79, v158, v159
    v_cvt_pk_bf16_f32 v92, v184, v185
    v_cvt_pk_bf16_f32 v93, v186, v187
    v_cvt_pk_bf16_f32 v94, v188, v189
    v_cvt_pk_bf16_f32 v95, v190, v191
    v_permlane32_swap_b32 v64, v66
    v_permlane32_swap_b32 v65, v67
    v_permlane32_swap_b32 v80, v82
    v_permlane32_swap_b32 v81, v83
    v_permlane32_swap_b32 v68, v70
    v_permlane32_swap_b32 v69, v71
    v_permlane32_swap_b32 v84, v86
    v_permlane32_swap_b32 v85, v87
    v_permlane32_swap_b32 v72, v74
    v_permlane32_swap_b32 v73, v75
    v_permlane32_swap_b32 v88, v90
    v_permlane32_swap_b32 v89, v91
    v_permlane32_swap_b32 v76, v78
    v_permlane32_swap_b32 v77, v79
    v_permlane32_swap_b32 v92, v94
    v_permlane32_swap_b32 v93, v95
    v_cvt_pk_bf16_f32 v96, v192, v193
    v_cvt_pk_bf16_f32 v97, v194, v195
    v_cvt_pk_bf16_f32 v98, v196, v197
    v_cvt_pk_bf16_f32 v99, v198, v199
    v_cvt_pk_bf16_f32 v112, v224, v225
    v_cvt_pk_bf16_f32 v113, v226, v227
    v_cvt_pk_bf16_f32 v114, v228, v229
    v_cvt_pk_bf16_f32 v115, v230, v231
    v_cvt_pk_bf16_f32 v100, v200, v201
    v_cvt_pk_bf16_f32 v101, v202, v203
    v_cvt_pk_bf16_f32 v102, v204, v205
    v_cvt_pk_bf16_f32 v103, v206, v207
    v_cvt_pk_bf16_f32 v116, v232, v233
    v_cvt_pk_bf16_f32 v117, v234, v235
    v_cvt_pk_bf16_f32 v118, v236, v237
    v_cvt_pk_bf16_f32 v119, v238, v239
    v_cvt_pk_bf16_f32 v104, v208, v209
    v_cvt_pk_bf16_f32 v105, v210, v211
    v_cvt_pk_bf16_f32 v106, v212, v213
    v_cvt_pk_bf16_f32 v107, v214, v215
    v_cvt_pk_bf16_f32 v120, v240, v241
    v_cvt_pk_bf16_f32 v121, v242, v243
    v_cvt_pk_bf16_f32 v122, v244, v245
    v_cvt_pk_bf16_f32 v123, v246, v247
    v_cvt_pk_bf16_f32 v108, v216, v217
    v_cvt_pk_bf16_f32 v109, v218, v219
    v_cvt_pk_bf16_f32 v110, v220, v221
    v_cvt_pk_bf16_f32 v111, v222, v223
    v_cvt_pk_bf16_f32 v124, v248, v249
    v_cvt_pk_bf16_f32 v125, v250, v251
    v_cvt_pk_bf16_f32 v126, v252, v253
    v_cvt_pk_bf16_f32 v127, v254, v255
    s_nop 0
    v_permlane32_swap_b32 v96, v98
    v_permlane32_swap_b32 v97, v99
    v_permlane32_swap_b32 v112, v114
    v_permlane32_swap_b32 v113, v115
    v_permlane32_swap_b32 v100, v102
    v_permlane32_swap_b32 v101, v103
    v_permlane32_swap_b32 v116, v118
    v_permlane32_swap_b32 v117, v119
    v_permlane32_swap_b32 v104, v106
    v_permlane32_swap_b32 v105, v107
    v_permlane32_swap_b32 v120, v122
    v_permlane32_swap_b32 v121, v123
    v_permlane32_swap_b32 v108, v110
    v_permlane32_swap_b32 v109, v111
    v_permlane32_swap_b32 v124, v126
    v_permlane32_swap_b32 v125, v127
    s_waitcnt lgkmcnt(12)
    v_mfma_f32_16x16x32_bf16 v[16:19], a[64:67], v[64:67], 0
    v_mfma_f32_16x16x32_bf16 v[16:19], a[68:71], v[68:71], v[16:19]
    v_mfma_f32_16x16x32_bf16 v[16:19], a[72:75], v[72:75], v[16:19]
    v_mfma_f32_16x16x32_bf16 v[16:19], a[76:79], v[76:79], v[16:19]
    v_mfma_f32_16x16x32_bf16 v[20:23], a[64:67], v[80:83], 0
    v_mfma_f32_16x16x32_bf16 v[20:23], a[68:71], v[84:87], v[20:23]
    v_mfma_f32_16x16x32_bf16 v[20:23], a[72:75], v[88:91], v[20:23]
    v_mfma_f32_16x16x32_bf16 v[20:23], a[76:79], v[92:95], v[20:23]
    v_mfma_f32_16x16x32_bf16 v[24:27], a[64:67], v[96:99], 0
    v_mfma_f32_16x16x32_bf16 v[24:27], a[68:71], v[100:103], v[24:27]
    v_mfma_f32_16x16x32_bf16 v[24:27], a[72:75], v[104:107], v[24:27]
    v_mfma_f32_16x16x32_bf16 v[24:27], a[76:79], v[108:111], v[24:27]
    v_mfma_f32_16x16x32_bf16 v[28:31], a[64:67], v[112:115], 0
    v_mfma_f32_16x16x32_bf16 v[28:31], a[68:71], v[116:119], v[28:31]
    v_mfma_f32_16x16x32_bf16 v[28:31], a[72:75], v[120:123], v[28:31]
    v_mfma_f32_16x16x32_bf16 v[28:31], a[76:79], v[124:127], v[28:31]
    s_nop 1
    v_max3_f32 v16, v16, v17, v18
    v_max_f32 v16, v16, v19
    v_max3_f32 v20, v20, v21, v22
    v_max_f32 v20, v20, v23
    v_max3_f32 v24, v24, v25, v26
    v_max_f32 v24, v24, v27
    v_max3_f32 v28, v28, v29, v30
    v_max_f32 v28, v28, v31
    v_mov_b32 v40, v16
    v_mov_b32 v41, v20
    v_mov_b32 v42, v24
    v_mov_b32 v43, v28
    v_permlane16_swap_b32 v40, v16
    v_permlane16_swap_b32 v41, v20
    v_permlane16_swap_b32 v42, v24
    v_permlane16_swap_b32 v43, v28
    v_max_f32 v16, v16, v40
    v_max_f32 v20, v20, v41
    v_max_f32 v24, v24, v42
    v_max_f32 v28, v28, v43
    v_mov_b32 v40, v16
    v_mov_b32 v41, v20
    v_mov_b32 v42, v24
    v_mov_b32 v43, v28
    v_permlane32_swap_b32 v40, v16
    v_permlane32_swap_b32 v41, v20
    v_permlane32_swap_b32 v42, v24
    v_permlane32_swap_b32 v43, v28
    v_max_f32 v16, v16, v40
    v_max_f32 v20, v20, v41
    v_max_f32 v24, v24, v42
    v_max_f32 v28, v28, v43
    v_sub_f32 v48, 0xc2800000, v16
    v_sub_f32 v49, 0xc2800000, v16
    v_sub_f32 v50, 0xc2800000, v16
    v_sub_f32 v51, 0xc2800000, v16
    v_sub_f32 v52, 0xc2800000, v20
    v_sub_f32 v53, 0xc2800000, v20
    v_sub_f32 v54, 0xc2800000, v20
    v_sub_f32 v55, 0xc2800000, v20
    v_sub_f32 v56, 0xc2800000, v24
    v_sub_f32 v57, 0xc2800000, v24
    v_sub_f32 v58, 0xc2800000, v24
    v_sub_f32 v59, 0xc2800000, v24
    v_sub_f32 v60, 0xc2800000, v28
    v_sub_f32 v61, 0xc2800000, v28
    v_sub_f32 v62, 0xc2800000, v28
    v_sub_f32 v63, 0xc2800000, v28
L2_entry:
    s_mov_b32 s47, s44
    s_mov_b32 s48, -73728
    s_mov_b32 s49, 11
    s_mov_b32 s46, 32768
    s_mov_b32 s100, 0x07060302
    s_waitcnt vmcnt(8)
    s_barrier
    v_mfma_f32_16x16x32_bf16 v[16:19], a[64:67], v[64:67], v[48:51]
    ds_read_b64_tr_b16 a[128:129], v2 offset:0
    ds_read_b64_tr_b16 a[130:131], v2 offset:256
    v_mfma_f32_16x16x32_bf16 v[16:19], a[68:71], v[68:71], v[16:19]
    ds_read_b64_tr_b16 a[132:133], v2 offset:512
    ds_read_b64_tr_b16 a[134:135], v2 offset:768
    v_mfma_f32_16x16x32_bf16 v[16:19], a[72:75], v[72:75], v[16:19]
    s_add_u32 m0, s47, 36864
    ds_read_b64_tr_b16 a[136:137], v2 offset:32
    ds_read_b64_tr_b16 a[138:139], v2 offset:288
    v_mfma_f32_16x16x32_bf16 v[16:19], a[76:79], v[76:79], v[16:19]
    s_waitcnt lgkmcnt(14)
    s_add_u32 s46, s46, 16384
    buffer_load_dwordx4 off, s[16:19], s46 offset:0 lds
    v_mfma_f32_16x16x32_bf16 v[20:23], a[80:83], v[64:67], v[48:51]
    ds_read_b64_tr_b16 a[140:141], v2 offset:544
    ds_read_b64_tr_b16 a[142:143], v2 offset:800
    v_mfma_f32_16x16x32_bf16 v[20:23], a[84:87], v[68:71], v[20:23]
    ds_read_b64_tr_b16 a[144:145], v2 offset:64
    ds_read_b64_tr_b16 a[146:147], v2 offset:320
    v_mfma_f32_16x16x32_bf16 v[20:23], a[88:91], v[72:75], v[20:23]
    s_add_u32 m0, s47, 36896
    ds_read_b64_tr_b16 a[148:149], v2 offset:576
    ds_read_b64_tr_b16 a[150:151], v2 offset:832
    v_mfma_f32_16x16x32_bf16 v[20:23], a[92:95], v[76:79], v[20:23]
    s_waitcnt lgkmcnt(15)
    buffer_load_dwordx4 off, s[16:19], s46 offset:1024 lds
    v_mfma_f32_16x16x32_bf16 v[24:27], a[96:99], v[64:67], v[48:51]
    s_nop 1
    v_exp_f32 v16, v16
    v_mfma_f32_16x16x32_bf16 v[24:27], a[100:103], v[68:71], v[24:27]
    ds_read_b64_tr_b16 a[152:153], v2 offset:96
    ds_read_b64_tr_b16 a[154:155], v2 offset:352
    v_mfma_f32_16x16x32_bf16 v[24:27], a[104:107], v[72:75], v[24:27]
    s_add_u32 m0, s47, 36928
    v_exp_f32 v17, v17
    v_mfma_f32_16x16x32_bf16 v[24:27], a[108:111], v[76:79], v[24:27]
    s_waitcnt lgkmcnt(14)
    buffer_load_dwordx4 off, s[16:19], s46 offset:2048 lds
    v_mfma_f32_16x16x32_bf16 v[28:31], a[112:115], v[64:67], v[48:51]
    v_exp_f32 v18, v18
    v_mfma_f32_16x16x32_bf16 v[28:31], a[116:119], v[68:71], v[28:31]
    ds_read_b64_tr_b16 a[156:157], v2 offset:608
    v_perm_b32 v32, v17, v16, s100
    v_mfma_f32_16x16x32_bf16 v[28:31], a[120:123], v[72:75], v[28:31]
    s_add_u32 m0, s47, 36960
    v_exp_f32 v19, v19
    v_mfma_f32_16x16x32_bf16 v[28:31], a[124:127], v[76:79], v[28:31]
    buffer_load_dwordx4 off, s[16:19], s46 offset:3072 lds
    s_nop 3
    ds_read_b64_tr_b16 a[158:159], v2 offset:864
    ds_read_b64_tr_b16 a[160:161], v2 offset:128
    ds_read_b64_tr_b16 a[162:163], v2 offset:384
    ds_read_b64_tr_b16 a[164:165], v2 offset:640
    ds_read_b64_tr_b16 a[166:167], v2 offset:896
    ds_read_b64_tr_b16 a[168:169], v2 offset:160
    ds_read_b64_tr_b16 a[170:171], v2 offset:416
    ds_read_b64_tr_b16 a[172:173], v2 offset:672
    ds_read_b64_tr_b16 a[174:175], v2 offset:928
    ds_read_b64_tr_b16 a[176:177], v2 offset:192
    ds_read_b64_tr_b16 a[178:179], v2 offset:448
    ds_read_b64_tr_b16 a[180:181], v2 offset:704
    ds_read_b64_tr_b16 a[182:183], v2 offset:960
    ds_read_b64_tr_b16 a[184:185], v2 offset:224
    ds_read_b64_tr_b16 a[186:187], v2 offset:480
    ds_read_b64_tr_b16 a[188:189], v2 offset:736
    ds_read_b64_tr_b16 a[190:191], v2 offset:992
    v_exp_f32 v20, v20
    s_nop 0
    ds_read_b64_tr_b16 a[192:193], v2 offset:36864
    v_perm_b32 v33, v19, v18, s100
    s_add_u32 m0, s47, 53760
    v_exp_f32 v21, v21
    s_nop 0
    buffer_load_dwordx4 off, s[20:23], s46 offset:0 lds
    v_exp_f32 v22, v22
    s_nop 0
    ds_read_b64_tr_b16 a[194:195], v2 offset:37120
    v_perm_b32 v34, v21, v20, s100
    s_add_u32 m0, s47, 53792
    v_exp_f32 v23, v23
    s_nop 0
    buffer_load_dwordx4 off, s[20:23], s46 offset:1024 lds
    v_exp_f32 v24, v24
    s_nop 0
    ds_read_b64_tr_b16 a[196:197], v2 offset:37376
    v_perm_b32 v35, v23, v22, s100
    s_add_u32 m0, s47, 53824
    v_exp_f32 v25, v25
    s_nop 0
    buffer_load_dwordx4 off, s[20:23], s46 offset:2048 lds
    v_exp_f32 v26, v26
    s_nop 0
    ds_read_b64_tr_b16 a[198:199], v2 offset:37632
    v_perm_b32 v36, v25, v24, s100
    s_add_u32 m0, s47, 53856
    v_exp_f32 v27, v27
    s_nop 0
    buffer_load_dwordx4 off, s[20:23], s46 offset:3072 lds
    ds_read_b64_tr_b16 a[200:201], v2 offset:36896
    s_nop 0
    v_mfma_f32_16x16x32_bf16 v[16:19], a[64:67], v[80:83], v[52:55]
    v_exp_f32 v28, v28
    v_mfma_f32_16x16x32_bf16 v[16:19], a[68:71], v[84:87], v[16:19]
    ds_read_b64_tr_b16 a[202:203], v2 offset:37152
    v_perm_b32 v37, v27, v26, s100
    v_mfma_f32_16x16x32_bf16 v[16:19], a[72:75], v[88:91], v[16:19]
    v_exp_f32 v29, v29
    v_mfma_f32_16x16x32_bf16 v[16:19], a[76:79], v[92:95], v[16:19]
    ds_read_b64_tr_b16 a[204:205], v2 offset:37408
    v_mov_b32 v224, 0
    v_mfma_f32_16x16x32_bf16 v[20:23], a[80:83], v[80:83], v[52:55]
    v_exp_f32 v30, v30
    v_mfma_f32_16x16x32_bf16 v[20:23], a[84:87], v[84:87], v[20:23]
    ds_read_b64_tr_b16 a[206:207], v2 offset:37664
    v_perm_b32 v38, v29, v28, s100
    v_mfma_f32_16x16x32_bf16 v[20:23], a[88:91], v[88:91], v[20:23]
    v_exp_f32 v31, v31
    v_mfma_f32_16x16x32_bf16 v[20:23], a[92:95], v[92:95], v[20:23]
    ds_read_b64_tr_b16 a[208:209], v2 offset:36928
    v_mov_b32 v225, 0
    v_mfma_f32_16x16x32_bf16 v[24:27], a[96:99], v[80:83], v[52:55]
    v_exp_f32 v16, v16
    v_mfma_f32_16x16x32_bf16 v[24:27], a[100:103], v[84:87], v[24:27]
    ds_read_b64_tr_b16 a[210:211], v2 offset:37184
    v_perm_b32 v39, v31, v30, s100
    v_mfma_f32_16x16x32_bf16 v[24:27], a[104:107], v[88:91], v[24:27]
    v_exp_f32 v17, v17
    v_mfma_f32_16x16x32_bf16 v[24:27], a[108:111], v[92:95], v[24:27]
    ds_read_b64_tr_b16 a[212:213], v2 offset:37440
    v_mov_b32 v226, 0
    v_mfma_f32_16x16x32_bf16 v[28:31], a[112:115], v[80:83], v[52:55]
    v_exp_f32 v18, v18
    v_mfma_f32_16x16x32_bf16 v[28:31], a[116:119], v[84:87], v[28:31]
    ds_read_b64_tr_b16 a[214:215], v2 offset:37696
    v_perm_b32 v40, v17, v16, s100
    v_mfma_f32_16x16x32_bf16 v[28:31], a[120:123], v[88:91], v[28:31]
    s_waitcnt lgkmcnt(12)
    v_exp_f32 v19, v19
    v_mfma_f32_16x16x32_bf16 v[28:31], a[124:127], v[92:95], v[28:31]
    ds_read_b64_tr_b16 a[216:217], v2 offset:36960
    v_mov_b32 v227, 0
    v_mfma_f32_16x16x32_bf16 v[128:131], a[128:131], v[32:35], 0
    v_exp_f32 v20, v20
    v_mfma_f32_16x16x32_bf16 v[128:131], a[132:135], v[36:39], v[128:131]
    ds_read_b64_tr_b16 a[218:219], v2 offset:37216
    v_perm_b32 v41, v19, v18, s100
    v_mfma_f32_16x16x32_bf16 v[132:135], a[136:139], v[32:35], 0
    v_exp_f32 v21, v21
    v_mfma_f32_16x16x32_bf16 v[132:135], a[140:143], v[36:39], v[132:135]
    ds_read_b64_tr_b16 a[220:221], v2 offset:37472
    v_mov_b32 v228, 0
    v_mfma_f32_16x16x32_bf16 v[136:139], a[144:147], v[32:35], 0
    v_exp_f32 v22, v22
    v_mfma_f32_16x16x32_bf16 v[136:139], a[148:151], v[36:39], v[136:139]
    ds_read_b64_tr_b16 a[222:223], v2 offset:37728
    v_perm_b32 v42, v21, v20, s100
    v_mfma_f32_16x16x32_bf16 v[140:143], a[152:155], v[32:35], 0
    v_exp_f32 v23, v23
    v_mfma_f32_16x16x32_bf16 v[140:143], a[156:159], v[36:39], v[140:143]
    ds_read_b64_tr_b16 a[224:225], v2 offset:36992
    v_mov_b32 v229, 0
    v_mfma_f32_16x16x32_bf16 v[144:147], a[160:163], v[32:35], 0
    v_exp_f32 v24, v24
    v_mfma_f32_16x16x32_bf16 v[144:147], a[164:167], v[36:39], v[144:147]
    ds_read_b64_tr_b16 a[226:227], v2 offset:37248
    v_perm_b32 v43, v23, v22, s100
    v_mfma_f32_16x16x32_bf16 v[148:151], a[168:171], v[32:35], 0
    v_exp_f32 v25, v25
    v_mfma_f32_16x16x32_bf16 v[148:151], a[172:175], v[36:39], v[148:151]
    ds_read_b64_tr_b16 a[228:229], v2 offset:37504
    v_mov_b32 v230, 0
    v_mfma_f32_16x16x32_bf16 v[152:155], a[176:179], v[32:35], 0
    v_exp_f32 v26, v26
    v_mfma_f32_16x16x32_bf16 v[152:155], a[180:183], v[36:39], v[152:155]
    ds_read_b64_tr_b16 a[230:231], v2 offset:37760
    v_perm_b32 v44, v25, v24, s100
    v_mfma_f32_16x16x32_bf16 v[156:159], a[184:187], v[32:35], 0
    v_exp_f32 v27, v27
    v_mfma_f32_16x16x32_bf16 v[156:159], a[188:191], v[36:39], v[156:159]
    ds_read_b64_tr_b16 a[232:233], v2 offset:37024
    v_mov_b32 v231, 0
    v_smfmac_f32_16x16x64_bf16 a[0:3], a[16:19], v[32:39], v11
    ds_read_b64_tr_b16 a[234:235], v2 offset:37280
    v_mov_b32 v232, 0
    v_mfma_f32_16x16x32_bf16 v[16:19], a[64:67], v[96:99], v[56:59]
    v_exp_f32 v28, v28
    v_mfma_f32_16x16x32_bf16 v[16:19], a[68:71], v[100:103], v[16:19]
    ds_read_b64_tr_b16 a[236:237], v2 offset:37536
    v_perm_b32 v45, v27, v26, s100
    v_mfma_f32_16x16x32_bf16 v[16:19], a[72:75], v[104:107], v[16:19]
    v_exp_f32 v29, v29
    v_mfma_f32_16x16x32_bf16 v[16:19], a[76:79], v[108:111], v[16:19]
    ds_read_b64_tr_b16 a[238:239], v2 offset:37792
    v_mov_b32 v233, 0
    v_mfma_f32_16x16x32_bf16 v[20:23], a[80:83], v[96:99], v[56:59]
    v_exp_f32 v30, v30
    v_mfma_f32_16x16x32_bf16 v[20:23], a[84:87], v[100:103], v[20:23]
    ds_read_b64_tr_b16 a[240:241], v2 offset:37056
    v_perm_b32 v46, v29, v28, s100
    v_mfma_f32_16x16x32_bf16 v[20:23], a[88:91], v[104:107], v[20:23]
    v_exp_f32 v31, v31
    v_mfma_f32_16x16x32_bf16 v[20:23], a[92:95], v[108:111], v[20:23]
    ds_read_b64_tr_b16 a[242:243], v2 offset:37312
    v_mov_b32 v234, 0
    v_mfma_f32_16x16x32_bf16 v[24:27], a[96:99], v[96:99], v[56:59]
    v_exp_f32 v16, v16
    v_mfma_f32_16x16x32_bf16 v[24:27], a[100:103], v[100:103], v[24:27]
    ds_read_b64_tr_b16 a[244:245], v2 offset:37568
    v_perm_b32 v47, v31, v30, s100
    v_mfma_f32_16x16x32_bf16 v[24:27], a[104:107], v[104:107], v[24:27]
    v_exp_f32 v17, v17
    v_mfma_f32_16x16x32_bf16 v[24:27], a[108:111], v[108:111], v[24:27]
    ds_read_b64_tr_b16 a[246:247], v2 offset:37824
    v_mov_b32 v235, 0
    v_mfma_f32_16x16x32_bf16 v[28:31], a[112:115], v[96:99], v[56:59]
    v_exp_f32 v18, v18
    v_mfma_f32_16x16x32_bf16 v[28:31], a[116:119], v[100:103], v[28:31]
    ds_read_b64_tr_b16 a[248:249], v2 offset:37088
    v_perm_b32 v32, v17, v16, s100
    v_mfma_f32_16x16x32_bf16 v[28:31], a[120:123], v[104:107], v[28:31]
    v_exp_f32 v19, v19
    v_mfma_f32_16x16x32_bf16 v[28:31], a[124:127], v[108:111], v[28:31]
    ds_read_b64_tr_b16 a[250:251], v2 offset:37344
    v_mov_b32 v236, 0
    v_mfma_f32_16x16x32_bf16 v[160:163], a[128:131], v[40:43], 0
    v_exp_f32 v20, v20
    v_mfma_f32_16x16x32_bf16 v[160:163], a[132:135], v[44:47], v[160:163]
    ds_read_b64_tr_b16 a[252:253], v2 offset:37600
    v_perm_b32 v33, v19, v18, s100
    v_mfma_f32_16x16x32_bf16 v[164:167], a[136:139], v[40:43], 0
    v_exp_f32 v21, v21
    v_mfma_f32_16x16x32_bf16 v[164:167], a[140:143], v[44:47], v[164:167]
    ds_read_b64_tr_b16 a[254:255], v2 offset:37856
    v_mov_b32 v237, 0
    v_mfma_f32_16x16x32_bf16 v[168:171], a[144:147], v[40:43], 0
    v_exp_f32 v22, v22
    v_mfma_f32_16x16x32_bf16 v[168:171], a[148:151], v[44:47], v[168:171]
    v_perm_b32 v34, v21, v20, s100
    v_mov_b32 v238, 0
    v_mfma_f32_16x16x32_bf16 v[172:175], a[152:155], v[40:43], 0
    v_exp_f32 v23, v23
    v_mfma_f32_16x16x32_bf16 v[172:175], a[156:159], v[44:47], v[172:175]
    v_mov_b32 v239, 0
    v_mov_b32 v240, 0
    v_mfma_f32_16x16x32_bf16 v[176:179], a[160:163], v[40:43], 0
    v_exp_f32 v24, v24
    v_mfma_f32_16x16x32_bf16 v[176:179], a[164:167], v[44:47], v[176:179]
    v_perm_b32 v35, v23, v22, s100
    v_mov_b32 v241, 0
    v_mfma_f32_16x16x32_bf16 v[180:183], a[168:171], v[40:43], 0
    v_exp_f32 v25, v25
    v_mfma_f32_16x16x32_bf16 v[180:183], a[172:175], v[44:47], v[180:183]
    v_mov_b32 v242, 0
    v_mov_b32 v243, 0
    v_mfma_f32_16x16x32_bf16 v[184:187], a[176:179], v[40:43], 0
    v_exp_f32 v26, v26
    v_mfma_f32_16x16x32_bf16 v[184:187], a[180:183], v[44:47], v[184:187]
    v_perm_b32 v36, v25, v24, s100
    v_mov_b32 v244, 0
    v_mfma_f32_16x16x32_bf16 v[188:191], a[184:187], v[40:43], 0
    v_exp_f32 v27, v27
    v_mfma_f32_16x16x32_bf16 v[188:191], a[188:191], v[44:47], v[188:191]
    v_mov_b32 v245, 0
    v_mov_b32 v246, 0
    v_smfmac_f32_16x16x64_bf16 a[4:7], a[16:19], v[40:47], v11
    v_mov_b32 v247, 0
    v_mov_b32 v248, 0
    v_mfma_f32_16x16x32_bf16 v[16:19], a[64:67], v[112:115], v[60:63]
    v_exp_f32 v28, v28
    v_mfma_f32_16x16x32_bf16 v[16:19], a[68:71], v[116:119], v[16:19]
    ds_read_b128 a[64:67], v1 offset:36864
    v_perm_b32 v37, v27, v26, s100
    v_mfma_f32_16x16x32_bf16 v[16:19], a[72:75], v[120:123], v[16:19]
    v_exp_f32 v29, v29
    v_mfma_f32_16x16x32_bf16 v[16:19], a[76:79], v[124:127], v[16:19]
    ds_read_b128 a[68:71], v1 offset:36928
    v_mov_b32 v249, 0
    v_mfma_f32_16x16x32_bf16 v[20:23], a[80:83], v[112:115], v[60:63]
    v_exp_f32 v30, v30
    v_mfma_f32_16x16x32_bf16 v[20:23], a[84:87], v[116:119], v[20:23]
    ds_read_b128 a[72:75], v1 offset:36992
    v_perm_b32 v38, v29, v28, s100
    v_mfma_f32_16x16x32_bf16 v[20:23], a[88:91], v[120:123], v[20:23]
    v_exp_f32 v31, v31
    v_mfma_f32_16x16x32_bf16 v[20:23], a[92:95], v[124:127], v[20:23]
    ds_read_b128 a[76:79], v1 offset:37056
    v_mov_b32 v250, 0
    v_mfma_f32_16x16x32_bf16 v[24:27], a[96:99], v[112:115], v[60:63]
    v_exp_f32 v16, v16
    v_mfma_f32_16x16x32_bf16 v[24:27], a[100:103], v[116:119], v[24:27]
    ds_read_b128 a[80:83], v1 offset:37120
    v_perm_b32 v39, v31, v30, s100
    v_mfma_f32_16x16x32_bf16 v[24:27], a[104:107], v[120:123], v[24:27]
    v_exp_f32 v17, v17
    v_mfma_f32_16x16x32_bf16 v[24:27], a[108:111], v[124:127], v[24:27]
    ds_read_b128 a[84:87], v1 offset:37184
    v_mov_b32 v251, 0
    v_mfma_f32_16x16x32_bf16 v[28:31], a[112:115], v[112:115], v[60:63]
    v_exp_f32 v18, v18
    v_mfma_f32_16x16x32_bf16 v[28:31], a[116:119], v[116:119], v[28:31]
    ds_read_b128 a[88:91], v1 offset:37248
    v_perm_b32 v40, v17, v16, s100
    v_mfma_f32_16x16x32_bf16 v[28:31], a[120:123], v[120:123], v[28:31]
    v_exp_f32 v19, v19
    v_mfma_f32_16x16x32_bf16 v[28:31], a[124:127], v[124:127], v[28:31]
    ds_read_b128 a[92:95], v1 offset:37312
    v_mov_b32 v252, 0
    v_mfma_f32_16x16x32_bf16 v[192:195], a[128:131], v[32:35], 0
    v_exp_f32 v20, v20
    v_mfma_f32_16x16x32_bf16 v[192:195], a[132:135], v[36:39], v[192:195]
    ds_read_b128 a[96:99], v1 offset:37376
    v_perm_b32 v41, v19, v18, s100
    v_mfma_f32_16x16x32_bf16 v[196:199], a[136:139], v[32:35], 0
    v_exp_f32 v21, v21
    v_mfma_f32_16x16x32_bf16 v[196:199], a[140:143], v[36:39], v[196:199]
    ds_read_b128 a[100:103], v1 offset:37440
    v_mov_b32 v253, 0
    v_mfma_f32_16x16x32_bf16 v[200:203], a[144:147], v[32:35], 0
    v_exp_f32 v22, v22
    v_mfma_f32_16x16x32_bf16 v[200:203], a[148:151], v[36:39], v[200:203]
    ds_read_b128 a[104:107], v1 offset:37504
    v_perm_b32 v42, v21, v20, s100
    v_mfma_f32_16x16x32_bf16 v[204:207], a[152:155], v[32:35], 0
    v_exp_f32 v23, v23
    v_mfma_f32_16x16x32_bf16 v[204:207], a[156:159], v[36:39], v[204:207]
    ds_read_b128 a[108:111], v1 offset:37568
    v_mov_b32 v254, 0
    v_mfma_f32_16x16x32_bf16 v[208:211], a[160:163], v[32:35], 0
    v_exp_f32 v24, v24
    v_mfma_f32_16x16x32_bf16 v[208:211], a[164:167], v[36:39], v[208:211]
    ds_read_b128 a[112:115], v1 offset:37632
    v_perm_b32 v43, v23, v22, s100
    v_mfma_f32_16x16x32_bf16 v[212:215], a[168:171], v[32:35], 0
    v_exp_f32 v25, v25
    v_mfma_f32_16x16x32_bf16 v[212:215], a[172:175], v[36:39], v[212:215]
    ds_read_b128 a[116:119], v1 offset:37696
    v_mov_b32 v255, 0
    v_mfma_f32_16x16x32_bf16 v[216:219], a[176:179], v[32:35], 0
    v_exp_f32 v26, v26
    v_mfma_f32_16x16x32_bf16 v[216:219], a[180:183], v[36:39], v[216:219]
    ds_read_b128 a[120:123], v1 offset:37760
    v_perm_b32 v44, v25, v24, s100
    v_mfma_f32_16x16x32_bf16 v[220:223], a[184:187], v[32:35], 0
    v_exp_f32 v27, v27
    v_mfma_f32_16x16x32_bf16 v[220:223], a[188:191], v[36:39], v[220:223]
    ds_read_b128 a[124:127], v1 offset:37824
    v_smfmac_f32_16x16x64_bf16 a[8:11], a[16:19], v[32:39], v11
    s_waitcnt lgkmcnt(12)
.p2align 5
L2_loop:
    v_mfma_f32_16x16x32_bf16 v[16:19], a[64:67], v[64:67], v[48:51]
    s_sub_u32 s47, s47, s48
    v_exp_f32 v28, v28
    v_mfma_f32_16x16x32_bf16 v[16:19], a[68:71], v[68:71], v[16:19]
    v_perm_b32 v45, v27, v26, s100
    v_add_u32 v1, s48, v1
    v_mfma_f32_16x16x32_bf16 v[16:19], a[72:75], v[72:75], v[16:19]
    v_exp_f32 v29, v29
    v_mfma_f32_16x16x32_bf16 v[16:19], a[76:79], v[76:79], v[16:19]
    s_waitcnt lgkmcnt(8)
    v_mfma_f32_16x16x32_bf16 v[20:23], a[80:83], v[64:67], v[48:51]
    v_exp_f32 v30, v30
    v_mfma_f32_16x16x32_bf16 v[20:23], a[84:87], v[68:71], v[20:23]
    v_perm_b32 v46, v29, v28, s100
    v_add_u32 v2, s48, v2
    v_mfma_f32_16x16x32_bf16 v[20:23], a[88:91], v[72:75], v[20:23]
    v_exp_f32 v31, v31
    v_mfma_f32_16x16x32_bf16 v[20:23], a[92:95], v[76:79], v[20:23]
    s_waitcnt lgkmcnt(4)
    v_mfma_f32_16x16x32_bf16 v[24:27], a[96:99], v[64:67], v[48:51]
    s_sub_u32 s48, 0, s48
    v_exp_f32 v16, v16
    v_mfma_f32_16x16x32_bf16 v[24:27], a[100:103], v[68:71], v[24:27]
L2_pad4:
    s_cbranch_execz L2_pad8
    v_perm_b32 v47, v31, v30, s100
    v_mfma_f32_16x16x32_bf16 v[24:27], a[104:107], v[72:75], v[24:27]
    v_exp_f32 v17, v17
    v_mfma_f32_16x16x32_bf16 v[24:27], a[108:111], v[76:79], v[24:27]
    s_waitcnt lgkmcnt(0)
    v_mfma_f32_16x16x32_bf16 v[28:31], a[112:115], v[64:67], v[48:51]
    v_exp_f32 v18, v18
    v_mfma_f32_16x16x32_bf16 v[28:31], a[116:119], v[68:71], v[28:31]
    v_perm_b32 v32, v17, v16, s100
    v_mfma_f32_16x16x32_bf16 v[28:31], a[120:123], v[72:75], v[28:31]
    v_exp_f32 v19, v19
    v_mfma_f32_16x16x32_bf16 v[28:31], a[124:127], v[76:79], v[28:31]
    s_waitcnt vmcnt(0)
    s_barrier
    v_mfma_f32_16x16x32_bf16 v[224:227], a[128:131], v[40:43], v[224:227]
    v_exp_f32 v20, v20
    v_mfma_f32_16x16x32_bf16 v[224:227], a[132:135], v[44:47], v[224:227]
    ds_read_b64_tr_b16 a[128:129], v2 offset:0
    v_perm_b32 v33, v19, v18, s100
    v_mfma_f32_16x16x32_bf16 v[228:231], a[136:139], v[40:43], v[228:231]
    s_add_u32 m0, s47, 0
    v_exp_f32 v21, v21
    v_mfma_f32_16x16x32_bf16 v[228:231], a[140:143], v[44:47], v[228:231]
    s_add_u32 s46, s46, 16384
    buffer_load_dwordx4 off, s[16:19], s46 offset:0 lds
    v_mfma_f32_16x16x32_bf16 v[232:235], a[144:147], v[40:43], v[232:235]
    v_exp_f32 v22, v22
    v_mfma_f32_16x16x32_bf16 v[232:235], a[148:151], v[44:47], v[232:235]
    ds_read_b64_tr_b16 a[130:131], v2 offset:256
    v_perm_b32 v34, v21, v20, s100
    v_mfma_f32_16x16x32_bf16 v[236:239], a[152:155], v[40:43], v[236:239]
    s_add_u32 m0, s47, 32
    v_exp_f32 v23, v23
    v_mfma_f32_16x16x32_bf16 v[236:239], a[156:159], v[44:47], v[236:239]
    buffer_load_dwordx4 off, s[16:19], s46 offset:1024 lds
    v_mfma_f32_16x16x32_bf16 v[240:243], a[160:163], v[40:43], v[240:243]
    v_exp_f32 v24, v24
    v_mfma_f32_16x16x32_bf16 v[240:243], a[164:167], v[44:47], v[240:243]
    ds_read_b64_tr_b16 a[132:133], v2 offset:512
    v_perm_b32 v35, v23, v22, s100
    v_mfma_f32_16x16x32_bf16 v[244:247], a[168:171], v[40:43], v[244:247]
    s_add_u32 m0, s47, 64
    v_exp_f32 v25, v25
    v_mfma_f32_16x16x32_bf16 v[244:247], a[172:175], v[44:47], v[244:247]
    buffer_load_dwordx4 off, s[16:19], s46 offset:2048 lds
    v_mfma_f32_16x16x32_bf16 v[248:251], a[176:179], v[40:43], v[248:251]
    v_exp_f32 v26, v26
    v_mfma_f32_16x16x32_bf16 v[248:251], a[180:183], v[44:47], v[248:251]
    ds_read_b64_tr_b16 a[134:135], v2 offset:768
    v_perm_b32 v36, v25, v24, s100
    v_mfma_f32_16x16x32_bf16 v[252:255], a[184:187], v[40:43], v[252:255]
    s_add_u32 m0, s47, 96
    v_exp_f32 v27, v27
    v_mfma_f32_16x16x32_bf16 v[252:255], a[188:191], v[44:47], v[252:255]
    buffer_load_dwordx4 off, s[16:19], s46 offset:3072 lds
    v_smfmac_f32_16x16x64_bf16 a[12:15], a[16:19], v[40:47], v11
    ds_read_b64_tr_b16 a[136:137], v2 offset:32
    v_mfma_f32_16x16x32_bf16 v[16:19], a[64:67], v[80:83], v[52:55]
    v_exp_f32 v28, v28
    v_mfma_f32_16x16x32_bf16 v[16:19], a[68:71], v[84:87], v[16:19]
    ds_read_b64_tr_b16 a[138:139], v2 offset:288
    v_perm_b32 v37, v27, v26, s100
    v_mfma_f32_16x16x32_bf16 v[16:19], a[72:75], v[88:91], v[16:19]
    s_add_u32 m0, s47, 16896
    v_exp_f32 v29, v29
    v_mfma_f32_16x16x32_bf16 v[16:19], a[76:79], v[92:95], v[16:19]
    buffer_load_dwordx4 off, s[20:23], s46 offset:0 lds
    v_mfma_f32_16x16x32_bf16 v[20:23], a[80:83], v[80:83], v[52:55]
    v_exp_f32 v30, v30
    v_mfma_f32_16x16x32_bf16 v[20:23], a[84:87], v[84:87], v[20:23]
    ds_read_b64_tr_b16 a[140:141], v2 offset:544
    v_perm_b32 v38, v29, v28, s100
    v_mfma_f32_16x16x32_bf16 v[20:23], a[88:91], v[88:91], v[20:23]
    s_add_u32 m0, s47, 16928
    v_exp_f32 v31, v31
    v_mfma_f32_16x16x32_bf16 v[20:23], a[92:95], v[92:95], v[20:23]
    buffer_load_dwordx4 off, s[20:23], s46 offset:1024 lds
    v_mfma_f32_16x16x32_bf16 v[24:27], a[96:99], v[80:83], v[52:55]
    v_exp_f32 v16, v16
    v_mfma_f32_16x16x32_bf16 v[24:27], a[100:103], v[84:87], v[24:27]
    ds_read_b64_tr_b16 a[142:143], v2 offset:800
    v_perm_b32 v39, v31, v30, s100
    v_mfma_f32_16x16x32_bf16 v[24:27], a[104:107], v[88:91], v[24:27]
    s_add_u32 m0, s47, 16960
    v_exp_f32 v17, v17
    v_mfma_f32_16x16x32_bf16 v[24:27], a[108:111], v[92:95], v[24:27]
    buffer_load_dwordx4 off, s[20:23], s46 offset:2048 lds
    v_mfma_f32_16x16x32_bf16 v[28:31], a[112:115], v[80:83], v[52:55]
    v_exp_f32 v18, v18
    v_mfma_f32_16x16x32_bf16 v[28:31], a[116:119], v[84:87], v[28:31]
    ds_read_b64_tr_b16 a[144:145], v2 offset:64
    v_perm_b32 v40, v17, v16, s100
    v_mfma_f32_16x16x32_bf16 v[28:31], a[120:123], v[88:91], v[28:31]
    s_add_u32 m0, s47, 16992
    v_exp_f32 v19, v19
    v_mfma_f32_16x16x32_bf16 v[28:31], a[124:127], v[92:95], v[28:31]
    buffer_load_dwordx4 off, s[20:23], s46 offset:3072 lds
    v_mfma_f32_16x16x32_bf16 v[128:131], a[192:195], v[32:35], v[128:131]
    v_exp_f32 v20, v20
    v_mfma_f32_16x16x32_bf16 v[128:131], a[196:199], v[36:39], v[128:131]
    ds_read_b64_tr_b16 a[146:147], v2 offset:320
    v_perm_b32 v41, v19, v18, s100
    v_mfma_f32_16x16x32_bf16 v[132:135], a[200:203], v[32:35], v[132:135]
    v_exp_f32 v21, v21
    v_mfma_f32_16x16x32_bf16 v[132:135], a[204:207], v[36:39], v[132:135]
    ds_read_b64_tr_b16 a[148:149], v2 offset:576
    v_mfma_f32_16x16x32_bf16 v[136:139], a[208:211], v[32:35], v[136:139]
    v_exp_f32 v22, v22
    v_mfma_f32_16x16x32_bf16 v[136:139], a[212:215], v[36:39], v[136:139]
    ds_read_b64_tr_b16 a[150:151], v2 offset:832
    v_perm_b32 v42, v21, v20, s100
    v_mfma_f32_16x16x32_bf16 v[140:143], a[216:219], v[32:35], v[140:143]
    v_exp_f32 v23, v23
    v_mfma_f32_16x16x32_bf16 v[140:143], a[220:223], v[36:39], v[140:143]
    ds_read_b64_tr_b16 a[152:153], v2 offset:96
    ds_read_b64_tr_b16 a[154:155], v2 offset:352
    v_mfma_f32_16x16x32_bf16 v[144:147], a[224:227], v[32:35], v[144:147]
    v_exp_f32 v24, v24
    v_mfma_f32_16x16x32_bf16 v[144:147], a[228:231], v[36:39], v[144:147]
    ds_read_b64_tr_b16 a[156:157], v2 offset:608
    v_perm_b32 v43, v23, v22, s100
    v_mfma_f32_16x16x32_bf16 v[148:151], a[232:235], v[32:35], v[148:151]
    v_exp_f32 v25, v25
    v_mfma_f32_16x16x32_bf16 v[148:151], a[236:239], v[36:39], v[148:151]
    ds_read_b64_tr_b16 a[158:159], v2 offset:864
    ds_read_b64_tr_b16 a[160:161], v2 offset:128
    v_mfma_f32_16x16x32_bf16 v[152:155], a[240:243], v[32:35], v[152:155]
    v_exp_f32 v26, v26
    v_mfma_f32_16x16x32_bf16 v[152:155], a[244:247], v[36:39], v[152:155]
    ds_read_b64_tr_b16 a[162:163], v2 offset:384
    v_perm_b32 v44, v25, v24, s100
    v_mfma_f32_16x16x32_bf16 v[156:159], a[248:251], v[32:35], v[156:159]
    v_exp_f32 v27, v27
    v_mfma_f32_16x16x32_bf16 v[156:159], a[252:255], v[36:39], v[156:159]
    ds_read_b64_tr_b16 a[164:165], v2 offset:640
    ds_read_b64_tr_b16 a[166:167], v2 offset:896
    v_smfmac_f32_16x16x64_bf16 a[0:3], a[16:19], v[32:39], v11
    ds_read_b64_tr_b16 a[168:169], v2 offset:160
    ds_read_b64_tr_b16 a[170:171], v2 offset:416
    v_mfma_f32_16x16x32_bf16 v[16:19], a[64:67], v[96:99], v[56:59]
    v_exp_f32 v28, v28
    v_mfma_f32_16x16x32_bf16 v[16:19], a[68:71], v[100:103], v[16:19]
    ds_read_b64_tr_b16 a[172:173], v2 offset:672
    v_perm_b32 v45, v27, v26, s100
    v_mfma_f32_16x16x32_bf16 v[16:19], a[72:75], v[104:107], v[16:19]
    s_add_u32 m0, s47, 36864
    v_exp_f32 v29, v29
    v_mfma_f32_16x16x32_bf16 v[16:19], a[76:79], v[108:111], v[16:19]
    s_add_u32 s46, s46, 16384
    buffer_load_dwordx4 off, s[16:19], s46 offset:0 lds
    v_mfma_f32_16x16x32_bf16 v[20:23], a[80:83], v[96:99], v[56:59]
    v_exp_f32 v30, v30
    v_mfma_f32_16x16x32_bf16 v[20:23], a[84:87], v[100:103], v[20:23]
    ds_read_b64_tr_b16 a[174:175], v2 offset:928
    v_perm_b32 v46, v29, v28, s100
    v_mfma_f32_16x16x32_bf16 v[20:23], a[88:91], v[104:107], v[20:23]
    s_add_u32 m0, s47, 36896
    v_exp_f32 v31, v31
    v_mfma_f32_16x16x32_bf16 v[20:23], a[92:95], v[108:111], v[20:23]
    buffer_load_dwordx4 off, s[16:19], s46 offset:1024 lds
    v_mfma_f32_16x16x32_bf16 v[24:27], a[96:99], v[96:99], v[56:59]
    v_exp_f32 v16, v16
    v_mfma_f32_16x16x32_bf16 v[24:27], a[100:103], v[100:103], v[24:27]
    ds_read_b64_tr_b16 a[176:177], v2 offset:192
    v_perm_b32 v47, v31, v30, s100
    v_mfma_f32_16x16x32_bf16 v[24:27], a[104:107], v[104:107], v[24:27]
    s_add_u32 m0, s47, 36928
    v_exp_f32 v17, v17
    v_mfma_f32_16x16x32_bf16 v[24:27], a[108:111], v[108:111], v[24:27]
    buffer_load_dwordx4 off, s[16:19], s46 offset:2048 lds
    v_mfma_f32_16x16x32_bf16 v[28:31], a[112:115], v[96:99], v[56:59]
    v_exp_f32 v18, v18
    v_mfma_f32_16x16x32_bf16 v[28:31], a[116:119], v[100:103], v[28:31]
    ds_read_b64_tr_b16 a[178:179], v2 offset:448
    v_perm_b32 v32, v17, v16, s100
    v_mfma_f32_16x16x32_bf16 v[28:31], a[120:123], v[104:107], v[28:31]
    s_add_u32 m0, s47, 36960
    v_exp_f32 v19, v19
    v_mfma_f32_16x16x32_bf16 v[28:31], a[124:127], v[108:111], v[28:31]
    buffer_load_dwordx4 off, s[16:19], s46 offset:3072 lds
    v_mfma_f32_16x16x32_bf16 v[160:163], a[192:195], v[40:43], v[160:163]
    v_exp_f32 v20, v20
    v_mfma_f32_16x16x32_bf16 v[160:163], a[196:199], v[44:47], v[160:163]
    ds_read_b64_tr_b16 a[180:181], v2 offset:704
    v_perm_b32 v33, v19, v18, s100
    v_mfma_f32_16x16x32_bf16 v[164:167], a[200:203], v[40:43], v[164:167]
    s_add_u32 m0, s47, 53760
    v_exp_f32 v21, v21
    v_mfma_f32_16x16x32_bf16 v[164:167], a[204:207], v[44:47], v[164:167]
    buffer_load_dwordx4 off, s[20:23], s46 offset:0 lds
    v_mfma_f32_16x16x32_bf16 v[168:171], a[208:211], v[40:43], v[168:171]
    v_exp_f32 v22, v22
    v_mfma_f32_16x16x32_bf16 v[168:171], a[212:215], v[44:47], v[168:171]
    ds_read_b64_tr_b16 a[182:183], v2 offset:960
    v_perm_b32 v34, v21, v20, s100
    v_mfma_f32_16x16x32_bf16 v[172:175], a[216:219], v[40:43], v[172:175]
    s_add_u32 m0, s47, 53792
    v_exp_f32 v23, v23
    v_mfma_f32_16x16x32_bf16 v[172:175], a[220:223], v[44:47], v[172:175]
    buffer_load_dwordx4 off, s[20:23], s46 offset:1024 lds
    v_mfma_f32_16x16x32_bf16 v[176:179], a[224:227], v[40:43], v[176:179]
    v_exp_f32 v24, v24
    v_mfma_f32_16x16x32_bf16 v[176:179], a[228:231], v[44:47], v[176:179]
    ds_read_b64_tr_b16 a[184:185], v2 offset:224
    v_perm_b32 v35, v23, v22, s100
    v_mfma_f32_16x16x32_bf16 v[180:183], a[232:235], v[40:43], v[180:183]
    s_add_u32 m0, s47, 53824
    v_exp_f32 v25, v25
    v_mfma_f32_16x16x32_bf16 v[180:183], a[236:239], v[44:47], v[180:183]
    buffer_load_dwordx4 off, s[20:23], s46 offset:2048 lds
    v_mfma_f32_16x16x32_bf16 v[184:187], a[240:243], v[40:43], v[184:187]
    v_exp_f32 v26, v26
    v_mfma_f32_16x16x32_bf16 v[184:187], a[244:247], v[44:47], v[184:187]
    ds_read_b64_tr_b16 a[186:187], v2 offset:480
    v_perm_b32 v36, v25, v24, s100
    v_mfma_f32_16x16x32_bf16 v[188:191], a[248:251], v[40:43], v[188:191]
    s_add_u32 m0, s47, 53856
    v_exp_f32 v27, v27
    v_mfma_f32_16x16x32_bf16 v[188:191], a[252:255], v[44:47], v[188:191]
    buffer_load_dwordx4 off, s[20:23], s46 offset:3072 lds
    v_smfmac_f32_16x16x64_bf16 a[4:7], a[16:19], v[40:47], v11
    ds_read_b64_tr_b16 a[188:189], v2 offset:736
    ds_read_b64_tr_b16 a[190:191], v2 offset:992
    v_mfma_f32_16x16x32_bf16 v[16:19], a[64:67], v[112:115], v[60:63]
    v_exp_f32 v28, v28
    v_mfma_f32_16x16x32_bf16 v[16:19], a[68:71], v[116:119], v[16:19]
    ds_read_b128 a[64:67], v1 offset:0
    v_perm_b32 v37, v27, v26, s100
    v_mfma_f32_16x16x32_bf16 v[16:19], a[72:75], v[120:123], v[16:19]
    v_exp_f32 v29, v29
    v_mfma_f32_16x16x32_bf16 v[16:19], a[76:79], v[124:127], v[16:19]
    ds_read_b128 a[68:71], v1 offset:64
    v_mfma_f32_16x16x32_bf16 v[20:23], a[80:83], v[112:115], v[60:63]
    v_exp_f32 v30, v30
    v_mfma_f32_16x16x32_bf16 v[20:23], a[84:87], v[116:119], v[20:23]
    ds_read_b128 a[72:75], v1 offset:128
    v_perm_b32 v38, v29, v28, s100
    v_mfma_f32_16x16x32_bf16 v[20:23], a[88:91], v[120:123], v[20:23]
    v_exp_f32 v31, v31
    v_mfma_f32_16x16x32_bf16 v[20:23], a[92:95], v[124:127], v[20:23]
    ds_read_b128 a[76:79], v1 offset:192
    v_mfma_f32_16x16x32_bf16 v[24:27], a[96:99], v[112:115], v[60:63]
    v_exp_f32 v16, v16
    v_mfma_f32_16x16x32_bf16 v[24:27], a[100:103], v[116:119], v[24:27]
    ds_read_b128 a[80:83], v1 offset:256
    v_perm_b32 v39, v31, v30, s100
    v_mfma_f32_16x16x32_bf16 v[24:27], a[104:107], v[120:123], v[24:27]
    v_exp_f32 v17, v17
    v_mfma_f32_16x16x32_bf16 v[24:27], a[108:111], v[124:127], v[24:27]
    ds_read_b128 a[84:87], v1 offset:320
    v_mfma_f32_16x16x32_bf16 v[28:31], a[112:115], v[112:115], v[60:63]
    v_exp_f32 v18, v18
    v_mfma_f32_16x16x32_bf16 v[28:31], a[116:119], v[116:119], v[28:31]
    ds_read_b128 a[88:91], v1 offset:384
    v_perm_b32 v40, v17, v16, s100
    v_mfma_f32_16x16x32_bf16 v[28:31], a[120:123], v[120:123], v[28:31]
    v_exp_f32 v19, v19
    v_mfma_f32_16x16x32_bf16 v[28:31], a[124:127], v[124:127], v[28:31]
    ds_read_b128 a[92:95], v1 offset:448
    v_mfma_f32_16x16x32_bf16 v[192:195], a[192:195], v[32:35], v[192:195]
    v_exp_f32 v20, v20
    v_mfma_f32_16x16x32_bf16 v[192:195], a[196:199], v[36:39], v[192:195]
    ds_read_b128 a[96:99], v1 offset:512
    v_perm_b32 v41, v19, v18, s100
    v_mfma_f32_16x16x32_bf16 v[196:199], a[200:203], v[32:35], v[196:199]
    v_exp_f32 v21, v21
    v_mfma_f32_16x16x32_bf16 v[196:199], a[204:207], v[36:39], v[196:199]
    ds_read_b128 a[100:103], v1 offset:576
    v_mfma_f32_16x16x32_bf16 v[200:203], a[208:211], v[32:35], v[200:203]
    v_exp_f32 v22, v22
    v_mfma_f32_16x16x32_bf16 v[200:203], a[212:215], v[36:39], v[200:203]
    ds_read_b128 a[104:107], v1 offset:640
    v_perm_b32 v42, v21, v20, s100
    v_mfma_f32_16x16x32_bf16 v[204:207], a[216:219], v[32:35], v[204:207]
    v_exp_f32 v23, v23
    v_mfma_f32_16x16x32_bf16 v[204:207], a[220:223], v[36:39], v[204:207]
    ds_read_b128 a[108:111], v1 offset:704
    v_mfma_f32_16x16x32_bf16 v[208:211], a[224:227], v[32:35], v[208:211]
    v_exp_f32 v24, v24
    v_mfma_f32_16x16x32_bf16 v[208:211], a[228:231], v[36:39], v[208:211]
    ds_read_b128 a[112:115], v1 offset:768
    v_perm_b32 v43, v23, v22, s100
    v_mfma_f32_16x16x32_bf16 v[212:215], a[232:235], v[32:35], v[212:215]
    v_exp_f32 v25, v25
    v_mfma_f32_16x16x32_bf16 v[212:215], a[236:239], v[36:39], v[212:215]
    ds_read_b128 a[116:119], v1 offset:832
    v_mfma_f32_16x16x32_bf16 v[216:219], a[240:243], v[32:35], v[216:219]
    v_exp_f32 v26, v26
    v_mfma_f32_16x16x32_bf16 v[216:219], a[244:247], v[36:39], v[216:219]
    ds_read_b128 a[120:123], v1 offset:896
    v_perm_b32 v44, v25, v24, s100
    v_mfma_f32_16x16x32_bf16 v[220:223], a[248:251], v[32:35], v[220:223]
    v_exp_f32 v27, v27
    v_mfma_f32_16x16x32_bf16 v[220:223], a[252:255], v[36:39], v[220:223]
    ds_read_b128 a[124:127], v1 offset:960
    v_smfmac_f32_16x16x64_bf16 a[8:11], a[16:19], v[32:39], v11
    s_waitcnt lgkmcnt(12)
    v_mfma_f32_16x16x32_bf16 v[16:19], a[64:67], v[64:67], v[48:51]
    v_exp_f32 v28, v28
    v_mfma_f32_16x16x32_bf16 v[16:19], a[68:71], v[68:71], v[16:19]
    v_perm_b32 v45, v27, v26, s100
    v_mfma_f32_16x16x32_bf16 v[16:19], a[72:75], v[72:75], v[16:19]
    v_exp_f32 v29, v29
    v_mfma_f32_16x16x32_bf16 v[16:19], a[76:79], v[76:79], v[16:19]
    s_waitcnt lgkmcnt(8)
    v_mfma_f32_16x16x32_bf16 v[20:23], a[80:83], v[64:67], v[48:51]
    v_exp_f32 v30, v30
    v_mfma_f32_16x16x32_bf16 v[20:23], a[84:87], v[68:71], v[20:23]
    v_perm_b32 v46, v29, v28, s100
    v_mfma_f32_16x16x32_bf16 v[20:23], a[88:91], v[72:75], v[20:23]
    v_exp_f32 v31, v31
    v_mfma_f32_16x16x32_bf16 v[20:23], a[92:95], v[76:79], v[20:23]
    s_waitcnt lgkmcnt(4)
    v_mfma_f32_16x16x32_bf16 v[24:27], a[96:99], v[64:67], v[48:51]
    v_exp_f32 v16, v16
    v_mfma_f32_16x16x32_bf16 v[24:27], a[100:103], v[68:71], v[24:27]
    v_perm_b32 v47, v31, v30, s100
    v_mfma_f32_16x16x32_bf16 v[24:27], a[104:107], v[72:75], v[24:27]
    v_exp_f32 v17, v17
    v_mfma_f32_16x16x32_bf16 v[24:27], a[108:111], v[76:79], v[24:27]
    s_waitcnt lgkmcnt(0)
    v_mfma_f32_16x16x32_bf16 v[28:31], a[112:115], v[64:67], v[48:51]
    v_exp_f32 v18, v18
    v_mfma_f32_16x16x32_bf16 v[28:31], a[116:119], v[68:71], v[28:31]
    v_perm_b32 v32, v17, v16, s100
    v_mfma_f32_16x16x32_bf16 v[28:31], a[120:123], v[72:75], v[28:31]
    v_exp_f32 v19, v19
    v_mfma_f32_16x16x32_bf16 v[28:31], a[124:127], v[76:79], v[28:31]
    v_mfma_f32_16x16x32_bf16 v[224:227], a[192:195], v[40:43], v[224:227]
    v_exp_f32 v20, v20
    v_mfma_f32_16x16x32_bf16 v[224:227], a[196:199], v[44:47], v[224:227]
    ds_read_b64_tr_b16 a[192:193], v2 offset:36864
    v_perm_b32 v33, v19, v18, s100
    v_mfma_f32_16x16x32_bf16 v[228:231], a[200:203], v[40:43], v[228:231]
    v_exp_f32 v21, v21
    v_mfma_f32_16x16x32_bf16 v[228:231], a[204:207], v[44:47], v[228:231]
    ds_read_b64_tr_b16 a[194:195], v2 offset:37120
    v_mfma_f32_16x16x32_bf16 v[232:235], a[208:211], v[40:43], v[232:235]
    v_exp_f32 v22, v22
    v_mfma_f32_16x16x32_bf16 v[232:235], a[212:215], v[44:47], v[232:235]
    ds_read_b64_tr_b16 a[196:197], v2 offset:37376
    v_perm_b32 v34, v21, v20, s100
    v_mfma_f32_16x16x32_bf16 v[236:239], a[216:219], v[40:43], v[236:239]
    v_exp_f32 v23, v23
    v_mfma_f32_16x16x32_bf16 v[236:239], a[220:223], v[44:47], v[236:239]
    ds_read_b64_tr_b16 a[198:199], v2 offset:37632
    v_mfma_f32_16x16x32_bf16 v[240:243], a[224:227], v[40:43], v[240:243]
    v_exp_f32 v24, v24
    v_mfma_f32_16x16x32_bf16 v[240:243], a[228:231], v[44:47], v[240:243]
    ds_read_b64_tr_b16 a[200:201], v2 offset:36896
    v_perm_b32 v35, v23, v22, s100
    v_mfma_f32_16x16x32_bf16 v[244:247], a[232:235], v[40:43], v[244:247]
    v_exp_f32 v25, v25
    v_mfma_f32_16x16x32_bf16 v[244:247], a[236:239], v[44:47], v[244:247]
    ds_read_b64_tr_b16 a[202:203], v2 offset:37152
    v_mfma_f32_16x16x32_bf16 v[248:251], a[240:243], v[40:43], v[248:251]
    v_exp_f32 v26, v26
    v_mfma_f32_16x16x32_bf16 v[248:251], a[244:247], v[44:47], v[248:251]
    ds_read_b64_tr_b16 a[204:205], v2 offset:37408
    v_perm_b32 v36, v25, v24, s100
    v_mfma_f32_16x16x32_bf16 v[252:255], a[248:251], v[40:43], v[252:255]
    v_exp_f32 v27, v27
    v_mfma_f32_16x16x32_bf16 v[252:255], a[252:255], v[44:47], v[252:255]
    ds_read_b64_tr_b16 a[206:207], v2 offset:37664
    v_smfmac_f32_16x16x64_bf16 a[12:15], a[16:19], v[40:47], v11
    ds_read_b64_tr_b16 a[208:209], v2 offset:36928
    v_mfma_f32_16x16x32_bf16 v[16:19], a[64:67], v[80:83], v[52:55]
    v_exp_f32 v28, v28
    v_mfma_f32_16x16x32_bf16 v[16:19], a[68:71], v[84:87], v[16:19]
    ds_read_b64_tr_b16 a[210:211], v2 offset:37184
    v_perm_b32 v37, v27, v26, s100
    v_mfma_f32_16x16x32_bf16 v[16:19], a[72:75], v[88:91], v[16:19]
    v_exp_f32 v29, v29
    v_mfma_f32_16x16x32_bf16 v[16:19], a[76:79], v[92:95], v[16:19]
    ds_read_b64_tr_b16 a[212:213], v2 offset:37440
    v_mfma_f32_16x16x32_bf16 v[20:23], a[80:83], v[80:83], v[52:55]
    v_exp_f32 v30, v30
    v_mfma_f32_16x16x32_bf16 v[20:23], a[84:87], v[84:87], v[20:23]
    ds_read_b64_tr_b16 a[214:215], v2 offset:37696
    v_perm_b32 v38, v29, v28, s100
    v_mfma_f32_16x16x32_bf16 v[20:23], a[88:91], v[88:91], v[20:23]
    v_exp_f32 v31, v31
    v_mfma_f32_16x16x32_bf16 v[20:23], a[92:95], v[92:95], v[20:23]
    ds_read_b64_tr_b16 a[216:217], v2 offset:36960
    v_mfma_f32_16x16x32_bf16 v[24:27], a[96:99], v[80:83], v[52:55]
    v_exp_f32 v16, v16
    v_mfma_f32_16x16x32_bf16 v[24:27], a[100:103], v[84:87], v[24:27]
    ds_read_b64_tr_b16 a[218:219], v2 offset:37216
    v_perm_b32 v39, v31, v30, s100
    v_mfma_f32_16x16x32_bf16 v[24:27], a[104:107], v[88:91], v[24:27]
    v_exp_f32 v17, v17
    v_mfma_f32_16x16x32_bf16 v[24:27], a[108:111], v[92:95], v[24:27]
    ds_read_b64_tr_b16 a[220:221], v2 offset:37472
    v_mfma_f32_16x16x32_bf16 v[28:31], a[112:115], v[80:83], v[52:55]
    v_exp_f32 v18, v18
    v_mfma_f32_16x16x32_bf16 v[28:31], a[116:119], v[84:87], v[28:31]
    ds_read_b64_tr_b16 a[222:223], v2 offset:37728
    v_perm_b32 v40, v17, v16, s100
    v_mfma_f32_16x16x32_bf16 v[28:31], a[120:123], v[88:91], v[28:31]
    v_exp_f32 v19, v19
    v_mfma_f32_16x16x32_bf16 v[28:31], a[124:127], v[92:95], v[28:31]
    ds_read_b64_tr_b16 a[224:225], v2 offset:36992
    v_mfma_f32_16x16x32_bf16 v[128:131], a[128:131], v[32:35], v[128:131]
    v_exp_f32 v20, v20
    v_mfma_f32_16x16x32_bf16 v[128:131], a[132:135], v[36:39], v[128:131]
    ds_read_b64_tr_b16 a[226:227], v2 offset:37248
    v_perm_b32 v41, v19, v18, s100
    v_mfma_f32_16x16x32_bf16 v[132:135], a[136:139], v[32:35], v[132:135]
    v_exp_f32 v21, v21
    v_mfma_f32_16x16x32_bf16 v[132:135], a[140:143], v[36:39], v[132:135]
    ds_read_b64_tr_b16 a[228:229], v2 offset:37504
    v_mfma_f32_16x16x32_bf16 v[136:139], a[144:147], v[32:35], v[136:139]
    v_exp_f32 v22, v22
    v_mfma_f32_16x16x32_bf16 v[136:139], a[148:151], v[36:39], v[136:139]
    ds_read_b64_tr_b16 a[230:231], v2 offset:37760
    v_perm_b32 v42, v21, v20, s100
    v_mfma_f32_16x16x32_bf16 v[140:143], a[152:155], v[32:35], v[140:143]
    v_exp_f32 v23, v23
    v_mfma_f32_16x16x32_bf16 v[140:143], a[156:159], v[36:39], v[140:143]
    ds_read_b64_tr_b16 a[232:233], v2 offset:37024
    v_mfma_f32_16x16x32_bf16 v[144:147], a[160:163], v[32:35], v[144:147]
    v_exp_f32 v24, v24
    v_mfma_f32_16x16x32_bf16 v[144:147], a[164:167], v[36:39], v[144:147]
    ds_read_b64_tr_b16 a[234:235], v2 offset:37280
    v_perm_b32 v43, v23, v22, s100
    v_mfma_f32_16x16x32_bf16 v[148:151], a[168:171], v[32:35], v[148:151]
    v_exp_f32 v25, v25
    v_mfma_f32_16x16x32_bf16 v[148:151], a[172:175], v[36:39], v[148:151]
    ds_read_b64_tr_b16 a[236:237], v2 offset:37536
    v_mfma_f32_16x16x32_bf16 v[152:155], a[176:179], v[32:35], v[152:155]
    v_exp_f32 v26, v26
    v_mfma_f32_16x16x32_bf16 v[152:155], a[180:183], v[36:39], v[152:155]
    ds_read_b64_tr_b16 a[238:239], v2 offset:37792
    v_perm_b32 v44, v25, v24, s100
    v_mfma_f32_16x16x32_bf16 v[156:159], a[184:187], v[32:35], v[156:159]
    v_exp_f32 v27, v27
    v_mfma_f32_16x16x32_bf16 v[156:159], a[188:191], v[36:39], v[156:159]
    ds_read_b64_tr_b16 a[240:241], v2 offset:37056
    v_smfmac_f32_16x16x64_bf16 a[0:3], a[16:19], v[32:39], v11
    ds_read_b64_tr_b16 a[242:243], v2 offset:37312
    v_mfma_f32_16x16x32_bf16 v[16:19], a[64:67], v[96:99], v[56:59]
    v_exp_f32 v28, v28
    v_mfma_f32_16x16x32_bf16 v[16:19], a[68:71], v[100:103], v[16:19]
    ds_read_b64_tr_b16 a[244:245], v2 offset:37568
    v_perm_b32 v45, v27, v26, s100
    v_mfma_f32_16x16x32_bf16 v[16:19], a[72:75], v[104:107], v[16:19]
    v_exp_f32 v29, v29
    v_mfma_f32_16x16x32_bf16 v[16:19], a[76:79], v[108:111], v[16:19]
    ds_read_b64_tr_b16 a[246:247], v2 offset:37824
    v_mfma_f32_16x16x32_bf16 v[20:23], a[80:83], v[96:99], v[56:59]
    v_exp_f32 v30, v30
    v_mfma_f32_16x16x32_bf16 v[20:23], a[84:87], v[100:103], v[20:23]
    ds_read_b64_tr_b16 a[248:249], v2 offset:37088
    v_perm_b32 v46, v29, v28, s100
    v_mfma_f32_16x16x32_bf16 v[20:23], a[88:91], v[104:107], v[20:23]
    v_exp_f32 v31, v31
    v_mfma_f32_16x16x32_bf16 v[20:23], a[92:95], v[108:111], v[20:23]
    ds_read_b64_tr_b16 a[250:251], v2 offset:37344
    v_mfma_f32_16x16x32_bf16 v[24:27], a[96:99], v[96:99], v[56:59]
    v_exp_f32 v16, v16
    v_mfma_f32_16x16x32_bf16 v[24:27], a[100:103], v[100:103], v[24:27]
    ds_read_b64_tr_b16 a[252:253], v2 offset:37600
    v_perm_b32 v47, v31, v30, s100
    v_mfma_f32_16x16x32_bf16 v[24:27], a[104:107], v[104:107], v[24:27]
    v_exp_f32 v17, v17
    v_mfma_f32_16x16x32_bf16 v[24:27], a[108:111], v[108:111], v[24:27]
    ds_read_b64_tr_b16 a[254:255], v2 offset:37856
    v_mfma_f32_16x16x32_bf16 v[28:31], a[112:115], v[96:99], v[56:59]
    v_exp_f32 v18, v18
    v_mfma_f32_16x16x32_bf16 v[28:31], a[116:119], v[100:103], v[28:31]
    v_perm_b32 v32, v17, v16, s100
    v_mfma_f32_16x16x32_bf16 v[28:31], a[120:123], v[104:107], v[28:31]
    v_exp_f32 v19, v19
    v_mfma_f32_16x16x32_bf16 v[28:31], a[124:127], v[108:111], v[28:31]
    v_mfma_f32_16x16x32_bf16 v[160:163], a[128:131], v[40:43], v[160:163]
    v_exp_f32 v20, v20
    v_mfma_f32_16x16x32_bf16 v[160:163], a[132:135], v[44:47], v[160:163]
    v_perm_b32 v33, v19, v18, s100
    v_mfma_f32_16x16x32_bf16 v[164:167], a[136:139], v[40:43], v[164:167]
    v_exp_f32 v21, v21
    v_mfma_f32_16x16x32_bf16 v[164:167], a[140:143], v[44:47], v[164:167]
    v_mfma_f32_16x16x32_bf16 v[168:171], a[144:147], v[40:43], v[168:171]
    v_exp_f32 v22, v22
    v_mfma_f32_16x16x32_bf16 v[168:171], a[148:151], v[44:47], v[168:171]
    v_perm_b32 v34, v21, v20, s100
    v_mfma_f32_16x16x32_bf16 v[172:175], a[152:155], v[40:43], v[172:175]
    v_exp_f32 v23, v23
    v_mfma_f32_16x16x32_bf16 v[172:175], a[156:159], v[44:47], v[172:175]
    v_mfma_f32_16x16x32_bf16 v[176:179], a[160:163], v[40:43], v[176:179]
    v_exp_f32 v24, v24
    v_mfma_f32_16x16x32_bf16 v[176:179], a[164:167], v[44:47], v[176:179]
    v_perm_b32 v35, v23, v22, s100
    v_mfma_f32_16x16x32_bf16 v[180:183], a[168:171], v[40:43], v[180:183]
    v_exp_f32 v25, v25
    v_mfma_f32_16x16x32_bf16 v[180:183], a[172:175], v[44:47], v[180:183]
    v_mfma_f32_16x16x32_bf16 v[184:187], a[176:179], v[40:43], v[184:187]
    v_exp_f32 v26, v26
    v_mfma_f32_16x16x32_bf16 v[184:187], a[180:183], v[44:47], v[184:187]
    v_perm_b32 v36, v25, v24, s100
    v_mfma_f32_16x16x32_bf16 v[188:191], a[184:187], v[40:43], v[188:191]
    v_exp_f32 v27, v27
    v_mfma_f32_16x16x32_bf16 v[188:191], a[188:191], v[44:47], v[188:191]
    v_smfmac_f32_16x16x64_bf16 a[4:7], a[16:19], v[40:47], v11
    v_mfma_f32_16x16x32_bf16 v[16:19], a[64:67], v[112:115], v[60:63]
    v_exp_f32 v28, v28
    v_mfma_f32_16x16x32_bf16 v[16:19], a[68:71], v[116:119], v[16:19]
    ds_read_b128 a[64:67], v1 offset:36864
    v_perm_b32 v37, v27, v26, s100
    v_mfma_f32_16x16x32_bf16 v[16:19], a[72:75], v[120:123], v[16:19]
    v_exp_f32 v29, v29
    v_mfma_f32_16x16x32_bf16 v[16:19], a[76:79], v[124:127], v[16:19]
    ds_read_b128 a[68:71], v1 offset:36928
    v_mfma_f32_16x16x32_bf16 v[20:23], a[80:83], v[112:115], v[60:63]
    v_exp_f32 v30, v30
    v_mfma_f32_16x16x32_bf16 v[20:23], a[84:87], v[116:119], v[20:23]
    ds_read_b128 a[72:75], v1 offset:36992
    v_perm_b32 v38, v29, v28, s100
    v_mfma_f32_16x16x32_bf16 v[20:23], a[88:91], v[120:123], v[20:23]
    v_exp_f32 v31, v31
    v_mfma_f32_16x16x32_bf16 v[20:23], a[92:95], v[124:127], v[20:23]
    ds_read_b128 a[76:79], v1 offset:37056
    v_mfma_f32_16x16x32_bf16 v[24:27], a[96:99], v[112:115], v[60:63]
    v_exp_f32 v16, v16
    v_mfma_f32_16x16x32_bf16 v[24:27], a[100:103], v[116:119], v[24:27]
    ds_read_b128 a[80:83], v1 offset:37120
    v_perm_b32 v39, v31, v30, s100
    v_mfma_f32_16x16x32_bf16 v[24:27], a[104:107], v[120:123], v[24:27]
    v_exp_f32 v17, v17
    v_mfma_f32_16x16x32_bf16 v[24:27], a[108:111], v[124:127], v[24:27]
    ds_read_b128 a[84:87], v1 offset:37184
    v_mfma_f32_16x16x32_bf16 v[28:31], a[112:115], v[112:115], v[60:63]
    v_exp_f32 v18, v18
    v_mfma_f32_16x16x32_bf16 v[28:31], a[116:119], v[116:119], v[28:31]
    ds_read_b128 a[88:91], v1 offset:37248
    v_perm_b32 v40, v17, v16, s100
    v_mfma_f32_16x16x32_bf16 v[28:31], a[120:123], v[120:123], v[28:31]
    v_exp_f32 v19, v19
    v_mfma_f32_16x16x32_bf16 v[28:31], a[124:127], v[124:127], v[28:31]
    ds_read_b128 a[92:95], v1 offset:37312
    v_mfma_f32_16x16x32_bf16 v[192:195], a[128:131], v[32:35], v[192:195]
    v_exp_f32 v20, v20
    v_mfma_f32_16x16x32_bf16 v[192:195], a[132:135], v[36:39], v[192:195]
    ds_read_b128 a[96:99], v1 offset:37376
    v_perm_b32 v41, v19, v18, s100
    v_mfma_f32_16x16x32_bf16 v[196:199], a[136:139], v[32:35], v[196:199]
    v_exp_f32 v21, v21
    v_mfma_f32_16x16x32_bf16 v[196:199], a[140:143], v[36:39], v[196:199]
    ds_read_b128 a[100:103], v1 offset:37440
    v_mfma_f32_16x16x32_bf16 v[200:203], a[144:147], v[32:35], v[200:203]
    v_exp_f32 v22, v22
    v_mfma_f32_16x16x32_bf16 v[200:203], a[148:151], v[36:39], v[200:203]
    ds_read_b128 a[104:107], v1 offset:37504
    v_perm_b32 v42, v21, v20, s100
    v_mfma_f32_16x16x32_bf16 v[204:207], a[152:155], v[32:35], v[204:207]
    v_exp_f32 v23, v23
    v_mfma_f32_16x16x32_bf16 v[204:207], a[156:159], v[36:39], v[204:207]
    ds_read_b128 a[108:111], v1 offset:37568
    v_mfma_f32_16x16x32_bf16 v[208:211], a[160:163], v[32:35], v[208:211]
    v_exp_f32 v24, v24
    v_mfma_f32_16x16x32_bf16 v[208:211], a[164:167], v[36:39], v[208:211]
    ds_read_b128 a[112:115], v1 offset:37632
    v_perm_b32 v43, v23, v22, s100
    v_mfma_f32_16x16x32_bf16 v[212:215], a[168:171], v[32:35], v[212:215]
    v_exp_f32 v25, v25
    v_mfma_f32_16x16x32_bf16 v[212:215], a[172:175], v[36:39], v[212:215]
    ds_read_b128 a[116:119], v1 offset:37696
    v_mfma_f32_16x16x32_bf16 v[216:219], a[176:179], v[32:35], v[216:219]
    v_exp_f32 v26, v26
    v_mfma_f32_16x16x32_bf16 v[216:219], a[180:183], v[36:39], v[216:219]
    s_sub_u32 s49, s49, 1
    ds_read_b128 a[120:123], v1 offset:37760
    v_perm_b32 v44, v25, v24, s100
    v_mfma_f32_16x16x32_bf16 v[220:223], a[184:187], v[32:35], v[220:223]
    s_cmp_lg_u32 s49, 0
    v_exp_f32 v27, v27
    v_mfma_f32_16x16x32_bf16 v[220:223], a[188:191], v[36:39], v[220:223]
    ds_read_b128 a[124:127], v1 offset:37824
    v_smfmac_f32_16x16x64_bf16 a[8:11], a[16:19], v[32:39], v11
    s_waitcnt lgkmcnt(12)
    s_cbranch_scc1 L2_loop
    v_mfma_f32_16x16x32_bf16 v[16:19], a[64:67], v[64:67], v[48:51]
    s_sub_u32 s47, s47, s48
    v_exp_f32 v28, v28
    v_mfma_f32_16x16x32_bf16 v[16:19], a[68:71], v[68:71], v[16:19]
L2_pad5:
    s_cbranch_execz L2_pad9
    v_perm_b32 v45, v27, v26, s100
    v_add_u32 v1, s48, v1
    v_mfma_f32_16x16x32_bf16 v[16:19], a[72:75], v[72:75], v[16:19]
    v_exp_f32 v29, v29
    v_mfma_f32_16x16x32_bf16 v[16:19], a[76:79], v[76:79], v[16:19]
    s_waitcnt lgkmcnt(8)
    v_mfma_f32_16x16x32_bf16 v[20:23], a[80:83], v[64:67], v[48:51]
    v_exp_f32 v30, v30
    v_mfma_f32_16x16x32_bf16 v[20:23], a[84:87], v[68:71], v[20:23]
    v_perm_b32 v46, v29, v28, s100
    v_add_u32 v2, s48, v2
    v_mfma_f32_16x16x32_bf16 v[20:23], a[88:91], v[72:75], v[20:23]
    v_exp_f32 v31, v31
    v_mfma_f32_16x16x32_bf16 v[20:23], a[92:95], v[76:79], v[20:23]
    s_waitcnt lgkmcnt(4)
    v_mfma_f32_16x16x32_bf16 v[24:27], a[96:99], v[64:67], v[48:51]
    s_sub_u32 s48, 0, s48
    v_exp_f32 v16, v16
    v_mfma_f32_16x16x32_bf16 v[24:27], a[100:103], v[68:71], v[24:27]
    v_perm_b32 v47, v31, v30, s100
    v_mfma_f32_16x16x32_bf16 v[24:27], a[104:107], v[72:75], v[24:27]
    v_exp_f32 v17, v17
    v_mfma_f32_16x16x32_bf16 v[24:27], a[108:111], v[76:79], v[24:27]
    s_waitcnt lgkmcnt(0)
    v_mfma_f32_16x16x32_bf16 v[28:31], a[112:115], v[64:67], v[48:51]
    v_exp_f32 v18, v18
    v_mfma_f32_16x16x32_bf16 v[28:31], a[116:119], v[68:71], v[28:31]
    v_perm_b32 v32, v17, v16, s100
    v_mfma_f32_16x16x32_bf16 v[28:31], a[120:123], v[72:75], v[28:31]
    v_exp_f32 v19, v19
    v_mfma_f32_16x16x32_bf16 v[28:31], a[124:127], v[76:79], v[28:31]
    s_waitcnt vmcnt(0)
    s_barrier
    v_mfma_f32_16x16x32_bf16 v[224:227], a[128:131], v[40:43], v[224:227]
    v_exp_f32 v20, v20
    v_mfma_f32_16x16x32_bf16 v[224:227], a[132:135], v[44:47], v[224:227]
    ds_read_b64_tr_b16 a[128:129], v2 offset:0
    v_perm_b32 v33, v19, v18, s100
    v_mfma_f32_16x16x32_bf16 v[228:231], a[136:139], v[40:43], v[228:231]
    s_add_u32 m0, s47, 0
    v_exp_f32 v21, v21
    v_mfma_f32_16x16x32_bf16 v[228:231], a[140:143], v[44:47], v[228:231]
    s_add_u32 s46, s46, 16384
    buffer_load_dwordx4 off, s[16:19], s46 offset:0 lds
    v_mfma_f32_16x16x32_bf16 v[232:235], a[144:147], v[40:43], v[232:235]
    v_exp_f32 v22, v22
    v_mfma_f32_16x16x32_bf16 v[232:235], a[148:151], v[44:47], v[232:235]
    ds_read_b64_tr_b16 a[130:131], v2 offset:256
    v_perm_b32 v34, v21, v20, s100
    v_mfma_f32_16x16x32_bf16 v[236:239], a[152:155], v[40:43], v[236:239]
    s_add_u32 m0, s47, 32
    v_exp_f32 v23, v23
    v_mfma_f32_16x16x32_bf16 v[236:239], a[156:159], v[44:47], v[236:239]
    buffer_load_dwordx4 off, s[16:19], s46 offset:1024 lds
    v_mfma_f32_16x16x32_bf16 v[240:243], a[160:163], v[40:43], v[240:243]
    v_exp_f32 v24, v24
    v_mfma_f32_16x16x32_bf16 v[240:243], a[164:167], v[44:47], v[240:243]
    ds_read_b64_tr_b16 a[132:133], v2 offset:512
    v_perm_b32 v35, v23, v22, s100
    v_mfma_f32_16x16x32_bf16 v[244:247], a[168:171], v[40:43], v[244:247]
    s_add_u32 m0, s47, 64
    v_exp_f32 v25, v25
    v_mfma_f32_16x16x32_bf16 v[244:247], a[172:175], v[44:47], v[244:247]
    buffer_load_dwordx4 off, s[16:19], s46 offset:2048 lds
    v_mfma_f32_16x16x32_bf16 v[248:251], a[176:179], v[40:43], v[248:251]
    v_exp_f32 v26, v26
    v_mfma_f32_16x16x32_bf16 v[248:251], a[180:183], v[44:47], v[248:251]
    ds_read_b64_tr_b16 a[134:135], v2 offset:768
    v_perm_b32 v36, v25, v24, s100
    v_mfma_f32_16x16x32_bf16 v[252:255], a[184:187], v[40:43], v[252:255]
    s_add_u32 m0, s47, 96
    v_exp_f32 v27, v27
    v_mfma_f32_16x16x32_bf16 v[252:255], a[188:191], v[44:47], v[252:255]
    buffer_load_dwordx4 off, s[16:19], s46 offset:3072 lds
    v_smfmac_f32_16x16x64_bf16 a[12:15], a[16:19], v[40:47], v11
    ds_read_b64_tr_b16 a[136:137], v2 offset:32
    v_mfma_f32_16x16x32_bf16 v[16:19], a[64:67], v[80:83], v[52:55]
    v_exp_f32 v28, v28
    v_mfma_f32_16x16x32_bf16 v[16:19], a[68:71], v[84:87], v[16:19]
    ds_read_b64_tr_b16 a[138:139], v2 offset:288
    v_perm_b32 v37, v27, v26, s100
    v_mfma_f32_16x16x32_bf16 v[16:19], a[72:75], v[88:91], v[16:19]
    s_add_u32 m0, s47, 16896
    v_exp_f32 v29, v29
    v_mfma_f32_16x16x32_bf16 v[16:19], a[76:79], v[92:95], v[16:19]
    buffer_load_dwordx4 off, s[20:23], s46 offset:0 lds
    v_mfma_f32_16x16x32_bf16 v[20:23], a[80:83], v[80:83], v[52:55]
    v_exp_f32 v30, v30
    v_mfma_f32_16x16x32_bf16 v[20:23], a[84:87], v[84:87], v[20:23]
    ds_read_b64_tr_b16 a[140:141], v2 offset:544
    v_perm_b32 v38, v29, v28, s100
    v_mfma_f32_16x16x32_bf16 v[20:23], a[88:91], v[88:91], v[20:23]
    s_add_u32 m0, s47, 16928
    v_exp_f32 v31, v31
    v_mfma_f32_16x16x32_bf16 v[20:23], a[92:95], v[92:95], v[20:23]
    buffer_load_dwordx4 off, s[20:23], s46 offset:1024 lds
    v_mfma_f32_16x16x32_bf16 v[24:27], a[96:99], v[80:83], v[52:55]
    v_exp_f32 v16, v16
    v_mfma_f32_16x16x32_bf16 v[24:27], a[100:103], v[84:87], v[24:27]
    ds_read_b64_tr_b16 a[142:143], v2 offset:800
    v_perm_b32 v39, v31, v30, s100
    v_mfma_f32_16x16x32_bf16 v[24:27], a[104:107], v[88:91], v[24:27]
    s_add_u32 m0, s47, 16960
    v_exp_f32 v17, v17
    v_mfma_f32_16x16x32_bf16 v[24:27], a[108:111], v[92:95], v[24:27]
    buffer_load_dwordx4 off, s[20:23], s46 offset:2048 lds
    v_mfma_f32_16x16x32_bf16 v[28:31], a[112:115], v[80:83], v[52:55]
    v_exp_f32 v18, v18
    v_mfma_f32_16x16x32_bf16 v[28:31], a[116:119], v[84:87], v[28:31]
    ds_read_b64_tr_b16 a[144:145], v2 offset:64
    v_perm_b32 v40, v17, v16, s100
    v_mfma_f32_16x16x32_bf16 v[28:31], a[120:123], v[88:91], v[28:31]
    s_add_u32 m0, s47, 16992
    v_exp_f32 v19, v19
    v_mfma_f32_16x16x32_bf16 v[28:31], a[124:127], v[92:95], v[28:31]
    buffer_load_dwordx4 off, s[20:23], s46 offset:3072 lds
    v_mfma_f32_16x16x32_bf16 v[128:131], a[192:195], v[32:35], v[128:131]
    v_exp_f32 v20, v20
    v_mfma_f32_16x16x32_bf16 v[128:131], a[196:199], v[36:39], v[128:131]
    ds_read_b64_tr_b16 a[146:147], v2 offset:320
    v_perm_b32 v41, v19, v18, s100
    v_mfma_f32_16x16x32_bf16 v[132:135], a[200:203], v[32:35], v[132:135]
    v_exp_f32 v21, v21
    v_mfma_f32_16x16x32_bf16 v[132:135], a[204:207], v[36:39], v[132:135]
    ds_read_b64_tr_b16 a[148:149], v2 offset:576
    v_mfma_f32_16x16x32_bf16 v[136:139], a[208:211], v[32:35], v[136:139]
    v_exp_f32 v22, v22
    v_mfma_f32_16x16x32_bf16 v[136:139], a[212:215], v[36:39], v[136:139]
    ds_read_b64_tr_b16 a[150:151], v2 offset:832
    v_perm_b32 v42, v21, v20, s100
    v_mfma_f32_16x16x32_bf16 v[140:143], a[216:219], v[32:35], v[140:143]
    v_exp_f32 v23, v23
    v_mfma_f32_16x16x32_bf16 v[140:143], a[220:223], v[36:39], v[140:143]
    ds_read_b64_tr_b16 a[152:153], v2 offset:96
    ds_read_b64_tr_b16 a[154:155], v2 offset:352
    v_mfma_f32_16x16x32_bf16 v[144:147], a[224:227], v[32:35], v[144:147]
    v_exp_f32 v24, v24
    v_mfma_f32_16x16x32_bf16 v[144:147], a[228:231], v[36:39], v[144:147]
    ds_read_b64_tr_b16 a[156:157], v2 offset:608
    v_perm_b32 v43, v23, v22, s100
    v_mfma_f32_16x16x32_bf16 v[148:151], a[232:235], v[32:35], v[148:151]
    v_exp_f32 v25, v25
    v_mfma_f32_16x16x32_bf16 v[148:151], a[236:239], v[36:39], v[148:151]
    ds_read_b64_tr_b16 a[158:159], v2 offset:864
    ds_read_b64_tr_b16 a[160:161], v2 offset:128
    v_mfma_f32_16x16x32_bf16 v[152:155], a[240:243], v[32:35], v[152:155]
    v_exp_f32 v26, v26
    v_mfma_f32_16x16x32_bf16 v[152:155], a[244:247], v[36:39], v[152:155]
    ds_read_b64_tr_b16 a[162:163], v2 offset:384
    v_perm_b32 v44, v25, v24, s100
    v_mfma_f32_16x16x32_bf16 v[156:159], a[248:251], v[32:35], v[156:159]
    v_exp_f32 v27, v27
    v_mfma_f32_16x16x32_bf16 v[156:159], a[252:255], v[36:39], v[156:159]
    ds_read_b64_tr_b16 a[164:165], v2 offset:640
    ds_read_b64_tr_b16 a[166:167], v2 offset:896
    v_smfmac_f32_16x16x64_bf16 a[0:3], a[16:19], v[32:39], v11
    ds_read_b64_tr_b16 a[168:169], v2 offset:160
    ds_read_b64_tr_b16 a[170:171], v2 offset:416
    v_mfma_f32_16x16x32_bf16 v[16:19], a[64:67], v[96:99], v[56:59]
    v_exp_f32 v28, v28
    v_mfma_f32_16x16x32_bf16 v[16:19], a[68:71], v[100:103], v[16:19]
    ds_read_b64_tr_b16 a[172:173], v2 offset:672
    v_perm_b32 v45, v27, v26, s100
    v_mfma_f32_16x16x32_bf16 v[16:19], a[72:75], v[104:107], v[16:19]
    s_add_u32 m0, s47, 36864
    v_exp_f32 v29, v29
    v_mfma_f32_16x16x32_bf16 v[16:19], a[76:79], v[108:111], v[16:19]
    s_add_u32 s46, s46, 16384
    buffer_load_dwordx4 off, s[16:19], s46 offset:0 lds
    v_mfma_f32_16x16x32_bf16 v[20:23], a[80:83], v[96:99], v[56:59]
    v_exp_f32 v30, v30
    v_mfma_f32_16x16x32_bf16 v[20:23], a[84:87], v[100:103], v[20:23]
    ds_read_b64_tr_b16 a[174:175], v2 offset:928
    v_perm_b32 v46, v29, v28, s100
    v_mfma_f32_16x16x32_bf16 v[20:23], a[88:91], v[104:107], v[20:23]
    s_add_u32 m0, s47, 36896
    v_exp_f32 v31, v31
    v_mfma_f32_16x16x32_bf16 v[20:23], a[92:95], v[108:111], v[20:23]
    buffer_load_dwordx4 off, s[16:19], s46 offset:1024 lds
    v_mfma_f32_16x16x32_bf16 v[24:27], a[96:99], v[96:99], v[56:59]
    v_exp_f32 v16, v16
    v_mfma_f32_16x16x32_bf16 v[24:27], a[100:103], v[100:103], v[24:27]
    ds_read_b64_tr_b16 a[176:177], v2 offset:192
    v_perm_b32 v47, v31, v30, s100
    v_mfma_f32_16x16x32_bf16 v[24:27], a[104:107], v[104:107], v[24:27]
    s_add_u32 m0, s47, 36928
    v_exp_f32 v17, v17
    v_mfma_f32_16x16x32_bf16 v[24:27], a[108:111], v[108:111], v[24:27]
    buffer_load_dwordx4 off, s[16:19], s46 offset:2048 lds
    v_mfma_f32_16x16x32_bf16 v[28:31], a[112:115], v[96:99], v[56:59]
    v_exp_f32 v18, v18
    v_mfma_f32_16x16x32_bf16 v[28:31], a[116:119], v[100:103], v[28:31]
    ds_read_b64_tr_b16 a[178:179], v2 offset:448
    v_perm_b32 v32, v17, v16, s100
    v_mfma_f32_16x16x32_bf16 v[28:31], a[120:123], v[104:107], v[28:31]
    s_add_u32 m0, s47, 36960
    v_exp_f32 v19, v19
    v_mfma_f32_16x16x32_bf16 v[28:31], a[124:127], v[108:111], v[28:31]
    buffer_load_dwordx4 off, s[16:19], s46 offset:3072 lds
    v_mfma_f32_16x16x32_bf16 v[160:163], a[192:195], v[40:43], v[160:163]
    v_exp_f32 v20, v20
    v_mfma_f32_16x16x32_bf16 v[160:163], a[196:199], v[44:47], v[160:163]
    ds_read_b64_tr_b16 a[180:181], v2 offset:704
    v_perm_b32 v33, v19, v18, s100
    v_mfma_f32_16x16x32_bf16 v[164:167], a[200:203], v[40:43], v[164:167]
    s_add_u32 m0, s47, 53760
    v_exp_f32 v21, v21
    v_mfma_f32_16x16x32_bf16 v[164:167], a[204:207], v[44:47], v[164:167]
    buffer_load_dwordx4 off, s[20:23], s46 offset:0 lds
    v_mfma_f32_16x16x32_bf16 v[168:171], a[208:211], v[40:43], v[168:171]
    v_exp_f32 v22, v22
    v_mfma_f32_16x16x32_bf16 v[168:171], a[212:215], v[44:47], v[168:171]
    ds_read_b64_tr_b16 a[182:183], v2 offset:960
    v_perm_b32 v34, v21, v20, s100
    v_mfma_f32_16x16x32_bf16 v[172:175], a[216:219], v[40:43], v[172:175]
    s_add_u32 m0, s47, 53792
    v_exp_f32 v23, v23
    v_mfma_f32_16x16x32_bf16 v[172:175], a[220:223], v[44:47], v[172:175]
    buffer_load_dwordx4 off, s[20:23], s46 offset:1024 lds
    v_mfma_f32_16x16x32_bf16 v[176:179], a[224:227], v[40:43], v[176:179]
    v_exp_f32 v24, v24
    v_mfma_f32_16x16x32_bf16 v[176:179], a[228:231], v[44:47], v[176:179]
    ds_read_b64_tr_b16 a[184:185], v2 offset:224
    v_perm_b32 v35, v23, v22, s100
    v_mfma_f32_16x16x32_bf16 v[180:183], a[232:235], v[40:43], v[180:183]
    s_add_u32 m0, s47, 53824
    v_exp_f32 v25, v25
    v_mfma_f32_16x16x32_bf16 v[180:183], a[236:239], v[44:47], v[180:183]
    buffer_load_dwordx4 off, s[20:23], s46 offset:2048 lds
    v_mfma_f32_16x16x32_bf16 v[184:187], a[240:243], v[40:43], v[184:187]
    v_exp_f32 v26, v26
    v_mfma_f32_16x16x32_bf16 v[184:187], a[244:247], v[44:47], v[184:187]
    ds_read_b64_tr_b16 a[186:187], v2 offset:480
    v_perm_b32 v36, v25, v24, s100
    v_mfma_f32_16x16x32_bf16 v[188:191], a[248:251], v[40:43], v[188:191]
    s_add_u32 m0, s47, 53856
    v_exp_f32 v27, v27
    v_mfma_f32_16x16x32_bf16 v[188:191], a[252:255], v[44:47], v[188:191]
    buffer_load_dwordx4 off, s[20:23], s46 offset:3072 lds
    v_smfmac_f32_16x16x64_bf16 a[4:7], a[16:19], v[40:47], v11
    ds_read_b64_tr_b16 a[188:189], v2 offset:736
    ds_read_b64_tr_b16 a[190:191], v2 offset:992
    v_mfma_f32_16x16x32_bf16 v[16:19], a[64:67], v[112:115], v[60:63]
    v_exp_f32 v28, v28
    v_mfma_f32_16x16x32_bf16 v[16:19], a[68:71], v[116:119], v[16:19]
    ds_read_b128 a[64:67], v1 offset:0
    v_perm_b32 v37, v27, v26, s100
    v_mfma_f32_16x16x32_bf16 v[16:19], a[72:75], v[120:123], v[16:19]
    v_exp_f32 v29, v29
    v_mfma_f32_16x16x32_bf16 v[16:19], a[76:79], v[124:127], v[16:19]
    ds_read_b128 a[68:71], v1 offset:64
    v_mfma_f32_16x16x32_bf16 v[20:23], a[80:83], v[112:115], v[60:63]
    v_exp_f32 v30, v30
    v_mfma_f32_16x16x32_bf16 v[20:23], a[84:87], v[116:119], v[20:23]
    ds_read_b128 a[72:75], v1 offset:128
    v_perm_b32 v38, v29, v28, s100
    v_mfma_f32_16x16x32_bf16 v[20:23], a[88:91], v[120:123], v[20:23]
    v_exp_f32 v31, v31
    v_mfma_f32_16x16x32_bf16 v[20:23], a[92:95], v[124:127], v[20:23]
    ds_read_b128 a[76:79], v1 offset:192
    v_mfma_f32_16x16x32_bf16 v[24:27], a[96:99], v[112:115], v[60:63]
    v_exp_f32 v16, v16
    v_mfma_f32_16x16x32_bf16 v[24:27], a[100:103], v[116:119], v[24:27]
    ds_read_b128 a[80:83], v1 offset:256
    v_perm_b32 v39, v31, v30, s100
    v_mfma_f32_16x16x32_bf16 v[24:27], a[104:107], v[120:123], v[24:27]
    v_exp_f32 v17, v17
    v_mfma_f32_16x16x32_bf16 v[24:27], a[108:111], v[124:127], v[24:27]
    ds_read_b128 a[84:87], v1 offset:320
    v_mfma_f32_16x16x32_bf16 v[28:31], a[112:115], v[112:115], v[60:63]
    v_exp_f32 v18, v18
    v_mfma_f32_16x16x32_bf16 v[28:31], a[116:119], v[116:119], v[28:31]
    ds_read_b128 a[88:91], v1 offset:384
    v_perm_b32 v40, v17, v16, s100
    v_mfma_f32_16x16x32_bf16 v[28:31], a[120:123], v[120:123], v[28:31]
    v_exp_f32 v19, v19
    v_mfma_f32_16x16x32_bf16 v[28:31], a[124:127], v[124:127], v[28:31]
    ds_read_b128 a[92:95], v1 offset:448
    v_mfma_f32_16x16x32_bf16 v[192:195], a[192:195], v[32:35], v[192:195]
    v_exp_f32 v20, v20
    v_mfma_f32_16x16x32_bf16 v[192:195], a[196:199], v[36:39], v[192:195]
    ds_read_b128 a[96:99], v1 offset:512
    v_perm_b32 v41, v19, v18, s100
    v_mfma_f32_16x16x32_bf16 v[196:199], a[200:203], v[32:35], v[196:199]
    v_exp_f32 v21, v21
    v_mfma_f32_16x16x32_bf16 v[196:199], a[204:207], v[36:39], v[196:199]
    ds_read_b128 a[100:103], v1 offset:576
    v_mfma_f32_16x16x32_bf16 v[200:203], a[208:211], v[32:35], v[200:203]
    v_exp_f32 v22, v22
    v_mfma_f32_16x16x32_bf16 v[200:203], a[212:215], v[36:39], v[200:203]
    ds_read_b128 a[104:107], v1 offset:640
    v_perm_b32 v42, v21, v20, s100
    v_mfma_f32_16x16x32_bf16 v[204:207], a[216:219], v[32:35], v[204:207]
    v_exp_f32 v23, v23
    v_mfma_f32_16x16x32_bf16 v[204:207], a[220:223], v[36:39], v[204:207]
    ds_read_b128 a[108:111], v1 offset:704
    v_mfma_f32_16x16x32_bf16 v[208:211], a[224:227], v[32:35], v[208:211]
    v_exp_f32 v24, v24
    v_mfma_f32_16x16x32_bf16 v[208:211], a[228:231], v[36:39], v[208:211]
    ds_read_b128 a[112:115], v1 offset:768
    v_perm_b32 v43, v23, v22, s100
    v_mfma_f32_16x16x32_bf16 v[212:215], a[232:235], v[32:35], v[212:215]
    v_exp_f32 v25, v25
    v_mfma_f32_16x16x32_bf16 v[212:215], a[236:239], v[36:39], v[212:215]
    ds_read_b128 a[116:119], v1 offset:832
    v_mfma_f32_16x16x32_bf16 v[216:219], a[240:243], v[32:35], v[216:219]
    v_exp_f32 v26, v26
    v_mfma_f32_16x16x32_bf16 v[216:219], a[244:247], v[36:39], v[216:219]
    ds_read_b128 a[120:123], v1 offset:896
    v_perm_b32 v44, v25, v24, s100
    v_mfma_f32_16x16x32_bf16 v[220:223], a[248:251], v[32:35], v[220:223]
    v_exp_f32 v27, v27
    v_mfma_f32_16x16x32_bf16 v[220:223], a[252:255], v[36:39], v[220:223]
    ds_read_b128 a[124:127], v1 offset:960
    v_smfmac_f32_16x16x64_bf16 a[8:11], a[16:19], v[32:39], v11
    s_waitcnt lgkmcnt(12)
    v_mfma_f32_16x16x32_bf16 v[16:19], a[64:67], v[64:67], v[48:51]
    v_exp_f32 v28, v28
    v_mfma_f32_16x16x32_bf16 v[16:19], a[68:71], v[68:71], v[16:19]
    v_perm_b32 v45, v27, v26, s100
    v_mfma_f32_16x16x32_bf16 v[16:19], a[72:75], v[72:75], v[16:19]
    v_exp_f32 v29, v29
    v_mfma_f32_16x16x32_bf16 v[16:19], a[76:79], v[76:79], v[16:19]
    s_waitcnt lgkmcnt(8)
    global_load_dword a63, v12, s[4:5]
    v_mfma_f32_16x16x32_bf16 v[20:23], a[80:83], v[64:67], v[48:51]
    v_exp_f32 v30, v30
    v_mfma_f32_16x16x32_bf16 v[20:23], a[84:87], v[68:71], v[20:23]
    v_perm_b32 v46, v29, v28, s100
    v_mfma_f32_16x16x32_bf16 v[20:23], a[88:91], v[72:75], v[20:23]
    v_exp_f32 v31, v31
    v_mfma_f32_16x16x32_bf16 v[20:23], a[92:95], v[76:79], v[20:23]
    s_waitcnt lgkmcnt(4)
    v_mfma_f32_16x16x32_bf16 v[24:27], a[96:99], v[64:67], v[48:51]
    v_exp_f32 v16, v16
    v_mfma_f32_16x16x32_bf16 v[24:27], a[100:103], v[68:71], v[24:27]
    v_perm_b32 v47, v31, v30, s100
    v_mfma_f32_16x16x32_bf16 v[24:27], a[104:107], v[72:75], v[24:27]
    v_exp_f32 v17, v17
    v_mfma_f32_16x16x32_bf16 v[24:27], a[108:111], v[76:79], v[24:27]
    s_waitcnt lgkmcnt(0)
    global_load_dword a63, v14, s[10:11]
    v_mfma_f32_16x16x32_bf16 v[28:31], a[112:115], v[64:67], v[48:51]
    v_exp_f32 v18, v18
    v_mfma_f32_16x16x32_bf16 v[28:31], a[116:119], v[68:71], v[28:31]
    v_perm_b32 v32, v17, v16, s100
    v_mfma_f32_16x16x32_bf16 v[28:31], a[120:123], v[72:75], v[28:31]
    v_exp_f32 v19, v19
    v_mfma_f32_16x16x32_bf16 v[28:31], a[124:127], v[76:79], v[28:31]
    v_mfma_f32_16x16x32_bf16 v[224:227], a[192:195], v[40:43], v[224:227]
    v_exp_f32 v20, v20
    v_mfma_f32_16x16x32_bf16 v[224:227], a[196:199], v[44:47], v[224:227]
    ds_read_b64_tr_b16 a[192:193], v2 offset:36864
    v_perm_b32 v33, v19, v18, s100
    v_mfma_f32_16x16x32_bf16 v[228:231], a[200:203], v[40:43], v[228:231]
    v_exp_f32 v21, v21
    v_mfma_f32_16x16x32_bf16 v[228:231], a[204:207], v[44:47], v[228:231]
    ds_read_b64_tr_b16 a[194:195], v2 offset:37120
    v_mfma_f32_16x16x32_bf16 v[232:235], a[208:211], v[40:43], v[232:235]
    v_exp_f32 v22, v22
    v_mfma_f32_16x16x32_bf16 v[232:235], a[212:215], v[44:47], v[232:235]
    ds_read_b64_tr_b16 a[196:197], v2 offset:37376
    v_perm_b32 v34, v21, v20, s100
    v_mfma_f32_16x16x32_bf16 v[236:239], a[216:219], v[40:43], v[236:239]
    v_exp_f32 v23, v23
    v_mfma_f32_16x16x32_bf16 v[236:239], a[220:223], v[44:47], v[236:239]
    ds_read_b64_tr_b16 a[198:199], v2 offset:37632
    v_mfma_f32_16x16x32_bf16 v[240:243], a[224:227], v[40:43], v[240:243]
    v_exp_f32 v24, v24
    v_mfma_f32_16x16x32_bf16 v[240:243], a[228:231], v[44:47], v[240:243]
    ds_read_b64_tr_b16 a[200:201], v2 offset:36896
    v_perm_b32 v35, v23, v22, s100
    v_mfma_f32_16x16x32_bf16 v[244:247], a[232:235], v[40:43], v[244:247]
    v_exp_f32 v25, v25
    v_mfma_f32_16x16x32_bf16 v[244:247], a[236:239], v[44:47], v[244:247]
    ds_read_b64_tr_b16 a[202:203], v2 offset:37152
    v_mfma_f32_16x16x32_bf16 v[248:251], a[240:243], v[40:43], v[248:251]
    v_exp_f32 v26, v26
    v_mfma_f32_16x16x32_bf16 v[248:251], a[244:247], v[44:47], v[248:251]
    ds_read_b64_tr_b16 a[204:205], v2 offset:37408
    v_perm_b32 v36, v25, v24, s100
    v_mfma_f32_16x16x32_bf16 v[252:255], a[248:251], v[40:43], v[252:255]
    v_exp_f32 v27, v27
    v_mfma_f32_16x16x32_bf16 v[252:255], a[252:255], v[44:47], v[252:255]
    ds_read_b64_tr_b16 a[206:207], v2 offset:37664
    v_smfmac_f32_16x16x64_bf16 a[12:15], a[16:19], v[40:47], v11
    ds_read_b64_tr_b16 a[208:209], v2 offset:36928
    v_mfma_f32_16x16x32_bf16 v[16:19], a[64:67], v[80:83], v[52:55]
    v_exp_f32 v28, v28
    v_mfma_f32_16x16x32_bf16 v[16:19], a[68:71], v[84:87], v[16:19]
    ds_read_b64_tr_b16 a[210:211], v2 offset:37184
    v_perm_b32 v37, v27, v26, s100
    v_mfma_f32_16x16x32_bf16 v[16:19], a[72:75], v[88:91], v[16:19]
    v_exp_f32 v29, v29
    v_mfma_f32_16x16x32_bf16 v[16:19], a[76:79], v[92:95], v[16:19]
    ds_read_b64_tr_b16 a[212:213], v2 offset:37440
    v_mfma_f32_16x16x32_bf16 v[20:23], a[80:83], v[80:83], v[52:55]
    v_exp_f32 v30, v30
    v_mfma_f32_16x16x32_bf16 v[20:23], a[84:87], v[84:87], v[20:23]
    ds_read_b64_tr_b16 a[214:215], v2 offset:37696
    v_perm_b32 v38, v29, v28, s100
    v_mfma_f32_16x16x32_bf16 v[20:23], a[88:91], v[88:91], v[20:23]
    v_exp_f32 v31, v31
    v_mfma_f32_16x16x32_bf16 v[20:23], a[92:95], v[92:95], v[20:23]
    ds_read_b64_tr_b16 a[216:217], v2 offset:36960
    v_mfma_f32_16x16x32_bf16 v[24:27], a[96:99], v[80:83], v[52:55]
    v_exp_f32 v16, v16
    v_mfma_f32_16x16x32_bf16 v[24:27], a[100:103], v[84:87], v[24:27]
    ds_read_b64_tr_b16 a[218:219], v2 offset:37216
    v_perm_b32 v39, v31, v30, s100
    v_mfma_f32_16x16x32_bf16 v[24:27], a[104:107], v[88:91], v[24:27]
    v_exp_f32 v17, v17
    v_mfma_f32_16x16x32_bf16 v[24:27], a[108:111], v[92:95], v[24:27]
    ds_read_b64_tr_b16 a[220:221], v2 offset:37472
    v_mfma_f32_16x16x32_bf16 v[28:31], a[112:115], v[80:83], v[52:55]
    v_exp_f32 v18, v18
    v_mfma_f32_16x16x32_bf16 v[28:31], a[116:119], v[84:87], v[28:31]
    ds_read_b64_tr_b16 a[222:223], v2 offset:37728
    v_perm_b32 v40, v17, v16, s100
    v_mfma_f32_16x16x32_bf16 v[28:31], a[120:123], v[88:91], v[28:31]
    v_exp_f32 v19, v19
    v_mfma_f32_16x16x32_bf16 v[28:31], a[124:127], v[92:95], v[28:31]
    ds_read_b64_tr_b16 a[224:225], v2 offset:36992
    v_mfma_f32_16x16x32_bf16 v[128:131], a[128:131], v[32:35], v[128:131]
    v_exp_f32 v20, v20
    v_mfma_f32_16x16x32_bf16 v[128:131], a[132:135], v[36:39], v[128:131]
    ds_read_b64_tr_b16 a[226:227], v2 offset:37248
    v_perm_b32 v41, v19, v18, s100
    v_mfma_f32_16x16x32_bf16 v[132:135], a[136:139], v[32:35], v[132:135]
    v_exp_f32 v21, v21
    v_mfma_f32_16x16x32_bf16 v[132:135], a[140:143], v[36:39], v[132:135]
    ds_read_b64_tr_b16 a[228:229], v2 offset:37504
    v_mfma_f32_16x16x32_bf16 v[136:139], a[144:147], v[32:35], v[136:139]
    v_exp_f32 v22, v22
    v_mfma_f32_16x16x32_bf16 v[136:139], a[148:151], v[36:39], v[136:139]
    ds_read_b64_tr_b16 a[230:231], v2 offset:37760
    v_perm_b32 v42, v21, v20, s100
    v_mfma_f32_16x16x32_bf16 v[140:143], a[152:155], v[32:35], v[140:143]
    v_exp_f32 v23, v23
    v_mfma_f32_16x16x32_bf16 v[140:143], a[156:159], v[36:39], v[140:143]
    ds_read_b64_tr_b16 a[232:233], v2 offset:37024
    v_mfma_f32_16x16x32_bf16 v[144:147], a[160:163], v[32:35], v[144:147]
    v_exp_f32 v24, v24
    v_mfma_f32_16x16x32_bf16 v[144:147], a[164:167], v[36:39], v[144:147]
    ds_read_b64_tr_b16 a[234:235], v2 offset:37280
    v_perm_b32 v43, v23, v22, s100
    v_mfma_f32_16x16x32_bf16 v[148:151], a[168:171], v[32:35], v[148:151]
    v_exp_f32 v25, v25
    v_mfma_f32_16x16x32_bf16 v[148:151], a[172:175], v[36:39], v[148:151]
    ds_read_b64_tr_b16 a[236:237], v2 offset:37536
    v_mfma_f32_16x16x32_bf16 v[152:155], a[176:179], v[32:35], v[152:155]
    v_exp_f32 v26, v26
    v_mfma_f32_16x16x32_bf16 v[152:155], a[180:183], v[36:39], v[152:155]
    ds_read_b64_tr_b16 a[238:239], v2 offset:37792
    v_perm_b32 v44, v25, v24, s100
    v_mfma_f32_16x16x32_bf16 v[156:159], a[184:187], v[32:35], v[156:159]
    v_exp_f32 v27, v27
    v_mfma_f32_16x16x32_bf16 v[156:159], a[188:191], v[36:39], v[156:159]
    ds_read_b64_tr_b16 a[240:241], v2 offset:37056
    v_smfmac_f32_16x16x64_bf16 a[0:3], a[16:19], v[32:39], v11
    ds_read_b64_tr_b16 a[242:243], v2 offset:37312
    v_mfma_f32_16x16x32_bf16 v[16:19], a[64:67], v[96:99], v[56:59]
    v_exp_f32 v28, v28
    v_mfma_f32_16x16x32_bf16 v[16:19], a[68:71], v[100:103], v[16:19]
    ds_read_b64_tr_b16 a[244:245], v2 offset:37568
    v_perm_b32 v45, v27, v26, s100
    v_mfma_f32_16x16x32_bf16 v[16:19], a[72:75], v[104:107], v[16:19]
    v_exp_f32 v29, v29
    v_mfma_f32_16x16x32_bf16 v[16:19], a[76:79], v[108:111], v[16:19]
    ds_read_b64_tr_b16 a[246:247], v2 offset:37824
    v_mfma_f32_16x16x32_bf16 v[20:23], a[80:83], v[96:99], v[56:59]
    v_exp_f32 v30, v30
    v_mfma_f32_16x16x32_bf16 v[20:23], a[84:87], v[100:103], v[20:23]
    ds_read_b64_tr_b16 a[248:249], v2 offset:37088
    v_perm_b32 v46, v29, v28, s100
    v_mfma_f32_16x16x32_bf16 v[20:23], a[88:91], v[104:107], v[20:23]
    v_exp_f32 v31, v31
    v_mfma_f32_16x16x32_bf16 v[20:23], a[92:95], v[108:111], v[20:23]
    ds_read_b64_tr_b16 a[250:251], v2 offset:37344
    v_mfma_f32_16x16x32_bf16 v[24:27], a[96:99], v[96:99], v[56:59]
    v_exp_f32 v16, v16
    v_mfma_f32_16x16x32_bf16 v[24:27], a[100:103], v[100:103], v[24:27]
    ds_read_b64_tr_b16 a[252:253], v2 offset:37600
    v_perm_b32 v47, v31, v30, s100
    v_mfma_f32_16x16x32_bf16 v[24:27], a[104:107], v[104:107], v[24:27]
    v_exp_f32 v17, v17
    v_mfma_f32_16x16x32_bf16 v[24:27], a[108:111], v[108:111], v[24:27]
    ds_read_b64_tr_b16 a[254:255], v2 offset:37856
    v_mfma_f32_16x16x32_bf16 v[28:31], a[112:115], v[96:99], v[56:59]
    v_exp_f32 v18, v18
    v_mfma_f32_16x16x32_bf16 v[28:31], a[116:119], v[100:103], v[28:31]
    v_perm_b32 v32, v17, v16, s100
    v_mfma_f32_16x16x32_bf16 v[28:31], a[120:123], v[104:107], v[28:31]
    v_exp_f32 v19, v19
    v_mfma_f32_16x16x32_bf16 v[28:31], a[124:127], v[108:111], v[28:31]
    v_mfma_f32_16x16x32_bf16 v[160:163], a[128:131], v[40:43], v[160:163]
    v_exp_f32 v20, v20
    v_mfma_f32_16x16x32_bf16 v[160:163], a[132:135], v[44:47], v[160:163]
    v_perm_b32 v33, v19, v18, s100
    v_mfma_f32_16x16x32_bf16 v[164:167], a[136:139], v[40:43], v[164:167]
    v_exp_f32 v21, v21
    v_mfma_f32_16x16x32_bf16 v[164:167], a[140:143], v[44:47], v[164:167]
    v_mfma_f32_16x16x32_bf16 v[168:171], a[144:147], v[40:43], v[168:171]
    v_exp_f32 v22, v22
    v_mfma_f32_16x16x32_bf16 v[168:171], a[148:151], v[44:47], v[168:171]
    v_perm_b32 v34, v21, v20, s100
    v_mfma_f32_16x16x32_bf16 v[172:175], a[152:155], v[40:43], v[172:175]
    v_exp_f32 v23, v23
    v_mfma_f32_16x16x32_bf16 v[172:175], a[156:159], v[44:47], v[172:175]
    v_mfma_f32_16x16x32_bf16 v[176:179], a[160:163], v[40:43], v[176:179]
    v_exp_f32 v24, v24
    v_mfma_f32_16x16x32_bf16 v[176:179], a[164:167], v[44:47], v[176:179]
    v_perm_b32 v35, v23, v22, s100
    v_mfma_f32_16x16x32_bf16 v[180:183], a[168:171], v[40:43], v[180:183]
    v_exp_f32 v25, v25
    v_mfma_f32_16x16x32_bf16 v[180:183], a[172:175], v[44:47], v[180:183]
    v_mfma_f32_16x16x32_bf16 v[184:187], a[176:179], v[40:43], v[184:187]
    v_exp_f32 v26, v26
    v_mfma_f32_16x16x32_bf16 v[184:187], a[180:183], v[44:47], v[184:187]
    v_perm_b32 v36, v25, v24, s100
    v_mfma_f32_16x16x32_bf16 v[188:191], a[184:187], v[40:43], v[188:191]
    v_exp_f32 v27, v27
    v_mfma_f32_16x16x32_bf16 v[188:191], a[188:191], v[44:47], v[188:191]
    v_smfmac_f32_16x16x64_bf16 a[4:7], a[16:19], v[40:47], v11
    v_mfma_f32_16x16x32_bf16 v[16:19], a[64:67], v[112:115], v[60:63]
    v_exp_f32 v28, v28
    v_mfma_f32_16x16x32_bf16 v[16:19], a[68:71], v[116:119], v[16:19]
    ds_read_b128 a[64:67], v1 offset:36864
    v_perm_b32 v37, v27, v26, s100
    v_mfma_f32_16x16x32_bf16 v[16:19], a[72:75], v[120:123], v[16:19]
    v_exp_f32 v29, v29
    v_mfma_f32_16x16x32_bf16 v[16:19], a[76:79], v[124:127], v[16:19]
    ds_read_b128 a[68:71], v1 offset:36928
    v_mfma_f32_16x16x32_bf16 v[20:23], a[80:83], v[112:115], v[60:63]
    v_exp_f32 v30, v30
    v_mfma_f32_16x16x32_bf16 v[20:23], a[84:87], v[116:119], v[20:23]
    ds_read_b128 a[72:75], v1 offset:36992
    v_perm_b32 v38, v29, v28, s100
    v_mfma_f32_16x16x32_bf16 v[20:23], a[88:91], v[120:123], v[20:23]
    v_exp_f32 v31, v31
    v_mfma_f32_16x16x32_bf16 v[20:23], a[92:95], v[124:127], v[20:23]
    ds_read_b128 a[76:79], v1 offset:37056
    v_mfma_f32_16x16x32_bf16 v[24:27], a[96:99], v[112:115], v[60:63]
    v_exp_f32 v16, v16
    v_mfma_f32_16x16x32_bf16 v[24:27], a[100:103], v[116:119], v[24:27]
    ds_read_b128 a[80:83], v1 offset:37120
    v_perm_b32 v39, v31, v30, s100
    v_mfma_f32_16x16x32_bf16 v[24:27], a[104:107], v[120:123], v[24:27]
    v_exp_f32 v17, v17
    v_mfma_f32_16x16x32_bf16 v[24:27], a[108:111], v[124:127], v[24:27]
    ds_read_b128 a[84:87], v1 offset:37184
    v_mfma_f32_16x16x32_bf16 v[28:31], a[112:115], v[112:115], v[60:63]
    v_exp_f32 v18, v18
    v_mfma_f32_16x16x32_bf16 v[28:31], a[116:119], v[116:119], v[28:31]
    ds_read_b128 a[88:91], v1 offset:37248
    v_perm_b32 v40, v17, v16, s100
    v_mfma_f32_16x16x32_bf16 v[28:31], a[120:123], v[120:123], v[28:31]
    v_exp_f32 v19, v19
    v_mfma_f32_16x16x32_bf16 v[28:31], a[124:127], v[124:127], v[28:31]
    ds_read_b128 a[92:95], v1 offset:37312
    v_mfma_f32_16x16x32_bf16 v[192:195], a[128:131], v[32:35], v[192:195]
    v_exp_f32 v20, v20
    v_mfma_f32_16x16x32_bf16 v[192:195], a[132:135], v[36:39], v[192:195]
    ds_read_b128 a[96:99], v1 offset:37376
    v_perm_b32 v41, v19, v18, s100
    v_mfma_f32_16x16x32_bf16 v[196:199], a[136:139], v[32:35], v[196:199]
    v_exp_f32 v21, v21
    v_mfma_f32_16x16x32_bf16 v[196:199], a[140:143], v[36:39], v[196:199]
    ds_read_b128 a[100:103], v1 offset:37440
    v_mfma_f32_16x16x32_bf16 v[200:203], a[144:147], v[32:35], v[200:203]
    v_exp_f32 v22, v22
    v_mfma_f32_16x16x32_bf16 v[200:203], a[148:151], v[36:39], v[200:203]
    ds_read_b128 a[104:107], v1 offset:37504
    v_perm_b32 v42, v21, v20, s100
    v_mfma_f32_16x16x32_bf16 v[204:207], a[152:155], v[32:35], v[204:207]
    v_exp_f32 v23, v23
    v_mfma_f32_16x16x32_bf16 v[204:207], a[156:159], v[36:39], v[204:207]
L2_pad6:
    s_cbranch_execz L2_pad10
    ds_read_b128 a[108:111], v1 offset:37568
    v_mfma_f32_16x16x32_bf16 v[208:211], a[160:163], v[32:35], v[208:211]
    v_exp_f32 v24, v24
    v_mfma_f32_16x16x32_bf16 v[208:211], a[164:167], v[36:39], v[208:211]
    ds_read_b128 a[112:115], v1 offset:37632
    v_perm_b32 v43, v23, v22, s100
    v_mfma_f32_16x16x32_bf16 v[212:215], a[168:171], v[32:35], v[212:215]
    v_exp_f32 v25, v25
    v_mfma_f32_16x16x32_bf16 v[212:215], a[172:175], v[36:39], v[212:215]
    ds_read_b128 a[116:119], v1 offset:37696
    v_mfma_f32_16x16x32_bf16 v[216:219], a[176:179], v[32:35], v[216:219]
    v_exp_f32 v26, v26
    v_mfma_f32_16x16x32_bf16 v[216:219], a[180:183], v[36:39], v[216:219]
    ds_read_b128 a[120:123], v1 offset:37760
    v_perm_b32 v44, v25, v24, s100
    v_mfma_f32_16x16x32_bf16 v[220:223], a[184:187], v[32:35], v[220:223]
    v_exp_f32 v27, v27
    v_mfma_f32_16x16x32_bf16 v[220:223], a[188:191], v[36:39], v[220:223]
    ds_read_b128 a[124:127], v1 offset:37824
    v_smfmac_f32_16x16x64_bf16 a[8:11], a[16:19], v[32:39], v11
    s_waitcnt lgkmcnt(12)
    v_mfma_f32_16x16x32_bf16 v[16:19], a[64:67], v[64:67], v[48:51]
    s_sub_u32 s47, s47, s48
    v_exp_f32 v28, v28
    v_mfma_f32_16x16x32_bf16 v[16:19], a[68:71], v[68:71], v[16:19]
    v_perm_b32 v45, v27, v26, s100
    v_add_u32 v1, s48, v1
    v_mfma_f32_16x16x32_bf16 v[16:19], a[72:75], v[72:75], v[16:19]
    v_exp_f32 v29, v29
    v_mfma_f32_16x16x32_bf16 v[16:19], a[76:79], v[76:79], v[16:19]
    s_waitcnt lgkmcnt(8)
    v_mfma_f32_16x16x32_bf16 v[20:23], a[80:83], v[64:67], v[48:51]
    v_exp_f32 v30, v30
    v_mfma_f32_16x16x32_bf16 v[20:23], a[84:87], v[68:71], v[20:23]
    v_perm_b32 v46, v29, v28, s100
    v_add_u32 v2, s48, v2
    v_mfma_f32_16x16x32_bf16 v[20:23], a[88:91], v[72:75], v[20:23]
    v_exp_f32 v31, v31
    v_mfma_f32_16x16x32_bf16 v[20:23], a[92:95], v[76:79], v[20:23]
    s_waitcnt lgkmcnt(4)
    v_mfma_f32_16x16x32_bf16 v[24:27], a[96:99], v[64:67], v[48:51]
    s_sub_u32 s48, 0, s48
    v_exp_f32 v16, v16
    v_mfma_f32_16x16x32_bf16 v[24:27], a[100:103], v[68:71], v[24:27]
    v_perm_b32 v47, v31, v30, s100
    v_mfma_f32_16x16x32_bf16 v[24:27], a[104:107], v[72:75], v[24:27]
    v_exp_f32 v17, v17
    v_mfma_f32_16x16x32_bf16 v[24:27], a[108:111], v[76:79], v[24:27]
    s_waitcnt lgkmcnt(0)
    v_mfma_f32_16x16x32_bf16 v[28:31], a[112:115], v[64:67], v[48:51]
    v_exp_f32 v18, v18
    v_mfma_f32_16x16x32_bf16 v[28:31], a[116:119], v[68:71], v[28:31]
    v_perm_b32 v32, v17, v16, s100
    v_mfma_f32_16x16x32_bf16 v[28:31], a[120:123], v[72:75], v[28:31]
    v_exp_f32 v19, v19
    v_mfma_f32_16x16x32_bf16 v[28:31], a[124:127], v[76:79], v[28:31]
    s_waitcnt vmcnt(2)
    s_barrier
    v_mfma_f32_16x16x32_bf16 v[224:227], a[128:131], v[40:43], v[224:227]
    v_exp_f32 v20, v20
    v_mfma_f32_16x16x32_bf16 v[224:227], a[132:135], v[44:47], v[224:227]
    ds_read_b64_tr_b16 a[128:129], v2 offset:0
    v_perm_b32 v33, v19, v18, s100
    v_mfma_f32_16x16x32_bf16 v[228:231], a[136:139], v[40:43], v[228:231]
    s_add_u32 m0, s47, 0
    v_exp_f32 v21, v21
    v_mfma_f32_16x16x32_bf16 v[228:231], a[140:143], v[44:47], v[228:231]
    s_add_u32 s46, s46, 16384
    buffer_load_dwordx4 off, s[16:19], s46 offset:0 lds
    v_mfma_f32_16x16x32_bf16 v[232:235], a[144:147], v[40:43], v[232:235]
    v_exp_f32 v22, v22
    v_mfma_f32_16x16x32_bf16 v[232:235], a[148:151], v[44:47], v[232:235]
    ds_read_b64_tr_b16 a[130:131], v2 offset:256
    v_perm_b32 v34, v21, v20, s100
    v_mfma_f32_16x16x32_bf16 v[236:239], a[152:155], v[40:43], v[236:239]
    s_add_u32 m0, s47, 32
    v_exp_f32 v23, v23
    v_mfma_f32_16x16x32_bf16 v[236:239], a[156:159], v[44:47], v[236:239]
    buffer_load_dwordx4 off, s[16:19], s46 offset:1024 lds
    v_mfma_f32_16x16x32_bf16 v[240:243], a[160:163], v[40:43], v[240:243]
    v_exp_f32 v24, v24
    v_mfma_f32_16x16x32_bf16 v[240:243], a[164:167], v[44:47], v[240:243]
    ds_read_b64_tr_b16 a[132:133], v2 offset:512
    v_perm_b32 v35, v23, v22, s100
    v_mfma_f32_16x16x32_bf16 v[244:247], a[168:171], v[40:43], v[244:247]
    s_add_u32 m0, s47, 64
    v_exp_f32 v25, v25
    v_mfma_f32_16x16x32_bf16 v[244:247], a[172:175], v[44:47], v[244:247]
    buffer_load_dwordx4 off, s[16:19], s46 offset:2048 lds
    v_mfma_f32_16x16x32_bf16 v[248:251], a[176:179], v[40:43], v[248:251]
    v_exp_f32 v26, v26
    v_mfma_f32_16x16x32_bf16 v[248:251], a[180:183], v[44:47], v[248:251]
    ds_read_b64_tr_b16 a[134:135], v2 offset:768
    v_perm_b32 v36, v25, v24, s100
    v_mfma_f32_16x16x32_bf16 v[252:255], a[184:187], v[40:43], v[252:255]
    s_add_u32 m0, s47, 96
    v_exp_f32 v27, v27
    v_mfma_f32_16x16x32_bf16 v[252:255], a[188:191], v[44:47], v[252:255]
    buffer_load_dwordx4 off, s[16:19], s46 offset:3072 lds
    v_smfmac_f32_16x16x64_bf16 a[12:15], a[16:19], v[40:47], v11
    ds_read_b64_tr_b16 a[136:137], v2 offset:32
    v_mfma_f32_16x16x32_bf16 v[16:19], a[64:67], v[80:83], v[52:55]
    v_exp_f32 v28, v28
    v_mfma_f32_16x16x32_bf16 v[16:19], a[68:71], v[84:87], v[16:19]
    ds_read_b64_tr_b16 a[138:139], v2 offset:288
    v_perm_b32 v37, v27, v26, s100
    v_mfma_f32_16x16x32_bf16 v[16:19], a[72:75], v[88:91], v[16:19]
    s_add_u32 m0, s47, 16896
    v_exp_f32 v29, v29
    v_mfma_f32_16x16x32_bf16 v[16:19], a[76:79], v[92:95], v[16:19]
    buffer_load_dwordx4 off, s[20:23], s46 offset:0 lds
    v_mfma_f32_16x16x32_bf16 v[20:23], a[80:83], v[80:83], v[52:55]
    v_exp_f32 v30, v30
    v_mfma_f32_16x16x32_bf16 v[20:23], a[84:87], v[84:87], v[20:23]
    ds_read_b64_tr_b16 a[140:141], v2 offset:544
    v_perm_b32 v38, v29, v28, s100
    v_mfma_f32_16x16x32_bf16 v[20:23], a[88:91], v[88:91], v[20:23]
    s_add_u32 m0, s47, 16928
    v_exp_f32 v31, v31
    v_mfma_f32_16x16x32_bf16 v[20:23], a[92:95], v[92:95], v[20:23]
    buffer_load_dwordx4 off, s[20:23], s46 offset:1024 lds
    v_mfma_f32_16x16x32_bf16 v[24:27], a[96:99], v[80:83], v[52:55]
    v_exp_f32 v16, v16
    v_mfma_f32_16x16x32_bf16 v[24:27], a[100:103], v[84:87], v[24:27]
    ds_read_b64_tr_b16 a[142:143], v2 offset:800
    v_perm_b32 v39, v31, v30, s100
    v_mfma_f32_16x16x32_bf16 v[24:27], a[104:107], v[88:91], v[24:27]
    s_add_u32 m0, s47, 16960
    v_exp_f32 v17, v17
    v_mfma_f32_16x16x32_bf16 v[24:27], a[108:111], v[92:95], v[24:27]
    buffer_load_dwordx4 off, s[20:23], s46 offset:2048 lds
    v_mfma_f32_16x16x32_bf16 v[28:31], a[112:115], v[80:83], v[52:55]
    v_exp_f32 v18, v18
    v_mfma_f32_16x16x32_bf16 v[28:31], a[116:119], v[84:87], v[28:31]
    ds_read_b64_tr_b16 a[144:145], v2 offset:64
    v_perm_b32 v40, v17, v16, s100
    v_mfma_f32_16x16x32_bf16 v[28:31], a[120:123], v[88:91], v[28:31]
    s_add_u32 m0, s47, 16992
    v_exp_f32 v19, v19
    v_mfma_f32_16x16x32_bf16 v[28:31], a[124:127], v[92:95], v[28:31]
    buffer_load_dwordx4 off, s[20:23], s46 offset:3072 lds
    v_mfma_f32_16x16x32_bf16 v[128:131], a[192:195], v[32:35], v[128:131]
    v_exp_f32 v20, v20
    v_mfma_f32_16x16x32_bf16 v[128:131], a[196:199], v[36:39], v[128:131]
    ds_read_b64_tr_b16 a[146:147], v2 offset:320
    v_perm_b32 v41, v19, v18, s100
    v_mfma_f32_16x16x32_bf16 v[132:135], a[200:203], v[32:35], v[132:135]
    v_exp_f32 v21, v21
    v_mfma_f32_16x16x32_bf16 v[132:135], a[204:207], v[36:39], v[132:135]
    ds_read_b64_tr_b16 a[148:149], v2 offset:576
    v_mfma_f32_16x16x32_bf16 v[136:139], a[208:211], v[32:35], v[136:139]
    v_exp_f32 v22, v22
    v_mfma_f32_16x16x32_bf16 v[136:139], a[212:215], v[36:39], v[136:139]
    ds_read_b64_tr_b16 a[150:151], v2 offset:832
    v_perm_b32 v42, v21, v20, s100
    v_mfma_f32_16x16x32_bf16 v[140:143], a[216:219], v[32:35], v[140:143]
    v_exp_f32 v23, v23
    v_mfma_f32_16x16x32_bf16 v[140:143], a[220:223], v[36:39], v[140:143]
    ds_read_b64_tr_b16 a[152:153], v2 offset:96
    ds_read_b64_tr_b16 a[154:155], v2 offset:352
    v_mfma_f32_16x16x32_bf16 v[144:147], a[224:227], v[32:35], v[144:147]
    v_exp_f32 v24, v24
    v_mfma_f32_16x16x32_bf16 v[144:147], a[228:231], v[36:39], v[144:147]
    ds_read_b64_tr_b16 a[156:157], v2 offset:608
    v_perm_b32 v43, v23, v22, s100
    v_mfma_f32_16x16x32_bf16 v[148:151], a[232:235], v[32:35], v[148:151]
    v_exp_f32 v25, v25
    v_mfma_f32_16x16x32_bf16 v[148:151], a[236:239], v[36:39], v[148:151]
    ds_read_b64_tr_b16 a[158:159], v2 offset:864
    ds_read_b64_tr_b16 a[160:161], v2 offset:128
    v_mfma_f32_16x16x32_bf16 v[152:155], a[240:243], v[32:35], v[152:155]
    v_exp_f32 v26, v26
    v_mfma_f32_16x16x32_bf16 v[152:155], a[244:247], v[36:39], v[152:155]
    ds_read_b64_tr_b16 a[162:163], v2 offset:384
    v_perm_b32 v44, v25, v24, s100
    v_mfma_f32_16x16x32_bf16 v[156:159], a[248:251], v[32:35], v[156:159]
    v_exp_f32 v27, v27
    v_mfma_f32_16x16x32_bf16 v[156:159], a[252:255], v[36:39], v[156:159]
    ds_read_b64_tr_b16 a[164:165], v2 offset:640
    ds_read_b64_tr_b16 a[166:167], v2 offset:896
    v_smfmac_f32_16x16x64_bf16 a[0:3], a[16:19], v[32:39], v11
    ds_read_b64_tr_b16 a[168:169], v2 offset:160
    ds_read_b64_tr_b16 a[170:171], v2 offset:416
    v_mfma_f32_16x16x32_bf16 v[16:19], a[64:67], v[96:99], v[56:59]
    v_exp_f32 v28, v28
    v_mfma_f32_16x16x32_bf16 v[16:19], a[68:71], v[100:103], v[16:19]
    ds_read_b64_tr_b16 a[172:173], v2 offset:672
    v_perm_b32 v45, v27, v26, s100
    v_mfma_f32_16x16x32_bf16 v[16:19], a[72:75], v[104:107], v[16:19]
    s_add_u32 m0, s47, 36864
    v_exp_f32 v29, v29
    v_mfma_f32_16x16x32_bf16 v[16:19], a[76:79], v[108:111], v[16:19]
    s_add_u32 s46, s46, 16384
    buffer_load_dwordx4 off, s[16:19], s46 offset:0 lds
    v_mfma_f32_16x16x32_bf16 v[20:23], a[80:83], v[96:99], v[56:59]
    v_exp_f32 v30, v30
    v_mfma_f32_16x16x32_bf16 v[20:23], a[84:87], v[100:103], v[20:23]
    ds_read_b64_tr_b16 a[174:175], v2 offset:928
    v_perm_b32 v46, v29, v28, s100
    v_mfma_f32_16x16x32_bf16 v[20:23], a[88:91], v[104:107], v[20:23]
    s_add_u32 m0, s47, 36896
    v_exp_f32 v31, v31
    v_mfma_f32_16x16x32_bf16 v[20:23], a[92:95], v[108:111], v[20:23]
    buffer_load_dwordx4 off, s[16:19], s46 offset:1024 lds
    v_mfma_f32_16x16x32_bf16 v[24:27], a[96:99], v[96:99], v[56:59]
    v_exp_f32 v16, v16
    v_mfma_f32_16x16x32_bf16 v[24:27], a[100:103], v[100:103], v[24:27]
    ds_read_b64_tr_b16 a[176:177], v2 offset:192
    v_perm_b32 v47, v31, v30, s100
    v_mfma_f32_16x16x32_bf16 v[24:27], a[104:107], v[104:107], v[24:27]
    s_add_u32 m0, s47, 36928
    v_exp_f32 v17, v17
    v_mfma_f32_16x16x32_bf16 v[24:27], a[108:111], v[108:111], v[24:27]
    buffer_load_dwordx4 off, s[16:19], s46 offset:2048 lds
    v_mfma_f32_16x16x32_bf16 v[28:31], a[112:115], v[96:99], v[56:59]
    v_exp_f32 v18, v18
    v_mfma_f32_16x16x32_bf16 v[28:31], a[116:119], v[100:103], v[28:31]
    ds_read_b64_tr_b16 a[178:179], v2 offset:448
    v_perm_b32 v32, v17, v16, s100
    v_mfma_f32_16x16x32_bf16 v[28:31], a[120:123], v[104:107], v[28:31]
    s_add_u32 m0, s47, 36960
    v_exp_f32 v19, v19
    v_mfma_f32_16x16x32_bf16 v[28:31], a[124:127], v[108:111], v[28:31]
    buffer_load_dwordx4 off, s[16:19], s46 offset:3072 lds
    v_mfma_f32_16x16x32_bf16 v[160:163], a[192:195], v[40:43], v[160:163]
    v_exp_f32 v20, v20
    v_mfma_f32_16x16x32_bf16 v[160:163], a[196:199], v[44:47], v[160:163]
    ds_read_b64_tr_b16 a[180:181], v2 offset:704
    v_perm_b32 v33, v19, v18, s100
    v_mfma_f32_16x16x32_bf16 v[164:167], a[200:203], v[40:43], v[164:167]
    s_add_u32 m0, s47, 53760
    v_exp_f32 v21, v21
    v_mfma_f32_16x16x32_bf16 v[164:167], a[204:207], v[44:47], v[164:167]
    buffer_load_dwordx4 off, s[20:23], s46 offset:0 lds
    v_mfma_f32_16x16x32_bf16 v[168:171], a[208:211], v[40:43], v[168:171]
    v_exp_f32 v22, v22
    v_mfma_f32_16x16x32_bf16 v[168:171], a[212:215], v[44:47], v[168:171]
    ds_read_b64_tr_b16 a[182:183], v2 offset:960
    v_perm_b32 v34, v21, v20, s100
    v_mfma_f32_16x16x32_bf16 v[172:175], a[216:219], v[40:43], v[172:175]
    s_add_u32 m0, s47, 53792
    v_exp_f32 v23, v23
    v_mfma_f32_16x16x32_bf16 v[172:175], a[220:223], v[44:47], v[172:175]
    buffer_load_dwordx4 off, s[20:23], s46 offset:1024 lds
    v_mfma_f32_16x16x32_bf16 v[176:179], a[224:227], v[40:43], v[176:179]
    v_exp_f32 v24, v24
    v_mfma_f32_16x16x32_bf16 v[176:179], a[228:231], v[44:47], v[176:179]
    ds_read_b64_tr_b16 a[184:185], v2 offset:224
    v_perm_b32 v35, v23, v22, s100
    v_mfma_f32_16x16x32_bf16 v[180:183], a[232:235], v[40:43], v[180:183]
    s_add_u32 m0, s47, 53824
    v_exp_f32 v25, v25
    v_mfma_f32_16x16x32_bf16 v[180:183], a[236:239], v[44:47], v[180:183]
    buffer_load_dwordx4 off, s[20:23], s46 offset:2048 lds
    v_mfma_f32_16x16x32_bf16 v[184:187], a[240:243], v[40:43], v[184:187]
    v_exp_f32 v26, v26
    v_mfma_f32_16x16x32_bf16 v[184:187], a[244:247], v[44:47], v[184:187]
    ds_read_b64_tr_b16 a[186:187], v2 offset:480
    v_perm_b32 v36, v25, v24, s100
    v_mfma_f32_16x16x32_bf16 v[188:191], a[248:251], v[40:43], v[188:191]
    s_add_u32 m0, s47, 53856
    v_exp_f32 v27, v27
    v_mfma_f32_16x16x32_bf16 v[188:191], a[252:255], v[44:47], v[188:191]
    buffer_load_dwordx4 off, s[20:23], s46 offset:3072 lds
    v_smfmac_f32_16x16x64_bf16 a[4:7], a[16:19], v[40:47], v11
    ds_read_b64_tr_b16 a[188:189], v2 offset:736
    ds_read_b64_tr_b16 a[190:191], v2 offset:992
    v_mfma_f32_16x16x32_bf16 v[16:19], a[64:67], v[112:115], v[60:63]
    v_exp_f32 v28, v28
    v_mfma_f32_16x16x32_bf16 v[16:19], a[68:71], v[116:119], v[16:19]
    ds_read_b128 a[64:67], v1 offset:0
    v_perm_b32 v37, v27, v26, s100
    v_mfma_f32_16x16x32_bf16 v[16:19], a[72:75], v[120:123], v[16:19]
    v_exp_f32 v29, v29
    v_mfma_f32_16x16x32_bf16 v[16:19], a[76:79], v[124:127], v[16:19]
    ds_read_b128 a[68:71], v1 offset:64
    v_mfma_f32_16x16x32_bf16 v[20:23], a[80:83], v[112:115], v[60:63]
    v_exp_f32 v30, v30
    v_mfma_f32_16x16x32_bf16 v[20:23], a[84:87], v[116:119], v[20:23]
    ds_read_b128 a[72:75], v1 offset:128
    v_perm_b32 v38, v29, v28, s100
    v_mfma_f32_16x16x32_bf16 v[20:23], a[88:91], v[120:123], v[20:23]
    v_exp_f32 v31, v31
    v_mfma_f32_16x16x32_bf16 v[20:23], a[92:95], v[124:127], v[20:23]
    ds_read_b128 a[76:79], v1 offset:192
    v_mfma_f32_16x16x32_bf16 v[24:27], a[96:99], v[112:115], v[60:63]
    v_exp_f32 v16, v16
    v_mfma_f32_16x16x32_bf16 v[24:27], a[100:103], v[116:119], v[24:27]
    ds_read_b128 a[80:83], v1 offset:256
    v_perm_b32 v39, v31, v30, s100
    v_mfma_f32_16x16x32_bf16 v[24:27], a[104:107], v[120:123], v[24:27]
    v_exp_f32 v17, v17
    v_mfma_f32_16x16x32_bf16 v[24:27], a[108:111], v[124:127], v[24:27]
    ds_read_b128 a[84:87], v1 offset:320
    v_mfma_f32_16x16x32_bf16 v[28:31], a[112:115], v[112:115], v[60:63]
    v_exp_f32 v18, v18
    v_mfma_f32_16x16x32_bf16 v[28:31], a[116:119], v[116:119], v[28:31]
    ds_read_b128 a[88:91], v1 offset:384
    v_perm_b32 v40, v17, v16, s100
    v_mfma_f32_16x16x32_bf16 v[28:31], a[120:123], v[120:123], v[28:31]
    v_exp_f32 v19, v19
    v_mfma_f32_16x16x32_bf16 v[28:31], a[124:127], v[124:127], v[28:31]
    ds_read_b128 a[92:95], v1 offset:448
    v_mfma_f32_16x16x32_bf16 v[192:195], a[192:195], v[32:35], v[192:195]
    v_exp_f32 v20, v20
    v_mfma_f32_16x16x32_bf16 v[192:195], a[196:199], v[36:39], v[192:195]
    ds_read_b128 a[96:99], v1 offset:512
    v_perm_b32 v41, v19, v18, s100
    v_mfma_f32_16x16x32_bf16 v[196:199], a[200:203], v[32:35], v[196:199]
    v_exp_f32 v21, v21
    v_mfma_f32_16x16x32_bf16 v[196:199], a[204:207], v[36:39], v[196:199]
    ds_read_b128 a[100:103], v1 offset:576
    v_mfma_f32_16x16x32_bf16 v[200:203], a[208:211], v[32:35], v[200:203]
    v_exp_f32 v22, v22
    v_mfma_f32_16x16x32_bf16 v[200:203], a[212:215], v[36:39], v[200:203]
    ds_read_b128 a[104:107], v1 offset:640
    v_perm_b32 v42, v21, v20, s100
    v_mfma_f32_16x16x32_bf16 v[204:207], a[216:219], v[32:35], v[204:207]
    v_exp_f32 v23, v23
    v_mfma_f32_16x16x32_bf16 v[204:207], a[220:223], v[36:39], v[204:207]
    ds_read_b128 a[108:111], v1 offset:704
    v_mfma_f32_16x16x32_bf16 v[208:211], a[224:227], v[32:35], v[208:211]
    v_exp_f32 v24, v24
    v_mfma_f32_16x16x32_bf16 v[208:211], a[228:231], v[36:39], v[208:211]
    ds_read_b128 a[112:115], v1 offset:768
    v_perm_b32 v43, v23, v22, s100
    v_mfma_f32_16x16x32_bf16 v[212:215], a[232:235], v[32:35], v[212:215]
    v_exp_f32 v25, v25
    v_mfma_f32_16x16x32_bf16 v[212:215], a[236:239], v[36:39], v[212:215]
    ds_read_b128 a[116:119], v1 offset:832
    v_mfma_f32_16x16x32_bf16 v[216:219], a[240:243], v[32:35], v[216:219]
    v_exp_f32 v26, v26
    v_mfma_f32_16x16x32_bf16 v[216:219], a[244:247], v[36:39], v[216:219]
    ds_read_b128 a[120:123], v1 offset:896
    v_perm_b32 v44, v25, v24, s100
    v_mfma_f32_16x16x32_bf16 v[220:223], a[248:251], v[32:35], v[220:223]
    v_exp_f32 v27, v27
    v_mfma_f32_16x16x32_bf16 v[220:223], a[252:255], v[36:39], v[220:223]
    ds_read_b128 a[124:127], v1 offset:960
    v_smfmac_f32_16x16x64_bf16 a[8:11], a[16:19], v[32:39], v11
    s_waitcnt lgkmcnt(12)
    v_mfma_f32_16x16x32_bf16 v[16:19], a[64:67], v[64:67], v[48:51]
    v_exp_f32 v28, v28
    v_mfma_f32_16x16x32_bf16 v[16:19], a[68:71], v[68:71], v[16:19]
    v_perm_b32 v45, v27, v26, s100
    v_mfma_f32_16x16x32_bf16 v[16:19], a[72:75], v[72:75], v[16:19]
    v_exp_f32 v29, v29
    v_mfma_f32_16x16x32_bf16 v[16:19], a[76:79], v[76:79], v[16:19]
    s_waitcnt lgkmcnt(8)
    global_load_dword a63, v15, s[10:11]
    v_mfma_f32_16x16x32_bf16 v[20:23], a[80:83], v[64:67], v[48:51]
    v_exp_f32 v30, v30
    v_mfma_f32_16x16x32_bf16 v[20:23], a[84:87], v[68:71], v[20:23]
    v_perm_b32 v46, v29, v28, s100
    v_mfma_f32_16x16x32_bf16 v[20:23], a[88:91], v[72:75], v[20:23]
    v_exp_f32 v31, v31
    v_mfma_f32_16x16x32_bf16 v[20:23], a[92:95], v[76:79], v[20:23]
    s_waitcnt lgkmcnt(4)
    v_mfma_f32_16x16x32_bf16 v[24:27], a[96:99], v[64:67], v[48:51]
    v_exp_f32 v16, v16
    v_mfma_f32_16x16x32_bf16 v[24:27], a[100:103], v[68:71], v[24:27]
    v_perm_b32 v47, v31, v30, s100
    v_mfma_f32_16x16x32_bf16 v[24:27], a[104:107], v[72:75], v[24:27]
    v_exp_f32 v17, v17
    v_mfma_f32_16x16x32_bf16 v[24:27], a[108:111], v[76:79], v[24:27]
    s_waitcnt lgkmcnt(0)
    global_load_dword a63, v12, s[6:7]
    v_mfma_f32_16x16x32_bf16 v[28:31], a[112:115], v[64:67], v[48:51]
    v_exp_f32 v18, v18
    v_mfma_f32_16x16x32_bf16 v[28:31], a[116:119], v[68:71], v[28:31]
    v_perm_b32 v32, v17, v16, s100
    v_mfma_f32_16x16x32_bf16 v[28:31], a[120:123], v[72:75], v[28:31]
    v_exp_f32 v19, v19
    v_mfma_f32_16x16x32_bf16 v[28:31], a[124:127], v[76:79], v[28:31]
    v_mfma_f32_16x16x32_bf16 v[224:227], a[192:195], v[40:43], v[224:227]
    v_exp_f32 v20, v20
    v_mfma_f32_16x16x32_bf16 v[224:227], a[196:199], v[44:47], v[224:227]
    ds_read_b64_tr_b16 a[192:193], v2 offset:36864
    v_perm_b32 v33, v19, v18, s100
    v_mfma_f32_16x16x32_bf16 v[228:231], a[200:203], v[40:43], v[228:231]
    v_exp_f32 v21, v21
    v_mfma_f32_16x16x32_bf16 v[228:231], a[204:207], v[44:47], v[228:231]
    ds_read_b64_tr_b16 a[194:195], v2 offset:37120
    v_mfma_f32_16x16x32_bf16 v[232:235], a[208:211], v[40:43], v[232:235]
    v_exp_f32 v22, v22
    v_mfma_f32_16x16x32_bf16 v[232:235], a[212:215], v[44:47], v[232:235]
    ds_read_b64_tr_b16 a[196:197], v2 offset:37376
    v_perm_b32 v34, v21, v20, s100
    v_mfma_f32_16x16x32_bf16 v[236:239], a[216:219], v[40:43], v[236:239]
    v_exp_f32 v23, v23
    v_mfma_f32_16x16x32_bf16 v[236:239], a[220:223], v[44:47], v[236:239]
    ds_read_b64_tr_b16 a[198:199], v2 offset:37632
    v_mfma_f32_16x16x32_bf16 v[240:243], a[224:227], v[40:43], v[240:243]
    v_exp_f32 v24, v24
    v_mfma_f32_16x16x32_bf16 v[240:243], a[228:231], v[44:47], v[240:243]
    ds_read_b64_tr_b16 a[200:201], v2 offset:36896
    v_perm_b32 v35, v23, v22, s100
    v_mfma_f32_16x16x32_bf16 v[244:247], a[232:235], v[40:43], v[244:247]
    v_exp_f32 v25, v25
    v_mfma_f32_16x16x32_bf16 v[244:247], a[236:239], v[44:47], v[244:247]
    ds_read_b64_tr_b16 a[202:203], v2 offset:37152
    v_mfma_f32_16x16x32_bf16 v[248:251], a[240:243], v[40:43], v[248:251]
    v_exp_f32 v26, v26
    v_mfma_f32_16x16x32_bf16 v[248:251], a[244:247], v[44:47], v[248:251]
    ds_read_b64_tr_b16 a[204:205], v2 offset:37408
    v_perm_b32 v36, v25, v24, s100
    v_mfma_f32_16x16x32_bf16 v[252:255], a[248:251], v[40:43], v[252:255]
    v_exp_f32 v27, v27
    v_mfma_f32_16x16x32_bf16 v[252:255], a[252:255], v[44:47], v[252:255]
    ds_read_b64_tr_b16 a[206:207], v2 offset:37664
    v_smfmac_f32_16x16x64_bf16 a[12:15], a[16:19], v[40:47], v11
    ds_read_b64_tr_b16 a[208:209], v2 offset:36928
    v_mfma_f32_16x16x32_bf16 v[16:19], a[64:67], v[80:83], v[52:55]
    v_exp_f32 v28, v28
    v_mfma_f32_16x16x32_bf16 v[16:19], a[68:71], v[84:87], v[16:19]
    ds_read_b64_tr_b16 a[210:211], v2 offset:37184
    v_perm_b32 v37, v27, v26, s100
    v_mfma_f32_16x16x32_bf16 v[16:19], a[72:75], v[88:91], v[16:19]
    v_exp_f32 v29, v29
    v_mfma_f32_16x16x32_bf16 v[16:19], a[76:79], v[92:95], v[16:19]
    ds_read_b64_tr_b16 a[212:213], v2 offset:37440
    v_mfma_f32_16x16x32_bf16 v[20:23], a[80:83], v[80:83], v[52:55]
    v_exp_f32 v30, v30
    v_mfma_f32_16x16x32_bf16 v[20:23], a[84:87], v[84:87], v[20:23]
    ds_read_b64_tr_b16 a[214:215], v2 offset:37696
    v_perm_b32 v38, v29, v28, s100
    v_mfma_f32_16x16x32_bf16 v[20:23], a[88:91], v[88:91], v[20:23]
    v_exp_f32 v31, v31
    v_mfma_f32_16x16x32_bf16 v[20:23], a[92:95], v[92:95], v[20:23]
    ds_read_b64_tr_b16 a[216:217], v2 offset:36960
    v_mfma_f32_16x16x32_bf16 v[24:27], a[96:99], v[80:83], v[52:55]
    v_exp_f32 v16, v16
    v_mfma_f32_16x16x32_bf16 v[24:27], a[100:103], v[84:87], v[24:27]
    ds_read_b64_tr_b16 a[218:219], v2 offset:37216
    v_perm_b32 v39, v31, v30, s100
    v_mfma_f32_16x16x32_bf16 v[24:27], a[104:107], v[88:91], v[24:27]
    v_exp_f32 v17, v17
    v_mfma_f32_16x16x32_bf16 v[24:27], a[108:111], v[92:95], v[24:27]
    ds_read_b64_tr_b16 a[220:221], v2 offset:37472
    v_mfma_f32_16x16x32_bf16 v[28:31], a[112:115], v[80:83], v[52:55]
    v_exp_f32 v18, v18
    v_mfma_f32_16x16x32_bf16 v[28:31], a[116:119], v[84:87], v[28:31]
    ds_read_b64_tr_b16 a[222:223], v2 offset:37728
    v_perm_b32 v40, v17, v16, s100
    v_mfma_f32_16x16x32_bf16 v[28:31], a[120:123], v[88:91], v[28:31]
    v_exp_f32 v19, v19
    v_mfma_f32_16x16x32_bf16 v[28:31], a[124:127], v[92:95], v[28:31]
    ds_read_b64_tr_b16 a[224:225], v2 offset:36992
    v_mfma_f32_16x16x32_bf16 v[128:131], a[128:131], v[32:35], v[128:131]
    v_exp_f32 v20, v20
    v_mfma_f32_16x16x32_bf16 v[128:131], a[132:135], v[36:39], v[128:131]
    ds_read_b64_tr_b16 a[226:227], v2 offset:37248
    v_perm_b32 v41, v19, v18, s100
    v_mfma_f32_16x16x32_bf16 v[132:135], a[136:139], v[32:35], v[132:135]
    v_exp_f32 v21, v21
    v_mfma_f32_16x16x32_bf16 v[132:135], a[140:143], v[36:39], v[132:135]
    ds_read_b64_tr_b16 a[228:229], v2 offset:37504
    v_mfma_f32_16x16x32_bf16 v[136:139], a[144:147], v[32:35], v[136:139]
    v_exp_f32 v22, v22
    v_mfma_f32_16x16x32_bf16 v[136:139], a[148:151], v[36:39], v[136:139]
    ds_read_b64_tr_b16 a[230:231], v2 offset:37760
    v_perm_b32 v42, v21, v20, s100
    v_mfma_f32_16x16x32_bf16 v[140:143], a[152:155], v[32:35], v[140:143]
    v_exp_f32 v23, v23
    v_mfma_f32_16x16x32_bf16 v[140:143], a[156:159], v[36:39], v[140:143]
    ds_read_b64_tr_b16 a[232:233], v2 offset:37024
    v_mfma_f32_16x16x32_bf16 v[144:147], a[160:163], v[32:35], v[144:147]
    v_exp_f32 v24, v24
    v_mfma_f32_16x16x32_bf16 v[144:147], a[164:167], v[36:39], v[144:147]
    ds_read_b64_tr_b16 a[234:235], v2 offset:37280
    v_perm_b32 v43, v23, v22, s100
    v_mfma_f32_16x16x32_bf16 v[148:151], a[168:171], v[32:35], v[148:151]
    v_exp_f32 v25, v25
    v_mfma_f32_16x16x32_bf16 v[148:151], a[172:175], v[36:39], v[148:151]
    ds_read_b64_tr_b16 a[236:237], v2 offset:37536
    v_mfma_f32_16x16x32_bf16 v[152:155], a[176:179], v[32:35], v[152:155]
    v_exp_f32 v26, v26
    v_mfma_f32_16x16x32_bf16 v[152:155], a[180:183], v[36:39], v[152:155]
    ds_read_b64_tr_b16 a[238:239], v2 offset:37792
    v_perm_b32 v44, v25, v24, s100
    v_mfma_f32_16x16x32_bf16 v[156:159], a[184:187], v[32:35], v[156:159]
    v_exp_f32 v27, v27
    v_mfma_f32_16x16x32_bf16 v[156:159], a[188:191], v[36:39], v[156:159]
    ds_read_b64_tr_b16 a[240:241], v2 offset:37056
    v_smfmac_f32_16x16x64_bf16 a[0:3], a[16:19], v[32:39], v11
    ds_read_b64_tr_b16 a[242:243], v2 offset:37312
    v_mfma_f32_16x16x32_bf16 v[16:19], a[64:67], v[96:99], v[56:59]
    v_exp_f32 v28, v28
    v_mfma_f32_16x16x32_bf16 v[16:19], a[68:71], v[100:103], v[16:19]
    ds_read_b64_tr_b16 a[244:245], v2 offset:37568
    v_perm_b32 v45, v27, v26, s100
    v_mfma_f32_16x16x32_bf16 v[16:19], a[72:75], v[104:107], v[16:19]
    v_exp_f32 v29, v29
    v_mfma_f32_16x16x32_bf16 v[16:19], a[76:79], v[108:111], v[16:19]
    ds_read_b64_tr_b16 a[246:247], v2 offset:37824
    v_mfma_f32_16x16x32_bf16 v[20:23], a[80:83], v[96:99], v[56:59]
    v_exp_f32 v30, v30
    v_mfma_f32_16x16x32_bf16 v[20:23], a[84:87], v[100:103], v[20:23]
    ds_read_b64_tr_b16 a[248:249], v2 offset:37088
    v_perm_b32 v46, v29, v28, s100
    v_mfma_f32_16x16x32_bf16 v[20:23], a[88:91], v[104:107], v[20:23]
    v_exp_f32 v31, v31
    v_mfma_f32_16x16x32_bf16 v[20:23], a[92:95], v[108:111], v[20:23]
    ds_read_b64_tr_b16 a[250:251], v2 offset:37344
    v_mfma_f32_16x16x32_bf16 v[24:27], a[96:99], v[96:99], v[56:59]
    v_exp_f32 v16, v16
    v_mfma_f32_16x16x32_bf16 v[24:27], a[100:103], v[100:103], v[24:27]
    ds_read_b64_tr_b16 a[252:253], v2 offset:37600
    v_perm_b32 v47, v31, v30, s100
    v_mfma_f32_16x16x32_bf16 v[24:27], a[104:107], v[104:107], v[24:27]
    v_exp_f32 v17, v17
    v_mfma_f32_16x16x32_bf16 v[24:27], a[108:111], v[108:111], v[24:27]
    ds_read_b64_tr_b16 a[254:255], v2 offset:37856
    v_mfma_f32_16x16x32_bf16 v[28:31], a[112:115], v[96:99], v[56:59]
    v_exp_f32 v18, v18
    v_mfma_f32_16x16x32_bf16 v[28:31], a[116:119], v[100:103], v[28:31]
    v_perm_b32 v32, v17, v16, s100
    v_mfma_f32_16x16x32_bf16 v[28:31], a[120:123], v[104:107], v[28:31]
    v_exp_f32 v19, v19
    v_mfma_f32_16x16x32_bf16 v[28:31], a[124:127], v[108:111], v[28:31]
    v_mfma_f32_16x16x32_bf16 v[160:163], a[128:131], v[40:43], v[160:163]
    v_exp_f32 v20, v20
    v_mfma_f32_16x16x32_bf16 v[160:163], a[132:135], v[44:47], v[160:163]
    v_perm_b32 v33, v19, v18, s100
    v_mfma_f32_16x16x32_bf16 v[164:167], a[136:139], v[40:43], v[164:167]
    v_exp_f32 v21, v21
    v_mfma_f32_16x16x32_bf16 v[164:167], a[140:143], v[44:47], v[164:167]
    v_mfma_f32_16x16x32_bf16 v[168:171], a[144:147], v[40:43], v[168:171]
    v_exp_f32 v22, v22
    v_mfma_f32_16x16x32_bf16 v[168:171], a[148:151], v[44:47], v[168:171]
    v_perm_b32 v34, v21, v20, s100
    v_mfma_f32_16x16x32_bf16 v[172:175], a[152:155], v[40:43], v[172:175]
    v_exp_f32 v23, v23
    v_mfma_f32_16x16x32_bf16 v[172:175], a[156:159], v[44:47], v[172:175]
    v_mfma_f32_16x16x32_bf16 v[176:179], a[160:163], v[40:43], v[176:179]
    v_exp_f32 v24, v24
    v_mfma_f32_16x16x32_bf16 v[176:179], a[164:167], v[44:47], v[176:179]
    v_perm_b32 v35, v23, v22, s100
    v_mfma_f32_16x16x32_bf16 v[180:183], a[168:171], v[40:43], v[180:183]
    v_exp_f32 v25, v25
    v_mfma_f32_16x16x32_bf16 v[180:183], a[172:175], v[44:47], v[180:183]
    v_mfma_f32_16x16x32_bf16 v[184:187], a[176:179], v[40:43], v[184:187]
    v_exp_f32 v26, v26
    v_mfma_f32_16x16x32_bf16 v[184:187], a[180:183], v[44:47], v[184:187]
    v_perm_b32 v36, v25, v24, s100
    v_mfma_f32_16x16x32_bf16 v[188:191], a[184:187], v[40:43], v[188:191]
    v_exp_f32 v27, v27
    v_mfma_f32_16x16x32_bf16 v[188:191], a[188:191], v[44:47], v[188:191]
    v_smfmac_f32_16x16x64_bf16 a[4:7], a[16:19], v[40:47], v11
    v_mfma_f32_16x16x32_bf16 v[16:19], a[64:67], v[112:115], v[60:63]
    v_exp_f32 v28, v28
    v_mfma_f32_16x16x32_bf16 v[16:19], a[68:71], v[116:119], v[16:19]
    ds_read_b128 a[64:67], v1 offset:36864
    v_perm_b32 v37, v27, v26, s100
    v_mfma_f32_16x16x32_bf16 v[16:19], a[72:75], v[120:123], v[16:19]
    v_exp_f32 v29, v29
    v_mfma_f32_16x16x32_bf16 v[16:19], a[76:79], v[124:127], v[16:19]
    ds_read_b128 a[68:71], v1 offset:36928
    v_mfma_f32_16x16x32_bf16 v[20:23], a[80:83], v[112:115], v[60:63]
    v_exp_f32 v30, v30
    v_mfma_f32_16x16x32_bf16 v[20:23], a[84:87], v[116:119], v[20:23]
    ds_read_b128 a[72:75], v1 offset:36992
    v_perm_b32 v38, v29, v28, s100
    v_mfma_f32_16x16x32_bf16 v[20:23], a[88:91], v[120:123], v[20:23]
    v_exp_f32 v31, v31
    v_mfma_f32_16x16x32_bf16 v[20:23], a[92:95], v[124:127], v[20:23]
    ds_read_b128 a[76:79], v1 offset:37056
    v_mfma_f32_16x16x32_bf16 v[24:27], a[96:99], v[112:115], v[60:63]
    v_exp_f32 v16, v16
    v_mfma_f32_16x16x32_bf16 v[24:27], a[100:103], v[116:119], v[24:27]
    ds_read_b128 a[80:83], v1 offset:37120
    v_perm_b32 v39, v31, v30, s100
    v_mfma_f32_16x16x32_bf16 v[24:27], a[104:107], v[120:123], v[24:27]
    v_exp_f32 v17, v17
    v_mfma_f32_16x16x32_bf16 v[24:27], a[108:111], v[124:127], v[24:27]
    ds_read_b128 a[84:87], v1 offset:37184
    v_mfma_f32_16x16x32_bf16 v[28:31], a[112:115], v[112:115], v[60:63]
    v_exp_f32 v18, v18
    v_mfma_f32_16x16x32_bf16 v[28:31], a[116:119], v[116:119], v[28:31]
    ds_read_b128 a[88:91], v1 offset:37248
    v_perm_b32 v40, v17, v16, s100
    v_mfma_f32_16x16x32_bf16 v[28:31], a[120:123], v[120:123], v[28:31]
L2_pad7:
    s_cbranch_execz L2_pad11
    v_exp_f32 v19, v19
    v_mfma_f32_16x16x32_bf16 v[28:31], a[124:127], v[124:127], v[28:31]
    ds_read_b128 a[92:95], v1 offset:37312
    v_mfma_f32_16x16x32_bf16 v[192:195], a[128:131], v[32:35], v[192:195]
    v_exp_f32 v20, v20
    v_mfma_f32_16x16x32_bf16 v[192:195], a[132:135], v[36:39], v[192:195]
    ds_read_b128 a[96:99], v1 offset:37376
    v_perm_b32 v41, v19, v18, s100
    v_mfma_f32_16x16x32_bf16 v[196:199], a[136:139], v[32:35], v[196:199]
    v_exp_f32 v21, v21
    v_mfma_f32_16x16x32_bf16 v[196:199], a[140:143], v[36:39], v[196:199]
    ds_read_b128 a[100:103], v1 offset:37440
    v_mfma_f32_16x16x32_bf16 v[200:203], a[144:147], v[32:35], v[200:203]
    v_exp_f32 v22, v22
    v_mfma_f32_16x16x32_bf16 v[200:203], a[148:151], v[36:39], v[200:203]
    ds_read_b128 a[104:107], v1 offset:37504
    v_perm_b32 v42, v21, v20, s100
    v_mfma_f32_16x16x32_bf16 v[204:207], a[152:155], v[32:35], v[204:207]
    v_exp_f32 v23, v23
    v_mfma_f32_16x16x32_bf16 v[204:207], a[156:159], v[36:39], v[204:207]
    ds_read_b128 a[108:111], v1 offset:37568
    v_mfma_f32_16x16x32_bf16 v[208:211], a[160:163], v[32:35], v[208:211]
    v_exp_f32 v24, v24
    v_mfma_f32_16x16x32_bf16 v[208:211], a[164:167], v[36:39], v[208:211]
    ds_read_b128 a[112:115], v1 offset:37632
    v_perm_b32 v43, v23, v22, s100
    v_mfma_f32_16x16x32_bf16 v[212:215], a[168:171], v[32:35], v[212:215]
    v_exp_f32 v25, v25
    v_mfma_f32_16x16x32_bf16 v[212:215], a[172:175], v[36:39], v[212:215]
    ds_read_b128 a[116:119], v1 offset:37696
    v_mfma_f32_16x16x32_bf16 v[216:219], a[176:179], v[32:35], v[216:219]
    v_exp_f32 v26, v26
    v_mfma_f32_16x16x32_bf16 v[216:219], a[180:183], v[36:39], v[216:219]
    ds_read_b128 a[120:123], v1 offset:37760
    v_perm_b32 v44, v25, v24, s100
    v_mfma_f32_16x16x32_bf16 v[220:223], a[184:187], v[32:35], v[220:223]
    v_exp_f32 v27, v27
    v_mfma_f32_16x16x32_bf16 v[220:223], a[188:191], v[36:39], v[220:223]
    ds_read_b128 a[124:127], v1 offset:37824
    v_smfmac_f32_16x16x64_bf16 a[8:11], a[16:19], v[32:39], v11
    s_waitcnt lgkmcnt(12)
    v_mfma_f32_16x16x32_bf16 v[16:19], a[64:67], v[64:67], v[48:51]
    s_sub_u32 s47, s47, s48
    v_exp_f32 v28, v28
    v_mfma_f32_16x16x32_bf16 v[16:19], a[68:71], v[68:71], v[16:19]
    v_perm_b32 v45, v27, v26, s100
    v_add_u32 v1, s48, v1
    v_mfma_f32_16x16x32_bf16 v[16:19], a[72:75], v[72:75], v[16:19]
    v_exp_f32 v29, v29
    v_mfma_f32_16x16x32_bf16 v[16:19], a[76:79], v[76:79], v[16:19]
    s_waitcnt lgkmcnt(8)
    v_mfma_f32_16x16x32_bf16 v[20:23], a[80:83], v[64:67], v[48:51]
    v_exp_f32 v30, v30
    v_mfma_f32_16x16x32_bf16 v[20:23], a[84:87], v[68:71], v[20:23]
    v_perm_b32 v46, v29, v28, s100
    v_add_u32 v2, s48, v2
    v_mfma_f32_16x16x32_bf16 v[20:23], a[88:91], v[72:75], v[20:23]
    v_exp_f32 v31, v31
    v_mfma_f32_16x16x32_bf16 v[20:23], a[92:95], v[76:79], v[20:23]
    s_waitcnt lgkmcnt(4)
    v_mfma_f32_16x16x32_bf16 v[24:27], a[96:99], v[64:67], v[48:51]
    s_sub_u32 s48, 0, s48
    v_exp_f32 v16, v16
    v_mfma_f32_16x16x32_bf16 v[24:27], a[100:103], v[68:71], v[24:27]
    v_perm_b32 v47, v31, v30, s100
    v_mfma_f32_16x16x32_bf16 v[24:27], a[104:107], v[72:75], v[24:27]
    v_exp_f32 v17, v17
    v_mfma_f32_16x16x32_bf16 v[24:27], a[108:111], v[76:79], v[24:27]
    s_waitcnt lgkmcnt(0)
    v_mfma_f32_16x16x32_bf16 v[28:31], a[112:115], v[64:67], v[48:51]
    v_exp_f32 v18, v18
    v_mfma_f32_16x16x32_bf16 v[28:31], a[116:119], v[68:71], v[28:31]
    v_perm_b32 v32, v17, v16, s100
    v_mfma_f32_16x16x32_bf16 v[28:31], a[120:123], v[72:75], v[28:31]
    v_exp_f32 v19, v19
    v_mfma_f32_16x16x32_bf16 v[28:31], a[124:127], v[76:79], v[28:31]
    s_waitcnt vmcnt(2)
    s_barrier
    v_mfma_f32_16x16x32_bf16 v[224:227], a[128:131], v[40:43], v[224:227]
    v_exp_f32 v20, v20
    v_mfma_f32_16x16x32_bf16 v[224:227], a[132:135], v[44:47], v[224:227]
    ds_read_b64_tr_b16 a[128:129], v2 offset:0
    v_perm_b32 v33, v19, v18, s100
    v_mfma_f32_16x16x32_bf16 v[228:231], a[136:139], v[40:43], v[228:231]
    s_add_u32 m0, s47, 0
    v_exp_f32 v21, v21
    v_mfma_f32_16x16x32_bf16 v[228:231], a[140:143], v[44:47], v[228:231]
    s_add_u32 s46, s46, 16384
    buffer_load_dwordx4 off, s[16:19], s46 offset:0 lds
    v_mfma_f32_16x16x32_bf16 v[232:235], a[144:147], v[40:43], v[232:235]
    v_exp_f32 v22, v22
    v_mfma_f32_16x16x32_bf16 v[232:235], a[148:151], v[44:47], v[232:235]
    ds_read_b64_tr_b16 a[130:131], v2 offset:256
    v_perm_b32 v34, v21, v20, s100
    v_mfma_f32_16x16x32_bf16 v[236:239], a[152:155], v[40:43], v[236:239]
    s_add_u32 m0, s47, 32
    v_exp_f32 v23, v23
    v_mfma_f32_16x16x32_bf16 v[236:239], a[156:159], v[44:47], v[236:239]
    buffer_load_dwordx4 off, s[16:19], s46 offset:1024 lds
    v_mfma_f32_16x16x32_bf16 v[240:243], a[160:163], v[40:43], v[240:243]
    v_exp_f32 v24, v24
    v_mfma_f32_16x16x32_bf16 v[240:243], a[164:167], v[44:47], v[240:243]
    ds_read_b64_tr_b16 a[132:133], v2 offset:512
    v_perm_b32 v35, v23, v22, s100
    v_mfma_f32_16x16x32_bf16 v[244:247], a[168:171], v[40:43], v[244:247]
    s_add_u32 m0, s47, 64
    v_exp_f32 v25, v25
    v_mfma_f32_16x16x32_bf16 v[244:247], a[172:175], v[44:47], v[244:247]
    buffer_load_dwordx4 off, s[16:19], s46 offset:2048 lds
    v_mfma_f32_16x16x32_bf16 v[248:251], a[176:179], v[40:43], v[248:251]
    v_exp_f32 v26, v26
    v_mfma_f32_16x16x32_bf16 v[248:251], a[180:183], v[44:47], v[248:251]
    ds_read_b64_tr_b16 a[134:135], v2 offset:768
    v_perm_b32 v36, v25, v24, s100
    v_mfma_f32_16x16x32_bf16 v[252:255], a[184:187], v[40:43], v[252:255]
    s_add_u32 m0, s47, 96
    v_exp_f32 v27, v27
    v_mfma_f32_16x16x32_bf16 v[252:255], a[188:191], v[44:47], v[252:255]
    buffer_load_dwordx4 off, s[16:19], s46 offset:3072 lds
    v_smfmac_f32_16x16x64_bf16 a[12:15], a[16:19], v[40:47], v11
    ds_read_b64_tr_b16 a[136:137], v2 offset:32
    v_mfma_f32_16x16x32_bf16 v[16:19], a[64:67], v[80:83], v[52:55]
    v_exp_f32 v28, v28
    v_mfma_f32_16x16x32_bf16 v[16:19], a[68:71], v[84:87], v[16:19]
    ds_read_b64_tr_b16 a[138:139], v2 offset:288
    v_perm_b32 v37, v27, v26, s100
    v_mfma_f32_16x16x32_bf16 v[16:19], a[72:75], v[88:91], v[16:19]
    s_add_u32 m0, s47, 16896
    v_exp_f32 v29, v29
    v_mfma_f32_16x16x32_bf16 v[16:19], a[76:79], v[92:95], v[16:19]
    buffer_load_dwordx4 off, s[20:23], s46 offset:0 lds
    v_mfma_f32_16x16x32_bf16 v[20:23], a[80:83], v[80:83], v[52:55]
    v_exp_f32 v30, v30
    v_mfma_f32_16x16x32_bf16 v[20:23], a[84:87], v[84:87], v[20:23]
    ds_read_b64_tr_b16 a[140:141], v2 offset:544
    v_perm_b32 v38, v29, v28, s100
    v_mfma_f32_16x16x32_bf16 v[20:23], a[88:91], v[88:91], v[20:23]
    s_add_u32 m0, s47, 16928
    v_exp_f32 v31, v31
    v_mfma_f32_16x16x32_bf16 v[20:23], a[92:95], v[92:95], v[20:23]
    buffer_load_dwordx4 off, s[20:23], s46 offset:1024 lds
    v_mfma_f32_16x16x32_bf16 v[24:27], a[96:99], v[80:83], v[52:55]
    v_exp_f32 v16, v16
    v_mfma_f32_16x16x32_bf16 v[24:27], a[100:103], v[84:87], v[24:27]
    ds_read_b64_tr_b16 a[142:143], v2 offset:800
    v_perm_b32 v39, v31, v30, s100
    v_mfma_f32_16x16x32_bf16 v[24:27], a[104:107], v[88:91], v[24:27]
    s_add_u32 m0, s47, 16960
    v_exp_f32 v17, v17
    v_mfma_f32_16x16x32_bf16 v[24:27], a[108:111], v[92:95], v[24:27]
    buffer_load_dwordx4 off, s[20:23], s46 offset:2048 lds
    v_mfma_f32_16x16x32_bf16 v[28:31], a[112:115], v[80:83], v[52:55]
    v_exp_f32 v18, v18
    v_mfma_f32_16x16x32_bf16 v[28:31], a[116:119], v[84:87], v[28:31]
    ds_read_b64_tr_b16 a[144:145], v2 offset:64
    v_perm_b32 v40, v17, v16, s100
    v_mfma_f32_16x16x32_bf16 v[28:31], a[120:123], v[88:91], v[28:31]
    s_add_u32 m0, s47, 16992
    v_exp_f32 v19, v19
    v_mfma_f32_16x16x32_bf16 v[28:31], a[124:127], v[92:95], v[28:31]
    buffer_load_dwordx4 off, s[20:23], s46 offset:3072 lds
    v_mfma_f32_16x16x32_bf16 v[128:131], a[192:195], v[32:35], v[128:131]
    v_exp_f32 v20, v20
    v_mfma_f32_16x16x32_bf16 v[128:131], a[196:199], v[36:39], v[128:131]
    ds_read_b64_tr_b16 a[146:147], v2 offset:320
    v_perm_b32 v41, v19, v18, s100
    v_mfma_f32_16x16x32_bf16 v[132:135], a[200:203], v[32:35], v[132:135]
    v_exp_f32 v21, v21
    v_mfma_f32_16x16x32_bf16 v[132:135], a[204:207], v[36:39], v[132:135]
    ds_read_b64_tr_b16 a[148:149], v2 offset:576
    v_mfma_f32_16x16x32_bf16 v[136:139], a[208:211], v[32:35], v[136:139]
    v_exp_f32 v22, v22
    v_mfma_f32_16x16x32_bf16 v[136:139], a[212:215], v[36:39], v[136:139]
    ds_read_b64_tr_b16 a[150:151], v2 offset:832
    v_perm_b32 v42, v21, v20, s100
    v_mfma_f32_16x16x32_bf16 v[140:143], a[216:219], v[32:35], v[140:143]
    v_exp_f32 v23, v23
    v_mfma_f32_16x16x32_bf16 v[140:143], a[220:223], v[36:39], v[140:143]
    ds_read_b64_tr_b16 a[152:153], v2 offset:96
    ds_read_b64_tr_b16 a[154:155], v2 offset:352
    v_mfma_f32_16x16x32_bf16 v[144:147], a[224:227], v[32:35], v[144:147]
    v_exp_f32 v24, v24
    v_mfma_f32_16x16x32_bf16 v[144:147], a[228:231], v[36:39], v[144:147]
    ds_read_b64_tr_b16 a[156:157], v2 offset:608
    v_perm_b32 v43, v23, v22, s100
    v_mfma_f32_16x16x32_bf16 v[148:151], a[232:235], v[32:35], v[148:151]
    v_exp_f32 v25, v25
    v_mfma_f32_16x16x32_bf16 v[148:151], a[236:239], v[36:39], v[148:151]
    ds_read_b64_tr_b16 a[158:159], v2 offset:864
    ds_read_b64_tr_b16 a[160:161], v2 offset:128
    v_mfma_f32_16x16x32_bf16 v[152:155], a[240:243], v[32:35], v[152:155]
    v_exp_f32 v26, v26
    v_mfma_f32_16x16x32_bf16 v[152:155], a[244:247], v[36:39], v[152:155]
    ds_read_b64_tr_b16 a[162:163], v2 offset:384
    v_perm_b32 v44, v25, v24, s100
    v_mfma_f32_16x16x32_bf16 v[156:159], a[248:251], v[32:35], v[156:159]
    v_exp_f32 v27, v27
    v_mfma_f32_16x16x32_bf16 v[156:159], a[252:255], v[36:39], v[156:159]
    ds_read_b64_tr_b16 a[164:165], v2 offset:640
    ds_read_b64_tr_b16 a[166:167], v2 offset:896
    v_smfmac_f32_16x16x64_bf16 a[0:3], a[16:19], v[32:39], v11
    ds_read_b64_tr_b16 a[168:169], v2 offset:160
    ds_read_b64_tr_b16 a[170:171], v2 offset:416
    v_mfma_f32_16x16x32_bf16 v[16:19], a[64:67], v[96:99], v[56:59]
    v_exp_f32 v28, v28
    v_mfma_f32_16x16x32_bf16 v[16:19], a[68:71], v[100:103], v[16:19]
    ds_read_b64_tr_b16 a[172:173], v2 offset:672
    v_perm_b32 v45, v27, v26, s100
    v_mfma_f32_16x16x32_bf16 v[16:19], a[72:75], v[104:107], v[16:19]
    s_add_u32 m0, s47, 36864
    v_exp_f32 v29, v29
    v_mfma_f32_16x16x32_bf16 v[16:19], a[76:79], v[108:111], v[16:19]
    s_add_u32 s46, s46, 16384
    buffer_load_dwordx4 off, s[16:19], s46 offset:0 lds
    v_mfma_f32_16x16x32_bf16 v[20:23], a[80:83], v[96:99], v[56:59]
    v_exp_f32 v30, v30
    v_mfma_f32_16x16x32_bf16 v[20:23], a[84:87], v[100:103], v[20:23]
    ds_read_b64_tr_b16 a[174:175], v2 offset:928
    v_perm_b32 v46, v29, v28, s100
    v_mfma_f32_16x16x32_bf16 v[20:23], a[88:91], v[104:107], v[20:23]
    s_add_u32 m0, s47, 36896
    v_exp_f32 v31, v31
    v_mfma_f32_16x16x32_bf16 v[20:23], a[92:95], v[108:111], v[20:23]
    buffer_load_dwordx4 off, s[16:19], s46 offset:1024 lds
    v_mfma_f32_16x16x32_bf16 v[24:27], a[96:99], v[96:99], v[56:59]
    v_exp_f32 v16, v16
    v_mfma_f32_16x16x32_bf16 v[24:27], a[100:103], v[100:103], v[24:27]
    ds_read_b64_tr_b16 a[176:177], v2 offset:192
    v_perm_b32 v47, v31, v30, s100
    v_mfma_f32_16x16x32_bf16 v[24:27], a[104:107], v[104:107], v[24:27]
    s_add_u32 m0, s47, 36928
    v_exp_f32 v17, v17
    v_mfma_f32_16x16x32_bf16 v[24:27], a[108:111], v[108:111], v[24:27]
    buffer_load_dwordx4 off, s[16:19], s46 offset:2048 lds
    v_mfma_f32_16x16x32_bf16 v[28:31], a[112:115], v[96:99], v[56:59]
    v_exp_f32 v18, v18
    v_mfma_f32_16x16x32_bf16 v[28:31], a[116:119], v[100:103], v[28:31]
    ds_read_b64_tr_b16 a[178:179], v2 offset:448
    v_perm_b32 v32, v17, v16, s100
    v_mfma_f32_16x16x32_bf16 v[28:31], a[120:123], v[104:107], v[28:31]
    s_add_u32 m0, s47, 36960
    v_exp_f32 v19, v19
    v_mfma_f32_16x16x32_bf16 v[28:31], a[124:127], v[108:111], v[28:31]
    buffer_load_dwordx4 off, s[16:19], s46 offset:3072 lds
    v_mfma_f32_16x16x32_bf16 v[160:163], a[192:195], v[40:43], v[160:163]
    v_exp_f32 v20, v20
    v_mfma_f32_16x16x32_bf16 v[160:163], a[196:199], v[44:47], v[160:163]
    ds_read_b64_tr_b16 a[180:181], v2 offset:704
    v_perm_b32 v33, v19, v18, s100
    v_mfma_f32_16x16x32_bf16 v[164:167], a[200:203], v[40:43], v[164:167]
    s_add_u32 m0, s47, 53760
    v_exp_f32 v21, v21
    v_mfma_f32_16x16x32_bf16 v[164:167], a[204:207], v[44:47], v[164:167]
    buffer_load_dwordx4 off, s[20:23], s46 offset:0 lds
    v_mfma_f32_16x16x32_bf16 v[168:171], a[208:211], v[40:43], v[168:171]
    v_exp_f32 v22, v22
    v_mfma_f32_16x16x32_bf16 v[168:171], a[212:215], v[44:47], v[168:171]
    ds_read_b64_tr_b16 a[182:183], v2 offset:960
    v_perm_b32 v34, v21, v20, s100
    v_mfma_f32_16x16x32_bf16 v[172:175], a[216:219], v[40:43], v[172:175]
    s_add_u32 m0, s47, 53792
    v_exp_f32 v23, v23
    v_mfma_f32_16x16x32_bf16 v[172:175], a[220:223], v[44:47], v[172:175]
    buffer_load_dwordx4 off, s[20:23], s46 offset:1024 lds
    v_mfma_f32_16x16x32_bf16 v[176:179], a[224:227], v[40:43], v[176:179]
    v_exp_f32 v24, v24
    v_mfma_f32_16x16x32_bf16 v[176:179], a[228:231], v[44:47], v[176:179]
    ds_read_b64_tr_b16 a[184:185], v2 offset:224
    v_perm_b32 v35, v23, v22, s100
    v_mfma_f32_16x16x32_bf16 v[180:183], a[232:235], v[40:43], v[180:183]
    s_add_u32 m0, s47, 53824
    v_exp_f32 v25, v25
    v_mfma_f32_16x16x32_bf16 v[180:183], a[236:239], v[44:47], v[180:183]
    buffer_load_dwordx4 off, s[20:23], s46 offset:2048 lds
    v_mfma_f32_16x16x32_bf16 v[184:187], a[240:243], v[40:43], v[184:187]
    v_exp_f32 v26, v26
    v_mfma_f32_16x16x32_bf16 v[184:187], a[244:247], v[44:47], v[184:187]
    ds_read_b64_tr_b16 a[186:187], v2 offset:480
    v_perm_b32 v36, v25, v24, s100
    v_mfma_f32_16x16x32_bf16 v[188:191], a[248:251], v[40:43], v[188:191]
    s_add_u32 m0, s47, 53856
    v_exp_f32 v27, v27
    v_mfma_f32_16x16x32_bf16 v[188:191], a[252:255], v[44:47], v[188:191]
    buffer_load_dwordx4 off, s[20:23], s46 offset:3072 lds
    v_smfmac_f32_16x16x64_bf16 a[4:7], a[16:19], v[40:47], v11
    ds_read_b64_tr_b16 a[188:189], v2 offset:736
    ds_read_b64_tr_b16 a[190:191], v2 offset:992
    v_mfma_f32_16x16x32_bf16 v[16:19], a[64:67], v[112:115], v[60:63]
    v_exp_f32 v28, v28
    v_mfma_f32_16x16x32_bf16 v[16:19], a[68:71], v[116:119], v[16:19]
    ds_read_b128 a[64:67], v1 offset:0
    v_perm_b32 v37, v27, v26, s100
    v_mfma_f32_16x16x32_bf16 v[16:19], a[72:75], v[120:123], v[16:19]
    v_exp_f32 v29, v29
    v_mfma_f32_16x16x32_bf16 v[16:19], a[76:79], v[124:127], v[16:19]
    ds_read_b128 a[68:71], v1 offset:64
    v_mfma_f32_16x16x32_bf16 v[20:23], a[80:83], v[112:115], v[60:63]
    v_exp_f32 v30, v30
    v_mfma_f32_16x16x32_bf16 v[20:23], a[84:87], v[116:119], v[20:23]
    ds_read_b128 a[72:75], v1 offset:128
    v_perm_b32 v38, v29, v28, s100
    v_mfma_f32_16x16x32_bf16 v[20:23], a[88:91], v[120:123], v[20:23]
    v_exp_f32 v31, v31
    v_mfma_f32_16x16x32_bf16 v[20:23], a[92:95], v[124:127], v[20:23]
    ds_read_b128 a[76:79], v1 offset:192
    v_mfma_f32_16x16x32_bf16 v[24:27], a[96:99], v[112:115], v[60:63]
    v_exp_f32 v16, v16
    v_mfma_f32_16x16x32_bf16 v[24:27], a[100:103], v[116:119], v[24:27]
    ds_read_b128 a[80:83], v1 offset:256
    v_perm_b32 v39, v31, v30, s100
    v_mfma_f32_16x16x32_bf16 v[24:27], a[104:107], v[120:123], v[24:27]
    v_exp_f32 v17, v17
    v_mfma_f32_16x16x32_bf16 v[24:27], a[108:111], v[124:127], v[24:27]
    ds_read_b128 a[84:87], v1 offset:320
    v_mfma_f32_16x16x32_bf16 v[28:31], a[112:115], v[112:115], v[60:63]
    v_exp_f32 v18, v18
    v_mfma_f32_16x16x32_bf16 v[28:31], a[116:119], v[116:119], v[28:31]
    ds_read_b128 a[88:91], v1 offset:384
    v_perm_b32 v40, v17, v16, s100
    v_mfma_f32_16x16x32_bf16 v[28:31], a[120:123], v[120:123], v[28:31]
    v_exp_f32 v19, v19
    v_mfma_f32_16x16x32_bf16 v[28:31], a[124:127], v[124:127], v[28:31]
    ds_read_b128 a[92:95], v1 offset:448
    v_mfma_f32_16x16x32_bf16 v[192:195], a[192:195], v[32:35], v[192:195]
    v_exp_f32 v20, v20
    v_mfma_f32_16x16x32_bf16 v[192:195], a[196:199], v[36:39], v[192:195]
    ds_read_b128 a[96:99], v1 offset:512
    v_perm_b32 v41, v19, v18, s100
    v_mfma_f32_16x16x32_bf16 v[196:199], a[200:203], v[32:35], v[196:199]
    v_exp_f32 v21, v21
    v_mfma_f32_16x16x32_bf16 v[196:199], a[204:207], v[36:39], v[196:199]
    ds_read_b128 a[100:103], v1 offset:576
    v_mfma_f32_16x16x32_bf16 v[200:203], a[208:211], v[32:35], v[200:203]
    v_exp_f32 v22, v22
    v_mfma_f32_16x16x32_bf16 v[200:203], a[212:215], v[36:39], v[200:203]
    ds_read_b128 a[104:107], v1 offset:640
    v_perm_b32 v42, v21, v20, s100
    v_mfma_f32_16x16x32_bf16 v[204:207], a[216:219], v[32:35], v[204:207]
    v_exp_f32 v23, v23
    v_mfma_f32_16x16x32_bf16 v[204:207], a[220:223], v[36:39], v[204:207]
    ds_read_b128 a[108:111], v1 offset:704
    v_mfma_f32_16x16x32_bf16 v[208:211], a[224:227], v[32:35], v[208:211]
    v_exp_f32 v24, v24
    v_mfma_f32_16x16x32_bf16 v[208:211], a[228:231], v[36:39], v[208:211]
    ds_read_b128 a[112:115], v1 offset:768
    v_perm_b32 v43, v23, v22, s100
    v_mfma_f32_16x16x32_bf16 v[212:215], a[232:235], v[32:35], v[212:215]
    v_exp_f32 v25, v25
    v_mfma_f32_16x16x32_bf16 v[212:215], a[236:239], v[36:39], v[212:215]
    ds_read_b128 a[116:119], v1 offset:832
    v_mfma_f32_16x16x32_bf16 v[216:219], a[240:243], v[32:35], v[216:219]
    v_exp_f32 v26, v26
    v_mfma_f32_16x16x32_bf16 v[216:219], a[244:247], v[36:39], v[216:219]
    ds_read_b128 a[120:123], v1 offset:896
    v_perm_b32 v44, v25, v24, s100
    v_mfma_f32_16x16x32_bf16 v[220:223], a[248:251], v[32:35], v[220:223]
    v_exp_f32 v27, v27
    v_mfma_f32_16x16x32_bf16 v[220:223], a[252:255], v[36:39], v[220:223]
    ds_read_b128 a[124:127], v1 offset:960
    v_smfmac_f32_16x16x64_bf16 a[8:11], a[16:19], v[32:39], v11
    s_waitcnt lgkmcnt(12)
    v_mfma_f32_16x16x32_bf16 v[16:19], a[64:67], v[64:67], v[48:51]
    v_exp_f32 v28, v28
    v_mfma_f32_16x16x32_bf16 v[16:19], a[68:71], v[68:71], v[16:19]
    v_perm_b32 v45, v27, v26, s100
    v_mfma_f32_16x16x32_bf16 v[16:19], a[72:75], v[72:75], v[16:19]
    v_exp_f32 v29, v29
    v_mfma_f32_16x16x32_bf16 v[16:19], a[76:79], v[76:79], v[16:19]
    s_waitcnt lgkmcnt(8)
    global_load_dword a63, v13, s[8:9]
    v_mfma_f32_16x16x32_bf16 v[20:23], a[80:83], v[64:67], v[48:51]
    v_exp_f32 v30, v30
    v_mfma_f32_16x16x32_bf16 v[20:23], a[84:87], v[68:71], v[20:23]
    v_perm_b32 v46, v29, v28, s100
    v_mfma_f32_16x16x32_bf16 v[20:23], a[88:91], v[72:75], v[20:23]
    v_exp_f32 v31, v31
    v_mfma_f32_16x16x32_bf16 v[20:23], a[92:95], v[76:79], v[20:23]
    s_waitcnt lgkmcnt(4)
    v_mfma_f32_16x16x32_bf16 v[24:27], a[96:99], v[64:67], v[48:51]
    v_exp_f32 v16, v16
    v_mfma_f32_16x16x32_bf16 v[24:27], a[100:103], v[68:71], v[24:27]
    v_perm_b32 v47, v31, v30, s100
    v_mfma_f32_16x16x32_bf16 v[24:27], a[104:107], v[72:75], v[24:27]
    v_exp_f32 v17, v17
    v_mfma_f32_16x16x32_bf16 v[24:27], a[108:111], v[76:79], v[24:27]
    s_waitcnt lgkmcnt(0)
    buffer_load_dword a63, v9, s[36:39], 0 offen
    v_mfma_f32_16x16x32_bf16 v[28:31], a[112:115], v[64:67], v[48:51]
    v_exp_f32 v18, v18
    v_mfma_f32_16x16x32_bf16 v[28:31], a[116:119], v[68:71], v[28:31]
    v_perm_b32 v32, v17, v16, s100
    v_mfma_f32_16x16x32_bf16 v[28:31], a[120:123], v[72:75], v[28:31]
    v_exp_f32 v19, v19
    v_mfma_f32_16x16x32_bf16 v[28:31], a[124:127], v[76:79], v[28:31]
    v_mfma_f32_16x16x32_bf16 v[224:227], a[192:195], v[40:43], v[224:227]
    v_exp_f32 v20, v20
    v_mfma_f32_16x16x32_bf16 v[224:227], a[196:199], v[44:47], v[224:227]
    ds_read_b64_tr_b16 a[192:193], v2 offset:36864
    v_perm_b32 v33, v19, v18, s100
    v_mfma_f32_16x16x32_bf16 v[228:231], a[200:203], v[40:43], v[228:231]
    s_mov_b32 s54, 0
    v_exp_f32 v21, v21
    v_mfma_f32_16x16x32_bf16 v[228:231], a[204:207], v[44:47], v[228:231]
    buffer_load_dwordx4 a[20:23], v6, s[64:67], s54 offen
    v_mfma_f32_16x16x32_bf16 v[232:235], a[208:211], v[40:43], v[232:235]
    v_exp_f32 v22, v22
    v_mfma_f32_16x16x32_bf16 v[232:235], a[212:215], v[44:47], v[232:235]
    ds_read_b64_tr_b16 a[194:195], v2 offset:37120
    v_perm_b32 v34, v21, v20, s100
    v_mfma_f32_16x16x32_bf16 v[236:239], a[216:219], v[40:43], v[236:239]
    v_exp_f32 v23, v23
    v_mfma_f32_16x16x32_bf16 v[236:239], a[220:223], v[44:47], v[236:239]
    ds_read_b64_tr_b16 a[196:197], v2 offset:37376
    v_mfma_f32_16x16x32_bf16 v[240:243], a[224:227], v[40:43], v[240:243]
    v_exp_f32 v24, v24
    v_mfma_f32_16x16x32_bf16 v[240:243], a[228:231], v[44:47], v[240:243]
    ds_read_b64_tr_b16 a[198:199], v2 offset:37632
    v_perm_b32 v35, v23, v22, s100
    v_mfma_f32_16x16x32_bf16 v[244:247], a[232:235], v[40:43], v[244:247]
    s_mov_b32 s54, 147456
    v_exp_f32 v25, v25
    v_mfma_f32_16x16x32_bf16 v[244:247], a[236:239], v[44:47], v[244:247]
    buffer_load_dwordx4 a[24:27], v6, s[64:67], s54 offen
    v_mfma_f32_16x16x32_bf16 v[248:251], a[240:243], v[40:43], v[248:251]
    v_exp_f32 v26, v26
    v_mfma_f32_16x16x32_bf16 v[248:251], a[244:247], v[44:47], v[248:251]
    ds_read_b64_tr_b16 a[200:201], v2 offset:36896
    v_perm_b32 v36, v25, v24, s100
    v_mfma_f32_16x16x32_bf16 v[252:255], a[248:251], v[40:43], v[252:255]
    v_exp_f32 v27, v27
    v_mfma_f32_16x16x32_bf16 v[252:255], a[252:255], v[44:47], v[252:255]
    ds_read_b64_tr_b16 a[202:203], v2 offset:37152
    v_smfmac_f32_16x16x64_bf16 a[12:15], a[16:19], v[40:47], v11
    ds_read_b64_tr_b16 a[204:205], v2 offset:37408
    v_mfma_f32_16x16x32_bf16 v[16:19], a[64:67], v[80:83], v[52:55]
    v_exp_f32 v28, v28
    v_mfma_f32_16x16x32_bf16 v[16:19], a[68:71], v[84:87], v[16:19]
    ds_read_b64_tr_b16 a[206:207], v2 offset:37664
    v_perm_b32 v37, v27, v26, s100
    v_mfma_f32_16x16x32_bf16 v[16:19], a[72:75], v[88:91], v[16:19]
    s_mov_b32 s54, 294912
    v_exp_f32 v29, v29
    v_mfma_f32_16x16x32_bf16 v[16:19], a[76:79], v[92:95], v[16:19]
    buffer_load_dwordx4 a[28:31], v6, s[64:67], s54 offen
    v_mfma_f32_16x16x32_bf16 v[20:23], a[80:83], v[80:83], v[52:55]
    v_exp_f32 v30, v30
    v_mfma_f32_16x16x32_bf16 v[20:23], a[84:87], v[84:87], v[20:23]
    ds_read_b64_tr_b16 a[208:209], v2 offset:36928
    v_perm_b32 v38, v29, v28, s100
    v_mfma_f32_16x16x32_bf16 v[20:23], a[88:91], v[88:91], v[20:23]
    v_exp_f32 v31, v31
    v_mfma_f32_16x16x32_bf16 v[20:23], a[92:95], v[92:95], v[20:23]
    ds_read_b64_tr_b16 a[210:211], v2 offset:37184
    v_mfma_f32_16x16x32_bf16 v[24:27], a[96:99], v[80:83], v[52:55]
    v_exp_f32 v16, v16
    v_mfma_f32_16x16x32_bf16 v[24:27], a[100:103], v[84:87], v[24:27]
    ds_read_b64_tr_b16 a[212:213], v2 offset:37440
    v_perm_b32 v39, v31, v30, s100
    v_mfma_f32_16x16x32_bf16 v[24:27], a[104:107], v[88:91], v[24:27]
    s_mov_b32 s54, 442368
    v_exp_f32 v17, v17
    v_mfma_f32_16x16x32_bf16 v[24:27], a[108:111], v[92:95], v[24:27]
    buffer_load_dwordx4 a[32:35], v6, s[64:67], s54 offen
    v_mfma_f32_16x16x32_bf16 v[28:31], a[112:115], v[80:83], v[52:55]
    v_exp_f32 v18, v18
    v_mfma_f32_16x16x32_bf16 v[28:31], a[116:119], v[84:87], v[28:31]
    ds_read_b64_tr_b16 a[214:215], v2 offset:37696
    v_perm_b32 v40, v17, v16, s100
    v_mfma_f32_16x16x32_bf16 v[28:31], a[120:123], v[88:91], v[28:31]
    v_exp_f32 v19, v19
    v_mfma_f32_16x16x32_bf16 v[28:31], a[124:127], v[92:95], v[28:31]
    ds_read_b64_tr_b16 a[216:217], v2 offset:36960
    v_mfma_f32_16x16x32_bf16 v[128:131], a[128:131], v[32:35], v[128:131]
    v_exp_f32 v20, v20
    v_mfma_f32_16x16x32_bf16 v[128:131], a[132:135], v[36:39], v[128:131]
    ds_read_b64_tr_b16 a[218:219], v2 offset:37216
    v_perm_b32 v41, v19, v18, s100
    v_mfma_f32_16x16x32_bf16 v[132:135], a[136:139], v[32:35], v[132:135]
    s_mov_b32 s54, 589824
    v_exp_f32 v21, v21
    v_mfma_f32_16x16x32_bf16 v[132:135], a[140:143], v[36:39], v[132:135]
    buffer_load_dwordx4 a[36:39], v6, s[64:67], s54 offen
    v_mfma_f32_16x16x32_bf16 v[136:139], a[144:147], v[32:35], v[136:139]
    v_exp_f32 v22, v22
    v_mfma_f32_16x16x32_bf16 v[136:139], a[148:151], v[36:39], v[136:139]
    ds_read_b64_tr_b16 a[220:221], v2 offset:37472
    v_perm_b32 v42, v21, v20, s100
    v_mfma_f32_16x16x32_bf16 v[140:143], a[152:155], v[32:35], v[140:143]
    v_exp_f32 v23, v23
    v_mfma_f32_16x16x32_bf16 v[140:143], a[156:159], v[36:39], v[140:143]
    ds_read_b64_tr_b16 a[222:223], v2 offset:37728
    v_mfma_f32_16x16x32_bf16 v[144:147], a[160:163], v[32:35], v[144:147]
    v_exp_f32 v24, v24
    v_mfma_f32_16x16x32_bf16 v[144:147], a[164:167], v[36:39], v[144:147]
    ds_read_b64_tr_b16 a[224:225], v2 offset:36992
    v_perm_b32 v43, v23, v22, s100
    v_mfma_f32_16x16x32_bf16 v[148:151], a[168:171], v[32:35], v[148:151]
    v_exp_f32 v25, v25
    v_mfma_f32_16x16x32_bf16 v[148:151], a[172:175], v[36:39], v[148:151]
    ds_read_b64_tr_b16 a[226:227], v2 offset:37248
    v_mfma_f32_16x16x32_bf16 v[152:155], a[176:179], v[32:35], v[152:155]
    v_exp_f32 v26, v26
    v_mfma_f32_16x16x32_bf16 v[152:155], a[180:183], v[36:39], v[152:155]
    ds_read_b64_tr_b16 a[228:229], v2 offset:37504
    v_perm_b32 v44, v25, v24, s100
    v_mfma_f32_16x16x32_bf16 v[156:159], a[184:187], v[32:35], v[156:159]
    v_exp_f32 v27, v27
    v_mfma_f32_16x16x32_bf16 v[156:159], a[188:191], v[36:39], v[156:159]
    ds_read_b64_tr_b16 a[230:231], v2 offset:37760
    v_smfmac_f32_16x16x64_bf16 a[0:3], a[16:19], v[32:39], v11
    ds_read_b64_tr_b16 a[232:233], v2 offset:37024
    v_mfma_f32_16x16x32_bf16 v[16:19], a[64:67], v[96:99], v[56:59]
    v_exp_f32 v28, v28
    v_mfma_f32_16x16x32_bf16 v[16:19], a[68:71], v[100:103], v[16:19]
    ds_read_b64_tr_b16 a[234:235], v2 offset:37280
    v_perm_b32 v45, v27, v26, s100
    v_mfma_f32_16x16x32_bf16 v[16:19], a[72:75], v[104:107], v[16:19]
    v_exp_f32 v29, v29
    v_mfma_f32_16x16x32_bf16 v[16:19], a[76:79], v[108:111], v[16:19]
    ds_read_b64_tr_b16 a[236:237], v2 offset:37536
    v_mfma_f32_16x16x32_bf16 v[20:23], a[80:83], v[96:99], v[56:59]
    v_exp_f32 v30, v30
    v_mfma_f32_16x16x32_bf16 v[20:23], a[84:87], v[100:103], v[20:23]
    ds_read_b64_tr_b16 a[238:239], v2 offset:37792
    v_perm_b32 v46, v29, v28, s100
    v_mfma_f32_16x16x32_bf16 v[20:23], a[88:91], v[104:107], v[20:23]
    v_exp_f32 v31, v31
    v_mfma_f32_16x16x32_bf16 v[20:23], a[92:95], v[108:111], v[20:23]
    ds_read_b64_tr_b16 a[240:241], v2 offset:37056
    v_mfma_f32_16x16x32_bf16 v[24:27], a[96:99], v[96:99], v[56:59]
    v_exp_f32 v16, v16
    v_mfma_f32_16x16x32_bf16 v[24:27], a[100:103], v[100:103], v[24:27]
    ds_read_b64_tr_b16 a[242:243], v2 offset:37312
    v_perm_b32 v47, v31, v30, s100
    v_mfma_f32_16x16x32_bf16 v[24:27], a[104:107], v[104:107], v[24:27]
    v_exp_f32 v17, v17
    v_mfma_f32_16x16x32_bf16 v[24:27], a[108:111], v[108:111], v[24:27]
    ds_read_b64_tr_b16 a[244:245], v2 offset:37568
    v_mfma_f32_16x16x32_bf16 v[28:31], a[112:115], v[96:99], v[56:59]
    v_exp_f32 v18, v18
    v_mfma_f32_16x16x32_bf16 v[28:31], a[116:119], v[100:103], v[28:31]
    ds_read_b64_tr_b16 a[246:247], v2 offset:37824
    v_perm_b32 v32, v17, v16, s100
    v_mfma_f32_16x16x32_bf16 v[28:31], a[120:123], v[104:107], v[28:31]
    v_exp_f32 v19, v19
    v_mfma_f32_16x16x32_bf16 v[28:31], a[124:127], v[108:111], v[28:31]
    ds_read_b64_tr_b16 a[248:249], v2 offset:37088
    v_mfma_f32_16x16x32_bf16 v[160:163], a[128:131], v[40:43], v[160:163]
    v_exp_f32 v20, v20
    v_mfma_f32_16x16x32_bf16 v[160:163], a[132:135], v[44:47], v[160:163]
    ds_read_b64_tr_b16 a[250:251], v2 offset:37344
    v_perm_b32 v33, v19, v18, s100
    v_mfma_f32_16x16x32_bf16 v[164:167], a[136:139], v[40:43], v[164:167]
    v_exp_f32 v21, v21
    v_mfma_f32_16x16x32_bf16 v[164:167], a[140:143], v[44:47], v[164:167]
    ds_read_b64_tr_b16 a[252:253], v2 offset:37600
    v_mfma_f32_16x16x32_bf16 v[168:171], a[144:147], v[40:43], v[168:171]
    v_exp_f32 v22, v22
    v_mfma_f32_16x16x32_bf16 v[168:171], a[148:151], v[44:47], v[168:171]
    ds_read_b64_tr_b16 a[254:255], v2 offset:37856
    v_perm_b32 v34, v21, v20, s100
    v_mfma_f32_16x16x32_bf16 v[172:175], a[152:155], v[40:43], v[172:175]
    v_exp_f32 v23, v23
    v_mfma_f32_16x16x32_bf16 v[172:175], a[156:159], v[44:47], v[172:175]
    v_mfma_f32_16x16x32_bf16 v[176:179], a[160:163], v[40:43], v[176:179]
    v_exp_f32 v24, v24
    v_mfma_f32_16x16x32_bf16 v[176:179], a[164:167], v[44:47], v[176:179]
    v_perm_b32 v35, v23, v22, s100
    v_mfma_f32_16x16x32_bf16 v[180:183], a[168:171], v[40:43], v[180:183]
    v_exp_f32 v25, v25
    v_mfma_f32_16x16x32_bf16 v[180:183], a[172:175], v[44:47], v[180:183]
    v_mfma_f32_16x16x32_bf16 v[184:187], a[176:179], v[40:43], v[184:187]
    v_exp_f32 v26, v26
    v_mfma_f32_16x16x32_bf16 v[184:187], a[180:183], v[44:47], v[184:187]
    v_perm_b32 v36, v25, v24, s100
    v_mfma_f32_16x16x32_bf16 v[188:191], a[184:187], v[40:43], v[188:191]
    v_exp_f32 v27, v27
    v_mfma_f32_16x16x32_bf16 v[188:191], a[188:191], v[44:47], v[188:191]
    v_smfmac_f32_16x16x64_bf16 a[4:7], a[16:19], v[40:47], v11
    v_mfma_f32_16x16x32_bf16 v[16:19], a[64:67], v[112:115], v[60:63]
L2_pad8:
    s_cbranch_execz L2_pad12
    v_exp_f32 v28, v28
    v_mfma_f32_16x16x32_bf16 v[16:19], a[68:71], v[116:119], v[16:19]
    ds_read_b128 a[64:67], v1 offset:36864
    v_perm_b32 v37, v27, v26, s100
    v_mfma_f32_16x16x32_bf16 v[16:19], a[72:75], v[120:123], v[16:19]
    v_exp_f32 v29, v29
    v_mfma_f32_16x16x32_bf16 v[16:19], a[76:79], v[124:127], v[16:19]
    ds_read_b128 a[68:71], v1 offset:36928
    v_mfma_f32_16x16x32_bf16 v[20:23], a[80:83], v[112:115], v[60:63]
    v_exp_f32 v30, v30
    v_mfma_f32_16x16x32_bf16 v[20:23], a[84:87], v[116:119], v[20:23]
    ds_read_b128 a[72:75], v1 offset:36992
    v_perm_b32 v38, v29, v28, s100
    v_mfma_f32_16x16x32_bf16 v[20:23], a[88:91], v[120:123], v[20:23]
    v_exp_f32 v31, v31
    v_mfma_f32_16x16x32_bf16 v[20:23], a[92:95], v[124:127], v[20:23]
    ds_read_b128 a[76:79], v1 offset:37056
    v_mfma_f32_16x16x32_bf16 v[24:27], a[96:99], v[112:115], v[60:63]
    v_exp_f32 v16, v16
    v_mfma_f32_16x16x32_bf16 v[24:27], a[100:103], v[116:119], v[24:27]
    ds_read_b128 a[80:83], v1 offset:37120
    v_perm_b32 v39, v31, v30, s100
    v_mfma_f32_16x16x32_bf16 v[24:27], a[104:107], v[120:123], v[24:27]
    v_exp_f32 v17, v17
    v_mfma_f32_16x16x32_bf16 v[24:27], a[108:111], v[124:127], v[24:27]
    ds_read_b128 a[84:87], v1 offset:37184
    v_mfma_f32_16x16x32_bf16 v[28:31], a[112:115], v[112:115], v[60:63]
    v_exp_f32 v18, v18
    v_mfma_f32_16x16x32_bf16 v[28:31], a[116:119], v[116:119], v[28:31]
    ds_read_b128 a[88:91], v1 offset:37248
    v_perm_b32 v40, v17, v16, s100
    v_mfma_f32_16x16x32_bf16 v[28:31], a[120:123], v[120:123], v[28:31]
    v_exp_f32 v19, v19
    v_mfma_f32_16x16x32_bf16 v[28:31], a[124:127], v[124:127], v[28:31]
    ds_read_b128 a[92:95], v1 offset:37312
    v_mfma_f32_16x16x32_bf16 v[192:195], a[128:131], v[32:35], v[192:195]
    v_exp_f32 v20, v20
    v_mfma_f32_16x16x32_bf16 v[192:195], a[132:135], v[36:39], v[192:195]
    ds_read_b128 a[96:99], v1 offset:37376
    v_perm_b32 v41, v19, v18, s100
    v_mfma_f32_16x16x32_bf16 v[196:199], a[136:139], v[32:35], v[196:199]
    v_exp_f32 v21, v21
    v_mfma_f32_16x16x32_bf16 v[196:199], a[140:143], v[36:39], v[196:199]
    ds_read_b128 a[100:103], v1 offset:37440
    v_mfma_f32_16x16x32_bf16 v[200:203], a[144:147], v[32:35], v[200:203]
    v_exp_f32 v22, v22
    v_mfma_f32_16x16x32_bf16 v[200:203], a[148:151], v[36:39], v[200:203]
    ds_read_b128 a[104:107], v1 offset:37504
    v_perm_b32 v42, v21, v20, s100
    v_mfma_f32_16x16x32_bf16 v[204:207], a[152:155], v[32:35], v[204:207]
    v_exp_f32 v23, v23
    v_mfma_f32_16x16x32_bf16 v[204:207], a[156:159], v[36:39], v[204:207]
    ds_read_b128 a[108:111], v1 offset:37568
    v_mfma_f32_16x16x32_bf16 v[208:211], a[160:163], v[32:35], v[208:211]
    v_exp_f32 v24, v24
    v_mfma_f32_16x16x32_bf16 v[208:211], a[164:167], v[36:39], v[208:211]
    ds_read_b128 a[112:115], v1 offset:37632
    v_perm_b32 v43, v23, v22, s100
    v_mfma_f32_16x16x32_bf16 v[212:215], a[168:171], v[32:35], v[212:215]
    v_exp_f32 v25, v25
    v_mfma_f32_16x16x32_bf16 v[212:215], a[172:175], v[36:39], v[212:215]
    ds_read_b128 a[116:119], v1 offset:37696
    v_mfma_f32_16x16x32_bf16 v[216:219], a[176:179], v[32:35], v[216:219]
    v_exp_f32 v26, v26
    v_mfma_f32_16x16x32_bf16 v[216:219], a[180:183], v[36:39], v[216:219]
    ds_read_b128 a[120:123], v1 offset:37760
    v_perm_b32 v44, v25, v24, s100
    v_mfma_f32_16x16x32_bf16 v[220:223], a[184:187], v[32:35], v[220:223]
    v_exp_f32 v27, v27
    v_mfma_f32_16x16x32_bf16 v[220:223], a[188:191], v[36:39], v[220:223]
    ds_read_b128 a[124:127], v1 offset:37824
    v_smfmac_f32_16x16x64_bf16 a[8:11], a[16:19], v[32:39], v11
    s_waitcnt lgkmcnt(12)
    v_mfma_f32_16x16x32_bf16 v[16:19], a[64:67], v[64:67], v[48:51]
    s_sub_u32 s47, s47, s48
    v_exp_f32 v28, v28
    v_mfma_f32_16x16x32_bf16 v[16:19], a[68:71], v[68:71], v[16:19]
    v_perm_b32 v45, v27, v26, s100
    v_add_u32 v1, s48, v1
    v_mfma_f32_16x16x32_bf16 v[16:19], a[72:75], v[72:75], v[16:19]
    v_exp_f32 v29, v29
    v_mfma_f32_16x16x32_bf16 v[16:19], a[76:79], v[76:79], v[16:19]
    s_waitcnt lgkmcnt(8)
    v_mfma_f32_16x16x32_bf16 v[20:23], a[80:83], v[64:67], v[48:51]
    v_exp_f32 v30, v30
    v_mfma_f32_16x16x32_bf16 v[20:23], a[84:87], v[68:71], v[20:23]
    v_perm_b32 v46, v29, v28, s100
    v_add_u32 v2, s48, v2
    v_mfma_f32_16x16x32_bf16 v[20:23], a[88:91], v[72:75], v[20:23]
    v_exp_f32 v31, v31
    v_mfma_f32_16x16x32_bf16 v[20:23], a[92:95], v[76:79], v[20:23]
    s_waitcnt lgkmcnt(4)
    v_mfma_f32_16x16x32_bf16 v[24:27], a[96:99], v[64:67], v[48:51]
    s_sub_u32 s48, 0, s48
    v_exp_f32 v16, v16
    v_mfma_f32_16x16x32_bf16 v[24:27], a[100:103], v[68:71], v[24:27]
    v_perm_b32 v47, v31, v30, s100
    v_mfma_f32_16x16x32_bf16 v[24:27], a[104:107], v[72:75], v[24:27]
    v_exp_f32 v17, v17
    v_mfma_f32_16x16x32_bf16 v[24:27], a[108:111], v[76:79], v[24:27]
    s_waitcnt lgkmcnt(0)
    v_mfma_f32_16x16x32_bf16 v[28:31], a[112:115], v[64:67], v[48:51]
    v_exp_f32 v18, v18
    v_mfma_f32_16x16x32_bf16 v[28:31], a[116:119], v[68:71], v[28:31]
    v_perm_b32 v32, v17, v16, s100
    v_mfma_f32_16x16x32_bf16 v[28:31], a[120:123], v[72:75], v[28:31]
    v_exp_f32 v19, v19
    v_mfma_f32_16x16x32_bf16 v[28:31], a[124:127], v[76:79], v[28:31]
    s_waitcnt vmcnt(7)
    s_barrier
    v_mfma_f32_16x16x32_bf16 v[224:227], a[128:131], v[40:43], v[224:227]
    v_exp_f32 v20, v20
    v_mfma_f32_16x16x32_bf16 v[224:227], a[132:135], v[44:47], v[224:227]
    ds_read_b64_tr_b16 a[128:129], v2 offset:0
    v_perm_b32 v33, v19, v18, s100
    v_mfma_f32_16x16x32_bf16 v[228:231], a[136:139], v[40:43], v[228:231]
    s_add_u32 m0, s44, 73728
    v_exp_f32 v21, v21
    v_mfma_f32_16x16x32_bf16 v[228:231], a[140:143], v[44:47], v[228:231]
    s_mov_b32 s45, 0
    buffer_load_dwordx4 v7, s[28:31], s45 offen offset:0 lds
    v_mfma_f32_16x16x32_bf16 v[232:235], a[144:147], v[40:43], v[232:235]
    v_exp_f32 v22, v22
    v_mfma_f32_16x16x32_bf16 v[232:235], a[148:151], v[44:47], v[232:235]
    ds_read_b64_tr_b16 a[130:131], v2 offset:256
    v_perm_b32 v34, v21, v20, s100
    v_mfma_f32_16x16x32_bf16 v[236:239], a[152:155], v[40:43], v[236:239]
    s_add_u32 m0, s44, 73632
    v_exp_f32 v23, v23
    v_mfma_f32_16x16x32_bf16 v[236:239], a[156:159], v[44:47], v[236:239]
    buffer_load_dwordx4 v7, s[28:31], s45 offen offset:1152 lds
    v_mfma_f32_16x16x32_bf16 v[240:243], a[160:163], v[40:43], v[240:243]
    v_exp_f32 v24, v24
    v_mfma_f32_16x16x32_bf16 v[240:243], a[164:167], v[44:47], v[240:243]
    ds_read_b64_tr_b16 a[132:133], v2 offset:512
    v_perm_b32 v35, v23, v22, s100
    v_mfma_f32_16x16x32_bf16 v[244:247], a[168:171], v[40:43], v[244:247]
    s_add_u32 m0, s44, 73536
    v_exp_f32 v25, v25
    v_mfma_f32_16x16x32_bf16 v[244:247], a[172:175], v[44:47], v[244:247]
    buffer_load_dwordx4 v7, s[28:31], s45 offen offset:2304 lds
    v_mfma_f32_16x16x32_bf16 v[248:251], a[176:179], v[40:43], v[248:251]
    v_exp_f32 v26, v26
    v_mfma_f32_16x16x32_bf16 v[248:251], a[180:183], v[44:47], v[248:251]
    ds_read_b64_tr_b16 a[134:135], v2 offset:768
    v_perm_b32 v36, v25, v24, s100
    v_mfma_f32_16x16x32_bf16 v[252:255], a[184:187], v[40:43], v[252:255]
    s_add_u32 m0, s44, 73440
    v_exp_f32 v27, v27
    v_mfma_f32_16x16x32_bf16 v[252:255], a[188:191], v[44:47], v[252:255]
    buffer_load_dwordx4 v7, s[28:31], s45 offen offset:3456 lds
    v_smfmac_f32_16x16x64_bf16 a[12:15], a[16:19], v[40:47], v11
    ds_read_b64_tr_b16 a[136:137], v2 offset:32
    v_mfma_f32_16x16x32_bf16 v[16:19], a[64:67], v[80:83], v[52:55]
    v_exp_f32 v28, v28
    v_mfma_f32_16x16x32_bf16 v[16:19], a[68:71], v[84:87], v[16:19]
    ds_read_b64_tr_b16 a[138:139], v2 offset:288
    v_perm_b32 v37, v27, v26, s100
    v_mfma_f32_16x16x32_bf16 v[16:19], a[72:75], v[88:91], v[16:19]
    s_add_u32 m0, s44, 90624
    v_exp_f32 v29, v29
    v_mfma_f32_16x16x32_bf16 v[16:19], a[76:79], v[92:95], v[16:19]
    s_mov_b32 s45, 147456
    buffer_load_dwordx4 v7, s[28:31], s45 offen offset:0 lds
    v_mfma_f32_16x16x32_bf16 v[20:23], a[80:83], v[80:83], v[52:55]
    v_exp_f32 v30, v30
    v_mfma_f32_16x16x32_bf16 v[20:23], a[84:87], v[84:87], v[20:23]
    ds_read_b64_tr_b16 a[140:141], v2 offset:544
    v_perm_b32 v38, v29, v28, s100
    v_mfma_f32_16x16x32_bf16 v[20:23], a[88:91], v[88:91], v[20:23]
    s_add_u32 m0, s44, 90528
    v_exp_f32 v31, v31
    v_mfma_f32_16x16x32_bf16 v[20:23], a[92:95], v[92:95], v[20:23]
    buffer_load_dwordx4 v7, s[28:31], s45 offen offset:1152 lds
    v_mfma_f32_16x16x32_bf16 v[24:27], a[96:99], v[80:83], v[52:55]
    v_exp_f32 v16, v16
    v_mfma_f32_16x16x32_bf16 v[24:27], a[100:103], v[84:87], v[24:27]
    ds_read_b64_tr_b16 a[142:143], v2 offset:800
    v_perm_b32 v39, v31, v30, s100
    v_mfma_f32_16x16x32_bf16 v[24:27], a[104:107], v[88:91], v[24:27]
    s_add_u32 m0, s44, 90432
    v_exp_f32 v17, v17
    v_mfma_f32_16x16x32_bf16 v[24:27], a[108:111], v[92:95], v[24:27]
    buffer_load_dwordx4 v7, s[28:31], s45 offen offset:2304 lds
    v_mfma_f32_16x16x32_bf16 v[28:31], a[112:115], v[80:83], v[52:55]
    v_exp_f32 v18, v18
    v_mfma_f32_16x16x32_bf16 v[28:31], a[116:119], v[84:87], v[28:31]
    ds_read_b64_tr_b16 a[144:145], v2 offset:64
    v_perm_b32 v40, v17, v16, s100
    v_mfma_f32_16x16x32_bf16 v[28:31], a[120:123], v[88:91], v[28:31]
    s_add_u32 m0, s44, 90336
    v_exp_f32 v19, v19
    v_mfma_f32_16x16x32_bf16 v[28:31], a[124:127], v[92:95], v[28:31]
    buffer_load_dwordx4 v7, s[28:31], s45 offen offset:3456 lds
    v_mfma_f32_16x16x32_bf16 v[128:131], a[192:195], v[32:35], v[128:131]
    v_exp_f32 v20, v20
    v_mfma_f32_16x16x32_bf16 v[128:131], a[196:199], v[36:39], v[128:131]
    ds_read_b64_tr_b16 a[146:147], v2 offset:320
    v_perm_b32 v41, v19, v18, s100
    v_mfma_f32_16x16x32_bf16 v[132:135], a[200:203], v[32:35], v[132:135]
    v_exp_f32 v21, v21
    v_mfma_f32_16x16x32_bf16 v[132:135], a[204:207], v[36:39], v[132:135]
    ds_read_b64_tr_b16 a[148:149], v2 offset:576
    v_mfma_f32_16x16x32_bf16 v[136:139], a[208:211], v[32:35], v[136:139]
    v_exp_f32 v22, v22
    v_mfma_f32_16x16x32_bf16 v[136:139], a[212:215], v[36:39], v[136:139]
    ds_read_b64_tr_b16 a[150:151], v2 offset:832
    v_perm_b32 v42, v21, v20, s100
    v_mfma_f32_16x16x32_bf16 v[140:143], a[216:219], v[32:35], v[140:143]
    v_exp_f32 v23, v23
    v_mfma_f32_16x16x32_bf16 v[140:143], a[220:223], v[36:39], v[140:143]
    ds_read_b64_tr_b16 a[152:153], v2 offset:96
    ds_read_b64_tr_b16 a[154:155], v2 offset:352
    v_mfma_f32_16x16x32_bf16 v[144:147], a[224:227], v[32:35], v[144:147]
    v_exp_f32 v24, v24
    v_mfma_f32_16x16x32_bf16 v[144:147], a[228:231], v[36:39], v[144:147]
    ds_read_b64_tr_b16 a[156:157], v2 offset:608
    v_perm_b32 v43, v23, v22, s100
    v_mfma_f32_16x16x32_bf16 v[148:151], a[232:235], v[32:35], v[148:151]
    v_exp_f32 v25, v25
    v_mfma_f32_16x16x32_bf16 v[148:151], a[236:239], v[36:39], v[148:151]
    ds_read_b64_tr_b16 a[158:159], v2 offset:864
    ds_read_b64_tr_b16 a[160:161], v2 offset:128
    v_mfma_f32_16x16x32_bf16 v[152:155], a[240:243], v[32:35], v[152:155]
    v_exp_f32 v26, v26
    v_mfma_f32_16x16x32_bf16 v[152:155], a[244:247], v[36:39], v[152:155]
    ds_read_b64_tr_b16 a[162:163], v2 offset:384
    v_perm_b32 v44, v25, v24, s100
    v_mfma_f32_16x16x32_bf16 v[156:159], a[248:251], v[32:35], v[156:159]
    v_exp_f32 v27, v27
    v_mfma_f32_16x16x32_bf16 v[156:159], a[252:255], v[36:39], v[156:159]
    ds_read_b64_tr_b16 a[164:165], v2 offset:640
    ds_read_b64_tr_b16 a[166:167], v2 offset:896
    v_smfmac_f32_16x16x64_bf16 a[0:3], a[16:19], v[32:39], v11
    ds_read_b64_tr_b16 a[168:169], v2 offset:160
    ds_read_b64_tr_b16 a[170:171], v2 offset:416
    v_mfma_f32_16x16x32_bf16 v[16:19], a[64:67], v[96:99], v[56:59]
    v_exp_f32 v28, v28
    v_mfma_f32_16x16x32_bf16 v[16:19], a[68:71], v[100:103], v[16:19]
    ds_read_b64_tr_b16 a[172:173], v2 offset:672
    v_perm_b32 v45, v27, v26, s100
    v_mfma_f32_16x16x32_bf16 v[16:19], a[72:75], v[104:107], v[16:19]
    s_add_u32 m0, s44, 110592
    v_exp_f32 v29, v29
    v_mfma_f32_16x16x32_bf16 v[16:19], a[76:79], v[108:111], v[16:19]
    s_mov_b32 s45, 128
    buffer_load_dwordx4 v7, s[28:31], s45 offen offset:0 lds
    v_mfma_f32_16x16x32_bf16 v[20:23], a[80:83], v[96:99], v[56:59]
    v_exp_f32 v30, v30
    v_mfma_f32_16x16x32_bf16 v[20:23], a[84:87], v[100:103], v[20:23]
    ds_read_b64_tr_b16 a[174:175], v2 offset:928
    v_perm_b32 v46, v29, v28, s100
    v_mfma_f32_16x16x32_bf16 v[20:23], a[88:91], v[104:107], v[20:23]
    s_add_u32 m0, s44, 110496
    v_exp_f32 v31, v31
    v_mfma_f32_16x16x32_bf16 v[20:23], a[92:95], v[108:111], v[20:23]
    buffer_load_dwordx4 v7, s[28:31], s45 offen offset:1152 lds
    v_mfma_f32_16x16x32_bf16 v[24:27], a[96:99], v[96:99], v[56:59]
    v_exp_f32 v16, v16
    v_mfma_f32_16x16x32_bf16 v[24:27], a[100:103], v[100:103], v[24:27]
    ds_read_b64_tr_b16 a[176:177], v2 offset:192
    v_perm_b32 v47, v31, v30, s100
    v_mfma_f32_16x16x32_bf16 v[24:27], a[104:107], v[104:107], v[24:27]
    s_add_u32 m0, s44, 110400
    v_exp_f32 v17, v17
    v_mfma_f32_16x16x32_bf16 v[24:27], a[108:111], v[108:111], v[24:27]
    buffer_load_dwordx4 v7, s[28:31], s45 offen offset:2304 lds
    v_mfma_f32_16x16x32_bf16 v[28:31], a[112:115], v[96:99], v[56:59]
    v_exp_f32 v18, v18
    v_mfma_f32_16x16x32_bf16 v[28:31], a[116:119], v[100:103], v[28:31]
    ds_read_b64_tr_b16 a[178:179], v2 offset:448
    v_perm_b32 v32, v17, v16, s100
    v_mfma_f32_16x16x32_bf16 v[28:31], a[120:123], v[104:107], v[28:31]
    s_add_u32 m0, s44, 110304
    v_exp_f32 v19, v19
    v_mfma_f32_16x16x32_bf16 v[28:31], a[124:127], v[108:111], v[28:31]
    buffer_load_dwordx4 v7, s[28:31], s45 offen offset:3456 lds
    v_mfma_f32_16x16x32_bf16 v[160:163], a[192:195], v[40:43], v[160:163]
    v_exp_f32 v20, v20
    v_mfma_f32_16x16x32_bf16 v[160:163], a[196:199], v[44:47], v[160:163]
    ds_read_b64_tr_b16 a[180:181], v2 offset:704
    v_perm_b32 v33, v19, v18, s100
    v_mfma_f32_16x16x32_bf16 v[164:167], a[200:203], v[40:43], v[164:167]
    s_add_u32 m0, s44, 127488
    v_exp_f32 v21, v21
    v_mfma_f32_16x16x32_bf16 v[164:167], a[204:207], v[44:47], v[164:167]
    s_mov_b32 s45, 147584
    buffer_load_dwordx4 v7, s[28:31], s45 offen offset:0 lds
    v_mfma_f32_16x16x32_bf16 v[168:171], a[208:211], v[40:43], v[168:171]
    v_exp_f32 v22, v22
    v_mfma_f32_16x16x32_bf16 v[168:171], a[212:215], v[44:47], v[168:171]
    ds_read_b64_tr_b16 a[182:183], v2 offset:960
    v_perm_b32 v34, v21, v20, s100
    v_mfma_f32_16x16x32_bf16 v[172:175], a[216:219], v[40:43], v[172:175]
    s_add_u32 m0, s44, 127392
    v_exp_f32 v23, v23
    v_mfma_f32_16x16x32_bf16 v[172:175], a[220:223], v[44:47], v[172:175]
    buffer_load_dwordx4 v7, s[28:31], s45 offen offset:1152 lds
    v_mfma_f32_16x16x32_bf16 v[176:179], a[224:227], v[40:43], v[176:179]
    v_exp_f32 v24, v24
    v_mfma_f32_16x16x32_bf16 v[176:179], a[228:231], v[44:47], v[176:179]
    ds_read_b64_tr_b16 a[184:185], v2 offset:224
    v_perm_b32 v35, v23, v22, s100
    v_mfma_f32_16x16x32_bf16 v[180:183], a[232:235], v[40:43], v[180:183]
    s_add_u32 m0, s44, 127296
    v_exp_f32 v25, v25
    v_mfma_f32_16x16x32_bf16 v[180:183], a[236:239], v[44:47], v[180:183]
    buffer_load_dwordx4 v7, s[28:31], s45 offen offset:2304 lds
    v_mfma_f32_16x16x32_bf16 v[184:187], a[240:243], v[40:43], v[184:187]
    v_exp_f32 v26, v26
    v_mfma_f32_16x16x32_bf16 v[184:187], a[244:247], v[44:47], v[184:187]
    ds_read_b64_tr_b16 a[186:187], v2 offset:480
    v_perm_b32 v36, v25, v24, s100
    v_mfma_f32_16x16x32_bf16 v[188:191], a[248:251], v[40:43], v[188:191]
    s_add_u32 m0, s44, 127200
    v_exp_f32 v27, v27
    v_mfma_f32_16x16x32_bf16 v[188:191], a[252:255], v[44:47], v[188:191]
    buffer_load_dwordx4 v7, s[28:31], s45 offen offset:3456 lds
    v_smfmac_f32_16x16x64_bf16 a[4:7], a[16:19], v[40:47], v11
    ds_read_b64_tr_b16 a[188:189], v2 offset:736
    ds_read_b64_tr_b16 a[190:191], v2 offset:992
    v_mfma_f32_16x16x32_bf16 v[16:19], a[64:67], v[112:115], v[60:63]
    v_exp_f32 v28, v28
    v_mfma_f32_16x16x32_bf16 v[16:19], a[68:71], v[116:119], v[16:19]
    ds_read_b128 a[64:67], v1 offset:0
    v_perm_b32 v37, v27, v26, s100
    v_mfma_f32_16x16x32_bf16 v[16:19], a[72:75], v[120:123], v[16:19]
    v_exp_f32 v29, v29
    v_mfma_f32_16x16x32_bf16 v[16:19], a[76:79], v[124:127], v[16:19]
    ds_read_b128 a[68:71], v1 offset:64
    v_mfma_f32_16x16x32_bf16 v[20:23], a[80:83], v[112:115], v[60:63]
    v_exp_f32 v30, v30
    v_mfma_f32_16x16x32_bf16 v[20:23], a[84:87], v[116:119], v[20:23]
    ds_read_b128 a[72:75], v1 offset:128
    v_perm_b32 v38, v29, v28, s100
    v_mfma_f32_16x16x32_bf16 v[20:23], a[88:91], v[120:123], v[20:23]
    v_exp_f32 v31, v31
    v_mfma_f32_16x16x32_bf16 v[20:23], a[92:95], v[124:127], v[20:23]
    ds_read_b128 a[76:79], v1 offset:192
    v_mfma_f32_16x16x32_bf16 v[24:27], a[96:99], v[112:115], v[60:63]
    v_exp_f32 v16, v16
    v_mfma_f32_16x16x32_bf16 v[24:27], a[100:103], v[116:119], v[24:27]
    ds_read_b128 a[80:83], v1 offset:256
    v_perm_b32 v39, v31, v30, s100
    v_mfma_f32_16x16x32_bf16 v[24:27], a[104:107], v[120:123], v[24:27]
    v_exp_f32 v17, v17
    v_mfma_f32_16x16x32_bf16 v[24:27], a[108:111], v[124:127], v[24:27]
    ds_read_b128 a[84:87], v1 offset:320
    v_mfma_f32_16x16x32_bf16 v[28:31], a[112:115], v[112:115], v[60:63]
    v_exp_f32 v18, v18
    v_mfma_f32_16x16x32_bf16 v[28:31], a[116:119], v[116:119], v[28:31]
    ds_read_b128 a[88:91], v1 offset:384
    v_perm_b32 v40, v17, v16, s100
    v_mfma_f32_16x16x32_bf16 v[28:31], a[120:123], v[120:123], v[28:31]
    v_exp_f32 v19, v19
    v_mfma_f32_16x16x32_bf16 v[28:31], a[124:127], v[124:127], v[28:31]
    ds_read_b128 a[92:95], v1 offset:448
    v_mfma_f32_16x16x32_bf16 v[192:195], a[192:195], v[32:35], v[192:195]
    v_exp_f32 v20, v20
    v_mfma_f32_16x16x32_bf16 v[192:195], a[196:199], v[36:39], v[192:195]
    ds_read_b128 a[96:99], v1 offset:512
    v_perm_b32 v41, v19, v18, s100
    v_mfma_f32_16x16x32_bf16 v[196:199], a[200:203], v[32:35], v[196:199]
    v_exp_f32 v21, v21
    v_mfma_f32_16x16x32_bf16 v[196:199], a[204:207], v[36:39], v[196:199]
    ds_read_b128 a[100:103], v1 offset:576
    v_mfma_f32_16x16x32_bf16 v[200:203], a[208:211], v[32:35], v[200:203]
    v_exp_f32 v22, v22
    v_mfma_f32_16x16x32_bf16 v[200:203], a[212:215], v[36:39], v[200:203]
    ds_read_b128 a[104:107], v1 offset:640
    v_perm_b32 v42, v21, v20, s100
    v_mfma_f32_16x16x32_bf16 v[204:207], a[216:219], v[32:35], v[204:207]
    v_exp_f32 v23, v23
    v_mfma_f32_16x16x32_bf16 v[204:207], a[220:223], v[36:39], v[204:207]
    ds_read_b128 a[108:111], v1 offset:704
    v_mfma_f32_16x16x32_bf16 v[208:211], a[224:227], v[32:35], v[208:211]
    v_exp_f32 v24, v24
    v_mfma_f32_16x16x32_bf16 v[208:211], a[228:231], v[36:39], v[208:211]
    ds_read_b128 a[112:115], v1 offset:768
    v_perm_b32 v43, v23, v22, s100
    v_mfma_f32_16x16x32_bf16 v[212:215], a[232:235], v[32:35], v[212:215]
    v_exp_f32 v25, v25
    v_mfma_f32_16x16x32_bf16 v[212:215], a[236:239], v[36:39], v[212:215]
    ds_read_b128 a[116:119], v1 offset:832
    v_mfma_f32_16x16x32_bf16 v[216:219], a[240:243], v[32:35], v[216:219]
    v_exp_f32 v26, v26
    v_mfma_f32_16x16x32_bf16 v[216:219], a[244:247], v[36:39], v[216:219]
    ds_read_b128 a[120:123], v1 offset:896
    v_perm_b32 v44, v25, v24, s100
    v_mfma_f32_16x16x32_bf16 v[220:223], a[248:251], v[32:35], v[220:223]
    v_exp_f32 v27, v27
    v_mfma_f32_16x16x32_bf16 v[220:223], a[252:255], v[36:39], v[220:223]
    ds_read_b128 a[124:127], v1 offset:960
    v_smfmac_f32_16x16x64_bf16 a[8:11], a[16:19], v[32:39], v11
    s_waitcnt lgkmcnt(12)
    v_mfma_f32_16x16x32_bf16 v[16:19], a[64:67], v[64:67], v[48:51]
    v_exp_f32 v28, v28
    v_mfma_f32_16x16x32_bf16 v[16:19], a[68:71], v[68:71], v[16:19]
    v_perm_b32 v45, v27, v26, s100
    v_mfma_f32_16x16x32_bf16 v[16:19], a[72:75], v[72:75], v[16:19]
    s_mov_b32 s54, 737280
    v_exp_f32 v29, v29
    v_mfma_f32_16x16x32_bf16 v[16:19], a[76:79], v[76:79], v[16:19]
    s_waitcnt lgkmcnt(8)
    buffer_load_dwordx4 a[40:43], v6, s[64:67], s54 offen
    v_mfma_f32_16x16x32_bf16 v[20:23], a[80:83], v[64:67], v[48:51]
    v_exp_f32 v30, v30
    v_mfma_f32_16x16x32_bf16 v[20:23], a[84:87], v[68:71], v[20:23]
    v_perm_b32 v46, v29, v28, s100
    v_mfma_f32_16x16x32_bf16 v[20:23], a[88:91], v[72:75], v[20:23]
    v_exp_f32 v31, v31
    v_mfma_f32_16x16x32_bf16 v[20:23], a[92:95], v[76:79], v[20:23]
    s_waitcnt lgkmcnt(4)
    v_mfma_f32_16x16x32_bf16 v[24:27], a[96:99], v[64:67], v[48:51]
    v_exp_f32 v16, v16
    v_mfma_f32_16x16x32_bf16 v[24:27], a[100:103], v[68:71], v[24:27]
    v_perm_b32 v47, v31, v30, s100
    v_mfma_f32_16x16x32_bf16 v[24:27], a[104:107], v[72:75], v[24:27]
    s_mov_b32 s54, 884736
    v_exp_f32 v17, v17
    v_mfma_f32_16x16x32_bf16 v[24:27], a[108:111], v[76:79], v[24:27]
    s_waitcnt lgkmcnt(0)
    buffer_load_dwordx4 a[44:47], v6, s[64:67], s54 offen
    v_mfma_f32_16x16x32_bf16 v[28:31], a[112:115], v[64:67], v[48:51]
    v_exp_f32 v18, v18
    v_mfma_f32_16x16x32_bf16 v[28:31], a[116:119], v[68:71], v[28:31]
    v_perm_b32 v32, v17, v16, s100
    v_mfma_f32_16x16x32_bf16 v[28:31], a[120:123], v[72:75], v[28:31]
    v_exp_f32 v19, v19
    v_mfma_f32_16x16x32_bf16 v[28:31], a[124:127], v[76:79], v[28:31]
    v_mfma_f32_16x16x32_bf16 v[224:227], a[192:195], v[40:43], v[224:227]
    v_exp_f32 v20, v20
    v_mfma_f32_16x16x32_bf16 v[224:227], a[196:199], v[44:47], v[224:227]
    ds_read_b64_tr_b16 a[192:193], v2 offset:36864
    v_perm_b32 v33, v19, v18, s100
    v_mfma_f32_16x16x32_bf16 v[228:231], a[200:203], v[40:43], v[228:231]
    s_mov_b32 s54, 1032192
    v_exp_f32 v21, v21
    v_mfma_f32_16x16x32_bf16 v[228:231], a[204:207], v[44:47], v[228:231]
    buffer_load_dwordx4 a[48:51], v6, s[64:67], s54 offen
    v_mfma_f32_16x16x32_bf16 v[232:235], a[208:211], v[40:43], v[232:235]
    v_exp_f32 v22, v22
    v_mfma_f32_16x16x32_bf16 v[232:235], a[212:215], v[44:47], v[232:235]
    ds_read_b64_tr_b16 a[194:195], v2 offset:37120
    v_perm_b32 v34, v21, v20, s100
    v_mfma_f32_16x16x32_bf16 v[236:239], a[216:219], v[40:43], v[236:239]
    v_exp_f32 v23, v23
    v_mfma_f32_16x16x32_bf16 v[236:239], a[220:223], v[44:47], v[236:239]
    ds_read_b64_tr_b16 a[196:197], v2 offset:37376
    v_mfma_f32_16x16x32_bf16 v[240:243], a[224:227], v[40:43], v[240:243]
    v_exp_f32 v24, v24
    v_mfma_f32_16x16x32_bf16 v[240:243], a[228:231], v[44:47], v[240:243]
    ds_read_b64_tr_b16 a[198:199], v2 offset:37632
    v_perm_b32 v35, v23, v22, s100
    v_mfma_f32_16x16x32_bf16 v[244:247], a[232:235], v[40:43], v[244:247]
    s_mov_b32 s54, 1179648
    v_exp_f32 v25, v25
    v_mfma_f32_16x16x32_bf16 v[244:247], a[236:239], v[44:47], v[244:247]
    buffer_load_dwordx4 a[52:55], v6, s[64:67], s54 offen
    v_mfma_f32_16x16x32_bf16 v[248:251], a[240:243], v[40:43], v[248:251]
    v_exp_f32 v26, v26
    v_mfma_f32_16x16x32_bf16 v[248:251], a[244:247], v[44:47], v[248:251]
    ds_read_b64_tr_b16 a[200:201], v2 offset:36896
    v_perm_b32 v36, v25, v24, s100
    v_mfma_f32_16x16x32_bf16 v[252:255], a[248:251], v[40:43], v[252:255]
    v_exp_f32 v27, v27
    v_mfma_f32_16x16x32_bf16 v[252:255], a[252:255], v[44:47], v[252:255]
    ds_read_b64_tr_b16 a[202:203], v2 offset:37152
    v_smfmac_f32_16x16x64_bf16 a[12:15], a[16:19], v[40:47], v11
    ds_read_b64_tr_b16 a[204:205], v2 offset:37408
    v_mfma_f32_16x16x32_bf16 v[16:19], a[64:67], v[80:83], v[52:55]
    v_exp_f32 v28, v28
    v_mfma_f32_16x16x32_bf16 v[16:19], a[68:71], v[84:87], v[16:19]
    ds_read_b64_tr_b16 a[206:207], v2 offset:37664
    v_perm_b32 v37, v27, v26, s100
    v_mfma_f32_16x16x32_bf16 v[16:19], a[72:75], v[88:91], v[16:19]
    v_exp_f32 v29, v29
    v_mfma_f32_16x16x32_bf16 v[16:19], a[76:79], v[92:95], v[16:19]
    buffer_store_dwordx4 a[56:59], v5, s[32:35], 0 offen offset:0 sc1
    v_mfma_f32_16x16x32_bf16 v[20:23], a[80:83], v[80:83], v[52:55]
    v_exp_f32 v30, v30
    v_mfma_f32_16x16x32_bf16 v[20:23], a[84:87], v[84:87], v[20:23]
    ds_read_b64_tr_b16 a[208:209], v2 offset:36928
    v_perm_b32 v38, v29, v28, s100
    v_mfma_f32_16x16x32_bf16 v[20:23], a[88:91], v[88:91], v[20:23]
    v_exp_f32 v31, v31
    v_mfma_f32_16x16x32_bf16 v[20:23], a[92:95], v[92:95], v[20:23]
    ds_read_b64_tr_b16 a[210:211], v2 offset:37184
    v_mfma_f32_16x16x32_bf16 v[24:27], a[96:99], v[80:83], v[52:55]
    v_exp_f32 v16, v16
    v_mfma_f32_16x16x32_bf16 v[24:27], a[100:103], v[84:87], v[24:27]
    ds_read_b64_tr_b16 a[212:213], v2 offset:37440
    v_perm_b32 v39, v31, v30, s100
    v_mfma_f32_16x16x32_bf16 v[24:27], a[104:107], v[88:91], v[24:27]
    v_exp_f32 v17, v17
    v_mfma_f32_16x16x32_bf16 v[24:27], a[108:111], v[92:95], v[24:27]
    buffer_store_dwordx4 a[56:59], v5, s[32:35], 0 offen offset:1024 sc1
    v_mfma_f32_16x16x32_bf16 v[28:31], a[112:115], v[80:83], v[52:55]
    v_exp_f32 v18, v18
    v_mfma_f32_16x16x32_bf16 v[28:31], a[116:119], v[84:87], v[28:31]
    ds_read_b64_tr_b16 a[214:215], v2 offset:37696
    v_perm_b32 v40, v17, v16, s100
    v_mfma_f32_16x16x32_bf16 v[28:31], a[120:123], v[88:91], v[28:31]
    v_exp_f32 v19, v19
    v_mfma_f32_16x16x32_bf16 v[28:31], a[124:127], v[92:95], v[28:31]
    ds_read_b64_tr_b16 a[216:217], v2 offset:36960
    v_mfma_f32_16x16x32_bf16 v[128:131], a[128:131], v[32:35], v[128:131]
    v_exp_f32 v20, v20
    v_mfma_f32_16x16x32_bf16 v[128:131], a[132:135], v[36:39], v[128:131]
    ds_read_b64_tr_b16 a[218:219], v2 offset:37216
    v_perm_b32 v41, v19, v18, s100
    v_mfma_f32_16x16x32_bf16 v[132:135], a[136:139], v[32:35], v[132:135]
    v_exp_f32 v21, v21
    v_mfma_f32_16x16x32_bf16 v[132:135], a[140:143], v[36:39], v[132:135]
    buffer_store_dwordx4 a[56:59], v5, s[32:35], 0 offen offset:2048 sc1
    v_mfma_f32_16x16x32_bf16 v[136:139], a[144:147], v[32:35], v[136:139]
    v_exp_f32 v22, v22
    v_mfma_f32_16x16x32_bf16 v[136:139], a[148:151], v[36:39], v[136:139]
    ds_read_b64_tr_b16 a[220:221], v2 offset:37472
    v_perm_b32 v42, v21, v20, s100
    v_mfma_f32_16x16x32_bf16 v[140:143], a[152:155], v[32:35], v[140:143]
    v_exp_f32 v23, v23
    v_mfma_f32_16x16x32_bf16 v[140:143], a[156:159], v[36:39], v[140:143]
    ds_read_b64_tr_b16 a[222:223], v2 offset:37728
    v_mfma_f32_16x16x32_bf16 v[144:147], a[160:163], v[32:35], v[144:147]
    v_exp_f32 v24, v24
    v_mfma_f32_16x16x32_bf16 v[144:147], a[164:167], v[36:39], v[144:147]
    ds_read_b64_tr_b16 a[224:225], v2 offset:36992
    v_perm_b32 v43, v23, v22, s100
    v_mfma_f32_16x16x32_bf16 v[148:151], a[168:171], v[32:35], v[148:151]
    v_exp_f32 v25, v25
    v_mfma_f32_16x16x32_bf16 v[148:151], a[172:175], v[36:39], v[148:151]
    buffer_store_dwordx4 a[56:59], v5, s[32:35], 0 offen offset:3072 sc1
    v_mfma_f32_16x16x32_bf16 v[152:155], a[176:179], v[32:35], v[152:155]
    v_exp_f32 v26, v26
    v_mfma_f32_16x16x32_bf16 v[152:155], a[180:183], v[36:39], v[152:155]
    ds_read_b64_tr_b16 a[226:227], v2 offset:37248
    v_perm_b32 v44, v25, v24, s100
    v_mfma_f32_16x16x32_bf16 v[156:159], a[184:187], v[32:35], v[156:159]
    v_exp_f32 v27, v27
    v_mfma_f32_16x16x32_bf16 v[156:159], a[188:191], v[36:39], v[156:159]
    ds_read_b64_tr_b16 a[228:229], v2 offset:37504
    v_smfmac_f32_16x16x64_bf16 a[0:3], a[16:19], v[32:39], v11
    ds_read_b64_tr_b16 a[230:231], v2 offset:37760
    v_mfma_f32_16x16x32_bf16 v[16:19], a[64:67], v[96:99], v[56:59]
    v_exp_f32 v28, v28
    v_mfma_f32_16x16x32_bf16 v[16:19], a[68:71], v[100:103], v[16:19]
    ds_read_b64_tr_b16 a[232:233], v2 offset:37024
    v_perm_b32 v45, v27, v26, s100
    v_mfma_f32_16x16x32_bf16 v[16:19], a[72:75], v[104:107], v[16:19]
    v_exp_f32 v29, v29
    v_mfma_f32_16x16x32_bf16 v[16:19], a[76:79], v[108:111], v[16:19]
    ds_read_b64_tr_b16 a[234:235], v2 offset:37280
    v_mfma_f32_16x16x32_bf16 v[20:23], a[80:83], v[96:99], v[56:59]
    v_exp_f32 v30, v30
    v_mfma_f32_16x16x32_bf16 v[20:23], a[84:87], v[100:103], v[20:23]
    ds_read_b64_tr_b16 a[236:237], v2 offset:37536
    v_perm_b32 v46, v29, v28, s100
    v_mfma_f32_16x16x32_bf16 v[20:23], a[88:91], v[104:107], v[20:23]
    v_exp_f32 v31, v31
    v_mfma_f32_16x16x32_bf16 v[20:23], a[92:95], v[108:111], v[20:23]
    ds_read_b64_tr_b16 a[238:239], v2 offset:37792
    v_mfma_f32_16x16x32_bf16 v[24:27], a[96:99], v[96:99], v[56:59]
    v_exp_f32 v16, v16
    v_mfma_f32_16x16x32_bf16 v[24:27], a[100:103], v[100:103], v[24:27]
    ds_read_b64_tr_b16 a[240:241], v2 offset:37056
    v_perm_b32 v47, v31, v30, s100
    v_mfma_f32_16x16x32_bf16 v[24:27], a[104:107], v[104:107], v[24:27]
    v_exp_f32 v17, v17
    v_mfma_f32_16x16x32_bf16 v[24:27], a[108:111], v[108:111], v[24:27]
    ds_read_b64_tr_b16 a[242:243], v2 offset:37312
    v_mfma_f32_16x16x32_bf16 v[28:31], a[112:115], v[96:99], v[56:59]
    v_exp_f32 v18, v18
    v_mfma_f32_16x16x32_bf16 v[28:31], a[116:119], v[100:103], v[28:31]
    ds_read_b64_tr_b16 a[244:245], v2 offset:37568
    v_perm_b32 v32, v17, v16, s100
    v_mfma_f32_16x16x32_bf16 v[28:31], a[120:123], v[104:107], v[28:31]
    v_exp_f32 v19, v19
    v_mfma_f32_16x16x32_bf16 v[28:31], a[124:127], v[108:111], v[28:31]
L2_pad9:
    s_cbranch_execz L2_pad13
    ds_read_b64_tr_b16 a[246:247], v2 offset:37824
    v_mfma_f32_16x16x32_bf16 v[160:163], a[128:131], v[40:43], v[160:163]
    v_exp_f32 v20, v20
    v_mfma_f32_16x16x32_bf16 v[160:163], a[132:135], v[44:47], v[160:163]
    ds_read_b64_tr_b16 a[248:249], v2 offset:37088
    v_perm_b32 v33, v19, v18, s100
    v_mfma_f32_16x16x32_bf16 v[164:167], a[136:139], v[40:43], v[164:167]
    v_exp_f32 v21, v21
    v_mfma_f32_16x16x32_bf16 v[164:167], a[140:143], v[44:47], v[164:167]
    ds_read_b64_tr_b16 a[250:251], v2 offset:37344
    v_mfma_f32_16x16x32_bf16 v[168:171], a[144:147], v[40:43], v[168:171]
    v_exp_f32 v22, v22
    v_mfma_f32_16x16x32_bf16 v[168:171], a[148:151], v[44:47], v[168:171]
    ds_read_b64_tr_b16 a[252:253], v2 offset:37600
    v_perm_b32 v34, v21, v20, s100
    v_mfma_f32_16x16x32_bf16 v[172:175], a[152:155], v[40:43], v[172:175]
    v_exp_f32 v23, v23
    v_mfma_f32_16x16x32_bf16 v[172:175], a[156:159], v[44:47], v[172:175]
    ds_read_b64_tr_b16 a[254:255], v2 offset:37856
    v_mfma_f32_16x16x32_bf16 v[176:179], a[160:163], v[40:43], v[176:179]
    v_exp_f32 v24, v24
    v_mfma_f32_16x16x32_bf16 v[176:179], a[164:167], v[44:47], v[176:179]
    v_perm_b32 v35, v23, v22, s100
    v_mfma_f32_16x16x32_bf16 v[180:183], a[168:171], v[40:43], v[180:183]
    v_exp_f32 v25, v25
    v_mfma_f32_16x16x32_bf16 v[180:183], a[172:175], v[44:47], v[180:183]
    v_mfma_f32_16x16x32_bf16 v[184:187], a[176:179], v[40:43], v[184:187]
    v_exp_f32 v26, v26
    v_mfma_f32_16x16x32_bf16 v[184:187], a[180:183], v[44:47], v[184:187]
    v_perm_b32 v36, v25, v24, s100
    v_mfma_f32_16x16x32_bf16 v[188:191], a[184:187], v[40:43], v[188:191]
    v_exp_f32 v27, v27
    v_mfma_f32_16x16x32_bf16 v[188:191], a[188:191], v[44:47], v[188:191]
    v_smfmac_f32_16x16x64_bf16 a[4:7], a[16:19], v[40:47], v11
    v_mfma_f32_16x16x32_bf16 v[16:19], a[64:67], v[112:115], v[60:63]
    v_exp_f32 v28, v28
    v_mfma_f32_16x16x32_bf16 v[16:19], a[68:71], v[116:119], v[16:19]
    ds_read_b128 a[64:67], v1 offset:36864
    v_perm_b32 v37, v27, v26, s100
    v_mfma_f32_16x16x32_bf16 v[16:19], a[72:75], v[120:123], v[16:19]
    v_exp_f32 v29, v29
    v_mfma_f32_16x16x32_bf16 v[16:19], a[76:79], v[124:127], v[16:19]
    ds_read_b128 a[68:71], v1 offset:36928
    v_mfma_f32_16x16x32_bf16 v[20:23], a[80:83], v[112:115], v[60:63]
    v_exp_f32 v30, v30
    v_mfma_f32_16x16x32_bf16 v[20:23], a[84:87], v[116:119], v[20:23]
    ds_read_b128 a[72:75], v1 offset:36992
    v_perm_b32 v38, v29, v28, s100
    v_mfma_f32_16x16x32_bf16 v[20:23], a[88:91], v[120:123], v[20:23]
    v_exp_f32 v31, v31
    v_mfma_f32_16x16x32_bf16 v[20:23], a[92:95], v[124:127], v[20:23]
    ds_read_b128 a[76:79], v1 offset:37056
    v_mfma_f32_16x16x32_bf16 v[24:27], a[96:99], v[112:115], v[60:63]
    v_exp_f32 v16, v16
    v_mfma_f32_16x16x32_bf16 v[24:27], a[100:103], v[116:119], v[24:27]
    ds_read_b128 a[80:83], v1 offset:37120
    v_perm_b32 v39, v31, v30, s100
    v_mfma_f32_16x16x32_bf16 v[24:27], a[104:107], v[120:123], v[24:27]
    v_exp_f32 v17, v17
    v_mfma_f32_16x16x32_bf16 v[24:27], a[108:111], v[124:127], v[24:27]
    ds_read_b128 a[84:87], v1 offset:37184
    v_mfma_f32_16x16x32_bf16 v[28:31], a[112:115], v[112:115], v[60:63]
    v_exp_f32 v18, v18
    v_mfma_f32_16x16x32_bf16 v[28:31], a[116:119], v[116:119], v[28:31]
    ds_read_b128 a[88:91], v1 offset:37248
    v_perm_b32 v40, v17, v16, s100
    v_mfma_f32_16x16x32_bf16 v[28:31], a[120:123], v[120:123], v[28:31]
    v_exp_f32 v19, v19
    v_mfma_f32_16x16x32_bf16 v[28:31], a[124:127], v[124:127], v[28:31]
    ds_read_b128 a[92:95], v1 offset:37312
    v_mfma_f32_16x16x32_bf16 v[192:195], a[128:131], v[32:35], v[192:195]
    v_exp_f32 v20, v20
    v_mfma_f32_16x16x32_bf16 v[192:195], a[132:135], v[36:39], v[192:195]
    ds_read_b128 a[96:99], v1 offset:37376
    v_perm_b32 v41, v19, v18, s100
    v_mfma_f32_16x16x32_bf16 v[196:199], a[136:139], v[32:35], v[196:199]
    v_exp_f32 v21, v21
    v_mfma_f32_16x16x32_bf16 v[196:199], a[140:143], v[36:39], v[196:199]
    ds_read_b128 a[100:103], v1 offset:37440
    v_mfma_f32_16x16x32_bf16 v[200:203], a[144:147], v[32:35], v[200:203]
    v_exp_f32 v22, v22
    v_mfma_f32_16x16x32_bf16 v[200:203], a[148:151], v[36:39], v[200:203]
    ds_read_b128 a[104:107], v1 offset:37504
    v_perm_b32 v42, v21, v20, s100
    v_mfma_f32_16x16x32_bf16 v[204:207], a[152:155], v[32:35], v[204:207]
    v_exp_f32 v23, v23
    v_mfma_f32_16x16x32_bf16 v[204:207], a[156:159], v[36:39], v[204:207]
    ds_read_b128 a[108:111], v1 offset:37568
    v_mfma_f32_16x16x32_bf16 v[208:211], a[160:163], v[32:35], v[208:211]
    v_exp_f32 v24, v24
    v_mfma_f32_16x16x32_bf16 v[208:211], a[164:167], v[36:39], v[208:211]
    ds_read_b128 a[112:115], v1 offset:37632
    v_perm_b32 v43, v23, v22, s100
    v_mfma_f32_16x16x32_bf16 v[212:215], a[168:171], v[32:35], v[212:215]
    v_exp_f32 v25, v25
    v_mfma_f32_16x16x32_bf16 v[212:215], a[172:175], v[36:39], v[212:215]
    ds_read_b128 a[116:119], v1 offset:37696
    v_mfma_f32_16x16x32_bf16 v[216:219], a[176:179], v[32:35], v[216:219]
    v_exp_f32 v26, v26
    v_mfma_f32_16x16x32_bf16 v[216:219], a[180:183], v[36:39], v[216:219]
    ds_read_b128 a[120:123], v1 offset:37760
    v_perm_b32 v44, v25, v24, s100
    v_mfma_f32_16x16x32_bf16 v[220:223], a[184:187], v[32:35], v[220:223]
    v_exp_f32 v27, v27
    v_mfma_f32_16x16x32_bf16 v[220:223], a[188:191], v[36:39], v[220:223]
    ds_read_b128 a[124:127], v1 offset:37824
    v_smfmac_f32_16x16x64_bf16 a[8:11], a[16:19], v[32:39], v11
    s_waitcnt lgkmcnt(12)
    v_mfma_f32_16x16x32_bf16 v[16:19], a[64:67], v[64:67], v[48:51]
    v_exp_f32 v28, v28
    v_mfma_f32_16x16x32_bf16 v[16:19], a[68:71], v[68:71], v[16:19]
    v_perm_b32 v45, v27, v26, s100
    v_mfma_f32_16x16x32_bf16 v[16:19], a[72:75], v[72:75], v[16:19]
    v_exp_f32 v29, v29
    v_mfma_f32_16x16x32_bf16 v[16:19], a[76:79], v[76:79], v[16:19]
    s_waitcnt lgkmcnt(8)
    v_mfma_f32_16x16x32_bf16 v[20:23], a[80:83], v[64:67], v[48:51]
    v_exp_f32 v30, v30
    v_mfma_f32_16x16x32_bf16 v[20:23], a[84:87], v[68:71], v[20:23]
    v_perm_b32 v46, v29, v28, s100
    v_mfma_f32_16x16x32_bf16 v[20:23], a[88:91], v[72:75], v[20:23]
    v_exp_f32 v31, v31
    v_mfma_f32_16x16x32_bf16 v[20:23], a[92:95], v[76:79], v[20:23]
    s_waitcnt lgkmcnt(4)
    v_mfma_f32_16x16x32_bf16 v[24:27], a[96:99], v[64:67], v[48:51]
    v_exp_f32 v16, v16
    v_mfma_f32_16x16x32_bf16 v[24:27], a[100:103], v[68:71], v[24:27]
    v_perm_b32 v47, v31, v30, s100
    v_mfma_f32_16x16x32_bf16 v[24:27], a[104:107], v[72:75], v[24:27]
    v_exp_f32 v17, v17
    v_mfma_f32_16x16x32_bf16 v[24:27], a[108:111], v[76:79], v[24:27]
    s_waitcnt lgkmcnt(0)
    v_mfma_f32_16x16x32_bf16 v[28:31], a[112:115], v[64:67], v[48:51]
    v_exp_f32 v18, v18
    v_mfma_f32_16x16x32_bf16 v[28:31], a[116:119], v[68:71], v[28:31]
    v_perm_b32 v32, v17, v16, s100
    v_mfma_f32_16x16x32_bf16 v[28:31], a[120:123], v[72:75], v[28:31]
    v_exp_f32 v19, v19
    v_mfma_f32_16x16x32_bf16 v[28:31], a[124:127], v[76:79], v[28:31]
    s_waitcnt vmcnt(8)
    s_barrier
    v_mfma_f32_16x16x32_bf16 v[224:227], a[128:131], v[40:43], v[224:227]
    v_exp_f32 v20, v20
    v_mfma_f32_16x16x32_bf16 v[224:227], a[132:135], v[44:47], v[224:227]
    v_perm_b32 v33, v19, v18, s100
    v_mfma_f32_16x16x32_bf16 v[228:231], a[136:139], v[40:43], v[228:231]
    s_add_u32 m0, s44, 0
    v_exp_f32 v21, v21
    v_mfma_f32_16x16x32_bf16 v[228:231], a[140:143], v[44:47], v[228:231]
    s_mov_b32 s45, 256
    buffer_load_dwordx4 v7, s[28:31], s45 offen offset:0 lds
    v_mfma_f32_16x16x32_bf16 v[232:235], a[144:147], v[40:43], v[232:235]
    v_exp_f32 v22, v22
    v_mfma_f32_16x16x32_bf16 v[232:235], a[148:151], v[44:47], v[232:235]
    v_perm_b32 v34, v21, v20, s100
    v_mfma_f32_16x16x32_bf16 v[236:239], a[152:155], v[40:43], v[236:239]
    s_add_u32 m0, s44, -96
    v_exp_f32 v23, v23
    v_mfma_f32_16x16x32_bf16 v[236:239], a[156:159], v[44:47], v[236:239]
    buffer_load_dwordx4 v7, s[28:31], s45 offen offset:1152 lds
    v_mfma_f32_16x16x32_bf16 v[240:243], a[160:163], v[40:43], v[240:243]
    v_exp_f32 v24, v24
    v_mfma_f32_16x16x32_bf16 v[240:243], a[164:167], v[44:47], v[240:243]
    v_perm_b32 v35, v23, v22, s100
    v_mfma_f32_16x16x32_bf16 v[244:247], a[168:171], v[40:43], v[244:247]
    s_add_u32 m0, s44, -192
    v_exp_f32 v25, v25
    v_mfma_f32_16x16x32_bf16 v[244:247], a[172:175], v[44:47], v[244:247]
    buffer_load_dwordx4 v7, s[28:31], s45 offen offset:2304 lds
    v_mfma_f32_16x16x32_bf16 v[248:251], a[176:179], v[40:43], v[248:251]
    v_exp_f32 v26, v26
    v_mfma_f32_16x16x32_bf16 v[248:251], a[180:183], v[44:47], v[248:251]
    v_perm_b32 v36, v25, v24, s100
    v_mfma_f32_16x16x32_bf16 v[252:255], a[184:187], v[40:43], v[252:255]
    s_add_u32 m0, s44, -288
    v_exp_f32 v27, v27
    v_mfma_f32_16x16x32_bf16 v[252:255], a[188:191], v[44:47], v[252:255]
    buffer_load_dwordx4 v7, s[28:31], s45 offen offset:3456 lds
    v_smfmac_f32_16x16x64_bf16 a[12:15], a[16:19], v[40:47], v11
    v_mfma_f32_16x16x32_bf16 v[16:19], a[64:67], v[80:83], v[52:55]
    v_exp_f32 v28, v28
    v_mfma_f32_16x16x32_bf16 v[16:19], a[68:71], v[84:87], v[16:19]
    v_perm_b32 v37, v27, v26, s100
    v_mfma_f32_16x16x32_bf16 v[16:19], a[72:75], v[88:91], v[16:19]
    s_add_u32 m0, s44, 16896
    v_exp_f32 v29, v29
    v_mfma_f32_16x16x32_bf16 v[16:19], a[76:79], v[92:95], v[16:19]
    s_mov_b32 s45, 147712
    buffer_load_dwordx4 v7, s[28:31], s45 offen offset:0 lds
    v_mfma_f32_16x16x32_bf16 v[20:23], a[80:83], v[80:83], v[52:55]
    v_exp_f32 v30, v30
    v_mfma_f32_16x16x32_bf16 v[20:23], a[84:87], v[84:87], v[20:23]
    v_perm_b32 v38, v29, v28, s100
    v_mfma_f32_16x16x32_bf16 v[20:23], a[88:91], v[88:91], v[20:23]
    s_add_u32 m0, s44, 16800
    v_exp_f32 v31, v31
    v_mfma_f32_16x16x32_bf16 v[20:23], a[92:95], v[92:95], v[20:23]
    s_mov_b32 s15, 0x3f800000
    buffer_load_dwordx4 v7, s[28:31], s45 offen offset:1152 lds
    v_mfma_f32_16x16x32_bf16 v[24:27], a[96:99], v[80:83], v[52:55]
    v_exp_f32 v16, v16
    v_mfma_f32_16x16x32_bf16 v[24:27], a[100:103], v[84:87], v[24:27]
    v_perm_b32 v39, v31, v30, s100
    v_mfma_f32_16x16x32_bf16 v[24:27], a[104:107], v[88:91], v[24:27]
    s_add_u32 m0, s44, 16704
    v_exp_f32 v17, v17
    v_mfma_f32_16x16x32_bf16 v[24:27], a[108:111], v[92:95], v[24:27]
    buffer_load_dwordx4 v7, s[28:31], s45 offen offset:2304 lds
    v_mfma_f32_16x16x32_bf16 v[28:31], a[112:115], v[80:83], v[52:55]
    v_exp_f32 v18, v18
    v_mfma_f32_16x16x32_bf16 v[28:31], a[116:119], v[84:87], v[28:31]
    v_perm_b32 v40, v17, v16, s100
    v_mfma_f32_16x16x32_bf16 v[28:31], a[120:123], v[88:91], v[28:31]
    s_add_u32 m0, s44, 16608
    v_exp_f32 v19, v19
    v_mfma_f32_16x16x32_bf16 v[28:31], a[124:127], v[92:95], v[28:31]
    buffer_load_dwordx4 v7, s[28:31], s45 offen offset:3456 lds
    v_mfma_f32_16x16x32_bf16 v[128:131], a[192:195], v[32:35], v[128:131]
    v_exp_f32 v20, v20
    v_mfma_f32_16x16x32_bf16 v[128:131], a[196:199], v[36:39], v[128:131]
    v_perm_b32 v41, v19, v18, s100
    v_mfma_f32_16x16x32_bf16 v[132:135], a[200:203], v[32:35], v[132:135]
    s_mov_b32 s54, 0
    v_exp_f32 v21, v21
    v_mfma_f32_16x16x32_bf16 v[132:135], a[204:207], v[36:39], v[132:135]
    buffer_load_dwordx4 a[128:131], v6, s[68:71], s54 offen
    v_mfma_f32_16x16x32_bf16 v[136:139], a[208:211], v[32:35], v[136:139]
    v_exp_f32 v22, v22
    v_mfma_f32_16x16x32_bf16 v[136:139], a[212:215], v[36:39], v[136:139]
    v_perm_b32 v42, v21, v20, s100
    v_mfma_f32_16x16x32_bf16 v[140:143], a[216:219], v[32:35], v[140:143]
    s_add_u32 s54, s55, 0
    v_exp_f32 v23, v23
    v_mfma_f32_16x16x32_bf16 v[140:143], a[220:223], v[36:39], v[140:143]
    buffer_load_dwordx4 a[164:167], v8, s[72:75], s54 offen
    v_mfma_f32_16x16x32_bf16 v[144:147], a[224:227], v[32:35], v[144:147]
    v_exp_f32 v24, v24
    v_mfma_f32_16x16x32_bf16 v[144:147], a[228:231], v[36:39], v[144:147]
    v_perm_b32 v43, v23, v22, s100
    v_mfma_f32_16x16x32_bf16 v[148:151], a[232:235], v[32:35], v[148:151]
    s_mov_b32 s54, 147456
    v_exp_f32 v25, v25
    v_mfma_f32_16x16x32_bf16 v[148:151], a[236:239], v[36:39], v[148:151]
    buffer_load_dwordx4 a[132:135], v6, s[68:71], s54 offen
    v_mfma_f32_16x16x32_bf16 v[152:155], a[240:243], v[32:35], v[152:155]
    v_exp_f32 v26, v26
    v_mfma_f32_16x16x32_bf16 v[152:155], a[244:247], v[36:39], v[152:155]
    v_perm_b32 v44, v25, v24, s100
    v_mfma_f32_16x16x32_bf16 v[156:159], a[248:251], v[32:35], v[156:159]
    s_add_u32 s54, s55, 1024
    v_exp_f32 v27, v27
    v_mfma_f32_16x16x32_bf16 v[156:159], a[252:255], v[36:39], v[156:159]
    buffer_load_dwordx4 a[168:171], v8, s[72:75], s54 offen
    v_smfmac_f32_16x16x64_bf16 a[0:3], a[16:19], v[32:39], v11
    v_mfma_f32_16x16x32_bf16 v[16:19], a[64:67], v[96:99], v[56:59]
    v_exp_f32 v28, v28
    v_mfma_f32_16x16x32_bf16 v[16:19], a[68:71], v[100:103], v[16:19]
    v_perm_b32 v45, v27, v26, s100
    v_mfma_f32_16x16x32_bf16 v[16:19], a[72:75], v[104:107], v[16:19]
    s_mov_b32 s54, 294912
    v_exp_f32 v29, v29
    v_mfma_f32_16x16x32_bf16 v[16:19], a[76:79], v[108:111], v[16:19]
    buffer_load_dwordx4 a[136:139], v6, s[68:71], s54 offen
    v_mfma_f32_16x16x32_bf16 v[20:23], a[80:83], v[96:99], v[56:59]
    v_exp_f32 v30, v30
    v_mfma_f32_16x16x32_bf16 v[20:23], a[84:87], v[100:103], v[20:23]
    v_perm_b32 v46, v29, v28, s100
    v_accvgpr_read_b32 v12, a0
    v_mfma_f32_16x16x32_bf16 v[20:23], a[88:91], v[104:107], v[20:23]
    s_add_u32 s54, s55, 2048
    v_exp_f32 v31, v31
    v_mfma_f32_16x16x32_bf16 v[20:23], a[92:95], v[108:111], v[20:23]
    buffer_load_dwordx4 a[172:175], v8, s[72:75], s54 offen
    v_mfma_f32_16x16x32_bf16 v[24:27], a[96:99], v[96:99], v[56:59]
    v_exp_f32 v16, v16
    v_mfma_f32_16x16x32_bf16 v[24:27], a[100:103], v[100:103], v[24:27]
    v_perm_b32 v47, v31, v30, s100
    v_accvgpr_read_b32 v13, a1
    v_mfma_f32_16x16x32_bf16 v[24:27], a[104:107], v[104:107], v[24:27]
    s_mov_b32 s54, 442368
    v_exp_f32 v17, v17
    v_mfma_f32_16x16x32_bf16 v[24:27], a[108:111], v[108:111], v[24:27]
    buffer_load_dwordx4 a[140:143], v6, s[68:71], s54 offen
    v_mfma_f32_16x16x32_bf16 v[28:31], a[112:115], v[96:99], v[56:59]
    v_exp_f32 v18, v18
    v_mfma_f32_16x16x32_bf16 v[28:31], a[116:119], v[100:103], v[28:31]
    v_perm_b32 v32, v17, v16, s100
    v_add_f32 v12, v12, v13
    v_mfma_f32_16x16x32_bf16 v[28:31], a[120:123], v[104:107], v[28:31]
    s_add_u32 s54, s55, 3072
    v_exp_f32 v19, v19
    v_mfma_f32_16x16x32_bf16 v[28:31], a[124:127], v[108:111], v[28:31]
    buffer_load_dwordx4 a[176:179], v8, s[72:75], s54 offen
    v_mfma_f32_16x16x32_bf16 v[160:163], a[192:195], v[40:43], v[160:163]
    v_exp_f32 v20, v20
    v_mfma_f32_16x16x32_bf16 v[160:163], a[196:199], v[44:47], v[160:163]
    v_perm_b32 v33, v19, v18, s100
    v_subrev_u32 v13, 0x1e000000, v12
    v_mfma_f32_16x16x32_bf16 v[164:167], a[200:203], v[40:43], v[164:167]
    s_mov_b32 s54, 589824
    v_exp_f32 v21, v21
    v_mfma_f32_16x16x32_bf16 v[164:167], a[204:207], v[44:47], v[164:167]
    buffer_load_dwordx4 a[144:147], v6, s[68:71], s54 offen
    v_mfma_f32_16x16x32_bf16 v[168:171], a[208:211], v[40:43], v[168:171]
    v_exp_f32 v22, v22
    v_mfma_f32_16x16x32_bf16 v[168:171], a[212:215], v[44:47], v[168:171]
    v_perm_b32 v34, v21, v20, s100
    v_cmp_gt_u32 s[56:57], v13, s15
    v_mfma_f32_16x16x32_bf16 v[172:175], a[216:219], v[40:43], v[172:175]
    s_add_u32 s54, s55, 4096
    v_exp_f32 v23, v23
    v_mfma_f32_16x16x32_bf16 v[172:175], a[220:223], v[44:47], v[172:175]
    buffer_load_dwordx4 a[180:183], v8, s[72:75], s54 offen
    v_mfma_f32_16x16x32_bf16 v[176:179], a[224:227], v[40:43], v[176:179]
    v_exp_f32 v24, v24
    v_mfma_f32_16x16x32_bf16 v[176:179], a[228:231], v[44:47], v[176:179]
    v_perm_b32 v35, v23, v22, s100
    v_mfma_f32_16x16x32_bf16 v[180:183], a[232:235], v[40:43], v[180:183]
    s_mov_b32 s54, 737280
    v_exp_f32 v25, v25
    v_mfma_f32_16x16x32_bf16 v[180:183], a[236:239], v[44:47], v[180:183]
    buffer_load_dwordx4 a[148:151], v6, s[68:71], s54 offen
    v_mfma_f32_16x16x32_bf16 v[184:187], a[240:243], v[40:43], v[184:187]
    v_exp_f32 v26, v26
    v_mfma_f32_16x16x32_bf16 v[184:187], a[244:247], v[44:47], v[184:187]
    v_perm_b32 v36, v25, v24, s100
    v_mfma_f32_16x16x32_bf16 v[188:191], a[248:251], v[40:43], v[188:191]
    s_add_u32 s54, s55, 5120
    v_exp_f32 v27, v27
    v_mfma_f32_16x16x32_bf16 v[188:191], a[252:255], v[44:47], v[188:191]
    buffer_load_dwordx4 a[184:187], v8, s[72:75], s54 offen
    v_smfmac_f32_16x16x64_bf16 a[4:7], a[16:19], v[40:47], v11
    v_rcp_f32 v12, v12
    v_mfma_f32_16x16x32_bf16 v[16:19], a[64:67], v[112:115], v[60:63]
    v_exp_f32 v28, v28
    v_mfma_f32_16x16x32_bf16 v[16:19], a[68:71], v[116:119], v[16:19]
    v_perm_b32 v37, v27, v26, s100
    v_mul_f32 v128, v128, v12
    v_mfma_f32_16x16x32_bf16 v[16:19], a[72:75], v[120:123], v[16:19]
    s_mov_b32 s54, 884736
    v_exp_f32 v29, v29
    v_mfma_f32_16x16x32_bf16 v[16:19], a[76:79], v[124:127], v[16:19]
    buffer_load_dwordx4 a[152:155], v6, s[68:71], s54 offen
    v_mfma_f32_16x16x32_bf16 v[20:23], a[80:83], v[112:115], v[60:63]
    v_exp_f32 v30, v30
    v_mfma_f32_16x16x32_bf16 v[20:23], a[84:87], v[116:119], v[20:23]
    v_perm_b32 v38, v29, v28, s100
    v_mul_f32 v129, v129, v12
    v_mfma_f32_16x16x32_bf16 v[20:23], a[88:91], v[120:123], v[20:23]
    s_add_u32 s54, s55, 6144
    v_exp_f32 v31, v31
    v_mfma_f32_16x16x32_bf16 v[20:23], a[92:95], v[124:127], v[20:23]
    buffer_load_dwordx4 a[188:191], v8, s[72:75], s54 offen
    v_mfma_f32_16x16x32_bf16 v[24:27], a[96:99], v[112:115], v[60:63]
    v_exp_f32 v16, v16
    v_mfma_f32_16x16x32_bf16 v[24:27], a[100:103], v[116:119], v[24:27]
    v_perm_b32 v39, v31, v30, s100
    v_mul_f32 v130, v130, v12
    v_mfma_f32_16x16x32_bf16 v[24:27], a[104:107], v[120:123], v[24:27]
    s_mov_b32 s54, 1032192
    v_exp_f32 v17, v17
    v_mfma_f32_16x16x32_bf16 v[24:27], a[108:111], v[124:127], v[24:27]
    buffer_load_dwordx4 a[156:159], v6, s[68:71], s54 offen
    v_mfma_f32_16x16x32_bf16 v[28:31], a[112:115], v[112:115], v[60:63]
    v_exp_f32 v18, v18
    v_mfma_f32_16x16x32_bf16 v[28:31], a[116:119], v[116:119], v[28:31]
    v_perm_b32 v40, v17, v16, s100
    v_mul_f32 v131, v131, v12
    v_mfma_f32_16x16x32_bf16 v[28:31], a[120:123], v[120:123], v[28:31]
    s_mov_b32 s54, 1179648
    v_exp_f32 v19, v19
    v_mfma_f32_16x16x32_bf16 v[28:31], a[124:127], v[124:127], v[28:31]
    buffer_load_dwordx4 a[160:163], v6, s[68:71], s54 offen
    v_mfma_f32_16x16x32_bf16 v[192:195], a[192:195], v[32:35], v[192:195]
    v_exp_f32 v20, v20
    v_mfma_f32_16x16x32_bf16 v[192:195], a[196:199], v[36:39], v[192:195]
    v_perm_b32 v41, v19, v18, s100
    v_mul_f32 v132, v132, v12
    v_mfma_f32_16x16x32_bf16 v[196:199], a[200:203], v[32:35], v[196:199]
    v_exp_f32 v21, v21
    v_mfma_f32_16x16x32_bf16 v[196:199], a[204:207], v[36:39], v[196:199]
    v_mul_f32 v133, v133, v12
    v_mul_f32 v134, v134, v12
    v_mfma_f32_16x16x32_bf16 v[200:203], a[208:211], v[32:35], v[200:203]
    v_exp_f32 v22, v22
    v_mfma_f32_16x16x32_bf16 v[200:203], a[212:215], v[36:39], v[200:203]
    v_perm_b32 v42, v21, v20, s100
    v_mul_f32 v135, v135, v12
    v_mfma_f32_16x16x32_bf16 v[204:207], a[216:219], v[32:35], v[204:207]
    v_exp_f32 v23, v23
    v_mfma_f32_16x16x32_bf16 v[204:207], a[220:223], v[36:39], v[204:207]
    v_cvt_pk_bf16_f32 v128, v128, v129
    v_cvt_pk_bf16_f32 v129, v130, v131
    v_mfma_f32_16x16x32_bf16 v[208:211], a[224:227], v[32:35], v[208:211]
    v_exp_f32 v24, v24
    v_mfma_f32_16x16x32_bf16 v[208:211], a[228:231], v[36:39], v[208:211]
    v_perm_b32 v43, v23, v22, s100
    v_cvt_pk_bf16_f32 v130, v132, v133
    v_mfma_f32_16x16x32_bf16 v[212:215], a[232:235], v[32:35], v[212:215]
    v_exp_f32 v25, v25
    v_mfma_f32_16x16x32_bf16 v[212:215], a[236:239], v[36:39], v[212:215]
    v_cvt_pk_bf16_f32 v131, v134, v135
    v_mul_f32 v136, v136, v12
    v_mfma_f32_16x16x32_bf16 v[216:219], a[240:243], v[32:35], v[216:219]
    v_exp_f32 v26, v26
    v_mfma_f32_16x16x32_bf16 v[216:219], a[244:247], v[36:39], v[216:219]
    v_perm_b32 v44, v25, v24, s100
    v_mul_f32 v137, v137, v12
    v_mfma_f32_16x16x32_bf16 v[220:223], a[248:251], v[32:35], v[220:223]
    v_exp_f32 v27, v27
    v_mfma_f32_16x16x32_bf16 v[220:223], a[252:255], v[36:39], v[220:223]
    v_mul_f32 v138, v138, v12
    v_mul_f32 v139, v139, v12
    v_smfmac_f32_16x16x64_bf16 a[8:11], a[16:19], v[32:39], v11
    v_mul_f32 v140, v140, v12
    v_mul_f32 v141, v141, v12
    v_exp_f32 v28, v28
    s_nop 0
    v_perm_b32 v45, v27, v26, s100
    v_exp_f32 v29, v29
    s_nop 0
    v_exp_f32 v30, v30
    s_nop 0
    v_perm_b32 v46, v29, v28, s100
    v_exp_f32 v31, v31
    s_nop 0
    v_perm_b32 v47, v31, v30, s100
    s_nop 1
    v_mfma_f32_16x16x32_bf16 v[224:227], a[192:195], v[40:43], v[224:227]
    v_mul_f32 v142, v142, v12
    v_mul_f32 v143, v143, v12
    v_mfma_f32_16x16x32_bf16 v[224:227], a[196:199], v[44:47], v[224:227]
    ds_read_b64_tr_b16 a[64:65], v4 offset:0
    ds_read_b64_tr_b16 a[66:67], v4 offset:128
    v_mfma_f32_16x16x32_bf16 v[228:231], a[200:203], v[40:43], v[228:231]
    ds_read_b64_tr_b16 a[68:69], v4 offset:256
    ds_read_b64_tr_b16 a[70:71], v4 offset:384
    v_mfma_f32_16x16x32_bf16 v[228:231], a[204:207], v[44:47], v[228:231]
    ds_read_b64_tr_b16 a[72:73], v4 offset:512
    ds_read_b64_tr_b16 a[74:75], v4 offset:640
    v_mfma_f32_16x16x32_bf16 v[232:235], a[208:211], v[40:43], v[232:235]
    ds_read_b64_tr_b16 a[76:77], v4 offset:768
    ds_read_b64_tr_b16 a[78:79], v4 offset:896
    v_mfma_f32_16x16x32_bf16 v[232:235], a[212:215], v[44:47], v[232:235]
    ds_read_b64_tr_b16 a[80:81], v4 offset:16896
    ds_read_b64_tr_b16 a[82:83], v4 offset:17024
    v_mfma_f32_16x16x32_bf16 v[236:239], a[216:219], v[40:43], v[236:239]
    ds_read_b64_tr_b16 a[84:85], v4 offset:17152
    ds_read_b64_tr_b16 a[86:87], v4 offset:17280
    v_mfma_f32_16x16x32_bf16 v[236:239], a[220:223], v[44:47], v[236:239]
    ds_read_b64_tr_b16 a[88:89], v4 offset:17408
    ds_read_b64_tr_b16 a[90:91], v4 offset:17536
    v_mfma_f32_16x16x32_bf16 v[240:243], a[224:227], v[40:43], v[240:243]
    ds_read_b64_tr_b16 a[92:93], v4 offset:17664
    ds_read_b64_tr_b16 a[94:95], v4 offset:17792
    v_mfma_f32_16x16x32_bf16 v[240:243], a[228:231], v[44:47], v[240:243]
    v_cvt_pk_bf16_f32 v136, v136, v137
    v_cvt_pk_bf16_f32 v137, v138, v139
    v_mfma_f32_16x16x32_bf16 v[244:247], a[232:235], v[40:43], v[244:247]
    v_cvt_pk_bf16_f32 v138, v140, v141
    v_cvt_pk_bf16_f32 v139, v142, v143
    v_mfma_f32_16x16x32_bf16 v[244:247], a[236:239], v[44:47], v[244:247]
    v_mul_f32 v144, v144, v12
    v_mul_f32 v145, v145, v12
    v_mfma_f32_16x16x32_bf16 v[248:251], a[240:243], v[40:43], v[248:251]
    v_mul_f32 v146, v146, v12
    v_mul_f32 v147, v147, v12
    v_mfma_f32_16x16x32_bf16 v[248:251], a[244:247], v[44:47], v[248:251]
    v_mul_f32 v148, v148, v12
    v_mul_f32 v149, v149, v12
    v_mfma_f32_16x16x32_bf16 v[252:255], a[248:251], v[40:43], v[252:255]
    v_mul_f32 v150, v150, v12
    v_mul_f32 v151, v151, v12
    v_mfma_f32_16x16x32_bf16 v[252:255], a[252:255], v[44:47], v[252:255]
    v_cvt_pk_bf16_f32 v144, v144, v145
    v_cvt_pk_bf16_f32 v145, v146, v147
    v_smfmac_f32_16x16x64_bf16 a[12:15], a[16:19], v[40:47], v11
    v_cvt_pk_bf16_f32 v146, v148, v149
    v_cvt_pk_bf16_f32 v147, v150, v151
    v_mul_f32 v152, v152, v12
    v_mul_f32 v153, v153, v12
    v_mul_f32 v154, v154, v12
    v_mul_f32 v155, v155, v12
    v_mul_f32 v156, v156, v12
    v_mul_f32 v157, v157, v12
    v_mul_f32 v158, v158, v12
    v_mul_f32 v159, v159, v12
    v_cvt_pk_bf16_f32 v152, v152, v153
    v_cvt_pk_bf16_f32 v153, v154, v155
    v_cvt_pk_bf16_f32 v154, v156, v157
    v_cvt_pk_bf16_f32 v155, v158, v159
    v_accvgpr_read_b32 v14, a4
    v_accvgpr_read_b32 v15, a5
    v_add_f32 v14, v14, v15
    v_subrev_u32 v15, 0x1e000000, v14
    v_cmp_gt_u32 s[58:59], v15, s15
    v_rcp_f32 v14, v14
    v_accvgpr_read_b32 v12, a8
    v_accvgpr_read_b32 v13, a9
    v_add_f32 v12, v12, v13
    v_subrev_u32 v13, 0x1e000000, v12
    v_cmp_gt_u32 s[60:61], v13, s15
    v_rcp_f32 v12, v12
    v_pk_mul_f32 v[160:161], v[160:161], v[14:15] op_sel_hi:[1,0]
    v_pk_mul_f32 v[162:163], v[162:163], v[14:15] op_sel_hi:[1,0]
    v_pk_mul_f32 v[164:165], v[164:165], v[14:15] op_sel_hi:[1,0]
    v_pk_mul_f32 v[166:167], v[166:167], v[14:15] op_sel_hi:[1,0]
    v_cvt_pk_bf16_f32 v160, v160, v161
    v_cvt_pk_bf16_f32 v161, v162, v163
    v_cvt_pk_bf16_f32 v162, v164, v165
    v_cvt_pk_bf16_f32 v163, v166, v167
    v_pk_mul_f32 v[168:169], v[168:169], v[14:15] op_sel_hi:[1,0]
    v_pk_mul_f32 v[170:171], v[170:171], v[14:15] op_sel_hi:[1,0]
    v_pk_mul_f32 v[172:173], v[172:173], v[14:15] op_sel_hi:[1,0]
    v_pk_mul_f32 v[174:175], v[174:175], v[14:15] op_sel_hi:[1,0]
    v_cvt_pk_bf16_f32 v168, v168, v169
    v_cvt_pk_bf16_f32 v169, v170, v171
    v_cvt_pk_bf16_f32 v170, v172, v173
    v_cvt_pk_bf16_f32 v171, v174, v175
    v_pk_mul_f32 v[176:177], v[176:177], v[14:15] op_sel_hi:[1,0]
    v_pk_mul_f32 v[178:179], v[178:179], v[14:15] op_sel_hi:[1,0]
    v_pk_mul_f32 v[180:181], v[180:181], v[14:15] op_sel_hi:[1,0]
    v_pk_mul_f32 v[182:183], v[182:183], v[14:15] op_sel_hi:[1,0]
    v_cvt_pk_bf16_f32 v176, v176, v177
    v_cvt_pk_bf16_f32 v177, v178, v179
    v_cvt_pk_bf16_f32 v178, v180, v181
    v_cvt_pk_bf16_f32 v179, v182, v183
    v_pk_mul_f32 v[184:185], v[184:185], v[14:15] op_sel_hi:[1,0]
    v_pk_mul_f32 v[186:187], v[186:187], v[14:15] op_sel_hi:[1,0]
    v_pk_mul_f32 v[188:189], v[188:189], v[14:15] op_sel_hi:[1,0]
    v_pk_mul_f32 v[190:191], v[190:191], v[14:15] op_sel_hi:[1,0]
    v_cvt_pk_bf16_f32 v184, v184, v185
    v_cvt_pk_bf16_f32 v185, v186, v187
    v_cvt_pk_bf16_f32 v186, v188, v189
    v_cvt_pk_bf16_f32 v187, v190, v191
    v_accvgpr_read_b32 v14, a12
    v_accvgpr_read_b32 v15, a13
    v_add_f32 v14, v14, v15
    v_subrev_u32 v15, 0x1e000000, v14
    v_cmp_gt_u32 s[62:63], v15, s15
    s_or_b64 s[56:57], s[56:57], s[58:59]
    v_rcp_f32 v14, v14
    s_or_b64 s[60:61], s[60:61], s[62:63]
    s_or_b64 s[56:57], s[56:57], s[60:61]
    s_lshl2_add_u32 s14, s51, 13824
    v_mov_b32 v57, s14
    v_mov_b32 v58, 13824
    v_pk_mul_f32 v[192:193], v[192:193], v[12:13] op_sel_hi:[1,0]
    v_pk_mul_f32 v[194:195], v[194:195], v[12:13] op_sel_hi:[1,0]
    v_pk_mul_f32 v[196:197], v[196:197], v[12:13] op_sel_hi:[1,0]
    v_pk_mul_f32 v[198:199], v[198:199], v[12:13] op_sel_hi:[1,0]
    v_cvt_pk_bf16_f32 v192, v192, v193
    v_cvt_pk_bf16_f32 v193, v194, v195
    v_cvt_pk_bf16_f32 v194, v196, v197
    v_cvt_pk_bf16_f32 v195, v198, v199
    v_pk_mul_f32 v[200:201], v[200:201], v[12:13] op_sel_hi:[1,0]
    v_pk_mul_f32 v[202:203], v[202:203], v[12:13] op_sel_hi:[1,0]
    v_pk_mul_f32 v[204:205], v[204:205], v[12:13] op_sel_hi:[1,0]
    v_pk_mul_f32 v[206:207], v[206:207], v[12:13] op_sel_hi:[1,0]
    v_cvt_pk_bf16_f32 v200, v200, v201
    v_cvt_pk_bf16_f32 v201, v202, v203
    v_cvt_pk_bf16_f32 v202, v204, v205
    v_cvt_pk_bf16_f32 v203, v206, v207
    v_pk_mul_f32 v[208:209], v[208:209], v[12:13] op_sel_hi:[1,0]
    v_pk_mul_f32 v[210:211], v[210:211], v[12:13] op_sel_hi:[1,0]
    v_pk_mul_f32 v[212:213], v[212:213], v[12:13] op_sel_hi:[1,0]
    v_pk_mul_f32 v[214:215], v[214:215], v[12:13] op_sel_hi:[1,0]
    v_cvt_pk_bf16_f32 v208, v208, v209
    v_cvt_pk_bf16_f32 v209, v210, v211
    v_cvt_pk_bf16_f32 v210, v212, v213
    v_cvt_pk_bf16_f32 v211, v214, v215
    v_pk_mul_f32 v[216:217], v[216:217], v[12:13] op_sel_hi:[1,0]
    v_pk_mul_f32 v[218:219], v[218:219], v[12:13] op_sel_hi:[1,0]
    v_pk_mul_f32 v[220:221], v[220:221], v[12:13] op_sel_hi:[1,0]
    v_pk_mul_f32 v[222:223], v[222:223], v[12:13] op_sel_hi:[1,0]
    v_cvt_pk_bf16_f32 v216, v216, v217
    v_cvt_pk_bf16_f32 v217, v218, v219
    v_cvt_pk_bf16_f32 v218, v220, v221
    v_cvt_pk_bf16_f32 v219, v222, v223
    v_pk_mul_f32 v[224:225], v[224:225], v[14:15] op_sel_hi:[1,0]
    v_pk_mul_f32 v[226:227], v[226:227], v[14:15] op_sel_hi:[1,0]
    v_pk_mul_f32 v[228:229], v[228:229], v[14:15] op_sel_hi:[1,0]
    v_pk_mul_f32 v[230:231], v[230:231], v[14:15] op_sel_hi:[1,0]
    v_cvt_pk_bf16_f32 v224, v224, v225
    v_cvt_pk_bf16_f32 v225, v226, v227
    v_cvt_pk_bf16_f32 v226, v228, v229
    v_cvt_pk_bf16_f32 v227, v230, v231
    v_pk_mul_f32 v[232:233], v[232:233], v[14:15] op_sel_hi:[1,0]
    v_pk_mul_f32 v[234:235], v[234:235], v[14:15] op_sel_hi:[1,0]
    v_pk_mul_f32 v[236:237], v[236:237], v[14:15] op_sel_hi:[1,0]
    v_pk_mul_f32 v[238:239], v[238:239], v[14:15] op_sel_hi:[1,0]
    v_cvt_pk_bf16_f32 v232, v232, v233
    v_cvt_pk_bf16_f32 v233, v234, v235
L2_pad10:
    s_cbranch_execz L2_pad14
    v_cvt_pk_bf16_f32 v234, v236, v237
    v_cvt_pk_bf16_f32 v235, v238, v239
    v_pk_mul_f32 v[240:241], v[240:241], v[14:15] op_sel_hi:[1,0]
    v_pk_mul_f32 v[242:243], v[242:243], v[14:15] op_sel_hi:[1,0]
    v_pk_mul_f32 v[244:245], v[244:245], v[14:15] op_sel_hi:[1,0]
    v_pk_mul_f32 v[246:247], v[246:247], v[14:15] op_sel_hi:[1,0]
    v_cvt_pk_bf16_f32 v240, v240, v241
    v_cvt_pk_bf16_f32 v241, v242, v243
    v_cvt_pk_bf16_f32 v242, v244, v245
    v_cvt_pk_bf16_f32 v243, v246, v247
    v_pk_mul_f32 v[248:249], v[248:249], v[14:15] op_sel_hi:[1,0]
    v_pk_mul_f32 v[250:251], v[250:251], v[14:15] op_sel_hi:[1,0]
    v_pk_mul_f32 v[252:253], v[252:253], v[14:15] op_sel_hi:[1,0]
    v_pk_mul_f32 v[254:255], v[254:255], v[14:15] op_sel_hi:[1,0]
    v_cvt_pk_bf16_f32 v248, v248, v249
    v_cvt_pk_bf16_f32 v249, v250, v251
    v_cvt_pk_bf16_f32 v250, v252, v253
    v_cvt_pk_bf16_f32 v251, v254, v255
    s_waitcnt lgkmcnt(12)
    v_mfma_f32_16x16x32_bf16 v[16:19], a[64:67], v[128:131], 0
    ds_read_b64_tr_b16 a[96:97], v4 offset:32
    ds_read_b64_tr_b16 a[98:99], v4 offset:160
    v_mfma_f32_16x16x32_bf16 v[16:19], a[68:71], v[136:139], v[16:19]
    s_waitcnt lgkmcnt(10)
    ds_read_b64_tr_b16 a[100:101], v4 offset:288
    ds_read_b64_tr_b16 a[102:103], v4 offset:416
    v_mfma_f32_16x16x32_bf16 v[16:19], a[72:75], v[144:147], v[16:19]
    s_add_u32 s54, s55, 7168
    s_cmp_lg_u64 s[56:57], 0
    s_cselect_b32 s3, 1, 0
    ds_read_b64_tr_b16 a[104:105], v4 offset:544
    v_mfma_f32_16x16x32_bf16 v[16:19], a[76:79], v[152:155], v[16:19]
    s_waitcnt lgkmcnt(9)
    buffer_load_dwordx4 a[192:195], v8, s[72:75], s54 offen
    v_mfma_f32_16x16x32_bf16 v[16:19], a[80:83], v[192:195], v[16:19]
    s_andn2_b32 s3, s3, s50
    ds_read_b64_tr_b16 a[106:107], v4 offset:672
    v_mfma_f32_16x16x32_bf16 v[16:19], a[84:87], v[200:203], v[16:19]
    s_waitcnt lgkmcnt(6)
    ds_read_b64_tr_b16 a[108:109], v4 offset:800
    v_mfma_f32_16x16x32_bf16 v[16:19], a[88:91], v[208:211], v[16:19]
    s_add_u32 s54, s55, 8192
    ds_read_b64_tr_b16 a[110:111], v4 offset:928
    v_mfma_f32_16x16x32_bf16 v[16:19], a[92:95], v[216:219], v[16:19]
    buffer_load_dwordx4 a[196:199], v8, s[72:75], s54 offen
    v_mfma_f32_16x16x32_bf16 v[20:23], a[64:67], v[160:163], 0
    ds_read_b64_tr_b16 a[112:113], v4 offset:16928
    v_mfma_f32_16x16x32_bf16 v[20:23], a[68:71], v[168:171], v[20:23]
    ds_read_b64_tr_b16 a[114:115], v4 offset:17056
    v_mov_b32 v56, s3
    v_mfma_f32_16x16x32_bf16 v[20:23], a[72:75], v[176:179], v[20:23]
    ds_read_b64_tr_b16 a[116:117], v4 offset:17184
    v_mfma_f32_16x16x32_bf16 v[20:23], a[76:79], v[184:187], v[20:23]
    ds_read_b64_tr_b16 a[118:119], v4 offset:17312
    v_mfma_f32_16x16x32_bf16 v[20:23], a[80:83], v[224:227], v[20:23]
    ds_read_b64_tr_b16 a[120:121], v4 offset:17440
    v_mfma_f32_16x16x32_bf16 v[20:23], a[84:87], v[232:235], v[20:23]
    ds_read_b64_tr_b16 a[122:123], v4 offset:17568
    v_mfma_f32_16x16x32_bf16 v[20:23], a[88:91], v[240:243], v[20:23]
    ds_read_b64_tr_b16 a[124:125], v4 offset:17696
    v_mfma_f32_16x16x32_bf16 v[20:23], a[92:95], v[248:251], v[20:23]
    s_waitcnt lgkmcnt(11)
    ds_read_b64_tr_b16 a[126:127], v4 offset:17824
    ds_write_b32 v57, v56
    v_mfma_f32_16x16x32_bf16 v[24:27], a[96:99], v[128:131], 0
    ds_read_b64_tr_b16 a[64:65], v4 offset:64
    v_mfma_f32_16x16x32_bf16 v[24:27], a[100:103], v[136:139], v[24:27]
    s_waitcnt lgkmcnt(10)
    ds_read_b64_tr_b16 a[66:67], v4 offset:192
    v_mfma_f32_16x16x32_bf16 v[24:27], a[104:107], v[144:147], v[24:27]
    ds_read_b64_tr_b16 a[68:69], v4 offset:320
    v_mfma_f32_16x16x32_bf16 v[24:27], a[108:111], v[152:155], v[24:27]
    s_waitcnt lgkmcnt(8)
    ds_read_b64_tr_b16 a[70:71], v4 offset:448
    v_mfma_f32_16x16x32_bf16 v[24:27], a[112:115], v[192:195], v[24:27]
    ds_read_b64_tr_b16 a[72:73], v4 offset:576
    v_mfma_f32_16x16x32_bf16 v[24:27], a[116:119], v[200:203], v[24:27]
    s_waitcnt lgkmcnt(6)
    ds_read_b64_tr_b16 a[74:75], v4 offset:704
    v_mfma_f32_16x16x32_bf16 v[24:27], a[120:123], v[208:211], v[24:27]
    ds_read_b64_tr_b16 a[76:77], v4 offset:832
    v_mfma_f32_16x16x32_bf16 v[24:27], a[124:127], v[216:219], v[24:27]
    ds_read_b64_tr_b16 a[78:79], v4 offset:960
    v_mfma_f32_16x16x32_bf16 v[28:31], a[96:99], v[160:163], 0
    ds_read_b64_tr_b16 a[80:81], v4 offset:16960
    v_mfma_f32_16x16x32_bf16 v[28:31], a[100:103], v[168:171], v[28:31]
    ds_read_b64_tr_b16 a[82:83], v4 offset:17088
    v_mfma_f32_16x16x32_bf16 v[28:31], a[104:107], v[176:179], v[28:31]
    ds_read_b64_tr_b16 a[84:85], v4 offset:17216
    v_mfma_f32_16x16x32_bf16 v[28:31], a[108:111], v[184:187], v[28:31]
    ds_read_b64_tr_b16 a[86:87], v4 offset:17344
    v_mfma_f32_16x16x32_bf16 v[28:31], a[112:115], v[224:227], v[28:31]
    ds_read_b64_tr_b16 a[88:89], v4 offset:17472
    v_mfma_f32_16x16x32_bf16 v[28:31], a[116:119], v[232:235], v[28:31]
    ds_read_b64_tr_b16 a[90:91], v4 offset:17600
    v_mfma_f32_16x16x32_bf16 v[28:31], a[120:123], v[240:243], v[28:31]
    ds_read_b64_tr_b16 a[92:93], v4 offset:17728
    v_mfma_f32_16x16x32_bf16 v[28:31], a[124:127], v[248:251], v[28:31]
    s_waitcnt lgkmcnt(11)
    ds_read_b64_tr_b16 a[94:95], v4 offset:17856
    v_mfma_f32_16x16x32_bf16 v[32:35], a[64:67], v[128:131], 0
    ds_read_b64_tr_b16 a[96:97], v4 offset:96
    v_cvt_pk_bf16_f32 v48, v16, v17
    v_mfma_f32_16x16x32_bf16 v[32:35], a[68:71], v[136:139], v[32:35]
    s_waitcnt lgkmcnt(9)
    ds_read_b64_tr_b16 a[98:99], v4 offset:224
    v_cvt_pk_bf16_f32 v49, v18, v19
    v_mfma_f32_16x16x32_bf16 v[32:35], a[72:75], v[144:147], v[32:35]
    ds_read_b64_tr_b16 a[100:101], v4 offset:352
    v_cvt_pk_bf16_f32 v50, v24, v25
    v_mfma_f32_16x16x32_bf16 v[32:35], a[76:79], v[152:155], v[32:35]
    s_waitcnt lgkmcnt(7)
    ds_read_b64_tr_b16 a[102:103], v4 offset:480
    v_cvt_pk_bf16_f32 v51, v26, v27
    v_mfma_f32_16x16x32_bf16 v[32:35], a[80:83], v[192:195], v[32:35]
    s_mov_b32 s54, 0
    ds_read_b64_tr_b16 a[104:105], v4 offset:608
    ds_read_b64_tr_b16 a[106:107], v4 offset:736
    v_mfma_f32_16x16x32_bf16 v[32:35], a[84:87], v[200:203], v[32:35]
    s_waitcnt lgkmcnt(6)
    v_permlane32_swap_b32 v48, v50
    v_mfma_f32_16x16x32_bf16 v[32:35], a[88:91], v[208:211], v[32:35]
    v_permlane32_swap_b32 v49, v51
    v_mfma_f32_16x16x32_bf16 v[32:35], a[92:95], v[216:219], v[32:35]
    ds_read_b64_tr_b16 a[108:109], v4 offset:864
    ds_read_b64_tr_b16 a[110:111], v4 offset:992
    buffer_store_dwordx4 v[48:51], v10, s[40:43], s54 offen offset:0 sc1
    v_mfma_f32_16x16x32_bf16 v[36:39], a[64:67], v[160:163], 0
    ds_read_b64_tr_b16 a[112:113], v4 offset:16992
    v_cvt_pk_bf16_f32 v52, v20, v21
    v_mfma_f32_16x16x32_bf16 v[36:39], a[68:71], v[168:171], v[36:39]
    ds_read_b64_tr_b16 a[114:115], v4 offset:17120
    v_cvt_pk_bf16_f32 v53, v22, v23
    v_mfma_f32_16x16x32_bf16 v[36:39], a[72:75], v[176:179], v[36:39]
    ds_read_b64_tr_b16 a[116:117], v4 offset:17248
    v_cvt_pk_bf16_f32 v54, v28, v29
    v_mfma_f32_16x16x32_bf16 v[36:39], a[76:79], v[184:187], v[36:39]
    ds_read_b64_tr_b16 a[118:119], v4 offset:17376
    v_cvt_pk_bf16_f32 v55, v30, v31
    v_mfma_f32_16x16x32_bf16 v[36:39], a[80:83], v[224:227], v[36:39]
    s_mov_b32 s54, 294912
    ds_read_b64_tr_b16 a[120:121], v4 offset:17504
    ds_read_b64_tr_b16 a[122:123], v4 offset:17632
    v_mfma_f32_16x16x32_bf16 v[36:39], a[84:87], v[232:235], v[36:39]
    v_permlane32_swap_b32 v52, v54
    v_mfma_f32_16x16x32_bf16 v[36:39], a[88:91], v[240:243], v[36:39]
    v_permlane32_swap_b32 v53, v55
    v_mfma_f32_16x16x32_bf16 v[36:39], a[92:95], v[248:251], v[36:39]
    s_barrier
    s_waitcnt lgkmcnt(10)
    ds_read_b64_tr_b16 a[124:125], v4 offset:17760
    ds_read_b64_tr_b16 a[126:127], v4 offset:17888
    ds_read_b128 v[60:63], v58
    buffer_store_dwordx4 v[52:55], v10, s[40:43], s54 offen offset:0 sc1
    v_mfma_f32_16x16x32_bf16 v[40:43], a[96:99], v[128:131], 0
    s_add_u32 m0, s44, 36864
    ds_read_b64_tr_b16 a[64:65], v4 offset:36864
    ds_read_b64_tr_b16 a[66:67], v4 offset:36992
    v_mfma_f32_16x16x32_bf16 v[40:43], a[100:103], v[136:139], v[40:43]
    s_mov_b32 s45, 384
    s_waitcnt lgkmcnt(11)
    buffer_load_dwordx4 v7, s[28:31], s45 offen offset:0 lds
    v_mfma_f32_16x16x32_bf16 v[40:43], a[104:107], v[144:147], v[40:43]
    s_add_u32 m0, s44, 36768
    ds_read_b64_tr_b16 a[68:69], v4 offset:37120
    ds_read_b64_tr_b16 a[70:71], v4 offset:37248
    v_mfma_f32_16x16x32_bf16 v[40:43], a[108:111], v[152:155], v[40:43]
    s_waitcnt lgkmcnt(9)
    buffer_load_dwordx4 v7, s[28:31], s45 offen offset:1152 lds
    v_mfma_f32_16x16x32_bf16 v[40:43], a[112:115], v[192:195], v[40:43]
    s_add_u32 m0, s44, 36672
    ds_read_b64_tr_b16 a[72:73], v4 offset:37376
    ds_read_b64_tr_b16 a[74:75], v4 offset:37504
    v_mfma_f32_16x16x32_bf16 v[40:43], a[116:119], v[200:203], v[40:43]
    s_waitcnt lgkmcnt(7)
    buffer_load_dwordx4 v7, s[28:31], s45 offen offset:2304 lds
    v_mfma_f32_16x16x32_bf16 v[40:43], a[120:123], v[208:211], v[40:43]
    s_add_u32 m0, s44, 36576
    ds_read_b64_tr_b16 a[76:77], v4 offset:37632
    ds_read_b64_tr_b16 a[78:79], v4 offset:37760
    v_mfma_f32_16x16x32_bf16 v[40:43], a[124:127], v[216:219], v[40:43]
    s_waitcnt lgkmcnt(8)
    buffer_load_dwordx4 v7, s[28:31], s45 offen offset:3456 lds
    v_or3_b32 v60, v60, v61, v62
    v_or_b32 v60, v60, v63
    v_mfma_f32_16x16x32_bf16 v[44:47], a[96:99], v[160:163], 0
    s_add_u32 m0, s44, 53760
    ds_read_b64_tr_b16 a[80:81], v4 offset:53760
    ds_read_b64_tr_b16 a[82:83], v4 offset:53888
    v_mfma_f32_16x16x32_bf16 v[44:47], a[100:103], v[168:171], v[44:47]
    s_mov_b32 s45, 147840
    buffer_load_dwordx4 v7, s[28:31], s45 offen offset:0 lds
    v_mfma_f32_16x16x32_bf16 v[44:47], a[104:107], v[176:179], v[44:47]
    s_add_u32 m0, s44, 53664
    ds_read_b64_tr_b16 a[84:85], v4 offset:54016
    ds_read_b64_tr_b16 a[86:87], v4 offset:54144
    v_mfma_f32_16x16x32_bf16 v[44:47], a[108:111], v[184:187], v[44:47]
    buffer_load_dwordx4 v7, s[28:31], s45 offen offset:1152 lds
    v_mfma_f32_16x16x32_bf16 v[44:47], a[112:115], v[224:227], v[44:47]
    s_add_u32 m0, s44, 53568
    ds_read_b64_tr_b16 a[88:89], v4 offset:54272
    ds_read_b64_tr_b16 a[90:91], v4 offset:54400
    v_mfma_f32_16x16x32_bf16 v[44:47], a[116:119], v[232:235], v[44:47]
    buffer_load_dwordx4 v7, s[28:31], s45 offen offset:2304 lds
    v_mfma_f32_16x16x32_bf16 v[44:47], a[120:123], v[240:243], v[44:47]
    s_add_u32 m0, s44, 53472
    ds_read_b64_tr_b16 a[92:93], v4 offset:54528
    ds_read_b64_tr_b16 a[94:95], v4 offset:54656
    v_mfma_f32_16x16x32_bf16 v[44:47], a[124:127], v[248:251], v[44:47]
    s_waitcnt lgkmcnt(12)
    buffer_load_dwordx4 v7, s[28:31], s45 offen offset:3456 lds
    v_readfirstlane_b32 s3, v60
    v_mfma_f32_16x16x32_bf16 v[16:19], a[64:67], v[128:131], 0
    ds_read_b64_tr_b16 a[96:97], v4 offset:36896
    v_cvt_pk_bf16_f32 v48, v32, v33
    v_mfma_f32_16x16x32_bf16 v[16:19], a[68:71], v[136:139], v[16:19]
    s_waitcnt lgkmcnt(9)
    s_cmp_lg_u32 s3, 0
    ds_read_b64_tr_b16 a[98:99], v4 offset:37024
    v_cvt_pk_bf16_f32 v49, v34, v35
    v_mfma_f32_16x16x32_bf16 v[16:19], a[72:75], v[144:147], v[16:19]
    s_cbranch_scc1 L2_fallback
    ds_read_b64_tr_b16 a[100:101], v4 offset:37152
    v_cvt_pk_bf16_f32 v50, v40, v41
    v_mfma_f32_16x16x32_bf16 v[16:19], a[76:79], v[152:155], v[16:19]
    s_waitcnt lgkmcnt(7)
    ds_read_b64_tr_b16 a[102:103], v4 offset:37280
    v_cvt_pk_bf16_f32 v51, v42, v43
    v_mfma_f32_16x16x32_bf16 v[16:19], a[80:83], v[192:195], v[16:19]
    s_mov_b32 s54, 0
    ds_read_b64_tr_b16 a[104:105], v4 offset:37408
    ds_read_b64_tr_b16 a[106:107], v4 offset:37536
    v_mfma_f32_16x16x32_bf16 v[16:19], a[84:87], v[200:203], v[16:19]
    s_waitcnt lgkmcnt(6)
    v_permlane32_swap_b32 v48, v50
    v_mfma_f32_16x16x32_bf16 v[16:19], a[88:91], v[208:211], v[16:19]
    v_permlane32_swap_b32 v49, v51
    v_mfma_f32_16x16x32_bf16 v[16:19], a[92:95], v[216:219], v[16:19]
    ds_read_b64_tr_b16 a[108:109], v4 offset:37664
    ds_read_b64_tr_b16 a[110:111], v4 offset:37792
    buffer_store_dwordx4 v[48:51], v10, s[40:43], s54 offen offset:512 sc1
    v_mfma_f32_16x16x32_bf16 v[20:23], a[64:67], v[160:163], 0
    ds_read_b64_tr_b16 a[112:113], v4 offset:53792
    v_cvt_pk_bf16_f32 v52, v36, v37
    v_mfma_f32_16x16x32_bf16 v[20:23], a[68:71], v[168:171], v[20:23]
    ds_read_b64_tr_b16 a[114:115], v4 offset:53920
    v_cvt_pk_bf16_f32 v53, v38, v39
    v_mfma_f32_16x16x32_bf16 v[20:23], a[72:75], v[176:179], v[20:23]
    ds_read_b64_tr_b16 a[116:117], v4 offset:54048
    v_cvt_pk_bf16_f32 v54, v44, v45
    v_mfma_f32_16x16x32_bf16 v[20:23], a[76:79], v[184:187], v[20:23]
    ds_read_b64_tr_b16 a[118:119], v4 offset:54176
    v_cvt_pk_bf16_f32 v55, v46, v47
    v_mfma_f32_16x16x32_bf16 v[20:23], a[80:83], v[224:227], v[20:23]
    s_mov_b32 s54, 294912
    ds_read_b64_tr_b16 a[120:121], v4 offset:54304
    ds_read_b64_tr_b16 a[122:123], v4 offset:54432
    v_mfma_f32_16x16x32_bf16 v[20:23], a[84:87], v[232:235], v[20:23]
    v_permlane32_swap_b32 v52, v54
    v_mfma_f32_16x16x32_bf16 v[20:23], a[88:91], v[240:243], v[20:23]
    v_permlane32_swap_b32 v53, v55
    v_mfma_f32_16x16x32_bf16 v[20:23], a[92:95], v[248:251], v[20:23]
    s_waitcnt lgkmcnt(10)
    ds_read_b64_tr_b16 a[124:125], v4 offset:54560
    ds_read_b64_tr_b16 a[126:127], v4 offset:54688
    buffer_store_dwordx4 v[52:55], v10, s[40:43], s54 offen offset:512 sc1
    v_mfma_f32_16x16x32_bf16 v[24:27], a[96:99], v[128:131], 0
    s_mul_i32 s3, s51, 128
    ds_read_b64_tr_b16 a[64:65], v4 offset:36928
    v_lshrrev_b32 v14, 3, v0
    v_mfma_f32_16x16x32_bf16 v[24:27], a[100:103], v[136:139], v[24:27]
    s_waitcnt lgkmcnt(9)
    ds_read_b64_tr_b16 a[66:67], v4 offset:37056
    v_lshl_add_u32 v12, v14, 4, s3
    v_mfma_f32_16x16x32_bf16 v[24:27], a[104:107], v[144:147], v[24:27]
    ds_read_b64_tr_b16 a[68:69], v4 offset:37184
    v_and_b32 v14, 1, v14
    v_mfma_f32_16x16x32_bf16 v[24:27], a[108:111], v[152:155], v[24:27]
    s_waitcnt lgkmcnt(7)
    s_mul_i32 s3, s51, 32
    ds_read_b64_tr_b16 a[70:71], v4 offset:37312
    v_lshl_add_u32 v13, v14, 4, s3
    v_mfma_f32_16x16x32_bf16 v[24:27], a[112:115], v[192:195], v[24:27]
    ds_read_b64_tr_b16 a[72:73], v4 offset:37440
    v_and_b32 v14, 7, v0
    v_mfma_f32_16x16x32_bf16 v[24:27], a[116:119], v[200:203], v[24:27]
    s_waitcnt lgkmcnt(5)
    ds_read_b64_tr_b16 a[74:75], v4 offset:37568
    v_mul_u32_u24 v14, 1152, v14
    v_mfma_f32_16x16x32_bf16 v[24:27], a[120:123], v[208:211], v[24:27]
    ds_read_b64_tr_b16 a[76:77], v4 offset:37696
    v_add_u32 v1, v14, v12
    v_mfma_f32_16x16x32_bf16 v[24:27], a[124:127], v[216:219], v[24:27]
    ds_read_b64_tr_b16 a[78:79], v4 offset:37824
    v_add_u32 v2, v14, v13
    v_mfma_f32_16x16x32_bf16 v[28:31], a[96:99], v[160:163], 0
    ds_read_b64_tr_b16 a[80:81], v4 offset:53824
    v_add_u32 v2, 1024, v2
    v_mfma_f32_16x16x32_bf16 v[28:31], a[100:103], v[168:171], v[28:31]
    s_lshl_b32 s14, s51, 10
    ds_read_b64_tr_b16 a[82:83], v4 offset:53952
    v_add_u32 v5, s14, v8
    v_mfma_f32_16x16x32_bf16 v[28:31], a[104:107], v[176:179], v[28:31]
    ds_read_b64_tr_b16 a[84:85], v4 offset:54080
    v_and_b32 v59, 0xf0, v8
    v_mfma_f32_16x16x32_bf16 v[28:31], a[108:111], v[184:187], v[28:31]
    s_lshl_b32 s14, s51, 8
    ds_read_b64_tr_b16 a[86:87], v4 offset:54208
    v_add_u32 v59, s14, v59
    v_mfma_f32_16x16x32_bf16 v[28:31], a[112:115], v[224:227], v[28:31]
    ds_read_b64_tr_b16 a[88:89], v4 offset:54336
    v_and_b32 v6, 15, v0
    v_mfma_f32_16x16x32_bf16 v[28:31], a[116:119], v[232:235], v[28:31]
    ds_read_b64_tr_b16 a[90:91], v4 offset:54464
    v_lshlrev_b32 v6, 8, v6
    v_mfma_f32_16x16x32_bf16 v[28:31], a[120:123], v[240:243], v[28:31]
    ds_read_b64_tr_b16 a[92:93], v4 offset:54592
    v_min_u32 v15, 1, v0
    v_mfma_f32_16x16x32_bf16 v[28:31], a[124:127], v[248:251], v[28:31]
    s_waitcnt lgkmcnt(11)
    ds_read_b64_tr_b16 a[94:95], v4 offset:54720
    v_lshlrev_b32 v15, 30, v15
    v_mfma_f32_16x16x32_bf16 v[32:35], a[64:67], v[128:131], 0
    s_lshl_b32 s15, s53, 14
    s_add_u32 s15, s15, 786432
    s_and_b32 s14, s52, 12
    s_lshl_b32 s14, s14, 10
    s_add_u32 s47, s15, s14
    s_lshl4_add_u32 s3, s51, s52
    s_lshl_b32 s3, s3, 8
    s_add_u32 s56, s3, s15
    s_add_u32 s14, s55, 16384
    ds_read_b64_tr_b16 a[96:97], v4 offset:36960
    v_cvt_pk_bf16_f32 v48, v16, v17
    v_mfma_f32_16x16x32_bf16 v[32:35], a[68:71], v[136:139], v[32:35]
    s_waitcnt lgkmcnt(9)
    ds_read_b64_tr_b16 a[98:99], v4 offset:37088
    v_cvt_pk_bf16_f32 v49, v18, v19
    v_mfma_f32_16x16x32_bf16 v[32:35], a[72:75], v[144:147], v[32:35]
    ds_read_b64_tr_b16 a[100:101], v4 offset:37216
    v_cvt_pk_bf16_f32 v50, v24, v25
    v_mfma_f32_16x16x32_bf16 v[32:35], a[76:79], v[152:155], v[32:35]
    s_waitcnt lgkmcnt(7)
    ds_read_b64_tr_b16 a[102:103], v4 offset:37344
    v_cvt_pk_bf16_f32 v51, v26, v27
    v_mfma_f32_16x16x32_bf16 v[32:35], a[80:83], v[192:195], v[32:35]
    s_mov_b32 s54, 1024
    ds_read_b64_tr_b16 a[104:105], v4 offset:37472
    ds_read_b64_tr_b16 a[106:107], v4 offset:37600
    v_mfma_f32_16x16x32_bf16 v[32:35], a[84:87], v[200:203], v[32:35]
    s_waitcnt lgkmcnt(6)
    v_permlane32_swap_b32 v48, v50
    v_mfma_f32_16x16x32_bf16 v[32:35], a[88:91], v[208:211], v[32:35]
    v_permlane32_swap_b32 v49, v51
    v_mfma_f32_16x16x32_bf16 v[32:35], a[92:95], v[216:219], v[32:35]
    ds_read_b64_tr_b16 a[108:109], v4 offset:37728
    ds_read_b64_tr_b16 a[110:111], v4 offset:37856
    buffer_store_dwordx4 v[48:51], v10, s[40:43], s54 offen offset:0 sc1
    v_mfma_f32_16x16x32_bf16 v[36:39], a[64:67], v[160:163], 0
    ds_read_b64_tr_b16 a[112:113], v4 offset:53856
    v_cvt_pk_bf16_f32 v52, v20, v21
    v_mfma_f32_16x16x32_bf16 v[36:39], a[68:71], v[168:171], v[36:39]
    ds_read_b64_tr_b16 a[114:115], v4 offset:53984
    v_cvt_pk_bf16_f32 v53, v22, v23
    v_mfma_f32_16x16x32_bf16 v[36:39], a[72:75], v[176:179], v[36:39]
    ds_read_b64_tr_b16 a[116:117], v4 offset:54112
    v_cvt_pk_bf16_f32 v54, v28, v29
    v_mfma_f32_16x16x32_bf16 v[36:39], a[76:79], v[184:187], v[36:39]
    ds_read_b64_tr_b16 a[118:119], v4 offset:54240
    v_cvt_pk_bf16_f32 v55, v30, v31
    v_mfma_f32_16x16x32_bf16 v[36:39], a[80:83], v[224:227], v[36:39]
    s_mov_b32 s54, 295936
    ds_read_b64_tr_b16 a[120:121], v4 offset:54368
    ds_read_b64_tr_b16 a[122:123], v4 offset:54496
    v_mfma_f32_16x16x32_bf16 v[36:39], a[84:87], v[232:235], v[36:39]
    v_permlane32_swap_b32 v52, v54
    v_mfma_f32_16x16x32_bf16 v[36:39], a[88:91], v[240:243], v[36:39]
    v_permlane32_swap_b32 v53, v55
    v_mfma_f32_16x16x32_bf16 v[36:39], a[92:95], v[248:251], v[36:39]
    s_waitcnt vmcnt(31)
    s_barrier
    s_waitcnt lgkmcnt(10)
    ds_read_b64_tr_b16 a[124:125], v4 offset:54624
    ds_read_b64_tr_b16 a[126:127], v4 offset:54752
    buffer_store_dwordx4 v[52:55], v10, s[40:43], s54 offen offset:0 sc1
    v_mfma_f32_16x16x32_bf16 v[40:43], a[96:99], v[128:131], 0
    s_add_u32 m0, s44, 73728
    ds_read_b64_tr_b16 a[64:65], v3 offset:0
    ds_read_b64_tr_b16 a[66:67], v3 offset:128
    v_mfma_f32_16x16x32_bf16 v[40:43], a[100:103], v[136:139], v[40:43]
    s_mov_b32 s45, 512
    s_waitcnt lgkmcnt(10)
    buffer_load_dwordx4 v7, s[28:31], s45 offen offset:0 lds
    v_mfma_f32_16x16x32_bf16 v[40:43], a[104:107], v[144:147], v[40:43]
    s_add_u32 m0, s44, 73632
    ds_read_b64_tr_b16 a[68:69], v3 offset:256
    ds_read_b64_tr_b16 a[70:71], v3 offset:384
    v_mfma_f32_16x16x32_bf16 v[40:43], a[108:111], v[152:155], v[40:43]
    s_waitcnt lgkmcnt(8)
    buffer_load_dwordx4 v7, s[28:31], s45 offen offset:1152 lds
    v_mfma_f32_16x16x32_bf16 v[40:43], a[112:115], v[192:195], v[40:43]
    s_add_u32 m0, s44, 73536
    ds_read_b64_tr_b16 a[72:73], v3 offset:512
    ds_read_b64_tr_b16 a[74:75], v3 offset:640
    v_mfma_f32_16x16x32_bf16 v[40:43], a[116:119], v[200:203], v[40:43]
    s_waitcnt lgkmcnt(6)
    buffer_load_dwordx4 v7, s[28:31], s45 offen offset:2304 lds
    v_mfma_f32_16x16x32_bf16 v[40:43], a[120:123], v[208:211], v[40:43]
    s_add_u32 m0, s44, 73440
    ds_read_b64_tr_b16 a[76:77], v3 offset:768
    ds_read_b64_tr_b16 a[78:79], v3 offset:896
    v_mfma_f32_16x16x32_bf16 v[40:43], a[124:127], v[216:219], v[40:43]
    buffer_load_dwordx4 v7, s[28:31], s45 offen offset:3456 lds
    v_mfma_f32_16x16x32_bf16 v[44:47], a[96:99], v[160:163], 0
    s_add_u32 m0, s44, 90624
    ds_read_b64_tr_b16 a[80:81], v3 offset:16896
    ds_read_b64_tr_b16 a[82:83], v3 offset:17024
    v_mfma_f32_16x16x32_bf16 v[44:47], a[100:103], v[168:171], v[44:47]
    s_mov_b32 s45, 147968
    buffer_load_dwordx4 v7, s[28:31], s45 offen offset:0 lds
    v_mfma_f32_16x16x32_bf16 v[44:47], a[104:107], v[176:179], v[44:47]
    s_add_u32 m0, s44, 90528
    ds_read_b64_tr_b16 a[84:85], v3 offset:17152
    ds_read_b64_tr_b16 a[86:87], v3 offset:17280
    v_mfma_f32_16x16x32_bf16 v[44:47], a[108:111], v[184:187], v[44:47]
    buffer_load_dwordx4 v7, s[28:31], s45 offen offset:1152 lds
    v_mfma_f32_16x16x32_bf16 v[44:47], a[112:115], v[224:227], v[44:47]
    s_add_u32 m0, s44, 90432
    ds_read_b64_tr_b16 a[88:89], v3 offset:17408
    ds_read_b64_tr_b16 a[90:91], v3 offset:17536
    v_mfma_f32_16x16x32_bf16 v[44:47], a[116:119], v[232:235], v[44:47]
    buffer_load_dwordx4 v7, s[28:31], s45 offen offset:2304 lds
    v_mfma_f32_16x16x32_bf16 v[44:47], a[120:123], v[240:243], v[44:47]
    s_add_u32 m0, s44, 90336
    ds_read_b64_tr_b16 a[92:93], v3 offset:17664
    ds_read_b64_tr_b16 a[94:95], v3 offset:17792
    v_mfma_f32_16x16x32_bf16 v[44:47], a[124:127], v[248:251], v[44:47]
    s_waitcnt lgkmcnt(12)
    buffer_load_dwordx4 v7, s[28:31], s45 offen offset:3456 lds
    v_mfma_f32_16x16x32_bf16 v[16:19], a[64:67], v[128:131], 0
    ds_read_b64_tr_b16 a[96:97], v3 offset:32
    v_cvt_pk_bf16_f32 v48, v32, v33
    v_mfma_f32_16x16x32_bf16 v[16:19], a[68:71], v[136:139], v[16:19]
    s_waitcnt lgkmcnt(9)
    ds_read_b64_tr_b16 a[98:99], v3 offset:160
    v_cvt_pk_bf16_f32 v49, v34, v35
    v_mfma_f32_16x16x32_bf16 v[16:19], a[72:75], v[144:147], v[16:19]
    ds_read_b64_tr_b16 a[100:101], v3 offset:288
    v_cvt_pk_bf16_f32 v50, v40, v41
    v_mfma_f32_16x16x32_bf16 v[16:19], a[76:79], v[152:155], v[16:19]
    s_waitcnt lgkmcnt(7)
    ds_read_b64_tr_b16 a[102:103], v3 offset:416
    v_cvt_pk_bf16_f32 v51, v42, v43
    v_mfma_f32_16x16x32_bf16 v[16:19], a[80:83], v[192:195], v[16:19]
    s_mov_b32 s54, 1024
    ds_read_b64_tr_b16 a[104:105], v3 offset:544
    ds_read_b64_tr_b16 a[106:107], v3 offset:672
    v_mfma_f32_16x16x32_bf16 v[16:19], a[84:87], v[200:203], v[16:19]
    s_waitcnt lgkmcnt(6)
    v_permlane32_swap_b32 v48, v50
    v_mfma_f32_16x16x32_bf16 v[16:19], a[88:91], v[208:211], v[16:19]
    v_permlane32_swap_b32 v49, v51
    v_mfma_f32_16x16x32_bf16 v[16:19], a[92:95], v[216:219], v[16:19]
    ds_read_b64_tr_b16 a[108:109], v3 offset:800
    ds_read_b64_tr_b16 a[110:111], v3 offset:928
    buffer_store_dwordx4 v[48:51], v10, s[40:43], s54 offen offset:512 sc1
    v_mfma_f32_16x16x32_bf16 v[20:23], a[64:67], v[160:163], 0
    ds_read_b64_tr_b16 a[112:113], v3 offset:16928
    v_cvt_pk_bf16_f32 v52, v36, v37
    v_mfma_f32_16x16x32_bf16 v[20:23], a[68:71], v[168:171], v[20:23]
    ds_read_b64_tr_b16 a[114:115], v3 offset:17056
    v_cvt_pk_bf16_f32 v53, v38, v39
    v_mfma_f32_16x16x32_bf16 v[20:23], a[72:75], v[176:179], v[20:23]
    ds_read_b64_tr_b16 a[116:117], v3 offset:17184
    v_cvt_pk_bf16_f32 v54, v44, v45
    v_mfma_f32_16x16x32_bf16 v[20:23], a[76:79], v[184:187], v[20:23]
    ds_read_b64_tr_b16 a[118:119], v3 offset:17312
    v_cvt_pk_bf16_f32 v55, v46, v47
    v_mfma_f32_16x16x32_bf16 v[20:23], a[80:83], v[224:227], v[20:23]
    s_mov_b32 s54, 295936
    ds_read_b64_tr_b16 a[120:121], v3 offset:17440
    ds_read_b64_tr_b16 a[122:123], v3 offset:17568
    v_mfma_f32_16x16x32_bf16 v[20:23], a[84:87], v[232:235], v[20:23]
    v_permlane32_swap_b32 v52, v54
    v_mfma_f32_16x16x32_bf16 v[20:23], a[88:91], v[240:243], v[20:23]
    v_permlane32_swap_b32 v53, v55
    v_mfma_f32_16x16x32_bf16 v[20:23], a[92:95], v[248:251], v[20:23]
    s_waitcnt lgkmcnt(10)
    ds_read_b64_tr_b16 a[124:125], v3 offset:17696
    ds_read_b64_tr_b16 a[126:127], v3 offset:17824
    buffer_store_dwordx4 v[52:55], v10, s[40:43], s54 offen offset:512 sc1
    v_mfma_f32_16x16x32_bf16 v[24:27], a[96:99], v[128:131], 0
    ds_read_b64_tr_b16 a[64:65], v3 offset:64
    v_add_u32 v104, s14, v8
    v_mfma_f32_16x16x32_bf16 v[24:27], a[100:103], v[136:139], v[24:27]
    s_waitcnt lgkmcnt(9)
    ds_read_b64_tr_b16 a[66:67], v3 offset:192
    v_and_b32 v14, 32, v0
    v_mfma_f32_16x16x32_bf16 v[24:27], a[104:107], v[144:147], v[24:27]
    ds_read_b64_tr_b16 a[68:69], v3 offset:320
    v_xor_b32 v105, v14, v104
    v_mfma_f32_16x16x32_bf16 v[24:27], a[108:111], v[152:155], v[24:27]
    s_waitcnt lgkmcnt(7)
    ds_read_b64_tr_b16 a[70:71], v3 offset:448
    v_add_u32 v106, 73728, v105
    v_mfma_f32_16x16x32_bf16 v[24:27], a[112:115], v[192:195], v[24:27]
    ds_read_b64_tr_b16 a[72:73], v3 offset:576
    v_lshrrev_b32 v110, 4, v0
    v_mfma_f32_16x16x32_bf16 v[24:27], a[116:119], v[200:203], v[24:27]
    s_waitcnt lgkmcnt(5)
    ds_read_b64_tr_b16 a[74:75], v3 offset:704
    v_bfe_u32 v14, v0, 2, 2
    v_mfma_f32_16x16x32_bf16 v[24:27], a[120:123], v[208:211], v[24:27]
    ds_read_b64_tr_b16 a[76:77], v3 offset:832
    v_lshl_add_u32 v110, v110, 3, v14
    v_mfma_f32_16x16x32_bf16 v[24:27], a[124:127], v[216:219], v[24:27]
    ds_read_b64_tr_b16 a[78:79], v3 offset:960
    v_and_b32 v14, 3, v0
    v_mfma_f32_16x16x32_bf16 v[28:31], a[96:99], v[160:163], 0
    ds_read_b64_tr_b16 a[80:81], v3 offset:16960
    v_mul_u32_u24 v111, 1152, v110
    v_mfma_f32_16x16x32_bf16 v[28:31], a[100:103], v[168:171], v[28:31]
    ds_read_b64_tr_b16 a[82:83], v3 offset:17088
    v_lshlrev_b32 v110, 6, v110
    v_mfma_f32_16x16x32_bf16 v[28:31], a[104:107], v[176:179], v[28:31]
    ds_read_b64_tr_b16 a[84:85], v3 offset:17216
    v_lshl_add_u32 v110, v14, 3, v110
    v_mfma_f32_16x16x32_bf16 v[28:31], a[108:111], v[184:187], v[28:31]
    ds_read_b64_tr_b16 a[86:87], v3 offset:17344
    v_lshl_add_u32 v111, v14, 3, v111
    v_mfma_f32_16x16x32_bf16 v[28:31], a[112:115], v[224:227], v[28:31]
    s_lshr_b32 s3, s51, 1
    s_xor_b32 s3, s3, 1
    s_mul_i32 s3, s3, 110592
    s_and_b32 s14, s51, 1
    s_lshl_b32 s14, s14, 5
    s_add_u32 s3, s3, s14
    s_add_u32 s3, s3, 16384
    ds_read_b64_tr_b16 a[88:89], v3 offset:17472
    v_add_u32 v110, s3, v110
    v_mfma_f32_16x16x32_bf16 v[28:31], a[116:119], v[232:235], v[28:31]
    ds_read_b64_tr_b16 a[90:91], v3 offset:17600
    v_and_b32 v14, 16, v0
    v_mfma_f32_16x16x32_bf16 v[28:31], a[120:123], v[240:243], v[28:31]
    ds_read_b64_tr_b16 a[92:93], v3 offset:17728
    v_lshlrev_b32 v14, 1, v14
    v_mfma_f32_16x16x32_bf16 v[28:31], a[124:127], v[248:251], v[28:31]
    s_waitcnt lgkmcnt(11)
    ds_read_b64_tr_b16 a[94:95], v3 offset:17856
    v_xor_b32 v110, v14, v110
    v_mfma_f32_16x16x32_bf16 v[32:35], a[64:67], v[128:131], 0
    s_mul_i32 s3, s51, 288
    s_add_u32 s3, s3, 53248
    ds_read_b64_tr_b16 a[96:97], v3 offset:96
    v_cvt_pk_bf16_f32 v48, v16, v17
    v_mfma_f32_16x16x32_bf16 v[32:35], a[68:71], v[136:139], v[32:35]
    s_waitcnt lgkmcnt(9)
    ds_read_b64_tr_b16 a[98:99], v3 offset:224
    v_cvt_pk_bf16_f32 v49, v18, v19
    v_mfma_f32_16x16x32_bf16 v[32:35], a[72:75], v[144:147], v[32:35]
L2_pad11:
    s_cbranch_execz L2_pad15
    ds_read_b64_tr_b16 a[100:101], v3 offset:352
    v_cvt_pk_bf16_f32 v50, v24, v25
    v_mfma_f32_16x16x32_bf16 v[32:35], a[76:79], v[152:155], v[32:35]
    s_waitcnt lgkmcnt(7)
    ds_read_b64_tr_b16 a[102:103], v3 offset:480
    v_cvt_pk_bf16_f32 v51, v26, v27
    v_mfma_f32_16x16x32_bf16 v[32:35], a[80:83], v[192:195], v[32:35]
    s_mov_b32 s54, 2048
    ds_read_b64_tr_b16 a[104:105], v3 offset:608
    ds_read_b64_tr_b16 a[106:107], v3 offset:736
    v_mfma_f32_16x16x32_bf16 v[32:35], a[84:87], v[200:203], v[32:35]
    s_waitcnt lgkmcnt(6)
    v_permlane32_swap_b32 v48, v50
    v_mfma_f32_16x16x32_bf16 v[32:35], a[88:91], v[208:211], v[32:35]
    v_permlane32_swap_b32 v49, v51
    v_mfma_f32_16x16x32_bf16 v[32:35], a[92:95], v[216:219], v[32:35]
    ds_read_b64_tr_b16 a[108:109], v3 offset:864
    ds_read_b64_tr_b16 a[110:111], v3 offset:992
    buffer_store_dwordx4 v[48:51], v10, s[40:43], s54 offen offset:0 sc1
    v_mfma_f32_16x16x32_bf16 v[36:39], a[64:67], v[160:163], 0
    ds_read_b64_tr_b16 a[112:113], v3 offset:16992
    v_cvt_pk_bf16_f32 v52, v20, v21
    v_mfma_f32_16x16x32_bf16 v[36:39], a[68:71], v[168:171], v[36:39]
    ds_read_b64_tr_b16 a[114:115], v3 offset:17120
    v_cvt_pk_bf16_f32 v53, v22, v23
    v_mfma_f32_16x16x32_bf16 v[36:39], a[72:75], v[176:179], v[36:39]
    ds_read_b64_tr_b16 a[116:117], v3 offset:17248
    v_cvt_pk_bf16_f32 v54, v28, v29
    v_mfma_f32_16x16x32_bf16 v[36:39], a[76:79], v[184:187], v[36:39]
    ds_read_b64_tr_b16 a[118:119], v3 offset:17376
    v_cvt_pk_bf16_f32 v55, v30, v31
    v_mfma_f32_16x16x32_bf16 v[36:39], a[80:83], v[224:227], v[36:39]
    s_mov_b32 s54, 296960
    ds_read_b64_tr_b16 a[120:121], v3 offset:17504
    ds_read_b64_tr_b16 a[122:123], v3 offset:17632
    v_mfma_f32_16x16x32_bf16 v[36:39], a[84:87], v[232:235], v[36:39]
    v_permlane32_swap_b32 v52, v54
    v_mfma_f32_16x16x32_bf16 v[36:39], a[88:91], v[240:243], v[36:39]
    v_permlane32_swap_b32 v53, v55
    v_mfma_f32_16x16x32_bf16 v[36:39], a[92:95], v[248:251], v[36:39]
    s_waitcnt vmcnt(15)
    s_barrier
    s_waitcnt lgkmcnt(10)
    ds_read_b64_tr_b16 a[124:125], v3 offset:17760
    ds_read_b64_tr_b16 a[126:127], v3 offset:17888
    buffer_store_dwordx4 v[52:55], v10, s[40:43], s54 offen offset:0 sc1
    v_mfma_f32_16x16x32_bf16 v[40:43], a[96:99], v[128:131], 0
    s_add_u32 m0, s44, 110592
    ds_read_b64_tr_b16 a[64:65], v3 offset:36864
    ds_read_b64_tr_b16 a[66:67], v3 offset:36992
    v_mfma_f32_16x16x32_bf16 v[40:43], a[100:103], v[136:139], v[40:43]
    s_mov_b32 s45, 640
    s_waitcnt lgkmcnt(10)
    buffer_load_dwordx4 v7, s[28:31], s45 offen offset:0 lds
    v_mfma_f32_16x16x32_bf16 v[40:43], a[104:107], v[144:147], v[40:43]
    s_add_u32 m0, s44, 110496
    ds_read_b64_tr_b16 a[68:69], v3 offset:37120
    ds_read_b64_tr_b16 a[70:71], v3 offset:37248
    v_mfma_f32_16x16x32_bf16 v[40:43], a[108:111], v[152:155], v[40:43]
    s_waitcnt lgkmcnt(8)
    buffer_load_dwordx4 v7, s[28:31], s45 offen offset:1152 lds
    v_mfma_f32_16x16x32_bf16 v[40:43], a[112:115], v[192:195], v[40:43]
    s_add_u32 m0, s44, 110400
    ds_read_b64_tr_b16 a[72:73], v3 offset:37376
    ds_read_b64_tr_b16 a[74:75], v3 offset:37504
    v_mfma_f32_16x16x32_bf16 v[40:43], a[116:119], v[200:203], v[40:43]
    s_waitcnt lgkmcnt(6)
    buffer_load_dwordx4 v7, s[28:31], s45 offen offset:2304 lds
    v_mfma_f32_16x16x32_bf16 v[40:43], a[120:123], v[208:211], v[40:43]
    s_add_u32 m0, s44, 110304
    ds_read_b64_tr_b16 a[76:77], v3 offset:37632
    ds_read_b64_tr_b16 a[78:79], v3 offset:37760
    v_mfma_f32_16x16x32_bf16 v[40:43], a[124:127], v[216:219], v[40:43]
    buffer_load_dwordx4 v7, s[28:31], s45 offen offset:3456 lds
    v_mfma_f32_16x16x32_bf16 v[44:47], a[96:99], v[160:163], 0
    s_add_u32 m0, s44, 127488
    ds_read_b64_tr_b16 a[80:81], v3 offset:53760
    ds_read_b64_tr_b16 a[82:83], v3 offset:53888
    v_mfma_f32_16x16x32_bf16 v[44:47], a[100:103], v[168:171], v[44:47]
    s_mov_b32 s45, 148096
    buffer_load_dwordx4 v7, s[28:31], s45 offen offset:0 lds
    v_mfma_f32_16x16x32_bf16 v[44:47], a[104:107], v[176:179], v[44:47]
    s_add_u32 m0, s44, 127392
    ds_read_b64_tr_b16 a[84:85], v3 offset:54016
    ds_read_b64_tr_b16 a[86:87], v3 offset:54144
    v_mfma_f32_16x16x32_bf16 v[44:47], a[108:111], v[184:187], v[44:47]
    buffer_load_dwordx4 v7, s[28:31], s45 offen offset:1152 lds
    v_mfma_f32_16x16x32_bf16 v[44:47], a[112:115], v[224:227], v[44:47]
    s_add_u32 m0, s44, 127296
    ds_read_b64_tr_b16 a[88:89], v3 offset:54272
    ds_read_b64_tr_b16 a[90:91], v3 offset:54400
    v_mfma_f32_16x16x32_bf16 v[44:47], a[116:119], v[232:235], v[44:47]
    buffer_load_dwordx4 v7, s[28:31], s45 offen offset:2304 lds
    v_mfma_f32_16x16x32_bf16 v[44:47], a[120:123], v[240:243], v[44:47]
    s_add_u32 m0, s44, 127200
    ds_read_b64_tr_b16 a[92:93], v3 offset:54528
    ds_read_b64_tr_b16 a[94:95], v3 offset:54656
    v_mfma_f32_16x16x32_bf16 v[44:47], a[124:127], v[248:251], v[44:47]
    s_waitcnt lgkmcnt(12)
    buffer_load_dwordx4 v7, s[28:31], s45 offen offset:3456 lds
    v_mfma_f32_16x16x32_bf16 v[16:19], a[64:67], v[128:131], 0
    ds_read_b64_tr_b16 a[96:97], v3 offset:36896
    v_cvt_pk_bf16_f32 v48, v32, v33
    v_mfma_f32_16x16x32_bf16 v[16:19], a[68:71], v[136:139], v[16:19]
    s_waitcnt lgkmcnt(9)
    ds_read_b64_tr_b16 a[98:99], v3 offset:37024
    v_cvt_pk_bf16_f32 v49, v34, v35
    v_mfma_f32_16x16x32_bf16 v[16:19], a[72:75], v[144:147], v[16:19]
    ds_read_b64_tr_b16 a[100:101], v3 offset:37152
    v_cvt_pk_bf16_f32 v50, v40, v41
    v_mfma_f32_16x16x32_bf16 v[16:19], a[76:79], v[152:155], v[16:19]
    s_waitcnt lgkmcnt(7)
    ds_read_b64_tr_b16 a[102:103], v3 offset:37280
    v_cvt_pk_bf16_f32 v51, v42, v43
    v_mfma_f32_16x16x32_bf16 v[16:19], a[80:83], v[192:195], v[16:19]
    s_mov_b32 s54, 2048
    ds_read_b64_tr_b16 a[104:105], v3 offset:37408
    ds_read_b64_tr_b16 a[106:107], v3 offset:37536
    v_mfma_f32_16x16x32_bf16 v[16:19], a[84:87], v[200:203], v[16:19]
    s_waitcnt lgkmcnt(6)
    v_permlane32_swap_b32 v48, v50
    v_mfma_f32_16x16x32_bf16 v[16:19], a[88:91], v[208:211], v[16:19]
    v_permlane32_swap_b32 v49, v51
    v_mfma_f32_16x16x32_bf16 v[16:19], a[92:95], v[216:219], v[16:19]
    ds_read_b64_tr_b16 a[108:109], v3 offset:37664
    ds_read_b64_tr_b16 a[110:111], v3 offset:37792
    buffer_store_dwordx4 v[48:51], v10, s[40:43], s54 offen offset:512 sc1
    v_mfma_f32_16x16x32_bf16 v[20:23], a[64:67], v[160:163], 0
    ds_read_b64_tr_b16 a[112:113], v3 offset:53792
    v_cvt_pk_bf16_f32 v52, v36, v37
    v_mfma_f32_16x16x32_bf16 v[20:23], a[68:71], v[168:171], v[20:23]
    ds_read_b64_tr_b16 a[114:115], v3 offset:53920
    v_cvt_pk_bf16_f32 v53, v38, v39
    v_mfma_f32_16x16x32_bf16 v[20:23], a[72:75], v[176:179], v[20:23]
    ds_read_b64_tr_b16 a[116:117], v3 offset:54048
    v_cvt_pk_bf16_f32 v54, v44, v45
    v_mfma_f32_16x16x32_bf16 v[20:23], a[76:79], v[184:187], v[20:23]
    ds_read_b64_tr_b16 a[118:119], v3 offset:54176
    v_cvt_pk_bf16_f32 v55, v46, v47
    v_mfma_f32_16x16x32_bf16 v[20:23], a[80:83], v[224:227], v[20:23]
    s_mov_b32 s54, 296960
    ds_read_b64_tr_b16 a[120:121], v3 offset:54304
    ds_read_b64_tr_b16 a[122:123], v3 offset:54432
    v_mfma_f32_16x16x32_bf16 v[20:23], a[84:87], v[232:235], v[20:23]
    v_permlane32_swap_b32 v52, v54
    v_mfma_f32_16x16x32_bf16 v[20:23], a[88:91], v[240:243], v[20:23]
    v_permlane32_swap_b32 v53, v55
    v_mfma_f32_16x16x32_bf16 v[20:23], a[92:95], v[248:251], v[20:23]
    s_waitcnt lgkmcnt(10)
    ds_read_b64_tr_b16 a[124:125], v3 offset:54560
    ds_read_b64_tr_b16 a[126:127], v3 offset:54688
    buffer_store_dwordx4 v[52:55], v10, s[40:43], s54 offen offset:512 sc1
    v_mfma_f32_16x16x32_bf16 v[24:27], a[96:99], v[128:131], 0
    ds_read_b64_tr_b16 a[64:65], v3 offset:36928
    v_add_u32 v111, s3, v111
    v_mfma_f32_16x16x32_bf16 v[24:27], a[100:103], v[136:139], v[24:27]
    s_waitcnt lgkmcnt(9)
    ds_read_b64_tr_b16 a[66:67], v3 offset:37056
    v_mfma_f32_16x16x32_bf16 v[24:27], a[104:107], v[144:147], v[24:27]
    ds_read_b64_tr_b16 a[68:69], v3 offset:37184
    v_mfma_f32_16x16x32_bf16 v[24:27], a[108:111], v[152:155], v[24:27]
    s_waitcnt lgkmcnt(7)
    ds_read_b64_tr_b16 a[70:71], v3 offset:37312
    v_mfma_f32_16x16x32_bf16 v[24:27], a[112:115], v[192:195], v[24:27]
    ds_read_b64_tr_b16 a[72:73], v3 offset:37440
    v_mfma_f32_16x16x32_bf16 v[24:27], a[116:119], v[200:203], v[24:27]
    s_waitcnt lgkmcnt(5)
    ds_read_b64_tr_b16 a[74:75], v3 offset:37568
    v_mfma_f32_16x16x32_bf16 v[24:27], a[120:123], v[208:211], v[24:27]
    ds_read_b64_tr_b16 a[76:77], v3 offset:37696
    v_mfma_f32_16x16x32_bf16 v[24:27], a[124:127], v[216:219], v[24:27]
    ds_read_b64_tr_b16 a[78:79], v3 offset:37824
    v_mfma_f32_16x16x32_bf16 v[28:31], a[96:99], v[160:163], 0
    ds_read_b64_tr_b16 a[80:81], v3 offset:53824
    v_mfma_f32_16x16x32_bf16 v[28:31], a[100:103], v[168:171], v[28:31]
    ds_read_b64_tr_b16 a[82:83], v3 offset:53952
    v_mfma_f32_16x16x32_bf16 v[28:31], a[104:107], v[176:179], v[28:31]
    ds_read_b64_tr_b16 a[84:85], v3 offset:54080
    v_mfma_f32_16x16x32_bf16 v[28:31], a[108:111], v[184:187], v[28:31]
    ds_read_b64_tr_b16 a[86:87], v3 offset:54208
    v_mfma_f32_16x16x32_bf16 v[28:31], a[112:115], v[224:227], v[28:31]
    ds_read_b64_tr_b16 a[88:89], v3 offset:54336
    v_mfma_f32_16x16x32_bf16 v[28:31], a[116:119], v[232:235], v[28:31]
    ds_read_b64_tr_b16 a[90:91], v3 offset:54464
    v_mfma_f32_16x16x32_bf16 v[28:31], a[120:123], v[240:243], v[28:31]
    ds_read_b64_tr_b16 a[92:93], v3 offset:54592
    v_mfma_f32_16x16x32_bf16 v[28:31], a[124:127], v[248:251], v[28:31]
    s_waitcnt lgkmcnt(11)
    ds_read_b64_tr_b16 a[94:95], v3 offset:54720
    v_mfma_f32_16x16x32_bf16 v[32:35], a[64:67], v[128:131], 0
    ds_read_b64_tr_b16 a[96:97], v3 offset:36960
    v_cvt_pk_bf16_f32 v48, v16, v17
    v_mfma_f32_16x16x32_bf16 v[32:35], a[68:71], v[136:139], v[32:35]
    s_waitcnt lgkmcnt(9)
    ds_read_b64_tr_b16 a[98:99], v3 offset:37088
    v_cvt_pk_bf16_f32 v49, v18, v19
    v_mfma_f32_16x16x32_bf16 v[32:35], a[72:75], v[144:147], v[32:35]
    ds_read_b64_tr_b16 a[100:101], v3 offset:37216
    v_cvt_pk_bf16_f32 v50, v24, v25
    v_mfma_f32_16x16x32_bf16 v[32:35], a[76:79], v[152:155], v[32:35]
    s_waitcnt lgkmcnt(7)
    ds_read_b64_tr_b16 a[102:103], v3 offset:37344
    v_cvt_pk_bf16_f32 v51, v26, v27
    v_mfma_f32_16x16x32_bf16 v[32:35], a[80:83], v[192:195], v[32:35]
    s_mov_b32 s54, 3072
    ds_read_b64_tr_b16 a[104:105], v3 offset:37472
    ds_read_b64_tr_b16 a[106:107], v3 offset:37600
    v_mfma_f32_16x16x32_bf16 v[32:35], a[84:87], v[200:203], v[32:35]
    s_waitcnt lgkmcnt(6)
    v_permlane32_swap_b32 v48, v50
    v_mfma_f32_16x16x32_bf16 v[32:35], a[88:91], v[208:211], v[32:35]
    v_permlane32_swap_b32 v49, v51
    v_mfma_f32_16x16x32_bf16 v[32:35], a[92:95], v[216:219], v[32:35]
    ds_read_b64_tr_b16 a[108:109], v3 offset:37728
    ds_read_b64_tr_b16 a[110:111], v3 offset:37856
    buffer_store_dwordx4 v[48:51], v10, s[40:43], s54 offen offset:0 sc1
    v_mfma_f32_16x16x32_bf16 v[36:39], a[64:67], v[160:163], 0
    ds_read_b64_tr_b16 a[112:113], v3 offset:53856
    v_cvt_pk_bf16_f32 v52, v20, v21
    v_mfma_f32_16x16x32_bf16 v[36:39], a[68:71], v[168:171], v[36:39]
    ds_read_b64_tr_b16 a[114:115], v3 offset:53984
    v_cvt_pk_bf16_f32 v53, v22, v23
    v_mfma_f32_16x16x32_bf16 v[36:39], a[72:75], v[176:179], v[36:39]
    ds_read_b64_tr_b16 a[116:117], v3 offset:54112
    v_cvt_pk_bf16_f32 v54, v28, v29
    v_mfma_f32_16x16x32_bf16 v[36:39], a[76:79], v[184:187], v[36:39]
    ds_read_b64_tr_b16 a[118:119], v3 offset:54240
    v_cvt_pk_bf16_f32 v55, v30, v31
    v_mfma_f32_16x16x32_bf16 v[36:39], a[80:83], v[224:227], v[36:39]
    s_mov_b32 s54, 297984
    ds_read_b64_tr_b16 a[120:121], v3 offset:54368
    ds_read_b64_tr_b16 a[122:123], v3 offset:54496
    v_mfma_f32_16x16x32_bf16 v[36:39], a[84:87], v[232:235], v[36:39]
    v_permlane32_swap_b32 v52, v54
    v_mfma_f32_16x16x32_bf16 v[36:39], a[88:91], v[240:243], v[36:39]
    v_permlane32_swap_b32 v53, v55
    v_mfma_f32_16x16x32_bf16 v[36:39], a[92:95], v[248:251], v[36:39]
    s_waitcnt vmcnt(15)
    s_barrier
    s_waitcnt lgkmcnt(10)
    ds_read_b64_tr_b16 a[124:125], v3 offset:54624
    ds_read_b64_tr_b16 a[126:127], v3 offset:54752
    buffer_store_dwordx4 v[52:55], v10, s[40:43], s54 offen offset:0 sc1
    v_mfma_f32_16x16x32_bf16 v[40:43], a[96:99], v[128:131], 0
    s_add_u32 m0, s44, 0
    ds_read_b64_tr_b16 a[64:65], v4 offset:0
    ds_read_b64_tr_b16 a[66:67], v4 offset:128
    v_mfma_f32_16x16x32_bf16 v[40:43], a[100:103], v[136:139], v[40:43]
    s_mov_b32 s45, 768
    s_waitcnt lgkmcnt(10)
    buffer_load_dwordx4 v7, s[28:31], s45 offen offset:0 lds
    v_mfma_f32_16x16x32_bf16 v[40:43], a[104:107], v[144:147], v[40:43]
    s_add_u32 m0, s44, -96
    ds_read_b64_tr_b16 a[68:69], v4 offset:256
    ds_read_b64_tr_b16 a[70:71], v4 offset:384
    v_mfma_f32_16x16x32_bf16 v[40:43], a[108:111], v[152:155], v[40:43]
    s_waitcnt lgkmcnt(8)
    buffer_load_dwordx4 v7, s[28:31], s45 offen offset:1152 lds
    v_mfma_f32_16x16x32_bf16 v[40:43], a[112:115], v[192:195], v[40:43]
    s_add_u32 m0, s44, -192
    ds_read_b64_tr_b16 a[72:73], v4 offset:512
    ds_read_b64_tr_b16 a[74:75], v4 offset:640
    v_mfma_f32_16x16x32_bf16 v[40:43], a[116:119], v[200:203], v[40:43]
    s_waitcnt lgkmcnt(6)
    buffer_load_dwordx4 v7, s[28:31], s45 offen offset:2304 lds
    v_mfma_f32_16x16x32_bf16 v[40:43], a[120:123], v[208:211], v[40:43]
    s_add_u32 m0, s44, -288
    ds_read_b64_tr_b16 a[76:77], v4 offset:768
    ds_read_b64_tr_b16 a[78:79], v4 offset:896
    v_mfma_f32_16x16x32_bf16 v[40:43], a[124:127], v[216:219], v[40:43]
    buffer_load_dwordx4 v7, s[28:31], s45 offen offset:3456 lds
    v_mfma_f32_16x16x32_bf16 v[44:47], a[96:99], v[160:163], 0
    s_add_u32 m0, s44, 16896
    ds_read_b64_tr_b16 a[80:81], v4 offset:16896
    ds_read_b64_tr_b16 a[82:83], v4 offset:17024
    v_mfma_f32_16x16x32_bf16 v[44:47], a[100:103], v[168:171], v[44:47]
    s_mov_b32 s45, 148224
    buffer_load_dwordx4 v7, s[28:31], s45 offen offset:0 lds
    v_mfma_f32_16x16x32_bf16 v[44:47], a[104:107], v[176:179], v[44:47]
    s_add_u32 m0, s44, 16800
    ds_read_b64_tr_b16 a[84:85], v4 offset:17152
    ds_read_b64_tr_b16 a[86:87], v4 offset:17280
    v_mfma_f32_16x16x32_bf16 v[44:47], a[108:111], v[184:187], v[44:47]
    buffer_load_dwordx4 v7, s[28:31], s45 offen offset:1152 lds
    v_mfma_f32_16x16x32_bf16 v[44:47], a[112:115], v[224:227], v[44:47]
    s_add_u32 m0, s44, 16704
    ds_read_b64_tr_b16 a[88:89], v4 offset:17408
    ds_read_b64_tr_b16 a[90:91], v4 offset:17536
    v_mfma_f32_16x16x32_bf16 v[44:47], a[116:119], v[232:235], v[44:47]
    buffer_load_dwordx4 v7, s[28:31], s45 offen offset:2304 lds
    v_mfma_f32_16x16x32_bf16 v[44:47], a[120:123], v[240:243], v[44:47]
    s_add_u32 m0, s44, 16608
    ds_read_b64_tr_b16 a[92:93], v4 offset:17664
    ds_read_b64_tr_b16 a[94:95], v4 offset:17792
    v_mfma_f32_16x16x32_bf16 v[44:47], a[124:127], v[248:251], v[44:47]
    s_waitcnt lgkmcnt(12)
    buffer_load_dwordx4 v7, s[28:31], s45 offen offset:3456 lds
    v_mfma_f32_16x16x32_bf16 v[16:19], a[64:67], v[128:131], 0
    ds_read_b64_tr_b16 a[96:97], v4 offset:32
    v_cvt_pk_bf16_f32 v48, v32, v33
    v_mfma_f32_16x16x32_bf16 v[16:19], a[68:71], v[136:139], v[16:19]
    s_waitcnt lgkmcnt(9)
    ds_read_b64_tr_b16 a[98:99], v4 offset:160
    v_cvt_pk_bf16_f32 v49, v34, v35
    v_mfma_f32_16x16x32_bf16 v[16:19], a[72:75], v[144:147], v[16:19]
    ds_read_b64_tr_b16 a[100:101], v4 offset:288
    v_cvt_pk_bf16_f32 v50, v40, v41
    v_mfma_f32_16x16x32_bf16 v[16:19], a[76:79], v[152:155], v[16:19]
    s_waitcnt lgkmcnt(7)
    ds_read_b64_tr_b16 a[102:103], v4 offset:416
    v_cvt_pk_bf16_f32 v51, v42, v43
    v_mfma_f32_16x16x32_bf16 v[16:19], a[80:83], v[192:195], v[16:19]
    s_mov_b32 s54, 3072
    ds_read_b64_tr_b16 a[104:105], v4 offset:544
    ds_read_b64_tr_b16 a[106:107], v4 offset:672
    v_mfma_f32_16x16x32_bf16 v[16:19], a[84:87], v[200:203], v[16:19]
    s_waitcnt lgkmcnt(6)
    v_permlane32_swap_b32 v48, v50
    v_mfma_f32_16x16x32_bf16 v[16:19], a[88:91], v[208:211], v[16:19]
    v_permlane32_swap_b32 v49, v51
    v_mfma_f32_16x16x32_bf16 v[16:19], a[92:95], v[216:219], v[16:19]
    ds_read_b64_tr_b16 a[108:109], v4 offset:800
    ds_read_b64_tr_b16 a[110:111], v4 offset:928
    buffer_store_dwordx4 v[48:51], v10, s[40:43], s54 offen offset:512 sc1
    v_mfma_f32_16x16x32_bf16 v[20:23], a[64:67], v[160:163], 0
    ds_read_b64_tr_b16 a[112:113], v4 offset:16928
    v_cvt_pk_bf16_f32 v52, v36, v37
    v_mfma_f32_16x16x32_bf16 v[20:23], a[68:71], v[168:171], v[20:23]
    ds_read_b64_tr_b16 a[114:115], v4 offset:17056
    v_cvt_pk_bf16_f32 v53, v38, v39
    v_mfma_f32_16x16x32_bf16 v[20:23], a[72:75], v[176:179], v[20:23]
    ds_read_b64_tr_b16 a[116:117], v4 offset:17184
    v_cvt_pk_bf16_f32 v54, v44, v45
    v_mfma_f32_16x16x32_bf16 v[20:23], a[76:79], v[184:187], v[20:23]
    ds_read_b64_tr_b16 a[118:119], v4 offset:17312
    v_cvt_pk_bf16_f32 v55, v46, v47
    v_mfma_f32_16x16x32_bf16 v[20:23], a[80:83], v[224:227], v[20:23]
    s_mov_b32 s54, 297984
    ds_read_b64_tr_b16 a[120:121], v4 offset:17440
    ds_read_b64_tr_b16 a[122:123], v4 offset:17568
    v_mfma_f32_16x16x32_bf16 v[20:23], a[84:87], v[232:235], v[20:23]
    v_permlane32_swap_b32 v52, v54
    v_mfma_f32_16x16x32_bf16 v[20:23], a[88:91], v[240:243], v[20:23]
    v_permlane32_swap_b32 v53, v55
    v_mfma_f32_16x16x32_bf16 v[20:23], a[92:95], v[248:251], v[20:23]
    s_waitcnt lgkmcnt(10)
    ds_read_b64_tr_b16 a[124:125], v4 offset:17696
    ds_read_b64_tr_b16 a[126:127], v4 offset:17824
    buffer_store_dwordx4 v[52:55], v10, s[40:43], s54 offen offset:512 sc1
    v_mfma_f32_16x16x32_bf16 v[24:27], a[96:99], v[128:131], 0
    ds_read_b64_tr_b16 a[64:65], v4 offset:64
    v_mfma_f32_16x16x32_bf16 v[24:27], a[100:103], v[136:139], v[24:27]
    s_waitcnt lgkmcnt(9)
    ds_read_b64_tr_b16 a[66:67], v4 offset:192
    v_mfma_f32_16x16x32_bf16 v[24:27], a[104:107], v[144:147], v[24:27]
    ds_read_b64_tr_b16 a[68:69], v4 offset:320
    v_mfma_f32_16x16x32_bf16 v[24:27], a[108:111], v[152:155], v[24:27]
    s_waitcnt lgkmcnt(7)
    ds_read_b64_tr_b16 a[70:71], v4 offset:448
    v_mfma_f32_16x16x32_bf16 v[24:27], a[112:115], v[192:195], v[24:27]
    ds_read_b64_tr_b16 a[72:73], v4 offset:576
    v_mfma_f32_16x16x32_bf16 v[24:27], a[116:119], v[200:203], v[24:27]
    s_waitcnt lgkmcnt(5)
    ds_read_b64_tr_b16 a[74:75], v4 offset:704
    v_mfma_f32_16x16x32_bf16 v[24:27], a[120:123], v[208:211], v[24:27]
    ds_read_b64_tr_b16 a[76:77], v4 offset:832
    v_mfma_f32_16x16x32_bf16 v[24:27], a[124:127], v[216:219], v[24:27]
    ds_read_b64_tr_b16 a[78:79], v4 offset:960
    v_mfma_f32_16x16x32_bf16 v[28:31], a[96:99], v[160:163], 0
    ds_read_b64_tr_b16 a[80:81], v4 offset:16960
    v_mfma_f32_16x16x32_bf16 v[28:31], a[100:103], v[168:171], v[28:31]
    ds_read_b64_tr_b16 a[82:83], v4 offset:17088
    v_mfma_f32_16x16x32_bf16 v[28:31], a[104:107], v[176:179], v[28:31]
    ds_read_b64_tr_b16 a[84:85], v4 offset:17216
    v_mfma_f32_16x16x32_bf16 v[28:31], a[108:111], v[184:187], v[28:31]
    ds_read_b64_tr_b16 a[86:87], v4 offset:17344
    v_mfma_f32_16x16x32_bf16 v[28:31], a[112:115], v[224:227], v[28:31]
    ds_read_b64_tr_b16 a[88:89], v4 offset:17472
    v_mfma_f32_16x16x32_bf16 v[28:31], a[116:119], v[232:235], v[28:31]
    ds_read_b64_tr_b16 a[90:91], v4 offset:17600
    v_mfma_f32_16x16x32_bf16 v[28:31], a[120:123], v[240:243], v[28:31]
    ds_read_b64_tr_b16 a[92:93], v4 offset:17728
    v_mfma_f32_16x16x32_bf16 v[28:31], a[124:127], v[248:251], v[28:31]
    s_waitcnt lgkmcnt(11)
    ds_read_b64_tr_b16 a[94:95], v4 offset:17856
    v_mfma_f32_16x16x32_bf16 v[32:35], a[64:67], v[128:131], 0
    ds_read_b64_tr_b16 a[96:97], v4 offset:96
    v_cvt_pk_bf16_f32 v48, v16, v17
    v_mfma_f32_16x16x32_bf16 v[32:35], a[68:71], v[136:139], v[32:35]
    s_waitcnt lgkmcnt(9)
    ds_read_b64_tr_b16 a[98:99], v4 offset:224
    v_cvt_pk_bf16_f32 v49, v18, v19
    v_mfma_f32_16x16x32_bf16 v[32:35], a[72:75], v[144:147], v[32:35]
    ds_read_b64_tr_b16 a[100:101], v4 offset:352
    v_cvt_pk_bf16_f32 v50, v24, v25
    v_mfma_f32_16x16x32_bf16 v[32:35], a[76:79], v[152:155], v[32:35]
    s_waitcnt lgkmcnt(7)
    ds_read_b64_tr_b16 a[102:103], v4 offset:480
    v_cvt_pk_bf16_f32 v51, v26, v27
    v_mfma_f32_16x16x32_bf16 v[32:35], a[80:83], v[192:195], v[32:35]
    s_mov_b32 s54, 4096
    ds_read_b64_tr_b16 a[104:105], v4 offset:608
    ds_read_b64_tr_b16 a[106:107], v4 offset:736
    v_mfma_f32_16x16x32_bf16 v[32:35], a[84:87], v[200:203], v[32:35]
    s_waitcnt lgkmcnt(6)
    v_permlane32_swap_b32 v48, v50
    v_mfma_f32_16x16x32_bf16 v[32:35], a[88:91], v[208:211], v[32:35]
    v_permlane32_swap_b32 v49, v51
    v_mfma_f32_16x16x32_bf16 v[32:35], a[92:95], v[216:219], v[32:35]
    ds_read_b64_tr_b16 a[108:109], v4 offset:864
    ds_read_b64_tr_b16 a[110:111], v4 offset:992
    buffer_store_dwordx4 v[48:51], v10, s[40:43], s54 offen offset:0 sc1
    v_mfma_f32_16x16x32_bf16 v[36:39], a[64:67], v[160:163], 0
    ds_read_b64_tr_b16 a[112:113], v4 offset:16992
    v_cvt_pk_bf16_f32 v52, v20, v21
    v_mfma_f32_16x16x32_bf16 v[36:39], a[68:71], v[168:171], v[36:39]
    ds_read_b64_tr_b16 a[114:115], v4 offset:17120
    v_cvt_pk_bf16_f32 v53, v22, v23
    v_mfma_f32_16x16x32_bf16 v[36:39], a[72:75], v[176:179], v[36:39]
    ds_read_b64_tr_b16 a[116:117], v4 offset:17248
    v_cvt_pk_bf16_f32 v54, v28, v29
    v_mfma_f32_16x16x32_bf16 v[36:39], a[76:79], v[184:187], v[36:39]
    ds_read_b64_tr_b16 a[118:119], v4 offset:17376
    v_cvt_pk_bf16_f32 v55, v30, v31
    v_mfma_f32_16x16x32_bf16 v[36:39], a[80:83], v[224:227], v[36:39]
    s_mov_b32 s54, 299008
    ds_read_b64_tr_b16 a[120:121], v4 offset:17504
    ds_read_b64_tr_b16 a[122:123], v4 offset:17632
    v_mfma_f32_16x16x32_bf16 v[36:39], a[84:87], v[232:235], v[36:39]
    v_permlane32_swap_b32 v52, v54
    v_mfma_f32_16x16x32_bf16 v[36:39], a[88:91], v[240:243], v[36:39]
    v_permlane32_swap_b32 v53, v55
    v_mfma_f32_16x16x32_bf16 v[36:39], a[92:95], v[248:251], v[36:39]
    s_waitcnt vmcnt(15)
    s_barrier
    s_waitcnt lgkmcnt(10)
    ds_read_b64_tr_b16 a[124:125], v4 offset:17760
    ds_read_b64_tr_b16 a[126:127], v4 offset:17888
    buffer_store_dwordx4 v[52:55], v10, s[40:43], s54 offen offset:0 sc1
    v_mfma_f32_16x16x32_bf16 v[40:43], a[96:99], v[128:131], 0
    s_add_u32 m0, s44, 36864
    ds_read_b64_tr_b16 a[64:65], v4 offset:36864
    ds_read_b64_tr_b16 a[66:67], v4 offset:36992
    v_mfma_f32_16x16x32_bf16 v[40:43], a[100:103], v[136:139], v[40:43]
    s_mov_b32 s45, 896
    s_waitcnt lgkmcnt(10)
    buffer_load_dwordx4 v7, s[28:31], s45 offen offset:0 lds
    v_mfma_f32_16x16x32_bf16 v[40:43], a[104:107], v[144:147], v[40:43]
    s_add_u32 m0, s44, 36768
    ds_read_b64_tr_b16 a[68:69], v4 offset:37120
    ds_read_b64_tr_b16 a[70:71], v4 offset:37248
    v_mfma_f32_16x16x32_bf16 v[40:43], a[108:111], v[152:155], v[40:43]
    s_waitcnt lgkmcnt(8)
    buffer_load_dwordx4 v7, s[28:31], s45 offen offset:1152 lds
    v_mfma_f32_16x16x32_bf16 v[40:43], a[112:115], v[192:195], v[40:43]
    s_add_u32 m0, s44, 36672
    ds_read_b64_tr_b16 a[72:73], v4 offset:37376
    ds_read_b64_tr_b16 a[74:75], v4 offset:37504
    v_mfma_f32_16x16x32_bf16 v[40:43], a[116:119], v[200:203], v[40:43]
    s_waitcnt lgkmcnt(6)
    buffer_load_dwordx4 v7, s[28:31], s45 offen offset:2304 lds
    v_mfma_f32_16x16x32_bf16 v[40:43], a[120:123], v[208:211], v[40:43]
    s_add_u32 m0, s44, 36576
    ds_read_b64_tr_b16 a[76:77], v4 offset:37632
    ds_read_b64_tr_b16 a[78:79], v4 offset:37760
    v_mfma_f32_16x16x32_bf16 v[40:43], a[124:127], v[216:219], v[40:43]
    buffer_load_dwordx4 v7, s[28:31], s45 offen offset:3456 lds
    v_mfma_f32_16x16x32_bf16 v[44:47], a[96:99], v[160:163], 0
    s_add_u32 m0, s44, 53760
    ds_read_b64_tr_b16 a[80:81], v4 offset:53760
    ds_read_b64_tr_b16 a[82:83], v4 offset:53888
    v_mfma_f32_16x16x32_bf16 v[44:47], a[100:103], v[168:171], v[44:47]
    s_mov_b32 s45, 148352
    buffer_load_dwordx4 v7, s[28:31], s45 offen offset:0 lds
    v_mfma_f32_16x16x32_bf16 v[44:47], a[104:107], v[176:179], v[44:47]
    s_add_u32 m0, s44, 53664
    ds_read_b64_tr_b16 a[84:85], v4 offset:54016
    ds_read_b64_tr_b16 a[86:87], v4 offset:54144
    v_mfma_f32_16x16x32_bf16 v[44:47], a[108:111], v[184:187], v[44:47]
    buffer_load_dwordx4 v7, s[28:31], s45 offen offset:1152 lds
    v_mfma_f32_16x16x32_bf16 v[44:47], a[112:115], v[224:227], v[44:47]
    s_add_u32 m0, s44, 53568
    ds_read_b64_tr_b16 a[88:89], v4 offset:54272
    ds_read_b64_tr_b16 a[90:91], v4 offset:54400
    v_mfma_f32_16x16x32_bf16 v[44:47], a[116:119], v[232:235], v[44:47]
    buffer_load_dwordx4 v7, s[28:31], s45 offen offset:2304 lds
    v_mfma_f32_16x16x32_bf16 v[44:47], a[120:123], v[240:243], v[44:47]
    s_add_u32 m0, s44, 53472
    ds_read_b64_tr_b16 a[92:93], v4 offset:54528
    ds_read_b64_tr_b16 a[94:95], v4 offset:54656
    v_mfma_f32_16x16x32_bf16 v[44:47], a[124:127], v[248:251], v[44:47]
    s_waitcnt lgkmcnt(12)
    buffer_load_dwordx4 v7, s[28:31], s45 offen offset:3456 lds
    v_mfma_f32_16x16x32_bf16 v[16:19], a[64:67], v[128:131], 0
    ds_read_b64_tr_b16 a[96:97], v4 offset:36896
    v_cvt_pk_bf16_f32 v48, v32, v33
    v_mfma_f32_16x16x32_bf16 v[16:19], a[68:71], v[136:139], v[16:19]
    s_waitcnt lgkmcnt(9)
    ds_read_b64_tr_b16 a[98:99], v4 offset:37024
    v_cvt_pk_bf16_f32 v49, v34, v35
    v_mfma_f32_16x16x32_bf16 v[16:19], a[72:75], v[144:147], v[16:19]
    ds_read_b64_tr_b16 a[100:101], v4 offset:37152
    v_cvt_pk_bf16_f32 v50, v40, v41
    v_mfma_f32_16x16x32_bf16 v[16:19], a[76:79], v[152:155], v[16:19]
    s_waitcnt lgkmcnt(7)
    ds_read_b64_tr_b16 a[102:103], v4 offset:37280
    v_cvt_pk_bf16_f32 v51, v42, v43
    v_mfma_f32_16x16x32_bf16 v[16:19], a[80:83], v[192:195], v[16:19]
    s_mov_b32 s54, 4096
    ds_read_b64_tr_b16 a[104:105], v4 offset:37408
    ds_read_b64_tr_b16 a[106:107], v4 offset:37536
    v_mfma_f32_16x16x32_bf16 v[16:19], a[84:87], v[200:203], v[16:19]
    s_waitcnt lgkmcnt(6)
    v_permlane32_swap_b32 v48, v50
    v_mfma_f32_16x16x32_bf16 v[16:19], a[88:91], v[208:211], v[16:19]
    v_permlane32_swap_b32 v49, v51
    v_mfma_f32_16x16x32_bf16 v[16:19], a[92:95], v[216:219], v[16:19]
    ds_read_b64_tr_b16 a[108:109], v4 offset:37664
    ds_read_b64_tr_b16 a[110:111], v4 offset:37792
    buffer_store_dwordx4 v[48:51], v10, s[40:43], s54 offen offset:512 sc1
    v_mfma_f32_16x16x32_bf16 v[20:23], a[64:67], v[160:163], 0
    ds_read_b64_tr_b16 a[112:113], v4 offset:53792
    v_cvt_pk_bf16_f32 v52, v36, v37
    v_mfma_f32_16x16x32_bf16 v[20:23], a[68:71], v[168:171], v[20:23]
    ds_read_b64_tr_b16 a[114:115], v4 offset:53920
    v_cvt_pk_bf16_f32 v53, v38, v39
    v_mfma_f32_16x16x32_bf16 v[20:23], a[72:75], v[176:179], v[20:23]
    ds_read_b64_tr_b16 a[116:117], v4 offset:54048
    v_cvt_pk_bf16_f32 v54, v44, v45
    v_mfma_f32_16x16x32_bf16 v[20:23], a[76:79], v[184:187], v[20:23]
    ds_read_b64_tr_b16 a[118:119], v4 offset:54176
    v_cvt_pk_bf16_f32 v55, v46, v47
    v_mfma_f32_16x16x32_bf16 v[20:23], a[80:83], v[224:227], v[20:23]
    s_mov_b32 s54, 299008
    ds_read_b64_tr_b16 a[120:121], v4 offset:54304
    ds_read_b64_tr_b16 a[122:123], v4 offset:54432
    v_mfma_f32_16x16x32_bf16 v[20:23], a[84:87], v[232:235], v[20:23]
    v_permlane32_swap_b32 v52, v54
    v_mfma_f32_16x16x32_bf16 v[20:23], a[88:91], v[240:243], v[20:23]
    v_permlane32_swap_b32 v53, v55
    v_mfma_f32_16x16x32_bf16 v[20:23], a[92:95], v[248:251], v[20:23]
    s_waitcnt lgkmcnt(10)
    ds_read_b64_tr_b16 a[124:125], v4 offset:54560
    ds_read_b64_tr_b16 a[126:127], v4 offset:54688
    buffer_store_dwordx4 v[52:55], v10, s[40:43], s54 offen offset:512 sc1
    v_mfma_f32_16x16x32_bf16 v[24:27], a[96:99], v[128:131], 0
    ds_read_b64_tr_b16 a[64:65], v4 offset:36928
    v_mfma_f32_16x16x32_bf16 v[24:27], a[100:103], v[136:139], v[24:27]
    s_waitcnt lgkmcnt(9)
    ds_read_b64_tr_b16 a[66:67], v4 offset:37056
    v_mfma_f32_16x16x32_bf16 v[24:27], a[104:107], v[144:147], v[24:27]
L2_pad12:
    s_cbranch_execz L2_walkret
    ds_read_b64_tr_b16 a[68:69], v4 offset:37184
    v_mfma_f32_16x16x32_bf16 v[24:27], a[108:111], v[152:155], v[24:27]
    s_waitcnt lgkmcnt(7)
    ds_read_b64_tr_b16 a[70:71], v4 offset:37312
    v_mfma_f32_16x16x32_bf16 v[24:27], a[112:115], v[192:195], v[24:27]
    ds_read_b64_tr_b16 a[72:73], v4 offset:37440
    v_mfma_f32_16x16x32_bf16 v[24:27], a[116:119], v[200:203], v[24:27]
    s_waitcnt lgkmcnt(5)
    ds_read_b64_tr_b16 a[74:75], v4 offset:37568
    v_mfma_f32_16x16x32_bf16 v[24:27], a[120:123], v[208:211], v[24:27]
    ds_read_b64_tr_b16 a[76:77], v4 offset:37696
    v_mfma_f32_16x16x32_bf16 v[24:27], a[124:127], v[216:219], v[24:27]
    ds_read_b64_tr_b16 a[78:79], v4 offset:37824
    v_mfma_f32_16x16x32_bf16 v[28:31], a[96:99], v[160:163], 0
    ds_read_b64_tr_b16 a[80:81], v4 offset:53824
    v_mfma_f32_16x16x32_bf16 v[28:31], a[100:103], v[168:171], v[28:31]
    ds_read_b64_tr_b16 a[82:83], v4 offset:53952
    v_mfma_f32_16x16x32_bf16 v[28:31], a[104:107], v[176:179], v[28:31]
    ds_read_b64_tr_b16 a[84:85], v4 offset:54080
    v_mfma_f32_16x16x32_bf16 v[28:31], a[108:111], v[184:187], v[28:31]
    ds_read_b64_tr_b16 a[86:87], v4 offset:54208
    v_mfma_f32_16x16x32_bf16 v[28:31], a[112:115], v[224:227], v[28:31]
    ds_read_b64_tr_b16 a[88:89], v4 offset:54336
    v_mfma_f32_16x16x32_bf16 v[28:31], a[116:119], v[232:235], v[28:31]
    ds_read_b64_tr_b16 a[90:91], v4 offset:54464
    v_mfma_f32_16x16x32_bf16 v[28:31], a[120:123], v[240:243], v[28:31]
    ds_read_b64_tr_b16 a[92:93], v4 offset:54592
    v_mfma_f32_16x16x32_bf16 v[28:31], a[124:127], v[248:251], v[28:31]
    s_waitcnt lgkmcnt(11)
    ds_read_b64_tr_b16 a[94:95], v4 offset:54720
    v_mfma_f32_16x16x32_bf16 v[32:35], a[64:67], v[128:131], 0
    ds_read_b64_tr_b16 a[96:97], v4 offset:36960
    v_cvt_pk_bf16_f32 v48, v16, v17
    v_mfma_f32_16x16x32_bf16 v[32:35], a[68:71], v[136:139], v[32:35]
    s_waitcnt lgkmcnt(9)
    ds_read_b64_tr_b16 a[98:99], v4 offset:37088
    v_cvt_pk_bf16_f32 v49, v18, v19
    v_mfma_f32_16x16x32_bf16 v[32:35], a[72:75], v[144:147], v[32:35]
    ds_read_b64_tr_b16 a[100:101], v4 offset:37216
    v_cvt_pk_bf16_f32 v50, v24, v25
    v_mfma_f32_16x16x32_bf16 v[32:35], a[76:79], v[152:155], v[32:35]
    s_waitcnt lgkmcnt(7)
    ds_read_b64_tr_b16 a[102:103], v4 offset:37344
    v_cvt_pk_bf16_f32 v51, v26, v27
    v_mfma_f32_16x16x32_bf16 v[32:35], a[80:83], v[192:195], v[32:35]
    s_mov_b32 s54, 5120
    ds_read_b64_tr_b16 a[104:105], v4 offset:37472
    ds_read_b64_tr_b16 a[106:107], v4 offset:37600
    v_mfma_f32_16x16x32_bf16 v[32:35], a[84:87], v[200:203], v[32:35]
    s_waitcnt lgkmcnt(6)
    v_permlane32_swap_b32 v48, v50
    v_mfma_f32_16x16x32_bf16 v[32:35], a[88:91], v[208:211], v[32:35]
    v_permlane32_swap_b32 v49, v51
    v_mfma_f32_16x16x32_bf16 v[32:35], a[92:95], v[216:219], v[32:35]
    ds_read_b64_tr_b16 a[108:109], v4 offset:37728
    ds_read_b64_tr_b16 a[110:111], v4 offset:37856
    buffer_store_dwordx4 v[48:51], v10, s[40:43], s54 offen offset:0 sc1
    v_mfma_f32_16x16x32_bf16 v[36:39], a[64:67], v[160:163], 0
    ds_read_b64_tr_b16 a[112:113], v4 offset:53856
    v_cvt_pk_bf16_f32 v52, v20, v21
    v_mfma_f32_16x16x32_bf16 v[36:39], a[68:71], v[168:171], v[36:39]
    ds_read_b64_tr_b16 a[114:115], v4 offset:53984
    v_cvt_pk_bf16_f32 v53, v22, v23
    v_mfma_f32_16x16x32_bf16 v[36:39], a[72:75], v[176:179], v[36:39]
    ds_read_b64_tr_b16 a[116:117], v4 offset:54112
    v_cvt_pk_bf16_f32 v54, v28, v29
    v_mfma_f32_16x16x32_bf16 v[36:39], a[76:79], v[184:187], v[36:39]
    ds_read_b64_tr_b16 a[118:119], v4 offset:54240
    v_cvt_pk_bf16_f32 v55, v30, v31
    v_mfma_f32_16x16x32_bf16 v[36:39], a[80:83], v[224:227], v[36:39]
    s_mov_b32 s54, 300032
    ds_read_b64_tr_b16 a[120:121], v4 offset:54368
    ds_read_b64_tr_b16 a[122:123], v4 offset:54496
    v_mfma_f32_16x16x32_bf16 v[36:39], a[84:87], v[232:235], v[36:39]
    v_permlane32_swap_b32 v52, v54
    v_mfma_f32_16x16x32_bf16 v[36:39], a[88:91], v[240:243], v[36:39]
    v_permlane32_swap_b32 v53, v55
    v_mfma_f32_16x16x32_bf16 v[36:39], a[92:95], v[248:251], v[36:39]
    s_waitcnt vmcnt(15)
    s_barrier
    s_waitcnt lgkmcnt(10)
    ds_read_b64_tr_b16 a[124:125], v4 offset:54624
    ds_read_b64_tr_b16 a[126:127], v4 offset:54752
    buffer_store_dwordx4 v[52:55], v10, s[40:43], s54 offen offset:0 sc1
    v_mfma_f32_16x16x32_bf16 v[40:43], a[96:99], v[128:131], 0
    s_add_u32 m0, s44, 73728
    ds_read_b64_tr_b16 a[64:65], v3 offset:0
    ds_read_b64_tr_b16 a[66:67], v3 offset:128
    v_mfma_f32_16x16x32_bf16 v[40:43], a[100:103], v[136:139], v[40:43]
    s_mov_b32 s45, 1024
    s_waitcnt lgkmcnt(10)
    buffer_load_dwordx4 v7, s[28:31], s45 offen offset:0 lds
    v_mfma_f32_16x16x32_bf16 v[40:43], a[104:107], v[144:147], v[40:43]
    s_add_u32 m0, s44, 73632
    ds_read_b64_tr_b16 a[68:69], v3 offset:256
    ds_read_b64_tr_b16 a[70:71], v3 offset:384
    v_mfma_f32_16x16x32_bf16 v[40:43], a[108:111], v[152:155], v[40:43]
    s_waitcnt lgkmcnt(8)
    buffer_load_dwordx4 v7, s[28:31], s45 offen offset:1152 lds
    v_mfma_f32_16x16x32_bf16 v[40:43], a[112:115], v[192:195], v[40:43]
    s_add_u32 m0, s44, 73536
    ds_read_b64_tr_b16 a[72:73], v3 offset:512
    ds_read_b64_tr_b16 a[74:75], v3 offset:640
    v_mfma_f32_16x16x32_bf16 v[40:43], a[116:119], v[200:203], v[40:43]
    s_waitcnt lgkmcnt(6)
    buffer_load_dwordx4 v7, s[28:31], s45 offen offset:2304 lds
    v_mfma_f32_16x16x32_bf16 v[40:43], a[120:123], v[208:211], v[40:43]
    s_add_u32 m0, s44, 73440
    ds_read_b64_tr_b16 a[76:77], v3 offset:768
    ds_read_b64_tr_b16 a[78:79], v3 offset:896
    v_mfma_f32_16x16x32_bf16 v[40:43], a[124:127], v[216:219], v[40:43]
    buffer_load_dwordx4 v7, s[28:31], s45 offen offset:3456 lds
    v_mfma_f32_16x16x32_bf16 v[44:47], a[96:99], v[160:163], 0
    s_add_u32 m0, s44, 90624
    ds_read_b64_tr_b16 a[80:81], v3 offset:16896
    ds_read_b64_tr_b16 a[82:83], v3 offset:17024
    v_mfma_f32_16x16x32_bf16 v[44:47], a[100:103], v[168:171], v[44:47]
    s_mov_b32 s45, 148480
    buffer_load_dwordx4 v7, s[28:31], s45 offen offset:0 lds
    v_mfma_f32_16x16x32_bf16 v[44:47], a[104:107], v[176:179], v[44:47]
    s_add_u32 m0, s44, 90528
    ds_read_b64_tr_b16 a[84:85], v3 offset:17152
    ds_read_b64_tr_b16 a[86:87], v3 offset:17280
    v_mfma_f32_16x16x32_bf16 v[44:47], a[108:111], v[184:187], v[44:47]
    buffer_load_dwordx4 v7, s[28:31], s45 offen offset:1152 lds
    v_mfma_f32_16x16x32_bf16 v[44:47], a[112:115], v[224:227], v[44:47]
    s_add_u32 m0, s44, 90432
    ds_read_b64_tr_b16 a[88:89], v3 offset:17408
    ds_read_b64_tr_b16 a[90:91], v3 offset:17536
    v_mfma_f32_16x16x32_bf16 v[44:47], a[116:119], v[232:235], v[44:47]
    buffer_load_dwordx4 v7, s[28:31], s45 offen offset:2304 lds
    v_mfma_f32_16x16x32_bf16 v[44:47], a[120:123], v[240:243], v[44:47]
    s_add_u32 m0, s44, 90336
    ds_read_b64_tr_b16 a[92:93], v3 offset:17664
    ds_read_b64_tr_b16 a[94:95], v3 offset:17792
    v_mfma_f32_16x16x32_bf16 v[44:47], a[124:127], v[248:251], v[44:47]
    s_waitcnt lgkmcnt(12)
    buffer_load_dwordx4 v7, s[28:31], s45 offen offset:3456 lds
    v_mfma_f32_16x16x32_bf16 v[16:19], a[64:67], v[128:131], 0
    ds_read_b64_tr_b16 a[96:97], v3 offset:32
    v_cvt_pk_bf16_f32 v48, v32, v33
    v_mfma_f32_16x16x32_bf16 v[16:19], a[68:71], v[136:139], v[16:19]
    s_waitcnt lgkmcnt(9)
    ds_read_b64_tr_b16 a[98:99], v3 offset:160
    v_cvt_pk_bf16_f32 v49, v34, v35
    v_mfma_f32_16x16x32_bf16 v[16:19], a[72:75], v[144:147], v[16:19]
    ds_read_b64_tr_b16 a[100:101], v3 offset:288
    v_cvt_pk_bf16_f32 v50, v40, v41
    v_mfma_f32_16x16x32_bf16 v[16:19], a[76:79], v[152:155], v[16:19]
    s_waitcnt lgkmcnt(7)
    ds_read_b64_tr_b16 a[102:103], v3 offset:416
    v_cvt_pk_bf16_f32 v51, v42, v43
    v_mfma_f32_16x16x32_bf16 v[16:19], a[80:83], v[192:195], v[16:19]
    s_mov_b32 s54, 5120
    ds_read_b64_tr_b16 a[104:105], v3 offset:544
    ds_read_b64_tr_b16 a[106:107], v3 offset:672
    v_mfma_f32_16x16x32_bf16 v[16:19], a[84:87], v[200:203], v[16:19]
    s_waitcnt lgkmcnt(6)
    v_permlane32_swap_b32 v48, v50
    v_mfma_f32_16x16x32_bf16 v[16:19], a[88:91], v[208:211], v[16:19]
    v_permlane32_swap_b32 v49, v51
    v_mfma_f32_16x16x32_bf16 v[16:19], a[92:95], v[216:219], v[16:19]
    ds_read_b64_tr_b16 a[108:109], v3 offset:800
    ds_read_b64_tr_b16 a[110:111], v3 offset:928
    buffer_store_dwordx4 v[48:51], v10, s[40:43], s54 offen offset:512 sc1
    v_mfma_f32_16x16x32_bf16 v[20:23], a[64:67], v[160:163], 0
    ds_read_b64_tr_b16 a[112:113], v3 offset:16928
    v_cvt_pk_bf16_f32 v52, v36, v37
    v_mfma_f32_16x16x32_bf16 v[20:23], a[68:71], v[168:171], v[20:23]
    ds_read_b64_tr_b16 a[114:115], v3 offset:17056
    v_cvt_pk_bf16_f32 v53, v38, v39
    v_mfma_f32_16x16x32_bf16 v[20:23], a[72:75], v[176:179], v[20:23]
    ds_read_b64_tr_b16 a[116:117], v3 offset:17184
    v_cvt_pk_bf16_f32 v54, v44, v45
    v_mfma_f32_16x16x32_bf16 v[20:23], a[76:79], v[184:187], v[20:23]
    ds_read_b64_tr_b16 a[118:119], v3 offset:17312
    v_cvt_pk_bf16_f32 v55, v46, v47
    v_mfma_f32_16x16x32_bf16 v[20:23], a[80:83], v[224:227], v[20:23]
    s_mov_b32 s54, 300032
    ds_read_b64_tr_b16 a[120:121], v3 offset:17440
    ds_read_b64_tr_b16 a[122:123], v3 offset:17568
    v_mfma_f32_16x16x32_bf16 v[20:23], a[84:87], v[232:235], v[20:23]
    v_permlane32_swap_b32 v52, v54
    v_mfma_f32_16x16x32_bf16 v[20:23], a[88:91], v[240:243], v[20:23]
    v_permlane32_swap_b32 v53, v55
    v_mfma_f32_16x16x32_bf16 v[20:23], a[92:95], v[248:251], v[20:23]
    s_waitcnt lgkmcnt(10)
    ds_read_b64_tr_b16 a[124:125], v3 offset:17696
    ds_read_b64_tr_b16 a[126:127], v3 offset:17824
    buffer_store_dwordx4 v[52:55], v10, s[40:43], s54 offen offset:512 sc1
    v_mfma_f32_16x16x32_bf16 v[24:27], a[96:99], v[128:131], 0
    ds_read_b64_tr_b16 a[64:65], v3 offset:64
    v_mfma_f32_16x16x32_bf16 v[24:27], a[100:103], v[136:139], v[24:27]
    s_waitcnt lgkmcnt(9)
    ds_read_b64_tr_b16 a[66:67], v3 offset:192
    v_mfma_f32_16x16x32_bf16 v[24:27], a[104:107], v[144:147], v[24:27]
    ds_read_b64_tr_b16 a[68:69], v3 offset:320
    v_mfma_f32_16x16x32_bf16 v[24:27], a[108:111], v[152:155], v[24:27]
    s_waitcnt lgkmcnt(7)
    ds_read_b64_tr_b16 a[70:71], v3 offset:448
    v_mfma_f32_16x16x32_bf16 v[24:27], a[112:115], v[192:195], v[24:27]
    ds_read_b64_tr_b16 a[72:73], v3 offset:576
    v_mfma_f32_16x16x32_bf16 v[24:27], a[116:119], v[200:203], v[24:27]
    s_waitcnt lgkmcnt(5)
    ds_read_b64_tr_b16 a[74:75], v3 offset:704
    v_mfma_f32_16x16x32_bf16 v[24:27], a[120:123], v[208:211], v[24:27]
    ds_read_b64_tr_b16 a[76:77], v3 offset:832
    v_mfma_f32_16x16x32_bf16 v[24:27], a[124:127], v[216:219], v[24:27]
    ds_read_b64_tr_b16 a[78:79], v3 offset:960
    v_mfma_f32_16x16x32_bf16 v[28:31], a[96:99], v[160:163], 0
    ds_read_b64_tr_b16 a[80:81], v3 offset:16960
    v_mfma_f32_16x16x32_bf16 v[28:31], a[100:103], v[168:171], v[28:31]
    ds_read_b64_tr_b16 a[82:83], v3 offset:17088
    v_mfma_f32_16x16x32_bf16 v[28:31], a[104:107], v[176:179], v[28:31]
    ds_read_b64_tr_b16 a[84:85], v3 offset:17216
    v_mfma_f32_16x16x32_bf16 v[28:31], a[108:111], v[184:187], v[28:31]
    ds_read_b64_tr_b16 a[86:87], v3 offset:17344
    v_mfma_f32_16x16x32_bf16 v[28:31], a[112:115], v[224:227], v[28:31]
    ds_read_b64_tr_b16 a[88:89], v3 offset:17472
    v_mfma_f32_16x16x32_bf16 v[28:31], a[116:119], v[232:235], v[28:31]
    ds_read_b64_tr_b16 a[90:91], v3 offset:17600
    v_mfma_f32_16x16x32_bf16 v[28:31], a[120:123], v[240:243], v[28:31]
    ds_read_b64_tr_b16 a[92:93], v3 offset:17728
    v_mfma_f32_16x16x32_bf16 v[28:31], a[124:127], v[248:251], v[28:31]
    s_waitcnt lgkmcnt(11)
    ds_read_b64_tr_b16 a[94:95], v3 offset:17856
    v_mfma_f32_16x16x32_bf16 v[32:35], a[64:67], v[128:131], 0
    ds_read_b64_tr_b16 a[96:97], v3 offset:96
    v_cvt_pk_bf16_f32 v48, v16, v17
    v_mfma_f32_16x16x32_bf16 v[32:35], a[68:71], v[136:139], v[32:35]
    s_waitcnt lgkmcnt(9)
    ds_read_b64_tr_b16 a[98:99], v3 offset:224
    v_cvt_pk_bf16_f32 v49, v18, v19
    v_mfma_f32_16x16x32_bf16 v[32:35], a[72:75], v[144:147], v[32:35]
    ds_read_b64_tr_b16 a[100:101], v3 offset:352
    v_cvt_pk_bf16_f32 v50, v24, v25
    v_mfma_f32_16x16x32_bf16 v[32:35], a[76:79], v[152:155], v[32:35]
    s_waitcnt lgkmcnt(7)
    ds_read_b64_tr_b16 a[102:103], v3 offset:480
    v_cvt_pk_bf16_f32 v51, v26, v27
    v_mfma_f32_16x16x32_bf16 v[32:35], a[80:83], v[192:195], v[32:35]
    s_mov_b32 s54, 6144
    ds_read_b64_tr_b16 a[104:105], v3 offset:608
    ds_read_b64_tr_b16 a[106:107], v3 offset:736
    v_mfma_f32_16x16x32_bf16 v[32:35], a[84:87], v[200:203], v[32:35]
    s_waitcnt lgkmcnt(6)
    v_permlane32_swap_b32 v48, v50
    v_mfma_f32_16x16x32_bf16 v[32:35], a[88:91], v[208:211], v[32:35]
    v_permlane32_swap_b32 v49, v51
    v_mfma_f32_16x16x32_bf16 v[32:35], a[92:95], v[216:219], v[32:35]
    ds_read_b64_tr_b16 a[108:109], v3 offset:864
    ds_read_b64_tr_b16 a[110:111], v3 offset:992
    buffer_store_dwordx4 v[48:51], v10, s[40:43], s54 offen offset:0 sc1
    v_mfma_f32_16x16x32_bf16 v[36:39], a[64:67], v[160:163], 0
    ds_read_b64_tr_b16 a[112:113], v3 offset:16992
    v_cvt_pk_bf16_f32 v52, v20, v21
    v_mfma_f32_16x16x32_bf16 v[36:39], a[68:71], v[168:171], v[36:39]
    ds_read_b64_tr_b16 a[114:115], v3 offset:17120
    v_cvt_pk_bf16_f32 v53, v22, v23
    v_mfma_f32_16x16x32_bf16 v[36:39], a[72:75], v[176:179], v[36:39]
    ds_read_b64_tr_b16 a[116:117], v3 offset:17248
    v_cvt_pk_bf16_f32 v54, v28, v29
    v_mfma_f32_16x16x32_bf16 v[36:39], a[76:79], v[184:187], v[36:39]
    ds_read_b64_tr_b16 a[118:119], v3 offset:17376
    v_cvt_pk_bf16_f32 v55, v30, v31
    v_mfma_f32_16x16x32_bf16 v[36:39], a[80:83], v[224:227], v[36:39]
    s_mov_b32 s54, 301056
    ds_read_b64_tr_b16 a[120:121], v3 offset:17504
    ds_read_b64_tr_b16 a[122:123], v3 offset:17632
    v_mfma_f32_16x16x32_bf16 v[36:39], a[84:87], v[232:235], v[36:39]
    v_permlane32_swap_b32 v52, v54
    v_mfma_f32_16x16x32_bf16 v[36:39], a[88:91], v[240:243], v[36:39]
    v_permlane32_swap_b32 v53, v55
    v_mfma_f32_16x16x32_bf16 v[36:39], a[92:95], v[248:251], v[36:39]
    s_waitcnt vmcnt(15)
    s_barrier
    s_waitcnt lgkmcnt(10)
    ds_read_b64_tr_b16 a[124:125], v3 offset:17760
    ds_read_b64_tr_b16 a[126:127], v3 offset:17888
    buffer_store_dwordx4 v[52:55], v10, s[40:43], s54 offen offset:0 sc1
    v_mfma_f32_16x16x32_bf16 v[40:43], a[96:99], v[128:131], 0
    ds_read_b64_tr_b16 a[64:65], v3 offset:36864
    v_mfma_f32_16x16x32_bf16 v[40:43], a[100:103], v[136:139], v[40:43]
    s_waitcnt lgkmcnt(9)
    ds_read_b64_tr_b16 a[66:67], v3 offset:36992
    v_mfma_f32_16x16x32_bf16 v[40:43], a[104:107], v[144:147], v[40:43]
    ds_read_b64_tr_b16 a[68:69], v3 offset:37120
    v_mfma_f32_16x16x32_bf16 v[40:43], a[108:111], v[152:155], v[40:43]
    s_waitcnt lgkmcnt(7)
    ds_read_b64_tr_b16 a[70:71], v3 offset:37248
    v_mfma_f32_16x16x32_bf16 v[40:43], a[112:115], v[192:195], v[40:43]
    ds_read_b64_tr_b16 a[72:73], v3 offset:37376
    v_mfma_f32_16x16x32_bf16 v[40:43], a[116:119], v[200:203], v[40:43]
    s_waitcnt lgkmcnt(5)
    ds_read_b64_tr_b16 a[74:75], v3 offset:37504
    v_mfma_f32_16x16x32_bf16 v[40:43], a[120:123], v[208:211], v[40:43]
    ds_read_b64_tr_b16 a[76:77], v3 offset:37632
    v_mfma_f32_16x16x32_bf16 v[40:43], a[124:127], v[216:219], v[40:43]
    ds_read_b64_tr_b16 a[78:79], v3 offset:37760
    v_mfma_f32_16x16x32_bf16 v[44:47], a[96:99], v[160:163], 0
    s_sub_u32 s28, s88, 4096
    s_subb_u32 s29, s89, 0
    ds_read_b64_tr_b16 a[80:81], v3 offset:53760
    v_mfma_f32_16x16x32_bf16 v[44:47], a[100:103], v[168:171], v[44:47]
    s_mov_b32 s30, 147456
    ds_read_b64_tr_b16 a[82:83], v3 offset:53888
    v_mfma_f32_16x16x32_bf16 v[44:47], a[104:107], v[176:179], v[44:47]
    ds_read_b64_tr_b16 a[84:85], v3 offset:54016
    v_mfma_f32_16x16x32_bf16 v[44:47], a[108:111], v[184:187], v[44:47]
    ds_read_b64_tr_b16 a[86:87], v3 offset:54144
    v_mfma_f32_16x16x32_bf16 v[44:47], a[112:115], v[224:227], v[44:47]
    ds_read_b64_tr_b16 a[88:89], v3 offset:54272
    v_mfma_f32_16x16x32_bf16 v[44:47], a[116:119], v[232:235], v[44:47]
    ds_read_b64_tr_b16 a[90:91], v3 offset:54400
    v_mfma_f32_16x16x32_bf16 v[44:47], a[120:123], v[240:243], v[44:47]
    ds_read_b64_tr_b16 a[92:93], v3 offset:54528
    v_mfma_f32_16x16x32_bf16 v[44:47], a[124:127], v[248:251], v[44:47]
    s_waitcnt lgkmcnt(11)
    ds_read_b64_tr_b16 a[94:95], v3 offset:54656
    v_mfma_f32_16x16x32_bf16 v[16:19], a[64:67], v[128:131], 0
    ds_read_b64_tr_b16 a[96:97], v3 offset:36896
    v_cvt_pk_bf16_f32 v48, v32, v33
    v_mfma_f32_16x16x32_bf16 v[16:19], a[68:71], v[136:139], v[16:19]
    s_waitcnt lgkmcnt(9)
    ds_read_b64_tr_b16 a[98:99], v3 offset:37024
    v_cvt_pk_bf16_f32 v49, v34, v35
    v_mfma_f32_16x16x32_bf16 v[16:19], a[72:75], v[144:147], v[16:19]
    ds_read_b64_tr_b16 a[100:101], v3 offset:37152
    v_cvt_pk_bf16_f32 v50, v40, v41
    v_mfma_f32_16x16x32_bf16 v[16:19], a[76:79], v[152:155], v[16:19]
    s_waitcnt lgkmcnt(7)
    ds_read_b64_tr_b16 a[102:103], v3 offset:37280
    v_cvt_pk_bf16_f32 v51, v42, v43
    v_mfma_f32_16x16x32_bf16 v[16:19], a[80:83], v[192:195], v[16:19]
    s_mov_b32 s54, 6144
    ds_read_b64_tr_b16 a[104:105], v3 offset:37408
    ds_read_b64_tr_b16 a[106:107], v3 offset:37536
    v_mfma_f32_16x16x32_bf16 v[16:19], a[84:87], v[200:203], v[16:19]
    s_waitcnt lgkmcnt(6)
    v_permlane32_swap_b32 v48, v50
    v_mfma_f32_16x16x32_bf16 v[16:19], a[88:91], v[208:211], v[16:19]
    v_permlane32_swap_b32 v49, v51
    v_mfma_f32_16x16x32_bf16 v[16:19], a[92:95], v[216:219], v[16:19]
    ds_read_b64_tr_b16 a[108:109], v3 offset:37664
    ds_read_b64_tr_b16 a[110:111], v3 offset:37792
    buffer_store_dwordx4 v[48:51], v10, s[40:43], s54 offen offset:512 sc1
    v_mfma_f32_16x16x32_bf16 v[20:23], a[64:67], v[160:163], 0
    ds_read_b64_tr_b16 a[112:113], v3 offset:53792
    v_cvt_pk_bf16_f32 v52, v36, v37
    v_mfma_f32_16x16x32_bf16 v[20:23], a[68:71], v[168:171], v[20:23]
    ds_read_b64_tr_b16 a[114:115], v3 offset:53920
    v_cvt_pk_bf16_f32 v53, v38, v39
    v_mfma_f32_16x16x32_bf16 v[20:23], a[72:75], v[176:179], v[20:23]
    ds_read_b64_tr_b16 a[116:117], v3 offset:54048
    v_cvt_pk_bf16_f32 v54, v44, v45
    v_mfma_f32_16x16x32_bf16 v[20:23], a[76:79], v[184:187], v[20:23]
    ds_read_b64_tr_b16 a[118:119], v3 offset:54176
    v_cvt_pk_bf16_f32 v55, v46, v47
    v_mfma_f32_16x16x32_bf16 v[20:23], a[80:83], v[224:227], v[20:23]
    s_mov_b32 s54, 301056
    ds_read_b64_tr_b16 a[120:121], v3 offset:54304
    ds_read_b64_tr_b16 a[122:123], v3 offset:54432
    v_mfma_f32_16x16x32_bf16 v[20:23], a[84:87], v[232:235], v[20:23]
    v_permlane32_swap_b32 v52, v54
    v_mfma_f32_16x16x32_bf16 v[20:23], a[88:91], v[240:243], v[20:23]
    v_permlane32_swap_b32 v53, v55
    v_mfma_f32_16x16x32_bf16 v[20:23], a[92:95], v[248:251], v[20:23]
    s_waitcnt lgkmcnt(10)
    ds_read_b64_tr_b16 a[124:125], v3 offset:54560
    ds_read_b64_tr_b16 a[126:127], v3 offset:54688
    buffer_store_dwordx4 v[52:55], v10, s[40:43], s54 offen offset:512 sc1
    v_mfma_f32_16x16x32_bf16 v[24:27], a[96:99], v[128:131], 0
    ds_read_b64_tr_b16 a[64:65], v3 offset:36928
    v_mfma_f32_16x16x32_bf16 v[24:27], a[100:103], v[136:139], v[24:27]
    s_waitcnt lgkmcnt(9)
    ds_read_b64_tr_b16 a[66:67], v3 offset:37056
    v_mfma_f32_16x16x32_bf16 v[24:27], a[104:107], v[144:147], v[24:27]
    ds_read_b64_tr_b16 a[68:69], v3 offset:37184
    v_mfma_f32_16x16x32_bf16 v[24:27], a[108:111], v[152:155], v[24:27]
    s_waitcnt lgkmcnt(7)
    ds_read_b64_tr_b16 a[70:71], v3 offset:37312
    v_mfma_f32_16x16x32_bf16 v[24:27], a[112:115], v[192:195], v[24:27]
    ds_read_b64_tr_b16 a[72:73], v3 offset:37440
    v_mfma_f32_16x16x32_bf16 v[24:27], a[116:119], v[200:203], v[24:27]
    s_waitcnt lgkmcnt(5)
    ds_read_b64_tr_b16 a[74:75], v3 offset:37568
    v_mfma_f32_16x16x32_bf16 v[24:27], a[120:123], v[208:211], v[24:27]
    ds_read_b64_tr_b16 a[76:77], v3 offset:37696
    v_mfma_f32_16x16x32_bf16 v[24:27], a[124:127], v[216:219], v[24:27]
    ds_read_b64_tr_b16 a[78:79], v3 offset:37824
    v_mfma_f32_16x16x32_bf16 v[28:31], a[96:99], v[160:163], 0
    ds_read_b64_tr_b16 a[80:81], v3 offset:53824
    v_mfma_f32_16x16x32_bf16 v[28:31], a[100:103], v[168:171], v[28:31]
    ds_read_b64_tr_b16 a[82:83], v3 offset:53952
    v_mfma_f32_16x16x32_bf16 v[28:31], a[104:107], v[176:179], v[28:31]
    ds_read_b64_tr_b16 a[84:85], v3 offset:54080
    v_mfma_f32_16x16x32_bf16 v[28:31], a[108:111], v[184:187], v[28:31]
    ds_read_b64_tr_b16 a[86:87], v3 offset:54208
    v_mfma_f32_16x16x32_bf16 v[28:31], a[112:115], v[224:227], v[28:31]
    ds_read_b64_tr_b16 a[88:89], v3 offset:54336
    v_mfma_f32_16x16x32_bf16 v[28:31], a[116:119], v[232:235], v[28:31]
    ds_read_b64_tr_b16 a[90:91], v3 offset:54464
    v_mfma_f32_16x16x32_bf16 v[28:31], a[120:123], v[240:243], v[28:31]
    ds_read_b64_tr_b16 a[92:93], v3 offset:54592
    v_mfma_f32_16x16x32_bf16 v[28:31], a[124:127], v[248:251], v[28:31]
    s_waitcnt lgkmcnt(11)
    ds_read_b64_tr_b16 a[94:95], v3 offset:54720
    v_mfma_f32_16x16x32_bf16 v[32:35], a[64:67], v[128:131], 0
    ds_read_b64_tr_b16 a[96:97], v3 offset:36960
    v_cvt_pk_bf16_f32 v48, v16, v17
    v_mfma_f32_16x16x32_bf16 v[32:35], a[68:71], v[136:139], v[32:35]
    s_waitcnt lgkmcnt(9)
    ds_read_b64_tr_b16 a[98:99], v3 offset:37088
    v_cvt_pk_bf16_f32 v49, v18, v19
    v_mfma_f32_16x16x32_bf16 v[32:35], a[72:75], v[144:147], v[32:35]
    ds_read_b64_tr_b16 a[100:101], v3 offset:37216
    v_cvt_pk_bf16_f32 v50, v24, v25
    v_mfma_f32_16x16x32_bf16 v[32:35], a[76:79], v[152:155], v[32:35]
    s_waitcnt lgkmcnt(7)
    ds_read_b64_tr_b16 a[102:103], v3 offset:37344
    v_cvt_pk_bf16_f32 v51, v26, v27
    v_mfma_f32_16x16x32_bf16 v[32:35], a[80:83], v[192:195], v[32:35]
    s_mov_b32 s54, 7168
    ds_read_b64_tr_b16 a[104:105], v3 offset:37472
    ds_read_b64_tr_b16 a[106:107], v3 offset:37600
    v_mfma_f32_16x16x32_bf16 v[32:35], a[84:87], v[200:203], v[32:35]
    s_waitcnt lgkmcnt(6)
    v_permlane32_swap_b32 v48, v50
    v_mfma_f32_16x16x32_bf16 v[32:35], a[88:91], v[208:211], v[32:35]
    v_permlane32_swap_b32 v49, v51
    v_mfma_f32_16x16x32_bf16 v[32:35], a[92:95], v[216:219], v[32:35]
    ds_read_b64_tr_b16 a[108:109], v3 offset:37728
    ds_read_b64_tr_b16 a[110:111], v3 offset:37856
    buffer_store_dwordx4 v[48:51], v10, s[40:43], s54 offen offset:0 sc1
    v_mfma_f32_16x16x32_bf16 v[36:39], a[64:67], v[160:163], 0
    ds_read_b64_tr_b16 a[112:113], v3 offset:53856
    v_cvt_pk_bf16_f32 v52, v20, v21
    v_mfma_f32_16x16x32_bf16 v[36:39], a[68:71], v[168:171], v[36:39]
    ds_read_b64_tr_b16 a[114:115], v3 offset:53984
    v_cvt_pk_bf16_f32 v53, v22, v23
    v_mfma_f32_16x16x32_bf16 v[36:39], a[72:75], v[176:179], v[36:39]
    ds_read_b64_tr_b16 a[116:117], v3 offset:54112
    v_cvt_pk_bf16_f32 v54, v28, v29
    v_mfma_f32_16x16x32_bf16 v[36:39], a[76:79], v[184:187], v[36:39]
    ds_read_b64_tr_b16 a[118:119], v3 offset:54240
    v_cvt_pk_bf16_f32 v55, v30, v31
    v_mfma_f32_16x16x32_bf16 v[36:39], a[80:83], v[224:227], v[36:39]
    s_mov_b32 s54, 302080
    ds_read_b64_tr_b16 a[120:121], v3 offset:54368
    ds_read_b64_tr_b16 a[122:123], v3 offset:54496
    v_mfma_f32_16x16x32_bf16 v[36:39], a[84:87], v[232:235], v[36:39]
    v_permlane32_swap_b32 v52, v54
    v_mfma_f32_16x16x32_bf16 v[36:39], a[88:91], v[240:243], v[36:39]
    v_permlane32_swap_b32 v53, v55
    v_mfma_f32_16x16x32_bf16 v[36:39], a[92:95], v[248:251], v[36:39]
    s_waitcnt vmcnt(7)
    s_barrier
    s_waitcnt lgkmcnt(10)
    ds_read_b64_tr_b16 a[124:125], v3 offset:54624
    ds_read_b64_tr_b16 a[126:127], v3 offset:54752
    buffer_store_dwordx4 v[52:55], v10, s[40:43], s54 offen offset:0 sc1
    v_mfma_f32_16x16x32_bf16 v[40:43], a[96:99], v[128:131], 0
    ds_read_b64_tr_b16 a[64:65], v4 offset:0
    v_mfma_f32_16x16x32_bf16 v[40:43], a[100:103], v[136:139], v[40:43]
    s_waitcnt lgkmcnt(9)
    ds_read_b64_tr_b16 a[66:67], v4 offset:128
    v_mfma_f32_16x16x32_bf16 v[40:43], a[104:107], v[144:147], v[40:43]
    ds_read_b64_tr_b16 a[68:69], v4 offset:256
    v_mfma_f32_16x16x32_bf16 v[40:43], a[108:111], v[152:155], v[40:43]
    s_waitcnt lgkmcnt(7)
    ds_read_b64_tr_b16 a[70:71], v4 offset:384
    v_mfma_f32_16x16x32_bf16 v[40:43], a[112:115], v[192:195], v[40:43]
    ds_read_b64_tr_b16 a[72:73], v4 offset:512
    v_mfma_f32_16x16x32_bf16 v[40:43], a[116:119], v[200:203], v[40:43]
    s_waitcnt lgkmcnt(5)
    ds_read_b64_tr_b16 a[74:75], v4 offset:640
    v_mfma_f32_16x16x32_bf16 v[40:43], a[120:123], v[208:211], v[40:43]
    ds_read_b64_tr_b16 a[76:77], v4 offset:768
    v_mfma_f32_16x16x32_bf16 v[40:43], a[124:127], v[216:219], v[40:43]
    ds_read_b64_tr_b16 a[78:79], v4 offset:896
    v_mfma_f32_16x16x32_bf16 v[44:47], a[96:99], v[160:163], 0
    ds_read_b64_tr_b16 a[80:81], v4 offset:16896
    v_mfma_f32_16x16x32_bf16 v[44:47], a[100:103], v[168:171], v[44:47]
    ds_read_b64_tr_b16 a[82:83], v4 offset:17024
    v_mfma_f32_16x16x32_bf16 v[44:47], a[104:107], v[176:179], v[44:47]
    ds_read_b64_tr_b16 a[84:85], v4 offset:17152
    v_mfma_f32_16x16x32_bf16 v[44:47], a[108:111], v[184:187], v[44:47]
    ds_read_b64_tr_b16 a[86:87], v4 offset:17280
    v_mfma_f32_16x16x32_bf16 v[44:47], a[112:115], v[224:227], v[44:47]
    ds_read_b64_tr_b16 a[88:89], v4 offset:17408
    v_mfma_f32_16x16x32_bf16 v[44:47], a[116:119], v[232:235], v[44:47]
    ds_read_b64_tr_b16 a[90:91], v4 offset:17536
    v_mfma_f32_16x16x32_bf16 v[44:47], a[120:123], v[240:243], v[44:47]
    ds_read_b64_tr_b16 a[92:93], v4 offset:17664
    v_mfma_f32_16x16x32_bf16 v[44:47], a[124:127], v[248:251], v[44:47]
    s_waitcnt lgkmcnt(11)
    ds_read_b64_tr_b16 a[94:95], v4 offset:17792
    v_mfma_f32_16x16x32_bf16 v[16:19], a[64:67], v[128:131], 0
    ds_read_b64_tr_b16 a[96:97], v4 offset:32
    v_cvt_pk_bf16_f32 v48, v32, v33
    v_mfma_f32_16x16x32_bf16 v[16:19], a[68:71], v[136:139], v[16:19]
    s_waitcnt lgkmcnt(9)
    ds_read_b64_tr_b16 a[98:99], v4 offset:160
    v_cvt_pk_bf16_f32 v49, v34, v35
    v_mfma_f32_16x16x32_bf16 v[16:19], a[72:75], v[144:147], v[16:19]
    ds_read_b64_tr_b16 a[100:101], v4 offset:288
    v_cvt_pk_bf16_f32 v50, v40, v41
    v_mfma_f32_16x16x32_bf16 v[16:19], a[76:79], v[152:155], v[16:19]
    s_waitcnt lgkmcnt(7)
    ds_read_b64_tr_b16 a[102:103], v4 offset:416
    v_cvt_pk_bf16_f32 v51, v42, v43
    v_mfma_f32_16x16x32_bf16 v[16:19], a[80:83], v[192:195], v[16:19]
    s_mov_b32 s54, 7168
    ds_read_b64_tr_b16 a[104:105], v4 offset:544
    ds_read_b64_tr_b16 a[106:107], v4 offset:672
    v_mfma_f32_16x16x32_bf16 v[16:19], a[84:87], v[200:203], v[16:19]
    s_waitcnt lgkmcnt(6)
    v_permlane32_swap_b32 v48, v50
    v_mfma_f32_16x16x32_bf16 v[16:19], a[88:91], v[208:211], v[16:19]
    v_permlane32_swap_b32 v49, v51
    v_mfma_f32_16x16x32_bf16 v[16:19], a[92:95], v[216:219], v[16:19]
    ds_read_b64_tr_b16 a[108:109], v4 offset:800
    ds_read_b64_tr_b16 a[110:111], v4 offset:928
    buffer_store_dwordx4 v[48:51], v10, s[40:43], s54 offen offset:512 sc1
    v_mfma_f32_16x16x32_bf16 v[20:23], a[64:67], v[160:163], 0
    ds_read_b64_tr_b16 a[112:113], v4 offset:16928
    v_cvt_pk_bf16_f32 v52, v36, v37
    v_mfma_f32_16x16x32_bf16 v[20:23], a[68:71], v[168:171], v[20:23]
    ds_read_b64_tr_b16 a[114:115], v4 offset:17056
    v_cvt_pk_bf16_f32 v53, v38, v39
    v_mfma_f32_16x16x32_bf16 v[20:23], a[72:75], v[176:179], v[20:23]
    ds_read_b64_tr_b16 a[116:117], v4 offset:17184
    v_cvt_pk_bf16_f32 v54, v44, v45
    v_mfma_f32_16x16x32_bf16 v[20:23], a[76:79], v[184:187], v[20:23]
    ds_read_b64_tr_b16 a[118:119], v4 offset:17312
    v_cvt_pk_bf16_f32 v55, v46, v47
    v_mfma_f32_16x16x32_bf16 v[20:23], a[80:83], v[224:227], v[20:23]
    s_mov_b32 s54, 302080
    ds_read_b64_tr_b16 a[120:121], v4 offset:17440
    ds_read_b64_tr_b16 a[122:123], v4 offset:17568
    v_mfma_f32_16x16x32_bf16 v[20:23], a[84:87], v[232:235], v[20:23]
    v_permlane32_swap_b32 v52, v54
    v_mfma_f32_16x16x32_bf16 v[20:23], a[88:91], v[240:243], v[20:23]
    v_permlane32_swap_b32 v53, v55
    v_mfma_f32_16x16x32_bf16 v[20:23], a[92:95], v[248:251], v[20:23]
    s_waitcnt lgkmcnt(10)
    ds_read_b64_tr_b16 a[124:125], v4 offset:17696
    ds_read_b64_tr_b16 a[126:127], v4 offset:17824
    buffer_store_dwordx4 v[52:55], v10, s[40:43], s54 offen offset:512 sc1
    v_mfma_f32_16x16x32_bf16 v[24:27], a[96:99], v[128:131], 0
L2_pad13:
    s_cbranch_execz L2_walkret
    ds_read_b64_tr_b16 a[64:65], v4 offset:64
    v_mfma_f32_16x16x32_bf16 v[24:27], a[100:103], v[136:139], v[24:27]
    s_waitcnt lgkmcnt(9)
    ds_read_b64_tr_b16 a[66:67], v4 offset:192
    v_mfma_f32_16x16x32_bf16 v[24:27], a[104:107], v[144:147], v[24:27]
    ds_read_b64_tr_b16 a[68:69], v4 offset:320
    v_mfma_f32_16x16x32_bf16 v[24:27], a[108:111], v[152:155], v[24:27]
    s_waitcnt lgkmcnt(7)
    ds_read_b64_tr_b16 a[70:71], v4 offset:448
    v_mfma_f32_16x16x32_bf16 v[24:27], a[112:115], v[192:195], v[24:27]
    ds_read_b64_tr_b16 a[72:73], v4 offset:576
    v_mfma_f32_16x16x32_bf16 v[24:27], a[116:119], v[200:203], v[24:27]
    s_waitcnt lgkmcnt(5)
    ds_read_b64_tr_b16 a[74:75], v4 offset:704
    v_mfma_f32_16x16x32_bf16 v[24:27], a[120:123], v[208:211], v[24:27]
    ds_read_b64_tr_b16 a[76:77], v4 offset:832
    v_mfma_f32_16x16x32_bf16 v[24:27], a[124:127], v[216:219], v[24:27]
    ds_read_b64_tr_b16 a[78:79], v4 offset:960
    v_mfma_f32_16x16x32_bf16 v[28:31], a[96:99], v[160:163], 0
    ds_read_b64_tr_b16 a[80:81], v4 offset:16960
    v_mfma_f32_16x16x32_bf16 v[28:31], a[100:103], v[168:171], v[28:31]
    ds_read_b64_tr_b16 a[82:83], v4 offset:17088
    v_mfma_f32_16x16x32_bf16 v[28:31], a[104:107], v[176:179], v[28:31]
    ds_read_b64_tr_b16 a[84:85], v4 offset:17216
    v_mfma_f32_16x16x32_bf16 v[28:31], a[108:111], v[184:187], v[28:31]
    ds_read_b64_tr_b16 a[86:87], v4 offset:17344
    v_mfma_f32_16x16x32_bf16 v[28:31], a[112:115], v[224:227], v[28:31]
    ds_read_b64_tr_b16 a[88:89], v4 offset:17472
    v_mfma_f32_16x16x32_bf16 v[28:31], a[116:119], v[232:235], v[28:31]
    ds_read_b64_tr_b16 a[90:91], v4 offset:17600
    v_mfma_f32_16x16x32_bf16 v[28:31], a[120:123], v[240:243], v[28:31]
    ds_read_b64_tr_b16 a[92:93], v4 offset:17728
    v_mfma_f32_16x16x32_bf16 v[28:31], a[124:127], v[248:251], v[28:31]
    s_waitcnt lgkmcnt(11)
    ds_read_b64_tr_b16 a[94:95], v4 offset:17856
    v_mfma_f32_16x16x32_bf16 v[32:35], a[64:67], v[128:131], 0
    ds_read_b64_tr_b16 a[96:97], v4 offset:96
    v_cvt_pk_bf16_f32 v48, v16, v17
    v_mfma_f32_16x16x32_bf16 v[32:35], a[68:71], v[136:139], v[32:35]
    s_waitcnt lgkmcnt(9)
    ds_read_b64_tr_b16 a[98:99], v4 offset:224
    v_cvt_pk_bf16_f32 v49, v18, v19
    v_mfma_f32_16x16x32_bf16 v[32:35], a[72:75], v[144:147], v[32:35]
    ds_read_b64_tr_b16 a[100:101], v4 offset:352
    v_cvt_pk_bf16_f32 v50, v24, v25
    v_mfma_f32_16x16x32_bf16 v[32:35], a[76:79], v[152:155], v[32:35]
    s_waitcnt lgkmcnt(7)
    ds_read_b64_tr_b16 a[102:103], v4 offset:480
    v_cvt_pk_bf16_f32 v51, v26, v27
    v_mfma_f32_16x16x32_bf16 v[32:35], a[80:83], v[192:195], v[32:35]
    s_mov_b32 s54, 8192
    ds_read_b64_tr_b16 a[104:105], v4 offset:608
    ds_read_b64_tr_b16 a[106:107], v4 offset:736
    v_mfma_f32_16x16x32_bf16 v[32:35], a[84:87], v[200:203], v[32:35]
    s_waitcnt lgkmcnt(6)
    v_permlane32_swap_b32 v48, v50
    v_mfma_f32_16x16x32_bf16 v[32:35], a[88:91], v[208:211], v[32:35]
    v_permlane32_swap_b32 v49, v51
    v_mfma_f32_16x16x32_bf16 v[32:35], a[92:95], v[216:219], v[32:35]
    ds_read_b64_tr_b16 a[108:109], v4 offset:864
    ds_read_b64_tr_b16 a[110:111], v4 offset:992
    buffer_store_dwordx4 v[48:51], v10, s[40:43], s54 offen offset:0 sc1
    v_mfma_f32_16x16x32_bf16 v[36:39], a[64:67], v[160:163], 0
    ds_read_b64_tr_b16 a[112:113], v4 offset:16992
    v_cvt_pk_bf16_f32 v52, v20, v21
    v_mfma_f32_16x16x32_bf16 v[36:39], a[68:71], v[168:171], v[36:39]
    ds_read_b64_tr_b16 a[114:115], v4 offset:17120
    v_cvt_pk_bf16_f32 v53, v22, v23
    v_mfma_f32_16x16x32_bf16 v[36:39], a[72:75], v[176:179], v[36:39]
    ds_read_b64_tr_b16 a[116:117], v4 offset:17248
    v_cvt_pk_bf16_f32 v54, v28, v29
    v_mfma_f32_16x16x32_bf16 v[36:39], a[76:79], v[184:187], v[36:39]
    ds_read_b64_tr_b16 a[118:119], v4 offset:17376
    v_cvt_pk_bf16_f32 v55, v30, v31
    v_mfma_f32_16x16x32_bf16 v[36:39], a[80:83], v[224:227], v[36:39]
    s_mov_b32 s54, 303104
    ds_read_b64_tr_b16 a[120:121], v4 offset:17504
    ds_read_b64_tr_b16 a[122:123], v4 offset:17632
    v_mfma_f32_16x16x32_bf16 v[36:39], a[84:87], v[232:235], v[36:39]
    v_permlane32_swap_b32 v52, v54
    v_mfma_f32_16x16x32_bf16 v[36:39], a[88:91], v[240:243], v[36:39]
    v_permlane32_swap_b32 v53, v55
    v_mfma_f32_16x16x32_bf16 v[36:39], a[92:95], v[248:251], v[36:39]
    s_waitcnt lgkmcnt(10)
    ds_read_b64_tr_b16 a[124:125], v4 offset:17760
    ds_read_b64_tr_b16 a[126:127], v4 offset:17888
    buffer_store_dwordx4 v[52:55], v10, s[40:43], s54 offen offset:0 sc1
    v_mfma_f32_16x16x32_bf16 v[40:43], a[96:99], v[128:131], 0
    v_mfma_f32_16x16x32_bf16 v[40:43], a[100:103], v[136:139], v[40:43]
    s_waitcnt lgkmcnt(8)
    v_mfma_f32_16x16x32_bf16 v[40:43], a[104:107], v[144:147], v[40:43]
    v_mfma_f32_16x16x32_bf16 v[40:43], a[108:111], v[152:155], v[40:43]
    s_waitcnt lgkmcnt(4)
    v_mfma_f32_16x16x32_bf16 v[40:43], a[112:115], v[192:195], v[40:43]
    v_mfma_f32_16x16x32_bf16 v[40:43], a[116:119], v[200:203], v[40:43]
    s_waitcnt lgkmcnt(0)
    v_mfma_f32_16x16x32_bf16 v[40:43], a[120:123], v[208:211], v[40:43]
    v_mfma_f32_16x16x32_bf16 v[40:43], a[124:127], v[216:219], v[40:43]
    v_mfma_f32_16x16x32_bf16 v[44:47], a[96:99], v[160:163], 0
    v_mfma_f32_16x16x32_bf16 v[44:47], a[100:103], v[168:171], v[44:47]
    v_mfma_f32_16x16x32_bf16 v[44:47], a[104:107], v[176:179], v[44:47]
    v_mfma_f32_16x16x32_bf16 v[44:47], a[108:111], v[184:187], v[44:47]
    v_mfma_f32_16x16x32_bf16 v[44:47], a[112:115], v[224:227], v[44:47]
    v_mfma_f32_16x16x32_bf16 v[44:47], a[116:119], v[232:235], v[44:47]
    v_mfma_f32_16x16x32_bf16 v[44:47], a[120:123], v[240:243], v[44:47]
    v_mfma_f32_16x16x32_bf16 v[44:47], a[124:127], v[248:251], v[44:47]
    s_nop 7
    v_cvt_pk_bf16_f32 v48, v32, v33
    v_cvt_pk_bf16_f32 v49, v34, v35
    v_cvt_pk_bf16_f32 v50, v40, v41
    v_cvt_pk_bf16_f32 v51, v42, v43
    s_nop 1
    v_permlane32_swap_b32 v48, v50
    v_permlane32_swap_b32 v49, v51
    s_mov_b32 s54, 8192
    buffer_store_dwordx4 v[48:51], v10, s[40:43], s54 offen offset:512 sc1
    v_cvt_pk_bf16_f32 v52, v36, v37
    v_cvt_pk_bf16_f32 v53, v38, v39
    v_cvt_pk_bf16_f32 v54, v44, v45
    v_cvt_pk_bf16_f32 v55, v46, v47
    s_nop 1
    v_permlane32_swap_b32 v52, v54
    v_permlane32_swap_b32 v53, v55
    s_mov_b32 s54, 303104
    buffer_store_dwordx4 v[52:55], v10, s[40:43], s54 offen offset:512 sc1
    buffer_load_dword v9, v6, s[84:87], s47 offen sc1
    s_movk_i32 s45, 4608
    buffer_load_dwordx4 v[76:79], v5, s[84:87], s45 offen sc1
    s_movk_i32 s45, 18432
    buffer_load_dwordx4 v[88:91], v5, s[84:87], s45 offen sc1
    s_movk_i32 s45, 8704
    buffer_load_dwordx4 v[80:83], v5, s[84:87], s45 offen sc1
    s_movk_i32 s45, 22528
    buffer_load_dwordx4 v[92:95], v5, s[84:87], s45 offen sc1
    s_movk_i32 s45, 12800
    buffer_load_dwordx4 v[84:87], v59, s[84:87], s45 offen sc1
    s_movk_i32 s45, 26624
    buffer_load_dwordx4 v[96:99], v59, s[84:87], s45 offen sc1
    buffer_load_dwordx4 v[224:227], v12, s[36:39], 0 offen offset:0
    buffer_load_dwordx4 v[232:235], v12, s[36:39], 0 offen offset:512
    buffer_load_dwordx4 v[240:243], v13, s[36:39], 0 offen offset:1024
    buffer_load_dwordx4 v[64:67], v1, s[76:79], 0 offen offset:0
    buffer_load_dwordx4 v[68:71], v1, s[76:79], 0 offen offset:512
    buffer_load_dwordx4 v[72:75], v2, s[76:79], 0 offen offset:0
    s_waitcnt vmcnt(13)
    buffer_store_dword v3, v15, s[84:87], s56 offen sc1
    s_movk_i32 s48, 0x1111
    v_lshrrev_b32 v15, 4, v0
    v_mul_u32_u24 v15, 9216, v15
    v_add_u32 v15, 4096, v15
    v_add_u32 v7, v59, v15
    s_waitcnt vmcnt(13)
    v_cmp_ne_u32 vcc, 0, v9
    s_nop 0
    s_lshr_b32 s3, vcc_lo, 1
    s_and_b32 s3, s3, vcc_lo
    s_lshr_b32 s14, s3, 2
    s_and_b32 s3, s3, s14
    s_and_b32 s3, s3, s48
    s_cbranch_scc0 L2_g0s
L2_g0r:
    s_ff1_i32_b32 s3, s3
    s_bitset0_b32 s48, s3
    s_mul_i32 s46, s3, 9216
    buffer_load_dwordx4 v[112:115], v7, s[88:91], s46 offen sc1
    buffer_load_dwordx4 v[116:119], v5, s[88:91], s46 offen sc1
    buffer_load_dwordx4 v[120:123], v5, s[28:31], s46 offen sc1
    s_add_u32 s46, s46, 9216
    buffer_load_dwordx4 v[124:127], v5, s[88:91], s46 offen sc1
    buffer_load_dwordx4 v[128:131], v5, s[28:31], s46 offen sc1
    s_add_u32 s46, s46, 9216
    buffer_load_dwordx4 v[132:135], v5, s[88:91], s46 offen sc1
    buffer_load_dwordx4 v[136:139], v5, s[28:31], s46 offen sc1
    s_add_u32 s46, s46, 9216
    buffer_load_dwordx4 v[140:143], v5, s[88:91], s46 offen sc1
    buffer_load_dwordx4 v[144:147], v5, s[28:31], s46 offen sc1
    v_cmp_ne_u32 vcc, 0, v9
    s_nop 0
    s_lshr_b32 s3, vcc_lo, 1
    s_and_b32 s3, s3, vcc_lo
    s_lshr_b32 s14, s3, 2
    s_and_b32 s3, s3, s14
    s_and_b32 s3, s3, s48
    s_cbranch_scc0 L2_g1s
L2_g1r:
    s_ff1_i32_b32 s3, s3
    s_bitset0_b32 s48, s3
    s_mul_i32 s46, s3, 9216
    buffer_load_dword v9, v6, s[84:87], s47 offen sc1
    buffer_load_dwordx4 v[148:151], v7, s[88:91], s46 offen sc1
    buffer_load_dwordx4 v[152:155], v5, s[88:91], s46 offen sc1
    buffer_load_dwordx4 v[156:159], v5, s[28:31], s46 offen sc1
    s_add_u32 s46, s46, 9216
    buffer_load_dwordx4 v[160:163], v5, s[88:91], s46 offen sc1
    buffer_load_dwordx4 v[164:167], v5, s[28:31], s46 offen sc1
    s_add_u32 s46, s46, 9216
    buffer_load_dwordx4 v[168:171], v5, s[88:91], s46 offen sc1
    buffer_load_dwordx4 v[172:175], v5, s[28:31], s46 offen sc1
    s_add_u32 s46, s46, 9216
    buffer_load_dwordx4 v[176:179], v5, s[88:91], s46 offen sc1
    buffer_load_dwordx4 v[180:183], v5, s[28:31], s46 offen sc1
    s_waitcnt vmcnt(20)
    v_mov_b32 v14, v13
    v_max_u32 v13, v76, v77
    v_max3_u32 v13, v13, v78, v79
    v_max3_u32 v13, v13, v88, v89
    v_max3_u32 v13, v13, v90, v91
    v_max3_u32 v13, v13, v80, v81
    v_max3_u32 v13, v13, v82, v83
    v_max3_u32 v13, v13, v92, v93
    v_max3_u32 v13, v13, v94, v95
    v_max3_u32 v13, v13, v84, v85
    v_max3_u32 v13, v13, v86, v87
    v_max3_u32 v13, v13, v96, v97
    v_max3_u32 v13, v13, v98, v99
    v_cmp_eq_u32 vcc, -1, v13
    s_nop 0
    s_cmp_lg_u64 vcc, 0
    s_cbranch_scc1 L2_pns
L2_pnr:
    v_pk_add_f32 v[76:77], v[76:77], v[88:89]
    v_pk_add_f32 v[78:79], v[78:79], v[90:91]
    ds_write_b128 v5, v[76:79] offset:0
    v_pk_add_f32 v[80:81], v[80:81], v[92:93]
    v_pk_add_f32 v[82:83], v[82:83], v[94:95]
    ds_write_b128 v5, v[80:83] offset:4096
    v_pk_add_f32 v[84:85], v[84:85], v[96:97]
    v_pk_add_f32 v[86:87], v[86:87], v[98:99]
    ds_write_b128 v59, v[84:87] offset:8192
    s_waitcnt lgkmcnt(0)
    s_barrier
    v_lshlrev_b32 v3, 1, v12
    v_lshlrev_b32 v4, 1, v14
    ds_read_b128 v[76:79], v3 offset:4608
    ds_read_b128 v[80:83], v3 offset:4624
    ds_read_b128 v[84:87], v3 offset:5632
    ds_read_b128 v[88:91], v3 offset:5648
    ds_read_b128 v[92:95], v4 offset:6656
    ds_read_b128 v[96:99], v4 offset:6672
    ds_read_b128 v[40:43], v3 offset:2304
    ds_read_b128 v[44:47], v3 offset:2320
    ds_read_b128 v[48:51], v3 offset:3328
    ds_read_b128 v[52:55], v3 offset:3344
    ds_read_b128 v[56:59], v4 offset:4352
    ds_read_b128 v[60:63], v4 offset:4368
    ds_write_b128 v106, a[20:23] offset:36864
    ds_write_b128 v106, a[24:27] offset:37888
    s_waitcnt lgkmcnt(2)
    v_lshlrev_b32 v12, 16, v224
    v_and_b32 v13, 0xffff0000, v224
    v_pk_mul_f32 v[76:77], v[76:77], v[12:13]
    v_pk_mul_f32 v[40:41], v[40:41], v[12:13]
    v_lshlrev_b32 v14, 16, v225
    v_and_b32 v15, 0xffff0000, v225
    v_pk_mul_f32 v[78:79], v[78:79], v[14:15]
    v_pk_mul_f32 v[42:43], v[42:43], v[14:15]
    v_lshlrev_b32 v12, 16, v226
    v_and_b32 v13, 0xffff0000, v226
    v_pk_mul_f32 v[80:81], v[80:81], v[12:13]
    v_pk_mul_f32 v[44:45], v[44:45], v[12:13]
    v_lshlrev_b32 v14, 16, v227
    v_and_b32 v15, 0xffff0000, v227
    v_pk_mul_f32 v[82:83], v[82:83], v[14:15]
    v_pk_mul_f32 v[46:47], v[46:47], v[14:15]
    v_lshlrev_b32 v12, 16, v232
    v_and_b32 v13, 0xffff0000, v232
    v_pk_mul_f32 v[84:85], v[84:85], v[12:13]
    v_pk_mul_f32 v[48:49], v[48:49], v[12:13]
    v_lshlrev_b32 v14, 16, v233
    v_and_b32 v15, 0xffff0000, v233
    v_pk_mul_f32 v[86:87], v[86:87], v[14:15]
    v_pk_mul_f32 v[50:51], v[50:51], v[14:15]
    ds_write_b128 v106, a[28:31] offset:38912
    ds_write_b128 v106, a[32:35] offset:39936
    v_lshlrev_b32 v12, 16, v234
    v_and_b32 v13, 0xffff0000, v234
    v_pk_mul_f32 v[88:89], v[88:89], v[12:13]
    v_pk_mul_f32 v[52:53], v[52:53], v[12:13]
    v_lshlrev_b32 v14, 16, v235
    v_and_b32 v15, 0xffff0000, v235
    v_pk_mul_f32 v[90:91], v[90:91], v[14:15]
    v_pk_mul_f32 v[54:55], v[54:55], v[14:15]
    v_lshlrev_b32 v12, 16, v240
    v_and_b32 v13, 0xffff0000, v240
    v_pk_mul_f32 v[92:93], v[92:93], v[12:13]
    v_pk_mul_f32 v[56:57], v[56:57], v[12:13]
    v_lshlrev_b32 v14, 16, v241
    v_and_b32 v15, 0xffff0000, v241
    v_pk_mul_f32 v[94:95], v[94:95], v[14:15]
    v_pk_mul_f32 v[58:59], v[58:59], v[14:15]
    v_lshlrev_b32 v12, 16, v242
    v_and_b32 v13, 0xffff0000, v242
    v_pk_mul_f32 v[96:97], v[96:97], v[12:13]
    v_pk_mul_f32 v[60:61], v[60:61], v[12:13]
    v_lshlrev_b32 v14, 16, v243
    v_and_b32 v15, 0xffff0000, v243
    v_pk_mul_f32 v[98:99], v[98:99], v[14:15]
    v_pk_mul_f32 v[62:63], v[62:63], v[14:15]
    ds_write_b128 v106, a[36:39] offset:40960
    ds_write_b128 v106, a[40:43] offset:41984
    v_pk_add_f32 v[12:13], v[76:77], v[78:79]
    v_pk_add_f32 v[12:13], v[12:13], v[80:81]
    v_pk_add_f32 v[12:13], v[12:13], v[82:83]
    v_pk_add_f32 v[12:13], v[12:13], v[84:85]
    v_pk_add_f32 v[12:13], v[12:13], v[86:87]
    v_pk_add_f32 v[12:13], v[12:13], v[88:89]
    v_pk_add_f32 v[12:13], v[12:13], v[90:91]
    v_pk_add_f32 v[14:15], v[92:93], v[94:95]
    v_pk_add_f32 v[14:15], v[14:15], v[96:97]
    v_pk_add_f32 v[14:15], v[14:15], v[98:99]
    v_add_f32 v100, v12, v13
    v_add_f32 v14, v14, v15
    v_fmac_f32 v100, 0x3e800000, v14
    v_pk_add_f32 v[12:13], v[40:41], v[42:43]
    v_pk_add_f32 v[12:13], v[12:13], v[44:45]
    v_pk_add_f32 v[12:13], v[12:13], v[46:47]
    v_pk_add_f32 v[12:13], v[12:13], v[48:49]
    v_pk_add_f32 v[12:13], v[12:13], v[50:51]
    v_pk_add_f32 v[12:13], v[12:13], v[52:53]
    v_pk_add_f32 v[12:13], v[12:13], v[54:55]
    v_pk_add_f32 v[14:15], v[56:57], v[58:59]
    v_pk_add_f32 v[14:15], v[14:15], v[60:61]
    v_pk_add_f32 v[14:15], v[14:15], v[62:63]
    v_add_f32 v101, v12, v13
    v_add_f32 v14, v14, v15
    v_fmac_f32 v101, 0x3e800000, v14
    ds_read_b128 v[40:43], v3 offset:0
    ds_read_b128 v[44:47], v3 offset:16
    ds_read_b128 v[48:51], v3 offset:1024
    ds_read_b128 v[52:55], v3 offset:1040
    ds_read_b128 v[56:59], v4 offset:2048
    ds_read_b128 v[60:63], v4 offset:2064
    ds_write_b128 v106, a[44:47] offset:43008
    ds_write_b128 v106, a[48:51] offset:44032
    s_nop 1
    v_add_f32_dpp v100, v100, v100 row_ror:8 row_mask:0xf bank_mask:0xf
    v_add_f32_dpp v101, v101, v101 row_ror:8 row_mask:0xf bank_mask:0xf
    v_mov_b32 v102, v100
    v_mov_b32 v103, v101
    s_nop 0
    v_permlane16_swap_b32 v102, v100
    v_permlane16_swap_b32 v103, v101
    v_add_f32 v100, v100, v102
    v_add_f32 v101, v101, v103
    v_mov_b32 v102, v100
    v_mov_b32 v103, v101
    s_nop 0
    v_permlane32_swap_b32 v102, v100
    v_permlane32_swap_b32 v103, v101
    v_add_f32 v100, v100, v102
    v_add_f32 v101, v101, v103
    v_and_b32 v14, 7, v0
    v_lshlrev_b32 v11, 4, v14
    v_add_u32 v11, 14080, v11
    s_lshl_b32 s3, s51, 2
    v_add_u32 v10, s3, v11
    ds_write_b32 v10, v100 offset:384
    ds_write_b32 v10, v101 offset:512
    v_lshl_add_u32 v1, v14, 4, v1
    v_lshl_add_u32 v2, v14, 4, v2
    v_add_u32 v1, 90112, v1
    v_add_u32 v2, 90112, v2
    s_and_b32 s14, s51, 1
    s_mul_i32 s14, s14, 9344
    s_add_u32 s14, s14, 90112
    v_add_u32 v107, s14, v8
    v_lshrrev_b32 v15, 3, v0
    v_mul_u32_u24 v12, 1024, v15
    v_add_u32 v109, v12, v8
    v_lshl_add_u32 v12, v15, 4, v12
    v_add_u32 v108, v12, v107
    s_mul_i32 s3, s96, 9216
    s_cmp_eq_u32 s51, 3
    s_cselect_b32 s3, 0, s3
    s_cselect_b64 s[24:25], s[32:33], s[80:81]
    s_add_u32 s24, s24, s3
    s_addc_u32 s25, s25, 0
    s_mov_b32 s26, 9216
    s_mov_b32 s27, 0x20000
    ds_write_b128 v106, a[52:55] offset:45056
    ds_write_b128 v105, a[128:131] offset:0
    s_waitcnt lgkmcnt(2)
    s_waitcnt vmcnt(18)
    ds_write_b128 v105, a[132:135] offset:1024
    ds_write_b128 v105, a[136:139] offset:2048
    v_lshlrev_b32 v32, 16, v112
    v_and_b32 v33, 0xffff0000, v112
    v_lshlrev_b32 v34, 16, v113
    v_and_b32 v35, 0xffff0000, v113
    v_lshlrev_b32 v36, 16, v114
    v_and_b32 v37, 0xffff0000, v114
    v_lshlrev_b32 v38, 16, v115
    v_and_b32 v39, 0xffff0000, v115
    s_waitcnt vmcnt(17)
    ds_write_b128 v105, a[140:143] offset:3072
    ds_write_b128 v105, a[144:147] offset:4096
    v_lshlrev_b32 v24, 16, v116
    v_and_b32 v25, 0xffff0000, v116
    v_lshlrev_b32 v26, 16, v117
    v_and_b32 v27, 0xffff0000, v117
    v_lshlrev_b32 v28, 16, v118
    v_and_b32 v29, 0xffff0000, v118
    v_lshlrev_b32 v30, 16, v119
    v_and_b32 v31, 0xffff0000, v119
    s_waitcnt vmcnt(16)
    v_lshlrev_b32 v16, 16, v120
    v_and_b32 v17, 0xffff0000, v120
    v_lshlrev_b32 v18, 16, v121
    v_and_b32 v19, 0xffff0000, v121
    v_lshlrev_b32 v20, 16, v122
    v_and_b32 v21, 0xffff0000, v122
    v_lshlrev_b32 v22, 16, v123
    v_and_b32 v23, 0xffff0000, v123
    s_waitcnt vmcnt(15)
    ds_write_b128 v105, a[148:151] offset:5120
    ds_write_b128 v105, a[152:155] offset:6144
    v_lshlrev_b32 v100, 16, v124
    v_and_b32 v101, 0xffff0000, v124
    v_pk_add_f32 v[24:25], v[24:25], v[100:101]
    v_lshlrev_b32 v102, 16, v125
    v_and_b32 v103, 0xffff0000, v125
    v_pk_add_f32 v[26:27], v[26:27], v[102:103]
    v_lshlrev_b32 v100, 16, v126
    v_and_b32 v101, 0xffff0000, v126
    v_pk_add_f32 v[28:29], v[28:29], v[100:101]
    v_lshlrev_b32 v102, 16, v127
    v_and_b32 v103, 0xffff0000, v127
    v_pk_add_f32 v[30:31], v[30:31], v[102:103]
    s_waitcnt vmcnt(14)
    v_lshlrev_b32 v100, 16, v128
    v_and_b32 v101, 0xffff0000, v128
    v_pk_add_f32 v[16:17], v[16:17], v[100:101]
    v_lshlrev_b32 v102, 16, v129
    v_and_b32 v103, 0xffff0000, v129
    v_pk_add_f32 v[18:19], v[18:19], v[102:103]
    v_lshlrev_b32 v100, 16, v130
    v_and_b32 v101, 0xffff0000, v130
    v_pk_add_f32 v[20:21], v[20:21], v[100:101]
    v_lshlrev_b32 v102, 16, v131
    v_and_b32 v103, 0xffff0000, v131
    v_pk_add_f32 v[22:23], v[22:23], v[102:103]
    s_waitcnt vmcnt(13)
    ds_write_b128 v105, a[156:159] offset:7168
    ds_write_b128 v105, a[160:163] offset:8192
    v_lshlrev_b32 v100, 16, v132
    v_and_b32 v101, 0xffff0000, v132
    v_pk_add_f32 v[24:25], v[24:25], v[100:101]
    v_lshlrev_b32 v102, 16, v133
    v_and_b32 v103, 0xffff0000, v133
    v_pk_add_f32 v[26:27], v[26:27], v[102:103]
    v_lshlrev_b32 v100, 16, v134
    v_and_b32 v101, 0xffff0000, v134
    v_pk_add_f32 v[28:29], v[28:29], v[100:101]
    v_lshlrev_b32 v102, 16, v135
    v_and_b32 v103, 0xffff0000, v135
    v_pk_add_f32 v[30:31], v[30:31], v[102:103]
    s_waitcnt vmcnt(12)
    v_lshlrev_b32 v100, 16, v136
    v_and_b32 v101, 0xffff0000, v136
    v_pk_add_f32 v[16:17], v[16:17], v[100:101]
    v_lshlrev_b32 v102, 16, v137
    v_and_b32 v103, 0xffff0000, v137
    v_pk_add_f32 v[18:19], v[18:19], v[102:103]
    v_lshlrev_b32 v100, 16, v138
    v_and_b32 v101, 0xffff0000, v138
    v_pk_add_f32 v[20:21], v[20:21], v[100:101]
    v_lshlrev_b32 v102, 16, v139
    v_and_b32 v103, 0xffff0000, v139
    v_pk_add_f32 v[22:23], v[22:23], v[102:103]
    s_waitcnt vmcnt(11)
    ds_write_b128 v104, a[164:167] offset:36864
    ds_write_b128 v104, a[168:171] offset:37888
    v_lshlrev_b32 v100, 16, v140
    v_and_b32 v101, 0xffff0000, v140
    v_pk_add_f32 v[24:25], v[24:25], v[100:101]
    v_lshlrev_b32 v102, 16, v141
    v_and_b32 v103, 0xffff0000, v141
    v_pk_add_f32 v[26:27], v[26:27], v[102:103]
    v_lshlrev_b32 v100, 16, v142
    v_and_b32 v101, 0xffff0000, v142
    v_pk_add_f32 v[28:29], v[28:29], v[100:101]
    v_lshlrev_b32 v102, 16, v143
    v_and_b32 v103, 0xffff0000, v143
    v_pk_add_f32 v[30:31], v[30:31], v[102:103]
    s_waitcnt vmcnt(10)
    v_lshlrev_b32 v100, 16, v144
    v_and_b32 v101, 0xffff0000, v144
    v_pk_add_f32 v[16:17], v[16:17], v[100:101]
    v_lshlrev_b32 v102, 16, v145
    v_and_b32 v103, 0xffff0000, v145
    v_pk_add_f32 v[18:19], v[18:19], v[102:103]
    v_lshlrev_b32 v100, 16, v146
    v_and_b32 v101, 0xffff0000, v146
    v_pk_add_f32 v[20:21], v[20:21], v[100:101]
    v_lshlrev_b32 v102, 16, v147
    v_and_b32 v103, 0xffff0000, v147
    v_pk_add_f32 v[22:23], v[22:23], v[102:103]
    s_waitcnt vmcnt(8)
    ds_write_b128 v104, a[172:175] offset:38912
    ds_write_b128 v104, a[176:179] offset:39936
    v_lshlrev_b32 v100, 16, v148
    v_and_b32 v101, 0xffff0000, v148
    v_pk_add_f32 v[32:33], v[32:33], v[100:101]
    v_lshlrev_b32 v102, 16, v149
    v_and_b32 v103, 0xffff0000, v149
    v_pk_add_f32 v[34:35], v[34:35], v[102:103]
    v_lshlrev_b32 v100, 16, v150
    v_and_b32 v101, 0xffff0000, v150
    v_pk_add_f32 v[36:37], v[36:37], v[100:101]
    v_lshlrev_b32 v102, 16, v151
    v_and_b32 v103, 0xffff0000, v151
    v_pk_add_f32 v[38:39], v[38:39], v[102:103]
    s_waitcnt vmcnt(7)
    ds_write_b128 v104, a[180:183] offset:40960
    ds_write_b128 v104, a[184:187] offset:41984
    v_lshlrev_b32 v100, 16, v152
    v_and_b32 v101, 0xffff0000, v152
    v_pk_add_f32 v[24:25], v[24:25], v[100:101]
    v_lshlrev_b32 v102, 16, v153
    v_and_b32 v103, 0xffff0000, v153
    v_pk_add_f32 v[26:27], v[26:27], v[102:103]
    v_lshlrev_b32 v100, 16, v154
    v_and_b32 v101, 0xffff0000, v154
    v_pk_add_f32 v[28:29], v[28:29], v[100:101]
    v_lshlrev_b32 v102, 16, v155
    v_and_b32 v103, 0xffff0000, v155
    v_pk_add_f32 v[30:31], v[30:31], v[102:103]
    s_waitcnt vmcnt(6)
    v_lshlrev_b32 v100, 16, v156
    v_and_b32 v101, 0xffff0000, v156
    v_pk_add_f32 v[16:17], v[16:17], v[100:101]
    v_lshlrev_b32 v102, 16, v157
    v_and_b32 v103, 0xffff0000, v157
    v_pk_add_f32 v[18:19], v[18:19], v[102:103]
    v_lshlrev_b32 v100, 16, v158
    v_and_b32 v101, 0xffff0000, v158
    v_pk_add_f32 v[20:21], v[20:21], v[100:101]
    v_lshlrev_b32 v102, 16, v159
    v_and_b32 v103, 0xffff0000, v159
    v_pk_add_f32 v[22:23], v[22:23], v[102:103]
    s_waitcnt vmcnt(5)
    v_cmp_ne_u32 vcc, 0, v9
    s_nop 0
    s_lshr_b32 s3, vcc_lo, 1
    s_and_b32 s3, s3, vcc_lo
    s_lshr_b32 s14, s3, 2
    s_and_b32 s3, s3, s14
    s_and_b32 s3, s3, s48
    s_cbranch_scc0 L2_g2s
L2_g2r:
    s_ff1_i32_b32 s3, s3
    s_bitset0_b32 s48, s3
    s_mul_i32 s46, s3, 9216
    buffer_load_dword v9, v6, s[84:87], s47 offen sc1
    buffer_load_dwordx4 v[184:187], v7, s[88:91], s46 offen sc1
    ds_write_b128 v104, a[188:191] offset:43008
    ds_write_b128 v104, a[192:195] offset:44032
    v_lshlrev_b32 v100, 16, v160
    v_and_b32 v101, 0xffff0000, v160
    v_pk_add_f32 v[24:25], v[24:25], v[100:101]
    v_lshlrev_b32 v102, 16, v161
    v_and_b32 v103, 0xffff0000, v161
    v_pk_add_f32 v[26:27], v[26:27], v[102:103]
    v_lshlrev_b32 v100, 16, v162
    v_and_b32 v101, 0xffff0000, v162
    v_pk_add_f32 v[28:29], v[28:29], v[100:101]
    v_lshlrev_b32 v102, 16, v163
    v_and_b32 v103, 0xffff0000, v163
    v_pk_add_f32 v[30:31], v[30:31], v[102:103]
    s_waitcnt vmcnt(6)
    v_lshlrev_b32 v100, 16, v164
    v_and_b32 v101, 0xffff0000, v164
    v_pk_add_f32 v[16:17], v[16:17], v[100:101]
    v_lshlrev_b32 v102, 16, v165
    v_and_b32 v103, 0xffff0000, v165
    v_pk_add_f32 v[18:19], v[18:19], v[102:103]
    v_lshlrev_b32 v100, 16, v166
    v_and_b32 v101, 0xffff0000, v166
    v_pk_add_f32 v[20:21], v[20:21], v[100:101]
    v_lshlrev_b32 v102, 16, v167
    v_and_b32 v103, 0xffff0000, v167
    v_pk_add_f32 v[22:23], v[22:23], v[102:103]
    s_waitcnt vmcnt(5)
    buffer_load_dwordx4 v[188:191], v5, s[88:91], s46 offen sc1
    buffer_load_dwordx4 v[192:195], v5, s[28:31], s46 offen sc1
    ds_write_b128 v104, a[196:199] offset:45056
    v_lshlrev_b32 v100, 16, v168
    v_and_b32 v101, 0xffff0000, v168
    v_pk_add_f32 v[24:25], v[24:25], v[100:101]
    v_lshlrev_b32 v102, 16, v169
    v_and_b32 v103, 0xffff0000, v169
    v_pk_add_f32 v[26:27], v[26:27], v[102:103]
    v_lshlrev_b32 v100, 16, v170
    v_and_b32 v101, 0xffff0000, v170
    v_pk_add_f32 v[28:29], v[28:29], v[100:101]
    v_lshlrev_b32 v102, 16, v171
    v_and_b32 v103, 0xffff0000, v171
    v_pk_add_f32 v[30:31], v[30:31], v[102:103]
    s_waitcnt vmcnt(6)
    v_lshlrev_b32 v100, 16, v172
    v_and_b32 v101, 0xffff0000, v172
    v_pk_add_f32 v[16:17], v[16:17], v[100:101]
    v_lshlrev_b32 v102, 16, v173
    v_and_b32 v103, 0xffff0000, v173
    v_pk_add_f32 v[18:19], v[18:19], v[102:103]
    v_lshlrev_b32 v100, 16, v174
    v_and_b32 v101, 0xffff0000, v174
    v_pk_add_f32 v[20:21], v[20:21], v[100:101]
    v_lshlrev_b32 v102, 16, v175
    v_and_b32 v103, 0xffff0000, v175
    v_pk_add_f32 v[22:23], v[22:23], v[102:103]
    s_waitcnt vmcnt(5)
    s_add_u32 s46, s46, 9216
    buffer_load_dwordx4 v[196:199], v5, s[88:91], s46 offen sc1
    buffer_load_dwordx4 v[200:203], v5, s[28:31], s46 offen sc1
    v_lshlrev_b32 v100, 16, v176
    v_and_b32 v101, 0xffff0000, v176
    v_pk_add_f32 v[24:25], v[24:25], v[100:101]
    v_lshlrev_b32 v102, 16, v177
    v_and_b32 v103, 0xffff0000, v177
    v_pk_add_f32 v[26:27], v[26:27], v[102:103]
    v_lshlrev_b32 v100, 16, v178
    v_and_b32 v101, 0xffff0000, v178
L2_pad14:
    s_cbranch_execz L2_walkret
    v_pk_add_f32 v[28:29], v[28:29], v[100:101]
    v_lshlrev_b32 v102, 16, v179
    v_and_b32 v103, 0xffff0000, v179
    v_pk_add_f32 v[30:31], v[30:31], v[102:103]
    s_waitcnt vmcnt(6)
    v_lshlrev_b32 v100, 16, v180
    v_and_b32 v101, 0xffff0000, v180
    v_pk_add_f32 v[16:17], v[16:17], v[100:101]
    v_lshlrev_b32 v102, 16, v181
    v_and_b32 v103, 0xffff0000, v181
    v_pk_add_f32 v[18:19], v[18:19], v[102:103]
    v_lshlrev_b32 v100, 16, v182
    v_and_b32 v101, 0xffff0000, v182
    v_pk_add_f32 v[20:21], v[20:21], v[100:101]
    v_lshlrev_b32 v102, 16, v183
    v_and_b32 v103, 0xffff0000, v183
    v_pk_add_f32 v[22:23], v[22:23], v[102:103]
    s_waitcnt vmcnt(4)
    s_add_u32 s46, s46, 9216
    buffer_load_dwordx4 v[204:207], v5, s[88:91], s46 offen sc1
    buffer_load_dwordx4 v[208:211], v5, s[28:31], s46 offen sc1
    v_lshlrev_b32 v100, 16, v184
    v_and_b32 v101, 0xffff0000, v184
    v_pk_add_f32 v[32:33], v[32:33], v[100:101]
    v_lshlrev_b32 v102, 16, v185
    v_and_b32 v103, 0xffff0000, v185
    v_pk_add_f32 v[34:35], v[34:35], v[102:103]
    v_lshlrev_b32 v100, 16, v186
    v_and_b32 v101, 0xffff0000, v186
    v_pk_add_f32 v[36:37], v[36:37], v[100:101]
    v_lshlrev_b32 v102, 16, v187
    v_and_b32 v103, 0xffff0000, v187
    v_pk_add_f32 v[38:39], v[38:39], v[102:103]
    ds_read_b128 v[112:115], v3 offset:4608
    ds_read_b128 v[116:119], v3 offset:4624
    ds_read_b128 v[120:123], v3 offset:5632
    ds_read_b128 v[124:127], v3 offset:5648
    ds_read_b128 v[128:131], v4 offset:6656
    ds_read_b128 v[132:135], v4 offset:6672
    ds_read_b128 v[136:139], v3 offset:2304
    ds_read_b128 v[140:143], v3 offset:2320
    ds_read_b128 v[144:147], v3 offset:3328
    ds_read_b128 v[148:151], v3 offset:3344
    ds_read_b128 v[152:155], v4 offset:4352
    ds_read_b128 v[156:159], v4 offset:4368
    ds_read_b128 v[160:163], v3 offset:6912
    ds_read_b128 v[164:167], v3 offset:6928
    ds_read_b128 v[168:171], v3 offset:7936
    ds_read_b128 v[172:175], v3 offset:7952
    ds_read_b128 v[176:179], v4 offset:8960
    ds_read_b128 v[180:183], v4 offset:8976
    s_waitcnt vmcnt(5)
    s_add_u32 s46, s46, 9216
    buffer_load_dwordx4 v[212:215], v5, s[88:91], s46 offen sc1
    buffer_load_dwordx4 v[216:219], v5, s[28:31], s46 offen sc1
    v_lshlrev_b32 v100, 16, v188
    v_and_b32 v101, 0xffff0000, v188
    v_pk_add_f32 v[24:25], v[24:25], v[100:101]
    v_lshlrev_b32 v102, 16, v189
    v_and_b32 v103, 0xffff0000, v189
    v_pk_add_f32 v[26:27], v[26:27], v[102:103]
    v_lshlrev_b32 v100, 16, v190
    v_and_b32 v101, 0xffff0000, v190
    v_pk_add_f32 v[28:29], v[28:29], v[100:101]
    v_lshlrev_b32 v102, 16, v191
    v_and_b32 v103, 0xffff0000, v191
    v_pk_add_f32 v[30:31], v[30:31], v[102:103]
    s_waitcnt vmcnt(6)
    v_lshlrev_b32 v100, 16, v192
    v_and_b32 v101, 0xffff0000, v192
    v_pk_add_f32 v[16:17], v[16:17], v[100:101]
    v_lshlrev_b32 v102, 16, v193
    v_and_b32 v103, 0xffff0000, v193
    v_pk_add_f32 v[18:19], v[18:19], v[102:103]
    v_lshlrev_b32 v100, 16, v194
    v_and_b32 v101, 0xffff0000, v194
    v_pk_add_f32 v[20:21], v[20:21], v[100:101]
    v_lshlrev_b32 v102, 16, v195
    v_and_b32 v103, 0xffff0000, v195
    v_pk_add_f32 v[22:23], v[22:23], v[102:103]
    s_waitcnt vmcnt(5)
    v_cmp_ne_u32 vcc, 0, v9
    s_nop 0
    s_lshr_b32 s3, vcc_lo, 1
    s_and_b32 s3, s3, vcc_lo
    s_lshr_b32 s14, s3, 2
    s_and_b32 s3, s3, s14
    s_and_b32 s3, s3, s48
    s_cbranch_scc0 L2_g3s
L2_g3r:
    s_ff1_i32_b32 s3, s3
    s_bitset0_b32 s48, s3
    s_mul_i32 s46, s3, 9216
    buffer_load_dwordx4 v[220:223], v7, s[88:91], s46 offen sc1
    v_lshlrev_b32 v100, 16, v196
    v_and_b32 v101, 0xffff0000, v196
    v_pk_add_f32 v[24:25], v[24:25], v[100:101]
    v_lshlrev_b32 v102, 16, v197
    v_and_b32 v103, 0xffff0000, v197
    v_pk_add_f32 v[26:27], v[26:27], v[102:103]
    v_lshlrev_b32 v100, 16, v198
    v_and_b32 v101, 0xffff0000, v198
    v_pk_add_f32 v[28:29], v[28:29], v[100:101]
    v_lshlrev_b32 v102, 16, v199
    v_and_b32 v103, 0xffff0000, v199
    v_pk_add_f32 v[30:31], v[30:31], v[102:103]
    s_waitcnt vmcnt(5)
    v_lshlrev_b32 v100, 16, v200
    v_and_b32 v101, 0xffff0000, v200
    v_pk_add_f32 v[16:17], v[16:17], v[100:101]
    v_lshlrev_b32 v102, 16, v201
    v_and_b32 v103, 0xffff0000, v201
    v_pk_add_f32 v[18:19], v[18:19], v[102:103]
    v_lshlrev_b32 v100, 16, v202
    v_and_b32 v101, 0xffff0000, v202
    v_pk_add_f32 v[20:21], v[20:21], v[100:101]
    v_lshlrev_b32 v102, 16, v203
    v_and_b32 v103, 0xffff0000, v203
    v_pk_add_f32 v[22:23], v[22:23], v[102:103]
    s_waitcnt vmcnt(4)
    buffer_load_dwordx4 v[224:227], v5, s[88:91], s46 offen sc1
    buffer_load_dwordx4 v[228:231], v5, s[28:31], s46 offen sc1
    v_lshlrev_b32 v100, 16, v204
    v_and_b32 v101, 0xffff0000, v204
    v_pk_add_f32 v[24:25], v[24:25], v[100:101]
    v_lshlrev_b32 v102, 16, v205
    v_and_b32 v103, 0xffff0000, v205
    v_pk_add_f32 v[26:27], v[26:27], v[102:103]
    v_lshlrev_b32 v100, 16, v206
    v_and_b32 v101, 0xffff0000, v206
    v_pk_add_f32 v[28:29], v[28:29], v[100:101]
    v_lshlrev_b32 v102, 16, v207
    v_and_b32 v103, 0xffff0000, v207
    v_pk_add_f32 v[30:31], v[30:31], v[102:103]
    s_waitcnt vmcnt(5)
    v_lshlrev_b32 v100, 16, v208
    v_and_b32 v101, 0xffff0000, v208
    v_pk_add_f32 v[16:17], v[16:17], v[100:101]
    v_lshlrev_b32 v102, 16, v209
    v_and_b32 v103, 0xffff0000, v209
    v_pk_add_f32 v[18:19], v[18:19], v[102:103]
    v_lshlrev_b32 v100, 16, v210
    v_and_b32 v101, 0xffff0000, v210
    v_pk_add_f32 v[20:21], v[20:21], v[100:101]
    v_lshlrev_b32 v102, 16, v211
    v_and_b32 v103, 0xffff0000, v211
    v_pk_add_f32 v[22:23], v[22:23], v[102:103]
    s_waitcnt vmcnt(4)
    s_add_u32 s46, s46, 9216
    buffer_load_dwordx4 v[232:235], v5, s[88:91], s46 offen sc1
    buffer_load_dwordx4 v[236:239], v5, s[28:31], s46 offen sc1
    v_lshlrev_b32 v100, 16, v212
    v_and_b32 v101, 0xffff0000, v212
    v_pk_add_f32 v[24:25], v[24:25], v[100:101]
    v_lshlrev_b32 v102, 16, v213
    v_and_b32 v103, 0xffff0000, v213
    v_pk_add_f32 v[26:27], v[26:27], v[102:103]
    v_lshlrev_b32 v100, 16, v214
    v_and_b32 v101, 0xffff0000, v214
    v_pk_add_f32 v[28:29], v[28:29], v[100:101]
    v_lshlrev_b32 v102, 16, v215
    v_and_b32 v103, 0xffff0000, v215
    v_pk_add_f32 v[30:31], v[30:31], v[102:103]
    s_waitcnt vmcnt(5)
    v_lshlrev_b32 v100, 16, v216
    v_and_b32 v101, 0xffff0000, v216
    v_pk_add_f32 v[16:17], v[16:17], v[100:101]
    v_lshlrev_b32 v102, 16, v217
    v_and_b32 v103, 0xffff0000, v217
    v_pk_add_f32 v[18:19], v[18:19], v[102:103]
    v_lshlrev_b32 v100, 16, v218
    v_and_b32 v101, 0xffff0000, v218
    v_pk_add_f32 v[20:21], v[20:21], v[100:101]
    v_lshlrev_b32 v102, 16, v219
    v_and_b32 v103, 0xffff0000, v219
    v_pk_add_f32 v[22:23], v[22:23], v[102:103]
    s_waitcnt vmcnt(4)
    s_add_u32 s46, s46, 9216
    buffer_load_dwordx4 v[240:243], v5, s[88:91], s46 offen sc1
    buffer_load_dwordx4 v[244:247], v5, s[28:31], s46 offen sc1
    v_lshlrev_b32 v100, 16, v220
    v_and_b32 v101, 0xffff0000, v220
    v_pk_add_f32 v[32:33], v[32:33], v[100:101]
    v_lshlrev_b32 v102, 16, v221
    v_and_b32 v103, 0xffff0000, v221
    v_pk_add_f32 v[34:35], v[34:35], v[102:103]
    v_lshlrev_b32 v100, 16, v222
    v_and_b32 v101, 0xffff0000, v222
    v_pk_add_f32 v[36:37], v[36:37], v[100:101]
    v_lshlrev_b32 v102, 16, v223
    v_and_b32 v103, 0xffff0000, v223
    v_pk_add_f32 v[38:39], v[38:39], v[102:103]
    s_lshl_b32 s3, s96, 3
    s_sub_u32 s3, 0xfff, s3
    v_and_b32 v6, 7, v0
    v_sub_u32 v6, s3, v6
    s_mov_b32 s57, 0xfffff000
    s_mul_i32 s58, s96, 128
    s_add_u32 s58, s58, 6815744
    s_xor_b32 s3, s51, 2
    v_or_b32 v9, s3, v0
    v_min_u32 v9, 1, v9
    v_lshlrev_b32 v9, 30, v9
    v_mov_b32 v208, v32
    v_mov_b32 v209, v33
    v_mov_b32 v210, v34
    v_mov_b32 v211, v35
    v_mov_b32 v212, v36
    v_mov_b32 v213, v37
    v_mov_b32 v214, v38
    v_mov_b32 v215, v39
    v_permlane16_swap_b32 v208, v32
    v_permlane16_swap_b32 v209, v33
    v_permlane16_swap_b32 v210, v34
    v_permlane16_swap_b32 v211, v35
    v_permlane16_swap_b32 v212, v36
    v_permlane16_swap_b32 v213, v37
    v_permlane16_swap_b32 v214, v38
    v_permlane16_swap_b32 v215, v39
    v_add_f32 v32, v32, v208
    v_add_f32 v33, v33, v209
    v_add_f32 v34, v34, v210
    v_add_f32 v35, v35, v211
    v_add_f32 v36, v36, v212
    v_add_f32 v37, v37, v213
    v_add_f32 v38, v38, v214
    v_add_f32 v39, v39, v215
    v_mov_b32 v208, v32
    v_mov_b32 v209, v33
    v_mov_b32 v210, v34
    v_mov_b32 v211, v35
    v_mov_b32 v212, v36
    v_mov_b32 v213, v37
    v_mov_b32 v214, v38
    v_mov_b32 v215, v39
    v_permlane32_swap_b32 v208, v32
    v_permlane32_swap_b32 v209, v33
    v_permlane32_swap_b32 v210, v34
    v_permlane32_swap_b32 v211, v35
    v_permlane32_swap_b32 v212, v36
    v_permlane32_swap_b32 v213, v37
    v_permlane32_swap_b32 v214, v38
    v_permlane32_swap_b32 v215, v39
    v_add_f32 v32, v32, v208
    v_add_f32 v33, v33, v209
    v_add_f32 v34, v34, v210
    v_add_f32 v35, v35, v211
    v_add_f32 v36, v36, v212
    v_add_f32 v37, v37, v213
    v_add_f32 v38, v38, v214
    v_add_f32 v39, v39, v215
    v_lshlrev_b32 v184, 16, v64
    v_and_b32 v185, 0xffff0000, v64
    v_lshlrev_b32 v186, 16, v65
    v_and_b32 v187, 0xffff0000, v65
    v_lshlrev_b32 v188, 16, v66
    v_and_b32 v189, 0xffff0000, v66
    v_lshlrev_b32 v190, 16, v67
    v_and_b32 v191, 0xffff0000, v67
    v_lshlrev_b32 v192, 16, v68
    v_and_b32 v193, 0xffff0000, v68
    v_lshlrev_b32 v194, 16, v69
    v_and_b32 v195, 0xffff0000, v69
    v_lshlrev_b32 v196, 16, v70
    v_and_b32 v197, 0xffff0000, v70
    v_lshlrev_b32 v198, 16, v71
    v_and_b32 v199, 0xffff0000, v71
    v_lshlrev_b32 v200, 16, v72
    v_and_b32 v201, 0xffff0000, v72
    v_lshlrev_b32 v202, 16, v73
    v_and_b32 v203, 0xffff0000, v73
    v_lshlrev_b32 v204, 16, v74
    v_and_b32 v205, 0xffff0000, v74
    v_lshlrev_b32 v206, 16, v75
    v_and_b32 v207, 0xffff0000, v75
    s_cmp_lt_u32 s2, 180
    s_cselect_b32 s3, 2, 0
    s_cmp_lt_u32 s51, s3
    s_cselect_b32 s3, 0, 0x40000000
    v_mul_u32_u24 v68, 128, v0
    v_or_b32 v68, s3, v68
    s_mul_i32 s15, s51, 16384
    s_add_u32 s15, s15, 6815744
    s_add_u32 s59, s15, 8192
    s_lshl_b32 s3, s51, 7
    s_sub_u32 s3, s96, s3
    v_cmp_eq_u32 s[60:61], s3, v0
    s_sub_u32 s3, s3, 64
    v_cmp_eq_u32 s[62:63], s3, v0
    s_waitcnt vmcnt(5)
    s_add_u32 s46, s46, 9216
    buffer_load_dwordx4 v[248:251], v5, s[88:91], s46 offen sc1
    buffer_load_dwordx4 v[252:255], v5, s[28:31], s46 offen sc1
    v_lshlrev_b32 v100, 16, v224
    v_and_b32 v101, 0xffff0000, v224
    v_pk_add_f32 v[24:25], v[24:25], v[100:101]
    v_lshlrev_b32 v102, 16, v225
    v_and_b32 v103, 0xffff0000, v225
    v_pk_add_f32 v[26:27], v[26:27], v[102:103]
    v_lshlrev_b32 v100, 16, v226
    v_and_b32 v101, 0xffff0000, v226
    v_pk_add_f32 v[28:29], v[28:29], v[100:101]
    v_lshlrev_b32 v102, 16, v227
    v_and_b32 v103, 0xffff0000, v227
    v_pk_add_f32 v[30:31], v[30:31], v[102:103]
    s_waitcnt vmcnt(6)
    v_lshlrev_b32 v100, 16, v228
    v_and_b32 v101, 0xffff0000, v228
    v_pk_add_f32 v[16:17], v[16:17], v[100:101]
    v_lshlrev_b32 v102, 16, v229
    v_and_b32 v103, 0xffff0000, v229
    v_pk_add_f32 v[18:19], v[18:19], v[102:103]
    v_lshlrev_b32 v100, 16, v230
    v_and_b32 v101, 0xffff0000, v230
    v_pk_add_f32 v[20:21], v[20:21], v[100:101]
    v_lshlrev_b32 v102, 16, v231
    v_and_b32 v103, 0xffff0000, v231
    v_pk_add_f32 v[22:23], v[22:23], v[102:103]
    s_waitcnt vmcnt(5)
    v_lshlrev_b32 v100, 16, v232
    v_and_b32 v101, 0xffff0000, v232
    v_pk_add_f32 v[24:25], v[24:25], v[100:101]
    v_lshlrev_b32 v102, 16, v233
    v_and_b32 v103, 0xffff0000, v233
    v_pk_add_f32 v[26:27], v[26:27], v[102:103]
    v_lshlrev_b32 v100, 16, v234
    v_and_b32 v101, 0xffff0000, v234
    v_pk_add_f32 v[28:29], v[28:29], v[100:101]
    v_lshlrev_b32 v102, 16, v235
    v_and_b32 v103, 0xffff0000, v235
    v_pk_add_f32 v[30:31], v[30:31], v[102:103]
    s_waitcnt vmcnt(4)
    v_lshlrev_b32 v100, 16, v236
    v_and_b32 v101, 0xffff0000, v236
    v_pk_add_f32 v[16:17], v[16:17], v[100:101]
    v_lshlrev_b32 v102, 16, v237
    v_and_b32 v103, 0xffff0000, v237
    v_pk_add_f32 v[18:19], v[18:19], v[102:103]
    v_lshlrev_b32 v100, 16, v238
    v_and_b32 v101, 0xffff0000, v238
    v_pk_add_f32 v[20:21], v[20:21], v[100:101]
    v_lshlrev_b32 v102, 16, v239
    v_and_b32 v103, 0xffff0000, v239
    v_pk_add_f32 v[22:23], v[22:23], v[102:103]
    s_waitcnt vmcnt(3)
    v_lshlrev_b32 v100, 16, v240
    v_and_b32 v101, 0xffff0000, v240
    v_pk_add_f32 v[24:25], v[24:25], v[100:101]
    v_lshlrev_b32 v102, 16, v241
    v_and_b32 v103, 0xffff0000, v241
    v_pk_add_f32 v[26:27], v[26:27], v[102:103]
    v_lshlrev_b32 v100, 16, v242
    v_and_b32 v101, 0xffff0000, v242
    v_pk_add_f32 v[28:29], v[28:29], v[100:101]
    v_lshlrev_b32 v102, 16, v243
    v_and_b32 v103, 0xffff0000, v243
    v_pk_add_f32 v[30:31], v[30:31], v[102:103]
    s_waitcnt vmcnt(2)
    v_lshlrev_b32 v100, 16, v244
    v_and_b32 v101, 0xffff0000, v244
    v_pk_add_f32 v[16:17], v[16:17], v[100:101]
    v_lshlrev_b32 v102, 16, v245
    v_and_b32 v103, 0xffff0000, v245
    v_pk_add_f32 v[18:19], v[18:19], v[102:103]
    v_lshlrev_b32 v100, 16, v246
    v_and_b32 v101, 0xffff0000, v246
    v_pk_add_f32 v[20:21], v[20:21], v[100:101]
    v_lshlrev_b32 v102, 16, v247
    v_and_b32 v103, 0xffff0000, v247
    v_pk_add_f32 v[22:23], v[22:23], v[102:103]
    s_waitcnt vmcnt(1)
    v_lshlrev_b32 v100, 16, v248
    v_and_b32 v101, 0xffff0000, v248
    v_pk_add_f32 v[24:25], v[24:25], v[100:101]
    v_lshlrev_b32 v102, 16, v249
    v_and_b32 v103, 0xffff0000, v249
    v_pk_add_f32 v[26:27], v[26:27], v[102:103]
    v_lshlrev_b32 v100, 16, v250
    v_and_b32 v101, 0xffff0000, v250
    v_pk_add_f32 v[28:29], v[28:29], v[100:101]
    v_lshlrev_b32 v102, 16, v251
    v_and_b32 v103, 0xffff0000, v251
    v_pk_add_f32 v[30:31], v[30:31], v[102:103]
    s_waitcnt vmcnt(0)
    v_lshlrev_b32 v100, 16, v252
    v_and_b32 v101, 0xffff0000, v252
    v_pk_add_f32 v[16:17], v[16:17], v[100:101]
    v_lshlrev_b32 v102, 16, v253
    v_and_b32 v103, 0xffff0000, v253
    v_pk_add_f32 v[18:19], v[18:19], v[102:103]
    v_lshlrev_b32 v100, 16, v254
    v_and_b32 v101, 0xffff0000, v254
    v_pk_add_f32 v[20:21], v[20:21], v[100:101]
    v_lshlrev_b32 v102, 16, v255
    v_and_b32 v103, 0xffff0000, v255
    v_pk_add_f32 v[22:23], v[22:23], v[102:103]
    v_pk_fma_f32 v[16:17], v[16:17], v[40:41], v[184:185]
    v_pk_fma_f32 v[18:19], v[18:19], v[42:43], v[186:187]
    v_pk_fma_f32 v[20:21], v[20:21], v[44:45], v[188:189]
    v_pk_fma_f32 v[22:23], v[22:23], v[46:47], v[190:191]
    v_pk_fma_f32 v[24:25], v[24:25], v[48:49], v[192:193]
    v_pk_fma_f32 v[26:27], v[26:27], v[50:51], v[194:195]
    v_pk_fma_f32 v[28:29], v[28:29], v[52:53], v[196:197]
    v_pk_fma_f32 v[30:31], v[30:31], v[54:55], v[198:199]
    v_pk_fma_f32 v[32:33], v[32:33], v[56:57], v[200:201]
    v_pk_fma_f32 v[34:35], v[34:35], v[58:59], v[202:203]
    v_pk_fma_f32 v[36:37], v[36:37], v[60:61], v[204:205]
    v_pk_fma_f32 v[38:39], v[38:39], v[62:63], v[206:207]
    v_pk_add_f32 v[12:13], v[16:17], v[18:19]
    v_pk_add_f32 v[12:13], v[12:13], v[20:21]
    v_pk_add_f32 v[12:13], v[12:13], v[22:23]
    v_pk_add_f32 v[12:13], v[12:13], v[24:25]
    v_pk_add_f32 v[12:13], v[12:13], v[26:27]
    v_pk_add_f32 v[12:13], v[12:13], v[28:29]
    v_pk_add_f32 v[12:13], v[12:13], v[30:31]
    v_pk_add_f32 v[14:15], v[32:33], v[34:35]
    v_pk_add_f32 v[14:15], v[14:15], v[36:37]
    v_pk_add_f32 v[14:15], v[14:15], v[38:39]
    v_add_f32 v100, v12, v13
    v_add_f32 v14, v14, v15
    v_fmac_f32 v100, 0x3e800000, v14
    s_nop 1
    v_add_f32_dpp v100, v100, v100 row_ror:8 row_mask:0xf bank_mask:0xf
    v_mov_b32 v103, v100
    s_nop 1
    v_permlane16_swap_b32 v103, v100
    v_add_f32 v100, v100, v103
    v_mov_b32 v103, v100
    s_nop 1
    v_permlane32_swap_b32 v103, v100
    v_add_f32 v100, v100, v103
    v_mul_f32 v100, 0x3be38e39, v100
    v_pk_add_f32 v[184:185], v[16:17], v[100:101] op_sel_hi:[1,0] neg_lo:[0,1] neg_hi:[0,1]
    v_pk_add_f32 v[186:187], v[18:19], v[100:101] op_sel_hi:[1,0] neg_lo:[0,1] neg_hi:[0,1]
    v_pk_add_f32 v[188:189], v[20:21], v[100:101] op_sel_hi:[1,0] neg_lo:[0,1] neg_hi:[0,1]
    v_pk_add_f32 v[190:191], v[22:23], v[100:101] op_sel_hi:[1,0] neg_lo:[0,1] neg_hi:[0,1]
    v_pk_add_f32 v[192:193], v[24:25], v[100:101] op_sel_hi:[1,0] neg_lo:[0,1] neg_hi:[0,1]
    v_pk_add_f32 v[194:195], v[26:27], v[100:101] op_sel_hi:[1,0] neg_lo:[0,1] neg_hi:[0,1]
    v_pk_add_f32 v[196:197], v[28:29], v[100:101] op_sel_hi:[1,0] neg_lo:[0,1] neg_hi:[0,1]
    v_pk_add_f32 v[198:199], v[30:31], v[100:101] op_sel_hi:[1,0] neg_lo:[0,1] neg_hi:[0,1]
    v_pk_add_f32 v[200:201], v[32:33], v[100:101] op_sel_hi:[1,0] neg_lo:[0,1] neg_hi:[0,1]
    v_pk_add_f32 v[202:203], v[34:35], v[100:101] op_sel_hi:[1,0] neg_lo:[0,1] neg_hi:[0,1]
    v_pk_add_f32 v[204:205], v[36:37], v[100:101] op_sel_hi:[1,0] neg_lo:[0,1] neg_hi:[0,1]
    v_pk_add_f32 v[206:207], v[38:39], v[100:101] op_sel_hi:[1,0] neg_lo:[0,1] neg_hi:[0,1]
    v_pk_mul_f32 v[12:13], v[184:185], v[184:185]
    v_pk_fma_f32 v[12:13], v[186:187], v[186:187], v[12:13]
    v_pk_fma_f32 v[12:13], v[188:189], v[188:189], v[12:13]
    v_pk_fma_f32 v[12:13], v[190:191], v[190:191], v[12:13]
    v_pk_fma_f32 v[12:13], v[192:193], v[192:193], v[12:13]
    v_pk_fma_f32 v[12:13], v[194:195], v[194:195], v[12:13]
    v_pk_fma_f32 v[12:13], v[196:197], v[196:197], v[12:13]
    v_pk_fma_f32 v[12:13], v[198:199], v[198:199], v[12:13]
    v_pk_mul_f32 v[14:15], v[200:201], v[200:201]
    v_pk_fma_f32 v[14:15], v[202:203], v[202:203], v[14:15]
    v_pk_fma_f32 v[14:15], v[204:205], v[204:205], v[14:15]
    v_pk_fma_f32 v[14:15], v[206:207], v[206:207], v[14:15]
    v_add_f32 v101, v12, v13
    v_add_f32 v14, v14, v15
    v_fmac_f32 v101, 0x3e800000, v14
    v_pk_mul_f32 v[12:13], v[184:185], v[76:77]
    v_pk_fma_f32 v[12:13], v[186:187], v[78:79], v[12:13]
    v_pk_fma_f32 v[12:13], v[188:189], v[80:81], v[12:13]
    v_pk_fma_f32 v[12:13], v[190:191], v[82:83], v[12:13]
    v_pk_fma_f32 v[12:13], v[192:193], v[84:85], v[12:13]
    v_pk_fma_f32 v[12:13], v[194:195], v[86:87], v[12:13]
    v_pk_fma_f32 v[12:13], v[196:197], v[88:89], v[12:13]
    v_pk_fma_f32 v[12:13], v[198:199], v[90:91], v[12:13]
    v_pk_mul_f32 v[14:15], v[200:201], v[92:93]
    v_pk_fma_f32 v[14:15], v[202:203], v[94:95], v[14:15]
    v_pk_fma_f32 v[14:15], v[204:205], v[96:97], v[14:15]
    v_pk_fma_f32 v[14:15], v[206:207], v[98:99], v[14:15]
    v_add_f32 v102, v12, v13
    v_add_f32 v14, v14, v15
    v_fmac_f32 v102, 0x3e800000, v14
    s_nop 1
    v_add_f32_dpp v101, v101, v101 row_ror:8 row_mask:0xf bank_mask:0xf
    v_add_f32_dpp v102, v102, v102 row_ror:8 row_mask:0xf bank_mask:0xf
    v_mov_b32 v103, v101
    v_mov_b32 v104, v102
    s_nop 0
    v_permlane16_swap_b32 v103, v101
    v_permlane16_swap_b32 v104, v102
    v_add_f32 v101, v101, v103
    v_add_f32 v102, v102, v104
    v_mov_b32 v103, v101
    v_mov_b32 v104, v102
    s_nop 0
    v_permlane32_swap_b32 v103, v101
    v_permlane32_swap_b32 v104, v102
    v_add_f32 v101, v101, v103
    v_add_f32 v102, v102, v104
    ds_write_b32 v10, v100 offset:0
    ds_write_b32 v10, v101 offset:128
    ds_write_b32 v10, v102 offset:256
    s_waitcnt lgkmcnt(0)
    s_barrier
    ds_read_b128 v[40:43], v11 offset:0
    ds_read_b128 v[44:47], v11 offset:128
    ds_read_b128 v[48:51], v11 offset:256
    ds_read_b128 v[52:55], v11 offset:384
    ds_read_b128 v[56:59], v11 offset:512
    s_waitcnt lgkmcnt(4)
    v_add_f32 v12, v40, v41
    v_add_f32 v13, v42, v43
    v_add_f32 v12, v12, v13
    v_mul_f32 v12, 0x3e800000, v12
    v_sub_f32 v40, v40, v12
    v_sub_f32 v41, v41, v12
    v_sub_f32 v42, v42, v12
    v_sub_f32 v43, v43, v12
    v_sub_f32 v100, v100, v12
    v_mul_f32 v13, v40, v40
    v_fmac_f32 v13, v41, v41
    v_fmac_f32 v13, v42, v42
    v_fmac_f32 v13, v43, v43
    s_waitcnt lgkmcnt(3)
    v_add_f32 v14, v44, v45
    v_add_f32 v15, v46, v47
    v_add_f32 v14, v14, v15
    v_fmac_f32 v14, 0x43100000, v13
    v_mov_b32 v13, 0x3727c5ac
    v_fmac_f32 v13, 0x3ae38e39, v14
    v_rsq_f32 v13, v13
    s_waitcnt lgkmcnt(0)
    v_pk_fma_f32 v[48:49], v[40:41], v[52:53], v[48:49]
    v_pk_fma_f32 v[50:51], v[42:43], v[54:55], v[50:51]
    v_pk_add_f32 v[48:49], v[48:49], v[50:51]
    v_pk_add_f32 v[56:57], v[56:57], v[58:59]
    v_add_f32 v14, v48, v49
    v_add_f32 v15, v56, v57
    v_fmac_f32 v15, v14, v13
    v_ashrrev_i32 v12, 31, v15
    v_or_b32 v12, 0x80000000, v12
    v_xor_b32 v12, v12, v15
    v_and_or_b32 v44, v12, s57, v6
    v_mov_b32 v45, 0
    s_nop 1
    v_mov_b32_dpp v14, v44 row_ror:1 row_mask:0xf bank_mask:0xf
    v_mov_b32_dpp v15, v45 row_ror:1 row_mask:0xf bank_mask:0xf
    v_max_u32 v45, v45, v15
    v_med3_u32 v45, v44, v14, v45
    v_max_u32 v44, v44, v14
    s_nop 1
    v_mov_b32_dpp v14, v44 row_ror:2 row_mask:0xf bank_mask:0xf
    v_mov_b32_dpp v15, v45 row_ror:2 row_mask:0xf bank_mask:0xf
    v_max_u32 v45, v45, v15
    v_med3_u32 v45, v44, v14, v45
    v_max_u32 v44, v44, v14
    s_nop 1
    v_mov_b32_dpp v14, v44 row_ror:4 row_mask:0xf bank_mask:0xf
    v_mov_b32_dpp v15, v45 row_ror:4 row_mask:0xf bank_mask:0xf
    v_max_u32 v45, v45, v15
    v_med3_u32 v45, v44, v14, v45
    v_max_u32 v44, v44, v14
    buffer_store_dwordx2 v[44:45], v9, s[84:87], s58 offen offset:8 sc1
    v_mul_f32 v100, v100, v13
    v_pk_fma_f32 v[184:185], v[184:185], v[12:13], v[100:101] op_sel:[0,1,0] op_sel_hi:[1,1,0]
    v_pk_fma_f32 v[186:187], v[186:187], v[12:13], v[100:101] op_sel:[0,1,0] op_sel_hi:[1,1,0]
    v_pk_fma_f32 v[188:189], v[188:189], v[12:13], v[100:101] op_sel:[0,1,0] op_sel_hi:[1,1,0]
    v_pk_fma_f32 v[190:191], v[190:191], v[12:13], v[100:101] op_sel:[0,1,0] op_sel_hi:[1,1,0]
    v_pk_fma_f32 v[192:193], v[192:193], v[12:13], v[100:101] op_sel:[0,1,0] op_sel_hi:[1,1,0]
    v_pk_fma_f32 v[194:195], v[194:195], v[12:13], v[100:101] op_sel:[0,1,0] op_sel_hi:[1,1,0]
    v_pk_fma_f32 v[196:197], v[196:197], v[12:13], v[100:101] op_sel:[0,1,0] op_sel_hi:[1,1,0]
    v_pk_fma_f32 v[198:199], v[198:199], v[12:13], v[100:101] op_sel:[0,1,0] op_sel_hi:[1,1,0]
    v_pk_fma_f32 v[200:201], v[200:201], v[12:13], v[100:101] op_sel:[0,1,0] op_sel_hi:[1,1,0]
    v_pk_fma_f32 v[202:203], v[202:203], v[12:13], v[100:101] op_sel:[0,1,0] op_sel_hi:[1,1,0]
    v_pk_fma_f32 v[204:205], v[204:205], v[12:13], v[100:101] op_sel:[0,1,0] op_sel_hi:[1,1,0]
    v_pk_fma_f32 v[206:207], v[206:207], v[12:13], v[100:101] op_sel:[0,1,0] op_sel_hi:[1,1,0]
    v_pk_fma_f32 v[184:185], v[184:185], v[112:113], v[136:137]
    v_pk_fma_f32 v[186:187], v[186:187], v[114:115], v[138:139]
    v_pk_fma_f32 v[188:189], v[188:189], v[116:117], v[140:141]
    v_pk_fma_f32 v[190:191], v[190:191], v[118:119], v[142:143]
    v_pk_fma_f32 v[192:193], v[192:193], v[120:121], v[144:145]
    v_pk_fma_f32 v[194:195], v[194:195], v[122:123], v[146:147]
    v_pk_fma_f32 v[196:197], v[196:197], v[124:125], v[148:149]
    v_pk_fma_f32 v[198:199], v[198:199], v[126:127], v[150:151]
    v_pk_fma_f32 v[200:201], v[200:201], v[128:129], v[152:153]
    v_pk_fma_f32 v[202:203], v[202:203], v[130:131], v[154:155]
    v_pk_fma_f32 v[204:205], v[204:205], v[132:133], v[156:157]
    v_pk_fma_f32 v[206:207], v[206:207], v[134:135], v[158:159]
    v_cvt_pk_bf16_f32 v124, v184, v185
    v_cvt_pk_bf16_f32 v125, v186, v187
    v_cvt_pk_bf16_f32 v126, v188, v189
    v_cvt_pk_bf16_f32 v127, v190, v191
    v_min_u32 v124, -2, v124
    v_min_u32 v125, -2, v125
    v_min_u32 v126, -2, v126
    v_min_u32 v127, -2, v127
    ds_write_b128 v1, v[124:127] offset:9344
    v_cvt_pk_bf16_f32 v128, v192, v193
    v_cvt_pk_bf16_f32 v129, v194, v195
    v_cvt_pk_bf16_f32 v130, v196, v197
    v_cvt_pk_bf16_f32 v131, v198, v199
    v_min_u32 v128, -2, v128
    v_min_u32 v129, -2, v129
    v_min_u32 v130, -2, v130
    v_min_u32 v131, -2, v131
    ds_write_b128 v1, v[128:131] offset:9856
    v_cvt_pk_bf16_f32 v132, v200, v201
    v_cvt_pk_bf16_f32 v133, v202, v203
    v_cvt_pk_bf16_f32 v134, v204, v205
    v_cvt_pk_bf16_f32 v135, v206, v207
    v_min_u32 v132, -2, v132
    v_min_u32 v133, -2, v133
    v_min_u32 v134, -2, v134
    v_min_u32 v135, -2, v135
    ds_write_b128 v2, v[132:135] offset:9344
    v_pk_fma_f32 v[16:17], v[184:185], v[160:161], v[16:17]
    v_pk_fma_f32 v[18:19], v[186:187], v[162:163], v[18:19]
    v_pk_fma_f32 v[20:21], v[188:189], v[164:165], v[20:21]
    v_pk_fma_f32 v[22:23], v[190:191], v[166:167], v[22:23]
    v_pk_fma_f32 v[24:25], v[192:193], v[168:169], v[24:25]
    v_pk_fma_f32 v[26:27], v[194:195], v[170:171], v[26:27]
    v_pk_fma_f32 v[28:29], v[196:197], v[172:173], v[28:29]
    v_pk_fma_f32 v[30:31], v[198:199], v[174:175], v[30:31]
    v_pk_fma_f32 v[32:33], v[200:201], v[176:177], v[32:33]
    v_pk_fma_f32 v[34:35], v[202:203], v[178:179], v[34:35]
    v_pk_fma_f32 v[36:37], v[204:205], v[180:181], v[36:37]
    v_pk_fma_f32 v[38:39], v[206:207], v[182:183], v[38:39]
    v_cvt_pk_bf16_f32 v112, v16, v17
    v_cvt_pk_bf16_f32 v113, v18, v19
    v_cvt_pk_bf16_f32 v114, v20, v21
    v_cvt_pk_bf16_f32 v115, v22, v23
    ds_write_b128 v1, v[112:115] offset:0
    v_cvt_pk_bf16_f32 v116, v24, v25
    v_cvt_pk_bf16_f32 v117, v26, v27
    v_cvt_pk_bf16_f32 v118, v28, v29
    v_cvt_pk_bf16_f32 v119, v30, v31
    ds_write_b128 v1, v[116:119] offset:512
    v_cvt_pk_bf16_f32 v120, v32, v33
    v_cvt_pk_bf16_f32 v121, v34, v35
    v_cvt_pk_bf16_f32 v122, v36, v37
    v_cvt_pk_bf16_f32 v123, v38, v39
    ds_write_b128 v2, v[120:123] offset:0
    v_lshrrev_b32 v7, 4, v0
    v_and_b32 v6, 1, v0
    v_bfe_u32 v5, v0, 2, 2
    v_lshlrev_b32 v5, 6, v5
    v_lshl_add_u32 v5, v7, 4, v5
    v_mov_b32 v14, 15616
    s_movk_i32 s57, 1168
    s_waitcnt lgkmcnt(0)
    s_barrier
    s_cmp_lt_u32 s51, 2
    s_cbranch_scc1 L2_keys
    s_cmp_eq_u32 s51, 2
    s_cbranch_scc1 L2_rows
L2_pad15:
    s_cbranch_execz L2_walkret
    v_not_b32 v12, v44
    v_not_b32 v13, v45
    v_and_b32 v12, 7, v12
    v_and_b32 v13, 7, v13
    v_cmp_gt_u32 vcc, 8, v0
    v_mul_u32_u24 v148, 1168, v12
    v_mul_u32_u24 v149, 1168, v13
    v_cndmask_b32 v15, v13, v12, vcc
    v_add_u32 v148, v148, v107
    v_add_u32 v149, v149, v107
    ds_read_b128 v[136:139], v148
    ds_read_b128 v[140:143], v149
    v_lshrrev_b32 v150, 3, v0
    v_sub_u32 v15, v15, v150
    v_mad_i32_i24 v150, v15, s57, v108
    ds_read_b128 v[144:147], v150 offset:1024
    s_movk_i32 s3, 1152
    v_mad_u32_u24 v12, v12, s3, v8
    v_mad_u32_u24 v13, v13, s3, v8
    v_mad_i32_i24 v15, v15, s3, v109
    s_waitcnt lgkmcnt(2)
    buffer_store_dwordx4 v[136:139], v12, s[24:27], 0 offen sc1
    s_waitcnt lgkmcnt(1)
    buffer_store_dwordx4 v[140:143], v13, s[24:27], 0 offen sc1
    s_mov_b64 exec, 0xffff
    s_waitcnt lgkmcnt(0)
    buffer_store_dwordx4 v[144:147], v15, s[24:27], 0 offen offset:1024 sc1
    s_mov_b64 exec, -1
    s_branch L2_rowsdone
L2_rows:
    ds_read_b128 v[136:139], v107 offset:0
    ds_read_b128 v[140:143], v107 offset:1168
    ds_read_b128 v[144:147], v107 offset:2336
    ds_read_b128 v[148:151], v107 offset:3504
    ds_read_b128 v[152:155], v107 offset:4672
    ds_read_b128 v[156:159], v107 offset:5840
    ds_read_b128 v[160:163], v107 offset:7008
    ds_read_b128 v[164:167], v107 offset:8176
    ds_read_b128 v[168:171], v108 offset:1024
    s_movk_i32 s3, 0
    s_waitcnt lgkmcnt(8)
    buffer_store_dwordx4 v[136:139], v8, s[24:27], s3 offen offset:0 sc1
    s_waitcnt lgkmcnt(7)
    buffer_store_dwordx4 v[140:143], v8, s[24:27], s3 offen offset:1152 sc1
    s_waitcnt lgkmcnt(6)
    buffer_store_dwordx4 v[144:147], v8, s[24:27], s3 offen offset:2304 sc1
    s_waitcnt lgkmcnt(5)
    buffer_store_dwordx4 v[148:151], v8, s[24:27], s3 offen offset:3456 sc1
    s_movk_i32 s3, 4608
    s_waitcnt lgkmcnt(4)
    buffer_store_dwordx4 v[152:155], v8, s[24:27], s3 offen offset:0 sc1
    s_waitcnt lgkmcnt(3)
    buffer_store_dwordx4 v[156:159], v8, s[24:27], s3 offen offset:1152 sc1
    s_waitcnt lgkmcnt(2)
    buffer_store_dwordx4 v[160:163], v8, s[24:27], s3 offen offset:2304 sc1
    s_waitcnt lgkmcnt(1)
    buffer_store_dwordx4 v[164:167], v8, s[24:27], s3 offen offset:3456 sc1
    s_waitcnt lgkmcnt(0)
    buffer_store_dwordx4 v[168:171], v109, s[24:27], 0 offen offset:1024 sc1
L2_rowsdone:
    ds_read_b64_tr_b16 a[64:65], v110 offset:0
    ds_read_b64_tr_b16 a[66:67], v110 offset:256
    ds_read_b64_tr_b16 a[68:69], v110 offset:2048
    ds_read_b64_tr_b16 a[70:71], v110 offset:2304
    ds_read_b64_tr_b16 a[72:73], v110 offset:4096
    ds_read_b64_tr_b16 a[74:75], v110 offset:4352
    ds_read_b64_tr_b16 a[76:77], v110 offset:6144
    ds_read_b64_tr_b16 a[78:79], v110 offset:6400
    ds_read_b64_tr_b16 a[80:81], v110 offset:8192
    ds_read_b64_tr_b16 a[82:83], v110 offset:8448
    ds_read_b64_tr_b16 a[84:85], v110 offset:10240
    ds_read_b64_tr_b16 a[86:87], v110 offset:10496
    ds_read_b64_tr_b16 a[88:89], v110 offset:12288
    ds_read_b64_tr_b16 a[90:91], v110 offset:12544
    ds_read_b64_tr_b16 a[92:93], v110 offset:14336
    ds_read_b64_tr_b16 a[94:95], v110 offset:14592
    ds_read_b64_tr_b16 a[96:97], v110 offset:16384
    ds_read_b64_tr_b16 a[98:99], v110 offset:16640
    ds_read_b64_tr_b16 a[100:101], v110 offset:18432
    ds_read_b64_tr_b16 a[102:103], v110 offset:18688
    ds_read_b64_tr_b16 a[104:105], v110 offset:20480
    ds_read_b64_tr_b16 a[106:107], v110 offset:20736
    ds_read_b64_tr_b16 a[108:109], v110 offset:22528
    ds_read_b64_tr_b16 a[110:111], v110 offset:22784
    ds_read_b64_tr_b16 a[112:113], v110 offset:24576
    ds_read_b64_tr_b16 a[114:115], v110 offset:24832
    ds_read_b64_tr_b16 a[116:117], v110 offset:26624
    ds_read_b64_tr_b16 a[118:119], v110 offset:26880
    ds_read_b64_tr_b16 a[120:121], v110 offset:28672
    ds_read_b64_tr_b16 a[122:123], v110 offset:28928
    ds_read_b64_tr_b16 a[124:125], v110 offset:30720
    ds_read_b64_tr_b16 a[126:127], v110 offset:30976
    ds_read_b64_tr_b16 a[128:129], v110 offset:32768
    ds_read_b64_tr_b16 a[130:131], v110 offset:33024
    ds_read_b64_tr_b16 a[132:133], v110 offset:34816
    ds_read_b64_tr_b16 a[134:135], v110 offset:35072
    ds_read_b64_tr_b16 a[136:137], v111 offset:0
    ds_read_b64_tr_b16 a[138:139], v111 offset:4608
    ds_read_b64_tr_b16 a[140:141], v111 offset:32
    ds_read_b64_tr_b16 a[142:143], v111 offset:4640
    ds_read_b64_tr_b16 a[144:145], v111 offset:64
    ds_read_b64_tr_b16 a[146:147], v111 offset:4672
    ds_read_b64_tr_b16 a[148:149], v111 offset:96
    ds_read_b64_tr_b16 a[150:151], v111 offset:4704
    ds_read_b64_tr_b16 a[152:153], v111 offset:128
    ds_read_b64_tr_b16 a[154:155], v111 offset:4736
    ds_read_b64_tr_b16 a[156:157], v111 offset:160
    ds_read_b64_tr_b16 a[158:159], v111 offset:4768
    ds_read_b64_tr_b16 a[160:161], v111 offset:192
    ds_read_b64_tr_b16 a[162:163], v111 offset:4800
    ds_read_b64_tr_b16 a[164:165], v111 offset:224
    ds_read_b64_tr_b16 a[166:167], v111 offset:4832
    ds_read_b64_tr_b16 a[168:169], v111 offset:256
    ds_read_b64_tr_b16 a[170:171], v111 offset:4864
    s_cmp_lt_u32 s2, 144
    s_cbranch_scc1 L2_join
    s_waitcnt vmcnt(0)
    buffer_store_dword v14, v9, s[84:87], s56 offen offset:128 sc1
    s_cmp_lt_u32 s2, 180
    s_cbranch_scc1 L2_join
    s_branch L2_fin
L2_keys:
    s_cmp_ge_u32 s2, 180
    s_cbranch_scc1 L2_fin
    buffer_load_dwordx2 v[64:65], v68, s[84:87], s15 offen offset:8 sc1
    buffer_load_dwordx2 v[66:67], v68, s[84:87], s59 offen offset:8 sc1
    ds_read_b64_tr_b16 a[64:65], v110 offset:0
    ds_read_b64_tr_b16 a[66:67], v110 offset:256
    ds_read_b64_tr_b16 a[68:69], v110 offset:2048
    ds_read_b64_tr_b16 a[70:71], v110 offset:2304
    ds_read_b64_tr_b16 a[72:73], v110 offset:4096
    ds_read_b64_tr_b16 a[74:75], v110 offset:4352
    ds_read_b64_tr_b16 a[76:77], v110 offset:6144
    ds_read_b64_tr_b16 a[78:79], v110 offset:6400
    ds_read_b64_tr_b16 a[80:81], v110 offset:8192
    ds_read_b64_tr_b16 a[82:83], v110 offset:8448
    ds_read_b64_tr_b16 a[84:85], v110 offset:10240
    ds_read_b64_tr_b16 a[86:87], v110 offset:10496
    ds_read_b64_tr_b16 a[88:89], v110 offset:12288
    ds_read_b64_tr_b16 a[90:91], v110 offset:12544
    ds_read_b64_tr_b16 a[92:93], v110 offset:14336
    ds_read_b64_tr_b16 a[94:95], v110 offset:14592
    ds_read_b64_tr_b16 a[96:97], v110 offset:16384
    ds_read_b64_tr_b16 a[98:99], v110 offset:16640
    ds_read_b64_tr_b16 a[100:101], v110 offset:18432
    ds_read_b64_tr_b16 a[102:103], v110 offset:18688
    ds_read_b64_tr_b16 a[104:105], v110 offset:20480
    ds_read_b64_tr_b16 a[106:107], v110 offset:20736
    ds_read_b64_tr_b16 a[108:109], v110 offset:22528
    ds_read_b64_tr_b16 a[110:111], v110 offset:22784
    ds_read_b64_tr_b16 a[112:113], v110 offset:24576
    ds_read_b64_tr_b16 a[114:115], v110 offset:24832
    ds_read_b64_tr_b16 a[116:117], v110 offset:26624
    ds_read_b64_tr_b16 a[118:119], v110 offset:26880
    ds_read_b64_tr_b16 a[120:121], v110 offset:28672
    ds_read_b64_tr_b16 a[122:123], v110 offset:28928
    ds_read_b64_tr_b16 a[124:125], v110 offset:30720
    ds_read_b64_tr_b16 a[126:127], v110 offset:30976
    ds_read_b64_tr_b16 a[128:129], v110 offset:32768
    ds_read_b64_tr_b16 a[130:131], v110 offset:33024
    ds_read_b64_tr_b16 a[132:133], v110 offset:34816
    ds_read_b64_tr_b16 a[134:135], v110 offset:35072
    ds_read_b64_tr_b16 a[136:137], v111 offset:0
    ds_read_b64_tr_b16 a[138:139], v111 offset:4608
    ds_read_b64_tr_b16 a[140:141], v111 offset:32
    ds_read_b64_tr_b16 a[142:143], v111 offset:4640
    ds_read_b64_tr_b16 a[144:145], v111 offset:64
    ds_read_b64_tr_b16 a[146:147], v111 offset:4672
    ds_read_b64_tr_b16 a[148:149], v111 offset:96
    ds_read_b64_tr_b16 a[150:151], v111 offset:4704
    ds_read_b64_tr_b16 a[152:153], v111 offset:128
    ds_read_b64_tr_b16 a[154:155], v111 offset:4736
    ds_read_b64_tr_b16 a[156:157], v111 offset:160
    ds_read_b64_tr_b16 a[158:159], v111 offset:4768
    ds_read_b64_tr_b16 a[160:161], v111 offset:192
    ds_read_b64_tr_b16 a[162:163], v111 offset:4800
    ds_read_b64_tr_b16 a[164:165], v111 offset:224
    ds_read_b64_tr_b16 a[166:167], v111 offset:4832
    ds_read_b64_tr_b16 a[168:169], v111 offset:256
    ds_read_b64_tr_b16 a[170:171], v111 offset:4864
    s_waitcnt vmcnt(0)
    v_cndmask_b32 v64, v64, v44, s[60:61]
    v_cndmask_b32 v65, v65, v45, s[60:61]
    v_cndmask_b32 v66, v66, v44, s[62:63]
    v_cndmask_b32 v67, v67, v45, s[62:63]
    v_min_u32 v12, v64, v65
    v_min_u32 v13, v66, v67
    v_cmp_eq_u32 s[4:5], 0, v12
    v_cmp_eq_u32 s[6:7], 0, v13
    s_nop 0
    s_or_b64 vcc, s[4:5], s[6:7]
    s_cbranch_scc0 L2_p2_ok
    s_mov_b32 s97, 0x20000
L2_p2:
    s_or_b64 exec, s[4:5], 1
    buffer_load_dwordx2 v[64:65], v68, s[84:87], s15 offen offset:8 sc1
    s_or_b64 exec, s[6:7], 1
    buffer_load_dwordx2 v[66:67], v68, s[84:87], s59 offen offset:8 sc1
    s_mov_b64 exec, -1
    s_waitcnt vmcnt(0)
    v_cndmask_b32 v64, v64, v44, s[60:61]
    v_cndmask_b32 v65, v65, v45, s[60:61]
    v_cndmask_b32 v66, v66, v44, s[62:63]
    v_cndmask_b32 v67, v67, v45, s[62:63]
    v_min_u32 v12, v64, v65
    v_min_u32 v13, v66, v67
    v_cmp_eq_u32 s[4:5], 0, v12
    v_cmp_eq_u32 s[6:7], 0, v13
    s_nop 0
    s_or_b64 vcc, s[4:5], s[6:7]
    s_sub_u32 s97, s97, 1
    s_cselect_b64 vcc, 0, vcc
    s_cmp_eq_u64 vcc, 0
    s_cbranch_scc1 L2_p2_ok
    s_sleep 1
    s_branch L2_p2
L2_p2_ok:
    v_max_u32 v65, v65, v67
    v_med3_u32 v65, v64, v66, v65
    v_max_u32 v64, v64, v66
    s_nop 1
    v_mov_b32_dpp v12, v64 row_ror:1 row_mask:0xf bank_mask:0xf
    v_mov_b32_dpp v13, v65 row_ror:1 row_mask:0xf bank_mask:0xf
    v_max_u32 v65, v65, v13
    v_med3_u32 v65, v64, v12, v65
    v_max_u32 v64, v64, v12
    s_nop 1
    v_mov_b32_dpp v12, v64 row_ror:2 row_mask:0xf bank_mask:0xf
    v_mov_b32_dpp v13, v65 row_ror:2 row_mask:0xf bank_mask:0xf
    v_max_u32 v65, v65, v13
    v_med3_u32 v65, v64, v12, v65
    v_max_u32 v64, v64, v12
    s_nop 1
    v_mov_b32_dpp v12, v64 row_ror:4 row_mask:0xf bank_mask:0xf
    v_mov_b32_dpp v13, v65 row_ror:4 row_mask:0xf bank_mask:0xf
    v_max_u32 v65, v65, v13
    v_med3_u32 v65, v64, v12, v65
    v_max_u32 v64, v64, v12
    s_nop 1
    v_mov_b32_dpp v12, v64 row_ror:8 row_mask:0xf bank_mask:0xf
    v_mov_b32_dpp v13, v65 row_ror:8 row_mask:0xf bank_mask:0xf
    v_max_u32 v65, v65, v13
    v_med3_u32 v65, v64, v12, v65
    v_max_u32 v64, v64, v12
    v_mov_b32 v12, v64
    v_mov_b32 v13, v65
    s_nop 0
    v_permlane16_swap_b32 v12, v64
    v_permlane16_swap_b32 v13, v65
    v_max_u32 v65, v65, v13
    v_med3_u32 v65, v64, v12, v65
    v_max_u32 v64, v64, v12
    v_mov_b32 v12, v64
    v_mov_b32 v13, v65
    s_nop 0
    v_permlane32_swap_b32 v12, v64
    v_permlane32_swap_b32 v13, v65
    v_max_u32 v65, v65, v13
    v_med3_u32 v65, v64, v12, v65
    v_max_u32 v64, v64, v12
    s_lshl3_add_u32 s3, s51, 15616
    v_mov_b32 v12, s3
    ds_write_b64 v12, v[64:65]
    s_waitcnt lgkmcnt(0)
L2_join:
    s_barrier
    ds_read_b128 v[16:19], v14
    v_cmp_eq_u32 vcc, 0, v6
    s_waitcnt lgkmcnt(0)
    v_max_u32 v17, v17, v19
    v_med3_u32 v17, v16, v18, v17
    v_max_u32 v16, v16, v18
    v_cndmask_b32 v16, v17, v16, vcc
    v_and_b32 v3, 0x7ff, v16
    v_sub_u32 v3, 2047, v3
    v_mul_u32_u24 v4, 1152, v3
    s_cmp_ge_u32 s2, 144
    s_cbranch_scc1 L2_red
    v_add_u32 v5, v5, v4
    s_mov_b32 s59, 4194304
    v_and_b32 v12, 8, v0
    v_lshlrev_b32 v12, 4, v12
    v_sub_u32 v3, v5, v12
    buffer_load_dwordx4 v[128:131], v5, s[84:87], s59 offen offset:0 sc1
    buffer_load_dwordx4 v[132:135], v5, s[84:87], s59 offen offset:256 sc1
    buffer_load_dwordx4 v[136:139], v5, s[84:87], s59 offen offset:512 sc1
    buffer_load_dwordx4 v[140:143], v5, s[84:87], s59 offen offset:768 sc1
    buffer_load_dwordx4 v[144:147], v3, s[84:87], s59 offen offset:1024 sc1
    v_lshlrev_b32 v11, 7, v6
    v_lshl_add_u32 v13, v7, 5, v11
    v_add_u32 v13, 14848, v13
    v_lshl_add_u32 v11, v7, 4, v11
    s_lshr_b32 s3, s51, 1
    s_lshl_b32 s3, s3, 8
    s_and_b32 s14, s51, 1
    s_lshl_b32 s14, s14, 6
    s_add_u32 s3, s3, s14
    s_add_u32 s3, s3, 14848
    v_add_u32 v11, s3, v11
    s_mul_i32 s14, s51, 1152
    s_mul_i32 s15, s2, 4608
    s_add_u32 s15, s15, s14
    s_add_u32 s15, s15, 98304
    v_lshlrev_b32 v10, 3, v0
    s_waitcnt vmcnt(0)
    buffer_store_dword v14, v9, s[84:87], s56 offen offset:128 sc1
L2_hr:
    v_mfma_f32_16x16x32_bf16 v[88:91], a[64:67], v[128:131], 0
    v_max_u32 v12, v128, v129
    v_mfma_f32_16x16x32_bf16 v[92:95], a[68:71], v[128:131], 0
    v_max3_u32 v12, v12, v130, v131
    v_mfma_f32_16x16x32_bf16 v[96:99], a[72:75], v[128:131], 0
    v_max3_u32 v12, v12, v132, v133
    v_mfma_f32_16x16x32_bf16 v[100:103], a[76:79], v[128:131], 0
    v_max3_u32 v12, v12, v134, v135
    v_mfma_f32_16x16x32_bf16 v[88:91], a[80:83], v[132:135], v[88:91]
    v_max3_u32 v12, v12, v136, v137
    v_mfma_f32_16x16x32_bf16 v[92:95], a[84:87], v[132:135], v[92:95]
    v_max3_u32 v12, v12, v138, v139
    v_mfma_f32_16x16x32_bf16 v[96:99], a[88:91], v[132:135], v[96:99]
    v_max3_u32 v12, v12, v140, v141
    v_mfma_f32_16x16x32_bf16 v[100:103], a[92:95], v[132:135], v[100:103]
    v_max3_u32 v12, v12, v142, v143
    v_mfma_f32_16x16x32_bf16 v[88:91], a[96:99], v[136:139], v[88:91]
    v_max3_u32 v12, v12, v144, v145
    v_mfma_f32_16x16x32_bf16 v[92:95], a[100:103], v[136:139], v[92:95]
    v_max3_u32 v12, v12, v146, v147
    v_mfma_f32_16x16x32_bf16 v[96:99], a[104:107], v[136:139], v[96:99]
    v_cmp_eq_u32 vcc, -1, v12
    v_mfma_f32_16x16x32_bf16 v[100:103], a[108:111], v[136:139], v[100:103]
    v_mfma_f32_16x16x32_bf16 v[96:99], a[120:123], v[140:143], v[96:99]
    v_mfma_f32_16x16x32_bf16 v[100:103], a[124:127], v[140:143], v[100:103]
    v_mfma_f32_16x16x32_bf16 v[88:91], a[112:115], v[140:143], v[88:91]
    v_mfma_f32_16x16x32_bf16 v[92:95], a[116:119], v[140:143], v[92:95]
    v_mfma_f32_16x16x32_bf16 v[92:95], a[132:135], v[144:147], v[92:95]
    v_mfma_f32_16x16x32_bf16 v[88:91], a[128:131], v[144:147], v[88:91]
    s_cmp_lg_u64 vcc, 0
    s_cbranch_scc1 L2_hs
    s_nop 1
    v_add_f32_dpp v96, v100, v96 row_shl:4 row_mask:0xf bank_mask:0xf bound_ctrl:1
    v_add_f32_dpp v97, v101, v97 row_shl:4 row_mask:0xf bank_mask:0xf bound_ctrl:1
    v_add_f32_dpp v98, v102, v98 row_shl:4 row_mask:0xf bank_mask:0xf bound_ctrl:1
    v_add_f32_dpp v99, v103, v99 row_shl:4 row_mask:0xf bank_mask:0xf bound_ctrl:1
    v_add_f32_dpp v88, v92, v88 row_shl:4 row_mask:0xf bank_mask:0xf bound_ctrl:1
    v_add_f32_dpp v89, v93, v89 row_shl:4 row_mask:0xf bank_mask:0xf bound_ctrl:1
    v_add_f32_dpp v90, v94, v90 row_shl:4 row_mask:0xf bank_mask:0xf bound_ctrl:1
    v_add_f32_dpp v91, v95, v91 row_shl:4 row_mask:0xf bank_mask:0xf bound_ctrl:1
    v_add_f32_dpp v88, v96, v88 row_shl:8 row_mask:0xf bank_mask:0xf bound_ctrl:1
    v_add_f32_dpp v89, v97, v89 row_shl:8 row_mask:0xf bank_mask:0xf bound_ctrl:1
    v_add_f32_dpp v90, v98, v90 row_shl:8 row_mask:0xf bank_mask:0xf bound_ctrl:1
    v_add_f32_dpp v91, v99, v91 row_shl:8 row_mask:0xf bank_mask:0xf bound_ctrl:1
    s_mov_b32 exec_lo, 0x30003
    s_mov_b32 exec_hi, 0x30003
    ds_write_b128 v11, v[88:91]
    s_mov_b64 exec, -1
    s_waitcnt lgkmcnt(0)
    s_barrier
    ds_read_b128 v[16:19], v13 offset:0
    ds_read_b128 v[20:23], v13 offset:16
    ds_read_b128 v[24:27], v13 offset:256
    ds_read_b128 v[28:31], v13 offset:272
    v_mov_b32 v12, 0xbfb8aa3b
    s_waitcnt lgkmcnt(2)
    v_pk_mul_f32 v[32:33], v[16:17], v[12:13] op_sel_hi:[1,0]
    v_pk_mul_f32 v[34:35], v[18:19], v[12:13] op_sel_hi:[1,0]
    v_pk_mul_f32 v[36:37], v[20:21], v[12:13] op_sel_hi:[1,0]
    v_pk_mul_f32 v[38:39], v[22:23], v[12:13] op_sel_hi:[1,0]
    v_exp_f32 v32, v32
    v_exp_f32 v33, v33
    v_exp_f32 v34, v34
    v_exp_f32 v35, v35
    v_exp_f32 v36, v36
    v_exp_f32 v37, v37
    v_exp_f32 v38, v38
    v_exp_f32 v39, v39
    v_pk_add_f32 v[32:33], v[32:33], 1.0 op_sel_hi:[1,0]
    v_pk_add_f32 v[34:35], v[34:35], 1.0 op_sel_hi:[1,0]
    v_pk_add_f32 v[36:37], v[36:37], 1.0 op_sel_hi:[1,0]
    v_pk_add_f32 v[38:39], v[38:39], 1.0 op_sel_hi:[1,0]
    v_rcp_f32 v32, v32
    v_rcp_f32 v33, v33
    v_rcp_f32 v34, v34
    v_rcp_f32 v35, v35
    v_rcp_f32 v36, v36
    v_rcp_f32 v37, v37
    v_rcp_f32 v38, v38
    v_rcp_f32 v39, v39
    s_waitcnt lgkmcnt(0)
    v_pk_mul_f32 v[16:17], v[16:17], v[32:33]
    v_pk_mul_f32 v[18:19], v[18:19], v[34:35]
    v_pk_mul_f32 v[20:21], v[20:21], v[36:37]
    v_pk_mul_f32 v[22:23], v[22:23], v[38:39]
    v_pk_mul_f32 v[16:17], v[16:17], v[24:25]
    v_pk_mul_f32 v[18:19], v[18:19], v[26:27]
    v_pk_mul_f32 v[20:21], v[20:21], v[28:29]
    v_pk_mul_f32 v[22:23], v[22:23], v[30:31]
    v_cvt_pk_bf16_f32 v40, v16, v17
    v_cvt_pk_bf16_f32 v41, v18, v19
    v_cvt_pk_bf16_f32 v42, v20, v21
    v_cvt_pk_bf16_f32 v43, v22, v23
    s_nop 1
    v_mfma_f32_16x16x32_bf16 v[48:51], v[40:43], a[136:139], 0
    v_mfma_f32_16x16x32_bf16 v[52:55], v[40:43], a[140:143], 0
    v_mfma_f32_16x16x32_bf16 v[56:59], v[40:43], a[144:147], 0
    v_mfma_f32_16x16x32_bf16 v[60:63], v[40:43], a[148:151], 0
    v_mfma_f32_16x16x32_bf16 v[64:67], v[40:43], a[152:155], 0
    v_mfma_f32_16x16x32_bf16 v[68:71], v[40:43], a[156:159], 0
    v_mfma_f32_16x16x32_bf16 v[72:75], v[40:43], a[160:163], 0
    v_mfma_f32_16x16x32_bf16 v[76:79], v[40:43], a[164:167], 0
    v_mfma_f32_16x16x32_bf16 v[80:83], v[40:43], a[168:171], 0
    s_nop 0
    v_mov_b32_dpp v48, v52 quad_perm:[0,1,2,3] row_mask:0x2 bank_mask:0xf
    v_mov_b32_dpp v49, v53 quad_perm:[0,1,2,3] row_mask:0x2 bank_mask:0xf
    s_nop 0
    v_mov_b32_dpp v48, v56 quad_perm:[0,1,2,3] row_mask:0x4 bank_mask:0xf
    v_mov_b32_dpp v49, v57 quad_perm:[0,1,2,3] row_mask:0x4 bank_mask:0xf
    s_nop 0
    v_mov_b32_dpp v48, v60 quad_perm:[0,1,2,3] row_mask:0x8 bank_mask:0xf
    v_mov_b32_dpp v49, v61 quad_perm:[0,1,2,3] row_mask:0x8 bank_mask:0xf
    v_mov_b32_dpp v50, v64 quad_perm:[0,1,2,3] row_mask:0x1 bank_mask:0xf
    v_mov_b32_dpp v51, v65 quad_perm:[0,1,2,3] row_mask:0x1 bank_mask:0xf
    s_nop 0
    v_mov_b32_dpp v50, v68 quad_perm:[0,1,2,3] row_mask:0x2 bank_mask:0xf
    v_mov_b32_dpp v51, v69 quad_perm:[0,1,2,3] row_mask:0x2 bank_mask:0xf
    s_nop 0
    v_mov_b32_dpp v50, v72 quad_perm:[0,1,2,3] row_mask:0x4 bank_mask:0xf
    v_mov_b32_dpp v51, v73 quad_perm:[0,1,2,3] row_mask:0x4 bank_mask:0xf
    s_nop 0
    v_mov_b32_dpp v50, v76 quad_perm:[0,1,2,3] row_mask:0x8 bank_mask:0xf
    v_mov_b32_dpp v51, v77 quad_perm:[0,1,2,3] row_mask:0x8 bank_mask:0xf
    v_min_u32 v48, -2, v48
    v_min_u32 v49, -2, v49
    v_min_u32 v50, -2, v50
    v_min_u32 v51, -2, v51
    v_min_u32 v80, -2, v80
    v_min_u32 v81, -2, v81
    buffer_store_dwordx4 v[48:51], v8, s[84:87], s15 offen sc1
    s_mov_b64 exec, 0xffff
    buffer_store_dwordx2 v[80:81], v10, s[84:87], s15 offen offset:1024 sc1
    s_branch L2_fin
L2_red:
    s_mov_b32 s3, 98304
    s_add_u32 s32, s84, s3
    s_addc_u32 s33, s85, 0
    s_mov_b32 s34, 663552
    s_mov_b32 s35, 0x20000
    s_sub_u32 s3, s2, 144
    s_mul_i32 s14, s3, 7282
    s_lshr_b32 s14, s14, 16
    s_mul_i32 s15, s14, 9
    s_sub_u32 s15, s3, s15
    s_mul_i32 s14, s14, 144
    s_cmp_eq_u32 s15, 8
    s_cselect_b32 s56, 1, 64
    s_cselect_b32 s57, 2, 1
    s_cselect_b32 s15, 16, s15
    s_lshl3_add_u32 s14, s15, s14
    v_bfe_u32 v7, v0, 2, 3
    v_mul_u32_u24 v7, s57, v7
    v_bfe_u32 v9, v0, 1, 1
    v_mul_u32_u24 v9, s56, v9
    v_add3_u32 v7, v7, v9, s14
    v_lshl_add_u32 v9, v7, 1, v4
    v_lshlrev_b32 v7, 2, v7
    v_lshrrev_b32 v12, 7, v3
    v_bfe_u32 v13, v3, 3, 4
    v_lshl_add_u32 v13, v12, 6, v13
    v_lshlrev_b32 v13, 8, v13
    s_mov_b32 s59, 794624
    s_mov_b32 s97, 0x20000
L2_r:
    buffer_load_dword v12, v13, s[84:87], s59 offen offset:128 sc1
    s_waitcnt vmcnt(0)
    v_cmp_eq_u32 vcc, 0, v12
    s_sub_u32 s97, s97, 1
    s_cselect_b64 vcc, 0, vcc
    s_cmp_eq_u64 vcc, 0
    s_cbranch_scc1 L2_r_ok
    s_sleep 1
    s_branch L2_r
L2_r_ok:
    buffer_load_ushort v18, v9, s[80:83], 0 offen sc1
    ds_read_b32 v20, v7 offset:6912
    v_and_b32 v6, 7, v0
    v_lshrrev_b32 v10, 3, v0
    s_lshl_b32 s14, s51, 3
    v_add_u32 v10, s14, v10
    v_mul_u32_u24 v10, 4608, v10
    v_lshl_add_u32 v10, v6, 4, v10
    s_lshl_b32 s3, s3, 7
    v_add_u32 v24, s3, v10
    v_add_u32 v25, 147456, v24
    v_add_u32 v26, 294912, v24
    v_add_u32 v27, 442368, v24
    v_add_u32 v28, 589824, v24
    v_and_b32 v16, 0xfffff800, v16
    v_not_b32 v12, v16
    v_ashrrev_i32 v12, 31, v12
    v_or_b32 v12, 0x80000000, v12
    v_xor_b32 v16, v16, v12
    v_mul_f32 v16, 0xbfb8aa3b, v16
    v_exp_f32 v16, v16
    s_nop 0
    v_add_f32 v16, 1.0, v16
    v_rcp_f32 v16, v16
    s_waitcnt lgkmcnt(0)
    v_mul_f32 v20, v20, v16
    s_lshl_b32 s14, s51, 7
    s_add_u32 s14, s14, 15872
    v_lshl_add_u32 v10, v6, 4, s14
    v_and_b32 v11, 31, v0
    v_lshlrev_b32 v11, 2, v11
    s_mov_b32 s97, 0x20000
L2_p3:
    buffer_load_dwordx4 v[32:35], v24, s[32:35], 0 offen sc1
    buffer_load_dwordx4 v[36:39], v25, s[32:35], 0 offen sc1
    buffer_load_dwordx4 v[40:43], v26, s[32:35], 0 offen sc1
    buffer_load_dwordx4 v[44:47], v27, s[32:35], 0 offen sc1
    buffer_load_dwordx4 v[48:51], v28, s[32:35], 0 offen sc1
    s_waitcnt vmcnt(0)
    v_max3_u32 v12, v32, v33, v34
    v_max3_u32 v12, v12, v35, v36
    v_max3_u32 v12, v12, v37, v38
    v_max3_u32 v12, v12, v39, v40
    v_max3_u32 v12, v12, v41, v42
    v_max3_u32 v12, v12, v43, v44
    v_max3_u32 v12, v12, v45, v46
    v_max3_u32 v12, v12, v47, v48
    v_max3_u32 v12, v12, v49, v50
    v_max_u32 v12, v12, v51
    v_cmp_eq_u32 vcc, -1, v12
    s_sub_u32 s97, s97, 1
    s_cselect_b64 vcc, 0, vcc
    s_cmp_eq_u64 vcc, 0
    s_cbranch_scc1 L2_p3_ok
    s_branch L2_p3
L2_p3_ok:
    v_pk_add_f32 v[32:33], v[32:33], v[36:37]
    v_pk_add_f32 v[40:41], v[40:41], v[44:45]
    v_pk_add_f32 v[32:33], v[32:33], v[48:49]
    v_pk_add_f32 v[32:33], v[32:33], v[40:41]
    v_pk_add_f32 v[34:35], v[34:35], v[38:39]
    v_pk_add_f32 v[42:43], v[42:43], v[46:47]
    v_pk_add_f32 v[34:35], v[34:35], v[50:51]
    v_pk_add_f32 v[34:35], v[34:35], v[42:43]
    s_nop 1
    v_add_f32_dpp v32, v32, v32 row_ror:8 row_mask:0xf bank_mask:0xf
    v_add_f32_dpp v33, v33, v33 row_ror:8 row_mask:0xf bank_mask:0xf
    v_add_f32_dpp v34, v34, v34 row_ror:8 row_mask:0xf bank_mask:0xf
    v_add_f32_dpp v35, v35, v35 row_ror:8 row_mask:0xf bank_mask:0xf
    v_mov_b32 v12, v32
    v_mov_b32 v13, v33
    v_mov_b32 v14, v34
    v_mov_b32 v15, v35
    v_permlane16_swap_b32 v12, v32
    v_permlane16_swap_b32 v13, v33
    v_permlane16_swap_b32 v14, v34
    v_permlane16_swap_b32 v15, v35
    v_add_f32 v32, v32, v12
    v_add_f32 v33, v33, v13
    v_add_f32 v34, v34, v14
    v_add_f32 v35, v35, v15
    v_mov_b32 v12, v32
    v_mov_b32 v13, v33
    v_mov_b32 v14, v34
    v_mov_b32 v15, v35
    v_permlane32_swap_b32 v12, v32
    v_permlane32_swap_b32 v13, v33
    v_permlane32_swap_b32 v14, v34
    v_permlane32_swap_b32 v15, v35
    v_add_f32 v32, v32, v12
    v_add_f32 v33, v33, v13
    v_add_f32 v34, v34, v14
    v_add_f32 v35, v35, v15
    ds_write_b128 v10, v[32:35]
    s_waitcnt lgkmcnt(0)
    s_barrier
    s_cmp_lg_u32 s51, 0
    s_cbranch_scc1 L2_fin
    ds_read_b32 v32, v11 offset:15872
    ds_read_b32 v33, v11 offset:16000
    ds_read_b32 v34, v11 offset:16128
    ds_read_b32 v35, v11 offset:16256
    v_lshlrev_b32 v12, 16, v18
    s_mov_b32 exec_hi, 0
    s_waitcnt lgkmcnt(0)
    v_pk_add_f32 v[32:33], v[32:33], v[34:35]
    v_add_f32 v32, v32, v33
    v_fmac_f32 v12, v32, v20
    v_cvt_pk_bf16_f32 v12, v12, v12
    buffer_store_short v12, v9, s[80:83], 0 offen sc1
L2_fin:
L2_end:
    s_endpgm
L2_p0s:
    s_mov_b32 s97, 0x20000
L2_p0:
    buffer_load_dword v51, v156, s[60:63], 0 offen sc1
    s_waitcnt vmcnt(0)
    v_cmp_eq_u32 vcc, 0, v51
    s_sub_u32 s97, s97, 1
    s_cselect_b64 vcc, 0, vcc
    s_cmp_eq_u64 vcc, 0
    s_cbranch_scc1 L2_p0_ok
    s_sleep 1
    s_branch L2_p0
L2_p0_ok:
    s_branch L2_p0r
L2_pms:
    s_mov_b32 s97, 0x20000
L2_pm:
    buffer_load_dwordx4 v[168:171], v166, s[84:87], 0 offen sc1
    buffer_load_dwordx4 v[176:179], v166, s[84:87], s14 offen sc1
    s_mov_b64 exec, 0xff
    buffer_load_dwordx4 v[172:175], v166, s[84:87], 0 offen offset:1024 sc1
    buffer_load_dwordx4 v[180:183], v166, s[84:87], s14 offen offset:1024 sc1
    s_mov_b64 exec, -1
    s_waitcnt vmcnt(0)
    v_max_u32 v13, v168, v169
    v_max3_u32 v13, v13, v170, v171
    v_max3_u32 v13, v13, v172, v173
    v_max3_u32 v13, v13, v174, v175
    v_max3_u32 v13, v13, v176, v177
    v_max3_u32 v13, v13, v178, v179
    v_max3_u32 v13, v13, v180, v181
    v_max3_u32 v13, v13, v182, v183
    v_cmp_eq_u32 vcc, -1, v13
    s_sub_u32 s97, s97, 1
    s_cselect_b64 vcc, 0, vcc
    s_cmp_eq_u64 vcc, 0
    s_cbranch_scc1 L2_pm_ok
    s_sleep 1
    s_branch L2_pm
L2_pm_ok:
    s_branch L2_pmr
L2_g0s:
    s_mov_b32 s97, 0x20000
L2_g0:
    buffer_load_dword v9, v6, s[84:87], s47 offen sc1
    s_waitcnt vmcnt(0)
    v_cmp_ne_u32 vcc, 0, v9
    s_nop 0
    s_lshr_b32 s3, vcc_lo, 1
    s_and_b32 s3, s3, vcc_lo
    s_lshr_b32 s14, s3, 2
    s_and_b32 s3, s3, s14
    s_and_b32 s3, s3, s48
    s_cselect_b64 vcc, 0, -1
    s_sub_u32 s97, s97, 1
    s_cselect_b64 vcc, 0, vcc
    s_cmp_eq_u64 vcc, 0
    s_cbranch_scc1 L2_g0_ok
    s_sleep 1
    s_branch L2_g0
L2_g0_ok:
    s_cmp_eq_u32 s3, 0
    s_cselect_b32 s3, s48, s3
    s_branch L2_g0r
L2_g1s:
    s_mov_b32 s97, 0x20000
L2_g1:
    buffer_load_dword v9, v6, s[84:87], s47 offen sc1
    s_waitcnt vmcnt(0)
    v_cmp_ne_u32 vcc, 0, v9
    s_nop 0
    s_lshr_b32 s3, vcc_lo, 1
    s_and_b32 s3, s3, vcc_lo
    s_lshr_b32 s14, s3, 2
    s_and_b32 s3, s3, s14
    s_and_b32 s3, s3, s48
    s_cselect_b64 vcc, 0, -1
    s_sub_u32 s97, s97, 1
    s_cselect_b64 vcc, 0, vcc
    s_cmp_eq_u64 vcc, 0
    s_cbranch_scc1 L2_g1_ok
    s_sleep 1
    s_branch L2_g1
L2_g1_ok:
    s_cmp_eq_u32 s3, 0
    s_cselect_b32 s3, s48, s3
    s_branch L2_g1r
L2_pns:
    s_mov_b32 s97, 0x20000
L2_pn:
    s_movk_i32 s45, 4608
    buffer_load_dwordx4 v[76:79], v5, s[84:87], s45 offen sc1
    s_movk_i32 s45, 18432
    buffer_load_dwordx4 v[88:91], v5, s[84:87], s45 offen sc1
    s_movk_i32 s45, 8704
    buffer_load_dwordx4 v[80:83], v5, s[84:87], s45 offen sc1
    s_movk_i32 s45, 22528
    buffer_load_dwordx4 v[92:95], v5, s[84:87], s45 offen sc1
    s_movk_i32 s45, 12800
    buffer_load_dwordx4 v[84:87], v59, s[84:87], s45 offen sc1
    s_movk_i32 s45, 26624
    buffer_load_dwordx4 v[96:99], v59, s[84:87], s45 offen sc1
    s_waitcnt vmcnt(0)
    v_max_u32 v13, v76, v77
    v_max3_u32 v13, v13, v78, v79
    v_max3_u32 v13, v13, v88, v89
    v_max3_u32 v13, v13, v90, v91
    v_max3_u32 v13, v13, v80, v81
    v_max3_u32 v13, v13, v82, v83
    v_max3_u32 v13, v13, v92, v93
    v_max3_u32 v13, v13, v94, v95
    v_max3_u32 v13, v13, v84, v85
    v_max3_u32 v13, v13, v86, v87
    v_max3_u32 v13, v13, v96, v97
    v_max3_u32 v13, v13, v98, v99
    v_cmp_eq_u32 vcc, -1, v13
    s_sub_u32 s97, s97, 1
    s_cselect_b64 vcc, 0, vcc
    s_cmp_eq_u64 vcc, 0
    s_cbranch_scc1 L2_pn_ok
    s_sleep 1
    s_branch L2_pn
L2_pn_ok:
    s_branch L2_pnr
L2_g2s:
    s_mov_b32 s97, 0x20000
L2_g2:
    buffer_load_dword v9, v6, s[84:87], s47 offen sc1
    s_waitcnt vmcnt(0)
    v_cmp_ne_u32 vcc, 0, v9
    s_nop 0
    s_lshr_b32 s3, vcc_lo, 1
    s_and_b32 s3, s3, vcc_lo
    s_lshr_b32 s14, s3, 2
    s_and_b32 s3, s3, s14
    s_and_b32 s3, s3, s48
    s_cselect_b64 vcc, 0, -1
    s_sub_u32 s97, s97, 1
    s_cselect_b64 vcc, 0, vcc
    s_cmp_eq_u64 vcc, 0
    s_cbranch_scc1 L2_g2_ok
    s_sleep 1
    s_branch L2_g2
L2_g2_ok:
    s_cmp_eq_u32 s3, 0
    s_cselect_b32 s3, s48, s3
    s_branch L2_g2r
L2_g3s:
    s_mov_b32 s97, 0x20000
L2_g3:
    buffer_load_dword v9, v6, s[84:87], s47 offen sc1
    s_waitcnt vmcnt(0)
    v_cmp_ne_u32 vcc, 0, v9
    s_nop 0
    s_lshr_b32 s3, vcc_lo, 1
    s_and_b32 s3, s3, vcc_lo
    s_lshr_b32 s14, s3, 2
    s_and_b32 s3, s3, s14
    s_and_b32 s3, s3, s48
    s_cselect_b64 vcc, 0, -1
    s_sub_u32 s97, s97, 1
    s_cselect_b64 vcc, 0, vcc
    s_cmp_eq_u64 vcc, 0
    s_cbranch_scc1 L2_g3_ok
    s_sleep 1
    s_branch L2_g3
L2_g3_ok:
    s_cmp_eq_u32 s3, 0
    s_cselect_b32 s3, s48, s3
    s_branch L2_g3r
L2_hs:
    s_mov_b32 s97, 0x20000
L2_h:
    buffer_load_dwordx4 v[128:131], v5, s[84:87], s59 offen offset:0 sc1
    buffer_load_dwordx4 v[132:135], v5, s[84:87], s59 offen offset:256 sc1
    buffer_load_dwordx4 v[136:139], v5, s[84:87], s59 offen offset:512 sc1
    buffer_load_dwordx4 v[140:143], v5, s[84:87], s59 offen offset:768 sc1
    buffer_load_dwordx4 v[144:147], v3, s[84:87], s59 offen offset:1024 sc1
    s_waitcnt vmcnt(0)
    v_max_u32 v12, v128, v129
    v_max3_u32 v12, v12, v130, v131
    v_max3_u32 v12, v12, v132, v133
    v_max3_u32 v12, v12, v134, v135
    v_max3_u32 v12, v12, v136, v137
    v_max3_u32 v12, v12, v138, v139
    v_max3_u32 v12, v12, v140, v141
    v_max3_u32 v12, v12, v142, v143
    v_max3_u32 v12, v12, v144, v145
    v_max3_u32 v12, v12, v146, v147
    v_cmp_eq_u32 vcc, -1, v12
    s_sub_u32 s97, s97, 1
    s_cselect_b64 vcc, 0, vcc
    s_cmp_eq_u64 vcc, 0
    s_cbranch_scc1 L2_h_ok
    s_sleep 1
    s_branch L2_h
L2_h_ok:
    v_min_u32 v128, -2, v128
    v_min_u32 v129, -2, v129
    v_min_u32 v130, -2, v130
    v_min_u32 v131, -2, v131
    v_min_u32 v132, -2, v132
    v_min_u32 v133, -2, v133
    v_min_u32 v134, -2, v134
    v_min_u32 v135, -2, v135
    v_min_u32 v136, -2, v136
    v_min_u32 v137, -2, v137
    v_min_u32 v138, -2, v138
    v_min_u32 v139, -2, v139
    v_min_u32 v140, -2, v140
    v_min_u32 v141, -2, v141
    v_min_u32 v142, -2, v142
    v_min_u32 v143, -2, v143
    v_min_u32 v144, -2, v144
    v_min_u32 v145, -2, v145
    v_min_u32 v146, -2, v146
    v_min_u32 v147, -2, v147
    s_nop 1
    s_branch L2_hr
L2_fallback:
    s_waitcnt vmcnt(0) lgkmcnt(0)
    s_nop 7
    s_barrier
    s_lshl_b32 s3, s51, 12
    v_add_u32 v5, s3, v8
    v_lshrrev_b32 v14, 2, v0
    v_mul_u32_u24 v14, 1056, v14
    v_and_b32 v15, 3, v0
    v_lshl_add_u32 v14, v15, 3, v14
    v_add_u32 v2, 107008, v14
    v_and_b32 v14, 15, v0
    v_mul_u32_u24 v14, 1056, v14
    v_lshrrev_b32 v15, 4, v0
    v_lshl_add_u32 v14, v15, 4, v14
    v_add_u32 v1, 90112, v14
    v_mov_b32 v32, 0xff800000
    v_mov_b32 v33, 0xff800000
    v_mov_b32 v34, 0xff800000
    v_mov_b32 v35, 0xff800000
    s_mov_b32 s50, 1
    s_mov_b32 s46, 0
L2_fb_loop:
    s_add_u32 m0, s44, 73728
    s_nop 0
    buffer_load_dwordx4 off, s[16:19], s46 offset:0 lds
    s_add_u32 m0, s44, 73760
    s_nop 0
    buffer_load_dwordx4 off, s[16:19], s46 offset:1024 lds
    s_add_u32 m0, s44, 73792
    s_nop 0
    buffer_load_dwordx4 off, s[16:19], s46 offset:2048 lds
    s_add_u32 m0, s44, 73824
    s_nop 0
    buffer_load_dwordx4 off, s[16:19], s46 offset:3072 lds
    s_waitcnt vmcnt(0) lgkmcnt(0)
    s_barrier
    ds_read_b128 a[64:67], v1 offset:0
    ds_read_b128 a[68:71], v1 offset:64
    ds_read_b128 a[72:75], v1 offset:128
    ds_read_b128 a[76:79], v1 offset:192
    ds_read_b128 a[80:83], v1 offset:256
    ds_read_b128 a[84:87], v1 offset:320
    ds_read_b128 a[88:91], v1 offset:384
    ds_read_b128 a[92:95], v1 offset:448
    ds_read_b128 a[96:99], v1 offset:512
    ds_read_b128 a[100:103], v1 offset:576
    ds_read_b128 a[104:107], v1 offset:640
    ds_read_b128 a[108:111], v1 offset:704
    ds_read_b128 a[112:115], v1 offset:768
    ds_read_b128 a[116:119], v1 offset:832
    ds_read_b128 a[120:123], v1 offset:896
    ds_read_b128 a[124:127], v1 offset:960
    s_waitcnt vmcnt(0) lgkmcnt(0)
    s_barrier
    v_mfma_f32_16x16x32_bf16 v[16:19], a[64:67], v[64:67], 0
    v_mfma_f32_16x16x32_bf16 v[16:19], a[68:71], v[68:71], v[16:19]
    v_mfma_f32_16x16x32_bf16 v[16:19], a[72:75], v[72:75], v[16:19]
    v_mfma_f32_16x16x32_bf16 v[16:19], a[76:79], v[76:79], v[16:19]
    v_mfma_f32_16x16x32_bf16 v[20:23], a[80:83], v[64:67], 0
    v_mfma_f32_16x16x32_bf16 v[20:23], a[84:87], v[68:71], v[20:23]
    v_mfma_f32_16x16x32_bf16 v[20:23], a[88:91], v[72:75], v[20:23]
    v_mfma_f32_16x16x32_bf16 v[20:23], a[92:95], v[76:79], v[20:23]
    v_mfma_f32_16x16x32_bf16 v[24:27], a[96:99], v[64:67], 0
    v_mfma_f32_16x16x32_bf16 v[24:27], a[100:103], v[68:71], v[24:27]
    v_mfma_f32_16x16x32_bf16 v[24:27], a[104:107], v[72:75], v[24:27]
    v_mfma_f32_16x16x32_bf16 v[24:27], a[108:111], v[76:79], v[24:27]
    v_mfma_f32_16x16x32_bf16 v[28:31], a[112:115], v[64:67], 0
    v_mfma_f32_16x16x32_bf16 v[28:31], a[116:119], v[68:71], v[28:31]
    v_mfma_f32_16x16x32_bf16 v[28:31], a[120:123], v[72:75], v[28:31]
    v_mfma_f32_16x16x32_bf16 v[28:31], a[124:127], v[76:79], v[28:31]
    s_nop 7
    v_max3_f32 v32, v32, v16, v17
    v_max3_f32 v32, v32, v18, v19
    v_max3_f32 v32, v32, v20, v21
    v_max3_f32 v32, v32, v22, v23
    v_max3_f32 v32, v32, v24, v25
    v_max3_f32 v32, v32, v26, v27
    v_max3_f32 v32, v32, v28, v29
    v_max3_f32 v32, v32, v30, v31
    v_mfma_f32_16x16x32_bf16 v[16:19], a[64:67], v[80:83], 0
    v_mfma_f32_16x16x32_bf16 v[16:19], a[68:71], v[84:87], v[16:19]
    v_mfma_f32_16x16x32_bf16 v[16:19], a[72:75], v[88:91], v[16:19]
    v_mfma_f32_16x16x32_bf16 v[16:19], a[76:79], v[92:95], v[16:19]
    v_mfma_f32_16x16x32_bf16 v[20:23], a[80:83], v[80:83], 0
    v_mfma_f32_16x16x32_bf16 v[20:23], a[84:87], v[84:87], v[20:23]
    v_mfma_f32_16x16x32_bf16 v[20:23], a[88:91], v[88:91], v[20:23]
    v_mfma_f32_16x16x32_bf16 v[20:23], a[92:95], v[92:95], v[20:23]
    v_mfma_f32_16x16x32_bf16 v[24:27], a[96:99], v[80:83], 0
    v_mfma_f32_16x16x32_bf16 v[24:27], a[100:103], v[84:87], v[24:27]
    v_mfma_f32_16x16x32_bf16 v[24:27], a[104:107], v[88:91], v[24:27]
    v_mfma_f32_16x16x32_bf16 v[24:27], a[108:111], v[92:95], v[24:27]
    v_mfma_f32_16x16x32_bf16 v[28:31], a[112:115], v[80:83], 0
    v_mfma_f32_16x16x32_bf16 v[28:31], a[116:119], v[84:87], v[28:31]
    v_mfma_f32_16x16x32_bf16 v[28:31], a[120:123], v[88:91], v[28:31]
    v_mfma_f32_16x16x32_bf16 v[28:31], a[124:127], v[92:95], v[28:31]
    s_nop 7
    v_max3_f32 v33, v33, v16, v17
    v_max3_f32 v33, v33, v18, v19
    v_max3_f32 v33, v33, v20, v21
    v_max3_f32 v33, v33, v22, v23
    v_max3_f32 v33, v33, v24, v25
    v_max3_f32 v33, v33, v26, v27
    v_max3_f32 v33, v33, v28, v29
    v_max3_f32 v33, v33, v30, v31
    v_mfma_f32_16x16x32_bf16 v[16:19], a[64:67], v[96:99], 0
    v_mfma_f32_16x16x32_bf16 v[16:19], a[68:71], v[100:103], v[16:19]
    v_mfma_f32_16x16x32_bf16 v[16:19], a[72:75], v[104:107], v[16:19]
    v_mfma_f32_16x16x32_bf16 v[16:19], a[76:79], v[108:111], v[16:19]
    v_mfma_f32_16x16x32_bf16 v[20:23], a[80:83], v[96:99], 0
    v_mfma_f32_16x16x32_bf16 v[20:23], a[84:87], v[100:103], v[20:23]
    v_mfma_f32_16x16x32_bf16 v[20:23], a[88:91], v[104:107], v[20:23]
    v_mfma_f32_16x16x32_bf16 v[20:23], a[92:95], v[108:111], v[20:23]
    v_mfma_f32_16x16x32_bf16 v[24:27], a[96:99], v[96:99], 0
    v_mfma_f32_16x16x32_bf16 v[24:27], a[100:103], v[100:103], v[24:27]
    v_mfma_f32_16x16x32_bf16 v[24:27], a[104:107], v[104:107], v[24:27]
    v_mfma_f32_16x16x32_bf16 v[24:27], a[108:111], v[108:111], v[24:27]
    v_mfma_f32_16x16x32_bf16 v[28:31], a[112:115], v[96:99], 0
    v_mfma_f32_16x16x32_bf16 v[28:31], a[116:119], v[100:103], v[28:31]
    v_mfma_f32_16x16x32_bf16 v[28:31], a[120:123], v[104:107], v[28:31]
    v_mfma_f32_16x16x32_bf16 v[28:31], a[124:127], v[108:111], v[28:31]
    s_nop 7
    v_max3_f32 v34, v34, v16, v17
    v_max3_f32 v34, v34, v18, v19
    v_max3_f32 v34, v34, v20, v21
    v_max3_f32 v34, v34, v22, v23
    v_max3_f32 v34, v34, v24, v25
    v_max3_f32 v34, v34, v26, v27
    v_max3_f32 v34, v34, v28, v29
    v_max3_f32 v34, v34, v30, v31
    v_mfma_f32_16x16x32_bf16 v[16:19], a[64:67], v[112:115], 0
    v_mfma_f32_16x16x32_bf16 v[16:19], a[68:71], v[116:119], v[16:19]
    v_mfma_f32_16x16x32_bf16 v[16:19], a[72:75], v[120:123], v[16:19]
    v_mfma_f32_16x16x32_bf16 v[16:19], a[76:79], v[124:127], v[16:19]
    v_mfma_f32_16x16x32_bf16 v[20:23], a[80:83], v[112:115], 0
    v_mfma_f32_16x16x32_bf16 v[20:23], a[84:87], v[116:119], v[20:23]
    v_mfma_f32_16x16x32_bf16 v[20:23], a[88:91], v[120:123], v[20:23]
    v_mfma_f32_16x16x32_bf16 v[20:23], a[92:95], v[124:127], v[20:23]
    v_mfma_f32_16x16x32_bf16 v[24:27], a[96:99], v[112:115], 0
    v_mfma_f32_16x16x32_bf16 v[24:27], a[100:103], v[116:119], v[24:27]
    v_mfma_f32_16x16x32_bf16 v[24:27], a[104:107], v[120:123], v[24:27]
    v_mfma_f32_16x16x32_bf16 v[24:27], a[108:111], v[124:127], v[24:27]
    v_mfma_f32_16x16x32_bf16 v[28:31], a[112:115], v[112:115], 0
    v_mfma_f32_16x16x32_bf16 v[28:31], a[116:119], v[116:119], v[28:31]
    v_mfma_f32_16x16x32_bf16 v[28:31], a[120:123], v[120:123], v[28:31]
    v_mfma_f32_16x16x32_bf16 v[28:31], a[124:127], v[124:127], v[28:31]
    s_nop 7
    v_max3_f32 v35, v35, v16, v17
    v_max3_f32 v35, v35, v18, v19
    v_max3_f32 v35, v35, v20, v21
    v_max3_f32 v35, v35, v22, v23
    v_max3_f32 v35, v35, v24, v25
    v_max3_f32 v35, v35, v26, v27
    v_max3_f32 v35, v35, v28, v29
    v_max3_f32 v35, v35, v30, v31
    s_add_u32 s46, s46, 16384
    s_cmp_lt_u32 s46, 524288
    s_cbranch_scc1 L2_fb_loop
    v_mov_b32 v40, v32
    v_mov_b32 v41, v33
    v_mov_b32 v42, v34
    v_mov_b32 v43, v35
    v_permlane16_swap_b32 v40, v32
    v_permlane16_swap_b32 v41, v33
    v_permlane16_swap_b32 v42, v34
    v_permlane16_swap_b32 v43, v35
    v_max_f32 v32, v32, v40
    v_max_f32 v33, v33, v41
    v_max_f32 v34, v34, v42
    v_max_f32 v35, v35, v43
    v_mov_b32 v40, v32
    v_mov_b32 v41, v33
    v_mov_b32 v42, v34
    v_mov_b32 v43, v35
    v_permlane32_swap_b32 v40, v32
    v_permlane32_swap_b32 v41, v33
    v_permlane32_swap_b32 v42, v34
    v_permlane32_swap_b32 v43, v35
    v_max_f32 v32, v32, v40
    v_max_f32 v33, v33, v41
    v_max_f32 v34, v34, v42
    v_max_f32 v35, v35, v43
    v_sub_f32 v48, 0x80000000, v32
    v_sub_f32 v49, 0x80000000, v32
    v_sub_f32 v50, 0x80000000, v32
    v_sub_f32 v51, 0x80000000, v32
    v_sub_f32 v52, 0x80000000, v33
    v_sub_f32 v53, 0x80000000, v33
    v_sub_f32 v54, 0x80000000, v33
    v_sub_f32 v55, 0x80000000, v33
    v_sub_f32 v56, 0x80000000, v34
    v_sub_f32 v57, 0x80000000, v34
    v_sub_f32 v58, 0x80000000, v34
    v_sub_f32 v59, 0x80000000, v34
    v_sub_f32 v60, 0x80000000, v35
    v_sub_f32 v61, 0x80000000, v35
    v_sub_f32 v62, 0x80000000, v35
    v_sub_f32 v63, 0x80000000, v35
    s_add_u32 m0, s44, 73728
    s_mov_b32 s46, 0
    buffer_load_dwordx4 off, s[16:19], s46 offset:0 lds
    s_add_u32 m0, s44, 73760
    s_nop 0
    buffer_load_dwordx4 off, s[16:19], s46 offset:1024 lds
    s_add_u32 m0, s44, 73792
    s_nop 0
    buffer_load_dwordx4 off, s[16:19], s46 offset:2048 lds
    s_add_u32 m0, s44, 73824
    s_nop 0
    buffer_load_dwordx4 off, s[16:19], s46 offset:3072 lds
    s_add_u32 m0, s44, 90624
    s_nop 0
    buffer_load_dwordx4 off, s[20:23], s46 offset:0 lds
    s_add_u32 m0, s44, 90656
    s_nop 0
    buffer_load_dwordx4 off, s[20:23], s46 offset:1024 lds
    s_add_u32 m0, s44, 90688
    s_nop 0
    buffer_load_dwordx4 off, s[20:23], s46 offset:2048 lds
    s_add_u32 m0, s44, 90720
    s_nop 0
    buffer_load_dwordx4 off, s[20:23], s46 offset:3072 lds
    s_add_u32 m0, s44, 110592
    s_mov_b32 s46, 16384
    buffer_load_dwordx4 off, s[16:19], s46 offset:0 lds
    s_add_u32 m0, s44, 110624
    s_nop 0
    buffer_load_dwordx4 off, s[16:19], s46 offset:1024 lds
    s_add_u32 m0, s44, 110656
    s_nop 0
    buffer_load_dwordx4 off, s[16:19], s46 offset:2048 lds
    s_add_u32 m0, s44, 110688
    s_nop 0
    buffer_load_dwordx4 off, s[16:19], s46 offset:3072 lds
    s_add_u32 m0, s44, 127488
    s_nop 0
    buffer_load_dwordx4 off, s[20:23], s46 offset:0 lds
    s_add_u32 m0, s44, 127520
    s_nop 0
    buffer_load_dwordx4 off, s[20:23], s46 offset:1024 lds
    s_add_u32 m0, s44, 127552
    s_nop 0
    buffer_load_dwordx4 off, s[20:23], s46 offset:2048 lds
    s_add_u32 m0, s44, 127584
    s_nop 0
    buffer_load_dwordx4 off, s[20:23], s46 offset:3072 lds
    s_add_u32 m0, s44, 0
    s_mov_b32 s46, 32768
    buffer_load_dwordx4 off, s[16:19], s46 offset:0 lds
    s_add_u32 m0, s44, 32
    s_nop 0
    buffer_load_dwordx4 off, s[16:19], s46 offset:1024 lds
    s_add_u32 m0, s44, 64
    s_nop 0
    buffer_load_dwordx4 off, s[16:19], s46 offset:2048 lds
    s_add_u32 m0, s44, 96
    s_nop 0
    buffer_load_dwordx4 off, s[16:19], s46 offset:3072 lds
    s_add_u32 m0, s44, 16896
    s_nop 0
    buffer_load_dwordx4 off, s[20:23], s46 offset:0 lds
    s_add_u32 m0, s44, 16928
    s_nop 0
    buffer_load_dwordx4 off, s[20:23], s46 offset:1024 lds
    s_add_u32 m0, s44, 16960
    s_nop 0
    buffer_load_dwordx4 off, s[20:23], s46 offset:2048 lds
    s_add_u32 m0, s44, 16992
    s_nop 0
    buffer_load_dwordx4 off, s[20:23], s46 offset:3072 lds
    s_waitcnt vmcnt(0) lgkmcnt(0)
    s_barrier
    ds_read_b128 a[64:67], v1 offset:0
    ds_read_b128 a[68:71], v1 offset:64
    ds_read_b128 a[72:75], v1 offset:128
    ds_read_b128 a[76:79], v1 offset:192
    ds_read_b128 a[80:83], v1 offset:256
    ds_read_b128 a[84:87], v1 offset:320
    ds_read_b128 a[88:91], v1 offset:384
    ds_read_b128 a[92:95], v1 offset:448
    ds_read_b128 a[96:99], v1 offset:512
    ds_read_b128 a[100:103], v1 offset:576
    ds_read_b128 a[104:107], v1 offset:640
    ds_read_b128 a[108:111], v1 offset:704
    ds_read_b128 a[112:115], v1 offset:768
    ds_read_b128 a[116:119], v1 offset:832
    ds_read_b128 a[120:123], v1 offset:896
    ds_read_b128 a[124:127], v1 offset:960
    v_lshrrev_b32 v14, 2, v0
    s_mul_i32 s3, s51, 144
    v_add_u32 v14, s3, v14
    v_mul_u32_u24 v14, 9216, v14
    v_and_b32 v15, 3, v0
    v_lshl_add_u32 v6, v15, 4, v14
    s_lshr_b32 s3, s2, 3
    s_lshl2_add_u32 s3, s3, s51
    s_and_b32 s15, s2, 7
    v_lshlrev_b32 v9, 7, v0
    s_mul_i32 s14, s3, 9
    s_lshr_b32 s14, s14, 1
    v_min_u32 v15, 44, v0
    v_mul_u32_u24 v12, 7282, v15
    v_lshrrev_b32 v12, 16, v12
    v_mul_u32_u24 v13, 63, v12
    v_add_u32 v12, v15, v13
    s_mul_i32 s14, s14, 72
    s_mul_i32 s56, s15, 9
    s_add_u32 s14, s14, s56
    v_add_lshl_u32 v12, s14, v12, 7
    s_mul_i32 s14, s3, 81
    s_lshr_b32 s14, s14, 1
    s_mul_i32 s56, s15, 5184
    s_add_u32 s14, s14, s56
    v_min_u32 v13, 40, v0
    v_add_lshl_u32 v13, s14, v13, 7
    s_mul_i32 s14, s3, 72
    s_andn2_b32 s56, s52, 3
    s_mul_i32 s56, s56, 2304
    s_add_u32 s14, s14, s56
    v_min_u32 v14, 35, v0
    v_add_lshl_u32 v14, s14, v14, 7
    v_add_u32 v15, 4608, v14
    v_accvgpr_write_b32 a0, 0
    v_accvgpr_write_b32 a1, 0
    v_accvgpr_write_b32 a2, 0
    v_accvgpr_write_b32 a3, 0
    v_accvgpr_write_b32 a4, 0
    v_accvgpr_write_b32 a5, 0
    v_accvgpr_write_b32 a6, 0
    v_accvgpr_write_b32 a7, 0
    v_accvgpr_write_b32 a8, 0
    v_accvgpr_write_b32 a9, 0
    v_accvgpr_write_b32 a10, 0
    v_accvgpr_write_b32 a11, 0
    v_accvgpr_write_b32 a12, 0
    v_accvgpr_write_b32 a13, 0
    v_accvgpr_write_b32 a14, 0
    v_accvgpr_write_b32 a15, 0
    s_waitcnt vmcnt(0) lgkmcnt(0)
    s_branch L2_entry
L2_codeend:

.section .rodata,"a"
.p2align 6
.amdhsa_kernel adaLN_cond__gqa_block_cached__moe_arch_mod__prompt_kernel
  .amdhsa_next_free_vgpr 512
  .amdhsa_next_free_sgpr 102
  .amdhsa_accum_offset 256
  .amdhsa_group_segment_fixed_size 0
  .amdhsa_kernarg_size 120
  .amdhsa_user_sgpr_count 2
  .amdhsa_user_sgpr_kernarg_segment_ptr 1
  .amdhsa_system_sgpr_workgroup_id_x 1
  .amdhsa_float_denorm_mode_32 3
.end_amdhsa_kernel
```

```asm
; @launch grid=(256,1,1) block=(256,1,1) lds=163840
.amdgcn_target "amdgcn-amd-amdhsa--gfx950"
.text
.globl adaLN_cond__gqa_block_cached__moe_arch_mod__prompt_kernel
.p2align 8
.type adaLN_cond__gqa_block_cached__moe_arch_mod__prompt_kernel,@function
adaLN_cond__gqa_block_cached__moe_arch_mod__prompt_kernel:
L2_begin:
    s_getpc_b64 s[98:99]
    s_cmp_ge_u32 s2, 256
    s_cbranch_scc1 L2_end
    s_load_dwordx2 s[76:77], s[0:1], 0
    s_load_dwordx2 s[16:17], s[0:1], 80
    s_load_dwordx2 s[88:89], s[0:1], 88
    s_load_dwordx2 s[12:13], s[0:1], 112
    s_load_dwordx2 s[60:61], s[0:1], 104
    s_and_b32 s3, s2, 7
    s_lshr_b32 s14, s2, 3
    v_mov_b32 v155, v0
    v_lshrrev_b32 v10, 6, v0
    v_and_b32 v0, 63, v0
    s_lshl_b32 s15, s14, 9
    v_lshl_add_u32 v13, v10, 7, s15
    v_lshl_add_u32 v13, v0, 14, v13
    v_min_u32 v13, L2_codeend-L2_begin-8, v13
    s_mov_b64 exec, 31
    global_load_dword a63, v13, s[98:99]
    s_mov_b64 exec, -1
    v_readfirstlane_b32 s51, v10
    s_and_b32 s52, s3, 3
    s_and_b32 s15, s14, 3
    s_lshl2_add_u32 s52, s52, s15
    s_lshr_b32 s53, s3, 2
    s_lshr_b32 s15, s14, 2
    s_lshl3_add_u32 s53, s53, s15
    s_lshl4_add_u32 s96, s53, s52
    s_mul_i32 s49, s3, 27
    s_max_u32 s14, s14, 5
    s_add_u32 s49, s49, s14
    s_sub_u32 s49, s49, 5
    s_lshr_b32 s55, s3, 2
    s_mul_i32 s15, s55, 108
    s_sub_u32 s50, s49, s15
    s_mul_i32 s3, s51, 288
    v_lshrrev_b32 v14, 3, v0
    v_lshl_add_u32 v12, v14, 4, s3
    v_and_b32 v14, 1, v14
    v_lshl_add_u32 v13, v14, 4, s3
    v_and_b32 v14, 7, v0
    v_mul_u32_u24 v14, 1152, v14
    v_add_u32 v1, v14, v12
    v_add_u32 v2, v14, v13
    v_add_u32 v2, 256, v2
    v_and_b32 v4, 0xfc, v155
    v_and_b32 v7, 3, v0
    v_mul_u32_u24 v3, 6912, v4
    v_lshl_add_u32 v153, v7, 4, v3
    s_mul_i32 s3, s96, 9216
    s_movk_i32 s78, 9216
    s_mov_b32 s79, 0x20000
    s_mov_b32 s91, s79
    v_lshlrev_b32 v8, 4, v0
    s_mov_b32 s86, 8388608
    s_mov_b32 s87, s79
    s_movk_i32 s62, 256
    s_mov_b32 s63, s79
    s_lshl_b32 s14, s50, 6
    s_sub_u32 s90, 1990656, s14
    s_cmp_ge_u32 s2, 40
    s_cselect_b32 s90, s90, 0
    s_mul_i32 s15, s55, 1990656
    s_add_u32 s14, s14, s15
    s_waitcnt lgkmcnt(0)
    s_add_u32 s76, s76, s3
    s_addc_u32 s77, s77, 0
    buffer_load_dwordx4 v[64:67], v1, s[76:79], 0 offen offset:0
    buffer_load_dwordx4 v[68:71], v1, s[76:79], 0 offen offset:128
    buffer_load_dwordx4 v[72:75], v2, s[76:79], 0 offen offset:0
    s_add_u32 s88, s88, s14
    s_addc_u32 s89, s89, 0
    s_mov_b64 s[84:85], s[12:13]
    s_cmp_ge_u32 s2, 8
    s_cbranch_scc1 L2_noclr
    v_mov_b32 v52, -1
    v_mov_b32 v56, 0
    v_mov_b32 v53, -1
    v_mov_b32 v57, 0
    v_mov_b32 v54, -1
    v_mov_b32 v58, 0
    v_mov_b32 v55, -1
    v_mov_b32 v59, 0
    s_lshl2_add_u32 s15, s2, s51
    s_lshl_b32 s3, s15, 10
    buffer_store_dwordx4 v[52:55], v8, s[84:87], s3 offen sc1
    v_lshrrev_b32 v13, 3, v0
    v_mul_u32_u24 v13, 0, v13
    v_add_u32 v13, v13, v8
    s_mul_i32 s3, s15, 1024
    s_add_u32 s3, s3, 6815744
    buffer_store_dwordx4 v[56:59], v13, s[84:87], s3 offen sc1
L2_noclr:
    buffer_load_dwordx4 v[128:131], v153, s[88:91], 0 offen
    s_movk_i32 s3, 6912
    buffer_load_dwordx4 v[132:135], v153, s[88:91], s3 offen
    s_movk_i32 s3, 13824
    buffer_load_dwordx4 v[136:139], v153, s[88:91], s3 offen
    s_movk_i32 s3, 20736
    buffer_load_dwordx4 v[140:143], v153, s[88:91], s3 offen
    v_lshrrev_b32 v3, 2, v3
    v_lshl_add_u32 v3, v7, 4, v3
    v_add_u32 v154, 1769472, v3
    v_lshrrev_b32 v3, 1, v4
    v_lshlrev_b32 v4, 1, v4
    s_mul_i32 s3, s55, 576
    s_add_u32 s16, s16, s3
    s_addc_u32 s17, s17, 0
    s_mov_b32 s18, 576
    s_mov_b32 s19, 0x20000
    v_mov_b32 v144, 0
    v_mov_b32 v145, 0
    v_mov_b32 v146, 0
    v_mov_b32 v147, 0
    v_mov_b32 v150, 0
    s_cmp_ge_u32 s51, 2
    s_cbranch_scc1 L2_w23
    buffer_load_dwordx4 v[144:147], v154, s[88:91], 0 offen
    buffer_load_ushort v150, v3, s[16:19], 0 offen offset:512
L2_w23:
    buffer_load_dwordx2 v[148:149], v4, s[16:19], 0 offen
    s_load_dwordx8 s[4:11], s[0:1], 8
    s_load_dwordx2 s[64:65], s[0:1], 56
    s_load_dwordx2 s[68:69], s[0:1], 64
    s_load_dwordx2 s[72:73], s[0:1], 72
    s_load_dwordx2 s[80:81], s[0:1], 96
    s_load_dwordx2 s[36:37], s[0:1], 48
    s_cmp_eq_u32 s51, 0
    s_cselect_b32 s3, 0, 0x40000000
    v_mul_u32_u24 v156, 32, v0
    v_or_b32 v156, s3, v156
    s_mul_i32 s44, s51, 4224
    s_add_u32 s44, s44, 16384
    v_lshl_add_u32 v5, v10, 12, v8
    v_lshrrev_b32 v13, 5, v0
    v_lshl_add_u32 v13, v10, 1, v13
    v_lshlrev_b32 v13, 15, v13
    v_and_b32 v14, 31, v0
    v_lshl_add_u32 v6, v14, 4, v13
    v_mov_b32 v56, 0
    v_mov_b32 v60, -1
    v_mov_b32 v57, 0
    v_mov_b32 v61, -1
    v_mov_b32 v58, 0
    v_mov_b32 v62, -1
    v_mov_b32 v59, 0
    v_mov_b32 v63, -1
    s_and_b32 s14, s53, 7
    s_lshl2_add_u32 s14, s14, s51
    v_lshrrev_b32 v13, 2, v0
    v_lshl_add_u32 v13, v13, 5, s14
    v_lshlrev_b32 v13, 13, v13
    v_lshl_add_u32 v165, v7, 7, v13
    s_waitcnt lgkmcnt(0)
    s_lshl_b32 s3, s52, 9
    s_add_u32 s24, s8, s3
    s_addc_u32 s25, s9, 0
    s_mov_b32 s26, 0
    s_mov_b32 s27, 0x20000
    s_sub_u32 s26, 4718592, s3
    s_mov_b32 s38, 1152
    s_mov_b32 s39, 0x20000
    v_and_b32 v14, 7, v0
    v_lshlrev_b32 v157, 4, v14
    v_add_u32 v157, 14080, v157
    v_lshl_add_u32 v158, v10, 2, v157
    s_mul_i32 s3, s51, 4608
    v_lshl_add_u32 v14, v14, 4, s3
    v_lshrrev_b32 v15, 3, v0
    v_lshl_add_u32 v159, v15, 8, v14
    s_lshr_b32 s3, s96, 1
    s_mul_i32 s3, s3, 18432
    s_and_b32 s14, s96, 1
    s_lshl_b32 s14, s14, 7
    s_add_u32 s3, s3, s14
    s_add_u32 s58, s3, 1048576
    s_lshl_b32 s3, s53, 2
    s_add_u32 s3, s3, s51
    s_lshl_b32 s14, s3, 4
    s_add_u32 s14, s14, s52
    s_lshl_b32 s14, s14, 8
    s_add_u32 s56, s14, 786432
    s_mul_i32 s14, s3, 512
    s_add_u32 s59, s14, 6815744
    v_and_b32 v14, 3, v0
    v_mul_u32_u24 v163, 128, v14
    s_mul_i32 s14, s3, 36864
    s_add_u32 s14, s14, 1048576
    s_add_u32 s32, s12, s14
    s_addc_u32 s33, s13, 0
    s_mov_b32 s34, 36864
    s_mov_b32 s35, 0x20000
    s_mul_i32 s15, s2, 4608
    s_mul_i32 s14, s51, 1152
    s_add_u32 s15, s15, s14
    s_add_u32 s57, s15, 98304
    s_cmp_ge_u32 s2, 144
    s_cselect_b32 s14, 0x40000000, 0
    v_or_b32 v160, s14, v8
    v_lshrrev_b32 v12, 4, v155
    v_lshlrev_b32 v12, 7, v12
    v_lshl_add_u32 v161, v7, 5, v12
    v_lshlrev_b32 v162, 2, v0
    s_mul_i32 s3, s50, 3641
    s_lshr_b32 s3, s3, 16
    s_mov_b32 s47, 1.0
    s_mov_b32 s48, 0
    s_cmp_lt_u32 s3, 2
    s_cselect_b32 s47, 0x3e0293ee, s47
    s_cmp_eq_u32 s3, 1
    s_cselect_b32 s48, 0x3e0293ee, s48
    s_cmp_eq_u32 s3, 4
    s_cselect_b32 s48, 1.0, s48
    s_cmp_eq_u32 s55, 0
    s_cselect_b32 s48, s48, 0
    s_lshl_b32 s100, s49, 7
    s_mul_i32 s14, s96, 128
    s_add_u32 s101, s14, 6815744
    s_mul_i32 s3, s51, 1152
    v_add_u32 v166, s3, v8
    s_and_b32 s3, s51, 1
    s_mul_i32 s3, s3, 2304
    s_cmp_lt_u32 s51, 2
    s_cselect_b32 s14, 32, 0
    s_add_u32 s3, s3, s14
    s_add_u32 s3, s3, 9216
    v_lshrrev_b32 v14, 1, v0
    v_lshl_add_u32 v14, v14, 6, s3
    v_and_b32 v15, 1, v0
    v_lshl_add_u32 v167, v15, 4, v14
    s_cmp_eq_u32 s51, 1
    s_cselect_b32 s3, 40, 256
    s_cmp_ge_u32 s2, s3
    s_cselect_b32 s3, 0, 0x40000000
    v_or_b32 v164, s3, v162
    v_mov_b32 v172, 0
    v_mov_b32 v180, 0
    v_mov_b32 v173, 0
    v_mov_b32 v181, 0
    v_mov_b32 v174, 0
    v_mov_b32 v182, 0
    v_mov_b32 v175, 0
    v_mov_b32 v183, 0
    s_lshl_b32 s3, s53, 2
    s_add_u32 s3, s3, s51
    v_mov_b32 v12, v10
    s_mul_i32 s14, s3, 589824
    s_mul_i32 s15, s52, 9216
    s_add_u32 s14, s14, s15
    s_add_u32 s14, s14, 8388608
    s_add_u32 s40, s12, s14
    s_addc_u32 s41, s13, 0
    s_mov_b32 s42, 0
    s_mov_b32 s43, 0x20000
    s_sub_u32 s42, 589824, s15
    s_lshl_b32 s3, s52, 19
    s_add_u32 s16, s4, s3
    s_addc_u32 s17, s5, 0
    s_mov_b32 s18, 524288
    s_mov_b32 s19, 0x20000
    s_add_u32 s20, s6, s3
    s_addc_u32 s21, s7, 0
    s_mov_b32 s22, 524288
    s_mov_b32 s23, 0x20000
    s_lshl_b32 s3, s51, 12
    s_add_u32 s16, s16, s3
    s_addc_u32 s17, s17, 0x100000
    s_mov_b32 s18, 32768
    s_mov_b32 s19, 0x800000
    s_add_u32 s20, s20, s3
    s_addc_u32 s21, s21, 0x100000
    s_mov_b32 s22, 32768
    s_mov_b32 s23, 0x800000
    s_mul_i32 s3, s52, 294912
    s_add_u32 s28, s10, s3
    s_addc_u32 s29, s11, 0
    s_mov_b32 s30, 294912
    s_mov_b32 s31, 0x20000
    s_mov_b64 s[4:5], s[64:65]
    s_mov_b64 s[6:7], s[68:69]
    s_mov_b64 s[8:9], s[72:73]
    s_mov_b32 s50, 0
    s_mul_i32 s55, s51, 9216
    s_min_u32 s15, s2, 143
    s_and_b32 s3, s15, 7
    s_mul_i32 s3, s3, 18
    s_lshr_b32 s15, s15, 3
    s_add_u32 s15, s15, s3
    s_lshl_b32 s3, s15, 6
    s_add_u32 s64, s64, s3
    s_addc_u32 s65, s65, 0
    s_mov_b32 s66, 0
    s_mov_b32 s67, 0x20000
    s_add_u32 s68, s68, s3
    s_addc_u32 s69, s69, 0
    s_mov_b32 s70, 0
    s_mov_b32 s71, 0x20000
    s_sub_u32 s14, 5308416, s3
    s_mul_i32 s3, s15, 36864
    s_add_u32 s72, s72, s3
    s_addc_u32 s73, s73, 0
    s_mov_b32 s74, 0
    s_mov_b32 s75, 0x20000
    s_cmp_lt_u32 s2, 144
    s_cselect_b32 s66, s14, 0
    s_cselect_b32 s70, s14, 0
    s_cselect_b32 s74, 36864, 0
    s_mov_b32 s82, 2359296
    s_mov_b32 s83, 0x20000
    v_lshrrev_b32 v13, 4, v0
    v_lshlrev_b32 v9, 6, v13
    v_lshrrev_b32 v14, 2, v0
    v_mul_u32_u24 v14, 1056, v14
    v_add_u32 v14, 16384, v14
    v_and_b32 v15, 1, v0
    v_lshlrev_b32 v15, 4, v15
    v_add_u32 v3, v14, v15
    v_and_b32 v15, 2, v0
    v_lshl_add_u32 v3, v15, 2, v3
    v_add_u32 v4, 73728, v3
    v_lshrrev_b32 v14, 3, v0
    v_lshlrev_b32 v14, 2, v14
    v_add_u32 v14, v14, v12
    v_mul_u32_u24 v14, 4608, v14
    v_and_b32 v15, 7, v0
    v_lshl_add_u32 v7, v15, 4, v14
    v_lshlrev_b32 v10, 4, v15
    v_lshl_add_u32 v10, v13, 7, v10
    v_bfe_u32 v14, v0, 3, 1
    v_mul_u32_u24 v14, 147456, v14
    v_add_u32 v10, v10, v14
    v_lshrrev_b32 v14, 2, v0
    v_mul_u32_u24 v14, 1056, v14
    v_and_b32 v15, 3, v0
    v_lshl_add_u32 v14, v15, 3, v14
    v_add_u32 v2, 107008, v14
    v_and_b32 v14, 15, v0
    v_mul_u32_u24 v14, 1056, v14
    v_lshrrev_b32 v15, 4, v0
    v_lshl_add_u32 v14, v15, 4, v14
    v_add_u32 v1, 90112, v14
    v_and_b32 v14, 1, v0
    v_cmp_eq_u32 vcc, 0, v14
    v_mov_b32 v11, 0xeeeeeeee
    v_mov_b32 v15, 0x44444444
    v_cndmask_b32 v11, v11, v15, vcc
    v_and_b32 v14, 2, v0
    v_cmp_eq_u32 vcc, 0, v14
    v_mov_b32 v15, 0x3f803f80
    s_nop 0
    v_cndmask_b32 v15, 0, v15, vcc
    v_accvgpr_write_b32 a16, v15
    v_accvgpr_write_b32 a56, -1
    v_accvgpr_write_b32 a17, v15
    v_accvgpr_write_b32 a57, -1
    v_accvgpr_write_b32 a18, v15
    v_accvgpr_write_b32 a58, -1
    v_accvgpr_write_b32 a19, v15
    v_accvgpr_write_b32 a59, -1
    v_accvgpr_write_b32 a0, 0
    v_accvgpr_write_b32 a1, 0
    v_accvgpr_write_b32 a2, 0
    v_accvgpr_write_b32 a3, 0
    v_accvgpr_write_b32 a4, 0
    v_accvgpr_write_b32 a5, 0
    v_accvgpr_write_b32 a6, 0
    v_accvgpr_write_b32 a7, 0
    v_accvgpr_write_b32 a8, 0
    v_accvgpr_write_b32 a9, 0
    v_accvgpr_write_b32 a10, 0
    v_accvgpr_write_b32 a11, 0
    v_accvgpr_write_b32 a12, 0
    v_accvgpr_write_b32 a13, 0
    v_accvgpr_write_b32 a14, 0
    v_accvgpr_write_b32 a15, 0
    s_cmp_ge_u32 s2, 8
    s_cbranch_scc1 L2_noclr2
    s_mul_i32 s14, s2, 32
    s_mov_b64 exec, 1
    s_waitcnt vmcnt(5)
    s_barrier
    buffer_store_dword v60, v156, s[60:63], s14 offen sc1
    s_mov_b64 exec, -1
L2_noclr2:
    s_mov_b64 exec, 0xffff
    buffer_load_dword a63, v165, s[24:27], 0 offen
    s_mov_b64 exec, -1
    s_waitcnt vmcnt(6)
    v_lshlrev_b32 v24, 16, v64
    v_and_b32 v25, 0xffff0000, v64
    v_lshlrev_b32 v26, 16, v65
    v_and_b32 v27, 0xffff0000, v65
    v_lshlrev_b32 v28, 16, v66
    v_and_b32 v29, 0xffff0000, v66
    v_lshlrev_b32 v30, 16, v67
    v_and_b32 v31, 0xffff0000, v67
    v_lshlrev_b32 v32, 16, v68
    v_and_b32 v33, 0xffff0000, v68
    v_lshlrev_b32 v34, 16, v69
    v_and_b32 v35, 0xffff0000, v69
    v_lshlrev_b32 v36, 16, v70
    v_and_b32 v37, 0xffff0000, v70
    v_lshlrev_b32 v38, 16, v71
    v_and_b32 v39, 0xffff0000, v71
    v_lshlrev_b32 v40, 16, v72
    v_and_b32 v41, 0xffff0000, v72
    v_lshlrev_b32 v42, 16, v73
    v_and_b32 v43, 0xffff0000, v73
    v_lshlrev_b32 v44, 16, v74
    v_and_b32 v45, 0xffff0000, v74
    v_lshlrev_b32 v46, 16, v75
    v_and_b32 v47, 0xffff0000, v75
    v_pk_add_f32 v[12:13], v[24:25], v[26:27]
    v_pk_add_f32 v[12:13], v[12:13], v[28:29]
    v_pk_add_f32 v[12:13], v[12:13], v[30:31]
    v_pk_add_f32 v[12:13], v[12:13], v[32:33]
    v_pk_add_f32 v[12:13], v[12:13], v[34:35]
    v_pk_add_f32 v[12:13], v[12:13], v[36:37]
    v_pk_add_f32 v[12:13], v[12:13], v[38:39]
    v_pk_add_f32 v[14:15], v[40:41], v[42:43]
    v_pk_add_f32 v[14:15], v[14:15], v[44:45]
    v_pk_add_f32 v[14:15], v[14:15], v[46:47]
    v_add_f32 v48, v12, v13
    v_add_f32 v14, v14, v15
    v_fmac_f32 v48, 0x3e800000, v14
    s_nop 1
    v_add_f32_dpp v48, v48, v48 row_ror:8 row_mask:0xf bank_mask:0xf
    v_mov_b32 v50, v48
    s_nop 1
    v_permlane16_swap_b32 v50, v48
    v_add_f32 v48, v48, v50
    v_mov_b32 v50, v48
    s_nop 1
    v_permlane32_swap_b32 v50, v48
    v_add_f32 v48, v48, v50
    v_mul_f32 v48, 0x3be38e39, v48
    v_pk_add_f32 v[24:25], v[24:25], v[48:49] op_sel_hi:[1,0] neg_lo:[0,1] neg_hi:[0,1]
    v_pk_add_f32 v[26:27], v[26:27], v[48:49] op_sel_hi:[1,0] neg_lo:[0,1] neg_hi:[0,1]
    v_pk_add_f32 v[28:29], v[28:29], v[48:49] op_sel_hi:[1,0] neg_lo:[0,1] neg_hi:[0,1]
    v_pk_add_f32 v[30:31], v[30:31], v[48:49] op_sel_hi:[1,0] neg_lo:[0,1] neg_hi:[0,1]
    v_pk_add_f32 v[32:33], v[32:33], v[48:49] op_sel_hi:[1,0] neg_lo:[0,1] neg_hi:[0,1]
    v_pk_add_f32 v[34:35], v[34:35], v[48:49] op_sel_hi:[1,0] neg_lo:[0,1] neg_hi:[0,1]
    v_pk_add_f32 v[36:37], v[36:37], v[48:49] op_sel_hi:[1,0] neg_lo:[0,1] neg_hi:[0,1]
    v_pk_add_f32 v[38:39], v[38:39], v[48:49] op_sel_hi:[1,0] neg_lo:[0,1] neg_hi:[0,1]
    v_pk_add_f32 v[40:41], v[40:41], v[48:49] op_sel_hi:[1,0] neg_lo:[0,1] neg_hi:[0,1]
    v_pk_add_f32 v[42:43], v[42:43], v[48:49] op_sel_hi:[1,0] neg_lo:[0,1] neg_hi:[0,1]
    v_pk_add_f32 v[44:45], v[44:45], v[48:49] op_sel_hi:[1,0] neg_lo:[0,1] neg_hi:[0,1]
    v_pk_add_f32 v[46:47], v[46:47], v[48:49] op_sel_hi:[1,0] neg_lo:[0,1] neg_hi:[0,1]
    v_pk_mul_f32 v[12:13], v[24:25], v[24:25]
    v_pk_fma_f32 v[12:13], v[26:27], v[26:27], v[12:13]
    v_pk_fma_f32 v[12:13], v[28:29], v[28:29], v[12:13]
    v_pk_fma_f32 v[12:13], v[30:31], v[30:31], v[12:13]
    v_pk_fma_f32 v[12:13], v[32:33], v[32:33], v[12:13]
    v_pk_fma_f32 v[12:13], v[34:35], v[34:35], v[12:13]
    v_pk_fma_f32 v[12:13], v[36:37], v[36:37], v[12:13]
    v_pk_fma_f32 v[12:13], v[38:39], v[38:39], v[12:13]
    v_pk_mul_f32 v[14:15], v[40:41], v[40:41]
    v_pk_fma_f32 v[14:15], v[42:43], v[42:43], v[14:15]
    v_pk_fma_f32 v[14:15], v[44:45], v[44:45], v[14:15]
    v_pk_fma_f32 v[14:15], v[46:47], v[46:47], v[14:15]
    v_add_f32 v49, v12, v13
    v_add_f32 v14, v14, v15
    v_fmac_f32 v49, 0x3e800000, v14
    s_nop 1
    v_add_f32_dpp v49, v49, v49 row_ror:8 row_mask:0xf bank_mask:0xf
    v_mov_b32 v50, v49
    s_nop 1
    v_permlane16_swap_b32 v50, v49
    v_add_f32 v49, v49, v50
    v_mov_b32 v50, v49
    s_nop 1
    v_permlane32_swap_b32 v50, v49
    v_add_f32 v49, v49, v50
    ds_write_b32 v158, v48
    ds_write_b32 v158, v49 offset:128
    s_waitcnt lgkmcnt(0)
    s_barrier
    ds_read_b128 v[16:19], v157
    ds_read_b128 v[20:23], v157 offset:128
    s_add_u32 s14, s58, 4096
    s_waitcnt lgkmcnt(1)
    v_add_f32 v12, v16, v17
    v_add_f32 v13, v18, v19
    v_add_f32 v12, v12, v13
    v_mul_f32 v12, 0x3e800000, v12
    v_sub_f32 v16, v16, v12
    v_sub_f32 v17, v17, v12
    v_sub_f32 v18, v18, v12
    v_sub_f32 v19, v19, v12
    v_sub_f32 v48, v48, v12
    v_mul_f32 v13, v16, v16
    v_fmac_f32 v13, v17, v17
    v_fmac_f32 v13, v18, v18
    v_fmac_f32 v13, v19, v19
    s_waitcnt lgkmcnt(0)
    v_add_f32 v14, v20, v21
    v_add_f32 v15, v22, v23
    v_add_f32 v14, v14, v15
    v_fmac_f32 v14, 0x43100000, v13
    v_mov_b32 v12, 0x3727c5ac
    v_fmac_f32 v12, 0x3ae38e39, v14
    v_rsq_f32 v12, v12
    s_nop 0
    v_mul_f32 v48, v48, v12
    v_pk_fma_f32 v[24:25], v[24:25], v[12:13], v[48:49] op_sel_hi:[1,0,0]
    v_pk_fma_f32 v[26:27], v[26:27], v[12:13], v[48:49] op_sel_hi:[1,0,0]
    v_pk_fma_f32 v[28:29], v[28:29], v[12:13], v[48:49] op_sel_hi:[1,0,0]
    v_pk_fma_f32 v[30:31], v[30:31], v[12:13], v[48:49] op_sel_hi:[1,0,0]
    v_cvt_pk_f16_f32 v64, v24, v25
    v_cvt_pk_f16_f32 v65, v26, v27
    v_cvt_pk_f16_f32 v66, v28, v29
    v_cvt_pk_f16_f32 v67, v30, v31
    buffer_store_dwordx4 v[64:67], v159, s[84:87], s58 offen offset:0 sc1
    v_pk_fma_f32 v[32:33], v[32:33], v[12:13], v[48:49] op_sel_hi:[1,0,0]
    v_pk_fma_f32 v[34:35], v[34:35], v[12:13], v[48:49] op_sel_hi:[1,0,0]
    v_pk_fma_f32 v[36:37], v[36:37], v[12:13], v[48:49] op_sel_hi:[1,0,0]
    v_pk_fma_f32 v[38:39], v[38:39], v[12:13], v[48:49] op_sel_hi:[1,0,0]
    v_cvt_pk_f16_f32 v68, v32, v33
    v_cvt_pk_f16_f32 v69, v34, v35
    v_cvt_pk_f16_f32 v70, v36, v37
    v_cvt_pk_f16_f32 v71, v38, v39
    buffer_store_dwordx4 v[68:71], v159, s[84:87], s58 offen offset:2048 sc1
    v_pk_fma_f32 v[40:41], v[40:41], v[12:13], v[48:49] op_sel_hi:[1,0,0]
    v_pk_fma_f32 v[42:43], v[42:43], v[12:13], v[48:49] op_sel_hi:[1,0,0]
    v_pk_fma_f32 v[44:45], v[44:45], v[12:13], v[48:49] op_sel_hi:[1,0,0]
    v_pk_fma_f32 v[46:47], v[46:47], v[12:13], v[48:49] op_sel_hi:[1,0,0]
    v_cvt_pk_f16_f32 v72, v40, v41
    v_cvt_pk_f16_f32 v73, v42, v43
    v_cvt_pk_f16_f32 v74, v44, v45
    v_cvt_pk_f16_f32 v75, v46, v47
    s_mov_b64 exec, 0xffff
    buffer_store_dwordx4 v[72:75], v159, s[84:87], s14 offen offset:0 sc1
    buffer_store_dwordx4 v[56:59], v8, s[84:87], s56 offen sc1
    s_mov_b64 exec, 0xff
    buffer_store_dwordx4 v[60:63], v160, s[84:87], s57 offen offset:1024 sc1
    s_mov_b64 exec, -1
    buffer_store_dwordx4 v[60:63], v160, s[84:87], s57 offen sc1
    s_mov_b64 exec, 255
    buffer_load_dword v51, v156, s[60:63], 0 offen sc1
    s_mov_b64 exec, -1
    s_mul_i32 s3, s96, 147456
    s_add_u32 s3, s3, 8392704
    s_add_u32 s88, s12, s3
    s_addc_u32 s89, s13, 0
    s_mov_b32 s90, 143360
    s_mov_b32 s91, 0x20000
    s_waitcnt vmcnt(8)
    v_lshlrev_b32 v40, 16, v148
    v_and_b32 v41, 0xffff0000, v148
    v_lshlrev_b32 v42, 16, v149
    v_and_b32 v43, 0xffff0000, v149
    v_lshlrev_b32 v44, 16, v150
    v_mul_f32 v16, 0xbfb8aa3b, v40
    v_mul_f32 v17, 0xbfb8aa3b, v41
    v_mul_f32 v18, 0xbfb8aa3b, v42
    v_mul_f32 v19, 0xbfb8aa3b, v43
    v_mul_f32 v20, 0xbfb8aa3b, v44
    v_exp_f32 v16, v16
    v_exp_f32 v17, v17
    v_exp_f32 v18, v18
    v_exp_f32 v19, v19
    v_exp_f32 v20, v20
    v_add_f32 v16, 1.0, v16
    v_add_f32 v17, 1.0, v17
    v_add_f32 v18, 1.0, v18
    v_add_f32 v19, 1.0, v19
    v_add_f32 v20, 1.0, v20
    v_rcp_f32 v16, v16
    v_rcp_f32 v17, v17
    v_rcp_f32 v18, v18
    v_rcp_f32 v19, v19
    v_rcp_f32 v20, v20
    v_mul_f32 v24, v40, v16
    v_mul_f32 v26, v41, v17
    v_mul_f32 v28, v42, v18
    v_mul_f32 v30, v43, v19
    v_mul_f32 v32, v44, v20
    v_lshlrev_b32 v12, 16, v128
    v_and_b32 v13, 0xffff0000, v128
    v_pk_mul_f32 v[16:17], v[12:13], v[24:25] op_sel_hi:[1,0]
    v_lshlrev_b32 v14, 16, v129
    v_and_b32 v15, 0xffff0000, v129
    v_pk_mul_f32 v[18:19], v[14:15], v[24:25] op_sel_hi:[1,0]
    v_lshlrev_b32 v12, 16, v130
    v_and_b32 v13, 0xffff0000, v130
    v_pk_mul_f32 v[20:21], v[12:13], v[24:25] op_sel_hi:[1,0]
    v_lshlrev_b32 v14, 16, v131
    v_and_b32 v15, 0xffff0000, v131
    v_pk_mul_f32 v[22:23], v[14:15], v[24:25] op_sel_hi:[1,0]
    v_lshlrev_b32 v12, 16, v132
    v_and_b32 v13, 0xffff0000, v132
    v_pk_fma_f32 v[16:17], v[12:13], v[26:27], v[16:17] op_sel_hi:[1,0,1]
    v_lshlrev_b32 v14, 16, v133
    v_and_b32 v15, 0xffff0000, v133
    v_pk_fma_f32 v[18:19], v[14:15], v[26:27], v[18:19] op_sel_hi:[1,0,1]
    v_lshlrev_b32 v12, 16, v134
    v_and_b32 v13, 0xffff0000, v134
    v_pk_fma_f32 v[20:21], v[12:13], v[26:27], v[20:21] op_sel_hi:[1,0,1]
    v_lshlrev_b32 v14, 16, v135
    v_and_b32 v15, 0xffff0000, v135
    v_pk_fma_f32 v[22:23], v[14:15], v[26:27], v[22:23] op_sel_hi:[1,0,1]
    v_lshlrev_b32 v12, 16, v136
    v_and_b32 v13, 0xffff0000, v136
    v_pk_fma_f32 v[16:17], v[12:13], v[28:29], v[16:17] op_sel_hi:[1,0,1]
    v_lshlrev_b32 v14, 16, v137
    v_and_b32 v15, 0xffff0000, v137
    v_pk_fma_f32 v[18:19], v[14:15], v[28:29], v[18:19] op_sel_hi:[1,0,1]
    v_lshlrev_b32 v12, 16, v138
    v_and_b32 v13, 0xffff0000, v138
    v_pk_fma_f32 v[20:21], v[12:13], v[28:29], v[20:21] op_sel_hi:[1,0,1]
    v_lshlrev_b32 v14, 16, v139
    v_and_b32 v15, 0xffff0000, v139
    v_pk_fma_f32 v[22:23], v[14:15], v[28:29], v[22:23] op_sel_hi:[1,0,1]
    v_lshlrev_b32 v12, 16, v140
    v_and_b32 v13, 0xffff0000, v140
    v_pk_fma_f32 v[16:17], v[12:13], v[30:31], v[16:17] op_sel_hi:[1,0,1]
    v_lshlrev_b32 v14, 16, v141
    v_and_b32 v15, 0xffff0000, v141
    v_pk_fma_f32 v[18:19], v[14:15], v[30:31], v[18:19] op_sel_hi:[1,0,1]
    v_lshlrev_b32 v12, 16, v142
    v_and_b32 v13, 0xffff0000, v142
    v_pk_fma_f32 v[20:21], v[12:13], v[30:31], v[20:21] op_sel_hi:[1,0,1]
    v_lshlrev_b32 v14, 16, v143
    v_and_b32 v15, 0xffff0000, v143
    v_pk_fma_f32 v[22:23], v[14:15], v[30:31], v[22:23] op_sel_hi:[1,0,1]
    v_lshlrev_b32 v12, 16, v144
    v_and_b32 v13, 0xffff0000, v144
    v_pk_fma_f32 v[16:17], v[12:13], v[32:33], v[16:17] op_sel_hi:[1,0,1]
    v_lshlrev_b32 v14, 16, v145
    v_and_b32 v15, 0xffff0000, v145
    v_pk_fma_f32 v[18:19], v[14:15], v[32:33], v[18:19] op_sel_hi:[1,0,1]
    v_lshlrev_b32 v12, 16, v146
    v_and_b32 v13, 0xffff0000, v146
    v_pk_fma_f32 v[20:21], v[12:13], v[32:33], v[20:21] op_sel_hi:[1,0,1]
    v_lshlrev_b32 v14, 16, v147
    v_and_b32 v15, 0xffff0000, v147
    v_pk_fma_f32 v[22:23], v[14:15], v[32:33], v[22:23] op_sel_hi:[1,0,1]
    v_add_f32_dpp v16, v16, v16 row_ror:4 row_mask:0xf bank_mask:0xf
    v_add_f32_dpp v17, v17, v17 row_ror:4 row_mask:0xf bank_mask:0xf
    v_add_f32_dpp v18, v18, v18 row_ror:4 row_mask:0xf bank_mask:0xf
    v_add_f32_dpp v19, v19, v19 row_ror:4 row_mask:0xf bank_mask:0xf
    v_add_f32_dpp v20, v20, v20 row_ror:4 row_mask:0xf bank_mask:0xf
    v_add_f32_dpp v21, v21, v21 row_ror:4 row_mask:0xf bank_mask:0xf
    v_add_f32_dpp v22, v22, v22 row_ror:4 row_mask:0xf bank_mask:0xf
    v_add_f32_dpp v23, v23, v23 row_ror:4 row_mask:0xf bank_mask:0xf
    v_add_f32_dpp v16, v16, v16 row_ror:8 row_mask:0xf bank_mask:0xf
    v_add_f32_dpp v17, v17, v17 row_ror:8 row_mask:0xf bank_mask:0xf
    v_add_f32_dpp v18, v18, v18 row_ror:8 row_mask:0xf bank_mask:0xf
    v_add_f32_dpp v19, v19, v19 row_ror:8 row_mask:0xf bank_mask:0xf
    v_add_f32_dpp v20, v20, v20 row_ror:8 row_mask:0xf bank_mask:0xf
    v_add_f32_dpp v21, v21, v21 row_ror:8 row_mask:0xf bank_mask:0xf
    v_add_f32_dpp v22, v22, v22 row_ror:8 row_mask:0xf bank_mask:0xf
    v_add_f32_dpp v23, v23, v23 row_ror:8 row_mask:0xf bank_mask:0xf
    s_mov_b32 exec_lo, 0xf000f
    s_mov_b32 exec_hi, 0xf000f
    ds_write_b128 v161, v[16:19] offset:16384
    ds_write_b128 v161, v[20:23] offset:16400
    s_mov_b64 exec, 255
    s_waitcnt vmcnt(0)
    v_cmp_eq_u32 vcc, s51, v51
    s_nop 0
    s_cmp_lg_u64 vcc, 0
    s_cbranch_scc1 L2_p0s
L2_p0r:
    s_mov_b64 exec, 1
    s_waitcnt lgkmcnt(0)
    s_barrier
    buffer_store_dword v60, v156, s[84:87], s101 offen sc1
    s_mov_b64 exec, -1
    ds_read_b32 v24, v162 offset:16384
    ds_read_b32 v25, v162 offset:16640
    ds_read_b32 v26, v162 offset:16896
    ds_read_b32 v27, v162 offset:17152
    ds_read_b32 v28, v162 offset:17408
    ds_read_b32 v29, v162 offset:17664
    ds_read_b32 v30, v162 offset:17920
    ds_read_b32 v31, v162 offset:18176
    s_waitcnt lgkmcnt(0)
    v_pk_add_f32 v[24:25], v[24:25], v[26:27]
    v_pk_add_f32 v[28:29], v[28:29], v[30:31]
    v_pk_add_f32 v[24:25], v[24:25], v[28:29]
    v_add_f32 v52, v24, v25
    v_mov_b32 v53, v52
    v_mov_b32 v54, s48
    s_nop 0
    v_permlane32_swap_b32 v53, v52
    v_add_f32 v52, v52, v53
    v_fma_f32 v52, v52, s47, v54
    v_min_u32 v52, -2, v52
    s_mov_b32 exec_hi, 0
    buffer_store_dword v52, v164, s[84:87], s100 offen sc1
    s_mov_b64 exec, -1
    s_add_u32 m0, s44, 36864
    s_mov_b32 s45, 0
    buffer_load_dwordx4 v6, s[24:27], s45 offen lds
    s_add_u32 m0, s44, 37920
    s_mov_b32 s45, 8192
    buffer_load_dwordx4 v6, s[24:27], s45 offen lds
    s_add_u32 m0, s44, 38976
    s_mov_b32 s45, 16384
    buffer_load_dwordx4 v6, s[24:27], s45 offen lds
    s_add_u32 m0, s44, 40032
    s_mov_b32 s45, 24576
    buffer_load_dwordx4 v6, s[24:27], s45 offen lds
    s_add_u32 m0, s44, 53760
    s_mov_b32 s45, 262144
    buffer_load_dwordx4 v6, s[24:27], s45 offen lds
    s_add_u32 m0, s44, 54816
    s_mov_b32 s45, 270336
    buffer_load_dwordx4 v6, s[24:27], s45 offen lds
    s_add_u32 m0, s44, 55872
    s_mov_b32 s45, 278528
    buffer_load_dwordx4 v6, s[24:27], s45 offen lds
    s_add_u32 m0, s44, 56928
    s_mov_b32 s45, 286720
    buffer_load_dwordx4 v6, s[24:27], s45 offen lds
    s_add_u32 m0, s44, 73728
    s_mov_b32 s45, 524288
    buffer_load_dwordx4 v6, s[24:27], s45 offen lds
    s_add_u32 m0, s44, 74784
    s_mov_b32 s45, 532480
    buffer_load_dwordx4 v6, s[24:27], s45 offen lds
    s_add_u32 m0, s44, 75840
    s_mov_b32 s45, 540672
    buffer_load_dwordx4 v6, s[24:27], s45 offen lds
    s_add_u32 m0, s44, 76896
    s_mov_b32 s45, 548864
    buffer_load_dwordx4 v6, s[24:27], s45 offen lds
    s_add_u32 m0, s44, 90624
    s_mov_b32 s45, 786432
    buffer_load_dwordx4 v6, s[24:27], s45 offen lds
    s_add_u32 m0, s44, 91680
    s_mov_b32 s45, 794624
    buffer_load_dwordx4 v6, s[24:27], s45 offen lds
    s_add_u32 m0, s44, 92736
    s_mov_b32 s45, 802816
    buffer_load_dwordx4 v6, s[24:27], s45 offen lds
    s_add_u32 m0, s44, 93792
    s_mov_b32 s45, 811008
    buffer_load_dwordx4 v6, s[24:27], s45 offen lds
    s_mov_b64 exec, 0
    s_cmp_eq_u32 s51, 0
    s_cbranch_scc1 L2_pad0
    s_cmp_eq_u32 s51, 1
    s_cbranch_scc1 L2_pad1
    s_cmp_eq_u32 s51, 2
    s_cbranch_scc1 L2_pad2
    s_branch L2_pad3
.p2align 12
L2_walkret:
    s_mov_b64 exec, 15
    buffer_load_dword v12, v163, s[84:87], s59 offen sc1
    s_mov_b64 exec, -1
    s_movk_i32 s14, 13824
    buffer_load_dwordx4 v[168:171], v166, s[84:87], 0 offen sc1
    buffer_load_dwordx4 v[176:179], v166, s[84:87], s14 offen sc1
    s_mov_b64 exec, 0xff
    buffer_load_dwordx4 v[172:175], v166, s[84:87], 0 offen offset:1024 sc1
    buffer_load_dwordx4 v[180:183], v166, s[84:87], s14 offen offset:1024 sc1
    s_mov_b64 exec, -1
    s_mov_b64 exec, 15
    s_waitcnt vmcnt(4)
    v_cmp_eq_u32 vcc, 0, v12
    s_nop 0
    s_cmp_eq_u64 vcc, 0
    s_cbranch_scc1 L2_px_ok
    s_mov_b32 s97, 0x20000
L2_px:
    buffer_load_dword v12, v163, s[84:87], s59 offen sc1
    s_waitcnt vmcnt(0)
    v_cmp_eq_u32 vcc, 0, v12
    s_sub_u32 s97, s97, 1
    s_cselect_b64 vcc, 0, vcc
    s_cmp_eq_u64 vcc, 0
    s_cbranch_scc1 L2_px_ok
    s_branch L2_px
L2_px_ok:
    s_mov_b64 exec, -1
    s_mov_b32 s54, 0
    buffer_load_dwordx4 v[80:83], v8, s[32:35], s54 offen sc1
    s_mov_b32 s54, 1024
    buffer_load_dwordx4 v[84:87], v8, s[32:35], s54 offen sc1
    s_mov_b32 s54, 18432
    buffer_load_dwordx4 v[88:91], v8, s[32:35], s54 offen sc1
    s_mov_b32 s54, 19456
    buffer_load_dwordx4 v[92:95], v8, s[32:35], s54 offen sc1
    s_mov_b32 s54, 2048
    buffer_load_dwordx4 v[96:99], v8, s[32:35], s54 offen sc1
    s_mov_b32 s54, 3072
    buffer_load_dwordx4 v[100:103], v8, s[32:35], s54 offen sc1
    s_mov_b32 s54, 20480
    buffer_load_dwordx4 v[104:107], v8, s[32:35], s54 offen sc1
    s_mov_b32 s54, 21504
    buffer_load_dwordx4 v[108:111], v8, s[32:35], s54 offen sc1
    s_waitcnt vmcnt(8)
    v_max_u32 v13, v168, v169
    v_max3_u32 v13, v13, v170, v171
    v_max3_u32 v13, v13, v172, v173
    v_max3_u32 v13, v13, v174, v175
    v_max3_u32 v13, v13, v176, v177
    v_max3_u32 v13, v13, v178, v179
    v_max3_u32 v13, v13, v180, v181
    v_max3_u32 v13, v13, v182, v183
    v_cmp_eq_u32 vcc, -1, v13
    s_nop 0
    s_cmp_lg_u64 vcc, 0
    s_cbranch_scc1 L2_pms
L2_pmr:
    v_pk_add_f32 v[168:169], v[168:169], v[176:177]
    v_pk_add_f32 v[170:171], v[170:171], v[178:179]
    v_pk_add_f32 v[172:173], v[172:173], v[180:181]
    v_pk_add_f32 v[174:175], v[174:175], v[182:183]
    ds_write_b128 v167, v[168:171]
    s_mov_b64 exec, 0xff
    ds_write_b128 v167, v[172:175] offset:2048
    s_mov_b64 exec, -1
    s_waitcnt lgkmcnt(0)
    s_barrier
    ds_read_b128 v[16:19], v9 offset:9216
    ds_read_b128 v[20:23], v9 offset:9248
    ds_read_b128 v[24:27], v9 offset:9232
    ds_read_b128 v[28:31], v9 offset:9264
    s_mov_b32 s54, 4096
    buffer_load_dwordx4 v[112:115], v8, s[32:35], s54 offen sc1
    s_mov_b32 s54, 5120
    buffer_load_dwordx4 v[116:119], v8, s[32:35], s54 offen sc1
    s_mov_b32 s54, 22528
    buffer_load_dwordx4 v[120:123], v8, s[32:35], s54 offen sc1
    s_mov_b32 s54, 23552
    buffer_load_dwordx4 v[124:127], v8, s[32:35], s54 offen sc1
    s_waitcnt vmcnt(8)
    s_waitcnt lgkmcnt(2)
    v_fma_mix_f32 v32, v80, v16, v20 op_sel:[0,0,0] op_sel_hi:[1,0,0]
    v_fma_mix_f32 v33, v80, v17, v21 op_sel:[1,0,0] op_sel_hi:[1,0,0]
    v_fma_mix_f32 v34, v81, v18, v22 op_sel:[0,0,0] op_sel_hi:[1,0,0]
    v_fma_mix_f32 v35, v81, v19, v23 op_sel:[1,0,0] op_sel_hi:[1,0,0]
    v_cvt_pk_bf16_f32 v80, v32, v33
    v_cvt_pk_bf16_f32 v81, v34, v35
    v_fma_mix_f32 v36, v88, v16, v20 op_sel:[0,0,0] op_sel_hi:[1,0,0]
    v_fma_mix_f32 v37, v88, v17, v21 op_sel:[1,0,0] op_sel_hi:[1,0,0]
    v_fma_mix_f32 v38, v89, v18, v22 op_sel:[0,0,0] op_sel_hi:[1,0,0]
    v_fma_mix_f32 v39, v89, v19, v23 op_sel:[1,0,0] op_sel_hi:[1,0,0]
    v_cvt_pk_bf16_f32 v88, v36, v37
    v_cvt_pk_bf16_f32 v89, v38, v39
    ds_read_b128 v[16:19], v9 offset:9472
    ds_read_b128 v[20:23], v9 offset:9504
    s_waitcnt lgkmcnt(2)
    v_fma_mix_f32 v32, v82, v24, v28 op_sel:[0,0,0] op_sel_hi:[1,0,0]
    v_fma_mix_f32 v33, v82, v25, v29 op_sel:[1,0,0] op_sel_hi:[1,0,0]
    v_fma_mix_f32 v34, v83, v26, v30 op_sel:[0,0,0] op_sel_hi:[1,0,0]
    v_fma_mix_f32 v35, v83, v27, v31 op_sel:[1,0,0] op_sel_hi:[1,0,0]
    v_cvt_pk_bf16_f32 v82, v32, v33
    v_cvt_pk_bf16_f32 v83, v34, v35
    v_fma_mix_f32 v36, v90, v24, v28 op_sel:[0,0,0] op_sel_hi:[1,0,0]
    v_fma_mix_f32 v37, v90, v25, v29 op_sel:[1,0,0] op_sel_hi:[1,0,0]
    v_fma_mix_f32 v38, v91, v26, v30 op_sel:[0,0,0] op_sel_hi:[1,0,0]
    v_fma_mix_f32 v39, v91, v27, v31 op_sel:[1,0,0] op_sel_hi:[1,0,0]
    v_cvt_pk_bf16_f32 v90, v36, v37
    v_cvt_pk_bf16_f32 v91, v38, v39
    ds_read_b128 v[24:27], v9 offset:9488
    ds_read_b128 v[28:31], v9 offset:9520
    s_waitcnt lgkmcnt(2)
    v_fma_mix_f32 v32, v84, v16, v20 op_sel:[0,0,0] op_sel_hi:[1,0,0]
    v_fma_mix_f32 v33, v84, v17, v21 op_sel:[1,0,0] op_sel_hi:[1,0,0]
    v_fma_mix_f32 v34, v85, v18, v22 op_sel:[0,0,0] op_sel_hi:[1,0,0]
    v_fma_mix_f32 v35, v85, v19, v23 op_sel:[1,0,0] op_sel_hi:[1,0,0]
    v_cvt_pk_bf16_f32 v84, v32, v33
    v_cvt_pk_bf16_f32 v85, v34, v35
    v_fma_mix_f32 v36, v92, v16, v20 op_sel:[0,0,0] op_sel_hi:[1,0,0]
    v_fma_mix_f32 v37, v92, v17, v21 op_sel:[1,0,0] op_sel_hi:[1,0,0]
    v_fma_mix_f32 v38, v93, v18, v22 op_sel:[0,0,0] op_sel_hi:[1,0,0]
    v_fma_mix_f32 v39, v93, v19, v23 op_sel:[1,0,0] op_sel_hi:[1,0,0]
    v_cvt_pk_bf16_f32 v92, v36, v37
    v_cvt_pk_bf16_f32 v93, v38, v39
    ds_read_b128 v[16:19], v9 offset:9728
    ds_read_b128 v[20:23], v9 offset:9760
    ds_read_b64_tr_b16 a[192:193], v3 offset:36864
    ds_read_b64_tr_b16 a[194:195], v3 offset:37376
    ds_read_b64_tr_b16 a[196:197], v3 offset:53760
    ds_read_b64_tr_b16 a[198:199], v3 offset:54272
    ds_read_b64_tr_b16 a[200:201], v3 offset:36896
    ds_read_b64_tr_b16 a[202:203], v3 offset:37408
    ds_read_b64_tr_b16 a[204:205], v3 offset:53792
    ds_read_b64_tr_b16 a[206:207], v3 offset:54304
    ds_read_b64_tr_b16 a[208:209], v3 offset:36928
    ds_read_b64_tr_b16 a[210:211], v3 offset:37440
    ds_read_b64_tr_b16 a[212:213], v3 offset:53824
    ds_read_b64_tr_b16 a[214:215], v3 offset:54336
    s_waitcnt lgkmcnt(14)
    v_fma_mix_f32 v32, v86, v24, v28 op_sel:[0,0,0] op_sel_hi:[1,0,0]
    v_fma_mix_f32 v33, v86, v25, v29 op_sel:[1,0,0] op_sel_hi:[1,0,0]
    v_fma_mix_f32 v34, v87, v26, v30 op_sel:[0,0,0] op_sel_hi:[1,0,0]
    v_fma_mix_f32 v35, v87, v27, v31 op_sel:[1,0,0] op_sel_hi:[1,0,0]
    v_cvt_pk_bf16_f32 v86, v32, v33
    v_cvt_pk_bf16_f32 v87, v34, v35
    v_fma_mix_f32 v36, v94, v24, v28 op_sel:[0,0,0] op_sel_hi:[1,0,0]
    v_fma_mix_f32 v37, v94, v25, v29 op_sel:[1,0,0] op_sel_hi:[1,0,0]
    v_fma_mix_f32 v38, v95, v26, v30 op_sel:[0,0,0] op_sel_hi:[1,0,0]
    v_fma_mix_f32 v39, v95, v27, v31 op_sel:[1,0,0] op_sel_hi:[1,0,0]
    v_cvt_pk_bf16_f32 v94, v36, v37
    v_cvt_pk_bf16_f32 v95, v38, v39
    s_waitcnt lgkmcnt(8)
    v_mfma_f32_16x16x32_bf16 v[128:131], a[192:195], v[80:83], 0
    s_waitcnt vmcnt(4)
    ds_read_b64_tr_b16 a[216:217], v3 offset:36960
    ds_read_b128 v[24:27], v9 offset:9744
    v_mfma_f32_16x16x32_bf16 v[128:131], a[196:199], v[84:87], v[128:131]
    ds_read_b64_tr_b16 a[218:219], v3 offset:37472
    ds_read_b64_tr_b16 a[220:221], v3 offset:53856
    v_fma_mix_f32 v32, v96, v16, v20 op_sel:[0,0,0] op_sel_hi:[1,0,0]
    v_mfma_f32_16x16x32_bf16 v[160:163], a[192:195], v[88:91], 0
    s_add_u32 m0, s44, 110592
    ds_read_b64_tr_b16 a[222:223], v3 offset:54368
    ds_read_b128 v[28:31], v9 offset:9776
    v_mfma_f32_16x16x32_bf16 v[160:163], a[196:199], v[92:95], v[160:163]
    s_mov_b32 s45, 1048576
    s_waitcnt lgkmcnt(10)
    buffer_load_dwordx4 v6, s[24:27], s45 offen lds
    v_mfma_f32_16x16x32_bf16 v[132:135], a[200:203], v[80:83], 0
    ds_read_b64_tr_b16 a[224:225], v3 offset:36992
    v_fma_mix_f32 v33, v96, v17, v21 op_sel:[1,0,0] op_sel_hi:[1,0,0]
    v_mfma_f32_16x16x32_bf16 v[132:135], a[204:207], v[84:87], v[132:135]
    ds_read_b64_tr_b16 a[226:227], v3 offset:37504
    ds_read_b64_tr_b16 a[228:229], v3 offset:53888
    v_fma_mix_f32 v34, v97, v18, v22 op_sel:[0,0,0] op_sel_hi:[1,0,0]
    v_mfma_f32_16x16x32_bf16 v[164:167], a[200:203], v[88:91], 0
    s_add_u32 m0, s44, 111648
    ds_read_b64_tr_b16 a[230:231], v3 offset:54400
    v_fma_mix_f32 v35, v97, v19, v23 op_sel:[1,0,0] op_sel_hi:[1,0,0]
    v_mfma_f32_16x16x32_bf16 v[164:167], a[204:207], v[92:95], v[164:167]
    s_mov_b32 s45, 1056768
    s_waitcnt lgkmcnt(10)
    buffer_load_dwordx4 v6, s[24:27], s45 offen lds
    v_mfma_f32_16x16x32_bf16 v[136:139], a[208:211], v[80:83], 0
    ds_read_b64_tr_b16 a[232:233], v3 offset:37024
    v_cvt_pk_bf16_f32 v96, v32, v33
    v_mfma_f32_16x16x32_bf16 v[136:139], a[212:215], v[84:87], v[136:139]
    ds_read_b64_tr_b16 a[234:235], v3 offset:37536
    ds_read_b64_tr_b16 a[236:237], v3 offset:53920
    v_cvt_pk_bf16_f32 v97, v34, v35
    v_mfma_f32_16x16x32_bf16 v[168:171], a[208:211], v[88:91], 0
    s_add_u32 m0, s44, 112704
    ds_read_b64_tr_b16 a[238:239], v3 offset:54432
    v_fma_mix_f32 v36, v104, v16, v20 op_sel:[0,0,0] op_sel_hi:[1,0,0]
    v_mfma_f32_16x16x32_bf16 v[168:171], a[212:215], v[92:95], v[168:171]
    s_mov_b32 s45, 1064960
    s_waitcnt lgkmcnt(9)
    buffer_load_dwordx4 v6, s[24:27], s45 offen lds
    v_fma_mix_f32 v37, v104, v17, v21 op_sel:[1,0,0] op_sel_hi:[1,0,0]
    v_mfma_f32_16x16x32_bf16 v[140:143], a[216:219], v[80:83], 0
    ds_read_b64_tr_b16 a[240:241], v3 offset:37056
    v_fma_mix_f32 v38, v105, v18, v22 op_sel:[0,0,0] op_sel_hi:[1,0,0]
    v_mfma_f32_16x16x32_bf16 v[140:143], a[220:223], v[84:87], v[140:143]
    ds_read_b64_tr_b16 a[242:243], v3 offset:37568
    ds_read_b64_tr_b16 a[244:245], v3 offset:53952
    v_fma_mix_f32 v39, v105, v19, v23 op_sel:[1,0,0] op_sel_hi:[1,0,0]
    v_mfma_f32_16x16x32_bf16 v[172:175], a[216:219], v[88:91], 0
    s_add_u32 m0, s44, 113760
    ds_read_b64_tr_b16 a[246:247], v3 offset:54464
    v_cvt_pk_bf16_f32 v104, v36, v37
    v_mfma_f32_16x16x32_bf16 v[172:175], a[220:223], v[92:95], v[172:175]
    s_mov_b32 s45, 1073152
    s_waitcnt lgkmcnt(8)
    buffer_load_dwordx4 v6, s[24:27], s45 offen lds
    v_cvt_pk_bf16_f32 v105, v38, v39
    v_mfma_f32_16x16x32_bf16 v[144:147], a[224:227], v[80:83], 0
    ds_read_b64_tr_b16 a[248:249], v3 offset:37088
    ds_read_b128 v[16:19], v9 offset:9984
    v_mfma_f32_16x16x32_bf16 v[144:147], a[228:231], v[84:87], v[144:147]
    ds_read_b64_tr_b16 a[250:251], v3 offset:37600
    ds_read_b64_tr_b16 a[252:253], v3 offset:53984
    v_fma_mix_f32 v32, v98, v24, v28 op_sel:[0,0,0] op_sel_hi:[1,0,0]
    v_mfma_f32_16x16x32_bf16 v[176:179], a[224:227], v[88:91], 0
    s_add_u32 m0, s44, 127488
    ds_read_b64_tr_b16 a[254:255], v3 offset:54496
    ds_read_b128 v[20:23], v9 offset:10016
    v_mfma_f32_16x16x32_bf16 v[176:179], a[228:231], v[92:95], v[176:179]
    s_mov_b32 s45, 1310720
    s_waitcnt lgkmcnt(10)
    buffer_load_dwordx4 v6, s[24:27], s45 offen lds
    v_mfma_f32_16x16x32_bf16 v[148:151], a[232:235], v[80:83], 0
    ds_read_b64_tr_b16 a[192:193], v3 offset:37120
    v_fma_mix_f32 v33, v98, v25, v29 op_sel:[1,0,0] op_sel_hi:[1,0,0]
    v_mfma_f32_16x16x32_bf16 v[148:151], a[236:239], v[84:87], v[148:151]
    ds_read_b64_tr_b16 a[194:195], v3 offset:37632
    ds_read_b64_tr_b16 a[196:197], v3 offset:54016
    v_fma_mix_f32 v34, v99, v26, v30 op_sel:[0,0,0] op_sel_hi:[1,0,0]
    v_mfma_f32_16x16x32_bf16 v[180:183], a[232:235], v[88:91], 0
    s_add_u32 m0, s44, 128544
    ds_read_b64_tr_b16 a[198:199], v3 offset:54528
    v_fma_mix_f32 v35, v99, v27, v31 op_sel:[1,0,0] op_sel_hi:[1,0,0]
    v_mfma_f32_16x16x32_bf16 v[180:183], a[236:239], v[92:95], v[180:183]
    s_mov_b32 s45, 1318912
    s_waitcnt lgkmcnt(10)
    buffer_load_dwordx4 v6, s[24:27], s45 offen lds
    v_mfma_f32_16x16x32_bf16 v[152:155], a[240:243], v[80:83], 0
    ds_read_b64_tr_b16 a[200:201], v3 offset:37152
    v_cvt_pk_bf16_f32 v98, v32, v33
    v_mfma_f32_16x16x32_bf16 v[152:155], a[244:247], v[84:87], v[152:155]
    ds_read_b64_tr_b16 a[202:203], v3 offset:37664
    ds_read_b64_tr_b16 a[204:205], v3 offset:54048
    v_cvt_pk_bf16_f32 v99, v34, v35
    v_mfma_f32_16x16x32_bf16 v[184:187], a[240:243], v[88:91], 0
    s_add_u32 m0, s44, 129600
    ds_read_b64_tr_b16 a[206:207], v3 offset:54560
    v_fma_mix_f32 v36, v106, v24, v28 op_sel:[0,0,0] op_sel_hi:[1,0,0]
    v_mfma_f32_16x16x32_bf16 v[184:187], a[244:247], v[92:95], v[184:187]
    s_mov_b32 s45, 1327104
    s_waitcnt lgkmcnt(9)
    buffer_load_dwordx4 v6, s[24:27], s45 offen lds
    v_fma_mix_f32 v37, v106, v25, v29 op_sel:[1,0,0] op_sel_hi:[1,0,0]
    v_mfma_f32_16x16x32_bf16 v[156:159], a[248:251], v[80:83], 0
    ds_read_b64_tr_b16 a[208:209], v3 offset:37184
    v_fma_mix_f32 v38, v107, v26, v30 op_sel:[0,0,0] op_sel_hi:[1,0,0]
    v_mfma_f32_16x16x32_bf16 v[156:159], a[252:255], v[84:87], v[156:159]
    ds_read_b64_tr_b16 a[210:211], v3 offset:37696
    ds_read_b64_tr_b16 a[212:213], v3 offset:54080
    v_fma_mix_f32 v39, v107, v27, v31 op_sel:[1,0,0] op_sel_hi:[1,0,0]
    v_mfma_f32_16x16x32_bf16 v[188:191], a[248:251], v[88:91], 0
    s_add_u32 m0, s44, 130656
    ds_read_b64_tr_b16 a[214:215], v3 offset:54592
    v_cvt_pk_bf16_f32 v106, v36, v37
    v_mfma_f32_16x16x32_bf16 v[188:191], a[252:255], v[92:95], v[188:191]
    s_mov_b32 s45, 1335296
    s_waitcnt lgkmcnt(8)
    buffer_load_dwordx4 v6, s[24:27], s45 offen lds
    v_cvt_pk_bf16_f32 v107, v38, v39
    v_mfma_f32_16x16x32_bf16 v[192:195], a[192:195], v[80:83], 0
    ds_read_b64_tr_b16 a[216:217], v3 offset:37216
    ds_read_b128 v[24:27], v9 offset:10000
    v_mfma_f32_16x16x32_bf16 v[192:195], a[196:199], v[84:87], v[192:195]
    ds_read_b64_tr_b16 a[218:219], v3 offset:37728
    ds_read_b64_tr_b16 a[220:221], v3 offset:54112
    v_fma_mix_f32 v32, v100, v16, v20 op_sel:[0,0,0] op_sel_hi:[1,0,0]
    v_mfma_f32_16x16x32_bf16 v[224:227], a[192:195], v[88:91], 0
    s_mov_b32 s54, 6144
    ds_read_b64_tr_b16 a[222:223], v3 offset:54624
    ds_read_b128 v[28:31], v9 offset:10032
    v_mfma_f32_16x16x32_bf16 v[224:227], a[196:199], v[92:95], v[224:227]
    s_waitcnt lgkmcnt(10)
    buffer_load_dwordx4 v[48:51], v8, s[32:35], s54 offen sc1
    v_mfma_f32_16x16x32_bf16 v[196:199], a[200:203], v[80:83], 0
    ds_read_b64_tr_b16 a[224:225], v3 offset:37248
    v_fma_mix_f32 v33, v100, v17, v21 op_sel:[1,0,0] op_sel_hi:[1,0,0]
    v_mfma_f32_16x16x32_bf16 v[196:199], a[204:207], v[84:87], v[196:199]
    ds_read_b64_tr_b16 a[226:227], v3 offset:37760
    ds_read_b64_tr_b16 a[228:229], v3 offset:54144
    v_fma_mix_f32 v34, v101, v18, v22 op_sel:[0,0,0] op_sel_hi:[1,0,0]
    v_mfma_f32_16x16x32_bf16 v[228:231], a[200:203], v[88:91], 0
    s_mov_b32 s54, 7168
    ds_read_b64_tr_b16 a[230:231], v3 offset:54656
    v_fma_mix_f32 v35, v101, v19, v23 op_sel:[1,0,0] op_sel_hi:[1,0,0]
    v_mfma_f32_16x16x32_bf16 v[228:231], a[204:207], v[92:95], v[228:231]
    s_waitcnt lgkmcnt(10)
    buffer_load_dwordx4 v[52:55], v8, s[32:35], s54 offen sc1
    v_mfma_f32_16x16x32_bf16 v[200:203], a[208:211], v[80:83], 0
    ds_read_b64_tr_b16 a[232:233], v3 offset:37280
    v_cvt_pk_bf16_f32 v100, v32, v33
    v_mfma_f32_16x16x32_bf16 v[200:203], a[212:215], v[84:87], v[200:203]
    ds_read_b64_tr_b16 a[234:235], v3 offset:37792
    ds_read_b64_tr_b16 a[236:237], v3 offset:54176
    v_cvt_pk_bf16_f32 v101, v34, v35
    v_mfma_f32_16x16x32_bf16 v[232:235], a[208:211], v[88:91], 0
    s_mov_b32 s54, 24576
    ds_read_b64_tr_b16 a[238:239], v3 offset:54688
    v_fma_mix_f32 v36, v108, v16, v20 op_sel:[0,0,0] op_sel_hi:[1,0,0]
    v_mfma_f32_16x16x32_bf16 v[232:235], a[212:215], v[92:95], v[232:235]
    s_waitcnt lgkmcnt(9)
    buffer_load_dwordx4 v[56:59], v8, s[32:35], s54 offen sc1
    v_fma_mix_f32 v37, v108, v17, v21 op_sel:[1,0,0] op_sel_hi:[1,0,0]
    v_mfma_f32_16x16x32_bf16 v[204:207], a[216:219], v[80:83], 0
    ds_read_b64_tr_b16 a[240:241], v3 offset:37312
    v_fma_mix_f32 v38, v109, v18, v22 op_sel:[0,0,0] op_sel_hi:[1,0,0]
    v_mfma_f32_16x16x32_bf16 v[204:207], a[220:223], v[84:87], v[204:207]
    ds_read_b64_tr_b16 a[242:243], v3 offset:37824
    ds_read_b64_tr_b16 a[244:245], v3 offset:54208
    v_fma_mix_f32 v39, v109, v19, v23 op_sel:[1,0,0] op_sel_hi:[1,0,0]
    v_mfma_f32_16x16x32_bf16 v[236:239], a[216:219], v[88:91], 0
    s_mov_b32 s54, 25600
    ds_read_b64_tr_b16 a[246:247], v3 offset:54720
    v_cvt_pk_bf16_f32 v108, v36, v37
    v_mfma_f32_16x16x32_bf16 v[236:239], a[220:223], v[92:95], v[236:239]
    s_waitcnt lgkmcnt(8)
    buffer_load_dwordx4 v[60:63], v8, s[32:35], s54 offen sc1
    v_cvt_pk_bf16_f32 v109, v38, v39
    v_mfma_f32_16x16x32_bf16 v[208:211], a[224:227], v[80:83], 0
    ds_read_b64_tr_b16 a[248:249], v3 offset:37344
    ds_read_b128 v[16:19], v9 offset:10240
    v_mfma_f32_16x16x32_bf16 v[208:211], a[228:231], v[84:87], v[208:211]
    ds_read_b64_tr_b16 a[250:251], v3 offset:37856
    ds_read_b128 v[20:23], v9 offset:10272
    v_mfma_f32_16x16x32_bf16 v[240:243], a[224:227], v[88:91], 0
    ds_read_b64_tr_b16 a[252:253], v3 offset:54240
    v_fma_mix_f32 v32, v102, v24, v28 op_sel:[0,0,0] op_sel_hi:[1,0,0]
    v_mfma_f32_16x16x32_bf16 v[240:243], a[228:231], v[92:95], v[240:243]
    s_barrier
    s_waitcnt lgkmcnt(9)
    ds_read_b64_tr_b16 a[254:255], v3 offset:54752
    v_fma_mix_f32 v33, v102, v25, v29 op_sel:[1,0,0] op_sel_hi:[1,0,0]
    v_fma_mix_f32 v34, v103, v26, v30 op_sel:[0,0,0] op_sel_hi:[1,0,0]
    v_mfma_f32_16x16x32_bf16 v[212:215], a[232:235], v[80:83], 0
    ds_read_b64_tr_b16 a[192:193], v4 offset:0
    v_fma_mix_f32 v35, v103, v27, v31 op_sel:[1,0,0] op_sel_hi:[1,0,0]
    v_mfma_f32_16x16x32_bf16 v[212:215], a[236:239], v[84:87], v[212:215]
    ds_read_b64_tr_b16 a[194:195], v4 offset:512
    ds_read_b64_tr_b16 a[196:197], v4 offset:16896
    v_cvt_pk_bf16_f32 v102, v32, v33
    v_mfma_f32_16x16x32_bf16 v[244:247], a[232:235], v[88:91], 0
    s_add_u32 m0, s44, 0
    ds_read_b64_tr_b16 a[198:199], v4 offset:17408
    v_cvt_pk_bf16_f32 v103, v34, v35
    v_mfma_f32_16x16x32_bf16 v[244:247], a[236:239], v[92:95], v[244:247]
    s_mov_b32 s45, 1572864
    s_waitcnt lgkmcnt(10)
    buffer_load_dwordx4 v6, s[24:27], s45 offen lds
    v_mfma_f32_16x16x32_bf16 v[216:219], a[240:243], v[80:83], 0
    ds_read_b64_tr_b16 a[200:201], v4 offset:32
    v_fma_mix_f32 v36, v110, v24, v28 op_sel:[0,0,0] op_sel_hi:[1,0,0]
    v_mfma_f32_16x16x32_bf16 v[216:219], a[244:247], v[84:87], v[216:219]
    ds_read_b64_tr_b16 a[202:203], v4 offset:544
    ds_read_b64_tr_b16 a[204:205], v4 offset:16928
    v_fma_mix_f32 v37, v110, v25, v29 op_sel:[1,0,0] op_sel_hi:[1,0,0]
    v_mfma_f32_16x16x32_bf16 v[248:251], a[240:243], v[88:91], 0
    s_add_u32 m0, s44, 1056
    ds_read_b64_tr_b16 a[206:207], v4 offset:17440
    v_fma_mix_f32 v38, v111, v26, v30 op_sel:[0,0,0] op_sel_hi:[1,0,0]
    v_mfma_f32_16x16x32_bf16 v[248:251], a[244:247], v[92:95], v[248:251]
    s_mov_b32 s45, 1581056
    s_waitcnt lgkmcnt(8)
    buffer_load_dwordx4 v6, s[24:27], s45 offen lds
    v_mfma_f32_16x16x32_bf16 v[220:223], a[248:251], v[80:83], 0
    ds_read_b64_tr_b16 a[208:209], v4 offset:64
    v_fma_mix_f32 v39, v111, v27, v31 op_sel:[1,0,0] op_sel_hi:[1,0,0]
    v_mfma_f32_16x16x32_bf16 v[220:223], a[252:255], v[84:87], v[220:223]
    ds_read_b64_tr_b16 a[210:211], v4 offset:576
    ds_read_b64_tr_b16 a[212:213], v4 offset:16960
    v_cvt_pk_bf16_f32 v110, v36, v37
    v_mfma_f32_16x16x32_bf16 v[252:255], a[248:251], v[88:91], 0
    s_add_u32 m0, s44, 2112
    ds_read_b64_tr_b16 a[214:215], v4 offset:17472
    v_cvt_pk_bf16_f32 v111, v38, v39
    v_mfma_f32_16x16x32_bf16 v[252:255], a[252:255], v[92:95], v[252:255]
    s_mov_b32 s45, 1589248
    s_waitcnt lgkmcnt(8)
    buffer_load_dwordx4 v6, s[24:27], s45 offen lds
    v_mfma_f32_16x16x32_bf16 v[128:131], a[192:195], v[96:99], v[128:131]
    s_waitcnt vmcnt(15)
    ds_read_b64_tr_b16 a[216:217], v4 offset:96
    ds_read_b128 v[24:27], v9 offset:10256
    v_mfma_f32_16x16x32_bf16 v[128:131], a[196:199], v[100:103], v[128:131]
    ds_read_b64_tr_b16 a[218:219], v4 offset:608
    ds_read_b64_tr_b16 a[220:221], v4 offset:16992
    v_fma_mix_f32 v32, v112, v16, v20 op_sel:[0,0,0] op_sel_hi:[1,0,0]
    v_mfma_f32_16x16x32_bf16 v[160:163], a[192:195], v[104:107], v[160:163]
    s_add_u32 m0, s44, 3168
    ds_read_b64_tr_b16 a[222:223], v4 offset:17504
    ds_read_b128 v[28:31], v9 offset:10288
    v_mfma_f32_16x16x32_bf16 v[160:163], a[196:199], v[108:111], v[160:163]
    s_mov_b32 s45, 1597440
    s_waitcnt lgkmcnt(10)
    buffer_load_dwordx4 v6, s[24:27], s45 offen lds
    v_mfma_f32_16x16x32_bf16 v[132:135], a[200:203], v[96:99], v[132:135]
    ds_read_b64_tr_b16 a[224:225], v4 offset:128
    v_fma_mix_f32 v33, v112, v17, v21 op_sel:[1,0,0] op_sel_hi:[1,0,0]
    v_mfma_f32_16x16x32_bf16 v[132:135], a[204:207], v[100:103], v[132:135]
    ds_read_b64_tr_b16 a[226:227], v4 offset:640
    ds_read_b64_tr_b16 a[228:229], v4 offset:17024
    v_fma_mix_f32 v34, v113, v18, v22 op_sel:[0,0,0] op_sel_hi:[1,0,0]
    v_mfma_f32_16x16x32_bf16 v[164:167], a[200:203], v[104:107], v[164:167]
    s_add_u32 m0, s44, 16896
    ds_read_b64_tr_b16 a[230:231], v4 offset:17536
    v_fma_mix_f32 v35, v113, v19, v23 op_sel:[1,0,0] op_sel_hi:[1,0,0]
    v_mfma_f32_16x16x32_bf16 v[164:167], a[204:207], v[108:111], v[164:167]
    s_mov_b32 s45, 1835008
    s_waitcnt lgkmcnt(10)
    buffer_load_dwordx4 v6, s[24:27], s45 offen lds
    v_mfma_f32_16x16x32_bf16 v[136:139], a[208:211], v[96:99], v[136:139]
    ds_read_b64_tr_b16 a[232:233], v4 offset:160
    v_cvt_pk_bf16_f32 v112, v32, v33
    v_mfma_f32_16x16x32_bf16 v[136:139], a[212:215], v[100:103], v[136:139]
    ds_read_b64_tr_b16 a[234:235], v4 offset:672
    ds_read_b64_tr_b16 a[236:237], v4 offset:17056
    v_cvt_pk_bf16_f32 v113, v34, v35
    v_mfma_f32_16x16x32_bf16 v[168:171], a[208:211], v[104:107], v[168:171]
    s_add_u32 m0, s44, 17952
    ds_read_b64_tr_b16 a[238:239], v4 offset:17568
    v_fma_mix_f32 v36, v120, v16, v20 op_sel:[0,0,0] op_sel_hi:[1,0,0]
    v_mfma_f32_16x16x32_bf16 v[168:171], a[212:215], v[108:111], v[168:171]
    s_mov_b32 s45, 1843200
    s_waitcnt lgkmcnt(9)
    buffer_load_dwordx4 v6, s[24:27], s45 offen lds
    v_fma_mix_f32 v37, v120, v17, v21 op_sel:[1,0,0] op_sel_hi:[1,0,0]
    v_mfma_f32_16x16x32_bf16 v[140:143], a[216:219], v[96:99], v[140:143]
    ds_read_b64_tr_b16 a[240:241], v4 offset:192
    v_fma_mix_f32 v38, v121, v18, v22 op_sel:[0,0,0] op_sel_hi:[1,0,0]
    v_mfma_f32_16x16x32_bf16 v[140:143], a[220:223], v[100:103], v[140:143]
    ds_read_b64_tr_b16 a[242:243], v4 offset:704
    ds_read_b64_tr_b16 a[244:245], v4 offset:17088
    v_fma_mix_f32 v39, v121, v19, v23 op_sel:[1,0,0] op_sel_hi:[1,0,0]
    v_mfma_f32_16x16x32_bf16 v[172:175], a[216:219], v[104:107], v[172:175]
    s_add_u32 m0, s44, 19008
    ds_read_b64_tr_b16 a[246:247], v4 offset:17600
    v_cvt_pk_bf16_f32 v120, v36, v37
    v_mfma_f32_16x16x32_bf16 v[172:175], a[220:223], v[108:111], v[172:175]
    s_mov_b32 s45, 1851392
    s_waitcnt lgkmcnt(8)
    buffer_load_dwordx4 v6, s[24:27], s45 offen lds
    v_cvt_pk_bf16_f32 v121, v38, v39
    v_mfma_f32_16x16x32_bf16 v[144:147], a[224:227], v[96:99], v[144:147]
    ds_read_b64_tr_b16 a[248:249], v4 offset:224
    ds_read_b128 v[16:19], v9 offset:10496
    v_mfma_f32_16x16x32_bf16 v[144:147], a[228:231], v[100:103], v[144:147]
    ds_read_b64_tr_b16 a[250:251], v4 offset:736
    ds_read_b64_tr_b16 a[252:253], v4 offset:17120
    v_mfma_f32_16x16x32_bf16 v[176:179], a[224:227], v[104:107], v[176:179]
    s_add_u32 m0, s44, 20064
    ds_read_b64_tr_b16 a[254:255], v4 offset:17632
    ds_read_b128 v[20:23], v9 offset:10528
    v_mfma_f32_16x16x32_bf16 v[176:179], a[228:231], v[108:111], v[176:179]
    s_mov_b32 s45, 1859584
    s_waitcnt lgkmcnt(10)
    buffer_load_dwordx4 v6, s[24:27], s45 offen lds
    v_mfma_f32_16x16x32_bf16 v[148:151], a[232:235], v[96:99], v[148:151]
    ds_read_b64_tr_b16 a[192:193], v4 offset:256
    v_fma_mix_f32 v32, v114, v24, v28 op_sel:[0,0,0] op_sel_hi:[1,0,0]
    v_mfma_f32_16x16x32_bf16 v[148:151], a[236:239], v[100:103], v[148:151]
    ds_read_b64_tr_b16 a[194:195], v4 offset:768
    v_fma_mix_f32 v33, v114, v25, v29 op_sel:[1,0,0] op_sel_hi:[1,0,0]
    v_mfma_f32_16x16x32_bf16 v[180:183], a[232:235], v[104:107], v[180:183]
    ds_read_b64_tr_b16 a[196:197], v4 offset:17152
    v_fma_mix_f32 v34, v115, v26, v30 op_sel:[0,0,0] op_sel_hi:[1,0,0]
    v_mfma_f32_16x16x32_bf16 v[180:183], a[236:239], v[108:111], v[180:183]
    s_waitcnt lgkmcnt(9)
    ds_read_b64_tr_b16 a[198:199], v4 offset:17664
    v_fma_mix_f32 v35, v115, v27, v31 op_sel:[1,0,0] op_sel_hi:[1,0,0]
    v_mfma_f32_16x16x32_bf16 v[152:155], a[240:243], v[96:99], v[152:155]
    ds_read_b64_tr_b16 a[200:201], v4 offset:288
    v_cvt_pk_bf16_f32 v114, v32, v33
    v_mfma_f32_16x16x32_bf16 v[152:155], a[244:247], v[100:103], v[152:155]
    ds_read_b64_tr_b16 a[202:203], v4 offset:800
    v_cvt_pk_bf16_f32 v115, v34, v35
    v_mfma_f32_16x16x32_bf16 v[184:187], a[240:243], v[104:107], v[184:187]
    ds_read_b64_tr_b16 a[204:205], v4 offset:17184
    v_fma_mix_f32 v36, v122, v24, v28 op_sel:[0,0,0] op_sel_hi:[1,0,0]
    v_mfma_f32_16x16x32_bf16 v[184:187], a[244:247], v[108:111], v[184:187]
    s_waitcnt lgkmcnt(8)
    ds_read_b64_tr_b16 a[206:207], v4 offset:17696
    v_fma_mix_f32 v37, v122, v25, v29 op_sel:[1,0,0] op_sel_hi:[1,0,0]
    v_mfma_f32_16x16x32_bf16 v[156:159], a[248:251], v[96:99], v[156:159]
    ds_read_b64_tr_b16 a[208:209], v4 offset:320
    v_fma_mix_f32 v38, v123, v26, v30 op_sel:[0,0,0] op_sel_hi:[1,0,0]
    v_mfma_f32_16x16x32_bf16 v[156:159], a[252:255], v[100:103], v[156:159]
    ds_read_b64_tr_b16 a[210:211], v4 offset:832
    v_fma_mix_f32 v39, v123, v27, v31 op_sel:[1,0,0] op_sel_hi:[1,0,0]
    v_mfma_f32_16x16x32_bf16 v[188:191], a[248:251], v[104:107], v[188:191]
    ds_read_b64_tr_b16 a[212:213], v4 offset:17216
    v_cvt_pk_bf16_f32 v122, v36, v37
    v_mfma_f32_16x16x32_bf16 v[188:191], a[252:255], v[108:111], v[188:191]
    s_waitcnt lgkmcnt(7)
    ds_read_b64_tr_b16 a[214:215], v4 offset:17728
    v_cvt_pk_bf16_f32 v123, v38, v39
    v_mfma_f32_16x16x32_bf16 v[192:195], a[192:195], v[96:99], v[192:195]
    ds_read_b64_tr_b16 a[216:217], v4 offset:352
    ds_read_b128 v[24:27], v9 offset:10512
    v_mfma_f32_16x16x32_bf16 v[192:195], a[196:199], v[100:103], v[192:195]
    ds_read_b64_tr_b16 a[218:219], v4 offset:864
    ds_read_b64_tr_b16 a[220:221], v4 offset:17248
    v_fma_mix_f32 v32, v116, v16, v20 op_sel:[0,0,0] op_sel_hi:[1,0,0]
    v_mfma_f32_16x16x32_bf16 v[224:227], a[192:195], v[104:107], v[224:227]
    s_mov_b32 s54, 8192
    ds_read_b64_tr_b16 a[222:223], v4 offset:17760
    ds_read_b128 v[28:31], v9 offset:10544
    v_mfma_f32_16x16x32_bf16 v[224:227], a[196:199], v[108:111], v[224:227]
    s_waitcnt lgkmcnt(10)
    buffer_load_dwordx4 v[64:67], v8, s[32:35], s54 offen sc1
    v_mfma_f32_16x16x32_bf16 v[196:199], a[200:203], v[96:99], v[196:199]
    ds_read_b64_tr_b16 a[224:225], v4 offset:384
    v_fma_mix_f32 v33, v116, v17, v21 op_sel:[1,0,0] op_sel_hi:[1,0,0]
    v_mfma_f32_16x16x32_bf16 v[196:199], a[204:207], v[100:103], v[196:199]
    ds_read_b64_tr_b16 a[226:227], v4 offset:896
    ds_read_b64_tr_b16 a[228:229], v4 offset:17280
    v_fma_mix_f32 v34, v117, v18, v22 op_sel:[0,0,0] op_sel_hi:[1,0,0]
    v_mfma_f32_16x16x32_bf16 v[228:231], a[200:203], v[104:107], v[228:231]
    s_mov_b32 s54, 9216
    ds_read_b64_tr_b16 a[230:231], v4 offset:17792
    v_fma_mix_f32 v35, v117, v19, v23 op_sel:[1,0,0] op_sel_hi:[1,0,0]
    v_mfma_f32_16x16x32_bf16 v[228:231], a[204:207], v[108:111], v[228:231]
    s_waitcnt lgkmcnt(10)
    buffer_load_dwordx4 v[68:71], v8, s[32:35], s54 offen sc1
    v_mfma_f32_16x16x32_bf16 v[200:203], a[208:211], v[96:99], v[200:203]
    ds_read_b64_tr_b16 a[232:233], v4 offset:416
    v_cvt_pk_bf16_f32 v116, v32, v33
    v_mfma_f32_16x16x32_bf16 v[200:203], a[212:215], v[100:103], v[200:203]
    ds_read_b64_tr_b16 a[234:235], v4 offset:928
    ds_read_b64_tr_b16 a[236:237], v4 offset:17312
    v_cvt_pk_bf16_f32 v117, v34, v35
    v_mfma_f32_16x16x32_bf16 v[232:235], a[208:211], v[104:107], v[232:235]
    s_mov_b32 s54, 26624
    ds_read_b64_tr_b16 a[238:239], v4 offset:17824
    v_fma_mix_f32 v36, v124, v16, v20 op_sel:[0,0,0] op_sel_hi:[1,0,0]
    v_mfma_f32_16x16x32_bf16 v[232:235], a[212:215], v[108:111], v[232:235]
    s_waitcnt lgkmcnt(9)
    buffer_load_dwordx4 v[72:75], v8, s[32:35], s54 offen sc1
    v_fma_mix_f32 v37, v124, v17, v21 op_sel:[1,0,0] op_sel_hi:[1,0,0]
L2_pad0:
    s_cbranch_execz L2_pad4
    v_mfma_f32_16x16x32_bf16 v[204:207], a[216:219], v[96:99], v[204:207]
    ds_read_b64_tr_b16 a[240:241], v4 offset:448
    v_fma_mix_f32 v38, v125, v18, v22 op_sel:[0,0,0] op_sel_hi:[1,0,0]
    v_mfma_f32_16x16x32_bf16 v[204:207], a[220:223], v[100:103], v[204:207]
    ds_read_b64_tr_b16 a[242:243], v4 offset:960
    ds_read_b64_tr_b16 a[244:245], v4 offset:17344
    v_fma_mix_f32 v39, v125, v19, v23 op_sel:[1,0,0] op_sel_hi:[1,0,0]
    v_mfma_f32_16x16x32_bf16 v[236:239], a[216:219], v[104:107], v[236:239]
    s_mov_b32 s54, 27648
    ds_read_b64_tr_b16 a[246:247], v4 offset:17856
    v_cvt_pk_bf16_f32 v124, v36, v37
    v_mfma_f32_16x16x32_bf16 v[236:239], a[220:223], v[108:111], v[236:239]
    s_waitcnt lgkmcnt(8)
    buffer_load_dwordx4 v[76:79], v8, s[32:35], s54 offen sc1
    v_cvt_pk_bf16_f32 v125, v38, v39
    v_mfma_f32_16x16x32_bf16 v[208:211], a[224:227], v[96:99], v[208:211]
    ds_read_b64_tr_b16 a[248:249], v4 offset:480
    ds_read_b128 v[16:19], v9 offset:10752
    v_mfma_f32_16x16x32_bf16 v[208:211], a[228:231], v[100:103], v[208:211]
    ds_read_b64_tr_b16 a[250:251], v4 offset:992
    ds_read_b128 v[20:23], v9 offset:10784
    v_mfma_f32_16x16x32_bf16 v[240:243], a[224:227], v[104:107], v[240:243]
    ds_read_b64_tr_b16 a[252:253], v4 offset:17376
    v_fma_mix_f32 v32, v118, v24, v28 op_sel:[0,0,0] op_sel_hi:[1,0,0]
    v_mfma_f32_16x16x32_bf16 v[240:243], a[228:231], v[108:111], v[240:243]
    s_waitcnt vmcnt(16)
    s_barrier
    s_waitcnt lgkmcnt(9)
    ds_read_b64_tr_b16 a[254:255], v4 offset:17888
    v_fma_mix_f32 v33, v118, v25, v29 op_sel:[1,0,0] op_sel_hi:[1,0,0]
    v_fma_mix_f32 v34, v119, v26, v30 op_sel:[0,0,0] op_sel_hi:[1,0,0]
    v_mfma_f32_16x16x32_bf16 v[212:215], a[232:235], v[96:99], v[212:215]
    ds_read_b64_tr_b16 a[192:193], v4 offset:36864
    v_fma_mix_f32 v35, v119, v27, v31 op_sel:[1,0,0] op_sel_hi:[1,0,0]
    v_mfma_f32_16x16x32_bf16 v[212:215], a[236:239], v[100:103], v[212:215]
    ds_read_b64_tr_b16 a[194:195], v4 offset:37376
    ds_read_b64_tr_b16 a[196:197], v4 offset:53760
    v_cvt_pk_bf16_f32 v118, v32, v33
    v_mfma_f32_16x16x32_bf16 v[244:247], a[232:235], v[104:107], v[244:247]
    s_add_u32 m0, s44, 36864
    ds_read_b64_tr_b16 a[198:199], v4 offset:54272
    v_cvt_pk_bf16_f32 v119, v34, v35
    v_mfma_f32_16x16x32_bf16 v[244:247], a[236:239], v[108:111], v[244:247]
    s_mov_b32 s45, 2097152
    s_waitcnt lgkmcnt(10)
    buffer_load_dwordx4 v6, s[24:27], s45 offen lds
    v_mfma_f32_16x16x32_bf16 v[216:219], a[240:243], v[96:99], v[216:219]
    ds_read_b64_tr_b16 a[200:201], v4 offset:36896
    v_fma_mix_f32 v36, v126, v24, v28 op_sel:[0,0,0] op_sel_hi:[1,0,0]
    v_mfma_f32_16x16x32_bf16 v[216:219], a[244:247], v[100:103], v[216:219]
    ds_read_b64_tr_b16 a[202:203], v4 offset:37408
    ds_read_b64_tr_b16 a[204:205], v4 offset:53792
    v_fma_mix_f32 v37, v126, v25, v29 op_sel:[1,0,0] op_sel_hi:[1,0,0]
    v_mfma_f32_16x16x32_bf16 v[248:251], a[240:243], v[104:107], v[248:251]
    s_add_u32 m0, s44, 37920
    ds_read_b64_tr_b16 a[206:207], v4 offset:54304
    v_fma_mix_f32 v38, v127, v26, v30 op_sel:[0,0,0] op_sel_hi:[1,0,0]
    v_mfma_f32_16x16x32_bf16 v[248:251], a[244:247], v[108:111], v[248:251]
    s_mov_b32 s45, 2105344
    s_waitcnt lgkmcnt(8)
    buffer_load_dwordx4 v6, s[24:27], s45 offen lds
    v_mfma_f32_16x16x32_bf16 v[220:223], a[248:251], v[96:99], v[220:223]
    ds_read_b64_tr_b16 a[208:209], v4 offset:36928
    v_fma_mix_f32 v39, v127, v27, v31 op_sel:[1,0,0] op_sel_hi:[1,0,0]
    v_mfma_f32_16x16x32_bf16 v[220:223], a[252:255], v[100:103], v[220:223]
    ds_read_b64_tr_b16 a[210:211], v4 offset:37440
    ds_read_b64_tr_b16 a[212:213], v4 offset:53824
    v_cvt_pk_bf16_f32 v126, v36, v37
    v_mfma_f32_16x16x32_bf16 v[252:255], a[248:251], v[104:107], v[252:255]
    s_add_u32 m0, s44, 38976
    ds_read_b64_tr_b16 a[214:215], v4 offset:54336
    v_cvt_pk_bf16_f32 v127, v38, v39
    v_mfma_f32_16x16x32_bf16 v[252:255], a[252:255], v[108:111], v[252:255]
    s_mov_b32 s45, 2113536
    s_waitcnt lgkmcnt(8)
    buffer_load_dwordx4 v6, s[24:27], s45 offen lds
    v_mfma_f32_16x16x32_bf16 v[128:131], a[192:195], v[112:115], v[128:131]
    s_waitcnt vmcnt(15)
    ds_read_b64_tr_b16 a[216:217], v4 offset:36960
    ds_read_b128 v[24:27], v9 offset:10768
    v_mfma_f32_16x16x32_bf16 v[128:131], a[196:199], v[116:119], v[128:131]
    ds_read_b64_tr_b16 a[218:219], v4 offset:37472
    ds_read_b64_tr_b16 a[220:221], v4 offset:53856
    v_fma_mix_f32 v32, v48, v16, v20 op_sel:[0,0,0] op_sel_hi:[1,0,0]
    v_mfma_f32_16x16x32_bf16 v[160:163], a[192:195], v[120:123], v[160:163]
    s_add_u32 m0, s44, 40032
    ds_read_b64_tr_b16 a[222:223], v4 offset:54368
    ds_read_b128 v[28:31], v9 offset:10800
    v_mfma_f32_16x16x32_bf16 v[160:163], a[196:199], v[124:127], v[160:163]
    s_mov_b32 s45, 2121728
    s_waitcnt lgkmcnt(10)
    buffer_load_dwordx4 v6, s[24:27], s45 offen lds
    v_mfma_f32_16x16x32_bf16 v[132:135], a[200:203], v[112:115], v[132:135]
    ds_read_b64_tr_b16 a[224:225], v4 offset:36992
    v_fma_mix_f32 v33, v48, v17, v21 op_sel:[1,0,0] op_sel_hi:[1,0,0]
    v_mfma_f32_16x16x32_bf16 v[132:135], a[204:207], v[116:119], v[132:135]
    ds_read_b64_tr_b16 a[226:227], v4 offset:37504
    ds_read_b64_tr_b16 a[228:229], v4 offset:53888
    v_fma_mix_f32 v34, v49, v18, v22 op_sel:[0,0,0] op_sel_hi:[1,0,0]
    v_mfma_f32_16x16x32_bf16 v[164:167], a[200:203], v[120:123], v[164:167]
    s_add_u32 m0, s44, 53760
    ds_read_b64_tr_b16 a[230:231], v4 offset:54400
    v_fma_mix_f32 v35, v49, v19, v23 op_sel:[1,0,0] op_sel_hi:[1,0,0]
    v_mfma_f32_16x16x32_bf16 v[164:167], a[204:207], v[124:127], v[164:167]
    s_mov_b32 s45, 2359296
    s_waitcnt lgkmcnt(10)
    buffer_load_dwordx4 v6, s[24:27], s45 offen lds
    v_mfma_f32_16x16x32_bf16 v[136:139], a[208:211], v[112:115], v[136:139]
    ds_read_b64_tr_b16 a[232:233], v4 offset:37024
    v_cvt_pk_bf16_f32 v48, v32, v33
    v_mfma_f32_16x16x32_bf16 v[136:139], a[212:215], v[116:119], v[136:139]
    ds_read_b64_tr_b16 a[234:235], v4 offset:37536
    ds_read_b64_tr_b16 a[236:237], v4 offset:53920
    v_cvt_pk_bf16_f32 v49, v34, v35
    v_mfma_f32_16x16x32_bf16 v[168:171], a[208:211], v[120:123], v[168:171]
    s_add_u32 m0, s44, 54816
    ds_read_b64_tr_b16 a[238:239], v4 offset:54432
    v_fma_mix_f32 v36, v56, v16, v20 op_sel:[0,0,0] op_sel_hi:[1,0,0]
    v_mfma_f32_16x16x32_bf16 v[168:171], a[212:215], v[124:127], v[168:171]
    s_mov_b32 s45, 2367488
    s_waitcnt lgkmcnt(9)
    buffer_load_dwordx4 v6, s[24:27], s45 offen lds
    v_fma_mix_f32 v37, v56, v17, v21 op_sel:[1,0,0] op_sel_hi:[1,0,0]
    v_mfma_f32_16x16x32_bf16 v[140:143], a[216:219], v[112:115], v[140:143]
    ds_read_b64_tr_b16 a[240:241], v4 offset:37056
    v_fma_mix_f32 v38, v57, v18, v22 op_sel:[0,0,0] op_sel_hi:[1,0,0]
    v_mfma_f32_16x16x32_bf16 v[140:143], a[220:223], v[116:119], v[140:143]
    ds_read_b64_tr_b16 a[242:243], v4 offset:37568
    ds_read_b64_tr_b16 a[244:245], v4 offset:53952
    v_fma_mix_f32 v39, v57, v19, v23 op_sel:[1,0,0] op_sel_hi:[1,0,0]
    v_mfma_f32_16x16x32_bf16 v[172:175], a[216:219], v[120:123], v[172:175]
    s_add_u32 m0, s44, 55872
    ds_read_b64_tr_b16 a[246:247], v4 offset:54464
    v_cvt_pk_bf16_f32 v56, v36, v37
    v_mfma_f32_16x16x32_bf16 v[172:175], a[220:223], v[124:127], v[172:175]
    s_mov_b32 s45, 2375680
    s_waitcnt lgkmcnt(8)
    buffer_load_dwordx4 v6, s[24:27], s45 offen lds
    v_cvt_pk_bf16_f32 v57, v38, v39
    v_mfma_f32_16x16x32_bf16 v[144:147], a[224:227], v[112:115], v[144:147]
    ds_read_b64_tr_b16 a[248:249], v4 offset:37088
    ds_read_b128 v[16:19], v9 offset:11008
    v_mfma_f32_16x16x32_bf16 v[144:147], a[228:231], v[116:119], v[144:147]
    ds_read_b64_tr_b16 a[250:251], v4 offset:37600
    ds_read_b64_tr_b16 a[252:253], v4 offset:53984
    v_mfma_f32_16x16x32_bf16 v[176:179], a[224:227], v[120:123], v[176:179]
    s_add_u32 m0, s44, 56928
    ds_read_b64_tr_b16 a[254:255], v4 offset:54496
    ds_read_b128 v[20:23], v9 offset:11040
    v_mfma_f32_16x16x32_bf16 v[176:179], a[228:231], v[124:127], v[176:179]
    s_mov_b32 s45, 2383872
    s_waitcnt lgkmcnt(10)
    buffer_load_dwordx4 v6, s[24:27], s45 offen lds
    v_mfma_f32_16x16x32_bf16 v[148:151], a[232:235], v[112:115], v[148:151]
    ds_read_b64_tr_b16 a[192:193], v4 offset:37120
    v_fma_mix_f32 v32, v50, v24, v28 op_sel:[0,0,0] op_sel_hi:[1,0,0]
    v_mfma_f32_16x16x32_bf16 v[148:151], a[236:239], v[116:119], v[148:151]
    ds_read_b64_tr_b16 a[194:195], v4 offset:37632
    v_fma_mix_f32 v33, v50, v25, v29 op_sel:[1,0,0] op_sel_hi:[1,0,0]
    v_mfma_f32_16x16x32_bf16 v[180:183], a[232:235], v[120:123], v[180:183]
    ds_read_b64_tr_b16 a[196:197], v4 offset:54016
    v_fma_mix_f32 v34, v51, v26, v30 op_sel:[0,0,0] op_sel_hi:[1,0,0]
    v_mfma_f32_16x16x32_bf16 v[180:183], a[236:239], v[124:127], v[180:183]
    s_waitcnt lgkmcnt(9)
    ds_read_b64_tr_b16 a[198:199], v4 offset:54528
    v_fma_mix_f32 v35, v51, v27, v31 op_sel:[1,0,0] op_sel_hi:[1,0,0]
    v_mfma_f32_16x16x32_bf16 v[152:155], a[240:243], v[112:115], v[152:155]
    ds_read_b64_tr_b16 a[200:201], v4 offset:37152
    v_cvt_pk_bf16_f32 v50, v32, v33
    v_mfma_f32_16x16x32_bf16 v[152:155], a[244:247], v[116:119], v[152:155]
    ds_read_b64_tr_b16 a[202:203], v4 offset:37664
    v_cvt_pk_bf16_f32 v51, v34, v35
    v_mfma_f32_16x16x32_bf16 v[184:187], a[240:243], v[120:123], v[184:187]
    ds_read_b64_tr_b16 a[204:205], v4 offset:54048
    v_fma_mix_f32 v36, v58, v24, v28 op_sel:[0,0,0] op_sel_hi:[1,0,0]
    v_mfma_f32_16x16x32_bf16 v[184:187], a[244:247], v[124:127], v[184:187]
    s_waitcnt lgkmcnt(8)
    ds_read_b64_tr_b16 a[206:207], v4 offset:54560
    v_fma_mix_f32 v37, v58, v25, v29 op_sel:[1,0,0] op_sel_hi:[1,0,0]
    v_mfma_f32_16x16x32_bf16 v[156:159], a[248:251], v[112:115], v[156:159]
    ds_read_b64_tr_b16 a[208:209], v4 offset:37184
    v_fma_mix_f32 v38, v59, v26, v30 op_sel:[0,0,0] op_sel_hi:[1,0,0]
    v_mfma_f32_16x16x32_bf16 v[156:159], a[252:255], v[116:119], v[156:159]
    ds_read_b64_tr_b16 a[210:211], v4 offset:37696
    v_fma_mix_f32 v39, v59, v27, v31 op_sel:[1,0,0] op_sel_hi:[1,0,0]
    v_mfma_f32_16x16x32_bf16 v[188:191], a[248:251], v[120:123], v[188:191]
    ds_read_b64_tr_b16 a[212:213], v4 offset:54080
    v_cvt_pk_bf16_f32 v58, v36, v37
    v_mfma_f32_16x16x32_bf16 v[188:191], a[252:255], v[124:127], v[188:191]
    s_waitcnt lgkmcnt(7)
    ds_read_b64_tr_b16 a[214:215], v4 offset:54592
    v_cvt_pk_bf16_f32 v59, v38, v39
    v_mfma_f32_16x16x32_bf16 v[192:195], a[192:195], v[112:115], v[192:195]
    ds_read_b64_tr_b16 a[216:217], v4 offset:37216
    ds_read_b128 v[24:27], v9 offset:11024
    v_mfma_f32_16x16x32_bf16 v[192:195], a[196:199], v[116:119], v[192:195]
    ds_read_b64_tr_b16 a[218:219], v4 offset:37728
    ds_read_b64_tr_b16 a[220:221], v4 offset:54112
    v_fma_mix_f32 v32, v52, v16, v20 op_sel:[0,0,0] op_sel_hi:[1,0,0]
    v_mfma_f32_16x16x32_bf16 v[224:227], a[192:195], v[120:123], v[224:227]
    s_mov_b32 s54, 10240
    ds_read_b64_tr_b16 a[222:223], v4 offset:54624
    ds_read_b128 v[28:31], v9 offset:11056
    v_mfma_f32_16x16x32_bf16 v[224:227], a[196:199], v[124:127], v[224:227]
    s_waitcnt lgkmcnt(10)
    buffer_load_dwordx4 v[80:83], v8, s[32:35], s54 offen sc1
    v_mfma_f32_16x16x32_bf16 v[196:199], a[200:203], v[112:115], v[196:199]
    ds_read_b64_tr_b16 a[224:225], v4 offset:37248
    v_fma_mix_f32 v33, v52, v17, v21 op_sel:[1,0,0] op_sel_hi:[1,0,0]
    v_mfma_f32_16x16x32_bf16 v[196:199], a[204:207], v[116:119], v[196:199]
    ds_read_b64_tr_b16 a[226:227], v4 offset:37760
    ds_read_b64_tr_b16 a[228:229], v4 offset:54144
    v_fma_mix_f32 v34, v53, v18, v22 op_sel:[0,0,0] op_sel_hi:[1,0,0]
    v_mfma_f32_16x16x32_bf16 v[228:231], a[200:203], v[120:123], v[228:231]
    s_mov_b32 s54, 11264
    ds_read_b64_tr_b16 a[230:231], v4 offset:54656
    v_fma_mix_f32 v35, v53, v19, v23 op_sel:[1,0,0] op_sel_hi:[1,0,0]
    v_mfma_f32_16x16x32_bf16 v[228:231], a[204:207], v[124:127], v[228:231]
    s_waitcnt lgkmcnt(10)
    buffer_load_dwordx4 v[84:87], v8, s[32:35], s54 offen sc1
    v_mfma_f32_16x16x32_bf16 v[200:203], a[208:211], v[112:115], v[200:203]
    ds_read_b64_tr_b16 a[232:233], v4 offset:37280
    v_cvt_pk_bf16_f32 v52, v32, v33
    v_mfma_f32_16x16x32_bf16 v[200:203], a[212:215], v[116:119], v[200:203]
    ds_read_b64_tr_b16 a[234:235], v4 offset:37792
    ds_read_b64_tr_b16 a[236:237], v4 offset:54176
    v_cvt_pk_bf16_f32 v53, v34, v35
    v_mfma_f32_16x16x32_bf16 v[232:235], a[208:211], v[120:123], v[232:235]
    s_mov_b32 s54, 28672
    ds_read_b64_tr_b16 a[238:239], v4 offset:54688
    v_fma_mix_f32 v36, v60, v16, v20 op_sel:[0,0,0] op_sel_hi:[1,0,0]
    v_mfma_f32_16x16x32_bf16 v[232:235], a[212:215], v[124:127], v[232:235]
    s_waitcnt lgkmcnt(9)
    buffer_load_dwordx4 v[88:91], v8, s[32:35], s54 offen sc1
    v_fma_mix_f32 v37, v60, v17, v21 op_sel:[1,0,0] op_sel_hi:[1,0,0]
    v_mfma_f32_16x16x32_bf16 v[204:207], a[216:219], v[112:115], v[204:207]
    ds_read_b64_tr_b16 a[240:241], v4 offset:37312
    v_fma_mix_f32 v38, v61, v18, v22 op_sel:[0,0,0] op_sel_hi:[1,0,0]
    v_mfma_f32_16x16x32_bf16 v[204:207], a[220:223], v[116:119], v[204:207]
    ds_read_b64_tr_b16 a[242:243], v4 offset:37824
    ds_read_b64_tr_b16 a[244:245], v4 offset:54208
    v_fma_mix_f32 v39, v61, v19, v23 op_sel:[1,0,0] op_sel_hi:[1,0,0]
    v_mfma_f32_16x16x32_bf16 v[236:239], a[216:219], v[120:123], v[236:239]
    s_mov_b32 s54, 29696
    ds_read_b64_tr_b16 a[246:247], v4 offset:54720
    v_cvt_pk_bf16_f32 v60, v36, v37
    v_mfma_f32_16x16x32_bf16 v[236:239], a[220:223], v[124:127], v[236:239]
    s_waitcnt lgkmcnt(8)
    buffer_load_dwordx4 v[92:95], v8, s[32:35], s54 offen sc1
    v_cvt_pk_bf16_f32 v61, v38, v39
    v_mfma_f32_16x16x32_bf16 v[208:211], a[224:227], v[112:115], v[208:211]
    ds_read_b64_tr_b16 a[248:249], v4 offset:37344
    ds_read_b128 v[16:19], v9 offset:11264
    v_mfma_f32_16x16x32_bf16 v[208:211], a[228:231], v[116:119], v[208:211]
    ds_read_b64_tr_b16 a[250:251], v4 offset:37856
    ds_read_b128 v[20:23], v9 offset:11296
    v_mfma_f32_16x16x32_bf16 v[240:243], a[224:227], v[120:123], v[240:243]
    ds_read_b64_tr_b16 a[252:253], v4 offset:54240
    v_fma_mix_f32 v32, v54, v24, v28 op_sel:[0,0,0] op_sel_hi:[1,0,0]
    v_mfma_f32_16x16x32_bf16 v[240:243], a[228:231], v[124:127], v[240:243]
    s_waitcnt vmcnt(16)
    s_barrier
    s_waitcnt lgkmcnt(9)
    ds_read_b64_tr_b16 a[254:255], v4 offset:54752
    v_fma_mix_f32 v33, v54, v25, v29 op_sel:[1,0,0] op_sel_hi:[1,0,0]
    v_fma_mix_f32 v34, v55, v26, v30 op_sel:[0,0,0] op_sel_hi:[1,0,0]
    v_mfma_f32_16x16x32_bf16 v[212:215], a[232:235], v[112:115], v[212:215]
    ds_read_b64_tr_b16 a[192:193], v3 offset:0
    v_fma_mix_f32 v35, v55, v27, v31 op_sel:[1,0,0] op_sel_hi:[1,0,0]
    v_mfma_f32_16x16x32_bf16 v[212:215], a[236:239], v[116:119], v[212:215]
    ds_read_b64_tr_b16 a[194:195], v3 offset:512
    ds_read_b64_tr_b16 a[196:197], v3 offset:16896
    v_cvt_pk_bf16_f32 v54, v32, v33
    v_mfma_f32_16x16x32_bf16 v[244:247], a[232:235], v[120:123], v[244:247]
    s_add_u32 m0, s44, 73728
    ds_read_b64_tr_b16 a[198:199], v3 offset:17408
    v_cvt_pk_bf16_f32 v55, v34, v35
    v_mfma_f32_16x16x32_bf16 v[244:247], a[236:239], v[124:127], v[244:247]
    s_mov_b32 s45, 2621440
    s_waitcnt lgkmcnt(10)
    buffer_load_dwordx4 v6, s[24:27], s45 offen lds
    v_mfma_f32_16x16x32_bf16 v[216:219], a[240:243], v[112:115], v[216:219]
    ds_read_b64_tr_b16 a[200:201], v3 offset:32
    v_fma_mix_f32 v36, v62, v24, v28 op_sel:[0,0,0] op_sel_hi:[1,0,0]
    v_mfma_f32_16x16x32_bf16 v[216:219], a[244:247], v[116:119], v[216:219]
    ds_read_b64_tr_b16 a[202:203], v3 offset:544
    ds_read_b64_tr_b16 a[204:205], v3 offset:16928
    v_fma_mix_f32 v37, v62, v25, v29 op_sel:[1,0,0] op_sel_hi:[1,0,0]
    v_mfma_f32_16x16x32_bf16 v[248:251], a[240:243], v[120:123], v[248:251]
    s_add_u32 m0, s44, 74784
    ds_read_b64_tr_b16 a[206:207], v3 offset:17440
    v_fma_mix_f32 v38, v63, v26, v30 op_sel:[0,0,0] op_sel_hi:[1,0,0]
    v_mfma_f32_16x16x32_bf16 v[248:251], a[244:247], v[124:127], v[248:251]
    s_mov_b32 s45, 2629632
    s_waitcnt lgkmcnt(8)
    buffer_load_dwordx4 v6, s[24:27], s45 offen lds
    v_mfma_f32_16x16x32_bf16 v[220:223], a[248:251], v[112:115], v[220:223]
    ds_read_b64_tr_b16 a[208:209], v3 offset:64
    v_fma_mix_f32 v39, v63, v27, v31 op_sel:[1,0,0] op_sel_hi:[1,0,0]
    v_mfma_f32_16x16x32_bf16 v[220:223], a[252:255], v[116:119], v[220:223]
    ds_read_b64_tr_b16 a[210:211], v3 offset:576
    ds_read_b64_tr_b16 a[212:213], v3 offset:16960
    v_cvt_pk_bf16_f32 v62, v36, v37
    v_mfma_f32_16x16x32_bf16 v[252:255], a[248:251], v[120:123], v[252:255]
    s_add_u32 m0, s44, 75840
    ds_read_b64_tr_b16 a[214:215], v3 offset:17472
    v_cvt_pk_bf16_f32 v63, v38, v39
    v_mfma_f32_16x16x32_bf16 v[252:255], a[252:255], v[124:127], v[252:255]
    s_mov_b32 s45, 2637824
    s_waitcnt lgkmcnt(8)
    buffer_load_dwordx4 v6, s[24:27], s45 offen lds
    v_mfma_f32_16x16x32_bf16 v[128:131], a[192:195], v[48:51], v[128:131]
    s_waitcnt vmcnt(15)
    ds_read_b64_tr_b16 a[216:217], v3 offset:96
    ds_read_b128 v[24:27], v9 offset:11280
    v_mfma_f32_16x16x32_bf16 v[128:131], a[196:199], v[52:55], v[128:131]
    ds_read_b64_tr_b16 a[218:219], v3 offset:608
    ds_read_b64_tr_b16 a[220:221], v3 offset:16992
    v_fma_mix_f32 v32, v64, v16, v20 op_sel:[0,0,0] op_sel_hi:[1,0,0]
    v_mfma_f32_16x16x32_bf16 v[160:163], a[192:195], v[56:59], v[160:163]
    s_add_u32 m0, s44, 76896
    ds_read_b64_tr_b16 a[222:223], v3 offset:17504
    ds_read_b128 v[28:31], v9 offset:11312
    v_mfma_f32_16x16x32_bf16 v[160:163], a[196:199], v[60:63], v[160:163]
    s_mov_b32 s45, 2646016
    s_waitcnt lgkmcnt(10)
    buffer_load_dwordx4 v6, s[24:27], s45 offen lds
    v_mfma_f32_16x16x32_bf16 v[132:135], a[200:203], v[48:51], v[132:135]
    ds_read_b64_tr_b16 a[224:225], v3 offset:128
    v_fma_mix_f32 v33, v64, v17, v21 op_sel:[1,0,0] op_sel_hi:[1,0,0]
    v_mfma_f32_16x16x32_bf16 v[132:135], a[204:207], v[52:55], v[132:135]
    ds_read_b64_tr_b16 a[226:227], v3 offset:640
    ds_read_b64_tr_b16 a[228:229], v3 offset:17024
    v_fma_mix_f32 v34, v65, v18, v22 op_sel:[0,0,0] op_sel_hi:[1,0,0]
    v_mfma_f32_16x16x32_bf16 v[164:167], a[200:203], v[56:59], v[164:167]
    s_add_u32 m0, s44, 90624
    ds_read_b64_tr_b16 a[230:231], v3 offset:17536
    v_fma_mix_f32 v35, v65, v19, v23 op_sel:[1,0,0] op_sel_hi:[1,0,0]
    v_mfma_f32_16x16x32_bf16 v[164:167], a[204:207], v[60:63], v[164:167]
    s_mov_b32 s45, 2883584
    s_waitcnt lgkmcnt(10)
    buffer_load_dwordx4 v6, s[24:27], s45 offen lds
    v_mfma_f32_16x16x32_bf16 v[136:139], a[208:211], v[48:51], v[136:139]
    ds_read_b64_tr_b16 a[232:233], v3 offset:160
    v_cvt_pk_bf16_f32 v64, v32, v33
    v_mfma_f32_16x16x32_bf16 v[136:139], a[212:215], v[52:55], v[136:139]
    ds_read_b64_tr_b16 a[234:235], v3 offset:672
    ds_read_b64_tr_b16 a[236:237], v3 offset:17056
    v_cvt_pk_bf16_f32 v65, v34, v35
    v_mfma_f32_16x16x32_bf16 v[168:171], a[208:211], v[56:59], v[168:171]
    s_add_u32 m0, s44, 91680
    ds_read_b64_tr_b16 a[238:239], v3 offset:17568
    v_fma_mix_f32 v36, v72, v16, v20 op_sel:[0,0,0] op_sel_hi:[1,0,0]
    v_mfma_f32_16x16x32_bf16 v[168:171], a[212:215], v[60:63], v[168:171]
    s_mov_b32 s45, 2891776
    s_waitcnt lgkmcnt(9)
    buffer_load_dwordx4 v6, s[24:27], s45 offen lds
    v_fma_mix_f32 v37, v72, v17, v21 op_sel:[1,0,0] op_sel_hi:[1,0,0]
    v_mfma_f32_16x16x32_bf16 v[140:143], a[216:219], v[48:51], v[140:143]
    ds_read_b64_tr_b16 a[240:241], v3 offset:192
    v_fma_mix_f32 v38, v73, v18, v22 op_sel:[0,0,0] op_sel_hi:[1,0,0]
    v_mfma_f32_16x16x32_bf16 v[140:143], a[220:223], v[52:55], v[140:143]
    ds_read_b64_tr_b16 a[242:243], v3 offset:704
    ds_read_b64_tr_b16 a[244:245], v3 offset:17088
    v_fma_mix_f32 v39, v73, v19, v23 op_sel:[1,0,0] op_sel_hi:[1,0,0]
    v_mfma_f32_16x16x32_bf16 v[172:175], a[216:219], v[56:59], v[172:175]
    s_add_u32 m0, s44, 92736
    ds_read_b64_tr_b16 a[246:247], v3 offset:17600
    v_cvt_pk_bf16_f32 v72, v36, v37
    v_mfma_f32_16x16x32_bf16 v[172:175], a[220:223], v[60:63], v[172:175]
    s_mov_b32 s45, 2899968
    s_waitcnt lgkmcnt(8)
    buffer_load_dwordx4 v6, s[24:27], s45 offen lds
    v_cvt_pk_bf16_f32 v73, v38, v39
    v_mfma_f32_16x16x32_bf16 v[144:147], a[224:227], v[48:51], v[144:147]
    ds_read_b64_tr_b16 a[248:249], v3 offset:224
    ds_read_b128 v[16:19], v9 offset:11520
    v_mfma_f32_16x16x32_bf16 v[144:147], a[228:231], v[52:55], v[144:147]
    ds_read_b64_tr_b16 a[250:251], v3 offset:736
    ds_read_b64_tr_b16 a[252:253], v3 offset:17120
    v_mfma_f32_16x16x32_bf16 v[176:179], a[224:227], v[56:59], v[176:179]
    s_add_u32 m0, s44, 93792
    ds_read_b64_tr_b16 a[254:255], v3 offset:17632
    ds_read_b128 v[20:23], v9 offset:11552
    v_mfma_f32_16x16x32_bf16 v[176:179], a[228:231], v[60:63], v[176:179]
    s_mov_b32 s45, 2908160
    s_waitcnt lgkmcnt(10)
    buffer_load_dwordx4 v6, s[24:27], s45 offen lds
    v_mfma_f32_16x16x32_bf16 v[148:151], a[232:235], v[48:51], v[148:151]
    ds_read_b64_tr_b16 a[192:193], v3 offset:256
    v_fma_mix_f32 v32, v66, v24, v28 op_sel:[0,0,0] op_sel_hi:[1,0,0]
    v_mfma_f32_16x16x32_bf16 v[148:151], a[236:239], v[52:55], v[148:151]
    ds_read_b64_tr_b16 a[194:195], v3 offset:768
    v_fma_mix_f32 v33, v66, v25, v29 op_sel:[1,0,0] op_sel_hi:[1,0,0]
    v_mfma_f32_16x16x32_bf16 v[180:183], a[232:235], v[56:59], v[180:183]
    ds_read_b64_tr_b16 a[196:197], v3 offset:17152
    v_fma_mix_f32 v34, v67, v26, v30 op_sel:[0,0,0] op_sel_hi:[1,0,0]
    v_mfma_f32_16x16x32_bf16 v[180:183], a[236:239], v[60:63], v[180:183]
    s_waitcnt lgkmcnt(9)
    ds_read_b64_tr_b16 a[198:199], v3 offset:17664
    v_fma_mix_f32 v35, v67, v27, v31 op_sel:[1,0,0] op_sel_hi:[1,0,0]
    v_mfma_f32_16x16x32_bf16 v[152:155], a[240:243], v[48:51], v[152:155]
    ds_read_b64_tr_b16 a[200:201], v3 offset:288
    v_cvt_pk_bf16_f32 v66, v32, v33
    v_mfma_f32_16x16x32_bf16 v[152:155], a[244:247], v[52:55], v[152:155]
    ds_read_b64_tr_b16 a[202:203], v3 offset:800
    v_cvt_pk_bf16_f32 v67, v34, v35
    v_mfma_f32_16x16x32_bf16 v[184:187], a[240:243], v[56:59], v[184:187]
    ds_read_b64_tr_b16 a[204:205], v3 offset:17184
    v_fma_mix_f32 v36, v74, v24, v28 op_sel:[0,0,0] op_sel_hi:[1,0,0]
    v_mfma_f32_16x16x32_bf16 v[184:187], a[244:247], v[60:63], v[184:187]
    s_waitcnt lgkmcnt(8)
    ds_read_b64_tr_b16 a[206:207], v3 offset:17696
    v_fma_mix_f32 v37, v74, v25, v29 op_sel:[1,0,0] op_sel_hi:[1,0,0]
    v_mfma_f32_16x16x32_bf16 v[156:159], a[248:251], v[48:51], v[156:159]
    ds_read_b64_tr_b16 a[208:209], v3 offset:320
    v_fma_mix_f32 v38, v75, v26, v30 op_sel:[0,0,0] op_sel_hi:[1,0,0]
    v_mfma_f32_16x16x32_bf16 v[156:159], a[252:255], v[52:55], v[156:159]
    ds_read_b64_tr_b16 a[210:211], v3 offset:832
    v_fma_mix_f32 v39, v75, v27, v31 op_sel:[1,0,0] op_sel_hi:[1,0,0]
    v_mfma_f32_16x16x32_bf16 v[188:191], a[248:251], v[56:59], v[188:191]
    ds_read_b64_tr_b16 a[212:213], v3 offset:17216
    v_cvt_pk_bf16_f32 v74, v36, v37
    v_mfma_f32_16x16x32_bf16 v[188:191], a[252:255], v[60:63], v[188:191]
    s_waitcnt lgkmcnt(7)
    ds_read_b64_tr_b16 a[214:215], v3 offset:17728
    v_cvt_pk_bf16_f32 v75, v38, v39
    v_mfma_f32_16x16x32_bf16 v[192:195], a[192:195], v[48:51], v[192:195]
    ds_read_b64_tr_b16 a[216:217], v3 offset:352
    ds_read_b128 v[24:27], v9 offset:11536
    v_mfma_f32_16x16x32_bf16 v[192:195], a[196:199], v[52:55], v[192:195]
    ds_read_b64_tr_b16 a[218:219], v3 offset:864
    ds_read_b64_tr_b16 a[220:221], v3 offset:17248
    v_fma_mix_f32 v32, v68, v16, v20 op_sel:[0,0,0] op_sel_hi:[1,0,0]
    v_mfma_f32_16x16x32_bf16 v[224:227], a[192:195], v[56:59], v[224:227]
    s_mov_b32 s54, 12288
    ds_read_b64_tr_b16 a[222:223], v3 offset:17760
    ds_read_b128 v[28:31], v9 offset:11568
    v_mfma_f32_16x16x32_bf16 v[224:227], a[196:199], v[60:63], v[224:227]
    s_waitcnt lgkmcnt(10)
    buffer_load_dwordx4 v[96:99], v8, s[32:35], s54 offen sc1
    v_mfma_f32_16x16x32_bf16 v[196:199], a[200:203], v[48:51], v[196:199]
    ds_read_b64_tr_b16 a[224:225], v3 offset:384
    v_fma_mix_f32 v33, v68, v17, v21 op_sel:[1,0,0] op_sel_hi:[1,0,0]
    v_mfma_f32_16x16x32_bf16 v[196:199], a[204:207], v[52:55], v[196:199]
    ds_read_b64_tr_b16 a[226:227], v3 offset:896
    ds_read_b64_tr_b16 a[228:229], v3 offset:17280
    v_fma_mix_f32 v34, v69, v18, v22 op_sel:[0,0,0] op_sel_hi:[1,0,0]
    v_mfma_f32_16x16x32_bf16 v[228:231], a[200:203], v[56:59], v[228:231]
    s_mov_b32 s54, 13312
    ds_read_b64_tr_b16 a[230:231], v3 offset:17792
    v_fma_mix_f32 v35, v69, v19, v23 op_sel:[1,0,0] op_sel_hi:[1,0,0]
    v_mfma_f32_16x16x32_bf16 v[228:231], a[204:207], v[60:63], v[228:231]
    s_waitcnt lgkmcnt(10)
    buffer_load_dwordx4 v[100:103], v8, s[32:35], s54 offen sc1
    v_mfma_f32_16x16x32_bf16 v[200:203], a[208:211], v[48:51], v[200:203]
    ds_read_b64_tr_b16 a[232:233], v3 offset:416
    v_cvt_pk_bf16_f32 v68, v32, v33
    v_mfma_f32_16x16x32_bf16 v[200:203], a[212:215], v[52:55], v[200:203]
    ds_read_b64_tr_b16 a[234:235], v3 offset:928
    ds_read_b64_tr_b16 a[236:237], v3 offset:17312
    v_cvt_pk_bf16_f32 v69, v34, v35
    v_mfma_f32_16x16x32_bf16 v[232:235], a[208:211], v[56:59], v[232:235]
    s_mov_b32 s54, 30720
    ds_read_b64_tr_b16 a[238:239], v3 offset:17824
    v_fma_mix_f32 v36, v76, v16, v20 op_sel:[0,0,0] op_sel_hi:[1,0,0]
    v_mfma_f32_16x16x32_bf16 v[232:235], a[212:215], v[60:63], v[232:235]
    s_waitcnt lgkmcnt(9)
    buffer_load_dwordx4 v[104:107], v8, s[32:35], s54 offen sc1
    v_fma_mix_f32 v37, v76, v17, v21 op_sel:[1,0,0] op_sel_hi:[1,0,0]
    v_mfma_f32_16x16x32_bf16 v[204:207], a[216:219], v[48:51], v[204:207]
    ds_read_b64_tr_b16 a[240:241], v3 offset:448
    v_fma_mix_f32 v38, v77, v18, v22 op_sel:[0,0,0] op_sel_hi:[1,0,0]
    v_mfma_f32_16x16x32_bf16 v[204:207], a[220:223], v[52:55], v[204:207]
    ds_read_b64_tr_b16 a[242:243], v3 offset:960
    ds_read_b64_tr_b16 a[244:245], v3 offset:17344
    v_fma_mix_f32 v39, v77, v19, v23 op_sel:[1,0,0] op_sel_hi:[1,0,0]
    v_mfma_f32_16x16x32_bf16 v[236:239], a[216:219], v[56:59], v[236:239]
    s_mov_b32 s54, 31744
    ds_read_b64_tr_b16 a[246:247], v3 offset:17856
    v_cvt_pk_bf16_f32 v76, v36, v37
    v_mfma_f32_16x16x32_bf16 v[236:239], a[220:223], v[60:63], v[236:239]
    s_waitcnt lgkmcnt(8)
    buffer_load_dwordx4 v[108:111], v8, s[32:35], s54 offen sc1
    v_cvt_pk_bf16_f32 v77, v38, v39
    v_mfma_f32_16x16x32_bf16 v[208:211], a[224:227], v[48:51], v[208:211]
    ds_read_b64_tr_b16 a[248:249], v3 offset:480
    ds_read_b128 v[16:19], v9 offset:11776
    v_mfma_f32_16x16x32_bf16 v[208:211], a[228:231], v[52:55], v[208:211]
    ds_read_b64_tr_b16 a[250:251], v3 offset:992
    ds_read_b128 v[20:23], v9 offset:11808
    v_mfma_f32_16x16x32_bf16 v[240:243], a[224:227], v[56:59], v[240:243]
    ds_read_b64_tr_b16 a[252:253], v3 offset:17376
    v_fma_mix_f32 v32, v70, v24, v28 op_sel:[0,0,0] op_sel_hi:[1,0,0]
    v_mfma_f32_16x16x32_bf16 v[240:243], a[228:231], v[60:63], v[240:243]
    s_waitcnt vmcnt(16)
    s_barrier
    s_waitcnt lgkmcnt(9)
    ds_read_b64_tr_b16 a[254:255], v3 offset:17888
    v_fma_mix_f32 v33, v70, v25, v29 op_sel:[1,0,0] op_sel_hi:[1,0,0]
    v_fma_mix_f32 v34, v71, v26, v30 op_sel:[0,0,0] op_sel_hi:[1,0,0]
    v_mfma_f32_16x16x32_bf16 v[212:215], a[232:235], v[48:51], v[212:215]
    ds_read_b64_tr_b16 a[192:193], v3 offset:36864
    v_fma_mix_f32 v35, v71, v27, v31 op_sel:[1,0,0] op_sel_hi:[1,0,0]
    v_mfma_f32_16x16x32_bf16 v[212:215], a[236:239], v[52:55], v[212:215]
    ds_read_b64_tr_b16 a[194:195], v3 offset:37376
    ds_read_b64_tr_b16 a[196:197], v3 offset:53760
    v_cvt_pk_bf16_f32 v70, v32, v33
    v_mfma_f32_16x16x32_bf16 v[244:247], a[232:235], v[56:59], v[244:247]
    s_add_u32 m0, s44, 110592
    ds_read_b64_tr_b16 a[198:199], v3 offset:54272
    v_cvt_pk_bf16_f32 v71, v34, v35
    v_mfma_f32_16x16x32_bf16 v[244:247], a[236:239], v[60:63], v[244:247]
    s_mov_b32 s45, 3145728
    s_waitcnt lgkmcnt(10)
    buffer_load_dwordx4 v6, s[24:27], s45 offen lds
    v_mfma_f32_16x16x32_bf16 v[216:219], a[240:243], v[48:51], v[216:219]
    ds_read_b64_tr_b16 a[200:201], v3 offset:36896
    v_fma_mix_f32 v36, v78, v24, v28 op_sel:[0,0,0] op_sel_hi:[1,0,0]
    v_mfma_f32_16x16x32_bf16 v[216:219], a[244:247], v[52:55], v[216:219]
    ds_read_b64_tr_b16 a[202:203], v3 offset:37408
    ds_read_b64_tr_b16 a[204:205], v3 offset:53792
    v_fma_mix_f32 v37, v78, v25, v29 op_sel:[1,0,0] op_sel_hi:[1,0,0]
    v_mfma_f32_16x16x32_bf16 v[248:251], a[240:243], v[56:59], v[248:251]
    s_add_u32 m0, s44, 111648
    ds_read_b64_tr_b16 a[206:207], v3 offset:54304
    v_fma_mix_f32 v38, v79, v26, v30 op_sel:[0,0,0] op_sel_hi:[1,0,0]
    v_mfma_f32_16x16x32_bf16 v[248:251], a[244:247], v[60:63], v[248:251]
    s_mov_b32 s45, 3153920
    s_waitcnt lgkmcnt(8)
    buffer_load_dwordx4 v6, s[24:27], s45 offen lds
    v_mfma_f32_16x16x32_bf16 v[220:223], a[248:251], v[48:51], v[220:223]
L2_pad1:
    s_cbranch_execz L2_pad5
    ds_read_b64_tr_b16 a[208:209], v3 offset:36928
    v_fma_mix_f32 v39, v79, v27, v31 op_sel:[1,0,0] op_sel_hi:[1,0,0]
    v_mfma_f32_16x16x32_bf16 v[220:223], a[252:255], v[52:55], v[220:223]
    ds_read_b64_tr_b16 a[210:211], v3 offset:37440
    ds_read_b64_tr_b16 a[212:213], v3 offset:53824
    v_cvt_pk_bf16_f32 v78, v36, v37
    v_mfma_f32_16x16x32_bf16 v[252:255], a[248:251], v[56:59], v[252:255]
    s_add_u32 m0, s44, 112704
    ds_read_b64_tr_b16 a[214:215], v3 offset:54336
    v_cvt_pk_bf16_f32 v79, v38, v39
    v_mfma_f32_16x16x32_bf16 v[252:255], a[252:255], v[60:63], v[252:255]
    s_mov_b32 s45, 3162112
    s_waitcnt lgkmcnt(8)
    buffer_load_dwordx4 v6, s[24:27], s45 offen lds
    v_mfma_f32_16x16x32_bf16 v[128:131], a[192:195], v[64:67], v[128:131]
    s_waitcnt vmcnt(15)
    ds_read_b64_tr_b16 a[216:217], v3 offset:36960
    ds_read_b128 v[24:27], v9 offset:11792
    v_mfma_f32_16x16x32_bf16 v[128:131], a[196:199], v[68:71], v[128:131]
    ds_read_b64_tr_b16 a[218:219], v3 offset:37472
    ds_read_b64_tr_b16 a[220:221], v3 offset:53856
    v_fma_mix_f32 v32, v80, v16, v20 op_sel:[0,0,0] op_sel_hi:[1,0,0]
    v_mfma_f32_16x16x32_bf16 v[160:163], a[192:195], v[72:75], v[160:163]
    s_add_u32 m0, s44, 113760
    ds_read_b64_tr_b16 a[222:223], v3 offset:54368
    ds_read_b128 v[28:31], v9 offset:11824
    v_mfma_f32_16x16x32_bf16 v[160:163], a[196:199], v[76:79], v[160:163]
    s_mov_b32 s45, 3170304
    s_waitcnt lgkmcnt(10)
    buffer_load_dwordx4 v6, s[24:27], s45 offen lds
    v_mfma_f32_16x16x32_bf16 v[132:135], a[200:203], v[64:67], v[132:135]
    ds_read_b64_tr_b16 a[224:225], v3 offset:36992
    v_fma_mix_f32 v33, v80, v17, v21 op_sel:[1,0,0] op_sel_hi:[1,0,0]
    v_mfma_f32_16x16x32_bf16 v[132:135], a[204:207], v[68:71], v[132:135]
    ds_read_b64_tr_b16 a[226:227], v3 offset:37504
    ds_read_b64_tr_b16 a[228:229], v3 offset:53888
    v_fma_mix_f32 v34, v81, v18, v22 op_sel:[0,0,0] op_sel_hi:[1,0,0]
    v_mfma_f32_16x16x32_bf16 v[164:167], a[200:203], v[72:75], v[164:167]
    s_add_u32 m0, s44, 127488
    ds_read_b64_tr_b16 a[230:231], v3 offset:54400
    v_fma_mix_f32 v35, v81, v19, v23 op_sel:[1,0,0] op_sel_hi:[1,0,0]
    v_mfma_f32_16x16x32_bf16 v[164:167], a[204:207], v[76:79], v[164:167]
    s_mov_b32 s45, 3407872
    s_waitcnt lgkmcnt(10)
    buffer_load_dwordx4 v6, s[24:27], s45 offen lds
    v_mfma_f32_16x16x32_bf16 v[136:139], a[208:211], v[64:67], v[136:139]
    ds_read_b64_tr_b16 a[232:233], v3 offset:37024
    v_cvt_pk_bf16_f32 v80, v32, v33
    v_mfma_f32_16x16x32_bf16 v[136:139], a[212:215], v[68:71], v[136:139]
    ds_read_b64_tr_b16 a[234:235], v3 offset:37536
    ds_read_b64_tr_b16 a[236:237], v3 offset:53920
    v_cvt_pk_bf16_f32 v81, v34, v35
    v_mfma_f32_16x16x32_bf16 v[168:171], a[208:211], v[72:75], v[168:171]
    s_add_u32 m0, s44, 128544
    ds_read_b64_tr_b16 a[238:239], v3 offset:54432
    v_fma_mix_f32 v36, v88, v16, v20 op_sel:[0,0,0] op_sel_hi:[1,0,0]
    v_mfma_f32_16x16x32_bf16 v[168:171], a[212:215], v[76:79], v[168:171]
    s_mov_b32 s45, 3416064
    s_waitcnt lgkmcnt(9)
    buffer_load_dwordx4 v6, s[24:27], s45 offen lds
    v_fma_mix_f32 v37, v88, v17, v21 op_sel:[1,0,0] op_sel_hi:[1,0,0]
    v_mfma_f32_16x16x32_bf16 v[140:143], a[216:219], v[64:67], v[140:143]
    ds_read_b64_tr_b16 a[240:241], v3 offset:37056
    v_fma_mix_f32 v38, v89, v18, v22 op_sel:[0,0,0] op_sel_hi:[1,0,0]
    v_mfma_f32_16x16x32_bf16 v[140:143], a[220:223], v[68:71], v[140:143]
    ds_read_b64_tr_b16 a[242:243], v3 offset:37568
    ds_read_b64_tr_b16 a[244:245], v3 offset:53952
    v_fma_mix_f32 v39, v89, v19, v23 op_sel:[1,0,0] op_sel_hi:[1,0,0]
    v_mfma_f32_16x16x32_bf16 v[172:175], a[216:219], v[72:75], v[172:175]
    s_add_u32 m0, s44, 129600
    ds_read_b64_tr_b16 a[246:247], v3 offset:54464
    v_cvt_pk_bf16_f32 v88, v36, v37
    v_mfma_f32_16x16x32_bf16 v[172:175], a[220:223], v[76:79], v[172:175]
    s_mov_b32 s45, 3424256
    s_waitcnt lgkmcnt(8)
    buffer_load_dwordx4 v6, s[24:27], s45 offen lds
    v_cvt_pk_bf16_f32 v89, v38, v39
    v_mfma_f32_16x16x32_bf16 v[144:147], a[224:227], v[64:67], v[144:147]
    ds_read_b64_tr_b16 a[248:249], v3 offset:37088
    ds_read_b128 v[16:19], v9 offset:12032
    v_mfma_f32_16x16x32_bf16 v[144:147], a[228:231], v[68:71], v[144:147]
    ds_read_b64_tr_b16 a[250:251], v3 offset:37600
    ds_read_b64_tr_b16 a[252:253], v3 offset:53984
    v_mfma_f32_16x16x32_bf16 v[176:179], a[224:227], v[72:75], v[176:179]
    s_add_u32 m0, s44, 130656
    ds_read_b64_tr_b16 a[254:255], v3 offset:54496
    ds_read_b128 v[20:23], v9 offset:12064
    v_mfma_f32_16x16x32_bf16 v[176:179], a[228:231], v[76:79], v[176:179]
    s_mov_b32 s45, 3432448
    s_waitcnt lgkmcnt(10)
    buffer_load_dwordx4 v6, s[24:27], s45 offen lds
    v_mfma_f32_16x16x32_bf16 v[148:151], a[232:235], v[64:67], v[148:151]
    ds_read_b64_tr_b16 a[192:193], v3 offset:37120
    v_fma_mix_f32 v32, v82, v24, v28 op_sel:[0,0,0] op_sel_hi:[1,0,0]
    v_mfma_f32_16x16x32_bf16 v[148:151], a[236:239], v[68:71], v[148:151]
    ds_read_b64_tr_b16 a[194:195], v3 offset:37632
    v_fma_mix_f32 v33, v82, v25, v29 op_sel:[1,0,0] op_sel_hi:[1,0,0]
    v_mfma_f32_16x16x32_bf16 v[180:183], a[232:235], v[72:75], v[180:183]
    ds_read_b64_tr_b16 a[196:197], v3 offset:54016
    v_fma_mix_f32 v34, v83, v26, v30 op_sel:[0,0,0] op_sel_hi:[1,0,0]
    v_mfma_f32_16x16x32_bf16 v[180:183], a[236:239], v[76:79], v[180:183]
    s_waitcnt lgkmcnt(9)
    ds_read_b64_tr_b16 a[198:199], v3 offset:54528
    v_fma_mix_f32 v35, v83, v27, v31 op_sel:[1,0,0] op_sel_hi:[1,0,0]
    v_mfma_f32_16x16x32_bf16 v[152:155], a[240:243], v[64:67], v[152:155]
    ds_read_b64_tr_b16 a[200:201], v3 offset:37152
    v_cvt_pk_bf16_f32 v82, v32, v33
    v_mfma_f32_16x16x32_bf16 v[152:155], a[244:247], v[68:71], v[152:155]
    ds_read_b64_tr_b16 a[202:203], v3 offset:37664
    v_cvt_pk_bf16_f32 v83, v34, v35
    v_mfma_f32_16x16x32_bf16 v[184:187], a[240:243], v[72:75], v[184:187]
    ds_read_b64_tr_b16 a[204:205], v3 offset:54048
    v_fma_mix_f32 v36, v90, v24, v28 op_sel:[0,0,0] op_sel_hi:[1,0,0]
    v_mfma_f32_16x16x32_bf16 v[184:187], a[244:247], v[76:79], v[184:187]
    s_waitcnt lgkmcnt(8)
    ds_read_b64_tr_b16 a[206:207], v3 offset:54560
    v_fma_mix_f32 v37, v90, v25, v29 op_sel:[1,0,0] op_sel_hi:[1,0,0]
    v_mfma_f32_16x16x32_bf16 v[156:159], a[248:251], v[64:67], v[156:159]
    ds_read_b64_tr_b16 a[208:209], v3 offset:37184
    v_fma_mix_f32 v38, v91, v26, v30 op_sel:[0,0,0] op_sel_hi:[1,0,0]
    v_mfma_f32_16x16x32_bf16 v[156:159], a[252:255], v[68:71], v[156:159]
    ds_read_b64_tr_b16 a[210:211], v3 offset:37696
    v_fma_mix_f32 v39, v91, v27, v31 op_sel:[1,0,0] op_sel_hi:[1,0,0]
    v_mfma_f32_16x16x32_bf16 v[188:191], a[248:251], v[72:75], v[188:191]
    ds_read_b64_tr_b16 a[212:213], v3 offset:54080
    v_cvt_pk_bf16_f32 v90, v36, v37
    v_mfma_f32_16x16x32_bf16 v[188:191], a[252:255], v[76:79], v[188:191]
    s_waitcnt lgkmcnt(7)
    ds_read_b64_tr_b16 a[214:215], v3 offset:54592
    v_cvt_pk_bf16_f32 v91, v38, v39
    v_mfma_f32_16x16x32_bf16 v[192:195], a[192:195], v[64:67], v[192:195]
    ds_read_b64_tr_b16 a[216:217], v3 offset:37216
    ds_read_b128 v[24:27], v9 offset:12048
    v_mfma_f32_16x16x32_bf16 v[192:195], a[196:199], v[68:71], v[192:195]
    ds_read_b64_tr_b16 a[218:219], v3 offset:37728
    ds_read_b64_tr_b16 a[220:221], v3 offset:54112
    v_fma_mix_f32 v32, v84, v16, v20 op_sel:[0,0,0] op_sel_hi:[1,0,0]
    v_mfma_f32_16x16x32_bf16 v[224:227], a[192:195], v[72:75], v[224:227]
    s_mov_b32 s54, 14336
    ds_read_b64_tr_b16 a[222:223], v3 offset:54624
    ds_read_b128 v[28:31], v9 offset:12080
    v_mfma_f32_16x16x32_bf16 v[224:227], a[196:199], v[76:79], v[224:227]
    s_waitcnt lgkmcnt(10)
    buffer_load_dwordx4 v[112:115], v8, s[32:35], s54 offen sc1
    v_mfma_f32_16x16x32_bf16 v[196:199], a[200:203], v[64:67], v[196:199]
    ds_read_b64_tr_b16 a[224:225], v3 offset:37248
    v_fma_mix_f32 v33, v84, v17, v21 op_sel:[1,0,0] op_sel_hi:[1,0,0]
    v_mfma_f32_16x16x32_bf16 v[196:199], a[204:207], v[68:71], v[196:199]
    ds_read_b64_tr_b16 a[226:227], v3 offset:37760
    ds_read_b64_tr_b16 a[228:229], v3 offset:54144
    v_fma_mix_f32 v34, v85, v18, v22 op_sel:[0,0,0] op_sel_hi:[1,0,0]
    v_mfma_f32_16x16x32_bf16 v[228:231], a[200:203], v[72:75], v[228:231]
    s_mov_b32 s54, 15360
    ds_read_b64_tr_b16 a[230:231], v3 offset:54656
    v_fma_mix_f32 v35, v85, v19, v23 op_sel:[1,0,0] op_sel_hi:[1,0,0]
    v_mfma_f32_16x16x32_bf16 v[228:231], a[204:207], v[76:79], v[228:231]
    s_waitcnt lgkmcnt(10)
    buffer_load_dwordx4 v[116:119], v8, s[32:35], s54 offen sc1
    v_mfma_f32_16x16x32_bf16 v[200:203], a[208:211], v[64:67], v[200:203]
    ds_read_b64_tr_b16 a[232:233], v3 offset:37280
    v_cvt_pk_bf16_f32 v84, v32, v33
    v_mfma_f32_16x16x32_bf16 v[200:203], a[212:215], v[68:71], v[200:203]
    ds_read_b64_tr_b16 a[234:235], v3 offset:37792
    ds_read_b64_tr_b16 a[236:237], v3 offset:54176
    v_cvt_pk_bf16_f32 v85, v34, v35
    v_mfma_f32_16x16x32_bf16 v[232:235], a[208:211], v[72:75], v[232:235]
    s_mov_b32 s54, 32768
    ds_read_b64_tr_b16 a[238:239], v3 offset:54688
    v_fma_mix_f32 v36, v92, v16, v20 op_sel:[0,0,0] op_sel_hi:[1,0,0]
    v_mfma_f32_16x16x32_bf16 v[232:235], a[212:215], v[76:79], v[232:235]
    s_waitcnt lgkmcnt(9)
    buffer_load_dwordx4 v[120:123], v8, s[32:35], s54 offen sc1
    v_fma_mix_f32 v37, v92, v17, v21 op_sel:[1,0,0] op_sel_hi:[1,0,0]
    v_mfma_f32_16x16x32_bf16 v[204:207], a[216:219], v[64:67], v[204:207]
    ds_read_b64_tr_b16 a[240:241], v3 offset:37312
    v_fma_mix_f32 v38, v93, v18, v22 op_sel:[0,0,0] op_sel_hi:[1,0,0]
    v_mfma_f32_16x16x32_bf16 v[204:207], a[220:223], v[68:71], v[204:207]
    ds_read_b64_tr_b16 a[242:243], v3 offset:37824
    ds_read_b64_tr_b16 a[244:245], v3 offset:54208
    v_fma_mix_f32 v39, v93, v19, v23 op_sel:[1,0,0] op_sel_hi:[1,0,0]
    v_mfma_f32_16x16x32_bf16 v[236:239], a[216:219], v[72:75], v[236:239]
    s_mov_b32 s54, 33792
    ds_read_b64_tr_b16 a[246:247], v3 offset:54720
    v_cvt_pk_bf16_f32 v92, v36, v37
    v_mfma_f32_16x16x32_bf16 v[236:239], a[220:223], v[76:79], v[236:239]
    s_waitcnt lgkmcnt(8)
    buffer_load_dwordx4 v[124:127], v8, s[32:35], s54 offen sc1
    v_cvt_pk_bf16_f32 v93, v38, v39
    v_mfma_f32_16x16x32_bf16 v[208:211], a[224:227], v[64:67], v[208:211]
    ds_read_b64_tr_b16 a[248:249], v3 offset:37344
    ds_read_b128 v[16:19], v9 offset:12288
    v_mfma_f32_16x16x32_bf16 v[208:211], a[228:231], v[68:71], v[208:211]
    ds_read_b64_tr_b16 a[250:251], v3 offset:37856
    ds_read_b128 v[20:23], v9 offset:12320
    v_mfma_f32_16x16x32_bf16 v[240:243], a[224:227], v[72:75], v[240:243]
    ds_read_b64_tr_b16 a[252:253], v3 offset:54240
    v_fma_mix_f32 v32, v86, v24, v28 op_sel:[0,0,0] op_sel_hi:[1,0,0]
    v_mfma_f32_16x16x32_bf16 v[240:243], a[228:231], v[76:79], v[240:243]
    s_waitcnt vmcnt(16)
    s_barrier
    s_waitcnt lgkmcnt(9)
    ds_read_b64_tr_b16 a[254:255], v3 offset:54752
    v_fma_mix_f32 v33, v86, v25, v29 op_sel:[1,0,0] op_sel_hi:[1,0,0]
    v_fma_mix_f32 v34, v87, v26, v30 op_sel:[0,0,0] op_sel_hi:[1,0,0]
    v_mfma_f32_16x16x32_bf16 v[212:215], a[232:235], v[64:67], v[212:215]
    ds_read_b64_tr_b16 a[192:193], v4 offset:0
    v_fma_mix_f32 v35, v87, v27, v31 op_sel:[1,0,0] op_sel_hi:[1,0,0]
    v_mfma_f32_16x16x32_bf16 v[212:215], a[236:239], v[68:71], v[212:215]
    ds_read_b64_tr_b16 a[194:195], v4 offset:512
    ds_read_b64_tr_b16 a[196:197], v4 offset:16896
    v_cvt_pk_bf16_f32 v86, v32, v33
    v_mfma_f32_16x16x32_bf16 v[244:247], a[232:235], v[72:75], v[244:247]
    s_add_u32 m0, s44, 0
    ds_read_b64_tr_b16 a[198:199], v4 offset:17408
    v_cvt_pk_bf16_f32 v87, v34, v35
    v_mfma_f32_16x16x32_bf16 v[244:247], a[236:239], v[76:79], v[244:247]
    s_mov_b32 s45, 3670016
    s_waitcnt lgkmcnt(10)
    buffer_load_dwordx4 v6, s[24:27], s45 offen lds
    v_mfma_f32_16x16x32_bf16 v[216:219], a[240:243], v[64:67], v[216:219]
    ds_read_b64_tr_b16 a[200:201], v4 offset:32
    v_fma_mix_f32 v36, v94, v24, v28 op_sel:[0,0,0] op_sel_hi:[1,0,0]
    v_mfma_f32_16x16x32_bf16 v[216:219], a[244:247], v[68:71], v[216:219]
    ds_read_b64_tr_b16 a[202:203], v4 offset:544
    ds_read_b64_tr_b16 a[204:205], v4 offset:16928
    v_fma_mix_f32 v37, v94, v25, v29 op_sel:[1,0,0] op_sel_hi:[1,0,0]
    v_mfma_f32_16x16x32_bf16 v[248:251], a[240:243], v[72:75], v[248:251]
    s_add_u32 m0, s44, 1056
    ds_read_b64_tr_b16 a[206:207], v4 offset:17440
    v_fma_mix_f32 v38, v95, v26, v30 op_sel:[0,0,0] op_sel_hi:[1,0,0]
    v_mfma_f32_16x16x32_bf16 v[248:251], a[244:247], v[76:79], v[248:251]
    s_mov_b32 s45, 3678208
    s_waitcnt lgkmcnt(8)
    buffer_load_dwordx4 v6, s[24:27], s45 offen lds
    v_mfma_f32_16x16x32_bf16 v[220:223], a[248:251], v[64:67], v[220:223]
    ds_read_b64_tr_b16 a[208:209], v4 offset:64
    v_fma_mix_f32 v39, v95, v27, v31 op_sel:[1,0,0] op_sel_hi:[1,0,0]
    v_mfma_f32_16x16x32_bf16 v[220:223], a[252:255], v[68:71], v[220:223]
    ds_read_b64_tr_b16 a[210:211], v4 offset:576
    ds_read_b64_tr_b16 a[212:213], v4 offset:16960
    v_cvt_pk_bf16_f32 v94, v36, v37
    v_mfma_f32_16x16x32_bf16 v[252:255], a[248:251], v[72:75], v[252:255]
    s_add_u32 m0, s44, 2112
    ds_read_b64_tr_b16 a[214:215], v4 offset:17472
    v_cvt_pk_bf16_f32 v95, v38, v39
    v_mfma_f32_16x16x32_bf16 v[252:255], a[252:255], v[76:79], v[252:255]
    s_mov_b32 s45, 3686400
    s_waitcnt lgkmcnt(8)
    buffer_load_dwordx4 v6, s[24:27], s45 offen lds
    v_mfma_f32_16x16x32_bf16 v[128:131], a[192:195], v[80:83], v[128:131]
    s_waitcnt vmcnt(15)
    ds_read_b64_tr_b16 a[216:217], v4 offset:96
    ds_read_b128 v[24:27], v9 offset:12304
    v_mfma_f32_16x16x32_bf16 v[128:131], a[196:199], v[84:87], v[128:131]
    ds_read_b64_tr_b16 a[218:219], v4 offset:608
    ds_read_b64_tr_b16 a[220:221], v4 offset:16992
    v_fma_mix_f32 v32, v96, v16, v20 op_sel:[0,0,0] op_sel_hi:[1,0,0]
    v_mfma_f32_16x16x32_bf16 v[160:163], a[192:195], v[88:91], v[160:163]
    s_add_u32 m0, s44, 3168
    ds_read_b64_tr_b16 a[222:223], v4 offset:17504
    ds_read_b128 v[28:31], v9 offset:12336
    v_mfma_f32_16x16x32_bf16 v[160:163], a[196:199], v[92:95], v[160:163]
    s_mov_b32 s45, 3694592
    s_waitcnt lgkmcnt(10)
    buffer_load_dwordx4 v6, s[24:27], s45 offen lds
    v_mfma_f32_16x16x32_bf16 v[132:135], a[200:203], v[80:83], v[132:135]
    ds_read_b64_tr_b16 a[224:225], v4 offset:128
    v_fma_mix_f32 v33, v96, v17, v21 op_sel:[1,0,0] op_sel_hi:[1,0,0]
    v_mfma_f32_16x16x32_bf16 v[132:135], a[204:207], v[84:87], v[132:135]
    ds_read_b64_tr_b16 a[226:227], v4 offset:640
    ds_read_b64_tr_b16 a[228:229], v4 offset:17024
    v_fma_mix_f32 v34, v97, v18, v22 op_sel:[0,0,0] op_sel_hi:[1,0,0]
    v_mfma_f32_16x16x32_bf16 v[164:167], a[200:203], v[88:91], v[164:167]
    s_add_u32 m0, s44, 16896
    ds_read_b64_tr_b16 a[230:231], v4 offset:17536
    v_fma_mix_f32 v35, v97, v19, v23 op_sel:[1,0,0] op_sel_hi:[1,0,0]
    v_mfma_f32_16x16x32_bf16 v[164:167], a[204:207], v[92:95], v[164:167]
    s_mov_b32 s45, 3932160
    s_waitcnt lgkmcnt(10)
    buffer_load_dwordx4 v6, s[24:27], s45 offen lds
    v_mfma_f32_16x16x32_bf16 v[136:139], a[208:211], v[80:83], v[136:139]
    ds_read_b64_tr_b16 a[232:233], v4 offset:160
    v_cvt_pk_bf16_f32 v96, v32, v33
    v_mfma_f32_16x16x32_bf16 v[136:139], a[212:215], v[84:87], v[136:139]
    ds_read_b64_tr_b16 a[234:235], v4 offset:672
    ds_read_b64_tr_b16 a[236:237], v4 offset:17056
    v_cvt_pk_bf16_f32 v97, v34, v35
    v_mfma_f32_16x16x32_bf16 v[168:171], a[208:211], v[88:91], v[168:171]
    s_add_u32 m0, s44, 17952
    ds_read_b64_tr_b16 a[238:239], v4 offset:17568
    v_fma_mix_f32 v36, v104, v16, v20 op_sel:[0,0,0] op_sel_hi:[1,0,0]
    v_mfma_f32_16x16x32_bf16 v[168:171], a[212:215], v[92:95], v[168:171]
    s_mov_b32 s45, 3940352
    s_waitcnt lgkmcnt(9)
    buffer_load_dwordx4 v6, s[24:27], s45 offen lds
    v_fma_mix_f32 v37, v104, v17, v21 op_sel:[1,0,0] op_sel_hi:[1,0,0]
    v_mfma_f32_16x16x32_bf16 v[140:143], a[216:219], v[80:83], v[140:143]
    ds_read_b64_tr_b16 a[240:241], v4 offset:192
    v_fma_mix_f32 v38, v105, v18, v22 op_sel:[0,0,0] op_sel_hi:[1,0,0]
    v_mfma_f32_16x16x32_bf16 v[140:143], a[220:223], v[84:87], v[140:143]
    ds_read_b64_tr_b16 a[242:243], v4 offset:704
    ds_read_b64_tr_b16 a[244:245], v4 offset:17088
    v_fma_mix_f32 v39, v105, v19, v23 op_sel:[1,0,0] op_sel_hi:[1,0,0]
    v_mfma_f32_16x16x32_bf16 v[172:175], a[216:219], v[88:91], v[172:175]
    s_add_u32 m0, s44, 19008
    ds_read_b64_tr_b16 a[246:247], v4 offset:17600
    v_cvt_pk_bf16_f32 v104, v36, v37
    v_mfma_f32_16x16x32_bf16 v[172:175], a[220:223], v[92:95], v[172:175]
    s_mov_b32 s45, 3948544
    s_waitcnt lgkmcnt(8)
    buffer_load_dwordx4 v6, s[24:27], s45 offen lds
    v_cvt_pk_bf16_f32 v105, v38, v39
    v_mfma_f32_16x16x32_bf16 v[144:147], a[224:227], v[80:83], v[144:147]
    ds_read_b64_tr_b16 a[248:249], v4 offset:224
    ds_read_b128 v[16:19], v9 offset:12544
    v_mfma_f32_16x16x32_bf16 v[144:147], a[228:231], v[84:87], v[144:147]
    ds_read_b64_tr_b16 a[250:251], v4 offset:736
    ds_read_b64_tr_b16 a[252:253], v4 offset:17120
    v_mfma_f32_16x16x32_bf16 v[176:179], a[224:227], v[88:91], v[176:179]
    s_add_u32 m0, s44, 20064
    ds_read_b64_tr_b16 a[254:255], v4 offset:17632
    ds_read_b128 v[20:23], v9 offset:12576
    v_mfma_f32_16x16x32_bf16 v[176:179], a[228:231], v[92:95], v[176:179]
    s_mov_b32 s45, 3956736
    s_waitcnt lgkmcnt(10)
    buffer_load_dwordx4 v6, s[24:27], s45 offen lds
    v_mfma_f32_16x16x32_bf16 v[148:151], a[232:235], v[80:83], v[148:151]
    ds_read_b64_tr_b16 a[192:193], v4 offset:256
    v_fma_mix_f32 v32, v98, v24, v28 op_sel:[0,0,0] op_sel_hi:[1,0,0]
    v_mfma_f32_16x16x32_bf16 v[148:151], a[236:239], v[84:87], v[148:151]
    ds_read_b64_tr_b16 a[194:195], v4 offset:768
    v_fma_mix_f32 v33, v98, v25, v29 op_sel:[1,0,0] op_sel_hi:[1,0,0]
    v_mfma_f32_16x16x32_bf16 v[180:183], a[232:235], v[88:91], v[180:183]
    ds_read_b64_tr_b16 a[196:197], v4 offset:17152
    v_fma_mix_f32 v34, v99, v26, v30 op_sel:[0,0,0] op_sel_hi:[1,0,0]
    v_mfma_f32_16x16x32_bf16 v[180:183], a[236:239], v[92:95], v[180:183]
    s_waitcnt lgkmcnt(9)
    ds_read_b64_tr_b16 a[198:199], v4 offset:17664
    v_fma_mix_f32 v35, v99, v27, v31 op_sel:[1,0,0] op_sel_hi:[1,0,0]
    v_mfma_f32_16x16x32_bf16 v[152:155], a[240:243], v[80:83], v[152:155]
    ds_read_b64_tr_b16 a[200:201], v4 offset:288
    v_cvt_pk_bf16_f32 v98, v32, v33
    v_mfma_f32_16x16x32_bf16 v[152:155], a[244:247], v[84:87], v[152:155]
    ds_read_b64_tr_b16 a[202:203], v4 offset:800
    v_cvt_pk_bf16_f32 v99, v34, v35
    v_mfma_f32_16x16x32_bf16 v[184:187], a[240:243], v[88:91], v[184:187]
    ds_read_b64_tr_b16 a[204:205], v4 offset:17184
    v_fma_mix_f32 v36, v106, v24, v28 op_sel:[0,0,0] op_sel_hi:[1,0,0]
    v_mfma_f32_16x16x32_bf16 v[184:187], a[244:247], v[92:95], v[184:187]
    s_waitcnt lgkmcnt(8)
    ds_read_b64_tr_b16 a[206:207], v4 offset:17696
    v_fma_mix_f32 v37, v106, v25, v29 op_sel:[1,0,0] op_sel_hi:[1,0,0]
    v_mfma_f32_16x16x32_bf16 v[156:159], a[248:251], v[80:83], v[156:159]
    ds_read_b64_tr_b16 a[208:209], v4 offset:320
    v_fma_mix_f32 v38, v107, v26, v30 op_sel:[0,0,0] op_sel_hi:[1,0,0]
    v_mfma_f32_16x16x32_bf16 v[156:159], a[252:255], v[84:87], v[156:159]
    ds_read_b64_tr_b16 a[210:211], v4 offset:832
    v_fma_mix_f32 v39, v107, v27, v31 op_sel:[1,0,0] op_sel_hi:[1,0,0]
    v_mfma_f32_16x16x32_bf16 v[188:191], a[248:251], v[88:91], v[188:191]
    ds_read_b64_tr_b16 a[212:213], v4 offset:17216
    v_cvt_pk_bf16_f32 v106, v36, v37
    v_mfma_f32_16x16x32_bf16 v[188:191], a[252:255], v[92:95], v[188:191]
    s_waitcnt lgkmcnt(7)
    ds_read_b64_tr_b16 a[214:215], v4 offset:17728
    v_cvt_pk_bf16_f32 v107, v38, v39
    v_mfma_f32_16x16x32_bf16 v[192:195], a[192:195], v[80:83], v[192:195]
    ds_read_b64_tr_b16 a[216:217], v4 offset:352
    ds_read_b128 v[24:27], v9 offset:12560
    v_mfma_f32_16x16x32_bf16 v[192:195], a[196:199], v[84:87], v[192:195]
    ds_read_b64_tr_b16 a[218:219], v4 offset:864
    ds_read_b64_tr_b16 a[220:221], v4 offset:17248
    v_fma_mix_f32 v32, v100, v16, v20 op_sel:[0,0,0] op_sel_hi:[1,0,0]
    v_mfma_f32_16x16x32_bf16 v[224:227], a[192:195], v[88:91], v[224:227]
    s_mov_b32 s54, 16384
    ds_read_b64_tr_b16 a[222:223], v4 offset:17760
    ds_read_b128 v[28:31], v9 offset:12592
    v_mfma_f32_16x16x32_bf16 v[224:227], a[196:199], v[92:95], v[224:227]
    s_waitcnt lgkmcnt(10)
    buffer_load_dwordx4 v[48:51], v8, s[32:35], s54 offen sc1
    v_mfma_f32_16x16x32_bf16 v[196:199], a[200:203], v[80:83], v[196:199]
    ds_read_b64_tr_b16 a[224:225], v4 offset:384
    v_fma_mix_f32 v33, v100, v17, v21 op_sel:[1,0,0] op_sel_hi:[1,0,0]
    v_mfma_f32_16x16x32_bf16 v[196:199], a[204:207], v[84:87], v[196:199]
    ds_read_b64_tr_b16 a[226:227], v4 offset:896
    ds_read_b64_tr_b16 a[228:229], v4 offset:17280
    v_fma_mix_f32 v34, v101, v18, v22 op_sel:[0,0,0] op_sel_hi:[1,0,0]
    v_mfma_f32_16x16x32_bf16 v[228:231], a[200:203], v[88:91], v[228:231]
    s_mov_b32 s54, 17408
    ds_read_b64_tr_b16 a[230:231], v4 offset:17792
    v_fma_mix_f32 v35, v101, v19, v23 op_sel:[1,0,0] op_sel_hi:[1,0,0]
    v_mfma_f32_16x16x32_bf16 v[228:231], a[204:207], v[92:95], v[228:231]
    s_waitcnt lgkmcnt(10)
    buffer_load_dwordx4 v[52:55], v8, s[32:35], s54 offen sc1
    v_mfma_f32_16x16x32_bf16 v[200:203], a[208:211], v[80:83], v[200:203]
    ds_read_b64_tr_b16 a[232:233], v4 offset:416
    v_cvt_pk_bf16_f32 v100, v32, v33
    v_mfma_f32_16x16x32_bf16 v[200:203], a[212:215], v[84:87], v[200:203]
    ds_read_b64_tr_b16 a[234:235], v4 offset:928
    ds_read_b64_tr_b16 a[236:237], v4 offset:17312
    v_cvt_pk_bf16_f32 v101, v34, v35
    v_mfma_f32_16x16x32_bf16 v[232:235], a[208:211], v[88:91], v[232:235]
    s_mov_b32 s54, 34816
    ds_read_b64_tr_b16 a[238:239], v4 offset:17824
    v_fma_mix_f32 v36, v108, v16, v20 op_sel:[0,0,0] op_sel_hi:[1,0,0]
    v_mfma_f32_16x16x32_bf16 v[232:235], a[212:215], v[92:95], v[232:235]
    s_waitcnt lgkmcnt(9)
    buffer_load_dwordx4 v[56:59], v8, s[32:35], s54 offen sc1
    v_fma_mix_f32 v37, v108, v17, v21 op_sel:[1,0,0] op_sel_hi:[1,0,0]
    v_mfma_f32_16x16x32_bf16 v[204:207], a[216:219], v[80:83], v[204:207]
    ds_read_b64_tr_b16 a[240:241], v4 offset:448
    v_fma_mix_f32 v38, v109, v18, v22 op_sel:[0,0,0] op_sel_hi:[1,0,0]
    v_mfma_f32_16x16x32_bf16 v[204:207], a[220:223], v[84:87], v[204:207]
    ds_read_b64_tr_b16 a[242:243], v4 offset:960
    ds_read_b64_tr_b16 a[244:245], v4 offset:17344
    v_fma_mix_f32 v39, v109, v19, v23 op_sel:[1,0,0] op_sel_hi:[1,0,0]
    v_mfma_f32_16x16x32_bf16 v[236:239], a[216:219], v[88:91], v[236:239]
    s_mov_b32 s54, 35840
    ds_read_b64_tr_b16 a[246:247], v4 offset:17856
    v_cvt_pk_bf16_f32 v108, v36, v37
    v_mfma_f32_16x16x32_bf16 v[236:239], a[220:223], v[92:95], v[236:239]
    s_waitcnt lgkmcnt(8)
    buffer_load_dwordx4 v[60:63], v8, s[32:35], s54 offen sc1
    v_cvt_pk_bf16_f32 v109, v38, v39
    v_mfma_f32_16x16x32_bf16 v[208:211], a[224:227], v[80:83], v[208:211]
    ds_read_b64_tr_b16 a[248:249], v4 offset:480
    ds_read_b128 v[16:19], v9 offset:12800
    v_mfma_f32_16x16x32_bf16 v[208:211], a[228:231], v[84:87], v[208:211]
    ds_read_b64_tr_b16 a[250:251], v4 offset:992
    ds_read_b128 v[20:23], v9 offset:12832
    v_mfma_f32_16x16x32_bf16 v[240:243], a[224:227], v[88:91], v[240:243]
    ds_read_b64_tr_b16 a[252:253], v4 offset:17376
    v_fma_mix_f32 v32, v102, v24, v28 op_sel:[0,0,0] op_sel_hi:[1,0,0]
    v_mfma_f32_16x16x32_bf16 v[240:243], a[228:231], v[92:95], v[240:243]
    s_waitcnt vmcnt(16)
    s_barrier
    s_waitcnt lgkmcnt(9)
    ds_read_b64_tr_b16 a[254:255], v4 offset:17888
    v_fma_mix_f32 v33, v102, v25, v29 op_sel:[1,0,0] op_sel_hi:[1,0,0]
    v_fma_mix_f32 v34, v103, v26, v30 op_sel:[0,0,0] op_sel_hi:[1,0,0]
    v_mfma_f32_16x16x32_bf16 v[212:215], a[232:235], v[80:83], v[212:215]
    ds_read_b64_tr_b16 a[192:193], v4 offset:36864
    v_fma_mix_f32 v35, v103, v27, v31 op_sel:[1,0,0] op_sel_hi:[1,0,0]
    v_mfma_f32_16x16x32_bf16 v[212:215], a[236:239], v[84:87], v[212:215]
    ds_read_b64_tr_b16 a[194:195], v4 offset:37376
    ds_read_b64_tr_b16 a[196:197], v4 offset:53760
    v_cvt_pk_bf16_f32 v102, v32, v33
    v_mfma_f32_16x16x32_bf16 v[244:247], a[232:235], v[88:91], v[244:247]
    s_add_u32 m0, s44, 36864
    ds_read_b64_tr_b16 a[198:199], v4 offset:54272
    v_cvt_pk_bf16_f32 v103, v34, v35
    v_mfma_f32_16x16x32_bf16 v[244:247], a[236:239], v[92:95], v[244:247]
    s_mov_b32 s45, 4194304
    s_waitcnt lgkmcnt(10)
    buffer_load_dwordx4 v6, s[24:27], s45 offen lds
    v_mfma_f32_16x16x32_bf16 v[216:219], a[240:243], v[80:83], v[216:219]
    ds_read_b64_tr_b16 a[200:201], v4 offset:36896
    v_fma_mix_f32 v36, v110, v24, v28 op_sel:[0,0,0] op_sel_hi:[1,0,0]
    v_mfma_f32_16x16x32_bf16 v[216:219], a[244:247], v[84:87], v[216:219]
    ds_read_b64_tr_b16 a[202:203], v4 offset:37408
    ds_read_b64_tr_b16 a[204:205], v4 offset:53792
    v_fma_mix_f32 v37, v110, v25, v29 op_sel:[1,0,0] op_sel_hi:[1,0,0]
    v_mfma_f32_16x16x32_bf16 v[248:251], a[240:243], v[88:91], v[248:251]
    s_add_u32 m0, s44, 37920
    ds_read_b64_tr_b16 a[206:207], v4 offset:54304
    v_fma_mix_f32 v38, v111, v26, v30 op_sel:[0,0,0] op_sel_hi:[1,0,0]
    v_mfma_f32_16x16x32_bf16 v[248:251], a[244:247], v[92:95], v[248:251]
    s_mov_b32 s45, 4202496
    s_waitcnt lgkmcnt(8)
    buffer_load_dwordx4 v6, s[24:27], s45 offen lds
    v_mfma_f32_16x16x32_bf16 v[220:223], a[248:251], v[80:83], v[220:223]
    ds_read_b64_tr_b16 a[208:209], v4 offset:36928
    v_fma_mix_f32 v39, v111, v27, v31 op_sel:[1,0,0] op_sel_hi:[1,0,0]
    v_mfma_f32_16x16x32_bf16 v[220:223], a[252:255], v[84:87], v[220:223]
    ds_read_b64_tr_b16 a[210:211], v4 offset:37440
    ds_read_b64_tr_b16 a[212:213], v4 offset:53824
    v_cvt_pk_bf16_f32 v110, v36, v37
    v_mfma_f32_16x16x32_bf16 v[252:255], a[248:251], v[88:91], v[252:255]
    s_add_u32 m0, s44, 38976
    ds_read_b64_tr_b16 a[214:215], v4 offset:54336
    v_cvt_pk_bf16_f32 v111, v38, v39
    v_mfma_f32_16x16x32_bf16 v[252:255], a[252:255], v[92:95], v[252:255]
    s_mov_b32 s45, 4210688
    s_waitcnt lgkmcnt(8)
    buffer_load_dwordx4 v6, s[24:27], s45 offen lds
    v_mfma_f32_16x16x32_bf16 v[128:131], a[192:195], v[96:99], v[128:131]
    s_waitcnt vmcnt(15)
    ds_read_b64_tr_b16 a[216:217], v4 offset:36960
    ds_read_b128 v[24:27], v9 offset:12816
    v_mfma_f32_16x16x32_bf16 v[128:131], a[196:199], v[100:103], v[128:131]
    ds_read_b64_tr_b16 a[218:219], v4 offset:37472
    ds_read_b64_tr_b16 a[220:221], v4 offset:53856
    v_fma_mix_f32 v32, v112, v16, v20 op_sel:[0,0,0] op_sel_hi:[1,0,0]
    v_mfma_f32_16x16x32_bf16 v[160:163], a[192:195], v[104:107], v[160:163]
    s_add_u32 m0, s44, 40032
    ds_read_b64_tr_b16 a[222:223], v4 offset:54368
    ds_read_b128 v[28:31], v9 offset:12848
    v_mfma_f32_16x16x32_bf16 v[160:163], a[196:199], v[108:111], v[160:163]
    s_mov_b32 s45, 4218880
    s_waitcnt lgkmcnt(10)
    buffer_load_dwordx4 v6, s[24:27], s45 offen lds
    v_mfma_f32_16x16x32_bf16 v[132:135], a[200:203], v[96:99], v[132:135]
    ds_read_b64_tr_b16 a[224:225], v4 offset:36992
    v_fma_mix_f32 v33, v112, v17, v21 op_sel:[1,0,0] op_sel_hi:[1,0,0]
    v_mfma_f32_16x16x32_bf16 v[132:135], a[204:207], v[100:103], v[132:135]
    ds_read_b64_tr_b16 a[226:227], v4 offset:37504
    ds_read_b64_tr_b16 a[228:229], v4 offset:53888
    v_fma_mix_f32 v34, v113, v18, v22 op_sel:[0,0,0] op_sel_hi:[1,0,0]
    v_mfma_f32_16x16x32_bf16 v[164:167], a[200:203], v[104:107], v[164:167]
    s_add_u32 m0, s44, 53760
    ds_read_b64_tr_b16 a[230:231], v4 offset:54400
    v_fma_mix_f32 v35, v113, v19, v23 op_sel:[1,0,0] op_sel_hi:[1,0,0]
    v_mfma_f32_16x16x32_bf16 v[164:167], a[204:207], v[108:111], v[164:167]
    s_mov_b32 s45, 4456448
    s_waitcnt lgkmcnt(10)
    buffer_load_dwordx4 v6, s[24:27], s45 offen lds
    v_mfma_f32_16x16x32_bf16 v[136:139], a[208:211], v[96:99], v[136:139]
    ds_read_b64_tr_b16 a[232:233], v4 offset:37024
    v_cvt_pk_bf16_f32 v112, v32, v33
    v_mfma_f32_16x16x32_bf16 v[136:139], a[212:215], v[100:103], v[136:139]
    ds_read_b64_tr_b16 a[234:235], v4 offset:37536
    ds_read_b64_tr_b16 a[236:237], v4 offset:53920
    v_cvt_pk_bf16_f32 v113, v34, v35
    v_mfma_f32_16x16x32_bf16 v[168:171], a[208:211], v[104:107], v[168:171]
    s_add_u32 m0, s44, 54816
    ds_read_b64_tr_b16 a[238:239], v4 offset:54432
    v_fma_mix_f32 v36, v120, v16, v20 op_sel:[0,0,0] op_sel_hi:[1,0,0]
    v_mfma_f32_16x16x32_bf16 v[168:171], a[212:215], v[108:111], v[168:171]
    s_mov_b32 s45, 4464640
    s_waitcnt lgkmcnt(9)
    buffer_load_dwordx4 v6, s[24:27], s45 offen lds
    v_fma_mix_f32 v37, v120, v17, v21 op_sel:[1,0,0] op_sel_hi:[1,0,0]
    v_mfma_f32_16x16x32_bf16 v[140:143], a[216:219], v[96:99], v[140:143]
L2_pad2:
    s_cbranch_execz L2_pad6
    ds_read_b64_tr_b16 a[240:241], v4 offset:37056
    v_fma_mix_f32 v38, v121, v18, v22 op_sel:[0,0,0] op_sel_hi:[1,0,0]
    v_mfma_f32_16x16x32_bf16 v[140:143], a[220:223], v[100:103], v[140:143]
    ds_read_b64_tr_b16 a[242:243], v4 offset:37568
    ds_read_b64_tr_b16 a[244:245], v4 offset:53952
    v_fma_mix_f32 v39, v121, v19, v23 op_sel:[1,0,0] op_sel_hi:[1,0,0]
    v_mfma_f32_16x16x32_bf16 v[172:175], a[216:219], v[104:107], v[172:175]
    s_add_u32 m0, s44, 55872
    ds_read_b64_tr_b16 a[246:247], v4 offset:54464
    v_cvt_pk_bf16_f32 v120, v36, v37
    v_mfma_f32_16x16x32_bf16 v[172:175], a[220:223], v[108:111], v[172:175]
    s_mov_b32 s45, 4472832
    s_waitcnt lgkmcnt(8)
    buffer_load_dwordx4 v6, s[24:27], s45 offen lds
    v_cvt_pk_bf16_f32 v121, v38, v39
    v_mfma_f32_16x16x32_bf16 v[144:147], a[224:227], v[96:99], v[144:147]
    ds_read_b64_tr_b16 a[248:249], v4 offset:37088
    ds_read_b128 v[16:19], v9 offset:13056
    v_mfma_f32_16x16x32_bf16 v[144:147], a[228:231], v[100:103], v[144:147]
    ds_read_b64_tr_b16 a[250:251], v4 offset:37600
    ds_read_b64_tr_b16 a[252:253], v4 offset:53984
    v_mfma_f32_16x16x32_bf16 v[176:179], a[224:227], v[104:107], v[176:179]
    s_add_u32 m0, s44, 56928
    ds_read_b64_tr_b16 a[254:255], v4 offset:54496
    ds_read_b128 v[20:23], v9 offset:13088
    v_mfma_f32_16x16x32_bf16 v[176:179], a[228:231], v[108:111], v[176:179]
    s_mov_b32 s45, 4481024
    s_waitcnt lgkmcnt(10)
    buffer_load_dwordx4 v6, s[24:27], s45 offen lds
    v_mfma_f32_16x16x32_bf16 v[148:151], a[232:235], v[96:99], v[148:151]
    ds_read_b64_tr_b16 a[192:193], v4 offset:37120
    v_fma_mix_f32 v32, v114, v24, v28 op_sel:[0,0,0] op_sel_hi:[1,0,0]
    v_mfma_f32_16x16x32_bf16 v[148:151], a[236:239], v[100:103], v[148:151]
    ds_read_b64_tr_b16 a[194:195], v4 offset:37632
    v_fma_mix_f32 v33, v114, v25, v29 op_sel:[1,0,0] op_sel_hi:[1,0,0]
    v_mfma_f32_16x16x32_bf16 v[180:183], a[232:235], v[104:107], v[180:183]
    ds_read_b64_tr_b16 a[196:197], v4 offset:54016
    v_fma_mix_f32 v34, v115, v26, v30 op_sel:[0,0,0] op_sel_hi:[1,0,0]
    v_mfma_f32_16x16x32_bf16 v[180:183], a[236:239], v[108:111], v[180:183]
    s_waitcnt lgkmcnt(9)
    ds_read_b64_tr_b16 a[198:199], v4 offset:54528
    v_fma_mix_f32 v35, v115, v27, v31 op_sel:[1,0,0] op_sel_hi:[1,0,0]
    v_mfma_f32_16x16x32_bf16 v[152:155], a[240:243], v[96:99], v[152:155]
    ds_read_b64_tr_b16 a[200:201], v4 offset:37152
    v_cvt_pk_bf16_f32 v114, v32, v33
    v_mfma_f32_16x16x32_bf16 v[152:155], a[244:247], v[100:103], v[152:155]
    ds_read_b64_tr_b16 a[202:203], v4 offset:37664
    v_cvt_pk_bf16_f32 v115, v34, v35
    v_mfma_f32_16x16x32_bf16 v[184:187], a[240:243], v[104:107], v[184:187]
    ds_read_b64_tr_b16 a[204:205], v4 offset:54048
    v_fma_mix_f32 v36, v122, v24, v28 op_sel:[0,0,0] op_sel_hi:[1,0,0]
    v_mfma_f32_16x16x32_bf16 v[184:187], a[244:247], v[108:111], v[184:187]
    s_waitcnt lgkmcnt(8)
    ds_read_b64_tr_b16 a[206:207], v4 offset:54560
    v_fma_mix_f32 v37, v122, v25, v29 op_sel:[1,0,0] op_sel_hi:[1,0,0]
    v_mfma_f32_16x16x32_bf16 v[156:159], a[248:251], v[96:99], v[156:159]
    ds_read_b64_tr_b16 a[208:209], v4 offset:37184
    v_fma_mix_f32 v38, v123, v26, v30 op_sel:[0,0,0] op_sel_hi:[1,0,0]
    v_mfma_f32_16x16x32_bf16 v[156:159], a[252:255], v[100:103], v[156:159]
    ds_read_b64_tr_b16 a[210:211], v4 offset:37696
    v_fma_mix_f32 v39, v123, v27, v31 op_sel:[1,0,0] op_sel_hi:[1,0,0]
    v_mfma_f32_16x16x32_bf16 v[188:191], a[248:251], v[104:107], v[188:191]
    ds_read_b64_tr_b16 a[212:213], v4 offset:54080
    v_cvt_pk_bf16_f32 v122, v36, v37
    v_mfma_f32_16x16x32_bf16 v[188:191], a[252:255], v[108:111], v[188:191]
    s_waitcnt lgkmcnt(7)
    ds_read_b64_tr_b16 a[214:215], v4 offset:54592
    v_cvt_pk_bf16_f32 v123, v38, v39
    v_mfma_f32_16x16x32_bf16 v[192:195], a[192:195], v[96:99], v[192:195]
    ds_read_b64_tr_b16 a[216:217], v4 offset:37216
    ds_read_b128 v[24:27], v9 offset:13072
    v_mfma_f32_16x16x32_bf16 v[192:195], a[196:199], v[100:103], v[192:195]
    ds_read_b64_tr_b16 a[218:219], v4 offset:37728
    ds_read_b128 v[28:31], v9 offset:13104
    v_mfma_f32_16x16x32_bf16 v[224:227], a[192:195], v[104:107], v[224:227]
    ds_read_b64_tr_b16 a[220:221], v4 offset:54112
    v_fma_mix_f32 v32, v116, v16, v20 op_sel:[0,0,0] op_sel_hi:[1,0,0]
    v_mfma_f32_16x16x32_bf16 v[224:227], a[196:199], v[108:111], v[224:227]
    s_waitcnt lgkmcnt(9)
    ds_read_b64_tr_b16 a[222:223], v4 offset:54624
    v_fma_mix_f32 v33, v116, v17, v21 op_sel:[1,0,0] op_sel_hi:[1,0,0]
    v_mfma_f32_16x16x32_bf16 v[196:199], a[200:203], v[96:99], v[196:199]
    ds_read_b64_tr_b16 a[224:225], v4 offset:37248
    v_fma_mix_f32 v34, v117, v18, v22 op_sel:[0,0,0] op_sel_hi:[1,0,0]
    v_mfma_f32_16x16x32_bf16 v[196:199], a[204:207], v[100:103], v[196:199]
    ds_read_b64_tr_b16 a[226:227], v4 offset:37760
    v_fma_mix_f32 v35, v117, v19, v23 op_sel:[1,0,0] op_sel_hi:[1,0,0]
    v_mfma_f32_16x16x32_bf16 v[228:231], a[200:203], v[104:107], v[228:231]
    ds_read_b64_tr_b16 a[228:229], v4 offset:54144
    v_cvt_pk_bf16_f32 v116, v32, v33
    v_mfma_f32_16x16x32_bf16 v[228:231], a[204:207], v[108:111], v[228:231]
    s_waitcnt lgkmcnt(9)
    ds_read_b64_tr_b16 a[230:231], v4 offset:54656
    v_cvt_pk_bf16_f32 v117, v34, v35
    v_mfma_f32_16x16x32_bf16 v[200:203], a[208:211], v[96:99], v[200:203]
    ds_read_b64_tr_b16 a[232:233], v4 offset:37280
    v_fma_mix_f32 v36, v124, v16, v20 op_sel:[0,0,0] op_sel_hi:[1,0,0]
    v_mfma_f32_16x16x32_bf16 v[200:203], a[212:215], v[100:103], v[200:203]
    ds_read_b64_tr_b16 a[234:235], v4 offset:37792
    v_fma_mix_f32 v37, v124, v17, v21 op_sel:[1,0,0] op_sel_hi:[1,0,0]
    v_mfma_f32_16x16x32_bf16 v[232:235], a[208:211], v[104:107], v[232:235]
    ds_read_b64_tr_b16 a[236:237], v4 offset:54176
    v_fma_mix_f32 v38, v125, v18, v22 op_sel:[0,0,0] op_sel_hi:[1,0,0]
    v_mfma_f32_16x16x32_bf16 v[232:235], a[212:215], v[108:111], v[232:235]
    s_waitcnt lgkmcnt(7)
    ds_read_b64_tr_b16 a[238:239], v4 offset:54688
    v_fma_mix_f32 v39, v125, v19, v23 op_sel:[1,0,0] op_sel_hi:[1,0,0]
    v_mfma_f32_16x16x32_bf16 v[204:207], a[216:219], v[96:99], v[204:207]
    ds_read_b64_tr_b16 a[240:241], v4 offset:37312
    v_cvt_pk_bf16_f32 v124, v36, v37
    v_mfma_f32_16x16x32_bf16 v[204:207], a[220:223], v[100:103], v[204:207]
    ds_read_b64_tr_b16 a[242:243], v4 offset:37824
    v_cvt_pk_bf16_f32 v125, v38, v39
    v_mfma_f32_16x16x32_bf16 v[236:239], a[216:219], v[104:107], v[236:239]
    ds_read_b64_tr_b16 a[244:245], v4 offset:54208
    v_mfma_f32_16x16x32_bf16 v[236:239], a[220:223], v[108:111], v[236:239]
    s_waitcnt lgkmcnt(7)
    ds_read_b64_tr_b16 a[246:247], v4 offset:54720
    v_mfma_f32_16x16x32_bf16 v[208:211], a[224:227], v[96:99], v[208:211]
    ds_read_b64_tr_b16 a[248:249], v4 offset:37344
    ds_read_b128 v[16:19], v9 offset:13312
    v_mfma_f32_16x16x32_bf16 v[208:211], a[228:231], v[100:103], v[208:211]
    ds_read_b64_tr_b16 a[250:251], v4 offset:37856
    ds_read_b128 v[20:23], v9 offset:13344
    v_mfma_f32_16x16x32_bf16 v[240:243], a[224:227], v[104:107], v[240:243]
    ds_read_b64_tr_b16 a[252:253], v4 offset:54240
    v_fma_mix_f32 v32, v118, v24, v28 op_sel:[0,0,0] op_sel_hi:[1,0,0]
    v_mfma_f32_16x16x32_bf16 v[240:243], a[228:231], v[108:111], v[240:243]
    s_waitcnt vmcnt(12)
    s_barrier
    s_waitcnt lgkmcnt(9)
    ds_read_b64_tr_b16 a[254:255], v4 offset:54752
    v_fma_mix_f32 v33, v118, v25, v29 op_sel:[1,0,0] op_sel_hi:[1,0,0]
    v_fma_mix_f32 v34, v119, v26, v30 op_sel:[0,0,0] op_sel_hi:[1,0,0]
    v_mfma_f32_16x16x32_bf16 v[212:215], a[232:235], v[96:99], v[212:215]
    ds_read_b64_tr_b16 a[192:193], v3 offset:0
    v_fma_mix_f32 v35, v119, v27, v31 op_sel:[1,0,0] op_sel_hi:[1,0,0]
    v_mfma_f32_16x16x32_bf16 v[212:215], a[236:239], v[100:103], v[212:215]
    ds_read_b64_tr_b16 a[194:195], v3 offset:512
    ds_read_b64_tr_b16 a[196:197], v3 offset:16896
    v_cvt_pk_bf16_f32 v118, v32, v33
    v_mfma_f32_16x16x32_bf16 v[244:247], a[232:235], v[104:107], v[244:247]
    s_add_u32 m0, s44, 73728
    ds_read_b64_tr_b16 a[198:199], v3 offset:17408
    v_cvt_pk_bf16_f32 v119, v34, v35
    v_mfma_f32_16x16x32_bf16 v[244:247], a[236:239], v[108:111], v[244:247]
    s_mov_b32 s46, 0
    s_waitcnt lgkmcnt(10)
    buffer_load_dwordx4 off, s[16:19], s46 offset:0 lds
    v_mfma_f32_16x16x32_bf16 v[216:219], a[240:243], v[96:99], v[216:219]
    ds_read_b64_tr_b16 a[200:201], v3 offset:32
    v_fma_mix_f32 v36, v126, v24, v28 op_sel:[0,0,0] op_sel_hi:[1,0,0]
    v_mfma_f32_16x16x32_bf16 v[216:219], a[244:247], v[100:103], v[216:219]
    ds_read_b64_tr_b16 a[202:203], v3 offset:544
    ds_read_b64_tr_b16 a[204:205], v3 offset:16928
    v_fma_mix_f32 v37, v126, v25, v29 op_sel:[1,0,0] op_sel_hi:[1,0,0]
    v_mfma_f32_16x16x32_bf16 v[248:251], a[240:243], v[104:107], v[248:251]
    s_add_u32 m0, s44, 73760
    ds_read_b64_tr_b16 a[206:207], v3 offset:17440
    v_fma_mix_f32 v38, v127, v26, v30 op_sel:[0,0,0] op_sel_hi:[1,0,0]
    v_mfma_f32_16x16x32_bf16 v[248:251], a[244:247], v[108:111], v[248:251]
    s_waitcnt lgkmcnt(8)
    buffer_load_dwordx4 off, s[16:19], s46 offset:1024 lds
    v_mfma_f32_16x16x32_bf16 v[220:223], a[248:251], v[96:99], v[220:223]
    ds_read_b64_tr_b16 a[208:209], v3 offset:64
    v_fma_mix_f32 v39, v127, v27, v31 op_sel:[1,0,0] op_sel_hi:[1,0,0]
    v_mfma_f32_16x16x32_bf16 v[220:223], a[252:255], v[100:103], v[220:223]
    ds_read_b64_tr_b16 a[210:211], v3 offset:576
    ds_read_b64_tr_b16 a[212:213], v3 offset:16960
    v_cvt_pk_bf16_f32 v126, v36, v37
    v_mfma_f32_16x16x32_bf16 v[252:255], a[248:251], v[104:107], v[252:255]
    s_add_u32 m0, s44, 73792
    ds_read_b64_tr_b16 a[214:215], v3 offset:17472
    v_cvt_pk_bf16_f32 v127, v38, v39
    v_mfma_f32_16x16x32_bf16 v[252:255], a[252:255], v[108:111], v[252:255]
    s_waitcnt lgkmcnt(8)
    buffer_load_dwordx4 off, s[16:19], s46 offset:2048 lds
    v_mfma_f32_16x16x32_bf16 v[128:131], a[192:195], v[112:115], v[128:131]
    s_waitcnt vmcnt(11)
    ds_read_b64_tr_b16 a[216:217], v3 offset:96
    ds_read_b128 v[24:27], v9 offset:13328
    v_mfma_f32_16x16x32_bf16 v[128:131], a[196:199], v[116:119], v[128:131]
    ds_read_b64_tr_b16 a[218:219], v3 offset:608
    ds_read_b64_tr_b16 a[220:221], v3 offset:16992
    v_fma_mix_f32 v32, v48, v16, v20 op_sel:[0,0,0] op_sel_hi:[1,0,0]
    v_mfma_f32_16x16x32_bf16 v[160:163], a[192:195], v[120:123], v[160:163]
    s_add_u32 m0, s44, 73824
    ds_read_b64_tr_b16 a[222:223], v3 offset:17504
    ds_read_b128 v[28:31], v9 offset:13360
    v_mfma_f32_16x16x32_bf16 v[160:163], a[196:199], v[124:127], v[160:163]
    s_waitcnt lgkmcnt(10)
    buffer_load_dwordx4 off, s[16:19], s46 offset:3072 lds
    v_mfma_f32_16x16x32_bf16 v[132:135], a[200:203], v[112:115], v[132:135]
    ds_read_b64_tr_b16 a[224:225], v3 offset:128
    v_fma_mix_f32 v33, v48, v17, v21 op_sel:[1,0,0] op_sel_hi:[1,0,0]
    v_mfma_f32_16x16x32_bf16 v[132:135], a[204:207], v[116:119], v[132:135]
    ds_read_b64_tr_b16 a[226:227], v3 offset:640
    ds_read_b64_tr_b16 a[228:229], v3 offset:17024
    v_fma_mix_f32 v34, v49, v18, v22 op_sel:[0,0,0] op_sel_hi:[1,0,0]
    v_mfma_f32_16x16x32_bf16 v[164:167], a[200:203], v[120:123], v[164:167]
    s_add_u32 m0, s44, 90624
    ds_read_b64_tr_b16 a[230:231], v3 offset:17536
    v_fma_mix_f32 v35, v49, v19, v23 op_sel:[1,0,0] op_sel_hi:[1,0,0]
    v_mfma_f32_16x16x32_bf16 v[164:167], a[204:207], v[124:127], v[164:167]
    s_waitcnt lgkmcnt(10)
    buffer_load_dwordx4 off, s[20:23], s46 offset:0 lds
    v_mfma_f32_16x16x32_bf16 v[136:139], a[208:211], v[112:115], v[136:139]
    ds_read_b64_tr_b16 a[232:233], v3 offset:160
    v_cvt_pk_bf16_f32 v48, v32, v33
    v_mfma_f32_16x16x32_bf16 v[136:139], a[212:215], v[116:119], v[136:139]
    ds_read_b64_tr_b16 a[234:235], v3 offset:672
    ds_read_b64_tr_b16 a[236:237], v3 offset:17056
    v_cvt_pk_bf16_f32 v49, v34, v35
    v_mfma_f32_16x16x32_bf16 v[168:171], a[208:211], v[120:123], v[168:171]
    s_add_u32 m0, s44, 90656
    ds_read_b64_tr_b16 a[238:239], v3 offset:17568
    v_fma_mix_f32 v36, v56, v16, v20 op_sel:[0,0,0] op_sel_hi:[1,0,0]
    v_mfma_f32_16x16x32_bf16 v[168:171], a[212:215], v[124:127], v[168:171]
    s_waitcnt lgkmcnt(9)
    buffer_load_dwordx4 off, s[20:23], s46 offset:1024 lds
    v_fma_mix_f32 v37, v56, v17, v21 op_sel:[1,0,0] op_sel_hi:[1,0,0]
    v_mfma_f32_16x16x32_bf16 v[140:143], a[216:219], v[112:115], v[140:143]
    ds_read_b64_tr_b16 a[240:241], v3 offset:192
    v_fma_mix_f32 v38, v57, v18, v22 op_sel:[0,0,0] op_sel_hi:[1,0,0]
    v_mfma_f32_16x16x32_bf16 v[140:143], a[220:223], v[116:119], v[140:143]
    ds_read_b64_tr_b16 a[242:243], v3 offset:704
    ds_read_b64_tr_b16 a[244:245], v3 offset:17088
    v_fma_mix_f32 v39, v57, v19, v23 op_sel:[1,0,0] op_sel_hi:[1,0,0]
    v_mfma_f32_16x16x32_bf16 v[172:175], a[216:219], v[120:123], v[172:175]
    s_add_u32 m0, s44, 90688
    ds_read_b64_tr_b16 a[246:247], v3 offset:17600
    v_cvt_pk_bf16_f32 v56, v36, v37
    v_mfma_f32_16x16x32_bf16 v[172:175], a[220:223], v[124:127], v[172:175]
    s_waitcnt lgkmcnt(8)
    buffer_load_dwordx4 off, s[20:23], s46 offset:2048 lds
    v_cvt_pk_bf16_f32 v57, v38, v39
    v_mfma_f32_16x16x32_bf16 v[144:147], a[224:227], v[112:115], v[144:147]
    ds_read_b64_tr_b16 a[248:249], v3 offset:224
    ds_read_b128 v[16:19], v9 offset:13568
    v_mfma_f32_16x16x32_bf16 v[144:147], a[228:231], v[116:119], v[144:147]
    ds_read_b64_tr_b16 a[250:251], v3 offset:736
    ds_read_b64_tr_b16 a[252:253], v3 offset:17120
    v_mfma_f32_16x16x32_bf16 v[176:179], a[224:227], v[120:123], v[176:179]
    s_add_u32 m0, s44, 90720
    ds_read_b64_tr_b16 a[254:255], v3 offset:17632
    ds_read_b128 v[20:23], v9 offset:13600
    v_mfma_f32_16x16x32_bf16 v[176:179], a[228:231], v[124:127], v[176:179]
    s_waitcnt lgkmcnt(10)
    buffer_load_dwordx4 off, s[20:23], s46 offset:3072 lds
    v_mfma_f32_16x16x32_bf16 v[148:151], a[232:235], v[112:115], v[148:151]
    ds_read_b64_tr_b16 a[192:193], v3 offset:256
    v_fma_mix_f32 v32, v50, v24, v28 op_sel:[0,0,0] op_sel_hi:[1,0,0]
    v_mfma_f32_16x16x32_bf16 v[148:151], a[236:239], v[116:119], v[148:151]
    ds_read_b64_tr_b16 a[194:195], v3 offset:768
    v_fma_mix_f32 v33, v50, v25, v29 op_sel:[1,0,0] op_sel_hi:[1,0,0]
    v_mfma_f32_16x16x32_bf16 v[180:183], a[232:235], v[120:123], v[180:183]
    ds_read_b64_tr_b16 a[196:197], v3 offset:17152
    v_fma_mix_f32 v34, v51, v26, v30 op_sel:[0,0,0] op_sel_hi:[1,0,0]
    v_mfma_f32_16x16x32_bf16 v[180:183], a[236:239], v[124:127], v[180:183]
    s_waitcnt lgkmcnt(9)
    ds_read_b64_tr_b16 a[198:199], v3 offset:17664
    v_fma_mix_f32 v35, v51, v27, v31 op_sel:[1,0,0] op_sel_hi:[1,0,0]
    v_mfma_f32_16x16x32_bf16 v[152:155], a[240:243], v[112:115], v[152:155]
    ds_read_b64_tr_b16 a[200:201], v3 offset:288
    v_cvt_pk_bf16_f32 v50, v32, v33
    v_mfma_f32_16x16x32_bf16 v[152:155], a[244:247], v[116:119], v[152:155]
    ds_read_b64_tr_b16 a[202:203], v3 offset:800
    v_cvt_pk_bf16_f32 v51, v34, v35
    v_mfma_f32_16x16x32_bf16 v[184:187], a[240:243], v[120:123], v[184:187]
    ds_read_b64_tr_b16 a[204:205], v3 offset:17184
    v_fma_mix_f32 v36, v58, v24, v28 op_sel:[0,0,0] op_sel_hi:[1,0,0]
    v_mfma_f32_16x16x32_bf16 v[184:187], a[244:247], v[124:127], v[184:187]
    s_waitcnt lgkmcnt(8)
    ds_read_b64_tr_b16 a[206:207], v3 offset:17696
    v_fma_mix_f32 v37, v58, v25, v29 op_sel:[1,0,0] op_sel_hi:[1,0,0]
    v_mfma_f32_16x16x32_bf16 v[156:159], a[248:251], v[112:115], v[156:159]
    ds_read_b64_tr_b16 a[208:209], v3 offset:320
    v_fma_mix_f32 v38, v59, v26, v30 op_sel:[0,0,0] op_sel_hi:[1,0,0]
    v_mfma_f32_16x16x32_bf16 v[156:159], a[252:255], v[116:119], v[156:159]
    ds_read_b64_tr_b16 a[210:211], v3 offset:832
    v_fma_mix_f32 v39, v59, v27, v31 op_sel:[1,0,0] op_sel_hi:[1,0,0]
    v_mfma_f32_16x16x32_bf16 v[188:191], a[248:251], v[120:123], v[188:191]
    ds_read_b64_tr_b16 a[212:213], v3 offset:17216
    v_cvt_pk_bf16_f32 v58, v36, v37
    v_mfma_f32_16x16x32_bf16 v[188:191], a[252:255], v[124:127], v[188:191]
    s_waitcnt lgkmcnt(7)
    ds_read_b64_tr_b16 a[214:215], v3 offset:17728
    v_cvt_pk_bf16_f32 v59, v38, v39
    v_mfma_f32_16x16x32_bf16 v[192:195], a[192:195], v[112:115], v[192:195]
    ds_read_b64_tr_b16 a[216:217], v3 offset:352
    ds_read_b128 v[24:27], v9 offset:13584
    v_mfma_f32_16x16x32_bf16 v[192:195], a[196:199], v[116:119], v[192:195]
    ds_read_b64_tr_b16 a[218:219], v3 offset:864
    ds_read_b128 v[28:31], v9 offset:13616
    v_mfma_f32_16x16x32_bf16 v[224:227], a[192:195], v[120:123], v[224:227]
    ds_read_b64_tr_b16 a[220:221], v3 offset:17248
    v_fma_mix_f32 v32, v52, v16, v20 op_sel:[0,0,0] op_sel_hi:[1,0,0]
    v_mfma_f32_16x16x32_bf16 v[224:227], a[196:199], v[124:127], v[224:227]
    s_waitcnt lgkmcnt(9)
    ds_read_b64_tr_b16 a[222:223], v3 offset:17760
    v_fma_mix_f32 v33, v52, v17, v21 op_sel:[1,0,0] op_sel_hi:[1,0,0]
    v_mfma_f32_16x16x32_bf16 v[196:199], a[200:203], v[112:115], v[196:199]
    ds_read_b64_tr_b16 a[224:225], v3 offset:384
    v_fma_mix_f32 v34, v53, v18, v22 op_sel:[0,0,0] op_sel_hi:[1,0,0]
    v_mfma_f32_16x16x32_bf16 v[196:199], a[204:207], v[116:119], v[196:199]
    ds_read_b64_tr_b16 a[226:227], v3 offset:896
    v_fma_mix_f32 v35, v53, v19, v23 op_sel:[1,0,0] op_sel_hi:[1,0,0]
    v_mfma_f32_16x16x32_bf16 v[228:231], a[200:203], v[120:123], v[228:231]
    ds_read_b64_tr_b16 a[228:229], v3 offset:17280
    v_cvt_pk_bf16_f32 v52, v32, v33
    v_mfma_f32_16x16x32_bf16 v[228:231], a[204:207], v[124:127], v[228:231]
    s_waitcnt lgkmcnt(9)
    ds_read_b64_tr_b16 a[230:231], v3 offset:17792
    v_cvt_pk_bf16_f32 v53, v34, v35
    v_mfma_f32_16x16x32_bf16 v[200:203], a[208:211], v[112:115], v[200:203]
    ds_read_b64_tr_b16 a[232:233], v3 offset:416
    v_fma_mix_f32 v36, v60, v16, v20 op_sel:[0,0,0] op_sel_hi:[1,0,0]
    v_mfma_f32_16x16x32_bf16 v[200:203], a[212:215], v[116:119], v[200:203]
    ds_read_b64_tr_b16 a[234:235], v3 offset:928
    v_fma_mix_f32 v37, v60, v17, v21 op_sel:[1,0,0] op_sel_hi:[1,0,0]
    v_mfma_f32_16x16x32_bf16 v[232:235], a[208:211], v[120:123], v[232:235]
    ds_read_b64_tr_b16 a[236:237], v3 offset:17312
    v_fma_mix_f32 v38, v61, v18, v22 op_sel:[0,0,0] op_sel_hi:[1,0,0]
    v_mfma_f32_16x16x32_bf16 v[232:235], a[212:215], v[124:127], v[232:235]
    s_waitcnt lgkmcnt(7)
    ds_read_b64_tr_b16 a[238:239], v3 offset:17824
    v_fma_mix_f32 v39, v61, v19, v23 op_sel:[1,0,0] op_sel_hi:[1,0,0]
    v_mfma_f32_16x16x32_bf16 v[204:207], a[216:219], v[112:115], v[204:207]
    ds_read_b64_tr_b16 a[240:241], v3 offset:448
    v_cvt_pk_bf16_f32 v60, v36, v37
    v_mfma_f32_16x16x32_bf16 v[204:207], a[220:223], v[116:119], v[204:207]
    ds_read_b64_tr_b16 a[242:243], v3 offset:960
    v_cvt_pk_bf16_f32 v61, v38, v39
    v_mfma_f32_16x16x32_bf16 v[236:239], a[216:219], v[120:123], v[236:239]
    ds_read_b64_tr_b16 a[244:245], v3 offset:17344
    v_mfma_f32_16x16x32_bf16 v[236:239], a[220:223], v[124:127], v[236:239]
    s_waitcnt lgkmcnt(7)
    ds_read_b64_tr_b16 a[246:247], v3 offset:17856
    v_mfma_f32_16x16x32_bf16 v[208:211], a[224:227], v[112:115], v[208:211]
    ds_read_b64_tr_b16 a[248:249], v3 offset:480
    v_fma_mix_f32 v32, v54, v24, v28 op_sel:[0,0,0] op_sel_hi:[1,0,0]
    v_mfma_f32_16x16x32_bf16 v[208:211], a[228:231], v[116:119], v[208:211]
    ds_read_b64_tr_b16 a[250:251], v3 offset:992
    v_fma_mix_f32 v33, v54, v25, v29 op_sel:[1,0,0] op_sel_hi:[1,0,0]
    v_mfma_f32_16x16x32_bf16 v[240:243], a[224:227], v[120:123], v[240:243]
    ds_read_b64_tr_b16 a[252:253], v3 offset:17376
    v_fma_mix_f32 v34, v55, v26, v30 op_sel:[0,0,0] op_sel_hi:[1,0,0]
    v_mfma_f32_16x16x32_bf16 v[240:243], a[228:231], v[124:127], v[240:243]
    s_waitcnt vmcnt(8)
    s_barrier
    s_waitcnt lgkmcnt(7)
    ds_read_b64_tr_b16 a[254:255], v3 offset:17888
    v_fma_mix_f32 v35, v55, v27, v31 op_sel:[1,0,0] op_sel_hi:[1,0,0]
    v_mfma_f32_16x16x32_bf16 v[212:215], a[232:235], v[112:115], v[212:215]
    ds_read_b64_tr_b16 a[192:193], v3 offset:36864
    v_cvt_pk_bf16_f32 v54, v32, v33
    v_mfma_f32_16x16x32_bf16 v[212:215], a[236:239], v[116:119], v[212:215]
    ds_read_b64_tr_b16 a[194:195], v3 offset:37376
    ds_read_b64_tr_b16 a[196:197], v3 offset:53760
    v_mfma_f32_16x16x32_bf16 v[244:247], a[232:235], v[120:123], v[244:247]
    s_add_u32 m0, s44, 110592
    ds_read_b64_tr_b16 a[198:199], v3 offset:54272
    v_cvt_pk_bf16_f32 v55, v34, v35
    v_mfma_f32_16x16x32_bf16 v[244:247], a[236:239], v[124:127], v[244:247]
    s_mov_b32 s46, 16384
    s_waitcnt lgkmcnt(8)
    buffer_load_dwordx4 off, s[16:19], s46 offset:0 lds
    v_mfma_f32_16x16x32_bf16 v[216:219], a[240:243], v[112:115], v[216:219]
    ds_read_b64_tr_b16 a[200:201], v3 offset:36896
    v_fma_mix_f32 v36, v62, v24, v28 op_sel:[0,0,0] op_sel_hi:[1,0,0]
    v_mfma_f32_16x16x32_bf16 v[216:219], a[244:247], v[116:119], v[216:219]
    ds_read_b64_tr_b16 a[202:203], v3 offset:37408
    ds_read_b64_tr_b16 a[204:205], v3 offset:53792
    v_fma_mix_f32 v37, v62, v25, v29 op_sel:[1,0,0] op_sel_hi:[1,0,0]
    v_mfma_f32_16x16x32_bf16 v[248:251], a[240:243], v[120:123], v[248:251]
    s_add_u32 m0, s44, 110624
    ds_read_b64_tr_b16 a[206:207], v3 offset:54304
    v_fma_mix_f32 v38, v63, v26, v30 op_sel:[0,0,0] op_sel_hi:[1,0,0]
    v_mfma_f32_16x16x32_bf16 v[248:251], a[244:247], v[124:127], v[248:251]
    s_waitcnt lgkmcnt(8)
    buffer_load_dwordx4 off, s[16:19], s46 offset:1024 lds
    v_mfma_f32_16x16x32_bf16 v[220:223], a[248:251], v[112:115], v[220:223]
    ds_read_b64_tr_b16 a[208:209], v3 offset:36928
    v_fma_mix_f32 v39, v63, v27, v31 op_sel:[1,0,0] op_sel_hi:[1,0,0]
    v_mfma_f32_16x16x32_bf16 v[220:223], a[252:255], v[116:119], v[220:223]
    ds_read_b64_tr_b16 a[210:211], v3 offset:37440
    ds_read_b64_tr_b16 a[212:213], v3 offset:53824
    v_cvt_pk_bf16_f32 v62, v36, v37
    v_mfma_f32_16x16x32_bf16 v[252:255], a[248:251], v[120:123], v[252:255]
    s_add_u32 m0, s44, 110656
    ds_read_b64_tr_b16 a[214:215], v3 offset:54336
    v_cvt_pk_bf16_f32 v63, v38, v39
    v_mfma_f32_16x16x32_bf16 v[252:255], a[252:255], v[124:127], v[252:255]
    s_waitcnt lgkmcnt(8)
    buffer_load_dwordx4 off, s[16:19], s46 offset:2048 lds
    v_mfma_f32_16x16x32_bf16 v[128:131], a[192:195], v[48:51], v[128:131]
    ds_read_b64_tr_b16 a[216:217], v3 offset:36960
    v_lshrrev_b32 v14, 2, v0
    v_mfma_f32_16x16x32_bf16 v[128:131], a[196:199], v[52:55], v[128:131]
    s_mul_i32 s3, s51, 144
    ds_read_b64_tr_b16 a[218:219], v3 offset:37472
    ds_read_b64_tr_b16 a[220:221], v3 offset:53856
    v_mfma_f32_16x16x32_bf16 v[160:163], a[192:195], v[56:59], v[160:163]
    s_add_u32 m0, s44, 110688
    ds_read_b64_tr_b16 a[222:223], v3 offset:54368
    v_add_u32 v14, s3, v14
    v_mfma_f32_16x16x32_bf16 v[160:163], a[196:199], v[60:63], v[160:163]
    s_waitcnt lgkmcnt(8)
    buffer_load_dwordx4 off, s[16:19], s46 offset:3072 lds
    v_mfma_f32_16x16x32_bf16 v[132:135], a[200:203], v[48:51], v[132:135]
    ds_read_b64_tr_b16 a[224:225], v3 offset:36992
    v_mul_u32_u24 v14, 9216, v14
    v_mfma_f32_16x16x32_bf16 v[132:135], a[204:207], v[52:55], v[132:135]
    ds_read_b64_tr_b16 a[226:227], v3 offset:37504
    ds_read_b64_tr_b16 a[228:229], v3 offset:53888
    v_mfma_f32_16x16x32_bf16 v[164:167], a[200:203], v[56:59], v[164:167]
    s_add_u32 m0, s44, 127488
    ds_read_b64_tr_b16 a[230:231], v3 offset:54400
    v_and_b32 v15, 3, v0
    v_mfma_f32_16x16x32_bf16 v[164:167], a[204:207], v[60:63], v[164:167]
    s_waitcnt lgkmcnt(8)
    buffer_load_dwordx4 off, s[20:23], s46 offset:0 lds
    v_mfma_f32_16x16x32_bf16 v[136:139], a[208:211], v[48:51], v[136:139]
    ds_read_b64_tr_b16 a[232:233], v3 offset:37024
    v_lshl_add_u32 v6, v15, 4, v14
    v_mfma_f32_16x16x32_bf16 v[136:139], a[212:215], v[52:55], v[136:139]
    s_lshr_b32 s3, s2, 3
    s_lshl2_add_u32 s3, s3, s51
    s_and_b32 s15, s2, 7
    ds_read_b64_tr_b16 a[234:235], v3 offset:37536
    ds_read_b64_tr_b16 a[236:237], v3 offset:53920
    v_mfma_f32_16x16x32_bf16 v[168:171], a[208:211], v[56:59], v[168:171]
    s_add_u32 m0, s44, 127520
    ds_read_b64_tr_b16 a[238:239], v3 offset:54432
    v_lshlrev_b32 v9, 7, v0
    v_mfma_f32_16x16x32_bf16 v[168:171], a[212:215], v[60:63], v[168:171]
    s_waitcnt lgkmcnt(8)
    s_mul_i32 s14, s3, 9
    s_lshr_b32 s14, s14, 1
    buffer_load_dwordx4 off, s[20:23], s46 offset:1024 lds
    v_mfma_f32_16x16x32_bf16 v[140:143], a[216:219], v[48:51], v[140:143]
    ds_read_b64_tr_b16 a[240:241], v3 offset:37056
    v_min_u32 v15, 44, v0
    v_mfma_f32_16x16x32_bf16 v[140:143], a[220:223], v[52:55], v[140:143]
    ds_read_b64_tr_b16 a[242:243], v3 offset:37568
    ds_read_b64_tr_b16 a[244:245], v3 offset:53952
    v_mfma_f32_16x16x32_bf16 v[172:175], a[216:219], v[56:59], v[172:175]
    s_add_u32 m0, s44, 127552
    ds_read_b64_tr_b16 a[246:247], v3 offset:54464
    v_mul_u32_u24 v12, 7282, v15
    v_mfma_f32_16x16x32_bf16 v[172:175], a[220:223], v[60:63], v[172:175]
    s_waitcnt lgkmcnt(8)
    buffer_load_dwordx4 off, s[20:23], s46 offset:2048 lds
    v_mfma_f32_16x16x32_bf16 v[144:147], a[224:227], v[48:51], v[144:147]
    ds_read_b64_tr_b16 a[248:249], v3 offset:37088
    v_lshrrev_b32 v12, 16, v12
    v_mfma_f32_16x16x32_bf16 v[144:147], a[228:231], v[52:55], v[144:147]
    ds_read_b64_tr_b16 a[250:251], v3 offset:37600
    ds_read_b64_tr_b16 a[252:253], v3 offset:53984
    v_mfma_f32_16x16x32_bf16 v[176:179], a[224:227], v[56:59], v[176:179]
    s_add_u32 m0, s44, 127584
    ds_read_b64_tr_b16 a[254:255], v3 offset:54496
    v_mul_u32_u24 v13, 63, v12
    v_mfma_f32_16x16x32_bf16 v[176:179], a[228:231], v[60:63], v[176:179]
    s_waitcnt lgkmcnt(8)
    buffer_load_dwordx4 off, s[20:23], s46 offset:3072 lds
    v_mfma_f32_16x16x32_bf16 v[148:151], a[232:235], v[48:51], v[148:151]
    ds_read_b64_tr_b16 a[192:193], v3 offset:37120
    v_add_u32 v12, v15, v13
    v_mfma_f32_16x16x32_bf16 v[148:151], a[236:239], v[52:55], v[148:151]
    s_mul_i32 s14, s14, 72
    s_mul_i32 s56, s15, 9
    s_add_u32 s14, s14, s56
    ds_read_b64_tr_b16 a[194:195], v3 offset:37632
    v_add_lshl_u32 v12, s14, v12, 7
    v_mfma_f32_16x16x32_bf16 v[180:183], a[232:235], v[56:59], v[180:183]
    s_mul_i32 s14, s3, 81
    s_lshr_b32 s14, s14, 1
    s_mul_i32 s56, s15, 5184
    s_add_u32 s14, s14, s56
    ds_read_b64_tr_b16 a[196:197], v3 offset:54016
    v_min_u32 v13, 40, v0
    v_mfma_f32_16x16x32_bf16 v[180:183], a[236:239], v[60:63], v[180:183]
    s_waitcnt lgkmcnt(7)
    ds_read_b64_tr_b16 a[198:199], v3 offset:54528
    v_add_lshl_u32 v13, s14, v13, 7
    v_mfma_f32_16x16x32_bf16 v[152:155], a[240:243], v[48:51], v[152:155]
    s_mul_i32 s14, s3, 72
    s_andn2_b32 s56, s52, 3
    s_mul_i32 s56, s56, 2304
    s_add_u32 s14, s14, s56
    ds_read_b64_tr_b16 a[200:201], v3 offset:37152
    v_min_u32 v14, 35, v0
    v_mfma_f32_16x16x32_bf16 v[152:155], a[244:247], v[52:55], v[152:155]
    ds_read_b64_tr_b16 a[202:203], v3 offset:37664
    v_add_lshl_u32 v14, s14, v14, 7
    v_mfma_f32_16x16x32_bf16 v[184:187], a[240:243], v[56:59], v[184:187]
    ds_read_b64_tr_b16 a[204:205], v3 offset:54048
    v_add_u32 v15, 4608, v14
    v_mfma_f32_16x16x32_bf16 v[184:187], a[244:247], v[60:63], v[184:187]
    s_waitcnt lgkmcnt(7)
    ds_read_b64_tr_b16 a[206:207], v3 offset:54560
    v_cvt_pk_bf16_f32 v64, v128, v129
    v_mfma_f32_16x16x32_bf16 v[156:159], a[248:251], v[48:51], v[156:159]
    ds_read_b64_tr_b16 a[208:209], v3 offset:37184
    v_cvt_pk_bf16_f32 v65, v130, v131
    v_mfma_f32_16x16x32_bf16 v[156:159], a[252:255], v[52:55], v[156:159]
    ds_read_b64_tr_b16 a[210:211], v3 offset:37696
    v_cvt_pk_bf16_f32 v66, v132, v133
    v_mfma_f32_16x16x32_bf16 v[188:191], a[248:251], v[56:59], v[188:191]
    ds_read_b64_tr_b16 a[212:213], v3 offset:54080
    v_cvt_pk_bf16_f32 v67, v134, v135
    v_mfma_f32_16x16x32_bf16 v[188:191], a[252:255], v[60:63], v[188:191]
    s_waitcnt lgkmcnt(7)
    ds_read_b64_tr_b16 a[214:215], v3 offset:54592
    v_cvt_pk_bf16_f32 v80, v160, v161
    v_mfma_f32_16x16x32_bf16 v[192:195], a[192:195], v[48:51], v[192:195]
    ds_read_b64_tr_b16 a[216:217], v3 offset:37216
    v_cvt_pk_bf16_f32 v81, v162, v163
    v_mfma_f32_16x16x32_bf16 v[192:195], a[196:199], v[52:55], v[192:195]
    ds_read_b64_tr_b16 a[218:219], v3 offset:37728
    v_cvt_pk_bf16_f32 v82, v164, v165
    v_mfma_f32_16x16x32_bf16 v[224:227], a[192:195], v[56:59], v[224:227]
    ds_read_b64_tr_b16 a[220:221], v3 offset:54112
    v_cvt_pk_bf16_f32 v83, v166, v167
    v_mfma_f32_16x16x32_bf16 v[224:227], a[196:199], v[60:63], v[224:227]
    s_waitcnt lgkmcnt(7)
    ds_read_b64_tr_b16 a[222:223], v3 offset:54624
    v_cvt_pk_bf16_f32 v68, v136, v137
    v_mfma_f32_16x16x32_bf16 v[196:199], a[200:203], v[48:51], v[196:199]
    ds_read_b64_tr_b16 a[224:225], v3 offset:37248
    v_cvt_pk_bf16_f32 v69, v138, v139
    v_mfma_f32_16x16x32_bf16 v[196:199], a[204:207], v[52:55], v[196:199]
    ds_read_b64_tr_b16 a[226:227], v3 offset:37760
    v_cvt_pk_bf16_f32 v70, v140, v141
    v_mfma_f32_16x16x32_bf16 v[228:231], a[200:203], v[56:59], v[228:231]
    ds_read_b64_tr_b16 a[228:229], v3 offset:54144
    v_cvt_pk_bf16_f32 v71, v142, v143
    v_mfma_f32_16x16x32_bf16 v[228:231], a[204:207], v[60:63], v[228:231]
    s_waitcnt vmcnt(8)
    s_barrier
    s_waitcnt lgkmcnt(7)
    ds_read_b64_tr_b16 a[230:231], v3 offset:54656
    v_cvt_pk_bf16_f32 v84, v168, v169
    v_mfma_f32_16x16x32_bf16 v[200:203], a[208:211], v[48:51], v[200:203]
L2_pad3:
    s_cbranch_execz L2_pad7
    ds_read_b64_tr_b16 a[232:233], v3 offset:37280
    v_cvt_pk_bf16_f32 v85, v170, v171
    v_mfma_f32_16x16x32_bf16 v[200:203], a[212:215], v[52:55], v[200:203]
    ds_read_b64_tr_b16 a[234:235], v3 offset:37792
    ds_read_b64_tr_b16 a[236:237], v3 offset:54176
    v_mfma_f32_16x16x32_bf16 v[232:235], a[208:211], v[56:59], v[232:235]
    s_add_u32 m0, s44, 0
    ds_read_b64_tr_b16 a[238:239], v3 offset:54688
    v_cvt_pk_bf16_f32 v86, v172, v173
    v_mfma_f32_16x16x32_bf16 v[232:235], a[212:215], v[60:63], v[232:235]
    s_mov_b32 s46, 32768
    s_waitcnt lgkmcnt(8)
    buffer_load_dwordx4 off, s[16:19], s46 offset:0 lds
    v_mfma_f32_16x16x32_bf16 v[204:207], a[216:219], v[48:51], v[204:207]
    ds_read_b64_tr_b16 a[240:241], v3 offset:37312
    v_cvt_pk_bf16_f32 v87, v174, v175
    v_mfma_f32_16x16x32_bf16 v[204:207], a[220:223], v[52:55], v[204:207]
    ds_read_b64_tr_b16 a[242:243], v3 offset:37824
    ds_read_b64_tr_b16 a[244:245], v3 offset:54208
    v_mfma_f32_16x16x32_bf16 v[236:239], a[216:219], v[56:59], v[236:239]
    s_add_u32 m0, s44, 32
    ds_read_b64_tr_b16 a[246:247], v3 offset:54720
    v_cvt_pk_bf16_f32 v72, v144, v145
    v_mfma_f32_16x16x32_bf16 v[236:239], a[220:223], v[60:63], v[236:239]
    s_waitcnt lgkmcnt(8)
    buffer_load_dwordx4 off, s[16:19], s46 offset:1024 lds
    v_mfma_f32_16x16x32_bf16 v[208:211], a[224:227], v[48:51], v[208:211]
    ds_read_b64_tr_b16 a[248:249], v3 offset:37344
    v_cvt_pk_bf16_f32 v73, v146, v147
    v_mfma_f32_16x16x32_bf16 v[208:211], a[228:231], v[52:55], v[208:211]
    ds_read_b64_tr_b16 a[250:251], v3 offset:37856
    ds_read_b64_tr_b16 a[252:253], v3 offset:54240
    v_mfma_f32_16x16x32_bf16 v[240:243], a[224:227], v[56:59], v[240:243]
    s_add_u32 m0, s44, 64
    ds_read_b64_tr_b16 a[254:255], v3 offset:54752
    v_cvt_pk_bf16_f32 v74, v148, v149
    v_mfma_f32_16x16x32_bf16 v[240:243], a[228:231], v[60:63], v[240:243]
    s_waitcnt lgkmcnt(8)
    buffer_load_dwordx4 off, s[16:19], s46 offset:2048 lds
    v_mfma_f32_16x16x32_bf16 v[212:215], a[232:235], v[48:51], v[212:215]
    ds_read_b128 a[64:67], v1 offset:0
    ds_read_b128 a[68:71], v1 offset:64
    v_mfma_f32_16x16x32_bf16 v[212:215], a[236:239], v[52:55], v[212:215]
    ds_read_b128 a[72:75], v1 offset:128
    ds_read_b128 a[76:79], v1 offset:192
    v_mfma_f32_16x16x32_bf16 v[244:247], a[232:235], v[56:59], v[244:247]
    s_add_u32 m0, s44, 96
    ds_read_b128 a[80:83], v1 offset:256
    ds_read_b128 a[84:87], v1 offset:320
    v_mfma_f32_16x16x32_bf16 v[244:247], a[236:239], v[60:63], v[244:247]
    s_waitcnt lgkmcnt(10)
    buffer_load_dwordx4 off, s[16:19], s46 offset:3072 lds
    v_mfma_f32_16x16x32_bf16 v[216:219], a[240:243], v[48:51], v[216:219]
    ds_read_b128 a[88:91], v1 offset:384
    ds_read_b128 a[92:95], v1 offset:448
    v_mfma_f32_16x16x32_bf16 v[216:219], a[244:247], v[52:55], v[216:219]
    ds_read_b128 a[96:99], v1 offset:512
    ds_read_b128 a[100:103], v1 offset:576
    v_mfma_f32_16x16x32_bf16 v[248:251], a[240:243], v[56:59], v[248:251]
    s_add_u32 m0, s44, 16896
    ds_read_b128 a[104:107], v1 offset:640
    ds_read_b128 a[108:111], v1 offset:704
    v_mfma_f32_16x16x32_bf16 v[248:251], a[244:247], v[60:63], v[248:251]
    s_waitcnt lgkmcnt(12)
    buffer_load_dwordx4 off, s[20:23], s46 offset:0 lds
    v_mfma_f32_16x16x32_bf16 v[220:223], a[248:251], v[48:51], v[220:223]
    ds_read_b128 a[112:115], v1 offset:768
    ds_read_b128 a[116:119], v1 offset:832
    v_mfma_f32_16x16x32_bf16 v[220:223], a[252:255], v[52:55], v[220:223]
    ds_read_b128 a[120:123], v1 offset:896
    ds_read_b128 a[124:127], v1 offset:960
    v_mfma_f32_16x16x32_bf16 v[252:255], a[248:251], v[56:59], v[252:255]
    s_add_u32 m0, s44, 16928
    v_cvt_pk_bf16_f32 v75, v150, v151
    v_cvt_pk_bf16_f32 v88, v176, v177
    v_mfma_f32_16x16x32_bf16 v[252:255], a[252:255], v[60:63], v[252:255]
    buffer_load_dwordx4 off, s[20:23], s46 offset:1024 lds
    s_mul_i32 s3, s96, 9216
    s_add_u32 s3, s3, 4194304
    s_add_u32 s32, s84, s3
    s_addc_u32 s33, s85, 0
    s_mov_b32 s34, 9216
    s_mov_b32 s35, 0x20000
    s_add_u32 m0, s44, 16960
    s_nop 0
    buffer_load_dwordx4 off, s[20:23], s46 offset:2048 lds
    s_add_u32 m0, s44, 16992
    s_nop 0
    buffer_load_dwordx4 off, s[20:23], s46 offset:3072 lds
    v_cvt_pk_bf16_f32 v89, v178, v179
    v_cvt_pk_bf16_f32 v90, v180, v181
    v_cvt_pk_bf16_f32 v91, v182, v183
    v_cvt_pk_bf16_f32 v76, v152, v153
    v_cvt_pk_bf16_f32 v77, v154, v155
    v_cvt_pk_bf16_f32 v78, v156, v157
    v_cvt_pk_bf16_f32 v79, v158, v159
    v_cvt_pk_bf16_f32 v92, v184, v185
    v_cvt_pk_bf16_f32 v93, v186, v187
    v_cvt_pk_bf16_f32 v94, v188, v189
    v_cvt_pk_bf16_f32 v95, v190, v191
    v_permlane32_swap_b32 v64, v66
    v_permlane32_swap_b32 v65, v67
    v_permlane32_swap_b32 v80, v82
    v_permlane32_swap_b32 v81, v83
    v_permlane32_swap_b32 v68, v70
    v_permlane32_swap_b32 v69, v71
    v_permlane32_swap_b32 v84, v86
    v_permlane32_swap_b32 v85, v87
    v_permlane32_swap_b32 v72, v74
    v_permlane32_swap_b32 v73, v75
    v_permlane32_swap_b32 v88, v90
    v_permlane32_swap_b32 v89, v91
    v_permlane32_swap_b32 v76, v78
    v_permlane32_swap_b32 v77, v79
    v_permlane32_swap_b32 v92, v94
    v_permlane32_swap_b32 v93, v95
    v_cvt_pk_bf16_f32 v96, v192, v193
    v_cvt_pk_bf16_f32 v97, v194, v195
    v_cvt_pk_bf16_f32 v98, v196, v197
    v_cvt_pk_bf16_f32 v99, v198, v199
    v_cvt_pk_bf16_f32 v112, v224, v225
    v_cvt_pk_bf16_f32 v113, v226, v227
    v_cvt_pk_bf16_f32 v114, v228, v229
    v_cvt_pk_bf16_f32 v115, v230, v231
    v_cvt_pk_bf16_f32 v100, v200, v201
    v_cvt_pk_bf16_f32 v101, v202, v203
    v_cvt_pk_bf16_f32 v102, v204, v205
    v_cvt_pk_bf16_f32 v103, v206, v207
    v_cvt_pk_bf16_f32 v116, v232, v233
    v_cvt_pk_bf16_f32 v117, v234, v235
    v_cvt_pk_bf16_f32 v118, v236, v237
    v_cvt_pk_bf16_f32 v119, v238, v239
    v_cvt_pk_bf16_f32 v104, v208, v209
    v_cvt_pk_bf16_f32 v105, v210, v211
    v_cvt_pk_bf16_f32 v106, v212, v213
    v_cvt_pk_bf16_f32 v107, v214, v215
    v_cvt_pk_bf16_f32 v120, v240, v241
    v_cvt_pk_bf16_f32 v121, v242, v243
    v_cvt_pk_bf16_f32 v122, v244, v245
    v_cvt_pk_bf16_f32 v123, v246, v247
    v_cvt_pk_bf16_f32 v108, v216, v217
    v_cvt_pk_bf16_f32 v109, v218, v219
    v_cvt_pk_bf16_f32 v110, v220, v221
    v_cvt_pk_bf16_f32 v111, v222, v223
    v_cvt_pk_bf16_f32 v124, v248, v249
    v_cvt_pk_bf16_f32 v125, v250, v251
    v_cvt_pk_bf16_f32 v126, v252, v253
    v_cvt_pk_bf16_f32 v127, v254, v255
    s_nop 0
    v_permlane32_swap_b32 v96, v98
    v_permlane32_swap_b32 v97, v99
    v_permlane32_swap_b32 v112, v114
    v_permlane32_swap_b32 v113, v115
    v_permlane32_swap_b32 v100, v102
    v_permlane32_swap_b32 v101, v103
    v_permlane32_swap_b32 v116, v118
    v_permlane32_swap_b32 v117, v119
    v_permlane32_swap_b32 v104, v106
    v_permlane32_swap_b32 v105, v107
    v_permlane32_swap_b32 v120, v122
    v_permlane32_swap_b32 v121, v123
    v_permlane32_swap_b32 v108, v110
    v_permlane32_swap_b32 v109, v111
    v_permlane32_swap_b32 v124, v126
    v_permlane32_swap_b32 v125, v127
    s_waitcnt lgkmcnt(12)
    v_mfma_f32_16x16x32_bf16 v[16:19], a[64:67], v[64:67], 0
    v_mfma_f32_16x16x32_bf16 v[16:19], a[68:71], v[68:71], v[16:19]
    v_mfma_f32_16x16x32_bf16 v[16:19], a[72:75], v[72:75], v[16:19]
    v_mfma_f32_16x16x32_bf16 v[16:19], a[76:79], v[76:79], v[16:19]
    v_mfma_f32_16x16x32_bf16 v[20:23], a[64:67], v[80:83], 0
    v_mfma_f32_16x16x32_bf16 v[20:23], a[68:71], v[84:87], v[20:23]
    v_mfma_f32_16x16x32_bf16 v[20:23], a[72:75], v[88:91], v[20:23]
    v_mfma_f32_16x16x32_bf16 v[20:23], a[76:79], v[92:95], v[20:23]
    v_mfma_f32_16x16x32_bf16 v[24:27], a[64:67], v[96:99], 0
    v_mfma_f32_16x16x32_bf16 v[24:27], a[68:71], v[100:103], v[24:27]
    v_mfma_f32_16x16x32_bf16 v[24:27], a[72:75], v[104:107], v[24:27]
    v_mfma_f32_16x16x32_bf16 v[24:27], a[76:79], v[108:111], v[24:27]
    v_mfma_f32_16x16x32_bf16 v[28:31], a[64:67], v[112:115], 0
    v_mfma_f32_16x16x32_bf16 v[28:31], a[68:71], v[116:119], v[28:31]
    v_mfma_f32_16x16x32_bf16 v[28:31], a[72:75], v[120:123], v[28:31]
    v_mfma_f32_16x16x32_bf16 v[28:31], a[76:79], v[124:127], v[28:31]
    s_nop 1
    v_max3_f32 v16, v16, v17, v18
    v_max_f32 v16, v16, v19
    v_max3_f32 v20, v20, v21, v22
    v_max_f32 v20, v20, v23
    v_max3_f32 v24, v24, v25, v26
    v_max_f32 v24, v24, v27
    v_max3_f32 v28, v28, v29, v30
    v_max_f32 v28, v28, v31
    v_mov_b32 v40, v16
    v_mov_b32 v41, v20
    v_mov_b32 v42, v24
    v_mov_b32 v43, v28
    v_permlane16_swap_b32 v40, v16
    v_permlane16_swap_b32 v41, v20
    v_permlane16_swap_b32 v42, v24
    v_permlane16_swap_b32 v43, v28
    v_max_f32 v16, v16, v40
    v_max_f32 v20, v20, v41
    v_max_f32 v24, v24, v42
    v_max_f32 v28, v28, v43
    v_mov_b32 v40, v16
    v_mov_b32 v41, v20
    v_mov_b32 v42, v24
    v_mov_b32 v43, v28
    v_permlane32_swap_b32 v40, v16
    v_permlane32_swap_b32 v41, v20
    v_permlane32_swap_b32 v42, v24
    v_permlane32_swap_b32 v43, v28
    v_max_f32 v16, v16, v40
    v_max_f32 v20, v20, v41
    v_max_f32 v24, v24, v42
    v_max_f32 v28, v28, v43
    v_sub_f32 v48, 0xc2800000, v16
    v_sub_f32 v49, 0xc2800000, v16
    v_sub_f32 v50, 0xc2800000, v16
    v_sub_f32 v51, 0xc2800000, v16
    v_sub_f32 v52, 0xc2800000, v20
    v_sub_f32 v53, 0xc2800000, v20
    v_sub_f32 v54, 0xc2800000, v20
    v_sub_f32 v55, 0xc2800000, v20
    v_sub_f32 v56, 0xc2800000, v24
    v_sub_f32 v57, 0xc2800000, v24
    v_sub_f32 v58, 0xc2800000, v24
    v_sub_f32 v59, 0xc2800000, v24
    v_sub_f32 v60, 0xc2800000, v28
    v_sub_f32 v61, 0xc2800000, v28
    v_sub_f32 v62, 0xc2800000, v28
    v_sub_f32 v63, 0xc2800000, v28
L2_entry:
    s_mov_b32 s47, s44
    s_mov_b32 s48, -73728
    s_mov_b32 s49, 11
    s_mov_b32 s46, 32768
    s_mov_b32 s100, 0x07060302
    s_waitcnt vmcnt(8)
    s_barrier
    v_mfma_f32_16x16x32_bf16 v[16:19], a[64:67], v[64:67], v[48:51]
    ds_read_b64_tr_b16 a[128:129], v2 offset:0
    ds_read_b64_tr_b16 a[130:131], v2 offset:256
    v_mfma_f32_16x16x32_bf16 v[16:19], a[68:71], v[68:71], v[16:19]
    ds_read_b64_tr_b16 a[132:133], v2 offset:512
    ds_read_b64_tr_b16 a[134:135], v2 offset:768
    v_mfma_f32_16x16x32_bf16 v[16:19], a[72:75], v[72:75], v[16:19]
    s_add_u32 m0, s47, 36864
    ds_read_b64_tr_b16 a[136:137], v2 offset:32
    ds_read_b64_tr_b16 a[138:139], v2 offset:288
    v_mfma_f32_16x16x32_bf16 v[16:19], a[76:79], v[76:79], v[16:19]
    s_waitcnt lgkmcnt(14)
    s_add_u32 s46, s46, 16384
    buffer_load_dwordx4 off, s[16:19], s46 offset:0 lds
    v_mfma_f32_16x16x32_bf16 v[20:23], a[80:83], v[64:67], v[48:51]
    ds_read_b64_tr_b16 a[140:141], v2 offset:544
    ds_read_b64_tr_b16 a[142:143], v2 offset:800
    v_mfma_f32_16x16x32_bf16 v[20:23], a[84:87], v[68:71], v[20:23]
    ds_read_b64_tr_b16 a[144:145], v2 offset:64
    ds_read_b64_tr_b16 a[146:147], v2 offset:320
    v_mfma_f32_16x16x32_bf16 v[20:23], a[88:91], v[72:75], v[20:23]
    s_add_u32 m0, s47, 36896
    ds_read_b64_tr_b16 a[148:149], v2 offset:576
    ds_read_b64_tr_b16 a[150:151], v2 offset:832
    v_mfma_f32_16x16x32_bf16 v[20:23], a[92:95], v[76:79], v[20:23]
    s_waitcnt lgkmcnt(15)
    buffer_load_dwordx4 off, s[16:19], s46 offset:1024 lds
    v_mfma_f32_16x16x32_bf16 v[24:27], a[96:99], v[64:67], v[48:51]
    s_nop 1
    v_exp_f32 v16, v16
    v_mfma_f32_16x16x32_bf16 v[24:27], a[100:103], v[68:71], v[24:27]
    ds_read_b64_tr_b16 a[152:153], v2 offset:96
    ds_read_b64_tr_b16 a[154:155], v2 offset:352
    v_mfma_f32_16x16x32_bf16 v[24:27], a[104:107], v[72:75], v[24:27]
    s_add_u32 m0, s47, 36928
    v_exp_f32 v17, v17
    v_mfma_f32_16x16x32_bf16 v[24:27], a[108:111], v[76:79], v[24:27]
    s_waitcnt lgkmcnt(14)
    buffer_load_dwordx4 off, s[16:19], s46 offset:2048 lds
    v_mfma_f32_16x16x32_bf16 v[28:31], a[112:115], v[64:67], v[48:51]
    v_exp_f32 v18, v18
    v_mfma_f32_16x16x32_bf16 v[28:31], a[116:119], v[68:71], v[28:31]
    ds_read_b64_tr_b16 a[156:157], v2 offset:608
    v_perm_b32 v32, v17, v16, s100
    v_mfma_f32_16x16x32_bf16 v[28:31], a[120:123], v[72:75], v[28:31]
    s_add_u32 m0, s47, 36960
    v_exp_f32 v19, v19
    v_mfma_f32_16x16x32_bf16 v[28:31], a[124:127], v[76:79], v[28:31]
    buffer_load_dwordx4 off, s[16:19], s46 offset:3072 lds
    s_nop 3
    ds_read_b64_tr_b16 a[158:159], v2 offset:864
    ds_read_b64_tr_b16 a[160:161], v2 offset:128
    ds_read_b64_tr_b16 a[162:163], v2 offset:384
    ds_read_b64_tr_b16 a[164:165], v2 offset:640
    ds_read_b64_tr_b16 a[166:167], v2 offset:896
    ds_read_b64_tr_b16 a[168:169], v2 offset:160
    ds_read_b64_tr_b16 a[170:171], v2 offset:416
    ds_read_b64_tr_b16 a[172:173], v2 offset:672
    ds_read_b64_tr_b16 a[174:175], v2 offset:928
    ds_read_b64_tr_b16 a[176:177], v2 offset:192
    ds_read_b64_tr_b16 a[178:179], v2 offset:448
    ds_read_b64_tr_b16 a[180:181], v2 offset:704
    ds_read_b64_tr_b16 a[182:183], v2 offset:960
    ds_read_b64_tr_b16 a[184:185], v2 offset:224
    ds_read_b64_tr_b16 a[186:187], v2 offset:480
    ds_read_b64_tr_b16 a[188:189], v2 offset:736
    ds_read_b64_tr_b16 a[190:191], v2 offset:992
    v_exp_f32 v20, v20
    s_nop 0
    ds_read_b64_tr_b16 a[192:193], v2 offset:36864
    v_perm_b32 v33, v19, v18, s100
    s_add_u32 m0, s47, 53760
    v_exp_f32 v21, v21
    s_nop 0
    buffer_load_dwordx4 off, s[20:23], s46 offset:0 lds
    v_exp_f32 v22, v22
    s_nop 0
    ds_read_b64_tr_b16 a[194:195], v2 offset:37120
    v_perm_b32 v34, v21, v20, s100
    s_add_u32 m0, s47, 53792
    v_exp_f32 v23, v23
    s_nop 0
    buffer_load_dwordx4 off, s[20:23], s46 offset:1024 lds
    v_exp_f32 v24, v24
    s_nop 0
    ds_read_b64_tr_b16 a[196:197], v2 offset:37376
    v_perm_b32 v35, v23, v22, s100
    s_add_u32 m0, s47, 53824
    v_exp_f32 v25, v25
    s_nop 0
    buffer_load_dwordx4 off, s[20:23], s46 offset:2048 lds
    v_exp_f32 v26, v26
    s_nop 0
    ds_read_b64_tr_b16 a[198:199], v2 offset:37632
    v_perm_b32 v36, v25, v24, s100
    s_add_u32 m0, s47, 53856
    v_exp_f32 v27, v27
    s_nop 0
    buffer_load_dwordx4 off, s[20:23], s46 offset:3072 lds
    ds_read_b64_tr_b16 a[200:201], v2 offset:36896
    s_nop 0
    v_mfma_f32_16x16x32_bf16 v[16:19], a[64:67], v[80:83], v[52:55]
    v_exp_f32 v28, v28
    v_mfma_f32_16x16x32_bf16 v[16:19], a[68:71], v[84:87], v[16:19]
    ds_read_b64_tr_b16 a[202:203], v2 offset:37152
    v_perm_b32 v37, v27, v26, s100
    v_mfma_f32_16x16x32_bf16 v[16:19], a[72:75], v[88:91], v[16:19]
    v_exp_f32 v29, v29
    v_mfma_f32_16x16x32_bf16 v[16:19], a[76:79], v[92:95], v[16:19]
    ds_read_b64_tr_b16 a[204:205], v2 offset:37408
    v_mov_b32 v224, 0
    v_mfma_f32_16x16x32_bf16 v[20:23], a[80:83], v[80:83], v[52:55]
    v_exp_f32 v30, v30
    v_mfma_f32_16x16x32_bf16 v[20:23], a[84:87], v[84:87], v[20:23]
    ds_read_b64_tr_b16 a[206:207], v2 offset:37664
    v_perm_b32 v38, v29, v28, s100
    v_mfma_f32_16x16x32_bf16 v[20:23], a[88:91], v[88:91], v[20:23]
    v_exp_f32 v31, v31
    v_mfma_f32_16x16x32_bf16 v[20:23], a[92:95], v[92:95], v[20:23]
    ds_read_b64_tr_b16 a[208:209], v2 offset:36928
    v_mov_b32 v225, 0
    v_mfma_f32_16x16x32_bf16 v[24:27], a[96:99], v[80:83], v[52:55]
    v_exp_f32 v16, v16
    v_mfma_f32_16x16x32_bf16 v[24:27], a[100:103], v[84:87], v[24:27]
    ds_read_b64_tr_b16 a[210:211], v2 offset:37184
    v_perm_b32 v39, v31, v30, s100
    v_mfma_f32_16x16x32_bf16 v[24:27], a[104:107], v[88:91], v[24:27]
    v_exp_f32 v17, v17
    v_mfma_f32_16x16x32_bf16 v[24:27], a[108:111], v[92:95], v[24:27]
    ds_read_b64_tr_b16 a[212:213], v2 offset:37440
    v_mov_b32 v226, 0
    v_mfma_f32_16x16x32_bf16 v[28:31], a[112:115], v[80:83], v[52:55]
    v_exp_f32 v18, v18
    v_mfma_f32_16x16x32_bf16 v[28:31], a[116:119], v[84:87], v[28:31]
    ds_read_b64_tr_b16 a[214:215], v2 offset:37696
    v_perm_b32 v40, v17, v16, s100
    v_mfma_f32_16x16x32_bf16 v[28:31], a[120:123], v[88:91], v[28:31]
    s_waitcnt lgkmcnt(12)
    v_exp_f32 v19, v19
    v_mfma_f32_16x16x32_bf16 v[28:31], a[124:127], v[92:95], v[28:31]
    ds_read_b64_tr_b16 a[216:217], v2 offset:36960
    v_mov_b32 v227, 0
    v_mfma_f32_16x16x32_bf16 v[128:131], a[128:131], v[32:35], 0
    v_exp_f32 v20, v20
    v_mfma_f32_16x16x32_bf16 v[128:131], a[132:135], v[36:39], v[128:131]
    ds_read_b64_tr_b16 a[218:219], v2 offset:37216
    v_perm_b32 v41, v19, v18, s100
    v_mfma_f32_16x16x32_bf16 v[132:135], a[136:139], v[32:35], 0
    v_exp_f32 v21, v21
    v_mfma_f32_16x16x32_bf16 v[132:135], a[140:143], v[36:39], v[132:135]
    ds_read_b64_tr_b16 a[220:221], v2 offset:37472
    v_mov_b32 v228, 0
    v_mfma_f32_16x16x32_bf16 v[136:139], a[144:147], v[32:35], 0
    v_exp_f32 v22, v22
    v_mfma_f32_16x16x32_bf16 v[136:139], a[148:151], v[36:39], v[136:139]
    ds_read_b64_tr_b16 a[222:223], v2 offset:37728
    v_perm_b32 v42, v21, v20, s100
    v_mfma_f32_16x16x32_bf16 v[140:143], a[152:155], v[32:35], 0
    v_exp_f32 v23, v23
    v_mfma_f32_16x16x32_bf16 v[140:143], a[156:159], v[36:39], v[140:143]
    ds_read_b64_tr_b16 a[224:225], v2 offset:36992
    v_mov_b32 v229, 0
    v_mfma_f32_16x16x32_bf16 v[144:147], a[160:163], v[32:35], 0
    v_exp_f32 v24, v24
    v_mfma_f32_16x16x32_bf16 v[144:147], a[164:167], v[36:39], v[144:147]
    ds_read_b64_tr_b16 a[226:227], v2 offset:37248
    v_perm_b32 v43, v23, v22, s100
    v_mfma_f32_16x16x32_bf16 v[148:151], a[168:171], v[32:35], 0
    v_exp_f32 v25, v25
    v_mfma_f32_16x16x32_bf16 v[148:151], a[172:175], v[36:39], v[148:151]
    ds_read_b64_tr_b16 a[228:229], v2 offset:37504
    v_mov_b32 v230, 0
    v_mfma_f32_16x16x32_bf16 v[152:155], a[176:179], v[32:35], 0
    v_exp_f32 v26, v26
    v_mfma_f32_16x16x32_bf16 v[152:155], a[180:183], v[36:39], v[152:155]
    ds_read_b64_tr_b16 a[230:231], v2 offset:37760
    v_perm_b32 v44, v25, v24, s100
    v_mfma_f32_16x16x32_bf16 v[156:159], a[184:187], v[32:35], 0
    v_exp_f32 v27, v27
    v_mfma_f32_16x16x32_bf16 v[156:159], a[188:191], v[36:39], v[156:159]
    ds_read_b64_tr_b16 a[232:233], v2 offset:37024
    v_mov_b32 v231, 0
    v_smfmac_f32_16x16x64_bf16 a[0:3], a[16:19], v[32:39], v11
    ds_read_b64_tr_b16 a[234:235], v2 offset:37280
    v_mov_b32 v232, 0
    v_mfma_f32_16x16x32_bf16 v[16:19], a[64:67], v[96:99], v[56:59]
    v_exp_f32 v28, v28
    v_mfma_f32_16x16x32_bf16 v[16:19], a[68:71], v[100:103], v[16:19]
    ds_read_b64_tr_b16 a[236:237], v2 offset:37536
    v_perm_b32 v45, v27, v26, s100
    v_mfma_f32_16x16x32_bf16 v[16:19], a[72:75], v[104:107], v[16:19]
    v_exp_f32 v29, v29
    v_mfma_f32_16x16x32_bf16 v[16:19], a[76:79], v[108:111], v[16:19]
    ds_read_b64_tr_b16 a[238:239], v2 offset:37792
    v_mov_b32 v233, 0
    v_mfma_f32_16x16x32_bf16 v[20:23], a[80:83], v[96:99], v[56:59]
    v_exp_f32 v30, v30
    v_mfma_f32_16x16x32_bf16 v[20:23], a[84:87], v[100:103], v[20:23]
    ds_read_b64_tr_b16 a[240:241], v2 offset:37056
    v_perm_b32 v46, v29, v28, s100
    v_mfma_f32_16x16x32_bf16 v[20:23], a[88:91], v[104:107], v[20:23]
    v_exp_f32 v31, v31
    v_mfma_f32_16x16x32_bf16 v[20:23], a[92:95], v[108:111], v[20:23]
    ds_read_b64_tr_b16 a[242:243], v2 offset:37312
    v_mov_b32 v234, 0
    v_mfma_f32_16x16x32_bf16 v[24:27], a[96:99], v[96:99], v[56:59]
    v_exp_f32 v16, v16
    v_mfma_f32_16x16x32_bf16 v[24:27], a[100:103], v[100:103], v[24:27]
    ds_read_b64_tr_b16 a[244:245], v2 offset:37568
    v_perm_b32 v47, v31, v30, s100
    v_mfma_f32_16x16x32_bf16 v[24:27], a[104:107], v[104:107], v[24:27]
    v_exp_f32 v17, v17
    v_mfma_f32_16x16x32_bf16 v[24:27], a[108:111], v[108:111], v[24:27]
    ds_read_b64_tr_b16 a[246:247], v2 offset:37824
    v_mov_b32 v235, 0
    v_mfma_f32_16x16x32_bf16 v[28:31], a[112:115], v[96:99], v[56:59]
    v_exp_f32 v18, v18
    v_mfma_f32_16x16x32_bf16 v[28:31], a[116:119], v[100:103], v[28:31]
    ds_read_b64_tr_b16 a[248:249], v2 offset:37088
    v_perm_b32 v32, v17, v16, s100
    v_mfma_f32_16x16x32_bf16 v[28:31], a[120:123], v[104:107], v[28:31]
    v_exp_f32 v19, v19
    v_mfma_f32_16x16x32_bf16 v[28:31], a[124:127], v[108:111], v[28:31]
    ds_read_b64_tr_b16 a[250:251], v2 offset:37344
    v_mov_b32 v236, 0
    v_mfma_f32_16x16x32_bf16 v[160:163], a[128:131], v[40:43], 0
    v_exp_f32 v20, v20
    v_mfma_f32_16x16x32_bf16 v[160:163], a[132:135], v[44:47], v[160:163]
    ds_read_b64_tr_b16 a[252:253], v2 offset:37600
    v_perm_b32 v33, v19, v18, s100
    v_mfma_f32_16x16x32_bf16 v[164:167], a[136:139], v[40:43], 0
    v_exp_f32 v21, v21
    v_mfma_f32_16x16x32_bf16 v[164:167], a[140:143], v[44:47], v[164:167]
    ds_read_b64_tr_b16 a[254:255], v2 offset:37856
    v_mov_b32 v237, 0
    v_mfma_f32_16x16x32_bf16 v[168:171], a[144:147], v[40:43], 0
    v_exp_f32 v22, v22
    v_mfma_f32_16x16x32_bf16 v[168:171], a[148:151], v[44:47], v[168:171]
    v_perm_b32 v34, v21, v20, s100
    v_mov_b32 v238, 0
    v_mfma_f32_16x16x32_bf16 v[172:175], a[152:155], v[40:43], 0
    v_exp_f32 v23, v23
    v_mfma_f32_16x16x32_bf16 v[172:175], a[156:159], v[44:47], v[172:175]
    v_mov_b32 v239, 0
    v_mov_b32 v240, 0
    v_mfma_f32_16x16x32_bf16 v[176:179], a[160:163], v[40:43], 0
    v_exp_f32 v24, v24
    v_mfma_f32_16x16x32_bf16 v[176:179], a[164:167], v[44:47], v[176:179]
    v_perm_b32 v35, v23, v22, s100
    v_mov_b32 v241, 0
    v_mfma_f32_16x16x32_bf16 v[180:183], a[168:171], v[40:43], 0
    v_exp_f32 v25, v25
    v_mfma_f32_16x16x32_bf16 v[180:183], a[172:175], v[44:47], v[180:183]
    v_mov_b32 v242, 0
    v_mov_b32 v243, 0
    v_mfma_f32_16x16x32_bf16 v[184:187], a[176:179], v[40:43], 0
    v_exp_f32 v26, v26
    v_mfma_f32_16x16x32_bf16 v[184:187], a[180:183], v[44:47], v[184:187]
    v_perm_b32 v36, v25, v24, s100
    v_mov_b32 v244, 0
    v_mfma_f32_16x16x32_bf16 v[188:191], a[184:187], v[40:43], 0
    v_exp_f32 v27, v27
    v_mfma_f32_16x16x32_bf16 v[188:191], a[188:191], v[44:47], v[188:191]
    v_mov_b32 v245, 0
    v_mov_b32 v246, 0
    v_smfmac_f32_16x16x64_bf16 a[4:7], a[16:19], v[40:47], v11
    v_mov_b32 v247, 0
    v_mov_b32 v248, 0
    v_mfma_f32_16x16x32_bf16 v[16:19], a[64:67], v[112:115], v[60:63]
    v_exp_f32 v28, v28
    v_mfma_f32_16x16x32_bf16 v[16:19], a[68:71], v[116:119], v[16:19]
    ds_read_b128 a[64:67], v1 offset:36864
    v_perm_b32 v37, v27, v26, s100
    v_mfma_f32_16x16x32_bf16 v[16:19], a[72:75], v[120:123], v[16:19]
    v_exp_f32 v29, v29
    v_mfma_f32_16x16x32_bf16 v[16:19], a[76:79], v[124:127], v[16:19]
    ds_read_b128 a[68:71], v1 offset:36928
    v_mov_b32 v249, 0
    v_mfma_f32_16x16x32_bf16 v[20:23], a[80:83], v[112:115], v[60:63]
    v_exp_f32 v30, v30
    v_mfma_f32_16x16x32_bf16 v[20:23], a[84:87], v[116:119], v[20:23]
    ds_read_b128 a[72:75], v1 offset:36992
    v_perm_b32 v38, v29, v28, s100
    v_mfma_f32_16x16x32_bf16 v[20:23], a[88:91], v[120:123], v[20:23]
    v_exp_f32 v31, v31
    v_mfma_f32_16x16x32_bf16 v[20:23], a[92:95], v[124:127], v[20:23]
    ds_read_b128 a[76:79], v1 offset:37056
    v_mov_b32 v250, 0
    v_mfma_f32_16x16x32_bf16 v[24:27], a[96:99], v[112:115], v[60:63]
    v_exp_f32 v16, v16
    v_mfma_f32_16x16x32_bf16 v[24:27], a[100:103], v[116:119], v[24:27]
    ds_read_b128 a[80:83], v1 offset:37120
    v_perm_b32 v39, v31, v30, s100
    v_mfma_f32_16x16x32_bf16 v[24:27], a[104:107], v[120:123], v[24:27]
    v_exp_f32 v17, v17
    v_mfma_f32_16x16x32_bf16 v[24:27], a[108:111], v[124:127], v[24:27]
    ds_read_b128 a[84:87], v1 offset:37184
    v_mov_b32 v251, 0
    v_mfma_f32_16x16x32_bf16 v[28:31], a[112:115], v[112:115], v[60:63]
    v_exp_f32 v18, v18
    v_mfma_f32_16x16x32_bf16 v[28:31], a[116:119], v[116:119], v[28:31]
    ds_read_b128 a[88:91], v1 offset:37248
    v_perm_b32 v40, v17, v16, s100
    v_mfma_f32_16x16x32_bf16 v[28:31], a[120:123], v[120:123], v[28:31]
    v_exp_f32 v19, v19
    v_mfma_f32_16x16x32_bf16 v[28:31], a[124:127], v[124:127], v[28:31]
    ds_read_b128 a[92:95], v1 offset:37312
    v_mov_b32 v252, 0
    v_mfma_f32_16x16x32_bf16 v[192:195], a[128:131], v[32:35], 0
    v_exp_f32 v20, v20
    v_mfma_f32_16x16x32_bf16 v[192:195], a[132:135], v[36:39], v[192:195]
    ds_read_b128 a[96:99], v1 offset:37376
    v_perm_b32 v41, v19, v18, s100
    v_mfma_f32_16x16x32_bf16 v[196:199], a[136:139], v[32:35], 0
    v_exp_f32 v21, v21
    v_mfma_f32_16x16x32_bf16 v[196:199], a[140:143], v[36:39], v[196:199]
    ds_read_b128 a[100:103], v1 offset:37440
    v_mov_b32 v253, 0
    v_mfma_f32_16x16x32_bf16 v[200:203], a[144:147], v[32:35], 0
    v_exp_f32 v22, v22
    v_mfma_f32_16x16x32_bf16 v[200:203], a[148:151], v[36:39], v[200:203]
    ds_read_b128 a[104:107], v1 offset:37504
    v_perm_b32 v42, v21, v20, s100
    v_mfma_f32_16x16x32_bf16 v[204:207], a[152:155], v[32:35], 0
    v_exp_f32 v23, v23
    v_mfma_f32_16x16x32_bf16 v[204:207], a[156:159], v[36:39], v[204:207]
    ds_read_b128 a[108:111], v1 offset:37568
    v_mov_b32 v254, 0
    v_mfma_f32_16x16x32_bf16 v[208:211], a[160:163], v[32:35], 0
    v_exp_f32 v24, v24
    v_mfma_f32_16x16x32_bf16 v[208:211], a[164:167], v[36:39], v[208:211]
    ds_read_b128 a[112:115], v1 offset:37632
    v_perm_b32 v43, v23, v22, s100
    v_mfma_f32_16x16x32_bf16 v[212:215], a[168:171], v[32:35], 0
    v_exp_f32 v25, v25
    v_mfma_f32_16x16x32_bf16 v[212:215], a[172:175], v[36:39], v[212:215]
    ds_read_b128 a[116:119], v1 offset:37696
    v_mov_b32 v255, 0
    v_mfma_f32_16x16x32_bf16 v[216:219], a[176:179], v[32:35], 0
    v_exp_f32 v26, v26
    v_mfma_f32_16x16x32_bf16 v[216:219], a[180:183], v[36:39], v[216:219]
    ds_read_b128 a[120:123], v1 offset:37760
    v_perm_b32 v44, v25, v24, s100
    v_mfma_f32_16x16x32_bf16 v[220:223], a[184:187], v[32:35], 0
    v_exp_f32 v27, v27
    v_mfma_f32_16x16x32_bf16 v[220:223], a[188:191], v[36:39], v[220:223]
    ds_read_b128 a[124:127], v1 offset:37824
    v_smfmac_f32_16x16x64_bf16 a[8:11], a[16:19], v[32:39], v11
    s_waitcnt lgkmcnt(12)
.p2align 5
L2_loop:
    v_mfma_f32_16x16x32_bf16 v[16:19], a[64:67], v[64:67], v[48:51]
    s_sub_u32 s47, s47, s48
    v_exp_f32 v28, v28
    v_mfma_f32_16x16x32_bf16 v[16:19], a[68:71], v[68:71], v[16:19]
    v_perm_b32 v45, v27, v26, s100
    v_add_u32 v1, s48, v1
    v_mfma_f32_16x16x32_bf16 v[16:19], a[72:75], v[72:75], v[16:19]
    v_exp_f32 v29, v29
    v_mfma_f32_16x16x32_bf16 v[16:19], a[76:79], v[76:79], v[16:19]
    s_waitcnt lgkmcnt(8)
    v_mfma_f32_16x16x32_bf16 v[20:23], a[80:83], v[64:67], v[48:51]
    v_exp_f32 v30, v30
    v_mfma_f32_16x16x32_bf16 v[20:23], a[84:87], v[68:71], v[20:23]
    v_perm_b32 v46, v29, v28, s100
    v_add_u32 v2, s48, v2
    v_mfma_f32_16x16x32_bf16 v[20:23], a[88:91], v[72:75], v[20:23]
L2_pad4:
    s_cbranch_execz L2_pad8
    v_exp_f32 v31, v31
    v_mfma_f32_16x16x32_bf16 v[20:23], a[92:95], v[76:79], v[20:23]
    s_waitcnt lgkmcnt(4)
    v_mfma_f32_16x16x32_bf16 v[24:27], a[96:99], v[64:67], v[48:51]
    s_sub_u32 s48, 0, s48
    v_exp_f32 v16, v16
    v_mfma_f32_16x16x32_bf16 v[24:27], a[100:103], v[68:71], v[24:27]
    v_perm_b32 v47, v31, v30, s100
    v_mfma_f32_16x16x32_bf16 v[24:27], a[104:107], v[72:75], v[24:27]
    v_exp_f32 v17, v17
    v_mfma_f32_16x16x32_bf16 v[24:27], a[108:111], v[76:79], v[24:27]
    s_waitcnt lgkmcnt(0)
    v_mfma_f32_16x16x32_bf16 v[28:31], a[112:115], v[64:67], v[48:51]
    v_exp_f32 v18, v18
    v_mfma_f32_16x16x32_bf16 v[28:31], a[116:119], v[68:71], v[28:31]
    v_perm_b32 v32, v17, v16, s100
    v_mfma_f32_16x16x32_bf16 v[28:31], a[120:123], v[72:75], v[28:31]
    v_exp_f32 v19, v19
    v_mfma_f32_16x16x32_bf16 v[28:31], a[124:127], v[76:79], v[28:31]
    s_waitcnt vmcnt(0)
    s_barrier
    v_mfma_f32_16x16x32_bf16 v[224:227], a[128:131], v[40:43], v[224:227]
    v_exp_f32 v20, v20
    v_mfma_f32_16x16x32_bf16 v[224:227], a[132:135], v[44:47], v[224:227]
    ds_read_b64_tr_b16 a[128:129], v2 offset:0
    v_perm_b32 v33, v19, v18, s100
    v_mfma_f32_16x16x32_bf16 v[228:231], a[136:139], v[40:43], v[228:231]
    s_add_u32 m0, s47, 0
    v_exp_f32 v21, v21
    v_mfma_f32_16x16x32_bf16 v[228:231], a[140:143], v[44:47], v[228:231]
    s_add_u32 s46, s46, 16384
    buffer_load_dwordx4 off, s[16:19], s46 offset:0 lds
    v_mfma_f32_16x16x32_bf16 v[232:235], a[144:147], v[40:43], v[232:235]
    v_exp_f32 v22, v22
    v_mfma_f32_16x16x32_bf16 v[232:235], a[148:151], v[44:47], v[232:235]
    ds_read_b64_tr_b16 a[130:131], v2 offset:256
    v_perm_b32 v34, v21, v20, s100
    v_mfma_f32_16x16x32_bf16 v[236:239], a[152:155], v[40:43], v[236:239]
    s_add_u32 m0, s47, 32
    v_exp_f32 v23, v23
    v_mfma_f32_16x16x32_bf16 v[236:239], a[156:159], v[44:47], v[236:239]
    buffer_load_dwordx4 off, s[16:19], s46 offset:1024 lds
    v_mfma_f32_16x16x32_bf16 v[240:243], a[160:163], v[40:43], v[240:243]
    v_exp_f32 v24, v24
    v_mfma_f32_16x16x32_bf16 v[240:243], a[164:167], v[44:47], v[240:243]
    ds_read_b64_tr_b16 a[132:133], v2 offset:512
    v_perm_b32 v35, v23, v22, s100
    v_mfma_f32_16x16x32_bf16 v[244:247], a[168:171], v[40:43], v[244:247]
    s_add_u32 m0, s47, 64
    v_exp_f32 v25, v25
    v_mfma_f32_16x16x32_bf16 v[244:247], a[172:175], v[44:47], v[244:247]
    buffer_load_dwordx4 off, s[16:19], s46 offset:2048 lds
    v_mfma_f32_16x16x32_bf16 v[248:251], a[176:179], v[40:43], v[248:251]
    v_exp_f32 v26, v26
    v_mfma_f32_16x16x32_bf16 v[248:251], a[180:183], v[44:47], v[248:251]
    ds_read_b64_tr_b16 a[134:135], v2 offset:768
    v_perm_b32 v36, v25, v24, s100
    v_mfma_f32_16x16x32_bf16 v[252:255], a[184:187], v[40:43], v[252:255]
    s_add_u32 m0, s47, 96
    v_exp_f32 v27, v27
    v_mfma_f32_16x16x32_bf16 v[252:255], a[188:191], v[44:47], v[252:255]
    buffer_load_dwordx4 off, s[16:19], s46 offset:3072 lds
    v_smfmac_f32_16x16x64_bf16 a[12:15], a[16:19], v[40:47], v11
    ds_read_b64_tr_b16 a[136:137], v2 offset:32
    v_mfma_f32_16x16x32_bf16 v[16:19], a[64:67], v[80:83], v[52:55]
    v_exp_f32 v28, v28
    v_mfma_f32_16x16x32_bf16 v[16:19], a[68:71], v[84:87], v[16:19]
    ds_read_b64_tr_b16 a[138:139], v2 offset:288
    v_perm_b32 v37, v27, v26, s100
    v_mfma_f32_16x16x32_bf16 v[16:19], a[72:75], v[88:91], v[16:19]
    s_add_u32 m0, s47, 16896
    v_exp_f32 v29, v29
    v_mfma_f32_16x16x32_bf16 v[16:19], a[76:79], v[92:95], v[16:19]
    buffer_load_dwordx4 off, s[20:23], s46 offset:0 lds
    v_mfma_f32_16x16x32_bf16 v[20:23], a[80:83], v[80:83], v[52:55]
    v_exp_f32 v30, v30
    v_mfma_f32_16x16x32_bf16 v[20:23], a[84:87], v[84:87], v[20:23]
    ds_read_b64_tr_b16 a[140:141], v2 offset:544
    v_perm_b32 v38, v29, v28, s100
    v_mfma_f32_16x16x32_bf16 v[20:23], a[88:91], v[88:91], v[20:23]
    s_add_u32 m0, s47, 16928
    v_exp_f32 v31, v31
    v_mfma_f32_16x16x32_bf16 v[20:23], a[92:95], v[92:95], v[20:23]
    buffer_load_dwordx4 off, s[20:23], s46 offset:1024 lds
    v_mfma_f32_16x16x32_bf16 v[24:27], a[96:99], v[80:83], v[52:55]
    v_exp_f32 v16, v16
    v_mfma_f32_16x16x32_bf16 v[24:27], a[100:103], v[84:87], v[24:27]
    ds_read_b64_tr_b16 a[142:143], v2 offset:800
    v_perm_b32 v39, v31, v30, s100
    v_mfma_f32_16x16x32_bf16 v[24:27], a[104:107], v[88:91], v[24:27]
    s_add_u32 m0, s47, 16960
    v_exp_f32 v17, v17
    v_mfma_f32_16x16x32_bf16 v[24:27], a[108:111], v[92:95], v[24:27]
    buffer_load_dwordx4 off, s[20:23], s46 offset:2048 lds
    v_mfma_f32_16x16x32_bf16 v[28:31], a[112:115], v[80:83], v[52:55]
    v_exp_f32 v18, v18
    v_mfma_f32_16x16x32_bf16 v[28:31], a[116:119], v[84:87], v[28:31]
    ds_read_b64_tr_b16 a[144:145], v2 offset:64
    v_perm_b32 v40, v17, v16, s100
    v_mfma_f32_16x16x32_bf16 v[28:31], a[120:123], v[88:91], v[28:31]
    s_add_u32 m0, s47, 16992
    v_exp_f32 v19, v19
    v_mfma_f32_16x16x32_bf16 v[28:31], a[124:127], v[92:95], v[28:31]
    buffer_load_dwordx4 off, s[20:23], s46 offset:3072 lds
    v_mfma_f32_16x16x32_bf16 v[128:131], a[192:195], v[32:35], v[128:131]
    v_exp_f32 v20, v20
    v_mfma_f32_16x16x32_bf16 v[128:131], a[196:199], v[36:39], v[128:131]
    ds_read_b64_tr_b16 a[146:147], v2 offset:320
    v_perm_b32 v41, v19, v18, s100
    v_mfma_f32_16x16x32_bf16 v[132:135], a[200:203], v[32:35], v[132:135]
    v_exp_f32 v21, v21
    v_mfma_f32_16x16x32_bf16 v[132:135], a[204:207], v[36:39], v[132:135]
    ds_read_b64_tr_b16 a[148:149], v2 offset:576
    v_mfma_f32_16x16x32_bf16 v[136:139], a[208:211], v[32:35], v[136:139]
    v_exp_f32 v22, v22
    v_mfma_f32_16x16x32_bf16 v[136:139], a[212:215], v[36:39], v[136:139]
    ds_read_b64_tr_b16 a[150:151], v2 offset:832
    v_perm_b32 v42, v21, v20, s100
    v_mfma_f32_16x16x32_bf16 v[140:143], a[216:219], v[32:35], v[140:143]
    v_exp_f32 v23, v23
    v_mfma_f32_16x16x32_bf16 v[140:143], a[220:223], v[36:39], v[140:143]
    ds_read_b64_tr_b16 a[152:153], v2 offset:96
    ds_read_b64_tr_b16 a[154:155], v2 offset:352
    v_mfma_f32_16x16x32_bf16 v[144:147], a[224:227], v[32:35], v[144:147]
    v_exp_f32 v24, v24
    v_mfma_f32_16x16x32_bf16 v[144:147], a[228:231], v[36:39], v[144:147]
    ds_read_b64_tr_b16 a[156:157], v2 offset:608
    v_perm_b32 v43, v23, v22, s100
    v_mfma_f32_16x16x32_bf16 v[148:151], a[232:235], v[32:35], v[148:151]
    v_exp_f32 v25, v25
    v_mfma_f32_16x16x32_bf16 v[148:151], a[236:239], v[36:39], v[148:151]
    ds_read_b64_tr_b16 a[158:159], v2 offset:864
    ds_read_b64_tr_b16 a[160:161], v2 offset:128
    v_mfma_f32_16x16x32_bf16 v[152:155], a[240:243], v[32:35], v[152:155]
    v_exp_f32 v26, v26
    v_mfma_f32_16x16x32_bf16 v[152:155], a[244:247], v[36:39], v[152:155]
    ds_read_b64_tr_b16 a[162:163], v2 offset:384
    v_perm_b32 v44, v25, v24, s100
    v_mfma_f32_16x16x32_bf16 v[156:159], a[248:251], v[32:35], v[156:159]
    v_exp_f32 v27, v27
    v_mfma_f32_16x16x32_bf16 v[156:159], a[252:255], v[36:39], v[156:159]
    ds_read_b64_tr_b16 a[164:165], v2 offset:640
    ds_read_b64_tr_b16 a[166:167], v2 offset:896
    v_smfmac_f32_16x16x64_bf16 a[0:3], a[16:19], v[32:39], v11
    ds_read_b64_tr_b16 a[168:169], v2 offset:160
    ds_read_b64_tr_b16 a[170:171], v2 offset:416
    v_mfma_f32_16x16x32_bf16 v[16:19], a[64:67], v[96:99], v[56:59]
    v_exp_f32 v28, v28
    v_mfma_f32_16x16x32_bf16 v[16:19], a[68:71], v[100:103], v[16:19]
    ds_read_b64_tr_b16 a[172:173], v2 offset:672
    v_perm_b32 v45, v27, v26, s100
    v_mfma_f32_16x16x32_bf16 v[16:19], a[72:75], v[104:107], v[16:19]
    s_add_u32 m0, s47, 36864
    v_exp_f32 v29, v29
    v_mfma_f32_16x16x32_bf16 v[16:19], a[76:79], v[108:111], v[16:19]
    s_add_u32 s46, s46, 16384
    buffer_load_dwordx4 off, s[16:19], s46 offset:0 lds
    v_mfma_f32_16x16x32_bf16 v[20:23], a[80:83], v[96:99], v[56:59]
    v_exp_f32 v30, v30
    v_mfma_f32_16x16x32_bf16 v[20:23], a[84:87], v[100:103], v[20:23]
    ds_read_b64_tr_b16 a[174:175], v2 offset:928
    v_perm_b32 v46, v29, v28, s100
    v_mfma_f32_16x16x32_bf16 v[20:23], a[88:91], v[104:107], v[20:23]
    s_add_u32 m0, s47, 36896
    v_exp_f32 v31, v31
    v_mfma_f32_16x16x32_bf16 v[20:23], a[92:95], v[108:111], v[20:23]
    buffer_load_dwordx4 off, s[16:19], s46 offset:1024 lds
    v_mfma_f32_16x16x32_bf16 v[24:27], a[96:99], v[96:99], v[56:59]
    v_exp_f32 v16, v16
    v_mfma_f32_16x16x32_bf16 v[24:27], a[100:103], v[100:103], v[24:27]
    ds_read_b64_tr_b16 a[176:177], v2 offset:192
    v_perm_b32 v47, v31, v30, s100
    v_mfma_f32_16x16x32_bf16 v[24:27], a[104:107], v[104:107], v[24:27]
    s_add_u32 m0, s47, 36928
    v_exp_f32 v17, v17
    v_mfma_f32_16x16x32_bf16 v[24:27], a[108:111], v[108:111], v[24:27]
    buffer_load_dwordx4 off, s[16:19], s46 offset:2048 lds
    v_mfma_f32_16x16x32_bf16 v[28:31], a[112:115], v[96:99], v[56:59]
    v_exp_f32 v18, v18
    v_mfma_f32_16x16x32_bf16 v[28:31], a[116:119], v[100:103], v[28:31]
    ds_read_b64_tr_b16 a[178:179], v2 offset:448
    v_perm_b32 v32, v17, v16, s100
    v_mfma_f32_16x16x32_bf16 v[28:31], a[120:123], v[104:107], v[28:31]
    s_add_u32 m0, s47, 36960
    v_exp_f32 v19, v19
    v_mfma_f32_16x16x32_bf16 v[28:31], a[124:127], v[108:111], v[28:31]
    buffer_load_dwordx4 off, s[16:19], s46 offset:3072 lds
    v_mfma_f32_16x16x32_bf16 v[160:163], a[192:195], v[40:43], v[160:163]
    v_exp_f32 v20, v20
    v_mfma_f32_16x16x32_bf16 v[160:163], a[196:199], v[44:47], v[160:163]
    ds_read_b64_tr_b16 a[180:181], v2 offset:704
    v_perm_b32 v33, v19, v18, s100
    v_mfma_f32_16x16x32_bf16 v[164:167], a[200:203], v[40:43], v[164:167]
    s_add_u32 m0, s47, 53760
    v_exp_f32 v21, v21
    v_mfma_f32_16x16x32_bf16 v[164:167], a[204:207], v[44:47], v[164:167]
    buffer_load_dwordx4 off, s[20:23], s46 offset:0 lds
    v_mfma_f32_16x16x32_bf16 v[168:171], a[208:211], v[40:43], v[168:171]
    v_exp_f32 v22, v22
    v_mfma_f32_16x16x32_bf16 v[168:171], a[212:215], v[44:47], v[168:171]
    ds_read_b64_tr_b16 a[182:183], v2 offset:960
    v_perm_b32 v34, v21, v20, s100
    v_mfma_f32_16x16x32_bf16 v[172:175], a[216:219], v[40:43], v[172:175]
    s_add_u32 m0, s47, 53792
    v_exp_f32 v23, v23
    v_mfma_f32_16x16x32_bf16 v[172:175], a[220:223], v[44:47], v[172:175]
    buffer_load_dwordx4 off, s[20:23], s46 offset:1024 lds
    v_mfma_f32_16x16x32_bf16 v[176:179], a[224:227], v[40:43], v[176:179]
    v_exp_f32 v24, v24
    v_mfma_f32_16x16x32_bf16 v[176:179], a[228:231], v[44:47], v[176:179]
    ds_read_b64_tr_b16 a[184:185], v2 offset:224
    v_perm_b32 v35, v23, v22, s100
    v_mfma_f32_16x16x32_bf16 v[180:183], a[232:235], v[40:43], v[180:183]
    s_add_u32 m0, s47, 53824
    v_exp_f32 v25, v25
    v_mfma_f32_16x16x32_bf16 v[180:183], a[236:239], v[44:47], v[180:183]
    buffer_load_dwordx4 off, s[20:23], s46 offset:2048 lds
    v_mfma_f32_16x16x32_bf16 v[184:187], a[240:243], v[40:43], v[184:187]
    v_exp_f32 v26, v26
    v_mfma_f32_16x16x32_bf16 v[184:187], a[244:247], v[44:47], v[184:187]
    ds_read_b64_tr_b16 a[186:187], v2 offset:480
    v_perm_b32 v36, v25, v24, s100
    v_mfma_f32_16x16x32_bf16 v[188:191], a[248:251], v[40:43], v[188:191]
    s_add_u32 m0, s47, 53856
    v_exp_f32 v27, v27
    v_mfma_f32_16x16x32_bf16 v[188:191], a[252:255], v[44:47], v[188:191]
    buffer_load_dwordx4 off, s[20:23], s46 offset:3072 lds
    v_smfmac_f32_16x16x64_bf16 a[4:7], a[16:19], v[40:47], v11
    ds_read_b64_tr_b16 a[188:189], v2 offset:736
    ds_read_b64_tr_b16 a[190:191], v2 offset:992
    v_mfma_f32_16x16x32_bf16 v[16:19], a[64:67], v[112:115], v[60:63]
    v_exp_f32 v28, v28
    v_mfma_f32_16x16x32_bf16 v[16:19], a[68:71], v[116:119], v[16:19]
    ds_read_b128 a[64:67], v1 offset:0
    v_perm_b32 v37, v27, v26, s100
    v_mfma_f32_16x16x32_bf16 v[16:19], a[72:75], v[120:123], v[16:19]
    v_exp_f32 v29, v29
    v_mfma_f32_16x16x32_bf16 v[16:19], a[76:79], v[124:127], v[16:19]
    ds_read_b128 a[68:71], v1 offset:64
    v_mfma_f32_16x16x32_bf16 v[20:23], a[80:83], v[112:115], v[60:63]
    v_exp_f32 v30, v30
    v_mfma_f32_16x16x32_bf16 v[20:23], a[84:87], v[116:119], v[20:23]
    ds_read_b128 a[72:75], v1 offset:128
    v_perm_b32 v38, v29, v28, s100
    v_mfma_f32_16x16x32_bf16 v[20:23], a[88:91], v[120:123], v[20:23]
    v_exp_f32 v31, v31
    v_mfma_f32_16x16x32_bf16 v[20:23], a[92:95], v[124:127], v[20:23]
    ds_read_b128 a[76:79], v1 offset:192
    v_mfma_f32_16x16x32_bf16 v[24:27], a[96:99], v[112:115], v[60:63]
    v_exp_f32 v16, v16
    v_mfma_f32_16x16x32_bf16 v[24:27], a[100:103], v[116:119], v[24:27]
    ds_read_b128 a[80:83], v1 offset:256
    v_perm_b32 v39, v31, v30, s100
    v_mfma_f32_16x16x32_bf16 v[24:27], a[104:107], v[120:123], v[24:27]
    v_exp_f32 v17, v17
    v_mfma_f32_16x16x32_bf16 v[24:27], a[108:111], v[124:127], v[24:27]
    ds_read_b128 a[84:87], v1 offset:320
    v_mfma_f32_16x16x32_bf16 v[28:31], a[112:115], v[112:115], v[60:63]
    v_exp_f32 v18, v18
    v_mfma_f32_16x16x32_bf16 v[28:31], a[116:119], v[116:119], v[28:31]
    ds_read_b128 a[88:91], v1 offset:384
    v_perm_b32 v40, v17, v16, s100
    v_mfma_f32_16x16x32_bf16 v[28:31], a[120:123], v[120:123], v[28:31]
    v_exp_f32 v19, v19
    v_mfma_f32_16x16x32_bf16 v[28:31], a[124:127], v[124:127], v[28:31]
    ds_read_b128 a[92:95], v1 offset:448
    v_mfma_f32_16x16x32_bf16 v[192:195], a[192:195], v[32:35], v[192:195]
    v_exp_f32 v20, v20
    v_mfma_f32_16x16x32_bf16 v[192:195], a[196:199], v[36:39], v[192:195]
    ds_read_b128 a[96:99], v1 offset:512
    v_perm_b32 v41, v19, v18, s100
    v_mfma_f32_16x16x32_bf16 v[196:199], a[200:203], v[32:35], v[196:199]
    v_exp_f32 v21, v21
    v_mfma_f32_16x16x32_bf16 v[196:199], a[204:207], v[36:39], v[196:199]
    ds_read_b128 a[100:103], v1 offset:576
    v_mfma_f32_16x16x32_bf16 v[200:203], a[208:211], v[32:35], v[200:203]
    v_exp_f32 v22, v22
    v_mfma_f32_16x16x32_bf16 v[200:203], a[212:215], v[36:39], v[200:203]
    ds_read_b128 a[104:107], v1 offset:640
    v_perm_b32 v42, v21, v20, s100
    v_mfma_f32_16x16x32_bf16 v[204:207], a[216:219], v[32:35], v[204:207]
    v_exp_f32 v23, v23
    v_mfma_f32_16x16x32_bf16 v[204:207], a[220:223], v[36:39], v[204:207]
    ds_read_b128 a[108:111], v1 offset:704
    v_mfma_f32_16x16x32_bf16 v[208:211], a[224:227], v[32:35], v[208:211]
    v_exp_f32 v24, v24
    v_mfma_f32_16x16x32_bf16 v[208:211], a[228:231], v[36:39], v[208:211]
    ds_read_b128 a[112:115], v1 offset:768
    v_perm_b32 v43, v23, v22, s100
    v_mfma_f32_16x16x32_bf16 v[212:215], a[232:235], v[32:35], v[212:215]
    v_exp_f32 v25, v25
    v_mfma_f32_16x16x32_bf16 v[212:215], a[236:239], v[36:39], v[212:215]
    ds_read_b128 a[116:119], v1 offset:832
    v_mfma_f32_16x16x32_bf16 v[216:219], a[240:243], v[32:35], v[216:219]
    v_exp_f32 v26, v26
    v_mfma_f32_16x16x32_bf16 v[216:219], a[244:247], v[36:39], v[216:219]
    ds_read_b128 a[120:123], v1 offset:896
    v_perm_b32 v44, v25, v24, s100
    v_mfma_f32_16x16x32_bf16 v[220:223], a[248:251], v[32:35], v[220:223]
    v_exp_f32 v27, v27
    v_mfma_f32_16x16x32_bf16 v[220:223], a[252:255], v[36:39], v[220:223]
    ds_read_b128 a[124:127], v1 offset:960
    v_smfmac_f32_16x16x64_bf16 a[8:11], a[16:19], v[32:39], v11
    s_waitcnt lgkmcnt(12)
    v_mfma_f32_16x16x32_bf16 v[16:19], a[64:67], v[64:67], v[48:51]
    v_exp_f32 v28, v28
    v_mfma_f32_16x16x32_bf16 v[16:19], a[68:71], v[68:71], v[16:19]
    v_perm_b32 v45, v27, v26, s100
    v_mfma_f32_16x16x32_bf16 v[16:19], a[72:75], v[72:75], v[16:19]
    v_exp_f32 v29, v29
    v_mfma_f32_16x16x32_bf16 v[16:19], a[76:79], v[76:79], v[16:19]
    s_waitcnt lgkmcnt(8)
    v_mfma_f32_16x16x32_bf16 v[20:23], a[80:83], v[64:67], v[48:51]
    v_exp_f32 v30, v30
    v_mfma_f32_16x16x32_bf16 v[20:23], a[84:87], v[68:71], v[20:23]
    v_perm_b32 v46, v29, v28, s100
    v_mfma_f32_16x16x32_bf16 v[20:23], a[88:91], v[72:75], v[20:23]
    v_exp_f32 v31, v31
    v_mfma_f32_16x16x32_bf16 v[20:23], a[92:95], v[76:79], v[20:23]
    s_waitcnt lgkmcnt(4)
    v_mfma_f32_16x16x32_bf16 v[24:27], a[96:99], v[64:67], v[48:51]
    v_exp_f32 v16, v16
    v_mfma_f32_16x16x32_bf16 v[24:27], a[100:103], v[68:71], v[24:27]
    v_perm_b32 v47, v31, v30, s100
    v_mfma_f32_16x16x32_bf16 v[24:27], a[104:107], v[72:75], v[24:27]
    v_exp_f32 v17, v17
    v_mfma_f32_16x16x32_bf16 v[24:27], a[108:111], v[76:79], v[24:27]
    s_waitcnt lgkmcnt(0)
    v_mfma_f32_16x16x32_bf16 v[28:31], a[112:115], v[64:67], v[48:51]
    v_exp_f32 v18, v18
    v_mfma_f32_16x16x32_bf16 v[28:31], a[116:119], v[68:71], v[28:31]
    v_perm_b32 v32, v17, v16, s100
    v_mfma_f32_16x16x32_bf16 v[28:31], a[120:123], v[72:75], v[28:31]
    v_exp_f32 v19, v19
    v_mfma_f32_16x16x32_bf16 v[28:31], a[124:127], v[76:79], v[28:31]
    v_mfma_f32_16x16x32_bf16 v[224:227], a[192:195], v[40:43], v[224:227]
    v_exp_f32 v20, v20
    v_mfma_f32_16x16x32_bf16 v[224:227], a[196:199], v[44:47], v[224:227]
    ds_read_b64_tr_b16 a[192:193], v2 offset:36864
    v_perm_b32 v33, v19, v18, s100
    v_mfma_f32_16x16x32_bf16 v[228:231], a[200:203], v[40:43], v[228:231]
    v_exp_f32 v21, v21
    v_mfma_f32_16x16x32_bf16 v[228:231], a[204:207], v[44:47], v[228:231]
    ds_read_b64_tr_b16 a[194:195], v2 offset:37120
    v_mfma_f32_16x16x32_bf16 v[232:235], a[208:211], v[40:43], v[232:235]
    v_exp_f32 v22, v22
    v_mfma_f32_16x16x32_bf16 v[232:235], a[212:215], v[44:47], v[232:235]
    ds_read_b64_tr_b16 a[196:197], v2 offset:37376
    v_perm_b32 v34, v21, v20, s100
    v_mfma_f32_16x16x32_bf16 v[236:239], a[216:219], v[40:43], v[236:239]
    v_exp_f32 v23, v23
    v_mfma_f32_16x16x32_bf16 v[236:239], a[220:223], v[44:47], v[236:239]
    ds_read_b64_tr_b16 a[198:199], v2 offset:37632
    v_mfma_f32_16x16x32_bf16 v[240:243], a[224:227], v[40:43], v[240:243]
    v_exp_f32 v24, v24
    v_mfma_f32_16x16x32_bf16 v[240:243], a[228:231], v[44:47], v[240:243]
    ds_read_b64_tr_b16 a[200:201], v2 offset:36896
    v_perm_b32 v35, v23, v22, s100
    v_mfma_f32_16x16x32_bf16 v[244:247], a[232:235], v[40:43], v[244:247]
    v_exp_f32 v25, v25
    v_mfma_f32_16x16x32_bf16 v[244:247], a[236:239], v[44:47], v[244:247]
    ds_read_b64_tr_b16 a[202:203], v2 offset:37152
    v_mfma_f32_16x16x32_bf16 v[248:251], a[240:243], v[40:43], v[248:251]
    v_exp_f32 v26, v26
    v_mfma_f32_16x16x32_bf16 v[248:251], a[244:247], v[44:47], v[248:251]
    ds_read_b64_tr_b16 a[204:205], v2 offset:37408
    v_perm_b32 v36, v25, v24, s100
    v_mfma_f32_16x16x32_bf16 v[252:255], a[248:251], v[40:43], v[252:255]
    v_exp_f32 v27, v27
    v_mfma_f32_16x16x32_bf16 v[252:255], a[252:255], v[44:47], v[252:255]
    ds_read_b64_tr_b16 a[206:207], v2 offset:37664
    v_smfmac_f32_16x16x64_bf16 a[12:15], a[16:19], v[40:47], v11
    ds_read_b64_tr_b16 a[208:209], v2 offset:36928
    v_mfma_f32_16x16x32_bf16 v[16:19], a[64:67], v[80:83], v[52:55]
    v_exp_f32 v28, v28
    v_mfma_f32_16x16x32_bf16 v[16:19], a[68:71], v[84:87], v[16:19]
    ds_read_b64_tr_b16 a[210:211], v2 offset:37184
    v_perm_b32 v37, v27, v26, s100
    v_mfma_f32_16x16x32_bf16 v[16:19], a[72:75], v[88:91], v[16:19]
    v_exp_f32 v29, v29
    v_mfma_f32_16x16x32_bf16 v[16:19], a[76:79], v[92:95], v[16:19]
    ds_read_b64_tr_b16 a[212:213], v2 offset:37440
    v_mfma_f32_16x16x32_bf16 v[20:23], a[80:83], v[80:83], v[52:55]
    v_exp_f32 v30, v30
    v_mfma_f32_16x16x32_bf16 v[20:23], a[84:87], v[84:87], v[20:23]
    ds_read_b64_tr_b16 a[214:215], v2 offset:37696
    v_perm_b32 v38, v29, v28, s100
    v_mfma_f32_16x16x32_bf16 v[20:23], a[88:91], v[88:91], v[20:23]
    v_exp_f32 v31, v31
    v_mfma_f32_16x16x32_bf16 v[20:23], a[92:95], v[92:95], v[20:23]
    ds_read_b64_tr_b16 a[216:217], v2 offset:36960
    v_mfma_f32_16x16x32_bf16 v[24:27], a[96:99], v[80:83], v[52:55]
    v_exp_f32 v16, v16
    v_mfma_f32_16x16x32_bf16 v[24:27], a[100:103], v[84:87], v[24:27]
    ds_read_b64_tr_b16 a[218:219], v2 offset:37216
    v_perm_b32 v39, v31, v30, s100
    v_mfma_f32_16x16x32_bf16 v[24:27], a[104:107], v[88:91], v[24:27]
    v_exp_f32 v17, v17
    v_mfma_f32_16x16x32_bf16 v[24:27], a[108:111], v[92:95], v[24:27]
    ds_read_b64_tr_b16 a[220:221], v2 offset:37472
    v_mfma_f32_16x16x32_bf16 v[28:31], a[112:115], v[80:83], v[52:55]
    v_exp_f32 v18, v18
    v_mfma_f32_16x16x32_bf16 v[28:31], a[116:119], v[84:87], v[28:31]
    ds_read_b64_tr_b16 a[222:223], v2 offset:37728
    v_perm_b32 v40, v17, v16, s100
    v_mfma_f32_16x16x32_bf16 v[28:31], a[120:123], v[88:91], v[28:31]
    v_exp_f32 v19, v19
    v_mfma_f32_16x16x32_bf16 v[28:31], a[124:127], v[92:95], v[28:31]
    ds_read_b64_tr_b16 a[224:225], v2 offset:36992
    v_mfma_f32_16x16x32_bf16 v[128:131], a[128:131], v[32:35], v[128:131]
    v_exp_f32 v20, v20
    v_mfma_f32_16x16x32_bf16 v[128:131], a[132:135], v[36:39], v[128:131]
    ds_read_b64_tr_b16 a[226:227], v2 offset:37248
    v_perm_b32 v41, v19, v18, s100
    v_mfma_f32_16x16x32_bf16 v[132:135], a[136:139], v[32:35], v[132:135]
    v_exp_f32 v21, v21
    v_mfma_f32_16x16x32_bf16 v[132:135], a[140:143], v[36:39], v[132:135]
    ds_read_b64_tr_b16 a[228:229], v2 offset:37504
    v_mfma_f32_16x16x32_bf16 v[136:139], a[144:147], v[32:35], v[136:139]
    v_exp_f32 v22, v22
    v_mfma_f32_16x16x32_bf16 v[136:139], a[148:151], v[36:39], v[136:139]
    ds_read_b64_tr_b16 a[230:231], v2 offset:37760
    v_perm_b32 v42, v21, v20, s100
    v_mfma_f32_16x16x32_bf16 v[140:143], a[152:155], v[32:35], v[140:143]
    v_exp_f32 v23, v23
    v_mfma_f32_16x16x32_bf16 v[140:143], a[156:159], v[36:39], v[140:143]
    ds_read_b64_tr_b16 a[232:233], v2 offset:37024
    v_mfma_f32_16x16x32_bf16 v[144:147], a[160:163], v[32:35], v[144:147]
    v_exp_f32 v24, v24
    v_mfma_f32_16x16x32_bf16 v[144:147], a[164:167], v[36:39], v[144:147]
    ds_read_b64_tr_b16 a[234:235], v2 offset:37280
    v_perm_b32 v43, v23, v22, s100
    v_mfma_f32_16x16x32_bf16 v[148:151], a[168:171], v[32:35], v[148:151]
    v_exp_f32 v25, v25
    v_mfma_f32_16x16x32_bf16 v[148:151], a[172:175], v[36:39], v[148:151]
    ds_read_b64_tr_b16 a[236:237], v2 offset:37536
    v_mfma_f32_16x16x32_bf16 v[152:155], a[176:179], v[32:35], v[152:155]
    v_exp_f32 v26, v26
    v_mfma_f32_16x16x32_bf16 v[152:155], a[180:183], v[36:39], v[152:155]
    ds_read_b64_tr_b16 a[238:239], v2 offset:37792
    v_perm_b32 v44, v25, v24, s100
    v_mfma_f32_16x16x32_bf16 v[156:159], a[184:187], v[32:35], v[156:159]
    v_exp_f32 v27, v27
    v_mfma_f32_16x16x32_bf16 v[156:159], a[188:191], v[36:39], v[156:159]
    ds_read_b64_tr_b16 a[240:241], v2 offset:37056
    v_smfmac_f32_16x16x64_bf16 a[0:3], a[16:19], v[32:39], v11
    ds_read_b64_tr_b16 a[242:243], v2 offset:37312
    v_mfma_f32_16x16x32_bf16 v[16:19], a[64:67], v[96:99], v[56:59]
    v_exp_f32 v28, v28
    v_mfma_f32_16x16x32_bf16 v[16:19], a[68:71], v[100:103], v[16:19]
    ds_read_b64_tr_b16 a[244:245], v2 offset:37568
    v_perm_b32 v45, v27, v26, s100
    v_mfma_f32_16x16x32_bf16 v[16:19], a[72:75], v[104:107], v[16:19]
    v_exp_f32 v29, v29
    v_mfma_f32_16x16x32_bf16 v[16:19], a[76:79], v[108:111], v[16:19]
    ds_read_b64_tr_b16 a[246:247], v2 offset:37824
    v_mfma_f32_16x16x32_bf16 v[20:23], a[80:83], v[96:99], v[56:59]
    v_exp_f32 v30, v30
    v_mfma_f32_16x16x32_bf16 v[20:23], a[84:87], v[100:103], v[20:23]
    ds_read_b64_tr_b16 a[248:249], v2 offset:37088
    v_perm_b32 v46, v29, v28, s100
    v_mfma_f32_16x16x32_bf16 v[20:23], a[88:91], v[104:107], v[20:23]
    v_exp_f32 v31, v31
    v_mfma_f32_16x16x32_bf16 v[20:23], a[92:95], v[108:111], v[20:23]
    ds_read_b64_tr_b16 a[250:251], v2 offset:37344
    v_mfma_f32_16x16x32_bf16 v[24:27], a[96:99], v[96:99], v[56:59]
    v_exp_f32 v16, v16
    v_mfma_f32_16x16x32_bf16 v[24:27], a[100:103], v[100:103], v[24:27]
    ds_read_b64_tr_b16 a[252:253], v2 offset:37600
    v_perm_b32 v47, v31, v30, s100
    v_mfma_f32_16x16x32_bf16 v[24:27], a[104:107], v[104:107], v[24:27]
    v_exp_f32 v17, v17
    v_mfma_f32_16x16x32_bf16 v[24:27], a[108:111], v[108:111], v[24:27]
    ds_read_b64_tr_b16 a[254:255], v2 offset:37856
    v_mfma_f32_16x16x32_bf16 v[28:31], a[112:115], v[96:99], v[56:59]
    v_exp_f32 v18, v18
    v_mfma_f32_16x16x32_bf16 v[28:31], a[116:119], v[100:103], v[28:31]
    v_perm_b32 v32, v17, v16, s100
    v_mfma_f32_16x16x32_bf16 v[28:31], a[120:123], v[104:107], v[28:31]
    v_exp_f32 v19, v19
    v_mfma_f32_16x16x32_bf16 v[28:31], a[124:127], v[108:111], v[28:31]
    v_mfma_f32_16x16x32_bf16 v[160:163], a[128:131], v[40:43], v[160:163]
    v_exp_f32 v20, v20
    v_mfma_f32_16x16x32_bf16 v[160:163], a[132:135], v[44:47], v[160:163]
    v_perm_b32 v33, v19, v18, s100
    v_mfma_f32_16x16x32_bf16 v[164:167], a[136:139], v[40:43], v[164:167]
    v_exp_f32 v21, v21
    v_mfma_f32_16x16x32_bf16 v[164:167], a[140:143], v[44:47], v[164:167]
    v_mfma_f32_16x16x32_bf16 v[168:171], a[144:147], v[40:43], v[168:171]
    v_exp_f32 v22, v22
    v_mfma_f32_16x16x32_bf16 v[168:171], a[148:151], v[44:47], v[168:171]
    v_perm_b32 v34, v21, v20, s100
    v_mfma_f32_16x16x32_bf16 v[172:175], a[152:155], v[40:43], v[172:175]
    v_exp_f32 v23, v23
    v_mfma_f32_16x16x32_bf16 v[172:175], a[156:159], v[44:47], v[172:175]
    v_mfma_f32_16x16x32_bf16 v[176:179], a[160:163], v[40:43], v[176:179]
    v_exp_f32 v24, v24
    v_mfma_f32_16x16x32_bf16 v[176:179], a[164:167], v[44:47], v[176:179]
    v_perm_b32 v35, v23, v22, s100
    v_mfma_f32_16x16x32_bf16 v[180:183], a[168:171], v[40:43], v[180:183]
    v_exp_f32 v25, v25
    v_mfma_f32_16x16x32_bf16 v[180:183], a[172:175], v[44:47], v[180:183]
    v_mfma_f32_16x16x32_bf16 v[184:187], a[176:179], v[40:43], v[184:187]
    v_exp_f32 v26, v26
    v_mfma_f32_16x16x32_bf16 v[184:187], a[180:183], v[44:47], v[184:187]
    v_perm_b32 v36, v25, v24, s100
    v_mfma_f32_16x16x32_bf16 v[188:191], a[184:187], v[40:43], v[188:191]
    v_exp_f32 v27, v27
    v_mfma_f32_16x16x32_bf16 v[188:191], a[188:191], v[44:47], v[188:191]
    v_smfmac_f32_16x16x64_bf16 a[4:7], a[16:19], v[40:47], v11
    v_mfma_f32_16x16x32_bf16 v[16:19], a[64:67], v[112:115], v[60:63]
    v_exp_f32 v28, v28
    v_mfma_f32_16x16x32_bf16 v[16:19], a[68:71], v[116:119], v[16:19]
    ds_read_b128 a[64:67], v1 offset:36864
    v_perm_b32 v37, v27, v26, s100
    v_mfma_f32_16x16x32_bf16 v[16:19], a[72:75], v[120:123], v[16:19]
    v_exp_f32 v29, v29
    v_mfma_f32_16x16x32_bf16 v[16:19], a[76:79], v[124:127], v[16:19]
    ds_read_b128 a[68:71], v1 offset:36928
    v_mfma_f32_16x16x32_bf16 v[20:23], a[80:83], v[112:115], v[60:63]
    v_exp_f32 v30, v30
    v_mfma_f32_16x16x32_bf16 v[20:23], a[84:87], v[116:119], v[20:23]
    ds_read_b128 a[72:75], v1 offset:36992
    v_perm_b32 v38, v29, v28, s100
    v_mfma_f32_16x16x32_bf16 v[20:23], a[88:91], v[120:123], v[20:23]
    v_exp_f32 v31, v31
    v_mfma_f32_16x16x32_bf16 v[20:23], a[92:95], v[124:127], v[20:23]
    ds_read_b128 a[76:79], v1 offset:37056
    v_mfma_f32_16x16x32_bf16 v[24:27], a[96:99], v[112:115], v[60:63]
    v_exp_f32 v16, v16
    v_mfma_f32_16x16x32_bf16 v[24:27], a[100:103], v[116:119], v[24:27]
    ds_read_b128 a[80:83], v1 offset:37120
    v_perm_b32 v39, v31, v30, s100
    v_mfma_f32_16x16x32_bf16 v[24:27], a[104:107], v[120:123], v[24:27]
    v_exp_f32 v17, v17
    v_mfma_f32_16x16x32_bf16 v[24:27], a[108:111], v[124:127], v[24:27]
    ds_read_b128 a[84:87], v1 offset:37184
    v_mfma_f32_16x16x32_bf16 v[28:31], a[112:115], v[112:115], v[60:63]
    v_exp_f32 v18, v18
    v_mfma_f32_16x16x32_bf16 v[28:31], a[116:119], v[116:119], v[28:31]
    ds_read_b128 a[88:91], v1 offset:37248
    v_perm_b32 v40, v17, v16, s100
    v_mfma_f32_16x16x32_bf16 v[28:31], a[120:123], v[120:123], v[28:31]
    v_exp_f32 v19, v19
    v_mfma_f32_16x16x32_bf16 v[28:31], a[124:127], v[124:127], v[28:31]
    ds_read_b128 a[92:95], v1 offset:37312
    v_mfma_f32_16x16x32_bf16 v[192:195], a[128:131], v[32:35], v[192:195]
    v_exp_f32 v20, v20
    v_mfma_f32_16x16x32_bf16 v[192:195], a[132:135], v[36:39], v[192:195]
    ds_read_b128 a[96:99], v1 offset:37376
    v_perm_b32 v41, v19, v18, s100
    v_mfma_f32_16x16x32_bf16 v[196:199], a[136:139], v[32:35], v[196:199]
    v_exp_f32 v21, v21
    v_mfma_f32_16x16x32_bf16 v[196:199], a[140:143], v[36:39], v[196:199]
    ds_read_b128 a[100:103], v1 offset:37440
    v_mfma_f32_16x16x32_bf16 v[200:203], a[144:147], v[32:35], v[200:203]
    v_exp_f32 v22, v22
    v_mfma_f32_16x16x32_bf16 v[200:203], a[148:151], v[36:39], v[200:203]
    ds_read_b128 a[104:107], v1 offset:37504
    v_perm_b32 v42, v21, v20, s100
    v_mfma_f32_16x16x32_bf16 v[204:207], a[152:155], v[32:35], v[204:207]
    v_exp_f32 v23, v23
    v_mfma_f32_16x16x32_bf16 v[204:207], a[156:159], v[36:39], v[204:207]
    ds_read_b128 a[108:111], v1 offset:37568
    v_mfma_f32_16x16x32_bf16 v[208:211], a[160:163], v[32:35], v[208:211]
    v_exp_f32 v24, v24
    v_mfma_f32_16x16x32_bf16 v[208:211], a[164:167], v[36:39], v[208:211]
    ds_read_b128 a[112:115], v1 offset:37632
    v_perm_b32 v43, v23, v22, s100
    v_mfma_f32_16x16x32_bf16 v[212:215], a[168:171], v[32:35], v[212:215]
    v_exp_f32 v25, v25
    v_mfma_f32_16x16x32_bf16 v[212:215], a[172:175], v[36:39], v[212:215]
    ds_read_b128 a[116:119], v1 offset:37696
    v_mfma_f32_16x16x32_bf16 v[216:219], a[176:179], v[32:35], v[216:219]
    v_exp_f32 v26, v26
    v_mfma_f32_16x16x32_bf16 v[216:219], a[180:183], v[36:39], v[216:219]
    s_sub_u32 s49, s49, 1
    ds_read_b128 a[120:123], v1 offset:37760
    v_perm_b32 v44, v25, v24, s100
    v_mfma_f32_16x16x32_bf16 v[220:223], a[184:187], v[32:35], v[220:223]
    s_cmp_lg_u32 s49, 0
    v_exp_f32 v27, v27
    v_mfma_f32_16x16x32_bf16 v[220:223], a[188:191], v[36:39], v[220:223]
L2_pad5:
    s_cbranch_execz L2_pad9
    ds_read_b128 a[124:127], v1 offset:37824
    v_smfmac_f32_16x16x64_bf16 a[8:11], a[16:19], v[32:39], v11
    s_waitcnt lgkmcnt(12)
    s_cbranch_scc1 L2_loop
    v_mfma_f32_16x16x32_bf16 v[16:19], a[64:67], v[64:67], v[48:51]
    s_sub_u32 s47, s47, s48
    v_exp_f32 v28, v28
    v_mfma_f32_16x16x32_bf16 v[16:19], a[68:71], v[68:71], v[16:19]
    v_perm_b32 v45, v27, v26, s100
    v_add_u32 v1, s48, v1
    v_mfma_f32_16x16x32_bf16 v[16:19], a[72:75], v[72:75], v[16:19]
    v_exp_f32 v29, v29
    v_mfma_f32_16x16x32_bf16 v[16:19], a[76:79], v[76:79], v[16:19]
    s_waitcnt lgkmcnt(8)
    v_mfma_f32_16x16x32_bf16 v[20:23], a[80:83], v[64:67], v[48:51]
    v_exp_f32 v30, v30
    v_mfma_f32_16x16x32_bf16 v[20:23], a[84:87], v[68:71], v[20:23]
    v_perm_b32 v46, v29, v28, s100
    v_add_u32 v2, s48, v2
    v_mfma_f32_16x16x32_bf16 v[20:23], a[88:91], v[72:75], v[20:23]
    v_exp_f32 v31, v31
    v_mfma_f32_16x16x32_bf16 v[20:23], a[92:95], v[76:79], v[20:23]
    s_waitcnt lgkmcnt(4)
    v_mfma_f32_16x16x32_bf16 v[24:27], a[96:99], v[64:67], v[48:51]
    s_sub_u32 s48, 0, s48
    v_exp_f32 v16, v16
    v_mfma_f32_16x16x32_bf16 v[24:27], a[100:103], v[68:71], v[24:27]
    v_perm_b32 v47, v31, v30, s100
    v_mfma_f32_16x16x32_bf16 v[24:27], a[104:107], v[72:75], v[24:27]
    v_exp_f32 v17, v17
    v_mfma_f32_16x16x32_bf16 v[24:27], a[108:111], v[76:79], v[24:27]
    s_waitcnt lgkmcnt(0)
    v_mfma_f32_16x16x32_bf16 v[28:31], a[112:115], v[64:67], v[48:51]
    v_exp_f32 v18, v18
    v_mfma_f32_16x16x32_bf16 v[28:31], a[116:119], v[68:71], v[28:31]
    v_perm_b32 v32, v17, v16, s100
    v_mfma_f32_16x16x32_bf16 v[28:31], a[120:123], v[72:75], v[28:31]
    v_exp_f32 v19, v19
    v_mfma_f32_16x16x32_bf16 v[28:31], a[124:127], v[76:79], v[28:31]
    s_waitcnt vmcnt(0)
    s_barrier
    v_mfma_f32_16x16x32_bf16 v[224:227], a[128:131], v[40:43], v[224:227]
    v_exp_f32 v20, v20
    v_mfma_f32_16x16x32_bf16 v[224:227], a[132:135], v[44:47], v[224:227]
    ds_read_b64_tr_b16 a[128:129], v2 offset:0
    v_perm_b32 v33, v19, v18, s100
    v_mfma_f32_16x16x32_bf16 v[228:231], a[136:139], v[40:43], v[228:231]
    s_add_u32 m0, s47, 0
    v_exp_f32 v21, v21
    v_mfma_f32_16x16x32_bf16 v[228:231], a[140:143], v[44:47], v[228:231]
    s_add_u32 s46, s46, 16384
    buffer_load_dwordx4 off, s[16:19], s46 offset:0 lds
    v_mfma_f32_16x16x32_bf16 v[232:235], a[144:147], v[40:43], v[232:235]
    v_exp_f32 v22, v22
    v_mfma_f32_16x16x32_bf16 v[232:235], a[148:151], v[44:47], v[232:235]
    ds_read_b64_tr_b16 a[130:131], v2 offset:256
    v_perm_b32 v34, v21, v20, s100
    v_mfma_f32_16x16x32_bf16 v[236:239], a[152:155], v[40:43], v[236:239]
    s_add_u32 m0, s47, 32
    v_exp_f32 v23, v23
    v_mfma_f32_16x16x32_bf16 v[236:239], a[156:159], v[44:47], v[236:239]
    buffer_load_dwordx4 off, s[16:19], s46 offset:1024 lds
    v_mfma_f32_16x16x32_bf16 v[240:243], a[160:163], v[40:43], v[240:243]
    v_exp_f32 v24, v24
    v_mfma_f32_16x16x32_bf16 v[240:243], a[164:167], v[44:47], v[240:243]
    ds_read_b64_tr_b16 a[132:133], v2 offset:512
    v_perm_b32 v35, v23, v22, s100
    v_mfma_f32_16x16x32_bf16 v[244:247], a[168:171], v[40:43], v[244:247]
    s_add_u32 m0, s47, 64
    v_exp_f32 v25, v25
    v_mfma_f32_16x16x32_bf16 v[244:247], a[172:175], v[44:47], v[244:247]
    buffer_load_dwordx4 off, s[16:19], s46 offset:2048 lds
    v_mfma_f32_16x16x32_bf16 v[248:251], a[176:179], v[40:43], v[248:251]
    v_exp_f32 v26, v26
    v_mfma_f32_16x16x32_bf16 v[248:251], a[180:183], v[44:47], v[248:251]
    ds_read_b64_tr_b16 a[134:135], v2 offset:768
    v_perm_b32 v36, v25, v24, s100
    v_mfma_f32_16x16x32_bf16 v[252:255], a[184:187], v[40:43], v[252:255]
    s_add_u32 m0, s47, 96
    v_exp_f32 v27, v27
    v_mfma_f32_16x16x32_bf16 v[252:255], a[188:191], v[44:47], v[252:255]
    buffer_load_dwordx4 off, s[16:19], s46 offset:3072 lds
    v_smfmac_f32_16x16x64_bf16 a[12:15], a[16:19], v[40:47], v11
    ds_read_b64_tr_b16 a[136:137], v2 offset:32
    v_mfma_f32_16x16x32_bf16 v[16:19], a[64:67], v[80:83], v[52:55]
    v_exp_f32 v28, v28
    v_mfma_f32_16x16x32_bf16 v[16:19], a[68:71], v[84:87], v[16:19]
    ds_read_b64_tr_b16 a[138:139], v2 offset:288
    v_perm_b32 v37, v27, v26, s100
    v_mfma_f32_16x16x32_bf16 v[16:19], a[72:75], v[88:91], v[16:19]
    s_add_u32 m0, s47, 16896
    v_exp_f32 v29, v29
    v_mfma_f32_16x16x32_bf16 v[16:19], a[76:79], v[92:95], v[16:19]
    buffer_load_dwordx4 off, s[20:23], s46 offset:0 lds
    v_mfma_f32_16x16x32_bf16 v[20:23], a[80:83], v[80:83], v[52:55]
    v_exp_f32 v30, v30
    v_mfma_f32_16x16x32_bf16 v[20:23], a[84:87], v[84:87], v[20:23]
    ds_read_b64_tr_b16 a[140:141], v2 offset:544
    v_perm_b32 v38, v29, v28, s100
    v_mfma_f32_16x16x32_bf16 v[20:23], a[88:91], v[88:91], v[20:23]
    s_add_u32 m0, s47, 16928
    v_exp_f32 v31, v31
    v_mfma_f32_16x16x32_bf16 v[20:23], a[92:95], v[92:95], v[20:23]
    buffer_load_dwordx4 off, s[20:23], s46 offset:1024 lds
    v_mfma_f32_16x16x32_bf16 v[24:27], a[96:99], v[80:83], v[52:55]
    v_exp_f32 v16, v16
    v_mfma_f32_16x16x32_bf16 v[24:27], a[100:103], v[84:87], v[24:27]
    ds_read_b64_tr_b16 a[142:143], v2 offset:800
    v_perm_b32 v39, v31, v30, s100
    v_mfma_f32_16x16x32_bf16 v[24:27], a[104:107], v[88:91], v[24:27]
    s_add_u32 m0, s47, 16960
    v_exp_f32 v17, v17
    v_mfma_f32_16x16x32_bf16 v[24:27], a[108:111], v[92:95], v[24:27]
    buffer_load_dwordx4 off, s[20:23], s46 offset:2048 lds
    v_mfma_f32_16x16x32_bf16 v[28:31], a[112:115], v[80:83], v[52:55]
    v_exp_f32 v18, v18
    v_mfma_f32_16x16x32_bf16 v[28:31], a[116:119], v[84:87], v[28:31]
    ds_read_b64_tr_b16 a[144:145], v2 offset:64
    v_perm_b32 v40, v17, v16, s100
    v_mfma_f32_16x16x32_bf16 v[28:31], a[120:123], v[88:91], v[28:31]
    s_add_u32 m0, s47, 16992
    v_exp_f32 v19, v19
    v_mfma_f32_16x16x32_bf16 v[28:31], a[124:127], v[92:95], v[28:31]
    buffer_load_dwordx4 off, s[20:23], s46 offset:3072 lds
    v_mfma_f32_16x16x32_bf16 v[128:131], a[192:195], v[32:35], v[128:131]
    v_exp_f32 v20, v20
    v_mfma_f32_16x16x32_bf16 v[128:131], a[196:199], v[36:39], v[128:131]
    ds_read_b64_tr_b16 a[146:147], v2 offset:320
    v_perm_b32 v41, v19, v18, s100
    v_mfma_f32_16x16x32_bf16 v[132:135], a[200:203], v[32:35], v[132:135]
    v_exp_f32 v21, v21
    v_mfma_f32_16x16x32_bf16 v[132:135], a[204:207], v[36:39], v[132:135]
    ds_read_b64_tr_b16 a[148:149], v2 offset:576
    v_mfma_f32_16x16x32_bf16 v[136:139], a[208:211], v[32:35], v[136:139]
    v_exp_f32 v22, v22
    v_mfma_f32_16x16x32_bf16 v[136:139], a[212:215], v[36:39], v[136:139]
    ds_read_b64_tr_b16 a[150:151], v2 offset:832
    v_perm_b32 v42, v21, v20, s100
    v_mfma_f32_16x16x32_bf16 v[140:143], a[216:219], v[32:35], v[140:143]
    v_exp_f32 v23, v23
    v_mfma_f32_16x16x32_bf16 v[140:143], a[220:223], v[36:39], v[140:143]
    ds_read_b64_tr_b16 a[152:153], v2 offset:96
    ds_read_b64_tr_b16 a[154:155], v2 offset:352
    v_mfma_f32_16x16x32_bf16 v[144:147], a[224:227], v[32:35], v[144:147]
    v_exp_f32 v24, v24
    v_mfma_f32_16x16x32_bf16 v[144:147], a[228:231], v[36:39], v[144:147]
    ds_read_b64_tr_b16 a[156:157], v2 offset:608
    v_perm_b32 v43, v23, v22, s100
    v_mfma_f32_16x16x32_bf16 v[148:151], a[232:235], v[32:35], v[148:151]
    v_exp_f32 v25, v25
    v_mfma_f32_16x16x32_bf16 v[148:151], a[236:239], v[36:39], v[148:151]
    ds_read_b64_tr_b16 a[158:159], v2 offset:864
    ds_read_b64_tr_b16 a[160:161], v2 offset:128
    v_mfma_f32_16x16x32_bf16 v[152:155], a[240:243], v[32:35], v[152:155]
    v_exp_f32 v26, v26
    v_mfma_f32_16x16x32_bf16 v[152:155], a[244:247], v[36:39], v[152:155]
    ds_read_b64_tr_b16 a[162:163], v2 offset:384
    v_perm_b32 v44, v25, v24, s100
    v_mfma_f32_16x16x32_bf16 v[156:159], a[248:251], v[32:35], v[156:159]
    v_exp_f32 v27, v27
    v_mfma_f32_16x16x32_bf16 v[156:159], a[252:255], v[36:39], v[156:159]
    ds_read_b64_tr_b16 a[164:165], v2 offset:640
    ds_read_b64_tr_b16 a[166:167], v2 offset:896
    v_smfmac_f32_16x16x64_bf16 a[0:3], a[16:19], v[32:39], v11
    ds_read_b64_tr_b16 a[168:169], v2 offset:160
    ds_read_b64_tr_b16 a[170:171], v2 offset:416
    v_mfma_f32_16x16x32_bf16 v[16:19], a[64:67], v[96:99], v[56:59]
    v_exp_f32 v28, v28
    v_mfma_f32_16x16x32_bf16 v[16:19], a[68:71], v[100:103], v[16:19]
    ds_read_b64_tr_b16 a[172:173], v2 offset:672
    v_perm_b32 v45, v27, v26, s100
    v_mfma_f32_16x16x32_bf16 v[16:19], a[72:75], v[104:107], v[16:19]
    s_add_u32 m0, s47, 36864
    v_exp_f32 v29, v29
    v_mfma_f32_16x16x32_bf16 v[16:19], a[76:79], v[108:111], v[16:19]
    s_add_u32 s46, s46, 16384
    buffer_load_dwordx4 off, s[16:19], s46 offset:0 lds
    v_mfma_f32_16x16x32_bf16 v[20:23], a[80:83], v[96:99], v[56:59]
    v_exp_f32 v30, v30
    v_mfma_f32_16x16x32_bf16 v[20:23], a[84:87], v[100:103], v[20:23]
    ds_read_b64_tr_b16 a[174:175], v2 offset:928
    v_perm_b32 v46, v29, v28, s100
    v_mfma_f32_16x16x32_bf16 v[20:23], a[88:91], v[104:107], v[20:23]
    s_add_u32 m0, s47, 36896
    v_exp_f32 v31, v31
    v_mfma_f32_16x16x32_bf16 v[20:23], a[92:95], v[108:111], v[20:23]
    buffer_load_dwordx4 off, s[16:19], s46 offset:1024 lds
    v_mfma_f32_16x16x32_bf16 v[24:27], a[96:99], v[96:99], v[56:59]
    v_exp_f32 v16, v16
    v_mfma_f32_16x16x32_bf16 v[24:27], a[100:103], v[100:103], v[24:27]
    ds_read_b64_tr_b16 a[176:177], v2 offset:192
    v_perm_b32 v47, v31, v30, s100
    v_mfma_f32_16x16x32_bf16 v[24:27], a[104:107], v[104:107], v[24:27]
    s_add_u32 m0, s47, 36928
    v_exp_f32 v17, v17
    v_mfma_f32_16x16x32_bf16 v[24:27], a[108:111], v[108:111], v[24:27]
    buffer_load_dwordx4 off, s[16:19], s46 offset:2048 lds
    v_mfma_f32_16x16x32_bf16 v[28:31], a[112:115], v[96:99], v[56:59]
    v_exp_f32 v18, v18
    v_mfma_f32_16x16x32_bf16 v[28:31], a[116:119], v[100:103], v[28:31]
    ds_read_b64_tr_b16 a[178:179], v2 offset:448
    v_perm_b32 v32, v17, v16, s100
    v_mfma_f32_16x16x32_bf16 v[28:31], a[120:123], v[104:107], v[28:31]
    s_add_u32 m0, s47, 36960
    v_exp_f32 v19, v19
    v_mfma_f32_16x16x32_bf16 v[28:31], a[124:127], v[108:111], v[28:31]
    buffer_load_dwordx4 off, s[16:19], s46 offset:3072 lds
    v_mfma_f32_16x16x32_bf16 v[160:163], a[192:195], v[40:43], v[160:163]
    v_exp_f32 v20, v20
    v_mfma_f32_16x16x32_bf16 v[160:163], a[196:199], v[44:47], v[160:163]
    ds_read_b64_tr_b16 a[180:181], v2 offset:704
    v_perm_b32 v33, v19, v18, s100
    v_mfma_f32_16x16x32_bf16 v[164:167], a[200:203], v[40:43], v[164:167]
    s_add_u32 m0, s47, 53760
    v_exp_f32 v21, v21
    v_mfma_f32_16x16x32_bf16 v[164:167], a[204:207], v[44:47], v[164:167]
    buffer_load_dwordx4 off, s[20:23], s46 offset:0 lds
    v_mfma_f32_16x16x32_bf16 v[168:171], a[208:211], v[40:43], v[168:171]
    v_exp_f32 v22, v22
    v_mfma_f32_16x16x32_bf16 v[168:171], a[212:215], v[44:47], v[168:171]
    ds_read_b64_tr_b16 a[182:183], v2 offset:960
    v_perm_b32 v34, v21, v20, s100
    v_mfma_f32_16x16x32_bf16 v[172:175], a[216:219], v[40:43], v[172:175]
    s_add_u32 m0, s47, 53792
    v_exp_f32 v23, v23
    v_mfma_f32_16x16x32_bf16 v[172:175], a[220:223], v[44:47], v[172:175]
    buffer_load_dwordx4 off, s[20:23], s46 offset:1024 lds
    v_mfma_f32_16x16x32_bf16 v[176:179], a[224:227], v[40:43], v[176:179]
    v_exp_f32 v24, v24
    v_mfma_f32_16x16x32_bf16 v[176:179], a[228:231], v[44:47], v[176:179]
    ds_read_b64_tr_b16 a[184:185], v2 offset:224
    v_perm_b32 v35, v23, v22, s100
    v_mfma_f32_16x16x32_bf16 v[180:183], a[232:235], v[40:43], v[180:183]
    s_add_u32 m0, s47, 53824
    v_exp_f32 v25, v25
    v_mfma_f32_16x16x32_bf16 v[180:183], a[236:239], v[44:47], v[180:183]
    buffer_load_dwordx4 off, s[20:23], s46 offset:2048 lds
    v_mfma_f32_16x16x32_bf16 v[184:187], a[240:243], v[40:43], v[184:187]
    v_exp_f32 v26, v26
    v_mfma_f32_16x16x32_bf16 v[184:187], a[244:247], v[44:47], v[184:187]
    ds_read_b64_tr_b16 a[186:187], v2 offset:480
    v_perm_b32 v36, v25, v24, s100
    v_mfma_f32_16x16x32_bf16 v[188:191], a[248:251], v[40:43], v[188:191]
    s_add_u32 m0, s47, 53856
    v_exp_f32 v27, v27
    v_mfma_f32_16x16x32_bf16 v[188:191], a[252:255], v[44:47], v[188:191]
    buffer_load_dwordx4 off, s[20:23], s46 offset:3072 lds
    v_smfmac_f32_16x16x64_bf16 a[4:7], a[16:19], v[40:47], v11
    ds_read_b64_tr_b16 a[188:189], v2 offset:736
    ds_read_b64_tr_b16 a[190:191], v2 offset:992
    v_mfma_f32_16x16x32_bf16 v[16:19], a[64:67], v[112:115], v[60:63]
    v_exp_f32 v28, v28
    v_mfma_f32_16x16x32_bf16 v[16:19], a[68:71], v[116:119], v[16:19]
    ds_read_b128 a[64:67], v1 offset:0
    v_perm_b32 v37, v27, v26, s100
    v_mfma_f32_16x16x32_bf16 v[16:19], a[72:75], v[120:123], v[16:19]
    v_exp_f32 v29, v29
    v_mfma_f32_16x16x32_bf16 v[16:19], a[76:79], v[124:127], v[16:19]
    ds_read_b128 a[68:71], v1 offset:64
    v_mfma_f32_16x16x32_bf16 v[20:23], a[80:83], v[112:115], v[60:63]
    v_exp_f32 v30, v30
    v_mfma_f32_16x16x32_bf16 v[20:23], a[84:87], v[116:119], v[20:23]
    ds_read_b128 a[72:75], v1 offset:128
    v_perm_b32 v38, v29, v28, s100
    v_mfma_f32_16x16x32_bf16 v[20:23], a[88:91], v[120:123], v[20:23]
    v_exp_f32 v31, v31
    v_mfma_f32_16x16x32_bf16 v[20:23], a[92:95], v[124:127], v[20:23]
    ds_read_b128 a[76:79], v1 offset:192
    v_mfma_f32_16x16x32_bf16 v[24:27], a[96:99], v[112:115], v[60:63]
    v_exp_f32 v16, v16
    v_mfma_f32_16x16x32_bf16 v[24:27], a[100:103], v[116:119], v[24:27]
    ds_read_b128 a[80:83], v1 offset:256
    v_perm_b32 v39, v31, v30, s100
    v_mfma_f32_16x16x32_bf16 v[24:27], a[104:107], v[120:123], v[24:27]
    v_exp_f32 v17, v17
    v_mfma_f32_16x16x32_bf16 v[24:27], a[108:111], v[124:127], v[24:27]
    ds_read_b128 a[84:87], v1 offset:320
    v_mfma_f32_16x16x32_bf16 v[28:31], a[112:115], v[112:115], v[60:63]
    v_exp_f32 v18, v18
    v_mfma_f32_16x16x32_bf16 v[28:31], a[116:119], v[116:119], v[28:31]
    ds_read_b128 a[88:91], v1 offset:384
    v_perm_b32 v40, v17, v16, s100
    v_mfma_f32_16x16x32_bf16 v[28:31], a[120:123], v[120:123], v[28:31]
    v_exp_f32 v19, v19
    v_mfma_f32_16x16x32_bf16 v[28:31], a[124:127], v[124:127], v[28:31]
    ds_read_b128 a[92:95], v1 offset:448
    v_mfma_f32_16x16x32_bf16 v[192:195], a[192:195], v[32:35], v[192:195]
    v_exp_f32 v20, v20
    v_mfma_f32_16x16x32_bf16 v[192:195], a[196:199], v[36:39], v[192:195]
    ds_read_b128 a[96:99], v1 offset:512
    v_perm_b32 v41, v19, v18, s100
    v_mfma_f32_16x16x32_bf16 v[196:199], a[200:203], v[32:35], v[196:199]
    v_exp_f32 v21, v21
    v_mfma_f32_16x16x32_bf16 v[196:199], a[204:207], v[36:39], v[196:199]
    ds_read_b128 a[100:103], v1 offset:576
    v_mfma_f32_16x16x32_bf16 v[200:203], a[208:211], v[32:35], v[200:203]
    v_exp_f32 v22, v22
    v_mfma_f32_16x16x32_bf16 v[200:203], a[212:215], v[36:39], v[200:203]
    ds_read_b128 a[104:107], v1 offset:640
    v_perm_b32 v42, v21, v20, s100
    v_mfma_f32_16x16x32_bf16 v[204:207], a[216:219], v[32:35], v[204:207]
    v_exp_f32 v23, v23
    v_mfma_f32_16x16x32_bf16 v[204:207], a[220:223], v[36:39], v[204:207]
    ds_read_b128 a[108:111], v1 offset:704
    v_mfma_f32_16x16x32_bf16 v[208:211], a[224:227], v[32:35], v[208:211]
    v_exp_f32 v24, v24
    v_mfma_f32_16x16x32_bf16 v[208:211], a[228:231], v[36:39], v[208:211]
    ds_read_b128 a[112:115], v1 offset:768
    v_perm_b32 v43, v23, v22, s100
    v_mfma_f32_16x16x32_bf16 v[212:215], a[232:235], v[32:35], v[212:215]
    v_exp_f32 v25, v25
    v_mfma_f32_16x16x32_bf16 v[212:215], a[236:239], v[36:39], v[212:215]
    ds_read_b128 a[116:119], v1 offset:832
    v_mfma_f32_16x16x32_bf16 v[216:219], a[240:243], v[32:35], v[216:219]
    v_exp_f32 v26, v26
    v_mfma_f32_16x16x32_bf16 v[216:219], a[244:247], v[36:39], v[216:219]
    ds_read_b128 a[120:123], v1 offset:896
    v_perm_b32 v44, v25, v24, s100
    v_mfma_f32_16x16x32_bf16 v[220:223], a[248:251], v[32:35], v[220:223]
    v_exp_f32 v27, v27
    v_mfma_f32_16x16x32_bf16 v[220:223], a[252:255], v[36:39], v[220:223]
    ds_read_b128 a[124:127], v1 offset:960
    v_smfmac_f32_16x16x64_bf16 a[8:11], a[16:19], v[32:39], v11
    s_waitcnt lgkmcnt(12)
    v_mfma_f32_16x16x32_bf16 v[16:19], a[64:67], v[64:67], v[48:51]
    v_exp_f32 v28, v28
    v_mfma_f32_16x16x32_bf16 v[16:19], a[68:71], v[68:71], v[16:19]
    v_perm_b32 v45, v27, v26, s100
    v_mfma_f32_16x16x32_bf16 v[16:19], a[72:75], v[72:75], v[16:19]
    v_exp_f32 v29, v29
    v_mfma_f32_16x16x32_bf16 v[16:19], a[76:79], v[76:79], v[16:19]
    s_waitcnt lgkmcnt(8)
    global_load_dword a63, v12, s[4:5]
    v_mfma_f32_16x16x32_bf16 v[20:23], a[80:83], v[64:67], v[48:51]
    v_exp_f32 v30, v30
    v_mfma_f32_16x16x32_bf16 v[20:23], a[84:87], v[68:71], v[20:23]
    v_perm_b32 v46, v29, v28, s100
    v_mfma_f32_16x16x32_bf16 v[20:23], a[88:91], v[72:75], v[20:23]
    v_exp_f32 v31, v31
    v_mfma_f32_16x16x32_bf16 v[20:23], a[92:95], v[76:79], v[20:23]
    s_waitcnt lgkmcnt(4)
    v_mfma_f32_16x16x32_bf16 v[24:27], a[96:99], v[64:67], v[48:51]
    v_exp_f32 v16, v16
    v_mfma_f32_16x16x32_bf16 v[24:27], a[100:103], v[68:71], v[24:27]
    v_perm_b32 v47, v31, v30, s100
    v_mfma_f32_16x16x32_bf16 v[24:27], a[104:107], v[72:75], v[24:27]
    v_exp_f32 v17, v17
    v_mfma_f32_16x16x32_bf16 v[24:27], a[108:111], v[76:79], v[24:27]
    s_waitcnt lgkmcnt(0)
    global_load_dword a63, v14, s[10:11]
    v_mfma_f32_16x16x32_bf16 v[28:31], a[112:115], v[64:67], v[48:51]
    v_exp_f32 v18, v18
    v_mfma_f32_16x16x32_bf16 v[28:31], a[116:119], v[68:71], v[28:31]
    v_perm_b32 v32, v17, v16, s100
    v_mfma_f32_16x16x32_bf16 v[28:31], a[120:123], v[72:75], v[28:31]
    v_exp_f32 v19, v19
    v_mfma_f32_16x16x32_bf16 v[28:31], a[124:127], v[76:79], v[28:31]
    v_mfma_f32_16x16x32_bf16 v[224:227], a[192:195], v[40:43], v[224:227]
    v_exp_f32 v20, v20
    v_mfma_f32_16x16x32_bf16 v[224:227], a[196:199], v[44:47], v[224:227]
    ds_read_b64_tr_b16 a[192:193], v2 offset:36864
    v_perm_b32 v33, v19, v18, s100
    v_mfma_f32_16x16x32_bf16 v[228:231], a[200:203], v[40:43], v[228:231]
    v_exp_f32 v21, v21
    v_mfma_f32_16x16x32_bf16 v[228:231], a[204:207], v[44:47], v[228:231]
    ds_read_b64_tr_b16 a[194:195], v2 offset:37120
    v_mfma_f32_16x16x32_bf16 v[232:235], a[208:211], v[40:43], v[232:235]
    v_exp_f32 v22, v22
    v_mfma_f32_16x16x32_bf16 v[232:235], a[212:215], v[44:47], v[232:235]
    ds_read_b64_tr_b16 a[196:197], v2 offset:37376
    v_perm_b32 v34, v21, v20, s100
    v_mfma_f32_16x16x32_bf16 v[236:239], a[216:219], v[40:43], v[236:239]
    v_exp_f32 v23, v23
    v_mfma_f32_16x16x32_bf16 v[236:239], a[220:223], v[44:47], v[236:239]
    ds_read_b64_tr_b16 a[198:199], v2 offset:37632
    v_mfma_f32_16x16x32_bf16 v[240:243], a[224:227], v[40:43], v[240:243]
    v_exp_f32 v24, v24
    v_mfma_f32_16x16x32_bf16 v[240:243], a[228:231], v[44:47], v[240:243]
    ds_read_b64_tr_b16 a[200:201], v2 offset:36896
    v_perm_b32 v35, v23, v22, s100
    v_mfma_f32_16x16x32_bf16 v[244:247], a[232:235], v[40:43], v[244:247]
    v_exp_f32 v25, v25
    v_mfma_f32_16x16x32_bf16 v[244:247], a[236:239], v[44:47], v[244:247]
    ds_read_b64_tr_b16 a[202:203], v2 offset:37152
    v_mfma_f32_16x16x32_bf16 v[248:251], a[240:243], v[40:43], v[248:251]
    v_exp_f32 v26, v26
    v_mfma_f32_16x16x32_bf16 v[248:251], a[244:247], v[44:47], v[248:251]
    ds_read_b64_tr_b16 a[204:205], v2 offset:37408
    v_perm_b32 v36, v25, v24, s100
    v_mfma_f32_16x16x32_bf16 v[252:255], a[248:251], v[40:43], v[252:255]
    v_exp_f32 v27, v27
    v_mfma_f32_16x16x32_bf16 v[252:255], a[252:255], v[44:47], v[252:255]
    ds_read_b64_tr_b16 a[206:207], v2 offset:37664
    v_smfmac_f32_16x16x64_bf16 a[12:15], a[16:19], v[40:47], v11
    ds_read_b64_tr_b16 a[208:209], v2 offset:36928
    v_mfma_f32_16x16x32_bf16 v[16:19], a[64:67], v[80:83], v[52:55]
    v_exp_f32 v28, v28
    v_mfma_f32_16x16x32_bf16 v[16:19], a[68:71], v[84:87], v[16:19]
    ds_read_b64_tr_b16 a[210:211], v2 offset:37184
    v_perm_b32 v37, v27, v26, s100
    v_mfma_f32_16x16x32_bf16 v[16:19], a[72:75], v[88:91], v[16:19]
    v_exp_f32 v29, v29
    v_mfma_f32_16x16x32_bf16 v[16:19], a[76:79], v[92:95], v[16:19]
    ds_read_b64_tr_b16 a[212:213], v2 offset:37440
    v_mfma_f32_16x16x32_bf16 v[20:23], a[80:83], v[80:83], v[52:55]
    v_exp_f32 v30, v30
    v_mfma_f32_16x16x32_bf16 v[20:23], a[84:87], v[84:87], v[20:23]
    ds_read_b64_tr_b16 a[214:215], v2 offset:37696
    v_perm_b32 v38, v29, v28, s100
    v_mfma_f32_16x16x32_bf16 v[20:23], a[88:91], v[88:91], v[20:23]
    v_exp_f32 v31, v31
    v_mfma_f32_16x16x32_bf16 v[20:23], a[92:95], v[92:95], v[20:23]
    ds_read_b64_tr_b16 a[216:217], v2 offset:36960
    v_mfma_f32_16x16x32_bf16 v[24:27], a[96:99], v[80:83], v[52:55]
    v_exp_f32 v16, v16
    v_mfma_f32_16x16x32_bf16 v[24:27], a[100:103], v[84:87], v[24:27]
    ds_read_b64_tr_b16 a[218:219], v2 offset:37216
    v_perm_b32 v39, v31, v30, s100
    v_mfma_f32_16x16x32_bf16 v[24:27], a[104:107], v[88:91], v[24:27]
    v_exp_f32 v17, v17
    v_mfma_f32_16x16x32_bf16 v[24:27], a[108:111], v[92:95], v[24:27]
    ds_read_b64_tr_b16 a[220:221], v2 offset:37472
    v_mfma_f32_16x16x32_bf16 v[28:31], a[112:115], v[80:83], v[52:55]
    v_exp_f32 v18, v18
    v_mfma_f32_16x16x32_bf16 v[28:31], a[116:119], v[84:87], v[28:31]
    ds_read_b64_tr_b16 a[222:223], v2 offset:37728
    v_perm_b32 v40, v17, v16, s100
    v_mfma_f32_16x16x32_bf16 v[28:31], a[120:123], v[88:91], v[28:31]
    v_exp_f32 v19, v19
    v_mfma_f32_16x16x32_bf16 v[28:31], a[124:127], v[92:95], v[28:31]
    ds_read_b64_tr_b16 a[224:225], v2 offset:36992
    v_mfma_f32_16x16x32_bf16 v[128:131], a[128:131], v[32:35], v[128:131]
    v_exp_f32 v20, v20
    v_mfma_f32_16x16x32_bf16 v[128:131], a[132:135], v[36:39], v[128:131]
    ds_read_b64_tr_b16 a[226:227], v2 offset:37248
    v_perm_b32 v41, v19, v18, s100
    v_mfma_f32_16x16x32_bf16 v[132:135], a[136:139], v[32:35], v[132:135]
    v_exp_f32 v21, v21
    v_mfma_f32_16x16x32_bf16 v[132:135], a[140:143], v[36:39], v[132:135]
    ds_read_b64_tr_b16 a[228:229], v2 offset:37504
    v_mfma_f32_16x16x32_bf16 v[136:139], a[144:147], v[32:35], v[136:139]
    v_exp_f32 v22, v22
    v_mfma_f32_16x16x32_bf16 v[136:139], a[148:151], v[36:39], v[136:139]
    ds_read_b64_tr_b16 a[230:231], v2 offset:37760
    v_perm_b32 v42, v21, v20, s100
    v_mfma_f32_16x16x32_bf16 v[140:143], a[152:155], v[32:35], v[140:143]
    v_exp_f32 v23, v23
    v_mfma_f32_16x16x32_bf16 v[140:143], a[156:159], v[36:39], v[140:143]
    ds_read_b64_tr_b16 a[232:233], v2 offset:37024
    v_mfma_f32_16x16x32_bf16 v[144:147], a[160:163], v[32:35], v[144:147]
    v_exp_f32 v24, v24
    v_mfma_f32_16x16x32_bf16 v[144:147], a[164:167], v[36:39], v[144:147]
    ds_read_b64_tr_b16 a[234:235], v2 offset:37280
    v_perm_b32 v43, v23, v22, s100
    v_mfma_f32_16x16x32_bf16 v[148:151], a[168:171], v[32:35], v[148:151]
    v_exp_f32 v25, v25
    v_mfma_f32_16x16x32_bf16 v[148:151], a[172:175], v[36:39], v[148:151]
    ds_read_b64_tr_b16 a[236:237], v2 offset:37536
    v_mfma_f32_16x16x32_bf16 v[152:155], a[176:179], v[32:35], v[152:155]
    v_exp_f32 v26, v26
    v_mfma_f32_16x16x32_bf16 v[152:155], a[180:183], v[36:39], v[152:155]
    ds_read_b64_tr_b16 a[238:239], v2 offset:37792
    v_perm_b32 v44, v25, v24, s100
    v_mfma_f32_16x16x32_bf16 v[156:159], a[184:187], v[32:35], v[156:159]
    v_exp_f32 v27, v27
    v_mfma_f32_16x16x32_bf16 v[156:159], a[188:191], v[36:39], v[156:159]
    ds_read_b64_tr_b16 a[240:241], v2 offset:37056
    v_smfmac_f32_16x16x64_bf16 a[0:3], a[16:19], v[32:39], v11
    ds_read_b64_tr_b16 a[242:243], v2 offset:37312
    v_mfma_f32_16x16x32_bf16 v[16:19], a[64:67], v[96:99], v[56:59]
    v_exp_f32 v28, v28
    v_mfma_f32_16x16x32_bf16 v[16:19], a[68:71], v[100:103], v[16:19]
    ds_read_b64_tr_b16 a[244:245], v2 offset:37568
    v_perm_b32 v45, v27, v26, s100
    v_mfma_f32_16x16x32_bf16 v[16:19], a[72:75], v[104:107], v[16:19]
    v_exp_f32 v29, v29
    v_mfma_f32_16x16x32_bf16 v[16:19], a[76:79], v[108:111], v[16:19]
    ds_read_b64_tr_b16 a[246:247], v2 offset:37824
    v_mfma_f32_16x16x32_bf16 v[20:23], a[80:83], v[96:99], v[56:59]
    v_exp_f32 v30, v30
    v_mfma_f32_16x16x32_bf16 v[20:23], a[84:87], v[100:103], v[20:23]
    ds_read_b64_tr_b16 a[248:249], v2 offset:37088
    v_perm_b32 v46, v29, v28, s100
    v_mfma_f32_16x16x32_bf16 v[20:23], a[88:91], v[104:107], v[20:23]
    v_exp_f32 v31, v31
    v_mfma_f32_16x16x32_bf16 v[20:23], a[92:95], v[108:111], v[20:23]
    ds_read_b64_tr_b16 a[250:251], v2 offset:37344
    v_mfma_f32_16x16x32_bf16 v[24:27], a[96:99], v[96:99], v[56:59]
    v_exp_f32 v16, v16
    v_mfma_f32_16x16x32_bf16 v[24:27], a[100:103], v[100:103], v[24:27]
    ds_read_b64_tr_b16 a[252:253], v2 offset:37600
    v_perm_b32 v47, v31, v30, s100
    v_mfma_f32_16x16x32_bf16 v[24:27], a[104:107], v[104:107], v[24:27]
    v_exp_f32 v17, v17
    v_mfma_f32_16x16x32_bf16 v[24:27], a[108:111], v[108:111], v[24:27]
    ds_read_b64_tr_b16 a[254:255], v2 offset:37856
    v_mfma_f32_16x16x32_bf16 v[28:31], a[112:115], v[96:99], v[56:59]
    v_exp_f32 v18, v18
    v_mfma_f32_16x16x32_bf16 v[28:31], a[116:119], v[100:103], v[28:31]
    v_perm_b32 v32, v17, v16, s100
    v_mfma_f32_16x16x32_bf16 v[28:31], a[120:123], v[104:107], v[28:31]
    v_exp_f32 v19, v19
    v_mfma_f32_16x16x32_bf16 v[28:31], a[124:127], v[108:111], v[28:31]
    v_mfma_f32_16x16x32_bf16 v[160:163], a[128:131], v[40:43], v[160:163]
    v_exp_f32 v20, v20
    v_mfma_f32_16x16x32_bf16 v[160:163], a[132:135], v[44:47], v[160:163]
    v_perm_b32 v33, v19, v18, s100
    v_mfma_f32_16x16x32_bf16 v[164:167], a[136:139], v[40:43], v[164:167]
    v_exp_f32 v21, v21
    v_mfma_f32_16x16x32_bf16 v[164:167], a[140:143], v[44:47], v[164:167]
    v_mfma_f32_16x16x32_bf16 v[168:171], a[144:147], v[40:43], v[168:171]
    v_exp_f32 v22, v22
    v_mfma_f32_16x16x32_bf16 v[168:171], a[148:151], v[44:47], v[168:171]
    v_perm_b32 v34, v21, v20, s100
    v_mfma_f32_16x16x32_bf16 v[172:175], a[152:155], v[40:43], v[172:175]
    v_exp_f32 v23, v23
    v_mfma_f32_16x16x32_bf16 v[172:175], a[156:159], v[44:47], v[172:175]
    v_mfma_f32_16x16x32_bf16 v[176:179], a[160:163], v[40:43], v[176:179]
    v_exp_f32 v24, v24
    v_mfma_f32_16x16x32_bf16 v[176:179], a[164:167], v[44:47], v[176:179]
    v_perm_b32 v35, v23, v22, s100
    v_mfma_f32_16x16x32_bf16 v[180:183], a[168:171], v[40:43], v[180:183]
    v_exp_f32 v25, v25
    v_mfma_f32_16x16x32_bf16 v[180:183], a[172:175], v[44:47], v[180:183]
    v_mfma_f32_16x16x32_bf16 v[184:187], a[176:179], v[40:43], v[184:187]
    v_exp_f32 v26, v26
    v_mfma_f32_16x16x32_bf16 v[184:187], a[180:183], v[44:47], v[184:187]
    v_perm_b32 v36, v25, v24, s100
    v_mfma_f32_16x16x32_bf16 v[188:191], a[184:187], v[40:43], v[188:191]
    v_exp_f32 v27, v27
    v_mfma_f32_16x16x32_bf16 v[188:191], a[188:191], v[44:47], v[188:191]
    v_smfmac_f32_16x16x64_bf16 a[4:7], a[16:19], v[40:47], v11
    v_mfma_f32_16x16x32_bf16 v[16:19], a[64:67], v[112:115], v[60:63]
    v_exp_f32 v28, v28
    v_mfma_f32_16x16x32_bf16 v[16:19], a[68:71], v[116:119], v[16:19]
    ds_read_b128 a[64:67], v1 offset:36864
    v_perm_b32 v37, v27, v26, s100
    v_mfma_f32_16x16x32_bf16 v[16:19], a[72:75], v[120:123], v[16:19]
    v_exp_f32 v29, v29
    v_mfma_f32_16x16x32_bf16 v[16:19], a[76:79], v[124:127], v[16:19]
    ds_read_b128 a[68:71], v1 offset:36928
    v_mfma_f32_16x16x32_bf16 v[20:23], a[80:83], v[112:115], v[60:63]
    v_exp_f32 v30, v30
    v_mfma_f32_16x16x32_bf16 v[20:23], a[84:87], v[116:119], v[20:23]
    ds_read_b128 a[72:75], v1 offset:36992
    v_perm_b32 v38, v29, v28, s100
    v_mfma_f32_16x16x32_bf16 v[20:23], a[88:91], v[120:123], v[20:23]
    v_exp_f32 v31, v31
    v_mfma_f32_16x16x32_bf16 v[20:23], a[92:95], v[124:127], v[20:23]
    ds_read_b128 a[76:79], v1 offset:37056
    v_mfma_f32_16x16x32_bf16 v[24:27], a[96:99], v[112:115], v[60:63]
    v_exp_f32 v16, v16
    v_mfma_f32_16x16x32_bf16 v[24:27], a[100:103], v[116:119], v[24:27]
    ds_read_b128 a[80:83], v1 offset:37120
    v_perm_b32 v39, v31, v30, s100
    v_mfma_f32_16x16x32_bf16 v[24:27], a[104:107], v[120:123], v[24:27]
    v_exp_f32 v17, v17
    v_mfma_f32_16x16x32_bf16 v[24:27], a[108:111], v[124:127], v[24:27]
    ds_read_b128 a[84:87], v1 offset:37184
    v_mfma_f32_16x16x32_bf16 v[28:31], a[112:115], v[112:115], v[60:63]
    v_exp_f32 v18, v18
    v_mfma_f32_16x16x32_bf16 v[28:31], a[116:119], v[116:119], v[28:31]
    ds_read_b128 a[88:91], v1 offset:37248
    v_perm_b32 v40, v17, v16, s100
    v_mfma_f32_16x16x32_bf16 v[28:31], a[120:123], v[120:123], v[28:31]
    v_exp_f32 v19, v19
    v_mfma_f32_16x16x32_bf16 v[28:31], a[124:127], v[124:127], v[28:31]
    ds_read_b128 a[92:95], v1 offset:37312
    v_mfma_f32_16x16x32_bf16 v[192:195], a[128:131], v[32:35], v[192:195]
    v_exp_f32 v20, v20
    v_mfma_f32_16x16x32_bf16 v[192:195], a[132:135], v[36:39], v[192:195]
    ds_read_b128 a[96:99], v1 offset:37376
    v_perm_b32 v41, v19, v18, s100
    v_mfma_f32_16x16x32_bf16 v[196:199], a[136:139], v[32:35], v[196:199]
    v_exp_f32 v21, v21
    v_mfma_f32_16x16x32_bf16 v[196:199], a[140:143], v[36:39], v[196:199]
    ds_read_b128 a[100:103], v1 offset:37440
    v_mfma_f32_16x16x32_bf16 v[200:203], a[144:147], v[32:35], v[200:203]
    v_exp_f32 v22, v22
    v_mfma_f32_16x16x32_bf16 v[200:203], a[148:151], v[36:39], v[200:203]
L2_pad6:
    s_cbranch_execz L2_pad10
    ds_read_b128 a[104:107], v1 offset:37504
    v_perm_b32 v42, v21, v20, s100
    v_mfma_f32_16x16x32_bf16 v[204:207], a[152:155], v[32:35], v[204:207]
    v_exp_f32 v23, v23
    v_mfma_f32_16x16x32_bf16 v[204:207], a[156:159], v[36:39], v[204:207]
    ds_read_b128 a[108:111], v1 offset:37568
    v_mfma_f32_16x16x32_bf16 v[208:211], a[160:163], v[32:35], v[208:211]
    v_exp_f32 v24, v24
    v_mfma_f32_16x16x32_bf16 v[208:211], a[164:167], v[36:39], v[208:211]
    ds_read_b128 a[112:115], v1 offset:37632
    v_perm_b32 v43, v23, v22, s100
    v_mfma_f32_16x16x32_bf16 v[212:215], a[168:171], v[32:35], v[212:215]
    v_exp_f32 v25, v25
    v_mfma_f32_16x16x32_bf16 v[212:215], a[172:175], v[36:39], v[212:215]
    ds_read_b128 a[116:119], v1 offset:37696
    v_mfma_f32_16x16x32_bf16 v[216:219], a[176:179], v[32:35], v[216:219]
    v_exp_f32 v26, v26
    v_mfma_f32_16x16x32_bf16 v[216:219], a[180:183], v[36:39], v[216:219]
    ds_read_b128 a[120:123], v1 offset:37760
    v_perm_b32 v44, v25, v24, s100
    v_mfma_f32_16x16x32_bf16 v[220:223], a[184:187], v[32:35], v[220:223]
    v_exp_f32 v27, v27
    v_mfma_f32_16x16x32_bf16 v[220:223], a[188:191], v[36:39], v[220:223]
    ds_read_b128 a[124:127], v1 offset:37824
    v_smfmac_f32_16x16x64_bf16 a[8:11], a[16:19], v[32:39], v11
    s_waitcnt lgkmcnt(12)
    v_mfma_f32_16x16x32_bf16 v[16:19], a[64:67], v[64:67], v[48:51]
    s_sub_u32 s47, s47, s48
    v_exp_f32 v28, v28
    v_mfma_f32_16x16x32_bf16 v[16:19], a[68:71], v[68:71], v[16:19]
    v_perm_b32 v45, v27, v26, s100
    v_add_u32 v1, s48, v1
    v_mfma_f32_16x16x32_bf16 v[16:19], a[72:75], v[72:75], v[16:19]
    v_exp_f32 v29, v29
    v_mfma_f32_16x16x32_bf16 v[16:19], a[76:79], v[76:79], v[16:19]
    s_waitcnt lgkmcnt(8)
    v_mfma_f32_16x16x32_bf16 v[20:23], a[80:83], v[64:67], v[48:51]
    v_exp_f32 v30, v30
    v_mfma_f32_16x16x32_bf16 v[20:23], a[84:87], v[68:71], v[20:23]
    v_perm_b32 v46, v29, v28, s100
    v_add_u32 v2, s48, v2
    v_mfma_f32_16x16x32_bf16 v[20:23], a[88:91], v[72:75], v[20:23]
    v_exp_f32 v31, v31
    v_mfma_f32_16x16x32_bf16 v[20:23], a[92:95], v[76:79], v[20:23]
    s_waitcnt lgkmcnt(4)
    v_mfma_f32_16x16x32_bf16 v[24:27], a[96:99], v[64:67], v[48:51]
    s_sub_u32 s48, 0, s48
    v_exp_f32 v16, v16
    v_mfma_f32_16x16x32_bf16 v[24:27], a[100:103], v[68:71], v[24:27]
    v_perm_b32 v47, v31, v30, s100
    v_mfma_f32_16x16x32_bf16 v[24:27], a[104:107], v[72:75], v[24:27]
    v_exp_f32 v17, v17
    v_mfma_f32_16x16x32_bf16 v[24:27], a[108:111], v[76:79], v[24:27]
    s_waitcnt lgkmcnt(0)
    v_mfma_f32_16x16x32_bf16 v[28:31], a[112:115], v[64:67], v[48:51]
    v_exp_f32 v18, v18
    v_mfma_f32_16x16x32_bf16 v[28:31], a[116:119], v[68:71], v[28:31]
    v_perm_b32 v32, v17, v16, s100
    v_mfma_f32_16x16x32_bf16 v[28:31], a[120:123], v[72:75], v[28:31]
    v_exp_f32 v19, v19
    v_mfma_f32_16x16x32_bf16 v[28:31], a[124:127], v[76:79], v[28:31]
    s_waitcnt vmcnt(2)
    s_barrier
    v_mfma_f32_16x16x32_bf16 v[224:227], a[128:131], v[40:43], v[224:227]
    v_exp_f32 v20, v20
    v_mfma_f32_16x16x32_bf16 v[224:227], a[132:135], v[44:47], v[224:227]
    ds_read_b64_tr_b16 a[128:129], v2 offset:0
    v_perm_b32 v33, v19, v18, s100
    v_mfma_f32_16x16x32_bf16 v[228:231], a[136:139], v[40:43], v[228:231]
    s_add_u32 m0, s47, 0
    v_exp_f32 v21, v21
    v_mfma_f32_16x16x32_bf16 v[228:231], a[140:143], v[44:47], v[228:231]
    s_add_u32 s46, s46, 16384
    buffer_load_dwordx4 off, s[16:19], s46 offset:0 lds
    v_mfma_f32_16x16x32_bf16 v[232:235], a[144:147], v[40:43], v[232:235]
    v_exp_f32 v22, v22
    v_mfma_f32_16x16x32_bf16 v[232:235], a[148:151], v[44:47], v[232:235]
    ds_read_b64_tr_b16 a[130:131], v2 offset:256
    v_perm_b32 v34, v21, v20, s100
    v_mfma_f32_16x16x32_bf16 v[236:239], a[152:155], v[40:43], v[236:239]
    s_add_u32 m0, s47, 32
    v_exp_f32 v23, v23
    v_mfma_f32_16x16x32_bf16 v[236:239], a[156:159], v[44:47], v[236:239]
    buffer_load_dwordx4 off, s[16:19], s46 offset:1024 lds
    v_mfma_f32_16x16x32_bf16 v[240:243], a[160:163], v[40:43], v[240:243]
    v_exp_f32 v24, v24
    v_mfma_f32_16x16x32_bf16 v[240:243], a[164:167], v[44:47], v[240:243]
    ds_read_b64_tr_b16 a[132:133], v2 offset:512
    v_perm_b32 v35, v23, v22, s100
    v_mfma_f32_16x16x32_bf16 v[244:247], a[168:171], v[40:43], v[244:247]
    s_add_u32 m0, s47, 64
    v_exp_f32 v25, v25
    v_mfma_f32_16x16x32_bf16 v[244:247], a[172:175], v[44:47], v[244:247]
    buffer_load_dwordx4 off, s[16:19], s46 offset:2048 lds
    v_mfma_f32_16x16x32_bf16 v[248:251], a[176:179], v[40:43], v[248:251]
    v_exp_f32 v26, v26
    v_mfma_f32_16x16x32_bf16 v[248:251], a[180:183], v[44:47], v[248:251]
    ds_read_b64_tr_b16 a[134:135], v2 offset:768
    v_perm_b32 v36, v25, v24, s100
    v_mfma_f32_16x16x32_bf16 v[252:255], a[184:187], v[40:43], v[252:255]
    s_add_u32 m0, s47, 96
    v_exp_f32 v27, v27
    v_mfma_f32_16x16x32_bf16 v[252:255], a[188:191], v[44:47], v[252:255]
    buffer_load_dwordx4 off, s[16:19], s46 offset:3072 lds
    v_smfmac_f32_16x16x64_bf16 a[12:15], a[16:19], v[40:47], v11
    ds_read_b64_tr_b16 a[136:137], v2 offset:32
    v_mfma_f32_16x16x32_bf16 v[16:19], a[64:67], v[80:83], v[52:55]
    v_exp_f32 v28, v28
    v_mfma_f32_16x16x32_bf16 v[16:19], a[68:71], v[84:87], v[16:19]
    ds_read_b64_tr_b16 a[138:139], v2 offset:288
    v_perm_b32 v37, v27, v26, s100
    v_mfma_f32_16x16x32_bf16 v[16:19], a[72:75], v[88:91], v[16:19]
    s_add_u32 m0, s47, 16896
    v_exp_f32 v29, v29
    v_mfma_f32_16x16x32_bf16 v[16:19], a[76:79], v[92:95], v[16:19]
    buffer_load_dwordx4 off, s[20:23], s46 offset:0 lds
    v_mfma_f32_16x16x32_bf16 v[20:23], a[80:83], v[80:83], v[52:55]
    v_exp_f32 v30, v30
    v_mfma_f32_16x16x32_bf16 v[20:23], a[84:87], v[84:87], v[20:23]
    ds_read_b64_tr_b16 a[140:141], v2 offset:544
    v_perm_b32 v38, v29, v28, s100
    v_mfma_f32_16x16x32_bf16 v[20:23], a[88:91], v[88:91], v[20:23]
    s_add_u32 m0, s47, 16928
    v_exp_f32 v31, v31
    v_mfma_f32_16x16x32_bf16 v[20:23], a[92:95], v[92:95], v[20:23]
    buffer_load_dwordx4 off, s[20:23], s46 offset:1024 lds
    v_mfma_f32_16x16x32_bf16 v[24:27], a[96:99], v[80:83], v[52:55]
    v_exp_f32 v16, v16
    v_mfma_f32_16x16x32_bf16 v[24:27], a[100:103], v[84:87], v[24:27]
    ds_read_b64_tr_b16 a[142:143], v2 offset:800
    v_perm_b32 v39, v31, v30, s100
    v_mfma_f32_16x16x32_bf16 v[24:27], a[104:107], v[88:91], v[24:27]
    s_add_u32 m0, s47, 16960
    v_exp_f32 v17, v17
    v_mfma_f32_16x16x32_bf16 v[24:27], a[108:111], v[92:95], v[24:27]
    buffer_load_dwordx4 off, s[20:23], s46 offset:2048 lds
    v_mfma_f32_16x16x32_bf16 v[28:31], a[112:115], v[80:83], v[52:55]
    v_exp_f32 v18, v18
    v_mfma_f32_16x16x32_bf16 v[28:31], a[116:119], v[84:87], v[28:31]
    ds_read_b64_tr_b16 a[144:145], v2 offset:64
    v_perm_b32 v40, v17, v16, s100
    v_mfma_f32_16x16x32_bf16 v[28:31], a[120:123], v[88:91], v[28:31]
    s_add_u32 m0, s47, 16992
    v_exp_f32 v19, v19
    v_mfma_f32_16x16x32_bf16 v[28:31], a[124:127], v[92:95], v[28:31]
    buffer_load_dwordx4 off, s[20:23], s46 offset:3072 lds
    v_mfma_f32_16x16x32_bf16 v[128:131], a[192:195], v[32:35], v[128:131]
    v_exp_f32 v20, v20
    v_mfma_f32_16x16x32_bf16 v[128:131], a[196:199], v[36:39], v[128:131]
    ds_read_b64_tr_b16 a[146:147], v2 offset:320
    v_perm_b32 v41, v19, v18, s100
    v_mfma_f32_16x16x32_bf16 v[132:135], a[200:203], v[32:35], v[132:135]
    v_exp_f32 v21, v21
    v_mfma_f32_16x16x32_bf16 v[132:135], a[204:207], v[36:39], v[132:135]
    ds_read_b64_tr_b16 a[148:149], v2 offset:576
    v_mfma_f32_16x16x32_bf16 v[136:139], a[208:211], v[32:35], v[136:139]
    v_exp_f32 v22, v22
    v_mfma_f32_16x16x32_bf16 v[136:139], a[212:215], v[36:39], v[136:139]
    ds_read_b64_tr_b16 a[150:151], v2 offset:832
    v_perm_b32 v42, v21, v20, s100
    v_mfma_f32_16x16x32_bf16 v[140:143], a[216:219], v[32:35], v[140:143]
    v_exp_f32 v23, v23
    v_mfma_f32_16x16x32_bf16 v[140:143], a[220:223], v[36:39], v[140:143]
    ds_read_b64_tr_b16 a[152:153], v2 offset:96
    ds_read_b64_tr_b16 a[154:155], v2 offset:352
    v_mfma_f32_16x16x32_bf16 v[144:147], a[224:227], v[32:35], v[144:147]
    v_exp_f32 v24, v24
    v_mfma_f32_16x16x32_bf16 v[144:147], a[228:231], v[36:39], v[144:147]
    ds_read_b64_tr_b16 a[156:157], v2 offset:608
    v_perm_b32 v43, v23, v22, s100
    v_mfma_f32_16x16x32_bf16 v[148:151], a[232:235], v[32:35], v[148:151]
    v_exp_f32 v25, v25
    v_mfma_f32_16x16x32_bf16 v[148:151], a[236:239], v[36:39], v[148:151]
    ds_read_b64_tr_b16 a[158:159], v2 offset:864
    ds_read_b64_tr_b16 a[160:161], v2 offset:128
    v_mfma_f32_16x16x32_bf16 v[152:155], a[240:243], v[32:35], v[152:155]
    v_exp_f32 v26, v26
    v_mfma_f32_16x16x32_bf16 v[152:155], a[244:247], v[36:39], v[152:155]
    ds_read_b64_tr_b16 a[162:163], v2 offset:384
    v_perm_b32 v44, v25, v24, s100
    v_mfma_f32_16x16x32_bf16 v[156:159], a[248:251], v[32:35], v[156:159]
    v_exp_f32 v27, v27
    v_mfma_f32_16x16x32_bf16 v[156:159], a[252:255], v[36:39], v[156:159]
    ds_read_b64_tr_b16 a[164:165], v2 offset:640
    ds_read_b64_tr_b16 a[166:167], v2 offset:896
    v_smfmac_f32_16x16x64_bf16 a[0:3], a[16:19], v[32:39], v11
    ds_read_b64_tr_b16 a[168:169], v2 offset:160
    ds_read_b64_tr_b16 a[170:171], v2 offset:416
    v_mfma_f32_16x16x32_bf16 v[16:19], a[64:67], v[96:99], v[56:59]
    v_exp_f32 v28, v28
    v_mfma_f32_16x16x32_bf16 v[16:19], a[68:71], v[100:103], v[16:19]
    ds_read_b64_tr_b16 a[172:173], v2 offset:672
    v_perm_b32 v45, v27, v26, s100
    v_mfma_f32_16x16x32_bf16 v[16:19], a[72:75], v[104:107], v[16:19]
    s_add_u32 m0, s47, 36864
    v_exp_f32 v29, v29
    v_mfma_f32_16x16x32_bf16 v[16:19], a[76:79], v[108:111], v[16:19]
    s_add_u32 s46, s46, 16384
    buffer_load_dwordx4 off, s[16:19], s46 offset:0 lds
    v_mfma_f32_16x16x32_bf16 v[20:23], a[80:83], v[96:99], v[56:59]
    v_exp_f32 v30, v30
    v_mfma_f32_16x16x32_bf16 v[20:23], a[84:87], v[100:103], v[20:23]
    ds_read_b64_tr_b16 a[174:175], v2 offset:928
    v_perm_b32 v46, v29, v28, s100
    v_mfma_f32_16x16x32_bf16 v[20:23], a[88:91], v[104:107], v[20:23]
    s_add_u32 m0, s47, 36896
    v_exp_f32 v31, v31
    v_mfma_f32_16x16x32_bf16 v[20:23], a[92:95], v[108:111], v[20:23]
    buffer_load_dwordx4 off, s[16:19], s46 offset:1024 lds
    v_mfma_f32_16x16x32_bf16 v[24:27], a[96:99], v[96:99], v[56:59]
    v_exp_f32 v16, v16
    v_mfma_f32_16x16x32_bf16 v[24:27], a[100:103], v[100:103], v[24:27]
    ds_read_b64_tr_b16 a[176:177], v2 offset:192
    v_perm_b32 v47, v31, v30, s100
    v_mfma_f32_16x16x32_bf16 v[24:27], a[104:107], v[104:107], v[24:27]
    s_add_u32 m0, s47, 36928
    v_exp_f32 v17, v17
    v_mfma_f32_16x16x32_bf16 v[24:27], a[108:111], v[108:111], v[24:27]
    buffer_load_dwordx4 off, s[16:19], s46 offset:2048 lds
    v_mfma_f32_16x16x32_bf16 v[28:31], a[112:115], v[96:99], v[56:59]
    v_exp_f32 v18, v18
    v_mfma_f32_16x16x32_bf16 v[28:31], a[116:119], v[100:103], v[28:31]
    ds_read_b64_tr_b16 a[178:179], v2 offset:448
    v_perm_b32 v32, v17, v16, s100
    v_mfma_f32_16x16x32_bf16 v[28:31], a[120:123], v[104:107], v[28:31]
    s_add_u32 m0, s47, 36960
    v_exp_f32 v19, v19
    v_mfma_f32_16x16x32_bf16 v[28:31], a[124:127], v[108:111], v[28:31]
    buffer_load_dwordx4 off, s[16:19], s46 offset:3072 lds
    v_mfma_f32_16x16x32_bf16 v[160:163], a[192:195], v[40:43], v[160:163]
    v_exp_f32 v20, v20
    v_mfma_f32_16x16x32_bf16 v[160:163], a[196:199], v[44:47], v[160:163]
    ds_read_b64_tr_b16 a[180:181], v2 offset:704
    v_perm_b32 v33, v19, v18, s100
    v_mfma_f32_16x16x32_bf16 v[164:167], a[200:203], v[40:43], v[164:167]
    s_add_u32 m0, s47, 53760
    v_exp_f32 v21, v21
    v_mfma_f32_16x16x32_bf16 v[164:167], a[204:207], v[44:47], v[164:167]
    buffer_load_dwordx4 off, s[20:23], s46 offset:0 lds
    v_mfma_f32_16x16x32_bf16 v[168:171], a[208:211], v[40:43], v[168:171]
    v_exp_f32 v22, v22
    v_mfma_f32_16x16x32_bf16 v[168:171], a[212:215], v[44:47], v[168:171]
    ds_read_b64_tr_b16 a[182:183], v2 offset:960
    v_perm_b32 v34, v21, v20, s100
    v_mfma_f32_16x16x32_bf16 v[172:175], a[216:219], v[40:43], v[172:175]
    s_add_u32 m0, s47, 53792
    v_exp_f32 v23, v23
    v_mfma_f32_16x16x32_bf16 v[172:175], a[220:223], v[44:47], v[172:175]
    buffer_load_dwordx4 off, s[20:23], s46 offset:1024 lds
    v_mfma_f32_16x16x32_bf16 v[176:179], a[224:227], v[40:43], v[176:179]
    v_exp_f32 v24, v24
    v_mfma_f32_16x16x32_bf16 v[176:179], a[228:231], v[44:47], v[176:179]
    ds_read_b64_tr_b16 a[184:185], v2 offset:224
    v_perm_b32 v35, v23, v22, s100
    v_mfma_f32_16x16x32_bf16 v[180:183], a[232:235], v[40:43], v[180:183]
    s_add_u32 m0, s47, 53824
    v_exp_f32 v25, v25
    v_mfma_f32_16x16x32_bf16 v[180:183], a[236:239], v[44:47], v[180:183]
    buffer_load_dwordx4 off, s[20:23], s46 offset:2048 lds
    v_mfma_f32_16x16x32_bf16 v[184:187], a[240:243], v[40:43], v[184:187]
    v_exp_f32 v26, v26
    v_mfma_f32_16x16x32_bf16 v[184:187], a[244:247], v[44:47], v[184:187]
    ds_read_b64_tr_b16 a[186:187], v2 offset:480
    v_perm_b32 v36, v25, v24, s100
    v_mfma_f32_16x16x32_bf16 v[188:191], a[248:251], v[40:43], v[188:191]
    s_add_u32 m0, s47, 53856
    v_exp_f32 v27, v27
    v_mfma_f32_16x16x32_bf16 v[188:191], a[252:255], v[44:47], v[188:191]
    buffer_load_dwordx4 off, s[20:23], s46 offset:3072 lds
    v_smfmac_f32_16x16x64_bf16 a[4:7], a[16:19], v[40:47], v11
    ds_read_b64_tr_b16 a[188:189], v2 offset:736
    ds_read_b64_tr_b16 a[190:191], v2 offset:992
    v_mfma_f32_16x16x32_bf16 v[16:19], a[64:67], v[112:115], v[60:63]
    v_exp_f32 v28, v28
    v_mfma_f32_16x16x32_bf16 v[16:19], a[68:71], v[116:119], v[16:19]
    ds_read_b128 a[64:67], v1 offset:0
    v_perm_b32 v37, v27, v26, s100
    v_mfma_f32_16x16x32_bf16 v[16:19], a[72:75], v[120:123], v[16:19]
    v_exp_f32 v29, v29
    v_mfma_f32_16x16x32_bf16 v[16:19], a[76:79], v[124:127], v[16:19]
    ds_read_b128 a[68:71], v1 offset:64
    v_mfma_f32_16x16x32_bf16 v[20:23], a[80:83], v[112:115], v[60:63]
    v_exp_f32 v30, v30
    v_mfma_f32_16x16x32_bf16 v[20:23], a[84:87], v[116:119], v[20:23]
    ds_read_b128 a[72:75], v1 offset:128
    v_perm_b32 v38, v29, v28, s100
    v_mfma_f32_16x16x32_bf16 v[20:23], a[88:91], v[120:123], v[20:23]
    v_exp_f32 v31, v31
    v_mfma_f32_16x16x32_bf16 v[20:23], a[92:95], v[124:127], v[20:23]
    ds_read_b128 a[76:79], v1 offset:192
    v_mfma_f32_16x16x32_bf16 v[24:27], a[96:99], v[112:115], v[60:63]
    v_exp_f32 v16, v16
    v_mfma_f32_16x16x32_bf16 v[24:27], a[100:103], v[116:119], v[24:27]
    ds_read_b128 a[80:83], v1 offset:256
    v_perm_b32 v39, v31, v30, s100
    v_mfma_f32_16x16x32_bf16 v[24:27], a[104:107], v[120:123], v[24:27]
    v_exp_f32 v17, v17
    v_mfma_f32_16x16x32_bf16 v[24:27], a[108:111], v[124:127], v[24:27]
    ds_read_b128 a[84:87], v1 offset:320
    v_mfma_f32_16x16x32_bf16 v[28:31], a[112:115], v[112:115], v[60:63]
    v_exp_f32 v18, v18
    v_mfma_f32_16x16x32_bf16 v[28:31], a[116:119], v[116:119], v[28:31]
    ds_read_b128 a[88:91], v1 offset:384
    v_perm_b32 v40, v17, v16, s100
    v_mfma_f32_16x16x32_bf16 v[28:31], a[120:123], v[120:123], v[28:31]
    v_exp_f32 v19, v19
    v_mfma_f32_16x16x32_bf16 v[28:31], a[124:127], v[124:127], v[28:31]
    ds_read_b128 a[92:95], v1 offset:448
    v_mfma_f32_16x16x32_bf16 v[192:195], a[192:195], v[32:35], v[192:195]
    v_exp_f32 v20, v20
    v_mfma_f32_16x16x32_bf16 v[192:195], a[196:199], v[36:39], v[192:195]
    ds_read_b128 a[96:99], v1 offset:512
    v_perm_b32 v41, v19, v18, s100
    v_mfma_f32_16x16x32_bf16 v[196:199], a[200:203], v[32:35], v[196:199]
    v_exp_f32 v21, v21
    v_mfma_f32_16x16x32_bf16 v[196:199], a[204:207], v[36:39], v[196:199]
    ds_read_b128 a[100:103], v1 offset:576
    v_mfma_f32_16x16x32_bf16 v[200:203], a[208:211], v[32:35], v[200:203]
    v_exp_f32 v22, v22
    v_mfma_f32_16x16x32_bf16 v[200:203], a[212:215], v[36:39], v[200:203]
    ds_read_b128 a[104:107], v1 offset:640
    v_perm_b32 v42, v21, v20, s100
    v_mfma_f32_16x16x32_bf16 v[204:207], a[216:219], v[32:35], v[204:207]
    v_exp_f32 v23, v23
    v_mfma_f32_16x16x32_bf16 v[204:207], a[220:223], v[36:39], v[204:207]
    ds_read_b128 a[108:111], v1 offset:704
    v_mfma_f32_16x16x32_bf16 v[208:211], a[224:227], v[32:35], v[208:211]
    v_exp_f32 v24, v24
    v_mfma_f32_16x16x32_bf16 v[208:211], a[228:231], v[36:39], v[208:211]
    ds_read_b128 a[112:115], v1 offset:768
    v_perm_b32 v43, v23, v22, s100
    v_mfma_f32_16x16x32_bf16 v[212:215], a[232:235], v[32:35], v[212:215]
    v_exp_f32 v25, v25
    v_mfma_f32_16x16x32_bf16 v[212:215], a[236:239], v[36:39], v[212:215]
    ds_read_b128 a[116:119], v1 offset:832
    v_mfma_f32_16x16x32_bf16 v[216:219], a[240:243], v[32:35], v[216:219]
    v_exp_f32 v26, v26
    v_mfma_f32_16x16x32_bf16 v[216:219], a[244:247], v[36:39], v[216:219]
    ds_read_b128 a[120:123], v1 offset:896
    v_perm_b32 v44, v25, v24, s100
    v_mfma_f32_16x16x32_bf16 v[220:223], a[248:251], v[32:35], v[220:223]
    v_exp_f32 v27, v27
    v_mfma_f32_16x16x32_bf16 v[220:223], a[252:255], v[36:39], v[220:223]
    ds_read_b128 a[124:127], v1 offset:960
    v_smfmac_f32_16x16x64_bf16 a[8:11], a[16:19], v[32:39], v11
    s_waitcnt lgkmcnt(12)
    v_mfma_f32_16x16x32_bf16 v[16:19], a[64:67], v[64:67], v[48:51]
    v_exp_f32 v28, v28
    v_mfma_f32_16x16x32_bf16 v[16:19], a[68:71], v[68:71], v[16:19]
    v_perm_b32 v45, v27, v26, s100
    v_mfma_f32_16x16x32_bf16 v[16:19], a[72:75], v[72:75], v[16:19]
    v_exp_f32 v29, v29
    v_mfma_f32_16x16x32_bf16 v[16:19], a[76:79], v[76:79], v[16:19]
    s_waitcnt lgkmcnt(8)
    global_load_dword a63, v15, s[10:11]
    v_mfma_f32_16x16x32_bf16 v[20:23], a[80:83], v[64:67], v[48:51]
    v_exp_f32 v30, v30
    v_mfma_f32_16x16x32_bf16 v[20:23], a[84:87], v[68:71], v[20:23]
    v_perm_b32 v46, v29, v28, s100
    v_mfma_f32_16x16x32_bf16 v[20:23], a[88:91], v[72:75], v[20:23]
    v_exp_f32 v31, v31
    v_mfma_f32_16x16x32_bf16 v[20:23], a[92:95], v[76:79], v[20:23]
    s_waitcnt lgkmcnt(4)
    v_mfma_f32_16x16x32_bf16 v[24:27], a[96:99], v[64:67], v[48:51]
    v_exp_f32 v16, v16
    v_mfma_f32_16x16x32_bf16 v[24:27], a[100:103], v[68:71], v[24:27]
    v_perm_b32 v47, v31, v30, s100
    v_mfma_f32_16x16x32_bf16 v[24:27], a[104:107], v[72:75], v[24:27]
    v_exp_f32 v17, v17
    v_mfma_f32_16x16x32_bf16 v[24:27], a[108:111], v[76:79], v[24:27]
    s_waitcnt lgkmcnt(0)
    global_load_dword a63, v12, s[6:7]
    v_mfma_f32_16x16x32_bf16 v[28:31], a[112:115], v[64:67], v[48:51]
    v_exp_f32 v18, v18
    v_mfma_f32_16x16x32_bf16 v[28:31], a[116:119], v[68:71], v[28:31]
    v_perm_b32 v32, v17, v16, s100
    v_mfma_f32_16x16x32_bf16 v[28:31], a[120:123], v[72:75], v[28:31]
    v_exp_f32 v19, v19
    v_mfma_f32_16x16x32_bf16 v[28:31], a[124:127], v[76:79], v[28:31]
    v_mfma_f32_16x16x32_bf16 v[224:227], a[192:195], v[40:43], v[224:227]
    v_exp_f32 v20, v20
    v_mfma_f32_16x16x32_bf16 v[224:227], a[196:199], v[44:47], v[224:227]
    ds_read_b64_tr_b16 a[192:193], v2 offset:36864
    v_perm_b32 v33, v19, v18, s100
    v_mfma_f32_16x16x32_bf16 v[228:231], a[200:203], v[40:43], v[228:231]
    v_exp_f32 v21, v21
    v_mfma_f32_16x16x32_bf16 v[228:231], a[204:207], v[44:47], v[228:231]
    ds_read_b64_tr_b16 a[194:195], v2 offset:37120
    v_mfma_f32_16x16x32_bf16 v[232:235], a[208:211], v[40:43], v[232:235]
    v_exp_f32 v22, v22
    v_mfma_f32_16x16x32_bf16 v[232:235], a[212:215], v[44:47], v[232:235]
    ds_read_b64_tr_b16 a[196:197], v2 offset:37376
    v_perm_b32 v34, v21, v20, s100
    v_mfma_f32_16x16x32_bf16 v[236:239], a[216:219], v[40:43], v[236:239]
    v_exp_f32 v23, v23
    v_mfma_f32_16x16x32_bf16 v[236:239], a[220:223], v[44:47], v[236:239]
    ds_read_b64_tr_b16 a[198:199], v2 offset:37632
    v_mfma_f32_16x16x32_bf16 v[240:243], a[224:227], v[40:43], v[240:243]
    v_exp_f32 v24, v24
    v_mfma_f32_16x16x32_bf16 v[240:243], a[228:231], v[44:47], v[240:243]
    ds_read_b64_tr_b16 a[200:201], v2 offset:36896
    v_perm_b32 v35, v23, v22, s100
    v_mfma_f32_16x16x32_bf16 v[244:247], a[232:235], v[40:43], v[244:247]
    v_exp_f32 v25, v25
    v_mfma_f32_16x16x32_bf16 v[244:247], a[236:239], v[44:47], v[244:247]
    ds_read_b64_tr_b16 a[202:203], v2 offset:37152
    v_mfma_f32_16x16x32_bf16 v[248:251], a[240:243], v[40:43], v[248:251]
    v_exp_f32 v26, v26
    v_mfma_f32_16x16x32_bf16 v[248:251], a[244:247], v[44:47], v[248:251]
    ds_read_b64_tr_b16 a[204:205], v2 offset:37408
    v_perm_b32 v36, v25, v24, s100
    v_mfma_f32_16x16x32_bf16 v[252:255], a[248:251], v[40:43], v[252:255]
    v_exp_f32 v27, v27
    v_mfma_f32_16x16x32_bf16 v[252:255], a[252:255], v[44:47], v[252:255]
    ds_read_b64_tr_b16 a[206:207], v2 offset:37664
    v_smfmac_f32_16x16x64_bf16 a[12:15], a[16:19], v[40:47], v11
    ds_read_b64_tr_b16 a[208:209], v2 offset:36928
    v_mfma_f32_16x16x32_bf16 v[16:19], a[64:67], v[80:83], v[52:55]
    v_exp_f32 v28, v28
    v_mfma_f32_16x16x32_bf16 v[16:19], a[68:71], v[84:87], v[16:19]
    ds_read_b64_tr_b16 a[210:211], v2 offset:37184
    v_perm_b32 v37, v27, v26, s100
    v_mfma_f32_16x16x32_bf16 v[16:19], a[72:75], v[88:91], v[16:19]
    v_exp_f32 v29, v29
    v_mfma_f32_16x16x32_bf16 v[16:19], a[76:79], v[92:95], v[16:19]
    ds_read_b64_tr_b16 a[212:213], v2 offset:37440
    v_mfma_f32_16x16x32_bf16 v[20:23], a[80:83], v[80:83], v[52:55]
    v_exp_f32 v30, v30
    v_mfma_f32_16x16x32_bf16 v[20:23], a[84:87], v[84:87], v[20:23]
    ds_read_b64_tr_b16 a[214:215], v2 offset:37696
    v_perm_b32 v38, v29, v28, s100
    v_mfma_f32_16x16x32_bf16 v[20:23], a[88:91], v[88:91], v[20:23]
    v_exp_f32 v31, v31
    v_mfma_f32_16x16x32_bf16 v[20:23], a[92:95], v[92:95], v[20:23]
    ds_read_b64_tr_b16 a[216:217], v2 offset:36960
    v_mfma_f32_16x16x32_bf16 v[24:27], a[96:99], v[80:83], v[52:55]
    v_exp_f32 v16, v16
    v_mfma_f32_16x16x32_bf16 v[24:27], a[100:103], v[84:87], v[24:27]
    ds_read_b64_tr_b16 a[218:219], v2 offset:37216
    v_perm_b32 v39, v31, v30, s100
    v_mfma_f32_16x16x32_bf16 v[24:27], a[104:107], v[88:91], v[24:27]
    v_exp_f32 v17, v17
    v_mfma_f32_16x16x32_bf16 v[24:27], a[108:111], v[92:95], v[24:27]
    ds_read_b64_tr_b16 a[220:221], v2 offset:37472
    v_mfma_f32_16x16x32_bf16 v[28:31], a[112:115], v[80:83], v[52:55]
    v_exp_f32 v18, v18
    v_mfma_f32_16x16x32_bf16 v[28:31], a[116:119], v[84:87], v[28:31]
    ds_read_b64_tr_b16 a[222:223], v2 offset:37728
    v_perm_b32 v40, v17, v16, s100
    v_mfma_f32_16x16x32_bf16 v[28:31], a[120:123], v[88:91], v[28:31]
    v_exp_f32 v19, v19
    v_mfma_f32_16x16x32_bf16 v[28:31], a[124:127], v[92:95], v[28:31]
    ds_read_b64_tr_b16 a[224:225], v2 offset:36992
    v_mfma_f32_16x16x32_bf16 v[128:131], a[128:131], v[32:35], v[128:131]
    v_exp_f32 v20, v20
    v_mfma_f32_16x16x32_bf16 v[128:131], a[132:135], v[36:39], v[128:131]
    ds_read_b64_tr_b16 a[226:227], v2 offset:37248
    v_perm_b32 v41, v19, v18, s100
    v_mfma_f32_16x16x32_bf16 v[132:135], a[136:139], v[32:35], v[132:135]
    v_exp_f32 v21, v21
    v_mfma_f32_16x16x32_bf16 v[132:135], a[140:143], v[36:39], v[132:135]
    ds_read_b64_tr_b16 a[228:229], v2 offset:37504
    v_mfma_f32_16x16x32_bf16 v[136:139], a[144:147], v[32:35], v[136:139]
    v_exp_f32 v22, v22
    v_mfma_f32_16x16x32_bf16 v[136:139], a[148:151], v[36:39], v[136:139]
    ds_read_b64_tr_b16 a[230:231], v2 offset:37760
    v_perm_b32 v42, v21, v20, s100
    v_mfma_f32_16x16x32_bf16 v[140:143], a[152:155], v[32:35], v[140:143]
    v_exp_f32 v23, v23
    v_mfma_f32_16x16x32_bf16 v[140:143], a[156:159], v[36:39], v[140:143]
    ds_read_b64_tr_b16 a[232:233], v2 offset:37024
    v_mfma_f32_16x16x32_bf16 v[144:147], a[160:163], v[32:35], v[144:147]
    v_exp_f32 v24, v24
    v_mfma_f32_16x16x32_bf16 v[144:147], a[164:167], v[36:39], v[144:147]
    ds_read_b64_tr_b16 a[234:235], v2 offset:37280
    v_perm_b32 v43, v23, v22, s100
    v_mfma_f32_16x16x32_bf16 v[148:151], a[168:171], v[32:35], v[148:151]
    v_exp_f32 v25, v25
    v_mfma_f32_16x16x32_bf16 v[148:151], a[172:175], v[36:39], v[148:151]
    ds_read_b64_tr_b16 a[236:237], v2 offset:37536
    v_mfma_f32_16x16x32_bf16 v[152:155], a[176:179], v[32:35], v[152:155]
    v_exp_f32 v26, v26
    v_mfma_f32_16x16x32_bf16 v[152:155], a[180:183], v[36:39], v[152:155]
    ds_read_b64_tr_b16 a[238:239], v2 offset:37792
    v_perm_b32 v44, v25, v24, s100
    v_mfma_f32_16x16x32_bf16 v[156:159], a[184:187], v[32:35], v[156:159]
    v_exp_f32 v27, v27
    v_mfma_f32_16x16x32_bf16 v[156:159], a[188:191], v[36:39], v[156:159]
    ds_read_b64_tr_b16 a[240:241], v2 offset:37056
    v_smfmac_f32_16x16x64_bf16 a[0:3], a[16:19], v[32:39], v11
    ds_read_b64_tr_b16 a[242:243], v2 offset:37312
    v_mfma_f32_16x16x32_bf16 v[16:19], a[64:67], v[96:99], v[56:59]
    v_exp_f32 v28, v28
    v_mfma_f32_16x16x32_bf16 v[16:19], a[68:71], v[100:103], v[16:19]
    ds_read_b64_tr_b16 a[244:245], v2 offset:37568
    v_perm_b32 v45, v27, v26, s100
    v_mfma_f32_16x16x32_bf16 v[16:19], a[72:75], v[104:107], v[16:19]
    v_exp_f32 v29, v29
    v_mfma_f32_16x16x32_bf16 v[16:19], a[76:79], v[108:111], v[16:19]
    ds_read_b64_tr_b16 a[246:247], v2 offset:37824
    v_mfma_f32_16x16x32_bf16 v[20:23], a[80:83], v[96:99], v[56:59]
    v_exp_f32 v30, v30
    v_mfma_f32_16x16x32_bf16 v[20:23], a[84:87], v[100:103], v[20:23]
    ds_read_b64_tr_b16 a[248:249], v2 offset:37088
    v_perm_b32 v46, v29, v28, s100
    v_mfma_f32_16x16x32_bf16 v[20:23], a[88:91], v[104:107], v[20:23]
    v_exp_f32 v31, v31
    v_mfma_f32_16x16x32_bf16 v[20:23], a[92:95], v[108:111], v[20:23]
    ds_read_b64_tr_b16 a[250:251], v2 offset:37344
    v_mfma_f32_16x16x32_bf16 v[24:27], a[96:99], v[96:99], v[56:59]
    v_exp_f32 v16, v16
    v_mfma_f32_16x16x32_bf16 v[24:27], a[100:103], v[100:103], v[24:27]
    ds_read_b64_tr_b16 a[252:253], v2 offset:37600
    v_perm_b32 v47, v31, v30, s100
    v_mfma_f32_16x16x32_bf16 v[24:27], a[104:107], v[104:107], v[24:27]
    v_exp_f32 v17, v17
    v_mfma_f32_16x16x32_bf16 v[24:27], a[108:111], v[108:111], v[24:27]
    ds_read_b64_tr_b16 a[254:255], v2 offset:37856
    v_mfma_f32_16x16x32_bf16 v[28:31], a[112:115], v[96:99], v[56:59]
    v_exp_f32 v18, v18
    v_mfma_f32_16x16x32_bf16 v[28:31], a[116:119], v[100:103], v[28:31]
    v_perm_b32 v32, v17, v16, s100
    v_mfma_f32_16x16x32_bf16 v[28:31], a[120:123], v[104:107], v[28:31]
    v_exp_f32 v19, v19
    v_mfma_f32_16x16x32_bf16 v[28:31], a[124:127], v[108:111], v[28:31]
    v_mfma_f32_16x16x32_bf16 v[160:163], a[128:131], v[40:43], v[160:163]
    v_exp_f32 v20, v20
    v_mfma_f32_16x16x32_bf16 v[160:163], a[132:135], v[44:47], v[160:163]
    v_perm_b32 v33, v19, v18, s100
    v_mfma_f32_16x16x32_bf16 v[164:167], a[136:139], v[40:43], v[164:167]
    v_exp_f32 v21, v21
    v_mfma_f32_16x16x32_bf16 v[164:167], a[140:143], v[44:47], v[164:167]
    v_mfma_f32_16x16x32_bf16 v[168:171], a[144:147], v[40:43], v[168:171]
    v_exp_f32 v22, v22
    v_mfma_f32_16x16x32_bf16 v[168:171], a[148:151], v[44:47], v[168:171]
    v_perm_b32 v34, v21, v20, s100
    v_mfma_f32_16x16x32_bf16 v[172:175], a[152:155], v[40:43], v[172:175]
    v_exp_f32 v23, v23
    v_mfma_f32_16x16x32_bf16 v[172:175], a[156:159], v[44:47], v[172:175]
    v_mfma_f32_16x16x32_bf16 v[176:179], a[160:163], v[40:43], v[176:179]
    v_exp_f32 v24, v24
    v_mfma_f32_16x16x32_bf16 v[176:179], a[164:167], v[44:47], v[176:179]
    v_perm_b32 v35, v23, v22, s100
    v_mfma_f32_16x16x32_bf16 v[180:183], a[168:171], v[40:43], v[180:183]
    v_exp_f32 v25, v25
    v_mfma_f32_16x16x32_bf16 v[180:183], a[172:175], v[44:47], v[180:183]
    v_mfma_f32_16x16x32_bf16 v[184:187], a[176:179], v[40:43], v[184:187]
    v_exp_f32 v26, v26
    v_mfma_f32_16x16x32_bf16 v[184:187], a[180:183], v[44:47], v[184:187]
    v_perm_b32 v36, v25, v24, s100
    v_mfma_f32_16x16x32_bf16 v[188:191], a[184:187], v[40:43], v[188:191]
    v_exp_f32 v27, v27
    v_mfma_f32_16x16x32_bf16 v[188:191], a[188:191], v[44:47], v[188:191]
    v_smfmac_f32_16x16x64_bf16 a[4:7], a[16:19], v[40:47], v11
    v_mfma_f32_16x16x32_bf16 v[16:19], a[64:67], v[112:115], v[60:63]
    v_exp_f32 v28, v28
    v_mfma_f32_16x16x32_bf16 v[16:19], a[68:71], v[116:119], v[16:19]
    ds_read_b128 a[64:67], v1 offset:36864
    v_perm_b32 v37, v27, v26, s100
    v_mfma_f32_16x16x32_bf16 v[16:19], a[72:75], v[120:123], v[16:19]
    v_exp_f32 v29, v29
    v_mfma_f32_16x16x32_bf16 v[16:19], a[76:79], v[124:127], v[16:19]
    ds_read_b128 a[68:71], v1 offset:36928
    v_mfma_f32_16x16x32_bf16 v[20:23], a[80:83], v[112:115], v[60:63]
    v_exp_f32 v30, v30
    v_mfma_f32_16x16x32_bf16 v[20:23], a[84:87], v[116:119], v[20:23]
    ds_read_b128 a[72:75], v1 offset:36992
    v_perm_b32 v38, v29, v28, s100
    v_mfma_f32_16x16x32_bf16 v[20:23], a[88:91], v[120:123], v[20:23]
    v_exp_f32 v31, v31
    v_mfma_f32_16x16x32_bf16 v[20:23], a[92:95], v[124:127], v[20:23]
    ds_read_b128 a[76:79], v1 offset:37056
    v_mfma_f32_16x16x32_bf16 v[24:27], a[96:99], v[112:115], v[60:63]
    v_exp_f32 v16, v16
    v_mfma_f32_16x16x32_bf16 v[24:27], a[100:103], v[116:119], v[24:27]
    ds_read_b128 a[80:83], v1 offset:37120
    v_perm_b32 v39, v31, v30, s100
    v_mfma_f32_16x16x32_bf16 v[24:27], a[104:107], v[120:123], v[24:27]
    v_exp_f32 v17, v17
    v_mfma_f32_16x16x32_bf16 v[24:27], a[108:111], v[124:127], v[24:27]
    ds_read_b128 a[84:87], v1 offset:37184
    v_mfma_f32_16x16x32_bf16 v[28:31], a[112:115], v[112:115], v[60:63]
L2_pad7:
    s_cbranch_execz L2_pad11
    v_exp_f32 v18, v18
    v_mfma_f32_16x16x32_bf16 v[28:31], a[116:119], v[116:119], v[28:31]
    ds_read_b128 a[88:91], v1 offset:37248
    v_perm_b32 v40, v17, v16, s100
    v_mfma_f32_16x16x32_bf16 v[28:31], a[120:123], v[120:123], v[28:31]
    v_exp_f32 v19, v19
    v_mfma_f32_16x16x32_bf16 v[28:31], a[124:127], v[124:127], v[28:31]
    ds_read_b128 a[92:95], v1 offset:37312
    v_mfma_f32_16x16x32_bf16 v[192:195], a[128:131], v[32:35], v[192:195]
    v_exp_f32 v20, v20
    v_mfma_f32_16x16x32_bf16 v[192:195], a[132:135], v[36:39], v[192:195]
    ds_read_b128 a[96:99], v1 offset:37376
    v_perm_b32 v41, v19, v18, s100
    v_mfma_f32_16x16x32_bf16 v[196:199], a[136:139], v[32:35], v[196:199]
    v_exp_f32 v21, v21
    v_mfma_f32_16x16x32_bf16 v[196:199], a[140:143], v[36:39], v[196:199]
    ds_read_b128 a[100:103], v1 offset:37440
    v_mfma_f32_16x16x32_bf16 v[200:203], a[144:147], v[32:35], v[200:203]
    v_exp_f32 v22, v22
    v_mfma_f32_16x16x32_bf16 v[200:203], a[148:151], v[36:39], v[200:203]
    ds_read_b128 a[104:107], v1 offset:37504
    v_perm_b32 v42, v21, v20, s100
    v_mfma_f32_16x16x32_bf16 v[204:207], a[152:155], v[32:35], v[204:207]
    v_exp_f32 v23, v23
    v_mfma_f32_16x16x32_bf16 v[204:207], a[156:159], v[36:39], v[204:207]
    ds_read_b128 a[108:111], v1 offset:37568
    v_mfma_f32_16x16x32_bf16 v[208:211], a[160:163], v[32:35], v[208:211]
    v_exp_f32 v24, v24
    v_mfma_f32_16x16x32_bf16 v[208:211], a[164:167], v[36:39], v[208:211]
    ds_read_b128 a[112:115], v1 offset:37632
    v_perm_b32 v43, v23, v22, s100
    v_mfma_f32_16x16x32_bf16 v[212:215], a[168:171], v[32:35], v[212:215]
    v_exp_f32 v25, v25
    v_mfma_f32_16x16x32_bf16 v[212:215], a[172:175], v[36:39], v[212:215]
    ds_read_b128 a[116:119], v1 offset:37696
    v_mfma_f32_16x16x32_bf16 v[216:219], a[176:179], v[32:35], v[216:219]
    v_exp_f32 v26, v26
    v_mfma_f32_16x16x32_bf16 v[216:219], a[180:183], v[36:39], v[216:219]
    ds_read_b128 a[120:123], v1 offset:37760
    v_perm_b32 v44, v25, v24, s100
    v_mfma_f32_16x16x32_bf16 v[220:223], a[184:187], v[32:35], v[220:223]
    v_exp_f32 v27, v27
    v_mfma_f32_16x16x32_bf16 v[220:223], a[188:191], v[36:39], v[220:223]
    ds_read_b128 a[124:127], v1 offset:37824
    v_smfmac_f32_16x16x64_bf16 a[8:11], a[16:19], v[32:39], v11
    s_waitcnt lgkmcnt(12)
    v_mfma_f32_16x16x32_bf16 v[16:19], a[64:67], v[64:67], v[48:51]
    s_sub_u32 s47, s47, s48
    v_exp_f32 v28, v28
    v_mfma_f32_16x16x32_bf16 v[16:19], a[68:71], v[68:71], v[16:19]
    v_perm_b32 v45, v27, v26, s100
    v_add_u32 v1, s48, v1
    v_mfma_f32_16x16x32_bf16 v[16:19], a[72:75], v[72:75], v[16:19]
    v_exp_f32 v29, v29
    v_mfma_f32_16x16x32_bf16 v[16:19], a[76:79], v[76:79], v[16:19]
    s_waitcnt lgkmcnt(8)
    v_mfma_f32_16x16x32_bf16 v[20:23], a[80:83], v[64:67], v[48:51]
    v_exp_f32 v30, v30
    v_mfma_f32_16x16x32_bf16 v[20:23], a[84:87], v[68:71], v[20:23]
    v_perm_b32 v46, v29, v28, s100
    v_add_u32 v2, s48, v2
    v_mfma_f32_16x16x32_bf16 v[20:23], a[88:91], v[72:75], v[20:23]
    v_exp_f32 v31, v31
    v_mfma_f32_16x16x32_bf16 v[20:23], a[92:95], v[76:79], v[20:23]
    s_waitcnt lgkmcnt(4)
    v_mfma_f32_16x16x32_bf16 v[24:27], a[96:99], v[64:67], v[48:51]
    s_sub_u32 s48, 0, s48
    v_exp_f32 v16, v16
    v_mfma_f32_16x16x32_bf16 v[24:27], a[100:103], v[68:71], v[24:27]
    v_perm_b32 v47, v31, v30, s100
    v_mfma_f32_16x16x32_bf16 v[24:27], a[104:107], v[72:75], v[24:27]
    v_exp_f32 v17, v17
    v_mfma_f32_16x16x32_bf16 v[24:27], a[108:111], v[76:79], v[24:27]
    s_waitcnt lgkmcnt(0)
    v_mfma_f32_16x16x32_bf16 v[28:31], a[112:115], v[64:67], v[48:51]
    v_exp_f32 v18, v18
    v_mfma_f32_16x16x32_bf16 v[28:31], a[116:119], v[68:71], v[28:31]
    v_perm_b32 v32, v17, v16, s100
    v_mfma_f32_16x16x32_bf16 v[28:31], a[120:123], v[72:75], v[28:31]
    v_exp_f32 v19, v19
    v_mfma_f32_16x16x32_bf16 v[28:31], a[124:127], v[76:79], v[28:31]
    s_waitcnt vmcnt(2)
    s_barrier
    v_mfma_f32_16x16x32_bf16 v[224:227], a[128:131], v[40:43], v[224:227]
    v_exp_f32 v20, v20
    v_mfma_f32_16x16x32_bf16 v[224:227], a[132:135], v[44:47], v[224:227]
    ds_read_b64_tr_b16 a[128:129], v2 offset:0
    v_perm_b32 v33, v19, v18, s100
    v_mfma_f32_16x16x32_bf16 v[228:231], a[136:139], v[40:43], v[228:231]
    s_add_u32 m0, s47, 0
    v_exp_f32 v21, v21
    v_mfma_f32_16x16x32_bf16 v[228:231], a[140:143], v[44:47], v[228:231]
    s_add_u32 s46, s46, 16384
    buffer_load_dwordx4 off, s[16:19], s46 offset:0 lds
    v_mfma_f32_16x16x32_bf16 v[232:235], a[144:147], v[40:43], v[232:235]
    v_exp_f32 v22, v22
    v_mfma_f32_16x16x32_bf16 v[232:235], a[148:151], v[44:47], v[232:235]
    ds_read_b64_tr_b16 a[130:131], v2 offset:256
    v_perm_b32 v34, v21, v20, s100
    v_mfma_f32_16x16x32_bf16 v[236:239], a[152:155], v[40:43], v[236:239]
    s_add_u32 m0, s47, 32
    v_exp_f32 v23, v23
    v_mfma_f32_16x16x32_bf16 v[236:239], a[156:159], v[44:47], v[236:239]
    buffer_load_dwordx4 off, s[16:19], s46 offset:1024 lds
    v_mfma_f32_16x16x32_bf16 v[240:243], a[160:163], v[40:43], v[240:243]
    v_exp_f32 v24, v24
    v_mfma_f32_16x16x32_bf16 v[240:243], a[164:167], v[44:47], v[240:243]
    ds_read_b64_tr_b16 a[132:133], v2 offset:512
    v_perm_b32 v35, v23, v22, s100
    v_mfma_f32_16x16x32_bf16 v[244:247], a[168:171], v[40:43], v[244:247]
    s_add_u32 m0, s47, 64
    v_exp_f32 v25, v25
    v_mfma_f32_16x16x32_bf16 v[244:247], a[172:175], v[44:47], v[244:247]
    buffer_load_dwordx4 off, s[16:19], s46 offset:2048 lds
    v_mfma_f32_16x16x32_bf16 v[248:251], a[176:179], v[40:43], v[248:251]
    v_exp_f32 v26, v26
    v_mfma_f32_16x16x32_bf16 v[248:251], a[180:183], v[44:47], v[248:251]
    ds_read_b64_tr_b16 a[134:135], v2 offset:768
    v_perm_b32 v36, v25, v24, s100
    v_mfma_f32_16x16x32_bf16 v[252:255], a[184:187], v[40:43], v[252:255]
    s_add_u32 m0, s47, 96
    v_exp_f32 v27, v27
    v_mfma_f32_16x16x32_bf16 v[252:255], a[188:191], v[44:47], v[252:255]
    buffer_load_dwordx4 off, s[16:19], s46 offset:3072 lds
    v_smfmac_f32_16x16x64_bf16 a[12:15], a[16:19], v[40:47], v11
    ds_read_b64_tr_b16 a[136:137], v2 offset:32
    v_mfma_f32_16x16x32_bf16 v[16:19], a[64:67], v[80:83], v[52:55]
    v_exp_f32 v28, v28
    v_mfma_f32_16x16x32_bf16 v[16:19], a[68:71], v[84:87], v[16:19]
    ds_read_b64_tr_b16 a[138:139], v2 offset:288
    v_perm_b32 v37, v27, v26, s100
    v_mfma_f32_16x16x32_bf16 v[16:19], a[72:75], v[88:91], v[16:19]
    s_add_u32 m0, s47, 16896
    v_exp_f32 v29, v29
    v_mfma_f32_16x16x32_bf16 v[16:19], a[76:79], v[92:95], v[16:19]
    buffer_load_dwordx4 off, s[20:23], s46 offset:0 lds
    v_mfma_f32_16x16x32_bf16 v[20:23], a[80:83], v[80:83], v[52:55]
    v_exp_f32 v30, v30
    v_mfma_f32_16x16x32_bf16 v[20:23], a[84:87], v[84:87], v[20:23]
    ds_read_b64_tr_b16 a[140:141], v2 offset:544
    v_perm_b32 v38, v29, v28, s100
    v_mfma_f32_16x16x32_bf16 v[20:23], a[88:91], v[88:91], v[20:23]
    s_add_u32 m0, s47, 16928
    v_exp_f32 v31, v31
    v_mfma_f32_16x16x32_bf16 v[20:23], a[92:95], v[92:95], v[20:23]
    buffer_load_dwordx4 off, s[20:23], s46 offset:1024 lds
    v_mfma_f32_16x16x32_bf16 v[24:27], a[96:99], v[80:83], v[52:55]
    v_exp_f32 v16, v16
    v_mfma_f32_16x16x32_bf16 v[24:27], a[100:103], v[84:87], v[24:27]
    ds_read_b64_tr_b16 a[142:143], v2 offset:800
    v_perm_b32 v39, v31, v30, s100
    v_mfma_f32_16x16x32_bf16 v[24:27], a[104:107], v[88:91], v[24:27]
    s_add_u32 m0, s47, 16960
    v_exp_f32 v17, v17
    v_mfma_f32_16x16x32_bf16 v[24:27], a[108:111], v[92:95], v[24:27]
    buffer_load_dwordx4 off, s[20:23], s46 offset:2048 lds
    v_mfma_f32_16x16x32_bf16 v[28:31], a[112:115], v[80:83], v[52:55]
    v_exp_f32 v18, v18
    v_mfma_f32_16x16x32_bf16 v[28:31], a[116:119], v[84:87], v[28:31]
    ds_read_b64_tr_b16 a[144:145], v2 offset:64
    v_perm_b32 v40, v17, v16, s100
    v_mfma_f32_16x16x32_bf16 v[28:31], a[120:123], v[88:91], v[28:31]
    s_add_u32 m0, s47, 16992
    v_exp_f32 v19, v19
    v_mfma_f32_16x16x32_bf16 v[28:31], a[124:127], v[92:95], v[28:31]
    buffer_load_dwordx4 off, s[20:23], s46 offset:3072 lds
    v_mfma_f32_16x16x32_bf16 v[128:131], a[192:195], v[32:35], v[128:131]
    v_exp_f32 v20, v20
    v_mfma_f32_16x16x32_bf16 v[128:131], a[196:199], v[36:39], v[128:131]
    ds_read_b64_tr_b16 a[146:147], v2 offset:320
    v_perm_b32 v41, v19, v18, s100
    v_mfma_f32_16x16x32_bf16 v[132:135], a[200:203], v[32:35], v[132:135]
    v_exp_f32 v21, v21
    v_mfma_f32_16x16x32_bf16 v[132:135], a[204:207], v[36:39], v[132:135]
    ds_read_b64_tr_b16 a[148:149], v2 offset:576
    v_mfma_f32_16x16x32_bf16 v[136:139], a[208:211], v[32:35], v[136:139]
    v_exp_f32 v22, v22
    v_mfma_f32_16x16x32_bf16 v[136:139], a[212:215], v[36:39], v[136:139]
    ds_read_b64_tr_b16 a[150:151], v2 offset:832
    v_perm_b32 v42, v21, v20, s100
    v_mfma_f32_16x16x32_bf16 v[140:143], a[216:219], v[32:35], v[140:143]
    v_exp_f32 v23, v23
    v_mfma_f32_16x16x32_bf16 v[140:143], a[220:223], v[36:39], v[140:143]
    ds_read_b64_tr_b16 a[152:153], v2 offset:96
    ds_read_b64_tr_b16 a[154:155], v2 offset:352
    v_mfma_f32_16x16x32_bf16 v[144:147], a[224:227], v[32:35], v[144:147]
    v_exp_f32 v24, v24
    v_mfma_f32_16x16x32_bf16 v[144:147], a[228:231], v[36:39], v[144:147]
    ds_read_b64_tr_b16 a[156:157], v2 offset:608
    v_perm_b32 v43, v23, v22, s100
    v_mfma_f32_16x16x32_bf16 v[148:151], a[232:235], v[32:35], v[148:151]
    v_exp_f32 v25, v25
    v_mfma_f32_16x16x32_bf16 v[148:151], a[236:239], v[36:39], v[148:151]
    ds_read_b64_tr_b16 a[158:159], v2 offset:864
    ds_read_b64_tr_b16 a[160:161], v2 offset:128
    v_mfma_f32_16x16x32_bf16 v[152:155], a[240:243], v[32:35], v[152:155]
    v_exp_f32 v26, v26
    v_mfma_f32_16x16x32_bf16 v[152:155], a[244:247], v[36:39], v[152:155]
    ds_read_b64_tr_b16 a[162:163], v2 offset:384
    v_perm_b32 v44, v25, v24, s100
    v_mfma_f32_16x16x32_bf16 v[156:159], a[248:251], v[32:35], v[156:159]
    v_exp_f32 v27, v27
    v_mfma_f32_16x16x32_bf16 v[156:159], a[252:255], v[36:39], v[156:159]
    ds_read_b64_tr_b16 a[164:165], v2 offset:640
    ds_read_b64_tr_b16 a[166:167], v2 offset:896
    v_smfmac_f32_16x16x64_bf16 a[0:3], a[16:19], v[32:39], v11
    ds_read_b64_tr_b16 a[168:169], v2 offset:160
    ds_read_b64_tr_b16 a[170:171], v2 offset:416
    v_mfma_f32_16x16x32_bf16 v[16:19], a[64:67], v[96:99], v[56:59]
    v_exp_f32 v28, v28
    v_mfma_f32_16x16x32_bf16 v[16:19], a[68:71], v[100:103], v[16:19]
    ds_read_b64_tr_b16 a[172:173], v2 offset:672
    v_perm_b32 v45, v27, v26, s100
    v_mfma_f32_16x16x32_bf16 v[16:19], a[72:75], v[104:107], v[16:19]
    s_add_u32 m0, s47, 36864
    v_exp_f32 v29, v29
    v_mfma_f32_16x16x32_bf16 v[16:19], a[76:79], v[108:111], v[16:19]
    s_add_u32 s46, s46, 16384
    buffer_load_dwordx4 off, s[16:19], s46 offset:0 lds
    v_mfma_f32_16x16x32_bf16 v[20:23], a[80:83], v[96:99], v[56:59]
    v_exp_f32 v30, v30
    v_mfma_f32_16x16x32_bf16 v[20:23], a[84:87], v[100:103], v[20:23]
    ds_read_b64_tr_b16 a[174:175], v2 offset:928
    v_perm_b32 v46, v29, v28, s100
    v_mfma_f32_16x16x32_bf16 v[20:23], a[88:91], v[104:107], v[20:23]
    s_add_u32 m0, s47, 36896
    v_exp_f32 v31, v31
    v_mfma_f32_16x16x32_bf16 v[20:23], a[92:95], v[108:111], v[20:23]
    buffer_load_dwordx4 off, s[16:19], s46 offset:1024 lds
    v_mfma_f32_16x16x32_bf16 v[24:27], a[96:99], v[96:99], v[56:59]
    v_exp_f32 v16, v16
    v_mfma_f32_16x16x32_bf16 v[24:27], a[100:103], v[100:103], v[24:27]
    ds_read_b64_tr_b16 a[176:177], v2 offset:192
    v_perm_b32 v47, v31, v30, s100
    v_mfma_f32_16x16x32_bf16 v[24:27], a[104:107], v[104:107], v[24:27]
    s_add_u32 m0, s47, 36928
    v_exp_f32 v17, v17
    v_mfma_f32_16x16x32_bf16 v[24:27], a[108:111], v[108:111], v[24:27]
    buffer_load_dwordx4 off, s[16:19], s46 offset:2048 lds
    v_mfma_f32_16x16x32_bf16 v[28:31], a[112:115], v[96:99], v[56:59]
    v_exp_f32 v18, v18
    v_mfma_f32_16x16x32_bf16 v[28:31], a[116:119], v[100:103], v[28:31]
    ds_read_b64_tr_b16 a[178:179], v2 offset:448
    v_perm_b32 v32, v17, v16, s100
    v_mfma_f32_16x16x32_bf16 v[28:31], a[120:123], v[104:107], v[28:31]
    s_add_u32 m0, s47, 36960
    v_exp_f32 v19, v19
    v_mfma_f32_16x16x32_bf16 v[28:31], a[124:127], v[108:111], v[28:31]
    buffer_load_dwordx4 off, s[16:19], s46 offset:3072 lds
    v_mfma_f32_16x16x32_bf16 v[160:163], a[192:195], v[40:43], v[160:163]
    v_exp_f32 v20, v20
    v_mfma_f32_16x16x32_bf16 v[160:163], a[196:199], v[44:47], v[160:163]
    ds_read_b64_tr_b16 a[180:181], v2 offset:704
    v_perm_b32 v33, v19, v18, s100
    v_mfma_f32_16x16x32_bf16 v[164:167], a[200:203], v[40:43], v[164:167]
    s_add_u32 m0, s47, 53760
    v_exp_f32 v21, v21
    v_mfma_f32_16x16x32_bf16 v[164:167], a[204:207], v[44:47], v[164:167]
    buffer_load_dwordx4 off, s[20:23], s46 offset:0 lds
    v_mfma_f32_16x16x32_bf16 v[168:171], a[208:211], v[40:43], v[168:171]
    v_exp_f32 v22, v22
    v_mfma_f32_16x16x32_bf16 v[168:171], a[212:215], v[44:47], v[168:171]
    ds_read_b64_tr_b16 a[182:183], v2 offset:960
    v_perm_b32 v34, v21, v20, s100
    v_mfma_f32_16x16x32_bf16 v[172:175], a[216:219], v[40:43], v[172:175]
    s_add_u32 m0, s47, 53792
    v_exp_f32 v23, v23
    v_mfma_f32_16x16x32_bf16 v[172:175], a[220:223], v[44:47], v[172:175]
    buffer_load_dwordx4 off, s[20:23], s46 offset:1024 lds
    v_mfma_f32_16x16x32_bf16 v[176:179], a[224:227], v[40:43], v[176:179]
    v_exp_f32 v24, v24
    v_mfma_f32_16x16x32_bf16 v[176:179], a[228:231], v[44:47], v[176:179]
    ds_read_b64_tr_b16 a[184:185], v2 offset:224
    v_perm_b32 v35, v23, v22, s100
    v_mfma_f32_16x16x32_bf16 v[180:183], a[232:235], v[40:43], v[180:183]
    s_add_u32 m0, s47, 53824
    v_exp_f32 v25, v25
    v_mfma_f32_16x16x32_bf16 v[180:183], a[236:239], v[44:47], v[180:183]
    buffer_load_dwordx4 off, s[20:23], s46 offset:2048 lds
    v_mfma_f32_16x16x32_bf16 v[184:187], a[240:243], v[40:43], v[184:187]
    v_exp_f32 v26, v26
    v_mfma_f32_16x16x32_bf16 v[184:187], a[244:247], v[44:47], v[184:187]
    ds_read_b64_tr_b16 a[186:187], v2 offset:480
    v_perm_b32 v36, v25, v24, s100
    v_mfma_f32_16x16x32_bf16 v[188:191], a[248:251], v[40:43], v[188:191]
    s_add_u32 m0, s47, 53856
    v_exp_f32 v27, v27
    v_mfma_f32_16x16x32_bf16 v[188:191], a[252:255], v[44:47], v[188:191]
    buffer_load_dwordx4 off, s[20:23], s46 offset:3072 lds
    v_smfmac_f32_16x16x64_bf16 a[4:7], a[16:19], v[40:47], v11
    ds_read_b64_tr_b16 a[188:189], v2 offset:736
    ds_read_b64_tr_b16 a[190:191], v2 offset:992
    v_mfma_f32_16x16x32_bf16 v[16:19], a[64:67], v[112:115], v[60:63]
    v_exp_f32 v28, v28
    v_mfma_f32_16x16x32_bf16 v[16:19], a[68:71], v[116:119], v[16:19]
    ds_read_b128 a[64:67], v1 offset:0
    v_perm_b32 v37, v27, v26, s100
    v_mfma_f32_16x16x32_bf16 v[16:19], a[72:75], v[120:123], v[16:19]
    v_exp_f32 v29, v29
    v_mfma_f32_16x16x32_bf16 v[16:19], a[76:79], v[124:127], v[16:19]
    ds_read_b128 a[68:71], v1 offset:64
    v_mfma_f32_16x16x32_bf16 v[20:23], a[80:83], v[112:115], v[60:63]
    v_exp_f32 v30, v30
    v_mfma_f32_16x16x32_bf16 v[20:23], a[84:87], v[116:119], v[20:23]
    ds_read_b128 a[72:75], v1 offset:128
    v_perm_b32 v38, v29, v28, s100
    v_mfma_f32_16x16x32_bf16 v[20:23], a[88:91], v[120:123], v[20:23]
    v_exp_f32 v31, v31
    v_mfma_f32_16x16x32_bf16 v[20:23], a[92:95], v[124:127], v[20:23]
    ds_read_b128 a[76:79], v1 offset:192
    v_mfma_f32_16x16x32_bf16 v[24:27], a[96:99], v[112:115], v[60:63]
    v_exp_f32 v16, v16
    v_mfma_f32_16x16x32_bf16 v[24:27], a[100:103], v[116:119], v[24:27]
    ds_read_b128 a[80:83], v1 offset:256
    v_perm_b32 v39, v31, v30, s100
    v_mfma_f32_16x16x32_bf16 v[24:27], a[104:107], v[120:123], v[24:27]
    v_exp_f32 v17, v17
    v_mfma_f32_16x16x32_bf16 v[24:27], a[108:111], v[124:127], v[24:27]
    ds_read_b128 a[84:87], v1 offset:320
    v_mfma_f32_16x16x32_bf16 v[28:31], a[112:115], v[112:115], v[60:63]
    v_exp_f32 v18, v18
    v_mfma_f32_16x16x32_bf16 v[28:31], a[116:119], v[116:119], v[28:31]
    ds_read_b128 a[88:91], v1 offset:384
    v_perm_b32 v40, v17, v16, s100
    v_mfma_f32_16x16x32_bf16 v[28:31], a[120:123], v[120:123], v[28:31]
    v_exp_f32 v19, v19
    v_mfma_f32_16x16x32_bf16 v[28:31], a[124:127], v[124:127], v[28:31]
    ds_read_b128 a[92:95], v1 offset:448
    v_mfma_f32_16x16x32_bf16 v[192:195], a[192:195], v[32:35], v[192:195]
    v_exp_f32 v20, v20
    v_mfma_f32_16x16x32_bf16 v[192:195], a[196:199], v[36:39], v[192:195]
    ds_read_b128 a[96:99], v1 offset:512
    v_perm_b32 v41, v19, v18, s100
    v_mfma_f32_16x16x32_bf16 v[196:199], a[200:203], v[32:35], v[196:199]
    v_exp_f32 v21, v21
    v_mfma_f32_16x16x32_bf16 v[196:199], a[204:207], v[36:39], v[196:199]
    ds_read_b128 a[100:103], v1 offset:576
    v_mfma_f32_16x16x32_bf16 v[200:203], a[208:211], v[32:35], v[200:203]
    v_exp_f32 v22, v22
    v_mfma_f32_16x16x32_bf16 v[200:203], a[212:215], v[36:39], v[200:203]
    ds_read_b128 a[104:107], v1 offset:640
    v_perm_b32 v42, v21, v20, s100
    v_mfma_f32_16x16x32_bf16 v[204:207], a[216:219], v[32:35], v[204:207]
    v_exp_f32 v23, v23
    v_mfma_f32_16x16x32_bf16 v[204:207], a[220:223], v[36:39], v[204:207]
    ds_read_b128 a[108:111], v1 offset:704
    v_mfma_f32_16x16x32_bf16 v[208:211], a[224:227], v[32:35], v[208:211]
    v_exp_f32 v24, v24
    v_mfma_f32_16x16x32_bf16 v[208:211], a[228:231], v[36:39], v[208:211]
    ds_read_b128 a[112:115], v1 offset:768
    v_perm_b32 v43, v23, v22, s100
    v_mfma_f32_16x16x32_bf16 v[212:215], a[232:235], v[32:35], v[212:215]
    v_exp_f32 v25, v25
    v_mfma_f32_16x16x32_bf16 v[212:215], a[236:239], v[36:39], v[212:215]
    ds_read_b128 a[116:119], v1 offset:832
    v_mfma_f32_16x16x32_bf16 v[216:219], a[240:243], v[32:35], v[216:219]
    v_exp_f32 v26, v26
    v_mfma_f32_16x16x32_bf16 v[216:219], a[244:247], v[36:39], v[216:219]
    ds_read_b128 a[120:123], v1 offset:896
    v_perm_b32 v44, v25, v24, s100
    v_mfma_f32_16x16x32_bf16 v[220:223], a[248:251], v[32:35], v[220:223]
    v_exp_f32 v27, v27
    v_mfma_f32_16x16x32_bf16 v[220:223], a[252:255], v[36:39], v[220:223]
    ds_read_b128 a[124:127], v1 offset:960
    v_smfmac_f32_16x16x64_bf16 a[8:11], a[16:19], v[32:39], v11
    s_waitcnt lgkmcnt(12)
    v_mfma_f32_16x16x32_bf16 v[16:19], a[64:67], v[64:67], v[48:51]
    v_exp_f32 v28, v28
    v_mfma_f32_16x16x32_bf16 v[16:19], a[68:71], v[68:71], v[16:19]
    v_perm_b32 v45, v27, v26, s100
    v_mfma_f32_16x16x32_bf16 v[16:19], a[72:75], v[72:75], v[16:19]
    v_exp_f32 v29, v29
    v_mfma_f32_16x16x32_bf16 v[16:19], a[76:79], v[76:79], v[16:19]
    s_waitcnt lgkmcnt(8)
    global_load_dword a63, v13, s[8:9]
    v_mfma_f32_16x16x32_bf16 v[20:23], a[80:83], v[64:67], v[48:51]
    v_exp_f32 v30, v30
    v_mfma_f32_16x16x32_bf16 v[20:23], a[84:87], v[68:71], v[20:23]
    v_perm_b32 v46, v29, v28, s100
    v_mfma_f32_16x16x32_bf16 v[20:23], a[88:91], v[72:75], v[20:23]
    v_exp_f32 v31, v31
    v_mfma_f32_16x16x32_bf16 v[20:23], a[92:95], v[76:79], v[20:23]
    s_waitcnt lgkmcnt(4)
    v_mfma_f32_16x16x32_bf16 v[24:27], a[96:99], v[64:67], v[48:51]
    v_exp_f32 v16, v16
    v_mfma_f32_16x16x32_bf16 v[24:27], a[100:103], v[68:71], v[24:27]
    v_perm_b32 v47, v31, v30, s100
    v_mfma_f32_16x16x32_bf16 v[24:27], a[104:107], v[72:75], v[24:27]
    v_exp_f32 v17, v17
    v_mfma_f32_16x16x32_bf16 v[24:27], a[108:111], v[76:79], v[24:27]
    s_waitcnt lgkmcnt(0)
    buffer_load_dword a63, v9, s[36:39], 0 offen
    v_mfma_f32_16x16x32_bf16 v[28:31], a[112:115], v[64:67], v[48:51]
    v_exp_f32 v18, v18
    v_mfma_f32_16x16x32_bf16 v[28:31], a[116:119], v[68:71], v[28:31]
    v_perm_b32 v32, v17, v16, s100
    v_mfma_f32_16x16x32_bf16 v[28:31], a[120:123], v[72:75], v[28:31]
    v_exp_f32 v19, v19
    v_mfma_f32_16x16x32_bf16 v[28:31], a[124:127], v[76:79], v[28:31]
    v_mfma_f32_16x16x32_bf16 v[224:227], a[192:195], v[40:43], v[224:227]
    v_exp_f32 v20, v20
    v_mfma_f32_16x16x32_bf16 v[224:227], a[196:199], v[44:47], v[224:227]
    ds_read_b64_tr_b16 a[192:193], v2 offset:36864
    v_perm_b32 v33, v19, v18, s100
    v_mfma_f32_16x16x32_bf16 v[228:231], a[200:203], v[40:43], v[228:231]
    s_mov_b32 s54, 0
    v_exp_f32 v21, v21
    v_mfma_f32_16x16x32_bf16 v[228:231], a[204:207], v[44:47], v[228:231]
    buffer_load_dwordx4 a[20:23], v6, s[64:67], s54 offen
    v_mfma_f32_16x16x32_bf16 v[232:235], a[208:211], v[40:43], v[232:235]
    v_exp_f32 v22, v22
    v_mfma_f32_16x16x32_bf16 v[232:235], a[212:215], v[44:47], v[232:235]
    ds_read_b64_tr_b16 a[194:195], v2 offset:37120
    v_perm_b32 v34, v21, v20, s100
    v_mfma_f32_16x16x32_bf16 v[236:239], a[216:219], v[40:43], v[236:239]
    v_exp_f32 v23, v23
    v_mfma_f32_16x16x32_bf16 v[236:239], a[220:223], v[44:47], v[236:239]
    ds_read_b64_tr_b16 a[196:197], v2 offset:37376
    v_mfma_f32_16x16x32_bf16 v[240:243], a[224:227], v[40:43], v[240:243]
    v_exp_f32 v24, v24
    v_mfma_f32_16x16x32_bf16 v[240:243], a[228:231], v[44:47], v[240:243]
    ds_read_b64_tr_b16 a[198:199], v2 offset:37632
    v_perm_b32 v35, v23, v22, s100
    v_mfma_f32_16x16x32_bf16 v[244:247], a[232:235], v[40:43], v[244:247]
    s_mov_b32 s54, 147456
    v_exp_f32 v25, v25
    v_mfma_f32_16x16x32_bf16 v[244:247], a[236:239], v[44:47], v[244:247]
    buffer_load_dwordx4 a[24:27], v6, s[64:67], s54 offen
    v_mfma_f32_16x16x32_bf16 v[248:251], a[240:243], v[40:43], v[248:251]
    v_exp_f32 v26, v26
    v_mfma_f32_16x16x32_bf16 v[248:251], a[244:247], v[44:47], v[248:251]
    ds_read_b64_tr_b16 a[200:201], v2 offset:36896
    v_perm_b32 v36, v25, v24, s100
    v_mfma_f32_16x16x32_bf16 v[252:255], a[248:251], v[40:43], v[252:255]
    v_exp_f32 v27, v27
    v_mfma_f32_16x16x32_bf16 v[252:255], a[252:255], v[44:47], v[252:255]
    ds_read_b64_tr_b16 a[202:203], v2 offset:37152
    v_smfmac_f32_16x16x64_bf16 a[12:15], a[16:19], v[40:47], v11
    ds_read_b64_tr_b16 a[204:205], v2 offset:37408
    v_mfma_f32_16x16x32_bf16 v[16:19], a[64:67], v[80:83], v[52:55]
    v_exp_f32 v28, v28
    v_mfma_f32_16x16x32_bf16 v[16:19], a[68:71], v[84:87], v[16:19]
    ds_read_b64_tr_b16 a[206:207], v2 offset:37664
    v_perm_b32 v37, v27, v26, s100
    v_mfma_f32_16x16x32_bf16 v[16:19], a[72:75], v[88:91], v[16:19]
    s_mov_b32 s54, 294912
    v_exp_f32 v29, v29
    v_mfma_f32_16x16x32_bf16 v[16:19], a[76:79], v[92:95], v[16:19]
    buffer_load_dwordx4 a[28:31], v6, s[64:67], s54 offen
    v_mfma_f32_16x16x32_bf16 v[20:23], a[80:83], v[80:83], v[52:55]
    v_exp_f32 v30, v30
    v_mfma_f32_16x16x32_bf16 v[20:23], a[84:87], v[84:87], v[20:23]
    ds_read_b64_tr_b16 a[208:209], v2 offset:36928
    v_perm_b32 v38, v29, v28, s100
    v_mfma_f32_16x16x32_bf16 v[20:23], a[88:91], v[88:91], v[20:23]
    v_exp_f32 v31, v31
    v_mfma_f32_16x16x32_bf16 v[20:23], a[92:95], v[92:95], v[20:23]
    ds_read_b64_tr_b16 a[210:211], v2 offset:37184
    v_mfma_f32_16x16x32_bf16 v[24:27], a[96:99], v[80:83], v[52:55]
    v_exp_f32 v16, v16
    v_mfma_f32_16x16x32_bf16 v[24:27], a[100:103], v[84:87], v[24:27]
    ds_read_b64_tr_b16 a[212:213], v2 offset:37440
    v_perm_b32 v39, v31, v30, s100
    v_mfma_f32_16x16x32_bf16 v[24:27], a[104:107], v[88:91], v[24:27]
    s_mov_b32 s54, 442368
    v_exp_f32 v17, v17
    v_mfma_f32_16x16x32_bf16 v[24:27], a[108:111], v[92:95], v[24:27]
    buffer_load_dwordx4 a[32:35], v6, s[64:67], s54 offen
    v_mfma_f32_16x16x32_bf16 v[28:31], a[112:115], v[80:83], v[52:55]
    v_exp_f32 v18, v18
    v_mfma_f32_16x16x32_bf16 v[28:31], a[116:119], v[84:87], v[28:31]
    ds_read_b64_tr_b16 a[214:215], v2 offset:37696
    v_perm_b32 v40, v17, v16, s100
    v_mfma_f32_16x16x32_bf16 v[28:31], a[120:123], v[88:91], v[28:31]
    v_exp_f32 v19, v19
    v_mfma_f32_16x16x32_bf16 v[28:31], a[124:127], v[92:95], v[28:31]
    ds_read_b64_tr_b16 a[216:217], v2 offset:36960
    v_mfma_f32_16x16x32_bf16 v[128:131], a[128:131], v[32:35], v[128:131]
    v_exp_f32 v20, v20
    v_mfma_f32_16x16x32_bf16 v[128:131], a[132:135], v[36:39], v[128:131]
    ds_read_b64_tr_b16 a[218:219], v2 offset:37216
    v_perm_b32 v41, v19, v18, s100
    v_mfma_f32_16x16x32_bf16 v[132:135], a[136:139], v[32:35], v[132:135]
    s_mov_b32 s54, 589824
    v_exp_f32 v21, v21
    v_mfma_f32_16x16x32_bf16 v[132:135], a[140:143], v[36:39], v[132:135]
    buffer_load_dwordx4 a[36:39], v6, s[64:67], s54 offen
    v_mfma_f32_16x16x32_bf16 v[136:139], a[144:147], v[32:35], v[136:139]
    v_exp_f32 v22, v22
    v_mfma_f32_16x16x32_bf16 v[136:139], a[148:151], v[36:39], v[136:139]
    ds_read_b64_tr_b16 a[220:221], v2 offset:37472
    v_perm_b32 v42, v21, v20, s100
    v_mfma_f32_16x16x32_bf16 v[140:143], a[152:155], v[32:35], v[140:143]
    v_exp_f32 v23, v23
    v_mfma_f32_16x16x32_bf16 v[140:143], a[156:159], v[36:39], v[140:143]
    ds_read_b64_tr_b16 a[222:223], v2 offset:37728
    v_mfma_f32_16x16x32_bf16 v[144:147], a[160:163], v[32:35], v[144:147]
    v_exp_f32 v24, v24
    v_mfma_f32_16x16x32_bf16 v[144:147], a[164:167], v[36:39], v[144:147]
    ds_read_b64_tr_b16 a[224:225], v2 offset:36992
    v_perm_b32 v43, v23, v22, s100
    v_mfma_f32_16x16x32_bf16 v[148:151], a[168:171], v[32:35], v[148:151]
    v_exp_f32 v25, v25
    v_mfma_f32_16x16x32_bf16 v[148:151], a[172:175], v[36:39], v[148:151]
    ds_read_b64_tr_b16 a[226:227], v2 offset:37248
    v_mfma_f32_16x16x32_bf16 v[152:155], a[176:179], v[32:35], v[152:155]
    v_exp_f32 v26, v26
    v_mfma_f32_16x16x32_bf16 v[152:155], a[180:183], v[36:39], v[152:155]
    ds_read_b64_tr_b16 a[228:229], v2 offset:37504
    v_perm_b32 v44, v25, v24, s100
    v_mfma_f32_16x16x32_bf16 v[156:159], a[184:187], v[32:35], v[156:159]
    v_exp_f32 v27, v27
    v_mfma_f32_16x16x32_bf16 v[156:159], a[188:191], v[36:39], v[156:159]
    ds_read_b64_tr_b16 a[230:231], v2 offset:37760
    v_smfmac_f32_16x16x64_bf16 a[0:3], a[16:19], v[32:39], v11
    ds_read_b64_tr_b16 a[232:233], v2 offset:37024
    v_mfma_f32_16x16x32_bf16 v[16:19], a[64:67], v[96:99], v[56:59]
    v_exp_f32 v28, v28
    v_mfma_f32_16x16x32_bf16 v[16:19], a[68:71], v[100:103], v[16:19]
    ds_read_b64_tr_b16 a[234:235], v2 offset:37280
    v_perm_b32 v45, v27, v26, s100
    v_mfma_f32_16x16x32_bf16 v[16:19], a[72:75], v[104:107], v[16:19]
    v_exp_f32 v29, v29
    v_mfma_f32_16x16x32_bf16 v[16:19], a[76:79], v[108:111], v[16:19]
    ds_read_b64_tr_b16 a[236:237], v2 offset:37536
    v_mfma_f32_16x16x32_bf16 v[20:23], a[80:83], v[96:99], v[56:59]
    v_exp_f32 v30, v30
    v_mfma_f32_16x16x32_bf16 v[20:23], a[84:87], v[100:103], v[20:23]
    ds_read_b64_tr_b16 a[238:239], v2 offset:37792
    v_perm_b32 v46, v29, v28, s100
    v_mfma_f32_16x16x32_bf16 v[20:23], a[88:91], v[104:107], v[20:23]
    v_exp_f32 v31, v31
    v_mfma_f32_16x16x32_bf16 v[20:23], a[92:95], v[108:111], v[20:23]
    ds_read_b64_tr_b16 a[240:241], v2 offset:37056
    v_mfma_f32_16x16x32_bf16 v[24:27], a[96:99], v[96:99], v[56:59]
    v_exp_f32 v16, v16
    v_mfma_f32_16x16x32_bf16 v[24:27], a[100:103], v[100:103], v[24:27]
    ds_read_b64_tr_b16 a[242:243], v2 offset:37312
    v_perm_b32 v47, v31, v30, s100
    v_mfma_f32_16x16x32_bf16 v[24:27], a[104:107], v[104:107], v[24:27]
    v_exp_f32 v17, v17
    v_mfma_f32_16x16x32_bf16 v[24:27], a[108:111], v[108:111], v[24:27]
    ds_read_b64_tr_b16 a[244:245], v2 offset:37568
    v_mfma_f32_16x16x32_bf16 v[28:31], a[112:115], v[96:99], v[56:59]
    v_exp_f32 v18, v18
    v_mfma_f32_16x16x32_bf16 v[28:31], a[116:119], v[100:103], v[28:31]
    ds_read_b64_tr_b16 a[246:247], v2 offset:37824
    v_perm_b32 v32, v17, v16, s100
    v_mfma_f32_16x16x32_bf16 v[28:31], a[120:123], v[104:107], v[28:31]
    v_exp_f32 v19, v19
    v_mfma_f32_16x16x32_bf16 v[28:31], a[124:127], v[108:111], v[28:31]
    ds_read_b64_tr_b16 a[248:249], v2 offset:37088
    v_mfma_f32_16x16x32_bf16 v[160:163], a[128:131], v[40:43], v[160:163]
    v_exp_f32 v20, v20
    v_mfma_f32_16x16x32_bf16 v[160:163], a[132:135], v[44:47], v[160:163]
    ds_read_b64_tr_b16 a[250:251], v2 offset:37344
    v_perm_b32 v33, v19, v18, s100
    v_mfma_f32_16x16x32_bf16 v[164:167], a[136:139], v[40:43], v[164:167]
    v_exp_f32 v21, v21
    v_mfma_f32_16x16x32_bf16 v[164:167], a[140:143], v[44:47], v[164:167]
    ds_read_b64_tr_b16 a[252:253], v2 offset:37600
    v_mfma_f32_16x16x32_bf16 v[168:171], a[144:147], v[40:43], v[168:171]
    v_exp_f32 v22, v22
    v_mfma_f32_16x16x32_bf16 v[168:171], a[148:151], v[44:47], v[168:171]
    ds_read_b64_tr_b16 a[254:255], v2 offset:37856
    v_perm_b32 v34, v21, v20, s100
    v_mfma_f32_16x16x32_bf16 v[172:175], a[152:155], v[40:43], v[172:175]
    v_exp_f32 v23, v23
    v_mfma_f32_16x16x32_bf16 v[172:175], a[156:159], v[44:47], v[172:175]
    v_mfma_f32_16x16x32_bf16 v[176:179], a[160:163], v[40:43], v[176:179]
    v_exp_f32 v24, v24
    v_mfma_f32_16x16x32_bf16 v[176:179], a[164:167], v[44:47], v[176:179]
    v_perm_b32 v35, v23, v22, s100
    v_mfma_f32_16x16x32_bf16 v[180:183], a[168:171], v[40:43], v[180:183]
    v_exp_f32 v25, v25
    v_mfma_f32_16x16x32_bf16 v[180:183], a[172:175], v[44:47], v[180:183]
    v_mfma_f32_16x16x32_bf16 v[184:187], a[176:179], v[40:43], v[184:187]
    v_exp_f32 v26, v26
    v_mfma_f32_16x16x32_bf16 v[184:187], a[180:183], v[44:47], v[184:187]
    v_perm_b32 v36, v25, v24, s100
    v_mfma_f32_16x16x32_bf16 v[188:191], a[184:187], v[40:43], v[188:191]
L2_pad8:
    s_cbranch_execz L2_pad12
    v_exp_f32 v27, v27
    v_mfma_f32_16x16x32_bf16 v[188:191], a[188:191], v[44:47], v[188:191]
    v_smfmac_f32_16x16x64_bf16 a[4:7], a[16:19], v[40:47], v11
    v_mfma_f32_16x16x32_bf16 v[16:19], a[64:67], v[112:115], v[60:63]
    v_exp_f32 v28, v28
    v_mfma_f32_16x16x32_bf16 v[16:19], a[68:71], v[116:119], v[16:19]
    ds_read_b128 a[64:67], v1 offset:36864
    v_perm_b32 v37, v27, v26, s100
    v_mfma_f32_16x16x32_bf16 v[16:19], a[72:75], v[120:123], v[16:19]
    v_exp_f32 v29, v29
    v_mfma_f32_16x16x32_bf16 v[16:19], a[76:79], v[124:127], v[16:19]
    ds_read_b128 a[68:71], v1 offset:36928
    v_mfma_f32_16x16x32_bf16 v[20:23], a[80:83], v[112:115], v[60:63]
    v_exp_f32 v30, v30
    v_mfma_f32_16x16x32_bf16 v[20:23], a[84:87], v[116:119], v[20:23]
    ds_read_b128 a[72:75], v1 offset:36992
    v_perm_b32 v38, v29, v28, s100
    v_mfma_f32_16x16x32_bf16 v[20:23], a[88:91], v[120:123], v[20:23]
    v_exp_f32 v31, v31
    v_mfma_f32_16x16x32_bf16 v[20:23], a[92:95], v[124:127], v[20:23]
    ds_read_b128 a[76:79], v1 offset:37056
    v_mfma_f32_16x16x32_bf16 v[24:27], a[96:99], v[112:115], v[60:63]
    v_exp_f32 v16, v16
    v_mfma_f32_16x16x32_bf16 v[24:27], a[100:103], v[116:119], v[24:27]
    ds_read_b128 a[80:83], v1 offset:37120
    v_perm_b32 v39, v31, v30, s100
    v_mfma_f32_16x16x32_bf16 v[24:27], a[104:107], v[120:123], v[24:27]
    v_exp_f32 v17, v17
    v_mfma_f32_16x16x32_bf16 v[24:27], a[108:111], v[124:127], v[24:27]
    ds_read_b128 a[84:87], v1 offset:37184
    v_mfma_f32_16x16x32_bf16 v[28:31], a[112:115], v[112:115], v[60:63]
    v_exp_f32 v18, v18
    v_mfma_f32_16x16x32_bf16 v[28:31], a[116:119], v[116:119], v[28:31]
    ds_read_b128 a[88:91], v1 offset:37248
    v_perm_b32 v40, v17, v16, s100
    v_mfma_f32_16x16x32_bf16 v[28:31], a[120:123], v[120:123], v[28:31]
    v_exp_f32 v19, v19
    v_mfma_f32_16x16x32_bf16 v[28:31], a[124:127], v[124:127], v[28:31]
    ds_read_b128 a[92:95], v1 offset:37312
    v_mfma_f32_16x16x32_bf16 v[192:195], a[128:131], v[32:35], v[192:195]
    v_exp_f32 v20, v20
    v_mfma_f32_16x16x32_bf16 v[192:195], a[132:135], v[36:39], v[192:195]
    ds_read_b128 a[96:99], v1 offset:37376
    v_perm_b32 v41, v19, v18, s100
    v_mfma_f32_16x16x32_bf16 v[196:199], a[136:139], v[32:35], v[196:199]
    v_exp_f32 v21, v21
    v_mfma_f32_16x16x32_bf16 v[196:199], a[140:143], v[36:39], v[196:199]
    ds_read_b128 a[100:103], v1 offset:37440
    v_mfma_f32_16x16x32_bf16 v[200:203], a[144:147], v[32:35], v[200:203]
    v_exp_f32 v22, v22
    v_mfma_f32_16x16x32_bf16 v[200:203], a[148:151], v[36:39], v[200:203]
    ds_read_b128 a[104:107], v1 offset:37504
    v_perm_b32 v42, v21, v20, s100
    v_mfma_f32_16x16x32_bf16 v[204:207], a[152:155], v[32:35], v[204:207]
    v_exp_f32 v23, v23
    v_mfma_f32_16x16x32_bf16 v[204:207], a[156:159], v[36:39], v[204:207]
    ds_read_b128 a[108:111], v1 offset:37568
    v_mfma_f32_16x16x32_bf16 v[208:211], a[160:163], v[32:35], v[208:211]
    v_exp_f32 v24, v24
    v_mfma_f32_16x16x32_bf16 v[208:211], a[164:167], v[36:39], v[208:211]
    ds_read_b128 a[112:115], v1 offset:37632
    v_perm_b32 v43, v23, v22, s100
    v_mfma_f32_16x16x32_bf16 v[212:215], a[168:171], v[32:35], v[212:215]
    v_exp_f32 v25, v25
    v_mfma_f32_16x16x32_bf16 v[212:215], a[172:175], v[36:39], v[212:215]
    ds_read_b128 a[116:119], v1 offset:37696
    v_mfma_f32_16x16x32_bf16 v[216:219], a[176:179], v[32:35], v[216:219]
    v_exp_f32 v26, v26
    v_mfma_f32_16x16x32_bf16 v[216:219], a[180:183], v[36:39], v[216:219]
    ds_read_b128 a[120:123], v1 offset:37760
    v_perm_b32 v44, v25, v24, s100
    v_mfma_f32_16x16x32_bf16 v[220:223], a[184:187], v[32:35], v[220:223]
    v_exp_f32 v27, v27
    v_mfma_f32_16x16x32_bf16 v[220:223], a[188:191], v[36:39], v[220:223]
    ds_read_b128 a[124:127], v1 offset:37824
    v_smfmac_f32_16x16x64_bf16 a[8:11], a[16:19], v[32:39], v11
    s_waitcnt lgkmcnt(12)
    v_mfma_f32_16x16x32_bf16 v[16:19], a[64:67], v[64:67], v[48:51]
    s_sub_u32 s47, s47, s48
    v_exp_f32 v28, v28
    v_mfma_f32_16x16x32_bf16 v[16:19], a[68:71], v[68:71], v[16:19]
    v_perm_b32 v45, v27, v26, s100
    v_add_u32 v1, s48, v1
    v_mfma_f32_16x16x32_bf16 v[16:19], a[72:75], v[72:75], v[16:19]
    v_exp_f32 v29, v29
    v_mfma_f32_16x16x32_bf16 v[16:19], a[76:79], v[76:79], v[16:19]
    s_waitcnt lgkmcnt(8)
    v_mfma_f32_16x16x32_bf16 v[20:23], a[80:83], v[64:67], v[48:51]
    v_exp_f32 v30, v30
    v_mfma_f32_16x16x32_bf16 v[20:23], a[84:87], v[68:71], v[20:23]
    v_perm_b32 v46, v29, v28, s100
    v_add_u32 v2, s48, v2
    v_mfma_f32_16x16x32_bf16 v[20:23], a[88:91], v[72:75], v[20:23]
    v_exp_f32 v31, v31
    v_mfma_f32_16x16x32_bf16 v[20:23], a[92:95], v[76:79], v[20:23]
    s_waitcnt lgkmcnt(4)
    v_mfma_f32_16x16x32_bf16 v[24:27], a[96:99], v[64:67], v[48:51]
    s_sub_u32 s48, 0, s48
    v_exp_f32 v16, v16
    v_mfma_f32_16x16x32_bf16 v[24:27], a[100:103], v[68:71], v[24:27]
    v_perm_b32 v47, v31, v30, s100
    v_mfma_f32_16x16x32_bf16 v[24:27], a[104:107], v[72:75], v[24:27]
    v_exp_f32 v17, v17
    v_mfma_f32_16x16x32_bf16 v[24:27], a[108:111], v[76:79], v[24:27]
    s_waitcnt lgkmcnt(0)
    v_mfma_f32_16x16x32_bf16 v[28:31], a[112:115], v[64:67], v[48:51]
    v_exp_f32 v18, v18
    v_mfma_f32_16x16x32_bf16 v[28:31], a[116:119], v[68:71], v[28:31]
    v_perm_b32 v32, v17, v16, s100
    v_mfma_f32_16x16x32_bf16 v[28:31], a[120:123], v[72:75], v[28:31]
    v_exp_f32 v19, v19
    v_mfma_f32_16x16x32_bf16 v[28:31], a[124:127], v[76:79], v[28:31]
    s_waitcnt vmcnt(7)
    s_barrier
    v_mfma_f32_16x16x32_bf16 v[224:227], a[128:131], v[40:43], v[224:227]
    v_exp_f32 v20, v20
    v_mfma_f32_16x16x32_bf16 v[224:227], a[132:135], v[44:47], v[224:227]
    ds_read_b64_tr_b16 a[128:129], v2 offset:0
    v_perm_b32 v33, v19, v18, s100
    v_mfma_f32_16x16x32_bf16 v[228:231], a[136:139], v[40:43], v[228:231]
    s_add_u32 m0, s44, 73728
    v_exp_f32 v21, v21
    v_mfma_f32_16x16x32_bf16 v[228:231], a[140:143], v[44:47], v[228:231]
    s_mov_b32 s45, 0
    buffer_load_dwordx4 v7, s[28:31], s45 offen offset:0 lds
    v_mfma_f32_16x16x32_bf16 v[232:235], a[144:147], v[40:43], v[232:235]
    v_exp_f32 v22, v22
    v_mfma_f32_16x16x32_bf16 v[232:235], a[148:151], v[44:47], v[232:235]
    ds_read_b64_tr_b16 a[130:131], v2 offset:256
    v_perm_b32 v34, v21, v20, s100
    v_mfma_f32_16x16x32_bf16 v[236:239], a[152:155], v[40:43], v[236:239]
    s_add_u32 m0, s44, 73632
    v_exp_f32 v23, v23
    v_mfma_f32_16x16x32_bf16 v[236:239], a[156:159], v[44:47], v[236:239]
    buffer_load_dwordx4 v7, s[28:31], s45 offen offset:1152 lds
    v_mfma_f32_16x16x32_bf16 v[240:243], a[160:163], v[40:43], v[240:243]
    v_exp_f32 v24, v24
    v_mfma_f32_16x16x32_bf16 v[240:243], a[164:167], v[44:47], v[240:243]
    ds_read_b64_tr_b16 a[132:133], v2 offset:512
    v_perm_b32 v35, v23, v22, s100
    v_mfma_f32_16x16x32_bf16 v[244:247], a[168:171], v[40:43], v[244:247]
    s_add_u32 m0, s44, 73536
    v_exp_f32 v25, v25
    v_mfma_f32_16x16x32_bf16 v[244:247], a[172:175], v[44:47], v[244:247]
    buffer_load_dwordx4 v7, s[28:31], s45 offen offset:2304 lds
    v_mfma_f32_16x16x32_bf16 v[248:251], a[176:179], v[40:43], v[248:251]
    v_exp_f32 v26, v26
    v_mfma_f32_16x16x32_bf16 v[248:251], a[180:183], v[44:47], v[248:251]
    ds_read_b64_tr_b16 a[134:135], v2 offset:768
    v_perm_b32 v36, v25, v24, s100
    v_mfma_f32_16x16x32_bf16 v[252:255], a[184:187], v[40:43], v[252:255]
    s_add_u32 m0, s44, 73440
    v_exp_f32 v27, v27
    v_mfma_f32_16x16x32_bf16 v[252:255], a[188:191], v[44:47], v[252:255]
    buffer_load_dwordx4 v7, s[28:31], s45 offen offset:3456 lds
    v_smfmac_f32_16x16x64_bf16 a[12:15], a[16:19], v[40:47], v11
    ds_read_b64_tr_b16 a[136:137], v2 offset:32
    v_mfma_f32_16x16x32_bf16 v[16:19], a[64:67], v[80:83], v[52:55]
    v_exp_f32 v28, v28
    v_mfma_f32_16x16x32_bf16 v[16:19], a[68:71], v[84:87], v[16:19]
    ds_read_b64_tr_b16 a[138:139], v2 offset:288
    v_perm_b32 v37, v27, v26, s100
    v_mfma_f32_16x16x32_bf16 v[16:19], a[72:75], v[88:91], v[16:19]
    s_add_u32 m0, s44, 90624
    v_exp_f32 v29, v29
    v_mfma_f32_16x16x32_bf16 v[16:19], a[76:79], v[92:95], v[16:19]
    s_mov_b32 s45, 147456
    buffer_load_dwordx4 v7, s[28:31], s45 offen offset:0 lds
    v_mfma_f32_16x16x32_bf16 v[20:23], a[80:83], v[80:83], v[52:55]
    v_exp_f32 v30, v30
    v_mfma_f32_16x16x32_bf16 v[20:23], a[84:87], v[84:87], v[20:23]
    ds_read_b64_tr_b16 a[140:141], v2 offset:544
    v_perm_b32 v38, v29, v28, s100
    v_mfma_f32_16x16x32_bf16 v[20:23], a[88:91], v[88:91], v[20:23]
    s_add_u32 m0, s44, 90528
    v_exp_f32 v31, v31
    v_mfma_f32_16x16x32_bf16 v[20:23], a[92:95], v[92:95], v[20:23]
    buffer_load_dwordx4 v7, s[28:31], s45 offen offset:1152 lds
    v_mfma_f32_16x16x32_bf16 v[24:27], a[96:99], v[80:83], v[52:55]
    v_exp_f32 v16, v16
    v_mfma_f32_16x16x32_bf16 v[24:27], a[100:103], v[84:87], v[24:27]
    ds_read_b64_tr_b16 a[142:143], v2 offset:800
    v_perm_b32 v39, v31, v30, s100
    v_mfma_f32_16x16x32_bf16 v[24:27], a[104:107], v[88:91], v[24:27]
    s_add_u32 m0, s44, 90432
    v_exp_f32 v17, v17
    v_mfma_f32_16x16x32_bf16 v[24:27], a[108:111], v[92:95], v[24:27]
    buffer_load_dwordx4 v7, s[28:31], s45 offen offset:2304 lds
    v_mfma_f32_16x16x32_bf16 v[28:31], a[112:115], v[80:83], v[52:55]
    v_exp_f32 v18, v18
    v_mfma_f32_16x16x32_bf16 v[28:31], a[116:119], v[84:87], v[28:31]
    ds_read_b64_tr_b16 a[144:145], v2 offset:64
    v_perm_b32 v40, v17, v16, s100
    v_mfma_f32_16x16x32_bf16 v[28:31], a[120:123], v[88:91], v[28:31]
    s_add_u32 m0, s44, 90336
    v_exp_f32 v19, v19
    v_mfma_f32_16x16x32_bf16 v[28:31], a[124:127], v[92:95], v[28:31]
    buffer_load_dwordx4 v7, s[28:31], s45 offen offset:3456 lds
    v_mfma_f32_16x16x32_bf16 v[128:131], a[192:195], v[32:35], v[128:131]
    v_exp_f32 v20, v20
    v_mfma_f32_16x16x32_bf16 v[128:131], a[196:199], v[36:39], v[128:131]
    ds_read_b64_tr_b16 a[146:147], v2 offset:320
    v_perm_b32 v41, v19, v18, s100
    v_mfma_f32_16x16x32_bf16 v[132:135], a[200:203], v[32:35], v[132:135]
    v_exp_f32 v21, v21
    v_mfma_f32_16x16x32_bf16 v[132:135], a[204:207], v[36:39], v[132:135]
    ds_read_b64_tr_b16 a[148:149], v2 offset:576
    v_mfma_f32_16x16x32_bf16 v[136:139], a[208:211], v[32:35], v[136:139]
    v_exp_f32 v22, v22
    v_mfma_f32_16x16x32_bf16 v[136:139], a[212:215], v[36:39], v[136:139]
    ds_read_b64_tr_b16 a[150:151], v2 offset:832
    v_perm_b32 v42, v21, v20, s100
    v_mfma_f32_16x16x32_bf16 v[140:143], a[216:219], v[32:35], v[140:143]
    v_exp_f32 v23, v23
    v_mfma_f32_16x16x32_bf16 v[140:143], a[220:223], v[36:39], v[140:143]
    ds_read_b64_tr_b16 a[152:153], v2 offset:96
    ds_read_b64_tr_b16 a[154:155], v2 offset:352
    v_mfma_f32_16x16x32_bf16 v[144:147], a[224:227], v[32:35], v[144:147]
    v_exp_f32 v24, v24
    v_mfma_f32_16x16x32_bf16 v[144:147], a[228:231], v[36:39], v[144:147]
    ds_read_b64_tr_b16 a[156:157], v2 offset:608
    v_perm_b32 v43, v23, v22, s100
    v_mfma_f32_16x16x32_bf16 v[148:151], a[232:235], v[32:35], v[148:151]
    v_exp_f32 v25, v25
    v_mfma_f32_16x16x32_bf16 v[148:151], a[236:239], v[36:39], v[148:151]
    ds_read_b64_tr_b16 a[158:159], v2 offset:864
    ds_read_b64_tr_b16 a[160:161], v2 offset:128
    v_mfma_f32_16x16x32_bf16 v[152:155], a[240:243], v[32:35], v[152:155]
    v_exp_f32 v26, v26
    v_mfma_f32_16x16x32_bf16 v[152:155], a[244:247], v[36:39], v[152:155]
    ds_read_b64_tr_b16 a[162:163], v2 offset:384
    v_perm_b32 v44, v25, v24, s100
    v_mfma_f32_16x16x32_bf16 v[156:159], a[248:251], v[32:35], v[156:159]
    v_exp_f32 v27, v27
    v_mfma_f32_16x16x32_bf16 v[156:159], a[252:255], v[36:39], v[156:159]
    ds_read_b64_tr_b16 a[164:165], v2 offset:640
    ds_read_b64_tr_b16 a[166:167], v2 offset:896
    v_smfmac_f32_16x16x64_bf16 a[0:3], a[16:19], v[32:39], v11
    ds_read_b64_tr_b16 a[168:169], v2 offset:160
    ds_read_b64_tr_b16 a[170:171], v2 offset:416
    v_mfma_f32_16x16x32_bf16 v[16:19], a[64:67], v[96:99], v[56:59]
    v_exp_f32 v28, v28
    v_mfma_f32_16x16x32_bf16 v[16:19], a[68:71], v[100:103], v[16:19]
    ds_read_b64_tr_b16 a[172:173], v2 offset:672
    v_perm_b32 v45, v27, v26, s100
    v_mfma_f32_16x16x32_bf16 v[16:19], a[72:75], v[104:107], v[16:19]
    s_add_u32 m0, s44, 110592
    v_exp_f32 v29, v29
    v_mfma_f32_16x16x32_bf16 v[16:19], a[76:79], v[108:111], v[16:19]
    s_mov_b32 s45, 128
    buffer_load_dwordx4 v7, s[28:31], s45 offen offset:0 lds
    v_mfma_f32_16x16x32_bf16 v[20:23], a[80:83], v[96:99], v[56:59]
    v_exp_f32 v30, v30
    v_mfma_f32_16x16x32_bf16 v[20:23], a[84:87], v[100:103], v[20:23]
    ds_read_b64_tr_b16 a[174:175], v2 offset:928
    v_perm_b32 v46, v29, v28, s100
    v_mfma_f32_16x16x32_bf16 v[20:23], a[88:91], v[104:107], v[20:23]
    s_add_u32 m0, s44, 110496
    v_exp_f32 v31, v31
    v_mfma_f32_16x16x32_bf16 v[20:23], a[92:95], v[108:111], v[20:23]
    buffer_load_dwordx4 v7, s[28:31], s45 offen offset:1152 lds
    v_mfma_f32_16x16x32_bf16 v[24:27], a[96:99], v[96:99], v[56:59]
    v_exp_f32 v16, v16
    v_mfma_f32_16x16x32_bf16 v[24:27], a[100:103], v[100:103], v[24:27]
    ds_read_b64_tr_b16 a[176:177], v2 offset:192
    v_perm_b32 v47, v31, v30, s100
    v_mfma_f32_16x16x32_bf16 v[24:27], a[104:107], v[104:107], v[24:27]
    s_add_u32 m0, s44, 110400
    v_exp_f32 v17, v17
    v_mfma_f32_16x16x32_bf16 v[24:27], a[108:111], v[108:111], v[24:27]
    buffer_load_dwordx4 v7, s[28:31], s45 offen offset:2304 lds
    v_mfma_f32_16x16x32_bf16 v[28:31], a[112:115], v[96:99], v[56:59]
    v_exp_f32 v18, v18
    v_mfma_f32_16x16x32_bf16 v[28:31], a[116:119], v[100:103], v[28:31]
    ds_read_b64_tr_b16 a[178:179], v2 offset:448
    v_perm_b32 v32, v17, v16, s100
    v_mfma_f32_16x16x32_bf16 v[28:31], a[120:123], v[104:107], v[28:31]
    s_add_u32 m0, s44, 110304
    v_exp_f32 v19, v19
    v_mfma_f32_16x16x32_bf16 v[28:31], a[124:127], v[108:111], v[28:31]
    buffer_load_dwordx4 v7, s[28:31], s45 offen offset:3456 lds
    v_mfma_f32_16x16x32_bf16 v[160:163], a[192:195], v[40:43], v[160:163]
    v_exp_f32 v20, v20
    v_mfma_f32_16x16x32_bf16 v[160:163], a[196:199], v[44:47], v[160:163]
    ds_read_b64_tr_b16 a[180:181], v2 offset:704
    v_perm_b32 v33, v19, v18, s100
    v_mfma_f32_16x16x32_bf16 v[164:167], a[200:203], v[40:43], v[164:167]
    s_add_u32 m0, s44, 127488
    v_exp_f32 v21, v21
    v_mfma_f32_16x16x32_bf16 v[164:167], a[204:207], v[44:47], v[164:167]
    s_mov_b32 s45, 147584
    buffer_load_dwordx4 v7, s[28:31], s45 offen offset:0 lds
    v_mfma_f32_16x16x32_bf16 v[168:171], a[208:211], v[40:43], v[168:171]
    v_exp_f32 v22, v22
    v_mfma_f32_16x16x32_bf16 v[168:171], a[212:215], v[44:47], v[168:171]
    ds_read_b64_tr_b16 a[182:183], v2 offset:960
    v_perm_b32 v34, v21, v20, s100
    v_mfma_f32_16x16x32_bf16 v[172:175], a[216:219], v[40:43], v[172:175]
    s_add_u32 m0, s44, 127392
    v_exp_f32 v23, v23
    v_mfma_f32_16x16x32_bf16 v[172:175], a[220:223], v[44:47], v[172:175]
    buffer_load_dwordx4 v7, s[28:31], s45 offen offset:1152 lds
    v_mfma_f32_16x16x32_bf16 v[176:179], a[224:227], v[40:43], v[176:179]
    v_exp_f32 v24, v24
    v_mfma_f32_16x16x32_bf16 v[176:179], a[228:231], v[44:47], v[176:179]
    ds_read_b64_tr_b16 a[184:185], v2 offset:224
    v_perm_b32 v35, v23, v22, s100
    v_mfma_f32_16x16x32_bf16 v[180:183], a[232:235], v[40:43], v[180:183]
    s_add_u32 m0, s44, 127296
    v_exp_f32 v25, v25
    v_mfma_f32_16x16x32_bf16 v[180:183], a[236:239], v[44:47], v[180:183]
    buffer_load_dwordx4 v7, s[28:31], s45 offen offset:2304 lds
    v_mfma_f32_16x16x32_bf16 v[184:187], a[240:243], v[40:43], v[184:187]
    v_exp_f32 v26, v26
    v_mfma_f32_16x16x32_bf16 v[184:187], a[244:247], v[44:47], v[184:187]
    ds_read_b64_tr_b16 a[186:187], v2 offset:480
    v_perm_b32 v36, v25, v24, s100
    v_mfma_f32_16x16x32_bf16 v[188:191], a[248:251], v[40:43], v[188:191]
    s_add_u32 m0, s44, 127200
    v_exp_f32 v27, v27
    v_mfma_f32_16x16x32_bf16 v[188:191], a[252:255], v[44:47], v[188:191]
    buffer_load_dwordx4 v7, s[28:31], s45 offen offset:3456 lds
    v_smfmac_f32_16x16x64_bf16 a[4:7], a[16:19], v[40:47], v11
    ds_read_b64_tr_b16 a[188:189], v2 offset:736
    ds_read_b64_tr_b16 a[190:191], v2 offset:992
    v_mfma_f32_16x16x32_bf16 v[16:19], a[64:67], v[112:115], v[60:63]
    v_exp_f32 v28, v28
    v_mfma_f32_16x16x32_bf16 v[16:19], a[68:71], v[116:119], v[16:19]
    ds_read_b128 a[64:67], v1 offset:0
    v_perm_b32 v37, v27, v26, s100
    v_mfma_f32_16x16x32_bf16 v[16:19], a[72:75], v[120:123], v[16:19]
    v_exp_f32 v29, v29
    v_mfma_f32_16x16x32_bf16 v[16:19], a[76:79], v[124:127], v[16:19]
    ds_read_b128 a[68:71], v1 offset:64
    v_mfma_f32_16x16x32_bf16 v[20:23], a[80:83], v[112:115], v[60:63]
    v_exp_f32 v30, v30
    v_mfma_f32_16x16x32_bf16 v[20:23], a[84:87], v[116:119], v[20:23]
    ds_read_b128 a[72:75], v1 offset:128
    v_perm_b32 v38, v29, v28, s100
    v_mfma_f32_16x16x32_bf16 v[20:23], a[88:91], v[120:123], v[20:23]
    v_exp_f32 v31, v31
    v_mfma_f32_16x16x32_bf16 v[20:23], a[92:95], v[124:127], v[20:23]
    ds_read_b128 a[76:79], v1 offset:192
    v_mfma_f32_16x16x32_bf16 v[24:27], a[96:99], v[112:115], v[60:63]
    v_exp_f32 v16, v16
    v_mfma_f32_16x16x32_bf16 v[24:27], a[100:103], v[116:119], v[24:27]
    ds_read_b128 a[80:83], v1 offset:256
    v_perm_b32 v39, v31, v30, s100
    v_mfma_f32_16x16x32_bf16 v[24:27], a[104:107], v[120:123], v[24:27]
    v_exp_f32 v17, v17
    v_mfma_f32_16x16x32_bf16 v[24:27], a[108:111], v[124:127], v[24:27]
    ds_read_b128 a[84:87], v1 offset:320
    v_mfma_f32_16x16x32_bf16 v[28:31], a[112:115], v[112:115], v[60:63]
    v_exp_f32 v18, v18
    v_mfma_f32_16x16x32_bf16 v[28:31], a[116:119], v[116:119], v[28:31]
    ds_read_b128 a[88:91], v1 offset:384
    v_perm_b32 v40, v17, v16, s100
    v_mfma_f32_16x16x32_bf16 v[28:31], a[120:123], v[120:123], v[28:31]
    v_exp_f32 v19, v19
    v_mfma_f32_16x16x32_bf16 v[28:31], a[124:127], v[124:127], v[28:31]
    ds_read_b128 a[92:95], v1 offset:448
    v_mfma_f32_16x16x32_bf16 v[192:195], a[192:195], v[32:35], v[192:195]
    v_exp_f32 v20, v20
    v_mfma_f32_16x16x32_bf16 v[192:195], a[196:199], v[36:39], v[192:195]
    ds_read_b128 a[96:99], v1 offset:512
    v_perm_b32 v41, v19, v18, s100
    v_mfma_f32_16x16x32_bf16 v[196:199], a[200:203], v[32:35], v[196:199]
    v_exp_f32 v21, v21
    v_mfma_f32_16x16x32_bf16 v[196:199], a[204:207], v[36:39], v[196:199]
    ds_read_b128 a[100:103], v1 offset:576
    v_mfma_f32_16x16x32_bf16 v[200:203], a[208:211], v[32:35], v[200:203]
    v_exp_f32 v22, v22
    v_mfma_f32_16x16x32_bf16 v[200:203], a[212:215], v[36:39], v[200:203]
    ds_read_b128 a[104:107], v1 offset:640
    v_perm_b32 v42, v21, v20, s100
    v_mfma_f32_16x16x32_bf16 v[204:207], a[216:219], v[32:35], v[204:207]
    v_exp_f32 v23, v23
    v_mfma_f32_16x16x32_bf16 v[204:207], a[220:223], v[36:39], v[204:207]
    ds_read_b128 a[108:111], v1 offset:704
    v_mfma_f32_16x16x32_bf16 v[208:211], a[224:227], v[32:35], v[208:211]
    v_exp_f32 v24, v24
    v_mfma_f32_16x16x32_bf16 v[208:211], a[228:231], v[36:39], v[208:211]
    ds_read_b128 a[112:115], v1 offset:768
    v_perm_b32 v43, v23, v22, s100
    v_mfma_f32_16x16x32_bf16 v[212:215], a[232:235], v[32:35], v[212:215]
    v_exp_f32 v25, v25
    v_mfma_f32_16x16x32_bf16 v[212:215], a[236:239], v[36:39], v[212:215]
    ds_read_b128 a[116:119], v1 offset:832
    v_mfma_f32_16x16x32_bf16 v[216:219], a[240:243], v[32:35], v[216:219]
    v_exp_f32 v26, v26
    v_mfma_f32_16x16x32_bf16 v[216:219], a[244:247], v[36:39], v[216:219]
    ds_read_b128 a[120:123], v1 offset:896
    v_perm_b32 v44, v25, v24, s100
    v_mfma_f32_16x16x32_bf16 v[220:223], a[248:251], v[32:35], v[220:223]
    v_exp_f32 v27, v27
    v_mfma_f32_16x16x32_bf16 v[220:223], a[252:255], v[36:39], v[220:223]
    ds_read_b128 a[124:127], v1 offset:960
    v_smfmac_f32_16x16x64_bf16 a[8:11], a[16:19], v[32:39], v11
    s_waitcnt lgkmcnt(12)
    v_mfma_f32_16x16x32_bf16 v[16:19], a[64:67], v[64:67], v[48:51]
    v_exp_f32 v28, v28
    v_mfma_f32_16x16x32_bf16 v[16:19], a[68:71], v[68:71], v[16:19]
    v_perm_b32 v45, v27, v26, s100
    v_mfma_f32_16x16x32_bf16 v[16:19], a[72:75], v[72:75], v[16:19]
    s_mov_b32 s54, 737280
    v_exp_f32 v29, v29
    v_mfma_f32_16x16x32_bf16 v[16:19], a[76:79], v[76:79], v[16:19]
    s_waitcnt lgkmcnt(8)
    buffer_load_dwordx4 a[40:43], v6, s[64:67], s54 offen
    v_mfma_f32_16x16x32_bf16 v[20:23], a[80:83], v[64:67], v[48:51]
    v_exp_f32 v30, v30
    v_mfma_f32_16x16x32_bf16 v[20:23], a[84:87], v[68:71], v[20:23]
    v_perm_b32 v46, v29, v28, s100
    v_mfma_f32_16x16x32_bf16 v[20:23], a[88:91], v[72:75], v[20:23]
    v_exp_f32 v31, v31
    v_mfma_f32_16x16x32_bf16 v[20:23], a[92:95], v[76:79], v[20:23]
    s_waitcnt lgkmcnt(4)
    v_mfma_f32_16x16x32_bf16 v[24:27], a[96:99], v[64:67], v[48:51]
    v_exp_f32 v16, v16
    v_mfma_f32_16x16x32_bf16 v[24:27], a[100:103], v[68:71], v[24:27]
    v_perm_b32 v47, v31, v30, s100
    v_mfma_f32_16x16x32_bf16 v[24:27], a[104:107], v[72:75], v[24:27]
    s_mov_b32 s54, 884736
    v_exp_f32 v17, v17
    v_mfma_f32_16x16x32_bf16 v[24:27], a[108:111], v[76:79], v[24:27]
    s_waitcnt lgkmcnt(0)
    buffer_load_dwordx4 a[44:47], v6, s[64:67], s54 offen
    v_mfma_f32_16x16x32_bf16 v[28:31], a[112:115], v[64:67], v[48:51]
    v_exp_f32 v18, v18
    v_mfma_f32_16x16x32_bf16 v[28:31], a[116:119], v[68:71], v[28:31]
    v_perm_b32 v32, v17, v16, s100
    v_mfma_f32_16x16x32_bf16 v[28:31], a[120:123], v[72:75], v[28:31]
    v_exp_f32 v19, v19
    v_mfma_f32_16x16x32_bf16 v[28:31], a[124:127], v[76:79], v[28:31]
    v_mfma_f32_16x16x32_bf16 v[224:227], a[192:195], v[40:43], v[224:227]
    v_exp_f32 v20, v20
    v_mfma_f32_16x16x32_bf16 v[224:227], a[196:199], v[44:47], v[224:227]
    ds_read_b64_tr_b16 a[192:193], v2 offset:36864
    v_perm_b32 v33, v19, v18, s100
    v_mfma_f32_16x16x32_bf16 v[228:231], a[200:203], v[40:43], v[228:231]
    s_mov_b32 s54, 1032192
    v_exp_f32 v21, v21
    v_mfma_f32_16x16x32_bf16 v[228:231], a[204:207], v[44:47], v[228:231]
    buffer_load_dwordx4 a[48:51], v6, s[64:67], s54 offen
    v_mfma_f32_16x16x32_bf16 v[232:235], a[208:211], v[40:43], v[232:235]
    v_exp_f32 v22, v22
    v_mfma_f32_16x16x32_bf16 v[232:235], a[212:215], v[44:47], v[232:235]
    ds_read_b64_tr_b16 a[194:195], v2 offset:37120
    v_perm_b32 v34, v21, v20, s100
    v_mfma_f32_16x16x32_bf16 v[236:239], a[216:219], v[40:43], v[236:239]
    v_exp_f32 v23, v23
    v_mfma_f32_16x16x32_bf16 v[236:239], a[220:223], v[44:47], v[236:239]
    ds_read_b64_tr_b16 a[196:197], v2 offset:37376
    v_mfma_f32_16x16x32_bf16 v[240:243], a[224:227], v[40:43], v[240:243]
    v_exp_f32 v24, v24
    v_mfma_f32_16x16x32_bf16 v[240:243], a[228:231], v[44:47], v[240:243]
    ds_read_b64_tr_b16 a[198:199], v2 offset:37632
    v_perm_b32 v35, v23, v22, s100
    v_mfma_f32_16x16x32_bf16 v[244:247], a[232:235], v[40:43], v[244:247]
    s_mov_b32 s54, 1179648
    v_exp_f32 v25, v25
    v_mfma_f32_16x16x32_bf16 v[244:247], a[236:239], v[44:47], v[244:247]
    buffer_load_dwordx4 a[52:55], v6, s[64:67], s54 offen
    v_mfma_f32_16x16x32_bf16 v[248:251], a[240:243], v[40:43], v[248:251]
    v_exp_f32 v26, v26
    v_mfma_f32_16x16x32_bf16 v[248:251], a[244:247], v[44:47], v[248:251]
    ds_read_b64_tr_b16 a[200:201], v2 offset:36896
    v_perm_b32 v36, v25, v24, s100
    v_mfma_f32_16x16x32_bf16 v[252:255], a[248:251], v[40:43], v[252:255]
    v_exp_f32 v27, v27
    v_mfma_f32_16x16x32_bf16 v[252:255], a[252:255], v[44:47], v[252:255]
    ds_read_b64_tr_b16 a[202:203], v2 offset:37152
    v_smfmac_f32_16x16x64_bf16 a[12:15], a[16:19], v[40:47], v11
    ds_read_b64_tr_b16 a[204:205], v2 offset:37408
    v_mfma_f32_16x16x32_bf16 v[16:19], a[64:67], v[80:83], v[52:55]
    v_exp_f32 v28, v28
    v_mfma_f32_16x16x32_bf16 v[16:19], a[68:71], v[84:87], v[16:19]
    ds_read_b64_tr_b16 a[206:207], v2 offset:37664
    v_perm_b32 v37, v27, v26, s100
    v_mfma_f32_16x16x32_bf16 v[16:19], a[72:75], v[88:91], v[16:19]
    v_exp_f32 v29, v29
    v_mfma_f32_16x16x32_bf16 v[16:19], a[76:79], v[92:95], v[16:19]
    buffer_store_dwordx4 a[56:59], v5, s[32:35], 0 offen offset:0 sc1
    v_mfma_f32_16x16x32_bf16 v[20:23], a[80:83], v[80:83], v[52:55]
    v_exp_f32 v30, v30
    v_mfma_f32_16x16x32_bf16 v[20:23], a[84:87], v[84:87], v[20:23]
    ds_read_b64_tr_b16 a[208:209], v2 offset:36928
    v_perm_b32 v38, v29, v28, s100
    v_mfma_f32_16x16x32_bf16 v[20:23], a[88:91], v[88:91], v[20:23]
    v_exp_f32 v31, v31
    v_mfma_f32_16x16x32_bf16 v[20:23], a[92:95], v[92:95], v[20:23]
    ds_read_b64_tr_b16 a[210:211], v2 offset:37184
    v_mfma_f32_16x16x32_bf16 v[24:27], a[96:99], v[80:83], v[52:55]
    v_exp_f32 v16, v16
    v_mfma_f32_16x16x32_bf16 v[24:27], a[100:103], v[84:87], v[24:27]
    ds_read_b64_tr_b16 a[212:213], v2 offset:37440
    v_perm_b32 v39, v31, v30, s100
    v_mfma_f32_16x16x32_bf16 v[24:27], a[104:107], v[88:91], v[24:27]
    v_exp_f32 v17, v17
    v_mfma_f32_16x16x32_bf16 v[24:27], a[108:111], v[92:95], v[24:27]
    buffer_store_dwordx4 a[56:59], v5, s[32:35], 0 offen offset:1024 sc1
    v_mfma_f32_16x16x32_bf16 v[28:31], a[112:115], v[80:83], v[52:55]
    v_exp_f32 v18, v18
    v_mfma_f32_16x16x32_bf16 v[28:31], a[116:119], v[84:87], v[28:31]
    ds_read_b64_tr_b16 a[214:215], v2 offset:37696
    v_perm_b32 v40, v17, v16, s100
    v_mfma_f32_16x16x32_bf16 v[28:31], a[120:123], v[88:91], v[28:31]
    v_exp_f32 v19, v19
    v_mfma_f32_16x16x32_bf16 v[28:31], a[124:127], v[92:95], v[28:31]
    ds_read_b64_tr_b16 a[216:217], v2 offset:36960
    v_mfma_f32_16x16x32_bf16 v[128:131], a[128:131], v[32:35], v[128:131]
    v_exp_f32 v20, v20
    v_mfma_f32_16x16x32_bf16 v[128:131], a[132:135], v[36:39], v[128:131]
    ds_read_b64_tr_b16 a[218:219], v2 offset:37216
    v_perm_b32 v41, v19, v18, s100
    v_mfma_f32_16x16x32_bf16 v[132:135], a[136:139], v[32:35], v[132:135]
    v_exp_f32 v21, v21
    v_mfma_f32_16x16x32_bf16 v[132:135], a[140:143], v[36:39], v[132:135]
    buffer_store_dwordx4 a[56:59], v5, s[32:35], 0 offen offset:2048 sc1
    v_mfma_f32_16x16x32_bf16 v[136:139], a[144:147], v[32:35], v[136:139]
    v_exp_f32 v22, v22
    v_mfma_f32_16x16x32_bf16 v[136:139], a[148:151], v[36:39], v[136:139]
    ds_read_b64_tr_b16 a[220:221], v2 offset:37472
    v_perm_b32 v42, v21, v20, s100
    v_mfma_f32_16x16x32_bf16 v[140:143], a[152:155], v[32:35], v[140:143]
    v_exp_f32 v23, v23
    v_mfma_f32_16x16x32_bf16 v[140:143], a[156:159], v[36:39], v[140:143]
    ds_read_b64_tr_b16 a[222:223], v2 offset:37728
    v_mfma_f32_16x16x32_bf16 v[144:147], a[160:163], v[32:35], v[144:147]
    v_exp_f32 v24, v24
    v_mfma_f32_16x16x32_bf16 v[144:147], a[164:167], v[36:39], v[144:147]
    ds_read_b64_tr_b16 a[224:225], v2 offset:36992
    v_perm_b32 v43, v23, v22, s100
    v_mfma_f32_16x16x32_bf16 v[148:151], a[168:171], v[32:35], v[148:151]
    v_exp_f32 v25, v25
    v_mfma_f32_16x16x32_bf16 v[148:151], a[172:175], v[36:39], v[148:151]
    buffer_store_dwordx4 a[56:59], v5, s[32:35], 0 offen offset:3072 sc1
    v_mfma_f32_16x16x32_bf16 v[152:155], a[176:179], v[32:35], v[152:155]
    v_exp_f32 v26, v26
    v_mfma_f32_16x16x32_bf16 v[152:155], a[180:183], v[36:39], v[152:155]
    ds_read_b64_tr_b16 a[226:227], v2 offset:37248
    v_perm_b32 v44, v25, v24, s100
    v_mfma_f32_16x16x32_bf16 v[156:159], a[184:187], v[32:35], v[156:159]
    v_exp_f32 v27, v27
    v_mfma_f32_16x16x32_bf16 v[156:159], a[188:191], v[36:39], v[156:159]
    ds_read_b64_tr_b16 a[228:229], v2 offset:37504
    v_smfmac_f32_16x16x64_bf16 a[0:3], a[16:19], v[32:39], v11
    ds_read_b64_tr_b16 a[230:231], v2 offset:37760
    v_mfma_f32_16x16x32_bf16 v[16:19], a[64:67], v[96:99], v[56:59]
    v_exp_f32 v28, v28
    v_mfma_f32_16x16x32_bf16 v[16:19], a[68:71], v[100:103], v[16:19]
    ds_read_b64_tr_b16 a[232:233], v2 offset:37024
    v_perm_b32 v45, v27, v26, s100
    v_mfma_f32_16x16x32_bf16 v[16:19], a[72:75], v[104:107], v[16:19]
    v_exp_f32 v29, v29
    v_mfma_f32_16x16x32_bf16 v[16:19], a[76:79], v[108:111], v[16:19]
    ds_read_b64_tr_b16 a[234:235], v2 offset:37280
    v_mfma_f32_16x16x32_bf16 v[20:23], a[80:83], v[96:99], v[56:59]
    v_exp_f32 v30, v30
    v_mfma_f32_16x16x32_bf16 v[20:23], a[84:87], v[100:103], v[20:23]
    ds_read_b64_tr_b16 a[236:237], v2 offset:37536
    v_perm_b32 v46, v29, v28, s100
    v_mfma_f32_16x16x32_bf16 v[20:23], a[88:91], v[104:107], v[20:23]
    v_exp_f32 v31, v31
    v_mfma_f32_16x16x32_bf16 v[20:23], a[92:95], v[108:111], v[20:23]
    ds_read_b64_tr_b16 a[238:239], v2 offset:37792
    v_mfma_f32_16x16x32_bf16 v[24:27], a[96:99], v[96:99], v[56:59]
    v_exp_f32 v16, v16
    v_mfma_f32_16x16x32_bf16 v[24:27], a[100:103], v[100:103], v[24:27]
    ds_read_b64_tr_b16 a[240:241], v2 offset:37056
    v_perm_b32 v47, v31, v30, s100
    v_mfma_f32_16x16x32_bf16 v[24:27], a[104:107], v[104:107], v[24:27]
    v_exp_f32 v17, v17
    v_mfma_f32_16x16x32_bf16 v[24:27], a[108:111], v[108:111], v[24:27]
    ds_read_b64_tr_b16 a[242:243], v2 offset:37312
    v_mfma_f32_16x16x32_bf16 v[28:31], a[112:115], v[96:99], v[56:59]
    v_exp_f32 v18, v18
    v_mfma_f32_16x16x32_bf16 v[28:31], a[116:119], v[100:103], v[28:31]
L2_pad9:
    s_cbranch_execz L2_pad13
    ds_read_b64_tr_b16 a[244:245], v2 offset:37568
    v_perm_b32 v32, v17, v16, s100
    v_mfma_f32_16x16x32_bf16 v[28:31], a[120:123], v[104:107], v[28:31]
    v_exp_f32 v19, v19
    v_mfma_f32_16x16x32_bf16 v[28:31], a[124:127], v[108:111], v[28:31]
    ds_read_b64_tr_b16 a[246:247], v2 offset:37824
    v_mfma_f32_16x16x32_bf16 v[160:163], a[128:131], v[40:43], v[160:163]
    v_exp_f32 v20, v20
    v_mfma_f32_16x16x32_bf16 v[160:163], a[132:135], v[44:47], v[160:163]
    ds_read_b64_tr_b16 a[248:249], v2 offset:37088
    v_perm_b32 v33, v19, v18, s100
    v_mfma_f32_16x16x32_bf16 v[164:167], a[136:139], v[40:43], v[164:167]
    v_exp_f32 v21, v21
    v_mfma_f32_16x16x32_bf16 v[164:167], a[140:143], v[44:47], v[164:167]
    ds_read_b64_tr_b16 a[250:251], v2 offset:37344
    v_mfma_f32_16x16x32_bf16 v[168:171], a[144:147], v[40:43], v[168:171]
    v_exp_f32 v22, v22
    v_mfma_f32_16x16x32_bf16 v[168:171], a[148:151], v[44:47], v[168:171]
    ds_read_b64_tr_b16 a[252:253], v2 offset:37600
    v_perm_b32 v34, v21, v20, s100
    v_mfma_f32_16x16x32_bf16 v[172:175], a[152:155], v[40:43], v[172:175]
    v_exp_f32 v23, v23
    v_mfma_f32_16x16x32_bf16 v[172:175], a[156:159], v[44:47], v[172:175]
    ds_read_b64_tr_b16 a[254:255], v2 offset:37856
    v_mfma_f32_16x16x32_bf16 v[176:179], a[160:163], v[40:43], v[176:179]
    v_exp_f32 v24, v24
    v_mfma_f32_16x16x32_bf16 v[176:179], a[164:167], v[44:47], v[176:179]
    v_perm_b32 v35, v23, v22, s100
    v_mfma_f32_16x16x32_bf16 v[180:183], a[168:171], v[40:43], v[180:183]
    v_exp_f32 v25, v25
    v_mfma_f32_16x16x32_bf16 v[180:183], a[172:175], v[44:47], v[180:183]
    v_mfma_f32_16x16x32_bf16 v[184:187], a[176:179], v[40:43], v[184:187]
    v_exp_f32 v26, v26
    v_mfma_f32_16x16x32_bf16 v[184:187], a[180:183], v[44:47], v[184:187]
    v_perm_b32 v36, v25, v24, s100
    v_mfma_f32_16x16x32_bf16 v[188:191], a[184:187], v[40:43], v[188:191]
    v_exp_f32 v27, v27
    v_mfma_f32_16x16x32_bf16 v[188:191], a[188:191], v[44:47], v[188:191]
    v_smfmac_f32_16x16x64_bf16 a[4:7], a[16:19], v[40:47], v11
    v_mfma_f32_16x16x32_bf16 v[16:19], a[64:67], v[112:115], v[60:63]
    v_exp_f32 v28, v28
    v_mfma_f32_16x16x32_bf16 v[16:19], a[68:71], v[116:119], v[16:19]
    ds_read_b128 a[64:67], v1 offset:36864
    v_perm_b32 v37, v27, v26, s100
    v_mfma_f32_16x16x32_bf16 v[16:19], a[72:75], v[120:123], v[16:19]
    v_exp_f32 v29, v29
    v_mfma_f32_16x16x32_bf16 v[16:19], a[76:79], v[124:127], v[16:19]
    ds_read_b128 a[68:71], v1 offset:36928
    v_mfma_f32_16x16x32_bf16 v[20:23], a[80:83], v[112:115], v[60:63]
    v_exp_f32 v30, v30
    v_mfma_f32_16x16x32_bf16 v[20:23], a[84:87], v[116:119], v[20:23]
    ds_read_b128 a[72:75], v1 offset:36992
    v_perm_b32 v38, v29, v28, s100
    v_mfma_f32_16x16x32_bf16 v[20:23], a[88:91], v[120:123], v[20:23]
    v_exp_f32 v31, v31
    v_mfma_f32_16x16x32_bf16 v[20:23], a[92:95], v[124:127], v[20:23]
    ds_read_b128 a[76:79], v1 offset:37056
    v_mfma_f32_16x16x32_bf16 v[24:27], a[96:99], v[112:115], v[60:63]
    v_exp_f32 v16, v16
    v_mfma_f32_16x16x32_bf16 v[24:27], a[100:103], v[116:119], v[24:27]
    ds_read_b128 a[80:83], v1 offset:37120
    v_perm_b32 v39, v31, v30, s100
    v_mfma_f32_16x16x32_bf16 v[24:27], a[104:107], v[120:123], v[24:27]
    v_exp_f32 v17, v17
    v_mfma_f32_16x16x32_bf16 v[24:27], a[108:111], v[124:127], v[24:27]
    ds_read_b128 a[84:87], v1 offset:37184
    v_mfma_f32_16x16x32_bf16 v[28:31], a[112:115], v[112:115], v[60:63]
    v_exp_f32 v18, v18
    v_mfma_f32_16x16x32_bf16 v[28:31], a[116:119], v[116:119], v[28:31]
    ds_read_b128 a[88:91], v1 offset:37248
    v_perm_b32 v40, v17, v16, s100
    v_mfma_f32_16x16x32_bf16 v[28:31], a[120:123], v[120:123], v[28:31]
    v_exp_f32 v19, v19
    v_mfma_f32_16x16x32_bf16 v[28:31], a[124:127], v[124:127], v[28:31]
    ds_read_b128 a[92:95], v1 offset:37312
    v_mfma_f32_16x16x32_bf16 v[192:195], a[128:131], v[32:35], v[192:195]
    v_exp_f32 v20, v20
    v_mfma_f32_16x16x32_bf16 v[192:195], a[132:135], v[36:39], v[192:195]
    ds_read_b128 a[96:99], v1 offset:37376
    v_perm_b32 v41, v19, v18, s100
    v_mfma_f32_16x16x32_bf16 v[196:199], a[136:139], v[32:35], v[196:199]
    v_exp_f32 v21, v21
    v_mfma_f32_16x16x32_bf16 v[196:199], a[140:143], v[36:39], v[196:199]
    ds_read_b128 a[100:103], v1 offset:37440
    v_mfma_f32_16x16x32_bf16 v[200:203], a[144:147], v[32:35], v[200:203]
    v_exp_f32 v22, v22
    v_mfma_f32_16x16x32_bf16 v[200:203], a[148:151], v[36:39], v[200:203]
    ds_read_b128 a[104:107], v1 offset:37504
    v_perm_b32 v42, v21, v20, s100
    v_mfma_f32_16x16x32_bf16 v[204:207], a[152:155], v[32:35], v[204:207]
    v_exp_f32 v23, v23
    v_mfma_f32_16x16x32_bf16 v[204:207], a[156:159], v[36:39], v[204:207]
    ds_read_b128 a[108:111], v1 offset:37568
    v_mfma_f32_16x16x32_bf16 v[208:211], a[160:163], v[32:35], v[208:211]
    v_exp_f32 v24, v24
    v_mfma_f32_16x16x32_bf16 v[208:211], a[164:167], v[36:39], v[208:211]
    ds_read_b128 a[112:115], v1 offset:37632
    v_perm_b32 v43, v23, v22, s100
    v_mfma_f32_16x16x32_bf16 v[212:215], a[168:171], v[32:35], v[212:215]
    v_exp_f32 v25, v25
    v_mfma_f32_16x16x32_bf16 v[212:215], a[172:175], v[36:39], v[212:215]
    ds_read_b128 a[116:119], v1 offset:37696
    v_mfma_f32_16x16x32_bf16 v[216:219], a[176:179], v[32:35], v[216:219]
    v_exp_f32 v26, v26
    v_mfma_f32_16x16x32_bf16 v[216:219], a[180:183], v[36:39], v[216:219]
    ds_read_b128 a[120:123], v1 offset:37760
    v_perm_b32 v44, v25, v24, s100
    v_mfma_f32_16x16x32_bf16 v[220:223], a[184:187], v[32:35], v[220:223]
    v_exp_f32 v27, v27
    v_mfma_f32_16x16x32_bf16 v[220:223], a[188:191], v[36:39], v[220:223]
    ds_read_b128 a[124:127], v1 offset:37824
    v_smfmac_f32_16x16x64_bf16 a[8:11], a[16:19], v[32:39], v11
    s_waitcnt lgkmcnt(12)
    v_mfma_f32_16x16x32_bf16 v[16:19], a[64:67], v[64:67], v[48:51]
    v_exp_f32 v28, v28
    v_mfma_f32_16x16x32_bf16 v[16:19], a[68:71], v[68:71], v[16:19]
    v_perm_b32 v45, v27, v26, s100
    v_mfma_f32_16x16x32_bf16 v[16:19], a[72:75], v[72:75], v[16:19]
    v_exp_f32 v29, v29
    v_mfma_f32_16x16x32_bf16 v[16:19], a[76:79], v[76:79], v[16:19]
    s_waitcnt lgkmcnt(8)
    v_mfma_f32_16x16x32_bf16 v[20:23], a[80:83], v[64:67], v[48:51]
    v_exp_f32 v30, v30
    v_mfma_f32_16x16x32_bf16 v[20:23], a[84:87], v[68:71], v[20:23]
    v_perm_b32 v46, v29, v28, s100
    v_mfma_f32_16x16x32_bf16 v[20:23], a[88:91], v[72:75], v[20:23]
    v_exp_f32 v31, v31
    v_mfma_f32_16x16x32_bf16 v[20:23], a[92:95], v[76:79], v[20:23]
    s_waitcnt lgkmcnt(4)
    v_mfma_f32_16x16x32_bf16 v[24:27], a[96:99], v[64:67], v[48:51]
    v_exp_f32 v16, v16
    v_mfma_f32_16x16x32_bf16 v[24:27], a[100:103], v[68:71], v[24:27]
    v_perm_b32 v47, v31, v30, s100
    v_mfma_f32_16x16x32_bf16 v[24:27], a[104:107], v[72:75], v[24:27]
    v_exp_f32 v17, v17
    v_mfma_f32_16x16x32_bf16 v[24:27], a[108:111], v[76:79], v[24:27]
    s_waitcnt lgkmcnt(0)
    v_mfma_f32_16x16x32_bf16 v[28:31], a[112:115], v[64:67], v[48:51]
    v_exp_f32 v18, v18
    v_mfma_f32_16x16x32_bf16 v[28:31], a[116:119], v[68:71], v[28:31]
    v_perm_b32 v32, v17, v16, s100
    v_mfma_f32_16x16x32_bf16 v[28:31], a[120:123], v[72:75], v[28:31]
    v_exp_f32 v19, v19
    v_mfma_f32_16x16x32_bf16 v[28:31], a[124:127], v[76:79], v[28:31]
    s_waitcnt vmcnt(8)
    s_barrier
    v_mfma_f32_16x16x32_bf16 v[224:227], a[128:131], v[40:43], v[224:227]
    v_exp_f32 v20, v20
    v_mfma_f32_16x16x32_bf16 v[224:227], a[132:135], v[44:47], v[224:227]
    v_perm_b32 v33, v19, v18, s100
    v_mfma_f32_16x16x32_bf16 v[228:231], a[136:139], v[40:43], v[228:231]
    s_add_u32 m0, s44, 0
    v_exp_f32 v21, v21
    v_mfma_f32_16x16x32_bf16 v[228:231], a[140:143], v[44:47], v[228:231]
    s_mov_b32 s45, 256
    buffer_load_dwordx4 v7, s[28:31], s45 offen offset:0 lds
    v_mfma_f32_16x16x32_bf16 v[232:235], a[144:147], v[40:43], v[232:235]
    v_exp_f32 v22, v22
    v_mfma_f32_16x16x32_bf16 v[232:235], a[148:151], v[44:47], v[232:235]
    v_perm_b32 v34, v21, v20, s100
    v_mfma_f32_16x16x32_bf16 v[236:239], a[152:155], v[40:43], v[236:239]
    s_add_u32 m0, s44, -96
    v_exp_f32 v23, v23
    v_mfma_f32_16x16x32_bf16 v[236:239], a[156:159], v[44:47], v[236:239]
    buffer_load_dwordx4 v7, s[28:31], s45 offen offset:1152 lds
    v_mfma_f32_16x16x32_bf16 v[240:243], a[160:163], v[40:43], v[240:243]
    v_exp_f32 v24, v24
    v_mfma_f32_16x16x32_bf16 v[240:243], a[164:167], v[44:47], v[240:243]
    v_perm_b32 v35, v23, v22, s100
    v_mfma_f32_16x16x32_bf16 v[244:247], a[168:171], v[40:43], v[244:247]
    s_add_u32 m0, s44, -192
    v_exp_f32 v25, v25
    v_mfma_f32_16x16x32_bf16 v[244:247], a[172:175], v[44:47], v[244:247]
    buffer_load_dwordx4 v7, s[28:31], s45 offen offset:2304 lds
    v_mfma_f32_16x16x32_bf16 v[248:251], a[176:179], v[40:43], v[248:251]
    v_exp_f32 v26, v26
    v_mfma_f32_16x16x32_bf16 v[248:251], a[180:183], v[44:47], v[248:251]
    v_perm_b32 v36, v25, v24, s100
    v_mfma_f32_16x16x32_bf16 v[252:255], a[184:187], v[40:43], v[252:255]
    s_add_u32 m0, s44, -288
    v_exp_f32 v27, v27
    v_mfma_f32_16x16x32_bf16 v[252:255], a[188:191], v[44:47], v[252:255]
    buffer_load_dwordx4 v7, s[28:31], s45 offen offset:3456 lds
    v_smfmac_f32_16x16x64_bf16 a[12:15], a[16:19], v[40:47], v11
    v_mfma_f32_16x16x32_bf16 v[16:19], a[64:67], v[80:83], v[52:55]
    v_exp_f32 v28, v28
    v_mfma_f32_16x16x32_bf16 v[16:19], a[68:71], v[84:87], v[16:19]
    v_perm_b32 v37, v27, v26, s100
    v_mfma_f32_16x16x32_bf16 v[16:19], a[72:75], v[88:91], v[16:19]
    s_add_u32 m0, s44, 16896
    v_exp_f32 v29, v29
    v_mfma_f32_16x16x32_bf16 v[16:19], a[76:79], v[92:95], v[16:19]
    s_mov_b32 s45, 147712
    buffer_load_dwordx4 v7, s[28:31], s45 offen offset:0 lds
    v_mfma_f32_16x16x32_bf16 v[20:23], a[80:83], v[80:83], v[52:55]
    v_exp_f32 v30, v30
    v_mfma_f32_16x16x32_bf16 v[20:23], a[84:87], v[84:87], v[20:23]
    v_perm_b32 v38, v29, v28, s100
    v_mfma_f32_16x16x32_bf16 v[20:23], a[88:91], v[88:91], v[20:23]
    s_add_u32 m0, s44, 16800
    v_exp_f32 v31, v31
    v_mfma_f32_16x16x32_bf16 v[20:23], a[92:95], v[92:95], v[20:23]
    s_mov_b32 s15, 0x3f800000
    buffer_load_dwordx4 v7, s[28:31], s45 offen offset:1152 lds
    v_mfma_f32_16x16x32_bf16 v[24:27], a[96:99], v[80:83], v[52:55]
    v_exp_f32 v16, v16
    v_mfma_f32_16x16x32_bf16 v[24:27], a[100:103], v[84:87], v[24:27]
    v_perm_b32 v39, v31, v30, s100
    v_mfma_f32_16x16x32_bf16 v[24:27], a[104:107], v[88:91], v[24:27]
    s_add_u32 m0, s44, 16704
    v_exp_f32 v17, v17
    v_mfma_f32_16x16x32_bf16 v[24:27], a[108:111], v[92:95], v[24:27]
    buffer_load_dwordx4 v7, s[28:31], s45 offen offset:2304 lds
    v_mfma_f32_16x16x32_bf16 v[28:31], a[112:115], v[80:83], v[52:55]
    v_exp_f32 v18, v18
    v_mfma_f32_16x16x32_bf16 v[28:31], a[116:119], v[84:87], v[28:31]
    v_perm_b32 v40, v17, v16, s100
    v_mfma_f32_16x16x32_bf16 v[28:31], a[120:123], v[88:91], v[28:31]
    s_add_u32 m0, s44, 16608
    v_exp_f32 v19, v19
    v_mfma_f32_16x16x32_bf16 v[28:31], a[124:127], v[92:95], v[28:31]
    buffer_load_dwordx4 v7, s[28:31], s45 offen offset:3456 lds
    v_mfma_f32_16x16x32_bf16 v[128:131], a[192:195], v[32:35], v[128:131]
    v_exp_f32 v20, v20
    v_mfma_f32_16x16x32_bf16 v[128:131], a[196:199], v[36:39], v[128:131]
    v_perm_b32 v41, v19, v18, s100
    v_mfma_f32_16x16x32_bf16 v[132:135], a[200:203], v[32:35], v[132:135]
    s_mov_b32 s54, 0
    v_exp_f32 v21, v21
    v_mfma_f32_16x16x32_bf16 v[132:135], a[204:207], v[36:39], v[132:135]
    buffer_load_dwordx4 a[128:131], v6, s[68:71], s54 offen
    v_mfma_f32_16x16x32_bf16 v[136:139], a[208:211], v[32:35], v[136:139]
    v_exp_f32 v22, v22
    v_mfma_f32_16x16x32_bf16 v[136:139], a[212:215], v[36:39], v[136:139]
    v_perm_b32 v42, v21, v20, s100
    v_mfma_f32_16x16x32_bf16 v[140:143], a[216:219], v[32:35], v[140:143]
    s_add_u32 s54, s55, 0
    v_exp_f32 v23, v23
    v_mfma_f32_16x16x32_bf16 v[140:143], a[220:223], v[36:39], v[140:143]
    buffer_load_dwordx4 a[164:167], v8, s[72:75], s54 offen
    v_mfma_f32_16x16x32_bf16 v[144:147], a[224:227], v[32:35], v[144:147]
    v_exp_f32 v24, v24
    v_mfma_f32_16x16x32_bf16 v[144:147], a[228:231], v[36:39], v[144:147]
    v_perm_b32 v43, v23, v22, s100
    v_mfma_f32_16x16x32_bf16 v[148:151], a[232:235], v[32:35], v[148:151]
    s_mov_b32 s54, 147456
    v_exp_f32 v25, v25
    v_mfma_f32_16x16x32_bf16 v[148:151], a[236:239], v[36:39], v[148:151]
    buffer_load_dwordx4 a[132:135], v6, s[68:71], s54 offen
    v_mfma_f32_16x16x32_bf16 v[152:155], a[240:243], v[32:35], v[152:155]
    v_exp_f32 v26, v26
    v_mfma_f32_16x16x32_bf16 v[152:155], a[244:247], v[36:39], v[152:155]
    v_perm_b32 v44, v25, v24, s100
    v_mfma_f32_16x16x32_bf16 v[156:159], a[248:251], v[32:35], v[156:159]
    s_add_u32 s54, s55, 1024
    v_exp_f32 v27, v27
    v_mfma_f32_16x16x32_bf16 v[156:159], a[252:255], v[36:39], v[156:159]
    buffer_load_dwordx4 a[168:171], v8, s[72:75], s54 offen
    v_smfmac_f32_16x16x64_bf16 a[0:3], a[16:19], v[32:39], v11
    v_mfma_f32_16x16x32_bf16 v[16:19], a[64:67], v[96:99], v[56:59]
    v_exp_f32 v28, v28
    v_mfma_f32_16x16x32_bf16 v[16:19], a[68:71], v[100:103], v[16:19]
    v_perm_b32 v45, v27, v26, s100
    v_mfma_f32_16x16x32_bf16 v[16:19], a[72:75], v[104:107], v[16:19]
    s_mov_b32 s54, 294912
    v_exp_f32 v29, v29
    v_mfma_f32_16x16x32_bf16 v[16:19], a[76:79], v[108:111], v[16:19]
    buffer_load_dwordx4 a[136:139], v6, s[68:71], s54 offen
    v_mfma_f32_16x16x32_bf16 v[20:23], a[80:83], v[96:99], v[56:59]
    v_exp_f32 v30, v30
    v_mfma_f32_16x16x32_bf16 v[20:23], a[84:87], v[100:103], v[20:23]
    v_perm_b32 v46, v29, v28, s100
    v_accvgpr_read_b32 v12, a0
    v_mfma_f32_16x16x32_bf16 v[20:23], a[88:91], v[104:107], v[20:23]
    s_add_u32 s54, s55, 2048
    v_exp_f32 v31, v31
    v_mfma_f32_16x16x32_bf16 v[20:23], a[92:95], v[108:111], v[20:23]
    buffer_load_dwordx4 a[172:175], v8, s[72:75], s54 offen
    v_mfma_f32_16x16x32_bf16 v[24:27], a[96:99], v[96:99], v[56:59]
    v_exp_f32 v16, v16
    v_mfma_f32_16x16x32_bf16 v[24:27], a[100:103], v[100:103], v[24:27]
    v_perm_b32 v47, v31, v30, s100
    v_accvgpr_read_b32 v13, a1
    v_mfma_f32_16x16x32_bf16 v[24:27], a[104:107], v[104:107], v[24:27]
    s_mov_b32 s54, 442368
    v_exp_f32 v17, v17
    v_mfma_f32_16x16x32_bf16 v[24:27], a[108:111], v[108:111], v[24:27]
    buffer_load_dwordx4 a[140:143], v6, s[68:71], s54 offen
    v_mfma_f32_16x16x32_bf16 v[28:31], a[112:115], v[96:99], v[56:59]
    v_exp_f32 v18, v18
    v_mfma_f32_16x16x32_bf16 v[28:31], a[116:119], v[100:103], v[28:31]
    v_perm_b32 v32, v17, v16, s100
    v_add_f32 v12, v12, v13
    v_mfma_f32_16x16x32_bf16 v[28:31], a[120:123], v[104:107], v[28:31]
    s_add_u32 s54, s55, 3072
    v_exp_f32 v19, v19
    v_mfma_f32_16x16x32_bf16 v[28:31], a[124:127], v[108:111], v[28:31]
    buffer_load_dwordx4 a[176:179], v8, s[72:75], s54 offen
    v_mfma_f32_16x16x32_bf16 v[160:163], a[192:195], v[40:43], v[160:163]
    v_exp_f32 v20, v20
    v_mfma_f32_16x16x32_bf16 v[160:163], a[196:199], v[44:47], v[160:163]
    v_perm_b32 v33, v19, v18, s100
    v_subrev_u32 v13, 0x1e000000, v12
    v_mfma_f32_16x16x32_bf16 v[164:167], a[200:203], v[40:43], v[164:167]
    s_mov_b32 s54, 589824
    v_exp_f32 v21, v21
    v_mfma_f32_16x16x32_bf16 v[164:167], a[204:207], v[44:47], v[164:167]
    buffer_load_dwordx4 a[144:147], v6, s[68:71], s54 offen
    v_mfma_f32_16x16x32_bf16 v[168:171], a[208:211], v[40:43], v[168:171]
    v_exp_f32 v22, v22
    v_mfma_f32_16x16x32_bf16 v[168:171], a[212:215], v[44:47], v[168:171]
    v_perm_b32 v34, v21, v20, s100
    v_cmp_gt_u32 s[56:57], v13, s15
    v_mfma_f32_16x16x32_bf16 v[172:175], a[216:219], v[40:43], v[172:175]
    s_add_u32 s54, s55, 4096
    v_exp_f32 v23, v23
    v_mfma_f32_16x16x32_bf16 v[172:175], a[220:223], v[44:47], v[172:175]
    buffer_load_dwordx4 a[180:183], v8, s[72:75], s54 offen
    v_mfma_f32_16x16x32_bf16 v[176:179], a[224:227], v[40:43], v[176:179]
    v_exp_f32 v24, v24
    v_mfma_f32_16x16x32_bf16 v[176:179], a[228:231], v[44:47], v[176:179]
    v_perm_b32 v35, v23, v22, s100
    v_mfma_f32_16x16x32_bf16 v[180:183], a[232:235], v[40:43], v[180:183]
    s_mov_b32 s54, 737280
    v_exp_f32 v25, v25
    v_mfma_f32_16x16x32_bf16 v[180:183], a[236:239], v[44:47], v[180:183]
    buffer_load_dwordx4 a[148:151], v6, s[68:71], s54 offen
    v_mfma_f32_16x16x32_bf16 v[184:187], a[240:243], v[40:43], v[184:187]
    v_exp_f32 v26, v26
    v_mfma_f32_16x16x32_bf16 v[184:187], a[244:247], v[44:47], v[184:187]
    v_perm_b32 v36, v25, v24, s100
    v_mfma_f32_16x16x32_bf16 v[188:191], a[248:251], v[40:43], v[188:191]
    s_add_u32 s54, s55, 5120
    v_exp_f32 v27, v27
    v_mfma_f32_16x16x32_bf16 v[188:191], a[252:255], v[44:47], v[188:191]
    buffer_load_dwordx4 a[184:187], v8, s[72:75], s54 offen
    v_smfmac_f32_16x16x64_bf16 a[4:7], a[16:19], v[40:47], v11
    v_rcp_f32 v12, v12
    v_mfma_f32_16x16x32_bf16 v[16:19], a[64:67], v[112:115], v[60:63]
    v_exp_f32 v28, v28
    v_mfma_f32_16x16x32_bf16 v[16:19], a[68:71], v[116:119], v[16:19]
    v_perm_b32 v37, v27, v26, s100
    v_mul_f32 v128, v128, v12
    v_mfma_f32_16x16x32_bf16 v[16:19], a[72:75], v[120:123], v[16:19]
    s_mov_b32 s54, 884736
    v_exp_f32 v29, v29
    v_mfma_f32_16x16x32_bf16 v[16:19], a[76:79], v[124:127], v[16:19]
    buffer_load_dwordx4 a[152:155], v6, s[68:71], s54 offen
    v_mfma_f32_16x16x32_bf16 v[20:23], a[80:83], v[112:115], v[60:63]
    v_exp_f32 v30, v30
    v_mfma_f32_16x16x32_bf16 v[20:23], a[84:87], v[116:119], v[20:23]
    v_perm_b32 v38, v29, v28, s100
    v_mul_f32 v129, v129, v12
    v_mfma_f32_16x16x32_bf16 v[20:23], a[88:91], v[120:123], v[20:23]
    s_add_u32 s54, s55, 6144
    v_exp_f32 v31, v31
    v_mfma_f32_16x16x32_bf16 v[20:23], a[92:95], v[124:127], v[20:23]
    buffer_load_dwordx4 a[188:191], v8, s[72:75], s54 offen
    v_mfma_f32_16x16x32_bf16 v[24:27], a[96:99], v[112:115], v[60:63]
    v_exp_f32 v16, v16
    v_mfma_f32_16x16x32_bf16 v[24:27], a[100:103], v[116:119], v[24:27]
    v_perm_b32 v39, v31, v30, s100
    v_mul_f32 v130, v130, v12
    v_mfma_f32_16x16x32_bf16 v[24:27], a[104:107], v[120:123], v[24:27]
    s_mov_b32 s54, 1032192
    v_exp_f32 v17, v17
    v_mfma_f32_16x16x32_bf16 v[24:27], a[108:111], v[124:127], v[24:27]
    buffer_load_dwordx4 a[156:159], v6, s[68:71], s54 offen
    v_mfma_f32_16x16x32_bf16 v[28:31], a[112:115], v[112:115], v[60:63]
    v_exp_f32 v18, v18
    v_mfma_f32_16x16x32_bf16 v[28:31], a[116:119], v[116:119], v[28:31]
    v_perm_b32 v40, v17, v16, s100
    v_mul_f32 v131, v131, v12
    v_mfma_f32_16x16x32_bf16 v[28:31], a[120:123], v[120:123], v[28:31]
    s_mov_b32 s54, 1179648
    v_exp_f32 v19, v19
    v_mfma_f32_16x16x32_bf16 v[28:31], a[124:127], v[124:127], v[28:31]
    buffer_load_dwordx4 a[160:163], v6, s[68:71], s54 offen
    v_mfma_f32_16x16x32_bf16 v[192:195], a[192:195], v[32:35], v[192:195]
    v_exp_f32 v20, v20
    v_mfma_f32_16x16x32_bf16 v[192:195], a[196:199], v[36:39], v[192:195]
    v_perm_b32 v41, v19, v18, s100
    v_mul_f32 v132, v132, v12
    v_mfma_f32_16x16x32_bf16 v[196:199], a[200:203], v[32:35], v[196:199]
    v_exp_f32 v21, v21
    v_mfma_f32_16x16x32_bf16 v[196:199], a[204:207], v[36:39], v[196:199]
    v_mul_f32 v133, v133, v12
    v_mul_f32 v134, v134, v12
    v_mfma_f32_16x16x32_bf16 v[200:203], a[208:211], v[32:35], v[200:203]
    v_exp_f32 v22, v22
    v_mfma_f32_16x16x32_bf16 v[200:203], a[212:215], v[36:39], v[200:203]
    v_perm_b32 v42, v21, v20, s100
    v_mul_f32 v135, v135, v12
    v_mfma_f32_16x16x32_bf16 v[204:207], a[216:219], v[32:35], v[204:207]
    v_exp_f32 v23, v23
    v_mfma_f32_16x16x32_bf16 v[204:207], a[220:223], v[36:39], v[204:207]
    v_cvt_pk_bf16_f32 v128, v128, v129
    v_cvt_pk_bf16_f32 v129, v130, v131
    v_mfma_f32_16x16x32_bf16 v[208:211], a[224:227], v[32:35], v[208:211]
    v_exp_f32 v24, v24
    v_mfma_f32_16x16x32_bf16 v[208:211], a[228:231], v[36:39], v[208:211]
    v_perm_b32 v43, v23, v22, s100
    v_cvt_pk_bf16_f32 v130, v132, v133
    v_mfma_f32_16x16x32_bf16 v[212:215], a[232:235], v[32:35], v[212:215]
    v_exp_f32 v25, v25
    v_mfma_f32_16x16x32_bf16 v[212:215], a[236:239], v[36:39], v[212:215]
    v_cvt_pk_bf16_f32 v131, v134, v135
    v_mul_f32 v136, v136, v12
    v_mfma_f32_16x16x32_bf16 v[216:219], a[240:243], v[32:35], v[216:219]
    v_exp_f32 v26, v26
    v_mfma_f32_16x16x32_bf16 v[216:219], a[244:247], v[36:39], v[216:219]
    v_perm_b32 v44, v25, v24, s100
    v_mul_f32 v137, v137, v12
    v_mfma_f32_16x16x32_bf16 v[220:223], a[248:251], v[32:35], v[220:223]
    v_exp_f32 v27, v27
    v_mfma_f32_16x16x32_bf16 v[220:223], a[252:255], v[36:39], v[220:223]
    v_mul_f32 v138, v138, v12
    v_mul_f32 v139, v139, v12
    v_smfmac_f32_16x16x64_bf16 a[8:11], a[16:19], v[32:39], v11
    v_mul_f32 v140, v140, v12
    v_mul_f32 v141, v141, v12
    v_exp_f32 v28, v28
    s_nop 0
    v_perm_b32 v45, v27, v26, s100
    v_exp_f32 v29, v29
    s_nop 0
    v_exp_f32 v30, v30
    s_nop 0
    v_perm_b32 v46, v29, v28, s100
    v_exp_f32 v31, v31
    s_nop 0
    v_perm_b32 v47, v31, v30, s100
    s_nop 1
    v_mfma_f32_16x16x32_bf16 v[224:227], a[192:195], v[40:43], v[224:227]
    v_mul_f32 v142, v142, v12
    v_mul_f32 v143, v143, v12
    v_mfma_f32_16x16x32_bf16 v[224:227], a[196:199], v[44:47], v[224:227]
    ds_read_b64_tr_b16 a[64:65], v4 offset:0
    ds_read_b64_tr_b16 a[66:67], v4 offset:128
    v_mfma_f32_16x16x32_bf16 v[228:231], a[200:203], v[40:43], v[228:231]
    ds_read_b64_tr_b16 a[68:69], v4 offset:256
    ds_read_b64_tr_b16 a[70:71], v4 offset:384
    v_mfma_f32_16x16x32_bf16 v[228:231], a[204:207], v[44:47], v[228:231]
    ds_read_b64_tr_b16 a[72:73], v4 offset:512
    ds_read_b64_tr_b16 a[74:75], v4 offset:640
    v_mfma_f32_16x16x32_bf16 v[232:235], a[208:211], v[40:43], v[232:235]
    ds_read_b64_tr_b16 a[76:77], v4 offset:768
    ds_read_b64_tr_b16 a[78:79], v4 offset:896
    v_mfma_f32_16x16x32_bf16 v[232:235], a[212:215], v[44:47], v[232:235]
    ds_read_b64_tr_b16 a[80:81], v4 offset:16896
    ds_read_b64_tr_b16 a[82:83], v4 offset:17024
    v_mfma_f32_16x16x32_bf16 v[236:239], a[216:219], v[40:43], v[236:239]
    ds_read_b64_tr_b16 a[84:85], v4 offset:17152
    ds_read_b64_tr_b16 a[86:87], v4 offset:17280
    v_mfma_f32_16x16x32_bf16 v[236:239], a[220:223], v[44:47], v[236:239]
    ds_read_b64_tr_b16 a[88:89], v4 offset:17408
    ds_read_b64_tr_b16 a[90:91], v4 offset:17536
    v_mfma_f32_16x16x32_bf16 v[240:243], a[224:227], v[40:43], v[240:243]
    ds_read_b64_tr_b16 a[92:93], v4 offset:17664
    ds_read_b64_tr_b16 a[94:95], v4 offset:17792
    v_mfma_f32_16x16x32_bf16 v[240:243], a[228:231], v[44:47], v[240:243]
    v_cvt_pk_bf16_f32 v136, v136, v137
    v_cvt_pk_bf16_f32 v137, v138, v139
    v_mfma_f32_16x16x32_bf16 v[244:247], a[232:235], v[40:43], v[244:247]
    v_cvt_pk_bf16_f32 v138, v140, v141
    v_cvt_pk_bf16_f32 v139, v142, v143
    v_mfma_f32_16x16x32_bf16 v[244:247], a[236:239], v[44:47], v[244:247]
    v_mul_f32 v144, v144, v12
    v_mul_f32 v145, v145, v12
    v_mfma_f32_16x16x32_bf16 v[248:251], a[240:243], v[40:43], v[248:251]
    v_mul_f32 v146, v146, v12
    v_mul_f32 v147, v147, v12
    v_mfma_f32_16x16x32_bf16 v[248:251], a[244:247], v[44:47], v[248:251]
    v_mul_f32 v148, v148, v12
    v_mul_f32 v149, v149, v12
    v_mfma_f32_16x16x32_bf16 v[252:255], a[248:251], v[40:43], v[252:255]
    v_mul_f32 v150, v150, v12
    v_mul_f32 v151, v151, v12
    v_mfma_f32_16x16x32_bf16 v[252:255], a[252:255], v[44:47], v[252:255]
    v_cvt_pk_bf16_f32 v144, v144, v145
    v_cvt_pk_bf16_f32 v145, v146, v147
    v_smfmac_f32_16x16x64_bf16 a[12:15], a[16:19], v[40:47], v11
    v_cvt_pk_bf16_f32 v146, v148, v149
    v_cvt_pk_bf16_f32 v147, v150, v151
    v_mul_f32 v152, v152, v12
    v_mul_f32 v153, v153, v12
    v_mul_f32 v154, v154, v12
    v_mul_f32 v155, v155, v12
    v_mul_f32 v156, v156, v12
    v_mul_f32 v157, v157, v12
    v_mul_f32 v158, v158, v12
    v_mul_f32 v159, v159, v12
    v_cvt_pk_bf16_f32 v152, v152, v153
    v_cvt_pk_bf16_f32 v153, v154, v155
    v_cvt_pk_bf16_f32 v154, v156, v157
    v_cvt_pk_bf16_f32 v155, v158, v159
    v_accvgpr_read_b32 v14, a4
    v_accvgpr_read_b32 v15, a5
    v_add_f32 v14, v14, v15
    v_subrev_u32 v15, 0x1e000000, v14
    v_cmp_gt_u32 s[58:59], v15, s15
    v_rcp_f32 v14, v14
    v_accvgpr_read_b32 v12, a8
    v_accvgpr_read_b32 v13, a9
    v_add_f32 v12, v12, v13
    v_subrev_u32 v13, 0x1e000000, v12
    v_cmp_gt_u32 s[60:61], v13, s15
    v_rcp_f32 v12, v12
    v_pk_mul_f32 v[160:161], v[160:161], v[14:15] op_sel_hi:[1,0]
    v_pk_mul_f32 v[162:163], v[162:163], v[14:15] op_sel_hi:[1,0]
    v_pk_mul_f32 v[164:165], v[164:165], v[14:15] op_sel_hi:[1,0]
    v_pk_mul_f32 v[166:167], v[166:167], v[14:15] op_sel_hi:[1,0]
    v_cvt_pk_bf16_f32 v160, v160, v161
    v_cvt_pk_bf16_f32 v161, v162, v163
    v_cvt_pk_bf16_f32 v162, v164, v165
    v_cvt_pk_bf16_f32 v163, v166, v167
    v_pk_mul_f32 v[168:169], v[168:169], v[14:15] op_sel_hi:[1,0]
    v_pk_mul_f32 v[170:171], v[170:171], v[14:15] op_sel_hi:[1,0]
    v_pk_mul_f32 v[172:173], v[172:173], v[14:15] op_sel_hi:[1,0]
    v_pk_mul_f32 v[174:175], v[174:175], v[14:15] op_sel_hi:[1,0]
    v_cvt_pk_bf16_f32 v168, v168, v169
    v_cvt_pk_bf16_f32 v169, v170, v171
    v_cvt_pk_bf16_f32 v170, v172, v173
    v_cvt_pk_bf16_f32 v171, v174, v175
    v_pk_mul_f32 v[176:177], v[176:177], v[14:15] op_sel_hi:[1,0]
    v_pk_mul_f32 v[178:179], v[178:179], v[14:15] op_sel_hi:[1,0]
    v_pk_mul_f32 v[180:181], v[180:181], v[14:15] op_sel_hi:[1,0]
    v_pk_mul_f32 v[182:183], v[182:183], v[14:15] op_sel_hi:[1,0]
    v_cvt_pk_bf16_f32 v176, v176, v177
    v_cvt_pk_bf16_f32 v177, v178, v179
    v_cvt_pk_bf16_f32 v178, v180, v181
    v_cvt_pk_bf16_f32 v179, v182, v183
    v_pk_mul_f32 v[184:185], v[184:185], v[14:15] op_sel_hi:[1,0]
    v_pk_mul_f32 v[186:187], v[186:187], v[14:15] op_sel_hi:[1,0]
    v_pk_mul_f32 v[188:189], v[188:189], v[14:15] op_sel_hi:[1,0]
    v_pk_mul_f32 v[190:191], v[190:191], v[14:15] op_sel_hi:[1,0]
    v_cvt_pk_bf16_f32 v184, v184, v185
    v_cvt_pk_bf16_f32 v185, v186, v187
    v_cvt_pk_bf16_f32 v186, v188, v189
    v_cvt_pk_bf16_f32 v187, v190, v191
    v_accvgpr_read_b32 v14, a12
    v_accvgpr_read_b32 v15, a13
    v_add_f32 v14, v14, v15
    v_subrev_u32 v15, 0x1e000000, v14
    v_cmp_gt_u32 s[62:63], v15, s15
    s_or_b64 s[56:57], s[56:57], s[58:59]
    v_rcp_f32 v14, v14
    s_or_b64 s[60:61], s[60:61], s[62:63]
    s_or_b64 s[56:57], s[56:57], s[60:61]
    s_lshl2_add_u32 s14, s51, 13824
    v_mov_b32 v57, s14
    v_mov_b32 v58, 13824
    v_pk_mul_f32 v[192:193], v[192:193], v[12:13] op_sel_hi:[1,0]
    v_pk_mul_f32 v[194:195], v[194:195], v[12:13] op_sel_hi:[1,0]
    v_pk_mul_f32 v[196:197], v[196:197], v[12:13] op_sel_hi:[1,0]
    v_pk_mul_f32 v[198:199], v[198:199], v[12:13] op_sel_hi:[1,0]
    v_cvt_pk_bf16_f32 v192, v192, v193
    v_cvt_pk_bf16_f32 v193, v194, v195
    v_cvt_pk_bf16_f32 v194, v196, v197
    v_cvt_pk_bf16_f32 v195, v198, v199
    v_pk_mul_f32 v[200:201], v[200:201], v[12:13] op_sel_hi:[1,0]
    v_pk_mul_f32 v[202:203], v[202:203], v[12:13] op_sel_hi:[1,0]
    v_pk_mul_f32 v[204:205], v[204:205], v[12:13] op_sel_hi:[1,0]
    v_pk_mul_f32 v[206:207], v[206:207], v[12:13] op_sel_hi:[1,0]
    v_cvt_pk_bf16_f32 v200, v200, v201
    v_cvt_pk_bf16_f32 v201, v202, v203
    v_cvt_pk_bf16_f32 v202, v204, v205
    v_cvt_pk_bf16_f32 v203, v206, v207
    v_pk_mul_f32 v[208:209], v[208:209], v[12:13] op_sel_hi:[1,0]
    v_pk_mul_f32 v[210:211], v[210:211], v[12:13] op_sel_hi:[1,0]
    v_pk_mul_f32 v[212:213], v[212:213], v[12:13] op_sel_hi:[1,0]
    v_pk_mul_f32 v[214:215], v[214:215], v[12:13] op_sel_hi:[1,0]
    v_cvt_pk_bf16_f32 v208, v208, v209
    v_cvt_pk_bf16_f32 v209, v210, v211
    v_cvt_pk_bf16_f32 v210, v212, v213
    v_cvt_pk_bf16_f32 v211, v214, v215
    v_pk_mul_f32 v[216:217], v[216:217], v[12:13] op_sel_hi:[1,0]
    v_pk_mul_f32 v[218:219], v[218:219], v[12:13] op_sel_hi:[1,0]
    v_pk_mul_f32 v[220:221], v[220:221], v[12:13] op_sel_hi:[1,0]
    v_pk_mul_f32 v[222:223], v[222:223], v[12:13] op_sel_hi:[1,0]
    v_cvt_pk_bf16_f32 v216, v216, v217
    v_cvt_pk_bf16_f32 v217, v218, v219
    v_cvt_pk_bf16_f32 v218, v220, v221
    v_cvt_pk_bf16_f32 v219, v222, v223
    v_pk_mul_f32 v[224:225], v[224:225], v[14:15] op_sel_hi:[1,0]
    v_pk_mul_f32 v[226:227], v[226:227], v[14:15] op_sel_hi:[1,0]
    v_pk_mul_f32 v[228:229], v[228:229], v[14:15] op_sel_hi:[1,0]
    v_pk_mul_f32 v[230:231], v[230:231], v[14:15] op_sel_hi:[1,0]
    v_cvt_pk_bf16_f32 v224, v224, v225
    v_cvt_pk_bf16_f32 v225, v226, v227
    v_cvt_pk_bf16_f32 v226, v228, v229
    v_cvt_pk_bf16_f32 v227, v230, v231
    v_pk_mul_f32 v[232:233], v[232:233], v[14:15] op_sel_hi:[1,0]
    v_pk_mul_f32 v[234:235], v[234:235], v[14:15] op_sel_hi:[1,0]
L2_pad10:
    s_cbranch_execz L2_pad14
    v_pk_mul_f32 v[236:237], v[236:237], v[14:15] op_sel_hi:[1,0]
    v_pk_mul_f32 v[238:239], v[238:239], v[14:15] op_sel_hi:[1,0]
    v_cvt_pk_bf16_f32 v232, v232, v233
    v_cvt_pk_bf16_f32 v233, v234, v235
    v_cvt_pk_bf16_f32 v234, v236, v237
    v_cvt_pk_bf16_f32 v235, v238, v239
    v_pk_mul_f32 v[240:241], v[240:241], v[14:15] op_sel_hi:[1,0]
    v_pk_mul_f32 v[242:243], v[242:243], v[14:15] op_sel_hi:[1,0]
    v_pk_mul_f32 v[244:245], v[244:245], v[14:15] op_sel_hi:[1,0]
    v_pk_mul_f32 v[246:247], v[246:247], v[14:15] op_sel_hi:[1,0]
    v_cvt_pk_bf16_f32 v240, v240, v241
    v_cvt_pk_bf16_f32 v241, v242, v243
    v_cvt_pk_bf16_f32 v242, v244, v245
    v_cvt_pk_bf16_f32 v243, v246, v247
    v_pk_mul_f32 v[248:249], v[248:249], v[14:15] op_sel_hi:[1,0]
    v_pk_mul_f32 v[250:251], v[250:251], v[14:15] op_sel_hi:[1,0]
    v_pk_mul_f32 v[252:253], v[252:253], v[14:15] op_sel_hi:[1,0]
    v_pk_mul_f32 v[254:255], v[254:255], v[14:15] op_sel_hi:[1,0]
    v_cvt_pk_bf16_f32 v248, v248, v249
    v_cvt_pk_bf16_f32 v249, v250, v251
    v_cvt_pk_bf16_f32 v250, v252, v253
    v_cvt_pk_bf16_f32 v251, v254, v255
    s_waitcnt lgkmcnt(12)
    v_mfma_f32_16x16x32_bf16 v[16:19], a[64:67], v[128:131], 0
    ds_read_b64_tr_b16 a[96:97], v4 offset:32
    ds_read_b64_tr_b16 a[98:99], v4 offset:160
    v_mfma_f32_16x16x32_bf16 v[16:19], a[68:71], v[136:139], v[16:19]
    s_waitcnt lgkmcnt(10)
    ds_read_b64_tr_b16 a[100:101], v4 offset:288
    ds_read_b64_tr_b16 a[102:103], v4 offset:416
    v_mfma_f32_16x16x32_bf16 v[16:19], a[72:75], v[144:147], v[16:19]
    s_add_u32 s54, s55, 7168
    s_cmp_lg_u64 s[56:57], 0
    s_cselect_b32 s3, 1, 0
    ds_read_b64_tr_b16 a[104:105], v4 offset:544
    v_mfma_f32_16x16x32_bf16 v[16:19], a[76:79], v[152:155], v[16:19]
    s_waitcnt lgkmcnt(9)
    buffer_load_dwordx4 a[192:195], v8, s[72:75], s54 offen
    v_mfma_f32_16x16x32_bf16 v[16:19], a[80:83], v[192:195], v[16:19]
    s_andn2_b32 s3, s3, s50
    ds_read_b64_tr_b16 a[106:107], v4 offset:672
    v_mfma_f32_16x16x32_bf16 v[16:19], a[84:87], v[200:203], v[16:19]
    s_waitcnt lgkmcnt(6)
    ds_read_b64_tr_b16 a[108:109], v4 offset:800
    v_mfma_f32_16x16x32_bf16 v[16:19], a[88:91], v[208:211], v[16:19]
    s_add_u32 s54, s55, 8192
    ds_read_b64_tr_b16 a[110:111], v4 offset:928
    v_mfma_f32_16x16x32_bf16 v[16:19], a[92:95], v[216:219], v[16:19]
    buffer_load_dwordx4 a[196:199], v8, s[72:75], s54 offen
    v_mfma_f32_16x16x32_bf16 v[20:23], a[64:67], v[160:163], 0
    ds_read_b64_tr_b16 a[112:113], v4 offset:16928
    v_mfma_f32_16x16x32_bf16 v[20:23], a[68:71], v[168:171], v[20:23]
    ds_read_b64_tr_b16 a[114:115], v4 offset:17056
    v_mov_b32 v56, s3
    v_mfma_f32_16x16x32_bf16 v[20:23], a[72:75], v[176:179], v[20:23]
    ds_read_b64_tr_b16 a[116:117], v4 offset:17184
    v_mfma_f32_16x16x32_bf16 v[20:23], a[76:79], v[184:187], v[20:23]
    ds_read_b64_tr_b16 a[118:119], v4 offset:17312
    v_mfma_f32_16x16x32_bf16 v[20:23], a[80:83], v[224:227], v[20:23]
    ds_read_b64_tr_b16 a[120:121], v4 offset:17440
    v_mfma_f32_16x16x32_bf16 v[20:23], a[84:87], v[232:235], v[20:23]
    ds_read_b64_tr_b16 a[122:123], v4 offset:17568
    v_mfma_f32_16x16x32_bf16 v[20:23], a[88:91], v[240:243], v[20:23]
    ds_read_b64_tr_b16 a[124:125], v4 offset:17696
    v_mfma_f32_16x16x32_bf16 v[20:23], a[92:95], v[248:251], v[20:23]
    s_waitcnt lgkmcnt(11)
    ds_read_b64_tr_b16 a[126:127], v4 offset:17824
    ds_write_b32 v57, v56
    v_mfma_f32_16x16x32_bf16 v[24:27], a[96:99], v[128:131], 0
    ds_read_b64_tr_b16 a[64:65], v4 offset:64
    v_mfma_f32_16x16x32_bf16 v[24:27], a[100:103], v[136:139], v[24:27]
    s_waitcnt lgkmcnt(10)
    ds_read_b64_tr_b16 a[66:67], v4 offset:192
    v_mfma_f32_16x16x32_bf16 v[24:27], a[104:107], v[144:147], v[24:27]
    ds_read_b64_tr_b16 a[68:69], v4 offset:320
    v_mfma_f32_16x16x32_bf16 v[24:27], a[108:111], v[152:155], v[24:27]
    s_waitcnt lgkmcnt(8)
    ds_read_b64_tr_b16 a[70:71], v4 offset:448
    v_mfma_f32_16x16x32_bf16 v[24:27], a[112:115], v[192:195], v[24:27]
    ds_read_b64_tr_b16 a[72:73], v4 offset:576
    v_mfma_f32_16x16x32_bf16 v[24:27], a[116:119], v[200:203], v[24:27]
    s_waitcnt lgkmcnt(6)
    ds_read_b64_tr_b16 a[74:75], v4 offset:704
    v_mfma_f32_16x16x32_bf16 v[24:27], a[120:123], v[208:211], v[24:27]
    ds_read_b64_tr_b16 a[76:77], v4 offset:832
    v_mfma_f32_16x16x32_bf16 v[24:27], a[124:127], v[216:219], v[24:27]
    ds_read_b64_tr_b16 a[78:79], v4 offset:960
    v_mfma_f32_16x16x32_bf16 v[28:31], a[96:99], v[160:163], 0
    ds_read_b64_tr_b16 a[80:81], v4 offset:16960
    v_mfma_f32_16x16x32_bf16 v[28:31], a[100:103], v[168:171], v[28:31]
    ds_read_b64_tr_b16 a[82:83], v4 offset:17088
    v_mfma_f32_16x16x32_bf16 v[28:31], a[104:107], v[176:179], v[28:31]
    ds_read_b64_tr_b16 a[84:85], v4 offset:17216
    v_mfma_f32_16x16x32_bf16 v[28:31], a[108:111], v[184:187], v[28:31]
    ds_read_b64_tr_b16 a[86:87], v4 offset:17344
    v_mfma_f32_16x16x32_bf16 v[28:31], a[112:115], v[224:227], v[28:31]
    ds_read_b64_tr_b16 a[88:89], v4 offset:17472
    v_mfma_f32_16x16x32_bf16 v[28:31], a[116:119], v[232:235], v[28:31]
    ds_read_b64_tr_b16 a[90:91], v4 offset:17600
    v_mfma_f32_16x16x32_bf16 v[28:31], a[120:123], v[240:243], v[28:31]
    ds_read_b64_tr_b16 a[92:93], v4 offset:17728
    v_mfma_f32_16x16x32_bf16 v[28:31], a[124:127], v[248:251], v[28:31]
    s_waitcnt lgkmcnt(11)
    ds_read_b64_tr_b16 a[94:95], v4 offset:17856
    v_mfma_f32_16x16x32_bf16 v[32:35], a[64:67], v[128:131], 0
    ds_read_b64_tr_b16 a[96:97], v4 offset:96
    v_cvt_pk_bf16_f32 v48, v16, v17
    v_mfma_f32_16x16x32_bf16 v[32:35], a[68:71], v[136:139], v[32:35]
    s_waitcnt lgkmcnt(9)
    ds_read_b64_tr_b16 a[98:99], v4 offset:224
    v_cvt_pk_bf16_f32 v49, v18, v19
    v_mfma_f32_16x16x32_bf16 v[32:35], a[72:75], v[144:147], v[32:35]
    ds_read_b64_tr_b16 a[100:101], v4 offset:352
    v_cvt_pk_bf16_f32 v50, v24, v25
    v_mfma_f32_16x16x32_bf16 v[32:35], a[76:79], v[152:155], v[32:35]
    s_waitcnt lgkmcnt(7)
    ds_read_b64_tr_b16 a[102:103], v4 offset:480
    v_cvt_pk_bf16_f32 v51, v26, v27
    v_mfma_f32_16x16x32_bf16 v[32:35], a[80:83], v[192:195], v[32:35]
    s_mov_b32 s54, 0
    ds_read_b64_tr_b16 a[104:105], v4 offset:608
    ds_read_b64_tr_b16 a[106:107], v4 offset:736
    v_mfma_f32_16x16x32_bf16 v[32:35], a[84:87], v[200:203], v[32:35]
    s_waitcnt lgkmcnt(6)
    v_permlane32_swap_b32 v48, v50
    v_mfma_f32_16x16x32_bf16 v[32:35], a[88:91], v[208:211], v[32:35]
    v_permlane32_swap_b32 v49, v51
    v_mfma_f32_16x16x32_bf16 v[32:35], a[92:95], v[216:219], v[32:35]
    ds_read_b64_tr_b16 a[108:109], v4 offset:864
    ds_read_b64_tr_b16 a[110:111], v4 offset:992
    buffer_store_dwordx4 v[48:51], v10, s[40:43], s54 offen offset:0 sc1
    v_mfma_f32_16x16x32_bf16 v[36:39], a[64:67], v[160:163], 0
    ds_read_b64_tr_b16 a[112:113], v4 offset:16992
    v_cvt_pk_bf16_f32 v52, v20, v21
    v_mfma_f32_16x16x32_bf16 v[36:39], a[68:71], v[168:171], v[36:39]
    ds_read_b64_tr_b16 a[114:115], v4 offset:17120
    v_cvt_pk_bf16_f32 v53, v22, v23
    v_mfma_f32_16x16x32_bf16 v[36:39], a[72:75], v[176:179], v[36:39]
    ds_read_b64_tr_b16 a[116:117], v4 offset:17248
    v_cvt_pk_bf16_f32 v54, v28, v29
    v_mfma_f32_16x16x32_bf16 v[36:39], a[76:79], v[184:187], v[36:39]
    ds_read_b64_tr_b16 a[118:119], v4 offset:17376
    v_cvt_pk_bf16_f32 v55, v30, v31
    v_mfma_f32_16x16x32_bf16 v[36:39], a[80:83], v[224:227], v[36:39]
    s_mov_b32 s54, 294912
    ds_read_b64_tr_b16 a[120:121], v4 offset:17504
    ds_read_b64_tr_b16 a[122:123], v4 offset:17632
    v_mfma_f32_16x16x32_bf16 v[36:39], a[84:87], v[232:235], v[36:39]
    v_permlane32_swap_b32 v52, v54
    v_mfma_f32_16x16x32_bf16 v[36:39], a[88:91], v[240:243], v[36:39]
    v_permlane32_swap_b32 v53, v55
    v_mfma_f32_16x16x32_bf16 v[36:39], a[92:95], v[248:251], v[36:39]
    s_barrier
    s_waitcnt lgkmcnt(10)
    ds_read_b64_tr_b16 a[124:125], v4 offset:17760
    ds_read_b64_tr_b16 a[126:127], v4 offset:17888
    ds_read_b128 v[60:63], v58
    buffer_store_dwordx4 v[52:55], v10, s[40:43], s54 offen offset:0 sc1
    v_mfma_f32_16x16x32_bf16 v[40:43], a[96:99], v[128:131], 0
    s_add_u32 m0, s44, 36864
    ds_read_b64_tr_b16 a[64:65], v4 offset:36864
    ds_read_b64_tr_b16 a[66:67], v4 offset:36992
    v_mfma_f32_16x16x32_bf16 v[40:43], a[100:103], v[136:139], v[40:43]
    s_mov_b32 s45, 384
    s_waitcnt lgkmcnt(11)
    buffer_load_dwordx4 v7, s[28:31], s45 offen offset:0 lds
    v_mfma_f32_16x16x32_bf16 v[40:43], a[104:107], v[144:147], v[40:43]
    s_add_u32 m0, s44, 36768
    ds_read_b64_tr_b16 a[68:69], v4 offset:37120
    ds_read_b64_tr_b16 a[70:71], v4 offset:37248
    v_mfma_f32_16x16x32_bf16 v[40:43], a[108:111], v[152:155], v[40:43]
    s_waitcnt lgkmcnt(9)
    buffer_load_dwordx4 v7, s[28:31], s45 offen offset:1152 lds
    v_mfma_f32_16x16x32_bf16 v[40:43], a[112:115], v[192:195], v[40:43]
    s_add_u32 m0, s44, 36672
    ds_read_b64_tr_b16 a[72:73], v4 offset:37376
    ds_read_b64_tr_b16 a[74:75], v4 offset:37504
    v_mfma_f32_16x16x32_bf16 v[40:43], a[116:119], v[200:203], v[40:43]
    s_waitcnt lgkmcnt(7)
    buffer_load_dwordx4 v7, s[28:31], s45 offen offset:2304 lds
    v_mfma_f32_16x16x32_bf16 v[40:43], a[120:123], v[208:211], v[40:43]
    s_add_u32 m0, s44, 36576
    ds_read_b64_tr_b16 a[76:77], v4 offset:37632
    ds_read_b64_tr_b16 a[78:79], v4 offset:37760
    v_mfma_f32_16x16x32_bf16 v[40:43], a[124:127], v[216:219], v[40:43]
    s_waitcnt lgkmcnt(8)
    buffer_load_dwordx4 v7, s[28:31], s45 offen offset:3456 lds
    v_or3_b32 v60, v60, v61, v62
    v_or_b32 v60, v60, v63
    v_mfma_f32_16x16x32_bf16 v[44:47], a[96:99], v[160:163], 0
    s_add_u32 m0, s44, 53760
    ds_read_b64_tr_b16 a[80:81], v4 offset:53760
    ds_read_b64_tr_b16 a[82:83], v4 offset:53888
    v_mfma_f32_16x16x32_bf16 v[44:47], a[100:103], v[168:171], v[44:47]
    s_mov_b32 s45, 147840
    buffer_load_dwordx4 v7, s[28:31], s45 offen offset:0 lds
    v_mfma_f32_16x16x32_bf16 v[44:47], a[104:107], v[176:179], v[44:47]
    s_add_u32 m0, s44, 53664
    ds_read_b64_tr_b16 a[84:85], v4 offset:54016
    ds_read_b64_tr_b16 a[86:87], v4 offset:54144
    v_mfma_f32_16x16x32_bf16 v[44:47], a[108:111], v[184:187], v[44:47]
    buffer_load_dwordx4 v7, s[28:31], s45 offen offset:1152 lds
    v_mfma_f32_16x16x32_bf16 v[44:47], a[112:115], v[224:227], v[44:47]
    s_add_u32 m0, s44, 53568
    ds_read_b64_tr_b16 a[88:89], v4 offset:54272
    ds_read_b64_tr_b16 a[90:91], v4 offset:54400
    v_mfma_f32_16x16x32_bf16 v[44:47], a[116:119], v[232:235], v[44:47]
    buffer_load_dwordx4 v7, s[28:31], s45 offen offset:2304 lds
    v_mfma_f32_16x16x32_bf16 v[44:47], a[120:123], v[240:243], v[44:47]
    s_add_u32 m0, s44, 53472
    ds_read_b64_tr_b16 a[92:93], v4 offset:54528
    ds_read_b64_tr_b16 a[94:95], v4 offset:54656
    v_mfma_f32_16x16x32_bf16 v[44:47], a[124:127], v[248:251], v[44:47]
    s_waitcnt lgkmcnt(12)
    buffer_load_dwordx4 v7, s[28:31], s45 offen offset:3456 lds
    v_readfirstlane_b32 s3, v60
    v_mfma_f32_16x16x32_bf16 v[16:19], a[64:67], v[128:131], 0
    ds_read_b64_tr_b16 a[96:97], v4 offset:36896
    v_cvt_pk_bf16_f32 v48, v32, v33
    v_mfma_f32_16x16x32_bf16 v[16:19], a[68:71], v[136:139], v[16:19]
    s_waitcnt lgkmcnt(9)
    s_cmp_lg_u32 s3, 0
    ds_read_b64_tr_b16 a[98:99], v4 offset:37024
    v_cvt_pk_bf16_f32 v49, v34, v35
    v_mfma_f32_16x16x32_bf16 v[16:19], a[72:75], v[144:147], v[16:19]
    s_cbranch_scc1 L2_fallback
    ds_read_b64_tr_b16 a[100:101], v4 offset:37152
    v_cvt_pk_bf16_f32 v50, v40, v41
    v_mfma_f32_16x16x32_bf16 v[16:19], a[76:79], v[152:155], v[16:19]
    s_waitcnt lgkmcnt(7)
    ds_read_b64_tr_b16 a[102:103], v4 offset:37280
    v_cvt_pk_bf16_f32 v51, v42, v43
    v_mfma_f32_16x16x32_bf16 v[16:19], a[80:83], v[192:195], v[16:19]
    s_mov_b32 s54, 0
    ds_read_b64_tr_b16 a[104:105], v4 offset:37408
    ds_read_b64_tr_b16 a[106:107], v4 offset:37536
    v_mfma_f32_16x16x32_bf16 v[16:19], a[84:87], v[200:203], v[16:19]
    s_waitcnt lgkmcnt(6)
    v_permlane32_swap_b32 v48, v50
    v_mfma_f32_16x16x32_bf16 v[16:19], a[88:91], v[208:211], v[16:19]
    v_permlane32_swap_b32 v49, v51
    v_mfma_f32_16x16x32_bf16 v[16:19], a[92:95], v[216:219], v[16:19]
    ds_read_b64_tr_b16 a[108:109], v4 offset:37664
    ds_read_b64_tr_b16 a[110:111], v4 offset:37792
    buffer_store_dwordx4 v[48:51], v10, s[40:43], s54 offen offset:512 sc1
    v_mfma_f32_16x16x32_bf16 v[20:23], a[64:67], v[160:163], 0
    ds_read_b64_tr_b16 a[112:113], v4 offset:53792
    v_cvt_pk_bf16_f32 v52, v36, v37
    v_mfma_f32_16x16x32_bf16 v[20:23], a[68:71], v[168:171], v[20:23]
    ds_read_b64_tr_b16 a[114:115], v4 offset:53920
    v_cvt_pk_bf16_f32 v53, v38, v39
    v_mfma_f32_16x16x32_bf16 v[20:23], a[72:75], v[176:179], v[20:23]
    ds_read_b64_tr_b16 a[116:117], v4 offset:54048
    v_cvt_pk_bf16_f32 v54, v44, v45
    v_mfma_f32_16x16x32_bf16 v[20:23], a[76:79], v[184:187], v[20:23]
    ds_read_b64_tr_b16 a[118:119], v4 offset:54176
    v_cvt_pk_bf16_f32 v55, v46, v47
    v_mfma_f32_16x16x32_bf16 v[20:23], a[80:83], v[224:227], v[20:23]
    s_mov_b32 s54, 294912
    ds_read_b64_tr_b16 a[120:121], v4 offset:54304
    ds_read_b64_tr_b16 a[122:123], v4 offset:54432
    v_mfma_f32_16x16x32_bf16 v[20:23], a[84:87], v[232:235], v[20:23]
    v_permlane32_swap_b32 v52, v54
    v_mfma_f32_16x16x32_bf16 v[20:23], a[88:91], v[240:243], v[20:23]
    v_permlane32_swap_b32 v53, v55
    v_mfma_f32_16x16x32_bf16 v[20:23], a[92:95], v[248:251], v[20:23]
    s_waitcnt lgkmcnt(10)
    ds_read_b64_tr_b16 a[124:125], v4 offset:54560
    ds_read_b64_tr_b16 a[126:127], v4 offset:54688
    buffer_store_dwordx4 v[52:55], v10, s[40:43], s54 offen offset:512 sc1
    v_mfma_f32_16x16x32_bf16 v[24:27], a[96:99], v[128:131], 0
    s_mul_i32 s3, s51, 128
    ds_read_b64_tr_b16 a[64:65], v4 offset:36928
    v_lshrrev_b32 v14, 3, v0
    v_mfma_f32_16x16x32_bf16 v[24:27], a[100:103], v[136:139], v[24:27]
    s_waitcnt lgkmcnt(9)
    ds_read_b64_tr_b16 a[66:67], v4 offset:37056
    v_lshl_add_u32 v12, v14, 4, s3
    v_mfma_f32_16x16x32_bf16 v[24:27], a[104:107], v[144:147], v[24:27]
    ds_read_b64_tr_b16 a[68:69], v4 offset:37184
    v_and_b32 v14, 1, v14
    v_mfma_f32_16x16x32_bf16 v[24:27], a[108:111], v[152:155], v[24:27]
    s_waitcnt lgkmcnt(7)
    s_mul_i32 s3, s51, 32
    ds_read_b64_tr_b16 a[70:71], v4 offset:37312
    v_lshl_add_u32 v13, v14, 4, s3
    v_mfma_f32_16x16x32_bf16 v[24:27], a[112:115], v[192:195], v[24:27]
    ds_read_b64_tr_b16 a[72:73], v4 offset:37440
    v_and_b32 v14, 7, v0
    v_mfma_f32_16x16x32_bf16 v[24:27], a[116:119], v[200:203], v[24:27]
    s_waitcnt lgkmcnt(5)
    ds_read_b64_tr_b16 a[74:75], v4 offset:37568
    v_mul_u32_u24 v14, 1152, v14
    v_mfma_f32_16x16x32_bf16 v[24:27], a[120:123], v[208:211], v[24:27]
    ds_read_b64_tr_b16 a[76:77], v4 offset:37696
    v_add_u32 v1, v14, v12
    v_mfma_f32_16x16x32_bf16 v[24:27], a[124:127], v[216:219], v[24:27]
    ds_read_b64_tr_b16 a[78:79], v4 offset:37824
    v_add_u32 v2, v14, v13
    v_mfma_f32_16x16x32_bf16 v[28:31], a[96:99], v[160:163], 0
    ds_read_b64_tr_b16 a[80:81], v4 offset:53824
    v_add_u32 v2, 1024, v2
    v_mfma_f32_16x16x32_bf16 v[28:31], a[100:103], v[168:171], v[28:31]
    s_lshl_b32 s14, s51, 10
    ds_read_b64_tr_b16 a[82:83], v4 offset:53952
    v_add_u32 v5, s14, v8
    v_mfma_f32_16x16x32_bf16 v[28:31], a[104:107], v[176:179], v[28:31]
    ds_read_b64_tr_b16 a[84:85], v4 offset:54080
    v_and_b32 v59, 0xf0, v8
    v_mfma_f32_16x16x32_bf16 v[28:31], a[108:111], v[184:187], v[28:31]
    s_lshl_b32 s14, s51, 8
    ds_read_b64_tr_b16 a[86:87], v4 offset:54208
    v_add_u32 v59, s14, v59
    v_mfma_f32_16x16x32_bf16 v[28:31], a[112:115], v[224:227], v[28:31]
    ds_read_b64_tr_b16 a[88:89], v4 offset:54336
    v_and_b32 v6, 15, v0
    v_mfma_f32_16x16x32_bf16 v[28:31], a[116:119], v[232:235], v[28:31]
    ds_read_b64_tr_b16 a[90:91], v4 offset:54464
    v_lshlrev_b32 v6, 8, v6
    v_mfma_f32_16x16x32_bf16 v[28:31], a[120:123], v[240:243], v[28:31]
    ds_read_b64_tr_b16 a[92:93], v4 offset:54592
    v_min_u32 v15, 1, v0
    v_mfma_f32_16x16x32_bf16 v[28:31], a[124:127], v[248:251], v[28:31]
    s_waitcnt lgkmcnt(11)
    ds_read_b64_tr_b16 a[94:95], v4 offset:54720
    v_lshlrev_b32 v15, 30, v15
    v_mfma_f32_16x16x32_bf16 v[32:35], a[64:67], v[128:131], 0
    s_lshl_b32 s15, s53, 14
    s_add_u32 s15, s15, 786432
    s_and_b32 s14, s52, 12
    s_lshl_b32 s14, s14, 10
    s_add_u32 s47, s15, s14
    s_lshl4_add_u32 s3, s51, s52
    s_lshl_b32 s3, s3, 8
    s_add_u32 s56, s3, s15
    s_add_u32 s14, s55, 16384
    ds_read_b64_tr_b16 a[96:97], v4 offset:36960
    v_cvt_pk_bf16_f32 v48, v16, v17
    v_mfma_f32_16x16x32_bf16 v[32:35], a[68:71], v[136:139], v[32:35]
    s_waitcnt lgkmcnt(9)
    ds_read_b64_tr_b16 a[98:99], v4 offset:37088
    v_cvt_pk_bf16_f32 v49, v18, v19
    v_mfma_f32_16x16x32_bf16 v[32:35], a[72:75], v[144:147], v[32:35]
    ds_read_b64_tr_b16 a[100:101], v4 offset:37216
    v_cvt_pk_bf16_f32 v50, v24, v25
    v_mfma_f32_16x16x32_bf16 v[32:35], a[76:79], v[152:155], v[32:35]
    s_waitcnt lgkmcnt(7)
    ds_read_b64_tr_b16 a[102:103], v4 offset:37344
    v_cvt_pk_bf16_f32 v51, v26, v27
    v_mfma_f32_16x16x32_bf16 v[32:35], a[80:83], v[192:195], v[32:35]
    s_mov_b32 s54, 1024
    ds_read_b64_tr_b16 a[104:105], v4 offset:37472
    ds_read_b64_tr_b16 a[106:107], v4 offset:37600
    v_mfma_f32_16x16x32_bf16 v[32:35], a[84:87], v[200:203], v[32:35]
    s_waitcnt lgkmcnt(6)
    v_permlane32_swap_b32 v48, v50
    v_mfma_f32_16x16x32_bf16 v[32:35], a[88:91], v[208:211], v[32:35]
    v_permlane32_swap_b32 v49, v51
    v_mfma_f32_16x16x32_bf16 v[32:35], a[92:95], v[216:219], v[32:35]
    ds_read_b64_tr_b16 a[108:109], v4 offset:37728
    ds_read_b64_tr_b16 a[110:111], v4 offset:37856
    buffer_store_dwordx4 v[48:51], v10, s[40:43], s54 offen offset:0 sc1
    v_mfma_f32_16x16x32_bf16 v[36:39], a[64:67], v[160:163], 0
    ds_read_b64_tr_b16 a[112:113], v4 offset:53856
    v_cvt_pk_bf16_f32 v52, v20, v21
    v_mfma_f32_16x16x32_bf16 v[36:39], a[68:71], v[168:171], v[36:39]
    ds_read_b64_tr_b16 a[114:115], v4 offset:53984
    v_cvt_pk_bf16_f32 v53, v22, v23
    v_mfma_f32_16x16x32_bf16 v[36:39], a[72:75], v[176:179], v[36:39]
    ds_read_b64_tr_b16 a[116:117], v4 offset:54112
    v_cvt_pk_bf16_f32 v54, v28, v29
    v_mfma_f32_16x16x32_bf16 v[36:39], a[76:79], v[184:187], v[36:39]
    ds_read_b64_tr_b16 a[118:119], v4 offset:54240
    v_cvt_pk_bf16_f32 v55, v30, v31
    v_mfma_f32_16x16x32_bf16 v[36:39], a[80:83], v[224:227], v[36:39]
    s_mov_b32 s54, 295936
    ds_read_b64_tr_b16 a[120:121], v4 offset:54368
    ds_read_b64_tr_b16 a[122:123], v4 offset:54496
    v_mfma_f32_16x16x32_bf16 v[36:39], a[84:87], v[232:235], v[36:39]
    v_permlane32_swap_b32 v52, v54
    v_mfma_f32_16x16x32_bf16 v[36:39], a[88:91], v[240:243], v[36:39]
    v_permlane32_swap_b32 v53, v55
    v_mfma_f32_16x16x32_bf16 v[36:39], a[92:95], v[248:251], v[36:39]
    s_waitcnt vmcnt(31)
    s_barrier
    s_waitcnt lgkmcnt(10)
    ds_read_b64_tr_b16 a[124:125], v4 offset:54624
    ds_read_b64_tr_b16 a[126:127], v4 offset:54752
    buffer_store_dwordx4 v[52:55], v10, s[40:43], s54 offen offset:0 sc1
    v_mfma_f32_16x16x32_bf16 v[40:43], a[96:99], v[128:131], 0
    s_add_u32 m0, s44, 73728
    ds_read_b64_tr_b16 a[64:65], v3 offset:0
    ds_read_b64_tr_b16 a[66:67], v3 offset:128
    v_mfma_f32_16x16x32_bf16 v[40:43], a[100:103], v[136:139], v[40:43]
    s_mov_b32 s45, 512
    s_waitcnt lgkmcnt(10)
    buffer_load_dwordx4 v7, s[28:31], s45 offen offset:0 lds
    v_mfma_f32_16x16x32_bf16 v[40:43], a[104:107], v[144:147], v[40:43]
    s_add_u32 m0, s44, 73632
    ds_read_b64_tr_b16 a[68:69], v3 offset:256
    ds_read_b64_tr_b16 a[70:71], v3 offset:384
    v_mfma_f32_16x16x32_bf16 v[40:43], a[108:111], v[152:155], v[40:43]
    s_waitcnt lgkmcnt(8)
    buffer_load_dwordx4 v7, s[28:31], s45 offen offset:1152 lds
    v_mfma_f32_16x16x32_bf16 v[40:43], a[112:115], v[192:195], v[40:43]
    s_add_u32 m0, s44, 73536
    ds_read_b64_tr_b16 a[72:73], v3 offset:512
    ds_read_b64_tr_b16 a[74:75], v3 offset:640
    v_mfma_f32_16x16x32_bf16 v[40:43], a[116:119], v[200:203], v[40:43]
    s_waitcnt lgkmcnt(6)
    buffer_load_dwordx4 v7, s[28:31], s45 offen offset:2304 lds
    v_mfma_f32_16x16x32_bf16 v[40:43], a[120:123], v[208:211], v[40:43]
    s_add_u32 m0, s44, 73440
    ds_read_b64_tr_b16 a[76:77], v3 offset:768
    ds_read_b64_tr_b16 a[78:79], v3 offset:896
    v_mfma_f32_16x16x32_bf16 v[40:43], a[124:127], v[216:219], v[40:43]
    buffer_load_dwordx4 v7, s[28:31], s45 offen offset:3456 lds
    v_mfma_f32_16x16x32_bf16 v[44:47], a[96:99], v[160:163], 0
    s_add_u32 m0, s44, 90624
    ds_read_b64_tr_b16 a[80:81], v3 offset:16896
    ds_read_b64_tr_b16 a[82:83], v3 offset:17024
    v_mfma_f32_16x16x32_bf16 v[44:47], a[100:103], v[168:171], v[44:47]
    s_mov_b32 s45, 147968
    buffer_load_dwordx4 v7, s[28:31], s45 offen offset:0 lds
    v_mfma_f32_16x16x32_bf16 v[44:47], a[104:107], v[176:179], v[44:47]
    s_add_u32 m0, s44, 90528
    ds_read_b64_tr_b16 a[84:85], v3 offset:17152
    ds_read_b64_tr_b16 a[86:87], v3 offset:17280
    v_mfma_f32_16x16x32_bf16 v[44:47], a[108:111], v[184:187], v[44:47]
    buffer_load_dwordx4 v7, s[28:31], s45 offen offset:1152 lds
    v_mfma_f32_16x16x32_bf16 v[44:47], a[112:115], v[224:227], v[44:47]
    s_add_u32 m0, s44, 90432
    ds_read_b64_tr_b16 a[88:89], v3 offset:17408
    ds_read_b64_tr_b16 a[90:91], v3 offset:17536
    v_mfma_f32_16x16x32_bf16 v[44:47], a[116:119], v[232:235], v[44:47]
    buffer_load_dwordx4 v7, s[28:31], s45 offen offset:2304 lds
    v_mfma_f32_16x16x32_bf16 v[44:47], a[120:123], v[240:243], v[44:47]
    s_add_u32 m0, s44, 90336
    ds_read_b64_tr_b16 a[92:93], v3 offset:17664
    ds_read_b64_tr_b16 a[94:95], v3 offset:17792
    v_mfma_f32_16x16x32_bf16 v[44:47], a[124:127], v[248:251], v[44:47]
    s_waitcnt lgkmcnt(12)
    buffer_load_dwordx4 v7, s[28:31], s45 offen offset:3456 lds
    v_mfma_f32_16x16x32_bf16 v[16:19], a[64:67], v[128:131], 0
    ds_read_b64_tr_b16 a[96:97], v3 offset:32
    v_cvt_pk_bf16_f32 v48, v32, v33
    v_mfma_f32_16x16x32_bf16 v[16:19], a[68:71], v[136:139], v[16:19]
    s_waitcnt lgkmcnt(9)
    ds_read_b64_tr_b16 a[98:99], v3 offset:160
    v_cvt_pk_bf16_f32 v49, v34, v35
    v_mfma_f32_16x16x32_bf16 v[16:19], a[72:75], v[144:147], v[16:19]
    ds_read_b64_tr_b16 a[100:101], v3 offset:288
    v_cvt_pk_bf16_f32 v50, v40, v41
    v_mfma_f32_16x16x32_bf16 v[16:19], a[76:79], v[152:155], v[16:19]
    s_waitcnt lgkmcnt(7)
    ds_read_b64_tr_b16 a[102:103], v3 offset:416
    v_cvt_pk_bf16_f32 v51, v42, v43
    v_mfma_f32_16x16x32_bf16 v[16:19], a[80:83], v[192:195], v[16:19]
    s_mov_b32 s54, 1024
    ds_read_b64_tr_b16 a[104:105], v3 offset:544
    ds_read_b64_tr_b16 a[106:107], v3 offset:672
    v_mfma_f32_16x16x32_bf16 v[16:19], a[84:87], v[200:203], v[16:19]
    s_waitcnt lgkmcnt(6)
    v_permlane32_swap_b32 v48, v50
    v_mfma_f32_16x16x32_bf16 v[16:19], a[88:91], v[208:211], v[16:19]
    v_permlane32_swap_b32 v49, v51
    v_mfma_f32_16x16x32_bf16 v[16:19], a[92:95], v[216:219], v[16:19]
    ds_read_b64_tr_b16 a[108:109], v3 offset:800
    ds_read_b64_tr_b16 a[110:111], v3 offset:928
    buffer_store_dwordx4 v[48:51], v10, s[40:43], s54 offen offset:512 sc1
    v_mfma_f32_16x16x32_bf16 v[20:23], a[64:67], v[160:163], 0
    ds_read_b64_tr_b16 a[112:113], v3 offset:16928
    v_cvt_pk_bf16_f32 v52, v36, v37
    v_mfma_f32_16x16x32_bf16 v[20:23], a[68:71], v[168:171], v[20:23]
    ds_read_b64_tr_b16 a[114:115], v3 offset:17056
    v_cvt_pk_bf16_f32 v53, v38, v39
    v_mfma_f32_16x16x32_bf16 v[20:23], a[72:75], v[176:179], v[20:23]
    ds_read_b64_tr_b16 a[116:117], v3 offset:17184
    v_cvt_pk_bf16_f32 v54, v44, v45
    v_mfma_f32_16x16x32_bf16 v[20:23], a[76:79], v[184:187], v[20:23]
    ds_read_b64_tr_b16 a[118:119], v3 offset:17312
    v_cvt_pk_bf16_f32 v55, v46, v47
    v_mfma_f32_16x16x32_bf16 v[20:23], a[80:83], v[224:227], v[20:23]
    s_mov_b32 s54, 295936
    ds_read_b64_tr_b16 a[120:121], v3 offset:17440
    ds_read_b64_tr_b16 a[122:123], v3 offset:17568
    v_mfma_f32_16x16x32_bf16 v[20:23], a[84:87], v[232:235], v[20:23]
    v_permlane32_swap_b32 v52, v54
    v_mfma_f32_16x16x32_bf16 v[20:23], a[88:91], v[240:243], v[20:23]
    v_permlane32_swap_b32 v53, v55
    v_mfma_f32_16x16x32_bf16 v[20:23], a[92:95], v[248:251], v[20:23]
    s_waitcnt lgkmcnt(10)
    ds_read_b64_tr_b16 a[124:125], v3 offset:17696
    ds_read_b64_tr_b16 a[126:127], v3 offset:17824
    buffer_store_dwordx4 v[52:55], v10, s[40:43], s54 offen offset:512 sc1
    v_mfma_f32_16x16x32_bf16 v[24:27], a[96:99], v[128:131], 0
    ds_read_b64_tr_b16 a[64:65], v3 offset:64
    v_add_u32 v104, s14, v8
    v_mfma_f32_16x16x32_bf16 v[24:27], a[100:103], v[136:139], v[24:27]
    s_waitcnt lgkmcnt(9)
    ds_read_b64_tr_b16 a[66:67], v3 offset:192
    v_and_b32 v14, 32, v0
    v_mfma_f32_16x16x32_bf16 v[24:27], a[104:107], v[144:147], v[24:27]
    ds_read_b64_tr_b16 a[68:69], v3 offset:320
    v_xor_b32 v105, v14, v104
    v_mfma_f32_16x16x32_bf16 v[24:27], a[108:111], v[152:155], v[24:27]
    s_waitcnt lgkmcnt(7)
    ds_read_b64_tr_b16 a[70:71], v3 offset:448
    v_add_u32 v106, 73728, v105
    v_mfma_f32_16x16x32_bf16 v[24:27], a[112:115], v[192:195], v[24:27]
    ds_read_b64_tr_b16 a[72:73], v3 offset:576
    v_lshrrev_b32 v110, 4, v0
    v_mfma_f32_16x16x32_bf16 v[24:27], a[116:119], v[200:203], v[24:27]
    s_waitcnt lgkmcnt(5)
    ds_read_b64_tr_b16 a[74:75], v3 offset:704
    v_bfe_u32 v14, v0, 2, 2
    v_mfma_f32_16x16x32_bf16 v[24:27], a[120:123], v[208:211], v[24:27]
    ds_read_b64_tr_b16 a[76:77], v3 offset:832
    v_lshl_add_u32 v110, v110, 3, v14
    v_mfma_f32_16x16x32_bf16 v[24:27], a[124:127], v[216:219], v[24:27]
    ds_read_b64_tr_b16 a[78:79], v3 offset:960
    v_and_b32 v14, 3, v0
    v_mfma_f32_16x16x32_bf16 v[28:31], a[96:99], v[160:163], 0
    ds_read_b64_tr_b16 a[80:81], v3 offset:16960
    v_mul_u32_u24 v111, 1152, v110
    v_mfma_f32_16x16x32_bf16 v[28:31], a[100:103], v[168:171], v[28:31]
    ds_read_b64_tr_b16 a[82:83], v3 offset:17088
    v_lshlrev_b32 v110, 6, v110
    v_mfma_f32_16x16x32_bf16 v[28:31], a[104:107], v[176:179], v[28:31]
    ds_read_b64_tr_b16 a[84:85], v3 offset:17216
    v_lshl_add_u32 v110, v14, 3, v110
    v_mfma_f32_16x16x32_bf16 v[28:31], a[108:111], v[184:187], v[28:31]
    ds_read_b64_tr_b16 a[86:87], v3 offset:17344
    v_lshl_add_u32 v111, v14, 3, v111
    v_mfma_f32_16x16x32_bf16 v[28:31], a[112:115], v[224:227], v[28:31]
    s_lshr_b32 s3, s51, 1
    s_xor_b32 s3, s3, 1
    s_mul_i32 s3, s3, 110592
    s_and_b32 s14, s51, 1
    s_lshl_b32 s14, s14, 5
    s_add_u32 s3, s3, s14
    s_add_u32 s3, s3, 16384
    ds_read_b64_tr_b16 a[88:89], v3 offset:17472
    v_add_u32 v110, s3, v110
    v_mfma_f32_16x16x32_bf16 v[28:31], a[116:119], v[232:235], v[28:31]
    ds_read_b64_tr_b16 a[90:91], v3 offset:17600
    v_and_b32 v14, 16, v0
    v_mfma_f32_16x16x32_bf16 v[28:31], a[120:123], v[240:243], v[28:31]
    ds_read_b64_tr_b16 a[92:93], v3 offset:17728
    v_lshlrev_b32 v14, 1, v14
    v_mfma_f32_16x16x32_bf16 v[28:31], a[124:127], v[248:251], v[28:31]
    s_waitcnt lgkmcnt(11)
    ds_read_b64_tr_b16 a[94:95], v3 offset:17856
    v_xor_b32 v110, v14, v110
    v_mfma_f32_16x16x32_bf16 v[32:35], a[64:67], v[128:131], 0
    s_mul_i32 s3, s51, 288
    s_add_u32 s3, s3, 53248
    ds_read_b64_tr_b16 a[96:97], v3 offset:96
    v_cvt_pk_bf16_f32 v48, v16, v17
    v_mfma_f32_16x16x32_bf16 v[32:35], a[68:71], v[136:139], v[32:35]
    s_waitcnt lgkmcnt(9)
    ds_read_b64_tr_b16 a[98:99], v3 offset:224
    v_cvt_pk_bf16_f32 v49, v18, v19
    v_mfma_f32_16x16x32_bf16 v[32:35], a[72:75], v[144:147], v[32:35]
L2_pad11:
    s_cbranch_execz L2_pad15
    ds_read_b64_tr_b16 a[100:101], v3 offset:352
    v_cvt_pk_bf16_f32 v50, v24, v25
    v_mfma_f32_16x16x32_bf16 v[32:35], a[76:79], v[152:155], v[32:35]
    s_waitcnt lgkmcnt(7)
    ds_read_b64_tr_b16 a[102:103], v3 offset:480
    v_cvt_pk_bf16_f32 v51, v26, v27
    v_mfma_f32_16x16x32_bf16 v[32:35], a[80:83], v[192:195], v[32:35]
    s_mov_b32 s54, 2048
    ds_read_b64_tr_b16 a[104:105], v3 offset:608
    ds_read_b64_tr_b16 a[106:107], v3 offset:736
    v_mfma_f32_16x16x32_bf16 v[32:35], a[84:87], v[200:203], v[32:35]
    s_waitcnt lgkmcnt(6)
    v_permlane32_swap_b32 v48, v50
    v_mfma_f32_16x16x32_bf16 v[32:35], a[88:91], v[208:211], v[32:35]
    v_permlane32_swap_b32 v49, v51
    v_mfma_f32_16x16x32_bf16 v[32:35], a[92:95], v[216:219], v[32:35]
    ds_read_b64_tr_b16 a[108:109], v3 offset:864
    ds_read_b64_tr_b16 a[110:111], v3 offset:992
    buffer_store_dwordx4 v[48:51], v10, s[40:43], s54 offen offset:0 sc1
    v_mfma_f32_16x16x32_bf16 v[36:39], a[64:67], v[160:163], 0
    ds_read_b64_tr_b16 a[112:113], v3 offset:16992
    v_cvt_pk_bf16_f32 v52, v20, v21
    v_mfma_f32_16x16x32_bf16 v[36:39], a[68:71], v[168:171], v[36:39]
    ds_read_b64_tr_b16 a[114:115], v3 offset:17120
    v_cvt_pk_bf16_f32 v53, v22, v23
    v_mfma_f32_16x16x32_bf16 v[36:39], a[72:75], v[176:179], v[36:39]
    ds_read_b64_tr_b16 a[116:117], v3 offset:17248
    v_cvt_pk_bf16_f32 v54, v28, v29
    v_mfma_f32_16x16x32_bf16 v[36:39], a[76:79], v[184:187], v[36:39]
    ds_read_b64_tr_b16 a[118:119], v3 offset:17376
    v_cvt_pk_bf16_f32 v55, v30, v31
    v_mfma_f32_16x16x32_bf16 v[36:39], a[80:83], v[224:227], v[36:39]
    s_mov_b32 s54, 296960
    ds_read_b64_tr_b16 a[120:121], v3 offset:17504
    ds_read_b64_tr_b16 a[122:123], v3 offset:17632
    v_mfma_f32_16x16x32_bf16 v[36:39], a[84:87], v[232:235], v[36:39]
    v_permlane32_swap_b32 v52, v54
    v_mfma_f32_16x16x32_bf16 v[36:39], a[88:91], v[240:243], v[36:39]
    v_permlane32_swap_b32 v53, v55
    v_mfma_f32_16x16x32_bf16 v[36:39], a[92:95], v[248:251], v[36:39]
    s_waitcnt vmcnt(15)
    s_barrier
    s_waitcnt lgkmcnt(10)
    ds_read_b64_tr_b16 a[124:125], v3 offset:17760
    ds_read_b64_tr_b16 a[126:127], v3 offset:17888
    buffer_store_dwordx4 v[52:55], v10, s[40:43], s54 offen offset:0 sc1
    v_mfma_f32_16x16x32_bf16 v[40:43], a[96:99], v[128:131], 0
    s_add_u32 m0, s44, 110592
    ds_read_b64_tr_b16 a[64:65], v3 offset:36864
    ds_read_b64_tr_b16 a[66:67], v3 offset:36992
    v_mfma_f32_16x16x32_bf16 v[40:43], a[100:103], v[136:139], v[40:43]
    s_mov_b32 s45, 640
    s_waitcnt lgkmcnt(10)
    buffer_load_dwordx4 v7, s[28:31], s45 offen offset:0 lds
    v_mfma_f32_16x16x32_bf16 v[40:43], a[104:107], v[144:147], v[40:43]
    s_add_u32 m0, s44, 110496
    ds_read_b64_tr_b16 a[68:69], v3 offset:37120
    ds_read_b64_tr_b16 a[70:71], v3 offset:37248
    v_mfma_f32_16x16x32_bf16 v[40:43], a[108:111], v[152:155], v[40:43]
    s_waitcnt lgkmcnt(8)
    buffer_load_dwordx4 v7, s[28:31], s45 offen offset:1152 lds
    v_mfma_f32_16x16x32_bf16 v[40:43], a[112:115], v[192:195], v[40:43]
    s_add_u32 m0, s44, 110400
    ds_read_b64_tr_b16 a[72:73], v3 offset:37376
    ds_read_b64_tr_b16 a[74:75], v3 offset:37504
    v_mfma_f32_16x16x32_bf16 v[40:43], a[116:119], v[200:203], v[40:43]
    s_waitcnt lgkmcnt(6)
    buffer_load_dwordx4 v7, s[28:31], s45 offen offset:2304 lds
    v_mfma_f32_16x16x32_bf16 v[40:43], a[120:123], v[208:211], v[40:43]
    s_add_u32 m0, s44, 110304
    ds_read_b64_tr_b16 a[76:77], v3 offset:37632
    ds_read_b64_tr_b16 a[78:79], v3 offset:37760
    v_mfma_f32_16x16x32_bf16 v[40:43], a[124:127], v[216:219], v[40:43]
    buffer_load_dwordx4 v7, s[28:31], s45 offen offset:3456 lds
    v_mfma_f32_16x16x32_bf16 v[44:47], a[96:99], v[160:163], 0
    s_add_u32 m0, s44, 127488
    ds_read_b64_tr_b16 a[80:81], v3 offset:53760
    ds_read_b64_tr_b16 a[82:83], v3 offset:53888
    v_mfma_f32_16x16x32_bf16 v[44:47], a[100:103], v[168:171], v[44:47]
    s_mov_b32 s45, 148096
    buffer_load_dwordx4 v7, s[28:31], s45 offen offset:0 lds
    v_mfma_f32_16x16x32_bf16 v[44:47], a[104:107], v[176:179], v[44:47]
    s_add_u32 m0, s44, 127392
    ds_read_b64_tr_b16 a[84:85], v3 offset:54016
    ds_read_b64_tr_b16 a[86:87], v3 offset:54144
    v_mfma_f32_16x16x32_bf16 v[44:47], a[108:111], v[184:187], v[44:47]
    buffer_load_dwordx4 v7, s[28:31], s45 offen offset:1152 lds
    v_mfma_f32_16x16x32_bf16 v[44:47], a[112:115], v[224:227], v[44:47]
    s_add_u32 m0, s44, 127296
    ds_read_b64_tr_b16 a[88:89], v3 offset:54272
    ds_read_b64_tr_b16 a[90:91], v3 offset:54400
    v_mfma_f32_16x16x32_bf16 v[44:47], a[116:119], v[232:235], v[44:47]
    buffer_load_dwordx4 v7, s[28:31], s45 offen offset:2304 lds
    v_mfma_f32_16x16x32_bf16 v[44:47], a[120:123], v[240:243], v[44:47]
    s_add_u32 m0, s44, 127200
    ds_read_b64_tr_b16 a[92:93], v3 offset:54528
    ds_read_b64_tr_b16 a[94:95], v3 offset:54656
    v_mfma_f32_16x16x32_bf16 v[44:47], a[124:127], v[248:251], v[44:47]
    s_waitcnt lgkmcnt(12)
    buffer_load_dwordx4 v7, s[28:31], s45 offen offset:3456 lds
    v_mfma_f32_16x16x32_bf16 v[16:19], a[64:67], v[128:131], 0
    ds_read_b64_tr_b16 a[96:97], v3 offset:36896
    v_cvt_pk_bf16_f32 v48, v32, v33
    v_mfma_f32_16x16x32_bf16 v[16:19], a[68:71], v[136:139], v[16:19]
    s_waitcnt lgkmcnt(9)
    ds_read_b64_tr_b16 a[98:99], v3 offset:37024
    v_cvt_pk_bf16_f32 v49, v34, v35
    v_mfma_f32_16x16x32_bf16 v[16:19], a[72:75], v[144:147], v[16:19]
    ds_read_b64_tr_b16 a[100:101], v3 offset:37152
    v_cvt_pk_bf16_f32 v50, v40, v41
    v_mfma_f32_16x16x32_bf16 v[16:19], a[76:79], v[152:155], v[16:19]
    s_waitcnt lgkmcnt(7)
    ds_read_b64_tr_b16 a[102:103], v3 offset:37280
    v_cvt_pk_bf16_f32 v51, v42, v43
    v_mfma_f32_16x16x32_bf16 v[16:19], a[80:83], v[192:195], v[16:19]
    s_mov_b32 s54, 2048
    ds_read_b64_tr_b16 a[104:105], v3 offset:37408
    ds_read_b64_tr_b16 a[106:107], v3 offset:37536
    v_mfma_f32_16x16x32_bf16 v[16:19], a[84:87], v[200:203], v[16:19]
    s_waitcnt lgkmcnt(6)
    v_permlane32_swap_b32 v48, v50
    v_mfma_f32_16x16x32_bf16 v[16:19], a[88:91], v[208:211], v[16:19]
    v_permlane32_swap_b32 v49, v51
    v_mfma_f32_16x16x32_bf16 v[16:19], a[92:95], v[216:219], v[16:19]
    ds_read_b64_tr_b16 a[108:109], v3 offset:37664
    ds_read_b64_tr_b16 a[110:111], v3 offset:37792
    buffer_store_dwordx4 v[48:51], v10, s[40:43], s54 offen offset:512 sc1
    v_mfma_f32_16x16x32_bf16 v[20:23], a[64:67], v[160:163], 0
    ds_read_b64_tr_b16 a[112:113], v3 offset:53792
    v_cvt_pk_bf16_f32 v52, v36, v37
    v_mfma_f32_16x16x32_bf16 v[20:23], a[68:71], v[168:171], v[20:23]
    ds_read_b64_tr_b16 a[114:115], v3 offset:53920
    v_cvt_pk_bf16_f32 v53, v38, v39
    v_mfma_f32_16x16x32_bf16 v[20:23], a[72:75], v[176:179], v[20:23]
    ds_read_b64_tr_b16 a[116:117], v3 offset:54048
    v_cvt_pk_bf16_f32 v54, v44, v45
    v_mfma_f32_16x16x32_bf16 v[20:23], a[76:79], v[184:187], v[20:23]
    ds_read_b64_tr_b16 a[118:119], v3 offset:54176
    v_cvt_pk_bf16_f32 v55, v46, v47
    v_mfma_f32_16x16x32_bf16 v[20:23], a[80:83], v[224:227], v[20:23]
    s_mov_b32 s54, 296960
    ds_read_b64_tr_b16 a[120:121], v3 offset:54304
    ds_read_b64_tr_b16 a[122:123], v3 offset:54432
    v_mfma_f32_16x16x32_bf16 v[20:23], a[84:87], v[232:235], v[20:23]
    v_permlane32_swap_b32 v52, v54
    v_mfma_f32_16x16x32_bf16 v[20:23], a[88:91], v[240:243], v[20:23]
    v_permlane32_swap_b32 v53, v55
    v_mfma_f32_16x16x32_bf16 v[20:23], a[92:95], v[248:251], v[20:23]
    s_waitcnt lgkmcnt(10)
    ds_read_b64_tr_b16 a[124:125], v3 offset:54560
    ds_read_b64_tr_b16 a[126:127], v3 offset:54688
    buffer_store_dwordx4 v[52:55], v10, s[40:43], s54 offen offset:512 sc1
    v_mfma_f32_16x16x32_bf16 v[24:27], a[96:99], v[128:131], 0
    ds_read_b64_tr_b16 a[64:65], v3 offset:36928
    v_add_u32 v111, s3, v111
    v_mfma_f32_16x16x32_bf16 v[24:27], a[100:103], v[136:139], v[24:27]
    s_waitcnt lgkmcnt(9)
    ds_read_b64_tr_b16 a[66:67], v3 offset:37056
    v_mfma_f32_16x16x32_bf16 v[24:27], a[104:107], v[144:147], v[24:27]
    ds_read_b64_tr_b16 a[68:69], v3 offset:37184
    v_mfma_f32_16x16x32_bf16 v[24:27], a[108:111], v[152:155], v[24:27]
    s_waitcnt lgkmcnt(7)
    ds_read_b64_tr_b16 a[70:71], v3 offset:37312
    v_mfma_f32_16x16x32_bf16 v[24:27], a[112:115], v[192:195], v[24:27]
    ds_read_b64_tr_b16 a[72:73], v3 offset:37440
    v_mfma_f32_16x16x32_bf16 v[24:27], a[116:119], v[200:203], v[24:27]
    s_waitcnt lgkmcnt(5)
    ds_read_b64_tr_b16 a[74:75], v3 offset:37568
    v_mfma_f32_16x16x32_bf16 v[24:27], a[120:123], v[208:211], v[24:27]
    ds_read_b64_tr_b16 a[76:77], v3 offset:37696
    v_mfma_f32_16x16x32_bf16 v[24:27], a[124:127], v[216:219], v[24:27]
    ds_read_b64_tr_b16 a[78:79], v3 offset:37824
    v_mfma_f32_16x16x32_bf16 v[28:31], a[96:99], v[160:163], 0
    ds_read_b64_tr_b16 a[80:81], v3 offset:53824
    v_mfma_f32_16x16x32_bf16 v[28:31], a[100:103], v[168:171], v[28:31]
    ds_read_b64_tr_b16 a[82:83], v3 offset:53952
    v_mfma_f32_16x16x32_bf16 v[28:31], a[104:107], v[176:179], v[28:31]
    ds_read_b64_tr_b16 a[84:85], v3 offset:54080
    v_mfma_f32_16x16x32_bf16 v[28:31], a[108:111], v[184:187], v[28:31]
    ds_read_b64_tr_b16 a[86:87], v3 offset:54208
    v_mfma_f32_16x16x32_bf16 v[28:31], a[112:115], v[224:227], v[28:31]
    ds_read_b64_tr_b16 a[88:89], v3 offset:54336
    v_mfma_f32_16x16x32_bf16 v[28:31], a[116:119], v[232:235], v[28:31]
    ds_read_b64_tr_b16 a[90:91], v3 offset:54464
    v_mfma_f32_16x16x32_bf16 v[28:31], a[120:123], v[240:243], v[28:31]
    ds_read_b64_tr_b16 a[92:93], v3 offset:54592
    v_mfma_f32_16x16x32_bf16 v[28:31], a[124:127], v[248:251], v[28:31]
    s_waitcnt lgkmcnt(11)
    ds_read_b64_tr_b16 a[94:95], v3 offset:54720
    v_mfma_f32_16x16x32_bf16 v[32:35], a[64:67], v[128:131], 0
    ds_read_b64_tr_b16 a[96:97], v3 offset:36960
    v_cvt_pk_bf16_f32 v48, v16, v17
    v_mfma_f32_16x16x32_bf16 v[32:35], a[68:71], v[136:139], v[32:35]
    s_waitcnt lgkmcnt(9)
    ds_read_b64_tr_b16 a[98:99], v3 offset:37088
    v_cvt_pk_bf16_f32 v49, v18, v19
    v_mfma_f32_16x16x32_bf16 v[32:35], a[72:75], v[144:147], v[32:35]
    ds_read_b64_tr_b16 a[100:101], v3 offset:37216
    v_cvt_pk_bf16_f32 v50, v24, v25
    v_mfma_f32_16x16x32_bf16 v[32:35], a[76:79], v[152:155], v[32:35]
    s_waitcnt lgkmcnt(7)
    ds_read_b64_tr_b16 a[102:103], v3 offset:37344
    v_cvt_pk_bf16_f32 v51, v26, v27
    v_mfma_f32_16x16x32_bf16 v[32:35], a[80:83], v[192:195], v[32:35]
    s_mov_b32 s54, 3072
    ds_read_b64_tr_b16 a[104:105], v3 offset:37472
    ds_read_b64_tr_b16 a[106:107], v3 offset:37600
    v_mfma_f32_16x16x32_bf16 v[32:35], a[84:87], v[200:203], v[32:35]
    s_waitcnt lgkmcnt(6)
    v_permlane32_swap_b32 v48, v50
    v_mfma_f32_16x16x32_bf16 v[32:35], a[88:91], v[208:211], v[32:35]
    v_permlane32_swap_b32 v49, v51
    v_mfma_f32_16x16x32_bf16 v[32:35], a[92:95], v[216:219], v[32:35]
    ds_read_b64_tr_b16 a[108:109], v3 offset:37728
    ds_read_b64_tr_b16 a[110:111], v3 offset:37856
    buffer_store_dwordx4 v[48:51], v10, s[40:43], s54 offen offset:0 sc1
    v_mfma_f32_16x16x32_bf16 v[36:39], a[64:67], v[160:163], 0
    ds_read_b64_tr_b16 a[112:113], v3 offset:53856
    v_cvt_pk_bf16_f32 v52, v20, v21
    v_mfma_f32_16x16x32_bf16 v[36:39], a[68:71], v[168:171], v[36:39]
    ds_read_b64_tr_b16 a[114:115], v3 offset:53984
    v_cvt_pk_bf16_f32 v53, v22, v23
    v_mfma_f32_16x16x32_bf16 v[36:39], a[72:75], v[176:179], v[36:39]
    ds_read_b64_tr_b16 a[116:117], v3 offset:54112
    v_cvt_pk_bf16_f32 v54, v28, v29
    v_mfma_f32_16x16x32_bf16 v[36:39], a[76:79], v[184:187], v[36:39]
    ds_read_b64_tr_b16 a[118:119], v3 offset:54240
    v_cvt_pk_bf16_f32 v55, v30, v31
    v_mfma_f32_16x16x32_bf16 v[36:39], a[80:83], v[224:227], v[36:39]
    s_mov_b32 s54, 297984
    ds_read_b64_tr_b16 a[120:121], v3 offset:54368
    ds_read_b64_tr_b16 a[122:123], v3 offset:54496
    v_mfma_f32_16x16x32_bf16 v[36:39], a[84:87], v[232:235], v[36:39]
    v_permlane32_swap_b32 v52, v54
    v_mfma_f32_16x16x32_bf16 v[36:39], a[88:91], v[240:243], v[36:39]
    v_permlane32_swap_b32 v53, v55
    v_mfma_f32_16x16x32_bf16 v[36:39], a[92:95], v[248:251], v[36:39]
    s_waitcnt vmcnt(15)
    s_barrier
    s_waitcnt lgkmcnt(10)
    ds_read_b64_tr_b16 a[124:125], v3 offset:54624
    ds_read_b64_tr_b16 a[126:127], v3 offset:54752
    buffer_store_dwordx4 v[52:55], v10, s[40:43], s54 offen offset:0 sc1
    v_mfma_f32_16x16x32_bf16 v[40:43], a[96:99], v[128:131], 0
    s_add_u32 m0, s44, 0
    ds_read_b64_tr_b16 a[64:65], v4 offset:0
    ds_read_b64_tr_b16 a[66:67], v4 offset:128
    v_mfma_f32_16x16x32_bf16 v[40:43], a[100:103], v[136:139], v[40:43]
    s_mov_b32 s45, 768
    s_waitcnt lgkmcnt(10)
    buffer_load_dwordx4 v7, s[28:31], s45 offen offset:0 lds
    v_mfma_f32_16x16x32_bf16 v[40:43], a[104:107], v[144:147], v[40:43]
    s_add_u32 m0, s44, -96
    ds_read_b64_tr_b16 a[68:69], v4 offset:256
    ds_read_b64_tr_b16 a[70:71], v4 offset:384
    v_mfma_f32_16x16x32_bf16 v[40:43], a[108:111], v[152:155], v[40:43]
    s_waitcnt lgkmcnt(8)
    buffer_load_dwordx4 v7, s[28:31], s45 offen offset:1152 lds
    v_mfma_f32_16x16x32_bf16 v[40:43], a[112:115], v[192:195], v[40:43]
    s_add_u32 m0, s44, -192
    ds_read_b64_tr_b16 a[72:73], v4 offset:512
    ds_read_b64_tr_b16 a[74:75], v4 offset:640
    v_mfma_f32_16x16x32_bf16 v[40:43], a[116:119], v[200:203], v[40:43]
    s_waitcnt lgkmcnt(6)
    buffer_load_dwordx4 v7, s[28:31], s45 offen offset:2304 lds
    v_mfma_f32_16x16x32_bf16 v[40:43], a[120:123], v[208:211], v[40:43]
    s_add_u32 m0, s44, -288
    ds_read_b64_tr_b16 a[76:77], v4 offset:768
    ds_read_b64_tr_b16 a[78:79], v4 offset:896
    v_mfma_f32_16x16x32_bf16 v[40:43], a[124:127], v[216:219], v[40:43]
    buffer_load_dwordx4 v7, s[28:31], s45 offen offset:3456 lds
    v_mfma_f32_16x16x32_bf16 v[44:47], a[96:99], v[160:163], 0
    s_add_u32 m0, s44, 16896
    ds_read_b64_tr_b16 a[80:81], v4 offset:16896
    ds_read_b64_tr_b16 a[82:83], v4 offset:17024
    v_mfma_f32_16x16x32_bf16 v[44:47], a[100:103], v[168:171], v[44:47]
    s_mov_b32 s45, 148224
    buffer_load_dwordx4 v7, s[28:31], s45 offen offset:0 lds
    v_mfma_f32_16x16x32_bf16 v[44:47], a[104:107], v[176:179], v[44:47]
    s_add_u32 m0, s44, 16800
    ds_read_b64_tr_b16 a[84:85], v4 offset:17152
    ds_read_b64_tr_b16 a[86:87], v4 offset:17280
    v_mfma_f32_16x16x32_bf16 v[44:47], a[108:111], v[184:187], v[44:47]
    buffer_load_dwordx4 v7, s[28:31], s45 offen offset:1152 lds
    v_mfma_f32_16x16x32_bf16 v[44:47], a[112:115], v[224:227], v[44:47]
    s_add_u32 m0, s44, 16704
    ds_read_b64_tr_b16 a[88:89], v4 offset:17408
    ds_read_b64_tr_b16 a[90:91], v4 offset:17536
    v_mfma_f32_16x16x32_bf16 v[44:47], a[116:119], v[232:235], v[44:47]
    buffer_load_dwordx4 v7, s[28:31], s45 offen offset:2304 lds
    v_mfma_f32_16x16x32_bf16 v[44:47], a[120:123], v[240:243], v[44:47]
    s_add_u32 m0, s44, 16608
    ds_read_b64_tr_b16 a[92:93], v4 offset:17664
    ds_read_b64_tr_b16 a[94:95], v4 offset:17792
    v_mfma_f32_16x16x32_bf16 v[44:47], a[124:127], v[248:251], v[44:47]
    s_waitcnt lgkmcnt(12)
    buffer_load_dwordx4 v7, s[28:31], s45 offen offset:3456 lds
    v_mfma_f32_16x16x32_bf16 v[16:19], a[64:67], v[128:131], 0
    ds_read_b64_tr_b16 a[96:97], v4 offset:32
    v_cvt_pk_bf16_f32 v48, v32, v33
    v_mfma_f32_16x16x32_bf16 v[16:19], a[68:71], v[136:139], v[16:19]
    s_waitcnt lgkmcnt(9)
    ds_read_b64_tr_b16 a[98:99], v4 offset:160
    v_cvt_pk_bf16_f32 v49, v34, v35
    v_mfma_f32_16x16x32_bf16 v[16:19], a[72:75], v[144:147], v[16:19]
    ds_read_b64_tr_b16 a[100:101], v4 offset:288
    v_cvt_pk_bf16_f32 v50, v40, v41
    v_mfma_f32_16x16x32_bf16 v[16:19], a[76:79], v[152:155], v[16:19]
    s_waitcnt lgkmcnt(7)
    ds_read_b64_tr_b16 a[102:103], v4 offset:416
    v_cvt_pk_bf16_f32 v51, v42, v43
    v_mfma_f32_16x16x32_bf16 v[16:19], a[80:83], v[192:195], v[16:19]
    s_mov_b32 s54, 3072
    ds_read_b64_tr_b16 a[104:105], v4 offset:544
    ds_read_b64_tr_b16 a[106:107], v4 offset:672
    v_mfma_f32_16x16x32_bf16 v[16:19], a[84:87], v[200:203], v[16:19]
    s_waitcnt lgkmcnt(6)
    v_permlane32_swap_b32 v48, v50
    v_mfma_f32_16x16x32_bf16 v[16:19], a[88:91], v[208:211], v[16:19]
    v_permlane32_swap_b32 v49, v51
    v_mfma_f32_16x16x32_bf16 v[16:19], a[92:95], v[216:219], v[16:19]
    ds_read_b64_tr_b16 a[108:109], v4 offset:800
    ds_read_b64_tr_b16 a[110:111], v4 offset:928
    buffer_store_dwordx4 v[48:51], v10, s[40:43], s54 offen offset:512 sc1
    v_mfma_f32_16x16x32_bf16 v[20:23], a[64:67], v[160:163], 0
    ds_read_b64_tr_b16 a[112:113], v4 offset:16928
    v_cvt_pk_bf16_f32 v52, v36, v37
    v_mfma_f32_16x16x32_bf16 v[20:23], a[68:71], v[168:171], v[20:23]
    ds_read_b64_tr_b16 a[114:115], v4 offset:17056
    v_cvt_pk_bf16_f32 v53, v38, v39
    v_mfma_f32_16x16x32_bf16 v[20:23], a[72:75], v[176:179], v[20:23]
    ds_read_b64_tr_b16 a[116:117], v4 offset:17184
    v_cvt_pk_bf16_f32 v54, v44, v45
    v_mfma_f32_16x16x32_bf16 v[20:23], a[76:79], v[184:187], v[20:23]
    ds_read_b64_tr_b16 a[118:119], v4 offset:17312
    v_cvt_pk_bf16_f32 v55, v46, v47
    v_mfma_f32_16x16x32_bf16 v[20:23], a[80:83], v[224:227], v[20:23]
    s_mov_b32 s54, 297984
    ds_read_b64_tr_b16 a[120:121], v4 offset:17440
    ds_read_b64_tr_b16 a[122:123], v4 offset:17568
    v_mfma_f32_16x16x32_bf16 v[20:23], a[84:87], v[232:235], v[20:23]
    v_permlane32_swap_b32 v52, v54
    v_mfma_f32_16x16x32_bf16 v[20:23], a[88:91], v[240:243], v[20:23]
    v_permlane32_swap_b32 v53, v55
    v_mfma_f32_16x16x32_bf16 v[20:23], a[92:95], v[248:251], v[20:23]
    s_waitcnt lgkmcnt(10)
    ds_read_b64_tr_b16 a[124:125], v4 offset:17696
    ds_read_b64_tr_b16 a[126:127], v4 offset:17824
    buffer_store_dwordx4 v[52:55], v10, s[40:43], s54 offen offset:512 sc1
    v_mfma_f32_16x16x32_bf16 v[24:27], a[96:99], v[128:131], 0
    ds_read_b64_tr_b16 a[64:65], v4 offset:64
    v_mfma_f32_16x16x32_bf16 v[24:27], a[100:103], v[136:139], v[24:27]
    s_waitcnt lgkmcnt(9)
    ds_read_b64_tr_b16 a[66:67], v4 offset:192
    v_mfma_f32_16x16x32_bf16 v[24:27], a[104:107], v[144:147], v[24:27]
    ds_read_b64_tr_b16 a[68:69], v4 offset:320
    v_mfma_f32_16x16x32_bf16 v[24:27], a[108:111], v[152:155], v[24:27]
    s_waitcnt lgkmcnt(7)
    ds_read_b64_tr_b16 a[70:71], v4 offset:448
    v_mfma_f32_16x16x32_bf16 v[24:27], a[112:115], v[192:195], v[24:27]
    ds_read_b64_tr_b16 a[72:73], v4 offset:576
    v_mfma_f32_16x16x32_bf16 v[24:27], a[116:119], v[200:203], v[24:27]
    s_waitcnt lgkmcnt(5)
    ds_read_b64_tr_b16 a[74:75], v4 offset:704
    v_mfma_f32_16x16x32_bf16 v[24:27], a[120:123], v[208:211], v[24:27]
    ds_read_b64_tr_b16 a[76:77], v4 offset:832
    v_mfma_f32_16x16x32_bf16 v[24:27], a[124:127], v[216:219], v[24:27]
    ds_read_b64_tr_b16 a[78:79], v4 offset:960
    v_mfma_f32_16x16x32_bf16 v[28:31], a[96:99], v[160:163], 0
    ds_read_b64_tr_b16 a[80:81], v4 offset:16960
    v_mfma_f32_16x16x32_bf16 v[28:31], a[100:103], v[168:171], v[28:31]
    ds_read_b64_tr_b16 a[82:83], v4 offset:17088
    v_mfma_f32_16x16x32_bf16 v[28:31], a[104:107], v[176:179], v[28:31]
    ds_read_b64_tr_b16 a[84:85], v4 offset:17216
    v_mfma_f32_16x16x32_bf16 v[28:31], a[108:111], v[184:187], v[28:31]
    ds_read_b64_tr_b16 a[86:87], v4 offset:17344
    v_mfma_f32_16x16x32_bf16 v[28:31], a[112:115], v[224:227], v[28:31]
    ds_read_b64_tr_b16 a[88:89], v4 offset:17472
    v_mfma_f32_16x16x32_bf16 v[28:31], a[116:119], v[232:235], v[28:31]
    ds_read_b64_tr_b16 a[90:91], v4 offset:17600
    v_mfma_f32_16x16x32_bf16 v[28:31], a[120:123], v[240:243], v[28:31]
    ds_read_b64_tr_b16 a[92:93], v4 offset:17728
    v_mfma_f32_16x16x32_bf16 v[28:31], a[124:127], v[248:251], v[28:31]
    s_waitcnt lgkmcnt(11)
    ds_read_b64_tr_b16 a[94:95], v4 offset:17856
    v_mfma_f32_16x16x32_bf16 v[32:35], a[64:67], v[128:131], 0
    ds_read_b64_tr_b16 a[96:97], v4 offset:96
    v_cvt_pk_bf16_f32 v48, v16, v17
    v_mfma_f32_16x16x32_bf16 v[32:35], a[68:71], v[136:139], v[32:35]
    s_waitcnt lgkmcnt(9)
    ds_read_b64_tr_b16 a[98:99], v4 offset:224
    v_cvt_pk_bf16_f32 v49, v18, v19
    v_mfma_f32_16x16x32_bf16 v[32:35], a[72:75], v[144:147], v[32:35]
    ds_read_b64_tr_b16 a[100:101], v4 offset:352
    v_cvt_pk_bf16_f32 v50, v24, v25
    v_mfma_f32_16x16x32_bf16 v[32:35], a[76:79], v[152:155], v[32:35]
    s_waitcnt lgkmcnt(7)
    ds_read_b64_tr_b16 a[102:103], v4 offset:480
    v_cvt_pk_bf16_f32 v51, v26, v27
    v_mfma_f32_16x16x32_bf16 v[32:35], a[80:83], v[192:195], v[32:35]
    s_mov_b32 s54, 4096
    ds_read_b64_tr_b16 a[104:105], v4 offset:608
    ds_read_b64_tr_b16 a[106:107], v4 offset:736
    v_mfma_f32_16x16x32_bf16 v[32:35], a[84:87], v[200:203], v[32:35]
    s_waitcnt lgkmcnt(6)
    v_permlane32_swap_b32 v48, v50
    v_mfma_f32_16x16x32_bf16 v[32:35], a[88:91], v[208:211], v[32:35]
    v_permlane32_swap_b32 v49, v51
    v_mfma_f32_16x16x32_bf16 v[32:35], a[92:95], v[216:219], v[32:35]
    ds_read_b64_tr_b16 a[108:109], v4 offset:864
    ds_read_b64_tr_b16 a[110:111], v4 offset:992
    buffer_store_dwordx4 v[48:51], v10, s[40:43], s54 offen offset:0 sc1
    v_mfma_f32_16x16x32_bf16 v[36:39], a[64:67], v[160:163], 0
    ds_read_b64_tr_b16 a[112:113], v4 offset:16992
    v_cvt_pk_bf16_f32 v52, v20, v21
    v_mfma_f32_16x16x32_bf16 v[36:39], a[68:71], v[168:171], v[36:39]
    ds_read_b64_tr_b16 a[114:115], v4 offset:17120
    v_cvt_pk_bf16_f32 v53, v22, v23
    v_mfma_f32_16x16x32_bf16 v[36:39], a[72:75], v[176:179], v[36:39]
    ds_read_b64_tr_b16 a[116:117], v4 offset:17248
    v_cvt_pk_bf16_f32 v54, v28, v29
    v_mfma_f32_16x16x32_bf16 v[36:39], a[76:79], v[184:187], v[36:39]
    ds_read_b64_tr_b16 a[118:119], v4 offset:17376
    v_cvt_pk_bf16_f32 v55, v30, v31
    v_mfma_f32_16x16x32_bf16 v[36:39], a[80:83], v[224:227], v[36:39]
    s_mov_b32 s54, 299008
    ds_read_b64_tr_b16 a[120:121], v4 offset:17504
    ds_read_b64_tr_b16 a[122:123], v4 offset:17632
    v_mfma_f32_16x16x32_bf16 v[36:39], a[84:87], v[232:235], v[36:39]
    v_permlane32_swap_b32 v52, v54
    v_mfma_f32_16x16x32_bf16 v[36:39], a[88:91], v[240:243], v[36:39]
    v_permlane32_swap_b32 v53, v55
    v_mfma_f32_16x16x32_bf16 v[36:39], a[92:95], v[248:251], v[36:39]
    s_waitcnt vmcnt(15)
    s_barrier
    s_waitcnt lgkmcnt(10)
    ds_read_b64_tr_b16 a[124:125], v4 offset:17760
    ds_read_b64_tr_b16 a[126:127], v4 offset:17888
    buffer_store_dwordx4 v[52:55], v10, s[40:43], s54 offen offset:0 sc1
    v_mfma_f32_16x16x32_bf16 v[40:43], a[96:99], v[128:131], 0
    s_add_u32 m0, s44, 36864
    ds_read_b64_tr_b16 a[64:65], v4 offset:36864
    ds_read_b64_tr_b16 a[66:67], v4 offset:36992
    v_mfma_f32_16x16x32_bf16 v[40:43], a[100:103], v[136:139], v[40:43]
    s_mov_b32 s45, 896
    s_waitcnt lgkmcnt(10)
    buffer_load_dwordx4 v7, s[28:31], s45 offen offset:0 lds
    v_mfma_f32_16x16x32_bf16 v[40:43], a[104:107], v[144:147], v[40:43]
    s_add_u32 m0, s44, 36768
    ds_read_b64_tr_b16 a[68:69], v4 offset:37120
    ds_read_b64_tr_b16 a[70:71], v4 offset:37248
    v_mfma_f32_16x16x32_bf16 v[40:43], a[108:111], v[152:155], v[40:43]
    s_waitcnt lgkmcnt(8)
    buffer_load_dwordx4 v7, s[28:31], s45 offen offset:1152 lds
    v_mfma_f32_16x16x32_bf16 v[40:43], a[112:115], v[192:195], v[40:43]
    s_add_u32 m0, s44, 36672
    ds_read_b64_tr_b16 a[72:73], v4 offset:37376
    ds_read_b64_tr_b16 a[74:75], v4 offset:37504
    v_mfma_f32_16x16x32_bf16 v[40:43], a[116:119], v[200:203], v[40:43]
    s_waitcnt lgkmcnt(6)
    buffer_load_dwordx4 v7, s[28:31], s45 offen offset:2304 lds
    v_mfma_f32_16x16x32_bf16 v[40:43], a[120:123], v[208:211], v[40:43]
    s_add_u32 m0, s44, 36576
    ds_read_b64_tr_b16 a[76:77], v4 offset:37632
    ds_read_b64_tr_b16 a[78:79], v4 offset:37760
    v_mfma_f32_16x16x32_bf16 v[40:43], a[124:127], v[216:219], v[40:43]
    buffer_load_dwordx4 v7, s[28:31], s45 offen offset:3456 lds
    v_mfma_f32_16x16x32_bf16 v[44:47], a[96:99], v[160:163], 0
    s_add_u32 m0, s44, 53760
    ds_read_b64_tr_b16 a[80:81], v4 offset:53760
    ds_read_b64_tr_b16 a[82:83], v4 offset:53888
    v_mfma_f32_16x16x32_bf16 v[44:47], a[100:103], v[168:171], v[44:47]
    s_mov_b32 s45, 148352
    buffer_load_dwordx4 v7, s[28:31], s45 offen offset:0 lds
    v_mfma_f32_16x16x32_bf16 v[44:47], a[104:107], v[176:179], v[44:47]
    s_add_u32 m0, s44, 53664
    ds_read_b64_tr_b16 a[84:85], v4 offset:54016
    ds_read_b64_tr_b16 a[86:87], v4 offset:54144
    v_mfma_f32_16x16x32_bf16 v[44:47], a[108:111], v[184:187], v[44:47]
    buffer_load_dwordx4 v7, s[28:31], s45 offen offset:1152 lds
    v_mfma_f32_16x16x32_bf16 v[44:47], a[112:115], v[224:227], v[44:47]
    s_add_u32 m0, s44, 53568
    ds_read_b64_tr_b16 a[88:89], v4 offset:54272
    ds_read_b64_tr_b16 a[90:91], v4 offset:54400
    v_mfma_f32_16x16x32_bf16 v[44:47], a[116:119], v[232:235], v[44:47]
    buffer_load_dwordx4 v7, s[28:31], s45 offen offset:2304 lds
    v_mfma_f32_16x16x32_bf16 v[44:47], a[120:123], v[240:243], v[44:47]
    s_add_u32 m0, s44, 53472
    ds_read_b64_tr_b16 a[92:93], v4 offset:54528
    ds_read_b64_tr_b16 a[94:95], v4 offset:54656
    v_mfma_f32_16x16x32_bf16 v[44:47], a[124:127], v[248:251], v[44:47]
    s_waitcnt lgkmcnt(12)
    buffer_load_dwordx4 v7, s[28:31], s45 offen offset:3456 lds
    v_mfma_f32_16x16x32_bf16 v[16:19], a[64:67], v[128:131], 0
    ds_read_b64_tr_b16 a[96:97], v4 offset:36896
    v_cvt_pk_bf16_f32 v48, v32, v33
    v_mfma_f32_16x16x32_bf16 v[16:19], a[68:71], v[136:139], v[16:19]
    s_waitcnt lgkmcnt(9)
    ds_read_b64_tr_b16 a[98:99], v4 offset:37024
    v_cvt_pk_bf16_f32 v49, v34, v35
    v_mfma_f32_16x16x32_bf16 v[16:19], a[72:75], v[144:147], v[16:19]
    ds_read_b64_tr_b16 a[100:101], v4 offset:37152
    v_cvt_pk_bf16_f32 v50, v40, v41
    v_mfma_f32_16x16x32_bf16 v[16:19], a[76:79], v[152:155], v[16:19]
    s_waitcnt lgkmcnt(7)
    ds_read_b64_tr_b16 a[102:103], v4 offset:37280
    v_cvt_pk_bf16_f32 v51, v42, v43
    v_mfma_f32_16x16x32_bf16 v[16:19], a[80:83], v[192:195], v[16:19]
    s_mov_b32 s54, 4096
    ds_read_b64_tr_b16 a[104:105], v4 offset:37408
    ds_read_b64_tr_b16 a[106:107], v4 offset:37536
    v_mfma_f32_16x16x32_bf16 v[16:19], a[84:87], v[200:203], v[16:19]
    s_waitcnt lgkmcnt(6)
    v_permlane32_swap_b32 v48, v50
    v_mfma_f32_16x16x32_bf16 v[16:19], a[88:91], v[208:211], v[16:19]
    v_permlane32_swap_b32 v49, v51
    v_mfma_f32_16x16x32_bf16 v[16:19], a[92:95], v[216:219], v[16:19]
    ds_read_b64_tr_b16 a[108:109], v4 offset:37664
    ds_read_b64_tr_b16 a[110:111], v4 offset:37792
    buffer_store_dwordx4 v[48:51], v10, s[40:43], s54 offen offset:512 sc1
    v_mfma_f32_16x16x32_bf16 v[20:23], a[64:67], v[160:163], 0
    ds_read_b64_tr_b16 a[112:113], v4 offset:53792
    v_cvt_pk_bf16_f32 v52, v36, v37
    v_mfma_f32_16x16x32_bf16 v[20:23], a[68:71], v[168:171], v[20:23]
    ds_read_b64_tr_b16 a[114:115], v4 offset:53920
    v_cvt_pk_bf16_f32 v53, v38, v39
    v_mfma_f32_16x16x32_bf16 v[20:23], a[72:75], v[176:179], v[20:23]
    ds_read_b64_tr_b16 a[116:117], v4 offset:54048
    v_cvt_pk_bf16_f32 v54, v44, v45
    v_mfma_f32_16x16x32_bf16 v[20:23], a[76:79], v[184:187], v[20:23]
    ds_read_b64_tr_b16 a[118:119], v4 offset:54176
    v_cvt_pk_bf16_f32 v55, v46, v47
    v_mfma_f32_16x16x32_bf16 v[20:23], a[80:83], v[224:227], v[20:23]
    s_mov_b32 s54, 299008
    ds_read_b64_tr_b16 a[120:121], v4 offset:54304
    ds_read_b64_tr_b16 a[122:123], v4 offset:54432
    v_mfma_f32_16x16x32_bf16 v[20:23], a[84:87], v[232:235], v[20:23]
    v_permlane32_swap_b32 v52, v54
    v_mfma_f32_16x16x32_bf16 v[20:23], a[88:91], v[240:243], v[20:23]
    v_permlane32_swap_b32 v53, v55
    v_mfma_f32_16x16x32_bf16 v[20:23], a[92:95], v[248:251], v[20:23]
    s_waitcnt lgkmcnt(10)
    ds_read_b64_tr_b16 a[124:125], v4 offset:54560
    ds_read_b64_tr_b16 a[126:127], v4 offset:54688
    buffer_store_dwordx4 v[52:55], v10, s[40:43], s54 offen offset:512 sc1
    v_mfma_f32_16x16x32_bf16 v[24:27], a[96:99], v[128:131], 0
L2_pad12:
    s_cbranch_execz L2_walkret
    ds_read_b64_tr_b16 a[64:65], v4 offset:36928
    v_mfma_f32_16x16x32_bf16 v[24:27], a[100:103], v[136:139], v[24:27]
    s_waitcnt lgkmcnt(9)
    ds_read_b64_tr_b16 a[66:67], v4 offset:37056
    v_mfma_f32_16x16x32_bf16 v[24:27], a[104:107], v[144:147], v[24:27]
    ds_read_b64_tr_b16 a[68:69], v4 offset:37184
    v_mfma_f32_16x16x32_bf16 v[24:27], a[108:111], v[152:155], v[24:27]
    s_waitcnt lgkmcnt(7)
    ds_read_b64_tr_b16 a[70:71], v4 offset:37312
    v_mfma_f32_16x16x32_bf16 v[24:27], a[112:115], v[192:195], v[24:27]
    ds_read_b64_tr_b16 a[72:73], v4 offset:37440
    v_mfma_f32_16x16x32_bf16 v[24:27], a[116:119], v[200:203], v[24:27]
    s_waitcnt lgkmcnt(5)
    ds_read_b64_tr_b16 a[74:75], v4 offset:37568
    v_mfma_f32_16x16x32_bf16 v[24:27], a[120:123], v[208:211], v[24:27]
    ds_read_b64_tr_b16 a[76:77], v4 offset:37696
    v_mfma_f32_16x16x32_bf16 v[24:27], a[124:127], v[216:219], v[24:27]
    ds_read_b64_tr_b16 a[78:79], v4 offset:37824
    v_mfma_f32_16x16x32_bf16 v[28:31], a[96:99], v[160:163], 0
    ds_read_b64_tr_b16 a[80:81], v4 offset:53824
    v_mfma_f32_16x16x32_bf16 v[28:31], a[100:103], v[168:171], v[28:31]
    ds_read_b64_tr_b16 a[82:83], v4 offset:53952
    v_mfma_f32_16x16x32_bf16 v[28:31], a[104:107], v[176:179], v[28:31]
    ds_read_b64_tr_b16 a[84:85], v4 offset:54080
    v_mfma_f32_16x16x32_bf16 v[28:31], a[108:111], v[184:187], v[28:31]
    ds_read_b64_tr_b16 a[86:87], v4 offset:54208
    v_mfma_f32_16x16x32_bf16 v[28:31], a[112:115], v[224:227], v[28:31]
    ds_read_b64_tr_b16 a[88:89], v4 offset:54336
    v_mfma_f32_16x16x32_bf16 v[28:31], a[116:119], v[232:235], v[28:31]
    ds_read_b64_tr_b16 a[90:91], v4 offset:54464
    v_mfma_f32_16x16x32_bf16 v[28:31], a[120:123], v[240:243], v[28:31]
    ds_read_b64_tr_b16 a[92:93], v4 offset:54592
    v_mfma_f32_16x16x32_bf16 v[28:31], a[124:127], v[248:251], v[28:31]
    s_waitcnt lgkmcnt(11)
    ds_read_b64_tr_b16 a[94:95], v4 offset:54720
    v_mfma_f32_16x16x32_bf16 v[32:35], a[64:67], v[128:131], 0
    ds_read_b64_tr_b16 a[96:97], v4 offset:36960
    v_cvt_pk_bf16_f32 v48, v16, v17
    v_mfma_f32_16x16x32_bf16 v[32:35], a[68:71], v[136:139], v[32:35]
    s_waitcnt lgkmcnt(9)
    ds_read_b64_tr_b16 a[98:99], v4 offset:37088
    v_cvt_pk_bf16_f32 v49, v18, v19
    v_mfma_f32_16x16x32_bf16 v[32:35], a[72:75], v[144:147], v[32:35]
    ds_read_b64_tr_b16 a[100:101], v4 offset:37216
    v_cvt_pk_bf16_f32 v50, v24, v25
    v_mfma_f32_16x16x32_bf16 v[32:35], a[76:79], v[152:155], v[32:35]
    s_waitcnt lgkmcnt(7)
    ds_read_b64_tr_b16 a[102:103], v4 offset:37344
    v_cvt_pk_bf16_f32 v51, v26, v27
    v_mfma_f32_16x16x32_bf16 v[32:35], a[80:83], v[192:195], v[32:35]
    s_mov_b32 s54, 5120
    ds_read_b64_tr_b16 a[104:105], v4 offset:37472
    ds_read_b64_tr_b16 a[106:107], v4 offset:37600
    v_mfma_f32_16x16x32_bf16 v[32:35], a[84:87], v[200:203], v[32:35]
    s_waitcnt lgkmcnt(6)
    v_permlane32_swap_b32 v48, v50
    v_mfma_f32_16x16x32_bf16 v[32:35], a[88:91], v[208:211], v[32:35]
    v_permlane32_swap_b32 v49, v51
    v_mfma_f32_16x16x32_bf16 v[32:35], a[92:95], v[216:219], v[32:35]
    ds_read_b64_tr_b16 a[108:109], v4 offset:37728
    ds_read_b64_tr_b16 a[110:111], v4 offset:37856
    buffer_store_dwordx4 v[48:51], v10, s[40:43], s54 offen offset:0 sc1
    v_mfma_f32_16x16x32_bf16 v[36:39], a[64:67], v[160:163], 0
    ds_read_b64_tr_b16 a[112:113], v4 offset:53856
    v_cvt_pk_bf16_f32 v52, v20, v21
    v_mfma_f32_16x16x32_bf16 v[36:39], a[68:71], v[168:171], v[36:39]
    ds_read_b64_tr_b16 a[114:115], v4 offset:53984
    v_cvt_pk_bf16_f32 v53, v22, v23
    v_mfma_f32_16x16x32_bf16 v[36:39], a[72:75], v[176:179], v[36:39]
    ds_read_b64_tr_b16 a[116:117], v4 offset:54112
    v_cvt_pk_bf16_f32 v54, v28, v29
    v_mfma_f32_16x16x32_bf16 v[36:39], a[76:79], v[184:187], v[36:39]
    ds_read_b64_tr_b16 a[118:119], v4 offset:54240
    v_cvt_pk_bf16_f32 v55, v30, v31
    v_mfma_f32_16x16x32_bf16 v[36:39], a[80:83], v[224:227], v[36:39]
    s_mov_b32 s54, 300032
    ds_read_b64_tr_b16 a[120:121], v4 offset:54368
    ds_read_b64_tr_b16 a[122:123], v4 offset:54496
    v_mfma_f32_16x16x32_bf16 v[36:39], a[84:87], v[232:235], v[36:39]
    v_permlane32_swap_b32 v52, v54
    v_mfma_f32_16x16x32_bf16 v[36:39], a[88:91], v[240:243], v[36:39]
    v_permlane32_swap_b32 v53, v55
    v_mfma_f32_16x16x32_bf16 v[36:39], a[92:95], v[248:251], v[36:39]
    s_waitcnt vmcnt(15)
    s_barrier
    s_waitcnt lgkmcnt(10)
    ds_read_b64_tr_b16 a[124:125], v4 offset:54624
    ds_read_b64_tr_b16 a[126:127], v4 offset:54752
    buffer_store_dwordx4 v[52:55], v10, s[40:43], s54 offen offset:0 sc1
    v_mfma_f32_16x16x32_bf16 v[40:43], a[96:99], v[128:131], 0
    s_add_u32 m0, s44, 73728
    ds_read_b64_tr_b16 a[64:65], v3 offset:0
    ds_read_b64_tr_b16 a[66:67], v3 offset:128
    v_mfma_f32_16x16x32_bf16 v[40:43], a[100:103], v[136:139], v[40:43]
    s_mov_b32 s45, 1024
    s_waitcnt lgkmcnt(10)
    buffer_load_dwordx4 v7, s[28:31], s45 offen offset:0 lds
    v_mfma_f32_16x16x32_bf16 v[40:43], a[104:107], v[144:147], v[40:43]
    s_add_u32 m0, s44, 73632
    ds_read_b64_tr_b16 a[68:69], v3 offset:256
    ds_read_b64_tr_b16 a[70:71], v3 offset:384
    v_mfma_f32_16x16x32_bf16 v[40:43], a[108:111], v[152:155], v[40:43]
    s_waitcnt lgkmcnt(8)
    buffer_load_dwordx4 v7, s[28:31], s45 offen offset:1152 lds
    v_mfma_f32_16x16x32_bf16 v[40:43], a[112:115], v[192:195], v[40:43]
    s_add_u32 m0, s44, 73536
    ds_read_b64_tr_b16 a[72:73], v3 offset:512
    ds_read_b64_tr_b16 a[74:75], v3 offset:640
    v_mfma_f32_16x16x32_bf16 v[40:43], a[116:119], v[200:203], v[40:43]
    s_waitcnt lgkmcnt(6)
    buffer_load_dwordx4 v7, s[28:31], s45 offen offset:2304 lds
    v_mfma_f32_16x16x32_bf16 v[40:43], a[120:123], v[208:211], v[40:43]
    s_add_u32 m0, s44, 73440
    ds_read_b64_tr_b16 a[76:77], v3 offset:768
    ds_read_b64_tr_b16 a[78:79], v3 offset:896
    v_mfma_f32_16x16x32_bf16 v[40:43], a[124:127], v[216:219], v[40:43]
    buffer_load_dwordx4 v7, s[28:31], s45 offen offset:3456 lds
    v_mfma_f32_16x16x32_bf16 v[44:47], a[96:99], v[160:163], 0
    s_add_u32 m0, s44, 90624
    ds_read_b64_tr_b16 a[80:81], v3 offset:16896
    ds_read_b64_tr_b16 a[82:83], v3 offset:17024
    v_mfma_f32_16x16x32_bf16 v[44:47], a[100:103], v[168:171], v[44:47]
    s_mov_b32 s45, 148480
    buffer_load_dwordx4 v7, s[28:31], s45 offen offset:0 lds
    v_mfma_f32_16x16x32_bf16 v[44:47], a[104:107], v[176:179], v[44:47]
    s_add_u32 m0, s44, 90528
    ds_read_b64_tr_b16 a[84:85], v3 offset:17152
    ds_read_b64_tr_b16 a[86:87], v3 offset:17280
    v_mfma_f32_16x16x32_bf16 v[44:47], a[108:111], v[184:187], v[44:47]
    buffer_load_dwordx4 v7, s[28:31], s45 offen offset:1152 lds
    v_mfma_f32_16x16x32_bf16 v[44:47], a[112:115], v[224:227], v[44:47]
    s_add_u32 m0, s44, 90432
    ds_read_b64_tr_b16 a[88:89], v3 offset:17408
    ds_read_b64_tr_b16 a[90:91], v3 offset:17536
    v_mfma_f32_16x16x32_bf16 v[44:47], a[116:119], v[232:235], v[44:47]
    buffer_load_dwordx4 v7, s[28:31], s45 offen offset:2304 lds
    v_mfma_f32_16x16x32_bf16 v[44:47], a[120:123], v[240:243], v[44:47]
    s_add_u32 m0, s44, 90336
    ds_read_b64_tr_b16 a[92:93], v3 offset:17664
    ds_read_b64_tr_b16 a[94:95], v3 offset:17792
    v_mfma_f32_16x16x32_bf16 v[44:47], a[124:127], v[248:251], v[44:47]
    s_waitcnt lgkmcnt(12)
    buffer_load_dwordx4 v7, s[28:31], s45 offen offset:3456 lds
    v_mfma_f32_16x16x32_bf16 v[16:19], a[64:67], v[128:131], 0
    ds_read_b64_tr_b16 a[96:97], v3 offset:32
    v_cvt_pk_bf16_f32 v48, v32, v33
    v_mfma_f32_16x16x32_bf16 v[16:19], a[68:71], v[136:139], v[16:19]
    s_waitcnt lgkmcnt(9)
    ds_read_b64_tr_b16 a[98:99], v3 offset:160
    v_cvt_pk_bf16_f32 v49, v34, v35
    v_mfma_f32_16x16x32_bf16 v[16:19], a[72:75], v[144:147], v[16:19]
    ds_read_b64_tr_b16 a[100:101], v3 offset:288
    v_cvt_pk_bf16_f32 v50, v40, v41
    v_mfma_f32_16x16x32_bf16 v[16:19], a[76:79], v[152:155], v[16:19]
    s_waitcnt lgkmcnt(7)
    ds_read_b64_tr_b16 a[102:103], v3 offset:416
    v_cvt_pk_bf16_f32 v51, v42, v43
    v_mfma_f32_16x16x32_bf16 v[16:19], a[80:83], v[192:195], v[16:19]
    s_mov_b32 s54, 5120
    ds_read_b64_tr_b16 a[104:105], v3 offset:544
    ds_read_b64_tr_b16 a[106:107], v3 offset:672
    v_mfma_f32_16x16x32_bf16 v[16:19], a[84:87], v[200:203], v[16:19]
    s_waitcnt lgkmcnt(6)
    v_permlane32_swap_b32 v48, v50
    v_mfma_f32_16x16x32_bf16 v[16:19], a[88:91], v[208:211], v[16:19]
    v_permlane32_swap_b32 v49, v51
    v_mfma_f32_16x16x32_bf16 v[16:19], a[92:95], v[216:219], v[16:19]
    ds_read_b64_tr_b16 a[108:109], v3 offset:800
    ds_read_b64_tr_b16 a[110:111], v3 offset:928
    buffer_store_dwordx4 v[48:51], v10, s[40:43], s54 offen offset:512 sc1
    v_mfma_f32_16x16x32_bf16 v[20:23], a[64:67], v[160:163], 0
    ds_read_b64_tr_b16 a[112:113], v3 offset:16928
    v_cvt_pk_bf16_f32 v52, v36, v37
    v_mfma_f32_16x16x32_bf16 v[20:23], a[68:71], v[168:171], v[20:23]
    ds_read_b64_tr_b16 a[114:115], v3 offset:17056
    v_cvt_pk_bf16_f32 v53, v38, v39
    v_mfma_f32_16x16x32_bf16 v[20:23], a[72:75], v[176:179], v[20:23]
    ds_read_b64_tr_b16 a[116:117], v3 offset:17184
    v_cvt_pk_bf16_f32 v54, v44, v45
    v_mfma_f32_16x16x32_bf16 v[20:23], a[76:79], v[184:187], v[20:23]
    ds_read_b64_tr_b16 a[118:119], v3 offset:17312
    v_cvt_pk_bf16_f32 v55, v46, v47
    v_mfma_f32_16x16x32_bf16 v[20:23], a[80:83], v[224:227], v[20:23]
    s_mov_b32 s54, 300032
    ds_read_b64_tr_b16 a[120:121], v3 offset:17440
    ds_read_b64_tr_b16 a[122:123], v3 offset:17568
    v_mfma_f32_16x16x32_bf16 v[20:23], a[84:87], v[232:235], v[20:23]
    v_permlane32_swap_b32 v52, v54
    v_mfma_f32_16x16x32_bf16 v[20:23], a[88:91], v[240:243], v[20:23]
    v_permlane32_swap_b32 v53, v55
    v_mfma_f32_16x16x32_bf16 v[20:23], a[92:95], v[248:251], v[20:23]
    s_waitcnt lgkmcnt(10)
    ds_read_b64_tr_b16 a[124:125], v3 offset:17696
    ds_read_b64_tr_b16 a[126:127], v3 offset:17824
    buffer_store_dwordx4 v[52:55], v10, s[40:43], s54 offen offset:512 sc1
    v_mfma_f32_16x16x32_bf16 v[24:27], a[96:99], v[128:131], 0
    ds_read_b64_tr_b16 a[64:65], v3 offset:64
    v_mfma_f32_16x16x32_bf16 v[24:27], a[100:103], v[136:139], v[24:27]
    s_waitcnt lgkmcnt(9)
    ds_read_b64_tr_b16 a[66:67], v3 offset:192
    v_mfma_f32_16x16x32_bf16 v[24:27], a[104:107], v[144:147], v[24:27]
    ds_read_b64_tr_b16 a[68:69], v3 offset:320
    v_mfma_f32_16x16x32_bf16 v[24:27], a[108:111], v[152:155], v[24:27]
    s_waitcnt lgkmcnt(7)
    ds_read_b64_tr_b16 a[70:71], v3 offset:448
    v_mfma_f32_16x16x32_bf16 v[24:27], a[112:115], v[192:195], v[24:27]
    ds_read_b64_tr_b16 a[72:73], v3 offset:576
    v_mfma_f32_16x16x32_bf16 v[24:27], a[116:119], v[200:203], v[24:27]
    s_waitcnt lgkmcnt(5)
    ds_read_b64_tr_b16 a[74:75], v3 offset:704
    v_mfma_f32_16x16x32_bf16 v[24:27], a[120:123], v[208:211], v[24:27]
    ds_read_b64_tr_b16 a[76:77], v3 offset:832
    v_mfma_f32_16x16x32_bf16 v[24:27], a[124:127], v[216:219], v[24:27]
    ds_read_b64_tr_b16 a[78:79], v3 offset:960
    v_mfma_f32_16x16x32_bf16 v[28:31], a[96:99], v[160:163], 0
    ds_read_b64_tr_b16 a[80:81], v3 offset:16960
    v_mfma_f32_16x16x32_bf16 v[28:31], a[100:103], v[168:171], v[28:31]
    ds_read_b64_tr_b16 a[82:83], v3 offset:17088
    v_mfma_f32_16x16x32_bf16 v[28:31], a[104:107], v[176:179], v[28:31]
    ds_read_b64_tr_b16 a[84:85], v3 offset:17216
    v_mfma_f32_16x16x32_bf16 v[28:31], a[108:111], v[184:187], v[28:31]
    ds_read_b64_tr_b16 a[86:87], v3 offset:17344
    v_mfma_f32_16x16x32_bf16 v[28:31], a[112:115], v[224:227], v[28:31]
    ds_read_b64_tr_b16 a[88:89], v3 offset:17472
    v_mfma_f32_16x16x32_bf16 v[28:31], a[116:119], v[232:235], v[28:31]
    ds_read_b64_tr_b16 a[90:91], v3 offset:17600
    v_mfma_f32_16x16x32_bf16 v[28:31], a[120:123], v[240:243], v[28:31]
    ds_read_b64_tr_b16 a[92:93], v3 offset:17728
    v_mfma_f32_16x16x32_bf16 v[28:31], a[124:127], v[248:251], v[28:31]
    s_waitcnt lgkmcnt(11)
    ds_read_b64_tr_b16 a[94:95], v3 offset:17856
    v_mfma_f32_16x16x32_bf16 v[32:35], a[64:67], v[128:131], 0
    ds_read_b64_tr_b16 a[96:97], v3 offset:96
    v_cvt_pk_bf16_f32 v48, v16, v17
    v_mfma_f32_16x16x32_bf16 v[32:35], a[68:71], v[136:139], v[32:35]
    s_waitcnt lgkmcnt(9)
    ds_read_b64_tr_b16 a[98:99], v3 offset:224
    v_cvt_pk_bf16_f32 v49, v18, v19
    v_mfma_f32_16x16x32_bf16 v[32:35], a[72:75], v[144:147], v[32:35]
    ds_read_b64_tr_b16 a[100:101], v3 offset:352
    v_cvt_pk_bf16_f32 v50, v24, v25
    v_mfma_f32_16x16x32_bf16 v[32:35], a[76:79], v[152:155], v[32:35]
    s_waitcnt lgkmcnt(7)
    ds_read_b64_tr_b16 a[102:103], v3 offset:480
    v_cvt_pk_bf16_f32 v51, v26, v27
    v_mfma_f32_16x16x32_bf16 v[32:35], a[80:83], v[192:195], v[32:35]
    s_mov_b32 s54, 6144
    ds_read_b64_tr_b16 a[104:105], v3 offset:608
    ds_read_b64_tr_b16 a[106:107], v3 offset:736
    v_mfma_f32_16x16x32_bf16 v[32:35], a[84:87], v[200:203], v[32:35]
    s_waitcnt lgkmcnt(6)
    v_permlane32_swap_b32 v48, v50
    v_mfma_f32_16x16x32_bf16 v[32:35], a[88:91], v[208:211], v[32:35]
    v_permlane32_swap_b32 v49, v51
    v_mfma_f32_16x16x32_bf16 v[32:35], a[92:95], v[216:219], v[32:35]
    ds_read_b64_tr_b16 a[108:109], v3 offset:864
    ds_read_b64_tr_b16 a[110:111], v3 offset:992
    buffer_store_dwordx4 v[48:51], v10, s[40:43], s54 offen offset:0 sc1
    v_mfma_f32_16x16x32_bf16 v[36:39], a[64:67], v[160:163], 0
    ds_read_b64_tr_b16 a[112:113], v3 offset:16992
    v_cvt_pk_bf16_f32 v52, v20, v21
    v_mfma_f32_16x16x32_bf16 v[36:39], a[68:71], v[168:171], v[36:39]
    ds_read_b64_tr_b16 a[114:115], v3 offset:17120
    v_cvt_pk_bf16_f32 v53, v22, v23
    v_mfma_f32_16x16x32_bf16 v[36:39], a[72:75], v[176:179], v[36:39]
    ds_read_b64_tr_b16 a[116:117], v3 offset:17248
    v_cvt_pk_bf16_f32 v54, v28, v29
    v_mfma_f32_16x16x32_bf16 v[36:39], a[76:79], v[184:187], v[36:39]
    ds_read_b64_tr_b16 a[118:119], v3 offset:17376
    v_cvt_pk_bf16_f32 v55, v30, v31
    v_mfma_f32_16x16x32_bf16 v[36:39], a[80:83], v[224:227], v[36:39]
    s_mov_b32 s54, 301056
    ds_read_b64_tr_b16 a[120:121], v3 offset:17504
    ds_read_b64_tr_b16 a[122:123], v3 offset:17632
    v_mfma_f32_16x16x32_bf16 v[36:39], a[84:87], v[232:235], v[36:39]
    v_permlane32_swap_b32 v52, v54
    v_mfma_f32_16x16x32_bf16 v[36:39], a[88:91], v[240:243], v[36:39]
    v_permlane32_swap_b32 v53, v55
    v_mfma_f32_16x16x32_bf16 v[36:39], a[92:95], v[248:251], v[36:39]
    s_waitcnt vmcnt(15)
    s_barrier
    s_waitcnt lgkmcnt(10)
    ds_read_b64_tr_b16 a[124:125], v3 offset:17760
    ds_read_b64_tr_b16 a[126:127], v3 offset:17888
    buffer_store_dwordx4 v[52:55], v10, s[40:43], s54 offen offset:0 sc1
    v_mfma_f32_16x16x32_bf16 v[40:43], a[96:99], v[128:131], 0
    ds_read_b64_tr_b16 a[64:65], v3 offset:36864
    v_mfma_f32_16x16x32_bf16 v[40:43], a[100:103], v[136:139], v[40:43]
    s_waitcnt lgkmcnt(9)
    ds_read_b64_tr_b16 a[66:67], v3 offset:36992
    v_mfma_f32_16x16x32_bf16 v[40:43], a[104:107], v[144:147], v[40:43]
    ds_read_b64_tr_b16 a[68:69], v3 offset:37120
    v_mfma_f32_16x16x32_bf16 v[40:43], a[108:111], v[152:155], v[40:43]
    s_waitcnt lgkmcnt(7)
    ds_read_b64_tr_b16 a[70:71], v3 offset:37248
    v_mfma_f32_16x16x32_bf16 v[40:43], a[112:115], v[192:195], v[40:43]
    ds_read_b64_tr_b16 a[72:73], v3 offset:37376
    v_mfma_f32_16x16x32_bf16 v[40:43], a[116:119], v[200:203], v[40:43]
    s_waitcnt lgkmcnt(5)
    ds_read_b64_tr_b16 a[74:75], v3 offset:37504
    v_mfma_f32_16x16x32_bf16 v[40:43], a[120:123], v[208:211], v[40:43]
    ds_read_b64_tr_b16 a[76:77], v3 offset:37632
    v_mfma_f32_16x16x32_bf16 v[40:43], a[124:127], v[216:219], v[40:43]
    ds_read_b64_tr_b16 a[78:79], v3 offset:37760
    v_mfma_f32_16x16x32_bf16 v[44:47], a[96:99], v[160:163], 0
    s_sub_u32 s28, s88, 4096
    s_subb_u32 s29, s89, 0
    ds_read_b64_tr_b16 a[80:81], v3 offset:53760
    v_mfma_f32_16x16x32_bf16 v[44:47], a[100:103], v[168:171], v[44:47]
    s_mov_b32 s30, 147456
    ds_read_b64_tr_b16 a[82:83], v3 offset:53888
    v_mfma_f32_16x16x32_bf16 v[44:47], a[104:107], v[176:179], v[44:47]
    ds_read_b64_tr_b16 a[84:85], v3 offset:54016
    v_mfma_f32_16x16x32_bf16 v[44:47], a[108:111], v[184:187], v[44:47]
    ds_read_b64_tr_b16 a[86:87], v3 offset:54144
    v_mfma_f32_16x16x32_bf16 v[44:47], a[112:115], v[224:227], v[44:47]
    ds_read_b64_tr_b16 a[88:89], v3 offset:54272
    v_mfma_f32_16x16x32_bf16 v[44:47], a[116:119], v[232:235], v[44:47]
    ds_read_b64_tr_b16 a[90:91], v3 offset:54400
    v_mfma_f32_16x16x32_bf16 v[44:47], a[120:123], v[240:243], v[44:47]
    ds_read_b64_tr_b16 a[92:93], v3 offset:54528
    v_mfma_f32_16x16x32_bf16 v[44:47], a[124:127], v[248:251], v[44:47]
    s_waitcnt lgkmcnt(11)
    ds_read_b64_tr_b16 a[94:95], v3 offset:54656
    v_mfma_f32_16x16x32_bf16 v[16:19], a[64:67], v[128:131], 0
    ds_read_b64_tr_b16 a[96:97], v3 offset:36896
    v_cvt_pk_bf16_f32 v48, v32, v33
    v_mfma_f32_16x16x32_bf16 v[16:19], a[68:71], v[136:139], v[16:19]
    s_waitcnt lgkmcnt(9)
    ds_read_b64_tr_b16 a[98:99], v3 offset:37024
    v_cvt_pk_bf16_f32 v49, v34, v35
    v_mfma_f32_16x16x32_bf16 v[16:19], a[72:75], v[144:147], v[16:19]
    ds_read_b64_tr_b16 a[100:101], v3 offset:37152
    v_cvt_pk_bf16_f32 v50, v40, v41
    v_mfma_f32_16x16x32_bf16 v[16:19], a[76:79], v[152:155], v[16:19]
    s_waitcnt lgkmcnt(7)
    ds_read_b64_tr_b16 a[102:103], v3 offset:37280
    v_cvt_pk_bf16_f32 v51, v42, v43
    v_mfma_f32_16x16x32_bf16 v[16:19], a[80:83], v[192:195], v[16:19]
    s_mov_b32 s54, 6144
    ds_read_b64_tr_b16 a[104:105], v3 offset:37408
    ds_read_b64_tr_b16 a[106:107], v3 offset:37536
    v_mfma_f32_16x16x32_bf16 v[16:19], a[84:87], v[200:203], v[16:19]
    s_waitcnt lgkmcnt(6)
    v_permlane32_swap_b32 v48, v50
    v_mfma_f32_16x16x32_bf16 v[16:19], a[88:91], v[208:211], v[16:19]
    v_permlane32_swap_b32 v49, v51
    v_mfma_f32_16x16x32_bf16 v[16:19], a[92:95], v[216:219], v[16:19]
    ds_read_b64_tr_b16 a[108:109], v3 offset:37664
    ds_read_b64_tr_b16 a[110:111], v3 offset:37792
    buffer_store_dwordx4 v[48:51], v10, s[40:43], s54 offen offset:512 sc1
    v_mfma_f32_16x16x32_bf16 v[20:23], a[64:67], v[160:163], 0
    ds_read_b64_tr_b16 a[112:113], v3 offset:53792
    v_cvt_pk_bf16_f32 v52, v36, v37
    v_mfma_f32_16x16x32_bf16 v[20:23], a[68:71], v[168:171], v[20:23]
    ds_read_b64_tr_b16 a[114:115], v3 offset:53920
    v_cvt_pk_bf16_f32 v53, v38, v39
    v_mfma_f32_16x16x32_bf16 v[20:23], a[72:75], v[176:179], v[20:23]
    ds_read_b64_tr_b16 a[116:117], v3 offset:54048
    v_cvt_pk_bf16_f32 v54, v44, v45
    v_mfma_f32_16x16x32_bf16 v[20:23], a[76:79], v[184:187], v[20:23]
    ds_read_b64_tr_b16 a[118:119], v3 offset:54176
    v_cvt_pk_bf16_f32 v55, v46, v47
    v_mfma_f32_16x16x32_bf16 v[20:23], a[80:83], v[224:227], v[20:23]
    s_mov_b32 s54, 301056
    ds_read_b64_tr_b16 a[120:121], v3 offset:54304
    ds_read_b64_tr_b16 a[122:123], v3 offset:54432
    v_mfma_f32_16x16x32_bf16 v[20:23], a[84:87], v[232:235], v[20:23]
    v_permlane32_swap_b32 v52, v54
    v_mfma_f32_16x16x32_bf16 v[20:23], a[88:91], v[240:243], v[20:23]
    v_permlane32_swap_b32 v53, v55
    v_mfma_f32_16x16x32_bf16 v[20:23], a[92:95], v[248:251], v[20:23]
    s_waitcnt lgkmcnt(10)
    ds_read_b64_tr_b16 a[124:125], v3 offset:54560
    ds_read_b64_tr_b16 a[126:127], v3 offset:54688
    buffer_store_dwordx4 v[52:55], v10, s[40:43], s54 offen offset:512 sc1
    v_mfma_f32_16x16x32_bf16 v[24:27], a[96:99], v[128:131], 0
    ds_read_b64_tr_b16 a[64:65], v3 offset:36928
    v_mfma_f32_16x16x32_bf16 v[24:27], a[100:103], v[136:139], v[24:27]
    s_waitcnt lgkmcnt(9)
    ds_read_b64_tr_b16 a[66:67], v3 offset:37056
    v_mfma_f32_16x16x32_bf16 v[24:27], a[104:107], v[144:147], v[24:27]
    ds_read_b64_tr_b16 a[68:69], v3 offset:37184
    v_mfma_f32_16x16x32_bf16 v[24:27], a[108:111], v[152:155], v[24:27]
    s_waitcnt lgkmcnt(7)
    ds_read_b64_tr_b16 a[70:71], v3 offset:37312
    v_mfma_f32_16x16x32_bf16 v[24:27], a[112:115], v[192:195], v[24:27]
    ds_read_b64_tr_b16 a[72:73], v3 offset:37440
    v_mfma_f32_16x16x32_bf16 v[24:27], a[116:119], v[200:203], v[24:27]
    s_waitcnt lgkmcnt(5)
    ds_read_b64_tr_b16 a[74:75], v3 offset:37568
    v_mfma_f32_16x16x32_bf16 v[24:27], a[120:123], v[208:211], v[24:27]
    ds_read_b64_tr_b16 a[76:77], v3 offset:37696
    v_mfma_f32_16x16x32_bf16 v[24:27], a[124:127], v[216:219], v[24:27]
    ds_read_b64_tr_b16 a[78:79], v3 offset:37824
    v_mfma_f32_16x16x32_bf16 v[28:31], a[96:99], v[160:163], 0
    ds_read_b64_tr_b16 a[80:81], v3 offset:53824
    v_mfma_f32_16x16x32_bf16 v[28:31], a[100:103], v[168:171], v[28:31]
    ds_read_b64_tr_b16 a[82:83], v3 offset:53952
    v_mfma_f32_16x16x32_bf16 v[28:31], a[104:107], v[176:179], v[28:31]
    ds_read_b64_tr_b16 a[84:85], v3 offset:54080
    v_mfma_f32_16x16x32_bf16 v[28:31], a[108:111], v[184:187], v[28:31]
    ds_read_b64_tr_b16 a[86:87], v3 offset:54208
    v_mfma_f32_16x16x32_bf16 v[28:31], a[112:115], v[224:227], v[28:31]
    ds_read_b64_tr_b16 a[88:89], v3 offset:54336
    v_mfma_f32_16x16x32_bf16 v[28:31], a[116:119], v[232:235], v[28:31]
    ds_read_b64_tr_b16 a[90:91], v3 offset:54464
    v_mfma_f32_16x16x32_bf16 v[28:31], a[120:123], v[240:243], v[28:31]
    ds_read_b64_tr_b16 a[92:93], v3 offset:54592
    v_mfma_f32_16x16x32_bf16 v[28:31], a[124:127], v[248:251], v[28:31]
    s_waitcnt lgkmcnt(11)
    ds_read_b64_tr_b16 a[94:95], v3 offset:54720
    v_mfma_f32_16x16x32_bf16 v[32:35], a[64:67], v[128:131], 0
    ds_read_b64_tr_b16 a[96:97], v3 offset:36960
    v_cvt_pk_bf16_f32 v48, v16, v17
    v_mfma_f32_16x16x32_bf16 v[32:35], a[68:71], v[136:139], v[32:35]
    s_waitcnt lgkmcnt(9)
    ds_read_b64_tr_b16 a[98:99], v3 offset:37088
    v_cvt_pk_bf16_f32 v49, v18, v19
    v_mfma_f32_16x16x32_bf16 v[32:35], a[72:75], v[144:147], v[32:35]
    ds_read_b64_tr_b16 a[100:101], v3 offset:37216
    v_cvt_pk_bf16_f32 v50, v24, v25
    v_mfma_f32_16x16x32_bf16 v[32:35], a[76:79], v[152:155], v[32:35]
    s_waitcnt lgkmcnt(7)
    ds_read_b64_tr_b16 a[102:103], v3 offset:37344
    v_cvt_pk_bf16_f32 v51, v26, v27
    v_mfma_f32_16x16x32_bf16 v[32:35], a[80:83], v[192:195], v[32:35]
    s_mov_b32 s54, 7168
    ds_read_b64_tr_b16 a[104:105], v3 offset:37472
    ds_read_b64_tr_b16 a[106:107], v3 offset:37600
    v_mfma_f32_16x16x32_bf16 v[32:35], a[84:87], v[200:203], v[32:35]
    s_waitcnt lgkmcnt(6)
    v_permlane32_swap_b32 v48, v50
    v_mfma_f32_16x16x32_bf16 v[32:35], a[88:91], v[208:211], v[32:35]
    v_permlane32_swap_b32 v49, v51
    v_mfma_f32_16x16x32_bf16 v[32:35], a[92:95], v[216:219], v[32:35]
    ds_read_b64_tr_b16 a[108:109], v3 offset:37728
    ds_read_b64_tr_b16 a[110:111], v3 offset:37856
    buffer_store_dwordx4 v[48:51], v10, s[40:43], s54 offen offset:0 sc1
    v_mfma_f32_16x16x32_bf16 v[36:39], a[64:67], v[160:163], 0
    ds_read_b64_tr_b16 a[112:113], v3 offset:53856
    v_cvt_pk_bf16_f32 v52, v20, v21
    v_mfma_f32_16x16x32_bf16 v[36:39], a[68:71], v[168:171], v[36:39]
    ds_read_b64_tr_b16 a[114:115], v3 offset:53984
    v_cvt_pk_bf16_f32 v53, v22, v23
    v_mfma_f32_16x16x32_bf16 v[36:39], a[72:75], v[176:179], v[36:39]
    ds_read_b64_tr_b16 a[116:117], v3 offset:54112
    v_cvt_pk_bf16_f32 v54, v28, v29
    v_mfma_f32_16x16x32_bf16 v[36:39], a[76:79], v[184:187], v[36:39]
    ds_read_b64_tr_b16 a[118:119], v3 offset:54240
    v_cvt_pk_bf16_f32 v55, v30, v31
    v_mfma_f32_16x16x32_bf16 v[36:39], a[80:83], v[224:227], v[36:39]
    s_mov_b32 s54, 302080
    ds_read_b64_tr_b16 a[120:121], v3 offset:54368
    ds_read_b64_tr_b16 a[122:123], v3 offset:54496
    v_mfma_f32_16x16x32_bf16 v[36:39], a[84:87], v[232:235], v[36:39]
    v_permlane32_swap_b32 v52, v54
    v_mfma_f32_16x16x32_bf16 v[36:39], a[88:91], v[240:243], v[36:39]
    v_permlane32_swap_b32 v53, v55
    v_mfma_f32_16x16x32_bf16 v[36:39], a[92:95], v[248:251], v[36:39]
    s_waitcnt vmcnt(7)
    s_barrier
    s_waitcnt lgkmcnt(10)
    ds_read_b64_tr_b16 a[124:125], v3 offset:54624
    ds_read_b64_tr_b16 a[126:127], v3 offset:54752
    buffer_store_dwordx4 v[52:55], v10, s[40:43], s54 offen offset:0 sc1
    v_mfma_f32_16x16x32_bf16 v[40:43], a[96:99], v[128:131], 0
    ds_read_b64_tr_b16 a[64:65], v4 offset:0
    v_mfma_f32_16x16x32_bf16 v[40:43], a[100:103], v[136:139], v[40:43]
    s_waitcnt lgkmcnt(9)
    ds_read_b64_tr_b16 a[66:67], v4 offset:128
    v_mfma_f32_16x16x32_bf16 v[40:43], a[104:107], v[144:147], v[40:43]
    ds_read_b64_tr_b16 a[68:69], v4 offset:256
    v_mfma_f32_16x16x32_bf16 v[40:43], a[108:111], v[152:155], v[40:43]
    s_waitcnt lgkmcnt(7)
    ds_read_b64_tr_b16 a[70:71], v4 offset:384
    v_mfma_f32_16x16x32_bf16 v[40:43], a[112:115], v[192:195], v[40:43]
    ds_read_b64_tr_b16 a[72:73], v4 offset:512
    v_mfma_f32_16x16x32_bf16 v[40:43], a[116:119], v[200:203], v[40:43]
    s_waitcnt lgkmcnt(5)
    ds_read_b64_tr_b16 a[74:75], v4 offset:640
    v_mfma_f32_16x16x32_bf16 v[40:43], a[120:123], v[208:211], v[40:43]
    ds_read_b64_tr_b16 a[76:77], v4 offset:768
    v_mfma_f32_16x16x32_bf16 v[40:43], a[124:127], v[216:219], v[40:43]
    ds_read_b64_tr_b16 a[78:79], v4 offset:896
    v_mfma_f32_16x16x32_bf16 v[44:47], a[96:99], v[160:163], 0
    ds_read_b64_tr_b16 a[80:81], v4 offset:16896
    v_mfma_f32_16x16x32_bf16 v[44:47], a[100:103], v[168:171], v[44:47]
    ds_read_b64_tr_b16 a[82:83], v4 offset:17024
    v_mfma_f32_16x16x32_bf16 v[44:47], a[104:107], v[176:179], v[44:47]
    ds_read_b64_tr_b16 a[84:85], v4 offset:17152
    v_mfma_f32_16x16x32_bf16 v[44:47], a[108:111], v[184:187], v[44:47]
    ds_read_b64_tr_b16 a[86:87], v4 offset:17280
    v_mfma_f32_16x16x32_bf16 v[44:47], a[112:115], v[224:227], v[44:47]
    ds_read_b64_tr_b16 a[88:89], v4 offset:17408
    v_mfma_f32_16x16x32_bf16 v[44:47], a[116:119], v[232:235], v[44:47]
    ds_read_b64_tr_b16 a[90:91], v4 offset:17536
    v_mfma_f32_16x16x32_bf16 v[44:47], a[120:123], v[240:243], v[44:47]
    ds_read_b64_tr_b16 a[92:93], v4 offset:17664
    v_mfma_f32_16x16x32_bf16 v[44:47], a[124:127], v[248:251], v[44:47]
    s_waitcnt lgkmcnt(11)
    ds_read_b64_tr_b16 a[94:95], v4 offset:17792
    v_mfma_f32_16x16x32_bf16 v[16:19], a[64:67], v[128:131], 0
    ds_read_b64_tr_b16 a[96:97], v4 offset:32
    v_cvt_pk_bf16_f32 v48, v32, v33
    v_mfma_f32_16x16x32_bf16 v[16:19], a[68:71], v[136:139], v[16:19]
    s_waitcnt lgkmcnt(9)
    ds_read_b64_tr_b16 a[98:99], v4 offset:160
    v_cvt_pk_bf16_f32 v49, v34, v35
    v_mfma_f32_16x16x32_bf16 v[16:19], a[72:75], v[144:147], v[16:19]
    ds_read_b64_tr_b16 a[100:101], v4 offset:288
    v_cvt_pk_bf16_f32 v50, v40, v41
    v_mfma_f32_16x16x32_bf16 v[16:19], a[76:79], v[152:155], v[16:19]
    s_waitcnt lgkmcnt(7)
    ds_read_b64_tr_b16 a[102:103], v4 offset:416
    v_cvt_pk_bf16_f32 v51, v42, v43
    v_mfma_f32_16x16x32_bf16 v[16:19], a[80:83], v[192:195], v[16:19]
    s_mov_b32 s54, 7168
    ds_read_b64_tr_b16 a[104:105], v4 offset:544
    ds_read_b64_tr_b16 a[106:107], v4 offset:672
    v_mfma_f32_16x16x32_bf16 v[16:19], a[84:87], v[200:203], v[16:19]
    s_waitcnt lgkmcnt(6)
    v_permlane32_swap_b32 v48, v50
    v_mfma_f32_16x16x32_bf16 v[16:19], a[88:91], v[208:211], v[16:19]
    v_permlane32_swap_b32 v49, v51
    v_mfma_f32_16x16x32_bf16 v[16:19], a[92:95], v[216:219], v[16:19]
    ds_read_b64_tr_b16 a[108:109], v4 offset:800
    ds_read_b64_tr_b16 a[110:111], v4 offset:928
    buffer_store_dwordx4 v[48:51], v10, s[40:43], s54 offen offset:512 sc1
    v_mfma_f32_16x16x32_bf16 v[20:23], a[64:67], v[160:163], 0
    ds_read_b64_tr_b16 a[112:113], v4 offset:16928
    v_cvt_pk_bf16_f32 v52, v36, v37
    v_mfma_f32_16x16x32_bf16 v[20:23], a[68:71], v[168:171], v[20:23]
    ds_read_b64_tr_b16 a[114:115], v4 offset:17056
    v_cvt_pk_bf16_f32 v53, v38, v39
    v_mfma_f32_16x16x32_bf16 v[20:23], a[72:75], v[176:179], v[20:23]
    ds_read_b64_tr_b16 a[116:117], v4 offset:17184
    v_cvt_pk_bf16_f32 v54, v44, v45
    v_mfma_f32_16x16x32_bf16 v[20:23], a[76:79], v[184:187], v[20:23]
    ds_read_b64_tr_b16 a[118:119], v4 offset:17312
    v_cvt_pk_bf16_f32 v55, v46, v47
    v_mfma_f32_16x16x32_bf16 v[20:23], a[80:83], v[224:227], v[20:23]
    s_mov_b32 s54, 302080
    ds_read_b64_tr_b16 a[120:121], v4 offset:17440
    ds_read_b64_tr_b16 a[122:123], v4 offset:17568
    v_mfma_f32_16x16x32_bf16 v[20:23], a[84:87], v[232:235], v[20:23]
    v_permlane32_swap_b32 v52, v54
    v_mfma_f32_16x16x32_bf16 v[20:23], a[88:91], v[240:243], v[20:23]
L2_pad13:
    s_cbranch_execz L2_walkret
    v_permlane32_swap_b32 v53, v55
    v_mfma_f32_16x16x32_bf16 v[20:23], a[92:95], v[248:251], v[20:23]
    s_waitcnt lgkmcnt(10)
    ds_read_b64_tr_b16 a[124:125], v4 offset:17696
    ds_read_b64_tr_b16 a[126:127], v4 offset:17824
    buffer_store_dwordx4 v[52:55], v10, s[40:43], s54 offen offset:512 sc1
    v_mfma_f32_16x16x32_bf16 v[24:27], a[96:99], v[128:131], 0
    ds_read_b64_tr_b16 a[64:65], v4 offset:64
    v_mfma_f32_16x16x32_bf16 v[24:27], a[100:103], v[136:139], v[24:27]
    s_waitcnt lgkmcnt(9)
    ds_read_b64_tr_b16 a[66:67], v4 offset:192
    v_mfma_f32_16x16x32_bf16 v[24:27], a[104:107], v[144:147], v[24:27]
    ds_read_b64_tr_b16 a[68:69], v4 offset:320
    v_mfma_f32_16x16x32_bf16 v[24:27], a[108:111], v[152:155], v[24:27]
    s_waitcnt lgkmcnt(7)
    ds_read_b64_tr_b16 a[70:71], v4 offset:448
    v_mfma_f32_16x16x32_bf16 v[24:27], a[112:115], v[192:195], v[24:27]
    ds_read_b64_tr_b16 a[72:73], v4 offset:576
    v_mfma_f32_16x16x32_bf16 v[24:27], a[116:119], v[200:203], v[24:27]
    s_waitcnt lgkmcnt(5)
    ds_read_b64_tr_b16 a[74:75], v4 offset:704
    v_mfma_f32_16x16x32_bf16 v[24:27], a[120:123], v[208:211], v[24:27]
    ds_read_b64_tr_b16 a[76:77], v4 offset:832
    v_mfma_f32_16x16x32_bf16 v[24:27], a[124:127], v[216:219], v[24:27]
    ds_read_b64_tr_b16 a[78:79], v4 offset:960
    v_mfma_f32_16x16x32_bf16 v[28:31], a[96:99], v[160:163], 0
    ds_read_b64_tr_b16 a[80:81], v4 offset:16960
    v_mfma_f32_16x16x32_bf16 v[28:31], a[100:103], v[168:171], v[28:31]
    ds_read_b64_tr_b16 a[82:83], v4 offset:17088
    v_mfma_f32_16x16x32_bf16 v[28:31], a[104:107], v[176:179], v[28:31]
    ds_read_b64_tr_b16 a[84:85], v4 offset:17216
    v_mfma_f32_16x16x32_bf16 v[28:31], a[108:111], v[184:187], v[28:31]
    ds_read_b64_tr_b16 a[86:87], v4 offset:17344
    v_mfma_f32_16x16x32_bf16 v[28:31], a[112:115], v[224:227], v[28:31]
    ds_read_b64_tr_b16 a[88:89], v4 offset:17472
    v_mfma_f32_16x16x32_bf16 v[28:31], a[116:119], v[232:235], v[28:31]
    ds_read_b64_tr_b16 a[90:91], v4 offset:17600
    v_mfma_f32_16x16x32_bf16 v[28:31], a[120:123], v[240:243], v[28:31]
    ds_read_b64_tr_b16 a[92:93], v4 offset:17728
    v_mfma_f32_16x16x32_bf16 v[28:31], a[124:127], v[248:251], v[28:31]
    s_waitcnt lgkmcnt(11)
    ds_read_b64_tr_b16 a[94:95], v4 offset:17856
    v_mfma_f32_16x16x32_bf16 v[32:35], a[64:67], v[128:131], 0
    ds_read_b64_tr_b16 a[96:97], v4 offset:96
    v_cvt_pk_bf16_f32 v48, v16, v17
    v_mfma_f32_16x16x32_bf16 v[32:35], a[68:71], v[136:139], v[32:35]
    s_waitcnt lgkmcnt(9)
    ds_read_b64_tr_b16 a[98:99], v4 offset:224
    v_cvt_pk_bf16_f32 v49, v18, v19
    v_mfma_f32_16x16x32_bf16 v[32:35], a[72:75], v[144:147], v[32:35]
    ds_read_b64_tr_b16 a[100:101], v4 offset:352
    v_cvt_pk_bf16_f32 v50, v24, v25
    v_mfma_f32_16x16x32_bf16 v[32:35], a[76:79], v[152:155], v[32:35]
    s_waitcnt lgkmcnt(7)
    ds_read_b64_tr_b16 a[102:103], v4 offset:480
    v_cvt_pk_bf16_f32 v51, v26, v27
    v_mfma_f32_16x16x32_bf16 v[32:35], a[80:83], v[192:195], v[32:35]
    s_mov_b32 s54, 8192
    ds_read_b64_tr_b16 a[104:105], v4 offset:608
    ds_read_b64_tr_b16 a[106:107], v4 offset:736
    v_mfma_f32_16x16x32_bf16 v[32:35], a[84:87], v[200:203], v[32:35]
    s_waitcnt lgkmcnt(6)
    v_permlane32_swap_b32 v48, v50
    v_mfma_f32_16x16x32_bf16 v[32:35], a[88:91], v[208:211], v[32:35]
    v_permlane32_swap_b32 v49, v51
    v_mfma_f32_16x16x32_bf16 v[32:35], a[92:95], v[216:219], v[32:35]
    ds_read_b64_tr_b16 a[108:109], v4 offset:864
    ds_read_b64_tr_b16 a[110:111], v4 offset:992
    buffer_store_dwordx4 v[48:51], v10, s[40:43], s54 offen offset:0 sc1
    v_mfma_f32_16x16x32_bf16 v[36:39], a[64:67], v[160:163], 0
    ds_read_b64_tr_b16 a[112:113], v4 offset:16992
    v_cvt_pk_bf16_f32 v52, v20, v21
    v_mfma_f32_16x16x32_bf16 v[36:39], a[68:71], v[168:171], v[36:39]
    ds_read_b64_tr_b16 a[114:115], v4 offset:17120
    v_cvt_pk_bf16_f32 v53, v22, v23
    v_mfma_f32_16x16x32_bf16 v[36:39], a[72:75], v[176:179], v[36:39]
    ds_read_b64_tr_b16 a[116:117], v4 offset:17248
    v_cvt_pk_bf16_f32 v54, v28, v29
    v_mfma_f32_16x16x32_bf16 v[36:39], a[76:79], v[184:187], v[36:39]
    ds_read_b64_tr_b16 a[118:119], v4 offset:17376
    v_cvt_pk_bf16_f32 v55, v30, v31
    v_mfma_f32_16x16x32_bf16 v[36:39], a[80:83], v[224:227], v[36:39]
    s_mov_b32 s54, 303104
    ds_read_b64_tr_b16 a[120:121], v4 offset:17504
    ds_read_b64_tr_b16 a[122:123], v4 offset:17632
    v_mfma_f32_16x16x32_bf16 v[36:39], a[84:87], v[232:235], v[36:39]
    v_permlane32_swap_b32 v52, v54
    v_mfma_f32_16x16x32_bf16 v[36:39], a[88:91], v[240:243], v[36:39]
    v_permlane32_swap_b32 v53, v55
    v_mfma_f32_16x16x32_bf16 v[36:39], a[92:95], v[248:251], v[36:39]
    s_waitcnt lgkmcnt(10)
    ds_read_b64_tr_b16 a[124:125], v4 offset:17760
    ds_read_b64_tr_b16 a[126:127], v4 offset:17888
    buffer_store_dwordx4 v[52:55], v10, s[40:43], s54 offen offset:0 sc1
    v_mfma_f32_16x16x32_bf16 v[40:43], a[96:99], v[128:131], 0
    v_mfma_f32_16x16x32_bf16 v[40:43], a[100:103], v[136:139], v[40:43]
    s_waitcnt lgkmcnt(8)
    v_mfma_f32_16x16x32_bf16 v[40:43], a[104:107], v[144:147], v[40:43]
    v_mfma_f32_16x16x32_bf16 v[40:43], a[108:111], v[152:155], v[40:43]
    s_waitcnt lgkmcnt(4)
    v_mfma_f32_16x16x32_bf16 v[40:43], a[112:115], v[192:195], v[40:43]
    v_mfma_f32_16x16x32_bf16 v[40:43], a[116:119], v[200:203], v[40:43]
    s_waitcnt lgkmcnt(0)
    v_mfma_f32_16x16x32_bf16 v[40:43], a[120:123], v[208:211], v[40:43]
    v_mfma_f32_16x16x32_bf16 v[40:43], a[124:127], v[216:219], v[40:43]
    v_mfma_f32_16x16x32_bf16 v[44:47], a[96:99], v[160:163], 0
    v_mfma_f32_16x16x32_bf16 v[44:47], a[100:103], v[168:171], v[44:47]
    v_mfma_f32_16x16x32_bf16 v[44:47], a[104:107], v[176:179], v[44:47]
    v_mfma_f32_16x16x32_bf16 v[44:47], a[108:111], v[184:187], v[44:47]
    v_mfma_f32_16x16x32_bf16 v[44:47], a[112:115], v[224:227], v[44:47]
    v_mfma_f32_16x16x32_bf16 v[44:47], a[116:119], v[232:235], v[44:47]
    v_mfma_f32_16x16x32_bf16 v[44:47], a[120:123], v[240:243], v[44:47]
    v_mfma_f32_16x16x32_bf16 v[44:47], a[124:127], v[248:251], v[44:47]
    s_nop 7
    v_cvt_pk_bf16_f32 v48, v32, v33
    v_cvt_pk_bf16_f32 v49, v34, v35
    v_cvt_pk_bf16_f32 v50, v40, v41
    v_cvt_pk_bf16_f32 v51, v42, v43
    s_nop 1
    v_permlane32_swap_b32 v48, v50
    v_permlane32_swap_b32 v49, v51
    s_mov_b32 s54, 8192
    buffer_store_dwordx4 v[48:51], v10, s[40:43], s54 offen offset:512 sc1
    v_cvt_pk_bf16_f32 v52, v36, v37
    v_cvt_pk_bf16_f32 v53, v38, v39
    v_cvt_pk_bf16_f32 v54, v44, v45
    v_cvt_pk_bf16_f32 v55, v46, v47
    s_nop 1
    v_permlane32_swap_b32 v52, v54
    v_permlane32_swap_b32 v53, v55
    s_mov_b32 s54, 303104
    buffer_store_dwordx4 v[52:55], v10, s[40:43], s54 offen offset:512 sc1
    buffer_load_dword v9, v6, s[84:87], s47 offen sc1
    s_movk_i32 s45, 4608
    buffer_load_dwordx4 v[76:79], v5, s[84:87], s45 offen sc1
    s_movk_i32 s45, 18432
    buffer_load_dwordx4 v[88:91], v5, s[84:87], s45 offen sc1
    s_movk_i32 s45, 8704
    buffer_load_dwordx4 v[80:83], v5, s[84:87], s45 offen sc1
    s_movk_i32 s45, 22528
    buffer_load_dwordx4 v[92:95], v5, s[84:87], s45 offen sc1
    s_movk_i32 s45, 12800
    buffer_load_dwordx4 v[84:87], v59, s[84:87], s45 offen sc1
    s_movk_i32 s45, 26624
    buffer_load_dwordx4 v[96:99], v59, s[84:87], s45 offen sc1
    buffer_load_dwordx4 v[224:227], v12, s[36:39], 0 offen offset:0
    buffer_load_dwordx4 v[232:235], v12, s[36:39], 0 offen offset:512
    buffer_load_dwordx4 v[240:243], v13, s[36:39], 0 offen offset:1024
    buffer_load_dwordx4 v[64:67], v1, s[76:79], 0 offen offset:0
    buffer_load_dwordx4 v[68:71], v1, s[76:79], 0 offen offset:512
    buffer_load_dwordx4 v[72:75], v2, s[76:79], 0 offen offset:0
    s_waitcnt vmcnt(13)
    buffer_store_dword v3, v15, s[84:87], s56 offen sc1
    s_movk_i32 s48, 0x1111
    v_lshrrev_b32 v15, 4, v0
    v_mul_u32_u24 v15, 9216, v15
    v_add_u32 v15, 4096, v15
    v_add_u32 v7, v59, v15
    s_waitcnt vmcnt(13)
    v_cmp_ne_u32 vcc, 0, v9
    s_nop 0
    s_lshr_b32 s3, vcc_lo, 1
    s_and_b32 s3, s3, vcc_lo
    s_lshr_b32 s14, s3, 2
    s_and_b32 s3, s3, s14
    s_and_b32 s3, s3, s48
    s_cbranch_scc0 L2_g0s
L2_g0r:
    s_ff1_i32_b32 s3, s3
    s_bitset0_b32 s48, s3
    s_mul_i32 s46, s3, 9216
    buffer_load_dwordx4 v[112:115], v7, s[88:91], s46 offen sc1
    buffer_load_dwordx4 v[116:119], v5, s[88:91], s46 offen sc1
    buffer_load_dwordx4 v[120:123], v5, s[28:31], s46 offen sc1
    s_add_u32 s46, s46, 9216
    buffer_load_dwordx4 v[124:127], v5, s[88:91], s46 offen sc1
    buffer_load_dwordx4 v[128:131], v5, s[28:31], s46 offen sc1
    s_add_u32 s46, s46, 9216
    buffer_load_dwordx4 v[132:135], v5, s[88:91], s46 offen sc1
    buffer_load_dwordx4 v[136:139], v5, s[28:31], s46 offen sc1
    s_add_u32 s46, s46, 9216
    buffer_load_dwordx4 v[140:143], v5, s[88:91], s46 offen sc1
    buffer_load_dwordx4 v[144:147], v5, s[28:31], s46 offen sc1
    v_cmp_ne_u32 vcc, 0, v9
    s_nop 0
    s_lshr_b32 s3, vcc_lo, 1
    s_and_b32 s3, s3, vcc_lo
    s_lshr_b32 s14, s3, 2
    s_and_b32 s3, s3, s14
    s_and_b32 s3, s3, s48
    s_cbranch_scc0 L2_g1s
L2_g1r:
    s_ff1_i32_b32 s3, s3
    s_bitset0_b32 s48, s3
    s_mul_i32 s46, s3, 9216
    buffer_load_dword v9, v6, s[84:87], s47 offen sc1
    buffer_load_dwordx4 v[148:151], v7, s[88:91], s46 offen sc1
    buffer_load_dwordx4 v[152:155], v5, s[88:91], s46 offen sc1
    buffer_load_dwordx4 v[156:159], v5, s[28:31], s46 offen sc1
    s_add_u32 s46, s46, 9216
    buffer_load_dwordx4 v[160:163], v5, s[88:91], s46 offen sc1
    buffer_load_dwordx4 v[164:167], v5, s[28:31], s46 offen sc1
    s_add_u32 s46, s46, 9216
    buffer_load_dwordx4 v[168:171], v5, s[88:91], s46 offen sc1
    buffer_load_dwordx4 v[172:175], v5, s[28:31], s46 offen sc1
    s_add_u32 s46, s46, 9216
    buffer_load_dwordx4 v[176:179], v5, s[88:91], s46 offen sc1
    buffer_load_dwordx4 v[180:183], v5, s[28:31], s46 offen sc1
    s_waitcnt vmcnt(20)
    v_mov_b32 v14, v13
    v_max_u32 v13, v76, v77
    v_max3_u32 v13, v13, v78, v79
    v_max3_u32 v13, v13, v88, v89
    v_max3_u32 v13, v13, v90, v91
    v_max3_u32 v13, v13, v80, v81
    v_max3_u32 v13, v13, v82, v83
    v_max3_u32 v13, v13, v92, v93
    v_max3_u32 v13, v13, v94, v95
    v_max3_u32 v13, v13, v84, v85
    v_max3_u32 v13, v13, v86, v87
    v_max3_u32 v13, v13, v96, v97
    v_max3_u32 v13, v13, v98, v99
    v_cmp_eq_u32 vcc, -1, v13
    s_nop 0
    s_cmp_lg_u64 vcc, 0
    s_cbranch_scc1 L2_pns
L2_pnr:
    v_pk_add_f32 v[76:77], v[76:77], v[88:89]
    v_pk_add_f32 v[78:79], v[78:79], v[90:91]
    ds_write_b128 v5, v[76:79] offset:0
    v_pk_add_f32 v[80:81], v[80:81], v[92:93]
    v_pk_add_f32 v[82:83], v[82:83], v[94:95]
    ds_write_b128 v5, v[80:83] offset:4096
    v_pk_add_f32 v[84:85], v[84:85], v[96:97]
    v_pk_add_f32 v[86:87], v[86:87], v[98:99]
    ds_write_b128 v59, v[84:87] offset:8192
    s_waitcnt lgkmcnt(0)
    s_barrier
    v_lshlrev_b32 v3, 1, v12
    v_lshlrev_b32 v4, 1, v14
    ds_read_b128 v[76:79], v3 offset:4608
    ds_read_b128 v[80:83], v3 offset:4624
    ds_read_b128 v[84:87], v3 offset:5632
    ds_read_b128 v[88:91], v3 offset:5648
    ds_read_b128 v[92:95], v4 offset:6656
    ds_read_b128 v[96:99], v4 offset:6672
    ds_read_b128 v[40:43], v3 offset:2304
    ds_read_b128 v[44:47], v3 offset:2320
    ds_read_b128 v[48:51], v3 offset:3328
    ds_read_b128 v[52:55], v3 offset:3344
    ds_read_b128 v[56:59], v4 offset:4352
    ds_read_b128 v[60:63], v4 offset:4368
    ds_write_b128 v106, a[20:23] offset:36864
    ds_write_b128 v106, a[24:27] offset:37888
    s_waitcnt lgkmcnt(2)
    v_lshlrev_b32 v12, 16, v224
    v_and_b32 v13, 0xffff0000, v224
    v_pk_mul_f32 v[76:77], v[76:77], v[12:13]
    v_pk_mul_f32 v[40:41], v[40:41], v[12:13]
    v_lshlrev_b32 v14, 16, v225
    v_and_b32 v15, 0xffff0000, v225
    v_pk_mul_f32 v[78:79], v[78:79], v[14:15]
    v_pk_mul_f32 v[42:43], v[42:43], v[14:15]
    v_lshlrev_b32 v12, 16, v226
    v_and_b32 v13, 0xffff0000, v226
    v_pk_mul_f32 v[80:81], v[80:81], v[12:13]
    v_pk_mul_f32 v[44:45], v[44:45], v[12:13]
    v_lshlrev_b32 v14, 16, v227
    v_and_b32 v15, 0xffff0000, v227
    v_pk_mul_f32 v[82:83], v[82:83], v[14:15]
    v_pk_mul_f32 v[46:47], v[46:47], v[14:15]
    v_lshlrev_b32 v12, 16, v232
    v_and_b32 v13, 0xffff0000, v232
    v_pk_mul_f32 v[84:85], v[84:85], v[12:13]
    v_pk_mul_f32 v[48:49], v[48:49], v[12:13]
    v_lshlrev_b32 v14, 16, v233
    v_and_b32 v15, 0xffff0000, v233
    v_pk_mul_f32 v[86:87], v[86:87], v[14:15]
    v_pk_mul_f32 v[50:51], v[50:51], v[14:15]
    ds_write_b128 v106, a[28:31] offset:38912
    ds_write_b128 v106, a[32:35] offset:39936
    v_lshlrev_b32 v12, 16, v234
    v_and_b32 v13, 0xffff0000, v234
    v_pk_mul_f32 v[88:89], v[88:89], v[12:13]
    v_pk_mul_f32 v[52:53], v[52:53], v[12:13]
    v_lshlrev_b32 v14, 16, v235
    v_and_b32 v15, 0xffff0000, v235
    v_pk_mul_f32 v[90:91], v[90:91], v[14:15]
    v_pk_mul_f32 v[54:55], v[54:55], v[14:15]
    v_lshlrev_b32 v12, 16, v240
    v_and_b32 v13, 0xffff0000, v240
    v_pk_mul_f32 v[92:93], v[92:93], v[12:13]
    v_pk_mul_f32 v[56:57], v[56:57], v[12:13]
    v_lshlrev_b32 v14, 16, v241
    v_and_b32 v15, 0xffff0000, v241
    v_pk_mul_f32 v[94:95], v[94:95], v[14:15]
    v_pk_mul_f32 v[58:59], v[58:59], v[14:15]
    v_lshlrev_b32 v12, 16, v242
    v_and_b32 v13, 0xffff0000, v242
    v_pk_mul_f32 v[96:97], v[96:97], v[12:13]
    v_pk_mul_f32 v[60:61], v[60:61], v[12:13]
    v_lshlrev_b32 v14, 16, v243
    v_and_b32 v15, 0xffff0000, v243
    v_pk_mul_f32 v[98:99], v[98:99], v[14:15]
    v_pk_mul_f32 v[62:63], v[62:63], v[14:15]
    ds_write_b128 v106, a[36:39] offset:40960
    ds_write_b128 v106, a[40:43] offset:41984
    v_pk_add_f32 v[12:13], v[76:77], v[78:79]
    v_pk_add_f32 v[12:13], v[12:13], v[80:81]
    v_pk_add_f32 v[12:13], v[12:13], v[82:83]
    v_pk_add_f32 v[12:13], v[12:13], v[84:85]
    v_pk_add_f32 v[12:13], v[12:13], v[86:87]
    v_pk_add_f32 v[12:13], v[12:13], v[88:89]
    v_pk_add_f32 v[12:13], v[12:13], v[90:91]
    v_pk_add_f32 v[14:15], v[92:93], v[94:95]
    v_pk_add_f32 v[14:15], v[14:15], v[96:97]
    v_pk_add_f32 v[14:15], v[14:15], v[98:99]
    v_add_f32 v100, v12, v13
    v_add_f32 v14, v14, v15
    v_fmac_f32 v100, 0x3e800000, v14
    v_pk_add_f32 v[12:13], v[40:41], v[42:43]
    v_pk_add_f32 v[12:13], v[12:13], v[44:45]
    v_pk_add_f32 v[12:13], v[12:13], v[46:47]
    v_pk_add_f32 v[12:13], v[12:13], v[48:49]
    v_pk_add_f32 v[12:13], v[12:13], v[50:51]
    v_pk_add_f32 v[12:13], v[12:13], v[52:53]
    v_pk_add_f32 v[12:13], v[12:13], v[54:55]
    v_pk_add_f32 v[14:15], v[56:57], v[58:59]
    v_pk_add_f32 v[14:15], v[14:15], v[60:61]
    v_pk_add_f32 v[14:15], v[14:15], v[62:63]
    v_add_f32 v101, v12, v13
    v_add_f32 v14, v14, v15
    v_fmac_f32 v101, 0x3e800000, v14
    ds_read_b128 v[40:43], v3 offset:0
    ds_read_b128 v[44:47], v3 offset:16
    ds_read_b128 v[48:51], v3 offset:1024
    ds_read_b128 v[52:55], v3 offset:1040
    ds_read_b128 v[56:59], v4 offset:2048
    ds_read_b128 v[60:63], v4 offset:2064
    ds_write_b128 v106, a[44:47] offset:43008
    ds_write_b128 v106, a[48:51] offset:44032
    s_nop 1
    v_add_f32_dpp v100, v100, v100 row_ror:8 row_mask:0xf bank_mask:0xf
    v_add_f32_dpp v101, v101, v101 row_ror:8 row_mask:0xf bank_mask:0xf
    v_mov_b32 v102, v100
    v_mov_b32 v103, v101
    s_nop 0
    v_permlane16_swap_b32 v102, v100
    v_permlane16_swap_b32 v103, v101
    v_add_f32 v100, v100, v102
    v_add_f32 v101, v101, v103
    v_mov_b32 v102, v100
    v_mov_b32 v103, v101
    s_nop 0
    v_permlane32_swap_b32 v102, v100
    v_permlane32_swap_b32 v103, v101
    v_add_f32 v100, v100, v102
    v_add_f32 v101, v101, v103
    v_and_b32 v14, 7, v0
    v_lshlrev_b32 v11, 4, v14
    v_add_u32 v11, 14080, v11
    s_lshl_b32 s3, s51, 2
    v_add_u32 v10, s3, v11
    ds_write_b32 v10, v100 offset:384
    ds_write_b32 v10, v101 offset:512
    v_lshl_add_u32 v1, v14, 4, v1
    v_lshl_add_u32 v2, v14, 4, v2
    v_add_u32 v1, 90112, v1
    v_add_u32 v2, 90112, v2
    s_and_b32 s14, s51, 1
    s_mul_i32 s14, s14, 9344
    s_add_u32 s14, s14, 90112
    v_add_u32 v107, s14, v8
    v_lshrrev_b32 v15, 3, v0
    v_mul_u32_u24 v12, 1024, v15
    v_add_u32 v109, v12, v8
    v_lshl_add_u32 v12, v15, 4, v12
    v_add_u32 v108, v12, v107
    s_mul_i32 s3, s96, 9216
    s_cmp_eq_u32 s51, 3
    s_cselect_b32 s3, 0, s3
    s_cselect_b64 s[24:25], s[32:33], s[80:81]
    s_add_u32 s24, s24, s3
    s_addc_u32 s25, s25, 0
    s_mov_b32 s26, 9216
    s_mov_b32 s27, 0x20000
    ds_write_b128 v106, a[52:55] offset:45056
    ds_write_b128 v105, a[128:131] offset:0
    s_waitcnt lgkmcnt(2)
    s_waitcnt vmcnt(18)
    ds_write_b128 v105, a[132:135] offset:1024
    ds_write_b128 v105, a[136:139] offset:2048
    v_lshlrev_b32 v32, 16, v112
    v_and_b32 v33, 0xffff0000, v112
    v_lshlrev_b32 v34, 16, v113
    v_and_b32 v35, 0xffff0000, v113
    v_lshlrev_b32 v36, 16, v114
    v_and_b32 v37, 0xffff0000, v114
    v_lshlrev_b32 v38, 16, v115
    v_and_b32 v39, 0xffff0000, v115
    s_waitcnt vmcnt(17)
    ds_write_b128 v105, a[140:143] offset:3072
    ds_write_b128 v105, a[144:147] offset:4096
    v_lshlrev_b32 v24, 16, v116
    v_and_b32 v25, 0xffff0000, v116
    v_lshlrev_b32 v26, 16, v117
    v_and_b32 v27, 0xffff0000, v117
    v_lshlrev_b32 v28, 16, v118
    v_and_b32 v29, 0xffff0000, v118
    v_lshlrev_b32 v30, 16, v119
    v_and_b32 v31, 0xffff0000, v119
    s_waitcnt vmcnt(16)
    v_lshlrev_b32 v16, 16, v120
    v_and_b32 v17, 0xffff0000, v120
    v_lshlrev_b32 v18, 16, v121
    v_and_b32 v19, 0xffff0000, v121
    v_lshlrev_b32 v20, 16, v122
    v_and_b32 v21, 0xffff0000, v122
    v_lshlrev_b32 v22, 16, v123
    v_and_b32 v23, 0xffff0000, v123
    s_waitcnt vmcnt(15)
    ds_write_b128 v105, a[148:151] offset:5120
    ds_write_b128 v105, a[152:155] offset:6144
    v_lshlrev_b32 v100, 16, v124
    v_and_b32 v101, 0xffff0000, v124
    v_pk_add_f32 v[24:25], v[24:25], v[100:101]
    v_lshlrev_b32 v102, 16, v125
    v_and_b32 v103, 0xffff0000, v125
    v_pk_add_f32 v[26:27], v[26:27], v[102:103]
    v_lshlrev_b32 v100, 16, v126
    v_and_b32 v101, 0xffff0000, v126
    v_pk_add_f32 v[28:29], v[28:29], v[100:101]
    v_lshlrev_b32 v102, 16, v127
    v_and_b32 v103, 0xffff0000, v127
    v_pk_add_f32 v[30:31], v[30:31], v[102:103]
    s_waitcnt vmcnt(14)
    v_lshlrev_b32 v100, 16, v128
    v_and_b32 v101, 0xffff0000, v128
    v_pk_add_f32 v[16:17], v[16:17], v[100:101]
    v_lshlrev_b32 v102, 16, v129
    v_and_b32 v103, 0xffff0000, v129
    v_pk_add_f32 v[18:19], v[18:19], v[102:103]
    v_lshlrev_b32 v100, 16, v130
    v_and_b32 v101, 0xffff0000, v130
    v_pk_add_f32 v[20:21], v[20:21], v[100:101]
    v_lshlrev_b32 v102, 16, v131
    v_and_b32 v103, 0xffff0000, v131
    v_pk_add_f32 v[22:23], v[22:23], v[102:103]
    s_waitcnt vmcnt(13)
    ds_write_b128 v105, a[156:159] offset:7168
    ds_write_b128 v105, a[160:163] offset:8192
    v_lshlrev_b32 v100, 16, v132
    v_and_b32 v101, 0xffff0000, v132
    v_pk_add_f32 v[24:25], v[24:25], v[100:101]
    v_lshlrev_b32 v102, 16, v133
    v_and_b32 v103, 0xffff0000, v133
    v_pk_add_f32 v[26:27], v[26:27], v[102:103]
    v_lshlrev_b32 v100, 16, v134
    v_and_b32 v101, 0xffff0000, v134
    v_pk_add_f32 v[28:29], v[28:29], v[100:101]
    v_lshlrev_b32 v102, 16, v135
    v_and_b32 v103, 0xffff0000, v135
    v_pk_add_f32 v[30:31], v[30:31], v[102:103]
    s_waitcnt vmcnt(12)
    v_lshlrev_b32 v100, 16, v136
    v_and_b32 v101, 0xffff0000, v136
    v_pk_add_f32 v[16:17], v[16:17], v[100:101]
    v_lshlrev_b32 v102, 16, v137
    v_and_b32 v103, 0xffff0000, v137
    v_pk_add_f32 v[18:19], v[18:19], v[102:103]
    v_lshlrev_b32 v100, 16, v138
    v_and_b32 v101, 0xffff0000, v138
    v_pk_add_f32 v[20:21], v[20:21], v[100:101]
    v_lshlrev_b32 v102, 16, v139
    v_and_b32 v103, 0xffff0000, v139
    v_pk_add_f32 v[22:23], v[22:23], v[102:103]
    s_waitcnt vmcnt(11)
    ds_write_b128 v104, a[164:167] offset:36864
    ds_write_b128 v104, a[168:171] offset:37888
    v_lshlrev_b32 v100, 16, v140
    v_and_b32 v101, 0xffff0000, v140
    v_pk_add_f32 v[24:25], v[24:25], v[100:101]
    v_lshlrev_b32 v102, 16, v141
    v_and_b32 v103, 0xffff0000, v141
    v_pk_add_f32 v[26:27], v[26:27], v[102:103]
    v_lshlrev_b32 v100, 16, v142
    v_and_b32 v101, 0xffff0000, v142
    v_pk_add_f32 v[28:29], v[28:29], v[100:101]
    v_lshlrev_b32 v102, 16, v143
    v_and_b32 v103, 0xffff0000, v143
    v_pk_add_f32 v[30:31], v[30:31], v[102:103]
    s_waitcnt vmcnt(10)
    v_lshlrev_b32 v100, 16, v144
    v_and_b32 v101, 0xffff0000, v144
    v_pk_add_f32 v[16:17], v[16:17], v[100:101]
    v_lshlrev_b32 v102, 16, v145
    v_and_b32 v103, 0xffff0000, v145
    v_pk_add_f32 v[18:19], v[18:19], v[102:103]
    v_lshlrev_b32 v100, 16, v146
    v_and_b32 v101, 0xffff0000, v146
    v_pk_add_f32 v[20:21], v[20:21], v[100:101]
    v_lshlrev_b32 v102, 16, v147
    v_and_b32 v103, 0xffff0000, v147
    v_pk_add_f32 v[22:23], v[22:23], v[102:103]
    s_waitcnt vmcnt(8)
    ds_write_b128 v104, a[172:175] offset:38912
    ds_write_b128 v104, a[176:179] offset:39936
    v_lshlrev_b32 v100, 16, v148
    v_and_b32 v101, 0xffff0000, v148
    v_pk_add_f32 v[32:33], v[32:33], v[100:101]
    v_lshlrev_b32 v102, 16, v149
    v_and_b32 v103, 0xffff0000, v149
    v_pk_add_f32 v[34:35], v[34:35], v[102:103]
    v_lshlrev_b32 v100, 16, v150
    v_and_b32 v101, 0xffff0000, v150
    v_pk_add_f32 v[36:37], v[36:37], v[100:101]
    v_lshlrev_b32 v102, 16, v151
    v_and_b32 v103, 0xffff0000, v151
    v_pk_add_f32 v[38:39], v[38:39], v[102:103]
    s_waitcnt vmcnt(7)
    ds_write_b128 v104, a[180:183] offset:40960
    ds_write_b128 v104, a[184:187] offset:41984
    v_lshlrev_b32 v100, 16, v152
    v_and_b32 v101, 0xffff0000, v152
    v_pk_add_f32 v[24:25], v[24:25], v[100:101]
    v_lshlrev_b32 v102, 16, v153
    v_and_b32 v103, 0xffff0000, v153
    v_pk_add_f32 v[26:27], v[26:27], v[102:103]
    v_lshlrev_b32 v100, 16, v154
    v_and_b32 v101, 0xffff0000, v154
    v_pk_add_f32 v[28:29], v[28:29], v[100:101]
    v_lshlrev_b32 v102, 16, v155
    v_and_b32 v103, 0xffff0000, v155
    v_pk_add_f32 v[30:31], v[30:31], v[102:103]
    s_waitcnt vmcnt(6)
    v_lshlrev_b32 v100, 16, v156
    v_and_b32 v101, 0xffff0000, v156
    v_pk_add_f32 v[16:17], v[16:17], v[100:101]
    v_lshlrev_b32 v102, 16, v157
    v_and_b32 v103, 0xffff0000, v157
    v_pk_add_f32 v[18:19], v[18:19], v[102:103]
    v_lshlrev_b32 v100, 16, v158
    v_and_b32 v101, 0xffff0000, v158
    v_pk_add_f32 v[20:21], v[20:21], v[100:101]
    v_lshlrev_b32 v102, 16, v159
    v_and_b32 v103, 0xffff0000, v159
    v_pk_add_f32 v[22:23], v[22:23], v[102:103]
    s_waitcnt vmcnt(5)
    v_cmp_ne_u32 vcc, 0, v9
    s_nop 0
    s_lshr_b32 s3, vcc_lo, 1
    s_and_b32 s3, s3, vcc_lo
    s_lshr_b32 s14, s3, 2
    s_and_b32 s3, s3, s14
    s_and_b32 s3, s3, s48
    s_cbranch_scc0 L2_g2s
L2_g2r:
    s_ff1_i32_b32 s3, s3
    s_bitset0_b32 s48, s3
    s_mul_i32 s46, s3, 9216
    buffer_load_dword v9, v6, s[84:87], s47 offen sc1
    buffer_load_dwordx4 v[184:187], v7, s[88:91], s46 offen sc1
    ds_write_b128 v104, a[188:191] offset:43008
    ds_write_b128 v104, a[192:195] offset:44032
    v_lshlrev_b32 v100, 16, v160
    v_and_b32 v101, 0xffff0000, v160
    v_pk_add_f32 v[24:25], v[24:25], v[100:101]
    v_lshlrev_b32 v102, 16, v161
    v_and_b32 v103, 0xffff0000, v161
    v_pk_add_f32 v[26:27], v[26:27], v[102:103]
    v_lshlrev_b32 v100, 16, v162
    v_and_b32 v101, 0xffff0000, v162
    v_pk_add_f32 v[28:29], v[28:29], v[100:101]
    v_lshlrev_b32 v102, 16, v163
    v_and_b32 v103, 0xffff0000, v163
    v_pk_add_f32 v[30:31], v[30:31], v[102:103]
    s_waitcnt vmcnt(6)
    v_lshlrev_b32 v100, 16, v164
    v_and_b32 v101, 0xffff0000, v164
    v_pk_add_f32 v[16:17], v[16:17], v[100:101]
    v_lshlrev_b32 v102, 16, v165
    v_and_b32 v103, 0xffff0000, v165
    v_pk_add_f32 v[18:19], v[18:19], v[102:103]
    v_lshlrev_b32 v100, 16, v166
    v_and_b32 v101, 0xffff0000, v166
    v_pk_add_f32 v[20:21], v[20:21], v[100:101]
    v_lshlrev_b32 v102, 16, v167
    v_and_b32 v103, 0xffff0000, v167
    v_pk_add_f32 v[22:23], v[22:23], v[102:103]
    s_waitcnt vmcnt(5)
    buffer_load_dwordx4 v[188:191], v5, s[88:91], s46 offen sc1
    buffer_load_dwordx4 v[192:195], v5, s[28:31], s46 offen sc1
    ds_write_b128 v104, a[196:199] offset:45056
    v_lshlrev_b32 v100, 16, v168
    v_and_b32 v101, 0xffff0000, v168
    v_pk_add_f32 v[24:25], v[24:25], v[100:101]
    v_lshlrev_b32 v102, 16, v169
    v_and_b32 v103, 0xffff0000, v169
    v_pk_add_f32 v[26:27], v[26:27], v[102:103]
    v_lshlrev_b32 v100, 16, v170
    v_and_b32 v101, 0xffff0000, v170
    v_pk_add_f32 v[28:29], v[28:29], v[100:101]
    v_lshlrev_b32 v102, 16, v171
    v_and_b32 v103, 0xffff0000, v171
    v_pk_add_f32 v[30:31], v[30:31], v[102:103]
    s_waitcnt vmcnt(6)
    v_lshlrev_b32 v100, 16, v172
    v_and_b32 v101, 0xffff0000, v172
    v_pk_add_f32 v[16:17], v[16:17], v[100:101]
    v_lshlrev_b32 v102, 16, v173
    v_and_b32 v103, 0xffff0000, v173
    v_pk_add_f32 v[18:19], v[18:19], v[102:103]
    v_lshlrev_b32 v100, 16, v174
    v_and_b32 v101, 0xffff0000, v174
    v_pk_add_f32 v[20:21], v[20:21], v[100:101]
    v_lshlrev_b32 v102, 16, v175
    v_and_b32 v103, 0xffff0000, v175
    v_pk_add_f32 v[22:23], v[22:23], v[102:103]
    s_waitcnt vmcnt(5)
    s_add_u32 s46, s46, 9216
    buffer_load_dwordx4 v[196:199], v5, s[88:91], s46 offen sc1
    buffer_load_dwordx4 v[200:203], v5, s[28:31], s46 offen sc1
    v_lshlrev_b32 v100, 16, v176
    v_and_b32 v101, 0xffff0000, v176
    v_pk_add_f32 v[24:25], v[24:25], v[100:101]
L2_pad14:
    s_cbranch_execz L2_walkret
    v_lshlrev_b32 v102, 16, v177
    v_and_b32 v103, 0xffff0000, v177
    v_pk_add_f32 v[26:27], v[26:27], v[102:103]
    v_lshlrev_b32 v100, 16, v178
    v_and_b32 v101, 0xffff0000, v178
    v_pk_add_f32 v[28:29], v[28:29], v[100:101]
    v_lshlrev_b32 v102, 16, v179
    v_and_b32 v103, 0xffff0000, v179
    v_pk_add_f32 v[30:31], v[30:31], v[102:103]
    s_waitcnt vmcnt(6)
    v_lshlrev_b32 v100, 16, v180
    v_and_b32 v101, 0xffff0000, v180
    v_pk_add_f32 v[16:17], v[16:17], v[100:101]
    v_lshlrev_b32 v102, 16, v181
    v_and_b32 v103, 0xffff0000, v181
    v_pk_add_f32 v[18:19], v[18:19], v[102:103]
    v_lshlrev_b32 v100, 16, v182
    v_and_b32 v101, 0xffff0000, v182
    v_pk_add_f32 v[20:21], v[20:21], v[100:101]
    v_lshlrev_b32 v102, 16, v183
    v_and_b32 v103, 0xffff0000, v183
    v_pk_add_f32 v[22:23], v[22:23], v[102:103]
    s_waitcnt vmcnt(4)
    s_add_u32 s46, s46, 9216
    buffer_load_dwordx4 v[204:207], v5, s[88:91], s46 offen sc1
    buffer_load_dwordx4 v[208:211], v5, s[28:31], s46 offen sc1
    v_lshlrev_b32 v100, 16, v184
    v_and_b32 v101, 0xffff0000, v184
    v_pk_add_f32 v[32:33], v[32:33], v[100:101]
    v_lshlrev_b32 v102, 16, v185
    v_and_b32 v103, 0xffff0000, v185
    v_pk_add_f32 v[34:35], v[34:35], v[102:103]
    v_lshlrev_b32 v100, 16, v186
    v_and_b32 v101, 0xffff0000, v186
    v_pk_add_f32 v[36:37], v[36:37], v[100:101]
    v_lshlrev_b32 v102, 16, v187
    v_and_b32 v103, 0xffff0000, v187
    v_pk_add_f32 v[38:39], v[38:39], v[102:103]
    ds_read_b128 v[112:115], v3 offset:4608
    ds_read_b128 v[116:119], v3 offset:4624
    ds_read_b128 v[120:123], v3 offset:5632
    ds_read_b128 v[124:127], v3 offset:5648
    ds_read_b128 v[128:131], v4 offset:6656
    ds_read_b128 v[132:135], v4 offset:6672
    ds_read_b128 v[136:139], v3 offset:2304
    ds_read_b128 v[140:143], v3 offset:2320
    ds_read_b128 v[144:147], v3 offset:3328
    ds_read_b128 v[148:151], v3 offset:3344
    ds_read_b128 v[152:155], v4 offset:4352
    ds_read_b128 v[156:159], v4 offset:4368
    ds_read_b128 v[160:163], v3 offset:6912
    ds_read_b128 v[164:167], v3 offset:6928
    ds_read_b128 v[168:171], v3 offset:7936
    ds_read_b128 v[172:175], v3 offset:7952
    ds_read_b128 v[176:179], v4 offset:8960
    ds_read_b128 v[180:183], v4 offset:8976
    s_waitcnt vmcnt(5)
    s_add_u32 s46, s46, 9216
    buffer_load_dwordx4 v[212:215], v5, s[88:91], s46 offen sc1
    buffer_load_dwordx4 v[216:219], v5, s[28:31], s46 offen sc1
    v_lshlrev_b32 v100, 16, v188
    v_and_b32 v101, 0xffff0000, v188
    v_pk_add_f32 v[24:25], v[24:25], v[100:101]
    v_lshlrev_b32 v102, 16, v189
    v_and_b32 v103, 0xffff0000, v189
    v_pk_add_f32 v[26:27], v[26:27], v[102:103]
    v_lshlrev_b32 v100, 16, v190
    v_and_b32 v101, 0xffff0000, v190
    v_pk_add_f32 v[28:29], v[28:29], v[100:101]
    v_lshlrev_b32 v102, 16, v191
    v_and_b32 v103, 0xffff0000, v191
    v_pk_add_f32 v[30:31], v[30:31], v[102:103]
    s_waitcnt vmcnt(6)
    v_lshlrev_b32 v100, 16, v192
    v_and_b32 v101, 0xffff0000, v192
    v_pk_add_f32 v[16:17], v[16:17], v[100:101]
    v_lshlrev_b32 v102, 16, v193
    v_and_b32 v103, 0xffff0000, v193
    v_pk_add_f32 v[18:19], v[18:19], v[102:103]
    v_lshlrev_b32 v100, 16, v194
    v_and_b32 v101, 0xffff0000, v194
    v_pk_add_f32 v[20:21], v[20:21], v[100:101]
    v_lshlrev_b32 v102, 16, v195
    v_and_b32 v103, 0xffff0000, v195
    v_pk_add_f32 v[22:23], v[22:23], v[102:103]
    s_waitcnt vmcnt(5)
    v_cmp_ne_u32 vcc, 0, v9
    s_nop 0
    s_lshr_b32 s3, vcc_lo, 1
    s_and_b32 s3, s3, vcc_lo
    s_lshr_b32 s14, s3, 2
    s_and_b32 s3, s3, s14
    s_and_b32 s3, s3, s48
    s_cbranch_scc0 L2_g3s
L2_g3r:
    s_ff1_i32_b32 s3, s3
    s_bitset0_b32 s48, s3
    s_mul_i32 s46, s3, 9216
    buffer_load_dwordx4 v[220:223], v7, s[88:91], s46 offen sc1
    v_lshlrev_b32 v100, 16, v196
    v_and_b32 v101, 0xffff0000, v196
    v_pk_add_f32 v[24:25], v[24:25], v[100:101]
    v_lshlrev_b32 v102, 16, v197
    v_and_b32 v103, 0xffff0000, v197
    v_pk_add_f32 v[26:27], v[26:27], v[102:103]
    v_lshlrev_b32 v100, 16, v198
    v_and_b32 v101, 0xffff0000, v198
    v_pk_add_f32 v[28:29], v[28:29], v[100:101]
    v_lshlrev_b32 v102, 16, v199
    v_and_b32 v103, 0xffff0000, v199
    v_pk_add_f32 v[30:31], v[30:31], v[102:103]
    s_waitcnt vmcnt(5)
    v_lshlrev_b32 v100, 16, v200
    v_and_b32 v101, 0xffff0000, v200
    v_pk_add_f32 v[16:17], v[16:17], v[100:101]
    v_lshlrev_b32 v102, 16, v201
    v_and_b32 v103, 0xffff0000, v201
    v_pk_add_f32 v[18:19], v[18:19], v[102:103]
    v_lshlrev_b32 v100, 16, v202
    v_and_b32 v101, 0xffff0000, v202
    v_pk_add_f32 v[20:21], v[20:21], v[100:101]
    v_lshlrev_b32 v102, 16, v203
    v_and_b32 v103, 0xffff0000, v203
    v_pk_add_f32 v[22:23], v[22:23], v[102:103]
    s_waitcnt vmcnt(4)
    buffer_load_dwordx4 v[224:227], v5, s[88:91], s46 offen sc1
    buffer_load_dwordx4 v[228:231], v5, s[28:31], s46 offen sc1
    v_lshlrev_b32 v100, 16, v204
    v_and_b32 v101, 0xffff0000, v204
    v_pk_add_f32 v[24:25], v[24:25], v[100:101]
    v_lshlrev_b32 v102, 16, v205
    v_and_b32 v103, 0xffff0000, v205
    v_pk_add_f32 v[26:27], v[26:27], v[102:103]
    v_lshlrev_b32 v100, 16, v206
    v_and_b32 v101, 0xffff0000, v206
    v_pk_add_f32 v[28:29], v[28:29], v[100:101]
    v_lshlrev_b32 v102, 16, v207
    v_and_b32 v103, 0xffff0000, v207
    v_pk_add_f32 v[30:31], v[30:31], v[102:103]
    s_waitcnt vmcnt(5)
    v_lshlrev_b32 v100, 16, v208
    v_and_b32 v101, 0xffff0000, v208
    v_pk_add_f32 v[16:17], v[16:17], v[100:101]
    v_lshlrev_b32 v102, 16, v209
    v_and_b32 v103, 0xffff0000, v209
    v_pk_add_f32 v[18:19], v[18:19], v[102:103]
    v_lshlrev_b32 v100, 16, v210
    v_and_b32 v101, 0xffff0000, v210
    v_pk_add_f32 v[20:21], v[20:21], v[100:101]
    v_lshlrev_b32 v102, 16, v211
    v_and_b32 v103, 0xffff0000, v211
    v_pk_add_f32 v[22:23], v[22:23], v[102:103]
    s_waitcnt vmcnt(4)
    s_add_u32 s46, s46, 9216
    buffer_load_dwordx4 v[232:235], v5, s[88:91], s46 offen sc1
    buffer_load_dwordx4 v[236:239], v5, s[28:31], s46 offen sc1
    v_lshlrev_b32 v100, 16, v212
    v_and_b32 v101, 0xffff0000, v212
    v_pk_add_f32 v[24:25], v[24:25], v[100:101]
    v_lshlrev_b32 v102, 16, v213
    v_and_b32 v103, 0xffff0000, v213
    v_pk_add_f32 v[26:27], v[26:27], v[102:103]
    v_lshlrev_b32 v100, 16, v214
    v_and_b32 v101, 0xffff0000, v214
    v_pk_add_f32 v[28:29], v[28:29], v[100:101]
    v_lshlrev_b32 v102, 16, v215
    v_and_b32 v103, 0xffff0000, v215
    v_pk_add_f32 v[30:31], v[30:31], v[102:103]
    s_waitcnt vmcnt(5)
    v_lshlrev_b32 v100, 16, v216
    v_and_b32 v101, 0xffff0000, v216
    v_pk_add_f32 v[16:17], v[16:17], v[100:101]
    v_lshlrev_b32 v102, 16, v217
    v_and_b32 v103, 0xffff0000, v217
    v_pk_add_f32 v[18:19], v[18:19], v[102:103]
    v_lshlrev_b32 v100, 16, v218
    v_and_b32 v101, 0xffff0000, v218
    v_pk_add_f32 v[20:21], v[20:21], v[100:101]
    v_lshlrev_b32 v102, 16, v219
    v_and_b32 v103, 0xffff0000, v219
    v_pk_add_f32 v[22:23], v[22:23], v[102:103]
    s_waitcnt vmcnt(4)
    s_add_u32 s46, s46, 9216
    buffer_load_dwordx4 v[240:243], v5, s[88:91], s46 offen sc1
    buffer_load_dwordx4 v[244:247], v5, s[28:31], s46 offen sc1
    v_lshlrev_b32 v100, 16, v220
    v_and_b32 v101, 0xffff0000, v220
    v_pk_add_f32 v[32:33], v[32:33], v[100:101]
    v_lshlrev_b32 v102, 16, v221
    v_and_b32 v103, 0xffff0000, v221
    v_pk_add_f32 v[34:35], v[34:35], v[102:103]
    v_lshlrev_b32 v100, 16, v222
    v_and_b32 v101, 0xffff0000, v222
    v_pk_add_f32 v[36:37], v[36:37], v[100:101]
    v_lshlrev_b32 v102, 16, v223
    v_and_b32 v103, 0xffff0000, v223
    v_pk_add_f32 v[38:39], v[38:39], v[102:103]
    s_lshl_b32 s3, s96, 3
    s_sub_u32 s3, 0xfff, s3
    v_and_b32 v6, 7, v0
    v_sub_u32 v6, s3, v6
    s_mov_b32 s57, 0xfffff000
    s_mul_i32 s58, s96, 128
    s_add_u32 s58, s58, 6815744
    s_xor_b32 s3, s51, 2
    v_or_b32 v9, s3, v0
    v_min_u32 v9, 1, v9
    v_lshlrev_b32 v9, 30, v9
    v_mov_b32 v208, v32
    v_mov_b32 v209, v33
    v_mov_b32 v210, v34
    v_mov_b32 v211, v35
    v_mov_b32 v212, v36
    v_mov_b32 v213, v37
    v_mov_b32 v214, v38
    v_mov_b32 v215, v39
    v_permlane16_swap_b32 v208, v32
    v_permlane16_swap_b32 v209, v33
    v_permlane16_swap_b32 v210, v34
    v_permlane16_swap_b32 v211, v35
    v_permlane16_swap_b32 v212, v36
    v_permlane16_swap_b32 v213, v37
    v_permlane16_swap_b32 v214, v38
    v_permlane16_swap_b32 v215, v39
    v_add_f32 v32, v32, v208
    v_add_f32 v33, v33, v209
    v_add_f32 v34, v34, v210
    v_add_f32 v35, v35, v211
    v_add_f32 v36, v36, v212
    v_add_f32 v37, v37, v213
    v_add_f32 v38, v38, v214
    v_add_f32 v39, v39, v215
    v_mov_b32 v208, v32
    v_mov_b32 v209, v33
    v_mov_b32 v210, v34
    v_mov_b32 v211, v35
    v_mov_b32 v212, v36
    v_mov_b32 v213, v37
    v_mov_b32 v214, v38
    v_mov_b32 v215, v39
    v_permlane32_swap_b32 v208, v32
    v_permlane32_swap_b32 v209, v33
    v_permlane32_swap_b32 v210, v34
    v_permlane32_swap_b32 v211, v35
    v_permlane32_swap_b32 v212, v36
    v_permlane32_swap_b32 v213, v37
    v_permlane32_swap_b32 v214, v38
    v_permlane32_swap_b32 v215, v39
    v_add_f32 v32, v32, v208
    v_add_f32 v33, v33, v209
    v_add_f32 v34, v34, v210
    v_add_f32 v35, v35, v211
    v_add_f32 v36, v36, v212
    v_add_f32 v37, v37, v213
    v_add_f32 v38, v38, v214
    v_add_f32 v39, v39, v215
    v_lshlrev_b32 v184, 16, v64
    v_and_b32 v185, 0xffff0000, v64
    v_lshlrev_b32 v186, 16, v65
    v_and_b32 v187, 0xffff0000, v65
    v_lshlrev_b32 v188, 16, v66
    v_and_b32 v189, 0xffff0000, v66
    v_lshlrev_b32 v190, 16, v67
    v_and_b32 v191, 0xffff0000, v67
    v_lshlrev_b32 v192, 16, v68
    v_and_b32 v193, 0xffff0000, v68
    v_lshlrev_b32 v194, 16, v69
    v_and_b32 v195, 0xffff0000, v69
    v_lshlrev_b32 v196, 16, v70
    v_and_b32 v197, 0xffff0000, v70
    v_lshlrev_b32 v198, 16, v71
    v_and_b32 v199, 0xffff0000, v71
    v_lshlrev_b32 v200, 16, v72
    v_and_b32 v201, 0xffff0000, v72
    v_lshlrev_b32 v202, 16, v73
    v_and_b32 v203, 0xffff0000, v73
    v_lshlrev_b32 v204, 16, v74
    v_and_b32 v205, 0xffff0000, v74
    v_lshlrev_b32 v206, 16, v75
    v_and_b32 v207, 0xffff0000, v75
    s_cmp_lt_u32 s2, 180
    s_cselect_b32 s3, 2, 0
    s_cmp_lt_u32 s51, s3
    s_cselect_b32 s3, 0, 0x40000000
    v_mul_u32_u24 v68, 128, v0
    v_or_b32 v68, s3, v68
    s_mul_i32 s15, s51, 16384
    s_add_u32 s15, s15, 6815744
    s_add_u32 s59, s15, 8192
    s_lshl_b32 s3, s51, 7
    s_sub_u32 s3, s96, s3
    v_cmp_eq_u32 s[60:61], s3, v0
    s_sub_u32 s3, s3, 64
    v_cmp_eq_u32 s[62:63], s3, v0
    s_waitcnt vmcnt(5)
    s_add_u32 s46, s46, 9216
    buffer_load_dwordx4 v[248:251], v5, s[88:91], s46 offen sc1
    buffer_load_dwordx4 v[252:255], v5, s[28:31], s46 offen sc1
    v_lshlrev_b32 v100, 16, v224
    v_and_b32 v101, 0xffff0000, v224
    v_pk_add_f32 v[24:25], v[24:25], v[100:101]
    v_lshlrev_b32 v102, 16, v225
    v_and_b32 v103, 0xffff0000, v225
    v_pk_add_f32 v[26:27], v[26:27], v[102:103]
    v_lshlrev_b32 v100, 16, v226
    v_and_b32 v101, 0xffff0000, v226
    v_pk_add_f32 v[28:29], v[28:29], v[100:101]
    v_lshlrev_b32 v102, 16, v227
    v_and_b32 v103, 0xffff0000, v227
    v_pk_add_f32 v[30:31], v[30:31], v[102:103]
    s_waitcnt vmcnt(6)
    v_lshlrev_b32 v100, 16, v228
    v_and_b32 v101, 0xffff0000, v228
    v_pk_add_f32 v[16:17], v[16:17], v[100:101]
    v_lshlrev_b32 v102, 16, v229
    v_and_b32 v103, 0xffff0000, v229
    v_pk_add_f32 v[18:19], v[18:19], v[102:103]
    v_lshlrev_b32 v100, 16, v230
    v_and_b32 v101, 0xffff0000, v230
    v_pk_add_f32 v[20:21], v[20:21], v[100:101]
    v_lshlrev_b32 v102, 16, v231
    v_and_b32 v103, 0xffff0000, v231
    v_pk_add_f32 v[22:23], v[22:23], v[102:103]
    s_waitcnt vmcnt(5)
    v_lshlrev_b32 v100, 16, v232
    v_and_b32 v101, 0xffff0000, v232
    v_pk_add_f32 v[24:25], v[24:25], v[100:101]
    v_lshlrev_b32 v102, 16, v233
    v_and_b32 v103, 0xffff0000, v233
    v_pk_add_f32 v[26:27], v[26:27], v[102:103]
    v_lshlrev_b32 v100, 16, v234
    v_and_b32 v101, 0xffff0000, v234
    v_pk_add_f32 v[28:29], v[28:29], v[100:101]
    v_lshlrev_b32 v102, 16, v235
    v_and_b32 v103, 0xffff0000, v235
    v_pk_add_f32 v[30:31], v[30:31], v[102:103]
    s_waitcnt vmcnt(4)
    v_lshlrev_b32 v100, 16, v236
    v_and_b32 v101, 0xffff0000, v236
    v_pk_add_f32 v[16:17], v[16:17], v[100:101]
    v_lshlrev_b32 v102, 16, v237
    v_and_b32 v103, 0xffff0000, v237
    v_pk_add_f32 v[18:19], v[18:19], v[102:103]
    v_lshlrev_b32 v100, 16, v238
    v_and_b32 v101, 0xffff0000, v238
    v_pk_add_f32 v[20:21], v[20:21], v[100:101]
    v_lshlrev_b32 v102, 16, v239
    v_and_b32 v103, 0xffff0000, v239
    v_pk_add_f32 v[22:23], v[22:23], v[102:103]
    s_waitcnt vmcnt(3)
    v_lshlrev_b32 v100, 16, v240
    v_and_b32 v101, 0xffff0000, v240
    v_pk_add_f32 v[24:25], v[24:25], v[100:101]
    v_lshlrev_b32 v102, 16, v241
    v_and_b32 v103, 0xffff0000, v241
    v_pk_add_f32 v[26:27], v[26:27], v[102:103]
    v_lshlrev_b32 v100, 16, v242
    v_and_b32 v101, 0xffff0000, v242
    v_pk_add_f32 v[28:29], v[28:29], v[100:101]
    v_lshlrev_b32 v102, 16, v243
    v_and_b32 v103, 0xffff0000, v243
    v_pk_add_f32 v[30:31], v[30:31], v[102:103]
    s_waitcnt vmcnt(2)
    v_lshlrev_b32 v100, 16, v244
    v_and_b32 v101, 0xffff0000, v244
    v_pk_add_f32 v[16:17], v[16:17], v[100:101]
    v_lshlrev_b32 v102, 16, v245
    v_and_b32 v103, 0xffff0000, v245
    v_pk_add_f32 v[18:19], v[18:19], v[102:103]
    v_lshlrev_b32 v100, 16, v246
    v_and_b32 v101, 0xffff0000, v246
    v_pk_add_f32 v[20:21], v[20:21], v[100:101]
    v_lshlrev_b32 v102, 16, v247
    v_and_b32 v103, 0xffff0000, v247
    v_pk_add_f32 v[22:23], v[22:23], v[102:103]
    s_waitcnt vmcnt(1)
    v_lshlrev_b32 v100, 16, v248
    v_and_b32 v101, 0xffff0000, v248
    v_pk_add_f32 v[24:25], v[24:25], v[100:101]
    v_lshlrev_b32 v102, 16, v249
    v_and_b32 v103, 0xffff0000, v249
    v_pk_add_f32 v[26:27], v[26:27], v[102:103]
    v_lshlrev_b32 v100, 16, v250
    v_and_b32 v101, 0xffff0000, v250
    v_pk_add_f32 v[28:29], v[28:29], v[100:101]
    v_lshlrev_b32 v102, 16, v251
    v_and_b32 v103, 0xffff0000, v251
    v_pk_add_f32 v[30:31], v[30:31], v[102:103]
    s_waitcnt vmcnt(0)
    v_lshlrev_b32 v100, 16, v252
    v_and_b32 v101, 0xffff0000, v252
    v_pk_add_f32 v[16:17], v[16:17], v[100:101]
    v_lshlrev_b32 v102, 16, v253
    v_and_b32 v103, 0xffff0000, v253
    v_pk_add_f32 v[18:19], v[18:19], v[102:103]
    v_lshlrev_b32 v100, 16, v254
    v_and_b32 v101, 0xffff0000, v254
    v_pk_add_f32 v[20:21], v[20:21], v[100:101]
    v_lshlrev_b32 v102, 16, v255
    v_and_b32 v103, 0xffff0000, v255
    v_pk_add_f32 v[22:23], v[22:23], v[102:103]
    v_pk_fma_f32 v[16:17], v[16:17], v[40:41], v[184:185]
    v_pk_fma_f32 v[18:19], v[18:19], v[42:43], v[186:187]
    v_pk_fma_f32 v[20:21], v[20:21], v[44:45], v[188:189]
    v_pk_fma_f32 v[22:23], v[22:23], v[46:47], v[190:191]
    v_pk_fma_f32 v[24:25], v[24:25], v[48:49], v[192:193]
    v_pk_fma_f32 v[26:27], v[26:27], v[50:51], v[194:195]
    v_pk_fma_f32 v[28:29], v[28:29], v[52:53], v[196:197]
    v_pk_fma_f32 v[30:31], v[30:31], v[54:55], v[198:199]
    v_pk_fma_f32 v[32:33], v[32:33], v[56:57], v[200:201]
    v_pk_fma_f32 v[34:35], v[34:35], v[58:59], v[202:203]
    v_pk_fma_f32 v[36:37], v[36:37], v[60:61], v[204:205]
    v_pk_fma_f32 v[38:39], v[38:39], v[62:63], v[206:207]
    v_pk_add_f32 v[12:13], v[16:17], v[18:19]
    v_pk_add_f32 v[12:13], v[12:13], v[20:21]
    v_pk_add_f32 v[12:13], v[12:13], v[22:23]
    v_pk_add_f32 v[12:13], v[12:13], v[24:25]
    v_pk_add_f32 v[12:13], v[12:13], v[26:27]
    v_pk_add_f32 v[12:13], v[12:13], v[28:29]
    v_pk_add_f32 v[12:13], v[12:13], v[30:31]
    v_pk_add_f32 v[14:15], v[32:33], v[34:35]
    v_pk_add_f32 v[14:15], v[14:15], v[36:37]
    v_pk_add_f32 v[14:15], v[14:15], v[38:39]
    v_add_f32 v100, v12, v13
    v_add_f32 v14, v14, v15
    v_fmac_f32 v100, 0x3e800000, v14
    s_nop 1
    v_add_f32_dpp v100, v100, v100 row_ror:8 row_mask:0xf bank_mask:0xf
    v_mov_b32 v103, v100
    s_nop 1
    v_permlane16_swap_b32 v103, v100
    v_add_f32 v100, v100, v103
    v_mov_b32 v103, v100
    s_nop 1
    v_permlane32_swap_b32 v103, v100
    v_add_f32 v100, v100, v103
    v_mul_f32 v100, 0x3be38e39, v100
    v_pk_add_f32 v[184:185], v[16:17], v[100:101] op_sel_hi:[1,0] neg_lo:[0,1] neg_hi:[0,1]
    v_pk_add_f32 v[186:187], v[18:19], v[100:101] op_sel_hi:[1,0] neg_lo:[0,1] neg_hi:[0,1]
    v_pk_add_f32 v[188:189], v[20:21], v[100:101] op_sel_hi:[1,0] neg_lo:[0,1] neg_hi:[0,1]
    v_pk_add_f32 v[190:191], v[22:23], v[100:101] op_sel_hi:[1,0] neg_lo:[0,1] neg_hi:[0,1]
    v_pk_add_f32 v[192:193], v[24:25], v[100:101] op_sel_hi:[1,0] neg_lo:[0,1] neg_hi:[0,1]
    v_pk_add_f32 v[194:195], v[26:27], v[100:101] op_sel_hi:[1,0] neg_lo:[0,1] neg_hi:[0,1]
    v_pk_add_f32 v[196:197], v[28:29], v[100:101] op_sel_hi:[1,0] neg_lo:[0,1] neg_hi:[0,1]
    v_pk_add_f32 v[198:199], v[30:31], v[100:101] op_sel_hi:[1,0] neg_lo:[0,1] neg_hi:[0,1]
    v_pk_add_f32 v[200:201], v[32:33], v[100:101] op_sel_hi:[1,0] neg_lo:[0,1] neg_hi:[0,1]
    v_pk_add_f32 v[202:203], v[34:35], v[100:101] op_sel_hi:[1,0] neg_lo:[0,1] neg_hi:[0,1]
    v_pk_add_f32 v[204:205], v[36:37], v[100:101] op_sel_hi:[1,0] neg_lo:[0,1] neg_hi:[0,1]
    v_pk_add_f32 v[206:207], v[38:39], v[100:101] op_sel_hi:[1,0] neg_lo:[0,1] neg_hi:[0,1]
    v_pk_mul_f32 v[12:13], v[184:185], v[184:185]
    v_pk_fma_f32 v[12:13], v[186:187], v[186:187], v[12:13]
    v_pk_fma_f32 v[12:13], v[188:189], v[188:189], v[12:13]
    v_pk_fma_f32 v[12:13], v[190:191], v[190:191], v[12:13]
    v_pk_fma_f32 v[12:13], v[192:193], v[192:193], v[12:13]
    v_pk_fma_f32 v[12:13], v[194:195], v[194:195], v[12:13]
    v_pk_fma_f32 v[12:13], v[196:197], v[196:197], v[12:13]
    v_pk_fma_f32 v[12:13], v[198:199], v[198:199], v[12:13]
    v_pk_mul_f32 v[14:15], v[200:201], v[200:201]
    v_pk_fma_f32 v[14:15], v[202:203], v[202:203], v[14:15]
    v_pk_fma_f32 v[14:15], v[204:205], v[204:205], v[14:15]
    v_pk_fma_f32 v[14:15], v[206:207], v[206:207], v[14:15]
    v_add_f32 v101, v12, v13
    v_add_f32 v14, v14, v15
    v_fmac_f32 v101, 0x3e800000, v14
    v_pk_mul_f32 v[12:13], v[184:185], v[76:77]
    v_pk_fma_f32 v[12:13], v[186:187], v[78:79], v[12:13]
    v_pk_fma_f32 v[12:13], v[188:189], v[80:81], v[12:13]
    v_pk_fma_f32 v[12:13], v[190:191], v[82:83], v[12:13]
    v_pk_fma_f32 v[12:13], v[192:193], v[84:85], v[12:13]
    v_pk_fma_f32 v[12:13], v[194:195], v[86:87], v[12:13]
    v_pk_fma_f32 v[12:13], v[196:197], v[88:89], v[12:13]
    v_pk_fma_f32 v[12:13], v[198:199], v[90:91], v[12:13]
    v_pk_mul_f32 v[14:15], v[200:201], v[92:93]
    v_pk_fma_f32 v[14:15], v[202:203], v[94:95], v[14:15]
    v_pk_fma_f32 v[14:15], v[204:205], v[96:97], v[14:15]
    v_pk_fma_f32 v[14:15], v[206:207], v[98:99], v[14:15]
    v_add_f32 v102, v12, v13
    v_add_f32 v14, v14, v15
    v_fmac_f32 v102, 0x3e800000, v14
    s_nop 1
    v_add_f32_dpp v101, v101, v101 row_ror:8 row_mask:0xf bank_mask:0xf
    v_add_f32_dpp v102, v102, v102 row_ror:8 row_mask:0xf bank_mask:0xf
    v_mov_b32 v103, v101
    v_mov_b32 v104, v102
    s_nop 0
    v_permlane16_swap_b32 v103, v101
    v_permlane16_swap_b32 v104, v102
    v_add_f32 v101, v101, v103
    v_add_f32 v102, v102, v104
    v_mov_b32 v103, v101
    v_mov_b32 v104, v102
    s_nop 0
    v_permlane32_swap_b32 v103, v101
    v_permlane32_swap_b32 v104, v102
    v_add_f32 v101, v101, v103
    v_add_f32 v102, v102, v104
    ds_write_b32 v10, v100 offset:0
    ds_write_b32 v10, v101 offset:128
    ds_write_b32 v10, v102 offset:256
    s_waitcnt lgkmcnt(0)
    s_barrier
    ds_read_b128 v[40:43], v11 offset:0
    ds_read_b128 v[44:47], v11 offset:128
    ds_read_b128 v[48:51], v11 offset:256
    ds_read_b128 v[52:55], v11 offset:384
    ds_read_b128 v[56:59], v11 offset:512
    s_waitcnt lgkmcnt(4)
    v_add_f32 v12, v40, v41
    v_add_f32 v13, v42, v43
    v_add_f32 v12, v12, v13
    v_mul_f32 v12, 0x3e800000, v12
    v_sub_f32 v40, v40, v12
    v_sub_f32 v41, v41, v12
    v_sub_f32 v42, v42, v12
    v_sub_f32 v43, v43, v12
    v_sub_f32 v100, v100, v12
    v_mul_f32 v13, v40, v40
    v_fmac_f32 v13, v41, v41
    v_fmac_f32 v13, v42, v42
    v_fmac_f32 v13, v43, v43
    s_waitcnt lgkmcnt(3)
    v_add_f32 v14, v44, v45
    v_add_f32 v15, v46, v47
    v_add_f32 v14, v14, v15
    v_fmac_f32 v14, 0x43100000, v13
    v_mov_b32 v13, 0x3727c5ac
    v_fmac_f32 v13, 0x3ae38e39, v14
    v_rsq_f32 v13, v13
    s_waitcnt lgkmcnt(0)
    v_pk_fma_f32 v[48:49], v[40:41], v[52:53], v[48:49]
    v_pk_fma_f32 v[50:51], v[42:43], v[54:55], v[50:51]
    v_pk_add_f32 v[48:49], v[48:49], v[50:51]
    v_pk_add_f32 v[56:57], v[56:57], v[58:59]
    v_add_f32 v14, v48, v49
    v_add_f32 v15, v56, v57
    v_fmac_f32 v15, v14, v13
    v_ashrrev_i32 v12, 31, v15
    v_or_b32 v12, 0x80000000, v12
    v_xor_b32 v12, v12, v15
    v_and_or_b32 v44, v12, s57, v6
    v_mov_b32 v45, 0
    s_nop 1
    v_mov_b32_dpp v14, v44 row_ror:1 row_mask:0xf bank_mask:0xf
    v_mov_b32_dpp v15, v45 row_ror:1 row_mask:0xf bank_mask:0xf
    v_max_u32 v45, v45, v15
    v_med3_u32 v45, v44, v14, v45
    v_max_u32 v44, v44, v14
    s_nop 1
    v_mov_b32_dpp v14, v44 row_ror:2 row_mask:0xf bank_mask:0xf
    v_mov_b32_dpp v15, v45 row_ror:2 row_mask:0xf bank_mask:0xf
    v_max_u32 v45, v45, v15
    v_med3_u32 v45, v44, v14, v45
    v_max_u32 v44, v44, v14
    s_nop 1
    v_mov_b32_dpp v14, v44 row_ror:4 row_mask:0xf bank_mask:0xf
    v_mov_b32_dpp v15, v45 row_ror:4 row_mask:0xf bank_mask:0xf
    v_max_u32 v45, v45, v15
    v_med3_u32 v45, v44, v14, v45
    v_max_u32 v44, v44, v14
    buffer_store_dwordx2 v[44:45], v9, s[84:87], s58 offen offset:8 sc1
    v_mul_f32 v100, v100, v13
    v_pk_fma_f32 v[184:185], v[184:185], v[12:13], v[100:101] op_sel:[0,1,0] op_sel_hi:[1,1,0]
    v_pk_fma_f32 v[186:187], v[186:187], v[12:13], v[100:101] op_sel:[0,1,0] op_sel_hi:[1,1,0]
    v_pk_fma_f32 v[188:189], v[188:189], v[12:13], v[100:101] op_sel:[0,1,0] op_sel_hi:[1,1,0]
    v_pk_fma_f32 v[190:191], v[190:191], v[12:13], v[100:101] op_sel:[0,1,0] op_sel_hi:[1,1,0]
    v_pk_fma_f32 v[192:193], v[192:193], v[12:13], v[100:101] op_sel:[0,1,0] op_sel_hi:[1,1,0]
    v_pk_fma_f32 v[194:195], v[194:195], v[12:13], v[100:101] op_sel:[0,1,0] op_sel_hi:[1,1,0]
    v_pk_fma_f32 v[196:197], v[196:197], v[12:13], v[100:101] op_sel:[0,1,0] op_sel_hi:[1,1,0]
    v_pk_fma_f32 v[198:199], v[198:199], v[12:13], v[100:101] op_sel:[0,1,0] op_sel_hi:[1,1,0]
    v_pk_fma_f32 v[200:201], v[200:201], v[12:13], v[100:101] op_sel:[0,1,0] op_sel_hi:[1,1,0]
    v_pk_fma_f32 v[202:203], v[202:203], v[12:13], v[100:101] op_sel:[0,1,0] op_sel_hi:[1,1,0]
    v_pk_fma_f32 v[204:205], v[204:205], v[12:13], v[100:101] op_sel:[0,1,0] op_sel_hi:[1,1,0]
    v_pk_fma_f32 v[206:207], v[206:207], v[12:13], v[100:101] op_sel:[0,1,0] op_sel_hi:[1,1,0]
    v_pk_fma_f32 v[184:185], v[184:185], v[112:113], v[136:137]
    v_pk_fma_f32 v[186:187], v[186:187], v[114:115], v[138:139]
    v_pk_fma_f32 v[188:189], v[188:189], v[116:117], v[140:141]
    v_pk_fma_f32 v[190:191], v[190:191], v[118:119], v[142:143]
    v_pk_fma_f32 v[192:193], v[192:193], v[120:121], v[144:145]
    v_pk_fma_f32 v[194:195], v[194:195], v[122:123], v[146:147]
    v_pk_fma_f32 v[196:197], v[196:197], v[124:125], v[148:149]
    v_pk_fma_f32 v[198:199], v[198:199], v[126:127], v[150:151]
    v_pk_fma_f32 v[200:201], v[200:201], v[128:129], v[152:153]
    v_pk_fma_f32 v[202:203], v[202:203], v[130:131], v[154:155]
    v_pk_fma_f32 v[204:205], v[204:205], v[132:133], v[156:157]
    v_pk_fma_f32 v[206:207], v[206:207], v[134:135], v[158:159]
    v_cvt_pk_bf16_f32 v124, v184, v185
    v_cvt_pk_bf16_f32 v125, v186, v187
    v_cvt_pk_bf16_f32 v126, v188, v189
    v_cvt_pk_bf16_f32 v127, v190, v191
    v_min_u32 v124, -2, v124
    v_min_u32 v125, -2, v125
    v_min_u32 v126, -2, v126
    v_min_u32 v127, -2, v127
    ds_write_b128 v1, v[124:127] offset:9344
    v_cvt_pk_bf16_f32 v128, v192, v193
    v_cvt_pk_bf16_f32 v129, v194, v195
    v_cvt_pk_bf16_f32 v130, v196, v197
    v_cvt_pk_bf16_f32 v131, v198, v199
    v_min_u32 v128, -2, v128
    v_min_u32 v129, -2, v129
    v_min_u32 v130, -2, v130
    v_min_u32 v131, -2, v131
    ds_write_b128 v1, v[128:131] offset:9856
    v_cvt_pk_bf16_f32 v132, v200, v201
    v_cvt_pk_bf16_f32 v133, v202, v203
    v_cvt_pk_bf16_f32 v134, v204, v205
    v_cvt_pk_bf16_f32 v135, v206, v207
    v_min_u32 v132, -2, v132
    v_min_u32 v133, -2, v133
    v_min_u32 v134, -2, v134
    v_min_u32 v135, -2, v135
    ds_write_b128 v2, v[132:135] offset:9344
    v_pk_fma_f32 v[16:17], v[184:185], v[160:161], v[16:17]
    v_pk_fma_f32 v[18:19], v[186:187], v[162:163], v[18:19]
    v_pk_fma_f32 v[20:21], v[188:189], v[164:165], v[20:21]
    v_pk_fma_f32 v[22:23], v[190:191], v[166:167], v[22:23]
    v_pk_fma_f32 v[24:25], v[192:193], v[168:169], v[24:25]
    v_pk_fma_f32 v[26:27], v[194:195], v[170:171], v[26:27]
    v_pk_fma_f32 v[28:29], v[196:197], v[172:173], v[28:29]
    v_pk_fma_f32 v[30:31], v[198:199], v[174:175], v[30:31]
    v_pk_fma_f32 v[32:33], v[200:201], v[176:177], v[32:33]
    v_pk_fma_f32 v[34:35], v[202:203], v[178:179], v[34:35]
    v_pk_fma_f32 v[36:37], v[204:205], v[180:181], v[36:37]
    v_pk_fma_f32 v[38:39], v[206:207], v[182:183], v[38:39]
    v_cvt_pk_bf16_f32 v112, v16, v17
    v_cvt_pk_bf16_f32 v113, v18, v19
    v_cvt_pk_bf16_f32 v114, v20, v21
    v_cvt_pk_bf16_f32 v115, v22, v23
    ds_write_b128 v1, v[112:115] offset:0
    v_cvt_pk_bf16_f32 v116, v24, v25
    v_cvt_pk_bf16_f32 v117, v26, v27
    v_cvt_pk_bf16_f32 v118, v28, v29
    v_cvt_pk_bf16_f32 v119, v30, v31
    ds_write_b128 v1, v[116:119] offset:512
    v_cvt_pk_bf16_f32 v120, v32, v33
    v_cvt_pk_bf16_f32 v121, v34, v35
    v_cvt_pk_bf16_f32 v122, v36, v37
    v_cvt_pk_bf16_f32 v123, v38, v39
    ds_write_b128 v2, v[120:123] offset:0
    v_lshrrev_b32 v7, 4, v0
    v_and_b32 v6, 1, v0
    v_bfe_u32 v5, v0, 2, 2
    v_lshlrev_b32 v5, 6, v5
    v_lshl_add_u32 v5, v7, 4, v5
L2_pad15:
    s_cbranch_execz L2_walkret
    v_mov_b32 v14, 15616
    s_movk_i32 s57, 1168
    s_waitcnt lgkmcnt(0)
    s_barrier
    s_cmp_lt_u32 s51, 2
    s_cbranch_scc1 L2_keys
    s_cmp_eq_u32 s51, 2
    s_cbranch_scc1 L2_rows
    v_not_b32 v12, v44
    v_not_b32 v13, v45
    v_and_b32 v12, 7, v12
    v_and_b32 v13, 7, v13
    v_cmp_gt_u32 vcc, 8, v0
    v_mul_u32_u24 v148, 1168, v12
    v_mul_u32_u24 v149, 1168, v13
    v_cndmask_b32 v15, v13, v12, vcc
    v_add_u32 v148, v148, v107
    v_add_u32 v149, v149, v107
    ds_read_b128 v[136:139], v148
    ds_read_b128 v[140:143], v149
    v_lshrrev_b32 v150, 3, v0
    v_sub_u32 v15, v15, v150
    v_mad_i32_i24 v150, v15, s57, v108
    ds_read_b128 v[144:147], v150 offset:1024
    s_movk_i32 s3, 1152
    v_mad_u32_u24 v12, v12, s3, v8
    v_mad_u32_u24 v13, v13, s3, v8
    v_mad_i32_i24 v15, v15, s3, v109
    s_waitcnt lgkmcnt(2)
    buffer_store_dwordx4 v[136:139], v12, s[24:27], 0 offen sc1
    s_waitcnt lgkmcnt(1)
    buffer_store_dwordx4 v[140:143], v13, s[24:27], 0 offen sc1
    s_mov_b64 exec, 0xffff
    s_waitcnt lgkmcnt(0)
    buffer_store_dwordx4 v[144:147], v15, s[24:27], 0 offen offset:1024 sc1
    s_mov_b64 exec, -1
    s_branch L2_rowsdone
L2_rows:
    ds_read_b128 v[136:139], v107 offset:0
    ds_read_b128 v[140:143], v107 offset:1168
    ds_read_b128 v[144:147], v107 offset:2336
    ds_read_b128 v[148:151], v107 offset:3504
    ds_read_b128 v[152:155], v107 offset:4672
    ds_read_b128 v[156:159], v107 offset:5840
    ds_read_b128 v[160:163], v107 offset:7008
    ds_read_b128 v[164:167], v107 offset:8176
    ds_read_b128 v[168:171], v108 offset:1024
    s_movk_i32 s3, 0
    s_waitcnt lgkmcnt(8)
    buffer_store_dwordx4 v[136:139], v8, s[24:27], s3 offen offset:0 sc1
    s_waitcnt lgkmcnt(7)
    buffer_store_dwordx4 v[140:143], v8, s[24:27], s3 offen offset:1152 sc1
    s_waitcnt lgkmcnt(6)
    buffer_store_dwordx4 v[144:147], v8, s[24:27], s3 offen offset:2304 sc1
    s_waitcnt lgkmcnt(5)
    buffer_store_dwordx4 v[148:151], v8, s[24:27], s3 offen offset:3456 sc1
    s_movk_i32 s3, 4608
    s_waitcnt lgkmcnt(4)
    buffer_store_dwordx4 v[152:155], v8, s[24:27], s3 offen offset:0 sc1
    s_waitcnt lgkmcnt(3)
    buffer_store_dwordx4 v[156:159], v8, s[24:27], s3 offen offset:1152 sc1
    s_waitcnt lgkmcnt(2)
    buffer_store_dwordx4 v[160:163], v8, s[24:27], s3 offen offset:2304 sc1
    s_waitcnt lgkmcnt(1)
    buffer_store_dwordx4 v[164:167], v8, s[24:27], s3 offen offset:3456 sc1
    s_waitcnt lgkmcnt(0)
    buffer_store_dwordx4 v[168:171], v109, s[24:27], 0 offen offset:1024 sc1
L2_rowsdone:
    ds_read_b64_tr_b16 a[64:65], v110 offset:0
    ds_read_b64_tr_b16 a[66:67], v110 offset:256
    ds_read_b64_tr_b16 a[68:69], v110 offset:2048
    ds_read_b64_tr_b16 a[70:71], v110 offset:2304
    ds_read_b64_tr_b16 a[72:73], v110 offset:4096
    ds_read_b64_tr_b16 a[74:75], v110 offset:4352
    ds_read_b64_tr_b16 a[76:77], v110 offset:6144
    ds_read_b64_tr_b16 a[78:79], v110 offset:6400
    ds_read_b64_tr_b16 a[80:81], v110 offset:8192
    ds_read_b64_tr_b16 a[82:83], v110 offset:8448
    ds_read_b64_tr_b16 a[84:85], v110 offset:10240
    ds_read_b64_tr_b16 a[86:87], v110 offset:10496
    ds_read_b64_tr_b16 a[88:89], v110 offset:12288
    ds_read_b64_tr_b16 a[90:91], v110 offset:12544
    ds_read_b64_tr_b16 a[92:93], v110 offset:14336
    ds_read_b64_tr_b16 a[94:95], v110 offset:14592
    ds_read_b64_tr_b16 a[96:97], v110 offset:16384
    ds_read_b64_tr_b16 a[98:99], v110 offset:16640
    ds_read_b64_tr_b16 a[100:101], v110 offset:18432
    ds_read_b64_tr_b16 a[102:103], v110 offset:18688
    ds_read_b64_tr_b16 a[104:105], v110 offset:20480
    ds_read_b64_tr_b16 a[106:107], v110 offset:20736
    ds_read_b64_tr_b16 a[108:109], v110 offset:22528
    ds_read_b64_tr_b16 a[110:111], v110 offset:22784
    ds_read_b64_tr_b16 a[112:113], v110 offset:24576
    ds_read_b64_tr_b16 a[114:115], v110 offset:24832
    ds_read_b64_tr_b16 a[116:117], v110 offset:26624
    ds_read_b64_tr_b16 a[118:119], v110 offset:26880
    ds_read_b64_tr_b16 a[120:121], v110 offset:28672
    ds_read_b64_tr_b16 a[122:123], v110 offset:28928
    ds_read_b64_tr_b16 a[124:125], v110 offset:30720
    ds_read_b64_tr_b16 a[126:127], v110 offset:30976
    ds_read_b64_tr_b16 a[128:129], v110 offset:32768
    ds_read_b64_tr_b16 a[130:131], v110 offset:33024
    ds_read_b64_tr_b16 a[132:133], v110 offset:34816
    ds_read_b64_tr_b16 a[134:135], v110 offset:35072
    ds_read_b64_tr_b16 a[136:137], v111 offset:0
    ds_read_b64_tr_b16 a[138:139], v111 offset:4608
    ds_read_b64_tr_b16 a[140:141], v111 offset:32
    ds_read_b64_tr_b16 a[142:143], v111 offset:4640
    ds_read_b64_tr_b16 a[144:145], v111 offset:64
    ds_read_b64_tr_b16 a[146:147], v111 offset:4672
    ds_read_b64_tr_b16 a[148:149], v111 offset:96
    ds_read_b64_tr_b16 a[150:151], v111 offset:4704
    ds_read_b64_tr_b16 a[152:153], v111 offset:128
    ds_read_b64_tr_b16 a[154:155], v111 offset:4736
    ds_read_b64_tr_b16 a[156:157], v111 offset:160
    ds_read_b64_tr_b16 a[158:159], v111 offset:4768
    ds_read_b64_tr_b16 a[160:161], v111 offset:192
    ds_read_b64_tr_b16 a[162:163], v111 offset:4800
    ds_read_b64_tr_b16 a[164:165], v111 offset:224
    ds_read_b64_tr_b16 a[166:167], v111 offset:4832
    ds_read_b64_tr_b16 a[168:169], v111 offset:256
    ds_read_b64_tr_b16 a[170:171], v111 offset:4864
    s_cmp_lt_u32 s2, 144
    s_cbranch_scc1 L2_join
    s_waitcnt vmcnt(0)
    buffer_store_dword v14, v9, s[84:87], s56 offen offset:128 sc1
    s_cmp_lt_u32 s2, 180
    s_cbranch_scc1 L2_join
    s_branch L2_fin
L2_keys:
    s_cmp_ge_u32 s2, 180
    s_cbranch_scc1 L2_fin
    buffer_load_dwordx2 v[64:65], v68, s[84:87], s15 offen offset:8 sc1
    buffer_load_dwordx2 v[66:67], v68, s[84:87], s59 offen offset:8 sc1
    ds_read_b64_tr_b16 a[64:65], v110 offset:0
    ds_read_b64_tr_b16 a[66:67], v110 offset:256
    ds_read_b64_tr_b16 a[68:69], v110 offset:2048
    ds_read_b64_tr_b16 a[70:71], v110 offset:2304
    ds_read_b64_tr_b16 a[72:73], v110 offset:4096
    ds_read_b64_tr_b16 a[74:75], v110 offset:4352
    ds_read_b64_tr_b16 a[76:77], v110 offset:6144
    ds_read_b64_tr_b16 a[78:79], v110 offset:6400
    ds_read_b64_tr_b16 a[80:81], v110 offset:8192
    ds_read_b64_tr_b16 a[82:83], v110 offset:8448
    ds_read_b64_tr_b16 a[84:85], v110 offset:10240
    ds_read_b64_tr_b16 a[86:87], v110 offset:10496
    ds_read_b64_tr_b16 a[88:89], v110 offset:12288
    ds_read_b64_tr_b16 a[90:91], v110 offset:12544
    ds_read_b64_tr_b16 a[92:93], v110 offset:14336
    ds_read_b64_tr_b16 a[94:95], v110 offset:14592
    ds_read_b64_tr_b16 a[96:97], v110 offset:16384
    ds_read_b64_tr_b16 a[98:99], v110 offset:16640
    ds_read_b64_tr_b16 a[100:101], v110 offset:18432
    ds_read_b64_tr_b16 a[102:103], v110 offset:18688
    ds_read_b64_tr_b16 a[104:105], v110 offset:20480
    ds_read_b64_tr_b16 a[106:107], v110 offset:20736
    ds_read_b64_tr_b16 a[108:109], v110 offset:22528
    ds_read_b64_tr_b16 a[110:111], v110 offset:22784
    ds_read_b64_tr_b16 a[112:113], v110 offset:24576
    ds_read_b64_tr_b16 a[114:115], v110 offset:24832
    ds_read_b64_tr_b16 a[116:117], v110 offset:26624
    ds_read_b64_tr_b16 a[118:119], v110 offset:26880
    ds_read_b64_tr_b16 a[120:121], v110 offset:28672
    ds_read_b64_tr_b16 a[122:123], v110 offset:28928
    ds_read_b64_tr_b16 a[124:125], v110 offset:30720
    ds_read_b64_tr_b16 a[126:127], v110 offset:30976
    ds_read_b64_tr_b16 a[128:129], v110 offset:32768
    ds_read_b64_tr_b16 a[130:131], v110 offset:33024
    ds_read_b64_tr_b16 a[132:133], v110 offset:34816
    ds_read_b64_tr_b16 a[134:135], v110 offset:35072
    ds_read_b64_tr_b16 a[136:137], v111 offset:0
    ds_read_b64_tr_b16 a[138:139], v111 offset:4608
    ds_read_b64_tr_b16 a[140:141], v111 offset:32
    ds_read_b64_tr_b16 a[142:143], v111 offset:4640
    ds_read_b64_tr_b16 a[144:145], v111 offset:64
    ds_read_b64_tr_b16 a[146:147], v111 offset:4672
    ds_read_b64_tr_b16 a[148:149], v111 offset:96
    ds_read_b64_tr_b16 a[150:151], v111 offset:4704
    ds_read_b64_tr_b16 a[152:153], v111 offset:128
    ds_read_b64_tr_b16 a[154:155], v111 offset:4736
    ds_read_b64_tr_b16 a[156:157], v111 offset:160
    ds_read_b64_tr_b16 a[158:159], v111 offset:4768
    ds_read_b64_tr_b16 a[160:161], v111 offset:192
    ds_read_b64_tr_b16 a[162:163], v111 offset:4800
    ds_read_b64_tr_b16 a[164:165], v111 offset:224
    ds_read_b64_tr_b16 a[166:167], v111 offset:4832
    ds_read_b64_tr_b16 a[168:169], v111 offset:256
    ds_read_b64_tr_b16 a[170:171], v111 offset:4864
    s_waitcnt vmcnt(0)
    v_cndmask_b32 v64, v64, v44, s[60:61]
    v_cndmask_b32 v65, v65, v45, s[60:61]
    v_cndmask_b32 v66, v66, v44, s[62:63]
    v_cndmask_b32 v67, v67, v45, s[62:63]
    v_min_u32 v12, v64, v65
    v_min_u32 v13, v66, v67
    v_cmp_eq_u32 s[4:5], 0, v12
    v_cmp_eq_u32 s[6:7], 0, v13
    s_nop 0
    s_or_b64 vcc, s[4:5], s[6:7]
    s_cbranch_scc0 L2_p2_ok
    s_mov_b32 s97, 0x20000
L2_p2:
    s_or_b64 exec, s[4:5], 1
    buffer_load_dwordx2 v[64:65], v68, s[84:87], s15 offen offset:8 sc1
    s_or_b64 exec, s[6:7], 1
    buffer_load_dwordx2 v[66:67], v68, s[84:87], s59 offen offset:8 sc1
    s_mov_b64 exec, -1
    s_waitcnt vmcnt(0)
    v_cndmask_b32 v64, v64, v44, s[60:61]
    v_cndmask_b32 v65, v65, v45, s[60:61]
    v_cndmask_b32 v66, v66, v44, s[62:63]
    v_cndmask_b32 v67, v67, v45, s[62:63]
    v_min_u32 v12, v64, v65
    v_min_u32 v13, v66, v67
    v_cmp_eq_u32 s[4:5], 0, v12
    v_cmp_eq_u32 s[6:7], 0, v13
    s_nop 0
    s_or_b64 vcc, s[4:5], s[6:7]
    s_sub_u32 s97, s97, 1
    s_cselect_b64 vcc, 0, vcc
    s_cmp_eq_u64 vcc, 0
    s_cbranch_scc1 L2_p2_ok
    s_sleep 1
    s_branch L2_p2
L2_p2_ok:
    v_max_u32 v65, v65, v67
    v_med3_u32 v65, v64, v66, v65
    v_max_u32 v64, v64, v66
    s_nop 1
    v_mov_b32_dpp v12, v64 row_ror:1 row_mask:0xf bank_mask:0xf
    v_mov_b32_dpp v13, v65 row_ror:1 row_mask:0xf bank_mask:0xf
    v_max_u32 v65, v65, v13
    v_med3_u32 v65, v64, v12, v65
    v_max_u32 v64, v64, v12
    s_nop 1
    v_mov_b32_dpp v12, v64 row_ror:2 row_mask:0xf bank_mask:0xf
    v_mov_b32_dpp v13, v65 row_ror:2 row_mask:0xf bank_mask:0xf
    v_max_u32 v65, v65, v13
    v_med3_u32 v65, v64, v12, v65
    v_max_u32 v64, v64, v12
    s_nop 1
    v_mov_b32_dpp v12, v64 row_ror:4 row_mask:0xf bank_mask:0xf
    v_mov_b32_dpp v13, v65 row_ror:4 row_mask:0xf bank_mask:0xf
    v_max_u32 v65, v65, v13
    v_med3_u32 v65, v64, v12, v65
    v_max_u32 v64, v64, v12
    s_nop 1
    v_mov_b32_dpp v12, v64 row_ror:8 row_mask:0xf bank_mask:0xf
    v_mov_b32_dpp v13, v65 row_ror:8 row_mask:0xf bank_mask:0xf
    v_max_u32 v65, v65, v13
    v_med3_u32 v65, v64, v12, v65
    v_max_u32 v64, v64, v12
    v_mov_b32 v12, v64
    v_mov_b32 v13, v65
    s_nop 0
    v_permlane16_swap_b32 v12, v64
    v_permlane16_swap_b32 v13, v65
    v_max_u32 v65, v65, v13
    v_med3_u32 v65, v64, v12, v65
    v_max_u32 v64, v64, v12
    v_mov_b32 v12, v64
    v_mov_b32 v13, v65
    s_nop 0
    v_permlane32_swap_b32 v12, v64
    v_permlane32_swap_b32 v13, v65
    v_max_u32 v65, v65, v13
    v_med3_u32 v65, v64, v12, v65
    v_max_u32 v64, v64, v12
    s_lshl3_add_u32 s3, s51, 15616
    v_mov_b32 v12, s3
    ds_write_b64 v12, v[64:65]
    s_waitcnt lgkmcnt(0)
L2_join:
    s_barrier
    ds_read_b128 v[16:19], v14
    v_cmp_eq_u32 vcc, 0, v6
    s_waitcnt lgkmcnt(0)
    v_max_u32 v17, v17, v19
    v_med3_u32 v17, v16, v18, v17
    v_max_u32 v16, v16, v18
    v_cndmask_b32 v16, v17, v16, vcc
    v_and_b32 v3, 0x7ff, v16
    v_sub_u32 v3, 2047, v3
    v_mul_u32_u24 v4, 1152, v3
    s_cmp_ge_u32 s2, 144
    s_cbranch_scc1 L2_red
    v_add_u32 v5, v5, v4
    s_mov_b32 s59, 4194304
    v_and_b32 v12, 8, v0
    v_lshlrev_b32 v12, 4, v12
    v_sub_u32 v3, v5, v12
    buffer_load_dwordx4 v[128:131], v5, s[84:87], s59 offen offset:0 sc1
    buffer_load_dwordx4 v[132:135], v5, s[84:87], s59 offen offset:256 sc1
    buffer_load_dwordx4 v[136:139], v5, s[84:87], s59 offen offset:512 sc1
    buffer_load_dwordx4 v[140:143], v5, s[84:87], s59 offen offset:768 sc1
    buffer_load_dwordx4 v[144:147], v3, s[84:87], s59 offen offset:1024 sc1
    v_lshlrev_b32 v11, 7, v6
    v_lshl_add_u32 v13, v7, 5, v11
    v_add_u32 v13, 14848, v13
    v_lshl_add_u32 v11, v7, 4, v11
    s_lshr_b32 s3, s51, 1
    s_lshl_b32 s3, s3, 8
    s_and_b32 s14, s51, 1
    s_lshl_b32 s14, s14, 6
    s_add_u32 s3, s3, s14
    s_add_u32 s3, s3, 14848
    v_add_u32 v11, s3, v11
    s_mul_i32 s14, s51, 1152
    s_mul_i32 s15, s2, 4608
    s_add_u32 s15, s15, s14
    s_add_u32 s15, s15, 98304
    v_lshlrev_b32 v10, 3, v0
    s_waitcnt vmcnt(0)
    buffer_store_dword v14, v9, s[84:87], s56 offen offset:128 sc1
L2_hr:
    v_mfma_f32_16x16x32_bf16 v[88:91], a[64:67], v[128:131], 0
    v_max_u32 v12, v128, v129
    v_mfma_f32_16x16x32_bf16 v[92:95], a[68:71], v[128:131], 0
    v_max3_u32 v12, v12, v130, v131
    v_mfma_f32_16x16x32_bf16 v[96:99], a[72:75], v[128:131], 0
    v_max3_u32 v12, v12, v132, v133
    v_mfma_f32_16x16x32_bf16 v[100:103], a[76:79], v[128:131], 0
    v_max3_u32 v12, v12, v134, v135
    v_mfma_f32_16x16x32_bf16 v[88:91], a[80:83], v[132:135], v[88:91]
    v_max3_u32 v12, v12, v136, v137
    v_mfma_f32_16x16x32_bf16 v[92:95], a[84:87], v[132:135], v[92:95]
    v_max3_u32 v12, v12, v138, v139
    v_mfma_f32_16x16x32_bf16 v[96:99], a[88:91], v[132:135], v[96:99]
    v_max3_u32 v12, v12, v140, v141
    v_mfma_f32_16x16x32_bf16 v[100:103], a[92:95], v[132:135], v[100:103]
    v_max3_u32 v12, v12, v142, v143
    v_mfma_f32_16x16x32_bf16 v[88:91], a[96:99], v[136:139], v[88:91]
    v_max3_u32 v12, v12, v144, v145
    v_mfma_f32_16x16x32_bf16 v[92:95], a[100:103], v[136:139], v[92:95]
    v_max3_u32 v12, v12, v146, v147
    v_mfma_f32_16x16x32_bf16 v[96:99], a[104:107], v[136:139], v[96:99]
    v_cmp_eq_u32 vcc, -1, v12
    v_mfma_f32_16x16x32_bf16 v[100:103], a[108:111], v[136:139], v[100:103]
    v_mfma_f32_16x16x32_bf16 v[96:99], a[120:123], v[140:143], v[96:99]
    v_mfma_f32_16x16x32_bf16 v[100:103], a[124:127], v[140:143], v[100:103]
    v_mfma_f32_16x16x32_bf16 v[88:91], a[112:115], v[140:143], v[88:91]
    v_mfma_f32_16x16x32_bf16 v[92:95], a[116:119], v[140:143], v[92:95]
    v_mfma_f32_16x16x32_bf16 v[92:95], a[132:135], v[144:147], v[92:95]
    v_mfma_f32_16x16x32_bf16 v[88:91], a[128:131], v[144:147], v[88:91]
    s_cmp_lg_u64 vcc, 0
    s_cbranch_scc1 L2_hs
    s_nop 1
    v_add_f32_dpp v96, v100, v96 row_shl:4 row_mask:0xf bank_mask:0xf bound_ctrl:1
    v_add_f32_dpp v97, v101, v97 row_shl:4 row_mask:0xf bank_mask:0xf bound_ctrl:1
    v_add_f32_dpp v98, v102, v98 row_shl:4 row_mask:0xf bank_mask:0xf bound_ctrl:1
    v_add_f32_dpp v99, v103, v99 row_shl:4 row_mask:0xf bank_mask:0xf bound_ctrl:1
    v_add_f32_dpp v88, v92, v88 row_shl:4 row_mask:0xf bank_mask:0xf bound_ctrl:1
    v_add_f32_dpp v89, v93, v89 row_shl:4 row_mask:0xf bank_mask:0xf bound_ctrl:1
    v_add_f32_dpp v90, v94, v90 row_shl:4 row_mask:0xf bank_mask:0xf bound_ctrl:1
    v_add_f32_dpp v91, v95, v91 row_shl:4 row_mask:0xf bank_mask:0xf bound_ctrl:1
    v_add_f32_dpp v88, v96, v88 row_shl:8 row_mask:0xf bank_mask:0xf bound_ctrl:1
    v_add_f32_dpp v89, v97, v89 row_shl:8 row_mask:0xf bank_mask:0xf bound_ctrl:1
    v_add_f32_dpp v90, v98, v90 row_shl:8 row_mask:0xf bank_mask:0xf bound_ctrl:1
    v_add_f32_dpp v91, v99, v91 row_shl:8 row_mask:0xf bank_mask:0xf bound_ctrl:1
    s_mov_b32 exec_lo, 0x30003
    s_mov_b32 exec_hi, 0x30003
    ds_write_b128 v11, v[88:91]
    s_mov_b64 exec, -1
    s_waitcnt lgkmcnt(0)
    s_barrier
    ds_read_b128 v[16:19], v13 offset:0
    ds_read_b128 v[20:23], v13 offset:16
    ds_read_b128 v[24:27], v13 offset:256
    ds_read_b128 v[28:31], v13 offset:272
    v_mov_b32 v12, 0xbfb8aa3b
    s_waitcnt lgkmcnt(2)
    v_pk_mul_f32 v[32:33], v[16:17], v[12:13] op_sel_hi:[1,0]
    v_pk_mul_f32 v[34:35], v[18:19], v[12:13] op_sel_hi:[1,0]
    v_pk_mul_f32 v[36:37], v[20:21], v[12:13] op_sel_hi:[1,0]
    v_pk_mul_f32 v[38:39], v[22:23], v[12:13] op_sel_hi:[1,0]
    v_exp_f32 v32, v32
    v_exp_f32 v33, v33
    v_exp_f32 v34, v34
    v_exp_f32 v35, v35
    v_exp_f32 v36, v36
    v_exp_f32 v37, v37
    v_exp_f32 v38, v38
    v_exp_f32 v39, v39
    v_pk_add_f32 v[32:33], v[32:33], 1.0 op_sel_hi:[1,0]
    v_pk_add_f32 v[34:35], v[34:35], 1.0 op_sel_hi:[1,0]
    v_pk_add_f32 v[36:37], v[36:37], 1.0 op_sel_hi:[1,0]
    v_pk_add_f32 v[38:39], v[38:39], 1.0 op_sel_hi:[1,0]
    v_rcp_f32 v32, v32
    v_rcp_f32 v33, v33
    v_rcp_f32 v34, v34
    v_rcp_f32 v35, v35
    v_rcp_f32 v36, v36
    v_rcp_f32 v37, v37
    v_rcp_f32 v38, v38
    v_rcp_f32 v39, v39
    s_waitcnt lgkmcnt(0)
    v_pk_mul_f32 v[16:17], v[16:17], v[32:33]
    v_pk_mul_f32 v[18:19], v[18:19], v[34:35]
    v_pk_mul_f32 v[20:21], v[20:21], v[36:37]
    v_pk_mul_f32 v[22:23], v[22:23], v[38:39]
    v_pk_mul_f32 v[16:17], v[16:17], v[24:25]
    v_pk_mul_f32 v[18:19], v[18:19], v[26:27]
    v_pk_mul_f32 v[20:21], v[20:21], v[28:29]
    v_pk_mul_f32 v[22:23], v[22:23], v[30:31]
    v_cvt_pk_bf16_f32 v40, v16, v17
    v_cvt_pk_bf16_f32 v41, v18, v19
    v_cvt_pk_bf16_f32 v42, v20, v21
    v_cvt_pk_bf16_f32 v43, v22, v23
    s_nop 1
    v_mfma_f32_16x16x32_bf16 v[48:51], v[40:43], a[136:139], 0
    v_mfma_f32_16x16x32_bf16 v[52:55], v[40:43], a[140:143], 0
    v_mfma_f32_16x16x32_bf16 v[56:59], v[40:43], a[144:147], 0
    v_mfma_f32_16x16x32_bf16 v[60:63], v[40:43], a[148:151], 0
    v_mfma_f32_16x16x32_bf16 v[64:67], v[40:43], a[152:155], 0
    v_mfma_f32_16x16x32_bf16 v[68:71], v[40:43], a[156:159], 0
    v_mfma_f32_16x16x32_bf16 v[72:75], v[40:43], a[160:163], 0
    v_mfma_f32_16x16x32_bf16 v[76:79], v[40:43], a[164:167], 0
    v_mfma_f32_16x16x32_bf16 v[80:83], v[40:43], a[168:171], 0
    s_nop 0
    v_mov_b32_dpp v48, v52 quad_perm:[0,1,2,3] row_mask:0x2 bank_mask:0xf
    v_mov_b32_dpp v49, v53 quad_perm:[0,1,2,3] row_mask:0x2 bank_mask:0xf
    s_nop 0
    v_mov_b32_dpp v48, v56 quad_perm:[0,1,2,3] row_mask:0x4 bank_mask:0xf
    v_mov_b32_dpp v49, v57 quad_perm:[0,1,2,3] row_mask:0x4 bank_mask:0xf
    s_nop 0
    v_mov_b32_dpp v48, v60 quad_perm:[0,1,2,3] row_mask:0x8 bank_mask:0xf
    v_mov_b32_dpp v49, v61 quad_perm:[0,1,2,3] row_mask:0x8 bank_mask:0xf
    v_mov_b32_dpp v50, v64 quad_perm:[0,1,2,3] row_mask:0x1 bank_mask:0xf
    v_mov_b32_dpp v51, v65 quad_perm:[0,1,2,3] row_mask:0x1 bank_mask:0xf
    s_nop 0
    v_mov_b32_dpp v50, v68 quad_perm:[0,1,2,3] row_mask:0x2 bank_mask:0xf
    v_mov_b32_dpp v51, v69 quad_perm:[0,1,2,3] row_mask:0x2 bank_mask:0xf
    s_nop 0
    v_mov_b32_dpp v50, v72 quad_perm:[0,1,2,3] row_mask:0x4 bank_mask:0xf
    v_mov_b32_dpp v51, v73 quad_perm:[0,1,2,3] row_mask:0x4 bank_mask:0xf
    s_nop 0
    v_mov_b32_dpp v50, v76 quad_perm:[0,1,2,3] row_mask:0x8 bank_mask:0xf
    v_mov_b32_dpp v51, v77 quad_perm:[0,1,2,3] row_mask:0x8 bank_mask:0xf
    v_min_u32 v48, -2, v48
    v_min_u32 v49, -2, v49
    v_min_u32 v50, -2, v50
    v_min_u32 v51, -2, v51
    v_min_u32 v80, -2, v80
    v_min_u32 v81, -2, v81
    buffer_store_dwordx4 v[48:51], v8, s[84:87], s15 offen sc1
    s_mov_b64 exec, 0xffff
    buffer_store_dwordx2 v[80:81], v10, s[84:87], s15 offen offset:1024 sc1
    s_branch L2_fin
L2_red:
    s_mov_b32 s3, 98304
    s_add_u32 s32, s84, s3
    s_addc_u32 s33, s85, 0
    s_mov_b32 s34, 663552
    s_mov_b32 s35, 0x20000
    s_sub_u32 s3, s2, 144
    s_mul_i32 s14, s3, 7282
    s_lshr_b32 s14, s14, 16
    s_mul_i32 s15, s14, 9
    s_sub_u32 s15, s3, s15
    s_mul_i32 s14, s14, 144
    s_cmp_eq_u32 s15, 8
    s_cselect_b32 s56, 1, 64
    s_cselect_b32 s57, 2, 1
    s_cselect_b32 s15, 16, s15
    s_lshl3_add_u32 s14, s15, s14
    v_bfe_u32 v7, v0, 2, 3
    v_mul_u32_u24 v7, s57, v7
    v_bfe_u32 v9, v0, 1, 1
    v_mul_u32_u24 v9, s56, v9
    v_add3_u32 v7, v7, v9, s14
    v_lshl_add_u32 v9, v7, 1, v4
    v_lshlrev_b32 v7, 2, v7
    v_lshrrev_b32 v12, 7, v3
    v_bfe_u32 v13, v3, 3, 4
    v_lshl_add_u32 v13, v12, 6, v13
    v_lshlrev_b32 v13, 8, v13
    s_mov_b32 s59, 794624
    s_mov_b32 s97, 0x20000
L2_r:
    buffer_load_dword v12, v13, s[84:87], s59 offen offset:128 sc1
    s_waitcnt vmcnt(0)
    v_cmp_eq_u32 vcc, 0, v12
    s_sub_u32 s97, s97, 1
    s_cselect_b64 vcc, 0, vcc
    s_cmp_eq_u64 vcc, 0
    s_cbranch_scc1 L2_r_ok
    s_sleep 1
    s_branch L2_r
L2_r_ok:
    buffer_load_ushort v18, v9, s[80:83], 0 offen sc1
    ds_read_b32 v20, v7 offset:6912
    v_and_b32 v6, 7, v0
    v_lshrrev_b32 v10, 3, v0
    s_lshl_b32 s14, s51, 3
    v_add_u32 v10, s14, v10
    v_mul_u32_u24 v10, 4608, v10
    v_lshl_add_u32 v10, v6, 4, v10
    s_lshl_b32 s3, s3, 7
    v_add_u32 v24, s3, v10
    v_add_u32 v25, 147456, v24
    v_add_u32 v26, 294912, v24
    v_add_u32 v27, 442368, v24
    v_add_u32 v28, 589824, v24
    v_and_b32 v16, 0xfffff800, v16
    v_not_b32 v12, v16
    v_ashrrev_i32 v12, 31, v12
    v_or_b32 v12, 0x80000000, v12
    v_xor_b32 v16, v16, v12
    v_mul_f32 v16, 0xbfb8aa3b, v16
    v_exp_f32 v16, v16
    s_nop 0
    v_add_f32 v16, 1.0, v16
    v_rcp_f32 v16, v16
    s_waitcnt lgkmcnt(0)
    v_mul_f32 v20, v20, v16
    s_lshl_b32 s14, s51, 7
    s_add_u32 s14, s14, 15872
    v_lshl_add_u32 v10, v6, 4, s14
    v_and_b32 v11, 31, v0
    v_lshlrev_b32 v11, 2, v11
    s_mov_b32 s97, 0x20000
L2_p3:
    buffer_load_dwordx4 v[32:35], v24, s[32:35], 0 offen sc1
    buffer_load_dwordx4 v[36:39], v25, s[32:35], 0 offen sc1
    buffer_load_dwordx4 v[40:43], v26, s[32:35], 0 offen sc1
    buffer_load_dwordx4 v[44:47], v27, s[32:35], 0 offen sc1
    buffer_load_dwordx4 v[48:51], v28, s[32:35], 0 offen sc1
    s_waitcnt vmcnt(0)
    v_max3_u32 v12, v32, v33, v34
    v_max3_u32 v12, v12, v35, v36
    v_max3_u32 v12, v12, v37, v38
    v_max3_u32 v12, v12, v39, v40
    v_max3_u32 v12, v12, v41, v42
    v_max3_u32 v12, v12, v43, v44
    v_max3_u32 v12, v12, v45, v46
    v_max3_u32 v12, v12, v47, v48
    v_max3_u32 v12, v12, v49, v50
    v_max_u32 v12, v12, v51
    v_cmp_eq_u32 vcc, -1, v12
    s_sub_u32 s97, s97, 1
    s_cselect_b64 vcc, 0, vcc
    s_cmp_eq_u64 vcc, 0
    s_cbranch_scc1 L2_p3_ok
    s_branch L2_p3
L2_p3_ok:
    v_pk_add_f32 v[32:33], v[32:33], v[36:37]
    v_pk_add_f32 v[40:41], v[40:41], v[44:45]
    v_pk_add_f32 v[32:33], v[32:33], v[48:49]
    v_pk_add_f32 v[32:33], v[32:33], v[40:41]
    v_pk_add_f32 v[34:35], v[34:35], v[38:39]
    v_pk_add_f32 v[42:43], v[42:43], v[46:47]
    v_pk_add_f32 v[34:35], v[34:35], v[50:51]
    v_pk_add_f32 v[34:35], v[34:35], v[42:43]
    s_nop 1
    v_add_f32_dpp v32, v32, v32 row_ror:8 row_mask:0xf bank_mask:0xf
    v_add_f32_dpp v33, v33, v33 row_ror:8 row_mask:0xf bank_mask:0xf
    v_add_f32_dpp v34, v34, v34 row_ror:8 row_mask:0xf bank_mask:0xf
    v_add_f32_dpp v35, v35, v35 row_ror:8 row_mask:0xf bank_mask:0xf
    v_mov_b32 v12, v32
    v_mov_b32 v13, v33
    v_mov_b32 v14, v34
    v_mov_b32 v15, v35
    v_permlane16_swap_b32 v12, v32
    v_permlane16_swap_b32 v13, v33
    v_permlane16_swap_b32 v14, v34
    v_permlane16_swap_b32 v15, v35
    v_add_f32 v32, v32, v12
    v_add_f32 v33, v33, v13
    v_add_f32 v34, v34, v14
    v_add_f32 v35, v35, v15
    v_mov_b32 v12, v32
    v_mov_b32 v13, v33
    v_mov_b32 v14, v34
    v_mov_b32 v15, v35
    v_permlane32_swap_b32 v12, v32
    v_permlane32_swap_b32 v13, v33
    v_permlane32_swap_b32 v14, v34
    v_permlane32_swap_b32 v15, v35
    v_add_f32 v32, v32, v12
    v_add_f32 v33, v33, v13
    v_add_f32 v34, v34, v14
    v_add_f32 v35, v35, v15
    ds_write_b128 v10, v[32:35]
    s_waitcnt lgkmcnt(0)
    s_barrier
    s_cmp_lg_u32 s51, 0
    s_cbranch_scc1 L2_fin
    ds_read_b32 v32, v11 offset:15872
    ds_read_b32 v33, v11 offset:16000
    ds_read_b32 v34, v11 offset:16128
    ds_read_b32 v35, v11 offset:16256
    v_lshlrev_b32 v12, 16, v18
    s_mov_b32 exec_hi, 0
    s_waitcnt lgkmcnt(0)
    v_pk_add_f32 v[32:33], v[32:33], v[34:35]
    v_add_f32 v32, v32, v33
    v_fmac_f32 v12, v32, v20
    v_cvt_pk_bf16_f32 v12, v12, v12
    buffer_store_short v12, v9, s[80:83], 0 offen sc1
L2_fin:
L2_end:
    s_endpgm
L2_p0s:
    s_mov_b32 s97, 0x20000
L2_p0:
    buffer_load_dword v51, v156, s[60:63], 0 offen sc1
    s_waitcnt vmcnt(0)
    v_cmp_eq_u32 vcc, 0, v51
    s_sub_u32 s97, s97, 1
    s_cselect_b64 vcc, 0, vcc
    s_cmp_eq_u64 vcc, 0
    s_cbranch_scc1 L2_p0_ok
    s_sleep 1
    s_branch L2_p0
L2_p0_ok:
    s_branch L2_p0r
L2_pms:
    s_mov_b32 s97, 0x20000
L2_pm:
    buffer_load_dwordx4 v[168:171], v166, s[84:87], 0 offen sc1
    buffer_load_dwordx4 v[176:179], v166, s[84:87], s14 offen sc1
    s_mov_b64 exec, 0xff
    buffer_load_dwordx4 v[172:175], v166, s[84:87], 0 offen offset:1024 sc1
    buffer_load_dwordx4 v[180:183], v166, s[84:87], s14 offen offset:1024 sc1
    s_mov_b64 exec, -1
    s_waitcnt vmcnt(0)
    v_max_u32 v13, v168, v169
    v_max3_u32 v13, v13, v170, v171
    v_max3_u32 v13, v13, v172, v173
    v_max3_u32 v13, v13, v174, v175
    v_max3_u32 v13, v13, v176, v177
    v_max3_u32 v13, v13, v178, v179
    v_max3_u32 v13, v13, v180, v181
    v_max3_u32 v13, v13, v182, v183
    v_cmp_eq_u32 vcc, -1, v13
    s_sub_u32 s97, s97, 1
    s_cselect_b64 vcc, 0, vcc
    s_cmp_eq_u64 vcc, 0
    s_cbranch_scc1 L2_pm_ok
    s_sleep 1
    s_branch L2_pm
L2_pm_ok:
    s_branch L2_pmr
L2_g0s:
    s_mov_b32 s97, 0x20000
L2_g0:
    buffer_load_dword v9, v6, s[84:87], s47 offen sc1
    s_waitcnt vmcnt(0)
    v_cmp_ne_u32 vcc, 0, v9
    s_nop 0
    s_lshr_b32 s3, vcc_lo, 1
    s_and_b32 s3, s3, vcc_lo
    s_lshr_b32 s14, s3, 2
    s_and_b32 s3, s3, s14
    s_and_b32 s3, s3, s48
    s_cselect_b64 vcc, 0, -1
    s_sub_u32 s97, s97, 1
    s_cselect_b64 vcc, 0, vcc
    s_cmp_eq_u64 vcc, 0
    s_cbranch_scc1 L2_g0_ok
    s_sleep 1
    s_branch L2_g0
L2_g0_ok:
    s_cmp_eq_u32 s3, 0
    s_cselect_b32 s3, s48, s3
    s_branch L2_g0r
L2_g1s:
    s_mov_b32 s97, 0x20000
L2_g1:
    buffer_load_dword v9, v6, s[84:87], s47 offen sc1
    s_waitcnt vmcnt(0)
    v_cmp_ne_u32 vcc, 0, v9
    s_nop 0
    s_lshr_b32 s3, vcc_lo, 1
    s_and_b32 s3, s3, vcc_lo
    s_lshr_b32 s14, s3, 2
    s_and_b32 s3, s3, s14
    s_and_b32 s3, s3, s48
    s_cselect_b64 vcc, 0, -1
    s_sub_u32 s97, s97, 1
    s_cselect_b64 vcc, 0, vcc
    s_cmp_eq_u64 vcc, 0
    s_cbranch_scc1 L2_g1_ok
    s_sleep 1
    s_branch L2_g1
L2_g1_ok:
    s_cmp_eq_u32 s3, 0
    s_cselect_b32 s3, s48, s3
    s_branch L2_g1r
L2_pns:
    s_mov_b32 s97, 0x20000
L2_pn:
    s_movk_i32 s45, 4608
    buffer_load_dwordx4 v[76:79], v5, s[84:87], s45 offen sc1
    s_movk_i32 s45, 18432
    buffer_load_dwordx4 v[88:91], v5, s[84:87], s45 offen sc1
    s_movk_i32 s45, 8704
    buffer_load_dwordx4 v[80:83], v5, s[84:87], s45 offen sc1
    s_movk_i32 s45, 22528
    buffer_load_dwordx4 v[92:95], v5, s[84:87], s45 offen sc1
    s_movk_i32 s45, 12800
    buffer_load_dwordx4 v[84:87], v59, s[84:87], s45 offen sc1
    s_movk_i32 s45, 26624
    buffer_load_dwordx4 v[96:99], v59, s[84:87], s45 offen sc1
    s_waitcnt vmcnt(0)
    v_max_u32 v13, v76, v77
    v_max3_u32 v13, v13, v78, v79
    v_max3_u32 v13, v13, v88, v89
    v_max3_u32 v13, v13, v90, v91
    v_max3_u32 v13, v13, v80, v81
    v_max3_u32 v13, v13, v82, v83
    v_max3_u32 v13, v13, v92, v93
    v_max3_u32 v13, v13, v94, v95
    v_max3_u32 v13, v13, v84, v85
    v_max3_u32 v13, v13, v86, v87
    v_max3_u32 v13, v13, v96, v97
    v_max3_u32 v13, v13, v98, v99
    v_cmp_eq_u32 vcc, -1, v13
    s_sub_u32 s97, s97, 1
    s_cselect_b64 vcc, 0, vcc
    s_cmp_eq_u64 vcc, 0
    s_cbranch_scc1 L2_pn_ok
    s_sleep 1
    s_branch L2_pn
L2_pn_ok:
    s_branch L2_pnr
L2_g2s:
    s_mov_b32 s97, 0x20000
L2_g2:
    buffer_load_dword v9, v6, s[84:87], s47 offen sc1
    s_waitcnt vmcnt(0)
    v_cmp_ne_u32 vcc, 0, v9
    s_nop 0
    s_lshr_b32 s3, vcc_lo, 1
    s_and_b32 s3, s3, vcc_lo
    s_lshr_b32 s14, s3, 2
    s_and_b32 s3, s3, s14
    s_and_b32 s3, s3, s48
    s_cselect_b64 vcc, 0, -1
    s_sub_u32 s97, s97, 1
    s_cselect_b64 vcc, 0, vcc
    s_cmp_eq_u64 vcc, 0
    s_cbranch_scc1 L2_g2_ok
    s_sleep 1
    s_branch L2_g2
L2_g2_ok:
    s_cmp_eq_u32 s3, 0
    s_cselect_b32 s3, s48, s3
    s_branch L2_g2r
L2_g3s:
    s_mov_b32 s97, 0x20000
L2_g3:
    buffer_load_dword v9, v6, s[84:87], s47 offen sc1
    s_waitcnt vmcnt(0)
    v_cmp_ne_u32 vcc, 0, v9
    s_nop 0
    s_lshr_b32 s3, vcc_lo, 1
    s_and_b32 s3, s3, vcc_lo
    s_lshr_b32 s14, s3, 2
    s_and_b32 s3, s3, s14
    s_and_b32 s3, s3, s48
    s_cselect_b64 vcc, 0, -1
    s_sub_u32 s97, s97, 1
    s_cselect_b64 vcc, 0, vcc
    s_cmp_eq_u64 vcc, 0
    s_cbranch_scc1 L2_g3_ok
    s_sleep 1
    s_branch L2_g3
L2_g3_ok:
    s_cmp_eq_u32 s3, 0
    s_cselect_b32 s3, s48, s3
    s_branch L2_g3r
L2_hs:
    s_mov_b32 s97, 0x20000
L2_h:
    buffer_load_dwordx4 v[128:131], v5, s[84:87], s59 offen offset:0 sc1
    buffer_load_dwordx4 v[132:135], v5, s[84:87], s59 offen offset:256 sc1
    buffer_load_dwordx4 v[136:139], v5, s[84:87], s59 offen offset:512 sc1
    buffer_load_dwordx4 v[140:143], v5, s[84:87], s59 offen offset:768 sc1
    buffer_load_dwordx4 v[144:147], v3, s[84:87], s59 offen offset:1024 sc1
    s_waitcnt vmcnt(0)
    v_max_u32 v12, v128, v129
    v_max3_u32 v12, v12, v130, v131
    v_max3_u32 v12, v12, v132, v133
    v_max3_u32 v12, v12, v134, v135
    v_max3_u32 v12, v12, v136, v137
    v_max3_u32 v12, v12, v138, v139
    v_max3_u32 v12, v12, v140, v141
    v_max3_u32 v12, v12, v142, v143
    v_max3_u32 v12, v12, v144, v145
    v_max3_u32 v12, v12, v146, v147
    v_cmp_eq_u32 vcc, -1, v12
    s_sub_u32 s97, s97, 1
    s_cselect_b64 vcc, 0, vcc
    s_cmp_eq_u64 vcc, 0
    s_cbranch_scc1 L2_h_ok
    s_sleep 1
    s_branch L2_h
L2_h_ok:
    v_min_u32 v128, -2, v128
    v_min_u32 v129, -2, v129
    v_min_u32 v130, -2, v130
    v_min_u32 v131, -2, v131
    v_min_u32 v132, -2, v132
    v_min_u32 v133, -2, v133
    v_min_u32 v134, -2, v134
    v_min_u32 v135, -2, v135
    v_min_u32 v136, -2, v136
    v_min_u32 v137, -2, v137
    v_min_u32 v138, -2, v138
    v_min_u32 v139, -2, v139
    v_min_u32 v140, -2, v140
    v_min_u32 v141, -2, v141
    v_min_u32 v142, -2, v142
    v_min_u32 v143, -2, v143
    v_min_u32 v144, -2, v144
    v_min_u32 v145, -2, v145
    v_min_u32 v146, -2, v146
    v_min_u32 v147, -2, v147
    s_nop 1
    s_branch L2_hr
L2_fallback:
    s_waitcnt vmcnt(0) lgkmcnt(0)
    s_nop 7
    s_barrier
    s_lshl_b32 s3, s51, 12
    v_add_u32 v5, s3, v8
    v_lshrrev_b32 v14, 2, v0
    v_mul_u32_u24 v14, 1056, v14
    v_and_b32 v15, 3, v0
    v_lshl_add_u32 v14, v15, 3, v14
    v_add_u32 v2, 107008, v14
    v_and_b32 v14, 15, v0
    v_mul_u32_u24 v14, 1056, v14
    v_lshrrev_b32 v15, 4, v0
    v_lshl_add_u32 v14, v15, 4, v14
    v_add_u32 v1, 90112, v14
    v_mov_b32 v32, 0xff800000
    v_mov_b32 v33, 0xff800000
    v_mov_b32 v34, 0xff800000
    v_mov_b32 v35, 0xff800000
    s_mov_b32 s50, 1
    s_mov_b32 s46, 0
L2_fb_loop:
    s_add_u32 m0, s44, 73728
    s_nop 0
    buffer_load_dwordx4 off, s[16:19], s46 offset:0 lds
    s_add_u32 m0, s44, 73760
    s_nop 0
    buffer_load_dwordx4 off, s[16:19], s46 offset:1024 lds
    s_add_u32 m0, s44, 73792
    s_nop 0
    buffer_load_dwordx4 off, s[16:19], s46 offset:2048 lds
    s_add_u32 m0, s44, 73824
    s_nop 0
    buffer_load_dwordx4 off, s[16:19], s46 offset:3072 lds
    s_waitcnt vmcnt(0) lgkmcnt(0)
    s_barrier
    ds_read_b128 a[64:67], v1 offset:0
    ds_read_b128 a[68:71], v1 offset:64
    ds_read_b128 a[72:75], v1 offset:128
    ds_read_b128 a[76:79], v1 offset:192
    ds_read_b128 a[80:83], v1 offset:256
    ds_read_b128 a[84:87], v1 offset:320
    ds_read_b128 a[88:91], v1 offset:384
    ds_read_b128 a[92:95], v1 offset:448
    ds_read_b128 a[96:99], v1 offset:512
    ds_read_b128 a[100:103], v1 offset:576
    ds_read_b128 a[104:107], v1 offset:640
    ds_read_b128 a[108:111], v1 offset:704
    ds_read_b128 a[112:115], v1 offset:768
    ds_read_b128 a[116:119], v1 offset:832
    ds_read_b128 a[120:123], v1 offset:896
    ds_read_b128 a[124:127], v1 offset:960
    s_waitcnt vmcnt(0) lgkmcnt(0)
    s_barrier
    v_mfma_f32_16x16x32_bf16 v[16:19], a[64:67], v[64:67], 0
    v_mfma_f32_16x16x32_bf16 v[16:19], a[68:71], v[68:71], v[16:19]
    v_mfma_f32_16x16x32_bf16 v[16:19], a[72:75], v[72:75], v[16:19]
    v_mfma_f32_16x16x32_bf16 v[16:19], a[76:79], v[76:79], v[16:19]
    v_mfma_f32_16x16x32_bf16 v[20:23], a[80:83], v[64:67], 0
    v_mfma_f32_16x16x32_bf16 v[20:23], a[84:87], v[68:71], v[20:23]
    v_mfma_f32_16x16x32_bf16 v[20:23], a[88:91], v[72:75], v[20:23]
    v_mfma_f32_16x16x32_bf16 v[20:23], a[92:95], v[76:79], v[20:23]
    v_mfma_f32_16x16x32_bf16 v[24:27], a[96:99], v[64:67], 0
    v_mfma_f32_16x16x32_bf16 v[24:27], a[100:103], v[68:71], v[24:27]
    v_mfma_f32_16x16x32_bf16 v[24:27], a[104:107], v[72:75], v[24:27]
    v_mfma_f32_16x16x32_bf16 v[24:27], a[108:111], v[76:79], v[24:27]
    v_mfma_f32_16x16x32_bf16 v[28:31], a[112:115], v[64:67], 0
    v_mfma_f32_16x16x32_bf16 v[28:31], a[116:119], v[68:71], v[28:31]
    v_mfma_f32_16x16x32_bf16 v[28:31], a[120:123], v[72:75], v[28:31]
    v_mfma_f32_16x16x32_bf16 v[28:31], a[124:127], v[76:79], v[28:31]
    s_nop 7
    v_max3_f32 v32, v32, v16, v17
    v_max3_f32 v32, v32, v18, v19
    v_max3_f32 v32, v32, v20, v21
    v_max3_f32 v32, v32, v22, v23
    v_max3_f32 v32, v32, v24, v25
    v_max3_f32 v32, v32, v26, v27
    v_max3_f32 v32, v32, v28, v29
    v_max3_f32 v32, v32, v30, v31
    v_mfma_f32_16x16x32_bf16 v[16:19], a[64:67], v[80:83], 0
    v_mfma_f32_16x16x32_bf16 v[16:19], a[68:71], v[84:87], v[16:19]
    v_mfma_f32_16x16x32_bf16 v[16:19], a[72:75], v[88:91], v[16:19]
    v_mfma_f32_16x16x32_bf16 v[16:19], a[76:79], v[92:95], v[16:19]
    v_mfma_f32_16x16x32_bf16 v[20:23], a[80:83], v[80:83], 0
    v_mfma_f32_16x16x32_bf16 v[20:23], a[84:87], v[84:87], v[20:23]
    v_mfma_f32_16x16x32_bf16 v[20:23], a[88:91], v[88:91], v[20:23]
    v_mfma_f32_16x16x32_bf16 v[20:23], a[92:95], v[92:95], v[20:23]
    v_mfma_f32_16x16x32_bf16 v[24:27], a[96:99], v[80:83], 0
    v_mfma_f32_16x16x32_bf16 v[24:27], a[100:103], v[84:87], v[24:27]
    v_mfma_f32_16x16x32_bf16 v[24:27], a[104:107], v[88:91], v[24:27]
    v_mfma_f32_16x16x32_bf16 v[24:27], a[108:111], v[92:95], v[24:27]
    v_mfma_f32_16x16x32_bf16 v[28:31], a[112:115], v[80:83], 0
    v_mfma_f32_16x16x32_bf16 v[28:31], a[116:119], v[84:87], v[28:31]
    v_mfma_f32_16x16x32_bf16 v[28:31], a[120:123], v[88:91], v[28:31]
    v_mfma_f32_16x16x32_bf16 v[28:31], a[124:127], v[92:95], v[28:31]
    s_nop 7
    v_max3_f32 v33, v33, v16, v17
    v_max3_f32 v33, v33, v18, v19
    v_max3_f32 v33, v33, v20, v21
    v_max3_f32 v33, v33, v22, v23
    v_max3_f32 v33, v33, v24, v25
    v_max3_f32 v33, v33, v26, v27
    v_max3_f32 v33, v33, v28, v29
    v_max3_f32 v33, v33, v30, v31
    v_mfma_f32_16x16x32_bf16 v[16:19], a[64:67], v[96:99], 0
    v_mfma_f32_16x16x32_bf16 v[16:19], a[68:71], v[100:103], v[16:19]
    v_mfma_f32_16x16x32_bf16 v[16:19], a[72:75], v[104:107], v[16:19]
    v_mfma_f32_16x16x32_bf16 v[16:19], a[76:79], v[108:111], v[16:19]
    v_mfma_f32_16x16x32_bf16 v[20:23], a[80:83], v[96:99], 0
    v_mfma_f32_16x16x32_bf16 v[20:23], a[84:87], v[100:103], v[20:23]
    v_mfma_f32_16x16x32_bf16 v[20:23], a[88:91], v[104:107], v[20:23]
    v_mfma_f32_16x16x32_bf16 v[20:23], a[92:95], v[108:111], v[20:23]
    v_mfma_f32_16x16x32_bf16 v[24:27], a[96:99], v[96:99], 0
    v_mfma_f32_16x16x32_bf16 v[24:27], a[100:103], v[100:103], v[24:27]
    v_mfma_f32_16x16x32_bf16 v[24:27], a[104:107], v[104:107], v[24:27]
    v_mfma_f32_16x16x32_bf16 v[24:27], a[108:111], v[108:111], v[24:27]
    v_mfma_f32_16x16x32_bf16 v[28:31], a[112:115], v[96:99], 0
    v_mfma_f32_16x16x32_bf16 v[28:31], a[116:119], v[100:103], v[28:31]
    v_mfma_f32_16x16x32_bf16 v[28:31], a[120:123], v[104:107], v[28:31]
    v_mfma_f32_16x16x32_bf16 v[28:31], a[124:127], v[108:111], v[28:31]
    s_nop 7
    v_max3_f32 v34, v34, v16, v17
    v_max3_f32 v34, v34, v18, v19
    v_max3_f32 v34, v34, v20, v21
    v_max3_f32 v34, v34, v22, v23
    v_max3_f32 v34, v34, v24, v25
    v_max3_f32 v34, v34, v26, v27
    v_max3_f32 v34, v34, v28, v29
    v_max3_f32 v34, v34, v30, v31
    v_mfma_f32_16x16x32_bf16 v[16:19], a[64:67], v[112:115], 0
    v_mfma_f32_16x16x32_bf16 v[16:19], a[68:71], v[116:119], v[16:19]
    v_mfma_f32_16x16x32_bf16 v[16:19], a[72:75], v[120:123], v[16:19]
    v_mfma_f32_16x16x32_bf16 v[16:19], a[76:79], v[124:127], v[16:19]
    v_mfma_f32_16x16x32_bf16 v[20:23], a[80:83], v[112:115], 0
    v_mfma_f32_16x16x32_bf16 v[20:23], a[84:87], v[116:119], v[20:23]
    v_mfma_f32_16x16x32_bf16 v[20:23], a[88:91], v[120:123], v[20:23]
    v_mfma_f32_16x16x32_bf16 v[20:23], a[92:95], v[124:127], v[20:23]
    v_mfma_f32_16x16x32_bf16 v[24:27], a[96:99], v[112:115], 0
    v_mfma_f32_16x16x32_bf16 v[24:27], a[100:103], v[116:119], v[24:27]
    v_mfma_f32_16x16x32_bf16 v[24:27], a[104:107], v[120:123], v[24:27]
    v_mfma_f32_16x16x32_bf16 v[24:27], a[108:111], v[124:127], v[24:27]
    v_mfma_f32_16x16x32_bf16 v[28:31], a[112:115], v[112:115], 0
    v_mfma_f32_16x16x32_bf16 v[28:31], a[116:119], v[116:119], v[28:31]
    v_mfma_f32_16x16x32_bf16 v[28:31], a[120:123], v[120:123], v[28:31]
    v_mfma_f32_16x16x32_bf16 v[28:31], a[124:127], v[124:127], v[28:31]
    s_nop 7
    v_max3_f32 v35, v35, v16, v17
    v_max3_f32 v35, v35, v18, v19
    v_max3_f32 v35, v35, v20, v21
    v_max3_f32 v35, v35, v22, v23
    v_max3_f32 v35, v35, v24, v25
    v_max3_f32 v35, v35, v26, v27
    v_max3_f32 v35, v35, v28, v29
    v_max3_f32 v35, v35, v30, v31
    s_add_u32 s46, s46, 16384
    s_cmp_lt_u32 s46, 524288
    s_cbranch_scc1 L2_fb_loop
    v_mov_b32 v40, v32
    v_mov_b32 v41, v33
    v_mov_b32 v42, v34
    v_mov_b32 v43, v35
    v_permlane16_swap_b32 v40, v32
    v_permlane16_swap_b32 v41, v33
    v_permlane16_swap_b32 v42, v34
    v_permlane16_swap_b32 v43, v35
    v_max_f32 v32, v32, v40
    v_max_f32 v33, v33, v41
    v_max_f32 v34, v34, v42
    v_max_f32 v35, v35, v43
    v_mov_b32 v40, v32
    v_mov_b32 v41, v33
    v_mov_b32 v42, v34
    v_mov_b32 v43, v35
    v_permlane32_swap_b32 v40, v32
    v_permlane32_swap_b32 v41, v33
    v_permlane32_swap_b32 v42, v34
    v_permlane32_swap_b32 v43, v35
    v_max_f32 v32, v32, v40
    v_max_f32 v33, v33, v41
    v_max_f32 v34, v34, v42
    v_max_f32 v35, v35, v43
    v_sub_f32 v48, 0x80000000, v32
    v_sub_f32 v49, 0x80000000, v32
    v_sub_f32 v50, 0x80000000, v32
    v_sub_f32 v51, 0x80000000, v32
    v_sub_f32 v52, 0x80000000, v33
    v_sub_f32 v53, 0x80000000, v33
    v_sub_f32 v54, 0x80000000, v33
    v_sub_f32 v55, 0x80000000, v33
    v_sub_f32 v56, 0x80000000, v34
    v_sub_f32 v57, 0x80000000, v34
    v_sub_f32 v58, 0x80000000, v34
    v_sub_f32 v59, 0x80000000, v34
    v_sub_f32 v60, 0x80000000, v35
    v_sub_f32 v61, 0x80000000, v35
    v_sub_f32 v62, 0x80000000, v35
    v_sub_f32 v63, 0x80000000, v35
    s_add_u32 m0, s44, 73728
    s_mov_b32 s46, 0
    buffer_load_dwordx4 off, s[16:19], s46 offset:0 lds
    s_add_u32 m0, s44, 73760
    s_nop 0
    buffer_load_dwordx4 off, s[16:19], s46 offset:1024 lds
    s_add_u32 m0, s44, 73792
    s_nop 0
    buffer_load_dwordx4 off, s[16:19], s46 offset:2048 lds
    s_add_u32 m0, s44, 73824
    s_nop 0
    buffer_load_dwordx4 off, s[16:19], s46 offset:3072 lds
    s_add_u32 m0, s44, 90624
    s_nop 0
    buffer_load_dwordx4 off, s[20:23], s46 offset:0 lds
    s_add_u32 m0, s44, 90656
    s_nop 0
    buffer_load_dwordx4 off, s[20:23], s46 offset:1024 lds
    s_add_u32 m0, s44, 90688
    s_nop 0
    buffer_load_dwordx4 off, s[20:23], s46 offset:2048 lds
    s_add_u32 m0, s44, 90720
    s_nop 0
    buffer_load_dwordx4 off, s[20:23], s46 offset:3072 lds
    s_add_u32 m0, s44, 110592
    s_mov_b32 s46, 16384
    buffer_load_dwordx4 off, s[16:19], s46 offset:0 lds
    s_add_u32 m0, s44, 110624
    s_nop 0
    buffer_load_dwordx4 off, s[16:19], s46 offset:1024 lds
    s_add_u32 m0, s44, 110656
    s_nop 0
    buffer_load_dwordx4 off, s[16:19], s46 offset:2048 lds
    s_add_u32 m0, s44, 110688
    s_nop 0
    buffer_load_dwordx4 off, s[16:19], s46 offset:3072 lds
    s_add_u32 m0, s44, 127488
    s_nop 0
    buffer_load_dwordx4 off, s[20:23], s46 offset:0 lds
    s_add_u32 m0, s44, 127520
    s_nop 0
    buffer_load_dwordx4 off, s[20:23], s46 offset:1024 lds
    s_add_u32 m0, s44, 127552
    s_nop 0
    buffer_load_dwordx4 off, s[20:23], s46 offset:2048 lds
    s_add_u32 m0, s44, 127584
    s_nop 0
    buffer_load_dwordx4 off, s[20:23], s46 offset:3072 lds
    s_add_u32 m0, s44, 0
    s_mov_b32 s46, 32768
    buffer_load_dwordx4 off, s[16:19], s46 offset:0 lds
    s_add_u32 m0, s44, 32
    s_nop 0
    buffer_load_dwordx4 off, s[16:19], s46 offset:1024 lds
    s_add_u32 m0, s44, 64
    s_nop 0
    buffer_load_dwordx4 off, s[16:19], s46 offset:2048 lds
    s_add_u32 m0, s44, 96
    s_nop 0
    buffer_load_dwordx4 off, s[16:19], s46 offset:3072 lds
    s_add_u32 m0, s44, 16896
    s_nop 0
    buffer_load_dwordx4 off, s[20:23], s46 offset:0 lds
    s_add_u32 m0, s44, 16928
    s_nop 0
    buffer_load_dwordx4 off, s[20:23], s46 offset:1024 lds
    s_add_u32 m0, s44, 16960
    s_nop 0
    buffer_load_dwordx4 off, s[20:23], s46 offset:2048 lds
    s_add_u32 m0, s44, 16992
    s_nop 0
    buffer_load_dwordx4 off, s[20:23], s46 offset:3072 lds
    s_waitcnt vmcnt(0) lgkmcnt(0)
    s_barrier
    ds_read_b128 a[64:67], v1 offset:0
    ds_read_b128 a[68:71], v1 offset:64
    ds_read_b128 a[72:75], v1 offset:128
    ds_read_b128 a[76:79], v1 offset:192
    ds_read_b128 a[80:83], v1 offset:256
    ds_read_b128 a[84:87], v1 offset:320
    ds_read_b128 a[88:91], v1 offset:384
    ds_read_b128 a[92:95], v1 offset:448
    ds_read_b128 a[96:99], v1 offset:512
    ds_read_b128 a[100:103], v1 offset:576
    ds_read_b128 a[104:107], v1 offset:640
    ds_read_b128 a[108:111], v1 offset:704
    ds_read_b128 a[112:115], v1 offset:768
    ds_read_b128 a[116:119], v1 offset:832
    ds_read_b128 a[120:123], v1 offset:896
    ds_read_b128 a[124:127], v1 offset:960
    v_lshrrev_b32 v14, 2, v0
    s_mul_i32 s3, s51, 144
    v_add_u32 v14, s3, v14
    v_mul_u32_u24 v14, 9216, v14
    v_and_b32 v15, 3, v0
    v_lshl_add_u32 v6, v15, 4, v14
    s_lshr_b32 s3, s2, 3
    s_lshl2_add_u32 s3, s3, s51
    s_and_b32 s15, s2, 7
    v_lshlrev_b32 v9, 7, v0
    s_mul_i32 s14, s3, 9
    s_lshr_b32 s14, s14, 1
    v_min_u32 v15, 44, v0
    v_mul_u32_u24 v12, 7282, v15
    v_lshrrev_b32 v12, 16, v12
    v_mul_u32_u24 v13, 63, v12
    v_add_u32 v12, v15, v13
    s_mul_i32 s14, s14, 72
    s_mul_i32 s56, s15, 9
    s_add_u32 s14, s14, s56
    v_add_lshl_u32 v12, s14, v12, 7
    s_mul_i32 s14, s3, 81
    s_lshr_b32 s14, s14, 1
    s_mul_i32 s56, s15, 5184
    s_add_u32 s14, s14, s56
    v_min_u32 v13, 40, v0
    v_add_lshl_u32 v13, s14, v13, 7
    s_mul_i32 s14, s3, 72
    s_andn2_b32 s56, s52, 3
    s_mul_i32 s56, s56, 2304
    s_add_u32 s14, s14, s56
    v_min_u32 v14, 35, v0
    v_add_lshl_u32 v14, s14, v14, 7
    v_add_u32 v15, 4608, v14
    v_accvgpr_write_b32 a0, 0
    v_accvgpr_write_b32 a1, 0
    v_accvgpr_write_b32 a2, 0
    v_accvgpr_write_b32 a3, 0
    v_accvgpr_write_b32 a4, 0
    v_accvgpr_write_b32 a5, 0
    v_accvgpr_write_b32 a6, 0
    v_accvgpr_write_b32 a7, 0
    v_accvgpr_write_b32 a8, 0
    v_accvgpr_write_b32 a9, 0
    v_accvgpr_write_b32 a10, 0
    v_accvgpr_write_b32 a11, 0
    v_accvgpr_write_b32 a12, 0
    v_accvgpr_write_b32 a13, 0
    v_accvgpr_write_b32 a14, 0
    v_accvgpr_write_b32 a15, 0
    s_waitcnt vmcnt(0) lgkmcnt(0)
    s_branch L2_entry
L2_codeend:

.section .rodata,"a"
.p2align 6
.amdhsa_kernel adaLN_cond__gqa_block_cached__moe_arch_mod__prompt_kernel
  .amdhsa_next_free_vgpr 512
  .amdhsa_next_free_sgpr 102
  .amdhsa_accum_offset 256
  .amdhsa_group_segment_fixed_size 0
  .amdhsa_kernarg_size 120
  .amdhsa_user_sgpr_count 2
  .amdhsa_user_sgpr_kernarg_segment_ptr 1
  .amdhsa_system_sgpr_workgroup_id_x 1
  .amdhsa_float_denorm_mode_32 3
.end_amdhsa_kernel
```

```asm
; @launch grid=(256,1,1) block=(256,1,1) lds=163840
.amdgcn_target "amdgcn-amd-amdhsa--gfx950"
.text
.globl adaLN_cond__gqa_block_cached__moe_arch_mod__prompt_kernel
.p2align 8
.type adaLN_cond__gqa_block_cached__moe_arch_mod__prompt_kernel,@function
adaLN_cond__gqa_block_cached__moe_arch_mod__prompt_kernel:
L2_begin:
    s_getpc_b64 s[98:99]
    s_cmp_ge_u32 s2, 256
    s_cbranch_scc1 L2_end
    s_load_dwordx2 s[76:77], s[0:1], 0
    s_load_dwordx2 s[16:17], s[0:1], 80
    s_load_dwordx2 s[88:89], s[0:1], 88
    s_load_dwordx2 s[12:13], s[0:1], 112
    s_load_dwordx2 s[60:61], s[0:1], 104
    s_and_b32 s3, s2, 7
    s_lshr_b32 s14, s2, 3
    v_mov_b32 v155, v0
    v_lshrrev_b32 v10, 6, v0
    v_and_b32 v0, 63, v0
    s_lshl_b32 s15, s14, 9
    v_lshl_add_u32 v13, v10, 7, s15
    v_lshl_add_u32 v13, v0, 14, v13
    v_min_u32 v13, L2_codeend-L2_begin-8, v13
    s_mov_b64 exec, 31
    global_load_dword a63, v13, s[98:99]
    s_mov_b64 exec, -1
    v_readfirstlane_b32 s51, v10
    s_and_b32 s52, s3, 3
    s_and_b32 s15, s14, 3
    s_lshl2_add_u32 s52, s52, s15
    s_lshr_b32 s53, s3, 2
    s_lshr_b32 s15, s14, 2
    s_lshl3_add_u32 s53, s53, s15
    s_lshl4_add_u32 s96, s53, s52
    s_mul_i32 s49, s3, 27
    s_max_u32 s14, s14, 5
    s_add_u32 s49, s49, s14
    s_sub_u32 s49, s49, 5
    s_lshr_b32 s55, s3, 2
    s_mul_i32 s15, s55, 108
    s_sub_u32 s50, s49, s15
    s_mul_i32 s3, s51, 288
    v_lshrrev_b32 v14, 3, v0
    v_lshl_add_u32 v12, v14, 4, s3
    v_and_b32 v14, 1, v14
    v_lshl_add_u32 v13, v14, 4, s3
    v_and_b32 v14, 7, v0
    v_mul_u32_u24 v14, 1152, v14
    v_add_u32 v1, v14, v12
    v_add_u32 v2, v14, v13
    v_add_u32 v2, 256, v2
    v_and_b32 v4, 0xfc, v155
    v_and_b32 v7, 3, v0
    v_mul_u32_u24 v3, 6912, v4
    v_lshl_add_u32 v153, v7, 4, v3
    s_mul_i32 s3, s96, 9216
    s_movk_i32 s78, 9216
    s_mov_b32 s79, 0x20000
    s_mov_b32 s91, s79
    v_lshlrev_b32 v8, 4, v0
    s_mov_b32 s86, 8388608
    s_mov_b32 s87, s79
    s_movk_i32 s62, 256
    s_mov_b32 s63, s79
    s_lshl_b32 s14, s50, 6
    s_sub_u32 s90, 1990656, s14
    s_cmp_ge_u32 s2, 40
    s_cselect_b32 s90, s90, 0
    s_mul_i32 s15, s55, 1990656
    s_add_u32 s14, s14, s15
    s_waitcnt lgkmcnt(0)
    s_add_u32 s76, s76, s3
    s_addc_u32 s77, s77, 0
    buffer_load_dwordx4 v[64:67], v1, s[76:79], 0 offen offset:0
    buffer_load_dwordx4 v[68:71], v1, s[76:79], 0 offen offset:128
    buffer_load_dwordx4 v[72:75], v2, s[76:79], 0 offen offset:0
    s_add_u32 s88, s88, s14
    s_addc_u32 s89, s89, 0
    s_mov_b64 s[84:85], s[12:13]
    s_cmp_ge_u32 s2, 8
    s_cbranch_scc1 L2_noclr
    v_mov_b32 v52, -1
    v_mov_b32 v56, 0
    v_mov_b32 v53, -1
    v_mov_b32 v57, 0
    v_mov_b32 v54, -1
    v_mov_b32 v58, 0
    v_mov_b32 v55, -1
    v_mov_b32 v59, 0
    s_lshl2_add_u32 s15, s2, s51
    s_lshl_b32 s3, s15, 10
    buffer_store_dwordx4 v[52:55], v8, s[84:87], s3 offen sc1
    v_lshrrev_b32 v13, 3, v0
    v_mul_u32_u24 v13, 0, v13
    v_add_u32 v13, v13, v8
    s_mul_i32 s3, s15, 1024
    s_add_u32 s3, s3, 6815744
    buffer_store_dwordx4 v[56:59], v13, s[84:87], s3 offen sc1
L2_noclr:
    buffer_load_dwordx4 v[128:131], v153, s[88:91], 0 offen
    s_movk_i32 s3, 6912
    buffer_load_dwordx4 v[132:135], v153, s[88:91], s3 offen
    s_movk_i32 s3, 13824
    buffer_load_dwordx4 v[136:139], v153, s[88:91], s3 offen
    s_movk_i32 s3, 20736
    buffer_load_dwordx4 v[140:143], v153, s[88:91], s3 offen
    v_lshrrev_b32 v3, 2, v3
    v_lshl_add_u32 v3, v7, 4, v3
    v_add_u32 v154, 1769472, v3
    v_lshrrev_b32 v3, 1, v4
    v_lshlrev_b32 v4, 1, v4
    s_mul_i32 s3, s55, 576
    s_add_u32 s16, s16, s3
    s_addc_u32 s17, s17, 0
    s_mov_b32 s18, 576
    s_mov_b32 s19, 0x20000
    v_mov_b32 v144, 0
    v_mov_b32 v145, 0
    v_mov_b32 v146, 0
    v_mov_b32 v147, 0
    v_mov_b32 v150, 0
    s_cmp_ge_u32 s51, 2
    s_cbranch_scc1 L2_w23
    buffer_load_dwordx4 v[144:147], v154, s[88:91], 0 offen
    buffer_load_ushort v150, v3, s[16:19], 0 offen offset:512
L2_w23:
    buffer_load_dwordx2 v[148:149], v4, s[16:19], 0 offen
    s_load_dwordx8 s[4:11], s[0:1], 8
    s_load_dwordx2 s[64:65], s[0:1], 56
    s_load_dwordx2 s[68:69], s[0:1], 64
    s_load_dwordx2 s[72:73], s[0:1], 72
    s_load_dwordx2 s[80:81], s[0:1], 96
    s_load_dwordx2 s[36:37], s[0:1], 48
    s_cmp_eq_u32 s51, 0
    s_cselect_b32 s3, 0, 0x40000000
    v_mul_u32_u24 v156, 32, v0
    v_or_b32 v156, s3, v156
    s_mul_i32 s44, s51, 4224
    s_add_u32 s44, s44, 16384
    v_lshl_add_u32 v5, v10, 12, v8
    v_lshrrev_b32 v13, 5, v0
    v_lshl_add_u32 v13, v10, 1, v13
    v_lshlrev_b32 v13, 15, v13
    v_and_b32 v14, 31, v0
    v_lshl_add_u32 v6, v14, 4, v13
    v_mov_b32 v56, 0
    v_mov_b32 v60, -1
    v_mov_b32 v57, 0
    v_mov_b32 v61, -1
    v_mov_b32 v58, 0
    v_mov_b32 v62, -1
    v_mov_b32 v59, 0
    v_mov_b32 v63, -1
    s_and_b32 s14, s53, 7
    s_lshl2_add_u32 s14, s14, s51
    v_lshrrev_b32 v13, 2, v0
    v_lshl_add_u32 v13, v13, 5, s14
    v_lshlrev_b32 v13, 13, v13
    v_lshl_add_u32 v165, v7, 7, v13
    s_waitcnt lgkmcnt(0)
    s_lshl_b32 s3, s52, 9
    s_add_u32 s24, s8, s3
    s_addc_u32 s25, s9, 0
    s_mov_b32 s26, 0
    s_mov_b32 s27, 0x20000
    s_sub_u32 s26, 4718592, s3
    s_mov_b32 s38, 1152
    s_mov_b32 s39, 0x20000
    v_and_b32 v14, 7, v0
    v_lshlrev_b32 v157, 4, v14
    v_add_u32 v157, 14080, v157
    v_lshl_add_u32 v158, v10, 2, v157
    s_mul_i32 s3, s51, 4608
    v_lshl_add_u32 v14, v14, 4, s3
    v_lshrrev_b32 v15, 3, v0
    v_lshl_add_u32 v159, v15, 8, v14
    s_lshr_b32 s3, s96, 1
    s_mul_i32 s3, s3, 18432
    s_and_b32 s14, s96, 1
    s_lshl_b32 s14, s14, 7
    s_add_u32 s3, s3, s14
    s_add_u32 s58, s3, 1048576
    s_lshl_b32 s3, s53, 2
    s_add_u32 s3, s3, s51
    s_lshl_b32 s14, s3, 4
    s_add_u32 s14, s14, s52
    s_lshl_b32 s14, s14, 8
    s_add_u32 s56, s14, 786432
    s_mul_i32 s14, s3, 512
    s_add_u32 s59, s14, 6815744
    v_and_b32 v14, 3, v0
    v_mul_u32_u24 v163, 128, v14
    s_mul_i32 s14, s3, 36864
    s_add_u32 s14, s14, 1048576
    s_add_u32 s32, s12, s14
    s_addc_u32 s33, s13, 0
    s_mov_b32 s34, 36864
    s_mov_b32 s35, 0x20000
    s_or_b32 s33, s33, 0x100000
    s_mov_b32 s35, 0x800000
    s_mul_i32 s15, s2, 4608
    s_mul_i32 s14, s51, 1152
    s_add_u32 s15, s15, s14
    s_add_u32 s57, s15, 98304
    s_cmp_ge_u32 s2, 144
    s_cselect_b32 s14, 0x40000000, 0
    v_or_b32 v160, s14, v8
    v_lshrrev_b32 v12, 4, v155
    v_lshlrev_b32 v12, 7, v12
    v_lshl_add_u32 v161, v7, 5, v12
    v_lshlrev_b32 v162, 2, v0
    s_mul_i32 s3, s50, 3641
    s_lshr_b32 s3, s3, 16
    s_mov_b32 s47, 1.0
    s_mov_b32 s48, 0
    s_cmp_lt_u32 s3, 2
    s_cselect_b32 s47, 0x3e0293ee, s47
    s_cmp_eq_u32 s3, 1
    s_cselect_b32 s48, 0x3e0293ee, s48
    s_cmp_eq_u32 s3, 4
    s_cselect_b32 s48, 1.0, s48
    s_cmp_eq_u32 s55, 0
    s_cselect_b32 s48, s48, 0
    s_lshl_b32 s100, s49, 7
    s_mul_i32 s14, s96, 128
    s_add_u32 s101, s14, 6815744
    s_mul_i32 s3, s51, 1152
    v_add_u32 v166, s3, v8
    s_and_b32 s3, s51, 1
    s_mul_i32 s3, s3, 2304
    s_cmp_lt_u32 s51, 2
    s_cselect_b32 s14, 32, 0
    s_add_u32 s3, s3, s14
    s_add_u32 s3, s3, 9216
    v_lshrrev_b32 v14, 1, v0
    v_lshl_add_u32 v14, v14, 6, s3
    v_and_b32 v15, 1, v0
    v_lshl_add_u32 v167, v15, 4, v14
    s_cmp_eq_u32 s51, 1
    s_cselect_b32 s3, 40, 256
    s_cmp_ge_u32 s2, s3
    s_cselect_b32 s3, 0, 0x40000000
    v_or_b32 v164, s3, v162
    v_mov_b32 v172, 0
    v_mov_b32 v180, 0
    v_mov_b32 v173, 0
    v_mov_b32 v181, 0
    v_mov_b32 v174, 0
    v_mov_b32 v182, 0
    v_mov_b32 v175, 0
    v_mov_b32 v183, 0
    s_lshl_b32 s3, s53, 2
    s_add_u32 s3, s3, s51
    v_mov_b32 v12, v10
    s_mul_i32 s14, s3, 589824
    s_mul_i32 s15, s52, 9216
    s_add_u32 s14, s14, s15
    s_add_u32 s14, s14, 8388608
    s_add_u32 s40, s12, s14
    s_addc_u32 s41, s13, 0
    s_mov_b32 s42, 0
    s_mov_b32 s43, 0x20000
    s_sub_u32 s42, 589824, s15
    s_lshl_b32 s3, s52, 19
    s_add_u32 s16, s4, s3
    s_addc_u32 s17, s5, 0
    s_mov_b32 s18, 524288
    s_mov_b32 s19, 0x20000
    s_add_u32 s20, s6, s3
    s_addc_u32 s21, s7, 0
    s_mov_b32 s22, 524288
    s_mov_b32 s23, 0x20000
    s_lshl_b32 s3, s51, 12
    s_add_u32 s16, s16, s3
    s_addc_u32 s17, s17, 0x100000
    s_mov_b32 s18, 32768
    s_mov_b32 s19, 0x800000
    s_add_u32 s20, s20, s3
    s_addc_u32 s21, s21, 0x100000
    s_mov_b32 s22, 32768
    s_mov_b32 s23, 0x800000
    s_mul_i32 s3, s52, 294912
    s_add_u32 s28, s10, s3
    s_addc_u32 s29, s11, 0
    s_mov_b32 s30, 294912
    s_mov_b32 s31, 0x20000
    s_mov_b64 s[4:5], s[64:65]
    s_mov_b64 s[6:7], s[68:69]
    s_mov_b64 s[8:9], s[72:73]
    s_mov_b32 s50, 0
    s_mul_i32 s55, s51, 9216
    s_min_u32 s15, s2, 143
    s_and_b32 s3, s15, 7
    s_mul_i32 s3, s3, 18
    s_lshr_b32 s15, s15, 3
    s_add_u32 s15, s15, s3
    s_lshl_b32 s3, s15, 6
    s_add_u32 s64, s64, s3
    s_addc_u32 s65, s65, 0
    s_mov_b32 s66, 0
    s_mov_b32 s67, 0x20000
    s_add_u32 s68, s68, s3
    s_addc_u32 s69, s69, 0
    s_mov_b32 s70, 0
    s_mov_b32 s71, 0x20000
    s_sub_u32 s14, 5308416, s3
    s_mul_i32 s3, s15, 36864
    s_add_u32 s72, s72, s3
    s_addc_u32 s73, s73, 0
    s_mov_b32 s74, 0
    s_mov_b32 s75, 0x20000
    s_cmp_lt_u32 s2, 144
    s_cselect_b32 s66, s14, 0
    s_cselect_b32 s70, s14, 0
    s_cselect_b32 s74, 36864, 0
    s_mov_b32 s82, 2359296
    s_mov_b32 s83, 0x20000
    v_lshrrev_b32 v13, 4, v0
    v_lshlrev_b32 v9, 6, v13
    v_lshrrev_b32 v14, 2, v0
    v_mul_u32_u24 v14, 1056, v14
    v_add_u32 v14, 16384, v14
    v_and_b32 v15, 1, v0
    v_lshlrev_b32 v15, 4, v15
    v_add_u32 v3, v14, v15
    v_and_b32 v15, 2, v0
    v_lshl_add_u32 v3, v15, 2, v3
    v_add_u32 v4, 73728, v3
    v_lshrrev_b32 v14, 3, v0
    v_lshlrev_b32 v14, 2, v14
    v_add_u32 v14, v14, v12
    v_mul_u32_u24 v14, 4608, v14
    v_and_b32 v15, 7, v0
    v_lshl_add_u32 v7, v15, 4, v14
    v_lshlrev_b32 v10, 4, v15
    v_lshl_add_u32 v10, v13, 7, v10
    v_bfe_u32 v14, v0, 3, 1
    v_mul_u32_u24 v14, 147456, v14
    v_add_u32 v10, v10, v14
    v_lshrrev_b32 v14, 2, v0
    v_mul_u32_u24 v14, 1056, v14
    v_and_b32 v15, 3, v0
    v_lshl_add_u32 v14, v15, 3, v14
    v_add_u32 v2, 107008, v14
    v_and_b32 v14, 15, v0
    v_mul_u32_u24 v14, 1056, v14
    v_lshrrev_b32 v15, 4, v0
    v_lshl_add_u32 v14, v15, 4, v14
    v_add_u32 v1, 90112, v14
    v_and_b32 v14, 1, v0
    v_cmp_eq_u32 vcc, 0, v14
    v_mov_b32 v11, 0xeeeeeeee
    v_mov_b32 v15, 0x44444444
    v_cndmask_b32 v11, v11, v15, vcc
    v_and_b32 v14, 2, v0
    v_cmp_eq_u32 vcc, 0, v14
    v_mov_b32 v15, 0x3f803f80
    s_nop 0
    v_cndmask_b32 v15, 0, v15, vcc
    v_accvgpr_write_b32 a16, v15
    v_accvgpr_write_b32 a56, -1
    v_accvgpr_write_b32 a17, v15
    v_accvgpr_write_b32 a57, -1
    v_accvgpr_write_b32 a18, v15
    v_accvgpr_write_b32 a58, -1
    v_accvgpr_write_b32 a19, v15
    v_accvgpr_write_b32 a59, -1
    v_accvgpr_write_b32 a0, 0
    v_accvgpr_write_b32 a1, 0
    v_accvgpr_write_b32 a2, 0
    v_accvgpr_write_b32 a3, 0
    v_accvgpr_write_b32 a4, 0
    v_accvgpr_write_b32 a5, 0
    v_accvgpr_write_b32 a6, 0
    v_accvgpr_write_b32 a7, 0
    v_accvgpr_write_b32 a8, 0
    v_accvgpr_write_b32 a9, 0
    v_accvgpr_write_b32 a10, 0
    v_accvgpr_write_b32 a11, 0
    v_accvgpr_write_b32 a12, 0
    v_accvgpr_write_b32 a13, 0
    v_accvgpr_write_b32 a14, 0
    v_accvgpr_write_b32 a15, 0
    s_cmp_ge_u32 s2, 8
    s_cbranch_scc1 L2_noclr2
    s_mul_i32 s14, s2, 32
    s_mov_b64 exec, 1
    s_waitcnt vmcnt(5)
    s_barrier
    buffer_store_dword v60, v156, s[60:63], s14 offen sc1
    s_mov_b64 exec, -1
L2_noclr2:
    s_mov_b64 exec, 0xffff
    buffer_load_dword a63, v165, s[24:27], 0 offen
    s_mov_b64 exec, -1
    s_waitcnt vmcnt(6)
    v_lshlrev_b32 v24, 16, v64
    v_and_b32 v25, 0xffff0000, v64
    v_lshlrev_b32 v26, 16, v65
    v_and_b32 v27, 0xffff0000, v65
    v_lshlrev_b32 v28, 16, v66
    v_and_b32 v29, 0xffff0000, v66
    v_lshlrev_b32 v30, 16, v67
    v_and_b32 v31, 0xffff0000, v67
    v_lshlrev_b32 v32, 16, v68
    v_and_b32 v33, 0xffff0000, v68
    v_lshlrev_b32 v34, 16, v69
    v_and_b32 v35, 0xffff0000, v69
    v_lshlrev_b32 v36, 16, v70
    v_and_b32 v37, 0xffff0000, v70
    v_lshlrev_b32 v38, 16, v71
    v_and_b32 v39, 0xffff0000, v71
    v_lshlrev_b32 v40, 16, v72
    v_and_b32 v41, 0xffff0000, v72
    v_lshlrev_b32 v42, 16, v73
    v_and_b32 v43, 0xffff0000, v73
    v_lshlrev_b32 v44, 16, v74
    v_and_b32 v45, 0xffff0000, v74
    v_lshlrev_b32 v46, 16, v75
    v_and_b32 v47, 0xffff0000, v75
    v_pk_add_f32 v[12:13], v[24:25], v[26:27]
    v_pk_add_f32 v[12:13], v[12:13], v[28:29]
    v_pk_add_f32 v[12:13], v[12:13], v[30:31]
    v_pk_add_f32 v[12:13], v[12:13], v[32:33]
    v_pk_add_f32 v[12:13], v[12:13], v[34:35]
    v_pk_add_f32 v[12:13], v[12:13], v[36:37]
    v_pk_add_f32 v[12:13], v[12:13], v[38:39]
    v_pk_add_f32 v[14:15], v[40:41], v[42:43]
    v_pk_add_f32 v[14:15], v[14:15], v[44:45]
    v_pk_add_f32 v[14:15], v[14:15], v[46:47]
    v_add_f32 v48, v12, v13
    v_add_f32 v14, v14, v15
    v_fmac_f32 v48, 0x3e800000, v14
    s_nop 1
    v_add_f32_dpp v48, v48, v48 row_ror:8 row_mask:0xf bank_mask:0xf
    v_mov_b32 v50, v48
    s_nop 1
    v_permlane16_swap_b32 v50, v48
    v_add_f32 v48, v48, v50
    v_mov_b32 v50, v48
    s_nop 1
    v_permlane32_swap_b32 v50, v48
    v_add_f32 v48, v48, v50
    v_mul_f32 v48, 0x3be38e39, v48
    v_pk_add_f32 v[24:25], v[24:25], v[48:49] op_sel_hi:[1,0] neg_lo:[0,1] neg_hi:[0,1]
    v_pk_add_f32 v[26:27], v[26:27], v[48:49] op_sel_hi:[1,0] neg_lo:[0,1] neg_hi:[0,1]
    v_pk_add_f32 v[28:29], v[28:29], v[48:49] op_sel_hi:[1,0] neg_lo:[0,1] neg_hi:[0,1]
    v_pk_add_f32 v[30:31], v[30:31], v[48:49] op_sel_hi:[1,0] neg_lo:[0,1] neg_hi:[0,1]
    v_pk_add_f32 v[32:33], v[32:33], v[48:49] op_sel_hi:[1,0] neg_lo:[0,1] neg_hi:[0,1]
    v_pk_add_f32 v[34:35], v[34:35], v[48:49] op_sel_hi:[1,0] neg_lo:[0,1] neg_hi:[0,1]
    v_pk_add_f32 v[36:37], v[36:37], v[48:49] op_sel_hi:[1,0] neg_lo:[0,1] neg_hi:[0,1]
    v_pk_add_f32 v[38:39], v[38:39], v[48:49] op_sel_hi:[1,0] neg_lo:[0,1] neg_hi:[0,1]
    v_pk_add_f32 v[40:41], v[40:41], v[48:49] op_sel_hi:[1,0] neg_lo:[0,1] neg_hi:[0,1]
    v_pk_add_f32 v[42:43], v[42:43], v[48:49] op_sel_hi:[1,0] neg_lo:[0,1] neg_hi:[0,1]
    v_pk_add_f32 v[44:45], v[44:45], v[48:49] op_sel_hi:[1,0] neg_lo:[0,1] neg_hi:[0,1]
    v_pk_add_f32 v[46:47], v[46:47], v[48:49] op_sel_hi:[1,0] neg_lo:[0,1] neg_hi:[0,1]
    v_pk_mul_f32 v[12:13], v[24:25], v[24:25]
    v_pk_fma_f32 v[12:13], v[26:27], v[26:27], v[12:13]
    v_pk_fma_f32 v[12:13], v[28:29], v[28:29], v[12:13]
    v_pk_fma_f32 v[12:13], v[30:31], v[30:31], v[12:13]
    v_pk_fma_f32 v[12:13], v[32:33], v[32:33], v[12:13]
    v_pk_fma_f32 v[12:13], v[34:35], v[34:35], v[12:13]
    v_pk_fma_f32 v[12:13], v[36:37], v[36:37], v[12:13]
    v_pk_fma_f32 v[12:13], v[38:39], v[38:39], v[12:13]
    v_pk_mul_f32 v[14:15], v[40:41], v[40:41]
    v_pk_fma_f32 v[14:15], v[42:43], v[42:43], v[14:15]
    v_pk_fma_f32 v[14:15], v[44:45], v[44:45], v[14:15]
    v_pk_fma_f32 v[14:15], v[46:47], v[46:47], v[14:15]
    v_add_f32 v49, v12, v13
    v_add_f32 v14, v14, v15
    v_fmac_f32 v49, 0x3e800000, v14
    s_nop 1
    v_add_f32_dpp v49, v49, v49 row_ror:8 row_mask:0xf bank_mask:0xf
    v_mov_b32 v50, v49
    s_nop 1
    v_permlane16_swap_b32 v50, v49
    v_add_f32 v49, v49, v50
    v_mov_b32 v50, v49
    s_nop 1
    v_permlane32_swap_b32 v50, v49
    v_add_f32 v49, v49, v50
    ds_write_b32 v158, v48
    ds_write_b32 v158, v49 offset:128
    s_waitcnt lgkmcnt(0)
    s_barrier
    ds_read_b128 v[16:19], v157
    ds_read_b128 v[20:23], v157 offset:128
    s_add_u32 s14, s58, 4096
    s_waitcnt lgkmcnt(1)
    v_add_f32 v12, v16, v17
    v_add_f32 v13, v18, v19
    v_add_f32 v12, v12, v13
    v_mul_f32 v12, 0x3e800000, v12
    v_sub_f32 v16, v16, v12
    v_sub_f32 v17, v17, v12
    v_sub_f32 v18, v18, v12
    v_sub_f32 v19, v19, v12
    v_sub_f32 v48, v48, v12
    v_mul_f32 v13, v16, v16
    v_fmac_f32 v13, v17, v17
    v_fmac_f32 v13, v18, v18
    v_fmac_f32 v13, v19, v19
    s_waitcnt lgkmcnt(0)
    v_add_f32 v14, v20, v21
    v_add_f32 v15, v22, v23
    v_add_f32 v14, v14, v15
    v_fmac_f32 v14, 0x43100000, v13
    v_mov_b32 v12, 0x3727c5ac
    v_fmac_f32 v12, 0x3ae38e39, v14
    v_rsq_f32 v12, v12
    s_nop 0
    v_mul_f32 v48, v48, v12
    v_pk_fma_f32 v[24:25], v[24:25], v[12:13], v[48:49] op_sel_hi:[1,0,0]
    v_pk_fma_f32 v[26:27], v[26:27], v[12:13], v[48:49] op_sel_hi:[1,0,0]
    v_pk_fma_f32 v[28:29], v[28:29], v[12:13], v[48:49] op_sel_hi:[1,0,0]
    v_pk_fma_f32 v[30:31], v[30:31], v[12:13], v[48:49] op_sel_hi:[1,0,0]
    v_cvt_pk_f16_f32 v64, v24, v25
    v_cvt_pk_f16_f32 v65, v26, v27
    v_cvt_pk_f16_f32 v66, v28, v29
    v_cvt_pk_f16_f32 v67, v30, v31
    buffer_store_dwordx4 v[64:67], v159, s[84:87], s58 offen offset:0 sc1
    v_pk_fma_f32 v[32:33], v[32:33], v[12:13], v[48:49] op_sel_hi:[1,0,0]
    v_pk_fma_f32 v[34:35], v[34:35], v[12:13], v[48:49] op_sel_hi:[1,0,0]
    v_pk_fma_f32 v[36:37], v[36:37], v[12:13], v[48:49] op_sel_hi:[1,0,0]
    v_pk_fma_f32 v[38:39], v[38:39], v[12:13], v[48:49] op_sel_hi:[1,0,0]
    v_cvt_pk_f16_f32 v68, v32, v33
    v_cvt_pk_f16_f32 v69, v34, v35
    v_cvt_pk_f16_f32 v70, v36, v37
    v_cvt_pk_f16_f32 v71, v38, v39
    buffer_store_dwordx4 v[68:71], v159, s[84:87], s58 offen offset:2048 sc1
    v_pk_fma_f32 v[40:41], v[40:41], v[12:13], v[48:49] op_sel_hi:[1,0,0]
    v_pk_fma_f32 v[42:43], v[42:43], v[12:13], v[48:49] op_sel_hi:[1,0,0]
    v_pk_fma_f32 v[44:45], v[44:45], v[12:13], v[48:49] op_sel_hi:[1,0,0]
    v_pk_fma_f32 v[46:47], v[46:47], v[12:13], v[48:49] op_sel_hi:[1,0,0]
    v_cvt_pk_f16_f32 v72, v40, v41
    v_cvt_pk_f16_f32 v73, v42, v43
    v_cvt_pk_f16_f32 v74, v44, v45
    v_cvt_pk_f16_f32 v75, v46, v47
    s_mov_b64 exec, 0xffff
    buffer_store_dwordx4 v[72:75], v159, s[84:87], s14 offen offset:0 sc1
    buffer_store_dwordx4 v[56:59], v8, s[84:87], s56 offen sc1
    s_mov_b64 exec, 0xff
    buffer_store_dwordx4 v[60:63], v160, s[84:87], s57 offen offset:1024 sc1
    s_mov_b64 exec, -1
    buffer_store_dwordx4 v[60:63], v160, s[84:87], s57 offen sc1
    s_mov_b64 exec, 255
    buffer_load_dword v51, v156, s[60:63], 0 offen sc1
    s_mov_b64 exec, -1
    s_mul_i32 s3, s96, 147456
    s_add_u32 s3, s3, 8392704
    s_add_u32 s88, s12, s3
    s_addc_u32 s89, s13, 0
    s_mov_b32 s90, 143360
    s_mov_b32 s91, 0x20000
    s_waitcnt vmcnt(8)
    v_lshlrev_b32 v40, 16, v148
    v_and_b32 v41, 0xffff0000, v148
    v_lshlrev_b32 v42, 16, v149
    v_and_b32 v43, 0xffff0000, v149
    v_lshlrev_b32 v44, 16, v150
    v_mul_f32 v16, 0xbfb8aa3b, v40
    v_mul_f32 v17, 0xbfb8aa3b, v41
    v_mul_f32 v18, 0xbfb8aa3b, v42
    v_mul_f32 v19, 0xbfb8aa3b, v43
    v_mul_f32 v20, 0xbfb8aa3b, v44
    v_exp_f32 v16, v16
    v_exp_f32 v17, v17
    v_exp_f32 v18, v18
    v_exp_f32 v19, v19
    v_exp_f32 v20, v20
    v_add_f32 v16, 1.0, v16
    v_add_f32 v17, 1.0, v17
    v_add_f32 v18, 1.0, v18
    v_add_f32 v19, 1.0, v19
    v_add_f32 v20, 1.0, v20
    v_rcp_f32 v16, v16
    v_rcp_f32 v17, v17
    v_rcp_f32 v18, v18
    v_rcp_f32 v19, v19
    v_rcp_f32 v20, v20
    v_mul_f32 v24, v40, v16
    v_mul_f32 v26, v41, v17
    v_mul_f32 v28, v42, v18
    v_mul_f32 v30, v43, v19
    v_mul_f32 v32, v44, v20
    v_lshlrev_b32 v12, 16, v128
    v_and_b32 v13, 0xffff0000, v128
    v_pk_mul_f32 v[16:17], v[12:13], v[24:25] op_sel_hi:[1,0]
    v_lshlrev_b32 v14, 16, v129
    v_and_b32 v15, 0xffff0000, v129
    v_pk_mul_f32 v[18:19], v[14:15], v[24:25] op_sel_hi:[1,0]
    v_lshlrev_b32 v12, 16, v130
    v_and_b32 v13, 0xffff0000, v130
    v_pk_mul_f32 v[20:21], v[12:13], v[24:25] op_sel_hi:[1,0]
    v_lshlrev_b32 v14, 16, v131
    v_and_b32 v15, 0xffff0000, v131
    v_pk_mul_f32 v[22:23], v[14:15], v[24:25] op_sel_hi:[1,0]
    v_lshlrev_b32 v12, 16, v132
    v_and_b32 v13, 0xffff0000, v132
    v_pk_fma_f32 v[16:17], v[12:13], v[26:27], v[16:17] op_sel_hi:[1,0,1]
    v_lshlrev_b32 v14, 16, v133
    v_and_b32 v15, 0xffff0000, v133
    v_pk_fma_f32 v[18:19], v[14:15], v[26:27], v[18:19] op_sel_hi:[1,0,1]
    v_lshlrev_b32 v12, 16, v134
    v_and_b32 v13, 0xffff0000, v134
    v_pk_fma_f32 v[20:21], v[12:13], v[26:27], v[20:21] op_sel_hi:[1,0,1]
    v_lshlrev_b32 v14, 16, v135
    v_and_b32 v15, 0xffff0000, v135
    v_pk_fma_f32 v[22:23], v[14:15], v[26:27], v[22:23] op_sel_hi:[1,0,1]
    v_lshlrev_b32 v12, 16, v136
    v_and_b32 v13, 0xffff0000, v136
    v_pk_fma_f32 v[16:17], v[12:13], v[28:29], v[16:17] op_sel_hi:[1,0,1]
    v_lshlrev_b32 v14, 16, v137
    v_and_b32 v15, 0xffff0000, v137
    v_pk_fma_f32 v[18:19], v[14:15], v[28:29], v[18:19] op_sel_hi:[1,0,1]
    v_lshlrev_b32 v12, 16, v138
    v_and_b32 v13, 0xffff0000, v138
    v_pk_fma_f32 v[20:21], v[12:13], v[28:29], v[20:21] op_sel_hi:[1,0,1]
    v_lshlrev_b32 v14, 16, v139
    v_and_b32 v15, 0xffff0000, v139
    v_pk_fma_f32 v[22:23], v[14:15], v[28:29], v[22:23] op_sel_hi:[1,0,1]
    v_lshlrev_b32 v12, 16, v140
    v_and_b32 v13, 0xffff0000, v140
    v_pk_fma_f32 v[16:17], v[12:13], v[30:31], v[16:17] op_sel_hi:[1,0,1]
    v_lshlrev_b32 v14, 16, v141
    v_and_b32 v15, 0xffff0000, v141
    v_pk_fma_f32 v[18:19], v[14:15], v[30:31], v[18:19] op_sel_hi:[1,0,1]
    v_lshlrev_b32 v12, 16, v142
    v_and_b32 v13, 0xffff0000, v142
    v_pk_fma_f32 v[20:21], v[12:13], v[30:31], v[20:21] op_sel_hi:[1,0,1]
    v_lshlrev_b32 v14, 16, v143
    v_and_b32 v15, 0xffff0000, v143
    v_pk_fma_f32 v[22:23], v[14:15], v[30:31], v[22:23] op_sel_hi:[1,0,1]
    v_lshlrev_b32 v12, 16, v144
    v_and_b32 v13, 0xffff0000, v144
    v_pk_fma_f32 v[16:17], v[12:13], v[32:33], v[16:17] op_sel_hi:[1,0,1]
    v_lshlrev_b32 v14, 16, v145
    v_and_b32 v15, 0xffff0000, v145
    v_pk_fma_f32 v[18:19], v[14:15], v[32:33], v[18:19] op_sel_hi:[1,0,1]
    v_lshlrev_b32 v12, 16, v146
    v_and_b32 v13, 0xffff0000, v146
    v_pk_fma_f32 v[20:21], v[12:13], v[32:33], v[20:21] op_sel_hi:[1,0,1]
    v_lshlrev_b32 v14, 16, v147
    v_and_b32 v15, 0xffff0000, v147
    v_pk_fma_f32 v[22:23], v[14:15], v[32:33], v[22:23] op_sel_hi:[1,0,1]
    v_add_f32_dpp v16, v16, v16 row_ror:4 row_mask:0xf bank_mask:0xf
    v_add_f32_dpp v17, v17, v17 row_ror:4 row_mask:0xf bank_mask:0xf
    v_add_f32_dpp v18, v18, v18 row_ror:4 row_mask:0xf bank_mask:0xf
    v_add_f32_dpp v19, v19, v19 row_ror:4 row_mask:0xf bank_mask:0xf
    v_add_f32_dpp v20, v20, v20 row_ror:4 row_mask:0xf bank_mask:0xf
    v_add_f32_dpp v21, v21, v21 row_ror:4 row_mask:0xf bank_mask:0xf
    v_add_f32_dpp v22, v22, v22 row_ror:4 row_mask:0xf bank_mask:0xf
    v_add_f32_dpp v23, v23, v23 row_ror:4 row_mask:0xf bank_mask:0xf
    v_add_f32_dpp v16, v16, v16 row_ror:8 row_mask:0xf bank_mask:0xf
    v_add_f32_dpp v17, v17, v17 row_ror:8 row_mask:0xf bank_mask:0xf
    v_add_f32_dpp v18, v18, v18 row_ror:8 row_mask:0xf bank_mask:0xf
    v_add_f32_dpp v19, v19, v19 row_ror:8 row_mask:0xf bank_mask:0xf
    v_add_f32_dpp v20, v20, v20 row_ror:8 row_mask:0xf bank_mask:0xf
    v_add_f32_dpp v21, v21, v21 row_ror:8 row_mask:0xf bank_mask:0xf
    v_add_f32_dpp v22, v22, v22 row_ror:8 row_mask:0xf bank_mask:0xf
    v_add_f32_dpp v23, v23, v23 row_ror:8 row_mask:0xf bank_mask:0xf
    s_mov_b32 exec_lo, 0xf000f
    s_mov_b32 exec_hi, 0xf000f
    ds_write_b128 v161, v[16:19] offset:16384
    ds_write_b128 v161, v[20:23] offset:16400
    s_mov_b64 exec, 255
    s_waitcnt vmcnt(0)
    v_cmp_eq_u32 vcc, s51, v51
    s_nop 0
    s_cmp_lg_u64 vcc, 0
    s_cbranch_scc1 L2_p0s
L2_p0r:
    s_mov_b64 exec, 1
    s_waitcnt lgkmcnt(0)
    s_barrier
    buffer_store_dword v60, v156, s[84:87], s101 offen sc1
    s_mov_b64 exec, -1
    ds_read_b32 v24, v162 offset:16384
    ds_read_b32 v25, v162 offset:16640
    ds_read_b32 v26, v162 offset:16896
    ds_read_b32 v27, v162 offset:17152
    ds_read_b32 v28, v162 offset:17408
    ds_read_b32 v29, v162 offset:17664
    ds_read_b32 v30, v162 offset:17920
    ds_read_b32 v31, v162 offset:18176
    s_waitcnt lgkmcnt(0)
    v_pk_add_f32 v[24:25], v[24:25], v[26:27]
    v_pk_add_f32 v[28:29], v[28:29], v[30:31]
    v_pk_add_f32 v[24:25], v[24:25], v[28:29]
    v_add_f32 v52, v24, v25
    v_mov_b32 v53, v52
    v_mov_b32 v54, s48
    s_nop 0
    v_permlane32_swap_b32 v53, v52
    v_add_f32 v52, v52, v53
    v_fma_f32 v52, v52, s47, v54
    v_min_u32 v52, -2, v52
    s_mov_b32 exec_hi, 0
    buffer_store_dword v52, v164, s[84:87], s100 offen sc1
    s_mov_b64 exec, -1
    s_add_u32 m0, s44, 36864
    s_mov_b32 s45, 0
    buffer_load_dwordx4 v6, s[24:27], s45 offen lds
    s_add_u32 m0, s44, 37920
    s_mov_b32 s45, 8192
    buffer_load_dwordx4 v6, s[24:27], s45 offen lds
    s_add_u32 m0, s44, 38976
    s_mov_b32 s45, 16384
    buffer_load_dwordx4 v6, s[24:27], s45 offen lds
    s_add_u32 m0, s44, 40032
    s_mov_b32 s45, 24576
    buffer_load_dwordx4 v6, s[24:27], s45 offen lds
    s_add_u32 m0, s44, 53760
    s_mov_b32 s45, 262144
    buffer_load_dwordx4 v6, s[24:27], s45 offen lds
    s_add_u32 m0, s44, 54816
    s_mov_b32 s45, 270336
    buffer_load_dwordx4 v6, s[24:27], s45 offen lds
    s_add_u32 m0, s44, 55872
    s_mov_b32 s45, 278528
    buffer_load_dwordx4 v6, s[24:27], s45 offen lds
    s_add_u32 m0, s44, 56928
    s_mov_b32 s45, 286720
    buffer_load_dwordx4 v6, s[24:27], s45 offen lds
    s_add_u32 m0, s44, 73728
    s_mov_b32 s45, 524288
    buffer_load_dwordx4 v6, s[24:27], s45 offen lds
    s_add_u32 m0, s44, 74784
    s_mov_b32 s45, 532480
    buffer_load_dwordx4 v6, s[24:27], s45 offen lds
    s_add_u32 m0, s44, 75840
    s_mov_b32 s45, 540672
    buffer_load_dwordx4 v6, s[24:27], s45 offen lds
    s_add_u32 m0, s44, 76896
    s_mov_b32 s45, 548864
    buffer_load_dwordx4 v6, s[24:27], s45 offen lds
    s_add_u32 m0, s44, 90624
    s_mov_b32 s45, 786432
    buffer_load_dwordx4 v6, s[24:27], s45 offen lds
    s_add_u32 m0, s44, 91680
    s_mov_b32 s45, 794624
    buffer_load_dwordx4 v6, s[24:27], s45 offen lds
    s_add_u32 m0, s44, 92736
    s_mov_b32 s45, 802816
    buffer_load_dwordx4 v6, s[24:27], s45 offen lds
    s_add_u32 m0, s44, 93792
    s_mov_b32 s45, 811008
    buffer_load_dwordx4 v6, s[24:27], s45 offen lds
    s_mov_b64 exec, 0
    s_cmp_eq_u32 s51, 0
    s_cbranch_scc1 L2_pad0
    s_cmp_eq_u32 s51, 1
    s_cbranch_scc1 L2_pad1
    s_cmp_eq_u32 s51, 2
    s_cbranch_scc1 L2_pad2
    s_branch L2_pad3
.p2align 12
L2_walkret:
    s_mov_b64 exec, 15
    buffer_load_dword v12, v163, s[84:87], s59 offen sc1
    s_mov_b64 exec, -1
    s_movk_i32 s14, 13824
    buffer_load_dwordx4 v[168:171], v166, s[84:87], 0 offen sc1
    buffer_load_dwordx4 v[176:179], v166, s[84:87], s14 offen sc1
    s_mov_b64 exec, 0xff
    buffer_load_dwordx4 v[172:175], v166, s[84:87], 0 offen offset:1024 sc1
    buffer_load_dwordx4 v[180:183], v166, s[84:87], s14 offen offset:1024 sc1
    s_mov_b64 exec, -1
    s_mov_b64 exec, 15
    s_waitcnt vmcnt(4)
    v_cmp_eq_u32 vcc, 0, v12
    s_nop 0
    s_cmp_eq_u64 vcc, 0
    s_cbranch_scc1 L2_px_ok
    s_mov_b32 s97, 0x20000
L2_px:
    buffer_load_dword v12, v163, s[84:87], s59 offen sc1
    s_waitcnt vmcnt(0)
    v_cmp_eq_u32 vcc, 0, v12
    s_sub_u32 s97, s97, 1
    s_cselect_b64 vcc, 0, vcc
    s_cmp_eq_u64 vcc, 0
    s_cbranch_scc1 L2_px_ok
    s_branch L2_px
L2_px_ok:
    s_mov_b64 exec, -1
    s_mov_b32 s54, 0
    buffer_load_dwordx4 v[80:83], off, s[32:35], s54 sc1
    s_mov_b32 s54, 1024
    buffer_load_dwordx4 v[84:87], off, s[32:35], s54 sc1
    s_mov_b32 s54, 18432
    buffer_load_dwordx4 v[88:91], off, s[32:35], s54 sc1
    s_mov_b32 s54, 19456
    buffer_load_dwordx4 v[92:95], off, s[32:35], s54 sc1
    s_mov_b32 s54, 2048
    buffer_load_dwordx4 v[96:99], off, s[32:35], s54 sc1
    s_mov_b32 s54, 3072
    buffer_load_dwordx4 v[100:103], off, s[32:35], s54 sc1
    s_mov_b32 s54, 20480
    buffer_load_dwordx4 v[104:107], off, s[32:35], s54 sc1
    s_mov_b32 s54, 21504
    buffer_load_dwordx4 v[108:111], off, s[32:35], s54 sc1
    s_waitcnt vmcnt(8)
    v_max_u32 v13, v168, v169
    v_max3_u32 v13, v13, v170, v171
    v_max3_u32 v13, v13, v172, v173
    v_max3_u32 v13, v13, v174, v175
    v_max3_u32 v13, v13, v176, v177
    v_max3_u32 v13, v13, v178, v179
    v_max3_u32 v13, v13, v180, v181
    v_max3_u32 v13, v13, v182, v183
    v_cmp_eq_u32 vcc, -1, v13
    s_nop 0
    s_cmp_lg_u64 vcc, 0
    s_cbranch_scc1 L2_pms
L2_pmr:
    v_pk_add_f32 v[168:169], v[168:169], v[176:177]
    v_pk_add_f32 v[170:171], v[170:171], v[178:179]
    v_pk_add_f32 v[172:173], v[172:173], v[180:181]
    v_pk_add_f32 v[174:175], v[174:175], v[182:183]
    ds_write_b128 v167, v[168:171]
    s_mov_b64 exec, 0xff
    ds_write_b128 v167, v[172:175] offset:2048
    s_mov_b64 exec, -1
    s_waitcnt lgkmcnt(0)
    s_barrier
    ds_read_b128 v[16:19], v9 offset:9216
    ds_read_b128 v[20:23], v9 offset:9248
    ds_read_b128 v[24:27], v9 offset:9232
    ds_read_b128 v[28:31], v9 offset:9264
    s_mov_b32 s54, 4096
    buffer_load_dwordx4 v[112:115], off, s[32:35], s54 sc1
    s_mov_b32 s54, 5120
    buffer_load_dwordx4 v[116:119], off, s[32:35], s54 sc1
    s_mov_b32 s54, 22528
    buffer_load_dwordx4 v[120:123], off, s[32:35], s54 sc1
    s_mov_b32 s54, 23552
    buffer_load_dwordx4 v[124:127], off, s[32:35], s54 sc1
    s_waitcnt vmcnt(8)
    s_waitcnt lgkmcnt(2)
    v_fma_mix_f32 v32, v80, v16, v20 op_sel:[0,0,0] op_sel_hi:[1,0,0]
    v_fma_mix_f32 v33, v80, v17, v21 op_sel:[1,0,0] op_sel_hi:[1,0,0]
    v_fma_mix_f32 v34, v81, v18, v22 op_sel:[0,0,0] op_sel_hi:[1,0,0]
    v_fma_mix_f32 v35, v81, v19, v23 op_sel:[1,0,0] op_sel_hi:[1,0,0]
    v_cvt_pk_bf16_f32 v80, v32, v33
    v_cvt_pk_bf16_f32 v81, v34, v35
    v_fma_mix_f32 v36, v88, v16, v20 op_sel:[0,0,0] op_sel_hi:[1,0,0]
    v_fma_mix_f32 v37, v88, v17, v21 op_sel:[1,0,0] op_sel_hi:[1,0,0]
    v_fma_mix_f32 v38, v89, v18, v22 op_sel:[0,0,0] op_sel_hi:[1,0,0]
    v_fma_mix_f32 v39, v89, v19, v23 op_sel:[1,0,0] op_sel_hi:[1,0,0]
    v_cvt_pk_bf16_f32 v88, v36, v37
    v_cvt_pk_bf16_f32 v89, v38, v39
    ds_read_b128 v[16:19], v9 offset:9472
    ds_read_b128 v[20:23], v9 offset:9504
    s_waitcnt lgkmcnt(2)
    v_fma_mix_f32 v32, v82, v24, v28 op_sel:[0,0,0] op_sel_hi:[1,0,0]
    v_fma_mix_f32 v33, v82, v25, v29 op_sel:[1,0,0] op_sel_hi:[1,0,0]
    v_fma_mix_f32 v34, v83, v26, v30 op_sel:[0,0,0] op_sel_hi:[1,0,0]
    v_fma_mix_f32 v35, v83, v27, v31 op_sel:[1,0,0] op_sel_hi:[1,0,0]
    v_cvt_pk_bf16_f32 v82, v32, v33
    v_cvt_pk_bf16_f32 v83, v34, v35
    v_fma_mix_f32 v36, v90, v24, v28 op_sel:[0,0,0] op_sel_hi:[1,0,0]
    v_fma_mix_f32 v37, v90, v25, v29 op_sel:[1,0,0] op_sel_hi:[1,0,0]
    v_fma_mix_f32 v38, v91, v26, v30 op_sel:[0,0,0] op_sel_hi:[1,0,0]
    v_fma_mix_f32 v39, v91, v27, v31 op_sel:[1,0,0] op_sel_hi:[1,0,0]
    v_cvt_pk_bf16_f32 v90, v36, v37
    v_cvt_pk_bf16_f32 v91, v38, v39
    ds_read_b128 v[24:27], v9 offset:9488
    ds_read_b128 v[28:31], v9 offset:9520
    s_waitcnt lgkmcnt(2)
    v_fma_mix_f32 v32, v84, v16, v20 op_sel:[0,0,0] op_sel_hi:[1,0,0]
    v_fma_mix_f32 v33, v84, v17, v21 op_sel:[1,0,0] op_sel_hi:[1,0,0]
    v_fma_mix_f32 v34, v85, v18, v22 op_sel:[0,0,0] op_sel_hi:[1,0,0]
    v_fma_mix_f32 v35, v85, v19, v23 op_sel:[1,0,0] op_sel_hi:[1,0,0]
    v_cvt_pk_bf16_f32 v84, v32, v33
    v_cvt_pk_bf16_f32 v85, v34, v35
    v_fma_mix_f32 v36, v92, v16, v20 op_sel:[0,0,0] op_sel_hi:[1,0,0]
    v_fma_mix_f32 v37, v92, v17, v21 op_sel:[1,0,0] op_sel_hi:[1,0,0]
    v_fma_mix_f32 v38, v93, v18, v22 op_sel:[0,0,0] op_sel_hi:[1,0,0]
    v_fma_mix_f32 v39, v93, v19, v23 op_sel:[1,0,0] op_sel_hi:[1,0,0]
    v_cvt_pk_bf16_f32 v92, v36, v37
    v_cvt_pk_bf16_f32 v93, v38, v39
    ds_read_b128 v[16:19], v9 offset:9728
    ds_read_b128 v[20:23], v9 offset:9760
    ds_read_b64_tr_b16 a[192:193], v3 offset:36864
    ds_read_b64_tr_b16 a[194:195], v3 offset:37376
    ds_read_b64_tr_b16 a[196:197], v3 offset:53760
    ds_read_b64_tr_b16 a[198:199], v3 offset:54272
    ds_read_b64_tr_b16 a[200:201], v3 offset:36896
    ds_read_b64_tr_b16 a[202:203], v3 offset:37408
    ds_read_b64_tr_b16 a[204:205], v3 offset:53792
    ds_read_b64_tr_b16 a[206:207], v3 offset:54304
    ds_read_b64_tr_b16 a[208:209], v3 offset:36928
    ds_read_b64_tr_b16 a[210:211], v3 offset:37440
    ds_read_b64_tr_b16 a[212:213], v3 offset:53824
    ds_read_b64_tr_b16 a[214:215], v3 offset:54336
    s_waitcnt lgkmcnt(14)
    v_fma_mix_f32 v32, v86, v24, v28 op_sel:[0,0,0] op_sel_hi:[1,0,0]
    v_fma_mix_f32 v33, v86, v25, v29 op_sel:[1,0,0] op_sel_hi:[1,0,0]
    v_fma_mix_f32 v34, v87, v26, v30 op_sel:[0,0,0] op_sel_hi:[1,0,0]
    v_fma_mix_f32 v35, v87, v27, v31 op_sel:[1,0,0] op_sel_hi:[1,0,0]
    v_cvt_pk_bf16_f32 v86, v32, v33
    v_cvt_pk_bf16_f32 v87, v34, v35
    v_fma_mix_f32 v36, v94, v24, v28 op_sel:[0,0,0] op_sel_hi:[1,0,0]
    v_fma_mix_f32 v37, v94, v25, v29 op_sel:[1,0,0] op_sel_hi:[1,0,0]
    v_fma_mix_f32 v38, v95, v26, v30 op_sel:[0,0,0] op_sel_hi:[1,0,0]
    v_fma_mix_f32 v39, v95, v27, v31 op_sel:[1,0,0] op_sel_hi:[1,0,0]
    v_cvt_pk_bf16_f32 v94, v36, v37
    v_cvt_pk_bf16_f32 v95, v38, v39
    s_waitcnt lgkmcnt(8)
    v_mfma_f32_16x16x32_bf16 v[128:131], a[192:195], v[80:83], 0
    s_waitcnt vmcnt(4)
    ds_read_b64_tr_b16 a[216:217], v3 offset:36960
    ds_read_b128 v[24:27], v9 offset:9744
    v_mfma_f32_16x16x32_bf16 v[128:131], a[196:199], v[84:87], v[128:131]
    ds_read_b64_tr_b16 a[218:219], v3 offset:37472
    ds_read_b64_tr_b16 a[220:221], v3 offset:53856
    v_fma_mix_f32 v32, v96, v16, v20 op_sel:[0,0,0] op_sel_hi:[1,0,0]
    v_mfma_f32_16x16x32_bf16 v[160:163], a[192:195], v[88:91], 0
    s_add_u32 m0, s44, 110592
    ds_read_b64_tr_b16 a[222:223], v3 offset:54368
    ds_read_b128 v[28:31], v9 offset:9776
    v_mfma_f32_16x16x32_bf16 v[160:163], a[196:199], v[92:95], v[160:163]
    s_mov_b32 s45, 1048576
    s_waitcnt lgkmcnt(10)
    buffer_load_dwordx4 v6, s[24:27], s45 offen lds
    v_mfma_f32_16x16x32_bf16 v[132:135], a[200:203], v[80:83], 0
    ds_read_b64_tr_b16 a[224:225], v3 offset:36992
    v_fma_mix_f32 v33, v96, v17, v21 op_sel:[1,0,0] op_sel_hi:[1,0,0]
    v_mfma_f32_16x16x32_bf16 v[132:135], a[204:207], v[84:87], v[132:135]
    ds_read_b64_tr_b16 a[226:227], v3 offset:37504
    ds_read_b64_tr_b16 a[228:229], v3 offset:53888
    v_fma_mix_f32 v34, v97, v18, v22 op_sel:[0,0,0] op_sel_hi:[1,0,0]
    v_mfma_f32_16x16x32_bf16 v[164:167], a[200:203], v[88:91], 0
    s_add_u32 m0, s44, 111648
    ds_read_b64_tr_b16 a[230:231], v3 offset:54400
    v_fma_mix_f32 v35, v97, v19, v23 op_sel:[1,0,0] op_sel_hi:[1,0,0]
    v_mfma_f32_16x16x32_bf16 v[164:167], a[204:207], v[92:95], v[164:167]
    s_mov_b32 s45, 1056768
    s_waitcnt lgkmcnt(10)
    buffer_load_dwordx4 v6, s[24:27], s45 offen lds
    v_mfma_f32_16x16x32_bf16 v[136:139], a[208:211], v[80:83], 0
    ds_read_b64_tr_b16 a[232:233], v3 offset:37024
    v_cvt_pk_bf16_f32 v96, v32, v33
    v_mfma_f32_16x16x32_bf16 v[136:139], a[212:215], v[84:87], v[136:139]
    ds_read_b64_tr_b16 a[234:235], v3 offset:37536
    ds_read_b64_tr_b16 a[236:237], v3 offset:53920
    v_cvt_pk_bf16_f32 v97, v34, v35
    v_mfma_f32_16x16x32_bf16 v[168:171], a[208:211], v[88:91], 0
    s_add_u32 m0, s44, 112704
    ds_read_b64_tr_b16 a[238:239], v3 offset:54432
    v_fma_mix_f32 v36, v104, v16, v20 op_sel:[0,0,0] op_sel_hi:[1,0,0]
    v_mfma_f32_16x16x32_bf16 v[168:171], a[212:215], v[92:95], v[168:171]
    s_mov_b32 s45, 1064960
    s_waitcnt lgkmcnt(9)
    buffer_load_dwordx4 v6, s[24:27], s45 offen lds
    v_fma_mix_f32 v37, v104, v17, v21 op_sel:[1,0,0] op_sel_hi:[1,0,0]
    v_mfma_f32_16x16x32_bf16 v[140:143], a[216:219], v[80:83], 0
    ds_read_b64_tr_b16 a[240:241], v3 offset:37056
    v_fma_mix_f32 v38, v105, v18, v22 op_sel:[0,0,0] op_sel_hi:[1,0,0]
    v_mfma_f32_16x16x32_bf16 v[140:143], a[220:223], v[84:87], v[140:143]
    ds_read_b64_tr_b16 a[242:243], v3 offset:37568
    ds_read_b64_tr_b16 a[244:245], v3 offset:53952
    v_fma_mix_f32 v39, v105, v19, v23 op_sel:[1,0,0] op_sel_hi:[1,0,0]
    v_mfma_f32_16x16x32_bf16 v[172:175], a[216:219], v[88:91], 0
    s_add_u32 m0, s44, 113760
    ds_read_b64_tr_b16 a[246:247], v3 offset:54464
    v_cvt_pk_bf16_f32 v104, v36, v37
    v_mfma_f32_16x16x32_bf16 v[172:175], a[220:223], v[92:95], v[172:175]
    s_mov_b32 s45, 1073152
    s_waitcnt lgkmcnt(8)
    buffer_load_dwordx4 v6, s[24:27], s45 offen lds
    v_cvt_pk_bf16_f32 v105, v38, v39
    v_mfma_f32_16x16x32_bf16 v[144:147], a[224:227], v[80:83], 0
    ds_read_b64_tr_b16 a[248:249], v3 offset:37088
    ds_read_b128 v[16:19], v9 offset:9984
    v_mfma_f32_16x16x32_bf16 v[144:147], a[228:231], v[84:87], v[144:147]
    ds_read_b64_tr_b16 a[250:251], v3 offset:37600
    ds_read_b64_tr_b16 a[252:253], v3 offset:53984
    v_fma_mix_f32 v32, v98, v24, v28 op_sel:[0,0,0] op_sel_hi:[1,0,0]
    v_mfma_f32_16x16x32_bf16 v[176:179], a[224:227], v[88:91], 0
    s_add_u32 m0, s44, 127488
    ds_read_b64_tr_b16 a[254:255], v3 offset:54496
    ds_read_b128 v[20:23], v9 offset:10016
    v_mfma_f32_16x16x32_bf16 v[176:179], a[228:231], v[92:95], v[176:179]
    s_mov_b32 s45, 1310720
    s_waitcnt lgkmcnt(10)
    buffer_load_dwordx4 v6, s[24:27], s45 offen lds
    v_mfma_f32_16x16x32_bf16 v[148:151], a[232:235], v[80:83], 0
    ds_read_b64_tr_b16 a[192:193], v3 offset:37120
    v_fma_mix_f32 v33, v98, v25, v29 op_sel:[1,0,0] op_sel_hi:[1,0,0]
    v_mfma_f32_16x16x32_bf16 v[148:151], a[236:239], v[84:87], v[148:151]
    ds_read_b64_tr_b16 a[194:195], v3 offset:37632
    ds_read_b64_tr_b16 a[196:197], v3 offset:54016
    v_fma_mix_f32 v34, v99, v26, v30 op_sel:[0,0,0] op_sel_hi:[1,0,0]
    v_mfma_f32_16x16x32_bf16 v[180:183], a[232:235], v[88:91], 0
    s_add_u32 m0, s44, 128544
    ds_read_b64_tr_b16 a[198:199], v3 offset:54528
    v_fma_mix_f32 v35, v99, v27, v31 op_sel:[1,0,0] op_sel_hi:[1,0,0]
    v_mfma_f32_16x16x32_bf16 v[180:183], a[236:239], v[92:95], v[180:183]
    s_mov_b32 s45, 1318912
    s_waitcnt lgkmcnt(10)
    buffer_load_dwordx4 v6, s[24:27], s45 offen lds
    v_mfma_f32_16x16x32_bf16 v[152:155], a[240:243], v[80:83], 0
    ds_read_b64_tr_b16 a[200:201], v3 offset:37152
    v_cvt_pk_bf16_f32 v98, v32, v33
    v_mfma_f32_16x16x32_bf16 v[152:155], a[244:247], v[84:87], v[152:155]
    ds_read_b64_tr_b16 a[202:203], v3 offset:37664
    ds_read_b64_tr_b16 a[204:205], v3 offset:54048
    v_cvt_pk_bf16_f32 v99, v34, v35
    v_mfma_f32_16x16x32_bf16 v[184:187], a[240:243], v[88:91], 0
    s_add_u32 m0, s44, 129600
    ds_read_b64_tr_b16 a[206:207], v3 offset:54560
    v_fma_mix_f32 v36, v106, v24, v28 op_sel:[0,0,0] op_sel_hi:[1,0,0]
    v_mfma_f32_16x16x32_bf16 v[184:187], a[244:247], v[92:95], v[184:187]
    s_mov_b32 s45, 1327104
    s_waitcnt lgkmcnt(9)
    buffer_load_dwordx4 v6, s[24:27], s45 offen lds
    v_fma_mix_f32 v37, v106, v25, v29 op_sel:[1,0,0] op_sel_hi:[1,0,0]
    v_mfma_f32_16x16x32_bf16 v[156:159], a[248:251], v[80:83], 0
    ds_read_b64_tr_b16 a[208:209], v3 offset:37184
    v_fma_mix_f32 v38, v107, v26, v30 op_sel:[0,0,0] op_sel_hi:[1,0,0]
    v_mfma_f32_16x16x32_bf16 v[156:159], a[252:255], v[84:87], v[156:159]
    ds_read_b64_tr_b16 a[210:211], v3 offset:37696
    ds_read_b64_tr_b16 a[212:213], v3 offset:54080
    v_fma_mix_f32 v39, v107, v27, v31 op_sel:[1,0,0] op_sel_hi:[1,0,0]
    v_mfma_f32_16x16x32_bf16 v[188:191], a[248:251], v[88:91], 0
    s_add_u32 m0, s44, 130656
    ds_read_b64_tr_b16 a[214:215], v3 offset:54592
    v_cvt_pk_bf16_f32 v106, v36, v37
    v_mfma_f32_16x16x32_bf16 v[188:191], a[252:255], v[92:95], v[188:191]
    s_mov_b32 s45, 1335296
    s_waitcnt lgkmcnt(8)
    buffer_load_dwordx4 v6, s[24:27], s45 offen lds
    v_cvt_pk_bf16_f32 v107, v38, v39
    v_mfma_f32_16x16x32_bf16 v[192:195], a[192:195], v[80:83], 0
    ds_read_b64_tr_b16 a[216:217], v3 offset:37216
    ds_read_b128 v[24:27], v9 offset:10000
    v_mfma_f32_16x16x32_bf16 v[192:195], a[196:199], v[84:87], v[192:195]
    ds_read_b64_tr_b16 a[218:219], v3 offset:37728
    ds_read_b64_tr_b16 a[220:221], v3 offset:54112
    v_fma_mix_f32 v32, v100, v16, v20 op_sel:[0,0,0] op_sel_hi:[1,0,0]
    v_mfma_f32_16x16x32_bf16 v[224:227], a[192:195], v[88:91], 0
    s_mov_b32 s54, 6144
    ds_read_b64_tr_b16 a[222:223], v3 offset:54624
    ds_read_b128 v[28:31], v9 offset:10032
    v_mfma_f32_16x16x32_bf16 v[224:227], a[196:199], v[92:95], v[224:227]
    s_waitcnt lgkmcnt(10)
    buffer_load_dwordx4 v[48:51], off, s[32:35], s54 sc1
    v_mfma_f32_16x16x32_bf16 v[196:199], a[200:203], v[80:83], 0
    ds_read_b64_tr_b16 a[224:225], v3 offset:37248
    v_fma_mix_f32 v33, v100, v17, v21 op_sel:[1,0,0] op_sel_hi:[1,0,0]
    v_mfma_f32_16x16x32_bf16 v[196:199], a[204:207], v[84:87], v[196:199]
    ds_read_b64_tr_b16 a[226:227], v3 offset:37760
    ds_read_b64_tr_b16 a[228:229], v3 offset:54144
    v_fma_mix_f32 v34, v101, v18, v22 op_sel:[0,0,0] op_sel_hi:[1,0,0]
    v_mfma_f32_16x16x32_bf16 v[228:231], a[200:203], v[88:91], 0
    s_mov_b32 s54, 7168
    ds_read_b64_tr_b16 a[230:231], v3 offset:54656
    v_fma_mix_f32 v35, v101, v19, v23 op_sel:[1,0,0] op_sel_hi:[1,0,0]
    v_mfma_f32_16x16x32_bf16 v[228:231], a[204:207], v[92:95], v[228:231]
    s_waitcnt lgkmcnt(10)
    buffer_load_dwordx4 v[52:55], off, s[32:35], s54 sc1
    v_mfma_f32_16x16x32_bf16 v[200:203], a[208:211], v[80:83], 0
    ds_read_b64_tr_b16 a[232:233], v3 offset:37280
    v_cvt_pk_bf16_f32 v100, v32, v33
    v_mfma_f32_16x16x32_bf16 v[200:203], a[212:215], v[84:87], v[200:203]
    ds_read_b64_tr_b16 a[234:235], v3 offset:37792
    ds_read_b64_tr_b16 a[236:237], v3 offset:54176
    v_cvt_pk_bf16_f32 v101, v34, v35
    v_mfma_f32_16x16x32_bf16 v[232:235], a[208:211], v[88:91], 0
    s_mov_b32 s54, 24576
    ds_read_b64_tr_b16 a[238:239], v3 offset:54688
    v_fma_mix_f32 v36, v108, v16, v20 op_sel:[0,0,0] op_sel_hi:[1,0,0]
    v_mfma_f32_16x16x32_bf16 v[232:235], a[212:215], v[92:95], v[232:235]
    s_waitcnt lgkmcnt(9)
    buffer_load_dwordx4 v[56:59], off, s[32:35], s54 sc1
    v_fma_mix_f32 v37, v108, v17, v21 op_sel:[1,0,0] op_sel_hi:[1,0,0]
    v_mfma_f32_16x16x32_bf16 v[204:207], a[216:219], v[80:83], 0
    ds_read_b64_tr_b16 a[240:241], v3 offset:37312
    v_fma_mix_f32 v38, v109, v18, v22 op_sel:[0,0,0] op_sel_hi:[1,0,0]
    v_mfma_f32_16x16x32_bf16 v[204:207], a[220:223], v[84:87], v[204:207]
    ds_read_b64_tr_b16 a[242:243], v3 offset:37824
    ds_read_b64_tr_b16 a[244:245], v3 offset:54208
    v_fma_mix_f32 v39, v109, v19, v23 op_sel:[1,0,0] op_sel_hi:[1,0,0]
    v_mfma_f32_16x16x32_bf16 v[236:239], a[216:219], v[88:91], 0
    s_mov_b32 s54, 25600
    ds_read_b64_tr_b16 a[246:247], v3 offset:54720
    v_cvt_pk_bf16_f32 v108, v36, v37
    v_mfma_f32_16x16x32_bf16 v[236:239], a[220:223], v[92:95], v[236:239]
    s_waitcnt lgkmcnt(8)
    buffer_load_dwordx4 v[60:63], off, s[32:35], s54 sc1
    v_cvt_pk_bf16_f32 v109, v38, v39
    v_mfma_f32_16x16x32_bf16 v[208:211], a[224:227], v[80:83], 0
    ds_read_b64_tr_b16 a[248:249], v3 offset:37344
    ds_read_b128 v[16:19], v9 offset:10240
    v_mfma_f32_16x16x32_bf16 v[208:211], a[228:231], v[84:87], v[208:211]
    ds_read_b64_tr_b16 a[250:251], v3 offset:37856
    ds_read_b128 v[20:23], v9 offset:10272
    v_mfma_f32_16x16x32_bf16 v[240:243], a[224:227], v[88:91], 0
    ds_read_b64_tr_b16 a[252:253], v3 offset:54240
    v_fma_mix_f32 v32, v102, v24, v28 op_sel:[0,0,0] op_sel_hi:[1,0,0]
    v_mfma_f32_16x16x32_bf16 v[240:243], a[228:231], v[92:95], v[240:243]
    s_barrier
    s_waitcnt lgkmcnt(9)
    ds_read_b64_tr_b16 a[254:255], v3 offset:54752
    v_fma_mix_f32 v33, v102, v25, v29 op_sel:[1,0,0] op_sel_hi:[1,0,0]
    v_fma_mix_f32 v34, v103, v26, v30 op_sel:[0,0,0] op_sel_hi:[1,0,0]
    v_mfma_f32_16x16x32_bf16 v[212:215], a[232:235], v[80:83], 0
    ds_read_b64_tr_b16 a[192:193], v4 offset:0
    v_fma_mix_f32 v35, v103, v27, v31 op_sel:[1,0,0] op_sel_hi:[1,0,0]
    v_mfma_f32_16x16x32_bf16 v[212:215], a[236:239], v[84:87], v[212:215]
    ds_read_b64_tr_b16 a[194:195], v4 offset:512
    ds_read_b64_tr_b16 a[196:197], v4 offset:16896
    v_cvt_pk_bf16_f32 v102, v32, v33
    v_mfma_f32_16x16x32_bf16 v[244:247], a[232:235], v[88:91], 0
    s_add_u32 m0, s44, 0
    ds_read_b64_tr_b16 a[198:199], v4 offset:17408
    v_cvt_pk_bf16_f32 v103, v34, v35
    v_mfma_f32_16x16x32_bf16 v[244:247], a[236:239], v[92:95], v[244:247]
    s_mov_b32 s45, 1572864
    s_waitcnt lgkmcnt(10)
    buffer_load_dwordx4 v6, s[24:27], s45 offen lds
    v_mfma_f32_16x16x32_bf16 v[216:219], a[240:243], v[80:83], 0
    ds_read_b64_tr_b16 a[200:201], v4 offset:32
    v_fma_mix_f32 v36, v110, v24, v28 op_sel:[0,0,0] op_sel_hi:[1,0,0]
    v_mfma_f32_16x16x32_bf16 v[216:219], a[244:247], v[84:87], v[216:219]
    ds_read_b64_tr_b16 a[202:203], v4 offset:544
    ds_read_b64_tr_b16 a[204:205], v4 offset:16928
    v_fma_mix_f32 v37, v110, v25, v29 op_sel:[1,0,0] op_sel_hi:[1,0,0]
    v_mfma_f32_16x16x32_bf16 v[248:251], a[240:243], v[88:91], 0
    s_add_u32 m0, s44, 1056
    ds_read_b64_tr_b16 a[206:207], v4 offset:17440
    v_fma_mix_f32 v38, v111, v26, v30 op_sel:[0,0,0] op_sel_hi:[1,0,0]
    v_mfma_f32_16x16x32_bf16 v[248:251], a[244:247], v[92:95], v[248:251]
    s_mov_b32 s45, 1581056
    s_waitcnt lgkmcnt(8)
    buffer_load_dwordx4 v6, s[24:27], s45 offen lds
    v_mfma_f32_16x16x32_bf16 v[220:223], a[248:251], v[80:83], 0
    ds_read_b64_tr_b16 a[208:209], v4 offset:64
    v_fma_mix_f32 v39, v111, v27, v31 op_sel:[1,0,0] op_sel_hi:[1,0,0]
    v_mfma_f32_16x16x32_bf16 v[220:223], a[252:255], v[84:87], v[220:223]
    ds_read_b64_tr_b16 a[210:211], v4 offset:576
    ds_read_b64_tr_b16 a[212:213], v4 offset:16960
    v_cvt_pk_bf16_f32 v110, v36, v37
    v_mfma_f32_16x16x32_bf16 v[252:255], a[248:251], v[88:91], 0
    s_add_u32 m0, s44, 2112
    ds_read_b64_tr_b16 a[214:215], v4 offset:17472
    v_cvt_pk_bf16_f32 v111, v38, v39
    v_mfma_f32_16x16x32_bf16 v[252:255], a[252:255], v[92:95], v[252:255]
    s_mov_b32 s45, 1589248
    s_waitcnt lgkmcnt(8)
    buffer_load_dwordx4 v6, s[24:27], s45 offen lds
    v_mfma_f32_16x16x32_bf16 v[128:131], a[192:195], v[96:99], v[128:131]
    s_waitcnt vmcnt(15)
    ds_read_b64_tr_b16 a[216:217], v4 offset:96
    ds_read_b128 v[24:27], v9 offset:10256
    v_mfma_f32_16x16x32_bf16 v[128:131], a[196:199], v[100:103], v[128:131]
    ds_read_b64_tr_b16 a[218:219], v4 offset:608
    ds_read_b64_tr_b16 a[220:221], v4 offset:16992
    v_fma_mix_f32 v32, v112, v16, v20 op_sel:[0,0,0] op_sel_hi:[1,0,0]
    v_mfma_f32_16x16x32_bf16 v[160:163], a[192:195], v[104:107], v[160:163]
    s_add_u32 m0, s44, 3168
    ds_read_b64_tr_b16 a[222:223], v4 offset:17504
    ds_read_b128 v[28:31], v9 offset:10288
    v_mfma_f32_16x16x32_bf16 v[160:163], a[196:199], v[108:111], v[160:163]
    s_mov_b32 s45, 1597440
    s_waitcnt lgkmcnt(10)
    buffer_load_dwordx4 v6, s[24:27], s45 offen lds
    v_mfma_f32_16x16x32_bf16 v[132:135], a[200:203], v[96:99], v[132:135]
    ds_read_b64_tr_b16 a[224:225], v4 offset:128
    v_fma_mix_f32 v33, v112, v17, v21 op_sel:[1,0,0] op_sel_hi:[1,0,0]
    v_mfma_f32_16x16x32_bf16 v[132:135], a[204:207], v[100:103], v[132:135]
    ds_read_b64_tr_b16 a[226:227], v4 offset:640
    ds_read_b64_tr_b16 a[228:229], v4 offset:17024
    v_fma_mix_f32 v34, v113, v18, v22 op_sel:[0,0,0] op_sel_hi:[1,0,0]
    v_mfma_f32_16x16x32_bf16 v[164:167], a[200:203], v[104:107], v[164:167]
    s_add_u32 m0, s44, 16896
    ds_read_b64_tr_b16 a[230:231], v4 offset:17536
    v_fma_mix_f32 v35, v113, v19, v23 op_sel:[1,0,0] op_sel_hi:[1,0,0]
    v_mfma_f32_16x16x32_bf16 v[164:167], a[204:207], v[108:111], v[164:167]
    s_mov_b32 s45, 1835008
    s_waitcnt lgkmcnt(10)
    buffer_load_dwordx4 v6, s[24:27], s45 offen lds
    v_mfma_f32_16x16x32_bf16 v[136:139], a[208:211], v[96:99], v[136:139]
    ds_read_b64_tr_b16 a[232:233], v4 offset:160
    v_cvt_pk_bf16_f32 v112, v32, v33
    v_mfma_f32_16x16x32_bf16 v[136:139], a[212:215], v[100:103], v[136:139]
    ds_read_b64_tr_b16 a[234:235], v4 offset:672
    ds_read_b64_tr_b16 a[236:237], v4 offset:17056
    v_cvt_pk_bf16_f32 v113, v34, v35
    v_mfma_f32_16x16x32_bf16 v[168:171], a[208:211], v[104:107], v[168:171]
    s_add_u32 m0, s44, 17952
    ds_read_b64_tr_b16 a[238:239], v4 offset:17568
    v_fma_mix_f32 v36, v120, v16, v20 op_sel:[0,0,0] op_sel_hi:[1,0,0]
    v_mfma_f32_16x16x32_bf16 v[168:171], a[212:215], v[108:111], v[168:171]
    s_mov_b32 s45, 1843200
    s_waitcnt lgkmcnt(9)
    buffer_load_dwordx4 v6, s[24:27], s45 offen lds
    v_fma_mix_f32 v37, v120, v17, v21 op_sel:[1,0,0] op_sel_hi:[1,0,0]
    v_mfma_f32_16x16x32_bf16 v[140:143], a[216:219], v[96:99], v[140:143]
    ds_read_b64_tr_b16 a[240:241], v4 offset:192
    v_fma_mix_f32 v38, v121, v18, v22 op_sel:[0,0,0] op_sel_hi:[1,0,0]
    v_mfma_f32_16x16x32_bf16 v[140:143], a[220:223], v[100:103], v[140:143]
    ds_read_b64_tr_b16 a[242:243], v4 offset:704
    ds_read_b64_tr_b16 a[244:245], v4 offset:17088
    v_fma_mix_f32 v39, v121, v19, v23 op_sel:[1,0,0] op_sel_hi:[1,0,0]
    v_mfma_f32_16x16x32_bf16 v[172:175], a[216:219], v[104:107], v[172:175]
    s_add_u32 m0, s44, 19008
    ds_read_b64_tr_b16 a[246:247], v4 offset:17600
    v_cvt_pk_bf16_f32 v120, v36, v37
    v_mfma_f32_16x16x32_bf16 v[172:175], a[220:223], v[108:111], v[172:175]
    s_mov_b32 s45, 1851392
    s_waitcnt lgkmcnt(8)
    buffer_load_dwordx4 v6, s[24:27], s45 offen lds
    v_cvt_pk_bf16_f32 v121, v38, v39
    v_mfma_f32_16x16x32_bf16 v[144:147], a[224:227], v[96:99], v[144:147]
    ds_read_b64_tr_b16 a[248:249], v4 offset:224
    ds_read_b128 v[16:19], v9 offset:10496
    v_mfma_f32_16x16x32_bf16 v[144:147], a[228:231], v[100:103], v[144:147]
    ds_read_b64_tr_b16 a[250:251], v4 offset:736
    ds_read_b64_tr_b16 a[252:253], v4 offset:17120
    v_mfma_f32_16x16x32_bf16 v[176:179], a[224:227], v[104:107], v[176:179]
    s_add_u32 m0, s44, 20064
    ds_read_b64_tr_b16 a[254:255], v4 offset:17632
    ds_read_b128 v[20:23], v9 offset:10528
    v_mfma_f32_16x16x32_bf16 v[176:179], a[228:231], v[108:111], v[176:179]
    s_mov_b32 s45, 1859584
    s_waitcnt lgkmcnt(10)
    buffer_load_dwordx4 v6, s[24:27], s45 offen lds
    v_mfma_f32_16x16x32_bf16 v[148:151], a[232:235], v[96:99], v[148:151]
    ds_read_b64_tr_b16 a[192:193], v4 offset:256
    v_fma_mix_f32 v32, v114, v24, v28 op_sel:[0,0,0] op_sel_hi:[1,0,0]
    v_mfma_f32_16x16x32_bf16 v[148:151], a[236:239], v[100:103], v[148:151]
    ds_read_b64_tr_b16 a[194:195], v4 offset:768
    v_fma_mix_f32 v33, v114, v25, v29 op_sel:[1,0,0] op_sel_hi:[1,0,0]
    v_mfma_f32_16x16x32_bf16 v[180:183], a[232:235], v[104:107], v[180:183]
    ds_read_b64_tr_b16 a[196:197], v4 offset:17152
    v_fma_mix_f32 v34, v115, v26, v30 op_sel:[0,0,0] op_sel_hi:[1,0,0]
    v_mfma_f32_16x16x32_bf16 v[180:183], a[236:239], v[108:111], v[180:183]
    s_waitcnt lgkmcnt(9)
    ds_read_b64_tr_b16 a[198:199], v4 offset:17664
    v_fma_mix_f32 v35, v115, v27, v31 op_sel:[1,0,0] op_sel_hi:[1,0,0]
    v_mfma_f32_16x16x32_bf16 v[152:155], a[240:243], v[96:99], v[152:155]
    ds_read_b64_tr_b16 a[200:201], v4 offset:288
    v_cvt_pk_bf16_f32 v114, v32, v33
    v_mfma_f32_16x16x32_bf16 v[152:155], a[244:247], v[100:103], v[152:155]
    ds_read_b64_tr_b16 a[202:203], v4 offset:800
    v_cvt_pk_bf16_f32 v115, v34, v35
    v_mfma_f32_16x16x32_bf16 v[184:187], a[240:243], v[104:107], v[184:187]
    ds_read_b64_tr_b16 a[204:205], v4 offset:17184
    v_fma_mix_f32 v36, v122, v24, v28 op_sel:[0,0,0] op_sel_hi:[1,0,0]
    v_mfma_f32_16x16x32_bf16 v[184:187], a[244:247], v[108:111], v[184:187]
    s_waitcnt lgkmcnt(8)
    ds_read_b64_tr_b16 a[206:207], v4 offset:17696
    v_fma_mix_f32 v37, v122, v25, v29 op_sel:[1,0,0] op_sel_hi:[1,0,0]
    v_mfma_f32_16x16x32_bf16 v[156:159], a[248:251], v[96:99], v[156:159]
    ds_read_b64_tr_b16 a[208:209], v4 offset:320
    v_fma_mix_f32 v38, v123, v26, v30 op_sel:[0,0,0] op_sel_hi:[1,0,0]
    v_mfma_f32_16x16x32_bf16 v[156:159], a[252:255], v[100:103], v[156:159]
    ds_read_b64_tr_b16 a[210:211], v4 offset:832
    v_fma_mix_f32 v39, v123, v27, v31 op_sel:[1,0,0] op_sel_hi:[1,0,0]
    v_mfma_f32_16x16x32_bf16 v[188:191], a[248:251], v[104:107], v[188:191]
    ds_read_b64_tr_b16 a[212:213], v4 offset:17216
    v_cvt_pk_bf16_f32 v122, v36, v37
    v_mfma_f32_16x16x32_bf16 v[188:191], a[252:255], v[108:111], v[188:191]
    s_waitcnt lgkmcnt(7)
    ds_read_b64_tr_b16 a[214:215], v4 offset:17728
    v_cvt_pk_bf16_f32 v123, v38, v39
    v_mfma_f32_16x16x32_bf16 v[192:195], a[192:195], v[96:99], v[192:195]
    ds_read_b64_tr_b16 a[216:217], v4 offset:352
    ds_read_b128 v[24:27], v9 offset:10512
    v_mfma_f32_16x16x32_bf16 v[192:195], a[196:199], v[100:103], v[192:195]
    ds_read_b64_tr_b16 a[218:219], v4 offset:864
    ds_read_b64_tr_b16 a[220:221], v4 offset:17248
    v_fma_mix_f32 v32, v116, v16, v20 op_sel:[0,0,0] op_sel_hi:[1,0,0]
    v_mfma_f32_16x16x32_bf16 v[224:227], a[192:195], v[104:107], v[224:227]
    s_mov_b32 s54, 8192
    ds_read_b64_tr_b16 a[222:223], v4 offset:17760
    ds_read_b128 v[28:31], v9 offset:10544
    v_mfma_f32_16x16x32_bf16 v[224:227], a[196:199], v[108:111], v[224:227]
    s_waitcnt lgkmcnt(10)
    buffer_load_dwordx4 v[64:67], off, s[32:35], s54 sc1
    v_mfma_f32_16x16x32_bf16 v[196:199], a[200:203], v[96:99], v[196:199]
    ds_read_b64_tr_b16 a[224:225], v4 offset:384
    v_fma_mix_f32 v33, v116, v17, v21 op_sel:[1,0,0] op_sel_hi:[1,0,0]
    v_mfma_f32_16x16x32_bf16 v[196:199], a[204:207], v[100:103], v[196:199]
    ds_read_b64_tr_b16 a[226:227], v4 offset:896
    ds_read_b64_tr_b16 a[228:229], v4 offset:17280
    v_fma_mix_f32 v34, v117, v18, v22 op_sel:[0,0,0] op_sel_hi:[1,0,0]
    v_mfma_f32_16x16x32_bf16 v[228:231], a[200:203], v[104:107], v[228:231]
    s_mov_b32 s54, 9216
    ds_read_b64_tr_b16 a[230:231], v4 offset:17792
    v_fma_mix_f32 v35, v117, v19, v23 op_sel:[1,0,0] op_sel_hi:[1,0,0]
    v_mfma_f32_16x16x32_bf16 v[228:231], a[204:207], v[108:111], v[228:231]
    s_waitcnt lgkmcnt(10)
    buffer_load_dwordx4 v[68:71], off, s[32:35], s54 sc1
    v_mfma_f32_16x16x32_bf16 v[200:203], a[208:211], v[96:99], v[200:203]
    ds_read_b64_tr_b16 a[232:233], v4 offset:416
    v_cvt_pk_bf16_f32 v116, v32, v33
    v_mfma_f32_16x16x32_bf16 v[200:203], a[212:215], v[100:103], v[200:203]
    ds_read_b64_tr_b16 a[234:235], v4 offset:928
    ds_read_b64_tr_b16 a[236:237], v4 offset:17312
    v_cvt_pk_bf16_f32 v117, v34, v35
    v_mfma_f32_16x16x32_bf16 v[232:235], a[208:211], v[104:107], v[232:235]
    s_mov_b32 s54, 26624
    ds_read_b64_tr_b16 a[238:239], v4 offset:17824
    v_fma_mix_f32 v36, v124, v16, v20 op_sel:[0,0,0] op_sel_hi:[1,0,0]
    v_mfma_f32_16x16x32_bf16 v[232:235], a[212:215], v[108:111], v[232:235]
    s_waitcnt lgkmcnt(9)
    buffer_load_dwordx4 v[72:75], off, s[32:35], s54 sc1
    v_fma_mix_f32 v37, v124, v17, v21 op_sel:[1,0,0] op_sel_hi:[1,0,0]
L2_pad0:
    s_cbranch_execz L2_pad4
    v_mfma_f32_16x16x32_bf16 v[204:207], a[216:219], v[96:99], v[204:207]
    ds_read_b64_tr_b16 a[240:241], v4 offset:448
    v_fma_mix_f32 v38, v125, v18, v22 op_sel:[0,0,0] op_sel_hi:[1,0,0]
    v_mfma_f32_16x16x32_bf16 v[204:207], a[220:223], v[100:103], v[204:207]
    ds_read_b64_tr_b16 a[242:243], v4 offset:960
    ds_read_b64_tr_b16 a[244:245], v4 offset:17344
    v_fma_mix_f32 v39, v125, v19, v23 op_sel:[1,0,0] op_sel_hi:[1,0,0]
    v_mfma_f32_16x16x32_bf16 v[236:239], a[216:219], v[104:107], v[236:239]
    s_mov_b32 s54, 27648
    ds_read_b64_tr_b16 a[246:247], v4 offset:17856
    v_cvt_pk_bf16_f32 v124, v36, v37
    v_mfma_f32_16x16x32_bf16 v[236:239], a[220:223], v[108:111], v[236:239]
    s_waitcnt lgkmcnt(8)
    buffer_load_dwordx4 v[76:79], off, s[32:35], s54 sc1
    v_cvt_pk_bf16_f32 v125, v38, v39
    v_mfma_f32_16x16x32_bf16 v[208:211], a[224:227], v[96:99], v[208:211]
    ds_read_b64_tr_b16 a[248:249], v4 offset:480
    ds_read_b128 v[16:19], v9 offset:10752
    v_mfma_f32_16x16x32_bf16 v[208:211], a[228:231], v[100:103], v[208:211]
    ds_read_b64_tr_b16 a[250:251], v4 offset:992
    ds_read_b128 v[20:23], v9 offset:10784
    v_mfma_f32_16x16x32_bf16 v[240:243], a[224:227], v[104:107], v[240:243]
    ds_read_b64_tr_b16 a[252:253], v4 offset:17376
    v_fma_mix_f32 v32, v118, v24, v28 op_sel:[0,0,0] op_sel_hi:[1,0,0]
    v_mfma_f32_16x16x32_bf16 v[240:243], a[228:231], v[108:111], v[240:243]
    s_waitcnt vmcnt(16)
    s_barrier
    s_waitcnt lgkmcnt(9)
    ds_read_b64_tr_b16 a[254:255], v4 offset:17888
    v_fma_mix_f32 v33, v118, v25, v29 op_sel:[1,0,0] op_sel_hi:[1,0,0]
    v_fma_mix_f32 v34, v119, v26, v30 op_sel:[0,0,0] op_sel_hi:[1,0,0]
    v_mfma_f32_16x16x32_bf16 v[212:215], a[232:235], v[96:99], v[212:215]
    ds_read_b64_tr_b16 a[192:193], v4 offset:36864
    v_fma_mix_f32 v35, v119, v27, v31 op_sel:[1,0,0] op_sel_hi:[1,0,0]
    v_mfma_f32_16x16x32_bf16 v[212:215], a[236:239], v[100:103], v[212:215]
    ds_read_b64_tr_b16 a[194:195], v4 offset:37376
    ds_read_b64_tr_b16 a[196:197], v4 offset:53760
    v_cvt_pk_bf16_f32 v118, v32, v33
    v_mfma_f32_16x16x32_bf16 v[244:247], a[232:235], v[104:107], v[244:247]
    s_add_u32 m0, s44, 36864
    ds_read_b64_tr_b16 a[198:199], v4 offset:54272
    v_cvt_pk_bf16_f32 v119, v34, v35
    v_mfma_f32_16x16x32_bf16 v[244:247], a[236:239], v[108:111], v[244:247]
    s_mov_b32 s45, 2097152
    s_waitcnt lgkmcnt(10)
    buffer_load_dwordx4 v6, s[24:27], s45 offen lds
    v_mfma_f32_16x16x32_bf16 v[216:219], a[240:243], v[96:99], v[216:219]
    ds_read_b64_tr_b16 a[200:201], v4 offset:36896
    v_fma_mix_f32 v36, v126, v24, v28 op_sel:[0,0,0] op_sel_hi:[1,0,0]
    v_mfma_f32_16x16x32_bf16 v[216:219], a[244:247], v[100:103], v[216:219]
    ds_read_b64_tr_b16 a[202:203], v4 offset:37408
    ds_read_b64_tr_b16 a[204:205], v4 offset:53792
    v_fma_mix_f32 v37, v126, v25, v29 op_sel:[1,0,0] op_sel_hi:[1,0,0]
    v_mfma_f32_16x16x32_bf16 v[248:251], a[240:243], v[104:107], v[248:251]
    s_add_u32 m0, s44, 37920
    ds_read_b64_tr_b16 a[206:207], v4 offset:54304
    v_fma_mix_f32 v38, v127, v26, v30 op_sel:[0,0,0] op_sel_hi:[1,0,0]
    v_mfma_f32_16x16x32_bf16 v[248:251], a[244:247], v[108:111], v[248:251]
    s_mov_b32 s45, 2105344
    s_waitcnt lgkmcnt(8)
    buffer_load_dwordx4 v6, s[24:27], s45 offen lds
    v_mfma_f32_16x16x32_bf16 v[220:223], a[248:251], v[96:99], v[220:223]
    ds_read_b64_tr_b16 a[208:209], v4 offset:36928
    v_fma_mix_f32 v39, v127, v27, v31 op_sel:[1,0,0] op_sel_hi:[1,0,0]
    v_mfma_f32_16x16x32_bf16 v[220:223], a[252:255], v[100:103], v[220:223]
    ds_read_b64_tr_b16 a[210:211], v4 offset:37440
    ds_read_b64_tr_b16 a[212:213], v4 offset:53824
    v_cvt_pk_bf16_f32 v126, v36, v37
    v_mfma_f32_16x16x32_bf16 v[252:255], a[248:251], v[104:107], v[252:255]
    s_add_u32 m0, s44, 38976
    ds_read_b64_tr_b16 a[214:215], v4 offset:54336
    v_cvt_pk_bf16_f32 v127, v38, v39
    v_mfma_f32_16x16x32_bf16 v[252:255], a[252:255], v[108:111], v[252:255]
    s_mov_b32 s45, 2113536
    s_waitcnt lgkmcnt(8)
    buffer_load_dwordx4 v6, s[24:27], s45 offen lds
    v_mfma_f32_16x16x32_bf16 v[128:131], a[192:195], v[112:115], v[128:131]
    s_waitcnt vmcnt(15)
    ds_read_b64_tr_b16 a[216:217], v4 offset:36960
    ds_read_b128 v[24:27], v9 offset:10768
    v_mfma_f32_16x16x32_bf16 v[128:131], a[196:199], v[116:119], v[128:131]
    ds_read_b64_tr_b16 a[218:219], v4 offset:37472
    ds_read_b64_tr_b16 a[220:221], v4 offset:53856
    v_fma_mix_f32 v32, v48, v16, v20 op_sel:[0,0,0] op_sel_hi:[1,0,0]
    v_mfma_f32_16x16x32_bf16 v[160:163], a[192:195], v[120:123], v[160:163]
    s_add_u32 m0, s44, 40032
    ds_read_b64_tr_b16 a[222:223], v4 offset:54368
    ds_read_b128 v[28:31], v9 offset:10800
    v_mfma_f32_16x16x32_bf16 v[160:163], a[196:199], v[124:127], v[160:163]
    s_mov_b32 s45, 2121728
    s_waitcnt lgkmcnt(10)
    buffer_load_dwordx4 v6, s[24:27], s45 offen lds
    v_mfma_f32_16x16x32_bf16 v[132:135], a[200:203], v[112:115], v[132:135]
    ds_read_b64_tr_b16 a[224:225], v4 offset:36992
    v_fma_mix_f32 v33, v48, v17, v21 op_sel:[1,0,0] op_sel_hi:[1,0,0]
    v_mfma_f32_16x16x32_bf16 v[132:135], a[204:207], v[116:119], v[132:135]
    ds_read_b64_tr_b16 a[226:227], v4 offset:37504
    ds_read_b64_tr_b16 a[228:229], v4 offset:53888
    v_fma_mix_f32 v34, v49, v18, v22 op_sel:[0,0,0] op_sel_hi:[1,0,0]
    v_mfma_f32_16x16x32_bf16 v[164:167], a[200:203], v[120:123], v[164:167]
    s_add_u32 m0, s44, 53760
    ds_read_b64_tr_b16 a[230:231], v4 offset:54400
    v_fma_mix_f32 v35, v49, v19, v23 op_sel:[1,0,0] op_sel_hi:[1,0,0]
    v_mfma_f32_16x16x32_bf16 v[164:167], a[204:207], v[124:127], v[164:167]
    s_mov_b32 s45, 2359296
    s_waitcnt lgkmcnt(10)
    buffer_load_dwordx4 v6, s[24:27], s45 offen lds
    v_mfma_f32_16x16x32_bf16 v[136:139], a[208:211], v[112:115], v[136:139]
    ds_read_b64_tr_b16 a[232:233], v4 offset:37024
    v_cvt_pk_bf16_f32 v48, v32, v33
    v_mfma_f32_16x16x32_bf16 v[136:139], a[212:215], v[116:119], v[136:139]
    ds_read_b64_tr_b16 a[234:235], v4 offset:37536
    ds_read_b64_tr_b16 a[236:237], v4 offset:53920
    v_cvt_pk_bf16_f32 v49, v34, v35
    v_mfma_f32_16x16x32_bf16 v[168:171], a[208:211], v[120:123], v[168:171]
    s_add_u32 m0, s44, 54816
    ds_read_b64_tr_b16 a[238:239], v4 offset:54432
    v_fma_mix_f32 v36, v56, v16, v20 op_sel:[0,0,0] op_sel_hi:[1,0,0]
    v_mfma_f32_16x16x32_bf16 v[168:171], a[212:215], v[124:127], v[168:171]
    s_mov_b32 s45, 2367488
    s_waitcnt lgkmcnt(9)
    buffer_load_dwordx4 v6, s[24:27], s45 offen lds
    v_fma_mix_f32 v37, v56, v17, v21 op_sel:[1,0,0] op_sel_hi:[1,0,0]
    v_mfma_f32_16x16x32_bf16 v[140:143], a[216:219], v[112:115], v[140:143]
    ds_read_b64_tr_b16 a[240:241], v4 offset:37056
    v_fma_mix_f32 v38, v57, v18, v22 op_sel:[0,0,0] op_sel_hi:[1,0,0]
    v_mfma_f32_16x16x32_bf16 v[140:143], a[220:223], v[116:119], v[140:143]
    ds_read_b64_tr_b16 a[242:243], v4 offset:37568
    ds_read_b64_tr_b16 a[244:245], v4 offset:53952
    v_fma_mix_f32 v39, v57, v19, v23 op_sel:[1,0,0] op_sel_hi:[1,0,0]
    v_mfma_f32_16x16x32_bf16 v[172:175], a[216:219], v[120:123], v[172:175]
    s_add_u32 m0, s44, 55872
    ds_read_b64_tr_b16 a[246:247], v4 offset:54464
    v_cvt_pk_bf16_f32 v56, v36, v37
    v_mfma_f32_16x16x32_bf16 v[172:175], a[220:223], v[124:127], v[172:175]
    s_mov_b32 s45, 2375680
    s_waitcnt lgkmcnt(8)
    buffer_load_dwordx4 v6, s[24:27], s45 offen lds
    v_cvt_pk_bf16_f32 v57, v38, v39
    v_mfma_f32_16x16x32_bf16 v[144:147], a[224:227], v[112:115], v[144:147]
    ds_read_b64_tr_b16 a[248:249], v4 offset:37088
    ds_read_b128 v[16:19], v9 offset:11008
    v_mfma_f32_16x16x32_bf16 v[144:147], a[228:231], v[116:119], v[144:147]
    ds_read_b64_tr_b16 a[250:251], v4 offset:37600
    ds_read_b64_tr_b16 a[252:253], v4 offset:53984
    v_mfma_f32_16x16x32_bf16 v[176:179], a[224:227], v[120:123], v[176:179]
    s_add_u32 m0, s44, 56928
    ds_read_b64_tr_b16 a[254:255], v4 offset:54496
    ds_read_b128 v[20:23], v9 offset:11040
    v_mfma_f32_16x16x32_bf16 v[176:179], a[228:231], v[124:127], v[176:179]
    s_mov_b32 s45, 2383872
    s_waitcnt lgkmcnt(10)
    buffer_load_dwordx4 v6, s[24:27], s45 offen lds
    v_mfma_f32_16x16x32_bf16 v[148:151], a[232:235], v[112:115], v[148:151]
    ds_read_b64_tr_b16 a[192:193], v4 offset:37120
    v_fma_mix_f32 v32, v50, v24, v28 op_sel:[0,0,0] op_sel_hi:[1,0,0]
    v_mfma_f32_16x16x32_bf16 v[148:151], a[236:239], v[116:119], v[148:151]
    ds_read_b64_tr_b16 a[194:195], v4 offset:37632
    v_fma_mix_f32 v33, v50, v25, v29 op_sel:[1,0,0] op_sel_hi:[1,0,0]
    v_mfma_f32_16x16x32_bf16 v[180:183], a[232:235], v[120:123], v[180:183]
    ds_read_b64_tr_b16 a[196:197], v4 offset:54016
    v_fma_mix_f32 v34, v51, v26, v30 op_sel:[0,0,0] op_sel_hi:[1,0,0]
    v_mfma_f32_16x16x32_bf16 v[180:183], a[236:239], v[124:127], v[180:183]
    s_waitcnt lgkmcnt(9)
    ds_read_b64_tr_b16 a[198:199], v4 offset:54528
    v_fma_mix_f32 v35, v51, v27, v31 op_sel:[1,0,0] op_sel_hi:[1,0,0]
    v_mfma_f32_16x16x32_bf16 v[152:155], a[240:243], v[112:115], v[152:155]
    ds_read_b64_tr_b16 a[200:201], v4 offset:37152
    v_cvt_pk_bf16_f32 v50, v32, v33
    v_mfma_f32_16x16x32_bf16 v[152:155], a[244:247], v[116:119], v[152:155]
    ds_read_b64_tr_b16 a[202:203], v4 offset:37664
    v_cvt_pk_bf16_f32 v51, v34, v35
    v_mfma_f32_16x16x32_bf16 v[184:187], a[240:243], v[120:123], v[184:187]
    ds_read_b64_tr_b16 a[204:205], v4 offset:54048
    v_fma_mix_f32 v36, v58, v24, v28 op_sel:[0,0,0] op_sel_hi:[1,0,0]
    v_mfma_f32_16x16x32_bf16 v[184:187], a[244:247], v[124:127], v[184:187]
    s_waitcnt lgkmcnt(8)
    ds_read_b64_tr_b16 a[206:207], v4 offset:54560
    v_fma_mix_f32 v37, v58, v25, v29 op_sel:[1,0,0] op_sel_hi:[1,0,0]
    v_mfma_f32_16x16x32_bf16 v[156:159], a[248:251], v[112:115], v[156:159]
    ds_read_b64_tr_b16 a[208:209], v4 offset:37184
    v_fma_mix_f32 v38, v59, v26, v30 op_sel:[0,0,0] op_sel_hi:[1,0,0]
    v_mfma_f32_16x16x32_bf16 v[156:159], a[252:255], v[116:119], v[156:159]
    ds_read_b64_tr_b16 a[210:211], v4 offset:37696
    v_fma_mix_f32 v39, v59, v27, v31 op_sel:[1,0,0] op_sel_hi:[1,0,0]
    v_mfma_f32_16x16x32_bf16 v[188:191], a[248:251], v[120:123], v[188:191]
    ds_read_b64_tr_b16 a[212:213], v4 offset:54080
    v_cvt_pk_bf16_f32 v58, v36, v37
    v_mfma_f32_16x16x32_bf16 v[188:191], a[252:255], v[124:127], v[188:191]
    s_waitcnt lgkmcnt(7)
    ds_read_b64_tr_b16 a[214:215], v4 offset:54592
    v_cvt_pk_bf16_f32 v59, v38, v39
    v_mfma_f32_16x16x32_bf16 v[192:195], a[192:195], v[112:115], v[192:195]
    ds_read_b64_tr_b16 a[216:217], v4 offset:37216
    ds_read_b128 v[24:27], v9 offset:11024
    v_mfma_f32_16x16x32_bf16 v[192:195], a[196:199], v[116:119], v[192:195]
    ds_read_b64_tr_b16 a[218:219], v4 offset:37728
    ds_read_b64_tr_b16 a[220:221], v4 offset:54112
    v_fma_mix_f32 v32, v52, v16, v20 op_sel:[0,0,0] op_sel_hi:[1,0,0]
    v_mfma_f32_16x16x32_bf16 v[224:227], a[192:195], v[120:123], v[224:227]
    s_mov_b32 s54, 10240
    ds_read_b64_tr_b16 a[222:223], v4 offset:54624
    ds_read_b128 v[28:31], v9 offset:11056
    v_mfma_f32_16x16x32_bf16 v[224:227], a[196:199], v[124:127], v[224:227]
    s_waitcnt lgkmcnt(10)
    buffer_load_dwordx4 v[80:83], off, s[32:35], s54 sc1
    v_mfma_f32_16x16x32_bf16 v[196:199], a[200:203], v[112:115], v[196:199]
    ds_read_b64_tr_b16 a[224:225], v4 offset:37248
    v_fma_mix_f32 v33, v52, v17, v21 op_sel:[1,0,0] op_sel_hi:[1,0,0]
    v_mfma_f32_16x16x32_bf16 v[196:199], a[204:207], v[116:119], v[196:199]
    ds_read_b64_tr_b16 a[226:227], v4 offset:37760
    ds_read_b64_tr_b16 a[228:229], v4 offset:54144
    v_fma_mix_f32 v34, v53, v18, v22 op_sel:[0,0,0] op_sel_hi:[1,0,0]
    v_mfma_f32_16x16x32_bf16 v[228:231], a[200:203], v[120:123], v[228:231]
    s_mov_b32 s54, 11264
    ds_read_b64_tr_b16 a[230:231], v4 offset:54656
    v_fma_mix_f32 v35, v53, v19, v23 op_sel:[1,0,0] op_sel_hi:[1,0,0]
    v_mfma_f32_16x16x32_bf16 v[228:231], a[204:207], v[124:127], v[228:231]
    s_waitcnt lgkmcnt(10)
    buffer_load_dwordx4 v[84:87], off, s[32:35], s54 sc1
    v_mfma_f32_16x16x32_bf16 v[200:203], a[208:211], v[112:115], v[200:203]
    ds_read_b64_tr_b16 a[232:233], v4 offset:37280
    v_cvt_pk_bf16_f32 v52, v32, v33
    v_mfma_f32_16x16x32_bf16 v[200:203], a[212:215], v[116:119], v[200:203]
    ds_read_b64_tr_b16 a[234:235], v4 offset:37792
    ds_read_b64_tr_b16 a[236:237], v4 offset:54176
    v_cvt_pk_bf16_f32 v53, v34, v35
    v_mfma_f32_16x16x32_bf16 v[232:235], a[208:211], v[120:123], v[232:235]
    s_mov_b32 s54, 28672
    ds_read_b64_tr_b16 a[238:239], v4 offset:54688
    v_fma_mix_f32 v36, v60, v16, v20 op_sel:[0,0,0] op_sel_hi:[1,0,0]
    v_mfma_f32_16x16x32_bf16 v[232:235], a[212:215], v[124:127], v[232:235]
    s_waitcnt lgkmcnt(9)
    buffer_load_dwordx4 v[88:91], off, s[32:35], s54 sc1
    v_fma_mix_f32 v37, v60, v17, v21 op_sel:[1,0,0] op_sel_hi:[1,0,0]
    v_mfma_f32_16x16x32_bf16 v[204:207], a[216:219], v[112:115], v[204:207]
    ds_read_b64_tr_b16 a[240:241], v4 offset:37312
    v_fma_mix_f32 v38, v61, v18, v22 op_sel:[0,0,0] op_sel_hi:[1,0,0]
    v_mfma_f32_16x16x32_bf16 v[204:207], a[220:223], v[116:119], v[204:207]
    ds_read_b64_tr_b16 a[242:243], v4 offset:37824
    ds_read_b64_tr_b16 a[244:245], v4 offset:54208
    v_fma_mix_f32 v39, v61, v19, v23 op_sel:[1,0,0] op_sel_hi:[1,0,0]
    v_mfma_f32_16x16x32_bf16 v[236:239], a[216:219], v[120:123], v[236:239]
    s_mov_b32 s54, 29696
    ds_read_b64_tr_b16 a[246:247], v4 offset:54720
    v_cvt_pk_bf16_f32 v60, v36, v37
    v_mfma_f32_16x16x32_bf16 v[236:239], a[220:223], v[124:127], v[236:239]
    s_waitcnt lgkmcnt(8)
    buffer_load_dwordx4 v[92:95], off, s[32:35], s54 sc1
    v_cvt_pk_bf16_f32 v61, v38, v39
    v_mfma_f32_16x16x32_bf16 v[208:211], a[224:227], v[112:115], v[208:211]
    ds_read_b64_tr_b16 a[248:249], v4 offset:37344
    ds_read_b128 v[16:19], v9 offset:11264
    v_mfma_f32_16x16x32_bf16 v[208:211], a[228:231], v[116:119], v[208:211]
    ds_read_b64_tr_b16 a[250:251], v4 offset:37856
    ds_read_b128 v[20:23], v9 offset:11296
    v_mfma_f32_16x16x32_bf16 v[240:243], a[224:227], v[120:123], v[240:243]
    ds_read_b64_tr_b16 a[252:253], v4 offset:54240
    v_fma_mix_f32 v32, v54, v24, v28 op_sel:[0,0,0] op_sel_hi:[1,0,0]
    v_mfma_f32_16x16x32_bf16 v[240:243], a[228:231], v[124:127], v[240:243]
    s_waitcnt vmcnt(16)
    s_barrier
    s_waitcnt lgkmcnt(9)
    ds_read_b64_tr_b16 a[254:255], v4 offset:54752
    v_fma_mix_f32 v33, v54, v25, v29 op_sel:[1,0,0] op_sel_hi:[1,0,0]
    v_fma_mix_f32 v34, v55, v26, v30 op_sel:[0,0,0] op_sel_hi:[1,0,0]
    v_mfma_f32_16x16x32_bf16 v[212:215], a[232:235], v[112:115], v[212:215]
    ds_read_b64_tr_b16 a[192:193], v3 offset:0
    v_fma_mix_f32 v35, v55, v27, v31 op_sel:[1,0,0] op_sel_hi:[1,0,0]
    v_mfma_f32_16x16x32_bf16 v[212:215], a[236:239], v[116:119], v[212:215]
    ds_read_b64_tr_b16 a[194:195], v3 offset:512
    ds_read_b64_tr_b16 a[196:197], v3 offset:16896
    v_cvt_pk_bf16_f32 v54, v32, v33
    v_mfma_f32_16x16x32_bf16 v[244:247], a[232:235], v[120:123], v[244:247]
    s_add_u32 m0, s44, 73728
    ds_read_b64_tr_b16 a[198:199], v3 offset:17408
    v_cvt_pk_bf16_f32 v55, v34, v35
    v_mfma_f32_16x16x32_bf16 v[244:247], a[236:239], v[124:127], v[244:247]
    s_mov_b32 s45, 2621440
    s_waitcnt lgkmcnt(10)
    buffer_load_dwordx4 v6, s[24:27], s45 offen lds
    v_mfma_f32_16x16x32_bf16 v[216:219], a[240:243], v[112:115], v[216:219]
    ds_read_b64_tr_b16 a[200:201], v3 offset:32
    v_fma_mix_f32 v36, v62, v24, v28 op_sel:[0,0,0] op_sel_hi:[1,0,0]
    v_mfma_f32_16x16x32_bf16 v[216:219], a[244:247], v[116:119], v[216:219]
    ds_read_b64_tr_b16 a[202:203], v3 offset:544
    ds_read_b64_tr_b16 a[204:205], v3 offset:16928
    v_fma_mix_f32 v37, v62, v25, v29 op_sel:[1,0,0] op_sel_hi:[1,0,0]
    v_mfma_f32_16x16x32_bf16 v[248:251], a[240:243], v[120:123], v[248:251]
    s_add_u32 m0, s44, 74784
    ds_read_b64_tr_b16 a[206:207], v3 offset:17440
    v_fma_mix_f32 v38, v63, v26, v30 op_sel:[0,0,0] op_sel_hi:[1,0,0]
    v_mfma_f32_16x16x32_bf16 v[248:251], a[244:247], v[124:127], v[248:251]
    s_mov_b32 s45, 2629632
    s_waitcnt lgkmcnt(8)
    buffer_load_dwordx4 v6, s[24:27], s45 offen lds
    v_mfma_f32_16x16x32_bf16 v[220:223], a[248:251], v[112:115], v[220:223]
    ds_read_b64_tr_b16 a[208:209], v3 offset:64
    v_fma_mix_f32 v39, v63, v27, v31 op_sel:[1,0,0] op_sel_hi:[1,0,0]
    v_mfma_f32_16x16x32_bf16 v[220:223], a[252:255], v[116:119], v[220:223]
    ds_read_b64_tr_b16 a[210:211], v3 offset:576
    ds_read_b64_tr_b16 a[212:213], v3 offset:16960
    v_cvt_pk_bf16_f32 v62, v36, v37
    v_mfma_f32_16x16x32_bf16 v[252:255], a[248:251], v[120:123], v[252:255]
    s_add_u32 m0, s44, 75840
    ds_read_b64_tr_b16 a[214:215], v3 offset:17472
    v_cvt_pk_bf16_f32 v63, v38, v39
    v_mfma_f32_16x16x32_bf16 v[252:255], a[252:255], v[124:127], v[252:255]
    s_mov_b32 s45, 2637824
    s_waitcnt lgkmcnt(8)
    buffer_load_dwordx4 v6, s[24:27], s45 offen lds
    v_mfma_f32_16x16x32_bf16 v[128:131], a[192:195], v[48:51], v[128:131]
    s_waitcnt vmcnt(15)
    ds_read_b64_tr_b16 a[216:217], v3 offset:96
    ds_read_b128 v[24:27], v9 offset:11280
    v_mfma_f32_16x16x32_bf16 v[128:131], a[196:199], v[52:55], v[128:131]
    ds_read_b64_tr_b16 a[218:219], v3 offset:608
    ds_read_b64_tr_b16 a[220:221], v3 offset:16992
    v_fma_mix_f32 v32, v64, v16, v20 op_sel:[0,0,0] op_sel_hi:[1,0,0]
    v_mfma_f32_16x16x32_bf16 v[160:163], a[192:195], v[56:59], v[160:163]
    s_add_u32 m0, s44, 76896
    ds_read_b64_tr_b16 a[222:223], v3 offset:17504
    ds_read_b128 v[28:31], v9 offset:11312
    v_mfma_f32_16x16x32_bf16 v[160:163], a[196:199], v[60:63], v[160:163]
    s_mov_b32 s45, 2646016
    s_waitcnt lgkmcnt(10)
    buffer_load_dwordx4 v6, s[24:27], s45 offen lds
    v_mfma_f32_16x16x32_bf16 v[132:135], a[200:203], v[48:51], v[132:135]
    ds_read_b64_tr_b16 a[224:225], v3 offset:128
    v_fma_mix_f32 v33, v64, v17, v21 op_sel:[1,0,0] op_sel_hi:[1,0,0]
    v_mfma_f32_16x16x32_bf16 v[132:135], a[204:207], v[52:55], v[132:135]
    ds_read_b64_tr_b16 a[226:227], v3 offset:640
    ds_read_b64_tr_b16 a[228:229], v3 offset:17024
    v_fma_mix_f32 v34, v65, v18, v22 op_sel:[0,0,0] op_sel_hi:[1,0,0]
    v_mfma_f32_16x16x32_bf16 v[164:167], a[200:203], v[56:59], v[164:167]
    s_add_u32 m0, s44, 90624
    ds_read_b64_tr_b16 a[230:231], v3 offset:17536
    v_fma_mix_f32 v35, v65, v19, v23 op_sel:[1,0,0] op_sel_hi:[1,0,0]
    v_mfma_f32_16x16x32_bf16 v[164:167], a[204:207], v[60:63], v[164:167]
    s_mov_b32 s45, 2883584
    s_waitcnt lgkmcnt(10)
    buffer_load_dwordx4 v6, s[24:27], s45 offen lds
    v_mfma_f32_16x16x32_bf16 v[136:139], a[208:211], v[48:51], v[136:139]
    ds_read_b64_tr_b16 a[232:233], v3 offset:160
    v_cvt_pk_bf16_f32 v64, v32, v33
    v_mfma_f32_16x16x32_bf16 v[136:139], a[212:215], v[52:55], v[136:139]
    ds_read_b64_tr_b16 a[234:235], v3 offset:672
    ds_read_b64_tr_b16 a[236:237], v3 offset:17056
    v_cvt_pk_bf16_f32 v65, v34, v35
    v_mfma_f32_16x16x32_bf16 v[168:171], a[208:211], v[56:59], v[168:171]
    s_add_u32 m0, s44, 91680
    ds_read_b64_tr_b16 a[238:239], v3 offset:17568
    v_fma_mix_f32 v36, v72, v16, v20 op_sel:[0,0,0] op_sel_hi:[1,0,0]
    v_mfma_f32_16x16x32_bf16 v[168:171], a[212:215], v[60:63], v[168:171]
    s_mov_b32 s45, 2891776
    s_waitcnt lgkmcnt(9)
    buffer_load_dwordx4 v6, s[24:27], s45 offen lds
    v_fma_mix_f32 v37, v72, v17, v21 op_sel:[1,0,0] op_sel_hi:[1,0,0]
    v_mfma_f32_16x16x32_bf16 v[140:143], a[216:219], v[48:51], v[140:143]
    ds_read_b64_tr_b16 a[240:241], v3 offset:192
    v_fma_mix_f32 v38, v73, v18, v22 op_sel:[0,0,0] op_sel_hi:[1,0,0]
    v_mfma_f32_16x16x32_bf16 v[140:143], a[220:223], v[52:55], v[140:143]
    ds_read_b64_tr_b16 a[242:243], v3 offset:704
    ds_read_b64_tr_b16 a[244:245], v3 offset:17088
    v_fma_mix_f32 v39, v73, v19, v23 op_sel:[1,0,0] op_sel_hi:[1,0,0]
    v_mfma_f32_16x16x32_bf16 v[172:175], a[216:219], v[56:59], v[172:175]
    s_add_u32 m0, s44, 92736
    ds_read_b64_tr_b16 a[246:247], v3 offset:17600
    v_cvt_pk_bf16_f32 v72, v36, v37
    v_mfma_f32_16x16x32_bf16 v[172:175], a[220:223], v[60:63], v[172:175]
    s_mov_b32 s45, 2899968
    s_waitcnt lgkmcnt(8)
    buffer_load_dwordx4 v6, s[24:27], s45 offen lds
    v_cvt_pk_bf16_f32 v73, v38, v39
    v_mfma_f32_16x16x32_bf16 v[144:147], a[224:227], v[48:51], v[144:147]
    ds_read_b64_tr_b16 a[248:249], v3 offset:224
    ds_read_b128 v[16:19], v9 offset:11520
    v_mfma_f32_16x16x32_bf16 v[144:147], a[228:231], v[52:55], v[144:147]
    ds_read_b64_tr_b16 a[250:251], v3 offset:736
    ds_read_b64_tr_b16 a[252:253], v3 offset:17120
    v_mfma_f32_16x16x32_bf16 v[176:179], a[224:227], v[56:59], v[176:179]
    s_add_u32 m0, s44, 93792
    ds_read_b64_tr_b16 a[254:255], v3 offset:17632
    ds_read_b128 v[20:23], v9 offset:11552
    v_mfma_f32_16x16x32_bf16 v[176:179], a[228:231], v[60:63], v[176:179]
    s_mov_b32 s45, 2908160
    s_waitcnt lgkmcnt(10)
    buffer_load_dwordx4 v6, s[24:27], s45 offen lds
    v_mfma_f32_16x16x32_bf16 v[148:151], a[232:235], v[48:51], v[148:151]
    ds_read_b64_tr_b16 a[192:193], v3 offset:256
    v_fma_mix_f32 v32, v66, v24, v28 op_sel:[0,0,0] op_sel_hi:[1,0,0]
    v_mfma_f32_16x16x32_bf16 v[148:151], a[236:239], v[52:55], v[148:151]
    ds_read_b64_tr_b16 a[194:195], v3 offset:768
    v_fma_mix_f32 v33, v66, v25, v29 op_sel:[1,0,0] op_sel_hi:[1,0,0]
    v_mfma_f32_16x16x32_bf16 v[180:183], a[232:235], v[56:59], v[180:183]
    ds_read_b64_tr_b16 a[196:197], v3 offset:17152
    v_fma_mix_f32 v34, v67, v26, v30 op_sel:[0,0,0] op_sel_hi:[1,0,0]
    v_mfma_f32_16x16x32_bf16 v[180:183], a[236:239], v[60:63], v[180:183]
    s_waitcnt lgkmcnt(9)
    ds_read_b64_tr_b16 a[198:199], v3 offset:17664
    v_fma_mix_f32 v35, v67, v27, v31 op_sel:[1,0,0] op_sel_hi:[1,0,0]
    v_mfma_f32_16x16x32_bf16 v[152:155], a[240:243], v[48:51], v[152:155]
    ds_read_b64_tr_b16 a[200:201], v3 offset:288
    v_cvt_pk_bf16_f32 v66, v32, v33
    v_mfma_f32_16x16x32_bf16 v[152:155], a[244:247], v[52:55], v[152:155]
    ds_read_b64_tr_b16 a[202:203], v3 offset:800
    v_cvt_pk_bf16_f32 v67, v34, v35
    v_mfma_f32_16x16x32_bf16 v[184:187], a[240:243], v[56:59], v[184:187]
    ds_read_b64_tr_b16 a[204:205], v3 offset:17184
    v_fma_mix_f32 v36, v74, v24, v28 op_sel:[0,0,0] op_sel_hi:[1,0,0]
    v_mfma_f32_16x16x32_bf16 v[184:187], a[244:247], v[60:63], v[184:187]
    s_waitcnt lgkmcnt(8)
    ds_read_b64_tr_b16 a[206:207], v3 offset:17696
    v_fma_mix_f32 v37, v74, v25, v29 op_sel:[1,0,0] op_sel_hi:[1,0,0]
    v_mfma_f32_16x16x32_bf16 v[156:159], a[248:251], v[48:51], v[156:159]
    ds_read_b64_tr_b16 a[208:209], v3 offset:320
    v_fma_mix_f32 v38, v75, v26, v30 op_sel:[0,0,0] op_sel_hi:[1,0,0]
    v_mfma_f32_16x16x32_bf16 v[156:159], a[252:255], v[52:55], v[156:159]
    ds_read_b64_tr_b16 a[210:211], v3 offset:832
    v_fma_mix_f32 v39, v75, v27, v31 op_sel:[1,0,0] op_sel_hi:[1,0,0]
    v_mfma_f32_16x16x32_bf16 v[188:191], a[248:251], v[56:59], v[188:191]
    ds_read_b64_tr_b16 a[212:213], v3 offset:17216
    v_cvt_pk_bf16_f32 v74, v36, v37
    v_mfma_f32_16x16x32_bf16 v[188:191], a[252:255], v[60:63], v[188:191]
    s_waitcnt lgkmcnt(7)
    ds_read_b64_tr_b16 a[214:215], v3 offset:17728
    v_cvt_pk_bf16_f32 v75, v38, v39
    v_mfma_f32_16x16x32_bf16 v[192:195], a[192:195], v[48:51], v[192:195]
    ds_read_b64_tr_b16 a[216:217], v3 offset:352
    ds_read_b128 v[24:27], v9 offset:11536
    v_mfma_f32_16x16x32_bf16 v[192:195], a[196:199], v[52:55], v[192:195]
    ds_read_b64_tr_b16 a[218:219], v3 offset:864
    ds_read_b64_tr_b16 a[220:221], v3 offset:17248
    v_fma_mix_f32 v32, v68, v16, v20 op_sel:[0,0,0] op_sel_hi:[1,0,0]
    v_mfma_f32_16x16x32_bf16 v[224:227], a[192:195], v[56:59], v[224:227]
    s_mov_b32 s54, 12288
    ds_read_b64_tr_b16 a[222:223], v3 offset:17760
    ds_read_b128 v[28:31], v9 offset:11568
    v_mfma_f32_16x16x32_bf16 v[224:227], a[196:199], v[60:63], v[224:227]
    s_waitcnt lgkmcnt(10)
    buffer_load_dwordx4 v[96:99], off, s[32:35], s54 sc1
    v_mfma_f32_16x16x32_bf16 v[196:199], a[200:203], v[48:51], v[196:199]
    ds_read_b64_tr_b16 a[224:225], v3 offset:384
    v_fma_mix_f32 v33, v68, v17, v21 op_sel:[1,0,0] op_sel_hi:[1,0,0]
    v_mfma_f32_16x16x32_bf16 v[196:199], a[204:207], v[52:55], v[196:199]
    ds_read_b64_tr_b16 a[226:227], v3 offset:896
    ds_read_b64_tr_b16 a[228:229], v3 offset:17280
    v_fma_mix_f32 v34, v69, v18, v22 op_sel:[0,0,0] op_sel_hi:[1,0,0]
    v_mfma_f32_16x16x32_bf16 v[228:231], a[200:203], v[56:59], v[228:231]
    s_mov_b32 s54, 13312
    ds_read_b64_tr_b16 a[230:231], v3 offset:17792
    v_fma_mix_f32 v35, v69, v19, v23 op_sel:[1,0,0] op_sel_hi:[1,0,0]
    v_mfma_f32_16x16x32_bf16 v[228:231], a[204:207], v[60:63], v[228:231]
    s_waitcnt lgkmcnt(10)
    buffer_load_dwordx4 v[100:103], off, s[32:35], s54 sc1
    v_mfma_f32_16x16x32_bf16 v[200:203], a[208:211], v[48:51], v[200:203]
    ds_read_b64_tr_b16 a[232:233], v3 offset:416
    v_cvt_pk_bf16_f32 v68, v32, v33
    v_mfma_f32_16x16x32_bf16 v[200:203], a[212:215], v[52:55], v[200:203]
    ds_read_b64_tr_b16 a[234:235], v3 offset:928
    ds_read_b64_tr_b16 a[236:237], v3 offset:17312
    v_cvt_pk_bf16_f32 v69, v34, v35
    v_mfma_f32_16x16x32_bf16 v[232:235], a[208:211], v[56:59], v[232:235]
    s_mov_b32 s54, 30720
    ds_read_b64_tr_b16 a[238:239], v3 offset:17824
    v_fma_mix_f32 v36, v76, v16, v20 op_sel:[0,0,0] op_sel_hi:[1,0,0]
    v_mfma_f32_16x16x32_bf16 v[232:235], a[212:215], v[60:63], v[232:235]
    s_waitcnt lgkmcnt(9)
    buffer_load_dwordx4 v[104:107], off, s[32:35], s54 sc1
    v_fma_mix_f32 v37, v76, v17, v21 op_sel:[1,0,0] op_sel_hi:[1,0,0]
    v_mfma_f32_16x16x32_bf16 v[204:207], a[216:219], v[48:51], v[204:207]
    ds_read_b64_tr_b16 a[240:241], v3 offset:448
    v_fma_mix_f32 v38, v77, v18, v22 op_sel:[0,0,0] op_sel_hi:[1,0,0]
    v_mfma_f32_16x16x32_bf16 v[204:207], a[220:223], v[52:55], v[204:207]
    ds_read_b64_tr_b16 a[242:243], v3 offset:960
    ds_read_b64_tr_b16 a[244:245], v3 offset:17344
    v_fma_mix_f32 v39, v77, v19, v23 op_sel:[1,0,0] op_sel_hi:[1,0,0]
    v_mfma_f32_16x16x32_bf16 v[236:239], a[216:219], v[56:59], v[236:239]
    s_mov_b32 s54, 31744
    ds_read_b64_tr_b16 a[246:247], v3 offset:17856
    v_cvt_pk_bf16_f32 v76, v36, v37
    v_mfma_f32_16x16x32_bf16 v[236:239], a[220:223], v[60:63], v[236:239]
    s_waitcnt lgkmcnt(8)
    buffer_load_dwordx4 v[108:111], off, s[32:35], s54 sc1
    v_cvt_pk_bf16_f32 v77, v38, v39
    v_mfma_f32_16x16x32_bf16 v[208:211], a[224:227], v[48:51], v[208:211]
    ds_read_b64_tr_b16 a[248:249], v3 offset:480
    ds_read_b128 v[16:19], v9 offset:11776
    v_mfma_f32_16x16x32_bf16 v[208:211], a[228:231], v[52:55], v[208:211]
    ds_read_b64_tr_b16 a[250:251], v3 offset:992
    ds_read_b128 v[20:23], v9 offset:11808
    v_mfma_f32_16x16x32_bf16 v[240:243], a[224:227], v[56:59], v[240:243]
    ds_read_b64_tr_b16 a[252:253], v3 offset:17376
    v_fma_mix_f32 v32, v70, v24, v28 op_sel:[0,0,0] op_sel_hi:[1,0,0]
    v_mfma_f32_16x16x32_bf16 v[240:243], a[228:231], v[60:63], v[240:243]
    s_waitcnt vmcnt(16)
    s_barrier
    s_waitcnt lgkmcnt(9)
    ds_read_b64_tr_b16 a[254:255], v3 offset:17888
    v_fma_mix_f32 v33, v70, v25, v29 op_sel:[1,0,0] op_sel_hi:[1,0,0]
    v_fma_mix_f32 v34, v71, v26, v30 op_sel:[0,0,0] op_sel_hi:[1,0,0]
    v_mfma_f32_16x16x32_bf16 v[212:215], a[232:235], v[48:51], v[212:215]
    ds_read_b64_tr_b16 a[192:193], v3 offset:36864
    v_fma_mix_f32 v35, v71, v27, v31 op_sel:[1,0,0] op_sel_hi:[1,0,0]
    v_mfma_f32_16x16x32_bf16 v[212:215], a[236:239], v[52:55], v[212:215]
    ds_read_b64_tr_b16 a[194:195], v3 offset:37376
    ds_read_b64_tr_b16 a[196:197], v3 offset:53760
    v_cvt_pk_bf16_f32 v70, v32, v33
    v_mfma_f32_16x16x32_bf16 v[244:247], a[232:235], v[56:59], v[244:247]
    s_add_u32 m0, s44, 110592
    ds_read_b64_tr_b16 a[198:199], v3 offset:54272
    v_cvt_pk_bf16_f32 v71, v34, v35
    v_mfma_f32_16x16x32_bf16 v[244:247], a[236:239], v[60:63], v[244:247]
    s_mov_b32 s45, 3145728
    s_waitcnt lgkmcnt(10)
    buffer_load_dwordx4 v6, s[24:27], s45 offen lds
    v_mfma_f32_16x16x32_bf16 v[216:219], a[240:243], v[48:51], v[216:219]
    ds_read_b64_tr_b16 a[200:201], v3 offset:36896
    v_fma_mix_f32 v36, v78, v24, v28 op_sel:[0,0,0] op_sel_hi:[1,0,0]
    v_mfma_f32_16x16x32_bf16 v[216:219], a[244:247], v[52:55], v[216:219]
    ds_read_b64_tr_b16 a[202:203], v3 offset:37408
    ds_read_b64_tr_b16 a[204:205], v3 offset:53792
    v_fma_mix_f32 v37, v78, v25, v29 op_sel:[1,0,0] op_sel_hi:[1,0,0]
    v_mfma_f32_16x16x32_bf16 v[248:251], a[240:243], v[56:59], v[248:251]
    s_add_u32 m0, s44, 111648
    ds_read_b64_tr_b16 a[206:207], v3 offset:54304
    v_fma_mix_f32 v38, v79, v26, v30 op_sel:[0,0,0] op_sel_hi:[1,0,0]
    v_mfma_f32_16x16x32_bf16 v[248:251], a[244:247], v[60:63], v[248:251]
    s_mov_b32 s45, 3153920
    s_waitcnt lgkmcnt(8)
    buffer_load_dwordx4 v6, s[24:27], s45 offen lds
    v_mfma_f32_16x16x32_bf16 v[220:223], a[248:251], v[48:51], v[220:223]
L2_pad1:
    s_cbranch_execz L2_pad5
    ds_read_b64_tr_b16 a[208:209], v3 offset:36928
    v_fma_mix_f32 v39, v79, v27, v31 op_sel:[1,0,0] op_sel_hi:[1,0,0]
    v_mfma_f32_16x16x32_bf16 v[220:223], a[252:255], v[52:55], v[220:223]
    ds_read_b64_tr_b16 a[210:211], v3 offset:37440
    ds_read_b64_tr_b16 a[212:213], v3 offset:53824
    v_cvt_pk_bf16_f32 v78, v36, v37
    v_mfma_f32_16x16x32_bf16 v[252:255], a[248:251], v[56:59], v[252:255]
    s_add_u32 m0, s44, 112704
    ds_read_b64_tr_b16 a[214:215], v3 offset:54336
    v_cvt_pk_bf16_f32 v79, v38, v39
    v_mfma_f32_16x16x32_bf16 v[252:255], a[252:255], v[60:63], v[252:255]
    s_mov_b32 s45, 3162112
    s_waitcnt lgkmcnt(8)
    buffer_load_dwordx4 v6, s[24:27], s45 offen lds
    v_mfma_f32_16x16x32_bf16 v[128:131], a[192:195], v[64:67], v[128:131]
    s_waitcnt vmcnt(15)
    ds_read_b64_tr_b16 a[216:217], v3 offset:36960
    ds_read_b128 v[24:27], v9 offset:11792
    v_mfma_f32_16x16x32_bf16 v[128:131], a[196:199], v[68:71], v[128:131]
    ds_read_b64_tr_b16 a[218:219], v3 offset:37472
    ds_read_b64_tr_b16 a[220:221], v3 offset:53856
    v_fma_mix_f32 v32, v80, v16, v20 op_sel:[0,0,0] op_sel_hi:[1,0,0]
    v_mfma_f32_16x16x32_bf16 v[160:163], a[192:195], v[72:75], v[160:163]
    s_add_u32 m0, s44, 113760
    ds_read_b64_tr_b16 a[222:223], v3 offset:54368
    ds_read_b128 v[28:31], v9 offset:11824
    v_mfma_f32_16x16x32_bf16 v[160:163], a[196:199], v[76:79], v[160:163]
    s_mov_b32 s45, 3170304
    s_waitcnt lgkmcnt(10)
    buffer_load_dwordx4 v6, s[24:27], s45 offen lds
    v_mfma_f32_16x16x32_bf16 v[132:135], a[200:203], v[64:67], v[132:135]
    ds_read_b64_tr_b16 a[224:225], v3 offset:36992
    v_fma_mix_f32 v33, v80, v17, v21 op_sel:[1,0,0] op_sel_hi:[1,0,0]
    v_mfma_f32_16x16x32_bf16 v[132:135], a[204:207], v[68:71], v[132:135]
    ds_read_b64_tr_b16 a[226:227], v3 offset:37504
    ds_read_b64_tr_b16 a[228:229], v3 offset:53888
    v_fma_mix_f32 v34, v81, v18, v22 op_sel:[0,0,0] op_sel_hi:[1,0,0]
    v_mfma_f32_16x16x32_bf16 v[164:167], a[200:203], v[72:75], v[164:167]
    s_add_u32 m0, s44, 127488
    ds_read_b64_tr_b16 a[230:231], v3 offset:54400
    v_fma_mix_f32 v35, v81, v19, v23 op_sel:[1,0,0] op_sel_hi:[1,0,0]
    v_mfma_f32_16x16x32_bf16 v[164:167], a[204:207], v[76:79], v[164:167]
    s_mov_b32 s45, 3407872
    s_waitcnt lgkmcnt(10)
    buffer_load_dwordx4 v6, s[24:27], s45 offen lds
    v_mfma_f32_16x16x32_bf16 v[136:139], a[208:211], v[64:67], v[136:139]
    ds_read_b64_tr_b16 a[232:233], v3 offset:37024
    v_cvt_pk_bf16_f32 v80, v32, v33
    v_mfma_f32_16x16x32_bf16 v[136:139], a[212:215], v[68:71], v[136:139]
    ds_read_b64_tr_b16 a[234:235], v3 offset:37536
    ds_read_b64_tr_b16 a[236:237], v3 offset:53920
    v_cvt_pk_bf16_f32 v81, v34, v35
    v_mfma_f32_16x16x32_bf16 v[168:171], a[208:211], v[72:75], v[168:171]
    s_add_u32 m0, s44, 128544
    ds_read_b64_tr_b16 a[238:239], v3 offset:54432
    v_fma_mix_f32 v36, v88, v16, v20 op_sel:[0,0,0] op_sel_hi:[1,0,0]
    v_mfma_f32_16x16x32_bf16 v[168:171], a[212:215], v[76:79], v[168:171]
    s_mov_b32 s45, 3416064
    s_waitcnt lgkmcnt(9)
    buffer_load_dwordx4 v6, s[24:27], s45 offen lds
    v_fma_mix_f32 v37, v88, v17, v21 op_sel:[1,0,0] op_sel_hi:[1,0,0]
    v_mfma_f32_16x16x32_bf16 v[140:143], a[216:219], v[64:67], v[140:143]
    ds_read_b64_tr_b16 a[240:241], v3 offset:37056
    v_fma_mix_f32 v38, v89, v18, v22 op_sel:[0,0,0] op_sel_hi:[1,0,0]
    v_mfma_f32_16x16x32_bf16 v[140:143], a[220:223], v[68:71], v[140:143]
    ds_read_b64_tr_b16 a[242:243], v3 offset:37568
    ds_read_b64_tr_b16 a[244:245], v3 offset:53952
    v_fma_mix_f32 v39, v89, v19, v23 op_sel:[1,0,0] op_sel_hi:[1,0,0]
    v_mfma_f32_16x16x32_bf16 v[172:175], a[216:219], v[72:75], v[172:175]
    s_add_u32 m0, s44, 129600
    ds_read_b64_tr_b16 a[246:247], v3 offset:54464
    v_cvt_pk_bf16_f32 v88, v36, v37
    v_mfma_f32_16x16x32_bf16 v[172:175], a[220:223], v[76:79], v[172:175]
    s_mov_b32 s45, 3424256
    s_waitcnt lgkmcnt(8)
    buffer_load_dwordx4 v6, s[24:27], s45 offen lds
    v_cvt_pk_bf16_f32 v89, v38, v39
    v_mfma_f32_16x16x32_bf16 v[144:147], a[224:227], v[64:67], v[144:147]
    ds_read_b64_tr_b16 a[248:249], v3 offset:37088
    ds_read_b128 v[16:19], v9 offset:12032
    v_mfma_f32_16x16x32_bf16 v[144:147], a[228:231], v[68:71], v[144:147]
    ds_read_b64_tr_b16 a[250:251], v3 offset:37600
    ds_read_b64_tr_b16 a[252:253], v3 offset:53984
    v_mfma_f32_16x16x32_bf16 v[176:179], a[224:227], v[72:75], v[176:179]
    s_add_u32 m0, s44, 130656
    ds_read_b64_tr_b16 a[254:255], v3 offset:54496
    ds_read_b128 v[20:23], v9 offset:12064
    v_mfma_f32_16x16x32_bf16 v[176:179], a[228:231], v[76:79], v[176:179]
    s_mov_b32 s45, 3432448
    s_waitcnt lgkmcnt(10)
    buffer_load_dwordx4 v6, s[24:27], s45 offen lds
    v_mfma_f32_16x16x32_bf16 v[148:151], a[232:235], v[64:67], v[148:151]
    ds_read_b64_tr_b16 a[192:193], v3 offset:37120
    v_fma_mix_f32 v32, v82, v24, v28 op_sel:[0,0,0] op_sel_hi:[1,0,0]
    v_mfma_f32_16x16x32_bf16 v[148:151], a[236:239], v[68:71], v[148:151]
    ds_read_b64_tr_b16 a[194:195], v3 offset:37632
    v_fma_mix_f32 v33, v82, v25, v29 op_sel:[1,0,0] op_sel_hi:[1,0,0]
    v_mfma_f32_16x16x32_bf16 v[180:183], a[232:235], v[72:75], v[180:183]
    ds_read_b64_tr_b16 a[196:197], v3 offset:54016
    v_fma_mix_f32 v34, v83, v26, v30 op_sel:[0,0,0] op_sel_hi:[1,0,0]
    v_mfma_f32_16x16x32_bf16 v[180:183], a[236:239], v[76:79], v[180:183]
    s_waitcnt lgkmcnt(9)
    ds_read_b64_tr_b16 a[198:199], v3 offset:54528
    v_fma_mix_f32 v35, v83, v27, v31 op_sel:[1,0,0] op_sel_hi:[1,0,0]
    v_mfma_f32_16x16x32_bf16 v[152:155], a[240:243], v[64:67], v[152:155]
    ds_read_b64_tr_b16 a[200:201], v3 offset:37152
    v_cvt_pk_bf16_f32 v82, v32, v33
    v_mfma_f32_16x16x32_bf16 v[152:155], a[244:247], v[68:71], v[152:155]
    ds_read_b64_tr_b16 a[202:203], v3 offset:37664
    v_cvt_pk_bf16_f32 v83, v34, v35
    v_mfma_f32_16x16x32_bf16 v[184:187], a[240:243], v[72:75], v[184:187]
    ds_read_b64_tr_b16 a[204:205], v3 offset:54048
    v_fma_mix_f32 v36, v90, v24, v28 op_sel:[0,0,0] op_sel_hi:[1,0,0]
    v_mfma_f32_16x16x32_bf16 v[184:187], a[244:247], v[76:79], v[184:187]
    s_waitcnt lgkmcnt(8)
    ds_read_b64_tr_b16 a[206:207], v3 offset:54560
    v_fma_mix_f32 v37, v90, v25, v29 op_sel:[1,0,0] op_sel_hi:[1,0,0]
    v_mfma_f32_16x16x32_bf16 v[156:159], a[248:251], v[64:67], v[156:159]
    ds_read_b64_tr_b16 a[208:209], v3 offset:37184
    v_fma_mix_f32 v38, v91, v26, v30 op_sel:[0,0,0] op_sel_hi:[1,0,0]
    v_mfma_f32_16x16x32_bf16 v[156:159], a[252:255], v[68:71], v[156:159]
    ds_read_b64_tr_b16 a[210:211], v3 offset:37696
    v_fma_mix_f32 v39, v91, v27, v31 op_sel:[1,0,0] op_sel_hi:[1,0,0]
    v_mfma_f32_16x16x32_bf16 v[188:191], a[248:251], v[72:75], v[188:191]
    ds_read_b64_tr_b16 a[212:213], v3 offset:54080
    v_cvt_pk_bf16_f32 v90, v36, v37
    v_mfma_f32_16x16x32_bf16 v[188:191], a[252:255], v[76:79], v[188:191]
    s_waitcnt lgkmcnt(7)
    ds_read_b64_tr_b16 a[214:215], v3 offset:54592
    v_cvt_pk_bf16_f32 v91, v38, v39
    v_mfma_f32_16x16x32_bf16 v[192:195], a[192:195], v[64:67], v[192:195]
    ds_read_b64_tr_b16 a[216:217], v3 offset:37216
    ds_read_b128 v[24:27], v9 offset:12048
    v_mfma_f32_16x16x32_bf16 v[192:195], a[196:199], v[68:71], v[192:195]
    ds_read_b64_tr_b16 a[218:219], v3 offset:37728
    ds_read_b64_tr_b16 a[220:221], v3 offset:54112
    v_fma_mix_f32 v32, v84, v16, v20 op_sel:[0,0,0] op_sel_hi:[1,0,0]
    v_mfma_f32_16x16x32_bf16 v[224:227], a[192:195], v[72:75], v[224:227]
    s_mov_b32 s54, 14336
    ds_read_b64_tr_b16 a[222:223], v3 offset:54624
    ds_read_b128 v[28:31], v9 offset:12080
    v_mfma_f32_16x16x32_bf16 v[224:227], a[196:199], v[76:79], v[224:227]
    s_waitcnt lgkmcnt(10)
    buffer_load_dwordx4 v[112:115], off, s[32:35], s54 sc1
    v_mfma_f32_16x16x32_bf16 v[196:199], a[200:203], v[64:67], v[196:199]
    ds_read_b64_tr_b16 a[224:225], v3 offset:37248
    v_fma_mix_f32 v33, v84, v17, v21 op_sel:[1,0,0] op_sel_hi:[1,0,0]
    v_mfma_f32_16x16x32_bf16 v[196:199], a[204:207], v[68:71], v[196:199]
    ds_read_b64_tr_b16 a[226:227], v3 offset:37760
    ds_read_b64_tr_b16 a[228:229], v3 offset:54144
    v_fma_mix_f32 v34, v85, v18, v22 op_sel:[0,0,0] op_sel_hi:[1,0,0]
    v_mfma_f32_16x16x32_bf16 v[228:231], a[200:203], v[72:75], v[228:231]
    s_mov_b32 s54, 15360
    ds_read_b64_tr_b16 a[230:231], v3 offset:54656
    v_fma_mix_f32 v35, v85, v19, v23 op_sel:[1,0,0] op_sel_hi:[1,0,0]
    v_mfma_f32_16x16x32_bf16 v[228:231], a[204:207], v[76:79], v[228:231]
    s_waitcnt lgkmcnt(10)
    buffer_load_dwordx4 v[116:119], off, s[32:35], s54 sc1
    v_mfma_f32_16x16x32_bf16 v[200:203], a[208:211], v[64:67], v[200:203]
    ds_read_b64_tr_b16 a[232:233], v3 offset:37280
    v_cvt_pk_bf16_f32 v84, v32, v33
    v_mfma_f32_16x16x32_bf16 v[200:203], a[212:215], v[68:71], v[200:203]
    ds_read_b64_tr_b16 a[234:235], v3 offset:37792
    ds_read_b64_tr_b16 a[236:237], v3 offset:54176
    v_cvt_pk_bf16_f32 v85, v34, v35
    v_mfma_f32_16x16x32_bf16 v[232:235], a[208:211], v[72:75], v[232:235]
    s_mov_b32 s54, 32768
    ds_read_b64_tr_b16 a[238:239], v3 offset:54688
    v_fma_mix_f32 v36, v92, v16, v20 op_sel:[0,0,0] op_sel_hi:[1,0,0]
    v_mfma_f32_16x16x32_bf16 v[232:235], a[212:215], v[76:79], v[232:235]
    s_waitcnt lgkmcnt(9)
    buffer_load_dwordx4 v[120:123], off, s[32:35], s54 sc1
    v_fma_mix_f32 v37, v92, v17, v21 op_sel:[1,0,0] op_sel_hi:[1,0,0]
    v_mfma_f32_16x16x32_bf16 v[204:207], a[216:219], v[64:67], v[204:207]
    ds_read_b64_tr_b16 a[240:241], v3 offset:37312
    v_fma_mix_f32 v38, v93, v18, v22 op_sel:[0,0,0] op_sel_hi:[1,0,0]
    v_mfma_f32_16x16x32_bf16 v[204:207], a[220:223], v[68:71], v[204:207]
    ds_read_b64_tr_b16 a[242:243], v3 offset:37824
    ds_read_b64_tr_b16 a[244:245], v3 offset:54208
    v_fma_mix_f32 v39, v93, v19, v23 op_sel:[1,0,0] op_sel_hi:[1,0,0]
    v_mfma_f32_16x16x32_bf16 v[236:239], a[216:219], v[72:75], v[236:239]
    s_mov_b32 s54, 33792
    ds_read_b64_tr_b16 a[246:247], v3 offset:54720
    v_cvt_pk_bf16_f32 v92, v36, v37
    v_mfma_f32_16x16x32_bf16 v[236:239], a[220:223], v[76:79], v[236:239]
    s_waitcnt lgkmcnt(8)
    buffer_load_dwordx4 v[124:127], off, s[32:35], s54 sc1
    v_cvt_pk_bf16_f32 v93, v38, v39
    v_mfma_f32_16x16x32_bf16 v[208:211], a[224:227], v[64:67], v[208:211]
    ds_read_b64_tr_b16 a[248:249], v3 offset:37344
    ds_read_b128 v[16:19], v9 offset:12288
    v_mfma_f32_16x16x32_bf16 v[208:211], a[228:231], v[68:71], v[208:211]
    ds_read_b64_tr_b16 a[250:251], v3 offset:37856
    ds_read_b128 v[20:23], v9 offset:12320
    v_mfma_f32_16x16x32_bf16 v[240:243], a[224:227], v[72:75], v[240:243]
    ds_read_b64_tr_b16 a[252:253], v3 offset:54240
    v_fma_mix_f32 v32, v86, v24, v28 op_sel:[0,0,0] op_sel_hi:[1,0,0]
    v_mfma_f32_16x16x32_bf16 v[240:243], a[228:231], v[76:79], v[240:243]
    s_waitcnt vmcnt(16)
    s_barrier
    s_waitcnt lgkmcnt(9)
    ds_read_b64_tr_b16 a[254:255], v3 offset:54752
    v_fma_mix_f32 v33, v86, v25, v29 op_sel:[1,0,0] op_sel_hi:[1,0,0]
    v_fma_mix_f32 v34, v87, v26, v30 op_sel:[0,0,0] op_sel_hi:[1,0,0]
    v_mfma_f32_16x16x32_bf16 v[212:215], a[232:235], v[64:67], v[212:215]
    ds_read_b64_tr_b16 a[192:193], v4 offset:0
    v_fma_mix_f32 v35, v87, v27, v31 op_sel:[1,0,0] op_sel_hi:[1,0,0]
    v_mfma_f32_16x16x32_bf16 v[212:215], a[236:239], v[68:71], v[212:215]
    ds_read_b64_tr_b16 a[194:195], v4 offset:512
    ds_read_b64_tr_b16 a[196:197], v4 offset:16896
    v_cvt_pk_bf16_f32 v86, v32, v33
    v_mfma_f32_16x16x32_bf16 v[244:247], a[232:235], v[72:75], v[244:247]
    s_add_u32 m0, s44, 0
    ds_read_b64_tr_b16 a[198:199], v4 offset:17408
    v_cvt_pk_bf16_f32 v87, v34, v35
    v_mfma_f32_16x16x32_bf16 v[244:247], a[236:239], v[76:79], v[244:247]
    s_mov_b32 s45, 3670016
    s_waitcnt lgkmcnt(10)
    buffer_load_dwordx4 v6, s[24:27], s45 offen lds
    v_mfma_f32_16x16x32_bf16 v[216:219], a[240:243], v[64:67], v[216:219]
    ds_read_b64_tr_b16 a[200:201], v4 offset:32
    v_fma_mix_f32 v36, v94, v24, v28 op_sel:[0,0,0] op_sel_hi:[1,0,0]
    v_mfma_f32_16x16x32_bf16 v[216:219], a[244:247], v[68:71], v[216:219]
    ds_read_b64_tr_b16 a[202:203], v4 offset:544
    ds_read_b64_tr_b16 a[204:205], v4 offset:16928
    v_fma_mix_f32 v37, v94, v25, v29 op_sel:[1,0,0] op_sel_hi:[1,0,0]
    v_mfma_f32_16x16x32_bf16 v[248:251], a[240:243], v[72:75], v[248:251]
    s_add_u32 m0, s44, 1056
    ds_read_b64_tr_b16 a[206:207], v4 offset:17440
    v_fma_mix_f32 v38, v95, v26, v30 op_sel:[0,0,0] op_sel_hi:[1,0,0]
    v_mfma_f32_16x16x32_bf16 v[248:251], a[244:247], v[76:79], v[248:251]
    s_mov_b32 s45, 3678208
    s_waitcnt lgkmcnt(8)
    buffer_load_dwordx4 v6, s[24:27], s45 offen lds
    v_mfma_f32_16x16x32_bf16 v[220:223], a[248:251], v[64:67], v[220:223]
    ds_read_b64_tr_b16 a[208:209], v4 offset:64
    v_fma_mix_f32 v39, v95, v27, v31 op_sel:[1,0,0] op_sel_hi:[1,0,0]
    v_mfma_f32_16x16x32_bf16 v[220:223], a[252:255], v[68:71], v[220:223]
    ds_read_b64_tr_b16 a[210:211], v4 offset:576
    ds_read_b64_tr_b16 a[212:213], v4 offset:16960
    v_cvt_pk_bf16_f32 v94, v36, v37
    v_mfma_f32_16x16x32_bf16 v[252:255], a[248:251], v[72:75], v[252:255]
    s_add_u32 m0, s44, 2112
    ds_read_b64_tr_b16 a[214:215], v4 offset:17472
    v_cvt_pk_bf16_f32 v95, v38, v39
    v_mfma_f32_16x16x32_bf16 v[252:255], a[252:255], v[76:79], v[252:255]
    s_mov_b32 s45, 3686400
    s_waitcnt lgkmcnt(8)
    buffer_load_dwordx4 v6, s[24:27], s45 offen lds
    v_mfma_f32_16x16x32_bf16 v[128:131], a[192:195], v[80:83], v[128:131]
    s_waitcnt vmcnt(15)
    ds_read_b64_tr_b16 a[216:217], v4 offset:96
    ds_read_b128 v[24:27], v9 offset:12304
    v_mfma_f32_16x16x32_bf16 v[128:131], a[196:199], v[84:87], v[128:131]
    ds_read_b64_tr_b16 a[218:219], v4 offset:608
    ds_read_b64_tr_b16 a[220:221], v4 offset:16992
    v_fma_mix_f32 v32, v96, v16, v20 op_sel:[0,0,0] op_sel_hi:[1,0,0]
    v_mfma_f32_16x16x32_bf16 v[160:163], a[192:195], v[88:91], v[160:163]
    s_add_u32 m0, s44, 3168
    ds_read_b64_tr_b16 a[222:223], v4 offset:17504
    ds_read_b128 v[28:31], v9 offset:12336
    v_mfma_f32_16x16x32_bf16 v[160:163], a[196:199], v[92:95], v[160:163]
    s_mov_b32 s45, 3694592
    s_waitcnt lgkmcnt(10)
    buffer_load_dwordx4 v6, s[24:27], s45 offen lds
    v_mfma_f32_16x16x32_bf16 v[132:135], a[200:203], v[80:83], v[132:135]
    ds_read_b64_tr_b16 a[224:225], v4 offset:128
    v_fma_mix_f32 v33, v96, v17, v21 op_sel:[1,0,0] op_sel_hi:[1,0,0]
    v_mfma_f32_16x16x32_bf16 v[132:135], a[204:207], v[84:87], v[132:135]
    ds_read_b64_tr_b16 a[226:227], v4 offset:640
    ds_read_b64_tr_b16 a[228:229], v4 offset:17024
    v_fma_mix_f32 v34, v97, v18, v22 op_sel:[0,0,0] op_sel_hi:[1,0,0]
    v_mfma_f32_16x16x32_bf16 v[164:167], a[200:203], v[88:91], v[164:167]
    s_add_u32 m0, s44, 16896
    ds_read_b64_tr_b16 a[230:231], v4 offset:17536
    v_fma_mix_f32 v35, v97, v19, v23 op_sel:[1,0,0] op_sel_hi:[1,0,0]
    v_mfma_f32_16x16x32_bf16 v[164:167], a[204:207], v[92:95], v[164:167]
    s_mov_b32 s45, 3932160
    s_waitcnt lgkmcnt(10)
    buffer_load_dwordx4 v6, s[24:27], s45 offen lds
    v_mfma_f32_16x16x32_bf16 v[136:139], a[208:211], v[80:83], v[136:139]
    ds_read_b64_tr_b16 a[232:233], v4 offset:160
    v_cvt_pk_bf16_f32 v96, v32, v33
    v_mfma_f32_16x16x32_bf16 v[136:139], a[212:215], v[84:87], v[136:139]
    ds_read_b64_tr_b16 a[234:235], v4 offset:672
    ds_read_b64_tr_b16 a[236:237], v4 offset:17056
    v_cvt_pk_bf16_f32 v97, v34, v35
    v_mfma_f32_16x16x32_bf16 v[168:171], a[208:211], v[88:91], v[168:171]
    s_add_u32 m0, s44, 17952
    ds_read_b64_tr_b16 a[238:239], v4 offset:17568
    v_fma_mix_f32 v36, v104, v16, v20 op_sel:[0,0,0] op_sel_hi:[1,0,0]
    v_mfma_f32_16x16x32_bf16 v[168:171], a[212:215], v[92:95], v[168:171]
    s_mov_b32 s45, 3940352
    s_waitcnt lgkmcnt(9)
    buffer_load_dwordx4 v6, s[24:27], s45 offen lds
    v_fma_mix_f32 v37, v104, v17, v21 op_sel:[1,0,0] op_sel_hi:[1,0,0]
    v_mfma_f32_16x16x32_bf16 v[140:143], a[216:219], v[80:83], v[140:143]
    ds_read_b64_tr_b16 a[240:241], v4 offset:192
    v_fma_mix_f32 v38, v105, v18, v22 op_sel:[0,0,0] op_sel_hi:[1,0,0]
    v_mfma_f32_16x16x32_bf16 v[140:143], a[220:223], v[84:87], v[140:143]
    ds_read_b64_tr_b16 a[242:243], v4 offset:704
    ds_read_b64_tr_b16 a[244:245], v4 offset:17088
    v_fma_mix_f32 v39, v105, v19, v23 op_sel:[1,0,0] op_sel_hi:[1,0,0]
    v_mfma_f32_16x16x32_bf16 v[172:175], a[216:219], v[88:91], v[172:175]
    s_add_u32 m0, s44, 19008
    ds_read_b64_tr_b16 a[246:247], v4 offset:17600
    v_cvt_pk_bf16_f32 v104, v36, v37
    v_mfma_f32_16x16x32_bf16 v[172:175], a[220:223], v[92:95], v[172:175]
    s_mov_b32 s45, 3948544
    s_waitcnt lgkmcnt(8)
    buffer_load_dwordx4 v6, s[24:27], s45 offen lds
    v_cvt_pk_bf16_f32 v105, v38, v39
    v_mfma_f32_16x16x32_bf16 v[144:147], a[224:227], v[80:83], v[144:147]
    ds_read_b64_tr_b16 a[248:249], v4 offset:224
    ds_read_b128 v[16:19], v9 offset:12544
    v_mfma_f32_16x16x32_bf16 v[144:147], a[228:231], v[84:87], v[144:147]
    ds_read_b64_tr_b16 a[250:251], v4 offset:736
    ds_read_b64_tr_b16 a[252:253], v4 offset:17120
    v_mfma_f32_16x16x32_bf16 v[176:179], a[224:227], v[88:91], v[176:179]
    s_add_u32 m0, s44, 20064
    ds_read_b64_tr_b16 a[254:255], v4 offset:17632
    ds_read_b128 v[20:23], v9 offset:12576
    v_mfma_f32_16x16x32_bf16 v[176:179], a[228:231], v[92:95], v[176:179]
    s_mov_b32 s45, 3956736
    s_waitcnt lgkmcnt(10)
    buffer_load_dwordx4 v6, s[24:27], s45 offen lds
    v_mfma_f32_16x16x32_bf16 v[148:151], a[232:235], v[80:83], v[148:151]
    ds_read_b64_tr_b16 a[192:193], v4 offset:256
    v_fma_mix_f32 v32, v98, v24, v28 op_sel:[0,0,0] op_sel_hi:[1,0,0]
    v_mfma_f32_16x16x32_bf16 v[148:151], a[236:239], v[84:87], v[148:151]
    ds_read_b64_tr_b16 a[194:195], v4 offset:768
    v_fma_mix_f32 v33, v98, v25, v29 op_sel:[1,0,0] op_sel_hi:[1,0,0]
    v_mfma_f32_16x16x32_bf16 v[180:183], a[232:235], v[88:91], v[180:183]
    ds_read_b64_tr_b16 a[196:197], v4 offset:17152
    v_fma_mix_f32 v34, v99, v26, v30 op_sel:[0,0,0] op_sel_hi:[1,0,0]
    v_mfma_f32_16x16x32_bf16 v[180:183], a[236:239], v[92:95], v[180:183]
    s_waitcnt lgkmcnt(9)
    ds_read_b64_tr_b16 a[198:199], v4 offset:17664
    v_fma_mix_f32 v35, v99, v27, v31 op_sel:[1,0,0] op_sel_hi:[1,0,0]
    v_mfma_f32_16x16x32_bf16 v[152:155], a[240:243], v[80:83], v[152:155]
    ds_read_b64_tr_b16 a[200:201], v4 offset:288
    v_cvt_pk_bf16_f32 v98, v32, v33
    v_mfma_f32_16x16x32_bf16 v[152:155], a[244:247], v[84:87], v[152:155]
    ds_read_b64_tr_b16 a[202:203], v4 offset:800
    v_cvt_pk_bf16_f32 v99, v34, v35
    v_mfma_f32_16x16x32_bf16 v[184:187], a[240:243], v[88:91], v[184:187]
    ds_read_b64_tr_b16 a[204:205], v4 offset:17184
    v_fma_mix_f32 v36, v106, v24, v28 op_sel:[0,0,0] op_sel_hi:[1,0,0]
    v_mfma_f32_16x16x32_bf16 v[184:187], a[244:247], v[92:95], v[184:187]
    s_waitcnt lgkmcnt(8)
    ds_read_b64_tr_b16 a[206:207], v4 offset:17696
    v_fma_mix_f32 v37, v106, v25, v29 op_sel:[1,0,0] op_sel_hi:[1,0,0]
    v_mfma_f32_16x16x32_bf16 v[156:159], a[248:251], v[80:83], v[156:159]
    ds_read_b64_tr_b16 a[208:209], v4 offset:320
    v_fma_mix_f32 v38, v107, v26, v30 op_sel:[0,0,0] op_sel_hi:[1,0,0]
    v_mfma_f32_16x16x32_bf16 v[156:159], a[252:255], v[84:87], v[156:159]
    ds_read_b64_tr_b16 a[210:211], v4 offset:832
    v_fma_mix_f32 v39, v107, v27, v31 op_sel:[1,0,0] op_sel_hi:[1,0,0]
    v_mfma_f32_16x16x32_bf16 v[188:191], a[248:251], v[88:91], v[188:191]
    ds_read_b64_tr_b16 a[212:213], v4 offset:17216
    v_cvt_pk_bf16_f32 v106, v36, v37
    v_mfma_f32_16x16x32_bf16 v[188:191], a[252:255], v[92:95], v[188:191]
    s_waitcnt lgkmcnt(7)
    ds_read_b64_tr_b16 a[214:215], v4 offset:17728
    v_cvt_pk_bf16_f32 v107, v38, v39
    v_mfma_f32_16x16x32_bf16 v[192:195], a[192:195], v[80:83], v[192:195]
    ds_read_b64_tr_b16 a[216:217], v4 offset:352
    ds_read_b128 v[24:27], v9 offset:12560
    v_mfma_f32_16x16x32_bf16 v[192:195], a[196:199], v[84:87], v[192:195]
    ds_read_b64_tr_b16 a[218:219], v4 offset:864
    ds_read_b64_tr_b16 a[220:221], v4 offset:17248
    v_fma_mix_f32 v32, v100, v16, v20 op_sel:[0,0,0] op_sel_hi:[1,0,0]
    v_mfma_f32_16x16x32_bf16 v[224:227], a[192:195], v[88:91], v[224:227]
    s_mov_b32 s54, 16384
    ds_read_b64_tr_b16 a[222:223], v4 offset:17760
    ds_read_b128 v[28:31], v9 offset:12592
    v_mfma_f32_16x16x32_bf16 v[224:227], a[196:199], v[92:95], v[224:227]
    s_waitcnt lgkmcnt(10)
    buffer_load_dwordx4 v[48:51], off, s[32:35], s54 sc1
    v_mfma_f32_16x16x32_bf16 v[196:199], a[200:203], v[80:83], v[196:199]
    ds_read_b64_tr_b16 a[224:225], v4 offset:384
    v_fma_mix_f32 v33, v100, v17, v21 op_sel:[1,0,0] op_sel_hi:[1,0,0]
    v_mfma_f32_16x16x32_bf16 v[196:199], a[204:207], v[84:87], v[196:199]
    ds_read_b64_tr_b16 a[226:227], v4 offset:896
    ds_read_b64_tr_b16 a[228:229], v4 offset:17280
    v_fma_mix_f32 v34, v101, v18, v22 op_sel:[0,0,0] op_sel_hi:[1,0,0]
    v_mfma_f32_16x16x32_bf16 v[228:231], a[200:203], v[88:91], v[228:231]
    s_mov_b32 s54, 17408
    ds_read_b64_tr_b16 a[230:231], v4 offset:17792
    v_fma_mix_f32 v35, v101, v19, v23 op_sel:[1,0,0] op_sel_hi:[1,0,0]
    v_mfma_f32_16x16x32_bf16 v[228:231], a[204:207], v[92:95], v[228:231]
    s_waitcnt lgkmcnt(10)
    buffer_load_dwordx4 v[52:55], off, s[32:35], s54 sc1
    v_mfma_f32_16x16x32_bf16 v[200:203], a[208:211], v[80:83], v[200:203]
    ds_read_b64_tr_b16 a[232:233], v4 offset:416
    v_cvt_pk_bf16_f32 v100, v32, v33
    v_mfma_f32_16x16x32_bf16 v[200:203], a[212:215], v[84:87], v[200:203]
    ds_read_b64_tr_b16 a[234:235], v4 offset:928
    ds_read_b64_tr_b16 a[236:237], v4 offset:17312
    v_cvt_pk_bf16_f32 v101, v34, v35
    v_mfma_f32_16x16x32_bf16 v[232:235], a[208:211], v[88:91], v[232:235]
    s_mov_b32 s54, 34816
    ds_read_b64_tr_b16 a[238:239], v4 offset:17824
    v_fma_mix_f32 v36, v108, v16, v20 op_sel:[0,0,0] op_sel_hi:[1,0,0]
    v_mfma_f32_16x16x32_bf16 v[232:235], a[212:215], v[92:95], v[232:235]
    s_waitcnt lgkmcnt(9)
    buffer_load_dwordx4 v[56:59], off, s[32:35], s54 sc1
    v_fma_mix_f32 v37, v108, v17, v21 op_sel:[1,0,0] op_sel_hi:[1,0,0]
    v_mfma_f32_16x16x32_bf16 v[204:207], a[216:219], v[80:83], v[204:207]
    ds_read_b64_tr_b16 a[240:241], v4 offset:448
    v_fma_mix_f32 v38, v109, v18, v22 op_sel:[0,0,0] op_sel_hi:[1,0,0]
    v_mfma_f32_16x16x32_bf16 v[204:207], a[220:223], v[84:87], v[204:207]
    ds_read_b64_tr_b16 a[242:243], v4 offset:960
    ds_read_b64_tr_b16 a[244:245], v4 offset:17344
    v_fma_mix_f32 v39, v109, v19, v23 op_sel:[1,0,0] op_sel_hi:[1,0,0]
    v_mfma_f32_16x16x32_bf16 v[236:239], a[216:219], v[88:91], v[236:239]
    s_mov_b32 s54, 35840
    ds_read_b64_tr_b16 a[246:247], v4 offset:17856
    v_cvt_pk_bf16_f32 v108, v36, v37
    v_mfma_f32_16x16x32_bf16 v[236:239], a[220:223], v[92:95], v[236:239]
    s_waitcnt lgkmcnt(8)
    buffer_load_dwordx4 v[60:63], off, s[32:35], s54 sc1
    v_cvt_pk_bf16_f32 v109, v38, v39
    v_mfma_f32_16x16x32_bf16 v[208:211], a[224:227], v[80:83], v[208:211]
    ds_read_b64_tr_b16 a[248:249], v4 offset:480
    ds_read_b128 v[16:19], v9 offset:12800
    v_mfma_f32_16x16x32_bf16 v[208:211], a[228:231], v[84:87], v[208:211]
    ds_read_b64_tr_b16 a[250:251], v4 offset:992
    ds_read_b128 v[20:23], v9 offset:12832
    v_mfma_f32_16x16x32_bf16 v[240:243], a[224:227], v[88:91], v[240:243]
    ds_read_b64_tr_b16 a[252:253], v4 offset:17376
    v_fma_mix_f32 v32, v102, v24, v28 op_sel:[0,0,0] op_sel_hi:[1,0,0]
    v_mfma_f32_16x16x32_bf16 v[240:243], a[228:231], v[92:95], v[240:243]
    s_waitcnt vmcnt(16)
    s_barrier
    s_waitcnt lgkmcnt(9)
    ds_read_b64_tr_b16 a[254:255], v4 offset:17888
    v_fma_mix_f32 v33, v102, v25, v29 op_sel:[1,0,0] op_sel_hi:[1,0,0]
    v_fma_mix_f32 v34, v103, v26, v30 op_sel:[0,0,0] op_sel_hi:[1,0,0]
    v_mfma_f32_16x16x32_bf16 v[212:215], a[232:235], v[80:83], v[212:215]
    ds_read_b64_tr_b16 a[192:193], v4 offset:36864
    v_fma_mix_f32 v35, v103, v27, v31 op_sel:[1,0,0] op_sel_hi:[1,0,0]
    v_mfma_f32_16x16x32_bf16 v[212:215], a[236:239], v[84:87], v[212:215]
    ds_read_b64_tr_b16 a[194:195], v4 offset:37376
    ds_read_b64_tr_b16 a[196:197], v4 offset:53760
    v_cvt_pk_bf16_f32 v102, v32, v33
    v_mfma_f32_16x16x32_bf16 v[244:247], a[232:235], v[88:91], v[244:247]
    s_add_u32 m0, s44, 36864
    ds_read_b64_tr_b16 a[198:199], v4 offset:54272
    v_cvt_pk_bf16_f32 v103, v34, v35
    v_mfma_f32_16x16x32_bf16 v[244:247], a[236:239], v[92:95], v[244:247]
    s_mov_b32 s45, 4194304
    s_waitcnt lgkmcnt(10)
    buffer_load_dwordx4 v6, s[24:27], s45 offen lds
    v_mfma_f32_16x16x32_bf16 v[216:219], a[240:243], v[80:83], v[216:219]
    ds_read_b64_tr_b16 a[200:201], v4 offset:36896
    v_fma_mix_f32 v36, v110, v24, v28 op_sel:[0,0,0] op_sel_hi:[1,0,0]
    v_mfma_f32_16x16x32_bf16 v[216:219], a[244:247], v[84:87], v[216:219]
    ds_read_b64_tr_b16 a[202:203], v4 offset:37408
    ds_read_b64_tr_b16 a[204:205], v4 offset:53792
    v_fma_mix_f32 v37, v110, v25, v29 op_sel:[1,0,0] op_sel_hi:[1,0,0]
    v_mfma_f32_16x16x32_bf16 v[248:251], a[240:243], v[88:91], v[248:251]
    s_add_u32 m0, s44, 37920
    ds_read_b64_tr_b16 a[206:207], v4 offset:54304
    v_fma_mix_f32 v38, v111, v26, v30 op_sel:[0,0,0] op_sel_hi:[1,0,0]
    v_mfma_f32_16x16x32_bf16 v[248:251], a[244:247], v[92:95], v[248:251]
    s_mov_b32 s45, 4202496
    s_waitcnt lgkmcnt(8)
    buffer_load_dwordx4 v6, s[24:27], s45 offen lds
    v_mfma_f32_16x16x32_bf16 v[220:223], a[248:251], v[80:83], v[220:223]
    ds_read_b64_tr_b16 a[208:209], v4 offset:36928
    v_fma_mix_f32 v39, v111, v27, v31 op_sel:[1,0,0] op_sel_hi:[1,0,0]
    v_mfma_f32_16x16x32_bf16 v[220:223], a[252:255], v[84:87], v[220:223]
    ds_read_b64_tr_b16 a[210:211], v4 offset:37440
    ds_read_b64_tr_b16 a[212:213], v4 offset:53824
    v_cvt_pk_bf16_f32 v110, v36, v37
    v_mfma_f32_16x16x32_bf16 v[252:255], a[248:251], v[88:91], v[252:255]
    s_add_u32 m0, s44, 38976
    ds_read_b64_tr_b16 a[214:215], v4 offset:54336
    v_cvt_pk_bf16_f32 v111, v38, v39
    v_mfma_f32_16x16x32_bf16 v[252:255], a[252:255], v[92:95], v[252:255]
    s_mov_b32 s45, 4210688
    s_waitcnt lgkmcnt(8)
    buffer_load_dwordx4 v6, s[24:27], s45 offen lds
    v_mfma_f32_16x16x32_bf16 v[128:131], a[192:195], v[96:99], v[128:131]
    s_waitcnt vmcnt(15)
    ds_read_b64_tr_b16 a[216:217], v4 offset:36960
    ds_read_b128 v[24:27], v9 offset:12816
    v_mfma_f32_16x16x32_bf16 v[128:131], a[196:199], v[100:103], v[128:131]
    ds_read_b64_tr_b16 a[218:219], v4 offset:37472
    ds_read_b64_tr_b16 a[220:221], v4 offset:53856
    v_fma_mix_f32 v32, v112, v16, v20 op_sel:[0,0,0] op_sel_hi:[1,0,0]
    v_mfma_f32_16x16x32_bf16 v[160:163], a[192:195], v[104:107], v[160:163]
    s_add_u32 m0, s44, 40032
    ds_read_b64_tr_b16 a[222:223], v4 offset:54368
    ds_read_b128 v[28:31], v9 offset:12848
    v_mfma_f32_16x16x32_bf16 v[160:163], a[196:199], v[108:111], v[160:163]
    s_mov_b32 s45, 4218880
    s_waitcnt lgkmcnt(10)
    buffer_load_dwordx4 v6, s[24:27], s45 offen lds
    v_mfma_f32_16x16x32_bf16 v[132:135], a[200:203], v[96:99], v[132:135]
    ds_read_b64_tr_b16 a[224:225], v4 offset:36992
    v_fma_mix_f32 v33, v112, v17, v21 op_sel:[1,0,0] op_sel_hi:[1,0,0]
    v_mfma_f32_16x16x32_bf16 v[132:135], a[204:207], v[100:103], v[132:135]
    ds_read_b64_tr_b16 a[226:227], v4 offset:37504
    ds_read_b64_tr_b16 a[228:229], v4 offset:53888
    v_fma_mix_f32 v34, v113, v18, v22 op_sel:[0,0,0] op_sel_hi:[1,0,0]
    v_mfma_f32_16x16x32_bf16 v[164:167], a[200:203], v[104:107], v[164:167]
    s_add_u32 m0, s44, 53760
    ds_read_b64_tr_b16 a[230:231], v4 offset:54400
    v_fma_mix_f32 v35, v113, v19, v23 op_sel:[1,0,0] op_sel_hi:[1,0,0]
    v_mfma_f32_16x16x32_bf16 v[164:167], a[204:207], v[108:111], v[164:167]
    s_mov_b32 s45, 4456448
    s_waitcnt lgkmcnt(10)
    buffer_load_dwordx4 v6, s[24:27], s45 offen lds
    v_mfma_f32_16x16x32_bf16 v[136:139], a[208:211], v[96:99], v[136:139]
    ds_read_b64_tr_b16 a[232:233], v4 offset:37024
    v_cvt_pk_bf16_f32 v112, v32, v33
    v_mfma_f32_16x16x32_bf16 v[136:139], a[212:215], v[100:103], v[136:139]
    ds_read_b64_tr_b16 a[234:235], v4 offset:37536
    ds_read_b64_tr_b16 a[236:237], v4 offset:53920
    v_cvt_pk_bf16_f32 v113, v34, v35
    v_mfma_f32_16x16x32_bf16 v[168:171], a[208:211], v[104:107], v[168:171]
    s_add_u32 m0, s44, 54816
    ds_read_b64_tr_b16 a[238:239], v4 offset:54432
    v_fma_mix_f32 v36, v120, v16, v20 op_sel:[0,0,0] op_sel_hi:[1,0,0]
    v_mfma_f32_16x16x32_bf16 v[168:171], a[212:215], v[108:111], v[168:171]
    s_mov_b32 s45, 4464640
    s_waitcnt lgkmcnt(9)
    buffer_load_dwordx4 v6, s[24:27], s45 offen lds
    v_fma_mix_f32 v37, v120, v17, v21 op_sel:[1,0,0] op_sel_hi:[1,0,0]
    v_mfma_f32_16x16x32_bf16 v[140:143], a[216:219], v[96:99], v[140:143]
L2_pad2:
    s_cbranch_execz L2_pad6
    ds_read_b64_tr_b16 a[240:241], v4 offset:37056
    v_fma_mix_f32 v38, v121, v18, v22 op_sel:[0,0,0] op_sel_hi:[1,0,0]
    v_mfma_f32_16x16x32_bf16 v[140:143], a[220:223], v[100:103], v[140:143]
    ds_read_b64_tr_b16 a[242:243], v4 offset:37568
    ds_read_b64_tr_b16 a[244:245], v4 offset:53952
    v_fma_mix_f32 v39, v121, v19, v23 op_sel:[1,0,0] op_sel_hi:[1,0,0]
    v_mfma_f32_16x16x32_bf16 v[172:175], a[216:219], v[104:107], v[172:175]
    s_add_u32 m0, s44, 55872
    ds_read_b64_tr_b16 a[246:247], v4 offset:54464
    v_cvt_pk_bf16_f32 v120, v36, v37
    v_mfma_f32_16x16x32_bf16 v[172:175], a[220:223], v[108:111], v[172:175]
    s_mov_b32 s45, 4472832
    s_waitcnt lgkmcnt(8)
    buffer_load_dwordx4 v6, s[24:27], s45 offen lds
    v_cvt_pk_bf16_f32 v121, v38, v39
    v_mfma_f32_16x16x32_bf16 v[144:147], a[224:227], v[96:99], v[144:147]
    ds_read_b64_tr_b16 a[248:249], v4 offset:37088
    ds_read_b128 v[16:19], v9 offset:13056
    v_mfma_f32_16x16x32_bf16 v[144:147], a[228:231], v[100:103], v[144:147]
    ds_read_b64_tr_b16 a[250:251], v4 offset:37600
    ds_read_b64_tr_b16 a[252:253], v4 offset:53984
    v_mfma_f32_16x16x32_bf16 v[176:179], a[224:227], v[104:107], v[176:179]
    s_add_u32 m0, s44, 56928
    ds_read_b64_tr_b16 a[254:255], v4 offset:54496
    ds_read_b128 v[20:23], v9 offset:13088
    v_mfma_f32_16x16x32_bf16 v[176:179], a[228:231], v[108:111], v[176:179]
    s_mov_b32 s45, 4481024
    s_waitcnt lgkmcnt(10)
    buffer_load_dwordx4 v6, s[24:27], s45 offen lds
    v_mfma_f32_16x16x32_bf16 v[148:151], a[232:235], v[96:99], v[148:151]
    ds_read_b64_tr_b16 a[192:193], v4 offset:37120
    v_fma_mix_f32 v32, v114, v24, v28 op_sel:[0,0,0] op_sel_hi:[1,0,0]
    v_mfma_f32_16x16x32_bf16 v[148:151], a[236:239], v[100:103], v[148:151]
    ds_read_b64_tr_b16 a[194:195], v4 offset:37632
    v_fma_mix_f32 v33, v114, v25, v29 op_sel:[1,0,0] op_sel_hi:[1,0,0]
    v_mfma_f32_16x16x32_bf16 v[180:183], a[232:235], v[104:107], v[180:183]
    ds_read_b64_tr_b16 a[196:197], v4 offset:54016
    v_fma_mix_f32 v34, v115, v26, v30 op_sel:[0,0,0] op_sel_hi:[1,0,0]
    v_mfma_f32_16x16x32_bf16 v[180:183], a[236:239], v[108:111], v[180:183]
    s_waitcnt lgkmcnt(9)
    ds_read_b64_tr_b16 a[198:199], v4 offset:54528
    v_fma_mix_f32 v35, v115, v27, v31 op_sel:[1,0,0] op_sel_hi:[1,0,0]
    v_mfma_f32_16x16x32_bf16 v[152:155], a[240:243], v[96:99], v[152:155]
    ds_read_b64_tr_b16 a[200:201], v4 offset:37152
    v_cvt_pk_bf16_f32 v114, v32, v33
    v_mfma_f32_16x16x32_bf16 v[152:155], a[244:247], v[100:103], v[152:155]
    ds_read_b64_tr_b16 a[202:203], v4 offset:37664
    v_cvt_pk_bf16_f32 v115, v34, v35
    v_mfma_f32_16x16x32_bf16 v[184:187], a[240:243], v[104:107], v[184:187]
    ds_read_b64_tr_b16 a[204:205], v4 offset:54048
    v_fma_mix_f32 v36, v122, v24, v28 op_sel:[0,0,0] op_sel_hi:[1,0,0]
    v_mfma_f32_16x16x32_bf16 v[184:187], a[244:247], v[108:111], v[184:187]
    s_waitcnt lgkmcnt(8)
    ds_read_b64_tr_b16 a[206:207], v4 offset:54560
    v_fma_mix_f32 v37, v122, v25, v29 op_sel:[1,0,0] op_sel_hi:[1,0,0]
    v_mfma_f32_16x16x32_bf16 v[156:159], a[248:251], v[96:99], v[156:159]
    ds_read_b64_tr_b16 a[208:209], v4 offset:37184
    v_fma_mix_f32 v38, v123, v26, v30 op_sel:[0,0,0] op_sel_hi:[1,0,0]
    v_mfma_f32_16x16x32_bf16 v[156:159], a[252:255], v[100:103], v[156:159]
    ds_read_b64_tr_b16 a[210:211], v4 offset:37696
    v_fma_mix_f32 v39, v123, v27, v31 op_sel:[1,0,0] op_sel_hi:[1,0,0]
    v_mfma_f32_16x16x32_bf16 v[188:191], a[248:251], v[104:107], v[188:191]
    ds_read_b64_tr_b16 a[212:213], v4 offset:54080
    v_cvt_pk_bf16_f32 v122, v36, v37
    v_mfma_f32_16x16x32_bf16 v[188:191], a[252:255], v[108:111], v[188:191]
    s_waitcnt lgkmcnt(7)
    ds_read_b64_tr_b16 a[214:215], v4 offset:54592
    v_cvt_pk_bf16_f32 v123, v38, v39
    v_mfma_f32_16x16x32_bf16 v[192:195], a[192:195], v[96:99], v[192:195]
    ds_read_b64_tr_b16 a[216:217], v4 offset:37216
    ds_read_b128 v[24:27], v9 offset:13072
    v_mfma_f32_16x16x32_bf16 v[192:195], a[196:199], v[100:103], v[192:195]
    ds_read_b64_tr_b16 a[218:219], v4 offset:37728
    ds_read_b128 v[28:31], v9 offset:13104
    v_mfma_f32_16x16x32_bf16 v[224:227], a[192:195], v[104:107], v[224:227]
    ds_read_b64_tr_b16 a[220:221], v4 offset:54112
    v_fma_mix_f32 v32, v116, v16, v20 op_sel:[0,0,0] op_sel_hi:[1,0,0]
    v_mfma_f32_16x16x32_bf16 v[224:227], a[196:199], v[108:111], v[224:227]
    s_waitcnt lgkmcnt(9)
    ds_read_b64_tr_b16 a[222:223], v4 offset:54624
    v_fma_mix_f32 v33, v116, v17, v21 op_sel:[1,0,0] op_sel_hi:[1,0,0]
    v_mfma_f32_16x16x32_bf16 v[196:199], a[200:203], v[96:99], v[196:199]
    ds_read_b64_tr_b16 a[224:225], v4 offset:37248
    v_fma_mix_f32 v34, v117, v18, v22 op_sel:[0,0,0] op_sel_hi:[1,0,0]
    v_mfma_f32_16x16x32_bf16 v[196:199], a[204:207], v[100:103], v[196:199]
    ds_read_b64_tr_b16 a[226:227], v4 offset:37760
    v_fma_mix_f32 v35, v117, v19, v23 op_sel:[1,0,0] op_sel_hi:[1,0,0]
    v_mfma_f32_16x16x32_bf16 v[228:231], a[200:203], v[104:107], v[228:231]
    ds_read_b64_tr_b16 a[228:229], v4 offset:54144
    v_cvt_pk_bf16_f32 v116, v32, v33
    v_mfma_f32_16x16x32_bf16 v[228:231], a[204:207], v[108:111], v[228:231]
    s_waitcnt lgkmcnt(9)
    ds_read_b64_tr_b16 a[230:231], v4 offset:54656
    v_cvt_pk_bf16_f32 v117, v34, v35
    v_mfma_f32_16x16x32_bf16 v[200:203], a[208:211], v[96:99], v[200:203]
    ds_read_b64_tr_b16 a[232:233], v4 offset:37280
    v_fma_mix_f32 v36, v124, v16, v20 op_sel:[0,0,0] op_sel_hi:[1,0,0]
    v_mfma_f32_16x16x32_bf16 v[200:203], a[212:215], v[100:103], v[200:203]
    ds_read_b64_tr_b16 a[234:235], v4 offset:37792
    v_fma_mix_f32 v37, v124, v17, v21 op_sel:[1,0,0] op_sel_hi:[1,0,0]
    v_mfma_f32_16x16x32_bf16 v[232:235], a[208:211], v[104:107], v[232:235]
    ds_read_b64_tr_b16 a[236:237], v4 offset:54176
    v_fma_mix_f32 v38, v125, v18, v22 op_sel:[0,0,0] op_sel_hi:[1,0,0]
    v_mfma_f32_16x16x32_bf16 v[232:235], a[212:215], v[108:111], v[232:235]
    s_waitcnt lgkmcnt(7)
    ds_read_b64_tr_b16 a[238:239], v4 offset:54688
    v_fma_mix_f32 v39, v125, v19, v23 op_sel:[1,0,0] op_sel_hi:[1,0,0]
    v_mfma_f32_16x16x32_bf16 v[204:207], a[216:219], v[96:99], v[204:207]
    ds_read_b64_tr_b16 a[240:241], v4 offset:37312
    v_cvt_pk_bf16_f32 v124, v36, v37
    v_mfma_f32_16x16x32_bf16 v[204:207], a[220:223], v[100:103], v[204:207]
    ds_read_b64_tr_b16 a[242:243], v4 offset:37824
    v_cvt_pk_bf16_f32 v125, v38, v39
    v_mfma_f32_16x16x32_bf16 v[236:239], a[216:219], v[104:107], v[236:239]
    ds_read_b64_tr_b16 a[244:245], v4 offset:54208
    v_mfma_f32_16x16x32_bf16 v[236:239], a[220:223], v[108:111], v[236:239]
    s_waitcnt lgkmcnt(7)
    ds_read_b64_tr_b16 a[246:247], v4 offset:54720
    v_mfma_f32_16x16x32_bf16 v[208:211], a[224:227], v[96:99], v[208:211]
    ds_read_b64_tr_b16 a[248:249], v4 offset:37344
    ds_read_b128 v[16:19], v9 offset:13312
    v_mfma_f32_16x16x32_bf16 v[208:211], a[228:231], v[100:103], v[208:211]
    ds_read_b64_tr_b16 a[250:251], v4 offset:37856
    ds_read_b128 v[20:23], v9 offset:13344
    v_mfma_f32_16x16x32_bf16 v[240:243], a[224:227], v[104:107], v[240:243]
    ds_read_b64_tr_b16 a[252:253], v4 offset:54240
    v_fma_mix_f32 v32, v118, v24, v28 op_sel:[0,0,0] op_sel_hi:[1,0,0]
    v_mfma_f32_16x16x32_bf16 v[240:243], a[228:231], v[108:111], v[240:243]
    s_waitcnt vmcnt(12)
    s_barrier
    s_waitcnt lgkmcnt(9)
    ds_read_b64_tr_b16 a[254:255], v4 offset:54752
    v_fma_mix_f32 v33, v118, v25, v29 op_sel:[1,0,0] op_sel_hi:[1,0,0]
    v_fma_mix_f32 v34, v119, v26, v30 op_sel:[0,0,0] op_sel_hi:[1,0,0]
    v_mfma_f32_16x16x32_bf16 v[212:215], a[232:235], v[96:99], v[212:215]
    ds_read_b64_tr_b16 a[192:193], v3 offset:0
    v_fma_mix_f32 v35, v119, v27, v31 op_sel:[1,0,0] op_sel_hi:[1,0,0]
    v_mfma_f32_16x16x32_bf16 v[212:215], a[236:239], v[100:103], v[212:215]
    ds_read_b64_tr_b16 a[194:195], v3 offset:512
    ds_read_b64_tr_b16 a[196:197], v3 offset:16896
    v_cvt_pk_bf16_f32 v118, v32, v33
    v_mfma_f32_16x16x32_bf16 v[244:247], a[232:235], v[104:107], v[244:247]
    s_add_u32 m0, s44, 73728
    ds_read_b64_tr_b16 a[198:199], v3 offset:17408
    v_cvt_pk_bf16_f32 v119, v34, v35
    v_mfma_f32_16x16x32_bf16 v[244:247], a[236:239], v[108:111], v[244:247]
    s_mov_b32 s46, 0
    s_waitcnt lgkmcnt(10)
    buffer_load_dwordx4 off, s[16:19], s46 offset:0 lds
    v_mfma_f32_16x16x32_bf16 v[216:219], a[240:243], v[96:99], v[216:219]
    ds_read_b64_tr_b16 a[200:201], v3 offset:32
    v_fma_mix_f32 v36, v126, v24, v28 op_sel:[0,0,0] op_sel_hi:[1,0,0]
    v_mfma_f32_16x16x32_bf16 v[216:219], a[244:247], v[100:103], v[216:219]
    ds_read_b64_tr_b16 a[202:203], v3 offset:544
    ds_read_b64_tr_b16 a[204:205], v3 offset:16928
    v_fma_mix_f32 v37, v126, v25, v29 op_sel:[1,0,0] op_sel_hi:[1,0,0]
    v_mfma_f32_16x16x32_bf16 v[248:251], a[240:243], v[104:107], v[248:251]
    s_add_u32 m0, s44, 73760
    ds_read_b64_tr_b16 a[206:207], v3 offset:17440
    v_fma_mix_f32 v38, v127, v26, v30 op_sel:[0,0,0] op_sel_hi:[1,0,0]
    v_mfma_f32_16x16x32_bf16 v[248:251], a[244:247], v[108:111], v[248:251]
    s_waitcnt lgkmcnt(8)
    buffer_load_dwordx4 off, s[16:19], s46 offset:1024 lds
    v_mfma_f32_16x16x32_bf16 v[220:223], a[248:251], v[96:99], v[220:223]
    ds_read_b64_tr_b16 a[208:209], v3 offset:64
    v_fma_mix_f32 v39, v127, v27, v31 op_sel:[1,0,0] op_sel_hi:[1,0,0]
    v_mfma_f32_16x16x32_bf16 v[220:223], a[252:255], v[100:103], v[220:223]
    ds_read_b64_tr_b16 a[210:211], v3 offset:576
    ds_read_b64_tr_b16 a[212:213], v3 offset:16960
    v_cvt_pk_bf16_f32 v126, v36, v37
    v_mfma_f32_16x16x32_bf16 v[252:255], a[248:251], v[104:107], v[252:255]
    s_add_u32 m0, s44, 73792
    ds_read_b64_tr_b16 a[214:215], v3 offset:17472
    v_cvt_pk_bf16_f32 v127, v38, v39
    v_mfma_f32_16x16x32_bf16 v[252:255], a[252:255], v[108:111], v[252:255]
    s_waitcnt lgkmcnt(8)
    buffer_load_dwordx4 off, s[16:19], s46 offset:2048 lds
    v_mfma_f32_16x16x32_bf16 v[128:131], a[192:195], v[112:115], v[128:131]
    s_waitcnt vmcnt(11)
    ds_read_b64_tr_b16 a[216:217], v3 offset:96
    ds_read_b128 v[24:27], v9 offset:13328
    v_mfma_f32_16x16x32_bf16 v[128:131], a[196:199], v[116:119], v[128:131]
    ds_read_b64_tr_b16 a[218:219], v3 offset:608
    ds_read_b64_tr_b16 a[220:221], v3 offset:16992
    v_fma_mix_f32 v32, v48, v16, v20 op_sel:[0,0,0] op_sel_hi:[1,0,0]
    v_mfma_f32_16x16x32_bf16 v[160:163], a[192:195], v[120:123], v[160:163]
    s_add_u32 m0, s44, 73824
    ds_read_b64_tr_b16 a[222:223], v3 offset:17504
    ds_read_b128 v[28:31], v9 offset:13360
    v_mfma_f32_16x16x32_bf16 v[160:163], a[196:199], v[124:127], v[160:163]
    s_waitcnt lgkmcnt(10)
    buffer_load_dwordx4 off, s[16:19], s46 offset:3072 lds
    v_mfma_f32_16x16x32_bf16 v[132:135], a[200:203], v[112:115], v[132:135]
    ds_read_b64_tr_b16 a[224:225], v3 offset:128
    v_fma_mix_f32 v33, v48, v17, v21 op_sel:[1,0,0] op_sel_hi:[1,0,0]
    v_mfma_f32_16x16x32_bf16 v[132:135], a[204:207], v[116:119], v[132:135]
    ds_read_b64_tr_b16 a[226:227], v3 offset:640
    ds_read_b64_tr_b16 a[228:229], v3 offset:17024
    v_fma_mix_f32 v34, v49, v18, v22 op_sel:[0,0,0] op_sel_hi:[1,0,0]
    v_mfma_f32_16x16x32_bf16 v[164:167], a[200:203], v[120:123], v[164:167]
    s_add_u32 m0, s44, 90624
    ds_read_b64_tr_b16 a[230:231], v3 offset:17536
    v_fma_mix_f32 v35, v49, v19, v23 op_sel:[1,0,0] op_sel_hi:[1,0,0]
    v_mfma_f32_16x16x32_bf16 v[164:167], a[204:207], v[124:127], v[164:167]
    s_waitcnt lgkmcnt(10)
    buffer_load_dwordx4 off, s[20:23], s46 offset:0 lds
    v_mfma_f32_16x16x32_bf16 v[136:139], a[208:211], v[112:115], v[136:139]
    ds_read_b64_tr_b16 a[232:233], v3 offset:160
    v_cvt_pk_bf16_f32 v48, v32, v33
    v_mfma_f32_16x16x32_bf16 v[136:139], a[212:215], v[116:119], v[136:139]
    ds_read_b64_tr_b16 a[234:235], v3 offset:672
    ds_read_b64_tr_b16 a[236:237], v3 offset:17056
    v_cvt_pk_bf16_f32 v49, v34, v35
    v_mfma_f32_16x16x32_bf16 v[168:171], a[208:211], v[120:123], v[168:171]
    s_add_u32 m0, s44, 90656
    ds_read_b64_tr_b16 a[238:239], v3 offset:17568
    v_fma_mix_f32 v36, v56, v16, v20 op_sel:[0,0,0] op_sel_hi:[1,0,0]
    v_mfma_f32_16x16x32_bf16 v[168:171], a[212:215], v[124:127], v[168:171]
    s_waitcnt lgkmcnt(9)
    buffer_load_dwordx4 off, s[20:23], s46 offset:1024 lds
    v_fma_mix_f32 v37, v56, v17, v21 op_sel:[1,0,0] op_sel_hi:[1,0,0]
    v_mfma_f32_16x16x32_bf16 v[140:143], a[216:219], v[112:115], v[140:143]
    ds_read_b64_tr_b16 a[240:241], v3 offset:192
    v_fma_mix_f32 v38, v57, v18, v22 op_sel:[0,0,0] op_sel_hi:[1,0,0]
    v_mfma_f32_16x16x32_bf16 v[140:143], a[220:223], v[116:119], v[140:143]
    ds_read_b64_tr_b16 a[242:243], v3 offset:704
    ds_read_b64_tr_b16 a[244:245], v3 offset:17088
    v_fma_mix_f32 v39, v57, v19, v23 op_sel:[1,0,0] op_sel_hi:[1,0,0]
    v_mfma_f32_16x16x32_bf16 v[172:175], a[216:219], v[120:123], v[172:175]
    s_add_u32 m0, s44, 90688
    ds_read_b64_tr_b16 a[246:247], v3 offset:17600
    v_cvt_pk_bf16_f32 v56, v36, v37
    v_mfma_f32_16x16x32_bf16 v[172:175], a[220:223], v[124:127], v[172:175]
    s_waitcnt lgkmcnt(8)
    buffer_load_dwordx4 off, s[20:23], s46 offset:2048 lds
    v_cvt_pk_bf16_f32 v57, v38, v39
    v_mfma_f32_16x16x32_bf16 v[144:147], a[224:227], v[112:115], v[144:147]
    ds_read_b64_tr_b16 a[248:249], v3 offset:224
    ds_read_b128 v[16:19], v9 offset:13568
    v_mfma_f32_16x16x32_bf16 v[144:147], a[228:231], v[116:119], v[144:147]
    ds_read_b64_tr_b16 a[250:251], v3 offset:736
    ds_read_b64_tr_b16 a[252:253], v3 offset:17120
    v_mfma_f32_16x16x32_bf16 v[176:179], a[224:227], v[120:123], v[176:179]
    s_add_u32 m0, s44, 90720
    ds_read_b64_tr_b16 a[254:255], v3 offset:17632
    ds_read_b128 v[20:23], v9 offset:13600
    v_mfma_f32_16x16x32_bf16 v[176:179], a[228:231], v[124:127], v[176:179]
    s_waitcnt lgkmcnt(10)
    buffer_load_dwordx4 off, s[20:23], s46 offset:3072 lds
    v_mfma_f32_16x16x32_bf16 v[148:151], a[232:235], v[112:115], v[148:151]
    ds_read_b64_tr_b16 a[192:193], v3 offset:256
    v_fma_mix_f32 v32, v50, v24, v28 op_sel:[0,0,0] op_sel_hi:[1,0,0]
    v_mfma_f32_16x16x32_bf16 v[148:151], a[236:239], v[116:119], v[148:151]
    ds_read_b64_tr_b16 a[194:195], v3 offset:768
    v_fma_mix_f32 v33, v50, v25, v29 op_sel:[1,0,0] op_sel_hi:[1,0,0]
    v_mfma_f32_16x16x32_bf16 v[180:183], a[232:235], v[120:123], v[180:183]
    ds_read_b64_tr_b16 a[196:197], v3 offset:17152
    v_fma_mix_f32 v34, v51, v26, v30 op_sel:[0,0,0] op_sel_hi:[1,0,0]
    v_mfma_f32_16x16x32_bf16 v[180:183], a[236:239], v[124:127], v[180:183]
    s_waitcnt lgkmcnt(9)
    ds_read_b64_tr_b16 a[198:199], v3 offset:17664
    v_fma_mix_f32 v35, v51, v27, v31 op_sel:[1,0,0] op_sel_hi:[1,0,0]
    v_mfma_f32_16x16x32_bf16 v[152:155], a[240:243], v[112:115], v[152:155]
    ds_read_b64_tr_b16 a[200:201], v3 offset:288
    v_cvt_pk_bf16_f32 v50, v32, v33
    v_mfma_f32_16x16x32_bf16 v[152:155], a[244:247], v[116:119], v[152:155]
    ds_read_b64_tr_b16 a[202:203], v3 offset:800
    v_cvt_pk_bf16_f32 v51, v34, v35
    v_mfma_f32_16x16x32_bf16 v[184:187], a[240:243], v[120:123], v[184:187]
    ds_read_b64_tr_b16 a[204:205], v3 offset:17184
    v_fma_mix_f32 v36, v58, v24, v28 op_sel:[0,0,0] op_sel_hi:[1,0,0]
    v_mfma_f32_16x16x32_bf16 v[184:187], a[244:247], v[124:127], v[184:187]
    s_waitcnt lgkmcnt(8)
    ds_read_b64_tr_b16 a[206:207], v3 offset:17696
    v_fma_mix_f32 v37, v58, v25, v29 op_sel:[1,0,0] op_sel_hi:[1,0,0]
    v_mfma_f32_16x16x32_bf16 v[156:159], a[248:251], v[112:115], v[156:159]
    ds_read_b64_tr_b16 a[208:209], v3 offset:320
    v_fma_mix_f32 v38, v59, v26, v30 op_sel:[0,0,0] op_sel_hi:[1,0,0]
    v_mfma_f32_16x16x32_bf16 v[156:159], a[252:255], v[116:119], v[156:159]
    ds_read_b64_tr_b16 a[210:211], v3 offset:832
    v_fma_mix_f32 v39, v59, v27, v31 op_sel:[1,0,0] op_sel_hi:[1,0,0]
    v_mfma_f32_16x16x32_bf16 v[188:191], a[248:251], v[120:123], v[188:191]
    ds_read_b64_tr_b16 a[212:213], v3 offset:17216
    v_cvt_pk_bf16_f32 v58, v36, v37
    v_mfma_f32_16x16x32_bf16 v[188:191], a[252:255], v[124:127], v[188:191]
    s_waitcnt lgkmcnt(7)
    ds_read_b64_tr_b16 a[214:215], v3 offset:17728
    v_cvt_pk_bf16_f32 v59, v38, v39
    v_mfma_f32_16x16x32_bf16 v[192:195], a[192:195], v[112:115], v[192:195]
    ds_read_b64_tr_b16 a[216:217], v3 offset:352
    ds_read_b128 v[24:27], v9 offset:13584
    v_mfma_f32_16x16x32_bf16 v[192:195], a[196:199], v[116:119], v[192:195]
    ds_read_b64_tr_b16 a[218:219], v3 offset:864
    ds_read_b128 v[28:31], v9 offset:13616
    v_mfma_f32_16x16x32_bf16 v[224:227], a[192:195], v[120:123], v[224:227]
    ds_read_b64_tr_b16 a[220:221], v3 offset:17248
    v_fma_mix_f32 v32, v52, v16, v20 op_sel:[0,0,0] op_sel_hi:[1,0,0]
    v_mfma_f32_16x16x32_bf16 v[224:227], a[196:199], v[124:127], v[224:227]
    s_waitcnt lgkmcnt(9)
    ds_read_b64_tr_b16 a[222:223], v3 offset:17760
    v_fma_mix_f32 v33, v52, v17, v21 op_sel:[1,0,0] op_sel_hi:[1,0,0]
    v_mfma_f32_16x16x32_bf16 v[196:199], a[200:203], v[112:115], v[196:199]
    ds_read_b64_tr_b16 a[224:225], v3 offset:384
    v_fma_mix_f32 v34, v53, v18, v22 op_sel:[0,0,0] op_sel_hi:[1,0,0]
    v_mfma_f32_16x16x32_bf16 v[196:199], a[204:207], v[116:119], v[196:199]
    ds_read_b64_tr_b16 a[226:227], v3 offset:896
    v_fma_mix_f32 v35, v53, v19, v23 op_sel:[1,0,0] op_sel_hi:[1,0,0]
    v_mfma_f32_16x16x32_bf16 v[228:231], a[200:203], v[120:123], v[228:231]
    ds_read_b64_tr_b16 a[228:229], v3 offset:17280
    v_cvt_pk_bf16_f32 v52, v32, v33
    v_mfma_f32_16x16x32_bf16 v[228:231], a[204:207], v[124:127], v[228:231]
    s_waitcnt lgkmcnt(9)
    ds_read_b64_tr_b16 a[230:231], v3 offset:17792
    v_cvt_pk_bf16_f32 v53, v34, v35
    v_mfma_f32_16x16x32_bf16 v[200:203], a[208:211], v[112:115], v[200:203]
    ds_read_b64_tr_b16 a[232:233], v3 offset:416
    v_fma_mix_f32 v36, v60, v16, v20 op_sel:[0,0,0] op_sel_hi:[1,0,0]
    v_mfma_f32_16x16x32_bf16 v[200:203], a[212:215], v[116:119], v[200:203]
    ds_read_b64_tr_b16 a[234:235], v3 offset:928
    v_fma_mix_f32 v37, v60, v17, v21 op_sel:[1,0,0] op_sel_hi:[1,0,0]
    v_mfma_f32_16x16x32_bf16 v[232:235], a[208:211], v[120:123], v[232:235]
    ds_read_b64_tr_b16 a[236:237], v3 offset:17312
    v_fma_mix_f32 v38, v61, v18, v22 op_sel:[0,0,0] op_sel_hi:[1,0,0]
    v_mfma_f32_16x16x32_bf16 v[232:235], a[212:215], v[124:127], v[232:235]
    s_waitcnt lgkmcnt(7)
    ds_read_b64_tr_b16 a[238:239], v3 offset:17824
    v_fma_mix_f32 v39, v61, v19, v23 op_sel:[1,0,0] op_sel_hi:[1,0,0]
    v_mfma_f32_16x16x32_bf16 v[204:207], a[216:219], v[112:115], v[204:207]
    ds_read_b64_tr_b16 a[240:241], v3 offset:448
    v_cvt_pk_bf16_f32 v60, v36, v37
    v_mfma_f32_16x16x32_bf16 v[204:207], a[220:223], v[116:119], v[204:207]
    ds_read_b64_tr_b16 a[242:243], v3 offset:960
    v_cvt_pk_bf16_f32 v61, v38, v39
    v_mfma_f32_16x16x32_bf16 v[236:239], a[216:219], v[120:123], v[236:239]
    ds_read_b64_tr_b16 a[244:245], v3 offset:17344
    v_mfma_f32_16x16x32_bf16 v[236:239], a[220:223], v[124:127], v[236:239]
    s_waitcnt lgkmcnt(7)
    ds_read_b64_tr_b16 a[246:247], v3 offset:17856
    v_mfma_f32_16x16x32_bf16 v[208:211], a[224:227], v[112:115], v[208:211]
    ds_read_b64_tr_b16 a[248:249], v3 offset:480
    v_fma_mix_f32 v32, v54, v24, v28 op_sel:[0,0,0] op_sel_hi:[1,0,0]
    v_mfma_f32_16x16x32_bf16 v[208:211], a[228:231], v[116:119], v[208:211]
    ds_read_b64_tr_b16 a[250:251], v3 offset:992
    v_fma_mix_f32 v33, v54, v25, v29 op_sel:[1,0,0] op_sel_hi:[1,0,0]
    v_mfma_f32_16x16x32_bf16 v[240:243], a[224:227], v[120:123], v[240:243]
    ds_read_b64_tr_b16 a[252:253], v3 offset:17376
    v_fma_mix_f32 v34, v55, v26, v30 op_sel:[0,0,0] op_sel_hi:[1,0,0]
    v_mfma_f32_16x16x32_bf16 v[240:243], a[228:231], v[124:127], v[240:243]
    s_waitcnt vmcnt(8)
    s_barrier
    s_waitcnt lgkmcnt(7)
    ds_read_b64_tr_b16 a[254:255], v3 offset:17888
    v_fma_mix_f32 v35, v55, v27, v31 op_sel:[1,0,0] op_sel_hi:[1,0,0]
    v_mfma_f32_16x16x32_bf16 v[212:215], a[232:235], v[112:115], v[212:215]
    ds_read_b64_tr_b16 a[192:193], v3 offset:36864
    v_cvt_pk_bf16_f32 v54, v32, v33
    v_mfma_f32_16x16x32_bf16 v[212:215], a[236:239], v[116:119], v[212:215]
    ds_read_b64_tr_b16 a[194:195], v3 offset:37376
    ds_read_b64_tr_b16 a[196:197], v3 offset:53760
    v_mfma_f32_16x16x32_bf16 v[244:247], a[232:235], v[120:123], v[244:247]
    s_add_u32 m0, s44, 110592
    ds_read_b64_tr_b16 a[198:199], v3 offset:54272
    v_cvt_pk_bf16_f32 v55, v34, v35
    v_mfma_f32_16x16x32_bf16 v[244:247], a[236:239], v[124:127], v[244:247]
    s_mov_b32 s46, 16384
    s_waitcnt lgkmcnt(8)
    buffer_load_dwordx4 off, s[16:19], s46 offset:0 lds
    v_mfma_f32_16x16x32_bf16 v[216:219], a[240:243], v[112:115], v[216:219]
    ds_read_b64_tr_b16 a[200:201], v3 offset:36896
    v_fma_mix_f32 v36, v62, v24, v28 op_sel:[0,0,0] op_sel_hi:[1,0,0]
    v_mfma_f32_16x16x32_bf16 v[216:219], a[244:247], v[116:119], v[216:219]
    ds_read_b64_tr_b16 a[202:203], v3 offset:37408
    ds_read_b64_tr_b16 a[204:205], v3 offset:53792
    v_fma_mix_f32 v37, v62, v25, v29 op_sel:[1,0,0] op_sel_hi:[1,0,0]
    v_mfma_f32_16x16x32_bf16 v[248:251], a[240:243], v[120:123], v[248:251]
    s_add_u32 m0, s44, 110624
    ds_read_b64_tr_b16 a[206:207], v3 offset:54304
    v_fma_mix_f32 v38, v63, v26, v30 op_sel:[0,0,0] op_sel_hi:[1,0,0]
    v_mfma_f32_16x16x32_bf16 v[248:251], a[244:247], v[124:127], v[248:251]
    s_waitcnt lgkmcnt(8)
    buffer_load_dwordx4 off, s[16:19], s46 offset:1024 lds
    v_mfma_f32_16x16x32_bf16 v[220:223], a[248:251], v[112:115], v[220:223]
    ds_read_b64_tr_b16 a[208:209], v3 offset:36928
    v_fma_mix_f32 v39, v63, v27, v31 op_sel:[1,0,0] op_sel_hi:[1,0,0]
    v_mfma_f32_16x16x32_bf16 v[220:223], a[252:255], v[116:119], v[220:223]
    ds_read_b64_tr_b16 a[210:211], v3 offset:37440
    ds_read_b64_tr_b16 a[212:213], v3 offset:53824
    v_cvt_pk_bf16_f32 v62, v36, v37
    v_mfma_f32_16x16x32_bf16 v[252:255], a[248:251], v[120:123], v[252:255]
    s_add_u32 m0, s44, 110656
    ds_read_b64_tr_b16 a[214:215], v3 offset:54336
    v_cvt_pk_bf16_f32 v63, v38, v39
    v_mfma_f32_16x16x32_bf16 v[252:255], a[252:255], v[124:127], v[252:255]
    s_waitcnt lgkmcnt(8)
    buffer_load_dwordx4 off, s[16:19], s46 offset:2048 lds
    v_mfma_f32_16x16x32_bf16 v[128:131], a[192:195], v[48:51], v[128:131]
    ds_read_b64_tr_b16 a[216:217], v3 offset:36960
    v_lshrrev_b32 v14, 2, v0
    v_mfma_f32_16x16x32_bf16 v[128:131], a[196:199], v[52:55], v[128:131]
    s_mul_i32 s3, s51, 144
    ds_read_b64_tr_b16 a[218:219], v3 offset:37472
    ds_read_b64_tr_b16 a[220:221], v3 offset:53856
    v_mfma_f32_16x16x32_bf16 v[160:163], a[192:195], v[56:59], v[160:163]
    s_add_u32 m0, s44, 110688
    ds_read_b64_tr_b16 a[222:223], v3 offset:54368
    v_add_u32 v14, s3, v14
    v_mfma_f32_16x16x32_bf16 v[160:163], a[196:199], v[60:63], v[160:163]
    s_waitcnt lgkmcnt(8)
    buffer_load_dwordx4 off, s[16:19], s46 offset:3072 lds
    v_mfma_f32_16x16x32_bf16 v[132:135], a[200:203], v[48:51], v[132:135]
    ds_read_b64_tr_b16 a[224:225], v3 offset:36992
    v_mul_u32_u24 v14, 9216, v14
    v_mfma_f32_16x16x32_bf16 v[132:135], a[204:207], v[52:55], v[132:135]
    ds_read_b64_tr_b16 a[226:227], v3 offset:37504
    ds_read_b64_tr_b16 a[228:229], v3 offset:53888
    v_mfma_f32_16x16x32_bf16 v[164:167], a[200:203], v[56:59], v[164:167]
    s_add_u32 m0, s44, 127488
    ds_read_b64_tr_b16 a[230:231], v3 offset:54400
    v_and_b32 v15, 3, v0
    v_mfma_f32_16x16x32_bf16 v[164:167], a[204:207], v[60:63], v[164:167]
    s_waitcnt lgkmcnt(8)
    buffer_load_dwordx4 off, s[20:23], s46 offset:0 lds
    v_mfma_f32_16x16x32_bf16 v[136:139], a[208:211], v[48:51], v[136:139]
    ds_read_b64_tr_b16 a[232:233], v3 offset:37024
    v_lshl_add_u32 v6, v15, 4, v14
    v_mfma_f32_16x16x32_bf16 v[136:139], a[212:215], v[52:55], v[136:139]
    s_lshr_b32 s3, s2, 3
    s_lshl2_add_u32 s3, s3, s51
    s_and_b32 s15, s2, 7
    ds_read_b64_tr_b16 a[234:235], v3 offset:37536
    ds_read_b64_tr_b16 a[236:237], v3 offset:53920
    v_mfma_f32_16x16x32_bf16 v[168:171], a[208:211], v[56:59], v[168:171]
    s_add_u32 m0, s44, 127520
    ds_read_b64_tr_b16 a[238:239], v3 offset:54432
    v_lshlrev_b32 v9, 7, v0
    v_mfma_f32_16x16x32_bf16 v[168:171], a[212:215], v[60:63], v[168:171]
    s_waitcnt lgkmcnt(8)
    s_mul_i32 s14, s3, 9
    s_lshr_b32 s14, s14, 1
    buffer_load_dwordx4 off, s[20:23], s46 offset:1024 lds
    v_mfma_f32_16x16x32_bf16 v[140:143], a[216:219], v[48:51], v[140:143]
    ds_read_b64_tr_b16 a[240:241], v3 offset:37056
    v_min_u32 v15, 44, v0
    v_mfma_f32_16x16x32_bf16 v[140:143], a[220:223], v[52:55], v[140:143]
    ds_read_b64_tr_b16 a[242:243], v3 offset:37568
    ds_read_b64_tr_b16 a[244:245], v3 offset:53952
    v_mfma_f32_16x16x32_bf16 v[172:175], a[216:219], v[56:59], v[172:175]
    s_add_u32 m0, s44, 127552
    ds_read_b64_tr_b16 a[246:247], v3 offset:54464
    v_mul_u32_u24 v12, 7282, v15
    v_mfma_f32_16x16x32_bf16 v[172:175], a[220:223], v[60:63], v[172:175]
    s_waitcnt lgkmcnt(8)
    buffer_load_dwordx4 off, s[20:23], s46 offset:2048 lds
    v_mfma_f32_16x16x32_bf16 v[144:147], a[224:227], v[48:51], v[144:147]
    ds_read_b64_tr_b16 a[248:249], v3 offset:37088
    v_lshrrev_b32 v12, 16, v12
    v_mfma_f32_16x16x32_bf16 v[144:147], a[228:231], v[52:55], v[144:147]
    ds_read_b64_tr_b16 a[250:251], v3 offset:37600
    ds_read_b64_tr_b16 a[252:253], v3 offset:53984
    v_mfma_f32_16x16x32_bf16 v[176:179], a[224:227], v[56:59], v[176:179]
    s_add_u32 m0, s44, 127584
    ds_read_b64_tr_b16 a[254:255], v3 offset:54496
    v_mul_u32_u24 v13, 63, v12
    v_mfma_f32_16x16x32_bf16 v[176:179], a[228:231], v[60:63], v[176:179]
    s_waitcnt lgkmcnt(8)
    buffer_load_dwordx4 off, s[20:23], s46 offset:3072 lds
    v_mfma_f32_16x16x32_bf16 v[148:151], a[232:235], v[48:51], v[148:151]
    ds_read_b64_tr_b16 a[192:193], v3 offset:37120
    v_add_u32 v12, v15, v13
    v_mfma_f32_16x16x32_bf16 v[148:151], a[236:239], v[52:55], v[148:151]
    s_mul_i32 s14, s14, 72
    s_mul_i32 s56, s15, 9
    s_add_u32 s14, s14, s56
    ds_read_b64_tr_b16 a[194:195], v3 offset:37632
    v_add_lshl_u32 v12, s14, v12, 7
    v_mfma_f32_16x16x32_bf16 v[180:183], a[232:235], v[56:59], v[180:183]
    s_mul_i32 s14, s3, 81
    s_lshr_b32 s14, s14, 1
    s_mul_i32 s56, s15, 5184
    s_add_u32 s14, s14, s56
    ds_read_b64_tr_b16 a[196:197], v3 offset:54016
    v_min_u32 v13, 40, v0
    v_mfma_f32_16x16x32_bf16 v[180:183], a[236:239], v[60:63], v[180:183]
    s_waitcnt lgkmcnt(7)
    ds_read_b64_tr_b16 a[198:199], v3 offset:54528
    v_add_lshl_u32 v13, s14, v13, 7
    v_mfma_f32_16x16x32_bf16 v[152:155], a[240:243], v[48:51], v[152:155]
    s_mul_i32 s14, s3, 72
    s_andn2_b32 s56, s52, 3
    s_mul_i32 s56, s56, 2304
    s_add_u32 s14, s14, s56
    ds_read_b64_tr_b16 a[200:201], v3 offset:37152
    v_min_u32 v14, 35, v0
    v_mfma_f32_16x16x32_bf16 v[152:155], a[244:247], v[52:55], v[152:155]
    ds_read_b64_tr_b16 a[202:203], v3 offset:37664
    v_add_lshl_u32 v14, s14, v14, 7
    v_mfma_f32_16x16x32_bf16 v[184:187], a[240:243], v[56:59], v[184:187]
    ds_read_b64_tr_b16 a[204:205], v3 offset:54048
    v_add_u32 v15, 4608, v14
    v_mfma_f32_16x16x32_bf16 v[184:187], a[244:247], v[60:63], v[184:187]
    s_waitcnt lgkmcnt(7)
    ds_read_b64_tr_b16 a[206:207], v3 offset:54560
    v_cvt_pk_bf16_f32 v64, v128, v129
    v_mfma_f32_16x16x32_bf16 v[156:159], a[248:251], v[48:51], v[156:159]
    ds_read_b64_tr_b16 a[208:209], v3 offset:37184
    v_cvt_pk_bf16_f32 v65, v130, v131
    v_mfma_f32_16x16x32_bf16 v[156:159], a[252:255], v[52:55], v[156:159]
    ds_read_b64_tr_b16 a[210:211], v3 offset:37696
    v_cvt_pk_bf16_f32 v66, v132, v133
    v_mfma_f32_16x16x32_bf16 v[188:191], a[248:251], v[56:59], v[188:191]
    ds_read_b64_tr_b16 a[212:213], v3 offset:54080
    v_cvt_pk_bf16_f32 v67, v134, v135
    v_mfma_f32_16x16x32_bf16 v[188:191], a[252:255], v[60:63], v[188:191]
    s_waitcnt lgkmcnt(7)
    ds_read_b64_tr_b16 a[214:215], v3 offset:54592
    v_cvt_pk_bf16_f32 v80, v160, v161
    v_mfma_f32_16x16x32_bf16 v[192:195], a[192:195], v[48:51], v[192:195]
    ds_read_b64_tr_b16 a[216:217], v3 offset:37216
    v_cvt_pk_bf16_f32 v81, v162, v163
    v_mfma_f32_16x16x32_bf16 v[192:195], a[196:199], v[52:55], v[192:195]
    ds_read_b64_tr_b16 a[218:219], v3 offset:37728
    v_cvt_pk_bf16_f32 v82, v164, v165
    v_mfma_f32_16x16x32_bf16 v[224:227], a[192:195], v[56:59], v[224:227]
    ds_read_b64_tr_b16 a[220:221], v3 offset:54112
    v_cvt_pk_bf16_f32 v83, v166, v167
    v_mfma_f32_16x16x32_bf16 v[224:227], a[196:199], v[60:63], v[224:227]
    s_waitcnt lgkmcnt(7)
    ds_read_b64_tr_b16 a[222:223], v3 offset:54624
    v_cvt_pk_bf16_f32 v68, v136, v137
    v_mfma_f32_16x16x32_bf16 v[196:199], a[200:203], v[48:51], v[196:199]
    ds_read_b64_tr_b16 a[224:225], v3 offset:37248
    v_cvt_pk_bf16_f32 v69, v138, v139
    v_mfma_f32_16x16x32_bf16 v[196:199], a[204:207], v[52:55], v[196:199]
    ds_read_b64_tr_b16 a[226:227], v3 offset:37760
    v_cvt_pk_bf16_f32 v70, v140, v141
    v_mfma_f32_16x16x32_bf16 v[228:231], a[200:203], v[56:59], v[228:231]
    ds_read_b64_tr_b16 a[228:229], v3 offset:54144
    v_cvt_pk_bf16_f32 v71, v142, v143
    v_mfma_f32_16x16x32_bf16 v[228:231], a[204:207], v[60:63], v[228:231]
    s_waitcnt vmcnt(8)
    s_barrier
    s_waitcnt lgkmcnt(7)
    ds_read_b64_tr_b16 a[230:231], v3 offset:54656
    v_cvt_pk_bf16_f32 v84, v168, v169
    v_mfma_f32_16x16x32_bf16 v[200:203], a[208:211], v[48:51], v[200:203]
L2_pad3:
    s_cbranch_execz L2_pad7
    ds_read_b64_tr_b16 a[232:233], v3 offset:37280
    v_cvt_pk_bf16_f32 v85, v170, v171
    v_mfma_f32_16x16x32_bf16 v[200:203], a[212:215], v[52:55], v[200:203]
    ds_read_b64_tr_b16 a[234:235], v3 offset:37792
    ds_read_b64_tr_b16 a[236:237], v3 offset:54176
    v_mfma_f32_16x16x32_bf16 v[232:235], a[208:211], v[56:59], v[232:235]
    s_add_u32 m0, s44, 0
    ds_read_b64_tr_b16 a[238:239], v3 offset:54688
    v_cvt_pk_bf16_f32 v86, v172, v173
    v_mfma_f32_16x16x32_bf16 v[232:235], a[212:215], v[60:63], v[232:235]
    s_mov_b32 s46, 32768
    s_waitcnt lgkmcnt(8)
    buffer_load_dwordx4 off, s[16:19], s46 offset:0 lds
    v_mfma_f32_16x16x32_bf16 v[204:207], a[216:219], v[48:51], v[204:207]
    ds_read_b64_tr_b16 a[240:241], v3 offset:37312
    v_cvt_pk_bf16_f32 v87, v174, v175
    v_mfma_f32_16x16x32_bf16 v[204:207], a[220:223], v[52:55], v[204:207]
    ds_read_b64_tr_b16 a[242:243], v3 offset:37824
    ds_read_b64_tr_b16 a[244:245], v3 offset:54208
    v_mfma_f32_16x16x32_bf16 v[236:239], a[216:219], v[56:59], v[236:239]
    s_add_u32 m0, s44, 32
    ds_read_b64_tr_b16 a[246:247], v3 offset:54720
    v_cvt_pk_bf16_f32 v72, v144, v145
    v_mfma_f32_16x16x32_bf16 v[236:239], a[220:223], v[60:63], v[236:239]
    s_waitcnt lgkmcnt(8)
    buffer_load_dwordx4 off, s[16:19], s46 offset:1024 lds
    v_mfma_f32_16x16x32_bf16 v[208:211], a[224:227], v[48:51], v[208:211]
    ds_read_b64_tr_b16 a[248:249], v3 offset:37344
    v_cvt_pk_bf16_f32 v73, v146, v147
    v_mfma_f32_16x16x32_bf16 v[208:211], a[228:231], v[52:55], v[208:211]
    ds_read_b64_tr_b16 a[250:251], v3 offset:37856
    ds_read_b64_tr_b16 a[252:253], v3 offset:54240
    v_mfma_f32_16x16x32_bf16 v[240:243], a[224:227], v[56:59], v[240:243]
    s_add_u32 m0, s44, 64
    ds_read_b64_tr_b16 a[254:255], v3 offset:54752
    v_cvt_pk_bf16_f32 v74, v148, v149
    v_mfma_f32_16x16x32_bf16 v[240:243], a[228:231], v[60:63], v[240:243]
    s_waitcnt lgkmcnt(8)
    buffer_load_dwordx4 off, s[16:19], s46 offset:2048 lds
    v_mfma_f32_16x16x32_bf16 v[212:215], a[232:235], v[48:51], v[212:215]
    ds_read_b128 a[64:67], v1 offset:0
    ds_read_b128 a[68:71], v1 offset:64
    v_mfma_f32_16x16x32_bf16 v[212:215], a[236:239], v[52:55], v[212:215]
    ds_read_b128 a[72:75], v1 offset:128
    ds_read_b128 a[76:79], v1 offset:192
    v_mfma_f32_16x16x32_bf16 v[244:247], a[232:235], v[56:59], v[244:247]
    s_add_u32 m0, s44, 96
    ds_read_b128 a[80:83], v1 offset:256
    ds_read_b128 a[84:87], v1 offset:320
    v_mfma_f32_16x16x32_bf16 v[244:247], a[236:239], v[60:63], v[244:247]
    s_waitcnt lgkmcnt(10)
    buffer_load_dwordx4 off, s[16:19], s46 offset:3072 lds
    v_mfma_f32_16x16x32_bf16 v[216:219], a[240:243], v[48:51], v[216:219]
    ds_read_b128 a[88:91], v1 offset:384
    ds_read_b128 a[92:95], v1 offset:448
    v_mfma_f32_16x16x32_bf16 v[216:219], a[244:247], v[52:55], v[216:219]
    ds_read_b128 a[96:99], v1 offset:512
    ds_read_b128 a[100:103], v1 offset:576
    v_mfma_f32_16x16x32_bf16 v[248:251], a[240:243], v[56:59], v[248:251]
    s_add_u32 m0, s44, 16896
    ds_read_b128 a[104:107], v1 offset:640
    ds_read_b128 a[108:111], v1 offset:704
    v_mfma_f32_16x16x32_bf16 v[248:251], a[244:247], v[60:63], v[248:251]
    s_waitcnt lgkmcnt(12)
    buffer_load_dwordx4 off, s[20:23], s46 offset:0 lds
    v_mfma_f32_16x16x32_bf16 v[220:223], a[248:251], v[48:51], v[220:223]
    ds_read_b128 a[112:115], v1 offset:768
    ds_read_b128 a[116:119], v1 offset:832
    v_mfma_f32_16x16x32_bf16 v[220:223], a[252:255], v[52:55], v[220:223]
    ds_read_b128 a[120:123], v1 offset:896
    ds_read_b128 a[124:127], v1 offset:960
    v_mfma_f32_16x16x32_bf16 v[252:255], a[248:251], v[56:59], v[252:255]
    s_add_u32 m0, s44, 16928
    v_cvt_pk_bf16_f32 v75, v150, v151
    v_cvt_pk_bf16_f32 v88, v176, v177
    v_mfma_f32_16x16x32_bf16 v[252:255], a[252:255], v[60:63], v[252:255]
    buffer_load_dwordx4 off, s[20:23], s46 offset:1024 lds
    s_mul_i32 s3, s96, 9216
    s_add_u32 s3, s3, 4194304
    s_add_u32 s32, s84, s3
    s_addc_u32 s33, s85, 0
    s_mov_b32 s34, 9216
    s_mov_b32 s35, 0x20000
    s_add_u32 m0, s44, 16960
    s_nop 0
    buffer_load_dwordx4 off, s[20:23], s46 offset:2048 lds
    s_add_u32 m0, s44, 16992
    s_nop 0
    buffer_load_dwordx4 off, s[20:23], s46 offset:3072 lds
    v_cvt_pk_bf16_f32 v89, v178, v179
    v_cvt_pk_bf16_f32 v90, v180, v181
    v_cvt_pk_bf16_f32 v91, v182, v183
    v_cvt_pk_bf16_f32 v76, v152, v153
    v_cvt_pk_bf16_f32 v77, v154, v155
    v_cvt_pk_bf16_f32 v78, v156, v157
    v_cvt_pk_bf16_f32 v79, v158, v159
    v_cvt_pk_bf16_f32 v92, v184, v185
    v_cvt_pk_bf16_f32 v93, v186, v187
    v_cvt_pk_bf16_f32 v94, v188, v189
    v_cvt_pk_bf16_f32 v95, v190, v191
    v_permlane32_swap_b32 v64, v66
    v_permlane32_swap_b32 v65, v67
    v_permlane32_swap_b32 v80, v82
    v_permlane32_swap_b32 v81, v83
    v_permlane32_swap_b32 v68, v70
    v_permlane32_swap_b32 v69, v71
    v_permlane32_swap_b32 v84, v86
    v_permlane32_swap_b32 v85, v87
    v_permlane32_swap_b32 v72, v74
    v_permlane32_swap_b32 v73, v75
    v_permlane32_swap_b32 v88, v90
    v_permlane32_swap_b32 v89, v91
    v_permlane32_swap_b32 v76, v78
    v_permlane32_swap_b32 v77, v79
    v_permlane32_swap_b32 v92, v94
    v_permlane32_swap_b32 v93, v95
    v_cvt_pk_bf16_f32 v96, v192, v193
    v_cvt_pk_bf16_f32 v97, v194, v195
    v_cvt_pk_bf16_f32 v98, v196, v197
    v_cvt_pk_bf16_f32 v99, v198, v199
    v_cvt_pk_bf16_f32 v112, v224, v225
    v_cvt_pk_bf16_f32 v113, v226, v227
    v_cvt_pk_bf16_f32 v114, v228, v229
    v_cvt_pk_bf16_f32 v115, v230, v231
    v_cvt_pk_bf16_f32 v100, v200, v201
    v_cvt_pk_bf16_f32 v101, v202, v203
    v_cvt_pk_bf16_f32 v102, v204, v205
    v_cvt_pk_bf16_f32 v103, v206, v207
    v_cvt_pk_bf16_f32 v116, v232, v233
    v_cvt_pk_bf16_f32 v117, v234, v235
    v_cvt_pk_bf16_f32 v118, v236, v237
    v_cvt_pk_bf16_f32 v119, v238, v239
    v_cvt_pk_bf16_f32 v104, v208, v209
    v_cvt_pk_bf16_f32 v105, v210, v211
    v_cvt_pk_bf16_f32 v106, v212, v213
    v_cvt_pk_bf16_f32 v107, v214, v215
    v_cvt_pk_bf16_f32 v120, v240, v241
    v_cvt_pk_bf16_f32 v121, v242, v243
    v_cvt_pk_bf16_f32 v122, v244, v245
    v_cvt_pk_bf16_f32 v123, v246, v247
    v_cvt_pk_bf16_f32 v108, v216, v217
    v_cvt_pk_bf16_f32 v109, v218, v219
    v_cvt_pk_bf16_f32 v110, v220, v221
    v_cvt_pk_bf16_f32 v111, v222, v223
    v_cvt_pk_bf16_f32 v124, v248, v249
    v_cvt_pk_bf16_f32 v125, v250, v251
    v_cvt_pk_bf16_f32 v126, v252, v253
    v_cvt_pk_bf16_f32 v127, v254, v255
    s_nop 0
    v_permlane32_swap_b32 v96, v98
    v_permlane32_swap_b32 v97, v99
    v_permlane32_swap_b32 v112, v114
    v_permlane32_swap_b32 v113, v115
    v_permlane32_swap_b32 v100, v102
    v_permlane32_swap_b32 v101, v103
    v_permlane32_swap_b32 v116, v118
    v_permlane32_swap_b32 v117, v119
    v_permlane32_swap_b32 v104, v106
    v_permlane32_swap_b32 v105, v107
    v_permlane32_swap_b32 v120, v122
    v_permlane32_swap_b32 v121, v123
    v_permlane32_swap_b32 v108, v110
    v_permlane32_swap_b32 v109, v111
    v_permlane32_swap_b32 v124, v126
    v_permlane32_swap_b32 v125, v127
    s_waitcnt lgkmcnt(12)
    v_mfma_f32_16x16x32_bf16 v[16:19], a[64:67], v[64:67], 0
    v_mfma_f32_16x16x32_bf16 v[16:19], a[68:71], v[68:71], v[16:19]
    v_mfma_f32_16x16x32_bf16 v[16:19], a[72:75], v[72:75], v[16:19]
    v_mfma_f32_16x16x32_bf16 v[16:19], a[76:79], v[76:79], v[16:19]
    v_mfma_f32_16x16x32_bf16 v[20:23], a[64:67], v[80:83], 0
    v_mfma_f32_16x16x32_bf16 v[20:23], a[68:71], v[84:87], v[20:23]
    v_mfma_f32_16x16x32_bf16 v[20:23], a[72:75], v[88:91], v[20:23]
    v_mfma_f32_16x16x32_bf16 v[20:23], a[76:79], v[92:95], v[20:23]
    v_mfma_f32_16x16x32_bf16 v[24:27], a[64:67], v[96:99], 0
    v_mfma_f32_16x16x32_bf16 v[24:27], a[68:71], v[100:103], v[24:27]
    v_mfma_f32_16x16x32_bf16 v[24:27], a[72:75], v[104:107], v[24:27]
    v_mfma_f32_16x16x32_bf16 v[24:27], a[76:79], v[108:111], v[24:27]
    v_mfma_f32_16x16x32_bf16 v[28:31], a[64:67], v[112:115], 0
    v_mfma_f32_16x16x32_bf16 v[28:31], a[68:71], v[116:119], v[28:31]
    v_mfma_f32_16x16x32_bf16 v[28:31], a[72:75], v[120:123], v[28:31]
    v_mfma_f32_16x16x32_bf16 v[28:31], a[76:79], v[124:127], v[28:31]
    s_nop 1
    v_max3_f32 v16, v16, v17, v18
    v_max_f32 v16, v16, v19
    v_max3_f32 v20, v20, v21, v22
    v_max_f32 v20, v20, v23
    v_max3_f32 v24, v24, v25, v26
    v_max_f32 v24, v24, v27
    v_max3_f32 v28, v28, v29, v30
    v_max_f32 v28, v28, v31
    v_mov_b32 v40, v16
    v_mov_b32 v41, v20
    v_mov_b32 v42, v24
    v_mov_b32 v43, v28
    v_permlane16_swap_b32 v40, v16
    v_permlane16_swap_b32 v41, v20
    v_permlane16_swap_b32 v42, v24
    v_permlane16_swap_b32 v43, v28
    v_max_f32 v16, v16, v40
    v_max_f32 v20, v20, v41
    v_max_f32 v24, v24, v42
    v_max_f32 v28, v28, v43
    v_mov_b32 v40, v16
    v_mov_b32 v41, v20
    v_mov_b32 v42, v24
    v_mov_b32 v43, v28
    v_permlane32_swap_b32 v40, v16
    v_permlane32_swap_b32 v41, v20
    v_permlane32_swap_b32 v42, v24
    v_permlane32_swap_b32 v43, v28
    v_max_f32 v16, v16, v40
    v_max_f32 v20, v20, v41
    v_max_f32 v24, v24, v42
    v_max_f32 v28, v28, v43
    v_sub_f32 v48, 0xc2800000, v16
    v_sub_f32 v49, 0xc2800000, v16
    v_sub_f32 v50, 0xc2800000, v16
    v_sub_f32 v51, 0xc2800000, v16
    v_sub_f32 v52, 0xc2800000, v20
    v_sub_f32 v53, 0xc2800000, v20
    v_sub_f32 v54, 0xc2800000, v20
    v_sub_f32 v55, 0xc2800000, v20
    v_sub_f32 v56, 0xc2800000, v24
    v_sub_f32 v57, 0xc2800000, v24
    v_sub_f32 v58, 0xc2800000, v24
    v_sub_f32 v59, 0xc2800000, v24
    v_sub_f32 v60, 0xc2800000, v28
    v_sub_f32 v61, 0xc2800000, v28
    v_sub_f32 v62, 0xc2800000, v28
    v_sub_f32 v63, 0xc2800000, v28
L2_entry:
    s_mov_b32 s47, s44
    s_mov_b32 s48, -73728
    s_mov_b32 s49, 11
    s_mov_b32 s46, 32768
    s_mov_b32 s100, 0x07060302
    s_waitcnt vmcnt(8)
    s_barrier
    v_mfma_f32_16x16x32_bf16 v[16:19], a[64:67], v[64:67], v[48:51]
    ds_read_b64_tr_b16 a[128:129], v2 offset:0
    ds_read_b64_tr_b16 a[130:131], v2 offset:256
    v_mfma_f32_16x16x32_bf16 v[16:19], a[68:71], v[68:71], v[16:19]
    ds_read_b64_tr_b16 a[132:133], v2 offset:512
    ds_read_b64_tr_b16 a[134:135], v2 offset:768
    v_mfma_f32_16x16x32_bf16 v[16:19], a[72:75], v[72:75], v[16:19]
    s_add_u32 m0, s47, 36864
    ds_read_b64_tr_b16 a[136:137], v2 offset:32
    ds_read_b64_tr_b16 a[138:139], v2 offset:288
    v_mfma_f32_16x16x32_bf16 v[16:19], a[76:79], v[76:79], v[16:19]
    s_waitcnt lgkmcnt(14)
    s_add_u32 s46, s46, 16384
    buffer_load_dwordx4 off, s[16:19], s46 offset:0 lds
    v_mfma_f32_16x16x32_bf16 v[20:23], a[80:83], v[64:67], v[48:51]
    ds_read_b64_tr_b16 a[140:141], v2 offset:544
    ds_read_b64_tr_b16 a[142:143], v2 offset:800
    v_mfma_f32_16x16x32_bf16 v[20:23], a[84:87], v[68:71], v[20:23]
    ds_read_b64_tr_b16 a[144:145], v2 offset:64
    ds_read_b64_tr_b16 a[146:147], v2 offset:320
    v_mfma_f32_16x16x32_bf16 v[20:23], a[88:91], v[72:75], v[20:23]
    s_add_u32 m0, s47, 36896
    ds_read_b64_tr_b16 a[148:149], v2 offset:576
    ds_read_b64_tr_b16 a[150:151], v2 offset:832
    v_mfma_f32_16x16x32_bf16 v[20:23], a[92:95], v[76:79], v[20:23]
    s_waitcnt lgkmcnt(15)
    buffer_load_dwordx4 off, s[16:19], s46 offset:1024 lds
    v_mfma_f32_16x16x32_bf16 v[24:27], a[96:99], v[64:67], v[48:51]
    s_nop 1
    v_exp_f32 v16, v16
    v_mfma_f32_16x16x32_bf16 v[24:27], a[100:103], v[68:71], v[24:27]
    ds_read_b64_tr_b16 a[152:153], v2 offset:96
    ds_read_b64_tr_b16 a[154:155], v2 offset:352
    v_mfma_f32_16x16x32_bf16 v[24:27], a[104:107], v[72:75], v[24:27]
    s_add_u32 m0, s47, 36928
    v_exp_f32 v17, v17
    v_mfma_f32_16x16x32_bf16 v[24:27], a[108:111], v[76:79], v[24:27]
    s_waitcnt lgkmcnt(14)
    buffer_load_dwordx4 off, s[16:19], s46 offset:2048 lds
    v_mfma_f32_16x16x32_bf16 v[28:31], a[112:115], v[64:67], v[48:51]
    v_exp_f32 v18, v18
    v_mfma_f32_16x16x32_bf16 v[28:31], a[116:119], v[68:71], v[28:31]
    ds_read_b64_tr_b16 a[156:157], v2 offset:608
    v_perm_b32 v32, v17, v16, s100
    v_mfma_f32_16x16x32_bf16 v[28:31], a[120:123], v[72:75], v[28:31]
    s_add_u32 m0, s47, 36960
    v_exp_f32 v19, v19
    v_mfma_f32_16x16x32_bf16 v[28:31], a[124:127], v[76:79], v[28:31]
    buffer_load_dwordx4 off, s[16:19], s46 offset:3072 lds
    s_nop 3
    ds_read_b64_tr_b16 a[158:159], v2 offset:864
    ds_read_b64_tr_b16 a[160:161], v2 offset:128
    ds_read_b64_tr_b16 a[162:163], v2 offset:384
    ds_read_b64_tr_b16 a[164:165], v2 offset:640
    ds_read_b64_tr_b16 a[166:167], v2 offset:896
    ds_read_b64_tr_b16 a[168:169], v2 offset:160
    ds_read_b64_tr_b16 a[170:171], v2 offset:416
    ds_read_b64_tr_b16 a[172:173], v2 offset:672
    ds_read_b64_tr_b16 a[174:175], v2 offset:928
    ds_read_b64_tr_b16 a[176:177], v2 offset:192
    ds_read_b64_tr_b16 a[178:179], v2 offset:448
    ds_read_b64_tr_b16 a[180:181], v2 offset:704
    ds_read_b64_tr_b16 a[182:183], v2 offset:960
    ds_read_b64_tr_b16 a[184:185], v2 offset:224
    ds_read_b64_tr_b16 a[186:187], v2 offset:480
    ds_read_b64_tr_b16 a[188:189], v2 offset:736
    ds_read_b64_tr_b16 a[190:191], v2 offset:992
    v_exp_f32 v20, v20
    s_nop 0
    ds_read_b64_tr_b16 a[192:193], v2 offset:36864
    v_perm_b32 v33, v19, v18, s100
    s_add_u32 m0, s47, 53760
    v_exp_f32 v21, v21
    s_nop 0
    buffer_load_dwordx4 off, s[20:23], s46 offset:0 lds
    v_exp_f32 v22, v22
    s_nop 0
    ds_read_b64_tr_b16 a[194:195], v2 offset:37120
    v_perm_b32 v34, v21, v20, s100
    s_add_u32 m0, s47, 53792
    v_exp_f32 v23, v23
    s_nop 0
    buffer_load_dwordx4 off, s[20:23], s46 offset:1024 lds
    v_exp_f32 v24, v24
    s_nop 0
    ds_read_b64_tr_b16 a[196:197], v2 offset:37376
    v_perm_b32 v35, v23, v22, s100
    s_add_u32 m0, s47, 53824
    v_exp_f32 v25, v25
    s_nop 0
    buffer_load_dwordx4 off, s[20:23], s46 offset:2048 lds
    v_exp_f32 v26, v26
    s_nop 0
    ds_read_b64_tr_b16 a[198:199], v2 offset:37632
    v_perm_b32 v36, v25, v24, s100
    s_add_u32 m0, s47, 53856
    v_exp_f32 v27, v27
    s_nop 0
    buffer_load_dwordx4 off, s[20:23], s46 offset:3072 lds
    ds_read_b64_tr_b16 a[200:201], v2 offset:36896
    s_nop 0
    v_mfma_f32_16x16x32_bf16 v[16:19], a[64:67], v[80:83], v[52:55]
    v_exp_f32 v28, v28
    v_mfma_f32_16x16x32_bf16 v[16:19], a[68:71], v[84:87], v[16:19]
    ds_read_b64_tr_b16 a[202:203], v2 offset:37152
    v_perm_b32 v37, v27, v26, s100
    v_mfma_f32_16x16x32_bf16 v[16:19], a[72:75], v[88:91], v[16:19]
    v_exp_f32 v29, v29
    v_mfma_f32_16x16x32_bf16 v[16:19], a[76:79], v[92:95], v[16:19]
    ds_read_b64_tr_b16 a[204:205], v2 offset:37408
    v_mov_b32 v224, 0
    v_mfma_f32_16x16x32_bf16 v[20:23], a[80:83], v[80:83], v[52:55]
    v_exp_f32 v30, v30
    v_mfma_f32_16x16x32_bf16 v[20:23], a[84:87], v[84:87], v[20:23]
    ds_read_b64_tr_b16 a[206:207], v2 offset:37664
    v_perm_b32 v38, v29, v28, s100
    v_mfma_f32_16x16x32_bf16 v[20:23], a[88:91], v[88:91], v[20:23]
    v_exp_f32 v31, v31
    v_mfma_f32_16x16x32_bf16 v[20:23], a[92:95], v[92:95], v[20:23]
    ds_read_b64_tr_b16 a[208:209], v2 offset:36928
    v_mov_b32 v225, 0
    v_mfma_f32_16x16x32_bf16 v[24:27], a[96:99], v[80:83], v[52:55]
    v_exp_f32 v16, v16
    v_mfma_f32_16x16x32_bf16 v[24:27], a[100:103], v[84:87], v[24:27]
    ds_read_b64_tr_b16 a[210:211], v2 offset:37184
    v_perm_b32 v39, v31, v30, s100
    v_mfma_f32_16x16x32_bf16 v[24:27], a[104:107], v[88:91], v[24:27]
    v_exp_f32 v17, v17
    v_mfma_f32_16x16x32_bf16 v[24:27], a[108:111], v[92:95], v[24:27]
    ds_read_b64_tr_b16 a[212:213], v2 offset:37440
    v_mov_b32 v226, 0
    v_mfma_f32_16x16x32_bf16 v[28:31], a[112:115], v[80:83], v[52:55]
    v_exp_f32 v18, v18
    v_mfma_f32_16x16x32_bf16 v[28:31], a[116:119], v[84:87], v[28:31]
    ds_read_b64_tr_b16 a[214:215], v2 offset:37696
    v_perm_b32 v40, v17, v16, s100
    v_mfma_f32_16x16x32_bf16 v[28:31], a[120:123], v[88:91], v[28:31]
    s_waitcnt lgkmcnt(12)
    v_exp_f32 v19, v19
    v_mfma_f32_16x16x32_bf16 v[28:31], a[124:127], v[92:95], v[28:31]
    ds_read_b64_tr_b16 a[216:217], v2 offset:36960
    v_mov_b32 v227, 0
    v_mfma_f32_16x16x32_bf16 v[128:131], a[128:131], v[32:35], 0
    v_exp_f32 v20, v20
    v_mfma_f32_16x16x32_bf16 v[128:131], a[132:135], v[36:39], v[128:131]
    ds_read_b64_tr_b16 a[218:219], v2 offset:37216
    v_perm_b32 v41, v19, v18, s100
    v_mfma_f32_16x16x32_bf16 v[132:135], a[136:139], v[32:35], 0
    v_exp_f32 v21, v21
    v_mfma_f32_16x16x32_bf16 v[132:135], a[140:143], v[36:39], v[132:135]
    ds_read_b64_tr_b16 a[220:221], v2 offset:37472
    v_mov_b32 v228, 0
    v_mfma_f32_16x16x32_bf16 v[136:139], a[144:147], v[32:35], 0
    v_exp_f32 v22, v22
    v_mfma_f32_16x16x32_bf16 v[136:139], a[148:151], v[36:39], v[136:139]
    ds_read_b64_tr_b16 a[222:223], v2 offset:37728
    v_perm_b32 v42, v21, v20, s100
    v_mfma_f32_16x16x32_bf16 v[140:143], a[152:155], v[32:35], 0
    v_exp_f32 v23, v23
    v_mfma_f32_16x16x32_bf16 v[140:143], a[156:159], v[36:39], v[140:143]
    ds_read_b64_tr_b16 a[224:225], v2 offset:36992
    v_mov_b32 v229, 0
    v_mfma_f32_16x16x32_bf16 v[144:147], a[160:163], v[32:35], 0
    v_exp_f32 v24, v24
    v_mfma_f32_16x16x32_bf16 v[144:147], a[164:167], v[36:39], v[144:147]
    ds_read_b64_tr_b16 a[226:227], v2 offset:37248
    v_perm_b32 v43, v23, v22, s100
    v_mfma_f32_16x16x32_bf16 v[148:151], a[168:171], v[32:35], 0
    v_exp_f32 v25, v25
    v_mfma_f32_16x16x32_bf16 v[148:151], a[172:175], v[36:39], v[148:151]
    ds_read_b64_tr_b16 a[228:229], v2 offset:37504
    v_mov_b32 v230, 0
    v_mfma_f32_16x16x32_bf16 v[152:155], a[176:179], v[32:35], 0
    v_exp_f32 v26, v26
    v_mfma_f32_16x16x32_bf16 v[152:155], a[180:183], v[36:39], v[152:155]
    ds_read_b64_tr_b16 a[230:231], v2 offset:37760
    v_perm_b32 v44, v25, v24, s100
    v_mfma_f32_16x16x32_bf16 v[156:159], a[184:187], v[32:35], 0
    v_exp_f32 v27, v27
    v_mfma_f32_16x16x32_bf16 v[156:159], a[188:191], v[36:39], v[156:159]
    ds_read_b64_tr_b16 a[232:233], v2 offset:37024
    v_mov_b32 v231, 0
    v_smfmac_f32_16x16x64_bf16 a[0:3], a[16:19], v[32:39], v11
    ds_read_b64_tr_b16 a[234:235], v2 offset:37280
    v_mov_b32 v232, 0
    v_mfma_f32_16x16x32_bf16 v[16:19], a[64:67], v[96:99], v[56:59]
    v_exp_f32 v28, v28
    v_mfma_f32_16x16x32_bf16 v[16:19], a[68:71], v[100:103], v[16:19]
    ds_read_b64_tr_b16 a[236:237], v2 offset:37536
    v_perm_b32 v45, v27, v26, s100
    v_mfma_f32_16x16x32_bf16 v[16:19], a[72:75], v[104:107], v[16:19]
    v_exp_f32 v29, v29
    v_mfma_f32_16x16x32_bf16 v[16:19], a[76:79], v[108:111], v[16:19]
    ds_read_b64_tr_b16 a[238:239], v2 offset:37792
    v_mov_b32 v233, 0
    v_mfma_f32_16x16x32_bf16 v[20:23], a[80:83], v[96:99], v[56:59]
    v_exp_f32 v30, v30
    v_mfma_f32_16x16x32_bf16 v[20:23], a[84:87], v[100:103], v[20:23]
    ds_read_b64_tr_b16 a[240:241], v2 offset:37056
    v_perm_b32 v46, v29, v28, s100
    v_mfma_f32_16x16x32_bf16 v[20:23], a[88:91], v[104:107], v[20:23]
    v_exp_f32 v31, v31
    v_mfma_f32_16x16x32_bf16 v[20:23], a[92:95], v[108:111], v[20:23]
    ds_read_b64_tr_b16 a[242:243], v2 offset:37312
    v_mov_b32 v234, 0
    v_mfma_f32_16x16x32_bf16 v[24:27], a[96:99], v[96:99], v[56:59]
    v_exp_f32 v16, v16
    v_mfma_f32_16x16x32_bf16 v[24:27], a[100:103], v[100:103], v[24:27]
    ds_read_b64_tr_b16 a[244:245], v2 offset:37568
    v_perm_b32 v47, v31, v30, s100
    v_mfma_f32_16x16x32_bf16 v[24:27], a[104:107], v[104:107], v[24:27]
    v_exp_f32 v17, v17
    v_mfma_f32_16x16x32_bf16 v[24:27], a[108:111], v[108:111], v[24:27]
    ds_read_b64_tr_b16 a[246:247], v2 offset:37824
    v_mov_b32 v235, 0
    v_mfma_f32_16x16x32_bf16 v[28:31], a[112:115], v[96:99], v[56:59]
    v_exp_f32 v18, v18
    v_mfma_f32_16x16x32_bf16 v[28:31], a[116:119], v[100:103], v[28:31]
    ds_read_b64_tr_b16 a[248:249], v2 offset:37088
    v_perm_b32 v32, v17, v16, s100
    v_mfma_f32_16x16x32_bf16 v[28:31], a[120:123], v[104:107], v[28:31]
    v_exp_f32 v19, v19
    v_mfma_f32_16x16x32_bf16 v[28:31], a[124:127], v[108:111], v[28:31]
    ds_read_b64_tr_b16 a[250:251], v2 offset:37344
    v_mov_b32 v236, 0
    v_mfma_f32_16x16x32_bf16 v[160:163], a[128:131], v[40:43], 0
    v_exp_f32 v20, v20
    v_mfma_f32_16x16x32_bf16 v[160:163], a[132:135], v[44:47], v[160:163]
    ds_read_b64_tr_b16 a[252:253], v2 offset:37600
    v_perm_b32 v33, v19, v18, s100
    v_mfma_f32_16x16x32_bf16 v[164:167], a[136:139], v[40:43], 0
    v_exp_f32 v21, v21
    v_mfma_f32_16x16x32_bf16 v[164:167], a[140:143], v[44:47], v[164:167]
    ds_read_b64_tr_b16 a[254:255], v2 offset:37856
    v_mov_b32 v237, 0
    v_mfma_f32_16x16x32_bf16 v[168:171], a[144:147], v[40:43], 0
    v_exp_f32 v22, v22
    v_mfma_f32_16x16x32_bf16 v[168:171], a[148:151], v[44:47], v[168:171]
    v_perm_b32 v34, v21, v20, s100
    v_mov_b32 v238, 0
    v_mfma_f32_16x16x32_bf16 v[172:175], a[152:155], v[40:43], 0
    v_exp_f32 v23, v23
    v_mfma_f32_16x16x32_bf16 v[172:175], a[156:159], v[44:47], v[172:175]
    v_mov_b32 v239, 0
    v_mov_b32 v240, 0
    v_mfma_f32_16x16x32_bf16 v[176:179], a[160:163], v[40:43], 0
    v_exp_f32 v24, v24
    v_mfma_f32_16x16x32_bf16 v[176:179], a[164:167], v[44:47], v[176:179]
    v_perm_b32 v35, v23, v22, s100
    v_mov_b32 v241, 0
    v_mfma_f32_16x16x32_bf16 v[180:183], a[168:171], v[40:43], 0
    v_exp_f32 v25, v25
    v_mfma_f32_16x16x32_bf16 v[180:183], a[172:175], v[44:47], v[180:183]
    v_mov_b32 v242, 0
    v_mov_b32 v243, 0
    v_mfma_f32_16x16x32_bf16 v[184:187], a[176:179], v[40:43], 0
    v_exp_f32 v26, v26
    v_mfma_f32_16x16x32_bf16 v[184:187], a[180:183], v[44:47], v[184:187]
    v_perm_b32 v36, v25, v24, s100
    v_mov_b32 v244, 0
    v_mfma_f32_16x16x32_bf16 v[188:191], a[184:187], v[40:43], 0
    v_exp_f32 v27, v27
    v_mfma_f32_16x16x32_bf16 v[188:191], a[188:191], v[44:47], v[188:191]
    v_mov_b32 v245, 0
    v_mov_b32 v246, 0
    v_smfmac_f32_16x16x64_bf16 a[4:7], a[16:19], v[40:47], v11
    v_mov_b32 v247, 0
    v_mov_b32 v248, 0
    v_mfma_f32_16x16x32_bf16 v[16:19], a[64:67], v[112:115], v[60:63]
    v_exp_f32 v28, v28
    v_mfma_f32_16x16x32_bf16 v[16:19], a[68:71], v[116:119], v[16:19]
    ds_read_b128 a[64:67], v1 offset:36864
    v_perm_b32 v37, v27, v26, s100
    v_mfma_f32_16x16x32_bf16 v[16:19], a[72:75], v[120:123], v[16:19]
    v_exp_f32 v29, v29
    v_mfma_f32_16x16x32_bf16 v[16:19], a[76:79], v[124:127], v[16:19]
    ds_read_b128 a[68:71], v1 offset:36928
    v_mov_b32 v249, 0
    v_mfma_f32_16x16x32_bf16 v[20:23], a[80:83], v[112:115], v[60:63]
    v_exp_f32 v30, v30
    v_mfma_f32_16x16x32_bf16 v[20:23], a[84:87], v[116:119], v[20:23]
    ds_read_b128 a[72:75], v1 offset:36992
    v_perm_b32 v38, v29, v28, s100
    v_mfma_f32_16x16x32_bf16 v[20:23], a[88:91], v[120:123], v[20:23]
    v_exp_f32 v31, v31
    v_mfma_f32_16x16x32_bf16 v[20:23], a[92:95], v[124:127], v[20:23]
    ds_read_b128 a[76:79], v1 offset:37056
    v_mov_b32 v250, 0
    v_mfma_f32_16x16x32_bf16 v[24:27], a[96:99], v[112:115], v[60:63]
    v_exp_f32 v16, v16
    v_mfma_f32_16x16x32_bf16 v[24:27], a[100:103], v[116:119], v[24:27]
    ds_read_b128 a[80:83], v1 offset:37120
    v_perm_b32 v39, v31, v30, s100
    v_mfma_f32_16x16x32_bf16 v[24:27], a[104:107], v[120:123], v[24:27]
    v_exp_f32 v17, v17
    v_mfma_f32_16x16x32_bf16 v[24:27], a[108:111], v[124:127], v[24:27]
    ds_read_b128 a[84:87], v1 offset:37184
    v_mov_b32 v251, 0
    v_mfma_f32_16x16x32_bf16 v[28:31], a[112:115], v[112:115], v[60:63]
    v_exp_f32 v18, v18
    v_mfma_f32_16x16x32_bf16 v[28:31], a[116:119], v[116:119], v[28:31]
    ds_read_b128 a[88:91], v1 offset:37248
    v_perm_b32 v40, v17, v16, s100
    v_mfma_f32_16x16x32_bf16 v[28:31], a[120:123], v[120:123], v[28:31]
    v_exp_f32 v19, v19
    v_mfma_f32_16x16x32_bf16 v[28:31], a[124:127], v[124:127], v[28:31]
    ds_read_b128 a[92:95], v1 offset:37312
    v_mov_b32 v252, 0
    v_mfma_f32_16x16x32_bf16 v[192:195], a[128:131], v[32:35], 0
    v_exp_f32 v20, v20
    v_mfma_f32_16x16x32_bf16 v[192:195], a[132:135], v[36:39], v[192:195]
    ds_read_b128 a[96:99], v1 offset:37376
    v_perm_b32 v41, v19, v18, s100
    v_mfma_f32_16x16x32_bf16 v[196:199], a[136:139], v[32:35], 0
    v_exp_f32 v21, v21
    v_mfma_f32_16x16x32_bf16 v[196:199], a[140:143], v[36:39], v[196:199]
    ds_read_b128 a[100:103], v1 offset:37440
    v_mov_b32 v253, 0
    v_mfma_f32_16x16x32_bf16 v[200:203], a[144:147], v[32:35], 0
    v_exp_f32 v22, v22
    v_mfma_f32_16x16x32_bf16 v[200:203], a[148:151], v[36:39], v[200:203]
    ds_read_b128 a[104:107], v1 offset:37504
    v_perm_b32 v42, v21, v20, s100
    v_mfma_f32_16x16x32_bf16 v[204:207], a[152:155], v[32:35], 0
    v_exp_f32 v23, v23
    v_mfma_f32_16x16x32_bf16 v[204:207], a[156:159], v[36:39], v[204:207]
    ds_read_b128 a[108:111], v1 offset:37568
    v_mov_b32 v254, 0
    v_mfma_f32_16x16x32_bf16 v[208:211], a[160:163], v[32:35], 0
    v_exp_f32 v24, v24
    v_mfma_f32_16x16x32_bf16 v[208:211], a[164:167], v[36:39], v[208:211]
    ds_read_b128 a[112:115], v1 offset:37632
    v_perm_b32 v43, v23, v22, s100
    v_mfma_f32_16x16x32_bf16 v[212:215], a[168:171], v[32:35], 0
    v_exp_f32 v25, v25
    v_mfma_f32_16x16x32_bf16 v[212:215], a[172:175], v[36:39], v[212:215]
    ds_read_b128 a[116:119], v1 offset:37696
    v_mov_b32 v255, 0
    v_mfma_f32_16x16x32_bf16 v[216:219], a[176:179], v[32:35], 0
    v_exp_f32 v26, v26
    v_mfma_f32_16x16x32_bf16 v[216:219], a[180:183], v[36:39], v[216:219]
    ds_read_b128 a[120:123], v1 offset:37760
    v_perm_b32 v44, v25, v24, s100
    v_mfma_f32_16x16x32_bf16 v[220:223], a[184:187], v[32:35], 0
    v_exp_f32 v27, v27
    v_mfma_f32_16x16x32_bf16 v[220:223], a[188:191], v[36:39], v[220:223]
    ds_read_b128 a[124:127], v1 offset:37824
    v_smfmac_f32_16x16x64_bf16 a[8:11], a[16:19], v[32:39], v11
    s_waitcnt lgkmcnt(12)
.p2align 5
L2_loop:
    v_mfma_f32_16x16x32_bf16 v[16:19], a[64:67], v[64:67], v[48:51]
    s_sub_u32 s47, s47, s48
    v_exp_f32 v28, v28
    v_mfma_f32_16x16x32_bf16 v[16:19], a[68:71], v[68:71], v[16:19]
    v_perm_b32 v45, v27, v26, s100
    v_add_u32 v1, s48, v1
    v_mfma_f32_16x16x32_bf16 v[16:19], a[72:75], v[72:75], v[16:19]
    v_exp_f32 v29, v29
    v_mfma_f32_16x16x32_bf16 v[16:19], a[76:79], v[76:79], v[16:19]
    s_waitcnt lgkmcnt(8)
    v_mfma_f32_16x16x32_bf16 v[20:23], a[80:83], v[64:67], v[48:51]
    v_exp_f32 v30, v30
    v_mfma_f32_16x16x32_bf16 v[20:23], a[84:87], v[68:71], v[20:23]
    v_perm_b32 v46, v29, v28, s100
    v_add_u32 v2, s48, v2
    v_mfma_f32_16x16x32_bf16 v[20:23], a[88:91], v[72:75], v[20:23]
L2_pad4:
    s_cbranch_execz L2_pad8
    v_exp_f32 v31, v31
    v_mfma_f32_16x16x32_bf16 v[20:23], a[92:95], v[76:79], v[20:23]
    s_waitcnt lgkmcnt(4)
    v_mfma_f32_16x16x32_bf16 v[24:27], a[96:99], v[64:67], v[48:51]
    s_sub_u32 s48, 0, s48
    v_exp_f32 v16, v16
    v_mfma_f32_16x16x32_bf16 v[24:27], a[100:103], v[68:71], v[24:27]
    v_perm_b32 v47, v31, v30, s100
    v_mfma_f32_16x16x32_bf16 v[24:27], a[104:107], v[72:75], v[24:27]
    v_exp_f32 v17, v17
    v_mfma_f32_16x16x32_bf16 v[24:27], a[108:111], v[76:79], v[24:27]
    s_waitcnt lgkmcnt(0)
    v_mfma_f32_16x16x32_bf16 v[28:31], a[112:115], v[64:67], v[48:51]
    v_exp_f32 v18, v18
    v_mfma_f32_16x16x32_bf16 v[28:31], a[116:119], v[68:71], v[28:31]
    v_perm_b32 v32, v17, v16, s100
    v_mfma_f32_16x16x32_bf16 v[28:31], a[120:123], v[72:75], v[28:31]
    v_exp_f32 v19, v19
    v_mfma_f32_16x16x32_bf16 v[28:31], a[124:127], v[76:79], v[28:31]
    s_waitcnt vmcnt(0)
    s_barrier
    v_mfma_f32_16x16x32_bf16 v[224:227], a[128:131], v[40:43], v[224:227]
    v_exp_f32 v20, v20
    v_mfma_f32_16x16x32_bf16 v[224:227], a[132:135], v[44:47], v[224:227]
    ds_read_b64_tr_b16 a[128:129], v2 offset:0
    v_perm_b32 v33, v19, v18, s100
    v_mfma_f32_16x16x32_bf16 v[228:231], a[136:139], v[40:43], v[228:231]
    s_add_u32 m0, s47, 0
    v_exp_f32 v21, v21
    v_mfma_f32_16x16x32_bf16 v[228:231], a[140:143], v[44:47], v[228:231]
    s_add_u32 s46, s46, 16384
    buffer_load_dwordx4 off, s[16:19], s46 offset:0 lds
    v_mfma_f32_16x16x32_bf16 v[232:235], a[144:147], v[40:43], v[232:235]
    v_exp_f32 v22, v22
    v_mfma_f32_16x16x32_bf16 v[232:235], a[148:151], v[44:47], v[232:235]
    ds_read_b64_tr_b16 a[130:131], v2 offset:256
    v_perm_b32 v34, v21, v20, s100
    v_mfma_f32_16x16x32_bf16 v[236:239], a[152:155], v[40:43], v[236:239]
    s_add_u32 m0, s47, 32
    v_exp_f32 v23, v23
    v_mfma_f32_16x16x32_bf16 v[236:239], a[156:159], v[44:47], v[236:239]
    buffer_load_dwordx4 off, s[16:19], s46 offset:1024 lds
    v_mfma_f32_16x16x32_bf16 v[240:243], a[160:163], v[40:43], v[240:243]
    v_exp_f32 v24, v24
    v_mfma_f32_16x16x32_bf16 v[240:243], a[164:167], v[44:47], v[240:243]
    ds_read_b64_tr_b16 a[132:133], v2 offset:512
    v_perm_b32 v35, v23, v22, s100
    v_mfma_f32_16x16x32_bf16 v[244:247], a[168:171], v[40:43], v[244:247]
    s_add_u32 m0, s47, 64
    v_exp_f32 v25, v25
    v_mfma_f32_16x16x32_bf16 v[244:247], a[172:175], v[44:47], v[244:247]
    buffer_load_dwordx4 off, s[16:19], s46 offset:2048 lds
    v_mfma_f32_16x16x32_bf16 v[248:251], a[176:179], v[40:43], v[248:251]
    v_exp_f32 v26, v26
    v_mfma_f32_16x16x32_bf16 v[248:251], a[180:183], v[44:47], v[248:251]
    ds_read_b64_tr_b16 a[134:135], v2 offset:768
    v_perm_b32 v36, v25, v24, s100
    v_mfma_f32_16x16x32_bf16 v[252:255], a[184:187], v[40:43], v[252:255]
    s_add_u32 m0, s47, 96
    v_exp_f32 v27, v27
    v_mfma_f32_16x16x32_bf16 v[252:255], a[188:191], v[44:47], v[252:255]
    buffer_load_dwordx4 off, s[16:19], s46 offset:3072 lds
    v_smfmac_f32_16x16x64_bf16 a[12:15], a[16:19], v[40:47], v11
    ds_read_b64_tr_b16 a[136:137], v2 offset:32
    v_mfma_f32_16x16x32_bf16 v[16:19], a[64:67], v[80:83], v[52:55]
    v_exp_f32 v28, v28
    v_mfma_f32_16x16x32_bf16 v[16:19], a[68:71], v[84:87], v[16:19]
    ds_read_b64_tr_b16 a[138:139], v2 offset:288
    v_perm_b32 v37, v27, v26, s100
    v_mfma_f32_16x16x32_bf16 v[16:19], a[72:75], v[88:91], v[16:19]
    s_add_u32 m0, s47, 16896
    v_exp_f32 v29, v29
    v_mfma_f32_16x16x32_bf16 v[16:19], a[76:79], v[92:95], v[16:19]
    buffer_load_dwordx4 off, s[20:23], s46 offset:0 lds
    v_mfma_f32_16x16x32_bf16 v[20:23], a[80:83], v[80:83], v[52:55]
    v_exp_f32 v30, v30
    v_mfma_f32_16x16x32_bf16 v[20:23], a[84:87], v[84:87], v[20:23]
    ds_read_b64_tr_b16 a[140:141], v2 offset:544
    v_perm_b32 v38, v29, v28, s100
    v_mfma_f32_16x16x32_bf16 v[20:23], a[88:91], v[88:91], v[20:23]
    s_add_u32 m0, s47, 16928
    v_exp_f32 v31, v31
    v_mfma_f32_16x16x32_bf16 v[20:23], a[92:95], v[92:95], v[20:23]
    buffer_load_dwordx4 off, s[20:23], s46 offset:1024 lds
    v_mfma_f32_16x16x32_bf16 v[24:27], a[96:99], v[80:83], v[52:55]
    v_exp_f32 v16, v16
    v_mfma_f32_16x16x32_bf16 v[24:27], a[100:103], v[84:87], v[24:27]
    ds_read_b64_tr_b16 a[142:143], v2 offset:800
    v_perm_b32 v39, v31, v30, s100
    v_mfma_f32_16x16x32_bf16 v[24:27], a[104:107], v[88:91], v[24:27]
    s_add_u32 m0, s47, 16960
    v_exp_f32 v17, v17
    v_mfma_f32_16x16x32_bf16 v[24:27], a[108:111], v[92:95], v[24:27]
    buffer_load_dwordx4 off, s[20:23], s46 offset:2048 lds
    v_mfma_f32_16x16x32_bf16 v[28:31], a[112:115], v[80:83], v[52:55]
    v_exp_f32 v18, v18
    v_mfma_f32_16x16x32_bf16 v[28:31], a[116:119], v[84:87], v[28:31]
    ds_read_b64_tr_b16 a[144:145], v2 offset:64
    v_perm_b32 v40, v17, v16, s100
    v_mfma_f32_16x16x32_bf16 v[28:31], a[120:123], v[88:91], v[28:31]
    s_add_u32 m0, s47, 16992
    v_exp_f32 v19, v19
    v_mfma_f32_16x16x32_bf16 v[28:31], a[124:127], v[92:95], v[28:31]
    buffer_load_dwordx4 off, s[20:23], s46 offset:3072 lds
    v_mfma_f32_16x16x32_bf16 v[128:131], a[192:195], v[32:35], v[128:131]
    v_exp_f32 v20, v20
    v_mfma_f32_16x16x32_bf16 v[128:131], a[196:199], v[36:39], v[128:131]
    ds_read_b64_tr_b16 a[146:147], v2 offset:320
    v_perm_b32 v41, v19, v18, s100
    v_mfma_f32_16x16x32_bf16 v[132:135], a[200:203], v[32:35], v[132:135]
    v_exp_f32 v21, v21
    v_mfma_f32_16x16x32_bf16 v[132:135], a[204:207], v[36:39], v[132:135]
    ds_read_b64_tr_b16 a[148:149], v2 offset:576
    v_mfma_f32_16x16x32_bf16 v[136:139], a[208:211], v[32:35], v[136:139]
    v_exp_f32 v22, v22
    v_mfma_f32_16x16x32_bf16 v[136:139], a[212:215], v[36:39], v[136:139]
    ds_read_b64_tr_b16 a[150:151], v2 offset:832
    v_perm_b32 v42, v21, v20, s100
    v_mfma_f32_16x16x32_bf16 v[140:143], a[216:219], v[32:35], v[140:143]
    v_exp_f32 v23, v23
    v_mfma_f32_16x16x32_bf16 v[140:143], a[220:223], v[36:39], v[140:143]
    ds_read_b64_tr_b16 a[152:153], v2 offset:96
    ds_read_b64_tr_b16 a[154:155], v2 offset:352
    v_mfma_f32_16x16x32_bf16 v[144:147], a[224:227], v[32:35], v[144:147]
    v_exp_f32 v24, v24
    v_mfma_f32_16x16x32_bf16 v[144:147], a[228:231], v[36:39], v[144:147]
    ds_read_b64_tr_b16 a[156:157], v2 offset:608
    v_perm_b32 v43, v23, v22, s100
    v_mfma_f32_16x16x32_bf16 v[148:151], a[232:235], v[32:35], v[148:151]
    v_exp_f32 v25, v25
    v_mfma_f32_16x16x32_bf16 v[148:151], a[236:239], v[36:39], v[148:151]
    ds_read_b64_tr_b16 a[158:159], v2 offset:864
    ds_read_b64_tr_b16 a[160:161], v2 offset:128
    v_mfma_f32_16x16x32_bf16 v[152:155], a[240:243], v[32:35], v[152:155]
    v_exp_f32 v26, v26
    v_mfma_f32_16x16x32_bf16 v[152:155], a[244:247], v[36:39], v[152:155]
    ds_read_b64_tr_b16 a[162:163], v2 offset:384
    v_perm_b32 v44, v25, v24, s100
    v_mfma_f32_16x16x32_bf16 v[156:159], a[248:251], v[32:35], v[156:159]
    v_exp_f32 v27, v27
    v_mfma_f32_16x16x32_bf16 v[156:159], a[252:255], v[36:39], v[156:159]
    ds_read_b64_tr_b16 a[164:165], v2 offset:640
    ds_read_b64_tr_b16 a[166:167], v2 offset:896
    v_smfmac_f32_16x16x64_bf16 a[0:3], a[16:19], v[32:39], v11
    ds_read_b64_tr_b16 a[168:169], v2 offset:160
    ds_read_b64_tr_b16 a[170:171], v2 offset:416
    v_mfma_f32_16x16x32_bf16 v[16:19], a[64:67], v[96:99], v[56:59]
    v_exp_f32 v28, v28
    v_mfma_f32_16x16x32_bf16 v[16:19], a[68:71], v[100:103], v[16:19]
    ds_read_b64_tr_b16 a[172:173], v2 offset:672
    v_perm_b32 v45, v27, v26, s100
    v_mfma_f32_16x16x32_bf16 v[16:19], a[72:75], v[104:107], v[16:19]
    s_add_u32 m0, s47, 36864
    v_exp_f32 v29, v29
    v_mfma_f32_16x16x32_bf16 v[16:19], a[76:79], v[108:111], v[16:19]
    s_add_u32 s46, s46, 16384
    buffer_load_dwordx4 off, s[16:19], s46 offset:0 lds
    v_mfma_f32_16x16x32_bf16 v[20:23], a[80:83], v[96:99], v[56:59]
    v_exp_f32 v30, v30
    v_mfma_f32_16x16x32_bf16 v[20:23], a[84:87], v[100:103], v[20:23]
    ds_read_b64_tr_b16 a[174:175], v2 offset:928
    v_perm_b32 v46, v29, v28, s100
    v_mfma_f32_16x16x32_bf16 v[20:23], a[88:91], v[104:107], v[20:23]
    s_add_u32 m0, s47, 36896
    v_exp_f32 v31, v31
    v_mfma_f32_16x16x32_bf16 v[20:23], a[92:95], v[108:111], v[20:23]
    buffer_load_dwordx4 off, s[16:19], s46 offset:1024 lds
    v_mfma_f32_16x16x32_bf16 v[24:27], a[96:99], v[96:99], v[56:59]
    v_exp_f32 v16, v16
    v_mfma_f32_16x16x32_bf16 v[24:27], a[100:103], v[100:103], v[24:27]
    ds_read_b64_tr_b16 a[176:177], v2 offset:192
    v_perm_b32 v47, v31, v30, s100
    v_mfma_f32_16x16x32_bf16 v[24:27], a[104:107], v[104:107], v[24:27]
    s_add_u32 m0, s47, 36928
    v_exp_f32 v17, v17
    v_mfma_f32_16x16x32_bf16 v[24:27], a[108:111], v[108:111], v[24:27]
    buffer_load_dwordx4 off, s[16:19], s46 offset:2048 lds
    v_mfma_f32_16x16x32_bf16 v[28:31], a[112:115], v[96:99], v[56:59]
    v_exp_f32 v18, v18
    v_mfma_f32_16x16x32_bf16 v[28:31], a[116:119], v[100:103], v[28:31]
    ds_read_b64_tr_b16 a[178:179], v2 offset:448
    v_perm_b32 v32, v17, v16, s100
    v_mfma_f32_16x16x32_bf16 v[28:31], a[120:123], v[104:107], v[28:31]
    s_add_u32 m0, s47, 36960
    v_exp_f32 v19, v19
    v_mfma_f32_16x16x32_bf16 v[28:31], a[124:127], v[108:111], v[28:31]
    buffer_load_dwordx4 off, s[16:19], s46 offset:3072 lds
    v_mfma_f32_16x16x32_bf16 v[160:163], a[192:195], v[40:43], v[160:163]
    v_exp_f32 v20, v20
    v_mfma_f32_16x16x32_bf16 v[160:163], a[196:199], v[44:47], v[160:163]
    ds_read_b64_tr_b16 a[180:181], v2 offset:704
    v_perm_b32 v33, v19, v18, s100
    v_mfma_f32_16x16x32_bf16 v[164:167], a[200:203], v[40:43], v[164:167]
    s_add_u32 m0, s47, 53760
    v_exp_f32 v21, v21
    v_mfma_f32_16x16x32_bf16 v[164:167], a[204:207], v[44:47], v[164:167]
    buffer_load_dwordx4 off, s[20:23], s46 offset:0 lds
    v_mfma_f32_16x16x32_bf16 v[168:171], a[208:211], v[40:43], v[168:171]
    v_exp_f32 v22, v22
    v_mfma_f32_16x16x32_bf16 v[168:171], a[212:215], v[44:47], v[168:171]
    ds_read_b64_tr_b16 a[182:183], v2 offset:960
    v_perm_b32 v34, v21, v20, s100
    v_mfma_f32_16x16x32_bf16 v[172:175], a[216:219], v[40:43], v[172:175]
    s_add_u32 m0, s47, 53792
    v_exp_f32 v23, v23
    v_mfma_f32_16x16x32_bf16 v[172:175], a[220:223], v[44:47], v[172:175]
    buffer_load_dwordx4 off, s[20:23], s46 offset:1024 lds
    v_mfma_f32_16x16x32_bf16 v[176:179], a[224:227], v[40:43], v[176:179]
    v_exp_f32 v24, v24
    v_mfma_f32_16x16x32_bf16 v[176:179], a[228:231], v[44:47], v[176:179]
    ds_read_b64_tr_b16 a[184:185], v2 offset:224
    v_perm_b32 v35, v23, v22, s100
    v_mfma_f32_16x16x32_bf16 v[180:183], a[232:235], v[40:43], v[180:183]
    s_add_u32 m0, s47, 53824
    v_exp_f32 v25, v25
    v_mfma_f32_16x16x32_bf16 v[180:183], a[236:239], v[44:47], v[180:183]
    buffer_load_dwordx4 off, s[20:23], s46 offset:2048 lds
    v_mfma_f32_16x16x32_bf16 v[184:187], a[240:243], v[40:43], v[184:187]
    v_exp_f32 v26, v26
    v_mfma_f32_16x16x32_bf16 v[184:187], a[244:247], v[44:47], v[184:187]
    ds_read_b64_tr_b16 a[186:187], v2 offset:480
    v_perm_b32 v36, v25, v24, s100
    v_mfma_f32_16x16x32_bf16 v[188:191], a[248:251], v[40:43], v[188:191]
    s_add_u32 m0, s47, 53856
    v_exp_f32 v27, v27
    v_mfma_f32_16x16x32_bf16 v[188:191], a[252:255], v[44:47], v[188:191]
    buffer_load_dwordx4 off, s[20:23], s46 offset:3072 lds
    v_smfmac_f32_16x16x64_bf16 a[4:7], a[16:19], v[40:47], v11
    ds_read_b64_tr_b16 a[188:189], v2 offset:736
    ds_read_b64_tr_b16 a[190:191], v2 offset:992
    v_mfma_f32_16x16x32_bf16 v[16:19], a[64:67], v[112:115], v[60:63]
    v_exp_f32 v28, v28
    v_mfma_f32_16x16x32_bf16 v[16:19], a[68:71], v[116:119], v[16:19]
    ds_read_b128 a[64:67], v1 offset:0
    v_perm_b32 v37, v27, v26, s100
    v_mfma_f32_16x16x32_bf16 v[16:19], a[72:75], v[120:123], v[16:19]
    v_exp_f32 v29, v29
    v_mfma_f32_16x16x32_bf16 v[16:19], a[76:79], v[124:127], v[16:19]
    ds_read_b128 a[68:71], v1 offset:64
    v_mfma_f32_16x16x32_bf16 v[20:23], a[80:83], v[112:115], v[60:63]
    v_exp_f32 v30, v30
    v_mfma_f32_16x16x32_bf16 v[20:23], a[84:87], v[116:119], v[20:23]
    ds_read_b128 a[72:75], v1 offset:128
    v_perm_b32 v38, v29, v28, s100
    v_mfma_f32_16x16x32_bf16 v[20:23], a[88:91], v[120:123], v[20:23]
    v_exp_f32 v31, v31
    v_mfma_f32_16x16x32_bf16 v[20:23], a[92:95], v[124:127], v[20:23]
    ds_read_b128 a[76:79], v1 offset:192
    v_mfma_f32_16x16x32_bf16 v[24:27], a[96:99], v[112:115], v[60:63]
    v_exp_f32 v16, v16
    v_mfma_f32_16x16x32_bf16 v[24:27], a[100:103], v[116:119], v[24:27]
    ds_read_b128 a[80:83], v1 offset:256
    v_perm_b32 v39, v31, v30, s100
    v_mfma_f32_16x16x32_bf16 v[24:27], a[104:107], v[120:123], v[24:27]
    v_exp_f32 v17, v17
    v_mfma_f32_16x16x32_bf16 v[24:27], a[108:111], v[124:127], v[24:27]
    ds_read_b128 a[84:87], v1 offset:320
    v_mfma_f32_16x16x32_bf16 v[28:31], a[112:115], v[112:115], v[60:63]
    v_exp_f32 v18, v18
    v_mfma_f32_16x16x32_bf16 v[28:31], a[116:119], v[116:119], v[28:31]
    ds_read_b128 a[88:91], v1 offset:384
    v_perm_b32 v40, v17, v16, s100
    v_mfma_f32_16x16x32_bf16 v[28:31], a[120:123], v[120:123], v[28:31]
    v_exp_f32 v19, v19
    v_mfma_f32_16x16x32_bf16 v[28:31], a[124:127], v[124:127], v[28:31]
    ds_read_b128 a[92:95], v1 offset:448
    v_mfma_f32_16x16x32_bf16 v[192:195], a[192:195], v[32:35], v[192:195]
    v_exp_f32 v20, v20
    v_mfma_f32_16x16x32_bf16 v[192:195], a[196:199], v[36:39], v[192:195]
    ds_read_b128 a[96:99], v1 offset:512
    v_perm_b32 v41, v19, v18, s100
    v_mfma_f32_16x16x32_bf16 v[196:199], a[200:203], v[32:35], v[196:199]
    v_exp_f32 v21, v21
    v_mfma_f32_16x16x32_bf16 v[196:199], a[204:207], v[36:39], v[196:199]
    ds_read_b128 a[100:103], v1 offset:576
    v_mfma_f32_16x16x32_bf16 v[200:203], a[208:211], v[32:35], v[200:203]
    v_exp_f32 v22, v22
    v_mfma_f32_16x16x32_bf16 v[200:203], a[212:215], v[36:39], v[200:203]
    ds_read_b128 a[104:107], v1 offset:640
    v_perm_b32 v42, v21, v20, s100
    v_mfma_f32_16x16x32_bf16 v[204:207], a[216:219], v[32:35], v[204:207]
    v_exp_f32 v23, v23
    v_mfma_f32_16x16x32_bf16 v[204:207], a[220:223], v[36:39], v[204:207]
    ds_read_b128 a[108:111], v1 offset:704
    v_mfma_f32_16x16x32_bf16 v[208:211], a[224:227], v[32:35], v[208:211]
    v_exp_f32 v24, v24
    v_mfma_f32_16x16x32_bf16 v[208:211], a[228:231], v[36:39], v[208:211]
    ds_read_b128 a[112:115], v1 offset:768
    v_perm_b32 v43, v23, v22, s100
    v_mfma_f32_16x16x32_bf16 v[212:215], a[232:235], v[32:35], v[212:215]
    v_exp_f32 v25, v25
    v_mfma_f32_16x16x32_bf16 v[212:215], a[236:239], v[36:39], v[212:215]
    ds_read_b128 a[116:119], v1 offset:832
    v_mfma_f32_16x16x32_bf16 v[216:219], a[240:243], v[32:35], v[216:219]
    v_exp_f32 v26, v26
    v_mfma_f32_16x16x32_bf16 v[216:219], a[244:247], v[36:39], v[216:219]
    ds_read_b128 a[120:123], v1 offset:896
    v_perm_b32 v44, v25, v24, s100
    v_mfma_f32_16x16x32_bf16 v[220:223], a[248:251], v[32:35], v[220:223]
    v_exp_f32 v27, v27
    v_mfma_f32_16x16x32_bf16 v[220:223], a[252:255], v[36:39], v[220:223]
    ds_read_b128 a[124:127], v1 offset:960
    v_smfmac_f32_16x16x64_bf16 a[8:11], a[16:19], v[32:39], v11
    s_waitcnt lgkmcnt(12)
    v_mfma_f32_16x16x32_bf16 v[16:19], a[64:67], v[64:67], v[48:51]
    v_exp_f32 v28, v28
    v_mfma_f32_16x16x32_bf16 v[16:19], a[68:71], v[68:71], v[16:19]
    v_perm_b32 v45, v27, v26, s100
    v_mfma_f32_16x16x32_bf16 v[16:19], a[72:75], v[72:75], v[16:19]
    v_exp_f32 v29, v29
    v_mfma_f32_16x16x32_bf16 v[16:19], a[76:79], v[76:79], v[16:19]
    s_waitcnt lgkmcnt(8)
    v_mfma_f32_16x16x32_bf16 v[20:23], a[80:83], v[64:67], v[48:51]
    v_exp_f32 v30, v30
    v_mfma_f32_16x16x32_bf16 v[20:23], a[84:87], v[68:71], v[20:23]
    v_perm_b32 v46, v29, v28, s100
    v_mfma_f32_16x16x32_bf16 v[20:23], a[88:91], v[72:75], v[20:23]
    v_exp_f32 v31, v31
    v_mfma_f32_16x16x32_bf16 v[20:23], a[92:95], v[76:79], v[20:23]
    s_waitcnt lgkmcnt(4)
    v_mfma_f32_16x16x32_bf16 v[24:27], a[96:99], v[64:67], v[48:51]
    v_exp_f32 v16, v16
    v_mfma_f32_16x16x32_bf16 v[24:27], a[100:103], v[68:71], v[24:27]
    v_perm_b32 v47, v31, v30, s100
    v_mfma_f32_16x16x32_bf16 v[24:27], a[104:107], v[72:75], v[24:27]
    v_exp_f32 v17, v17
    v_mfma_f32_16x16x32_bf16 v[24:27], a[108:111], v[76:79], v[24:27]
    s_waitcnt lgkmcnt(0)
    v_mfma_f32_16x16x32_bf16 v[28:31], a[112:115], v[64:67], v[48:51]
    v_exp_f32 v18, v18
    v_mfma_f32_16x16x32_bf16 v[28:31], a[116:119], v[68:71], v[28:31]
    v_perm_b32 v32, v17, v16, s100
    v_mfma_f32_16x16x32_bf16 v[28:31], a[120:123], v[72:75], v[28:31]
    v_exp_f32 v19, v19
    v_mfma_f32_16x16x32_bf16 v[28:31], a[124:127], v[76:79], v[28:31]
    v_mfma_f32_16x16x32_bf16 v[224:227], a[192:195], v[40:43], v[224:227]
    v_exp_f32 v20, v20
    v_mfma_f32_16x16x32_bf16 v[224:227], a[196:199], v[44:47], v[224:227]
    ds_read_b64_tr_b16 a[192:193], v2 offset:36864
    v_perm_b32 v33, v19, v18, s100
    v_mfma_f32_16x16x32_bf16 v[228:231], a[200:203], v[40:43], v[228:231]
    v_exp_f32 v21, v21
    v_mfma_f32_16x16x32_bf16 v[228:231], a[204:207], v[44:47], v[228:231]
    ds_read_b64_tr_b16 a[194:195], v2 offset:37120
    v_mfma_f32_16x16x32_bf16 v[232:235], a[208:211], v[40:43], v[232:235]
    v_exp_f32 v22, v22
    v_mfma_f32_16x16x32_bf16 v[232:235], a[212:215], v[44:47], v[232:235]
    ds_read_b64_tr_b16 a[196:197], v2 offset:37376
    v_perm_b32 v34, v21, v20, s100
    v_mfma_f32_16x16x32_bf16 v[236:239], a[216:219], v[40:43], v[236:239]
    v_exp_f32 v23, v23
    v_mfma_f32_16x16x32_bf16 v[236:239], a[220:223], v[44:47], v[236:239]
    ds_read_b64_tr_b16 a[198:199], v2 offset:37632
    v_mfma_f32_16x16x32_bf16 v[240:243], a[224:227], v[40:43], v[240:243]
    v_exp_f32 v24, v24
    v_mfma_f32_16x16x32_bf16 v[240:243], a[228:231], v[44:47], v[240:243]
    ds_read_b64_tr_b16 a[200:201], v2 offset:36896
    v_perm_b32 v35, v23, v22, s100
    v_mfma_f32_16x16x32_bf16 v[244:247], a[232:235], v[40:43], v[244:247]
    v_exp_f32 v25, v25
    v_mfma_f32_16x16x32_bf16 v[244:247], a[236:239], v[44:47], v[244:247]
    ds_read_b64_tr_b16 a[202:203], v2 offset:37152
    v_mfma_f32_16x16x32_bf16 v[248:251], a[240:243], v[40:43], v[248:251]
    v_exp_f32 v26, v26
    v_mfma_f32_16x16x32_bf16 v[248:251], a[244:247], v[44:47], v[248:251]
    ds_read_b64_tr_b16 a[204:205], v2 offset:37408
    v_perm_b32 v36, v25, v24, s100
    v_mfma_f32_16x16x32_bf16 v[252:255], a[248:251], v[40:43], v[252:255]
    v_exp_f32 v27, v27
    v_mfma_f32_16x16x32_bf16 v[252:255], a[252:255], v[44:47], v[252:255]
    ds_read_b64_tr_b16 a[206:207], v2 offset:37664
    v_smfmac_f32_16x16x64_bf16 a[12:15], a[16:19], v[40:47], v11
    ds_read_b64_tr_b16 a[208:209], v2 offset:36928
    v_mfma_f32_16x16x32_bf16 v[16:19], a[64:67], v[80:83], v[52:55]
    v_exp_f32 v28, v28
    v_mfma_f32_16x16x32_bf16 v[16:19], a[68:71], v[84:87], v[16:19]
    ds_read_b64_tr_b16 a[210:211], v2 offset:37184
    v_perm_b32 v37, v27, v26, s100
    v_mfma_f32_16x16x32_bf16 v[16:19], a[72:75], v[88:91], v[16:19]
    v_exp_f32 v29, v29
    v_mfma_f32_16x16x32_bf16 v[16:19], a[76:79], v[92:95], v[16:19]
    ds_read_b64_tr_b16 a[212:213], v2 offset:37440
    v_mfma_f32_16x16x32_bf16 v[20:23], a[80:83], v[80:83], v[52:55]
    v_exp_f32 v30, v30
    v_mfma_f32_16x16x32_bf16 v[20:23], a[84:87], v[84:87], v[20:23]
    ds_read_b64_tr_b16 a[214:215], v2 offset:37696
    v_perm_b32 v38, v29, v28, s100
    v_mfma_f32_16x16x32_bf16 v[20:23], a[88:91], v[88:91], v[20:23]
    v_exp_f32 v31, v31
    v_mfma_f32_16x16x32_bf16 v[20:23], a[92:95], v[92:95], v[20:23]
    ds_read_b64_tr_b16 a[216:217], v2 offset:36960
    v_mfma_f32_16x16x32_bf16 v[24:27], a[96:99], v[80:83], v[52:55]
    v_exp_f32 v16, v16
    v_mfma_f32_16x16x32_bf16 v[24:27], a[100:103], v[84:87], v[24:27]
    ds_read_b64_tr_b16 a[218:219], v2 offset:37216
    v_perm_b32 v39, v31, v30, s100
    v_mfma_f32_16x16x32_bf16 v[24:27], a[104:107], v[88:91], v[24:27]
    v_exp_f32 v17, v17
    v_mfma_f32_16x16x32_bf16 v[24:27], a[108:111], v[92:95], v[24:27]
    ds_read_b64_tr_b16 a[220:221], v2 offset:37472
    v_mfma_f32_16x16x32_bf16 v[28:31], a[112:115], v[80:83], v[52:55]
    v_exp_f32 v18, v18
    v_mfma_f32_16x16x32_bf16 v[28:31], a[116:119], v[84:87], v[28:31]
    ds_read_b64_tr_b16 a[222:223], v2 offset:37728
    v_perm_b32 v40, v17, v16, s100
    v_mfma_f32_16x16x32_bf16 v[28:31], a[120:123], v[88:91], v[28:31]
    v_exp_f32 v19, v19
    v_mfma_f32_16x16x32_bf16 v[28:31], a[124:127], v[92:95], v[28:31]
    ds_read_b64_tr_b16 a[224:225], v2 offset:36992
    v_mfma_f32_16x16x32_bf16 v[128:131], a[128:131], v[32:35], v[128:131]
    v_exp_f32 v20, v20
    v_mfma_f32_16x16x32_bf16 v[128:131], a[132:135], v[36:39], v[128:131]
    ds_read_b64_tr_b16 a[226:227], v2 offset:37248
    v_perm_b32 v41, v19, v18, s100
    v_mfma_f32_16x16x32_bf16 v[132:135], a[136:139], v[32:35], v[132:135]
    v_exp_f32 v21, v21
    v_mfma_f32_16x16x32_bf16 v[132:135], a[140:143], v[36:39], v[132:135]
    ds_read_b64_tr_b16 a[228:229], v2 offset:37504
    v_mfma_f32_16x16x32_bf16 v[136:139], a[144:147], v[32:35], v[136:139]
    v_exp_f32 v22, v22
    v_mfma_f32_16x16x32_bf16 v[136:139], a[148:151], v[36:39], v[136:139]
    ds_read_b64_tr_b16 a[230:231], v2 offset:37760
    v_perm_b32 v42, v21, v20, s100
    v_mfma_f32_16x16x32_bf16 v[140:143], a[152:155], v[32:35], v[140:143]
    v_exp_f32 v23, v23
    v_mfma_f32_16x16x32_bf16 v[140:143], a[156:159], v[36:39], v[140:143]
    ds_read_b64_tr_b16 a[232:233], v2 offset:37024
    v_mfma_f32_16x16x32_bf16 v[144:147], a[160:163], v[32:35], v[144:147]
    v_exp_f32 v24, v24
    v_mfma_f32_16x16x32_bf16 v[144:147], a[164:167], v[36:39], v[144:147]
    ds_read_b64_tr_b16 a[234:235], v2 offset:37280
    v_perm_b32 v43, v23, v22, s100
    v_mfma_f32_16x16x32_bf16 v[148:151], a[168:171], v[32:35], v[148:151]
    v_exp_f32 v25, v25
    v_mfma_f32_16x16x32_bf16 v[148:151], a[172:175], v[36:39], v[148:151]
    ds_read_b64_tr_b16 a[236:237], v2 offset:37536
    v_mfma_f32_16x16x32_bf16 v[152:155], a[176:179], v[32:35], v[152:155]
    v_exp_f32 v26, v26
    v_mfma_f32_16x16x32_bf16 v[152:155], a[180:183], v[36:39], v[152:155]
    ds_read_b64_tr_b16 a[238:239], v2 offset:37792
    v_perm_b32 v44, v25, v24, s100
    v_mfma_f32_16x16x32_bf16 v[156:159], a[184:187], v[32:35], v[156:159]
    v_exp_f32 v27, v27
    v_mfma_f32_16x16x32_bf16 v[156:159], a[188:191], v[36:39], v[156:159]
    ds_read_b64_tr_b16 a[240:241], v2 offset:37056
    v_smfmac_f32_16x16x64_bf16 a[0:3], a[16:19], v[32:39], v11
    ds_read_b64_tr_b16 a[242:243], v2 offset:37312
    v_mfma_f32_16x16x32_bf16 v[16:19], a[64:67], v[96:99], v[56:59]
    v_exp_f32 v28, v28
    v_mfma_f32_16x16x32_bf16 v[16:19], a[68:71], v[100:103], v[16:19]
    ds_read_b64_tr_b16 a[244:245], v2 offset:37568
    v_perm_b32 v45, v27, v26, s100
    v_mfma_f32_16x16x32_bf16 v[16:19], a[72:75], v[104:107], v[16:19]
    v_exp_f32 v29, v29
    v_mfma_f32_16x16x32_bf16 v[16:19], a[76:79], v[108:111], v[16:19]
    ds_read_b64_tr_b16 a[246:247], v2 offset:37824
    v_mfma_f32_16x16x32_bf16 v[20:23], a[80:83], v[96:99], v[56:59]
    v_exp_f32 v30, v30
    v_mfma_f32_16x16x32_bf16 v[20:23], a[84:87], v[100:103], v[20:23]
    ds_read_b64_tr_b16 a[248:249], v2 offset:37088
    v_perm_b32 v46, v29, v28, s100
    v_mfma_f32_16x16x32_bf16 v[20:23], a[88:91], v[104:107], v[20:23]
    v_exp_f32 v31, v31
    v_mfma_f32_16x16x32_bf16 v[20:23], a[92:95], v[108:111], v[20:23]
    ds_read_b64_tr_b16 a[250:251], v2 offset:37344
    v_mfma_f32_16x16x32_bf16 v[24:27], a[96:99], v[96:99], v[56:59]
    v_exp_f32 v16, v16
    v_mfma_f32_16x16x32_bf16 v[24:27], a[100:103], v[100:103], v[24:27]
    ds_read_b64_tr_b16 a[252:253], v2 offset:37600
    v_perm_b32 v47, v31, v30, s100
    v_mfma_f32_16x16x32_bf16 v[24:27], a[104:107], v[104:107], v[24:27]
    v_exp_f32 v17, v17
    v_mfma_f32_16x16x32_bf16 v[24:27], a[108:111], v[108:111], v[24:27]
    ds_read_b64_tr_b16 a[254:255], v2 offset:37856
    v_mfma_f32_16x16x32_bf16 v[28:31], a[112:115], v[96:99], v[56:59]
    v_exp_f32 v18, v18
    v_mfma_f32_16x16x32_bf16 v[28:31], a[116:119], v[100:103], v[28:31]
    v_perm_b32 v32, v17, v16, s100
    v_mfma_f32_16x16x32_bf16 v[28:31], a[120:123], v[104:107], v[28:31]
    v_exp_f32 v19, v19
    v_mfma_f32_16x16x32_bf16 v[28:31], a[124:127], v[108:111], v[28:31]
    v_mfma_f32_16x16x32_bf16 v[160:163], a[128:131], v[40:43], v[160:163]
    v_exp_f32 v20, v20
    v_mfma_f32_16x16x32_bf16 v[160:163], a[132:135], v[44:47], v[160:163]
    v_perm_b32 v33, v19, v18, s100
    v_mfma_f32_16x16x32_bf16 v[164:167], a[136:139], v[40:43], v[164:167]
    v_exp_f32 v21, v21
    v_mfma_f32_16x16x32_bf16 v[164:167], a[140:143], v[44:47], v[164:167]
    v_mfma_f32_16x16x32_bf16 v[168:171], a[144:147], v[40:43], v[168:171]
    v_exp_f32 v22, v22
    v_mfma_f32_16x16x32_bf16 v[168:171], a[148:151], v[44:47], v[168:171]
    v_perm_b32 v34, v21, v20, s100
    v_mfma_f32_16x16x32_bf16 v[172:175], a[152:155], v[40:43], v[172:175]
    v_exp_f32 v23, v23
    v_mfma_f32_16x16x32_bf16 v[172:175], a[156:159], v[44:47], v[172:175]
    v_mfma_f32_16x16x32_bf16 v[176:179], a[160:163], v[40:43], v[176:179]
    v_exp_f32 v24, v24
    v_mfma_f32_16x16x32_bf16 v[176:179], a[164:167], v[44:47], v[176:179]
    v_perm_b32 v35, v23, v22, s100
    v_mfma_f32_16x16x32_bf16 v[180:183], a[168:171], v[40:43], v[180:183]
    v_exp_f32 v25, v25
    v_mfma_f32_16x16x32_bf16 v[180:183], a[172:175], v[44:47], v[180:183]
    v_mfma_f32_16x16x32_bf16 v[184:187], a[176:179], v[40:43], v[184:187]
    v_exp_f32 v26, v26
    v_mfma_f32_16x16x32_bf16 v[184:187], a[180:183], v[44:47], v[184:187]
    v_perm_b32 v36, v25, v24, s100
    v_mfma_f32_16x16x32_bf16 v[188:191], a[184:187], v[40:43], v[188:191]
    v_exp_f32 v27, v27
    v_mfma_f32_16x16x32_bf16 v[188:191], a[188:191], v[44:47], v[188:191]
    v_smfmac_f32_16x16x64_bf16 a[4:7], a[16:19], v[40:47], v11
    v_mfma_f32_16x16x32_bf16 v[16:19], a[64:67], v[112:115], v[60:63]
    v_exp_f32 v28, v28
    v_mfma_f32_16x16x32_bf16 v[16:19], a[68:71], v[116:119], v[16:19]
    ds_read_b128 a[64:67], v1 offset:36864
    v_perm_b32 v37, v27, v26, s100
    v_mfma_f32_16x16x32_bf16 v[16:19], a[72:75], v[120:123], v[16:19]
    v_exp_f32 v29, v29
    v_mfma_f32_16x16x32_bf16 v[16:19], a[76:79], v[124:127], v[16:19]
    ds_read_b128 a[68:71], v1 offset:36928
    v_mfma_f32_16x16x32_bf16 v[20:23], a[80:83], v[112:115], v[60:63]
    v_exp_f32 v30, v30
    v_mfma_f32_16x16x32_bf16 v[20:23], a[84:87], v[116:119], v[20:23]
    ds_read_b128 a[72:75], v1 offset:36992
    v_perm_b32 v38, v29, v28, s100
    v_mfma_f32_16x16x32_bf16 v[20:23], a[88:91], v[120:123], v[20:23]
    v_exp_f32 v31, v31
    v_mfma_f32_16x16x32_bf16 v[20:23], a[92:95], v[124:127], v[20:23]
    ds_read_b128 a[76:79], v1 offset:37056
    v_mfma_f32_16x16x32_bf16 v[24:27], a[96:99], v[112:115], v[60:63]
    v_exp_f32 v16, v16
    v_mfma_f32_16x16x32_bf16 v[24:27], a[100:103], v[116:119], v[24:27]
    ds_read_b128 a[80:83], v1 offset:37120
    v_perm_b32 v39, v31, v30, s100
    v_mfma_f32_16x16x32_bf16 v[24:27], a[104:107], v[120:123], v[24:27]
    v_exp_f32 v17, v17
    v_mfma_f32_16x16x32_bf16 v[24:27], a[108:111], v[124:127], v[24:27]
    ds_read_b128 a[84:87], v1 offset:37184
    v_mfma_f32_16x16x32_bf16 v[28:31], a[112:115], v[112:115], v[60:63]
    v_exp_f32 v18, v18
    v_mfma_f32_16x16x32_bf16 v[28:31], a[116:119], v[116:119], v[28:31]
    ds_read_b128 a[88:91], v1 offset:37248
    v_perm_b32 v40, v17, v16, s100
    v_mfma_f32_16x16x32_bf16 v[28:31], a[120:123], v[120:123], v[28:31]
    v_exp_f32 v19, v19
    v_mfma_f32_16x16x32_bf16 v[28:31], a[124:127], v[124:127], v[28:31]
    ds_read_b128 a[92:95], v1 offset:37312
    v_mfma_f32_16x16x32_bf16 v[192:195], a[128:131], v[32:35], v[192:195]
    v_exp_f32 v20, v20
    v_mfma_f32_16x16x32_bf16 v[192:195], a[132:135], v[36:39], v[192:195]
    ds_read_b128 a[96:99], v1 offset:37376
    v_perm_b32 v41, v19, v18, s100
    v_mfma_f32_16x16x32_bf16 v[196:199], a[136:139], v[32:35], v[196:199]
    v_exp_f32 v21, v21
    v_mfma_f32_16x16x32_bf16 v[196:199], a[140:143], v[36:39], v[196:199]
    ds_read_b128 a[100:103], v1 offset:37440
    v_mfma_f32_16x16x32_bf16 v[200:203], a[144:147], v[32:35], v[200:203]
    v_exp_f32 v22, v22
    v_mfma_f32_16x16x32_bf16 v[200:203], a[148:151], v[36:39], v[200:203]
    ds_read_b128 a[104:107], v1 offset:37504
    v_perm_b32 v42, v21, v20, s100
    v_mfma_f32_16x16x32_bf16 v[204:207], a[152:155], v[32:35], v[204:207]
    v_exp_f32 v23, v23
    v_mfma_f32_16x16x32_bf16 v[204:207], a[156:159], v[36:39], v[204:207]
    ds_read_b128 a[108:111], v1 offset:37568
    v_mfma_f32_16x16x32_bf16 v[208:211], a[160:163], v[32:35], v[208:211]
    v_exp_f32 v24, v24
    v_mfma_f32_16x16x32_bf16 v[208:211], a[164:167], v[36:39], v[208:211]
    ds_read_b128 a[112:115], v1 offset:37632
    v_perm_b32 v43, v23, v22, s100
    v_mfma_f32_16x16x32_bf16 v[212:215], a[168:171], v[32:35], v[212:215]
    v_exp_f32 v25, v25
    v_mfma_f32_16x16x32_bf16 v[212:215], a[172:175], v[36:39], v[212:215]
    ds_read_b128 a[116:119], v1 offset:37696
    v_mfma_f32_16x16x32_bf16 v[216:219], a[176:179], v[32:35], v[216:219]
    v_exp_f32 v26, v26
    v_mfma_f32_16x16x32_bf16 v[216:219], a[180:183], v[36:39], v[216:219]
    s_sub_u32 s49, s49, 1
    ds_read_b128 a[120:123], v1 offset:37760
    v_perm_b32 v44, v25, v24, s100
    v_mfma_f32_16x16x32_bf16 v[220:223], a[184:187], v[32:35], v[220:223]
    s_cmp_lg_u32 s49, 0
    v_exp_f32 v27, v27
    v_mfma_f32_16x16x32_bf16 v[220:223], a[188:191], v[36:39], v[220:223]
L2_pad5:
    s_cbranch_execz L2_pad9
    ds_read_b128 a[124:127], v1 offset:37824
    v_smfmac_f32_16x16x64_bf16 a[8:11], a[16:19], v[32:39], v11
    s_waitcnt lgkmcnt(12)
    s_cbranch_scc1 L2_loop
    v_mfma_f32_16x16x32_bf16 v[16:19], a[64:67], v[64:67], v[48:51]
    s_sub_u32 s47, s47, s48
    v_exp_f32 v28, v28
    v_mfma_f32_16x16x32_bf16 v[16:19], a[68:71], v[68:71], v[16:19]
    v_perm_b32 v45, v27, v26, s100
    v_add_u32 v1, s48, v1
    v_mfma_f32_16x16x32_bf16 v[16:19], a[72:75], v[72:75], v[16:19]
    v_exp_f32 v29, v29
    v_mfma_f32_16x16x32_bf16 v[16:19], a[76:79], v[76:79], v[16:19]
    s_waitcnt lgkmcnt(8)
    v_mfma_f32_16x16x32_bf16 v[20:23], a[80:83], v[64:67], v[48:51]
    v_exp_f32 v30, v30
    v_mfma_f32_16x16x32_bf16 v[20:23], a[84:87], v[68:71], v[20:23]
    v_perm_b32 v46, v29, v28, s100
    v_add_u32 v2, s48, v2
    v_mfma_f32_16x16x32_bf16 v[20:23], a[88:91], v[72:75], v[20:23]
    v_exp_f32 v31, v31
    v_mfma_f32_16x16x32_bf16 v[20:23], a[92:95], v[76:79], v[20:23]
    s_waitcnt lgkmcnt(4)
    v_mfma_f32_16x16x32_bf16 v[24:27], a[96:99], v[64:67], v[48:51]
    s_sub_u32 s48, 0, s48
    v_exp_f32 v16, v16
    v_mfma_f32_16x16x32_bf16 v[24:27], a[100:103], v[68:71], v[24:27]
    v_perm_b32 v47, v31, v30, s100
    v_mfma_f32_16x16x32_bf16 v[24:27], a[104:107], v[72:75], v[24:27]
    v_exp_f32 v17, v17
    v_mfma_f32_16x16x32_bf16 v[24:27], a[108:111], v[76:79], v[24:27]
    s_waitcnt lgkmcnt(0)
    v_mfma_f32_16x16x32_bf16 v[28:31], a[112:115], v[64:67], v[48:51]
    v_exp_f32 v18, v18
    v_mfma_f32_16x16x32_bf16 v[28:31], a[116:119], v[68:71], v[28:31]
    v_perm_b32 v32, v17, v16, s100
    v_mfma_f32_16x16x32_bf16 v[28:31], a[120:123], v[72:75], v[28:31]
    v_exp_f32 v19, v19
    v_mfma_f32_16x16x32_bf16 v[28:31], a[124:127], v[76:79], v[28:31]
    s_waitcnt vmcnt(0)
    s_barrier
    v_mfma_f32_16x16x32_bf16 v[224:227], a[128:131], v[40:43], v[224:227]
    v_exp_f32 v20, v20
    v_mfma_f32_16x16x32_bf16 v[224:227], a[132:135], v[44:47], v[224:227]
    ds_read_b64_tr_b16 a[128:129], v2 offset:0
    v_perm_b32 v33, v19, v18, s100
    v_mfma_f32_16x16x32_bf16 v[228:231], a[136:139], v[40:43], v[228:231]
    s_add_u32 m0, s47, 0
    v_exp_f32 v21, v21
    v_mfma_f32_16x16x32_bf16 v[228:231], a[140:143], v[44:47], v[228:231]
    s_add_u32 s46, s46, 16384
    buffer_load_dwordx4 off, s[16:19], s46 offset:0 lds
    v_mfma_f32_16x16x32_bf16 v[232:235], a[144:147], v[40:43], v[232:235]
    v_exp_f32 v22, v22
    v_mfma_f32_16x16x32_bf16 v[232:235], a[148:151], v[44:47], v[232:235]
    ds_read_b64_tr_b16 a[130:131], v2 offset:256
    v_perm_b32 v34, v21, v20, s100
    v_mfma_f32_16x16x32_bf16 v[236:239], a[152:155], v[40:43], v[236:239]
    s_add_u32 m0, s47, 32
    v_exp_f32 v23, v23
    v_mfma_f32_16x16x32_bf16 v[236:239], a[156:159], v[44:47], v[236:239]
    buffer_load_dwordx4 off, s[16:19], s46 offset:1024 lds
    v_mfma_f32_16x16x32_bf16 v[240:243], a[160:163], v[40:43], v[240:243]
    v_exp_f32 v24, v24
    v_mfma_f32_16x16x32_bf16 v[240:243], a[164:167], v[44:47], v[240:243]
    ds_read_b64_tr_b16 a[132:133], v2 offset:512
    v_perm_b32 v35, v23, v22, s100
    v_mfma_f32_16x16x32_bf16 v[244:247], a[168:171], v[40:43], v[244:247]
    s_add_u32 m0, s47, 64
    v_exp_f32 v25, v25
    v_mfma_f32_16x16x32_bf16 v[244:247], a[172:175], v[44:47], v[244:247]
    buffer_load_dwordx4 off, s[16:19], s46 offset:2048 lds
    v_mfma_f32_16x16x32_bf16 v[248:251], a[176:179], v[40:43], v[248:251]
    v_exp_f32 v26, v26
    v_mfma_f32_16x16x32_bf16 v[248:251], a[180:183], v[44:47], v[248:251]
    ds_read_b64_tr_b16 a[134:135], v2 offset:768
    v_perm_b32 v36, v25, v24, s100
    v_mfma_f32_16x16x32_bf16 v[252:255], a[184:187], v[40:43], v[252:255]
    s_add_u32 m0, s47, 96
    v_exp_f32 v27, v27
    v_mfma_f32_16x16x32_bf16 v[252:255], a[188:191], v[44:47], v[252:255]
    buffer_load_dwordx4 off, s[16:19], s46 offset:3072 lds
    v_smfmac_f32_16x16x64_bf16 a[12:15], a[16:19], v[40:47], v11
    ds_read_b64_tr_b16 a[136:137], v2 offset:32
    v_mfma_f32_16x16x32_bf16 v[16:19], a[64:67], v[80:83], v[52:55]
    v_exp_f32 v28, v28
    v_mfma_f32_16x16x32_bf16 v[16:19], a[68:71], v[84:87], v[16:19]
    ds_read_b64_tr_b16 a[138:139], v2 offset:288
    v_perm_b32 v37, v27, v26, s100
    v_mfma_f32_16x16x32_bf16 v[16:19], a[72:75], v[88:91], v[16:19]
    s_add_u32 m0, s47, 16896
    v_exp_f32 v29, v29
    v_mfma_f32_16x16x32_bf16 v[16:19], a[76:79], v[92:95], v[16:19]
    buffer_load_dwordx4 off, s[20:23], s46 offset:0 lds
    v_mfma_f32_16x16x32_bf16 v[20:23], a[80:83], v[80:83], v[52:55]
    v_exp_f32 v30, v30
    v_mfma_f32_16x16x32_bf16 v[20:23], a[84:87], v[84:87], v[20:23]
    ds_read_b64_tr_b16 a[140:141], v2 offset:544
    v_perm_b32 v38, v29, v28, s100
    v_mfma_f32_16x16x32_bf16 v[20:23], a[88:91], v[88:91], v[20:23]
    s_add_u32 m0, s47, 16928
    v_exp_f32 v31, v31
    v_mfma_f32_16x16x32_bf16 v[20:23], a[92:95], v[92:95], v[20:23]
    buffer_load_dwordx4 off, s[20:23], s46 offset:1024 lds
    v_mfma_f32_16x16x32_bf16 v[24:27], a[96:99], v[80:83], v[52:55]
    v_exp_f32 v16, v16
    v_mfma_f32_16x16x32_bf16 v[24:27], a[100:103], v[84:87], v[24:27]
    ds_read_b64_tr_b16 a[142:143], v2 offset:800
    v_perm_b32 v39, v31, v30, s100
    v_mfma_f32_16x16x32_bf16 v[24:27], a[104:107], v[88:91], v[24:27]
    s_add_u32 m0, s47, 16960
    v_exp_f32 v17, v17
    v_mfma_f32_16x16x32_bf16 v[24:27], a[108:111], v[92:95], v[24:27]
    buffer_load_dwordx4 off, s[20:23], s46 offset:2048 lds
    v_mfma_f32_16x16x32_bf16 v[28:31], a[112:115], v[80:83], v[52:55]
    v_exp_f32 v18, v18
    v_mfma_f32_16x16x32_bf16 v[28:31], a[116:119], v[84:87], v[28:31]
    ds_read_b64_tr_b16 a[144:145], v2 offset:64
    v_perm_b32 v40, v17, v16, s100
    v_mfma_f32_16x16x32_bf16 v[28:31], a[120:123], v[88:91], v[28:31]
    s_add_u32 m0, s47, 16992
    v_exp_f32 v19, v19
    v_mfma_f32_16x16x32_bf16 v[28:31], a[124:127], v[92:95], v[28:31]
    buffer_load_dwordx4 off, s[20:23], s46 offset:3072 lds
    v_mfma_f32_16x16x32_bf16 v[128:131], a[192:195], v[32:35], v[128:131]
    v_exp_f32 v20, v20
    v_mfma_f32_16x16x32_bf16 v[128:131], a[196:199], v[36:39], v[128:131]
    ds_read_b64_tr_b16 a[146:147], v2 offset:320
    v_perm_b32 v41, v19, v18, s100
    v_mfma_f32_16x16x32_bf16 v[132:135], a[200:203], v[32:35], v[132:135]
    v_exp_f32 v21, v21
    v_mfma_f32_16x16x32_bf16 v[132:135], a[204:207], v[36:39], v[132:135]
    ds_read_b64_tr_b16 a[148:149], v2 offset:576
    v_mfma_f32_16x16x32_bf16 v[136:139], a[208:211], v[32:35], v[136:139]
    v_exp_f32 v22, v22
    v_mfma_f32_16x16x32_bf16 v[136:139], a[212:215], v[36:39], v[136:139]
    ds_read_b64_tr_b16 a[150:151], v2 offset:832
    v_perm_b32 v42, v21, v20, s100
    v_mfma_f32_16x16x32_bf16 v[140:143], a[216:219], v[32:35], v[140:143]
    v_exp_f32 v23, v23
    v_mfma_f32_16x16x32_bf16 v[140:143], a[220:223], v[36:39], v[140:143]
    ds_read_b64_tr_b16 a[152:153], v2 offset:96
    ds_read_b64_tr_b16 a[154:155], v2 offset:352
    v_mfma_f32_16x16x32_bf16 v[144:147], a[224:227], v[32:35], v[144:147]
    v_exp_f32 v24, v24
    v_mfma_f32_16x16x32_bf16 v[144:147], a[228:231], v[36:39], v[144:147]
    ds_read_b64_tr_b16 a[156:157], v2 offset:608
    v_perm_b32 v43, v23, v22, s100
    v_mfma_f32_16x16x32_bf16 v[148:151], a[232:235], v[32:35], v[148:151]
    v_exp_f32 v25, v25
    v_mfma_f32_16x16x32_bf16 v[148:151], a[236:239], v[36:39], v[148:151]
    ds_read_b64_tr_b16 a[158:159], v2 offset:864
    ds_read_b64_tr_b16 a[160:161], v2 offset:128
    v_mfma_f32_16x16x32_bf16 v[152:155], a[240:243], v[32:35], v[152:155]
    v_exp_f32 v26, v26
    v_mfma_f32_16x16x32_bf16 v[152:155], a[244:247], v[36:39], v[152:155]
    ds_read_b64_tr_b16 a[162:163], v2 offset:384
    v_perm_b32 v44, v25, v24, s100
    v_mfma_f32_16x16x32_bf16 v[156:159], a[248:251], v[32:35], v[156:159]
    v_exp_f32 v27, v27
    v_mfma_f32_16x16x32_bf16 v[156:159], a[252:255], v[36:39], v[156:159]
    ds_read_b64_tr_b16 a[164:165], v2 offset:640
    ds_read_b64_tr_b16 a[166:167], v2 offset:896
    v_smfmac_f32_16x16x64_bf16 a[0:3], a[16:19], v[32:39], v11
    ds_read_b64_tr_b16 a[168:169], v2 offset:160
    ds_read_b64_tr_b16 a[170:171], v2 offset:416
    v_mfma_f32_16x16x32_bf16 v[16:19], a[64:67], v[96:99], v[56:59]
    v_exp_f32 v28, v28
    v_mfma_f32_16x16x32_bf16 v[16:19], a[68:71], v[100:103], v[16:19]
    ds_read_b64_tr_b16 a[172:173], v2 offset:672
    v_perm_b32 v45, v27, v26, s100
    v_mfma_f32_16x16x32_bf16 v[16:19], a[72:75], v[104:107], v[16:19]
    s_add_u32 m0, s47, 36864
    v_exp_f32 v29, v29
    v_mfma_f32_16x16x32_bf16 v[16:19], a[76:79], v[108:111], v[16:19]
    s_add_u32 s46, s46, 16384
    buffer_load_dwordx4 off, s[16:19], s46 offset:0 lds
    v_mfma_f32_16x16x32_bf16 v[20:23], a[80:83], v[96:99], v[56:59]
    v_exp_f32 v30, v30
    v_mfma_f32_16x16x32_bf16 v[20:23], a[84:87], v[100:103], v[20:23]
    ds_read_b64_tr_b16 a[174:175], v2 offset:928
    v_perm_b32 v46, v29, v28, s100
    v_mfma_f32_16x16x32_bf16 v[20:23], a[88:91], v[104:107], v[20:23]
    s_add_u32 m0, s47, 36896
    v_exp_f32 v31, v31
    v_mfma_f32_16x16x32_bf16 v[20:23], a[92:95], v[108:111], v[20:23]
    buffer_load_dwordx4 off, s[16:19], s46 offset:1024 lds
    v_mfma_f32_16x16x32_bf16 v[24:27], a[96:99], v[96:99], v[56:59]
    v_exp_f32 v16, v16
    v_mfma_f32_16x16x32_bf16 v[24:27], a[100:103], v[100:103], v[24:27]
    ds_read_b64_tr_b16 a[176:177], v2 offset:192
    v_perm_b32 v47, v31, v30, s100
    v_mfma_f32_16x16x32_bf16 v[24:27], a[104:107], v[104:107], v[24:27]
    s_add_u32 m0, s47, 36928
    v_exp_f32 v17, v17
    v_mfma_f32_16x16x32_bf16 v[24:27], a[108:111], v[108:111], v[24:27]
    buffer_load_dwordx4 off, s[16:19], s46 offset:2048 lds
    v_mfma_f32_16x16x32_bf16 v[28:31], a[112:115], v[96:99], v[56:59]
    v_exp_f32 v18, v18
    v_mfma_f32_16x16x32_bf16 v[28:31], a[116:119], v[100:103], v[28:31]
    ds_read_b64_tr_b16 a[178:179], v2 offset:448
    v_perm_b32 v32, v17, v16, s100
    v_mfma_f32_16x16x32_bf16 v[28:31], a[120:123], v[104:107], v[28:31]
    s_add_u32 m0, s47, 36960
    v_exp_f32 v19, v19
    v_mfma_f32_16x16x32_bf16 v[28:31], a[124:127], v[108:111], v[28:31]
    buffer_load_dwordx4 off, s[16:19], s46 offset:3072 lds
    v_mfma_f32_16x16x32_bf16 v[160:163], a[192:195], v[40:43], v[160:163]
    v_exp_f32 v20, v20
    v_mfma_f32_16x16x32_bf16 v[160:163], a[196:199], v[44:47], v[160:163]
    ds_read_b64_tr_b16 a[180:181], v2 offset:704
    v_perm_b32 v33, v19, v18, s100
    v_mfma_f32_16x16x32_bf16 v[164:167], a[200:203], v[40:43], v[164:167]
    s_add_u32 m0, s47, 53760
    v_exp_f32 v21, v21
    v_mfma_f32_16x16x32_bf16 v[164:167], a[204:207], v[44:47], v[164:167]
    buffer_load_dwordx4 off, s[20:23], s46 offset:0 lds
    v_mfma_f32_16x16x32_bf16 v[168:171], a[208:211], v[40:43], v[168:171]
    v_exp_f32 v22, v22
    v_mfma_f32_16x16x32_bf16 v[168:171], a[212:215], v[44:47], v[168:171]
    ds_read_b64_tr_b16 a[182:183], v2 offset:960
    v_perm_b32 v34, v21, v20, s100
    v_mfma_f32_16x16x32_bf16 v[172:175], a[216:219], v[40:43], v[172:175]
    s_add_u32 m0, s47, 53792
    v_exp_f32 v23, v23
    v_mfma_f32_16x16x32_bf16 v[172:175], a[220:223], v[44:47], v[172:175]
    buffer_load_dwordx4 off, s[20:23], s46 offset:1024 lds
    v_mfma_f32_16x16x32_bf16 v[176:179], a[224:227], v[40:43], v[176:179]
    v_exp_f32 v24, v24
    v_mfma_f32_16x16x32_bf16 v[176:179], a[228:231], v[44:47], v[176:179]
    ds_read_b64_tr_b16 a[184:185], v2 offset:224
    v_perm_b32 v35, v23, v22, s100
    v_mfma_f32_16x16x32_bf16 v[180:183], a[232:235], v[40:43], v[180:183]
    s_add_u32 m0, s47, 53824
    v_exp_f32 v25, v25
    v_mfma_f32_16x16x32_bf16 v[180:183], a[236:239], v[44:47], v[180:183]
    buffer_load_dwordx4 off, s[20:23], s46 offset:2048 lds
    v_mfma_f32_16x16x32_bf16 v[184:187], a[240:243], v[40:43], v[184:187]
    v_exp_f32 v26, v26
    v_mfma_f32_16x16x32_bf16 v[184:187], a[244:247], v[44:47], v[184:187]
    ds_read_b64_tr_b16 a[186:187], v2 offset:480
    v_perm_b32 v36, v25, v24, s100
    v_mfma_f32_16x16x32_bf16 v[188:191], a[248:251], v[40:43], v[188:191]
    s_add_u32 m0, s47, 53856
    v_exp_f32 v27, v27
    v_mfma_f32_16x16x32_bf16 v[188:191], a[252:255], v[44:47], v[188:191]
    buffer_load_dwordx4 off, s[20:23], s46 offset:3072 lds
    v_smfmac_f32_16x16x64_bf16 a[4:7], a[16:19], v[40:47], v11
    ds_read_b64_tr_b16 a[188:189], v2 offset:736
    ds_read_b64_tr_b16 a[190:191], v2 offset:992
    v_mfma_f32_16x16x32_bf16 v[16:19], a[64:67], v[112:115], v[60:63]
    v_exp_f32 v28, v28
    v_mfma_f32_16x16x32_bf16 v[16:19], a[68:71], v[116:119], v[16:19]
    ds_read_b128 a[64:67], v1 offset:0
    v_perm_b32 v37, v27, v26, s100
    v_mfma_f32_16x16x32_bf16 v[16:19], a[72:75], v[120:123], v[16:19]
    v_exp_f32 v29, v29
    v_mfma_f32_16x16x32_bf16 v[16:19], a[76:79], v[124:127], v[16:19]
    ds_read_b128 a[68:71], v1 offset:64
    v_mfma_f32_16x16x32_bf16 v[20:23], a[80:83], v[112:115], v[60:63]
    v_exp_f32 v30, v30
    v_mfma_f32_16x16x32_bf16 v[20:23], a[84:87], v[116:119], v[20:23]
    ds_read_b128 a[72:75], v1 offset:128
    v_perm_b32 v38, v29, v28, s100
    v_mfma_f32_16x16x32_bf16 v[20:23], a[88:91], v[120:123], v[20:23]
    v_exp_f32 v31, v31
    v_mfma_f32_16x16x32_bf16 v[20:23], a[92:95], v[124:127], v[20:23]
    ds_read_b128 a[76:79], v1 offset:192
    v_mfma_f32_16x16x32_bf16 v[24:27], a[96:99], v[112:115], v[60:63]
    v_exp_f32 v16, v16
    v_mfma_f32_16x16x32_bf16 v[24:27], a[100:103], v[116:119], v[24:27]
    ds_read_b128 a[80:83], v1 offset:256
    v_perm_b32 v39, v31, v30, s100
    v_mfma_f32_16x16x32_bf16 v[24:27], a[104:107], v[120:123], v[24:27]
    v_exp_f32 v17, v17
    v_mfma_f32_16x16x32_bf16 v[24:27], a[108:111], v[124:127], v[24:27]
    ds_read_b128 a[84:87], v1 offset:320
    v_mfma_f32_16x16x32_bf16 v[28:31], a[112:115], v[112:115], v[60:63]
    v_exp_f32 v18, v18
    v_mfma_f32_16x16x32_bf16 v[28:31], a[116:119], v[116:119], v[28:31]
    ds_read_b128 a[88:91], v1 offset:384
    v_perm_b32 v40, v17, v16, s100
    v_mfma_f32_16x16x32_bf16 v[28:31], a[120:123], v[120:123], v[28:31]
    v_exp_f32 v19, v19
    v_mfma_f32_16x16x32_bf16 v[28:31], a[124:127], v[124:127], v[28:31]
    ds_read_b128 a[92:95], v1 offset:448
    v_mfma_f32_16x16x32_bf16 v[192:195], a[192:195], v[32:35], v[192:195]
    v_exp_f32 v20, v20
    v_mfma_f32_16x16x32_bf16 v[192:195], a[196:199], v[36:39], v[192:195]
    ds_read_b128 a[96:99], v1 offset:512
    v_perm_b32 v41, v19, v18, s100
    v_mfma_f32_16x16x32_bf16 v[196:199], a[200:203], v[32:35], v[196:199]
    v_exp_f32 v21, v21
    v_mfma_f32_16x16x32_bf16 v[196:199], a[204:207], v[36:39], v[196:199]
    ds_read_b128 a[100:103], v1 offset:576
    v_mfma_f32_16x16x32_bf16 v[200:203], a[208:211], v[32:35], v[200:203]
    v_exp_f32 v22, v22
    v_mfma_f32_16x16x32_bf16 v[200:203], a[212:215], v[36:39], v[200:203]
    ds_read_b128 a[104:107], v1 offset:640
    v_perm_b32 v42, v21, v20, s100
    v_mfma_f32_16x16x32_bf16 v[204:207], a[216:219], v[32:35], v[204:207]
    v_exp_f32 v23, v23
    v_mfma_f32_16x16x32_bf16 v[204:207], a[220:223], v[36:39], v[204:207]
    ds_read_b128 a[108:111], v1 offset:704
    v_mfma_f32_16x16x32_bf16 v[208:211], a[224:227], v[32:35], v[208:211]
    v_exp_f32 v24, v24
    v_mfma_f32_16x16x32_bf16 v[208:211], a[228:231], v[36:39], v[208:211]
    ds_read_b128 a[112:115], v1 offset:768
    v_perm_b32 v43, v23, v22, s100
    v_mfma_f32_16x16x32_bf16 v[212:215], a[232:235], v[32:35], v[212:215]
    v_exp_f32 v25, v25
    v_mfma_f32_16x16x32_bf16 v[212:215], a[236:239], v[36:39], v[212:215]
    ds_read_b128 a[116:119], v1 offset:832
    v_mfma_f32_16x16x32_bf16 v[216:219], a[240:243], v[32:35], v[216:219]
    v_exp_f32 v26, v26
    v_mfma_f32_16x16x32_bf16 v[216:219], a[244:247], v[36:39], v[216:219]
    ds_read_b128 a[120:123], v1 offset:896
    v_perm_b32 v44, v25, v24, s100
    v_mfma_f32_16x16x32_bf16 v[220:223], a[248:251], v[32:35], v[220:223]
    v_exp_f32 v27, v27
    v_mfma_f32_16x16x32_bf16 v[220:223], a[252:255], v[36:39], v[220:223]
    ds_read_b128 a[124:127], v1 offset:960
    v_smfmac_f32_16x16x64_bf16 a[8:11], a[16:19], v[32:39], v11
    s_waitcnt lgkmcnt(12)
    v_mfma_f32_16x16x32_bf16 v[16:19], a[64:67], v[64:67], v[48:51]
    v_exp_f32 v28, v28
    v_mfma_f32_16x16x32_bf16 v[16:19], a[68:71], v[68:71], v[16:19]
    v_perm_b32 v45, v27, v26, s100
    v_mfma_f32_16x16x32_bf16 v[16:19], a[72:75], v[72:75], v[16:19]
    v_exp_f32 v29, v29
    v_mfma_f32_16x16x32_bf16 v[16:19], a[76:79], v[76:79], v[16:19]
    s_waitcnt lgkmcnt(8)
    global_load_dword a63, v12, s[4:5]
    v_mfma_f32_16x16x32_bf16 v[20:23], a[80:83], v[64:67], v[48:51]
    v_exp_f32 v30, v30
    v_mfma_f32_16x16x32_bf16 v[20:23], a[84:87], v[68:71], v[20:23]
    v_perm_b32 v46, v29, v28, s100
    v_mfma_f32_16x16x32_bf16 v[20:23], a[88:91], v[72:75], v[20:23]
    v_exp_f32 v31, v31
    v_mfma_f32_16x16x32_bf16 v[20:23], a[92:95], v[76:79], v[20:23]
    s_waitcnt lgkmcnt(4)
    v_mfma_f32_16x16x32_bf16 v[24:27], a[96:99], v[64:67], v[48:51]
    v_exp_f32 v16, v16
    v_mfma_f32_16x16x32_bf16 v[24:27], a[100:103], v[68:71], v[24:27]
    v_perm_b32 v47, v31, v30, s100
    v_mfma_f32_16x16x32_bf16 v[24:27], a[104:107], v[72:75], v[24:27]
    v_exp_f32 v17, v17
    v_mfma_f32_16x16x32_bf16 v[24:27], a[108:111], v[76:79], v[24:27]
    s_waitcnt lgkmcnt(0)
    global_load_dword a63, v14, s[10:11]
    v_mfma_f32_16x16x32_bf16 v[28:31], a[112:115], v[64:67], v[48:51]
    v_exp_f32 v18, v18
    v_mfma_f32_16x16x32_bf16 v[28:31], a[116:119], v[68:71], v[28:31]
    v_perm_b32 v32, v17, v16, s100
    v_mfma_f32_16x16x32_bf16 v[28:31], a[120:123], v[72:75], v[28:31]
    v_exp_f32 v19, v19
    v_mfma_f32_16x16x32_bf16 v[28:31], a[124:127], v[76:79], v[28:31]
    v_mfma_f32_16x16x32_bf16 v[224:227], a[192:195], v[40:43], v[224:227]
    v_exp_f32 v20, v20
    v_mfma_f32_16x16x32_bf16 v[224:227], a[196:199], v[44:47], v[224:227]
    ds_read_b64_tr_b16 a[192:193], v2 offset:36864
    v_perm_b32 v33, v19, v18, s100
    v_mfma_f32_16x16x32_bf16 v[228:231], a[200:203], v[40:43], v[228:231]
    v_exp_f32 v21, v21
    v_mfma_f32_16x16x32_bf16 v[228:231], a[204:207], v[44:47], v[228:231]
    ds_read_b64_tr_b16 a[194:195], v2 offset:37120
    v_mfma_f32_16x16x32_bf16 v[232:235], a[208:211], v[40:43], v[232:235]
    v_exp_f32 v22, v22
    v_mfma_f32_16x16x32_bf16 v[232:235], a[212:215], v[44:47], v[232:235]
    ds_read_b64_tr_b16 a[196:197], v2 offset:37376
    v_perm_b32 v34, v21, v20, s100
    v_mfma_f32_16x16x32_bf16 v[236:239], a[216:219], v[40:43], v[236:239]
    v_exp_f32 v23, v23
    v_mfma_f32_16x16x32_bf16 v[236:239], a[220:223], v[44:47], v[236:239]
    ds_read_b64_tr_b16 a[198:199], v2 offset:37632
    v_mfma_f32_16x16x32_bf16 v[240:243], a[224:227], v[40:43], v[240:243]
    v_exp_f32 v24, v24
    v_mfma_f32_16x16x32_bf16 v[240:243], a[228:231], v[44:47], v[240:243]
    ds_read_b64_tr_b16 a[200:201], v2 offset:36896
    v_perm_b32 v35, v23, v22, s100
    v_mfma_f32_16x16x32_bf16 v[244:247], a[232:235], v[40:43], v[244:247]
    v_exp_f32 v25, v25
    v_mfma_f32_16x16x32_bf16 v[244:247], a[236:239], v[44:47], v[244:247]
    ds_read_b64_tr_b16 a[202:203], v2 offset:37152
    v_mfma_f32_16x16x32_bf16 v[248:251], a[240:243], v[40:43], v[248:251]
    v_exp_f32 v26, v26
    v_mfma_f32_16x16x32_bf16 v[248:251], a[244:247], v[44:47], v[248:251]
    ds_read_b64_tr_b16 a[204:205], v2 offset:37408
    v_perm_b32 v36, v25, v24, s100
    v_mfma_f32_16x16x32_bf16 v[252:255], a[248:251], v[40:43], v[252:255]
    v_exp_f32 v27, v27
    v_mfma_f32_16x16x32_bf16 v[252:255], a[252:255], v[44:47], v[252:255]
    ds_read_b64_tr_b16 a[206:207], v2 offset:37664
    v_smfmac_f32_16x16x64_bf16 a[12:15], a[16:19], v[40:47], v11
    ds_read_b64_tr_b16 a[208:209], v2 offset:36928
    v_mfma_f32_16x16x32_bf16 v[16:19], a[64:67], v[80:83], v[52:55]
    v_exp_f32 v28, v28
    v_mfma_f32_16x16x32_bf16 v[16:19], a[68:71], v[84:87], v[16:19]
    ds_read_b64_tr_b16 a[210:211], v2 offset:37184
    v_perm_b32 v37, v27, v26, s100
    v_mfma_f32_16x16x32_bf16 v[16:19], a[72:75], v[88:91], v[16:19]
    v_exp_f32 v29, v29
    v_mfma_f32_16x16x32_bf16 v[16:19], a[76:79], v[92:95], v[16:19]
    ds_read_b64_tr_b16 a[212:213], v2 offset:37440
    v_mfma_f32_16x16x32_bf16 v[20:23], a[80:83], v[80:83], v[52:55]
    v_exp_f32 v30, v30
    v_mfma_f32_16x16x32_bf16 v[20:23], a[84:87], v[84:87], v[20:23]
    ds_read_b64_tr_b16 a[214:215], v2 offset:37696
    v_perm_b32 v38, v29, v28, s100
    v_mfma_f32_16x16x32_bf16 v[20:23], a[88:91], v[88:91], v[20:23]
    v_exp_f32 v31, v31
    v_mfma_f32_16x16x32_bf16 v[20:23], a[92:95], v[92:95], v[20:23]
    ds_read_b64_tr_b16 a[216:217], v2 offset:36960
    v_mfma_f32_16x16x32_bf16 v[24:27], a[96:99], v[80:83], v[52:55]
    v_exp_f32 v16, v16
    v_mfma_f32_16x16x32_bf16 v[24:27], a[100:103], v[84:87], v[24:27]
    ds_read_b64_tr_b16 a[218:219], v2 offset:37216
    v_perm_b32 v39, v31, v30, s100
    v_mfma_f32_16x16x32_bf16 v[24:27], a[104:107], v[88:91], v[24:27]
    v_exp_f32 v17, v17
    v_mfma_f32_16x16x32_bf16 v[24:27], a[108:111], v[92:95], v[24:27]
    ds_read_b64_tr_b16 a[220:221], v2 offset:37472
    v_mfma_f32_16x16x32_bf16 v[28:31], a[112:115], v[80:83], v[52:55]
    v_exp_f32 v18, v18
    v_mfma_f32_16x16x32_bf16 v[28:31], a[116:119], v[84:87], v[28:31]
    ds_read_b64_tr_b16 a[222:223], v2 offset:37728
    v_perm_b32 v40, v17, v16, s100
    v_mfma_f32_16x16x32_bf16 v[28:31], a[120:123], v[88:91], v[28:31]
    v_exp_f32 v19, v19
    v_mfma_f32_16x16x32_bf16 v[28:31], a[124:127], v[92:95], v[28:31]
    ds_read_b64_tr_b16 a[224:225], v2 offset:36992
    v_mfma_f32_16x16x32_bf16 v[128:131], a[128:131], v[32:35], v[128:131]
    v_exp_f32 v20, v20
    v_mfma_f32_16x16x32_bf16 v[128:131], a[132:135], v[36:39], v[128:131]
    ds_read_b64_tr_b16 a[226:227], v2 offset:37248
    v_perm_b32 v41, v19, v18, s100
    v_mfma_f32_16x16x32_bf16 v[132:135], a[136:139], v[32:35], v[132:135]
    v_exp_f32 v21, v21
    v_mfma_f32_16x16x32_bf16 v[132:135], a[140:143], v[36:39], v[132:135]
    ds_read_b64_tr_b16 a[228:229], v2 offset:37504
    v_mfma_f32_16x16x32_bf16 v[136:139], a[144:147], v[32:35], v[136:139]
    v_exp_f32 v22, v22
    v_mfma_f32_16x16x32_bf16 v[136:139], a[148:151], v[36:39], v[136:139]
    ds_read_b64_tr_b16 a[230:231], v2 offset:37760
    v_perm_b32 v42, v21, v20, s100
    v_mfma_f32_16x16x32_bf16 v[140:143], a[152:155], v[32:35], v[140:143]
    v_exp_f32 v23, v23
    v_mfma_f32_16x16x32_bf16 v[140:143], a[156:159], v[36:39], v[140:143]
    ds_read_b64_tr_b16 a[232:233], v2 offset:37024
    v_mfma_f32_16x16x32_bf16 v[144:147], a[160:163], v[32:35], v[144:147]
    v_exp_f32 v24, v24
    v_mfma_f32_16x16x32_bf16 v[144:147], a[164:167], v[36:39], v[144:147]
    ds_read_b64_tr_b16 a[234:235], v2 offset:37280
    v_perm_b32 v43, v23, v22, s100
    v_mfma_f32_16x16x32_bf16 v[148:151], a[168:171], v[32:35], v[148:151]
    v_exp_f32 v25, v25
    v_mfma_f32_16x16x32_bf16 v[148:151], a[172:175], v[36:39], v[148:151]
    ds_read_b64_tr_b16 a[236:237], v2 offset:37536
    v_mfma_f32_16x16x32_bf16 v[152:155], a[176:179], v[32:35], v[152:155]
    v_exp_f32 v26, v26
    v_mfma_f32_16x16x32_bf16 v[152:155], a[180:183], v[36:39], v[152:155]
    ds_read_b64_tr_b16 a[238:239], v2 offset:37792
    v_perm_b32 v44, v25, v24, s100
    v_mfma_f32_16x16x32_bf16 v[156:159], a[184:187], v[32:35], v[156:159]
    v_exp_f32 v27, v27
    v_mfma_f32_16x16x32_bf16 v[156:159], a[188:191], v[36:39], v[156:159]
    ds_read_b64_tr_b16 a[240:241], v2 offset:37056
    v_smfmac_f32_16x16x64_bf16 a[0:3], a[16:19], v[32:39], v11
    ds_read_b64_tr_b16 a[242:243], v2 offset:37312
    v_mfma_f32_16x16x32_bf16 v[16:19], a[64:67], v[96:99], v[56:59]
    v_exp_f32 v28, v28
    v_mfma_f32_16x16x32_bf16 v[16:19], a[68:71], v[100:103], v[16:19]
    ds_read_b64_tr_b16 a[244:245], v2 offset:37568
    v_perm_b32 v45, v27, v26, s100
    v_mfma_f32_16x16x32_bf16 v[16:19], a[72:75], v[104:107], v[16:19]
    v_exp_f32 v29, v29
    v_mfma_f32_16x16x32_bf16 v[16:19], a[76:79], v[108:111], v[16:19]
    ds_read_b64_tr_b16 a[246:247], v2 offset:37824
    v_mfma_f32_16x16x32_bf16 v[20:23], a[80:83], v[96:99], v[56:59]
    v_exp_f32 v30, v30
    v_mfma_f32_16x16x32_bf16 v[20:23], a[84:87], v[100:103], v[20:23]
    ds_read_b64_tr_b16 a[248:249], v2 offset:37088
    v_perm_b32 v46, v29, v28, s100
    v_mfma_f32_16x16x32_bf16 v[20:23], a[88:91], v[104:107], v[20:23]
    v_exp_f32 v31, v31
    v_mfma_f32_16x16x32_bf16 v[20:23], a[92:95], v[108:111], v[20:23]
    ds_read_b64_tr_b16 a[250:251], v2 offset:37344
    v_mfma_f32_16x16x32_bf16 v[24:27], a[96:99], v[96:99], v[56:59]
    v_exp_f32 v16, v16
    v_mfma_f32_16x16x32_bf16 v[24:27], a[100:103], v[100:103], v[24:27]
    ds_read_b64_tr_b16 a[252:253], v2 offset:37600
    v_perm_b32 v47, v31, v30, s100
    v_mfma_f32_16x16x32_bf16 v[24:27], a[104:107], v[104:107], v[24:27]
    v_exp_f32 v17, v17
    v_mfma_f32_16x16x32_bf16 v[24:27], a[108:111], v[108:111], v[24:27]
    ds_read_b64_tr_b16 a[254:255], v2 offset:37856
    v_mfma_f32_16x16x32_bf16 v[28:31], a[112:115], v[96:99], v[56:59]
    v_exp_f32 v18, v18
    v_mfma_f32_16x16x32_bf16 v[28:31], a[116:119], v[100:103], v[28:31]
    v_perm_b32 v32, v17, v16, s100
    v_mfma_f32_16x16x32_bf16 v[28:31], a[120:123], v[104:107], v[28:31]
    v_exp_f32 v19, v19
    v_mfma_f32_16x16x32_bf16 v[28:31], a[124:127], v[108:111], v[28:31]
    v_mfma_f32_16x16x32_bf16 v[160:163], a[128:131], v[40:43], v[160:163]
    v_exp_f32 v20, v20
    v_mfma_f32_16x16x32_bf16 v[160:163], a[132:135], v[44:47], v[160:163]
    v_perm_b32 v33, v19, v18, s100
    v_mfma_f32_16x16x32_bf16 v[164:167], a[136:139], v[40:43], v[164:167]
    v_exp_f32 v21, v21
    v_mfma_f32_16x16x32_bf16 v[164:167], a[140:143], v[44:47], v[164:167]
    v_mfma_f32_16x16x32_bf16 v[168:171], a[144:147], v[40:43], v[168:171]
    v_exp_f32 v22, v22
    v_mfma_f32_16x16x32_bf16 v[168:171], a[148:151], v[44:47], v[168:171]
    v_perm_b32 v34, v21, v20, s100
    v_mfma_f32_16x16x32_bf16 v[172:175], a[152:155], v[40:43], v[172:175]
    v_exp_f32 v23, v23
    v_mfma_f32_16x16x32_bf16 v[172:175], a[156:159], v[44:47], v[172:175]
    v_mfma_f32_16x16x32_bf16 v[176:179], a[160:163], v[40:43], v[176:179]
    v_exp_f32 v24, v24
    v_mfma_f32_16x16x32_bf16 v[176:179], a[164:167], v[44:47], v[176:179]
    v_perm_b32 v35, v23, v22, s100
    v_mfma_f32_16x16x32_bf16 v[180:183], a[168:171], v[40:43], v[180:183]
    v_exp_f32 v25, v25
    v_mfma_f32_16x16x32_bf16 v[180:183], a[172:175], v[44:47], v[180:183]
    v_mfma_f32_16x16x32_bf16 v[184:187], a[176:179], v[40:43], v[184:187]
    v_exp_f32 v26, v26
    v_mfma_f32_16x16x32_bf16 v[184:187], a[180:183], v[44:47], v[184:187]
    v_perm_b32 v36, v25, v24, s100
    v_mfma_f32_16x16x32_bf16 v[188:191], a[184:187], v[40:43], v[188:191]
    v_exp_f32 v27, v27
    v_mfma_f32_16x16x32_bf16 v[188:191], a[188:191], v[44:47], v[188:191]
    v_smfmac_f32_16x16x64_bf16 a[4:7], a[16:19], v[40:47], v11
    v_mfma_f32_16x16x32_bf16 v[16:19], a[64:67], v[112:115], v[60:63]
    v_exp_f32 v28, v28
    v_mfma_f32_16x16x32_bf16 v[16:19], a[68:71], v[116:119], v[16:19]
    ds_read_b128 a[64:67], v1 offset:36864
    v_perm_b32 v37, v27, v26, s100
    v_mfma_f32_16x16x32_bf16 v[16:19], a[72:75], v[120:123], v[16:19]
    v_exp_f32 v29, v29
    v_mfma_f32_16x16x32_bf16 v[16:19], a[76:79], v[124:127], v[16:19]
    ds_read_b128 a[68:71], v1 offset:36928
    v_mfma_f32_16x16x32_bf16 v[20:23], a[80:83], v[112:115], v[60:63]
    v_exp_f32 v30, v30
    v_mfma_f32_16x16x32_bf16 v[20:23], a[84:87], v[116:119], v[20:23]
    ds_read_b128 a[72:75], v1 offset:36992
    v_perm_b32 v38, v29, v28, s100
    v_mfma_f32_16x16x32_bf16 v[20:23], a[88:91], v[120:123], v[20:23]
    v_exp_f32 v31, v31
    v_mfma_f32_16x16x32_bf16 v[20:23], a[92:95], v[124:127], v[20:23]
    ds_read_b128 a[76:79], v1 offset:37056
    v_mfma_f32_16x16x32_bf16 v[24:27], a[96:99], v[112:115], v[60:63]
    v_exp_f32 v16, v16
    v_mfma_f32_16x16x32_bf16 v[24:27], a[100:103], v[116:119], v[24:27]
    ds_read_b128 a[80:83], v1 offset:37120
    v_perm_b32 v39, v31, v30, s100
    v_mfma_f32_16x16x32_bf16 v[24:27], a[104:107], v[120:123], v[24:27]
    v_exp_f32 v17, v17
    v_mfma_f32_16x16x32_bf16 v[24:27], a[108:111], v[124:127], v[24:27]
    ds_read_b128 a[84:87], v1 offset:37184
    v_mfma_f32_16x16x32_bf16 v[28:31], a[112:115], v[112:115], v[60:63]
    v_exp_f32 v18, v18
    v_mfma_f32_16x16x32_bf16 v[28:31], a[116:119], v[116:119], v[28:31]
    ds_read_b128 a[88:91], v1 offset:37248
    v_perm_b32 v40, v17, v16, s100
    v_mfma_f32_16x16x32_bf16 v[28:31], a[120:123], v[120:123], v[28:31]
    v_exp_f32 v19, v19
    v_mfma_f32_16x16x32_bf16 v[28:31], a[124:127], v[124:127], v[28:31]
    ds_read_b128 a[92:95], v1 offset:37312
    v_mfma_f32_16x16x32_bf16 v[192:195], a[128:131], v[32:35], v[192:195]
    v_exp_f32 v20, v20
    v_mfma_f32_16x16x32_bf16 v[192:195], a[132:135], v[36:39], v[192:195]
    ds_read_b128 a[96:99], v1 offset:37376
    v_perm_b32 v41, v19, v18, s100
    v_mfma_f32_16x16x32_bf16 v[196:199], a[136:139], v[32:35], v[196:199]
    v_exp_f32 v21, v21
    v_mfma_f32_16x16x32_bf16 v[196:199], a[140:143], v[36:39], v[196:199]
    ds_read_b128 a[100:103], v1 offset:37440
    v_mfma_f32_16x16x32_bf16 v[200:203], a[144:147], v[32:35], v[200:203]
    v_exp_f32 v22, v22
    v_mfma_f32_16x16x32_bf16 v[200:203], a[148:151], v[36:39], v[200:203]
L2_pad6:
    s_cbranch_execz L2_pad10
    ds_read_b128 a[104:107], v1 offset:37504
    v_perm_b32 v42, v21, v20, s100
    v_mfma_f32_16x16x32_bf16 v[204:207], a[152:155], v[32:35], v[204:207]
    v_exp_f32 v23, v23
    v_mfma_f32_16x16x32_bf16 v[204:207], a[156:159], v[36:39], v[204:207]
    ds_read_b128 a[108:111], v1 offset:37568
    v_mfma_f32_16x16x32_bf16 v[208:211], a[160:163], v[32:35], v[208:211]
    v_exp_f32 v24, v24
    v_mfma_f32_16x16x32_bf16 v[208:211], a[164:167], v[36:39], v[208:211]
    ds_read_b128 a[112:115], v1 offset:37632
    v_perm_b32 v43, v23, v22, s100
    v_mfma_f32_16x16x32_bf16 v[212:215], a[168:171], v[32:35], v[212:215]
    v_exp_f32 v25, v25
    v_mfma_f32_16x16x32_bf16 v[212:215], a[172:175], v[36:39], v[212:215]
    ds_read_b128 a[116:119], v1 offset:37696
    v_mfma_f32_16x16x32_bf16 v[216:219], a[176:179], v[32:35], v[216:219]
    v_exp_f32 v26, v26
    v_mfma_f32_16x16x32_bf16 v[216:219], a[180:183], v[36:39], v[216:219]
    ds_read_b128 a[120:123], v1 offset:37760
    v_perm_b32 v44, v25, v24, s100
    v_mfma_f32_16x16x32_bf16 v[220:223], a[184:187], v[32:35], v[220:223]
    v_exp_f32 v27, v27
    v_mfma_f32_16x16x32_bf16 v[220:223], a[188:191], v[36:39], v[220:223]
    ds_read_b128 a[124:127], v1 offset:37824
    v_smfmac_f32_16x16x64_bf16 a[8:11], a[16:19], v[32:39], v11
    s_waitcnt lgkmcnt(12)
    v_mfma_f32_16x16x32_bf16 v[16:19], a[64:67], v[64:67], v[48:51]
    s_sub_u32 s47, s47, s48
    v_exp_f32 v28, v28
    v_mfma_f32_16x16x32_bf16 v[16:19], a[68:71], v[68:71], v[16:19]
    v_perm_b32 v45, v27, v26, s100
    v_add_u32 v1, s48, v1
    v_mfma_f32_16x16x32_bf16 v[16:19], a[72:75], v[72:75], v[16:19]
    v_exp_f32 v29, v29
    v_mfma_f32_16x16x32_bf16 v[16:19], a[76:79], v[76:79], v[16:19]
    s_waitcnt lgkmcnt(8)
    v_mfma_f32_16x16x32_bf16 v[20:23], a[80:83], v[64:67], v[48:51]
    v_exp_f32 v30, v30
    v_mfma_f32_16x16x32_bf16 v[20:23], a[84:87], v[68:71], v[20:23]
    v_perm_b32 v46, v29, v28, s100
    v_add_u32 v2, s48, v2
    v_mfma_f32_16x16x32_bf16 v[20:23], a[88:91], v[72:75], v[20:23]
    v_exp_f32 v31, v31
    v_mfma_f32_16x16x32_bf16 v[20:23], a[92:95], v[76:79], v[20:23]
    s_waitcnt lgkmcnt(4)
    v_mfma_f32_16x16x32_bf16 v[24:27], a[96:99], v[64:67], v[48:51]
    s_sub_u32 s48, 0, s48
    v_exp_f32 v16, v16
    v_mfma_f32_16x16x32_bf16 v[24:27], a[100:103], v[68:71], v[24:27]
    v_perm_b32 v47, v31, v30, s100
    v_mfma_f32_16x16x32_bf16 v[24:27], a[104:107], v[72:75], v[24:27]
    v_exp_f32 v17, v17
    v_mfma_f32_16x16x32_bf16 v[24:27], a[108:111], v[76:79], v[24:27]
    s_waitcnt lgkmcnt(0)
    v_mfma_f32_16x16x32_bf16 v[28:31], a[112:115], v[64:67], v[48:51]
    v_exp_f32 v18, v18
    v_mfma_f32_16x16x32_bf16 v[28:31], a[116:119], v[68:71], v[28:31]
    v_perm_b32 v32, v17, v16, s100
    v_mfma_f32_16x16x32_bf16 v[28:31], a[120:123], v[72:75], v[28:31]
    v_exp_f32 v19, v19
    v_mfma_f32_16x16x32_bf16 v[28:31], a[124:127], v[76:79], v[28:31]
    s_waitcnt vmcnt(2)
    s_barrier
    v_mfma_f32_16x16x32_bf16 v[224:227], a[128:131], v[40:43], v[224:227]
    v_exp_f32 v20, v20
    v_mfma_f32_16x16x32_bf16 v[224:227], a[132:135], v[44:47], v[224:227]
    ds_read_b64_tr_b16 a[128:129], v2 offset:0
    v_perm_b32 v33, v19, v18, s100
    v_mfma_f32_16x16x32_bf16 v[228:231], a[136:139], v[40:43], v[228:231]
    s_add_u32 m0, s47, 0
    v_exp_f32 v21, v21
    v_mfma_f32_16x16x32_bf16 v[228:231], a[140:143], v[44:47], v[228:231]
    s_add_u32 s46, s46, 16384
    buffer_load_dwordx4 off, s[16:19], s46 offset:0 lds
    v_mfma_f32_16x16x32_bf16 v[232:235], a[144:147], v[40:43], v[232:235]
    v_exp_f32 v22, v22
    v_mfma_f32_16x16x32_bf16 v[232:235], a[148:151], v[44:47], v[232:235]
    ds_read_b64_tr_b16 a[130:131], v2 offset:256
    v_perm_b32 v34, v21, v20, s100
    v_mfma_f32_16x16x32_bf16 v[236:239], a[152:155], v[40:43], v[236:239]
    s_add_u32 m0, s47, 32
    v_exp_f32 v23, v23
    v_mfma_f32_16x16x32_bf16 v[236:239], a[156:159], v[44:47], v[236:239]
    buffer_load_dwordx4 off, s[16:19], s46 offset:1024 lds
    v_mfma_f32_16x16x32_bf16 v[240:243], a[160:163], v[40:43], v[240:243]
    v_exp_f32 v24, v24
    v_mfma_f32_16x16x32_bf16 v[240:243], a[164:167], v[44:47], v[240:243]
    ds_read_b64_tr_b16 a[132:133], v2 offset:512
    v_perm_b32 v35, v23, v22, s100
    v_mfma_f32_16x16x32_bf16 v[244:247], a[168:171], v[40:43], v[244:247]
    s_add_u32 m0, s47, 64
    v_exp_f32 v25, v25
    v_mfma_f32_16x16x32_bf16 v[244:247], a[172:175], v[44:47], v[244:247]
    buffer_load_dwordx4 off, s[16:19], s46 offset:2048 lds
    v_mfma_f32_16x16x32_bf16 v[248:251], a[176:179], v[40:43], v[248:251]
    v_exp_f32 v26, v26
    v_mfma_f32_16x16x32_bf16 v[248:251], a[180:183], v[44:47], v[248:251]
    ds_read_b64_tr_b16 a[134:135], v2 offset:768
    v_perm_b32 v36, v25, v24, s100
    v_mfma_f32_16x16x32_bf16 v[252:255], a[184:187], v[40:43], v[252:255]
    s_add_u32 m0, s47, 96
    v_exp_f32 v27, v27
    v_mfma_f32_16x16x32_bf16 v[252:255], a[188:191], v[44:47], v[252:255]
    buffer_load_dwordx4 off, s[16:19], s46 offset:3072 lds
    v_smfmac_f32_16x16x64_bf16 a[12:15], a[16:19], v[40:47], v11
    ds_read_b64_tr_b16 a[136:137], v2 offset:32
    v_mfma_f32_16x16x32_bf16 v[16:19], a[64:67], v[80:83], v[52:55]
    v_exp_f32 v28, v28
    v_mfma_f32_16x16x32_bf16 v[16:19], a[68:71], v[84:87], v[16:19]
    ds_read_b64_tr_b16 a[138:139], v2 offset:288
    v_perm_b32 v37, v27, v26, s100
    v_mfma_f32_16x16x32_bf16 v[16:19], a[72:75], v[88:91], v[16:19]
    s_add_u32 m0, s47, 16896
    v_exp_f32 v29, v29
    v_mfma_f32_16x16x32_bf16 v[16:19], a[76:79], v[92:95], v[16:19]
    buffer_load_dwordx4 off, s[20:23], s46 offset:0 lds
    v_mfma_f32_16x16x32_bf16 v[20:23], a[80:83], v[80:83], v[52:55]
    v_exp_f32 v30, v30
    v_mfma_f32_16x16x32_bf16 v[20:23], a[84:87], v[84:87], v[20:23]
    ds_read_b64_tr_b16 a[140:141], v2 offset:544
    v_perm_b32 v38, v29, v28, s100
    v_mfma_f32_16x16x32_bf16 v[20:23], a[88:91], v[88:91], v[20:23]
    s_add_u32 m0, s47, 16928
    v_exp_f32 v31, v31
    v_mfma_f32_16x16x32_bf16 v[20:23], a[92:95], v[92:95], v[20:23]
    buffer_load_dwordx4 off, s[20:23], s46 offset:1024 lds
    v_mfma_f32_16x16x32_bf16 v[24:27], a[96:99], v[80:83], v[52:55]
    v_exp_f32 v16, v16
    v_mfma_f32_16x16x32_bf16 v[24:27], a[100:103], v[84:87], v[24:27]
    ds_read_b64_tr_b16 a[142:143], v2 offset:800
    v_perm_b32 v39, v31, v30, s100
    v_mfma_f32_16x16x32_bf16 v[24:27], a[104:107], v[88:91], v[24:27]
    s_add_u32 m0, s47, 16960
    v_exp_f32 v17, v17
    v_mfma_f32_16x16x32_bf16 v[24:27], a[108:111], v[92:95], v[24:27]
    buffer_load_dwordx4 off, s[20:23], s46 offset:2048 lds
    v_mfma_f32_16x16x32_bf16 v[28:31], a[112:115], v[80:83], v[52:55]
    v_exp_f32 v18, v18
    v_mfma_f32_16x16x32_bf16 v[28:31], a[116:119], v[84:87], v[28:31]
    ds_read_b64_tr_b16 a[144:145], v2 offset:64
    v_perm_b32 v40, v17, v16, s100
    v_mfma_f32_16x16x32_bf16 v[28:31], a[120:123], v[88:91], v[28:31]
    s_add_u32 m0, s47, 16992
    v_exp_f32 v19, v19
    v_mfma_f32_16x16x32_bf16 v[28:31], a[124:127], v[92:95], v[28:31]
    buffer_load_dwordx4 off, s[20:23], s46 offset:3072 lds
    v_mfma_f32_16x16x32_bf16 v[128:131], a[192:195], v[32:35], v[128:131]
    v_exp_f32 v20, v20
    v_mfma_f32_16x16x32_bf16 v[128:131], a[196:199], v[36:39], v[128:131]
    ds_read_b64_tr_b16 a[146:147], v2 offset:320
    v_perm_b32 v41, v19, v18, s100
    v_mfma_f32_16x16x32_bf16 v[132:135], a[200:203], v[32:35], v[132:135]
    v_exp_f32 v21, v21
    v_mfma_f32_16x16x32_bf16 v[132:135], a[204:207], v[36:39], v[132:135]
    ds_read_b64_tr_b16 a[148:149], v2 offset:576
    v_mfma_f32_16x16x32_bf16 v[136:139], a[208:211], v[32:35], v[136:139]
    v_exp_f32 v22, v22
    v_mfma_f32_16x16x32_bf16 v[136:139], a[212:215], v[36:39], v[136:139]
    ds_read_b64_tr_b16 a[150:151], v2 offset:832
    v_perm_b32 v42, v21, v20, s100
    v_mfma_f32_16x16x32_bf16 v[140:143], a[216:219], v[32:35], v[140:143]
    v_exp_f32 v23, v23
    v_mfma_f32_16x16x32_bf16 v[140:143], a[220:223], v[36:39], v[140:143]
    ds_read_b64_tr_b16 a[152:153], v2 offset:96
    ds_read_b64_tr_b16 a[154:155], v2 offset:352
    v_mfma_f32_16x16x32_bf16 v[144:147], a[224:227], v[32:35], v[144:147]
    v_exp_f32 v24, v24
    v_mfma_f32_16x16x32_bf16 v[144:147], a[228:231], v[36:39], v[144:147]
    ds_read_b64_tr_b16 a[156:157], v2 offset:608
    v_perm_b32 v43, v23, v22, s100
    v_mfma_f32_16x16x32_bf16 v[148:151], a[232:235], v[32:35], v[148:151]
    v_exp_f32 v25, v25
    v_mfma_f32_16x16x32_bf16 v[148:151], a[236:239], v[36:39], v[148:151]
    ds_read_b64_tr_b16 a[158:159], v2 offset:864
    ds_read_b64_tr_b16 a[160:161], v2 offset:128
    v_mfma_f32_16x16x32_bf16 v[152:155], a[240:243], v[32:35], v[152:155]
    v_exp_f32 v26, v26
    v_mfma_f32_16x16x32_bf16 v[152:155], a[244:247], v[36:39], v[152:155]
    ds_read_b64_tr_b16 a[162:163], v2 offset:384
    v_perm_b32 v44, v25, v24, s100
    v_mfma_f32_16x16x32_bf16 v[156:159], a[248:251], v[32:35], v[156:159]
    v_exp_f32 v27, v27
    v_mfma_f32_16x16x32_bf16 v[156:159], a[252:255], v[36:39], v[156:159]
    ds_read_b64_tr_b16 a[164:165], v2 offset:640
    ds_read_b64_tr_b16 a[166:167], v2 offset:896
    v_smfmac_f32_16x16x64_bf16 a[0:3], a[16:19], v[32:39], v11
    ds_read_b64_tr_b16 a[168:169], v2 offset:160
    ds_read_b64_tr_b16 a[170:171], v2 offset:416
    v_mfma_f32_16x16x32_bf16 v[16:19], a[64:67], v[96:99], v[56:59]
    v_exp_f32 v28, v28
    v_mfma_f32_16x16x32_bf16 v[16:19], a[68:71], v[100:103], v[16:19]
    ds_read_b64_tr_b16 a[172:173], v2 offset:672
    v_perm_b32 v45, v27, v26, s100
    v_mfma_f32_16x16x32_bf16 v[16:19], a[72:75], v[104:107], v[16:19]
    s_add_u32 m0, s47, 36864
    v_exp_f32 v29, v29
    v_mfma_f32_16x16x32_bf16 v[16:19], a[76:79], v[108:111], v[16:19]
    s_add_u32 s46, s46, 16384
    buffer_load_dwordx4 off, s[16:19], s46 offset:0 lds
    v_mfma_f32_16x16x32_bf16 v[20:23], a[80:83], v[96:99], v[56:59]
    v_exp_f32 v30, v30
    v_mfma_f32_16x16x32_bf16 v[20:23], a[84:87], v[100:103], v[20:23]
    ds_read_b64_tr_b16 a[174:175], v2 offset:928
    v_perm_b32 v46, v29, v28, s100
    v_mfma_f32_16x16x32_bf16 v[20:23], a[88:91], v[104:107], v[20:23]
    s_add_u32 m0, s47, 36896
    v_exp_f32 v31, v31
    v_mfma_f32_16x16x32_bf16 v[20:23], a[92:95], v[108:111], v[20:23]
    buffer_load_dwordx4 off, s[16:19], s46 offset:1024 lds
    v_mfma_f32_16x16x32_bf16 v[24:27], a[96:99], v[96:99], v[56:59]
    v_exp_f32 v16, v16
    v_mfma_f32_16x16x32_bf16 v[24:27], a[100:103], v[100:103], v[24:27]
    ds_read_b64_tr_b16 a[176:177], v2 offset:192
    v_perm_b32 v47, v31, v30, s100
    v_mfma_f32_16x16x32_bf16 v[24:27], a[104:107], v[104:107], v[24:27]
    s_add_u32 m0, s47, 36928
    v_exp_f32 v17, v17
    v_mfma_f32_16x16x32_bf16 v[24:27], a[108:111], v[108:111], v[24:27]
    buffer_load_dwordx4 off, s[16:19], s46 offset:2048 lds
    v_mfma_f32_16x16x32_bf16 v[28:31], a[112:115], v[96:99], v[56:59]
    v_exp_f32 v18, v18
    v_mfma_f32_16x16x32_bf16 v[28:31], a[116:119], v[100:103], v[28:31]
    ds_read_b64_tr_b16 a[178:179], v2 offset:448
    v_perm_b32 v32, v17, v16, s100
    v_mfma_f32_16x16x32_bf16 v[28:31], a[120:123], v[104:107], v[28:31]
    s_add_u32 m0, s47, 36960
    v_exp_f32 v19, v19
    v_mfma_f32_16x16x32_bf16 v[28:31], a[124:127], v[108:111], v[28:31]
    buffer_load_dwordx4 off, s[16:19], s46 offset:3072 lds
    v_mfma_f32_16x16x32_bf16 v[160:163], a[192:195], v[40:43], v[160:163]
    v_exp_f32 v20, v20
    v_mfma_f32_16x16x32_bf16 v[160:163], a[196:199], v[44:47], v[160:163]
    ds_read_b64_tr_b16 a[180:181], v2 offset:704
    v_perm_b32 v33, v19, v18, s100
    v_mfma_f32_16x16x32_bf16 v[164:167], a[200:203], v[40:43], v[164:167]
    s_add_u32 m0, s47, 53760
    v_exp_f32 v21, v21
    v_mfma_f32_16x16x32_bf16 v[164:167], a[204:207], v[44:47], v[164:167]
    buffer_load_dwordx4 off, s[20:23], s46 offset:0 lds
    v_mfma_f32_16x16x32_bf16 v[168:171], a[208:211], v[40:43], v[168:171]
    v_exp_f32 v22, v22
    v_mfma_f32_16x16x32_bf16 v[168:171], a[212:215], v[44:47], v[168:171]
    ds_read_b64_tr_b16 a[182:183], v2 offset:960
    v_perm_b32 v34, v21, v20, s100
    v_mfma_f32_16x16x32_bf16 v[172:175], a[216:219], v[40:43], v[172:175]
    s_add_u32 m0, s47, 53792
    v_exp_f32 v23, v23
    v_mfma_f32_16x16x32_bf16 v[172:175], a[220:223], v[44:47], v[172:175]
    buffer_load_dwordx4 off, s[20:23], s46 offset:1024 lds
    v_mfma_f32_16x16x32_bf16 v[176:179], a[224:227], v[40:43], v[176:179]
    v_exp_f32 v24, v24
    v_mfma_f32_16x16x32_bf16 v[176:179], a[228:231], v[44:47], v[176:179]
    ds_read_b64_tr_b16 a[184:185], v2 offset:224
    v_perm_b32 v35, v23, v22, s100
    v_mfma_f32_16x16x32_bf16 v[180:183], a[232:235], v[40:43], v[180:183]
    s_add_u32 m0, s47, 53824
    v_exp_f32 v25, v25
    v_mfma_f32_16x16x32_bf16 v[180:183], a[236:239], v[44:47], v[180:183]
    buffer_load_dwordx4 off, s[20:23], s46 offset:2048 lds
    v_mfma_f32_16x16x32_bf16 v[184:187], a[240:243], v[40:43], v[184:187]
    v_exp_f32 v26, v26
    v_mfma_f32_16x16x32_bf16 v[184:187], a[244:247], v[44:47], v[184:187]
    ds_read_b64_tr_b16 a[186:187], v2 offset:480
    v_perm_b32 v36, v25, v24, s100
    v_mfma_f32_16x16x32_bf16 v[188:191], a[248:251], v[40:43], v[188:191]
    s_add_u32 m0, s47, 53856
    v_exp_f32 v27, v27
    v_mfma_f32_16x16x32_bf16 v[188:191], a[252:255], v[44:47], v[188:191]
    buffer_load_dwordx4 off, s[20:23], s46 offset:3072 lds
    v_smfmac_f32_16x16x64_bf16 a[4:7], a[16:19], v[40:47], v11
    ds_read_b64_tr_b16 a[188:189], v2 offset:736
    ds_read_b64_tr_b16 a[190:191], v2 offset:992
    v_mfma_f32_16x16x32_bf16 v[16:19], a[64:67], v[112:115], v[60:63]
    v_exp_f32 v28, v28
    v_mfma_f32_16x16x32_bf16 v[16:19], a[68:71], v[116:119], v[16:19]
    ds_read_b128 a[64:67], v1 offset:0
    v_perm_b32 v37, v27, v26, s100
    v_mfma_f32_16x16x32_bf16 v[16:19], a[72:75], v[120:123], v[16:19]
    v_exp_f32 v29, v29
    v_mfma_f32_16x16x32_bf16 v[16:19], a[76:79], v[124:127], v[16:19]
    ds_read_b128 a[68:71], v1 offset:64
    v_mfma_f32_16x16x32_bf16 v[20:23], a[80:83], v[112:115], v[60:63]
    v_exp_f32 v30, v30
    v_mfma_f32_16x16x32_bf16 v[20:23], a[84:87], v[116:119], v[20:23]
    ds_read_b128 a[72:75], v1 offset:128
    v_perm_b32 v38, v29, v28, s100
    v_mfma_f32_16x16x32_bf16 v[20:23], a[88:91], v[120:123], v[20:23]
    v_exp_f32 v31, v31
    v_mfma_f32_16x16x32_bf16 v[20:23], a[92:95], v[124:127], v[20:23]
    ds_read_b128 a[76:79], v1 offset:192
    v_mfma_f32_16x16x32_bf16 v[24:27], a[96:99], v[112:115], v[60:63]
    v_exp_f32 v16, v16
    v_mfma_f32_16x16x32_bf16 v[24:27], a[100:103], v[116:119], v[24:27]
    ds_read_b128 a[80:83], v1 offset:256
    v_perm_b32 v39, v31, v30, s100
    v_mfma_f32_16x16x32_bf16 v[24:27], a[104:107], v[120:123], v[24:27]
    v_exp_f32 v17, v17
    v_mfma_f32_16x16x32_bf16 v[24:27], a[108:111], v[124:127], v[24:27]
    ds_read_b128 a[84:87], v1 offset:320
    v_mfma_f32_16x16x32_bf16 v[28:31], a[112:115], v[112:115], v[60:63]
    v_exp_f32 v18, v18
    v_mfma_f32_16x16x32_bf16 v[28:31], a[116:119], v[116:119], v[28:31]
    ds_read_b128 a[88:91], v1 offset:384
    v_perm_b32 v40, v17, v16, s100
    v_mfma_f32_16x16x32_bf16 v[28:31], a[120:123], v[120:123], v[28:31]
    v_exp_f32 v19, v19
    v_mfma_f32_16x16x32_bf16 v[28:31], a[124:127], v[124:127], v[28:31]
    ds_read_b128 a[92:95], v1 offset:448
    v_mfma_f32_16x16x32_bf16 v[192:195], a[192:195], v[32:35], v[192:195]
    v_exp_f32 v20, v20
    v_mfma_f32_16x16x32_bf16 v[192:195], a[196:199], v[36:39], v[192:195]
    ds_read_b128 a[96:99], v1 offset:512
    v_perm_b32 v41, v19, v18, s100
    v_mfma_f32_16x16x32_bf16 v[196:199], a[200:203], v[32:35], v[196:199]
    v_exp_f32 v21, v21
    v_mfma_f32_16x16x32_bf16 v[196:199], a[204:207], v[36:39], v[196:199]
    ds_read_b128 a[100:103], v1 offset:576
    v_mfma_f32_16x16x32_bf16 v[200:203], a[208:211], v[32:35], v[200:203]
    v_exp_f32 v22, v22
    v_mfma_f32_16x16x32_bf16 v[200:203], a[212:215], v[36:39], v[200:203]
    ds_read_b128 a[104:107], v1 offset:640
    v_perm_b32 v42, v21, v20, s100
    v_mfma_f32_16x16x32_bf16 v[204:207], a[216:219], v[32:35], v[204:207]
    v_exp_f32 v23, v23
    v_mfma_f32_16x16x32_bf16 v[204:207], a[220:223], v[36:39], v[204:207]
    ds_read_b128 a[108:111], v1 offset:704
    v_mfma_f32_16x16x32_bf16 v[208:211], a[224:227], v[32:35], v[208:211]
    v_exp_f32 v24, v24
    v_mfma_f32_16x16x32_bf16 v[208:211], a[228:231], v[36:39], v[208:211]
    ds_read_b128 a[112:115], v1 offset:768
    v_perm_b32 v43, v23, v22, s100
    v_mfma_f32_16x16x32_bf16 v[212:215], a[232:235], v[32:35], v[212:215]
    v_exp_f32 v25, v25
    v_mfma_f32_16x16x32_bf16 v[212:215], a[236:239], v[36:39], v[212:215]
    ds_read_b128 a[116:119], v1 offset:832
    v_mfma_f32_16x16x32_bf16 v[216:219], a[240:243], v[32:35], v[216:219]
    v_exp_f32 v26, v26
    v_mfma_f32_16x16x32_bf16 v[216:219], a[244:247], v[36:39], v[216:219]
    ds_read_b128 a[120:123], v1 offset:896
    v_perm_b32 v44, v25, v24, s100
    v_mfma_f32_16x16x32_bf16 v[220:223], a[248:251], v[32:35], v[220:223]
    v_exp_f32 v27, v27
    v_mfma_f32_16x16x32_bf16 v[220:223], a[252:255], v[36:39], v[220:223]
    ds_read_b128 a[124:127], v1 offset:960
    v_smfmac_f32_16x16x64_bf16 a[8:11], a[16:19], v[32:39], v11
    s_waitcnt lgkmcnt(12)
    v_mfma_f32_16x16x32_bf16 v[16:19], a[64:67], v[64:67], v[48:51]
    v_exp_f32 v28, v28
    v_mfma_f32_16x16x32_bf16 v[16:19], a[68:71], v[68:71], v[16:19]
    v_perm_b32 v45, v27, v26, s100
    v_mfma_f32_16x16x32_bf16 v[16:19], a[72:75], v[72:75], v[16:19]
    v_exp_f32 v29, v29
    v_mfma_f32_16x16x32_bf16 v[16:19], a[76:79], v[76:79], v[16:19]
    s_waitcnt lgkmcnt(8)
    global_load_dword a63, v15, s[10:11]
    v_mfma_f32_16x16x32_bf16 v[20:23], a[80:83], v[64:67], v[48:51]
    v_exp_f32 v30, v30
    v_mfma_f32_16x16x32_bf16 v[20:23], a[84:87], v[68:71], v[20:23]
    v_perm_b32 v46, v29, v28, s100
    v_mfma_f32_16x16x32_bf16 v[20:23], a[88:91], v[72:75], v[20:23]
    v_exp_f32 v31, v31
    v_mfma_f32_16x16x32_bf16 v[20:23], a[92:95], v[76:79], v[20:23]
    s_waitcnt lgkmcnt(4)
    v_mfma_f32_16x16x32_bf16 v[24:27], a[96:99], v[64:67], v[48:51]
    v_exp_f32 v16, v16
    v_mfma_f32_16x16x32_bf16 v[24:27], a[100:103], v[68:71], v[24:27]
    v_perm_b32 v47, v31, v30, s100
    v_mfma_f32_16x16x32_bf16 v[24:27], a[104:107], v[72:75], v[24:27]
    v_exp_f32 v17, v17
    v_mfma_f32_16x16x32_bf16 v[24:27], a[108:111], v[76:79], v[24:27]
    s_waitcnt lgkmcnt(0)
    global_load_dword a63, v12, s[6:7]
    v_mfma_f32_16x16x32_bf16 v[28:31], a[112:115], v[64:67], v[48:51]
    v_exp_f32 v18, v18
    v_mfma_f32_16x16x32_bf16 v[28:31], a[116:119], v[68:71], v[28:31]
    v_perm_b32 v32, v17, v16, s100
    v_mfma_f32_16x16x32_bf16 v[28:31], a[120:123], v[72:75], v[28:31]
    v_exp_f32 v19, v19
    v_mfma_f32_16x16x32_bf16 v[28:31], a[124:127], v[76:79], v[28:31]
    v_mfma_f32_16x16x32_bf16 v[224:227], a[192:195], v[40:43], v[224:227]
    v_exp_f32 v20, v20
    v_mfma_f32_16x16x32_bf16 v[224:227], a[196:199], v[44:47], v[224:227]
    ds_read_b64_tr_b16 a[192:193], v2 offset:36864
    v_perm_b32 v33, v19, v18, s100
    v_mfma_f32_16x16x32_bf16 v[228:231], a[200:203], v[40:43], v[228:231]
    v_exp_f32 v21, v21
    v_mfma_f32_16x16x32_bf16 v[228:231], a[204:207], v[44:47], v[228:231]
    ds_read_b64_tr_b16 a[194:195], v2 offset:37120
    v_mfma_f32_16x16x32_bf16 v[232:235], a[208:211], v[40:43], v[232:235]
    v_exp_f32 v22, v22
    v_mfma_f32_16x16x32_bf16 v[232:235], a[212:215], v[44:47], v[232:235]
    ds_read_b64_tr_b16 a[196:197], v2 offset:37376
    v_perm_b32 v34, v21, v20, s100
    v_mfma_f32_16x16x32_bf16 v[236:239], a[216:219], v[40:43], v[236:239]
    v_exp_f32 v23, v23
    v_mfma_f32_16x16x32_bf16 v[236:239], a[220:223], v[44:47], v[236:239]
    ds_read_b64_tr_b16 a[198:199], v2 offset:37632
    v_mfma_f32_16x16x32_bf16 v[240:243], a[224:227], v[40:43], v[240:243]
    v_exp_f32 v24, v24
    v_mfma_f32_16x16x32_bf16 v[240:243], a[228:231], v[44:47], v[240:243]
    ds_read_b64_tr_b16 a[200:201], v2 offset:36896
    v_perm_b32 v35, v23, v22, s100
    v_mfma_f32_16x16x32_bf16 v[244:247], a[232:235], v[40:43], v[244:247]
    v_exp_f32 v25, v25
    v_mfma_f32_16x16x32_bf16 v[244:247], a[236:239], v[44:47], v[244:247]
    ds_read_b64_tr_b16 a[202:203], v2 offset:37152
    v_mfma_f32_16x16x32_bf16 v[248:251], a[240:243], v[40:43], v[248:251]
    v_exp_f32 v26, v26
    v_mfma_f32_16x16x32_bf16 v[248:251], a[244:247], v[44:47], v[248:251]
    ds_read_b64_tr_b16 a[204:205], v2 offset:37408
    v_perm_b32 v36, v25, v24, s100
    v_mfma_f32_16x16x32_bf16 v[252:255], a[248:251], v[40:43], v[252:255]
    v_exp_f32 v27, v27
    v_mfma_f32_16x16x32_bf16 v[252:255], a[252:255], v[44:47], v[252:255]
    ds_read_b64_tr_b16 a[206:207], v2 offset:37664
    v_smfmac_f32_16x16x64_bf16 a[12:15], a[16:19], v[40:47], v11
    ds_read_b64_tr_b16 a[208:209], v2 offset:36928
    v_mfma_f32_16x16x32_bf16 v[16:19], a[64:67], v[80:83], v[52:55]
    v_exp_f32 v28, v28
    v_mfma_f32_16x16x32_bf16 v[16:19], a[68:71], v[84:87], v[16:19]
    ds_read_b64_tr_b16 a[210:211], v2 offset:37184
    v_perm_b32 v37, v27, v26, s100
    v_mfma_f32_16x16x32_bf16 v[16:19], a[72:75], v[88:91], v[16:19]
    v_exp_f32 v29, v29
    v_mfma_f32_16x16x32_bf16 v[16:19], a[76:79], v[92:95], v[16:19]
    ds_read_b64_tr_b16 a[212:213], v2 offset:37440
    v_mfma_f32_16x16x32_bf16 v[20:23], a[80:83], v[80:83], v[52:55]
    v_exp_f32 v30, v30
    v_mfma_f32_16x16x32_bf16 v[20:23], a[84:87], v[84:87], v[20:23]
    ds_read_b64_tr_b16 a[214:215], v2 offset:37696
    v_perm_b32 v38, v29, v28, s100
    v_mfma_f32_16x16x32_bf16 v[20:23], a[88:91], v[88:91], v[20:23]
    v_exp_f32 v31, v31
    v_mfma_f32_16x16x32_bf16 v[20:23], a[92:95], v[92:95], v[20:23]
    ds_read_b64_tr_b16 a[216:217], v2 offset:36960
    v_mfma_f32_16x16x32_bf16 v[24:27], a[96:99], v[80:83], v[52:55]
    v_exp_f32 v16, v16
    v_mfma_f32_16x16x32_bf16 v[24:27], a[100:103], v[84:87], v[24:27]
    ds_read_b64_tr_b16 a[218:219], v2 offset:37216
    v_perm_b32 v39, v31, v30, s100
    v_mfma_f32_16x16x32_bf16 v[24:27], a[104:107], v[88:91], v[24:27]
    v_exp_f32 v17, v17
    v_mfma_f32_16x16x32_bf16 v[24:27], a[108:111], v[92:95], v[24:27]
    ds_read_b64_tr_b16 a[220:221], v2 offset:37472
    v_mfma_f32_16x16x32_bf16 v[28:31], a[112:115], v[80:83], v[52:55]
    v_exp_f32 v18, v18
    v_mfma_f32_16x16x32_bf16 v[28:31], a[116:119], v[84:87], v[28:31]
    ds_read_b64_tr_b16 a[222:223], v2 offset:37728
    v_perm_b32 v40, v17, v16, s100
    v_mfma_f32_16x16x32_bf16 v[28:31], a[120:123], v[88:91], v[28:31]
    v_exp_f32 v19, v19
    v_mfma_f32_16x16x32_bf16 v[28:31], a[124:127], v[92:95], v[28:31]
    ds_read_b64_tr_b16 a[224:225], v2 offset:36992
    v_mfma_f32_16x16x32_bf16 v[128:131], a[128:131], v[32:35], v[128:131]
    v_exp_f32 v20, v20
    v_mfma_f32_16x16x32_bf16 v[128:131], a[132:135], v[36:39], v[128:131]
    ds_read_b64_tr_b16 a[226:227], v2 offset:37248
    v_perm_b32 v41, v19, v18, s100
    v_mfma_f32_16x16x32_bf16 v[132:135], a[136:139], v[32:35], v[132:135]
    v_exp_f32 v21, v21
    v_mfma_f32_16x16x32_bf16 v[132:135], a[140:143], v[36:39], v[132:135]
    ds_read_b64_tr_b16 a[228:229], v2 offset:37504
    v_mfma_f32_16x16x32_bf16 v[136:139], a[144:147], v[32:35], v[136:139]
    v_exp_f32 v22, v22
    v_mfma_f32_16x16x32_bf16 v[136:139], a[148:151], v[36:39], v[136:139]
    ds_read_b64_tr_b16 a[230:231], v2 offset:37760
    v_perm_b32 v42, v21, v20, s100
    v_mfma_f32_16x16x32_bf16 v[140:143], a[152:155], v[32:35], v[140:143]
    v_exp_f32 v23, v23
    v_mfma_f32_16x16x32_bf16 v[140:143], a[156:159], v[36:39], v[140:143]
    ds_read_b64_tr_b16 a[232:233], v2 offset:37024
    v_mfma_f32_16x16x32_bf16 v[144:147], a[160:163], v[32:35], v[144:147]
    v_exp_f32 v24, v24
    v_mfma_f32_16x16x32_bf16 v[144:147], a[164:167], v[36:39], v[144:147]
    ds_read_b64_tr_b16 a[234:235], v2 offset:37280
    v_perm_b32 v43, v23, v22, s100
    v_mfma_f32_16x16x32_bf16 v[148:151], a[168:171], v[32:35], v[148:151]
    v_exp_f32 v25, v25
    v_mfma_f32_16x16x32_bf16 v[148:151], a[172:175], v[36:39], v[148:151]
    ds_read_b64_tr_b16 a[236:237], v2 offset:37536
    v_mfma_f32_16x16x32_bf16 v[152:155], a[176:179], v[32:35], v[152:155]
    v_exp_f32 v26, v26
    v_mfma_f32_16x16x32_bf16 v[152:155], a[180:183], v[36:39], v[152:155]
    ds_read_b64_tr_b16 a[238:239], v2 offset:37792
    v_perm_b32 v44, v25, v24, s100
    v_mfma_f32_16x16x32_bf16 v[156:159], a[184:187], v[32:35], v[156:159]
    v_exp_f32 v27, v27
    v_mfma_f32_16x16x32_bf16 v[156:159], a[188:191], v[36:39], v[156:159]
    ds_read_b64_tr_b16 a[240:241], v2 offset:37056
    v_smfmac_f32_16x16x64_bf16 a[0:3], a[16:19], v[32:39], v11
    ds_read_b64_tr_b16 a[242:243], v2 offset:37312
    v_mfma_f32_16x16x32_bf16 v[16:19], a[64:67], v[96:99], v[56:59]
    v_exp_f32 v28, v28
    v_mfma_f32_16x16x32_bf16 v[16:19], a[68:71], v[100:103], v[16:19]
    ds_read_b64_tr_b16 a[244:245], v2 offset:37568
    v_perm_b32 v45, v27, v26, s100
    v_mfma_f32_16x16x32_bf16 v[16:19], a[72:75], v[104:107], v[16:19]
    v_exp_f32 v29, v29
    v_mfma_f32_16x16x32_bf16 v[16:19], a[76:79], v[108:111], v[16:19]
    ds_read_b64_tr_b16 a[246:247], v2 offset:37824
    v_mfma_f32_16x16x32_bf16 v[20:23], a[80:83], v[96:99], v[56:59]
    v_exp_f32 v30, v30
    v_mfma_f32_16x16x32_bf16 v[20:23], a[84:87], v[100:103], v[20:23]
    ds_read_b64_tr_b16 a[248:249], v2 offset:37088
    v_perm_b32 v46, v29, v28, s100
    v_mfma_f32_16x16x32_bf16 v[20:23], a[88:91], v[104:107], v[20:23]
    v_exp_f32 v31, v31
    v_mfma_f32_16x16x32_bf16 v[20:23], a[92:95], v[108:111], v[20:23]
    ds_read_b64_tr_b16 a[250:251], v2 offset:37344
    v_mfma_f32_16x16x32_bf16 v[24:27], a[96:99], v[96:99], v[56:59]
    v_exp_f32 v16, v16
    v_mfma_f32_16x16x32_bf16 v[24:27], a[100:103], v[100:103], v[24:27]
    ds_read_b64_tr_b16 a[252:253], v2 offset:37600
    v_perm_b32 v47, v31, v30, s100
    v_mfma_f32_16x16x32_bf16 v[24:27], a[104:107], v[104:107], v[24:27]
    v_exp_f32 v17, v17
    v_mfma_f32_16x16x32_bf16 v[24:27], a[108:111], v[108:111], v[24:27]
    ds_read_b64_tr_b16 a[254:255], v2 offset:37856
    v_mfma_f32_16x16x32_bf16 v[28:31], a[112:115], v[96:99], v[56:59]
    v_exp_f32 v18, v18
    v_mfma_f32_16x16x32_bf16 v[28:31], a[116:119], v[100:103], v[28:31]
    v_perm_b32 v32, v17, v16, s100
    v_mfma_f32_16x16x32_bf16 v[28:31], a[120:123], v[104:107], v[28:31]
    v_exp_f32 v19, v19
    v_mfma_f32_16x16x32_bf16 v[28:31], a[124:127], v[108:111], v[28:31]
    v_mfma_f32_16x16x32_bf16 v[160:163], a[128:131], v[40:43], v[160:163]
    v_exp_f32 v20, v20
    v_mfma_f32_16x16x32_bf16 v[160:163], a[132:135], v[44:47], v[160:163]
    v_perm_b32 v33, v19, v18, s100
    v_mfma_f32_16x16x32_bf16 v[164:167], a[136:139], v[40:43], v[164:167]
    v_exp_f32 v21, v21
    v_mfma_f32_16x16x32_bf16 v[164:167], a[140:143], v[44:47], v[164:167]
    v_mfma_f32_16x16x32_bf16 v[168:171], a[144:147], v[40:43], v[168:171]
    v_exp_f32 v22, v22
    v_mfma_f32_16x16x32_bf16 v[168:171], a[148:151], v[44:47], v[168:171]
    v_perm_b32 v34, v21, v20, s100
    v_mfma_f32_16x16x32_bf16 v[172:175], a[152:155], v[40:43], v[172:175]
    v_exp_f32 v23, v23
    v_mfma_f32_16x16x32_bf16 v[172:175], a[156:159], v[44:47], v[172:175]
    v_mfma_f32_16x16x32_bf16 v[176:179], a[160:163], v[40:43], v[176:179]
    v_exp_f32 v24, v24
    v_mfma_f32_16x16x32_bf16 v[176:179], a[164:167], v[44:47], v[176:179]
    v_perm_b32 v35, v23, v22, s100
    v_mfma_f32_16x16x32_bf16 v[180:183], a[168:171], v[40:43], v[180:183]
    v_exp_f32 v25, v25
    v_mfma_f32_16x16x32_bf16 v[180:183], a[172:175], v[44:47], v[180:183]
    v_mfma_f32_16x16x32_bf16 v[184:187], a[176:179], v[40:43], v[184:187]
    v_exp_f32 v26, v26
    v_mfma_f32_16x16x32_bf16 v[184:187], a[180:183], v[44:47], v[184:187]
    v_perm_b32 v36, v25, v24, s100
    v_mfma_f32_16x16x32_bf16 v[188:191], a[184:187], v[40:43], v[188:191]
    v_exp_f32 v27, v27
    v_mfma_f32_16x16x32_bf16 v[188:191], a[188:191], v[44:47], v[188:191]
    v_smfmac_f32_16x16x64_bf16 a[4:7], a[16:19], v[40:47], v11
    v_mfma_f32_16x16x32_bf16 v[16:19], a[64:67], v[112:115], v[60:63]
    v_exp_f32 v28, v28
    v_mfma_f32_16x16x32_bf16 v[16:19], a[68:71], v[116:119], v[16:19]
    ds_read_b128 a[64:67], v1 offset:36864
    v_perm_b32 v37, v27, v26, s100
    v_mfma_f32_16x16x32_bf16 v[16:19], a[72:75], v[120:123], v[16:19]
    v_exp_f32 v29, v29
    v_mfma_f32_16x16x32_bf16 v[16:19], a[76:79], v[124:127], v[16:19]
    ds_read_b128 a[68:71], v1 offset:36928
    v_mfma_f32_16x16x32_bf16 v[20:23], a[80:83], v[112:115], v[60:63]
    v_exp_f32 v30, v30
    v_mfma_f32_16x16x32_bf16 v[20:23], a[84:87], v[116:119], v[20:23]
    ds_read_b128 a[72:75], v1 offset:36992
    v_perm_b32 v38, v29, v28, s100
    v_mfma_f32_16x16x32_bf16 v[20:23], a[88:91], v[120:123], v[20:23]
    v_exp_f32 v31, v31
    v_mfma_f32_16x16x32_bf16 v[20:23], a[92:95], v[124:127], v[20:23]
    ds_read_b128 a[76:79], v1 offset:37056
    v_mfma_f32_16x16x32_bf16 v[24:27], a[96:99], v[112:115], v[60:63]
    v_exp_f32 v16, v16
    v_mfma_f32_16x16x32_bf16 v[24:27], a[100:103], v[116:119], v[24:27]
    ds_read_b128 a[80:83], v1 offset:37120
    v_perm_b32 v39, v31, v30, s100
    v_mfma_f32_16x16x32_bf16 v[24:27], a[104:107], v[120:123], v[24:27]
    v_exp_f32 v17, v17
    v_mfma_f32_16x16x32_bf16 v[24:27], a[108:111], v[124:127], v[24:27]
    ds_read_b128 a[84:87], v1 offset:37184
    v_mfma_f32_16x16x32_bf16 v[28:31], a[112:115], v[112:115], v[60:63]
L2_pad7:
    s_cbranch_execz L2_pad11
    v_exp_f32 v18, v18
    v_mfma_f32_16x16x32_bf16 v[28:31], a[116:119], v[116:119], v[28:31]
    ds_read_b128 a[88:91], v1 offset:37248
    v_perm_b32 v40, v17, v16, s100
    v_mfma_f32_16x16x32_bf16 v[28:31], a[120:123], v[120:123], v[28:31]
    v_exp_f32 v19, v19
    v_mfma_f32_16x16x32_bf16 v[28:31], a[124:127], v[124:127], v[28:31]
    ds_read_b128 a[92:95], v1 offset:37312
    v_mfma_f32_16x16x32_bf16 v[192:195], a[128:131], v[32:35], v[192:195]
    v_exp_f32 v20, v20
    v_mfma_f32_16x16x32_bf16 v[192:195], a[132:135], v[36:39], v[192:195]
    ds_read_b128 a[96:99], v1 offset:37376
    v_perm_b32 v41, v19, v18, s100
    v_mfma_f32_16x16x32_bf16 v[196:199], a[136:139], v[32:35], v[196:199]
    v_exp_f32 v21, v21
    v_mfma_f32_16x16x32_bf16 v[196:199], a[140:143], v[36:39], v[196:199]
    ds_read_b128 a[100:103], v1 offset:37440
    v_mfma_f32_16x16x32_bf16 v[200:203], a[144:147], v[32:35], v[200:203]
    v_exp_f32 v22, v22
    v_mfma_f32_16x16x32_bf16 v[200:203], a[148:151], v[36:39], v[200:203]
    ds_read_b128 a[104:107], v1 offset:37504
    v_perm_b32 v42, v21, v20, s100
    v_mfma_f32_16x16x32_bf16 v[204:207], a[152:155], v[32:35], v[204:207]
    v_exp_f32 v23, v23
    v_mfma_f32_16x16x32_bf16 v[204:207], a[156:159], v[36:39], v[204:207]
    ds_read_b128 a[108:111], v1 offset:37568
    v_mfma_f32_16x16x32_bf16 v[208:211], a[160:163], v[32:35], v[208:211]
    v_exp_f32 v24, v24
    v_mfma_f32_16x16x32_bf16 v[208:211], a[164:167], v[36:39], v[208:211]
    ds_read_b128 a[112:115], v1 offset:37632
    v_perm_b32 v43, v23, v22, s100
    v_mfma_f32_16x16x32_bf16 v[212:215], a[168:171], v[32:35], v[212:215]
    v_exp_f32 v25, v25
    v_mfma_f32_16x16x32_bf16 v[212:215], a[172:175], v[36:39], v[212:215]
    ds_read_b128 a[116:119], v1 offset:37696
    v_mfma_f32_16x16x32_bf16 v[216:219], a[176:179], v[32:35], v[216:219]
    v_exp_f32 v26, v26
    v_mfma_f32_16x16x32_bf16 v[216:219], a[180:183], v[36:39], v[216:219]
    ds_read_b128 a[120:123], v1 offset:37760
    v_perm_b32 v44, v25, v24, s100
    v_mfma_f32_16x16x32_bf16 v[220:223], a[184:187], v[32:35], v[220:223]
    v_exp_f32 v27, v27
    v_mfma_f32_16x16x32_bf16 v[220:223], a[188:191], v[36:39], v[220:223]
    ds_read_b128 a[124:127], v1 offset:37824
    v_smfmac_f32_16x16x64_bf16 a[8:11], a[16:19], v[32:39], v11
    s_waitcnt lgkmcnt(12)
    v_mfma_f32_16x16x32_bf16 v[16:19], a[64:67], v[64:67], v[48:51]
    s_sub_u32 s47, s47, s48
    v_exp_f32 v28, v28
    v_mfma_f32_16x16x32_bf16 v[16:19], a[68:71], v[68:71], v[16:19]
    v_perm_b32 v45, v27, v26, s100
    v_add_u32 v1, s48, v1
    v_mfma_f32_16x16x32_bf16 v[16:19], a[72:75], v[72:75], v[16:19]
    v_exp_f32 v29, v29
    v_mfma_f32_16x16x32_bf16 v[16:19], a[76:79], v[76:79], v[16:19]
    s_waitcnt lgkmcnt(8)
    v_mfma_f32_16x16x32_bf16 v[20:23], a[80:83], v[64:67], v[48:51]
    v_exp_f32 v30, v30
    v_mfma_f32_16x16x32_bf16 v[20:23], a[84:87], v[68:71], v[20:23]
    v_perm_b32 v46, v29, v28, s100
    v_add_u32 v2, s48, v2
    v_mfma_f32_16x16x32_bf16 v[20:23], a[88:91], v[72:75], v[20:23]
    v_exp_f32 v31, v31
    v_mfma_f32_16x16x32_bf16 v[20:23], a[92:95], v[76:79], v[20:23]
    s_waitcnt lgkmcnt(4)
    v_mfma_f32_16x16x32_bf16 v[24:27], a[96:99], v[64:67], v[48:51]
    s_sub_u32 s48, 0, s48
    v_exp_f32 v16, v16
    v_mfma_f32_16x16x32_bf16 v[24:27], a[100:103], v[68:71], v[24:27]
    v_perm_b32 v47, v31, v30, s100
    v_mfma_f32_16x16x32_bf16 v[24:27], a[104:107], v[72:75], v[24:27]
    v_exp_f32 v17, v17
    v_mfma_f32_16x16x32_bf16 v[24:27], a[108:111], v[76:79], v[24:27]
    s_waitcnt lgkmcnt(0)
    v_mfma_f32_16x16x32_bf16 v[28:31], a[112:115], v[64:67], v[48:51]
    v_exp_f32 v18, v18
    v_mfma_f32_16x16x32_bf16 v[28:31], a[116:119], v[68:71], v[28:31]
    v_perm_b32 v32, v17, v16, s100
    v_mfma_f32_16x16x32_bf16 v[28:31], a[120:123], v[72:75], v[28:31]
    v_exp_f32 v19, v19
    v_mfma_f32_16x16x32_bf16 v[28:31], a[124:127], v[76:79], v[28:31]
    s_waitcnt vmcnt(2)
    s_barrier
    v_mfma_f32_16x16x32_bf16 v[224:227], a[128:131], v[40:43], v[224:227]
    v_exp_f32 v20, v20
    v_mfma_f32_16x16x32_bf16 v[224:227], a[132:135], v[44:47], v[224:227]
    ds_read_b64_tr_b16 a[128:129], v2 offset:0
    v_perm_b32 v33, v19, v18, s100
    v_mfma_f32_16x16x32_bf16 v[228:231], a[136:139], v[40:43], v[228:231]
    s_add_u32 m0, s47, 0
    v_exp_f32 v21, v21
    v_mfma_f32_16x16x32_bf16 v[228:231], a[140:143], v[44:47], v[228:231]
    s_add_u32 s46, s46, 16384
    buffer_load_dwordx4 off, s[16:19], s46 offset:0 lds
    v_mfma_f32_16x16x32_bf16 v[232:235], a[144:147], v[40:43], v[232:235]
    v_exp_f32 v22, v22
    v_mfma_f32_16x16x32_bf16 v[232:235], a[148:151], v[44:47], v[232:235]
    ds_read_b64_tr_b16 a[130:131], v2 offset:256
    v_perm_b32 v34, v21, v20, s100
    v_mfma_f32_16x16x32_bf16 v[236:239], a[152:155], v[40:43], v[236:239]
    s_add_u32 m0, s47, 32
    v_exp_f32 v23, v23
    v_mfma_f32_16x16x32_bf16 v[236:239], a[156:159], v[44:47], v[236:239]
    buffer_load_dwordx4 off, s[16:19], s46 offset:1024 lds
    v_mfma_f32_16x16x32_bf16 v[240:243], a[160:163], v[40:43], v[240:243]
    v_exp_f32 v24, v24
    v_mfma_f32_16x16x32_bf16 v[240:243], a[164:167], v[44:47], v[240:243]
    ds_read_b64_tr_b16 a[132:133], v2 offset:512
    v_perm_b32 v35, v23, v22, s100
    v_mfma_f32_16x16x32_bf16 v[244:247], a[168:171], v[40:43], v[244:247]
    s_add_u32 m0, s47, 64
    v_exp_f32 v25, v25
    v_mfma_f32_16x16x32_bf16 v[244:247], a[172:175], v[44:47], v[244:247]
    buffer_load_dwordx4 off, s[16:19], s46 offset:2048 lds
    v_mfma_f32_16x16x32_bf16 v[248:251], a[176:179], v[40:43], v[248:251]
    v_exp_f32 v26, v26
    v_mfma_f32_16x16x32_bf16 v[248:251], a[180:183], v[44:47], v[248:251]
    ds_read_b64_tr_b16 a[134:135], v2 offset:768
    v_perm_b32 v36, v25, v24, s100
    v_mfma_f32_16x16x32_bf16 v[252:255], a[184:187], v[40:43], v[252:255]
    s_add_u32 m0, s47, 96
    v_exp_f32 v27, v27
    v_mfma_f32_16x16x32_bf16 v[252:255], a[188:191], v[44:47], v[252:255]
    buffer_load_dwordx4 off, s[16:19], s46 offset:3072 lds
    v_smfmac_f32_16x16x64_bf16 a[12:15], a[16:19], v[40:47], v11
    ds_read_b64_tr_b16 a[136:137], v2 offset:32
    v_mfma_f32_16x16x32_bf16 v[16:19], a[64:67], v[80:83], v[52:55]
    v_exp_f32 v28, v28
    v_mfma_f32_16x16x32_bf16 v[16:19], a[68:71], v[84:87], v[16:19]
    ds_read_b64_tr_b16 a[138:139], v2 offset:288
    v_perm_b32 v37, v27, v26, s100
    v_mfma_f32_16x16x32_bf16 v[16:19], a[72:75], v[88:91], v[16:19]
    s_add_u32 m0, s47, 16896
    v_exp_f32 v29, v29
    v_mfma_f32_16x16x32_bf16 v[16:19], a[76:79], v[92:95], v[16:19]
    buffer_load_dwordx4 off, s[20:23], s46 offset:0 lds
    v_mfma_f32_16x16x32_bf16 v[20:23], a[80:83], v[80:83], v[52:55]
    v_exp_f32 v30, v30
    v_mfma_f32_16x16x32_bf16 v[20:23], a[84:87], v[84:87], v[20:23]
    ds_read_b64_tr_b16 a[140:141], v2 offset:544
    v_perm_b32 v38, v29, v28, s100
    v_mfma_f32_16x16x32_bf16 v[20:23], a[88:91], v[88:91], v[20:23]
    s_add_u32 m0, s47, 16928
    v_exp_f32 v31, v31
    v_mfma_f32_16x16x32_bf16 v[20:23], a[92:95], v[92:95], v[20:23]
    buffer_load_dwordx4 off, s[20:23], s46 offset:1024 lds
    v_mfma_f32_16x16x32_bf16 v[24:27], a[96:99], v[80:83], v[52:55]
    v_exp_f32 v16, v16
    v_mfma_f32_16x16x32_bf16 v[24:27], a[100:103], v[84:87], v[24:27]
    ds_read_b64_tr_b16 a[142:143], v2 offset:800
    v_perm_b32 v39, v31, v30, s100
    v_mfma_f32_16x16x32_bf16 v[24:27], a[104:107], v[88:91], v[24:27]
    s_add_u32 m0, s47, 16960
    v_exp_f32 v17, v17
    v_mfma_f32_16x16x32_bf16 v[24:27], a[108:111], v[92:95], v[24:27]
    buffer_load_dwordx4 off, s[20:23], s46 offset:2048 lds
    v_mfma_f32_16x16x32_bf16 v[28:31], a[112:115], v[80:83], v[52:55]
    v_exp_f32 v18, v18
    v_mfma_f32_16x16x32_bf16 v[28:31], a[116:119], v[84:87], v[28:31]
    ds_read_b64_tr_b16 a[144:145], v2 offset:64
    v_perm_b32 v40, v17, v16, s100
    v_mfma_f32_16x16x32_bf16 v[28:31], a[120:123], v[88:91], v[28:31]
    s_add_u32 m0, s47, 16992
    v_exp_f32 v19, v19
    v_mfma_f32_16x16x32_bf16 v[28:31], a[124:127], v[92:95], v[28:31]
    buffer_load_dwordx4 off, s[20:23], s46 offset:3072 lds
    v_mfma_f32_16x16x32_bf16 v[128:131], a[192:195], v[32:35], v[128:131]
    v_exp_f32 v20, v20
    v_mfma_f32_16x16x32_bf16 v[128:131], a[196:199], v[36:39], v[128:131]
    ds_read_b64_tr_b16 a[146:147], v2 offset:320
    v_perm_b32 v41, v19, v18, s100
    v_mfma_f32_16x16x32_bf16 v[132:135], a[200:203], v[32:35], v[132:135]
    v_exp_f32 v21, v21
    v_mfma_f32_16x16x32_bf16 v[132:135], a[204:207], v[36:39], v[132:135]
    ds_read_b64_tr_b16 a[148:149], v2 offset:576
    v_mfma_f32_16x16x32_bf16 v[136:139], a[208:211], v[32:35], v[136:139]
    v_exp_f32 v22, v22
    v_mfma_f32_16x16x32_bf16 v[136:139], a[212:215], v[36:39], v[136:139]
    ds_read_b64_tr_b16 a[150:151], v2 offset:832
    v_perm_b32 v42, v21, v20, s100
    v_mfma_f32_16x16x32_bf16 v[140:143], a[216:219], v[32:35], v[140:143]
    v_exp_f32 v23, v23
    v_mfma_f32_16x16x32_bf16 v[140:143], a[220:223], v[36:39], v[140:143]
    ds_read_b64_tr_b16 a[152:153], v2 offset:96
    ds_read_b64_tr_b16 a[154:155], v2 offset:352
    v_mfma_f32_16x16x32_bf16 v[144:147], a[224:227], v[32:35], v[144:147]
    v_exp_f32 v24, v24
    v_mfma_f32_16x16x32_bf16 v[144:147], a[228:231], v[36:39], v[144:147]
    ds_read_b64_tr_b16 a[156:157], v2 offset:608
    v_perm_b32 v43, v23, v22, s100
    v_mfma_f32_16x16x32_bf16 v[148:151], a[232:235], v[32:35], v[148:151]
    v_exp_f32 v25, v25
    v_mfma_f32_16x16x32_bf16 v[148:151], a[236:239], v[36:39], v[148:151]
    ds_read_b64_tr_b16 a[158:159], v2 offset:864
    ds_read_b64_tr_b16 a[160:161], v2 offset:128
    v_mfma_f32_16x16x32_bf16 v[152:155], a[240:243], v[32:35], v[152:155]
    v_exp_f32 v26, v26
    v_mfma_f32_16x16x32_bf16 v[152:155], a[244:247], v[36:39], v[152:155]
    ds_read_b64_tr_b16 a[162:163], v2 offset:384
    v_perm_b32 v44, v25, v24, s100
    v_mfma_f32_16x16x32_bf16 v[156:159], a[248:251], v[32:35], v[156:159]
    v_exp_f32 v27, v27
    v_mfma_f32_16x16x32_bf16 v[156:159], a[252:255], v[36:39], v[156:159]
    ds_read_b64_tr_b16 a[164:165], v2 offset:640
    ds_read_b64_tr_b16 a[166:167], v2 offset:896
    v_smfmac_f32_16x16x64_bf16 a[0:3], a[16:19], v[32:39], v11
    ds_read_b64_tr_b16 a[168:169], v2 offset:160
    ds_read_b64_tr_b16 a[170:171], v2 offset:416
    v_mfma_f32_16x16x32_bf16 v[16:19], a[64:67], v[96:99], v[56:59]
    v_exp_f32 v28, v28
    v_mfma_f32_16x16x32_bf16 v[16:19], a[68:71], v[100:103], v[16:19]
    ds_read_b64_tr_b16 a[172:173], v2 offset:672
    v_perm_b32 v45, v27, v26, s100
    v_mfma_f32_16x16x32_bf16 v[16:19], a[72:75], v[104:107], v[16:19]
    s_add_u32 m0, s47, 36864
    v_exp_f32 v29, v29
    v_mfma_f32_16x16x32_bf16 v[16:19], a[76:79], v[108:111], v[16:19]
    s_add_u32 s46, s46, 16384
    buffer_load_dwordx4 off, s[16:19], s46 offset:0 lds
    v_mfma_f32_16x16x32_bf16 v[20:23], a[80:83], v[96:99], v[56:59]
    v_exp_f32 v30, v30
    v_mfma_f32_16x16x32_bf16 v[20:23], a[84:87], v[100:103], v[20:23]
    ds_read_b64_tr_b16 a[174:175], v2 offset:928
    v_perm_b32 v46, v29, v28, s100
    v_mfma_f32_16x16x32_bf16 v[20:23], a[88:91], v[104:107], v[20:23]
    s_add_u32 m0, s47, 36896
    v_exp_f32 v31, v31
    v_mfma_f32_16x16x32_bf16 v[20:23], a[92:95], v[108:111], v[20:23]
    buffer_load_dwordx4 off, s[16:19], s46 offset:1024 lds
    v_mfma_f32_16x16x32_bf16 v[24:27], a[96:99], v[96:99], v[56:59]
    v_exp_f32 v16, v16
    v_mfma_f32_16x16x32_bf16 v[24:27], a[100:103], v[100:103], v[24:27]
    ds_read_b64_tr_b16 a[176:177], v2 offset:192
    v_perm_b32 v47, v31, v30, s100
    v_mfma_f32_16x16x32_bf16 v[24:27], a[104:107], v[104:107], v[24:27]
    s_add_u32 m0, s47, 36928
    v_exp_f32 v17, v17
    v_mfma_f32_16x16x32_bf16 v[24:27], a[108:111], v[108:111], v[24:27]
    buffer_load_dwordx4 off, s[16:19], s46 offset:2048 lds
    v_mfma_f32_16x16x32_bf16 v[28:31], a[112:115], v[96:99], v[56:59]
    v_exp_f32 v18, v18
    v_mfma_f32_16x16x32_bf16 v[28:31], a[116:119], v[100:103], v[28:31]
    ds_read_b64_tr_b16 a[178:179], v2 offset:448
    v_perm_b32 v32, v17, v16, s100
    v_mfma_f32_16x16x32_bf16 v[28:31], a[120:123], v[104:107], v[28:31]
    s_add_u32 m0, s47, 36960
    v_exp_f32 v19, v19
    v_mfma_f32_16x16x32_bf16 v[28:31], a[124:127], v[108:111], v[28:31]
    buffer_load_dwordx4 off, s[16:19], s46 offset:3072 lds
    v_mfma_f32_16x16x32_bf16 v[160:163], a[192:195], v[40:43], v[160:163]
    v_exp_f32 v20, v20
    v_mfma_f32_16x16x32_bf16 v[160:163], a[196:199], v[44:47], v[160:163]
    ds_read_b64_tr_b16 a[180:181], v2 offset:704
    v_perm_b32 v33, v19, v18, s100
    v_mfma_f32_16x16x32_bf16 v[164:167], a[200:203], v[40:43], v[164:167]
    s_add_u32 m0, s47, 53760
    v_exp_f32 v21, v21
    v_mfma_f32_16x16x32_bf16 v[164:167], a[204:207], v[44:47], v[164:167]
    buffer_load_dwordx4 off, s[20:23], s46 offset:0 lds
    v_mfma_f32_16x16x32_bf16 v[168:171], a[208:211], v[40:43], v[168:171]
    v_exp_f32 v22, v22
    v_mfma_f32_16x16x32_bf16 v[168:171], a[212:215], v[44:47], v[168:171]
    ds_read_b64_tr_b16 a[182:183], v2 offset:960
    v_perm_b32 v34, v21, v20, s100
    v_mfma_f32_16x16x32_bf16 v[172:175], a[216:219], v[40:43], v[172:175]
    s_add_u32 m0, s47, 53792
    v_exp_f32 v23, v23
    v_mfma_f32_16x16x32_bf16 v[172:175], a[220:223], v[44:47], v[172:175]
    buffer_load_dwordx4 off, s[20:23], s46 offset:1024 lds
    v_mfma_f32_16x16x32_bf16 v[176:179], a[224:227], v[40:43], v[176:179]
    v_exp_f32 v24, v24
    v_mfma_f32_16x16x32_bf16 v[176:179], a[228:231], v[44:47], v[176:179]
    ds_read_b64_tr_b16 a[184:185], v2 offset:224
    v_perm_b32 v35, v23, v22, s100
    v_mfma_f32_16x16x32_bf16 v[180:183], a[232:235], v[40:43], v[180:183]
    s_add_u32 m0, s47, 53824
    v_exp_f32 v25, v25
    v_mfma_f32_16x16x32_bf16 v[180:183], a[236:239], v[44:47], v[180:183]
    buffer_load_dwordx4 off, s[20:23], s46 offset:2048 lds
    v_mfma_f32_16x16x32_bf16 v[184:187], a[240:243], v[40:43], v[184:187]
    v_exp_f32 v26, v26
    v_mfma_f32_16x16x32_bf16 v[184:187], a[244:247], v[44:47], v[184:187]
    ds_read_b64_tr_b16 a[186:187], v2 offset:480
    v_perm_b32 v36, v25, v24, s100
    v_mfma_f32_16x16x32_bf16 v[188:191], a[248:251], v[40:43], v[188:191]
    s_add_u32 m0, s47, 53856
    v_exp_f32 v27, v27
    v_mfma_f32_16x16x32_bf16 v[188:191], a[252:255], v[44:47], v[188:191]
    buffer_load_dwordx4 off, s[20:23], s46 offset:3072 lds
    v_smfmac_f32_16x16x64_bf16 a[4:7], a[16:19], v[40:47], v11
    ds_read_b64_tr_b16 a[188:189], v2 offset:736
    ds_read_b64_tr_b16 a[190:191], v2 offset:992
    v_mfma_f32_16x16x32_bf16 v[16:19], a[64:67], v[112:115], v[60:63]
    v_exp_f32 v28, v28
    v_mfma_f32_16x16x32_bf16 v[16:19], a[68:71], v[116:119], v[16:19]
    ds_read_b128 a[64:67], v1 offset:0
    v_perm_b32 v37, v27, v26, s100
    v_mfma_f32_16x16x32_bf16 v[16:19], a[72:75], v[120:123], v[16:19]
    v_exp_f32 v29, v29
    v_mfma_f32_16x16x32_bf16 v[16:19], a[76:79], v[124:127], v[16:19]
    ds_read_b128 a[68:71], v1 offset:64
    v_mfma_f32_16x16x32_bf16 v[20:23], a[80:83], v[112:115], v[60:63]
    v_exp_f32 v30, v30
    v_mfma_f32_16x16x32_bf16 v[20:23], a[84:87], v[116:119], v[20:23]
    ds_read_b128 a[72:75], v1 offset:128
    v_perm_b32 v38, v29, v28, s100
    v_mfma_f32_16x16x32_bf16 v[20:23], a[88:91], v[120:123], v[20:23]
    v_exp_f32 v31, v31
    v_mfma_f32_16x16x32_bf16 v[20:23], a[92:95], v[124:127], v[20:23]
    ds_read_b128 a[76:79], v1 offset:192
    v_mfma_f32_16x16x32_bf16 v[24:27], a[96:99], v[112:115], v[60:63]
    v_exp_f32 v16, v16
    v_mfma_f32_16x16x32_bf16 v[24:27], a[100:103], v[116:119], v[24:27]
    ds_read_b128 a[80:83], v1 offset:256
    v_perm_b32 v39, v31, v30, s100
    v_mfma_f32_16x16x32_bf16 v[24:27], a[104:107], v[120:123], v[24:27]
    v_exp_f32 v17, v17
    v_mfma_f32_16x16x32_bf16 v[24:27], a[108:111], v[124:127], v[24:27]
    ds_read_b128 a[84:87], v1 offset:320
    v_mfma_f32_16x16x32_bf16 v[28:31], a[112:115], v[112:115], v[60:63]
    v_exp_f32 v18, v18
    v_mfma_f32_16x16x32_bf16 v[28:31], a[116:119], v[116:119], v[28:31]
    ds_read_b128 a[88:91], v1 offset:384
    v_perm_b32 v40, v17, v16, s100
    v_mfma_f32_16x16x32_bf16 v[28:31], a[120:123], v[120:123], v[28:31]
    v_exp_f32 v19, v19
    v_mfma_f32_16x16x32_bf16 v[28:31], a[124:127], v[124:127], v[28:31]
    ds_read_b128 a[92:95], v1 offset:448
    v_mfma_f32_16x16x32_bf16 v[192:195], a[192:195], v[32:35], v[192:195]
    v_exp_f32 v20, v20
    v_mfma_f32_16x16x32_bf16 v[192:195], a[196:199], v[36:39], v[192:195]
    ds_read_b128 a[96:99], v1 offset:512
    v_perm_b32 v41, v19, v18, s100
    v_mfma_f32_16x16x32_bf16 v[196:199], a[200:203], v[32:35], v[196:199]
    v_exp_f32 v21, v21
    v_mfma_f32_16x16x32_bf16 v[196:199], a[204:207], v[36:39], v[196:199]
    ds_read_b128 a[100:103], v1 offset:576
    v_mfma_f32_16x16x32_bf16 v[200:203], a[208:211], v[32:35], v[200:203]
    v_exp_f32 v22, v22
    v_mfma_f32_16x16x32_bf16 v[200:203], a[212:215], v[36:39], v[200:203]
    ds_read_b128 a[104:107], v1 offset:640
    v_perm_b32 v42, v21, v20, s100
    v_mfma_f32_16x16x32_bf16 v[204:207], a[216:219], v[32:35], v[204:207]
    v_exp_f32 v23, v23
    v_mfma_f32_16x16x32_bf16 v[204:207], a[220:223], v[36:39], v[204:207]
    ds_read_b128 a[108:111], v1 offset:704
    v_mfma_f32_16x16x32_bf16 v[208:211], a[224:227], v[32:35], v[208:211]
    v_exp_f32 v24, v24
    v_mfma_f32_16x16x32_bf16 v[208:211], a[228:231], v[36:39], v[208:211]
    ds_read_b128 a[112:115], v1 offset:768
    v_perm_b32 v43, v23, v22, s100
    v_mfma_f32_16x16x32_bf16 v[212:215], a[232:235], v[32:35], v[212:215]
    v_exp_f32 v25, v25
    v_mfma_f32_16x16x32_bf16 v[212:215], a[236:239], v[36:39], v[212:215]
    ds_read_b128 a[116:119], v1 offset:832
    v_mfma_f32_16x16x32_bf16 v[216:219], a[240:243], v[32:35], v[216:219]
    v_exp_f32 v26, v26
    v_mfma_f32_16x16x32_bf16 v[216:219], a[244:247], v[36:39], v[216:219]
    ds_read_b128 a[120:123], v1 offset:896
    v_perm_b32 v44, v25, v24, s100
    v_mfma_f32_16x16x32_bf16 v[220:223], a[248:251], v[32:35], v[220:223]
    v_exp_f32 v27, v27
    v_mfma_f32_16x16x32_bf16 v[220:223], a[252:255], v[36:39], v[220:223]
    ds_read_b128 a[124:127], v1 offset:960
    v_smfmac_f32_16x16x64_bf16 a[8:11], a[16:19], v[32:39], v11
    s_waitcnt lgkmcnt(12)
    v_mfma_f32_16x16x32_bf16 v[16:19], a[64:67], v[64:67], v[48:51]
    v_exp_f32 v28, v28
    v_mfma_f32_16x16x32_bf16 v[16:19], a[68:71], v[68:71], v[16:19]
    v_perm_b32 v45, v27, v26, s100
    v_mfma_f32_16x16x32_bf16 v[16:19], a[72:75], v[72:75], v[16:19]
    v_exp_f32 v29, v29
    v_mfma_f32_16x16x32_bf16 v[16:19], a[76:79], v[76:79], v[16:19]
    s_waitcnt lgkmcnt(8)
    global_load_dword a63, v13, s[8:9]
    v_mfma_f32_16x16x32_bf16 v[20:23], a[80:83], v[64:67], v[48:51]
    v_exp_f32 v30, v30
    v_mfma_f32_16x16x32_bf16 v[20:23], a[84:87], v[68:71], v[20:23]
    v_perm_b32 v46, v29, v28, s100
    v_mfma_f32_16x16x32_bf16 v[20:23], a[88:91], v[72:75], v[20:23]
    v_exp_f32 v31, v31
    v_mfma_f32_16x16x32_bf16 v[20:23], a[92:95], v[76:79], v[20:23]
    s_waitcnt lgkmcnt(4)
    v_mfma_f32_16x16x32_bf16 v[24:27], a[96:99], v[64:67], v[48:51]
    v_exp_f32 v16, v16
    v_mfma_f32_16x16x32_bf16 v[24:27], a[100:103], v[68:71], v[24:27]
    v_perm_b32 v47, v31, v30, s100
    v_mfma_f32_16x16x32_bf16 v[24:27], a[104:107], v[72:75], v[24:27]
    v_exp_f32 v17, v17
    v_mfma_f32_16x16x32_bf16 v[24:27], a[108:111], v[76:79], v[24:27]
    s_waitcnt lgkmcnt(0)
    buffer_load_dword a63, v9, s[36:39], 0 offen
    v_mfma_f32_16x16x32_bf16 v[28:31], a[112:115], v[64:67], v[48:51]
    v_exp_f32 v18, v18
    v_mfma_f32_16x16x32_bf16 v[28:31], a[116:119], v[68:71], v[28:31]
    v_perm_b32 v32, v17, v16, s100
    v_mfma_f32_16x16x32_bf16 v[28:31], a[120:123], v[72:75], v[28:31]
    v_exp_f32 v19, v19
    v_mfma_f32_16x16x32_bf16 v[28:31], a[124:127], v[76:79], v[28:31]
    v_mfma_f32_16x16x32_bf16 v[224:227], a[192:195], v[40:43], v[224:227]
    v_exp_f32 v20, v20
    v_mfma_f32_16x16x32_bf16 v[224:227], a[196:199], v[44:47], v[224:227]
    ds_read_b64_tr_b16 a[192:193], v2 offset:36864
    v_perm_b32 v33, v19, v18, s100
    v_mfma_f32_16x16x32_bf16 v[228:231], a[200:203], v[40:43], v[228:231]
    s_mov_b32 s54, 0
    v_exp_f32 v21, v21
    v_mfma_f32_16x16x32_bf16 v[228:231], a[204:207], v[44:47], v[228:231]
    buffer_load_dwordx4 a[20:23], v6, s[64:67], s54 offen
    v_mfma_f32_16x16x32_bf16 v[232:235], a[208:211], v[40:43], v[232:235]
    v_exp_f32 v22, v22
    v_mfma_f32_16x16x32_bf16 v[232:235], a[212:215], v[44:47], v[232:235]
    ds_read_b64_tr_b16 a[194:195], v2 offset:37120
    v_perm_b32 v34, v21, v20, s100
    v_mfma_f32_16x16x32_bf16 v[236:239], a[216:219], v[40:43], v[236:239]
    v_exp_f32 v23, v23
    v_mfma_f32_16x16x32_bf16 v[236:239], a[220:223], v[44:47], v[236:239]
    ds_read_b64_tr_b16 a[196:197], v2 offset:37376
    v_mfma_f32_16x16x32_bf16 v[240:243], a[224:227], v[40:43], v[240:243]
    v_exp_f32 v24, v24
    v_mfma_f32_16x16x32_bf16 v[240:243], a[228:231], v[44:47], v[240:243]
    ds_read_b64_tr_b16 a[198:199], v2 offset:37632
    v_perm_b32 v35, v23, v22, s100
    v_mfma_f32_16x16x32_bf16 v[244:247], a[232:235], v[40:43], v[244:247]
    s_mov_b32 s54, 147456
    v_exp_f32 v25, v25
    v_mfma_f32_16x16x32_bf16 v[244:247], a[236:239], v[44:47], v[244:247]
    buffer_load_dwordx4 a[24:27], v6, s[64:67], s54 offen
    v_mfma_f32_16x16x32_bf16 v[248:251], a[240:243], v[40:43], v[248:251]
    v_exp_f32 v26, v26
    v_mfma_f32_16x16x32_bf16 v[248:251], a[244:247], v[44:47], v[248:251]
    ds_read_b64_tr_b16 a[200:201], v2 offset:36896
    v_perm_b32 v36, v25, v24, s100
    v_mfma_f32_16x16x32_bf16 v[252:255], a[248:251], v[40:43], v[252:255]
    v_exp_f32 v27, v27
    v_mfma_f32_16x16x32_bf16 v[252:255], a[252:255], v[44:47], v[252:255]
    ds_read_b64_tr_b16 a[202:203], v2 offset:37152
    v_smfmac_f32_16x16x64_bf16 a[12:15], a[16:19], v[40:47], v11
    ds_read_b64_tr_b16 a[204:205], v2 offset:37408
    v_mfma_f32_16x16x32_bf16 v[16:19], a[64:67], v[80:83], v[52:55]
    v_exp_f32 v28, v28
    v_mfma_f32_16x16x32_bf16 v[16:19], a[68:71], v[84:87], v[16:19]
    ds_read_b64_tr_b16 a[206:207], v2 offset:37664
    v_perm_b32 v37, v27, v26, s100
    v_mfma_f32_16x16x32_bf16 v[16:19], a[72:75], v[88:91], v[16:19]
    s_mov_b32 s54, 294912
    v_exp_f32 v29, v29
    v_mfma_f32_16x16x32_bf16 v[16:19], a[76:79], v[92:95], v[16:19]
    buffer_load_dwordx4 a[28:31], v6, s[64:67], s54 offen
    v_mfma_f32_16x16x32_bf16 v[20:23], a[80:83], v[80:83], v[52:55]
    v_exp_f32 v30, v30
    v_mfma_f32_16x16x32_bf16 v[20:23], a[84:87], v[84:87], v[20:23]
    ds_read_b64_tr_b16 a[208:209], v2 offset:36928
    v_perm_b32 v38, v29, v28, s100
    v_mfma_f32_16x16x32_bf16 v[20:23], a[88:91], v[88:91], v[20:23]
    v_exp_f32 v31, v31
    v_mfma_f32_16x16x32_bf16 v[20:23], a[92:95], v[92:95], v[20:23]
    ds_read_b64_tr_b16 a[210:211], v2 offset:37184
    v_mfma_f32_16x16x32_bf16 v[24:27], a[96:99], v[80:83], v[52:55]
    v_exp_f32 v16, v16
    v_mfma_f32_16x16x32_bf16 v[24:27], a[100:103], v[84:87], v[24:27]
    ds_read_b64_tr_b16 a[212:213], v2 offset:37440
    v_perm_b32 v39, v31, v30, s100
    v_mfma_f32_16x16x32_bf16 v[24:27], a[104:107], v[88:91], v[24:27]
    s_mov_b32 s54, 442368
    v_exp_f32 v17, v17
    v_mfma_f32_16x16x32_bf16 v[24:27], a[108:111], v[92:95], v[24:27]
    buffer_load_dwordx4 a[32:35], v6, s[64:67], s54 offen
    v_mfma_f32_16x16x32_bf16 v[28:31], a[112:115], v[80:83], v[52:55]
    v_exp_f32 v18, v18
    v_mfma_f32_16x16x32_bf16 v[28:31], a[116:119], v[84:87], v[28:31]
    ds_read_b64_tr_b16 a[214:215], v2 offset:37696
    v_perm_b32 v40, v17, v16, s100
    v_mfma_f32_16x16x32_bf16 v[28:31], a[120:123], v[88:91], v[28:31]
    v_exp_f32 v19, v19
    v_mfma_f32_16x16x32_bf16 v[28:31], a[124:127], v[92:95], v[28:31]
    ds_read_b64_tr_b16 a[216:217], v2 offset:36960
    v_mfma_f32_16x16x32_bf16 v[128:131], a[128:131], v[32:35], v[128:131]
    v_exp_f32 v20, v20
    v_mfma_f32_16x16x32_bf16 v[128:131], a[132:135], v[36:39], v[128:131]
    ds_read_b64_tr_b16 a[218:219], v2 offset:37216
    v_perm_b32 v41, v19, v18, s100
    v_mfma_f32_16x16x32_bf16 v[132:135], a[136:139], v[32:35], v[132:135]
    s_mov_b32 s54, 589824
    v_exp_f32 v21, v21
    v_mfma_f32_16x16x32_bf16 v[132:135], a[140:143], v[36:39], v[132:135]
    buffer_load_dwordx4 a[36:39], v6, s[64:67], s54 offen
    v_mfma_f32_16x16x32_bf16 v[136:139], a[144:147], v[32:35], v[136:139]
    v_exp_f32 v22, v22
    v_mfma_f32_16x16x32_bf16 v[136:139], a[148:151], v[36:39], v[136:139]
    ds_read_b64_tr_b16 a[220:221], v2 offset:37472
    v_perm_b32 v42, v21, v20, s100
    v_mfma_f32_16x16x32_bf16 v[140:143], a[152:155], v[32:35], v[140:143]
    v_exp_f32 v23, v23
    v_mfma_f32_16x16x32_bf16 v[140:143], a[156:159], v[36:39], v[140:143]
    ds_read_b64_tr_b16 a[222:223], v2 offset:37728
    v_mfma_f32_16x16x32_bf16 v[144:147], a[160:163], v[32:35], v[144:147]
    v_exp_f32 v24, v24
    v_mfma_f32_16x16x32_bf16 v[144:147], a[164:167], v[36:39], v[144:147]
    ds_read_b64_tr_b16 a[224:225], v2 offset:36992
    v_perm_b32 v43, v23, v22, s100
    v_mfma_f32_16x16x32_bf16 v[148:151], a[168:171], v[32:35], v[148:151]
    v_exp_f32 v25, v25
    v_mfma_f32_16x16x32_bf16 v[148:151], a[172:175], v[36:39], v[148:151]
    ds_read_b64_tr_b16 a[226:227], v2 offset:37248
    v_mfma_f32_16x16x32_bf16 v[152:155], a[176:179], v[32:35], v[152:155]
    v_exp_f32 v26, v26
    v_mfma_f32_16x16x32_bf16 v[152:155], a[180:183], v[36:39], v[152:155]
    ds_read_b64_tr_b16 a[228:229], v2 offset:37504
    v_perm_b32 v44, v25, v24, s100
    v_mfma_f32_16x16x32_bf16 v[156:159], a[184:187], v[32:35], v[156:159]
    v_exp_f32 v27, v27
    v_mfma_f32_16x16x32_bf16 v[156:159], a[188:191], v[36:39], v[156:159]
    ds_read_b64_tr_b16 a[230:231], v2 offset:37760
    v_smfmac_f32_16x16x64_bf16 a[0:3], a[16:19], v[32:39], v11
    ds_read_b64_tr_b16 a[232:233], v2 offset:37024
    v_mfma_f32_16x16x32_bf16 v[16:19], a[64:67], v[96:99], v[56:59]
    v_exp_f32 v28, v28
    v_mfma_f32_16x16x32_bf16 v[16:19], a[68:71], v[100:103], v[16:19]
    ds_read_b64_tr_b16 a[234:235], v2 offset:37280
    v_perm_b32 v45, v27, v26, s100
    v_mfma_f32_16x16x32_bf16 v[16:19], a[72:75], v[104:107], v[16:19]
    v_exp_f32 v29, v29
    v_mfma_f32_16x16x32_bf16 v[16:19], a[76:79], v[108:111], v[16:19]
    ds_read_b64_tr_b16 a[236:237], v2 offset:37536
    v_mfma_f32_16x16x32_bf16 v[20:23], a[80:83], v[96:99], v[56:59]
    v_exp_f32 v30, v30
    v_mfma_f32_16x16x32_bf16 v[20:23], a[84:87], v[100:103], v[20:23]
    ds_read_b64_tr_b16 a[238:239], v2 offset:37792
    v_perm_b32 v46, v29, v28, s100
    v_mfma_f32_16x16x32_bf16 v[20:23], a[88:91], v[104:107], v[20:23]
    v_exp_f32 v31, v31
    v_mfma_f32_16x16x32_bf16 v[20:23], a[92:95], v[108:111], v[20:23]
    ds_read_b64_tr_b16 a[240:241], v2 offset:37056
    v_mfma_f32_16x16x32_bf16 v[24:27], a[96:99], v[96:99], v[56:59]
    v_exp_f32 v16, v16
    v_mfma_f32_16x16x32_bf16 v[24:27], a[100:103], v[100:103], v[24:27]
    ds_read_b64_tr_b16 a[242:243], v2 offset:37312
    v_perm_b32 v47, v31, v30, s100
    v_mfma_f32_16x16x32_bf16 v[24:27], a[104:107], v[104:107], v[24:27]
    v_exp_f32 v17, v17
    v_mfma_f32_16x16x32_bf16 v[24:27], a[108:111], v[108:111], v[24:27]
    ds_read_b64_tr_b16 a[244:245], v2 offset:37568
    v_mfma_f32_16x16x32_bf16 v[28:31], a[112:115], v[96:99], v[56:59]
    v_exp_f32 v18, v18
    v_mfma_f32_16x16x32_bf16 v[28:31], a[116:119], v[100:103], v[28:31]
    ds_read_b64_tr_b16 a[246:247], v2 offset:37824
    v_perm_b32 v32, v17, v16, s100
    v_mfma_f32_16x16x32_bf16 v[28:31], a[120:123], v[104:107], v[28:31]
    v_exp_f32 v19, v19
    v_mfma_f32_16x16x32_bf16 v[28:31], a[124:127], v[108:111], v[28:31]
    ds_read_b64_tr_b16 a[248:249], v2 offset:37088
    v_mfma_f32_16x16x32_bf16 v[160:163], a[128:131], v[40:43], v[160:163]
    v_exp_f32 v20, v20
    v_mfma_f32_16x16x32_bf16 v[160:163], a[132:135], v[44:47], v[160:163]
    ds_read_b64_tr_b16 a[250:251], v2 offset:37344
    v_perm_b32 v33, v19, v18, s100
    v_mfma_f32_16x16x32_bf16 v[164:167], a[136:139], v[40:43], v[164:167]
    v_exp_f32 v21, v21
    v_mfma_f32_16x16x32_bf16 v[164:167], a[140:143], v[44:47], v[164:167]
    ds_read_b64_tr_b16 a[252:253], v2 offset:37600
    v_mfma_f32_16x16x32_bf16 v[168:171], a[144:147], v[40:43], v[168:171]
    v_exp_f32 v22, v22
    v_mfma_f32_16x16x32_bf16 v[168:171], a[148:151], v[44:47], v[168:171]
    ds_read_b64_tr_b16 a[254:255], v2 offset:37856
    v_perm_b32 v34, v21, v20, s100
    v_mfma_f32_16x16x32_bf16 v[172:175], a[152:155], v[40:43], v[172:175]
    v_exp_f32 v23, v23
    v_mfma_f32_16x16x32_bf16 v[172:175], a[156:159], v[44:47], v[172:175]
    v_mfma_f32_16x16x32_bf16 v[176:179], a[160:163], v[40:43], v[176:179]
    v_exp_f32 v24, v24
    v_mfma_f32_16x16x32_bf16 v[176:179], a[164:167], v[44:47], v[176:179]
    v_perm_b32 v35, v23, v22, s100
    v_mfma_f32_16x16x32_bf16 v[180:183], a[168:171], v[40:43], v[180:183]
    v_exp_f32 v25, v25
    v_mfma_f32_16x16x32_bf16 v[180:183], a[172:175], v[44:47], v[180:183]
    v_mfma_f32_16x16x32_bf16 v[184:187], a[176:179], v[40:43], v[184:187]
    v_exp_f32 v26, v26
    v_mfma_f32_16x16x32_bf16 v[184:187], a[180:183], v[44:47], v[184:187]
    v_perm_b32 v36, v25, v24, s100
    v_mfma_f32_16x16x32_bf16 v[188:191], a[184:187], v[40:43], v[188:191]
L2_pad8:
    s_cbranch_execz L2_pad12
    v_exp_f32 v27, v27
    v_mfma_f32_16x16x32_bf16 v[188:191], a[188:191], v[44:47], v[188:191]
    v_smfmac_f32_16x16x64_bf16 a[4:7], a[16:19], v[40:47], v11
    v_mfma_f32_16x16x32_bf16 v[16:19], a[64:67], v[112:115], v[60:63]
    v_exp_f32 v28, v28
    v_mfma_f32_16x16x32_bf16 v[16:19], a[68:71], v[116:119], v[16:19]
    ds_read_b128 a[64:67], v1 offset:36864
    v_perm_b32 v37, v27, v26, s100
    v_mfma_f32_16x16x32_bf16 v[16:19], a[72:75], v[120:123], v[16:19]
    v_exp_f32 v29, v29
    v_mfma_f32_16x16x32_bf16 v[16:19], a[76:79], v[124:127], v[16:19]
    ds_read_b128 a[68:71], v1 offset:36928
    v_mfma_f32_16x16x32_bf16 v[20:23], a[80:83], v[112:115], v[60:63]
    v_exp_f32 v30, v30
    v_mfma_f32_16x16x32_bf16 v[20:23], a[84:87], v[116:119], v[20:23]
    ds_read_b128 a[72:75], v1 offset:36992
    v_perm_b32 v38, v29, v28, s100
    v_mfma_f32_16x16x32_bf16 v[20:23], a[88:91], v[120:123], v[20:23]
    v_exp_f32 v31, v31
    v_mfma_f32_16x16x32_bf16 v[20:23], a[92:95], v[124:127], v[20:23]
    ds_read_b128 a[76:79], v1 offset:37056
    v_mfma_f32_16x16x32_bf16 v[24:27], a[96:99], v[112:115], v[60:63]
    v_exp_f32 v16, v16
    v_mfma_f32_16x16x32_bf16 v[24:27], a[100:103], v[116:119], v[24:27]
    ds_read_b128 a[80:83], v1 offset:37120
    v_perm_b32 v39, v31, v30, s100
    v_mfma_f32_16x16x32_bf16 v[24:27], a[104:107], v[120:123], v[24:27]
    v_exp_f32 v17, v17
    v_mfma_f32_16x16x32_bf16 v[24:27], a[108:111], v[124:127], v[24:27]
    ds_read_b128 a[84:87], v1 offset:37184
    v_mfma_f32_16x16x32_bf16 v[28:31], a[112:115], v[112:115], v[60:63]
    v_exp_f32 v18, v18
    v_mfma_f32_16x16x32_bf16 v[28:31], a[116:119], v[116:119], v[28:31]
    ds_read_b128 a[88:91], v1 offset:37248
    v_perm_b32 v40, v17, v16, s100
    v_mfma_f32_16x16x32_bf16 v[28:31], a[120:123], v[120:123], v[28:31]
    v_exp_f32 v19, v19
    v_mfma_f32_16x16x32_bf16 v[28:31], a[124:127], v[124:127], v[28:31]
    ds_read_b128 a[92:95], v1 offset:37312
    v_mfma_f32_16x16x32_bf16 v[192:195], a[128:131], v[32:35], v[192:195]
    v_exp_f32 v20, v20
    v_mfma_f32_16x16x32_bf16 v[192:195], a[132:135], v[36:39], v[192:195]
    ds_read_b128 a[96:99], v1 offset:37376
    v_perm_b32 v41, v19, v18, s100
    v_mfma_f32_16x16x32_bf16 v[196:199], a[136:139], v[32:35], v[196:199]
    v_exp_f32 v21, v21
    v_mfma_f32_16x16x32_bf16 v[196:199], a[140:143], v[36:39], v[196:199]
    ds_read_b128 a[100:103], v1 offset:37440
    v_mfma_f32_16x16x32_bf16 v[200:203], a[144:147], v[32:35], v[200:203]
    v_exp_f32 v22, v22
    v_mfma_f32_16x16x32_bf16 v[200:203], a[148:151], v[36:39], v[200:203]
    ds_read_b128 a[104:107], v1 offset:37504
    v_perm_b32 v42, v21, v20, s100
    v_mfma_f32_16x16x32_bf16 v[204:207], a[152:155], v[32:35], v[204:207]
    v_exp_f32 v23, v23
    v_mfma_f32_16x16x32_bf16 v[204:207], a[156:159], v[36:39], v[204:207]
    ds_read_b128 a[108:111], v1 offset:37568
    v_mfma_f32_16x16x32_bf16 v[208:211], a[160:163], v[32:35], v[208:211]
    v_exp_f32 v24, v24
    v_mfma_f32_16x16x32_bf16 v[208:211], a[164:167], v[36:39], v[208:211]
    ds_read_b128 a[112:115], v1 offset:37632
    v_perm_b32 v43, v23, v22, s100
    v_mfma_f32_16x16x32_bf16 v[212:215], a[168:171], v[32:35], v[212:215]
    v_exp_f32 v25, v25
    v_mfma_f32_16x16x32_bf16 v[212:215], a[172:175], v[36:39], v[212:215]
    ds_read_b128 a[116:119], v1 offset:37696
    v_mfma_f32_16x16x32_bf16 v[216:219], a[176:179], v[32:35], v[216:219]
    v_exp_f32 v26, v26
    v_mfma_f32_16x16x32_bf16 v[216:219], a[180:183], v[36:39], v[216:219]
    ds_read_b128 a[120:123], v1 offset:37760
    v_perm_b32 v44, v25, v24, s100
    v_mfma_f32_16x16x32_bf16 v[220:223], a[184:187], v[32:35], v[220:223]
    v_exp_f32 v27, v27
    v_mfma_f32_16x16x32_bf16 v[220:223], a[188:191], v[36:39], v[220:223]
    ds_read_b128 a[124:127], v1 offset:37824
    v_smfmac_f32_16x16x64_bf16 a[8:11], a[16:19], v[32:39], v11
    s_waitcnt lgkmcnt(12)
    v_mfma_f32_16x16x32_bf16 v[16:19], a[64:67], v[64:67], v[48:51]
    s_sub_u32 s47, s47, s48
    v_exp_f32 v28, v28
    v_mfma_f32_16x16x32_bf16 v[16:19], a[68:71], v[68:71], v[16:19]
    v_perm_b32 v45, v27, v26, s100
    v_add_u32 v1, s48, v1
    v_mfma_f32_16x16x32_bf16 v[16:19], a[72:75], v[72:75], v[16:19]
    v_exp_f32 v29, v29
    v_mfma_f32_16x16x32_bf16 v[16:19], a[76:79], v[76:79], v[16:19]
    s_waitcnt lgkmcnt(8)
    v_mfma_f32_16x16x32_bf16 v[20:23], a[80:83], v[64:67], v[48:51]
    v_exp_f32 v30, v30
    v_mfma_f32_16x16x32_bf16 v[20:23], a[84:87], v[68:71], v[20:23]
    v_perm_b32 v46, v29, v28, s100
    v_add_u32 v2, s48, v2
    v_mfma_f32_16x16x32_bf16 v[20:23], a[88:91], v[72:75], v[20:23]
    v_exp_f32 v31, v31
    v_mfma_f32_16x16x32_bf16 v[20:23], a[92:95], v[76:79], v[20:23]
    s_waitcnt lgkmcnt(4)
    v_mfma_f32_16x16x32_bf16 v[24:27], a[96:99], v[64:67], v[48:51]
    s_sub_u32 s48, 0, s48
    v_exp_f32 v16, v16
    v_mfma_f32_16x16x32_bf16 v[24:27], a[100:103], v[68:71], v[24:27]
    v_perm_b32 v47, v31, v30, s100
    v_mfma_f32_16x16x32_bf16 v[24:27], a[104:107], v[72:75], v[24:27]
    v_exp_f32 v17, v17
    v_mfma_f32_16x16x32_bf16 v[24:27], a[108:111], v[76:79], v[24:27]
    s_waitcnt lgkmcnt(0)
    v_mfma_f32_16x16x32_bf16 v[28:31], a[112:115], v[64:67], v[48:51]
    v_exp_f32 v18, v18
    v_mfma_f32_16x16x32_bf16 v[28:31], a[116:119], v[68:71], v[28:31]
    v_perm_b32 v32, v17, v16, s100
    v_mfma_f32_16x16x32_bf16 v[28:31], a[120:123], v[72:75], v[28:31]
    v_exp_f32 v19, v19
    v_mfma_f32_16x16x32_bf16 v[28:31], a[124:127], v[76:79], v[28:31]
    s_waitcnt vmcnt(7)
    s_barrier
    v_mfma_f32_16x16x32_bf16 v[224:227], a[128:131], v[40:43], v[224:227]
    v_exp_f32 v20, v20
    v_mfma_f32_16x16x32_bf16 v[224:227], a[132:135], v[44:47], v[224:227]
    ds_read_b64_tr_b16 a[128:129], v2 offset:0
    v_perm_b32 v33, v19, v18, s100
    v_mfma_f32_16x16x32_bf16 v[228:231], a[136:139], v[40:43], v[228:231]
    s_add_u32 m0, s44, 73728
    v_exp_f32 v21, v21
    v_mfma_f32_16x16x32_bf16 v[228:231], a[140:143], v[44:47], v[228:231]
    s_mov_b32 s45, 0
    buffer_load_dwordx4 v7, s[28:31], s45 offen offset:0 lds
    v_mfma_f32_16x16x32_bf16 v[232:235], a[144:147], v[40:43], v[232:235]
    v_exp_f32 v22, v22
    v_mfma_f32_16x16x32_bf16 v[232:235], a[148:151], v[44:47], v[232:235]
    ds_read_b64_tr_b16 a[130:131], v2 offset:256
    v_perm_b32 v34, v21, v20, s100
    v_mfma_f32_16x16x32_bf16 v[236:239], a[152:155], v[40:43], v[236:239]
    s_add_u32 m0, s44, 73632
    v_exp_f32 v23, v23
    v_mfma_f32_16x16x32_bf16 v[236:239], a[156:159], v[44:47], v[236:239]
    buffer_load_dwordx4 v7, s[28:31], s45 offen offset:1152 lds
    v_mfma_f32_16x16x32_bf16 v[240:243], a[160:163], v[40:43], v[240:243]
    v_exp_f32 v24, v24
    v_mfma_f32_16x16x32_bf16 v[240:243], a[164:167], v[44:47], v[240:243]
    ds_read_b64_tr_b16 a[132:133], v2 offset:512
    v_perm_b32 v35, v23, v22, s100
    v_mfma_f32_16x16x32_bf16 v[244:247], a[168:171], v[40:43], v[244:247]
    s_add_u32 m0, s44, 73536
    v_exp_f32 v25, v25
    v_mfma_f32_16x16x32_bf16 v[244:247], a[172:175], v[44:47], v[244:247]
    buffer_load_dwordx4 v7, s[28:31], s45 offen offset:2304 lds
    v_mfma_f32_16x16x32_bf16 v[248:251], a[176:179], v[40:43], v[248:251]
    v_exp_f32 v26, v26
    v_mfma_f32_16x16x32_bf16 v[248:251], a[180:183], v[44:47], v[248:251]
    ds_read_b64_tr_b16 a[134:135], v2 offset:768
    v_perm_b32 v36, v25, v24, s100
    v_mfma_f32_16x16x32_bf16 v[252:255], a[184:187], v[40:43], v[252:255]
    s_add_u32 m0, s44, 73440
    v_exp_f32 v27, v27
    v_mfma_f32_16x16x32_bf16 v[252:255], a[188:191], v[44:47], v[252:255]
    buffer_load_dwordx4 v7, s[28:31], s45 offen offset:3456 lds
    v_smfmac_f32_16x16x64_bf16 a[12:15], a[16:19], v[40:47], v11
    ds_read_b64_tr_b16 a[136:137], v2 offset:32
    v_mfma_f32_16x16x32_bf16 v[16:19], a[64:67], v[80:83], v[52:55]
    v_exp_f32 v28, v28
    v_mfma_f32_16x16x32_bf16 v[16:19], a[68:71], v[84:87], v[16:19]
    ds_read_b64_tr_b16 a[138:139], v2 offset:288
    v_perm_b32 v37, v27, v26, s100
    v_mfma_f32_16x16x32_bf16 v[16:19], a[72:75], v[88:91], v[16:19]
    s_add_u32 m0, s44, 90624
    v_exp_f32 v29, v29
    v_mfma_f32_16x16x32_bf16 v[16:19], a[76:79], v[92:95], v[16:19]
    s_mov_b32 s45, 147456
    buffer_load_dwordx4 v7, s[28:31], s45 offen offset:0 lds
    v_mfma_f32_16x16x32_bf16 v[20:23], a[80:83], v[80:83], v[52:55]
    v_exp_f32 v30, v30
    v_mfma_f32_16x16x32_bf16 v[20:23], a[84:87], v[84:87], v[20:23]
    ds_read_b64_tr_b16 a[140:141], v2 offset:544
    v_perm_b32 v38, v29, v28, s100
    v_mfma_f32_16x16x32_bf16 v[20:23], a[88:91], v[88:91], v[20:23]
    s_add_u32 m0, s44, 90528
    v_exp_f32 v31, v31
    v_mfma_f32_16x16x32_bf16 v[20:23], a[92:95], v[92:95], v[20:23]
    buffer_load_dwordx4 v7, s[28:31], s45 offen offset:1152 lds
    v_mfma_f32_16x16x32_bf16 v[24:27], a[96:99], v[80:83], v[52:55]
    v_exp_f32 v16, v16
    v_mfma_f32_16x16x32_bf16 v[24:27], a[100:103], v[84:87], v[24:27]
    ds_read_b64_tr_b16 a[142:143], v2 offset:800
    v_perm_b32 v39, v31, v30, s100
    v_mfma_f32_16x16x32_bf16 v[24:27], a[104:107], v[88:91], v[24:27]
    s_add_u32 m0, s44, 90432
    v_exp_f32 v17, v17
    v_mfma_f32_16x16x32_bf16 v[24:27], a[108:111], v[92:95], v[24:27]
    buffer_load_dwordx4 v7, s[28:31], s45 offen offset:2304 lds
    v_mfma_f32_16x16x32_bf16 v[28:31], a[112:115], v[80:83], v[52:55]
    v_exp_f32 v18, v18
    v_mfma_f32_16x16x32_bf16 v[28:31], a[116:119], v[84:87], v[28:31]
    ds_read_b64_tr_b16 a[144:145], v2 offset:64
    v_perm_b32 v40, v17, v16, s100
    v_mfma_f32_16x16x32_bf16 v[28:31], a[120:123], v[88:91], v[28:31]
    s_add_u32 m0, s44, 90336
    v_exp_f32 v19, v19
    v_mfma_f32_16x16x32_bf16 v[28:31], a[124:127], v[92:95], v[28:31]
    buffer_load_dwordx4 v7, s[28:31], s45 offen offset:3456 lds
    v_mfma_f32_16x16x32_bf16 v[128:131], a[192:195], v[32:35], v[128:131]
    v_exp_f32 v20, v20
    v_mfma_f32_16x16x32_bf16 v[128:131], a[196:199], v[36:39], v[128:131]
    ds_read_b64_tr_b16 a[146:147], v2 offset:320
    v_perm_b32 v41, v19, v18, s100
    v_mfma_f32_16x16x32_bf16 v[132:135], a[200:203], v[32:35], v[132:135]
    v_exp_f32 v21, v21
    v_mfma_f32_16x16x32_bf16 v[132:135], a[204:207], v[36:39], v[132:135]
    ds_read_b64_tr_b16 a[148:149], v2 offset:576
    v_mfma_f32_16x16x32_bf16 v[136:139], a[208:211], v[32:35], v[136:139]
    v_exp_f32 v22, v22
    v_mfma_f32_16x16x32_bf16 v[136:139], a[212:215], v[36:39], v[136:139]
    ds_read_b64_tr_b16 a[150:151], v2 offset:832
    v_perm_b32 v42, v21, v20, s100
    v_mfma_f32_16x16x32_bf16 v[140:143], a[216:219], v[32:35], v[140:143]
    v_exp_f32 v23, v23
    v_mfma_f32_16x16x32_bf16 v[140:143], a[220:223], v[36:39], v[140:143]
    ds_read_b64_tr_b16 a[152:153], v2 offset:96
    ds_read_b64_tr_b16 a[154:155], v2 offset:352
    v_mfma_f32_16x16x32_bf16 v[144:147], a[224:227], v[32:35], v[144:147]
    v_exp_f32 v24, v24
    v_mfma_f32_16x16x32_bf16 v[144:147], a[228:231], v[36:39], v[144:147]
    ds_read_b64_tr_b16 a[156:157], v2 offset:608
    v_perm_b32 v43, v23, v22, s100
    v_mfma_f32_16x16x32_bf16 v[148:151], a[232:235], v[32:35], v[148:151]
    v_exp_f32 v25, v25
    v_mfma_f32_16x16x32_bf16 v[148:151], a[236:239], v[36:39], v[148:151]
    ds_read_b64_tr_b16 a[158:159], v2 offset:864
    ds_read_b64_tr_b16 a[160:161], v2 offset:128
    v_mfma_f32_16x16x32_bf16 v[152:155], a[240:243], v[32:35], v[152:155]
    v_exp_f32 v26, v26
    v_mfma_f32_16x16x32_bf16 v[152:155], a[244:247], v[36:39], v[152:155]
    ds_read_b64_tr_b16 a[162:163], v2 offset:384
    v_perm_b32 v44, v25, v24, s100
    v_mfma_f32_16x16x32_bf16 v[156:159], a[248:251], v[32:35], v[156:159]
    v_exp_f32 v27, v27
    v_mfma_f32_16x16x32_bf16 v[156:159], a[252:255], v[36:39], v[156:159]
    ds_read_b64_tr_b16 a[164:165], v2 offset:640
    ds_read_b64_tr_b16 a[166:167], v2 offset:896
    v_smfmac_f32_16x16x64_bf16 a[0:3], a[16:19], v[32:39], v11
    ds_read_b64_tr_b16 a[168:169], v2 offset:160
    ds_read_b64_tr_b16 a[170:171], v2 offset:416
    v_mfma_f32_16x16x32_bf16 v[16:19], a[64:67], v[96:99], v[56:59]
    v_exp_f32 v28, v28
    v_mfma_f32_16x16x32_bf16 v[16:19], a[68:71], v[100:103], v[16:19]
    ds_read_b64_tr_b16 a[172:173], v2 offset:672
    v_perm_b32 v45, v27, v26, s100
    v_mfma_f32_16x16x32_bf16 v[16:19], a[72:75], v[104:107], v[16:19]
    s_add_u32 m0, s44, 110592
    v_exp_f32 v29, v29
    v_mfma_f32_16x16x32_bf16 v[16:19], a[76:79], v[108:111], v[16:19]
    s_mov_b32 s45, 128
    buffer_load_dwordx4 v7, s[28:31], s45 offen offset:0 lds
    v_mfma_f32_16x16x32_bf16 v[20:23], a[80:83], v[96:99], v[56:59]
    v_exp_f32 v30, v30
    v_mfma_f32_16x16x32_bf16 v[20:23], a[84:87], v[100:103], v[20:23]
    ds_read_b64_tr_b16 a[174:175], v2 offset:928
    v_perm_b32 v46, v29, v28, s100
    v_mfma_f32_16x16x32_bf16 v[20:23], a[88:91], v[104:107], v[20:23]
    s_add_u32 m0, s44, 110496
    v_exp_f32 v31, v31
    v_mfma_f32_16x16x32_bf16 v[20:23], a[92:95], v[108:111], v[20:23]
    buffer_load_dwordx4 v7, s[28:31], s45 offen offset:1152 lds
    v_mfma_f32_16x16x32_bf16 v[24:27], a[96:99], v[96:99], v[56:59]
    v_exp_f32 v16, v16
    v_mfma_f32_16x16x32_bf16 v[24:27], a[100:103], v[100:103], v[24:27]
    ds_read_b64_tr_b16 a[176:177], v2 offset:192
    v_perm_b32 v47, v31, v30, s100
    v_mfma_f32_16x16x32_bf16 v[24:27], a[104:107], v[104:107], v[24:27]
    s_add_u32 m0, s44, 110400
    v_exp_f32 v17, v17
    v_mfma_f32_16x16x32_bf16 v[24:27], a[108:111], v[108:111], v[24:27]
    buffer_load_dwordx4 v7, s[28:31], s45 offen offset:2304 lds
    v_mfma_f32_16x16x32_bf16 v[28:31], a[112:115], v[96:99], v[56:59]
    v_exp_f32 v18, v18
    v_mfma_f32_16x16x32_bf16 v[28:31], a[116:119], v[100:103], v[28:31]
    ds_read_b64_tr_b16 a[178:179], v2 offset:448
    v_perm_b32 v32, v17, v16, s100
    v_mfma_f32_16x16x32_bf16 v[28:31], a[120:123], v[104:107], v[28:31]
    s_add_u32 m0, s44, 110304
    v_exp_f32 v19, v19
    v_mfma_f32_16x16x32_bf16 v[28:31], a[124:127], v[108:111], v[28:31]
    buffer_load_dwordx4 v7, s[28:31], s45 offen offset:3456 lds
    v_mfma_f32_16x16x32_bf16 v[160:163], a[192:195], v[40:43], v[160:163]
    v_exp_f32 v20, v20
    v_mfma_f32_16x16x32_bf16 v[160:163], a[196:199], v[44:47], v[160:163]
    ds_read_b64_tr_b16 a[180:181], v2 offset:704
    v_perm_b32 v33, v19, v18, s100
    v_mfma_f32_16x16x32_bf16 v[164:167], a[200:203], v[40:43], v[164:167]
    s_add_u32 m0, s44, 127488
    v_exp_f32 v21, v21
    v_mfma_f32_16x16x32_bf16 v[164:167], a[204:207], v[44:47], v[164:167]
    s_mov_b32 s45, 147584
    buffer_load_dwordx4 v7, s[28:31], s45 offen offset:0 lds
    v_mfma_f32_16x16x32_bf16 v[168:171], a[208:211], v[40:43], v[168:171]
    v_exp_f32 v22, v22
    v_mfma_f32_16x16x32_bf16 v[168:171], a[212:215], v[44:47], v[168:171]
    ds_read_b64_tr_b16 a[182:183], v2 offset:960
    v_perm_b32 v34, v21, v20, s100
    v_mfma_f32_16x16x32_bf16 v[172:175], a[216:219], v[40:43], v[172:175]
    s_add_u32 m0, s44, 127392
    v_exp_f32 v23, v23
    v_mfma_f32_16x16x32_bf16 v[172:175], a[220:223], v[44:47], v[172:175]
    buffer_load_dwordx4 v7, s[28:31], s45 offen offset:1152 lds
    v_mfma_f32_16x16x32_bf16 v[176:179], a[224:227], v[40:43], v[176:179]
    v_exp_f32 v24, v24
    v_mfma_f32_16x16x32_bf16 v[176:179], a[228:231], v[44:47], v[176:179]
    ds_read_b64_tr_b16 a[184:185], v2 offset:224
    v_perm_b32 v35, v23, v22, s100
    v_mfma_f32_16x16x32_bf16 v[180:183], a[232:235], v[40:43], v[180:183]
    s_add_u32 m0, s44, 127296
    v_exp_f32 v25, v25
    v_mfma_f32_16x16x32_bf16 v[180:183], a[236:239], v[44:47], v[180:183]
    buffer_load_dwordx4 v7, s[28:31], s45 offen offset:2304 lds
    v_mfma_f32_16x16x32_bf16 v[184:187], a[240:243], v[40:43], v[184:187]
    v_exp_f32 v26, v26
    v_mfma_f32_16x16x32_bf16 v[184:187], a[244:247], v[44:47], v[184:187]
    ds_read_b64_tr_b16 a[186:187], v2 offset:480
    v_perm_b32 v36, v25, v24, s100
    v_mfma_f32_16x16x32_bf16 v[188:191], a[248:251], v[40:43], v[188:191]
    s_add_u32 m0, s44, 127200
    v_exp_f32 v27, v27
    v_mfma_f32_16x16x32_bf16 v[188:191], a[252:255], v[44:47], v[188:191]
    buffer_load_dwordx4 v7, s[28:31], s45 offen offset:3456 lds
    v_smfmac_f32_16x16x64_bf16 a[4:7], a[16:19], v[40:47], v11
    ds_read_b64_tr_b16 a[188:189], v2 offset:736
    ds_read_b64_tr_b16 a[190:191], v2 offset:992
    v_mfma_f32_16x16x32_bf16 v[16:19], a[64:67], v[112:115], v[60:63]
    v_exp_f32 v28, v28
    v_mfma_f32_16x16x32_bf16 v[16:19], a[68:71], v[116:119], v[16:19]
    ds_read_b128 a[64:67], v1 offset:0
    v_perm_b32 v37, v27, v26, s100
    v_mfma_f32_16x16x32_bf16 v[16:19], a[72:75], v[120:123], v[16:19]
    v_exp_f32 v29, v29
    v_mfma_f32_16x16x32_bf16 v[16:19], a[76:79], v[124:127], v[16:19]
    ds_read_b128 a[68:71], v1 offset:64
    v_mfma_f32_16x16x32_bf16 v[20:23], a[80:83], v[112:115], v[60:63]
    v_exp_f32 v30, v30
    v_mfma_f32_16x16x32_bf16 v[20:23], a[84:87], v[116:119], v[20:23]
    ds_read_b128 a[72:75], v1 offset:128
    v_perm_b32 v38, v29, v28, s100
    v_mfma_f32_16x16x32_bf16 v[20:23], a[88:91], v[120:123], v[20:23]
    v_exp_f32 v31, v31
    v_mfma_f32_16x16x32_bf16 v[20:23], a[92:95], v[124:127], v[20:23]
    ds_read_b128 a[76:79], v1 offset:192
    v_mfma_f32_16x16x32_bf16 v[24:27], a[96:99], v[112:115], v[60:63]
    v_exp_f32 v16, v16
    v_mfma_f32_16x16x32_bf16 v[24:27], a[100:103], v[116:119], v[24:27]
    ds_read_b128 a[80:83], v1 offset:256
    v_perm_b32 v39, v31, v30, s100
    v_mfma_f32_16x16x32_bf16 v[24:27], a[104:107], v[120:123], v[24:27]
    v_exp_f32 v17, v17
    v_mfma_f32_16x16x32_bf16 v[24:27], a[108:111], v[124:127], v[24:27]
    ds_read_b128 a[84:87], v1 offset:320
    v_mfma_f32_16x16x32_bf16 v[28:31], a[112:115], v[112:115], v[60:63]
    v_exp_f32 v18, v18
    v_mfma_f32_16x16x32_bf16 v[28:31], a[116:119], v[116:119], v[28:31]
    ds_read_b128 a[88:91], v1 offset:384
    v_perm_b32 v40, v17, v16, s100
    v_mfma_f32_16x16x32_bf16 v[28:31], a[120:123], v[120:123], v[28:31]
    v_exp_f32 v19, v19
    v_mfma_f32_16x16x32_bf16 v[28:31], a[124:127], v[124:127], v[28:31]
    ds_read_b128 a[92:95], v1 offset:448
    v_mfma_f32_16x16x32_bf16 v[192:195], a[192:195], v[32:35], v[192:195]
    v_exp_f32 v20, v20
    v_mfma_f32_16x16x32_bf16 v[192:195], a[196:199], v[36:39], v[192:195]
    ds_read_b128 a[96:99], v1 offset:512
    v_perm_b32 v41, v19, v18, s100
    v_mfma_f32_16x16x32_bf16 v[196:199], a[200:203], v[32:35], v[196:199]
    v_exp_f32 v21, v21
    v_mfma_f32_16x16x32_bf16 v[196:199], a[204:207], v[36:39], v[196:199]
    ds_read_b128 a[100:103], v1 offset:576
    v_mfma_f32_16x16x32_bf16 v[200:203], a[208:211], v[32:35], v[200:203]
    v_exp_f32 v22, v22
    v_mfma_f32_16x16x32_bf16 v[200:203], a[212:215], v[36:39], v[200:203]
    ds_read_b128 a[104:107], v1 offset:640
    v_perm_b32 v42, v21, v20, s100
    v_mfma_f32_16x16x32_bf16 v[204:207], a[216:219], v[32:35], v[204:207]
    v_exp_f32 v23, v23
    v_mfma_f32_16x16x32_bf16 v[204:207], a[220:223], v[36:39], v[204:207]
    ds_read_b128 a[108:111], v1 offset:704
    v_mfma_f32_16x16x32_bf16 v[208:211], a[224:227], v[32:35], v[208:211]
    v_exp_f32 v24, v24
    v_mfma_f32_16x16x32_bf16 v[208:211], a[228:231], v[36:39], v[208:211]
    ds_read_b128 a[112:115], v1 offset:768
    v_perm_b32 v43, v23, v22, s100
    v_mfma_f32_16x16x32_bf16 v[212:215], a[232:235], v[32:35], v[212:215]
    v_exp_f32 v25, v25
    v_mfma_f32_16x16x32_bf16 v[212:215], a[236:239], v[36:39], v[212:215]
    ds_read_b128 a[116:119], v1 offset:832
    v_mfma_f32_16x16x32_bf16 v[216:219], a[240:243], v[32:35], v[216:219]
    v_exp_f32 v26, v26
    v_mfma_f32_16x16x32_bf16 v[216:219], a[244:247], v[36:39], v[216:219]
    ds_read_b128 a[120:123], v1 offset:896
    v_perm_b32 v44, v25, v24, s100
    v_mfma_f32_16x16x32_bf16 v[220:223], a[248:251], v[32:35], v[220:223]
    v_exp_f32 v27, v27
    v_mfma_f32_16x16x32_bf16 v[220:223], a[252:255], v[36:39], v[220:223]
    ds_read_b128 a[124:127], v1 offset:960
    v_smfmac_f32_16x16x64_bf16 a[8:11], a[16:19], v[32:39], v11
    s_waitcnt lgkmcnt(12)
    v_mfma_f32_16x16x32_bf16 v[16:19], a[64:67], v[64:67], v[48:51]
    v_exp_f32 v28, v28
    v_mfma_f32_16x16x32_bf16 v[16:19], a[68:71], v[68:71], v[16:19]
    v_perm_b32 v45, v27, v26, s100
    v_mfma_f32_16x16x32_bf16 v[16:19], a[72:75], v[72:75], v[16:19]
    s_mov_b32 s54, 737280
    v_exp_f32 v29, v29
    v_mfma_f32_16x16x32_bf16 v[16:19], a[76:79], v[76:79], v[16:19]
    s_waitcnt lgkmcnt(8)
    buffer_load_dwordx4 a[40:43], v6, s[64:67], s54 offen
    v_mfma_f32_16x16x32_bf16 v[20:23], a[80:83], v[64:67], v[48:51]
    v_exp_f32 v30, v30
    v_mfma_f32_16x16x32_bf16 v[20:23], a[84:87], v[68:71], v[20:23]
    v_perm_b32 v46, v29, v28, s100
    v_mfma_f32_16x16x32_bf16 v[20:23], a[88:91], v[72:75], v[20:23]
    v_exp_f32 v31, v31
    v_mfma_f32_16x16x32_bf16 v[20:23], a[92:95], v[76:79], v[20:23]
    s_waitcnt lgkmcnt(4)
    v_mfma_f32_16x16x32_bf16 v[24:27], a[96:99], v[64:67], v[48:51]
    v_exp_f32 v16, v16
    v_mfma_f32_16x16x32_bf16 v[24:27], a[100:103], v[68:71], v[24:27]
    v_perm_b32 v47, v31, v30, s100
    v_mfma_f32_16x16x32_bf16 v[24:27], a[104:107], v[72:75], v[24:27]
    s_mov_b32 s54, 884736
    v_exp_f32 v17, v17
    v_mfma_f32_16x16x32_bf16 v[24:27], a[108:111], v[76:79], v[24:27]
    s_waitcnt lgkmcnt(0)
    buffer_load_dwordx4 a[44:47], v6, s[64:67], s54 offen
    v_mfma_f32_16x16x32_bf16 v[28:31], a[112:115], v[64:67], v[48:51]
    v_exp_f32 v18, v18
    v_mfma_f32_16x16x32_bf16 v[28:31], a[116:119], v[68:71], v[28:31]
    v_perm_b32 v32, v17, v16, s100
    v_mfma_f32_16x16x32_bf16 v[28:31], a[120:123], v[72:75], v[28:31]
    v_exp_f32 v19, v19
    v_mfma_f32_16x16x32_bf16 v[28:31], a[124:127], v[76:79], v[28:31]
    v_mfma_f32_16x16x32_bf16 v[224:227], a[192:195], v[40:43], v[224:227]
    v_exp_f32 v20, v20
    v_mfma_f32_16x16x32_bf16 v[224:227], a[196:199], v[44:47], v[224:227]
    ds_read_b64_tr_b16 a[192:193], v2 offset:36864
    v_perm_b32 v33, v19, v18, s100
    v_mfma_f32_16x16x32_bf16 v[228:231], a[200:203], v[40:43], v[228:231]
    s_mov_b32 s54, 1032192
    v_exp_f32 v21, v21
    v_mfma_f32_16x16x32_bf16 v[228:231], a[204:207], v[44:47], v[228:231]
    buffer_load_dwordx4 a[48:51], v6, s[64:67], s54 offen
    v_mfma_f32_16x16x32_bf16 v[232:235], a[208:211], v[40:43], v[232:235]
    v_exp_f32 v22, v22
    v_mfma_f32_16x16x32_bf16 v[232:235], a[212:215], v[44:47], v[232:235]
    ds_read_b64_tr_b16 a[194:195], v2 offset:37120
    v_perm_b32 v34, v21, v20, s100
    v_mfma_f32_16x16x32_bf16 v[236:239], a[216:219], v[40:43], v[236:239]
    v_exp_f32 v23, v23
    v_mfma_f32_16x16x32_bf16 v[236:239], a[220:223], v[44:47], v[236:239]
    ds_read_b64_tr_b16 a[196:197], v2 offset:37376
    v_mfma_f32_16x16x32_bf16 v[240:243], a[224:227], v[40:43], v[240:243]
    v_exp_f32 v24, v24
    v_mfma_f32_16x16x32_bf16 v[240:243], a[228:231], v[44:47], v[240:243]
    ds_read_b64_tr_b16 a[198:199], v2 offset:37632
    v_perm_b32 v35, v23, v22, s100
    v_mfma_f32_16x16x32_bf16 v[244:247], a[232:235], v[40:43], v[244:247]
    s_mov_b32 s54, 1179648
    v_exp_f32 v25, v25
    v_mfma_f32_16x16x32_bf16 v[244:247], a[236:239], v[44:47], v[244:247]
    buffer_load_dwordx4 a[52:55], v6, s[64:67], s54 offen
    v_mfma_f32_16x16x32_bf16 v[248:251], a[240:243], v[40:43], v[248:251]
    v_exp_f32 v26, v26
    v_mfma_f32_16x16x32_bf16 v[248:251], a[244:247], v[44:47], v[248:251]
    ds_read_b64_tr_b16 a[200:201], v2 offset:36896
    v_perm_b32 v36, v25, v24, s100
    v_mfma_f32_16x16x32_bf16 v[252:255], a[248:251], v[40:43], v[252:255]
    v_exp_f32 v27, v27
    v_mfma_f32_16x16x32_bf16 v[252:255], a[252:255], v[44:47], v[252:255]
    ds_read_b64_tr_b16 a[202:203], v2 offset:37152
    v_smfmac_f32_16x16x64_bf16 a[12:15], a[16:19], v[40:47], v11
    ds_read_b64_tr_b16 a[204:205], v2 offset:37408
    v_mfma_f32_16x16x32_bf16 v[16:19], a[64:67], v[80:83], v[52:55]
    v_exp_f32 v28, v28
    v_mfma_f32_16x16x32_bf16 v[16:19], a[68:71], v[84:87], v[16:19]
    ds_read_b64_tr_b16 a[206:207], v2 offset:37664
    v_perm_b32 v37, v27, v26, s100
    v_mfma_f32_16x16x32_bf16 v[16:19], a[72:75], v[88:91], v[16:19]
    v_exp_f32 v29, v29
    v_mfma_f32_16x16x32_bf16 v[16:19], a[76:79], v[92:95], v[16:19]
    buffer_store_dwordx4 a[56:59], v5, s[32:35], 0 offen offset:0 sc1
    v_mfma_f32_16x16x32_bf16 v[20:23], a[80:83], v[80:83], v[52:55]
    v_exp_f32 v30, v30
    v_mfma_f32_16x16x32_bf16 v[20:23], a[84:87], v[84:87], v[20:23]
    ds_read_b64_tr_b16 a[208:209], v2 offset:36928
    v_perm_b32 v38, v29, v28, s100
    v_mfma_f32_16x16x32_bf16 v[20:23], a[88:91], v[88:91], v[20:23]
    v_exp_f32 v31, v31
    v_mfma_f32_16x16x32_bf16 v[20:23], a[92:95], v[92:95], v[20:23]
    ds_read_b64_tr_b16 a[210:211], v2 offset:37184
    v_mfma_f32_16x16x32_bf16 v[24:27], a[96:99], v[80:83], v[52:55]
    v_exp_f32 v16, v16
    v_mfma_f32_16x16x32_bf16 v[24:27], a[100:103], v[84:87], v[24:27]
    ds_read_b64_tr_b16 a[212:213], v2 offset:37440
    v_perm_b32 v39, v31, v30, s100
    v_mfma_f32_16x16x32_bf16 v[24:27], a[104:107], v[88:91], v[24:27]
    v_exp_f32 v17, v17
    v_mfma_f32_16x16x32_bf16 v[24:27], a[108:111], v[92:95], v[24:27]
    buffer_store_dwordx4 a[56:59], v5, s[32:35], 0 offen offset:1024 sc1
    v_mfma_f32_16x16x32_bf16 v[28:31], a[112:115], v[80:83], v[52:55]
    v_exp_f32 v18, v18
    v_mfma_f32_16x16x32_bf16 v[28:31], a[116:119], v[84:87], v[28:31]
    ds_read_b64_tr_b16 a[214:215], v2 offset:37696
    v_perm_b32 v40, v17, v16, s100
    v_mfma_f32_16x16x32_bf16 v[28:31], a[120:123], v[88:91], v[28:31]
    v_exp_f32 v19, v19
    v_mfma_f32_16x16x32_bf16 v[28:31], a[124:127], v[92:95], v[28:31]
    ds_read_b64_tr_b16 a[216:217], v2 offset:36960
    v_mfma_f32_16x16x32_bf16 v[128:131], a[128:131], v[32:35], v[128:131]
    v_exp_f32 v20, v20
    v_mfma_f32_16x16x32_bf16 v[128:131], a[132:135], v[36:39], v[128:131]
    ds_read_b64_tr_b16 a[218:219], v2 offset:37216
    v_perm_b32 v41, v19, v18, s100
    v_mfma_f32_16x16x32_bf16 v[132:135], a[136:139], v[32:35], v[132:135]
    v_exp_f32 v21, v21
    v_mfma_f32_16x16x32_bf16 v[132:135], a[140:143], v[36:39], v[132:135]
    buffer_store_dwordx4 a[56:59], v5, s[32:35], 0 offen offset:2048 sc1
    v_mfma_f32_16x16x32_bf16 v[136:139], a[144:147], v[32:35], v[136:139]
    v_exp_f32 v22, v22
    v_mfma_f32_16x16x32_bf16 v[136:139], a[148:151], v[36:39], v[136:139]
    ds_read_b64_tr_b16 a[220:221], v2 offset:37472
    v_perm_b32 v42, v21, v20, s100
    v_mfma_f32_16x16x32_bf16 v[140:143], a[152:155], v[32:35], v[140:143]
    v_exp_f32 v23, v23
    v_mfma_f32_16x16x32_bf16 v[140:143], a[156:159], v[36:39], v[140:143]
    ds_read_b64_tr_b16 a[222:223], v2 offset:37728
    v_mfma_f32_16x16x32_bf16 v[144:147], a[160:163], v[32:35], v[144:147]
    v_exp_f32 v24, v24
    v_mfma_f32_16x16x32_bf16 v[144:147], a[164:167], v[36:39], v[144:147]
    ds_read_b64_tr_b16 a[224:225], v2 offset:36992
    v_perm_b32 v43, v23, v22, s100
    v_mfma_f32_16x16x32_bf16 v[148:151], a[168:171], v[32:35], v[148:151]
    v_exp_f32 v25, v25
    v_mfma_f32_16x16x32_bf16 v[148:151], a[172:175], v[36:39], v[148:151]
    buffer_store_dwordx4 a[56:59], v5, s[32:35], 0 offen offset:3072 sc1
    v_mfma_f32_16x16x32_bf16 v[152:155], a[176:179], v[32:35], v[152:155]
    v_exp_f32 v26, v26
    v_mfma_f32_16x16x32_bf16 v[152:155], a[180:183], v[36:39], v[152:155]
    ds_read_b64_tr_b16 a[226:227], v2 offset:37248
    v_perm_b32 v44, v25, v24, s100
    v_mfma_f32_16x16x32_bf16 v[156:159], a[184:187], v[32:35], v[156:159]
    v_exp_f32 v27, v27
    v_mfma_f32_16x16x32_bf16 v[156:159], a[188:191], v[36:39], v[156:159]
    ds_read_b64_tr_b16 a[228:229], v2 offset:37504
    v_smfmac_f32_16x16x64_bf16 a[0:3], a[16:19], v[32:39], v11
    ds_read_b64_tr_b16 a[230:231], v2 offset:37760
    v_mfma_f32_16x16x32_bf16 v[16:19], a[64:67], v[96:99], v[56:59]
    v_exp_f32 v28, v28
    v_mfma_f32_16x16x32_bf16 v[16:19], a[68:71], v[100:103], v[16:19]
    ds_read_b64_tr_b16 a[232:233], v2 offset:37024
    v_perm_b32 v45, v27, v26, s100
    v_mfma_f32_16x16x32_bf16 v[16:19], a[72:75], v[104:107], v[16:19]
    v_exp_f32 v29, v29
    v_mfma_f32_16x16x32_bf16 v[16:19], a[76:79], v[108:111], v[16:19]
    ds_read_b64_tr_b16 a[234:235], v2 offset:37280
    v_mfma_f32_16x16x32_bf16 v[20:23], a[80:83], v[96:99], v[56:59]
    v_exp_f32 v30, v30
    v_mfma_f32_16x16x32_bf16 v[20:23], a[84:87], v[100:103], v[20:23]
    ds_read_b64_tr_b16 a[236:237], v2 offset:37536
    v_perm_b32 v46, v29, v28, s100
    v_mfma_f32_16x16x32_bf16 v[20:23], a[88:91], v[104:107], v[20:23]
    v_exp_f32 v31, v31
    v_mfma_f32_16x16x32_bf16 v[20:23], a[92:95], v[108:111], v[20:23]
    ds_read_b64_tr_b16 a[238:239], v2 offset:37792
    v_mfma_f32_16x16x32_bf16 v[24:27], a[96:99], v[96:99], v[56:59]
    v_exp_f32 v16, v16
    v_mfma_f32_16x16x32_bf16 v[24:27], a[100:103], v[100:103], v[24:27]
    ds_read_b64_tr_b16 a[240:241], v2 offset:37056
    v_perm_b32 v47, v31, v30, s100
    v_mfma_f32_16x16x32_bf16 v[24:27], a[104:107], v[104:107], v[24:27]
    v_exp_f32 v17, v17
    v_mfma_f32_16x16x32_bf16 v[24:27], a[108:111], v[108:111], v[24:27]
    ds_read_b64_tr_b16 a[242:243], v2 offset:37312
    v_mfma_f32_16x16x32_bf16 v[28:31], a[112:115], v[96:99], v[56:59]
    v_exp_f32 v18, v18
    v_mfma_f32_16x16x32_bf16 v[28:31], a[116:119], v[100:103], v[28:31]
L2_pad9:
    s_cbranch_execz L2_pad13
    ds_read_b64_tr_b16 a[244:245], v2 offset:37568
    v_perm_b32 v32, v17, v16, s100
    v_mfma_f32_16x16x32_bf16 v[28:31], a[120:123], v[104:107], v[28:31]
    v_exp_f32 v19, v19
    v_mfma_f32_16x16x32_bf16 v[28:31], a[124:127], v[108:111], v[28:31]
    ds_read_b64_tr_b16 a[246:247], v2 offset:37824
    v_mfma_f32_16x16x32_bf16 v[160:163], a[128:131], v[40:43], v[160:163]
    v_exp_f32 v20, v20
    v_mfma_f32_16x16x32_bf16 v[160:163], a[132:135], v[44:47], v[160:163]
    ds_read_b64_tr_b16 a[248:249], v2 offset:37088
    v_perm_b32 v33, v19, v18, s100
    v_mfma_f32_16x16x32_bf16 v[164:167], a[136:139], v[40:43], v[164:167]
    v_exp_f32 v21, v21
    v_mfma_f32_16x16x32_bf16 v[164:167], a[140:143], v[44:47], v[164:167]
    ds_read_b64_tr_b16 a[250:251], v2 offset:37344
    v_mfma_f32_16x16x32_bf16 v[168:171], a[144:147], v[40:43], v[168:171]
    v_exp_f32 v22, v22
    v_mfma_f32_16x16x32_bf16 v[168:171], a[148:151], v[44:47], v[168:171]
    ds_read_b64_tr_b16 a[252:253], v2 offset:37600
    v_perm_b32 v34, v21, v20, s100
    v_mfma_f32_16x16x32_bf16 v[172:175], a[152:155], v[40:43], v[172:175]
    v_exp_f32 v23, v23
    v_mfma_f32_16x16x32_bf16 v[172:175], a[156:159], v[44:47], v[172:175]
    ds_read_b64_tr_b16 a[254:255], v2 offset:37856
    v_mfma_f32_16x16x32_bf16 v[176:179], a[160:163], v[40:43], v[176:179]
    v_exp_f32 v24, v24
    v_mfma_f32_16x16x32_bf16 v[176:179], a[164:167], v[44:47], v[176:179]
    v_perm_b32 v35, v23, v22, s100
    v_mfma_f32_16x16x32_bf16 v[180:183], a[168:171], v[40:43], v[180:183]
    v_exp_f32 v25, v25
    v_mfma_f32_16x16x32_bf16 v[180:183], a[172:175], v[44:47], v[180:183]
    v_mfma_f32_16x16x32_bf16 v[184:187], a[176:179], v[40:43], v[184:187]
    v_exp_f32 v26, v26
    v_mfma_f32_16x16x32_bf16 v[184:187], a[180:183], v[44:47], v[184:187]
    v_perm_b32 v36, v25, v24, s100
    v_mfma_f32_16x16x32_bf16 v[188:191], a[184:187], v[40:43], v[188:191]
    v_exp_f32 v27, v27
    v_mfma_f32_16x16x32_bf16 v[188:191], a[188:191], v[44:47], v[188:191]
    v_smfmac_f32_16x16x64_bf16 a[4:7], a[16:19], v[40:47], v11
    v_mfma_f32_16x16x32_bf16 v[16:19], a[64:67], v[112:115], v[60:63]
    v_exp_f32 v28, v28
    v_mfma_f32_16x16x32_bf16 v[16:19], a[68:71], v[116:119], v[16:19]
    ds_read_b128 a[64:67], v1 offset:36864
    v_perm_b32 v37, v27, v26, s100
    v_mfma_f32_16x16x32_bf16 v[16:19], a[72:75], v[120:123], v[16:19]
    v_exp_f32 v29, v29
    v_mfma_f32_16x16x32_bf16 v[16:19], a[76:79], v[124:127], v[16:19]
    ds_read_b128 a[68:71], v1 offset:36928
    v_mfma_f32_16x16x32_bf16 v[20:23], a[80:83], v[112:115], v[60:63]
    v_exp_f32 v30, v30
    v_mfma_f32_16x16x32_bf16 v[20:23], a[84:87], v[116:119], v[20:23]
    ds_read_b128 a[72:75], v1 offset:36992
    v_perm_b32 v38, v29, v28, s100
    v_mfma_f32_16x16x32_bf16 v[20:23], a[88:91], v[120:123], v[20:23]
    v_exp_f32 v31, v31
    v_mfma_f32_16x16x32_bf16 v[20:23], a[92:95], v[124:127], v[20:23]
    ds_read_b128 a[76:79], v1 offset:37056
    v_mfma_f32_16x16x32_bf16 v[24:27], a[96:99], v[112:115], v[60:63]
    v_exp_f32 v16, v16
    v_mfma_f32_16x16x32_bf16 v[24:27], a[100:103], v[116:119], v[24:27]
    ds_read_b128 a[80:83], v1 offset:37120
    v_perm_b32 v39, v31, v30, s100
    v_mfma_f32_16x16x32_bf16 v[24:27], a[104:107], v[120:123], v[24:27]
    v_exp_f32 v17, v17
    v_mfma_f32_16x16x32_bf16 v[24:27], a[108:111], v[124:127], v[24:27]
    ds_read_b128 a[84:87], v1 offset:37184
    v_mfma_f32_16x16x32_bf16 v[28:31], a[112:115], v[112:115], v[60:63]
    v_exp_f32 v18, v18
    v_mfma_f32_16x16x32_bf16 v[28:31], a[116:119], v[116:119], v[28:31]
    ds_read_b128 a[88:91], v1 offset:37248
    v_perm_b32 v40, v17, v16, s100
    v_mfma_f32_16x16x32_bf16 v[28:31], a[120:123], v[120:123], v[28:31]
    v_exp_f32 v19, v19
    v_mfma_f32_16x16x32_bf16 v[28:31], a[124:127], v[124:127], v[28:31]
    ds_read_b128 a[92:95], v1 offset:37312
    v_mfma_f32_16x16x32_bf16 v[192:195], a[128:131], v[32:35], v[192:195]
    v_exp_f32 v20, v20
    v_mfma_f32_16x16x32_bf16 v[192:195], a[132:135], v[36:39], v[192:195]
    ds_read_b128 a[96:99], v1 offset:37376
    v_perm_b32 v41, v19, v18, s100
    v_mfma_f32_16x16x32_bf16 v[196:199], a[136:139], v[32:35], v[196:199]
    v_exp_f32 v21, v21
    v_mfma_f32_16x16x32_bf16 v[196:199], a[140:143], v[36:39], v[196:199]
    ds_read_b128 a[100:103], v1 offset:37440
    v_mfma_f32_16x16x32_bf16 v[200:203], a[144:147], v[32:35], v[200:203]
    v_exp_f32 v22, v22
    v_mfma_f32_16x16x32_bf16 v[200:203], a[148:151], v[36:39], v[200:203]
    ds_read_b128 a[104:107], v1 offset:37504
    v_perm_b32 v42, v21, v20, s100
    v_mfma_f32_16x16x32_bf16 v[204:207], a[152:155], v[32:35], v[204:207]
    v_exp_f32 v23, v23
    v_mfma_f32_16x16x32_bf16 v[204:207], a[156:159], v[36:39], v[204:207]
    ds_read_b128 a[108:111], v1 offset:37568
    v_mfma_f32_16x16x32_bf16 v[208:211], a[160:163], v[32:35], v[208:211]
    v_exp_f32 v24, v24
    v_mfma_f32_16x16x32_bf16 v[208:211], a[164:167], v[36:39], v[208:211]
    ds_read_b128 a[112:115], v1 offset:37632
    v_perm_b32 v43, v23, v22, s100
    v_mfma_f32_16x16x32_bf16 v[212:215], a[168:171], v[32:35], v[212:215]
    v_exp_f32 v25, v25
    v_mfma_f32_16x16x32_bf16 v[212:215], a[172:175], v[36:39], v[212:215]
    ds_read_b128 a[116:119], v1 offset:37696
    v_mfma_f32_16x16x32_bf16 v[216:219], a[176:179], v[32:35], v[216:219]
    v_exp_f32 v26, v26
    v_mfma_f32_16x16x32_bf16 v[216:219], a[180:183], v[36:39], v[216:219]
    ds_read_b128 a[120:123], v1 offset:37760
    v_perm_b32 v44, v25, v24, s100
    v_mfma_f32_16x16x32_bf16 v[220:223], a[184:187], v[32:35], v[220:223]
    v_exp_f32 v27, v27
    v_mfma_f32_16x16x32_bf16 v[220:223], a[188:191], v[36:39], v[220:223]
    ds_read_b128 a[124:127], v1 offset:37824
    v_smfmac_f32_16x16x64_bf16 a[8:11], a[16:19], v[32:39], v11
    s_waitcnt lgkmcnt(12)
    v_mfma_f32_16x16x32_bf16 v[16:19], a[64:67], v[64:67], v[48:51]
    v_exp_f32 v28, v28
    v_mfma_f32_16x16x32_bf16 v[16:19], a[68:71], v[68:71], v[16:19]
    v_perm_b32 v45, v27, v26, s100
    v_mfma_f32_16x16x32_bf16 v[16:19], a[72:75], v[72:75], v[16:19]
    v_exp_f32 v29, v29
    v_mfma_f32_16x16x32_bf16 v[16:19], a[76:79], v[76:79], v[16:19]
    s_waitcnt lgkmcnt(8)
    v_mfma_f32_16x16x32_bf16 v[20:23], a[80:83], v[64:67], v[48:51]
    v_exp_f32 v30, v30
    v_mfma_f32_16x16x32_bf16 v[20:23], a[84:87], v[68:71], v[20:23]
    v_perm_b32 v46, v29, v28, s100
    v_mfma_f32_16x16x32_bf16 v[20:23], a[88:91], v[72:75], v[20:23]
    v_exp_f32 v31, v31
    v_mfma_f32_16x16x32_bf16 v[20:23], a[92:95], v[76:79], v[20:23]
    s_waitcnt lgkmcnt(4)
    v_mfma_f32_16x16x32_bf16 v[24:27], a[96:99], v[64:67], v[48:51]
    v_exp_f32 v16, v16
    v_mfma_f32_16x16x32_bf16 v[24:27], a[100:103], v[68:71], v[24:27]
    v_perm_b32 v47, v31, v30, s100
    v_mfma_f32_16x16x32_bf16 v[24:27], a[104:107], v[72:75], v[24:27]
    v_exp_f32 v17, v17
    v_mfma_f32_16x16x32_bf16 v[24:27], a[108:111], v[76:79], v[24:27]
    s_waitcnt lgkmcnt(0)
    v_mfma_f32_16x16x32_bf16 v[28:31], a[112:115], v[64:67], v[48:51]
    v_exp_f32 v18, v18
    v_mfma_f32_16x16x32_bf16 v[28:31], a[116:119], v[68:71], v[28:31]
    v_perm_b32 v32, v17, v16, s100
    v_mfma_f32_16x16x32_bf16 v[28:31], a[120:123], v[72:75], v[28:31]
    v_exp_f32 v19, v19
    v_mfma_f32_16x16x32_bf16 v[28:31], a[124:127], v[76:79], v[28:31]
    s_waitcnt vmcnt(8)
    s_barrier
    v_mfma_f32_16x16x32_bf16 v[224:227], a[128:131], v[40:43], v[224:227]
    v_exp_f32 v20, v20
    v_mfma_f32_16x16x32_bf16 v[224:227], a[132:135], v[44:47], v[224:227]
    v_perm_b32 v33, v19, v18, s100
    v_mfma_f32_16x16x32_bf16 v[228:231], a[136:139], v[40:43], v[228:231]
    s_add_u32 m0, s44, 0
    v_exp_f32 v21, v21
    v_mfma_f32_16x16x32_bf16 v[228:231], a[140:143], v[44:47], v[228:231]
    s_mov_b32 s45, 256
    buffer_load_dwordx4 v7, s[28:31], s45 offen offset:0 lds
    v_mfma_f32_16x16x32_bf16 v[232:235], a[144:147], v[40:43], v[232:235]
    v_exp_f32 v22, v22
    v_mfma_f32_16x16x32_bf16 v[232:235], a[148:151], v[44:47], v[232:235]
    v_perm_b32 v34, v21, v20, s100
    v_mfma_f32_16x16x32_bf16 v[236:239], a[152:155], v[40:43], v[236:239]
    s_add_u32 m0, s44, -96
    v_exp_f32 v23, v23
    v_mfma_f32_16x16x32_bf16 v[236:239], a[156:159], v[44:47], v[236:239]
    buffer_load_dwordx4 v7, s[28:31], s45 offen offset:1152 lds
    v_mfma_f32_16x16x32_bf16 v[240:243], a[160:163], v[40:43], v[240:243]
    v_exp_f32 v24, v24
    v_mfma_f32_16x16x32_bf16 v[240:243], a[164:167], v[44:47], v[240:243]
    v_perm_b32 v35, v23, v22, s100
    v_mfma_f32_16x16x32_bf16 v[244:247], a[168:171], v[40:43], v[244:247]
    s_add_u32 m0, s44, -192
    v_exp_f32 v25, v25
    v_mfma_f32_16x16x32_bf16 v[244:247], a[172:175], v[44:47], v[244:247]
    buffer_load_dwordx4 v7, s[28:31], s45 offen offset:2304 lds
    v_mfma_f32_16x16x32_bf16 v[248:251], a[176:179], v[40:43], v[248:251]
    v_exp_f32 v26, v26
    v_mfma_f32_16x16x32_bf16 v[248:251], a[180:183], v[44:47], v[248:251]
    v_perm_b32 v36, v25, v24, s100
    v_mfma_f32_16x16x32_bf16 v[252:255], a[184:187], v[40:43], v[252:255]
    s_add_u32 m0, s44, -288
    v_exp_f32 v27, v27
    v_mfma_f32_16x16x32_bf16 v[252:255], a[188:191], v[44:47], v[252:255]
    buffer_load_dwordx4 v7, s[28:31], s45 offen offset:3456 lds
    v_smfmac_f32_16x16x64_bf16 a[12:15], a[16:19], v[40:47], v11
    v_mfma_f32_16x16x32_bf16 v[16:19], a[64:67], v[80:83], v[52:55]
    v_exp_f32 v28, v28
    v_mfma_f32_16x16x32_bf16 v[16:19], a[68:71], v[84:87], v[16:19]
    v_perm_b32 v37, v27, v26, s100
    v_mfma_f32_16x16x32_bf16 v[16:19], a[72:75], v[88:91], v[16:19]
    s_add_u32 m0, s44, 16896
    v_exp_f32 v29, v29
    v_mfma_f32_16x16x32_bf16 v[16:19], a[76:79], v[92:95], v[16:19]
    s_mov_b32 s45, 147712
    buffer_load_dwordx4 v7, s[28:31], s45 offen offset:0 lds
    v_mfma_f32_16x16x32_bf16 v[20:23], a[80:83], v[80:83], v[52:55]
    v_exp_f32 v30, v30
    v_mfma_f32_16x16x32_bf16 v[20:23], a[84:87], v[84:87], v[20:23]
    v_perm_b32 v38, v29, v28, s100
    v_mfma_f32_16x16x32_bf16 v[20:23], a[88:91], v[88:91], v[20:23]
    s_add_u32 m0, s44, 16800
    v_exp_f32 v31, v31
    v_mfma_f32_16x16x32_bf16 v[20:23], a[92:95], v[92:95], v[20:23]
    s_mov_b32 s15, 0x3f800000
    buffer_load_dwordx4 v7, s[28:31], s45 offen offset:1152 lds
    v_mfma_f32_16x16x32_bf16 v[24:27], a[96:99], v[80:83], v[52:55]
    v_exp_f32 v16, v16
    v_mfma_f32_16x16x32_bf16 v[24:27], a[100:103], v[84:87], v[24:27]
    v_perm_b32 v39, v31, v30, s100
    v_mfma_f32_16x16x32_bf16 v[24:27], a[104:107], v[88:91], v[24:27]
    s_add_u32 m0, s44, 16704
    v_exp_f32 v17, v17
    v_mfma_f32_16x16x32_bf16 v[24:27], a[108:111], v[92:95], v[24:27]
    buffer_load_dwordx4 v7, s[28:31], s45 offen offset:2304 lds
    v_mfma_f32_16x16x32_bf16 v[28:31], a[112:115], v[80:83], v[52:55]
    v_exp_f32 v18, v18
    v_mfma_f32_16x16x32_bf16 v[28:31], a[116:119], v[84:87], v[28:31]
    v_perm_b32 v40, v17, v16, s100
    v_mfma_f32_16x16x32_bf16 v[28:31], a[120:123], v[88:91], v[28:31]
    s_add_u32 m0, s44, 16608
    v_exp_f32 v19, v19
    v_mfma_f32_16x16x32_bf16 v[28:31], a[124:127], v[92:95], v[28:31]
    buffer_load_dwordx4 v7, s[28:31], s45 offen offset:3456 lds
    v_mfma_f32_16x16x32_bf16 v[128:131], a[192:195], v[32:35], v[128:131]
    v_exp_f32 v20, v20
    v_mfma_f32_16x16x32_bf16 v[128:131], a[196:199], v[36:39], v[128:131]
    v_perm_b32 v41, v19, v18, s100
    v_mfma_f32_16x16x32_bf16 v[132:135], a[200:203], v[32:35], v[132:135]
    s_mov_b32 s54, 0
    v_exp_f32 v21, v21
    v_mfma_f32_16x16x32_bf16 v[132:135], a[204:207], v[36:39], v[132:135]
    buffer_load_dwordx4 a[128:131], v6, s[68:71], s54 offen
    v_mfma_f32_16x16x32_bf16 v[136:139], a[208:211], v[32:35], v[136:139]
    v_exp_f32 v22, v22
    v_mfma_f32_16x16x32_bf16 v[136:139], a[212:215], v[36:39], v[136:139]
    v_perm_b32 v42, v21, v20, s100
    v_mfma_f32_16x16x32_bf16 v[140:143], a[216:219], v[32:35], v[140:143]
    s_add_u32 s54, s55, 0
    v_exp_f32 v23, v23
    v_mfma_f32_16x16x32_bf16 v[140:143], a[220:223], v[36:39], v[140:143]
    buffer_load_dwordx4 a[164:167], v8, s[72:75], s54 offen
    v_mfma_f32_16x16x32_bf16 v[144:147], a[224:227], v[32:35], v[144:147]
    v_exp_f32 v24, v24
    v_mfma_f32_16x16x32_bf16 v[144:147], a[228:231], v[36:39], v[144:147]
    v_perm_b32 v43, v23, v22, s100
    v_mfma_f32_16x16x32_bf16 v[148:151], a[232:235], v[32:35], v[148:151]
    s_mov_b32 s54, 147456
    v_exp_f32 v25, v25
    v_mfma_f32_16x16x32_bf16 v[148:151], a[236:239], v[36:39], v[148:151]
    buffer_load_dwordx4 a[132:135], v6, s[68:71], s54 offen
    v_mfma_f32_16x16x32_bf16 v[152:155], a[240:243], v[32:35], v[152:155]
    v_exp_f32 v26, v26
    v_mfma_f32_16x16x32_bf16 v[152:155], a[244:247], v[36:39], v[152:155]
    v_perm_b32 v44, v25, v24, s100
    v_mfma_f32_16x16x32_bf16 v[156:159], a[248:251], v[32:35], v[156:159]
    s_add_u32 s54, s55, 1024
    v_exp_f32 v27, v27
    v_mfma_f32_16x16x32_bf16 v[156:159], a[252:255], v[36:39], v[156:159]
    buffer_load_dwordx4 a[168:171], v8, s[72:75], s54 offen
    v_smfmac_f32_16x16x64_bf16 a[0:3], a[16:19], v[32:39], v11
    v_mfma_f32_16x16x32_bf16 v[16:19], a[64:67], v[96:99], v[56:59]
    v_exp_f32 v28, v28
    v_mfma_f32_16x16x32_bf16 v[16:19], a[68:71], v[100:103], v[16:19]
    v_perm_b32 v45, v27, v26, s100
    v_mfma_f32_16x16x32_bf16 v[16:19], a[72:75], v[104:107], v[16:19]
    s_mov_b32 s54, 294912
    v_exp_f32 v29, v29
    v_mfma_f32_16x16x32_bf16 v[16:19], a[76:79], v[108:111], v[16:19]
    buffer_load_dwordx4 a[136:139], v6, s[68:71], s54 offen
    v_mfma_f32_16x16x32_bf16 v[20:23], a[80:83], v[96:99], v[56:59]
    v_exp_f32 v30, v30
    v_mfma_f32_16x16x32_bf16 v[20:23], a[84:87], v[100:103], v[20:23]
    v_perm_b32 v46, v29, v28, s100
    v_accvgpr_read_b32 v12, a0
    v_mfma_f32_16x16x32_bf16 v[20:23], a[88:91], v[104:107], v[20:23]
    s_add_u32 s54, s55, 2048
    v_exp_f32 v31, v31
    v_mfma_f32_16x16x32_bf16 v[20:23], a[92:95], v[108:111], v[20:23]
    buffer_load_dwordx4 a[172:175], v8, s[72:75], s54 offen
    v_mfma_f32_16x16x32_bf16 v[24:27], a[96:99], v[96:99], v[56:59]
    v_exp_f32 v16, v16
    v_mfma_f32_16x16x32_bf16 v[24:27], a[100:103], v[100:103], v[24:27]
    v_perm_b32 v47, v31, v30, s100
    v_accvgpr_read_b32 v13, a1
    v_mfma_f32_16x16x32_bf16 v[24:27], a[104:107], v[104:107], v[24:27]
    s_mov_b32 s54, 442368
    v_exp_f32 v17, v17
    v_mfma_f32_16x16x32_bf16 v[24:27], a[108:111], v[108:111], v[24:27]
    buffer_load_dwordx4 a[140:143], v6, s[68:71], s54 offen
    v_mfma_f32_16x16x32_bf16 v[28:31], a[112:115], v[96:99], v[56:59]
    v_exp_f32 v18, v18
    v_mfma_f32_16x16x32_bf16 v[28:31], a[116:119], v[100:103], v[28:31]
    v_perm_b32 v32, v17, v16, s100
    v_add_f32 v12, v12, v13
    v_mfma_f32_16x16x32_bf16 v[28:31], a[120:123], v[104:107], v[28:31]
    s_add_u32 s54, s55, 3072
    v_exp_f32 v19, v19
    v_mfma_f32_16x16x32_bf16 v[28:31], a[124:127], v[108:111], v[28:31]
    buffer_load_dwordx4 a[176:179], v8, s[72:75], s54 offen
    v_mfma_f32_16x16x32_bf16 v[160:163], a[192:195], v[40:43], v[160:163]
    v_exp_f32 v20, v20
    v_mfma_f32_16x16x32_bf16 v[160:163], a[196:199], v[44:47], v[160:163]
    v_perm_b32 v33, v19, v18, s100
    v_subrev_u32 v13, 0x1e000000, v12
    v_mfma_f32_16x16x32_bf16 v[164:167], a[200:203], v[40:43], v[164:167]
    s_mov_b32 s54, 589824
    v_exp_f32 v21, v21
    v_mfma_f32_16x16x32_bf16 v[164:167], a[204:207], v[44:47], v[164:167]
    buffer_load_dwordx4 a[144:147], v6, s[68:71], s54 offen
    v_mfma_f32_16x16x32_bf16 v[168:171], a[208:211], v[40:43], v[168:171]
    v_exp_f32 v22, v22
    v_mfma_f32_16x16x32_bf16 v[168:171], a[212:215], v[44:47], v[168:171]
    v_perm_b32 v34, v21, v20, s100
    v_cmp_gt_u32 s[56:57], v13, s15
    v_mfma_f32_16x16x32_bf16 v[172:175], a[216:219], v[40:43], v[172:175]
    s_add_u32 s54, s55, 4096
    v_exp_f32 v23, v23
    v_mfma_f32_16x16x32_bf16 v[172:175], a[220:223], v[44:47], v[172:175]
    buffer_load_dwordx4 a[180:183], v8, s[72:75], s54 offen
    v_mfma_f32_16x16x32_bf16 v[176:179], a[224:227], v[40:43], v[176:179]
    v_exp_f32 v24, v24
    v_mfma_f32_16x16x32_bf16 v[176:179], a[228:231], v[44:47], v[176:179]
    v_perm_b32 v35, v23, v22, s100
    v_mfma_f32_16x16x32_bf16 v[180:183], a[232:235], v[40:43], v[180:183]
    s_mov_b32 s54, 737280
    v_exp_f32 v25, v25
    v_mfma_f32_16x16x32_bf16 v[180:183], a[236:239], v[44:47], v[180:183]
    buffer_load_dwordx4 a[148:151], v6, s[68:71], s54 offen
    v_mfma_f32_16x16x32_bf16 v[184:187], a[240:243], v[40:43], v[184:187]
    v_exp_f32 v26, v26
    v_mfma_f32_16x16x32_bf16 v[184:187], a[244:247], v[44:47], v[184:187]
    v_perm_b32 v36, v25, v24, s100
    v_mfma_f32_16x16x32_bf16 v[188:191], a[248:251], v[40:43], v[188:191]
    s_add_u32 s54, s55, 5120
    v_exp_f32 v27, v27
    v_mfma_f32_16x16x32_bf16 v[188:191], a[252:255], v[44:47], v[188:191]
    buffer_load_dwordx4 a[184:187], v8, s[72:75], s54 offen
    v_smfmac_f32_16x16x64_bf16 a[4:7], a[16:19], v[40:47], v11
    v_rcp_f32 v12, v12
    v_mfma_f32_16x16x32_bf16 v[16:19], a[64:67], v[112:115], v[60:63]
    v_exp_f32 v28, v28
    v_mfma_f32_16x16x32_bf16 v[16:19], a[68:71], v[116:119], v[16:19]
    v_perm_b32 v37, v27, v26, s100
    v_mul_f32 v128, v128, v12
    v_mfma_f32_16x16x32_bf16 v[16:19], a[72:75], v[120:123], v[16:19]
    s_mov_b32 s54, 884736
    v_exp_f32 v29, v29
    v_mfma_f32_16x16x32_bf16 v[16:19], a[76:79], v[124:127], v[16:19]
    buffer_load_dwordx4 a[152:155], v6, s[68:71], s54 offen
    v_mfma_f32_16x16x32_bf16 v[20:23], a[80:83], v[112:115], v[60:63]
    v_exp_f32 v30, v30
    v_mfma_f32_16x16x32_bf16 v[20:23], a[84:87], v[116:119], v[20:23]
    v_perm_b32 v38, v29, v28, s100
    v_mul_f32 v129, v129, v12
    v_mfma_f32_16x16x32_bf16 v[20:23], a[88:91], v[120:123], v[20:23]
    s_add_u32 s54, s55, 6144
    v_exp_f32 v31, v31
    v_mfma_f32_16x16x32_bf16 v[20:23], a[92:95], v[124:127], v[20:23]
    buffer_load_dwordx4 a[188:191], v8, s[72:75], s54 offen
    v_mfma_f32_16x16x32_bf16 v[24:27], a[96:99], v[112:115], v[60:63]
    v_exp_f32 v16, v16
    v_mfma_f32_16x16x32_bf16 v[24:27], a[100:103], v[116:119], v[24:27]
    v_perm_b32 v39, v31, v30, s100
    v_mul_f32 v130, v130, v12
    v_mfma_f32_16x16x32_bf16 v[24:27], a[104:107], v[120:123], v[24:27]
    s_mov_b32 s54, 1032192
    v_exp_f32 v17, v17
    v_mfma_f32_16x16x32_bf16 v[24:27], a[108:111], v[124:127], v[24:27]
    buffer_load_dwordx4 a[156:159], v6, s[68:71], s54 offen
    v_mfma_f32_16x16x32_bf16 v[28:31], a[112:115], v[112:115], v[60:63]
    v_exp_f32 v18, v18
    v_mfma_f32_16x16x32_bf16 v[28:31], a[116:119], v[116:119], v[28:31]
    v_perm_b32 v40, v17, v16, s100
    v_mul_f32 v131, v131, v12
    v_mfma_f32_16x16x32_bf16 v[28:31], a[120:123], v[120:123], v[28:31]
    s_mov_b32 s54, 1179648
    v_exp_f32 v19, v19
    v_mfma_f32_16x16x32_bf16 v[28:31], a[124:127], v[124:127], v[28:31]
    buffer_load_dwordx4 a[160:163], v6, s[68:71], s54 offen
    v_mfma_f32_16x16x32_bf16 v[192:195], a[192:195], v[32:35], v[192:195]
    v_exp_f32 v20, v20
    v_mfma_f32_16x16x32_bf16 v[192:195], a[196:199], v[36:39], v[192:195]
    v_perm_b32 v41, v19, v18, s100
    v_mul_f32 v132, v132, v12
    v_mfma_f32_16x16x32_bf16 v[196:199], a[200:203], v[32:35], v[196:199]
    v_exp_f32 v21, v21
    v_mfma_f32_16x16x32_bf16 v[196:199], a[204:207], v[36:39], v[196:199]
    v_mul_f32 v133, v133, v12
    v_mul_f32 v134, v134, v12
    v_mfma_f32_16x16x32_bf16 v[200:203], a[208:211], v[32:35], v[200:203]
    v_exp_f32 v22, v22
    v_mfma_f32_16x16x32_bf16 v[200:203], a[212:215], v[36:39], v[200:203]
    v_perm_b32 v42, v21, v20, s100
    v_mul_f32 v135, v135, v12
    v_mfma_f32_16x16x32_bf16 v[204:207], a[216:219], v[32:35], v[204:207]
    v_exp_f32 v23, v23
    v_mfma_f32_16x16x32_bf16 v[204:207], a[220:223], v[36:39], v[204:207]
    v_cvt_pk_bf16_f32 v128, v128, v129
    v_cvt_pk_bf16_f32 v129, v130, v131
    v_mfma_f32_16x16x32_bf16 v[208:211], a[224:227], v[32:35], v[208:211]
    v_exp_f32 v24, v24
    v_mfma_f32_16x16x32_bf16 v[208:211], a[228:231], v[36:39], v[208:211]
    v_perm_b32 v43, v23, v22, s100
    v_cvt_pk_bf16_f32 v130, v132, v133
    v_mfma_f32_16x16x32_bf16 v[212:215], a[232:235], v[32:35], v[212:215]
    v_exp_f32 v25, v25
    v_mfma_f32_16x16x32_bf16 v[212:215], a[236:239], v[36:39], v[212:215]
    v_cvt_pk_bf16_f32 v131, v134, v135
    v_mul_f32 v136, v136, v12
    v_mfma_f32_16x16x32_bf16 v[216:219], a[240:243], v[32:35], v[216:219]
    v_exp_f32 v26, v26
    v_mfma_f32_16x16x32_bf16 v[216:219], a[244:247], v[36:39], v[216:219]
    v_perm_b32 v44, v25, v24, s100
    v_mul_f32 v137, v137, v12
    v_mfma_f32_16x16x32_bf16 v[220:223], a[248:251], v[32:35], v[220:223]
    v_exp_f32 v27, v27
    v_mfma_f32_16x16x32_bf16 v[220:223], a[252:255], v[36:39], v[220:223]
    v_mul_f32 v138, v138, v12
    v_mul_f32 v139, v139, v12
    v_smfmac_f32_16x16x64_bf16 a[8:11], a[16:19], v[32:39], v11
    v_mul_f32 v140, v140, v12
    v_mul_f32 v141, v141, v12
    v_exp_f32 v28, v28
    s_nop 0
    v_perm_b32 v45, v27, v26, s100
    v_exp_f32 v29, v29
    s_nop 0
    v_exp_f32 v30, v30
    s_nop 0
    v_perm_b32 v46, v29, v28, s100
    v_exp_f32 v31, v31
    s_nop 0
    v_perm_b32 v47, v31, v30, s100
    s_nop 1
    v_mfma_f32_16x16x32_bf16 v[224:227], a[192:195], v[40:43], v[224:227]
    v_mul_f32 v142, v142, v12
    v_mul_f32 v143, v143, v12
    v_mfma_f32_16x16x32_bf16 v[224:227], a[196:199], v[44:47], v[224:227]
    ds_read_b64_tr_b16 a[64:65], v4 offset:0
    ds_read_b64_tr_b16 a[66:67], v4 offset:128
    v_mfma_f32_16x16x32_bf16 v[228:231], a[200:203], v[40:43], v[228:231]
    ds_read_b64_tr_b16 a[68:69], v4 offset:256
    ds_read_b64_tr_b16 a[70:71], v4 offset:384
    v_mfma_f32_16x16x32_bf16 v[228:231], a[204:207], v[44:47], v[228:231]
    ds_read_b64_tr_b16 a[72:73], v4 offset:512
    ds_read_b64_tr_b16 a[74:75], v4 offset:640
    v_mfma_f32_16x16x32_bf16 v[232:235], a[208:211], v[40:43], v[232:235]
    ds_read_b64_tr_b16 a[76:77], v4 offset:768
    ds_read_b64_tr_b16 a[78:79], v4 offset:896
    v_mfma_f32_16x16x32_bf16 v[232:235], a[212:215], v[44:47], v[232:235]
    ds_read_b64_tr_b16 a[80:81], v4 offset:16896
    ds_read_b64_tr_b16 a[82:83], v4 offset:17024
    v_mfma_f32_16x16x32_bf16 v[236:239], a[216:219], v[40:43], v[236:239]
    ds_read_b64_tr_b16 a[84:85], v4 offset:17152
    ds_read_b64_tr_b16 a[86:87], v4 offset:17280
    v_mfma_f32_16x16x32_bf16 v[236:239], a[220:223], v[44:47], v[236:239]
    ds_read_b64_tr_b16 a[88:89], v4 offset:17408
    ds_read_b64_tr_b16 a[90:91], v4 offset:17536
    v_mfma_f32_16x16x32_bf16 v[240:243], a[224:227], v[40:43], v[240:243]
    ds_read_b64_tr_b16 a[92:93], v4 offset:17664
    ds_read_b64_tr_b16 a[94:95], v4 offset:17792
    v_mfma_f32_16x16x32_bf16 v[240:243], a[228:231], v[44:47], v[240:243]
    v_cvt_pk_bf16_f32 v136, v136, v137
    v_cvt_pk_bf16_f32 v137, v138, v139
    v_mfma_f32_16x16x32_bf16 v[244:247], a[232:235], v[40:43], v[244:247]
    v_cvt_pk_bf16_f32 v138, v140, v141
    v_cvt_pk_bf16_f32 v139, v142, v143
    v_mfma_f32_16x16x32_bf16 v[244:247], a[236:239], v[44:47], v[244:247]
    v_mul_f32 v144, v144, v12
    v_mul_f32 v145, v145, v12
    v_mfma_f32_16x16x32_bf16 v[248:251], a[240:243], v[40:43], v[248:251]
    v_mul_f32 v146, v146, v12
    v_mul_f32 v147, v147, v12
    v_mfma_f32_16x16x32_bf16 v[248:251], a[244:247], v[44:47], v[248:251]
    v_mul_f32 v148, v148, v12
    v_mul_f32 v149, v149, v12
    v_mfma_f32_16x16x32_bf16 v[252:255], a[248:251], v[40:43], v[252:255]
    v_mul_f32 v150, v150, v12
    v_mul_f32 v151, v151, v12
    v_mfma_f32_16x16x32_bf16 v[252:255], a[252:255], v[44:47], v[252:255]
    v_cvt_pk_bf16_f32 v144, v144, v145
    v_cvt_pk_bf16_f32 v145, v146, v147
    v_smfmac_f32_16x16x64_bf16 a[12:15], a[16:19], v[40:47], v11
    v_cvt_pk_bf16_f32 v146, v148, v149
    v_cvt_pk_bf16_f32 v147, v150, v151
    v_mul_f32 v152, v152, v12
    v_mul_f32 v153, v153, v12
    v_mul_f32 v154, v154, v12
    v_mul_f32 v155, v155, v12
    v_mul_f32 v156, v156, v12
    v_mul_f32 v157, v157, v12
    v_mul_f32 v158, v158, v12
    v_mul_f32 v159, v159, v12
    v_cvt_pk_bf16_f32 v152, v152, v153
    v_cvt_pk_bf16_f32 v153, v154, v155
    v_cvt_pk_bf16_f32 v154, v156, v157
    v_cvt_pk_bf16_f32 v155, v158, v159
    v_accvgpr_read_b32 v14, a4
    v_accvgpr_read_b32 v15, a5
    v_add_f32 v14, v14, v15
    v_subrev_u32 v15, 0x1e000000, v14
    v_cmp_gt_u32 s[58:59], v15, s15
    v_rcp_f32 v14, v14
    v_accvgpr_read_b32 v12, a8
    v_accvgpr_read_b32 v13, a9
    v_add_f32 v12, v12, v13
    v_subrev_u32 v13, 0x1e000000, v12
    v_cmp_gt_u32 s[60:61], v13, s15
    v_rcp_f32 v12, v12
    v_pk_mul_f32 v[160:161], v[160:161], v[14:15] op_sel_hi:[1,0]
    v_pk_mul_f32 v[162:163], v[162:163], v[14:15] op_sel_hi:[1,0]
    v_pk_mul_f32 v[164:165], v[164:165], v[14:15] op_sel_hi:[1,0]
    v_pk_mul_f32 v[166:167], v[166:167], v[14:15] op_sel_hi:[1,0]
    v_cvt_pk_bf16_f32 v160, v160, v161
    v_cvt_pk_bf16_f32 v161, v162, v163
    v_cvt_pk_bf16_f32 v162, v164, v165
    v_cvt_pk_bf16_f32 v163, v166, v167
    v_pk_mul_f32 v[168:169], v[168:169], v[14:15] op_sel_hi:[1,0]
    v_pk_mul_f32 v[170:171], v[170:171], v[14:15] op_sel_hi:[1,0]
    v_pk_mul_f32 v[172:173], v[172:173], v[14:15] op_sel_hi:[1,0]
    v_pk_mul_f32 v[174:175], v[174:175], v[14:15] op_sel_hi:[1,0]
    v_cvt_pk_bf16_f32 v168, v168, v169
    v_cvt_pk_bf16_f32 v169, v170, v171
    v_cvt_pk_bf16_f32 v170, v172, v173
    v_cvt_pk_bf16_f32 v171, v174, v175
    v_pk_mul_f32 v[176:177], v[176:177], v[14:15] op_sel_hi:[1,0]
    v_pk_mul_f32 v[178:179], v[178:179], v[14:15] op_sel_hi:[1,0]
    v_pk_mul_f32 v[180:181], v[180:181], v[14:15] op_sel_hi:[1,0]
    v_pk_mul_f32 v[182:183], v[182:183], v[14:15] op_sel_hi:[1,0]
    v_cvt_pk_bf16_f32 v176, v176, v177
    v_cvt_pk_bf16_f32 v177, v178, v179
    v_cvt_pk_bf16_f32 v178, v180, v181
    v_cvt_pk_bf16_f32 v179, v182, v183
    v_pk_mul_f32 v[184:185], v[184:185], v[14:15] op_sel_hi:[1,0]
    v_pk_mul_f32 v[186:187], v[186:187], v[14:15] op_sel_hi:[1,0]
    v_pk_mul_f32 v[188:189], v[188:189], v[14:15] op_sel_hi:[1,0]
    v_pk_mul_f32 v[190:191], v[190:191], v[14:15] op_sel_hi:[1,0]
    v_cvt_pk_bf16_f32 v184, v184, v185
    v_cvt_pk_bf16_f32 v185, v186, v187
    v_cvt_pk_bf16_f32 v186, v188, v189
    v_cvt_pk_bf16_f32 v187, v190, v191
    v_accvgpr_read_b32 v14, a12
    v_accvgpr_read_b32 v15, a13
    v_add_f32 v14, v14, v15
    v_subrev_u32 v15, 0x1e000000, v14
    v_cmp_gt_u32 s[62:63], v15, s15
    s_or_b64 s[56:57], s[56:57], s[58:59]
    v_rcp_f32 v14, v14
    s_or_b64 s[60:61], s[60:61], s[62:63]
    s_or_b64 s[56:57], s[56:57], s[60:61]
    s_lshl2_add_u32 s14, s51, 13824
    v_mov_b32 v57, s14
    v_mov_b32 v58, 13824
    v_pk_mul_f32 v[192:193], v[192:193], v[12:13] op_sel_hi:[1,0]
    v_pk_mul_f32 v[194:195], v[194:195], v[12:13] op_sel_hi:[1,0]
    v_pk_mul_f32 v[196:197], v[196:197], v[12:13] op_sel_hi:[1,0]
    v_pk_mul_f32 v[198:199], v[198:199], v[12:13] op_sel_hi:[1,0]
    v_cvt_pk_bf16_f32 v192, v192, v193
    v_cvt_pk_bf16_f32 v193, v194, v195
    v_cvt_pk_bf16_f32 v194, v196, v197
    v_cvt_pk_bf16_f32 v195, v198, v199
    v_pk_mul_f32 v[200:201], v[200:201], v[12:13] op_sel_hi:[1,0]
    v_pk_mul_f32 v[202:203], v[202:203], v[12:13] op_sel_hi:[1,0]
    v_pk_mul_f32 v[204:205], v[204:205], v[12:13] op_sel_hi:[1,0]
    v_pk_mul_f32 v[206:207], v[206:207], v[12:13] op_sel_hi:[1,0]
    v_cvt_pk_bf16_f32 v200, v200, v201
    v_cvt_pk_bf16_f32 v201, v202, v203
    v_cvt_pk_bf16_f32 v202, v204, v205
    v_cvt_pk_bf16_f32 v203, v206, v207
    v_pk_mul_f32 v[208:209], v[208:209], v[12:13] op_sel_hi:[1,0]
    v_pk_mul_f32 v[210:211], v[210:211], v[12:13] op_sel_hi:[1,0]
    v_pk_mul_f32 v[212:213], v[212:213], v[12:13] op_sel_hi:[1,0]
    v_pk_mul_f32 v[214:215], v[214:215], v[12:13] op_sel_hi:[1,0]
    v_cvt_pk_bf16_f32 v208, v208, v209
    v_cvt_pk_bf16_f32 v209, v210, v211
    v_cvt_pk_bf16_f32 v210, v212, v213
    v_cvt_pk_bf16_f32 v211, v214, v215
    v_pk_mul_f32 v[216:217], v[216:217], v[12:13] op_sel_hi:[1,0]
    v_pk_mul_f32 v[218:219], v[218:219], v[12:13] op_sel_hi:[1,0]
    v_pk_mul_f32 v[220:221], v[220:221], v[12:13] op_sel_hi:[1,0]
    v_pk_mul_f32 v[222:223], v[222:223], v[12:13] op_sel_hi:[1,0]
    v_cvt_pk_bf16_f32 v216, v216, v217
    v_cvt_pk_bf16_f32 v217, v218, v219
    v_cvt_pk_bf16_f32 v218, v220, v221
    v_cvt_pk_bf16_f32 v219, v222, v223
    v_pk_mul_f32 v[224:225], v[224:225], v[14:15] op_sel_hi:[1,0]
    v_pk_mul_f32 v[226:227], v[226:227], v[14:15] op_sel_hi:[1,0]
    v_pk_mul_f32 v[228:229], v[228:229], v[14:15] op_sel_hi:[1,0]
    v_pk_mul_f32 v[230:231], v[230:231], v[14:15] op_sel_hi:[1,0]
    v_cvt_pk_bf16_f32 v224, v224, v225
    v_cvt_pk_bf16_f32 v225, v226, v227
    v_cvt_pk_bf16_f32 v226, v228, v229
    v_cvt_pk_bf16_f32 v227, v230, v231
    v_pk_mul_f32 v[232:233], v[232:233], v[14:15] op_sel_hi:[1,0]
    v_pk_mul_f32 v[234:235], v[234:235], v[14:15] op_sel_hi:[1,0]
L2_pad10:
    s_cbranch_execz L2_pad14
    v_pk_mul_f32 v[236:237], v[236:237], v[14:15] op_sel_hi:[1,0]
    v_pk_mul_f32 v[238:239], v[238:239], v[14:15] op_sel_hi:[1,0]
    v_cvt_pk_bf16_f32 v232, v232, v233
    v_cvt_pk_bf16_f32 v233, v234, v235
    v_cvt_pk_bf16_f32 v234, v236, v237
    v_cvt_pk_bf16_f32 v235, v238, v239
    v_pk_mul_f32 v[240:241], v[240:241], v[14:15] op_sel_hi:[1,0]
    v_pk_mul_f32 v[242:243], v[242:243], v[14:15] op_sel_hi:[1,0]
    v_pk_mul_f32 v[244:245], v[244:245], v[14:15] op_sel_hi:[1,0]
    v_pk_mul_f32 v[246:247], v[246:247], v[14:15] op_sel_hi:[1,0]
    v_cvt_pk_bf16_f32 v240, v240, v241
    v_cvt_pk_bf16_f32 v241, v242, v243
    v_cvt_pk_bf16_f32 v242, v244, v245
    v_cvt_pk_bf16_f32 v243, v246, v247
    v_pk_mul_f32 v[248:249], v[248:249], v[14:15] op_sel_hi:[1,0]
    v_pk_mul_f32 v[250:251], v[250:251], v[14:15] op_sel_hi:[1,0]
    v_pk_mul_f32 v[252:253], v[252:253], v[14:15] op_sel_hi:[1,0]
    v_pk_mul_f32 v[254:255], v[254:255], v[14:15] op_sel_hi:[1,0]
    v_cvt_pk_bf16_f32 v248, v248, v249
    v_cvt_pk_bf16_f32 v249, v250, v251
    v_cvt_pk_bf16_f32 v250, v252, v253
    v_cvt_pk_bf16_f32 v251, v254, v255
    s_waitcnt lgkmcnt(12)
    v_mfma_f32_16x16x32_bf16 v[16:19], a[64:67], v[128:131], 0
    ds_read_b64_tr_b16 a[96:97], v4 offset:32
    ds_read_b64_tr_b16 a[98:99], v4 offset:160
    v_mfma_f32_16x16x32_bf16 v[16:19], a[68:71], v[136:139], v[16:19]
    s_waitcnt lgkmcnt(10)
    ds_read_b64_tr_b16 a[100:101], v4 offset:288
    ds_read_b64_tr_b16 a[102:103], v4 offset:416
    v_mfma_f32_16x16x32_bf16 v[16:19], a[72:75], v[144:147], v[16:19]
    s_add_u32 s54, s55, 7168
    s_cmp_lg_u64 s[56:57], 0
    s_cselect_b32 s3, 1, 0
    ds_read_b64_tr_b16 a[104:105], v4 offset:544
    v_mfma_f32_16x16x32_bf16 v[16:19], a[76:79], v[152:155], v[16:19]
    s_waitcnt lgkmcnt(9)
    buffer_load_dwordx4 a[192:195], v8, s[72:75], s54 offen
    v_mfma_f32_16x16x32_bf16 v[16:19], a[80:83], v[192:195], v[16:19]
    s_andn2_b32 s3, s3, s50
    ds_read_b64_tr_b16 a[106:107], v4 offset:672
    v_mfma_f32_16x16x32_bf16 v[16:19], a[84:87], v[200:203], v[16:19]
    s_waitcnt lgkmcnt(6)
    ds_read_b64_tr_b16 a[108:109], v4 offset:800
    v_mfma_f32_16x16x32_bf16 v[16:19], a[88:91], v[208:211], v[16:19]
    s_add_u32 s54, s55, 8192
    ds_read_b64_tr_b16 a[110:111], v4 offset:928
    v_mfma_f32_16x16x32_bf16 v[16:19], a[92:95], v[216:219], v[16:19]
    buffer_load_dwordx4 a[196:199], v8, s[72:75], s54 offen
    v_mfma_f32_16x16x32_bf16 v[20:23], a[64:67], v[160:163], 0
    ds_read_b64_tr_b16 a[112:113], v4 offset:16928
    v_mfma_f32_16x16x32_bf16 v[20:23], a[68:71], v[168:171], v[20:23]
    ds_read_b64_tr_b16 a[114:115], v4 offset:17056
    v_mov_b32 v56, s3
    v_mfma_f32_16x16x32_bf16 v[20:23], a[72:75], v[176:179], v[20:23]
    ds_read_b64_tr_b16 a[116:117], v4 offset:17184
    v_mfma_f32_16x16x32_bf16 v[20:23], a[76:79], v[184:187], v[20:23]
    ds_read_b64_tr_b16 a[118:119], v4 offset:17312
    v_mfma_f32_16x16x32_bf16 v[20:23], a[80:83], v[224:227], v[20:23]
    ds_read_b64_tr_b16 a[120:121], v4 offset:17440
    v_mfma_f32_16x16x32_bf16 v[20:23], a[84:87], v[232:235], v[20:23]
    ds_read_b64_tr_b16 a[122:123], v4 offset:17568
    v_mfma_f32_16x16x32_bf16 v[20:23], a[88:91], v[240:243], v[20:23]
    ds_read_b64_tr_b16 a[124:125], v4 offset:17696
    v_mfma_f32_16x16x32_bf16 v[20:23], a[92:95], v[248:251], v[20:23]
    s_waitcnt lgkmcnt(11)
    ds_read_b64_tr_b16 a[126:127], v4 offset:17824
    ds_write_b32 v57, v56
    v_mfma_f32_16x16x32_bf16 v[24:27], a[96:99], v[128:131], 0
    ds_read_b64_tr_b16 a[64:65], v4 offset:64
    v_mfma_f32_16x16x32_bf16 v[24:27], a[100:103], v[136:139], v[24:27]
    s_waitcnt lgkmcnt(10)
    ds_read_b64_tr_b16 a[66:67], v4 offset:192
    v_mfma_f32_16x16x32_bf16 v[24:27], a[104:107], v[144:147], v[24:27]
    ds_read_b64_tr_b16 a[68:69], v4 offset:320
    v_mfma_f32_16x16x32_bf16 v[24:27], a[108:111], v[152:155], v[24:27]
    s_waitcnt lgkmcnt(8)
    ds_read_b64_tr_b16 a[70:71], v4 offset:448
    v_mfma_f32_16x16x32_bf16 v[24:27], a[112:115], v[192:195], v[24:27]
    ds_read_b64_tr_b16 a[72:73], v4 offset:576
    v_mfma_f32_16x16x32_bf16 v[24:27], a[116:119], v[200:203], v[24:27]
    s_waitcnt lgkmcnt(6)
    ds_read_b64_tr_b16 a[74:75], v4 offset:704
    v_mfma_f32_16x16x32_bf16 v[24:27], a[120:123], v[208:211], v[24:27]
    ds_read_b64_tr_b16 a[76:77], v4 offset:832
    v_mfma_f32_16x16x32_bf16 v[24:27], a[124:127], v[216:219], v[24:27]
    ds_read_b64_tr_b16 a[78:79], v4 offset:960
    v_mfma_f32_16x16x32_bf16 v[28:31], a[96:99], v[160:163], 0
    ds_read_b64_tr_b16 a[80:81], v4 offset:16960
    v_mfma_f32_16x16x32_bf16 v[28:31], a[100:103], v[168:171], v[28:31]
    ds_read_b64_tr_b16 a[82:83], v4 offset:17088
    v_mfma_f32_16x16x32_bf16 v[28:31], a[104:107], v[176:179], v[28:31]
    ds_read_b64_tr_b16 a[84:85], v4 offset:17216
    v_mfma_f32_16x16x32_bf16 v[28:31], a[108:111], v[184:187], v[28:31]
    ds_read_b64_tr_b16 a[86:87], v4 offset:17344
    v_mfma_f32_16x16x32_bf16 v[28:31], a[112:115], v[224:227], v[28:31]
    ds_read_b64_tr_b16 a[88:89], v4 offset:17472
    v_mfma_f32_16x16x32_bf16 v[28:31], a[116:119], v[232:235], v[28:31]
    ds_read_b64_tr_b16 a[90:91], v4 offset:17600
    v_mfma_f32_16x16x32_bf16 v[28:31], a[120:123], v[240:243], v[28:31]
    ds_read_b64_tr_b16 a[92:93], v4 offset:17728
    v_mfma_f32_16x16x32_bf16 v[28:31], a[124:127], v[248:251], v[28:31]
    s_waitcnt lgkmcnt(11)
    ds_read_b64_tr_b16 a[94:95], v4 offset:17856
    v_mfma_f32_16x16x32_bf16 v[32:35], a[64:67], v[128:131], 0
    ds_read_b64_tr_b16 a[96:97], v4 offset:96
    v_cvt_pk_bf16_f32 v48, v16, v17
    v_mfma_f32_16x16x32_bf16 v[32:35], a[68:71], v[136:139], v[32:35]
    s_waitcnt lgkmcnt(9)
    ds_read_b64_tr_b16 a[98:99], v4 offset:224
    v_cvt_pk_bf16_f32 v49, v18, v19
    v_mfma_f32_16x16x32_bf16 v[32:35], a[72:75], v[144:147], v[32:35]
    ds_read_b64_tr_b16 a[100:101], v4 offset:352
    v_cvt_pk_bf16_f32 v50, v24, v25
    v_mfma_f32_16x16x32_bf16 v[32:35], a[76:79], v[152:155], v[32:35]
    s_waitcnt lgkmcnt(7)
    ds_read_b64_tr_b16 a[102:103], v4 offset:480
    v_cvt_pk_bf16_f32 v51, v26, v27
    v_mfma_f32_16x16x32_bf16 v[32:35], a[80:83], v[192:195], v[32:35]
    s_mov_b32 s54, 0
    ds_read_b64_tr_b16 a[104:105], v4 offset:608
    ds_read_b64_tr_b16 a[106:107], v4 offset:736
    v_mfma_f32_16x16x32_bf16 v[32:35], a[84:87], v[200:203], v[32:35]
    s_waitcnt lgkmcnt(6)
    v_permlane32_swap_b32 v48, v50
    v_mfma_f32_16x16x32_bf16 v[32:35], a[88:91], v[208:211], v[32:35]
    v_permlane32_swap_b32 v49, v51
    v_mfma_f32_16x16x32_bf16 v[32:35], a[92:95], v[216:219], v[32:35]
    ds_read_b64_tr_b16 a[108:109], v4 offset:864
    ds_read_b64_tr_b16 a[110:111], v4 offset:992
    buffer_store_dwordx4 v[48:51], v10, s[40:43], s54 offen offset:0 sc1
    v_mfma_f32_16x16x32_bf16 v[36:39], a[64:67], v[160:163], 0
    ds_read_b64_tr_b16 a[112:113], v4 offset:16992
    v_cvt_pk_bf16_f32 v52, v20, v21
    v_mfma_f32_16x16x32_bf16 v[36:39], a[68:71], v[168:171], v[36:39]
    ds_read_b64_tr_b16 a[114:115], v4 offset:17120
    v_cvt_pk_bf16_f32 v53, v22, v23
    v_mfma_f32_16x16x32_bf16 v[36:39], a[72:75], v[176:179], v[36:39]
    ds_read_b64_tr_b16 a[116:117], v4 offset:17248
    v_cvt_pk_bf16_f32 v54, v28, v29
    v_mfma_f32_16x16x32_bf16 v[36:39], a[76:79], v[184:187], v[36:39]
    ds_read_b64_tr_b16 a[118:119], v4 offset:17376
    v_cvt_pk_bf16_f32 v55, v30, v31
    v_mfma_f32_16x16x32_bf16 v[36:39], a[80:83], v[224:227], v[36:39]
    s_mov_b32 s54, 294912
    ds_read_b64_tr_b16 a[120:121], v4 offset:17504
    ds_read_b64_tr_b16 a[122:123], v4 offset:17632
    v_mfma_f32_16x16x32_bf16 v[36:39], a[84:87], v[232:235], v[36:39]
    v_permlane32_swap_b32 v52, v54
    v_mfma_f32_16x16x32_bf16 v[36:39], a[88:91], v[240:243], v[36:39]
    v_permlane32_swap_b32 v53, v55
    v_mfma_f32_16x16x32_bf16 v[36:39], a[92:95], v[248:251], v[36:39]
    s_barrier
    s_waitcnt lgkmcnt(10)
    ds_read_b64_tr_b16 a[124:125], v4 offset:17760
    ds_read_b64_tr_b16 a[126:127], v4 offset:17888
    ds_read_b128 v[60:63], v58
    buffer_store_dwordx4 v[52:55], v10, s[40:43], s54 offen offset:0 sc1
    v_mfma_f32_16x16x32_bf16 v[40:43], a[96:99], v[128:131], 0
    s_add_u32 m0, s44, 36864
    ds_read_b64_tr_b16 a[64:65], v4 offset:36864
    ds_read_b64_tr_b16 a[66:67], v4 offset:36992
    v_mfma_f32_16x16x32_bf16 v[40:43], a[100:103], v[136:139], v[40:43]
    s_mov_b32 s45, 384
    s_waitcnt lgkmcnt(11)
    buffer_load_dwordx4 v7, s[28:31], s45 offen offset:0 lds
    v_mfma_f32_16x16x32_bf16 v[40:43], a[104:107], v[144:147], v[40:43]
    s_add_u32 m0, s44, 36768
    ds_read_b64_tr_b16 a[68:69], v4 offset:37120
    ds_read_b64_tr_b16 a[70:71], v4 offset:37248
    v_mfma_f32_16x16x32_bf16 v[40:43], a[108:111], v[152:155], v[40:43]
    s_waitcnt lgkmcnt(9)
    buffer_load_dwordx4 v7, s[28:31], s45 offen offset:1152 lds
    v_mfma_f32_16x16x32_bf16 v[40:43], a[112:115], v[192:195], v[40:43]
    s_add_u32 m0, s44, 36672
    ds_read_b64_tr_b16 a[72:73], v4 offset:37376
    ds_read_b64_tr_b16 a[74:75], v4 offset:37504
    v_mfma_f32_16x16x32_bf16 v[40:43], a[116:119], v[200:203], v[40:43]
    s_waitcnt lgkmcnt(7)
    buffer_load_dwordx4 v7, s[28:31], s45 offen offset:2304 lds
    v_mfma_f32_16x16x32_bf16 v[40:43], a[120:123], v[208:211], v[40:43]
    s_add_u32 m0, s44, 36576
    ds_read_b64_tr_b16 a[76:77], v4 offset:37632
    ds_read_b64_tr_b16 a[78:79], v4 offset:37760
    v_mfma_f32_16x16x32_bf16 v[40:43], a[124:127], v[216:219], v[40:43]
    s_waitcnt lgkmcnt(8)
    buffer_load_dwordx4 v7, s[28:31], s45 offen offset:3456 lds
    v_or3_b32 v60, v60, v61, v62
    v_or_b32 v60, v60, v63
    v_mfma_f32_16x16x32_bf16 v[44:47], a[96:99], v[160:163], 0
    s_add_u32 m0, s44, 53760
    ds_read_b64_tr_b16 a[80:81], v4 offset:53760
    ds_read_b64_tr_b16 a[82:83], v4 offset:53888
    v_mfma_f32_16x16x32_bf16 v[44:47], a[100:103], v[168:171], v[44:47]
    s_mov_b32 s45, 147840
    buffer_load_dwordx4 v7, s[28:31], s45 offen offset:0 lds
    v_mfma_f32_16x16x32_bf16 v[44:47], a[104:107], v[176:179], v[44:47]
    s_add_u32 m0, s44, 53664
    ds_read_b64_tr_b16 a[84:85], v4 offset:54016
    ds_read_b64_tr_b16 a[86:87], v4 offset:54144
    v_mfma_f32_16x16x32_bf16 v[44:47], a[108:111], v[184:187], v[44:47]
    buffer_load_dwordx4 v7, s[28:31], s45 offen offset:1152 lds
    v_mfma_f32_16x16x32_bf16 v[44:47], a[112:115], v[224:227], v[44:47]
    s_add_u32 m0, s44, 53568
    ds_read_b64_tr_b16 a[88:89], v4 offset:54272
    ds_read_b64_tr_b16 a[90:91], v4 offset:54400
    v_mfma_f32_16x16x32_bf16 v[44:47], a[116:119], v[232:235], v[44:47]
    buffer_load_dwordx4 v7, s[28:31], s45 offen offset:2304 lds
    v_mfma_f32_16x16x32_bf16 v[44:47], a[120:123], v[240:243], v[44:47]
    s_add_u32 m0, s44, 53472
    ds_read_b64_tr_b16 a[92:93], v4 offset:54528
    ds_read_b64_tr_b16 a[94:95], v4 offset:54656
    v_mfma_f32_16x16x32_bf16 v[44:47], a[124:127], v[248:251], v[44:47]
    s_waitcnt lgkmcnt(12)
    buffer_load_dwordx4 v7, s[28:31], s45 offen offset:3456 lds
    v_readfirstlane_b32 s3, v60
    v_mfma_f32_16x16x32_bf16 v[16:19], a[64:67], v[128:131], 0
    ds_read_b64_tr_b16 a[96:97], v4 offset:36896
    v_cvt_pk_bf16_f32 v48, v32, v33
    v_mfma_f32_16x16x32_bf16 v[16:19], a[68:71], v[136:139], v[16:19]
    s_waitcnt lgkmcnt(9)
    s_cmp_lg_u32 s3, 0
    ds_read_b64_tr_b16 a[98:99], v4 offset:37024
    v_cvt_pk_bf16_f32 v49, v34, v35
    v_mfma_f32_16x16x32_bf16 v[16:19], a[72:75], v[144:147], v[16:19]
    s_cbranch_scc1 L2_fallback
    ds_read_b64_tr_b16 a[100:101], v4 offset:37152
    v_cvt_pk_bf16_f32 v50, v40, v41
    v_mfma_f32_16x16x32_bf16 v[16:19], a[76:79], v[152:155], v[16:19]
    s_waitcnt lgkmcnt(7)
    ds_read_b64_tr_b16 a[102:103], v4 offset:37280
    v_cvt_pk_bf16_f32 v51, v42, v43
    v_mfma_f32_16x16x32_bf16 v[16:19], a[80:83], v[192:195], v[16:19]
    s_mov_b32 s54, 0
    ds_read_b64_tr_b16 a[104:105], v4 offset:37408
    ds_read_b64_tr_b16 a[106:107], v4 offset:37536
    v_mfma_f32_16x16x32_bf16 v[16:19], a[84:87], v[200:203], v[16:19]
    s_waitcnt lgkmcnt(6)
    v_permlane32_swap_b32 v48, v50
    v_mfma_f32_16x16x32_bf16 v[16:19], a[88:91], v[208:211], v[16:19]
    v_permlane32_swap_b32 v49, v51
    v_mfma_f32_16x16x32_bf16 v[16:19], a[92:95], v[216:219], v[16:19]
    ds_read_b64_tr_b16 a[108:109], v4 offset:37664
    ds_read_b64_tr_b16 a[110:111], v4 offset:37792
    buffer_store_dwordx4 v[48:51], v10, s[40:43], s54 offen offset:512 sc1
    v_mfma_f32_16x16x32_bf16 v[20:23], a[64:67], v[160:163], 0
    ds_read_b64_tr_b16 a[112:113], v4 offset:53792
    v_cvt_pk_bf16_f32 v52, v36, v37
    v_mfma_f32_16x16x32_bf16 v[20:23], a[68:71], v[168:171], v[20:23]
    ds_read_b64_tr_b16 a[114:115], v4 offset:53920
    v_cvt_pk_bf16_f32 v53, v38, v39
    v_mfma_f32_16x16x32_bf16 v[20:23], a[72:75], v[176:179], v[20:23]
    ds_read_b64_tr_b16 a[116:117], v4 offset:54048
    v_cvt_pk_bf16_f32 v54, v44, v45
    v_mfma_f32_16x16x32_bf16 v[20:23], a[76:79], v[184:187], v[20:23]
    ds_read_b64_tr_b16 a[118:119], v4 offset:54176
    v_cvt_pk_bf16_f32 v55, v46, v47
    v_mfma_f32_16x16x32_bf16 v[20:23], a[80:83], v[224:227], v[20:23]
    s_mov_b32 s54, 294912
    ds_read_b64_tr_b16 a[120:121], v4 offset:54304
    ds_read_b64_tr_b16 a[122:123], v4 offset:54432
    v_mfma_f32_16x16x32_bf16 v[20:23], a[84:87], v[232:235], v[20:23]
    v_permlane32_swap_b32 v52, v54
    v_mfma_f32_16x16x32_bf16 v[20:23], a[88:91], v[240:243], v[20:23]
    v_permlane32_swap_b32 v53, v55
    v_mfma_f32_16x16x32_bf16 v[20:23], a[92:95], v[248:251], v[20:23]
    s_waitcnt lgkmcnt(10)
    ds_read_b64_tr_b16 a[124:125], v4 offset:54560
    ds_read_b64_tr_b16 a[126:127], v4 offset:54688
    buffer_store_dwordx4 v[52:55], v10, s[40:43], s54 offen offset:512 sc1
    v_mfma_f32_16x16x32_bf16 v[24:27], a[96:99], v[128:131], 0
    s_mul_i32 s3, s51, 128
    ds_read_b64_tr_b16 a[64:65], v4 offset:36928
    v_lshrrev_b32 v14, 3, v0
    v_mfma_f32_16x16x32_bf16 v[24:27], a[100:103], v[136:139], v[24:27]
    s_waitcnt lgkmcnt(9)
    ds_read_b64_tr_b16 a[66:67], v4 offset:37056
    v_lshl_add_u32 v12, v14, 4, s3
    v_mfma_f32_16x16x32_bf16 v[24:27], a[104:107], v[144:147], v[24:27]
    ds_read_b64_tr_b16 a[68:69], v4 offset:37184
    v_and_b32 v14, 1, v14
    v_mfma_f32_16x16x32_bf16 v[24:27], a[108:111], v[152:155], v[24:27]
    s_waitcnt lgkmcnt(7)
    s_mul_i32 s3, s51, 32
    ds_read_b64_tr_b16 a[70:71], v4 offset:37312
    v_lshl_add_u32 v13, v14, 4, s3
    v_mfma_f32_16x16x32_bf16 v[24:27], a[112:115], v[192:195], v[24:27]
    ds_read_b64_tr_b16 a[72:73], v4 offset:37440
    v_and_b32 v14, 7, v0
    v_mfma_f32_16x16x32_bf16 v[24:27], a[116:119], v[200:203], v[24:27]
    s_waitcnt lgkmcnt(5)
    ds_read_b64_tr_b16 a[74:75], v4 offset:37568
    v_mul_u32_u24 v14, 1152, v14
    v_mfma_f32_16x16x32_bf16 v[24:27], a[120:123], v[208:211], v[24:27]
    ds_read_b64_tr_b16 a[76:77], v4 offset:37696
    v_add_u32 v1, v14, v12
    v_mfma_f32_16x16x32_bf16 v[24:27], a[124:127], v[216:219], v[24:27]
    ds_read_b64_tr_b16 a[78:79], v4 offset:37824
    v_add_u32 v2, v14, v13
    v_mfma_f32_16x16x32_bf16 v[28:31], a[96:99], v[160:163], 0
    ds_read_b64_tr_b16 a[80:81], v4 offset:53824
    v_add_u32 v2, 1024, v2
    v_mfma_f32_16x16x32_bf16 v[28:31], a[100:103], v[168:171], v[28:31]
    s_lshl_b32 s14, s51, 10
    ds_read_b64_tr_b16 a[82:83], v4 offset:53952
    v_add_u32 v5, s14, v8
    v_mfma_f32_16x16x32_bf16 v[28:31], a[104:107], v[176:179], v[28:31]
    ds_read_b64_tr_b16 a[84:85], v4 offset:54080
    v_and_b32 v59, 0xf0, v8
    v_mfma_f32_16x16x32_bf16 v[28:31], a[108:111], v[184:187], v[28:31]
    s_lshl_b32 s14, s51, 8
    ds_read_b64_tr_b16 a[86:87], v4 offset:54208
    v_add_u32 v59, s14, v59
    v_mfma_f32_16x16x32_bf16 v[28:31], a[112:115], v[224:227], v[28:31]
    ds_read_b64_tr_b16 a[88:89], v4 offset:54336
    v_and_b32 v6, 15, v0
    v_mfma_f32_16x16x32_bf16 v[28:31], a[116:119], v[232:235], v[28:31]
    ds_read_b64_tr_b16 a[90:91], v4 offset:54464
    v_lshlrev_b32 v6, 8, v6
    v_mfma_f32_16x16x32_bf16 v[28:31], a[120:123], v[240:243], v[28:31]
    ds_read_b64_tr_b16 a[92:93], v4 offset:54592
    v_min_u32 v15, 1, v0
    v_mfma_f32_16x16x32_bf16 v[28:31], a[124:127], v[248:251], v[28:31]
    s_waitcnt lgkmcnt(11)
    ds_read_b64_tr_b16 a[94:95], v4 offset:54720
    v_lshlrev_b32 v15, 30, v15
    v_mfma_f32_16x16x32_bf16 v[32:35], a[64:67], v[128:131], 0
    s_lshl_b32 s15, s53, 14
    s_add_u32 s15, s15, 786432
    s_and_b32 s14, s52, 12
    s_lshl_b32 s14, s14, 10
    s_add_u32 s47, s15, s14
    s_lshl4_add_u32 s3, s51, s52
    s_lshl_b32 s3, s3, 8
    s_add_u32 s56, s3, s15
    s_add_u32 s14, s55, 16384
    ds_read_b64_tr_b16 a[96:97], v4 offset:36960
    v_cvt_pk_bf16_f32 v48, v16, v17
    v_mfma_f32_16x16x32_bf16 v[32:35], a[68:71], v[136:139], v[32:35]
    s_waitcnt lgkmcnt(9)
    ds_read_b64_tr_b16 a[98:99], v4 offset:37088
    v_cvt_pk_bf16_f32 v49, v18, v19
    v_mfma_f32_16x16x32_bf16 v[32:35], a[72:75], v[144:147], v[32:35]
    ds_read_b64_tr_b16 a[100:101], v4 offset:37216
    v_cvt_pk_bf16_f32 v50, v24, v25
    v_mfma_f32_16x16x32_bf16 v[32:35], a[76:79], v[152:155], v[32:35]
    s_waitcnt lgkmcnt(7)
    ds_read_b64_tr_b16 a[102:103], v4 offset:37344
    v_cvt_pk_bf16_f32 v51, v26, v27
    v_mfma_f32_16x16x32_bf16 v[32:35], a[80:83], v[192:195], v[32:35]
    s_mov_b32 s54, 1024
    ds_read_b64_tr_b16 a[104:105], v4 offset:37472
    ds_read_b64_tr_b16 a[106:107], v4 offset:37600
    v_mfma_f32_16x16x32_bf16 v[32:35], a[84:87], v[200:203], v[32:35]
    s_waitcnt lgkmcnt(6)
    v_permlane32_swap_b32 v48, v50
    v_mfma_f32_16x16x32_bf16 v[32:35], a[88:91], v[208:211], v[32:35]
    v_permlane32_swap_b32 v49, v51
    v_mfma_f32_16x16x32_bf16 v[32:35], a[92:95], v[216:219], v[32:35]
    ds_read_b64_tr_b16 a[108:109], v4 offset:37728
    ds_read_b64_tr_b16 a[110:111], v4 offset:37856
    buffer_store_dwordx4 v[48:51], v10, s[40:43], s54 offen offset:0 sc1
    v_mfma_f32_16x16x32_bf16 v[36:39], a[64:67], v[160:163], 0
    ds_read_b64_tr_b16 a[112:113], v4 offset:53856
    v_cvt_pk_bf16_f32 v52, v20, v21
    v_mfma_f32_16x16x32_bf16 v[36:39], a[68:71], v[168:171], v[36:39]
    ds_read_b64_tr_b16 a[114:115], v4 offset:53984
    v_cvt_pk_bf16_f32 v53, v22, v23
    v_mfma_f32_16x16x32_bf16 v[36:39], a[72:75], v[176:179], v[36:39]
    ds_read_b64_tr_b16 a[116:117], v4 offset:54112
    v_cvt_pk_bf16_f32 v54, v28, v29
    v_mfma_f32_16x16x32_bf16 v[36:39], a[76:79], v[184:187], v[36:39]
    ds_read_b64_tr_b16 a[118:119], v4 offset:54240
    v_cvt_pk_bf16_f32 v55, v30, v31
    v_mfma_f32_16x16x32_bf16 v[36:39], a[80:83], v[224:227], v[36:39]
    s_mov_b32 s54, 295936
    ds_read_b64_tr_b16 a[120:121], v4 offset:54368
    ds_read_b64_tr_b16 a[122:123], v4 offset:54496
    v_mfma_f32_16x16x32_bf16 v[36:39], a[84:87], v[232:235], v[36:39]
    v_permlane32_swap_b32 v52, v54
    v_mfma_f32_16x16x32_bf16 v[36:39], a[88:91], v[240:243], v[36:39]
    v_permlane32_swap_b32 v53, v55
    v_mfma_f32_16x16x32_bf16 v[36:39], a[92:95], v[248:251], v[36:39]
    s_waitcnt vmcnt(31)
    s_barrier
    s_waitcnt lgkmcnt(10)
    ds_read_b64_tr_b16 a[124:125], v4 offset:54624
    ds_read_b64_tr_b16 a[126:127], v4 offset:54752
    buffer_store_dwordx4 v[52:55], v10, s[40:43], s54 offen offset:0 sc1
    v_mfma_f32_16x16x32_bf16 v[40:43], a[96:99], v[128:131], 0
    s_add_u32 m0, s44, 73728
    ds_read_b64_tr_b16 a[64:65], v3 offset:0
    ds_read_b64_tr_b16 a[66:67], v3 offset:128
    v_mfma_f32_16x16x32_bf16 v[40:43], a[100:103], v[136:139], v[40:43]
    s_mov_b32 s45, 512
    s_waitcnt lgkmcnt(10)
    buffer_load_dwordx4 v7, s[28:31], s45 offen offset:0 lds
    v_mfma_f32_16x16x32_bf16 v[40:43], a[104:107], v[144:147], v[40:43]
    s_add_u32 m0, s44, 73632
    ds_read_b64_tr_b16 a[68:69], v3 offset:256
    ds_read_b64_tr_b16 a[70:71], v3 offset:384
    v_mfma_f32_16x16x32_bf16 v[40:43], a[108:111], v[152:155], v[40:43]
    s_waitcnt lgkmcnt(8)
    buffer_load_dwordx4 v7, s[28:31], s45 offen offset:1152 lds
    v_mfma_f32_16x16x32_bf16 v[40:43], a[112:115], v[192:195], v[40:43]
    s_add_u32 m0, s44, 73536
    ds_read_b64_tr_b16 a[72:73], v3 offset:512
    ds_read_b64_tr_b16 a[74:75], v3 offset:640
    v_mfma_f32_16x16x32_bf16 v[40:43], a[116:119], v[200:203], v[40:43]
    s_waitcnt lgkmcnt(6)
    buffer_load_dwordx4 v7, s[28:31], s45 offen offset:2304 lds
    v_mfma_f32_16x16x32_bf16 v[40:43], a[120:123], v[208:211], v[40:43]
    s_add_u32 m0, s44, 73440
    ds_read_b64_tr_b16 a[76:77], v3 offset:768
    ds_read_b64_tr_b16 a[78:79], v3 offset:896
    v_mfma_f32_16x16x32_bf16 v[40:43], a[124:127], v[216:219], v[40:43]
    buffer_load_dwordx4 v7, s[28:31], s45 offen offset:3456 lds
    v_mfma_f32_16x16x32_bf16 v[44:47], a[96:99], v[160:163], 0
    s_add_u32 m0, s44, 90624
    ds_read_b64_tr_b16 a[80:81], v3 offset:16896
    ds_read_b64_tr_b16 a[82:83], v3 offset:17024
    v_mfma_f32_16x16x32_bf16 v[44:47], a[100:103], v[168:171], v[44:47]
    s_mov_b32 s45, 147968
    buffer_load_dwordx4 v7, s[28:31], s45 offen offset:0 lds
    v_mfma_f32_16x16x32_bf16 v[44:47], a[104:107], v[176:179], v[44:47]
    s_add_u32 m0, s44, 90528
    ds_read_b64_tr_b16 a[84:85], v3 offset:17152
    ds_read_b64_tr_b16 a[86:87], v3 offset:17280
    v_mfma_f32_16x16x32_bf16 v[44:47], a[108:111], v[184:187], v[44:47]
    buffer_load_dwordx4 v7, s[28:31], s45 offen offset:1152 lds
    v_mfma_f32_16x16x32_bf16 v[44:47], a[112:115], v[224:227], v[44:47]
    s_add_u32 m0, s44, 90432
    ds_read_b64_tr_b16 a[88:89], v3 offset:17408
    ds_read_b64_tr_b16 a[90:91], v3 offset:17536
    v_mfma_f32_16x16x32_bf16 v[44:47], a[116:119], v[232:235], v[44:47]
    buffer_load_dwordx4 v7, s[28:31], s45 offen offset:2304 lds
    v_mfma_f32_16x16x32_bf16 v[44:47], a[120:123], v[240:243], v[44:47]
    s_add_u32 m0, s44, 90336
    ds_read_b64_tr_b16 a[92:93], v3 offset:17664
    ds_read_b64_tr_b16 a[94:95], v3 offset:17792
    v_mfma_f32_16x16x32_bf16 v[44:47], a[124:127], v[248:251], v[44:47]
    s_waitcnt lgkmcnt(12)
    buffer_load_dwordx4 v7, s[28:31], s45 offen offset:3456 lds
    v_mfma_f32_16x16x32_bf16 v[16:19], a[64:67], v[128:131], 0
    ds_read_b64_tr_b16 a[96:97], v3 offset:32
    v_cvt_pk_bf16_f32 v48, v32, v33
    v_mfma_f32_16x16x32_bf16 v[16:19], a[68:71], v[136:139], v[16:19]
    s_waitcnt lgkmcnt(9)
    ds_read_b64_tr_b16 a[98:99], v3 offset:160
    v_cvt_pk_bf16_f32 v49, v34, v35
    v_mfma_f32_16x16x32_bf16 v[16:19], a[72:75], v[144:147], v[16:19]
    ds_read_b64_tr_b16 a[100:101], v3 offset:288
    v_cvt_pk_bf16_f32 v50, v40, v41
    v_mfma_f32_16x16x32_bf16 v[16:19], a[76:79], v[152:155], v[16:19]
    s_waitcnt lgkmcnt(7)
    ds_read_b64_tr_b16 a[102:103], v3 offset:416
    v_cvt_pk_bf16_f32 v51, v42, v43
    v_mfma_f32_16x16x32_bf16 v[16:19], a[80:83], v[192:195], v[16:19]
    s_mov_b32 s54, 1024
    ds_read_b64_tr_b16 a[104:105], v3 offset:544
    ds_read_b64_tr_b16 a[106:107], v3 offset:672
    v_mfma_f32_16x16x32_bf16 v[16:19], a[84:87], v[200:203], v[16:19]
    s_waitcnt lgkmcnt(6)
    v_permlane32_swap_b32 v48, v50
    v_mfma_f32_16x16x32_bf16 v[16:19], a[88:91], v[208:211], v[16:19]
    v_permlane32_swap_b32 v49, v51
    v_mfma_f32_16x16x32_bf16 v[16:19], a[92:95], v[216:219], v[16:19]
    ds_read_b64_tr_b16 a[108:109], v3 offset:800
    ds_read_b64_tr_b16 a[110:111], v3 offset:928
    buffer_store_dwordx4 v[48:51], v10, s[40:43], s54 offen offset:512 sc1
    v_mfma_f32_16x16x32_bf16 v[20:23], a[64:67], v[160:163], 0
    ds_read_b64_tr_b16 a[112:113], v3 offset:16928
    v_cvt_pk_bf16_f32 v52, v36, v37
    v_mfma_f32_16x16x32_bf16 v[20:23], a[68:71], v[168:171], v[20:23]
    ds_read_b64_tr_b16 a[114:115], v3 offset:17056
    v_cvt_pk_bf16_f32 v53, v38, v39
    v_mfma_f32_16x16x32_bf16 v[20:23], a[72:75], v[176:179], v[20:23]
    ds_read_b64_tr_b16 a[116:117], v3 offset:17184
    v_cvt_pk_bf16_f32 v54, v44, v45
    v_mfma_f32_16x16x32_bf16 v[20:23], a[76:79], v[184:187], v[20:23]
    ds_read_b64_tr_b16 a[118:119], v3 offset:17312
    v_cvt_pk_bf16_f32 v55, v46, v47
    v_mfma_f32_16x16x32_bf16 v[20:23], a[80:83], v[224:227], v[20:23]
    s_mov_b32 s54, 295936
    ds_read_b64_tr_b16 a[120:121], v3 offset:17440
    ds_read_b64_tr_b16 a[122:123], v3 offset:17568
    v_mfma_f32_16x16x32_bf16 v[20:23], a[84:87], v[232:235], v[20:23]
    v_permlane32_swap_b32 v52, v54
    v_mfma_f32_16x16x32_bf16 v[20:23], a[88:91], v[240:243], v[20:23]
    v_permlane32_swap_b32 v53, v55
    v_mfma_f32_16x16x32_bf16 v[20:23], a[92:95], v[248:251], v[20:23]
    s_waitcnt lgkmcnt(10)
    ds_read_b64_tr_b16 a[124:125], v3 offset:17696
    ds_read_b64_tr_b16 a[126:127], v3 offset:17824
    buffer_store_dwordx4 v[52:55], v10, s[40:43], s54 offen offset:512 sc1
    v_mfma_f32_16x16x32_bf16 v[24:27], a[96:99], v[128:131], 0
    ds_read_b64_tr_b16 a[64:65], v3 offset:64
    v_add_u32 v104, s14, v8
    v_mfma_f32_16x16x32_bf16 v[24:27], a[100:103], v[136:139], v[24:27]
    s_waitcnt lgkmcnt(9)
    ds_read_b64_tr_b16 a[66:67], v3 offset:192
    v_and_b32 v14, 32, v0
    v_mfma_f32_16x16x32_bf16 v[24:27], a[104:107], v[144:147], v[24:27]
    ds_read_b64_tr_b16 a[68:69], v3 offset:320
    v_xor_b32 v105, v14, v104
    v_mfma_f32_16x16x32_bf16 v[24:27], a[108:111], v[152:155], v[24:27]
    s_waitcnt lgkmcnt(7)
    ds_read_b64_tr_b16 a[70:71], v3 offset:448
    v_add_u32 v106, 73728, v105
    v_mfma_f32_16x16x32_bf16 v[24:27], a[112:115], v[192:195], v[24:27]
    ds_read_b64_tr_b16 a[72:73], v3 offset:576
    v_lshrrev_b32 v110, 4, v0
    v_mfma_f32_16x16x32_bf16 v[24:27], a[116:119], v[200:203], v[24:27]
    s_waitcnt lgkmcnt(5)
    ds_read_b64_tr_b16 a[74:75], v3 offset:704
    v_bfe_u32 v14, v0, 2, 2
    v_mfma_f32_16x16x32_bf16 v[24:27], a[120:123], v[208:211], v[24:27]
    ds_read_b64_tr_b16 a[76:77], v3 offset:832
    v_lshl_add_u32 v110, v110, 3, v14
    v_mfma_f32_16x16x32_bf16 v[24:27], a[124:127], v[216:219], v[24:27]
    ds_read_b64_tr_b16 a[78:79], v3 offset:960
    v_and_b32 v14, 3, v0
    v_mfma_f32_16x16x32_bf16 v[28:31], a[96:99], v[160:163], 0
    ds_read_b64_tr_b16 a[80:81], v3 offset:16960
    v_mul_u32_u24 v111, 1152, v110
    v_mfma_f32_16x16x32_bf16 v[28:31], a[100:103], v[168:171], v[28:31]
    ds_read_b64_tr_b16 a[82:83], v3 offset:17088
    v_lshlrev_b32 v110, 6, v110
    v_mfma_f32_16x16x32_bf16 v[28:31], a[104:107], v[176:179], v[28:31]
    ds_read_b64_tr_b16 a[84:85], v3 offset:17216
    v_lshl_add_u32 v110, v14, 3, v110
    v_mfma_f32_16x16x32_bf16 v[28:31], a[108:111], v[184:187], v[28:31]
    ds_read_b64_tr_b16 a[86:87], v3 offset:17344
    v_lshl_add_u32 v111, v14, 3, v111
    v_mfma_f32_16x16x32_bf16 v[28:31], a[112:115], v[224:227], v[28:31]
    s_lshr_b32 s3, s51, 1
    s_xor_b32 s3, s3, 1
    s_mul_i32 s3, s3, 110592
    s_and_b32 s14, s51, 1
    s_lshl_b32 s14, s14, 5
    s_add_u32 s3, s3, s14
    s_add_u32 s3, s3, 16384
    ds_read_b64_tr_b16 a[88:89], v3 offset:17472
    v_add_u32 v110, s3, v110
    v_mfma_f32_16x16x32_bf16 v[28:31], a[116:119], v[232:235], v[28:31]
    ds_read_b64_tr_b16 a[90:91], v3 offset:17600
    v_and_b32 v14, 16, v0
    v_mfma_f32_16x16x32_bf16 v[28:31], a[120:123], v[240:243], v[28:31]
    ds_read_b64_tr_b16 a[92:93], v3 offset:17728
    v_lshlrev_b32 v14, 1, v14
    v_mfma_f32_16x16x32_bf16 v[28:31], a[124:127], v[248:251], v[28:31]
    s_waitcnt lgkmcnt(11)
    ds_read_b64_tr_b16 a[94:95], v3 offset:17856
    v_xor_b32 v110, v14, v110
    v_mfma_f32_16x16x32_bf16 v[32:35], a[64:67], v[128:131], 0
    s_mul_i32 s3, s51, 288
    s_add_u32 s3, s3, 53248
    ds_read_b64_tr_b16 a[96:97], v3 offset:96
    v_cvt_pk_bf16_f32 v48, v16, v17
    v_mfma_f32_16x16x32_bf16 v[32:35], a[68:71], v[136:139], v[32:35]
    s_waitcnt lgkmcnt(9)
    ds_read_b64_tr_b16 a[98:99], v3 offset:224
    v_cvt_pk_bf16_f32 v49, v18, v19
    v_mfma_f32_16x16x32_bf16 v[32:35], a[72:75], v[144:147], v[32:35]
L2_pad11:
    s_cbranch_execz L2_pad15
    ds_read_b64_tr_b16 a[100:101], v3 offset:352
    v_cvt_pk_bf16_f32 v50, v24, v25
    v_mfma_f32_16x16x32_bf16 v[32:35], a[76:79], v[152:155], v[32:35]
    s_waitcnt lgkmcnt(7)
    ds_read_b64_tr_b16 a[102:103], v3 offset:480
    v_cvt_pk_bf16_f32 v51, v26, v27
    v_mfma_f32_16x16x32_bf16 v[32:35], a[80:83], v[192:195], v[32:35]
    s_mov_b32 s54, 2048
    ds_read_b64_tr_b16 a[104:105], v3 offset:608
    ds_read_b64_tr_b16 a[106:107], v3 offset:736
    v_mfma_f32_16x16x32_bf16 v[32:35], a[84:87], v[200:203], v[32:35]
    s_waitcnt lgkmcnt(6)
    v_permlane32_swap_b32 v48, v50
    v_mfma_f32_16x16x32_bf16 v[32:35], a[88:91], v[208:211], v[32:35]
    v_permlane32_swap_b32 v49, v51
    v_mfma_f32_16x16x32_bf16 v[32:35], a[92:95], v[216:219], v[32:35]
    ds_read_b64_tr_b16 a[108:109], v3 offset:864
    ds_read_b64_tr_b16 a[110:111], v3 offset:992
    buffer_store_dwordx4 v[48:51], v10, s[40:43], s54 offen offset:0 sc1
    v_mfma_f32_16x16x32_bf16 v[36:39], a[64:67], v[160:163], 0
    ds_read_b64_tr_b16 a[112:113], v3 offset:16992
    v_cvt_pk_bf16_f32 v52, v20, v21
    v_mfma_f32_16x16x32_bf16 v[36:39], a[68:71], v[168:171], v[36:39]
    ds_read_b64_tr_b16 a[114:115], v3 offset:17120
    v_cvt_pk_bf16_f32 v53, v22, v23
    v_mfma_f32_16x16x32_bf16 v[36:39], a[72:75], v[176:179], v[36:39]
    ds_read_b64_tr_b16 a[116:117], v3 offset:17248
    v_cvt_pk_bf16_f32 v54, v28, v29
    v_mfma_f32_16x16x32_bf16 v[36:39], a[76:79], v[184:187], v[36:39]
    ds_read_b64_tr_b16 a[118:119], v3 offset:17376
    v_cvt_pk_bf16_f32 v55, v30, v31
    v_mfma_f32_16x16x32_bf16 v[36:39], a[80:83], v[224:227], v[36:39]
    s_mov_b32 s54, 296960
    ds_read_b64_tr_b16 a[120:121], v3 offset:17504
    ds_read_b64_tr_b16 a[122:123], v3 offset:17632
    v_mfma_f32_16x16x32_bf16 v[36:39], a[84:87], v[232:235], v[36:39]
    v_permlane32_swap_b32 v52, v54
    v_mfma_f32_16x16x32_bf16 v[36:39], a[88:91], v[240:243], v[36:39]
    v_permlane32_swap_b32 v53, v55
    v_mfma_f32_16x16x32_bf16 v[36:39], a[92:95], v[248:251], v[36:39]
    s_waitcnt vmcnt(15)
    s_barrier
    s_waitcnt lgkmcnt(10)
    ds_read_b64_tr_b16 a[124:125], v3 offset:17760
    ds_read_b64_tr_b16 a[126:127], v3 offset:17888
    buffer_store_dwordx4 v[52:55], v10, s[40:43], s54 offen offset:0 sc1
    v_mfma_f32_16x16x32_bf16 v[40:43], a[96:99], v[128:131], 0
    s_add_u32 m0, s44, 110592
    ds_read_b64_tr_b16 a[64:65], v3 offset:36864
    ds_read_b64_tr_b16 a[66:67], v3 offset:36992
    v_mfma_f32_16x16x32_bf16 v[40:43], a[100:103], v[136:139], v[40:43]
    s_mov_b32 s45, 640
    s_waitcnt lgkmcnt(10)
    buffer_load_dwordx4 v7, s[28:31], s45 offen offset:0 lds
    v_mfma_f32_16x16x32_bf16 v[40:43], a[104:107], v[144:147], v[40:43]
    s_add_u32 m0, s44, 110496
    ds_read_b64_tr_b16 a[68:69], v3 offset:37120
    ds_read_b64_tr_b16 a[70:71], v3 offset:37248
    v_mfma_f32_16x16x32_bf16 v[40:43], a[108:111], v[152:155], v[40:43]
    s_waitcnt lgkmcnt(8)
    buffer_load_dwordx4 v7, s[28:31], s45 offen offset:1152 lds
    v_mfma_f32_16x16x32_bf16 v[40:43], a[112:115], v[192:195], v[40:43]
    s_add_u32 m0, s44, 110400
    ds_read_b64_tr_b16 a[72:73], v3 offset:37376
    ds_read_b64_tr_b16 a[74:75], v3 offset:37504
    v_mfma_f32_16x16x32_bf16 v[40:43], a[116:119], v[200:203], v[40:43]
    s_waitcnt lgkmcnt(6)
    buffer_load_dwordx4 v7, s[28:31], s45 offen offset:2304 lds
    v_mfma_f32_16x16x32_bf16 v[40:43], a[120:123], v[208:211], v[40:43]
    s_add_u32 m0, s44, 110304
    ds_read_b64_tr_b16 a[76:77], v3 offset:37632
    ds_read_b64_tr_b16 a[78:79], v3 offset:37760
    v_mfma_f32_16x16x32_bf16 v[40:43], a[124:127], v[216:219], v[40:43]
    buffer_load_dwordx4 v7, s[28:31], s45 offen offset:3456 lds
    v_mfma_f32_16x16x32_bf16 v[44:47], a[96:99], v[160:163], 0
    s_add_u32 m0, s44, 127488
    ds_read_b64_tr_b16 a[80:81], v3 offset:53760
    ds_read_b64_tr_b16 a[82:83], v3 offset:53888
    v_mfma_f32_16x16x32_bf16 v[44:47], a[100:103], v[168:171], v[44:47]
    s_mov_b32 s45, 148096
    buffer_load_dwordx4 v7, s[28:31], s45 offen offset:0 lds
    v_mfma_f32_16x16x32_bf16 v[44:47], a[104:107], v[176:179], v[44:47]
    s_add_u32 m0, s44, 127392
    ds_read_b64_tr_b16 a[84:85], v3 offset:54016
    ds_read_b64_tr_b16 a[86:87], v3 offset:54144
    v_mfma_f32_16x16x32_bf16 v[44:47], a[108:111], v[184:187], v[44:47]
    buffer_load_dwordx4 v7, s[28:31], s45 offen offset:1152 lds
    v_mfma_f32_16x16x32_bf16 v[44:47], a[112:115], v[224:227], v[44:47]
    s_add_u32 m0, s44, 127296
    ds_read_b64_tr_b16 a[88:89], v3 offset:54272
    ds_read_b64_tr_b16 a[90:91], v3 offset:54400
    v_mfma_f32_16x16x32_bf16 v[44:47], a[116:119], v[232:235], v[44:47]
    buffer_load_dwordx4 v7, s[28:31], s45 offen offset:2304 lds
    v_mfma_f32_16x16x32_bf16 v[44:47], a[120:123], v[240:243], v[44:47]
    s_add_u32 m0, s44, 127200
    ds_read_b64_tr_b16 a[92:93], v3 offset:54528
    ds_read_b64_tr_b16 a[94:95], v3 offset:54656
    v_mfma_f32_16x16x32_bf16 v[44:47], a[124:127], v[248:251], v[44:47]
    s_waitcnt lgkmcnt(12)
    buffer_load_dwordx4 v7, s[28:31], s45 offen offset:3456 lds
    v_mfma_f32_16x16x32_bf16 v[16:19], a[64:67], v[128:131], 0
    ds_read_b64_tr_b16 a[96:97], v3 offset:36896
    v_cvt_pk_bf16_f32 v48, v32, v33
    v_mfma_f32_16x16x32_bf16 v[16:19], a[68:71], v[136:139], v[16:19]
    s_waitcnt lgkmcnt(9)
    ds_read_b64_tr_b16 a[98:99], v3 offset:37024
    v_cvt_pk_bf16_f32 v49, v34, v35
    v_mfma_f32_16x16x32_bf16 v[16:19], a[72:75], v[144:147], v[16:19]
    ds_read_b64_tr_b16 a[100:101], v3 offset:37152
    v_cvt_pk_bf16_f32 v50, v40, v41
    v_mfma_f32_16x16x32_bf16 v[16:19], a[76:79], v[152:155], v[16:19]
    s_waitcnt lgkmcnt(7)
    ds_read_b64_tr_b16 a[102:103], v3 offset:37280
    v_cvt_pk_bf16_f32 v51, v42, v43
    v_mfma_f32_16x16x32_bf16 v[16:19], a[80:83], v[192:195], v[16:19]
    s_mov_b32 s54, 2048
    ds_read_b64_tr_b16 a[104:105], v3 offset:37408
    ds_read_b64_tr_b16 a[106:107], v3 offset:37536
    v_mfma_f32_16x16x32_bf16 v[16:19], a[84:87], v[200:203], v[16:19]
    s_waitcnt lgkmcnt(6)
    v_permlane32_swap_b32 v48, v50
    v_mfma_f32_16x16x32_bf16 v[16:19], a[88:91], v[208:211], v[16:19]
    v_permlane32_swap_b32 v49, v51
    v_mfma_f32_16x16x32_bf16 v[16:19], a[92:95], v[216:219], v[16:19]
    ds_read_b64_tr_b16 a[108:109], v3 offset:37664
    ds_read_b64_tr_b16 a[110:111], v3 offset:37792
    buffer_store_dwordx4 v[48:51], v10, s[40:43], s54 offen offset:512 sc1
    v_mfma_f32_16x16x32_bf16 v[20:23], a[64:67], v[160:163], 0
    ds_read_b64_tr_b16 a[112:113], v3 offset:53792
    v_cvt_pk_bf16_f32 v52, v36, v37
    v_mfma_f32_16x16x32_bf16 v[20:23], a[68:71], v[168:171], v[20:23]
    ds_read_b64_tr_b16 a[114:115], v3 offset:53920
    v_cvt_pk_bf16_f32 v53, v38, v39
    v_mfma_f32_16x16x32_bf16 v[20:23], a[72:75], v[176:179], v[20:23]
    ds_read_b64_tr_b16 a[116:117], v3 offset:54048
    v_cvt_pk_bf16_f32 v54, v44, v45
    v_mfma_f32_16x16x32_bf16 v[20:23], a[76:79], v[184:187], v[20:23]
    ds_read_b64_tr_b16 a[118:119], v3 offset:54176
    v_cvt_pk_bf16_f32 v55, v46, v47
    v_mfma_f32_16x16x32_bf16 v[20:23], a[80:83], v[224:227], v[20:23]
    s_mov_b32 s54, 296960
    ds_read_b64_tr_b16 a[120:121], v3 offset:54304
    ds_read_b64_tr_b16 a[122:123], v3 offset:54432
    v_mfma_f32_16x16x32_bf16 v[20:23], a[84:87], v[232:235], v[20:23]
    v_permlane32_swap_b32 v52, v54
    v_mfma_f32_16x16x32_bf16 v[20:23], a[88:91], v[240:243], v[20:23]
    v_permlane32_swap_b32 v53, v55
    v_mfma_f32_16x16x32_bf16 v[20:23], a[92:95], v[248:251], v[20:23]
    s_waitcnt lgkmcnt(10)
    ds_read_b64_tr_b16 a[124:125], v3 offset:54560
    ds_read_b64_tr_b16 a[126:127], v3 offset:54688
    buffer_store_dwordx4 v[52:55], v10, s[40:43], s54 offen offset:512 sc1
    v_mfma_f32_16x16x32_bf16 v[24:27], a[96:99], v[128:131], 0
    ds_read_b64_tr_b16 a[64:65], v3 offset:36928
    v_add_u32 v111, s3, v111
    v_mfma_f32_16x16x32_bf16 v[24:27], a[100:103], v[136:139], v[24:27]
    s_waitcnt lgkmcnt(9)
    ds_read_b64_tr_b16 a[66:67], v3 offset:37056
    v_mfma_f32_16x16x32_bf16 v[24:27], a[104:107], v[144:147], v[24:27]
    ds_read_b64_tr_b16 a[68:69], v3 offset:37184
    v_mfma_f32_16x16x32_bf16 v[24:27], a[108:111], v[152:155], v[24:27]
    s_waitcnt lgkmcnt(7)
    ds_read_b64_tr_b16 a[70:71], v3 offset:37312
    v_mfma_f32_16x16x32_bf16 v[24:27], a[112:115], v[192:195], v[24:27]
    ds_read_b64_tr_b16 a[72:73], v3 offset:37440
    v_mfma_f32_16x16x32_bf16 v[24:27], a[116:119], v[200:203], v[24:27]
    s_waitcnt lgkmcnt(5)
    ds_read_b64_tr_b16 a[74:75], v3 offset:37568
    v_mfma_f32_16x16x32_bf16 v[24:27], a[120:123], v[208:211], v[24:27]
    ds_read_b64_tr_b16 a[76:77], v3 offset:37696
    v_mfma_f32_16x16x32_bf16 v[24:27], a[124:127], v[216:219], v[24:27]
    ds_read_b64_tr_b16 a[78:79], v3 offset:37824
    v_mfma_f32_16x16x32_bf16 v[28:31], a[96:99], v[160:163], 0
    ds_read_b64_tr_b16 a[80:81], v3 offset:53824
    v_mfma_f32_16x16x32_bf16 v[28:31], a[100:103], v[168:171], v[28:31]
    ds_read_b64_tr_b16 a[82:83], v3 offset:53952
    v_mfma_f32_16x16x32_bf16 v[28:31], a[104:107], v[176:179], v[28:31]
    ds_read_b64_tr_b16 a[84:85], v3 offset:54080
    v_mfma_f32_16x16x32_bf16 v[28:31], a[108:111], v[184:187], v[28:31]
    ds_read_b64_tr_b16 a[86:87], v3 offset:54208
    v_mfma_f32_16x16x32_bf16 v[28:31], a[112:115], v[224:227], v[28:31]
    ds_read_b64_tr_b16 a[88:89], v3 offset:54336
    v_mfma_f32_16x16x32_bf16 v[28:31], a[116:119], v[232:235], v[28:31]
    ds_read_b64_tr_b16 a[90:91], v3 offset:54464
    v_mfma_f32_16x16x32_bf16 v[28:31], a[120:123], v[240:243], v[28:31]
    ds_read_b64_tr_b16 a[92:93], v3 offset:54592
    v_mfma_f32_16x16x32_bf16 v[28:31], a[124:127], v[248:251], v[28:31]
    s_waitcnt lgkmcnt(11)
    ds_read_b64_tr_b16 a[94:95], v3 offset:54720
    v_mfma_f32_16x16x32_bf16 v[32:35], a[64:67], v[128:131], 0
    ds_read_b64_tr_b16 a[96:97], v3 offset:36960
    v_cvt_pk_bf16_f32 v48, v16, v17
    v_mfma_f32_16x16x32_bf16 v[32:35], a[68:71], v[136:139], v[32:35]
    s_waitcnt lgkmcnt(9)
    ds_read_b64_tr_b16 a[98:99], v3 offset:37088
    v_cvt_pk_bf16_f32 v49, v18, v19
    v_mfma_f32_16x16x32_bf16 v[32:35], a[72:75], v[144:147], v[32:35]
    ds_read_b64_tr_b16 a[100:101], v3 offset:37216
    v_cvt_pk_bf16_f32 v50, v24, v25
    v_mfma_f32_16x16x32_bf16 v[32:35], a[76:79], v[152:155], v[32:35]
    s_waitcnt lgkmcnt(7)
    ds_read_b64_tr_b16 a[102:103], v3 offset:37344
    v_cvt_pk_bf16_f32 v51, v26, v27
    v_mfma_f32_16x16x32_bf16 v[32:35], a[80:83], v[192:195], v[32:35]
    s_mov_b32 s54, 3072
    ds_read_b64_tr_b16 a[104:105], v3 offset:37472
    ds_read_b64_tr_b16 a[106:107], v3 offset:37600
    v_mfma_f32_16x16x32_bf16 v[32:35], a[84:87], v[200:203], v[32:35]
    s_waitcnt lgkmcnt(6)
    v_permlane32_swap_b32 v48, v50
    v_mfma_f32_16x16x32_bf16 v[32:35], a[88:91], v[208:211], v[32:35]
    v_permlane32_swap_b32 v49, v51
    v_mfma_f32_16x16x32_bf16 v[32:35], a[92:95], v[216:219], v[32:35]
    ds_read_b64_tr_b16 a[108:109], v3 offset:37728
    ds_read_b64_tr_b16 a[110:111], v3 offset:37856
    buffer_store_dwordx4 v[48:51], v10, s[40:43], s54 offen offset:0 sc1
    v_mfma_f32_16x16x32_bf16 v[36:39], a[64:67], v[160:163], 0
    ds_read_b64_tr_b16 a[112:113], v3 offset:53856
    v_cvt_pk_bf16_f32 v52, v20, v21
    v_mfma_f32_16x16x32_bf16 v[36:39], a[68:71], v[168:171], v[36:39]
    ds_read_b64_tr_b16 a[114:115], v3 offset:53984
    v_cvt_pk_bf16_f32 v53, v22, v23
    v_mfma_f32_16x16x32_bf16 v[36:39], a[72:75], v[176:179], v[36:39]
    ds_read_b64_tr_b16 a[116:117], v3 offset:54112
    v_cvt_pk_bf16_f32 v54, v28, v29
    v_mfma_f32_16x16x32_bf16 v[36:39], a[76:79], v[184:187], v[36:39]
    ds_read_b64_tr_b16 a[118:119], v3 offset:54240
    v_cvt_pk_bf16_f32 v55, v30, v31
    v_mfma_f32_16x16x32_bf16 v[36:39], a[80:83], v[224:227], v[36:39]
    s_mov_b32 s54, 297984
    ds_read_b64_tr_b16 a[120:121], v3 offset:54368
    ds_read_b64_tr_b16 a[122:123], v3 offset:54496
    v_mfma_f32_16x16x32_bf16 v[36:39], a[84:87], v[232:235], v[36:39]
    v_permlane32_swap_b32 v52, v54
    v_mfma_f32_16x16x32_bf16 v[36:39], a[88:91], v[240:243], v[36:39]
    v_permlane32_swap_b32 v53, v55
    v_mfma_f32_16x16x32_bf16 v[36:39], a[92:95], v[248:251], v[36:39]
    s_waitcnt vmcnt(15)
    s_barrier
    s_waitcnt lgkmcnt(10)
    ds_read_b64_tr_b16 a[124:125], v3 offset:54624
    ds_read_b64_tr_b16 a[126:127], v3 offset:54752
    buffer_store_dwordx4 v[52:55], v10, s[40:43], s54 offen offset:0 sc1
    v_mfma_f32_16x16x32_bf16 v[40:43], a[96:99], v[128:131], 0
    s_add_u32 m0, s44, 0
    ds_read_b64_tr_b16 a[64:65], v4 offset:0
    ds_read_b64_tr_b16 a[66:67], v4 offset:128
    v_mfma_f32_16x16x32_bf16 v[40:43], a[100:103], v[136:139], v[40:43]
    s_mov_b32 s45, 768
    s_waitcnt lgkmcnt(10)
    buffer_load_dwordx4 v7, s[28:31], s45 offen offset:0 lds
    v_mfma_f32_16x16x32_bf16 v[40:43], a[104:107], v[144:147], v[40:43]
    s_add_u32 m0, s44, -96
    ds_read_b64_tr_b16 a[68:69], v4 offset:256
    ds_read_b64_tr_b16 a[70:71], v4 offset:384
    v_mfma_f32_16x16x32_bf16 v[40:43], a[108:111], v[152:155], v[40:43]
    s_waitcnt lgkmcnt(8)
    buffer_load_dwordx4 v7, s[28:31], s45 offen offset:1152 lds
    v_mfma_f32_16x16x32_bf16 v[40:43], a[112:115], v[192:195], v[40:43]
    s_add_u32 m0, s44, -192
    ds_read_b64_tr_b16 a[72:73], v4 offset:512
    ds_read_b64_tr_b16 a[74:75], v4 offset:640
    v_mfma_f32_16x16x32_bf16 v[40:43], a[116:119], v[200:203], v[40:43]
    s_waitcnt lgkmcnt(6)
    buffer_load_dwordx4 v7, s[28:31], s45 offen offset:2304 lds
    v_mfma_f32_16x16x32_bf16 v[40:43], a[120:123], v[208:211], v[40:43]
    s_add_u32 m0, s44, -288
    ds_read_b64_tr_b16 a[76:77], v4 offset:768
    ds_read_b64_tr_b16 a[78:79], v4 offset:896
    v_mfma_f32_16x16x32_bf16 v[40:43], a[124:127], v[216:219], v[40:43]
    buffer_load_dwordx4 v7, s[28:31], s45 offen offset:3456 lds
    v_mfma_f32_16x16x32_bf16 v[44:47], a[96:99], v[160:163], 0
    s_add_u32 m0, s44, 16896
    ds_read_b64_tr_b16 a[80:81], v4 offset:16896
    ds_read_b64_tr_b16 a[82:83], v4 offset:17024
    v_mfma_f32_16x16x32_bf16 v[44:47], a[100:103], v[168:171], v[44:47]
    s_mov_b32 s45, 148224
    buffer_load_dwordx4 v7, s[28:31], s45 offen offset:0 lds
    v_mfma_f32_16x16x32_bf16 v[44:47], a[104:107], v[176:179], v[44:47]
    s_add_u32 m0, s44, 16800
    ds_read_b64_tr_b16 a[84:85], v4 offset:17152
    ds_read_b64_tr_b16 a[86:87], v4 offset:17280
    v_mfma_f32_16x16x32_bf16 v[44:47], a[108:111], v[184:187], v[44:47]
    buffer_load_dwordx4 v7, s[28:31], s45 offen offset:1152 lds
    v_mfma_f32_16x16x32_bf16 v[44:47], a[112:115], v[224:227], v[44:47]
    s_add_u32 m0, s44, 16704
    ds_read_b64_tr_b16 a[88:89], v4 offset:17408
    ds_read_b64_tr_b16 a[90:91], v4 offset:17536
    v_mfma_f32_16x16x32_bf16 v[44:47], a[116:119], v[232:235], v[44:47]
    buffer_load_dwordx4 v7, s[28:31], s45 offen offset:2304 lds
    v_mfma_f32_16x16x32_bf16 v[44:47], a[120:123], v[240:243], v[44:47]
    s_add_u32 m0, s44, 16608
    ds_read_b64_tr_b16 a[92:93], v4 offset:17664
    ds_read_b64_tr_b16 a[94:95], v4 offset:17792
    v_mfma_f32_16x16x32_bf16 v[44:47], a[124:127], v[248:251], v[44:47]
    s_waitcnt lgkmcnt(12)
    buffer_load_dwordx4 v7, s[28:31], s45 offen offset:3456 lds
    v_mfma_f32_16x16x32_bf16 v[16:19], a[64:67], v[128:131], 0
    ds_read_b64_tr_b16 a[96:97], v4 offset:32
    v_cvt_pk_bf16_f32 v48, v32, v33
    v_mfma_f32_16x16x32_bf16 v[16:19], a[68:71], v[136:139], v[16:19]
    s_waitcnt lgkmcnt(9)
    ds_read_b64_tr_b16 a[98:99], v4 offset:160
    v_cvt_pk_bf16_f32 v49, v34, v35
    v_mfma_f32_16x16x32_bf16 v[16:19], a[72:75], v[144:147], v[16:19]
    ds_read_b64_tr_b16 a[100:101], v4 offset:288
    v_cvt_pk_bf16_f32 v50, v40, v41
    v_mfma_f32_16x16x32_bf16 v[16:19], a[76:79], v[152:155], v[16:19]
    s_waitcnt lgkmcnt(7)
    ds_read_b64_tr_b16 a[102:103], v4 offset:416
    v_cvt_pk_bf16_f32 v51, v42, v43
    v_mfma_f32_16x16x32_bf16 v[16:19], a[80:83], v[192:195], v[16:19]
    s_mov_b32 s54, 3072
    ds_read_b64_tr_b16 a[104:105], v4 offset:544
    ds_read_b64_tr_b16 a[106:107], v4 offset:672
    v_mfma_f32_16x16x32_bf16 v[16:19], a[84:87], v[200:203], v[16:19]
    s_waitcnt lgkmcnt(6)
    v_permlane32_swap_b32 v48, v50
    v_mfma_f32_16x16x32_bf16 v[16:19], a[88:91], v[208:211], v[16:19]
    v_permlane32_swap_b32 v49, v51
    v_mfma_f32_16x16x32_bf16 v[16:19], a[92:95], v[216:219], v[16:19]
    ds_read_b64_tr_b16 a[108:109], v4 offset:800
    ds_read_b64_tr_b16 a[110:111], v4 offset:928
    buffer_store_dwordx4 v[48:51], v10, s[40:43], s54 offen offset:512 sc1
    v_mfma_f32_16x16x32_bf16 v[20:23], a[64:67], v[160:163], 0
    ds_read_b64_tr_b16 a[112:113], v4 offset:16928
    v_cvt_pk_bf16_f32 v52, v36, v37
    v_mfma_f32_16x16x32_bf16 v[20:23], a[68:71], v[168:171], v[20:23]
    ds_read_b64_tr_b16 a[114:115], v4 offset:17056
    v_cvt_pk_bf16_f32 v53, v38, v39
    v_mfma_f32_16x16x32_bf16 v[20:23], a[72:75], v[176:179], v[20:23]
    ds_read_b64_tr_b16 a[116:117], v4 offset:17184
    v_cvt_pk_bf16_f32 v54, v44, v45
    v_mfma_f32_16x16x32_bf16 v[20:23], a[76:79], v[184:187], v[20:23]
    ds_read_b64_tr_b16 a[118:119], v4 offset:17312
    v_cvt_pk_bf16_f32 v55, v46, v47
    v_mfma_f32_16x16x32_bf16 v[20:23], a[80:83], v[224:227], v[20:23]
    s_mov_b32 s54, 297984
    ds_read_b64_tr_b16 a[120:121], v4 offset:17440
    ds_read_b64_tr_b16 a[122:123], v4 offset:17568
    v_mfma_f32_16x16x32_bf16 v[20:23], a[84:87], v[232:235], v[20:23]
    v_permlane32_swap_b32 v52, v54
    v_mfma_f32_16x16x32_bf16 v[20:23], a[88:91], v[240:243], v[20:23]
    v_permlane32_swap_b32 v53, v55
    v_mfma_f32_16x16x32_bf16 v[20:23], a[92:95], v[248:251], v[20:23]
    s_waitcnt lgkmcnt(10)
    ds_read_b64_tr_b16 a[124:125], v4 offset:17696
    ds_read_b64_tr_b16 a[126:127], v4 offset:17824
    buffer_store_dwordx4 v[52:55], v10, s[40:43], s54 offen offset:512 sc1
    v_mfma_f32_16x16x32_bf16 v[24:27], a[96:99], v[128:131], 0
    ds_read_b64_tr_b16 a[64:65], v4 offset:64
    v_mfma_f32_16x16x32_bf16 v[24:27], a[100:103], v[136:139], v[24:27]
    s_waitcnt lgkmcnt(9)
    ds_read_b64_tr_b16 a[66:67], v4 offset:192
    v_mfma_f32_16x16x32_bf16 v[24:27], a[104:107], v[144:147], v[24:27]
    ds_read_b64_tr_b16 a[68:69], v4 offset:320
    v_mfma_f32_16x16x32_bf16 v[24:27], a[108:111], v[152:155], v[24:27]
    s_waitcnt lgkmcnt(7)
    ds_read_b64_tr_b16 a[70:71], v4 offset:448
    v_mfma_f32_16x16x32_bf16 v[24:27], a[112:115], v[192:195], v[24:27]
    ds_read_b64_tr_b16 a[72:73], v4 offset:576
    v_mfma_f32_16x16x32_bf16 v[24:27], a[116:119], v[200:203], v[24:27]
    s_waitcnt lgkmcnt(5)
    ds_read_b64_tr_b16 a[74:75], v4 offset:704
    v_mfma_f32_16x16x32_bf16 v[24:27], a[120:123], v[208:211], v[24:27]
    ds_read_b64_tr_b16 a[76:77], v4 offset:832
    v_mfma_f32_16x16x32_bf16 v[24:27], a[124:127], v[216:219], v[24:27]
    ds_read_b64_tr_b16 a[78:79], v4 offset:960
    v_mfma_f32_16x16x32_bf16 v[28:31], a[96:99], v[160:163], 0
    ds_read_b64_tr_b16 a[80:81], v4 offset:16960
    v_mfma_f32_16x16x32_bf16 v[28:31], a[100:103], v[168:171], v[28:31]
    ds_read_b64_tr_b16 a[82:83], v4 offset:17088
    v_mfma_f32_16x16x32_bf16 v[28:31], a[104:107], v[176:179], v[28:31]
    ds_read_b64_tr_b16 a[84:85], v4 offset:17216
    v_mfma_f32_16x16x32_bf16 v[28:31], a[108:111], v[184:187], v[28:31]
    ds_read_b64_tr_b16 a[86:87], v4 offset:17344
    v_mfma_f32_16x16x32_bf16 v[28:31], a[112:115], v[224:227], v[28:31]
    ds_read_b64_tr_b16 a[88:89], v4 offset:17472
    v_mfma_f32_16x16x32_bf16 v[28:31], a[116:119], v[232:235], v[28:31]
    ds_read_b64_tr_b16 a[90:91], v4 offset:17600
    v_mfma_f32_16x16x32_bf16 v[28:31], a[120:123], v[240:243], v[28:31]
    ds_read_b64_tr_b16 a[92:93], v4 offset:17728
    v_mfma_f32_16x16x32_bf16 v[28:31], a[124:127], v[248:251], v[28:31]
    s_waitcnt lgkmcnt(11)
    ds_read_b64_tr_b16 a[94:95], v4 offset:17856
    v_mfma_f32_16x16x32_bf16 v[32:35], a[64:67], v[128:131], 0
    ds_read_b64_tr_b16 a[96:97], v4 offset:96
    v_cvt_pk_bf16_f32 v48, v16, v17
    v_mfma_f32_16x16x32_bf16 v[32:35], a[68:71], v[136:139], v[32:35]
    s_waitcnt lgkmcnt(9)
    ds_read_b64_tr_b16 a[98:99], v4 offset:224
    v_cvt_pk_bf16_f32 v49, v18, v19
    v_mfma_f32_16x16x32_bf16 v[32:35], a[72:75], v[144:147], v[32:35]
    ds_read_b64_tr_b16 a[100:101], v4 offset:352
    v_cvt_pk_bf16_f32 v50, v24, v25
    v_mfma_f32_16x16x32_bf16 v[32:35], a[76:79], v[152:155], v[32:35]
    s_waitcnt lgkmcnt(7)
    ds_read_b64_tr_b16 a[102:103], v4 offset:480
    v_cvt_pk_bf16_f32 v51, v26, v27
    v_mfma_f32_16x16x32_bf16 v[32:35], a[80:83], v[192:195], v[32:35]
    s_mov_b32 s54, 4096
    ds_read_b64_tr_b16 a[104:105], v4 offset:608
    ds_read_b64_tr_b16 a[106:107], v4 offset:736
    v_mfma_f32_16x16x32_bf16 v[32:35], a[84:87], v[200:203], v[32:35]
    s_waitcnt lgkmcnt(6)
    v_permlane32_swap_b32 v48, v50
    v_mfma_f32_16x16x32_bf16 v[32:35], a[88:91], v[208:211], v[32:35]
    v_permlane32_swap_b32 v49, v51
    v_mfma_f32_16x16x32_bf16 v[32:35], a[92:95], v[216:219], v[32:35]
    ds_read_b64_tr_b16 a[108:109], v4 offset:864
    ds_read_b64_tr_b16 a[110:111], v4 offset:992
    buffer_store_dwordx4 v[48:51], v10, s[40:43], s54 offen offset:0 sc1
    v_mfma_f32_16x16x32_bf16 v[36:39], a[64:67], v[160:163], 0
    ds_read_b64_tr_b16 a[112:113], v4 offset:16992
    v_cvt_pk_bf16_f32 v52, v20, v21
    v_mfma_f32_16x16x32_bf16 v[36:39], a[68:71], v[168:171], v[36:39]
    ds_read_b64_tr_b16 a[114:115], v4 offset:17120
    v_cvt_pk_bf16_f32 v53, v22, v23
    v_mfma_f32_16x16x32_bf16 v[36:39], a[72:75], v[176:179], v[36:39]
    ds_read_b64_tr_b16 a[116:117], v4 offset:17248
    v_cvt_pk_bf16_f32 v54, v28, v29
    v_mfma_f32_16x16x32_bf16 v[36:39], a[76:79], v[184:187], v[36:39]
    ds_read_b64_tr_b16 a[118:119], v4 offset:17376
    v_cvt_pk_bf16_f32 v55, v30, v31
    v_mfma_f32_16x16x32_bf16 v[36:39], a[80:83], v[224:227], v[36:39]
    s_mov_b32 s54, 299008
    ds_read_b64_tr_b16 a[120:121], v4 offset:17504
    ds_read_b64_tr_b16 a[122:123], v4 offset:17632
    v_mfma_f32_16x16x32_bf16 v[36:39], a[84:87], v[232:235], v[36:39]
    v_permlane32_swap_b32 v52, v54
    v_mfma_f32_16x16x32_bf16 v[36:39], a[88:91], v[240:243], v[36:39]
    v_permlane32_swap_b32 v53, v55
    v_mfma_f32_16x16x32_bf16 v[36:39], a[92:95], v[248:251], v[36:39]
    s_waitcnt vmcnt(15)
    s_barrier
    s_waitcnt lgkmcnt(10)
    ds_read_b64_tr_b16 a[124:125], v4 offset:17760
    ds_read_b64_tr_b16 a[126:127], v4 offset:17888
    buffer_store_dwordx4 v[52:55], v10, s[40:43], s54 offen offset:0 sc1
    v_mfma_f32_16x16x32_bf16 v[40:43], a[96:99], v[128:131], 0
    s_add_u32 m0, s44, 36864
    ds_read_b64_tr_b16 a[64:65], v4 offset:36864
    ds_read_b64_tr_b16 a[66:67], v4 offset:36992
    v_mfma_f32_16x16x32_bf16 v[40:43], a[100:103], v[136:139], v[40:43]
    s_mov_b32 s45, 896
    s_waitcnt lgkmcnt(10)
    buffer_load_dwordx4 v7, s[28:31], s45 offen offset:0 lds
    v_mfma_f32_16x16x32_bf16 v[40:43], a[104:107], v[144:147], v[40:43]
    s_add_u32 m0, s44, 36768
    ds_read_b64_tr_b16 a[68:69], v4 offset:37120
    ds_read_b64_tr_b16 a[70:71], v4 offset:37248
    v_mfma_f32_16x16x32_bf16 v[40:43], a[108:111], v[152:155], v[40:43]
    s_waitcnt lgkmcnt(8)
    buffer_load_dwordx4 v7, s[28:31], s45 offen offset:1152 lds
    v_mfma_f32_16x16x32_bf16 v[40:43], a[112:115], v[192:195], v[40:43]
    s_add_u32 m0, s44, 36672
    ds_read_b64_tr_b16 a[72:73], v4 offset:37376
    ds_read_b64_tr_b16 a[74:75], v4 offset:37504
    v_mfma_f32_16x16x32_bf16 v[40:43], a[116:119], v[200:203], v[40:43]
    s_waitcnt lgkmcnt(6)
    buffer_load_dwordx4 v7, s[28:31], s45 offen offset:2304 lds
    v_mfma_f32_16x16x32_bf16 v[40:43], a[120:123], v[208:211], v[40:43]
    s_add_u32 m0, s44, 36576
    ds_read_b64_tr_b16 a[76:77], v4 offset:37632
    ds_read_b64_tr_b16 a[78:79], v4 offset:37760
    v_mfma_f32_16x16x32_bf16 v[40:43], a[124:127], v[216:219], v[40:43]
    buffer_load_dwordx4 v7, s[28:31], s45 offen offset:3456 lds
    v_mfma_f32_16x16x32_bf16 v[44:47], a[96:99], v[160:163], 0
    s_add_u32 m0, s44, 53760
    ds_read_b64_tr_b16 a[80:81], v4 offset:53760
    ds_read_b64_tr_b16 a[82:83], v4 offset:53888
    v_mfma_f32_16x16x32_bf16 v[44:47], a[100:103], v[168:171], v[44:47]
    s_mov_b32 s45, 148352
    buffer_load_dwordx4 v7, s[28:31], s45 offen offset:0 lds
    v_mfma_f32_16x16x32_bf16 v[44:47], a[104:107], v[176:179], v[44:47]
    s_add_u32 m0, s44, 53664
    ds_read_b64_tr_b16 a[84:85], v4 offset:54016
    ds_read_b64_tr_b16 a[86:87], v4 offset:54144
    v_mfma_f32_16x16x32_bf16 v[44:47], a[108:111], v[184:187], v[44:47]
    buffer_load_dwordx4 v7, s[28:31], s45 offen offset:1152 lds
    v_mfma_f32_16x16x32_bf16 v[44:47], a[112:115], v[224:227], v[44:47]
    s_add_u32 m0, s44, 53568
    ds_read_b64_tr_b16 a[88:89], v4 offset:54272
    ds_read_b64_tr_b16 a[90:91], v4 offset:54400
    v_mfma_f32_16x16x32_bf16 v[44:47], a[116:119], v[232:235], v[44:47]
    buffer_load_dwordx4 v7, s[28:31], s45 offen offset:2304 lds
    v_mfma_f32_16x16x32_bf16 v[44:47], a[120:123], v[240:243], v[44:47]
    s_add_u32 m0, s44, 53472
    ds_read_b64_tr_b16 a[92:93], v4 offset:54528
    ds_read_b64_tr_b16 a[94:95], v4 offset:54656
    v_mfma_f32_16x16x32_bf16 v[44:47], a[124:127], v[248:251], v[44:47]
    s_waitcnt lgkmcnt(12)
    buffer_load_dwordx4 v7, s[28:31], s45 offen offset:3456 lds
    v_mfma_f32_16x16x32_bf16 v[16:19], a[64:67], v[128:131], 0
    ds_read_b64_tr_b16 a[96:97], v4 offset:36896
    v_cvt_pk_bf16_f32 v48, v32, v33
    v_mfma_f32_16x16x32_bf16 v[16:19], a[68:71], v[136:139], v[16:19]
    s_waitcnt lgkmcnt(9)
    ds_read_b64_tr_b16 a[98:99], v4 offset:37024
    v_cvt_pk_bf16_f32 v49, v34, v35
    v_mfma_f32_16x16x32_bf16 v[16:19], a[72:75], v[144:147], v[16:19]
    ds_read_b64_tr_b16 a[100:101], v4 offset:37152
    v_cvt_pk_bf16_f32 v50, v40, v41
    v_mfma_f32_16x16x32_bf16 v[16:19], a[76:79], v[152:155], v[16:19]
    s_waitcnt lgkmcnt(7)
    ds_read_b64_tr_b16 a[102:103], v4 offset:37280
    v_cvt_pk_bf16_f32 v51, v42, v43
    v_mfma_f32_16x16x32_bf16 v[16:19], a[80:83], v[192:195], v[16:19]
    s_mov_b32 s54, 4096
    ds_read_b64_tr_b16 a[104:105], v4 offset:37408
    ds_read_b64_tr_b16 a[106:107], v4 offset:37536
    v_mfma_f32_16x16x32_bf16 v[16:19], a[84:87], v[200:203], v[16:19]
    s_waitcnt lgkmcnt(6)
    v_permlane32_swap_b32 v48, v50
    v_mfma_f32_16x16x32_bf16 v[16:19], a[88:91], v[208:211], v[16:19]
    v_permlane32_swap_b32 v49, v51
    v_mfma_f32_16x16x32_bf16 v[16:19], a[92:95], v[216:219], v[16:19]
    ds_read_b64_tr_b16 a[108:109], v4 offset:37664
    ds_read_b64_tr_b16 a[110:111], v4 offset:37792
    buffer_store_dwordx4 v[48:51], v10, s[40:43], s54 offen offset:512 sc1
    v_mfma_f32_16x16x32_bf16 v[20:23], a[64:67], v[160:163], 0
    ds_read_b64_tr_b16 a[112:113], v4 offset:53792
    v_cvt_pk_bf16_f32 v52, v36, v37
    v_mfma_f32_16x16x32_bf16 v[20:23], a[68:71], v[168:171], v[20:23]
    ds_read_b64_tr_b16 a[114:115], v4 offset:53920
    v_cvt_pk_bf16_f32 v53, v38, v39
    v_mfma_f32_16x16x32_bf16 v[20:23], a[72:75], v[176:179], v[20:23]
    ds_read_b64_tr_b16 a[116:117], v4 offset:54048
    v_cvt_pk_bf16_f32 v54, v44, v45
    v_mfma_f32_16x16x32_bf16 v[20:23], a[76:79], v[184:187], v[20:23]
    ds_read_b64_tr_b16 a[118:119], v4 offset:54176
    v_cvt_pk_bf16_f32 v55, v46, v47
    v_mfma_f32_16x16x32_bf16 v[20:23], a[80:83], v[224:227], v[20:23]
    s_mov_b32 s54, 299008
    ds_read_b64_tr_b16 a[120:121], v4 offset:54304
    ds_read_b64_tr_b16 a[122:123], v4 offset:54432
    v_mfma_f32_16x16x32_bf16 v[20:23], a[84:87], v[232:235], v[20:23]
    v_permlane32_swap_b32 v52, v54
    v_mfma_f32_16x16x32_bf16 v[20:23], a[88:91], v[240:243], v[20:23]
    v_permlane32_swap_b32 v53, v55
    v_mfma_f32_16x16x32_bf16 v[20:23], a[92:95], v[248:251], v[20:23]
    s_waitcnt lgkmcnt(10)
    ds_read_b64_tr_b16 a[124:125], v4 offset:54560
    ds_read_b64_tr_b16 a[126:127], v4 offset:54688
    buffer_store_dwordx4 v[52:55], v10, s[40:43], s54 offen offset:512 sc1
    v_mfma_f32_16x16x32_bf16 v[24:27], a[96:99], v[128:131], 0
L2_pad12:
    s_cbranch_execz L2_walkret
    ds_read_b64_tr_b16 a[64:65], v4 offset:36928
    v_mfma_f32_16x16x32_bf16 v[24:27], a[100:103], v[136:139], v[24:27]
    s_waitcnt lgkmcnt(9)
    ds_read_b64_tr_b16 a[66:67], v4 offset:37056
    v_mfma_f32_16x16x32_bf16 v[24:27], a[104:107], v[144:147], v[24:27]
    ds_read_b64_tr_b16 a[68:69], v4 offset:37184
    v_mfma_f32_16x16x32_bf16 v[24:27], a[108:111], v[152:155], v[24:27]
    s_waitcnt lgkmcnt(7)
    ds_read_b64_tr_b16 a[70:71], v4 offset:37312
    v_mfma_f32_16x16x32_bf16 v[24:27], a[112:115], v[192:195], v[24:27]
    ds_read_b64_tr_b16 a[72:73], v4 offset:37440
    v_mfma_f32_16x16x32_bf16 v[24:27], a[116:119], v[200:203], v[24:27]
    s_waitcnt lgkmcnt(5)
    ds_read_b64_tr_b16 a[74:75], v4 offset:37568
    v_mfma_f32_16x16x32_bf16 v[24:27], a[120:123], v[208:211], v[24:27]
    ds_read_b64_tr_b16 a[76:77], v4 offset:37696
    v_mfma_f32_16x16x32_bf16 v[24:27], a[124:127], v[216:219], v[24:27]
    ds_read_b64_tr_b16 a[78:79], v4 offset:37824
    v_mfma_f32_16x16x32_bf16 v[28:31], a[96:99], v[160:163], 0
    ds_read_b64_tr_b16 a[80:81], v4 offset:53824
    v_mfma_f32_16x16x32_bf16 v[28:31], a[100:103], v[168:171], v[28:31]
    ds_read_b64_tr_b16 a[82:83], v4 offset:53952
    v_mfma_f32_16x16x32_bf16 v[28:31], a[104:107], v[176:179], v[28:31]
    ds_read_b64_tr_b16 a[84:85], v4 offset:54080
    v_mfma_f32_16x16x32_bf16 v[28:31], a[108:111], v[184:187], v[28:31]
    ds_read_b64_tr_b16 a[86:87], v4 offset:54208
    v_mfma_f32_16x16x32_bf16 v[28:31], a[112:115], v[224:227], v[28:31]
    ds_read_b64_tr_b16 a[88:89], v4 offset:54336
    v_mfma_f32_16x16x32_bf16 v[28:31], a[116:119], v[232:235], v[28:31]
    ds_read_b64_tr_b16 a[90:91], v4 offset:54464
    v_mfma_f32_16x16x32_bf16 v[28:31], a[120:123], v[240:243], v[28:31]
    ds_read_b64_tr_b16 a[92:93], v4 offset:54592
    v_mfma_f32_16x16x32_bf16 v[28:31], a[124:127], v[248:251], v[28:31]
    s_waitcnt lgkmcnt(11)
    ds_read_b64_tr_b16 a[94:95], v4 offset:54720
    v_mfma_f32_16x16x32_bf16 v[32:35], a[64:67], v[128:131], 0
    ds_read_b64_tr_b16 a[96:97], v4 offset:36960
    v_cvt_pk_bf16_f32 v48, v16, v17
    v_mfma_f32_16x16x32_bf16 v[32:35], a[68:71], v[136:139], v[32:35]
    s_waitcnt lgkmcnt(9)
    ds_read_b64_tr_b16 a[98:99], v4 offset:37088
    v_cvt_pk_bf16_f32 v49, v18, v19
    v_mfma_f32_16x16x32_bf16 v[32:35], a[72:75], v[144:147], v[32:35]
    ds_read_b64_tr_b16 a[100:101], v4 offset:37216
    v_cvt_pk_bf16_f32 v50, v24, v25
    v_mfma_f32_16x16x32_bf16 v[32:35], a[76:79], v[152:155], v[32:35]
    s_waitcnt lgkmcnt(7)
    ds_read_b64_tr_b16 a[102:103], v4 offset:37344
    v_cvt_pk_bf16_f32 v51, v26, v27
    v_mfma_f32_16x16x32_bf16 v[32:35], a[80:83], v[192:195], v[32:35]
    s_mov_b32 s54, 5120
    ds_read_b64_tr_b16 a[104:105], v4 offset:37472
    ds_read_b64_tr_b16 a[106:107], v4 offset:37600
    v_mfma_f32_16x16x32_bf16 v[32:35], a[84:87], v[200:203], v[32:35]
    s_waitcnt lgkmcnt(6)
    v_permlane32_swap_b32 v48, v50
    v_mfma_f32_16x16x32_bf16 v[32:35], a[88:91], v[208:211], v[32:35]
    v_permlane32_swap_b32 v49, v51
    v_mfma_f32_16x16x32_bf16 v[32:35], a[92:95], v[216:219], v[32:35]
    ds_read_b64_tr_b16 a[108:109], v4 offset:37728
    ds_read_b64_tr_b16 a[110:111], v4 offset:37856
    buffer_store_dwordx4 v[48:51], v10, s[40:43], s54 offen offset:0 sc1
    v_mfma_f32_16x16x32_bf16 v[36:39], a[64:67], v[160:163], 0
    ds_read_b64_tr_b16 a[112:113], v4 offset:53856
    v_cvt_pk_bf16_f32 v52, v20, v21
    v_mfma_f32_16x16x32_bf16 v[36:39], a[68:71], v[168:171], v[36:39]
    ds_read_b64_tr_b16 a[114:115], v4 offset:53984
    v_cvt_pk_bf16_f32 v53, v22, v23
    v_mfma_f32_16x16x32_bf16 v[36:39], a[72:75], v[176:179], v[36:39]
    ds_read_b64_tr_b16 a[116:117], v4 offset:54112
    v_cvt_pk_bf16_f32 v54, v28, v29
    v_mfma_f32_16x16x32_bf16 v[36:39], a[76:79], v[184:187], v[36:39]
    ds_read_b64_tr_b16 a[118:119], v4 offset:54240
    v_cvt_pk_bf16_f32 v55, v30, v31
    v_mfma_f32_16x16x32_bf16 v[36:39], a[80:83], v[224:227], v[36:39]
    s_mov_b32 s54, 300032
    ds_read_b64_tr_b16 a[120:121], v4 offset:54368
    ds_read_b64_tr_b16 a[122:123], v4 offset:54496
    v_mfma_f32_16x16x32_bf16 v[36:39], a[84:87], v[232:235], v[36:39]
    v_permlane32_swap_b32 v52, v54
    v_mfma_f32_16x16x32_bf16 v[36:39], a[88:91], v[240:243], v[36:39]
    v_permlane32_swap_b32 v53, v55
    v_mfma_f32_16x16x32_bf16 v[36:39], a[92:95], v[248:251], v[36:39]
    s_waitcnt vmcnt(15)
    s_barrier
    s_waitcnt lgkmcnt(10)
    ds_read_b64_tr_b16 a[124:125], v4 offset:54624
    ds_read_b64_tr_b16 a[126:127], v4 offset:54752
    buffer_store_dwordx4 v[52:55], v10, s[40:43], s54 offen offset:0 sc1
    v_mfma_f32_16x16x32_bf16 v[40:43], a[96:99], v[128:131], 0
    s_add_u32 m0, s44, 73728
    ds_read_b64_tr_b16 a[64:65], v3 offset:0
    ds_read_b64_tr_b16 a[66:67], v3 offset:128
    v_mfma_f32_16x16x32_bf16 v[40:43], a[100:103], v[136:139], v[40:43]
    s_mov_b32 s45, 1024
    s_waitcnt lgkmcnt(10)
    buffer_load_dwordx4 v7, s[28:31], s45 offen offset:0 lds
    v_mfma_f32_16x16x32_bf16 v[40:43], a[104:107], v[144:147], v[40:43]
    s_add_u32 m0, s44, 73632
    ds_read_b64_tr_b16 a[68:69], v3 offset:256
    ds_read_b64_tr_b16 a[70:71], v3 offset:384
    v_mfma_f32_16x16x32_bf16 v[40:43], a[108:111], v[152:155], v[40:43]
    s_waitcnt lgkmcnt(8)
    buffer_load_dwordx4 v7, s[28:31], s45 offen offset:1152 lds
    v_mfma_f32_16x16x32_bf16 v[40:43], a[112:115], v[192:195], v[40:43]
    s_add_u32 m0, s44, 73536
    ds_read_b64_tr_b16 a[72:73], v3 offset:512
    ds_read_b64_tr_b16 a[74:75], v3 offset:640
    v_mfma_f32_16x16x32_bf16 v[40:43], a[116:119], v[200:203], v[40:43]
    s_waitcnt lgkmcnt(6)
    buffer_load_dwordx4 v7, s[28:31], s45 offen offset:2304 lds
    v_mfma_f32_16x16x32_bf16 v[40:43], a[120:123], v[208:211], v[40:43]
    s_add_u32 m0, s44, 73440
    ds_read_b64_tr_b16 a[76:77], v3 offset:768
    ds_read_b64_tr_b16 a[78:79], v3 offset:896
    v_mfma_f32_16x16x32_bf16 v[40:43], a[124:127], v[216:219], v[40:43]
    buffer_load_dwordx4 v7, s[28:31], s45 offen offset:3456 lds
    v_mfma_f32_16x16x32_bf16 v[44:47], a[96:99], v[160:163], 0
    s_add_u32 m0, s44, 90624
    ds_read_b64_tr_b16 a[80:81], v3 offset:16896
    ds_read_b64_tr_b16 a[82:83], v3 offset:17024
    v_mfma_f32_16x16x32_bf16 v[44:47], a[100:103], v[168:171], v[44:47]
    s_mov_b32 s45, 148480
    buffer_load_dwordx4 v7, s[28:31], s45 offen offset:0 lds
    v_mfma_f32_16x16x32_bf16 v[44:47], a[104:107], v[176:179], v[44:47]
    s_add_u32 m0, s44, 90528
    ds_read_b64_tr_b16 a[84:85], v3 offset:17152
    ds_read_b64_tr_b16 a[86:87], v3 offset:17280
    v_mfma_f32_16x16x32_bf16 v[44:47], a[108:111], v[184:187], v[44:47]
    buffer_load_dwordx4 v7, s[28:31], s45 offen offset:1152 lds
    v_mfma_f32_16x16x32_bf16 v[44:47], a[112:115], v[224:227], v[44:47]
    s_add_u32 m0, s44, 90432
    ds_read_b64_tr_b16 a[88:89], v3 offset:17408
    ds_read_b64_tr_b16 a[90:91], v3 offset:17536
    v_mfma_f32_16x16x32_bf16 v[44:47], a[116:119], v[232:235], v[44:47]
    buffer_load_dwordx4 v7, s[28:31], s45 offen offset:2304 lds
    v_mfma_f32_16x16x32_bf16 v[44:47], a[120:123], v[240:243], v[44:47]
    s_add_u32 m0, s44, 90336
    ds_read_b64_tr_b16 a[92:93], v3 offset:17664
    ds_read_b64_tr_b16 a[94:95], v3 offset:17792
    v_mfma_f32_16x16x32_bf16 v[44:47], a[124:127], v[248:251], v[44:47]
    s_waitcnt lgkmcnt(12)
    buffer_load_dwordx4 v7, s[28:31], s45 offen offset:3456 lds
    v_mfma_f32_16x16x32_bf16 v[16:19], a[64:67], v[128:131], 0
    ds_read_b64_tr_b16 a[96:97], v3 offset:32
    v_cvt_pk_bf16_f32 v48, v32, v33
    v_mfma_f32_16x16x32_bf16 v[16:19], a[68:71], v[136:139], v[16:19]
    s_waitcnt lgkmcnt(9)
    ds_read_b64_tr_b16 a[98:99], v3 offset:160
    v_cvt_pk_bf16_f32 v49, v34, v35
    v_mfma_f32_16x16x32_bf16 v[16:19], a[72:75], v[144:147], v[16:19]
    ds_read_b64_tr_b16 a[100:101], v3 offset:288
    v_cvt_pk_bf16_f32 v50, v40, v41
    v_mfma_f32_16x16x32_bf16 v[16:19], a[76:79], v[152:155], v[16:19]
    s_waitcnt lgkmcnt(7)
    ds_read_b64_tr_b16 a[102:103], v3 offset:416
    v_cvt_pk_bf16_f32 v51, v42, v43
    v_mfma_f32_16x16x32_bf16 v[16:19], a[80:83], v[192:195], v[16:19]
    s_mov_b32 s54, 5120
    ds_read_b64_tr_b16 a[104:105], v3 offset:544
    ds_read_b64_tr_b16 a[106:107], v3 offset:672
    v_mfma_f32_16x16x32_bf16 v[16:19], a[84:87], v[200:203], v[16:19]
    s_waitcnt lgkmcnt(6)
    v_permlane32_swap_b32 v48, v50
    v_mfma_f32_16x16x32_bf16 v[16:19], a[88:91], v[208:211], v[16:19]
    v_permlane32_swap_b32 v49, v51
    v_mfma_f32_16x16x32_bf16 v[16:19], a[92:95], v[216:219], v[16:19]
    ds_read_b64_tr_b16 a[108:109], v3 offset:800
    ds_read_b64_tr_b16 a[110:111], v3 offset:928
    buffer_store_dwordx4 v[48:51], v10, s[40:43], s54 offen offset:512 sc1
    v_mfma_f32_16x16x32_bf16 v[20:23], a[64:67], v[160:163], 0
    ds_read_b64_tr_b16 a[112:113], v3 offset:16928
    v_cvt_pk_bf16_f32 v52, v36, v37
    v_mfma_f32_16x16x32_bf16 v[20:23], a[68:71], v[168:171], v[20:23]
    ds_read_b64_tr_b16 a[114:115], v3 offset:17056
    v_cvt_pk_bf16_f32 v53, v38, v39
    v_mfma_f32_16x16x32_bf16 v[20:23], a[72:75], v[176:179], v[20:23]
    ds_read_b64_tr_b16 a[116:117], v3 offset:17184
    v_cvt_pk_bf16_f32 v54, v44, v45
    v_mfma_f32_16x16x32_bf16 v[20:23], a[76:79], v[184:187], v[20:23]
    ds_read_b64_tr_b16 a[118:119], v3 offset:17312
    v_cvt_pk_bf16_f32 v55, v46, v47
    v_mfma_f32_16x16x32_bf16 v[20:23], a[80:83], v[224:227], v[20:23]
    s_mov_b32 s54, 300032
    ds_read_b64_tr_b16 a[120:121], v3 offset:17440
    ds_read_b64_tr_b16 a[122:123], v3 offset:17568
    v_mfma_f32_16x16x32_bf16 v[20:23], a[84:87], v[232:235], v[20:23]
    v_permlane32_swap_b32 v52, v54
    v_mfma_f32_16x16x32_bf16 v[20:23], a[88:91], v[240:243], v[20:23]
    v_permlane32_swap_b32 v53, v55
    v_mfma_f32_16x16x32_bf16 v[20:23], a[92:95], v[248:251], v[20:23]
    s_waitcnt lgkmcnt(10)
    ds_read_b64_tr_b16 a[124:125], v3 offset:17696
    ds_read_b64_tr_b16 a[126:127], v3 offset:17824
    buffer_store_dwordx4 v[52:55], v10, s[40:43], s54 offen offset:512 sc1
    v_mfma_f32_16x16x32_bf16 v[24:27], a[96:99], v[128:131], 0
    ds_read_b64_tr_b16 a[64:65], v3 offset:64
    v_mfma_f32_16x16x32_bf16 v[24:27], a[100:103], v[136:139], v[24:27]
    s_waitcnt lgkmcnt(9)
    ds_read_b64_tr_b16 a[66:67], v3 offset:192
    v_mfma_f32_16x16x32_bf16 v[24:27], a[104:107], v[144:147], v[24:27]
    ds_read_b64_tr_b16 a[68:69], v3 offset:320
    v_mfma_f32_16x16x32_bf16 v[24:27], a[108:111], v[152:155], v[24:27]
    s_waitcnt lgkmcnt(7)
    ds_read_b64_tr_b16 a[70:71], v3 offset:448
    v_mfma_f32_16x16x32_bf16 v[24:27], a[112:115], v[192:195], v[24:27]
    ds_read_b64_tr_b16 a[72:73], v3 offset:576
    v_mfma_f32_16x16x32_bf16 v[24:27], a[116:119], v[200:203], v[24:27]
    s_waitcnt lgkmcnt(5)
    ds_read_b64_tr_b16 a[74:75], v3 offset:704
    v_mfma_f32_16x16x32_bf16 v[24:27], a[120:123], v[208:211], v[24:27]
    ds_read_b64_tr_b16 a[76:77], v3 offset:832
    v_mfma_f32_16x16x32_bf16 v[24:27], a[124:127], v[216:219], v[24:27]
    ds_read_b64_tr_b16 a[78:79], v3 offset:960
    v_mfma_f32_16x16x32_bf16 v[28:31], a[96:99], v[160:163], 0
    ds_read_b64_tr_b16 a[80:81], v3 offset:16960
    v_mfma_f32_16x16x32_bf16 v[28:31], a[100:103], v[168:171], v[28:31]
    ds_read_b64_tr_b16 a[82:83], v3 offset:17088
    v_mfma_f32_16x16x32_bf16 v[28:31], a[104:107], v[176:179], v[28:31]
    ds_read_b64_tr_b16 a[84:85], v3 offset:17216
    v_mfma_f32_16x16x32_bf16 v[28:31], a[108:111], v[184:187], v[28:31]
    ds_read_b64_tr_b16 a[86:87], v3 offset:17344
    v_mfma_f32_16x16x32_bf16 v[28:31], a[112:115], v[224:227], v[28:31]
    ds_read_b64_tr_b16 a[88:89], v3 offset:17472
    v_mfma_f32_16x16x32_bf16 v[28:31], a[116:119], v[232:235], v[28:31]
    ds_read_b64_tr_b16 a[90:91], v3 offset:17600
    v_mfma_f32_16x16x32_bf16 v[28:31], a[120:123], v[240:243], v[28:31]
    ds_read_b64_tr_b16 a[92:93], v3 offset:17728
    v_mfma_f32_16x16x32_bf16 v[28:31], a[124:127], v[248:251], v[28:31]
    s_waitcnt lgkmcnt(11)
    ds_read_b64_tr_b16 a[94:95], v3 offset:17856
    v_mfma_f32_16x16x32_bf16 v[32:35], a[64:67], v[128:131], 0
    ds_read_b64_tr_b16 a[96:97], v3 offset:96
    v_cvt_pk_bf16_f32 v48, v16, v17
    v_mfma_f32_16x16x32_bf16 v[32:35], a[68:71], v[136:139], v[32:35]
    s_waitcnt lgkmcnt(9)
    ds_read_b64_tr_b16 a[98:99], v3 offset:224
    v_cvt_pk_bf16_f32 v49, v18, v19
    v_mfma_f32_16x16x32_bf16 v[32:35], a[72:75], v[144:147], v[32:35]
    ds_read_b64_tr_b16 a[100:101], v3 offset:352
    v_cvt_pk_bf16_f32 v50, v24, v25
    v_mfma_f32_16x16x32_bf16 v[32:35], a[76:79], v[152:155], v[32:35]
    s_waitcnt lgkmcnt(7)
    ds_read_b64_tr_b16 a[102:103], v3 offset:480
    v_cvt_pk_bf16_f32 v51, v26, v27
    v_mfma_f32_16x16x32_bf16 v[32:35], a[80:83], v[192:195], v[32:35]
    s_mov_b32 s54, 6144
    ds_read_b64_tr_b16 a[104:105], v3 offset:608
    ds_read_b64_tr_b16 a[106:107], v3 offset:736
    v_mfma_f32_16x16x32_bf16 v[32:35], a[84:87], v[200:203], v[32:35]
    s_waitcnt lgkmcnt(6)
    v_permlane32_swap_b32 v48, v50
    v_mfma_f32_16x16x32_bf16 v[32:35], a[88:91], v[208:211], v[32:35]
    v_permlane32_swap_b32 v49, v51
    v_mfma_f32_16x16x32_bf16 v[32:35], a[92:95], v[216:219], v[32:35]
    ds_read_b64_tr_b16 a[108:109], v3 offset:864
    ds_read_b64_tr_b16 a[110:111], v3 offset:992
    buffer_store_dwordx4 v[48:51], v10, s[40:43], s54 offen offset:0 sc1
    v_mfma_f32_16x16x32_bf16 v[36:39], a[64:67], v[160:163], 0
    ds_read_b64_tr_b16 a[112:113], v3 offset:16992
    v_cvt_pk_bf16_f32 v52, v20, v21
    v_mfma_f32_16x16x32_bf16 v[36:39], a[68:71], v[168:171], v[36:39]
    ds_read_b64_tr_b16 a[114:115], v3 offset:17120
    v_cvt_pk_bf16_f32 v53, v22, v23
    v_mfma_f32_16x16x32_bf16 v[36:39], a[72:75], v[176:179], v[36:39]
    ds_read_b64_tr_b16 a[116:117], v3 offset:17248
    v_cvt_pk_bf16_f32 v54, v28, v29
    v_mfma_f32_16x16x32_bf16 v[36:39], a[76:79], v[184:187], v[36:39]
    ds_read_b64_tr_b16 a[118:119], v3 offset:17376
    v_cvt_pk_bf16_f32 v55, v30, v31
    v_mfma_f32_16x16x32_bf16 v[36:39], a[80:83], v[224:227], v[36:39]
    s_mov_b32 s54, 301056
    ds_read_b64_tr_b16 a[120:121], v3 offset:17504
    ds_read_b64_tr_b16 a[122:123], v3 offset:17632
    v_mfma_f32_16x16x32_bf16 v[36:39], a[84:87], v[232:235], v[36:39]
    v_permlane32_swap_b32 v52, v54
    v_mfma_f32_16x16x32_bf16 v[36:39], a[88:91], v[240:243], v[36:39]
    v_permlane32_swap_b32 v53, v55
    v_mfma_f32_16x16x32_bf16 v[36:39], a[92:95], v[248:251], v[36:39]
    s_waitcnt vmcnt(15)
    s_barrier
    s_waitcnt lgkmcnt(10)
    ds_read_b64_tr_b16 a[124:125], v3 offset:17760
    ds_read_b64_tr_b16 a[126:127], v3 offset:17888
    buffer_store_dwordx4 v[52:55], v10, s[40:43], s54 offen offset:0 sc1
    v_mfma_f32_16x16x32_bf16 v[40:43], a[96:99], v[128:131], 0
    ds_read_b64_tr_b16 a[64:65], v3 offset:36864
    v_mfma_f32_16x16x32_bf16 v[40:43], a[100:103], v[136:139], v[40:43]
    s_waitcnt lgkmcnt(9)
    ds_read_b64_tr_b16 a[66:67], v3 offset:36992
    v_mfma_f32_16x16x32_bf16 v[40:43], a[104:107], v[144:147], v[40:43]
    ds_read_b64_tr_b16 a[68:69], v3 offset:37120
    v_mfma_f32_16x16x32_bf16 v[40:43], a[108:111], v[152:155], v[40:43]
    s_waitcnt lgkmcnt(7)
    ds_read_b64_tr_b16 a[70:71], v3 offset:37248
    v_mfma_f32_16x16x32_bf16 v[40:43], a[112:115], v[192:195], v[40:43]
    ds_read_b64_tr_b16 a[72:73], v3 offset:37376
    v_mfma_f32_16x16x32_bf16 v[40:43], a[116:119], v[200:203], v[40:43]
    s_waitcnt lgkmcnt(5)
    ds_read_b64_tr_b16 a[74:75], v3 offset:37504
    v_mfma_f32_16x16x32_bf16 v[40:43], a[120:123], v[208:211], v[40:43]
    ds_read_b64_tr_b16 a[76:77], v3 offset:37632
    v_mfma_f32_16x16x32_bf16 v[40:43], a[124:127], v[216:219], v[40:43]
    ds_read_b64_tr_b16 a[78:79], v3 offset:37760
    v_mfma_f32_16x16x32_bf16 v[44:47], a[96:99], v[160:163], 0
    s_sub_u32 s28, s88, 4096
    s_subb_u32 s29, s89, 0
    ds_read_b64_tr_b16 a[80:81], v3 offset:53760
    v_mfma_f32_16x16x32_bf16 v[44:47], a[100:103], v[168:171], v[44:47]
    s_mov_b32 s30, 147456
    ds_read_b64_tr_b16 a[82:83], v3 offset:53888
    v_mfma_f32_16x16x32_bf16 v[44:47], a[104:107], v[176:179], v[44:47]
    ds_read_b64_tr_b16 a[84:85], v3 offset:54016
    v_mfma_f32_16x16x32_bf16 v[44:47], a[108:111], v[184:187], v[44:47]
    ds_read_b64_tr_b16 a[86:87], v3 offset:54144
    v_mfma_f32_16x16x32_bf16 v[44:47], a[112:115], v[224:227], v[44:47]
    ds_read_b64_tr_b16 a[88:89], v3 offset:54272
    v_mfma_f32_16x16x32_bf16 v[44:47], a[116:119], v[232:235], v[44:47]
    ds_read_b64_tr_b16 a[90:91], v3 offset:54400
    v_mfma_f32_16x16x32_bf16 v[44:47], a[120:123], v[240:243], v[44:47]
    ds_read_b64_tr_b16 a[92:93], v3 offset:54528
    v_mfma_f32_16x16x32_bf16 v[44:47], a[124:127], v[248:251], v[44:47]
    s_waitcnt lgkmcnt(11)
    ds_read_b64_tr_b16 a[94:95], v3 offset:54656
    v_mfma_f32_16x16x32_bf16 v[16:19], a[64:67], v[128:131], 0
    ds_read_b64_tr_b16 a[96:97], v3 offset:36896
    v_cvt_pk_bf16_f32 v48, v32, v33
    v_mfma_f32_16x16x32_bf16 v[16:19], a[68:71], v[136:139], v[16:19]
    s_waitcnt lgkmcnt(9)
    ds_read_b64_tr_b16 a[98:99], v3 offset:37024
    v_cvt_pk_bf16_f32 v49, v34, v35
    v_mfma_f32_16x16x32_bf16 v[16:19], a[72:75], v[144:147], v[16:19]
    ds_read_b64_tr_b16 a[100:101], v3 offset:37152
    v_cvt_pk_bf16_f32 v50, v40, v41
    v_mfma_f32_16x16x32_bf16 v[16:19], a[76:79], v[152:155], v[16:19]
    s_waitcnt lgkmcnt(7)
    ds_read_b64_tr_b16 a[102:103], v3 offset:37280
    v_cvt_pk_bf16_f32 v51, v42, v43
    v_mfma_f32_16x16x32_bf16 v[16:19], a[80:83], v[192:195], v[16:19]
    s_mov_b32 s54, 6144
    ds_read_b64_tr_b16 a[104:105], v3 offset:37408
    ds_read_b64_tr_b16 a[106:107], v3 offset:37536
    v_mfma_f32_16x16x32_bf16 v[16:19], a[84:87], v[200:203], v[16:19]
    s_waitcnt lgkmcnt(6)
    v_permlane32_swap_b32 v48, v50
    v_mfma_f32_16x16x32_bf16 v[16:19], a[88:91], v[208:211], v[16:19]
    v_permlane32_swap_b32 v49, v51
    v_mfma_f32_16x16x32_bf16 v[16:19], a[92:95], v[216:219], v[16:19]
    ds_read_b64_tr_b16 a[108:109], v3 offset:37664
    ds_read_b64_tr_b16 a[110:111], v3 offset:37792
    buffer_store_dwordx4 v[48:51], v10, s[40:43], s54 offen offset:512 sc1
    v_mfma_f32_16x16x32_bf16 v[20:23], a[64:67], v[160:163], 0
    ds_read_b64_tr_b16 a[112:113], v3 offset:53792
    v_cvt_pk_bf16_f32 v52, v36, v37
    v_mfma_f32_16x16x32_bf16 v[20:23], a[68:71], v[168:171], v[20:23]
    ds_read_b64_tr_b16 a[114:115], v3 offset:53920
    v_cvt_pk_bf16_f32 v53, v38, v39
    v_mfma_f32_16x16x32_bf16 v[20:23], a[72:75], v[176:179], v[20:23]
    ds_read_b64_tr_b16 a[116:117], v3 offset:54048
    v_cvt_pk_bf16_f32 v54, v44, v45
    v_mfma_f32_16x16x32_bf16 v[20:23], a[76:79], v[184:187], v[20:23]
    ds_read_b64_tr_b16 a[118:119], v3 offset:54176
    v_cvt_pk_bf16_f32 v55, v46, v47
    v_mfma_f32_16x16x32_bf16 v[20:23], a[80:83], v[224:227], v[20:23]
    s_mov_b32 s54, 301056
    ds_read_b64_tr_b16 a[120:121], v3 offset:54304
    ds_read_b64_tr_b16 a[122:123], v3 offset:54432
    v_mfma_f32_16x16x32_bf16 v[20:23], a[84:87], v[232:235], v[20:23]
    v_permlane32_swap_b32 v52, v54
    v_mfma_f32_16x16x32_bf16 v[20:23], a[88:91], v[240:243], v[20:23]
    v_permlane32_swap_b32 v53, v55
    v_mfma_f32_16x16x32_bf16 v[20:23], a[92:95], v[248:251], v[20:23]
    s_waitcnt lgkmcnt(10)
    ds_read_b64_tr_b16 a[124:125], v3 offset:54560
    ds_read_b64_tr_b16 a[126:127], v3 offset:54688
    buffer_store_dwordx4 v[52:55], v10, s[40:43], s54 offen offset:512 sc1
    v_mfma_f32_16x16x32_bf16 v[24:27], a[96:99], v[128:131], 0
    ds_read_b64_tr_b16 a[64:65], v3 offset:36928
    v_mfma_f32_16x16x32_bf16 v[24:27], a[100:103], v[136:139], v[24:27]
    s_waitcnt lgkmcnt(9)
    ds_read_b64_tr_b16 a[66:67], v3 offset:37056
    v_mfma_f32_16x16x32_bf16 v[24:27], a[104:107], v[144:147], v[24:27]
    ds_read_b64_tr_b16 a[68:69], v3 offset:37184
    v_mfma_f32_16x16x32_bf16 v[24:27], a[108:111], v[152:155], v[24:27]
    s_waitcnt lgkmcnt(7)
    ds_read_b64_tr_b16 a[70:71], v3 offset:37312
    v_mfma_f32_16x16x32_bf16 v[24:27], a[112:115], v[192:195], v[24:27]
    ds_read_b64_tr_b16 a[72:73], v3 offset:37440
    v_mfma_f32_16x16x32_bf16 v[24:27], a[116:119], v[200:203], v[24:27]
    s_waitcnt lgkmcnt(5)
    ds_read_b64_tr_b16 a[74:75], v3 offset:37568
    v_mfma_f32_16x16x32_bf16 v[24:27], a[120:123], v[208:211], v[24:27]
    ds_read_b64_tr_b16 a[76:77], v3 offset:37696
    v_mfma_f32_16x16x32_bf16 v[24:27], a[124:127], v[216:219], v[24:27]
    ds_read_b64_tr_b16 a[78:79], v3 offset:37824
    v_mfma_f32_16x16x32_bf16 v[28:31], a[96:99], v[160:163], 0
    ds_read_b64_tr_b16 a[80:81], v3 offset:53824
    v_mfma_f32_16x16x32_bf16 v[28:31], a[100:103], v[168:171], v[28:31]
    ds_read_b64_tr_b16 a[82:83], v3 offset:53952
    v_mfma_f32_16x16x32_bf16 v[28:31], a[104:107], v[176:179], v[28:31]
    ds_read_b64_tr_b16 a[84:85], v3 offset:54080
    v_mfma_f32_16x16x32_bf16 v[28:31], a[108:111], v[184:187], v[28:31]
    ds_read_b64_tr_b16 a[86:87], v3 offset:54208
    v_mfma_f32_16x16x32_bf16 v[28:31], a[112:115], v[224:227], v[28:31]
    ds_read_b64_tr_b16 a[88:89], v3 offset:54336
    v_mfma_f32_16x16x32_bf16 v[28:31], a[116:119], v[232:235], v[28:31]
    ds_read_b64_tr_b16 a[90:91], v3 offset:54464
    v_mfma_f32_16x16x32_bf16 v[28:31], a[120:123], v[240:243], v[28:31]
    ds_read_b64_tr_b16 a[92:93], v3 offset:54592
    v_mfma_f32_16x16x32_bf16 v[28:31], a[124:127], v[248:251], v[28:31]
    s_waitcnt lgkmcnt(11)
    ds_read_b64_tr_b16 a[94:95], v3 offset:54720
    v_mfma_f32_16x16x32_bf16 v[32:35], a[64:67], v[128:131], 0
    ds_read_b64_tr_b16 a[96:97], v3 offset:36960
    v_cvt_pk_bf16_f32 v48, v16, v17
    v_mfma_f32_16x16x32_bf16 v[32:35], a[68:71], v[136:139], v[32:35]
    s_waitcnt lgkmcnt(9)
    ds_read_b64_tr_b16 a[98:99], v3 offset:37088
    v_cvt_pk_bf16_f32 v49, v18, v19
    v_mfma_f32_16x16x32_bf16 v[32:35], a[72:75], v[144:147], v[32:35]
    ds_read_b64_tr_b16 a[100:101], v3 offset:37216
    v_cvt_pk_bf16_f32 v50, v24, v25
    v_mfma_f32_16x16x32_bf16 v[32:35], a[76:79], v[152:155], v[32:35]
    s_waitcnt lgkmcnt(7)
    ds_read_b64_tr_b16 a[102:103], v3 offset:37344
    v_cvt_pk_bf16_f32 v51, v26, v27
    v_mfma_f32_16x16x32_bf16 v[32:35], a[80:83], v[192:195], v[32:35]
    s_mov_b32 s54, 7168
    ds_read_b64_tr_b16 a[104:105], v3 offset:37472
    ds_read_b64_tr_b16 a[106:107], v3 offset:37600
    v_mfma_f32_16x16x32_bf16 v[32:35], a[84:87], v[200:203], v[32:35]
    s_waitcnt lgkmcnt(6)
    v_permlane32_swap_b32 v48, v50
    v_mfma_f32_16x16x32_bf16 v[32:35], a[88:91], v[208:211], v[32:35]
    v_permlane32_swap_b32 v49, v51
    v_mfma_f32_16x16x32_bf16 v[32:35], a[92:95], v[216:219], v[32:35]
    ds_read_b64_tr_b16 a[108:109], v3 offset:37728
    ds_read_b64_tr_b16 a[110:111], v3 offset:37856
    buffer_store_dwordx4 v[48:51], v10, s[40:43], s54 offen offset:0 sc1
    v_mfma_f32_16x16x32_bf16 v[36:39], a[64:67], v[160:163], 0
    ds_read_b64_tr_b16 a[112:113], v3 offset:53856
    v_cvt_pk_bf16_f32 v52, v20, v21
    v_mfma_f32_16x16x32_bf16 v[36:39], a[68:71], v[168:171], v[36:39]
    ds_read_b64_tr_b16 a[114:115], v3 offset:53984
    v_cvt_pk_bf16_f32 v53, v22, v23
    v_mfma_f32_16x16x32_bf16 v[36:39], a[72:75], v[176:179], v[36:39]
    ds_read_b64_tr_b16 a[116:117], v3 offset:54112
    v_cvt_pk_bf16_f32 v54, v28, v29
    v_mfma_f32_16x16x32_bf16 v[36:39], a[76:79], v[184:187], v[36:39]
    ds_read_b64_tr_b16 a[118:119], v3 offset:54240
    v_cvt_pk_bf16_f32 v55, v30, v31
    v_mfma_f32_16x16x32_bf16 v[36:39], a[80:83], v[224:227], v[36:39]
    s_mov_b32 s54, 302080
    ds_read_b64_tr_b16 a[120:121], v3 offset:54368
    ds_read_b64_tr_b16 a[122:123], v3 offset:54496
    v_mfma_f32_16x16x32_bf16 v[36:39], a[84:87], v[232:235], v[36:39]
    v_permlane32_swap_b32 v52, v54
    v_mfma_f32_16x16x32_bf16 v[36:39], a[88:91], v[240:243], v[36:39]
    v_permlane32_swap_b32 v53, v55
    v_mfma_f32_16x16x32_bf16 v[36:39], a[92:95], v[248:251], v[36:39]
    s_waitcnt vmcnt(7)
    s_barrier
    s_waitcnt lgkmcnt(10)
    ds_read_b64_tr_b16 a[124:125], v3 offset:54624
    ds_read_b64_tr_b16 a[126:127], v3 offset:54752
    buffer_store_dwordx4 v[52:55], v10, s[40:43], s54 offen offset:0 sc1
    v_mfma_f32_16x16x32_bf16 v[40:43], a[96:99], v[128:131], 0
    ds_read_b64_tr_b16 a[64:65], v4 offset:0
    v_mfma_f32_16x16x32_bf16 v[40:43], a[100:103], v[136:139], v[40:43]
    s_waitcnt lgkmcnt(9)
    ds_read_b64_tr_b16 a[66:67], v4 offset:128
    v_mfma_f32_16x16x32_bf16 v[40:43], a[104:107], v[144:147], v[40:43]
    ds_read_b64_tr_b16 a[68:69], v4 offset:256
    v_mfma_f32_16x16x32_bf16 v[40:43], a[108:111], v[152:155], v[40:43]
    s_waitcnt lgkmcnt(7)
    ds_read_b64_tr_b16 a[70:71], v4 offset:384
    v_mfma_f32_16x16x32_bf16 v[40:43], a[112:115], v[192:195], v[40:43]
    ds_read_b64_tr_b16 a[72:73], v4 offset:512
    v_mfma_f32_16x16x32_bf16 v[40:43], a[116:119], v[200:203], v[40:43]
    s_waitcnt lgkmcnt(5)
    ds_read_b64_tr_b16 a[74:75], v4 offset:640
    v_mfma_f32_16x16x32_bf16 v[40:43], a[120:123], v[208:211], v[40:43]
    ds_read_b64_tr_b16 a[76:77], v4 offset:768
    v_mfma_f32_16x16x32_bf16 v[40:43], a[124:127], v[216:219], v[40:43]
    ds_read_b64_tr_b16 a[78:79], v4 offset:896
    v_mfma_f32_16x16x32_bf16 v[44:47], a[96:99], v[160:163], 0
    ds_read_b64_tr_b16 a[80:81], v4 offset:16896
    v_mfma_f32_16x16x32_bf16 v[44:47], a[100:103], v[168:171], v[44:47]
    ds_read_b64_tr_b16 a[82:83], v4 offset:17024
    v_mfma_f32_16x16x32_bf16 v[44:47], a[104:107], v[176:179], v[44:47]
    ds_read_b64_tr_b16 a[84:85], v4 offset:17152
    v_mfma_f32_16x16x32_bf16 v[44:47], a[108:111], v[184:187], v[44:47]
    ds_read_b64_tr_b16 a[86:87], v4 offset:17280
    v_mfma_f32_16x16x32_bf16 v[44:47], a[112:115], v[224:227], v[44:47]
    ds_read_b64_tr_b16 a[88:89], v4 offset:17408
    v_mfma_f32_16x16x32_bf16 v[44:47], a[116:119], v[232:235], v[44:47]
    ds_read_b64_tr_b16 a[90:91], v4 offset:17536
    v_mfma_f32_16x16x32_bf16 v[44:47], a[120:123], v[240:243], v[44:47]
    ds_read_b64_tr_b16 a[92:93], v4 offset:17664
    v_mfma_f32_16x16x32_bf16 v[44:47], a[124:127], v[248:251], v[44:47]
    s_waitcnt lgkmcnt(11)
    ds_read_b64_tr_b16 a[94:95], v4 offset:17792
    v_mfma_f32_16x16x32_bf16 v[16:19], a[64:67], v[128:131], 0
    ds_read_b64_tr_b16 a[96:97], v4 offset:32
    v_cvt_pk_bf16_f32 v48, v32, v33
    v_mfma_f32_16x16x32_bf16 v[16:19], a[68:71], v[136:139], v[16:19]
    s_waitcnt lgkmcnt(9)
    ds_read_b64_tr_b16 a[98:99], v4 offset:160
    v_cvt_pk_bf16_f32 v49, v34, v35
    v_mfma_f32_16x16x32_bf16 v[16:19], a[72:75], v[144:147], v[16:19]
    ds_read_b64_tr_b16 a[100:101], v4 offset:288
    v_cvt_pk_bf16_f32 v50, v40, v41
    v_mfma_f32_16x16x32_bf16 v[16:19], a[76:79], v[152:155], v[16:19]
    s_waitcnt lgkmcnt(7)
    ds_read_b64_tr_b16 a[102:103], v4 offset:416
    v_cvt_pk_bf16_f32 v51, v42, v43
    v_mfma_f32_16x16x32_bf16 v[16:19], a[80:83], v[192:195], v[16:19]
    s_mov_b32 s54, 7168
    ds_read_b64_tr_b16 a[104:105], v4 offset:544
    ds_read_b64_tr_b16 a[106:107], v4 offset:672
    v_mfma_f32_16x16x32_bf16 v[16:19], a[84:87], v[200:203], v[16:19]
    s_waitcnt lgkmcnt(6)
    v_permlane32_swap_b32 v48, v50
    v_mfma_f32_16x16x32_bf16 v[16:19], a[88:91], v[208:211], v[16:19]
    v_permlane32_swap_b32 v49, v51
    v_mfma_f32_16x16x32_bf16 v[16:19], a[92:95], v[216:219], v[16:19]
    ds_read_b64_tr_b16 a[108:109], v4 offset:800
    ds_read_b64_tr_b16 a[110:111], v4 offset:928
    buffer_store_dwordx4 v[48:51], v10, s[40:43], s54 offen offset:512 sc1
    v_mfma_f32_16x16x32_bf16 v[20:23], a[64:67], v[160:163], 0
    ds_read_b64_tr_b16 a[112:113], v4 offset:16928
    v_cvt_pk_bf16_f32 v52, v36, v37
    v_mfma_f32_16x16x32_bf16 v[20:23], a[68:71], v[168:171], v[20:23]
    ds_read_b64_tr_b16 a[114:115], v4 offset:17056
    v_cvt_pk_bf16_f32 v53, v38, v39
    v_mfma_f32_16x16x32_bf16 v[20:23], a[72:75], v[176:179], v[20:23]
    ds_read_b64_tr_b16 a[116:117], v4 offset:17184
    v_cvt_pk_bf16_f32 v54, v44, v45
    v_mfma_f32_16x16x32_bf16 v[20:23], a[76:79], v[184:187], v[20:23]
    ds_read_b64_tr_b16 a[118:119], v4 offset:17312
    v_cvt_pk_bf16_f32 v55, v46, v47
    v_mfma_f32_16x16x32_bf16 v[20:23], a[80:83], v[224:227], v[20:23]
    s_mov_b32 s54, 302080
    ds_read_b64_tr_b16 a[120:121], v4 offset:17440
    ds_read_b64_tr_b16 a[122:123], v4 offset:17568
    v_mfma_f32_16x16x32_bf16 v[20:23], a[84:87], v[232:235], v[20:23]
    v_permlane32_swap_b32 v52, v54
    v_mfma_f32_16x16x32_bf16 v[20:23], a[88:91], v[240:243], v[20:23]
L2_pad13:
    s_cbranch_execz L2_walkret
    v_permlane32_swap_b32 v53, v55
    v_mfma_f32_16x16x32_bf16 v[20:23], a[92:95], v[248:251], v[20:23]
    s_waitcnt lgkmcnt(10)
    ds_read_b64_tr_b16 a[124:125], v4 offset:17696
    ds_read_b64_tr_b16 a[126:127], v4 offset:17824
    buffer_store_dwordx4 v[52:55], v10, s[40:43], s54 offen offset:512 sc1
    v_mfma_f32_16x16x32_bf16 v[24:27], a[96:99], v[128:131], 0
    ds_read_b64_tr_b16 a[64:65], v4 offset:64
    v_mfma_f32_16x16x32_bf16 v[24:27], a[100:103], v[136:139], v[24:27]
    s_waitcnt lgkmcnt(9)
    ds_read_b64_tr_b16 a[66:67], v4 offset:192
    v_mfma_f32_16x16x32_bf16 v[24:27], a[104:107], v[144:147], v[24:27]
    ds_read_b64_tr_b16 a[68:69], v4 offset:320
    v_mfma_f32_16x16x32_bf16 v[24:27], a[108:111], v[152:155], v[24:27]
    s_waitcnt lgkmcnt(7)
    ds_read_b64_tr_b16 a[70:71], v4 offset:448
    v_mfma_f32_16x16x32_bf16 v[24:27], a[112:115], v[192:195], v[24:27]
    ds_read_b64_tr_b16 a[72:73], v4 offset:576
    v_mfma_f32_16x16x32_bf16 v[24:27], a[116:119], v[200:203], v[24:27]
    s_waitcnt lgkmcnt(5)
    ds_read_b64_tr_b16 a[74:75], v4 offset:704
    v_mfma_f32_16x16x32_bf16 v[24:27], a[120:123], v[208:211], v[24:27]
    ds_read_b64_tr_b16 a[76:77], v4 offset:832
    v_mfma_f32_16x16x32_bf16 v[24:27], a[124:127], v[216:219], v[24:27]
    ds_read_b64_tr_b16 a[78:79], v4 offset:960
    v_mfma_f32_16x16x32_bf16 v[28:31], a[96:99], v[160:163], 0
    ds_read_b64_tr_b16 a[80:81], v4 offset:16960
    v_mfma_f32_16x16x32_bf16 v[28:31], a[100:103], v[168:171], v[28:31]
    ds_read_b64_tr_b16 a[82:83], v4 offset:17088
    v_mfma_f32_16x16x32_bf16 v[28:31], a[104:107], v[176:179], v[28:31]
    ds_read_b64_tr_b16 a[84:85], v4 offset:17216
    v_mfma_f32_16x16x32_bf16 v[28:31], a[108:111], v[184:187], v[28:31]
    ds_read_b64_tr_b16 a[86:87], v4 offset:17344
    v_mfma_f32_16x16x32_bf16 v[28:31], a[112:115], v[224:227], v[28:31]
    ds_read_b64_tr_b16 a[88:89], v4 offset:17472
    v_mfma_f32_16x16x32_bf16 v[28:31], a[116:119], v[232:235], v[28:31]
    ds_read_b64_tr_b16 a[90:91], v4 offset:17600
    v_mfma_f32_16x16x32_bf16 v[28:31], a[120:123], v[240:243], v[28:31]
    ds_read_b64_tr_b16 a[92:93], v4 offset:17728
    v_mfma_f32_16x16x32_bf16 v[28:31], a[124:127], v[248:251], v[28:31]
    s_waitcnt lgkmcnt(11)
    ds_read_b64_tr_b16 a[94:95], v4 offset:17856
    v_mfma_f32_16x16x32_bf16 v[32:35], a[64:67], v[128:131], 0
    ds_read_b64_tr_b16 a[96:97], v4 offset:96
    v_cvt_pk_bf16_f32 v48, v16, v17
    v_mfma_f32_16x16x32_bf16 v[32:35], a[68:71], v[136:139], v[32:35]
    s_waitcnt lgkmcnt(9)
    ds_read_b64_tr_b16 a[98:99], v4 offset:224
    v_cvt_pk_bf16_f32 v49, v18, v19
    v_mfma_f32_16x16x32_bf16 v[32:35], a[72:75], v[144:147], v[32:35]
    ds_read_b64_tr_b16 a[100:101], v4 offset:352
    v_cvt_pk_bf16_f32 v50, v24, v25
    v_mfma_f32_16x16x32_bf16 v[32:35], a[76:79], v[152:155], v[32:35]
    s_waitcnt lgkmcnt(7)
    ds_read_b64_tr_b16 a[102:103], v4 offset:480
    v_cvt_pk_bf16_f32 v51, v26, v27
    v_mfma_f32_16x16x32_bf16 v[32:35], a[80:83], v[192:195], v[32:35]
    s_mov_b32 s54, 8192
    ds_read_b64_tr_b16 a[104:105], v4 offset:608
    ds_read_b64_tr_b16 a[106:107], v4 offset:736
    v_mfma_f32_16x16x32_bf16 v[32:35], a[84:87], v[200:203], v[32:35]
    s_waitcnt lgkmcnt(6)
    v_permlane32_swap_b32 v48, v50
    v_mfma_f32_16x16x32_bf16 v[32:35], a[88:91], v[208:211], v[32:35]
    v_permlane32_swap_b32 v49, v51
    v_mfma_f32_16x16x32_bf16 v[32:35], a[92:95], v[216:219], v[32:35]
    ds_read_b64_tr_b16 a[108:109], v4 offset:864
    ds_read_b64_tr_b16 a[110:111], v4 offset:992
    buffer_store_dwordx4 v[48:51], v10, s[40:43], s54 offen offset:0 sc1
    v_mfma_f32_16x16x32_bf16 v[36:39], a[64:67], v[160:163], 0
    ds_read_b64_tr_b16 a[112:113], v4 offset:16992
    v_cvt_pk_bf16_f32 v52, v20, v21
    v_mfma_f32_16x16x32_bf16 v[36:39], a[68:71], v[168:171], v[36:39]
    ds_read_b64_tr_b16 a[114:115], v4 offset:17120
    v_cvt_pk_bf16_f32 v53, v22, v23
    v_mfma_f32_16x16x32_bf16 v[36:39], a[72:75], v[176:179], v[36:39]
    ds_read_b64_tr_b16 a[116:117], v4 offset:17248
    v_cvt_pk_bf16_f32 v54, v28, v29
    v_mfma_f32_16x16x32_bf16 v[36:39], a[76:79], v[184:187], v[36:39]
    ds_read_b64_tr_b16 a[118:119], v4 offset:17376
    v_cvt_pk_bf16_f32 v55, v30, v31
    v_mfma_f32_16x16x32_bf16 v[36:39], a[80:83], v[224:227], v[36:39]
    s_mov_b32 s54, 303104
    ds_read_b64_tr_b16 a[120:121], v4 offset:17504
    ds_read_b64_tr_b16 a[122:123], v4 offset:17632
    v_mfma_f32_16x16x32_bf16 v[36:39], a[84:87], v[232:235], v[36:39]
    v_permlane32_swap_b32 v52, v54
    v_mfma_f32_16x16x32_bf16 v[36:39], a[88:91], v[240:243], v[36:39]
    v_permlane32_swap_b32 v53, v55
    v_mfma_f32_16x16x32_bf16 v[36:39], a[92:95], v[248:251], v[36:39]
    s_waitcnt lgkmcnt(10)
    ds_read_b64_tr_b16 a[124:125], v4 offset:17760
    ds_read_b64_tr_b16 a[126:127], v4 offset:17888
    buffer_store_dwordx4 v[52:55], v10, s[40:43], s54 offen offset:0 sc1
    v_mfma_f32_16x16x32_bf16 v[40:43], a[96:99], v[128:131], 0
    v_mfma_f32_16x16x32_bf16 v[40:43], a[100:103], v[136:139], v[40:43]
    s_waitcnt lgkmcnt(8)
    v_mfma_f32_16x16x32_bf16 v[40:43], a[104:107], v[144:147], v[40:43]
    v_mfma_f32_16x16x32_bf16 v[40:43], a[108:111], v[152:155], v[40:43]
    s_waitcnt lgkmcnt(4)
    v_mfma_f32_16x16x32_bf16 v[40:43], a[112:115], v[192:195], v[40:43]
    v_mfma_f32_16x16x32_bf16 v[40:43], a[116:119], v[200:203], v[40:43]
    s_waitcnt lgkmcnt(0)
    v_mfma_f32_16x16x32_bf16 v[40:43], a[120:123], v[208:211], v[40:43]
    v_mfma_f32_16x16x32_bf16 v[40:43], a[124:127], v[216:219], v[40:43]
    v_mfma_f32_16x16x32_bf16 v[44:47], a[96:99], v[160:163], 0
    v_mfma_f32_16x16x32_bf16 v[44:47], a[100:103], v[168:171], v[44:47]
    v_mfma_f32_16x16x32_bf16 v[44:47], a[104:107], v[176:179], v[44:47]
    v_mfma_f32_16x16x32_bf16 v[44:47], a[108:111], v[184:187], v[44:47]
    v_mfma_f32_16x16x32_bf16 v[44:47], a[112:115], v[224:227], v[44:47]
    v_mfma_f32_16x16x32_bf16 v[44:47], a[116:119], v[232:235], v[44:47]
    v_mfma_f32_16x16x32_bf16 v[44:47], a[120:123], v[240:243], v[44:47]
    v_mfma_f32_16x16x32_bf16 v[44:47], a[124:127], v[248:251], v[44:47]
    s_nop 7
    v_cvt_pk_bf16_f32 v48, v32, v33
    v_cvt_pk_bf16_f32 v49, v34, v35
    v_cvt_pk_bf16_f32 v50, v40, v41
    v_cvt_pk_bf16_f32 v51, v42, v43
    s_nop 1
    v_permlane32_swap_b32 v48, v50
    v_permlane32_swap_b32 v49, v51
    s_mov_b32 s54, 8192
    buffer_store_dwordx4 v[48:51], v10, s[40:43], s54 offen offset:512 sc1
    v_cvt_pk_bf16_f32 v52, v36, v37
    v_cvt_pk_bf16_f32 v53, v38, v39
    v_cvt_pk_bf16_f32 v54, v44, v45
    v_cvt_pk_bf16_f32 v55, v46, v47
    s_nop 1
    v_permlane32_swap_b32 v52, v54
    v_permlane32_swap_b32 v53, v55
    s_mov_b32 s54, 303104
    buffer_store_dwordx4 v[52:55], v10, s[40:43], s54 offen offset:512 sc1
    buffer_load_dword v9, v6, s[84:87], s47 offen sc1
    s_movk_i32 s45, 4608
    buffer_load_dwordx4 v[76:79], v5, s[84:87], s45 offen sc1
    s_movk_i32 s45, 18432
    buffer_load_dwordx4 v[88:91], v5, s[84:87], s45 offen sc1
    s_movk_i32 s45, 8704
    buffer_load_dwordx4 v[80:83], v5, s[84:87], s45 offen sc1
    s_movk_i32 s45, 22528
    buffer_load_dwordx4 v[92:95], v5, s[84:87], s45 offen sc1
    s_movk_i32 s45, 12800
    buffer_load_dwordx4 v[84:87], v59, s[84:87], s45 offen sc1
    s_movk_i32 s45, 26624
    buffer_load_dwordx4 v[96:99], v59, s[84:87], s45 offen sc1
    buffer_load_dwordx4 v[224:227], v12, s[36:39], 0 offen offset:0
    buffer_load_dwordx4 v[232:235], v12, s[36:39], 0 offen offset:512
    buffer_load_dwordx4 v[240:243], v13, s[36:39], 0 offen offset:1024
    buffer_load_dwordx4 v[64:67], v1, s[76:79], 0 offen offset:0
    buffer_load_dwordx4 v[68:71], v1, s[76:79], 0 offen offset:512
    buffer_load_dwordx4 v[72:75], v2, s[76:79], 0 offen offset:0
    s_waitcnt vmcnt(13)
    buffer_store_dword v3, v15, s[84:87], s56 offen sc1
    s_movk_i32 s48, 0x1111
    v_lshrrev_b32 v15, 4, v0
    v_mul_u32_u24 v15, 9216, v15
    v_add_u32 v15, 4096, v15
    v_add_u32 v7, v59, v15
    s_waitcnt vmcnt(13)
    v_cmp_ne_u32 vcc, 0, v9
    s_nop 0
    s_lshr_b32 s3, vcc_lo, 1
    s_and_b32 s3, s3, vcc_lo
    s_lshr_b32 s14, s3, 2
    s_and_b32 s3, s3, s14
    s_and_b32 s3, s3, s48
    s_cbranch_scc0 L2_g0s
L2_g0r:
    s_ff1_i32_b32 s3, s3
    s_bitset0_b32 s48, s3
    s_mul_i32 s46, s3, 9216
    buffer_load_dwordx4 v[112:115], v7, s[88:91], s46 offen sc1
    buffer_load_dwordx4 v[116:119], v5, s[88:91], s46 offen sc1
    buffer_load_dwordx4 v[120:123], v5, s[28:31], s46 offen sc1
    s_add_u32 s46, s46, 9216
    buffer_load_dwordx4 v[124:127], v5, s[88:91], s46 offen sc1
    buffer_load_dwordx4 v[128:131], v5, s[28:31], s46 offen sc1
    s_add_u32 s46, s46, 9216
    buffer_load_dwordx4 v[132:135], v5, s[88:91], s46 offen sc1
    buffer_load_dwordx4 v[136:139], v5, s[28:31], s46 offen sc1
    s_add_u32 s46, s46, 9216
    buffer_load_dwordx4 v[140:143], v5, s[88:91], s46 offen sc1
    buffer_load_dwordx4 v[144:147], v5, s[28:31], s46 offen sc1
    v_cmp_ne_u32 vcc, 0, v9
    s_nop 0
    s_lshr_b32 s3, vcc_lo, 1
    s_and_b32 s3, s3, vcc_lo
    s_lshr_b32 s14, s3, 2
    s_and_b32 s3, s3, s14
    s_and_b32 s3, s3, s48
    s_cbranch_scc0 L2_g1s
L2_g1r:
    s_ff1_i32_b32 s3, s3
    s_bitset0_b32 s48, s3
    s_mul_i32 s46, s3, 9216
    buffer_load_dword v9, v6, s[84:87], s47 offen sc1
    buffer_load_dwordx4 v[148:151], v7, s[88:91], s46 offen sc1
    buffer_load_dwordx4 v[152:155], v5, s[88:91], s46 offen sc1
    buffer_load_dwordx4 v[156:159], v5, s[28:31], s46 offen sc1
    s_add_u32 s46, s46, 9216
    buffer_load_dwordx4 v[160:163], v5, s[88:91], s46 offen sc1
    buffer_load_dwordx4 v[164:167], v5, s[28:31], s46 offen sc1
    s_add_u32 s46, s46, 9216
    buffer_load_dwordx4 v[168:171], v5, s[88:91], s46 offen sc1
    buffer_load_dwordx4 v[172:175], v5, s[28:31], s46 offen sc1
    s_add_u32 s46, s46, 9216
    buffer_load_dwordx4 v[176:179], v5, s[88:91], s46 offen sc1
    buffer_load_dwordx4 v[180:183], v5, s[28:31], s46 offen sc1
    s_waitcnt vmcnt(20)
    v_mov_b32 v14, v13
    v_max_u32 v13, v76, v77
    v_max3_u32 v13, v13, v78, v79
    v_max3_u32 v13, v13, v88, v89
    v_max3_u32 v13, v13, v90, v91
    v_max3_u32 v13, v13, v80, v81
    v_max3_u32 v13, v13, v82, v83
    v_max3_u32 v13, v13, v92, v93
    v_max3_u32 v13, v13, v94, v95
    v_max3_u32 v13, v13, v84, v85
    v_max3_u32 v13, v13, v86, v87
    v_max3_u32 v13, v13, v96, v97
    v_max3_u32 v13, v13, v98, v99
    v_cmp_eq_u32 vcc, -1, v13
    s_nop 0
    s_cmp_lg_u64 vcc, 0
    s_cbranch_scc1 L2_pns
L2_pnr:
    v_pk_add_f32 v[76:77], v[76:77], v[88:89]
    v_pk_add_f32 v[78:79], v[78:79], v[90:91]
    ds_write_b128 v5, v[76:79] offset:0
    v_pk_add_f32 v[80:81], v[80:81], v[92:93]
    v_pk_add_f32 v[82:83], v[82:83], v[94:95]
    ds_write_b128 v5, v[80:83] offset:4096
    v_pk_add_f32 v[84:85], v[84:85], v[96:97]
    v_pk_add_f32 v[86:87], v[86:87], v[98:99]
    ds_write_b128 v59, v[84:87] offset:8192
    s_waitcnt lgkmcnt(0)
    s_barrier
    v_lshlrev_b32 v3, 1, v12
    v_lshlrev_b32 v4, 1, v14
    ds_read_b128 v[76:79], v3 offset:4608
    ds_read_b128 v[80:83], v3 offset:4624
    ds_read_b128 v[84:87], v3 offset:5632
    ds_read_b128 v[88:91], v3 offset:5648
    ds_read_b128 v[92:95], v4 offset:6656
    ds_read_b128 v[96:99], v4 offset:6672
    ds_read_b128 v[40:43], v3 offset:2304
    ds_read_b128 v[44:47], v3 offset:2320
    ds_read_b128 v[48:51], v3 offset:3328
    ds_read_b128 v[52:55], v3 offset:3344
    ds_read_b128 v[56:59], v4 offset:4352
    ds_read_b128 v[60:63], v4 offset:4368
    ds_write_b128 v106, a[20:23] offset:36864
    ds_write_b128 v106, a[24:27] offset:37888
    s_waitcnt lgkmcnt(2)
    v_lshlrev_b32 v12, 16, v224
    v_and_b32 v13, 0xffff0000, v224
    v_pk_mul_f32 v[76:77], v[76:77], v[12:13]
    v_pk_mul_f32 v[40:41], v[40:41], v[12:13]
    v_lshlrev_b32 v14, 16, v225
    v_and_b32 v15, 0xffff0000, v225
    v_pk_mul_f32 v[78:79], v[78:79], v[14:15]
    v_pk_mul_f32 v[42:43], v[42:43], v[14:15]
    v_lshlrev_b32 v12, 16, v226
    v_and_b32 v13, 0xffff0000, v226
    v_pk_mul_f32 v[80:81], v[80:81], v[12:13]
    v_pk_mul_f32 v[44:45], v[44:45], v[12:13]
    v_lshlrev_b32 v14, 16, v227
    v_and_b32 v15, 0xffff0000, v227
    v_pk_mul_f32 v[82:83], v[82:83], v[14:15]
    v_pk_mul_f32 v[46:47], v[46:47], v[14:15]
    v_lshlrev_b32 v12, 16, v232
    v_and_b32 v13, 0xffff0000, v232
    v_pk_mul_f32 v[84:85], v[84:85], v[12:13]
    v_pk_mul_f32 v[48:49], v[48:49], v[12:13]
    v_lshlrev_b32 v14, 16, v233
    v_and_b32 v15, 0xffff0000, v233
    v_pk_mul_f32 v[86:87], v[86:87], v[14:15]
    v_pk_mul_f32 v[50:51], v[50:51], v[14:15]
    ds_write_b128 v106, a[28:31] offset:38912
    ds_write_b128 v106, a[32:35] offset:39936
    v_lshlrev_b32 v12, 16, v234
    v_and_b32 v13, 0xffff0000, v234
    v_pk_mul_f32 v[88:89], v[88:89], v[12:13]
    v_pk_mul_f32 v[52:53], v[52:53], v[12:13]
    v_lshlrev_b32 v14, 16, v235
    v_and_b32 v15, 0xffff0000, v235
    v_pk_mul_f32 v[90:91], v[90:91], v[14:15]
    v_pk_mul_f32 v[54:55], v[54:55], v[14:15]
    v_lshlrev_b32 v12, 16, v240
    v_and_b32 v13, 0xffff0000, v240
    v_pk_mul_f32 v[92:93], v[92:93], v[12:13]
    v_pk_mul_f32 v[56:57], v[56:57], v[12:13]
    v_lshlrev_b32 v14, 16, v241
    v_and_b32 v15, 0xffff0000, v241
    v_pk_mul_f32 v[94:95], v[94:95], v[14:15]
    v_pk_mul_f32 v[58:59], v[58:59], v[14:15]
    v_lshlrev_b32 v12, 16, v242
    v_and_b32 v13, 0xffff0000, v242
    v_pk_mul_f32 v[96:97], v[96:97], v[12:13]
    v_pk_mul_f32 v[60:61], v[60:61], v[12:13]
    v_lshlrev_b32 v14, 16, v243
    v_and_b32 v15, 0xffff0000, v243
    v_pk_mul_f32 v[98:99], v[98:99], v[14:15]
    v_pk_mul_f32 v[62:63], v[62:63], v[14:15]
    ds_write_b128 v106, a[36:39] offset:40960
    ds_write_b128 v106, a[40:43] offset:41984
    v_pk_add_f32 v[12:13], v[76:77], v[78:79]
    v_pk_add_f32 v[12:13], v[12:13], v[80:81]
    v_pk_add_f32 v[12:13], v[12:13], v[82:83]
    v_pk_add_f32 v[12:13], v[12:13], v[84:85]
    v_pk_add_f32 v[12:13], v[12:13], v[86:87]
    v_pk_add_f32 v[12:13], v[12:13], v[88:89]
    v_pk_add_f32 v[12:13], v[12:13], v[90:91]
    v_pk_add_f32 v[14:15], v[92:93], v[94:95]
    v_pk_add_f32 v[14:15], v[14:15], v[96:97]
    v_pk_add_f32 v[14:15], v[14:15], v[98:99]
    v_add_f32 v100, v12, v13
    v_add_f32 v14, v14, v15
    v_fmac_f32 v100, 0x3e800000, v14
    v_pk_add_f32 v[12:13], v[40:41], v[42:43]
    v_pk_add_f32 v[12:13], v[12:13], v[44:45]
    v_pk_add_f32 v[12:13], v[12:13], v[46:47]
    v_pk_add_f32 v[12:13], v[12:13], v[48:49]
    v_pk_add_f32 v[12:13], v[12:13], v[50:51]
    v_pk_add_f32 v[12:13], v[12:13], v[52:53]
    v_pk_add_f32 v[12:13], v[12:13], v[54:55]
    v_pk_add_f32 v[14:15], v[56:57], v[58:59]
    v_pk_add_f32 v[14:15], v[14:15], v[60:61]
    v_pk_add_f32 v[14:15], v[14:15], v[62:63]
    v_add_f32 v101, v12, v13
    v_add_f32 v14, v14, v15
    v_fmac_f32 v101, 0x3e800000, v14
    ds_read_b128 v[40:43], v3 offset:0
    ds_read_b128 v[44:47], v3 offset:16
    ds_read_b128 v[48:51], v3 offset:1024
    ds_read_b128 v[52:55], v3 offset:1040
    ds_read_b128 v[56:59], v4 offset:2048
    ds_read_b128 v[60:63], v4 offset:2064
    ds_write_b128 v106, a[44:47] offset:43008
    ds_write_b128 v106, a[48:51] offset:44032
    s_nop 1
    v_add_f32_dpp v100, v100, v100 row_ror:8 row_mask:0xf bank_mask:0xf
    v_add_f32_dpp v101, v101, v101 row_ror:8 row_mask:0xf bank_mask:0xf
    v_mov_b32 v102, v100
    v_mov_b32 v103, v101
    s_nop 0
    v_permlane16_swap_b32 v102, v100
    v_permlane16_swap_b32 v103, v101
    v_add_f32 v100, v100, v102
    v_add_f32 v101, v101, v103
    v_mov_b32 v102, v100
    v_mov_b32 v103, v101
    s_nop 0
    v_permlane32_swap_b32 v102, v100
    v_permlane32_swap_b32 v103, v101
    v_add_f32 v100, v100, v102
    v_add_f32 v101, v101, v103
    v_and_b32 v14, 7, v0
    v_lshlrev_b32 v11, 4, v14
    v_add_u32 v11, 14080, v11
    s_lshl_b32 s3, s51, 2
    v_add_u32 v10, s3, v11
    ds_write_b32 v10, v100 offset:384
    ds_write_b32 v10, v101 offset:512
    v_lshl_add_u32 v1, v14, 4, v1
    v_lshl_add_u32 v2, v14, 4, v2
    v_add_u32 v1, 90112, v1
    v_add_u32 v2, 90112, v2
    s_and_b32 s14, s51, 1
    s_mul_i32 s14, s14, 9344
    s_add_u32 s14, s14, 90112
    v_add_u32 v107, s14, v8
    v_lshrrev_b32 v15, 3, v0
    v_mul_u32_u24 v12, 1024, v15
    v_add_u32 v109, v12, v8
    v_lshl_add_u32 v12, v15, 4, v12
    v_add_u32 v108, v12, v107
    s_mul_i32 s3, s96, 9216
    s_cmp_eq_u32 s51, 3
    s_cselect_b32 s3, 0, s3
    s_cselect_b64 s[24:25], s[32:33], s[80:81]
    s_add_u32 s24, s24, s3
    s_addc_u32 s25, s25, 0
    s_mov_b32 s26, 9216
    s_mov_b32 s27, 0x20000
    ds_write_b128 v106, a[52:55] offset:45056
    ds_write_b128 v105, a[128:131] offset:0
    s_waitcnt lgkmcnt(2)
    s_waitcnt vmcnt(18)
    ds_write_b128 v105, a[132:135] offset:1024
    ds_write_b128 v105, a[136:139] offset:2048
    v_lshlrev_b32 v32, 16, v112
    v_and_b32 v33, 0xffff0000, v112
    v_lshlrev_b32 v34, 16, v113
    v_and_b32 v35, 0xffff0000, v113
    v_lshlrev_b32 v36, 16, v114
    v_and_b32 v37, 0xffff0000, v114
    v_lshlrev_b32 v38, 16, v115
    v_and_b32 v39, 0xffff0000, v115
    s_waitcnt vmcnt(17)
    ds_write_b128 v105, a[140:143] offset:3072
    ds_write_b128 v105, a[144:147] offset:4096
    v_lshlrev_b32 v24, 16, v116
    v_and_b32 v25, 0xffff0000, v116
    v_lshlrev_b32 v26, 16, v117
    v_and_b32 v27, 0xffff0000, v117
    v_lshlrev_b32 v28, 16, v118
    v_and_b32 v29, 0xffff0000, v118
    v_lshlrev_b32 v30, 16, v119
    v_and_b32 v31, 0xffff0000, v119
    s_waitcnt vmcnt(16)
    v_lshlrev_b32 v16, 16, v120
    v_and_b32 v17, 0xffff0000, v120
    v_lshlrev_b32 v18, 16, v121
    v_and_b32 v19, 0xffff0000, v121
    v_lshlrev_b32 v20, 16, v122
    v_and_b32 v21, 0xffff0000, v122
    v_lshlrev_b32 v22, 16, v123
    v_and_b32 v23, 0xffff0000, v123
    s_waitcnt vmcnt(15)
    ds_write_b128 v105, a[148:151] offset:5120
    ds_write_b128 v105, a[152:155] offset:6144
    v_lshlrev_b32 v100, 16, v124
    v_and_b32 v101, 0xffff0000, v124
    v_pk_add_f32 v[24:25], v[24:25], v[100:101]
    v_lshlrev_b32 v102, 16, v125
    v_and_b32 v103, 0xffff0000, v125
    v_pk_add_f32 v[26:27], v[26:27], v[102:103]
    v_lshlrev_b32 v100, 16, v126
    v_and_b32 v101, 0xffff0000, v126
    v_pk_add_f32 v[28:29], v[28:29], v[100:101]
    v_lshlrev_b32 v102, 16, v127
    v_and_b32 v103, 0xffff0000, v127
    v_pk_add_f32 v[30:31], v[30:31], v[102:103]
    s_waitcnt vmcnt(14)
    v_lshlrev_b32 v100, 16, v128
    v_and_b32 v101, 0xffff0000, v128
    v_pk_add_f32 v[16:17], v[16:17], v[100:101]
    v_lshlrev_b32 v102, 16, v129
    v_and_b32 v103, 0xffff0000, v129
    v_pk_add_f32 v[18:19], v[18:19], v[102:103]
    v_lshlrev_b32 v100, 16, v130
    v_and_b32 v101, 0xffff0000, v130
    v_pk_add_f32 v[20:21], v[20:21], v[100:101]
    v_lshlrev_b32 v102, 16, v131
    v_and_b32 v103, 0xffff0000, v131
    v_pk_add_f32 v[22:23], v[22:23], v[102:103]
    s_waitcnt vmcnt(13)
    ds_write_b128 v105, a[156:159] offset:7168
    ds_write_b128 v105, a[160:163] offset:8192
    v_lshlrev_b32 v100, 16, v132
    v_and_b32 v101, 0xffff0000, v132
    v_pk_add_f32 v[24:25], v[24:25], v[100:101]
    v_lshlrev_b32 v102, 16, v133
    v_and_b32 v103, 0xffff0000, v133
    v_pk_add_f32 v[26:27], v[26:27], v[102:103]
    v_lshlrev_b32 v100, 16, v134
    v_and_b32 v101, 0xffff0000, v134
    v_pk_add_f32 v[28:29], v[28:29], v[100:101]
    v_lshlrev_b32 v102, 16, v135
    v_and_b32 v103, 0xffff0000, v135
    v_pk_add_f32 v[30:31], v[30:31], v[102:103]
    s_waitcnt vmcnt(12)
    v_lshlrev_b32 v100, 16, v136
    v_and_b32 v101, 0xffff0000, v136
    v_pk_add_f32 v[16:17], v[16:17], v[100:101]
    v_lshlrev_b32 v102, 16, v137
    v_and_b32 v103, 0xffff0000, v137
    v_pk_add_f32 v[18:19], v[18:19], v[102:103]
    v_lshlrev_b32 v100, 16, v138
    v_and_b32 v101, 0xffff0000, v138
    v_pk_add_f32 v[20:21], v[20:21], v[100:101]
    v_lshlrev_b32 v102, 16, v139
    v_and_b32 v103, 0xffff0000, v139
    v_pk_add_f32 v[22:23], v[22:23], v[102:103]
    s_waitcnt vmcnt(11)
    ds_write_b128 v104, a[164:167] offset:36864
    ds_write_b128 v104, a[168:171] offset:37888
    v_lshlrev_b32 v100, 16, v140
    v_and_b32 v101, 0xffff0000, v140
    v_pk_add_f32 v[24:25], v[24:25], v[100:101]
    v_lshlrev_b32 v102, 16, v141
    v_and_b32 v103, 0xffff0000, v141
    v_pk_add_f32 v[26:27], v[26:27], v[102:103]
    v_lshlrev_b32 v100, 16, v142
    v_and_b32 v101, 0xffff0000, v142
    v_pk_add_f32 v[28:29], v[28:29], v[100:101]
    v_lshlrev_b32 v102, 16, v143
    v_and_b32 v103, 0xffff0000, v143
    v_pk_add_f32 v[30:31], v[30:31], v[102:103]
    s_waitcnt vmcnt(10)
    v_lshlrev_b32 v100, 16, v144
    v_and_b32 v101, 0xffff0000, v144
    v_pk_add_f32 v[16:17], v[16:17], v[100:101]
    v_lshlrev_b32 v102, 16, v145
    v_and_b32 v103, 0xffff0000, v145
    v_pk_add_f32 v[18:19], v[18:19], v[102:103]
    v_lshlrev_b32 v100, 16, v146
    v_and_b32 v101, 0xffff0000, v146
    v_pk_add_f32 v[20:21], v[20:21], v[100:101]
    v_lshlrev_b32 v102, 16, v147
    v_and_b32 v103, 0xffff0000, v147
    v_pk_add_f32 v[22:23], v[22:23], v[102:103]
    s_waitcnt vmcnt(8)
    ds_write_b128 v104, a[172:175] offset:38912
    ds_write_b128 v104, a[176:179] offset:39936
    v_lshlrev_b32 v100, 16, v148
    v_and_b32 v101, 0xffff0000, v148
    v_pk_add_f32 v[32:33], v[32:33], v[100:101]
    v_lshlrev_b32 v102, 16, v149
    v_and_b32 v103, 0xffff0000, v149
    v_pk_add_f32 v[34:35], v[34:35], v[102:103]
    v_lshlrev_b32 v100, 16, v150
    v_and_b32 v101, 0xffff0000, v150
    v_pk_add_f32 v[36:37], v[36:37], v[100:101]
    v_lshlrev_b32 v102, 16, v151
    v_and_b32 v103, 0xffff0000, v151
    v_pk_add_f32 v[38:39], v[38:39], v[102:103]
    s_waitcnt vmcnt(7)
    ds_write_b128 v104, a[180:183] offset:40960
    ds_write_b128 v104, a[184:187] offset:41984
    v_lshlrev_b32 v100, 16, v152
    v_and_b32 v101, 0xffff0000, v152
    v_pk_add_f32 v[24:25], v[24:25], v[100:101]
    v_lshlrev_b32 v102, 16, v153
    v_and_b32 v103, 0xffff0000, v153
    v_pk_add_f32 v[26:27], v[26:27], v[102:103]
    v_lshlrev_b32 v100, 16, v154
    v_and_b32 v101, 0xffff0000, v154
    v_pk_add_f32 v[28:29], v[28:29], v[100:101]
    v_lshlrev_b32 v102, 16, v155
    v_and_b32 v103, 0xffff0000, v155
    v_pk_add_f32 v[30:31], v[30:31], v[102:103]
    s_waitcnt vmcnt(6)
    v_lshlrev_b32 v100, 16, v156
    v_and_b32 v101, 0xffff0000, v156
    v_pk_add_f32 v[16:17], v[16:17], v[100:101]
    v_lshlrev_b32 v102, 16, v157
    v_and_b32 v103, 0xffff0000, v157
    v_pk_add_f32 v[18:19], v[18:19], v[102:103]
    v_lshlrev_b32 v100, 16, v158
    v_and_b32 v101, 0xffff0000, v158
    v_pk_add_f32 v[20:21], v[20:21], v[100:101]
    v_lshlrev_b32 v102, 16, v159
    v_and_b32 v103, 0xffff0000, v159
    v_pk_add_f32 v[22:23], v[22:23], v[102:103]
    s_waitcnt vmcnt(5)
    v_cmp_ne_u32 vcc, 0, v9
    s_nop 0
    s_lshr_b32 s3, vcc_lo, 1
    s_and_b32 s3, s3, vcc_lo
    s_lshr_b32 s14, s3, 2
    s_and_b32 s3, s3, s14
    s_and_b32 s3, s3, s48
    s_cbranch_scc0 L2_g2s
L2_g2r:
    s_ff1_i32_b32 s3, s3
    s_bitset0_b32 s48, s3
    s_mul_i32 s46, s3, 9216
    buffer_load_dword v9, v6, s[84:87], s47 offen sc1
    buffer_load_dwordx4 v[184:187], v7, s[88:91], s46 offen sc1
    ds_write_b128 v104, a[188:191] offset:43008
    ds_write_b128 v104, a[192:195] offset:44032
    v_lshlrev_b32 v100, 16, v160
    v_and_b32 v101, 0xffff0000, v160
    v_pk_add_f32 v[24:25], v[24:25], v[100:101]
    v_lshlrev_b32 v102, 16, v161
    v_and_b32 v103, 0xffff0000, v161
    v_pk_add_f32 v[26:27], v[26:27], v[102:103]
    v_lshlrev_b32 v100, 16, v162
    v_and_b32 v101, 0xffff0000, v162
    v_pk_add_f32 v[28:29], v[28:29], v[100:101]
    v_lshlrev_b32 v102, 16, v163
    v_and_b32 v103, 0xffff0000, v163
    v_pk_add_f32 v[30:31], v[30:31], v[102:103]
    s_waitcnt vmcnt(6)
    v_lshlrev_b32 v100, 16, v164
    v_and_b32 v101, 0xffff0000, v164
    v_pk_add_f32 v[16:17], v[16:17], v[100:101]
    v_lshlrev_b32 v102, 16, v165
    v_and_b32 v103, 0xffff0000, v165
    v_pk_add_f32 v[18:19], v[18:19], v[102:103]
    v_lshlrev_b32 v100, 16, v166
    v_and_b32 v101, 0xffff0000, v166
    v_pk_add_f32 v[20:21], v[20:21], v[100:101]
    v_lshlrev_b32 v102, 16, v167
    v_and_b32 v103, 0xffff0000, v167
    v_pk_add_f32 v[22:23], v[22:23], v[102:103]
    s_waitcnt vmcnt(5)
    buffer_load_dwordx4 v[188:191], v5, s[88:91], s46 offen sc1
    buffer_load_dwordx4 v[192:195], v5, s[28:31], s46 offen sc1
    ds_write_b128 v104, a[196:199] offset:45056
    v_lshlrev_b32 v100, 16, v168
    v_and_b32 v101, 0xffff0000, v168
    v_pk_add_f32 v[24:25], v[24:25], v[100:101]
    v_lshlrev_b32 v102, 16, v169
    v_and_b32 v103, 0xffff0000, v169
    v_pk_add_f32 v[26:27], v[26:27], v[102:103]
    v_lshlrev_b32 v100, 16, v170
    v_and_b32 v101, 0xffff0000, v170
    v_pk_add_f32 v[28:29], v[28:29], v[100:101]
    v_lshlrev_b32 v102, 16, v171
    v_and_b32 v103, 0xffff0000, v171
    v_pk_add_f32 v[30:31], v[30:31], v[102:103]
    s_waitcnt vmcnt(6)
    v_lshlrev_b32 v100, 16, v172
    v_and_b32 v101, 0xffff0000, v172
    v_pk_add_f32 v[16:17], v[16:17], v[100:101]
    v_lshlrev_b32 v102, 16, v173
    v_and_b32 v103, 0xffff0000, v173
    v_pk_add_f32 v[18:19], v[18:19], v[102:103]
    v_lshlrev_b32 v100, 16, v174
    v_and_b32 v101, 0xffff0000, v174
    v_pk_add_f32 v[20:21], v[20:21], v[100:101]
    v_lshlrev_b32 v102, 16, v175
    v_and_b32 v103, 0xffff0000, v175
    v_pk_add_f32 v[22:23], v[22:23], v[102:103]
    s_waitcnt vmcnt(5)
    s_add_u32 s46, s46, 9216
    buffer_load_dwordx4 v[196:199], v5, s[88:91], s46 offen sc1
    buffer_load_dwordx4 v[200:203], v5, s[28:31], s46 offen sc1
    v_lshlrev_b32 v100, 16, v176
    v_and_b32 v101, 0xffff0000, v176
    v_pk_add_f32 v[24:25], v[24:25], v[100:101]
L2_pad14:
    s_cbranch_execz L2_walkret
    v_lshlrev_b32 v102, 16, v177
    v_and_b32 v103, 0xffff0000, v177
    v_pk_add_f32 v[26:27], v[26:27], v[102:103]
    v_lshlrev_b32 v100, 16, v178
    v_and_b32 v101, 0xffff0000, v178
    v_pk_add_f32 v[28:29], v[28:29], v[100:101]
    v_lshlrev_b32 v102, 16, v179
    v_and_b32 v103, 0xffff0000, v179
    v_pk_add_f32 v[30:31], v[30:31], v[102:103]
    s_waitcnt vmcnt(6)
    v_lshlrev_b32 v100, 16, v180
    v_and_b32 v101, 0xffff0000, v180
    v_pk_add_f32 v[16:17], v[16:17], v[100:101]
    v_lshlrev_b32 v102, 16, v181
    v_and_b32 v103, 0xffff0000, v181
    v_pk_add_f32 v[18:19], v[18:19], v[102:103]
    v_lshlrev_b32 v100, 16, v182
    v_and_b32 v101, 0xffff0000, v182
    v_pk_add_f32 v[20:21], v[20:21], v[100:101]
    v_lshlrev_b32 v102, 16, v183
    v_and_b32 v103, 0xffff0000, v183
    v_pk_add_f32 v[22:23], v[22:23], v[102:103]
    s_waitcnt vmcnt(4)
    s_add_u32 s46, s46, 9216
    buffer_load_dwordx4 v[204:207], v5, s[88:91], s46 offen sc1
    buffer_load_dwordx4 v[208:211], v5, s[28:31], s46 offen sc1
    v_lshlrev_b32 v100, 16, v184
    v_and_b32 v101, 0xffff0000, v184
    v_pk_add_f32 v[32:33], v[32:33], v[100:101]
    v_lshlrev_b32 v102, 16, v185
    v_and_b32 v103, 0xffff0000, v185
    v_pk_add_f32 v[34:35], v[34:35], v[102:103]
    v_lshlrev_b32 v100, 16, v186
    v_and_b32 v101, 0xffff0000, v186
    v_pk_add_f32 v[36:37], v[36:37], v[100:101]
    v_lshlrev_b32 v102, 16, v187
    v_and_b32 v103, 0xffff0000, v187
    v_pk_add_f32 v[38:39], v[38:39], v[102:103]
    ds_read_b128 v[112:115], v3 offset:4608
    ds_read_b128 v[116:119], v3 offset:4624
    ds_read_b128 v[120:123], v3 offset:5632
    ds_read_b128 v[124:127], v3 offset:5648
    ds_read_b128 v[128:131], v4 offset:6656
    ds_read_b128 v[132:135], v4 offset:6672
    ds_read_b128 v[136:139], v3 offset:2304
    ds_read_b128 v[140:143], v3 offset:2320
    ds_read_b128 v[144:147], v3 offset:3328
    ds_read_b128 v[148:151], v3 offset:3344
    ds_read_b128 v[152:155], v4 offset:4352
    ds_read_b128 v[156:159], v4 offset:4368
    ds_read_b128 v[160:163], v3 offset:6912
    ds_read_b128 v[164:167], v3 offset:6928
    ds_read_b128 v[168:171], v3 offset:7936
    ds_read_b128 v[172:175], v3 offset:7952
    ds_read_b128 v[176:179], v4 offset:8960
    ds_read_b128 v[180:183], v4 offset:8976
    s_waitcnt vmcnt(5)
    s_add_u32 s46, s46, 9216
    buffer_load_dwordx4 v[212:215], v5, s[88:91], s46 offen sc1
    buffer_load_dwordx4 v[216:219], v5, s[28:31], s46 offen sc1
    v_lshlrev_b32 v100, 16, v188
    v_and_b32 v101, 0xffff0000, v188
    v_pk_add_f32 v[24:25], v[24:25], v[100:101]
    v_lshlrev_b32 v102, 16, v189
    v_and_b32 v103, 0xffff0000, v189
    v_pk_add_f32 v[26:27], v[26:27], v[102:103]
    v_lshlrev_b32 v100, 16, v190
    v_and_b32 v101, 0xffff0000, v190
    v_pk_add_f32 v[28:29], v[28:29], v[100:101]
    v_lshlrev_b32 v102, 16, v191
    v_and_b32 v103, 0xffff0000, v191
    v_pk_add_f32 v[30:31], v[30:31], v[102:103]
    s_waitcnt vmcnt(6)
    v_lshlrev_b32 v100, 16, v192
    v_and_b32 v101, 0xffff0000, v192
    v_pk_add_f32 v[16:17], v[16:17], v[100:101]
    v_lshlrev_b32 v102, 16, v193
    v_and_b32 v103, 0xffff0000, v193
    v_pk_add_f32 v[18:19], v[18:19], v[102:103]
    v_lshlrev_b32 v100, 16, v194
    v_and_b32 v101, 0xffff0000, v194
    v_pk_add_f32 v[20:21], v[20:21], v[100:101]
    v_lshlrev_b32 v102, 16, v195
    v_and_b32 v103, 0xffff0000, v195
    v_pk_add_f32 v[22:23], v[22:23], v[102:103]
    s_waitcnt vmcnt(5)
    v_cmp_ne_u32 vcc, 0, v9
    s_nop 0
    s_lshr_b32 s3, vcc_lo, 1
    s_and_b32 s3, s3, vcc_lo
    s_lshr_b32 s14, s3, 2
    s_and_b32 s3, s3, s14
    s_and_b32 s3, s3, s48
    s_cbranch_scc0 L2_g3s
L2_g3r:
    s_ff1_i32_b32 s3, s3
    s_bitset0_b32 s48, s3
    s_mul_i32 s46, s3, 9216
    buffer_load_dwordx4 v[220:223], v7, s[88:91], s46 offen sc1
    v_lshlrev_b32 v100, 16, v196
    v_and_b32 v101, 0xffff0000, v196
    v_pk_add_f32 v[24:25], v[24:25], v[100:101]
    v_lshlrev_b32 v102, 16, v197
    v_and_b32 v103, 0xffff0000, v197
    v_pk_add_f32 v[26:27], v[26:27], v[102:103]
    v_lshlrev_b32 v100, 16, v198
    v_and_b32 v101, 0xffff0000, v198
    v_pk_add_f32 v[28:29], v[28:29], v[100:101]
    v_lshlrev_b32 v102, 16, v199
    v_and_b32 v103, 0xffff0000, v199
    v_pk_add_f32 v[30:31], v[30:31], v[102:103]
    s_waitcnt vmcnt(5)
    v_lshlrev_b32 v100, 16, v200
    v_and_b32 v101, 0xffff0000, v200
    v_pk_add_f32 v[16:17], v[16:17], v[100:101]
    v_lshlrev_b32 v102, 16, v201
    v_and_b32 v103, 0xffff0000, v201
    v_pk_add_f32 v[18:19], v[18:19], v[102:103]
    v_lshlrev_b32 v100, 16, v202
    v_and_b32 v101, 0xffff0000, v202
    v_pk_add_f32 v[20:21], v[20:21], v[100:101]
    v_lshlrev_b32 v102, 16, v203
    v_and_b32 v103, 0xffff0000, v203
    v_pk_add_f32 v[22:23], v[22:23], v[102:103]
    s_waitcnt vmcnt(4)
    buffer_load_dwordx4 v[224:227], v5, s[88:91], s46 offen sc1
    buffer_load_dwordx4 v[228:231], v5, s[28:31], s46 offen sc1
    v_lshlrev_b32 v100, 16, v204
    v_and_b32 v101, 0xffff0000, v204
    v_pk_add_f32 v[24:25], v[24:25], v[100:101]
    v_lshlrev_b32 v102, 16, v205
    v_and_b32 v103, 0xffff0000, v205
    v_pk_add_f32 v[26:27], v[26:27], v[102:103]
    v_lshlrev_b32 v100, 16, v206
    v_and_b32 v101, 0xffff0000, v206
    v_pk_add_f32 v[28:29], v[28:29], v[100:101]
    v_lshlrev_b32 v102, 16, v207
    v_and_b32 v103, 0xffff0000, v207
    v_pk_add_f32 v[30:31], v[30:31], v[102:103]
    s_waitcnt vmcnt(5)
    v_lshlrev_b32 v100, 16, v208
    v_and_b32 v101, 0xffff0000, v208
    v_pk_add_f32 v[16:17], v[16:17], v[100:101]
    v_lshlrev_b32 v102, 16, v209
    v_and_b32 v103, 0xffff0000, v209
    v_pk_add_f32 v[18:19], v[18:19], v[102:103]
    v_lshlrev_b32 v100, 16, v210
    v_and_b32 v101, 0xffff0000, v210
    v_pk_add_f32 v[20:21], v[20:21], v[100:101]
    v_lshlrev_b32 v102, 16, v211
    v_and_b32 v103, 0xffff0000, v211
    v_pk_add_f32 v[22:23], v[22:23], v[102:103]
    s_waitcnt vmcnt(4)
    s_add_u32 s46, s46, 9216
    buffer_load_dwordx4 v[232:235], v5, s[88:91], s46 offen sc1
    buffer_load_dwordx4 v[236:239], v5, s[28:31], s46 offen sc1
    v_lshlrev_b32 v100, 16, v212
    v_and_b32 v101, 0xffff0000, v212
    v_pk_add_f32 v[24:25], v[24:25], v[100:101]
    v_lshlrev_b32 v102, 16, v213
    v_and_b32 v103, 0xffff0000, v213
    v_pk_add_f32 v[26:27], v[26:27], v[102:103]
    v_lshlrev_b32 v100, 16, v214
    v_and_b32 v101, 0xffff0000, v214
    v_pk_add_f32 v[28:29], v[28:29], v[100:101]
    v_lshlrev_b32 v102, 16, v215
    v_and_b32 v103, 0xffff0000, v215
    v_pk_add_f32 v[30:31], v[30:31], v[102:103]
    s_waitcnt vmcnt(5)
    v_lshlrev_b32 v100, 16, v216
    v_and_b32 v101, 0xffff0000, v216
    v_pk_add_f32 v[16:17], v[16:17], v[100:101]
    v_lshlrev_b32 v102, 16, v217
    v_and_b32 v103, 0xffff0000, v217
    v_pk_add_f32 v[18:19], v[18:19], v[102:103]
    v_lshlrev_b32 v100, 16, v218
    v_and_b32 v101, 0xffff0000, v218
    v_pk_add_f32 v[20:21], v[20:21], v[100:101]
    v_lshlrev_b32 v102, 16, v219
    v_and_b32 v103, 0xffff0000, v219
    v_pk_add_f32 v[22:23], v[22:23], v[102:103]
    s_waitcnt vmcnt(4)
    s_add_u32 s46, s46, 9216
    buffer_load_dwordx4 v[240:243], v5, s[88:91], s46 offen sc1
    buffer_load_dwordx4 v[244:247], v5, s[28:31], s46 offen sc1
    v_lshlrev_b32 v100, 16, v220
    v_and_b32 v101, 0xffff0000, v220
    v_pk_add_f32 v[32:33], v[32:33], v[100:101]
    v_lshlrev_b32 v102, 16, v221
    v_and_b32 v103, 0xffff0000, v221
    v_pk_add_f32 v[34:35], v[34:35], v[102:103]
    v_lshlrev_b32 v100, 16, v222
    v_and_b32 v101, 0xffff0000, v222
    v_pk_add_f32 v[36:37], v[36:37], v[100:101]
    v_lshlrev_b32 v102, 16, v223
    v_and_b32 v103, 0xffff0000, v223
    v_pk_add_f32 v[38:39], v[38:39], v[102:103]
    s_lshl_b32 s3, s96, 3
    s_sub_u32 s3, 0xfff, s3
    v_and_b32 v6, 7, v0
    v_sub_u32 v6, s3, v6
    s_mov_b32 s57, 0xfffff000
    s_mul_i32 s58, s96, 128
    s_add_u32 s58, s58, 6815744
    s_xor_b32 s3, s51, 2
    v_or_b32 v9, s3, v0
    v_min_u32 v9, 1, v9
    v_lshlrev_b32 v9, 30, v9
    v_mov_b32 v208, v32
    v_mov_b32 v209, v33
    v_mov_b32 v210, v34
    v_mov_b32 v211, v35
    v_mov_b32 v212, v36
    v_mov_b32 v213, v37
    v_mov_b32 v214, v38
    v_mov_b32 v215, v39
    v_permlane16_swap_b32 v208, v32
    v_permlane16_swap_b32 v209, v33
    v_permlane16_swap_b32 v210, v34
    v_permlane16_swap_b32 v211, v35
    v_permlane16_swap_b32 v212, v36
    v_permlane16_swap_b32 v213, v37
    v_permlane16_swap_b32 v214, v38
    v_permlane16_swap_b32 v215, v39
    v_add_f32 v32, v32, v208
    v_add_f32 v33, v33, v209
    v_add_f32 v34, v34, v210
    v_add_f32 v35, v35, v211
    v_add_f32 v36, v36, v212
    v_add_f32 v37, v37, v213
    v_add_f32 v38, v38, v214
    v_add_f32 v39, v39, v215
    v_mov_b32 v208, v32
    v_mov_b32 v209, v33
    v_mov_b32 v210, v34
    v_mov_b32 v211, v35
    v_mov_b32 v212, v36
    v_mov_b32 v213, v37
    v_mov_b32 v214, v38
    v_mov_b32 v215, v39
    v_permlane32_swap_b32 v208, v32
    v_permlane32_swap_b32 v209, v33
    v_permlane32_swap_b32 v210, v34
    v_permlane32_swap_b32 v211, v35
    v_permlane32_swap_b32 v212, v36
    v_permlane32_swap_b32 v213, v37
    v_permlane32_swap_b32 v214, v38
    v_permlane32_swap_b32 v215, v39
    v_add_f32 v32, v32, v208
    v_add_f32 v33, v33, v209
    v_add_f32 v34, v34, v210
    v_add_f32 v35, v35, v211
    v_add_f32 v36, v36, v212
    v_add_f32 v37, v37, v213
    v_add_f32 v38, v38, v214
    v_add_f32 v39, v39, v215
    v_lshlrev_b32 v184, 16, v64
    v_and_b32 v185, 0xffff0000, v64
    v_lshlrev_b32 v186, 16, v65
    v_and_b32 v187, 0xffff0000, v65
    v_lshlrev_b32 v188, 16, v66
    v_and_b32 v189, 0xffff0000, v66
    v_lshlrev_b32 v190, 16, v67
    v_and_b32 v191, 0xffff0000, v67
    v_lshlrev_b32 v192, 16, v68
    v_and_b32 v193, 0xffff0000, v68
    v_lshlrev_b32 v194, 16, v69
    v_and_b32 v195, 0xffff0000, v69
    v_lshlrev_b32 v196, 16, v70
    v_and_b32 v197, 0xffff0000, v70
    v_lshlrev_b32 v198, 16, v71
    v_and_b32 v199, 0xffff0000, v71
    v_lshlrev_b32 v200, 16, v72
    v_and_b32 v201, 0xffff0000, v72
    v_lshlrev_b32 v202, 16, v73
    v_and_b32 v203, 0xffff0000, v73
    v_lshlrev_b32 v204, 16, v74
    v_and_b32 v205, 0xffff0000, v74
    v_lshlrev_b32 v206, 16, v75
    v_and_b32 v207, 0xffff0000, v75
    s_cmp_lt_u32 s2, 180
    s_cselect_b32 s3, 2, 0
    s_cmp_lt_u32 s51, s3
    s_cselect_b32 s3, 0, 0x40000000
    v_mul_u32_u24 v68, 128, v0
    v_or_b32 v68, s3, v68
    s_mul_i32 s15, s51, 16384
    s_add_u32 s15, s15, 6815744
    s_add_u32 s59, s15, 8192
    s_lshl_b32 s3, s51, 7
    s_sub_u32 s3, s96, s3
    v_cmp_eq_u32 s[60:61], s3, v0
    s_sub_u32 s3, s3, 64
    v_cmp_eq_u32 s[62:63], s3, v0
    s_waitcnt vmcnt(5)
    s_add_u32 s46, s46, 9216
    buffer_load_dwordx4 v[248:251], v5, s[88:91], s46 offen sc1
    buffer_load_dwordx4 v[252:255], v5, s[28:31], s46 offen sc1
    v_lshlrev_b32 v100, 16, v224
    v_and_b32 v101, 0xffff0000, v224
    v_pk_add_f32 v[24:25], v[24:25], v[100:101]
    v_lshlrev_b32 v102, 16, v225
    v_and_b32 v103, 0xffff0000, v225
    v_pk_add_f32 v[26:27], v[26:27], v[102:103]
    v_lshlrev_b32 v100, 16, v226
    v_and_b32 v101, 0xffff0000, v226
    v_pk_add_f32 v[28:29], v[28:29], v[100:101]
    v_lshlrev_b32 v102, 16, v227
    v_and_b32 v103, 0xffff0000, v227
    v_pk_add_f32 v[30:31], v[30:31], v[102:103]
    s_waitcnt vmcnt(6)
    v_lshlrev_b32 v100, 16, v228
    v_and_b32 v101, 0xffff0000, v228
    v_pk_add_f32 v[16:17], v[16:17], v[100:101]
    v_lshlrev_b32 v102, 16, v229
    v_and_b32 v103, 0xffff0000, v229
    v_pk_add_f32 v[18:19], v[18:19], v[102:103]
    v_lshlrev_b32 v100, 16, v230
    v_and_b32 v101, 0xffff0000, v230
    v_pk_add_f32 v[20:21], v[20:21], v[100:101]
    v_lshlrev_b32 v102, 16, v231
    v_and_b32 v103, 0xffff0000, v231
    v_pk_add_f32 v[22:23], v[22:23], v[102:103]
    s_waitcnt vmcnt(5)
    v_lshlrev_b32 v100, 16, v232
    v_and_b32 v101, 0xffff0000, v232
    v_pk_add_f32 v[24:25], v[24:25], v[100:101]
    v_lshlrev_b32 v102, 16, v233
    v_and_b32 v103, 0xffff0000, v233
    v_pk_add_f32 v[26:27], v[26:27], v[102:103]
    v_lshlrev_b32 v100, 16, v234
    v_and_b32 v101, 0xffff0000, v234
    v_pk_add_f32 v[28:29], v[28:29], v[100:101]
    v_lshlrev_b32 v102, 16, v235
    v_and_b32 v103, 0xffff0000, v235
    v_pk_add_f32 v[30:31], v[30:31], v[102:103]
    s_waitcnt vmcnt(4)
    v_lshlrev_b32 v100, 16, v236
    v_and_b32 v101, 0xffff0000, v236
    v_pk_add_f32 v[16:17], v[16:17], v[100:101]
    v_lshlrev_b32 v102, 16, v237
    v_and_b32 v103, 0xffff0000, v237
    v_pk_add_f32 v[18:19], v[18:19], v[102:103]
    v_lshlrev_b32 v100, 16, v238
    v_and_b32 v101, 0xffff0000, v238
    v_pk_add_f32 v[20:21], v[20:21], v[100:101]
    v_lshlrev_b32 v102, 16, v239
    v_and_b32 v103, 0xffff0000, v239
    v_pk_add_f32 v[22:23], v[22:23], v[102:103]
    s_waitcnt vmcnt(3)
    v_lshlrev_b32 v100, 16, v240
    v_and_b32 v101, 0xffff0000, v240
    v_pk_add_f32 v[24:25], v[24:25], v[100:101]
    v_lshlrev_b32 v102, 16, v241
    v_and_b32 v103, 0xffff0000, v241
    v_pk_add_f32 v[26:27], v[26:27], v[102:103]
    v_lshlrev_b32 v100, 16, v242
    v_and_b32 v101, 0xffff0000, v242
    v_pk_add_f32 v[28:29], v[28:29], v[100:101]
    v_lshlrev_b32 v102, 16, v243
    v_and_b32 v103, 0xffff0000, v243
    v_pk_add_f32 v[30:31], v[30:31], v[102:103]
    s_waitcnt vmcnt(2)
    v_lshlrev_b32 v100, 16, v244
    v_and_b32 v101, 0xffff0000, v244
    v_pk_add_f32 v[16:17], v[16:17], v[100:101]
    v_lshlrev_b32 v102, 16, v245
    v_and_b32 v103, 0xffff0000, v245
    v_pk_add_f32 v[18:19], v[18:19], v[102:103]
    v_lshlrev_b32 v100, 16, v246
    v_and_b32 v101, 0xffff0000, v246
    v_pk_add_f32 v[20:21], v[20:21], v[100:101]
    v_lshlrev_b32 v102, 16, v247
    v_and_b32 v103, 0xffff0000, v247
    v_pk_add_f32 v[22:23], v[22:23], v[102:103]
    s_waitcnt vmcnt(1)
    v_lshlrev_b32 v100, 16, v248
    v_and_b32 v101, 0xffff0000, v248
    v_pk_add_f32 v[24:25], v[24:25], v[100:101]
    v_lshlrev_b32 v102, 16, v249
    v_and_b32 v103, 0xffff0000, v249
    v_pk_add_f32 v[26:27], v[26:27], v[102:103]
    v_lshlrev_b32 v100, 16, v250
    v_and_b32 v101, 0xffff0000, v250
    v_pk_add_f32 v[28:29], v[28:29], v[100:101]
    v_lshlrev_b32 v102, 16, v251
    v_and_b32 v103, 0xffff0000, v251
    v_pk_add_f32 v[30:31], v[30:31], v[102:103]
    s_waitcnt vmcnt(0)
    v_lshlrev_b32 v100, 16, v252
    v_and_b32 v101, 0xffff0000, v252
    v_pk_add_f32 v[16:17], v[16:17], v[100:101]
    v_lshlrev_b32 v102, 16, v253
    v_and_b32 v103, 0xffff0000, v253
    v_pk_add_f32 v[18:19], v[18:19], v[102:103]
    v_lshlrev_b32 v100, 16, v254
    v_and_b32 v101, 0xffff0000, v254
    v_pk_add_f32 v[20:21], v[20:21], v[100:101]
    v_lshlrev_b32 v102, 16, v255
    v_and_b32 v103, 0xffff0000, v255
    v_pk_add_f32 v[22:23], v[22:23], v[102:103]
    v_pk_fma_f32 v[16:17], v[16:17], v[40:41], v[184:185]
    v_pk_fma_f32 v[18:19], v[18:19], v[42:43], v[186:187]
    v_pk_fma_f32 v[20:21], v[20:21], v[44:45], v[188:189]
    v_pk_fma_f32 v[22:23], v[22:23], v[46:47], v[190:191]
    v_pk_fma_f32 v[24:25], v[24:25], v[48:49], v[192:193]
    v_pk_fma_f32 v[26:27], v[26:27], v[50:51], v[194:195]
    v_pk_fma_f32 v[28:29], v[28:29], v[52:53], v[196:197]
    v_pk_fma_f32 v[30:31], v[30:31], v[54:55], v[198:199]
    v_pk_fma_f32 v[32:33], v[32:33], v[56:57], v[200:201]
    v_pk_fma_f32 v[34:35], v[34:35], v[58:59], v[202:203]
    v_pk_fma_f32 v[36:37], v[36:37], v[60:61], v[204:205]
    v_pk_fma_f32 v[38:39], v[38:39], v[62:63], v[206:207]
    v_pk_add_f32 v[12:13], v[16:17], v[18:19]
    v_pk_add_f32 v[12:13], v[12:13], v[20:21]
    v_pk_add_f32 v[12:13], v[12:13], v[22:23]
    v_pk_add_f32 v[12:13], v[12:13], v[24:25]
    v_pk_add_f32 v[12:13], v[12:13], v[26:27]
    v_pk_add_f32 v[12:13], v[12:13], v[28:29]
    v_pk_add_f32 v[12:13], v[12:13], v[30:31]
    v_pk_add_f32 v[14:15], v[32:33], v[34:35]
    v_pk_add_f32 v[14:15], v[14:15], v[36:37]
    v_pk_add_f32 v[14:15], v[14:15], v[38:39]
    v_add_f32 v100, v12, v13
    v_add_f32 v14, v14, v15
    v_fmac_f32 v100, 0x3e800000, v14
    s_nop 1
    v_add_f32_dpp v100, v100, v100 row_ror:8 row_mask:0xf bank_mask:0xf
    v_mov_b32 v103, v100
    s_nop 1
    v_permlane16_swap_b32 v103, v100
    v_add_f32 v100, v100, v103
    v_mov_b32 v103, v100
    s_nop 1
    v_permlane32_swap_b32 v103, v100
    v_add_f32 v100, v100, v103
    v_mul_f32 v100, 0x3be38e39, v100
    v_pk_add_f32 v[184:185], v[16:17], v[100:101] op_sel_hi:[1,0] neg_lo:[0,1] neg_hi:[0,1]
    v_pk_add_f32 v[186:187], v[18:19], v[100:101] op_sel_hi:[1,0] neg_lo:[0,1] neg_hi:[0,1]
    v_pk_add_f32 v[188:189], v[20:21], v[100:101] op_sel_hi:[1,0] neg_lo:[0,1] neg_hi:[0,1]
    v_pk_add_f32 v[190:191], v[22:23], v[100:101] op_sel_hi:[1,0] neg_lo:[0,1] neg_hi:[0,1]
    v_pk_add_f32 v[192:193], v[24:25], v[100:101] op_sel_hi:[1,0] neg_lo:[0,1] neg_hi:[0,1]
    v_pk_add_f32 v[194:195], v[26:27], v[100:101] op_sel_hi:[1,0] neg_lo:[0,1] neg_hi:[0,1]
    v_pk_add_f32 v[196:197], v[28:29], v[100:101] op_sel_hi:[1,0] neg_lo:[0,1] neg_hi:[0,1]
    v_pk_add_f32 v[198:199], v[30:31], v[100:101] op_sel_hi:[1,0] neg_lo:[0,1] neg_hi:[0,1]
    v_pk_add_f32 v[200:201], v[32:33], v[100:101] op_sel_hi:[1,0] neg_lo:[0,1] neg_hi:[0,1]
    v_pk_add_f32 v[202:203], v[34:35], v[100:101] op_sel_hi:[1,0] neg_lo:[0,1] neg_hi:[0,1]
    v_pk_add_f32 v[204:205], v[36:37], v[100:101] op_sel_hi:[1,0] neg_lo:[0,1] neg_hi:[0,1]
    v_pk_add_f32 v[206:207], v[38:39], v[100:101] op_sel_hi:[1,0] neg_lo:[0,1] neg_hi:[0,1]
    v_pk_mul_f32 v[12:13], v[184:185], v[184:185]
    v_pk_fma_f32 v[12:13], v[186:187], v[186:187], v[12:13]
    v_pk_fma_f32 v[12:13], v[188:189], v[188:189], v[12:13]
    v_pk_fma_f32 v[12:13], v[190:191], v[190:191], v[12:13]
    v_pk_fma_f32 v[12:13], v[192:193], v[192:193], v[12:13]
    v_pk_fma_f32 v[12:13], v[194:195], v[194:195], v[12:13]
    v_pk_fma_f32 v[12:13], v[196:197], v[196:197], v[12:13]
    v_pk_fma_f32 v[12:13], v[198:199], v[198:199], v[12:13]
    v_pk_mul_f32 v[14:15], v[200:201], v[200:201]
    v_pk_fma_f32 v[14:15], v[202:203], v[202:203], v[14:15]
    v_pk_fma_f32 v[14:15], v[204:205], v[204:205], v[14:15]
    v_pk_fma_f32 v[14:15], v[206:207], v[206:207], v[14:15]
    v_add_f32 v101, v12, v13
    v_add_f32 v14, v14, v15
    v_fmac_f32 v101, 0x3e800000, v14
    v_pk_mul_f32 v[12:13], v[184:185], v[76:77]
    v_pk_fma_f32 v[12:13], v[186:187], v[78:79], v[12:13]
    v_pk_fma_f32 v[12:13], v[188:189], v[80:81], v[12:13]
    v_pk_fma_f32 v[12:13], v[190:191], v[82:83], v[12:13]
    v_pk_fma_f32 v[12:13], v[192:193], v[84:85], v[12:13]
    v_pk_fma_f32 v[12:13], v[194:195], v[86:87], v[12:13]
    v_pk_fma_f32 v[12:13], v[196:197], v[88:89], v[12:13]
    v_pk_fma_f32 v[12:13], v[198:199], v[90:91], v[12:13]
    v_pk_mul_f32 v[14:15], v[200:201], v[92:93]
    v_pk_fma_f32 v[14:15], v[202:203], v[94:95], v[14:15]
    v_pk_fma_f32 v[14:15], v[204:205], v[96:97], v[14:15]
    v_pk_fma_f32 v[14:15], v[206:207], v[98:99], v[14:15]
    v_add_f32 v102, v12, v13
    v_add_f32 v14, v14, v15
    v_fmac_f32 v102, 0x3e800000, v14
    s_nop 1
    v_add_f32_dpp v101, v101, v101 row_ror:8 row_mask:0xf bank_mask:0xf
    v_add_f32_dpp v102, v102, v102 row_ror:8 row_mask:0xf bank_mask:0xf
    v_mov_b32 v103, v101
    v_mov_b32 v104, v102
    s_nop 0
    v_permlane16_swap_b32 v103, v101
    v_permlane16_swap_b32 v104, v102
    v_add_f32 v101, v101, v103
    v_add_f32 v102, v102, v104
    v_mov_b32 v103, v101
    v_mov_b32 v104, v102
    s_nop 0
    v_permlane32_swap_b32 v103, v101
    v_permlane32_swap_b32 v104, v102
    v_add_f32 v101, v101, v103
    v_add_f32 v102, v102, v104
    ds_write_b32 v10, v100 offset:0
    ds_write_b32 v10, v101 offset:128
    ds_write_b32 v10, v102 offset:256
    s_waitcnt lgkmcnt(0)
    s_barrier
    ds_read_b128 v[40:43], v11 offset:0
    ds_read_b128 v[44:47], v11 offset:128
    ds_read_b128 v[48:51], v11 offset:256
    ds_read_b128 v[52:55], v11 offset:384
    ds_read_b128 v[56:59], v11 offset:512
    s_waitcnt lgkmcnt(4)
    v_add_f32 v12, v40, v41
    v_add_f32 v13, v42, v43
    v_add_f32 v12, v12, v13
    v_mul_f32 v12, 0x3e800000, v12
    v_sub_f32 v40, v40, v12
    v_sub_f32 v41, v41, v12
    v_sub_f32 v42, v42, v12
    v_sub_f32 v43, v43, v12
    v_sub_f32 v100, v100, v12
    v_mul_f32 v13, v40, v40
    v_fmac_f32 v13, v41, v41
    v_fmac_f32 v13, v42, v42
    v_fmac_f32 v13, v43, v43
    s_waitcnt lgkmcnt(3)
    v_add_f32 v14, v44, v45
    v_add_f32 v15, v46, v47
    v_add_f32 v14, v14, v15
    v_fmac_f32 v14, 0x43100000, v13
    v_mov_b32 v13, 0x3727c5ac
    v_fmac_f32 v13, 0x3ae38e39, v14
    v_rsq_f32 v13, v13
    s_waitcnt lgkmcnt(0)
    v_pk_fma_f32 v[48:49], v[40:41], v[52:53], v[48:49]
    v_pk_fma_f32 v[50:51], v[42:43], v[54:55], v[50:51]
    v_pk_add_f32 v[48:49], v[48:49], v[50:51]
    v_pk_add_f32 v[56:57], v[56:57], v[58:59]
    v_add_f32 v14, v48, v49
    v_add_f32 v15, v56, v57
    v_fmac_f32 v15, v14, v13
    v_ashrrev_i32 v12, 31, v15
    v_or_b32 v12, 0x80000000, v12
    v_xor_b32 v12, v12, v15
    v_and_or_b32 v44, v12, s57, v6
    v_mov_b32 v45, 0
    s_nop 1
    v_mov_b32_dpp v14, v44 row_ror:1 row_mask:0xf bank_mask:0xf
    v_mov_b32_dpp v15, v45 row_ror:1 row_mask:0xf bank_mask:0xf
    v_max_u32 v45, v45, v15
    v_med3_u32 v45, v44, v14, v45
    v_max_u32 v44, v44, v14
    s_nop 1
    v_mov_b32_dpp v14, v44 row_ror:2 row_mask:0xf bank_mask:0xf
    v_mov_b32_dpp v15, v45 row_ror:2 row_mask:0xf bank_mask:0xf
    v_max_u32 v45, v45, v15
    v_med3_u32 v45, v44, v14, v45
    v_max_u32 v44, v44, v14
    s_nop 1
    v_mov_b32_dpp v14, v44 row_ror:4 row_mask:0xf bank_mask:0xf
    v_mov_b32_dpp v15, v45 row_ror:4 row_mask:0xf bank_mask:0xf
    v_max_u32 v45, v45, v15
    v_med3_u32 v45, v44, v14, v45
    v_max_u32 v44, v44, v14
    buffer_store_dwordx2 v[44:45], v9, s[84:87], s58 offen offset:8 sc1
    v_mul_f32 v100, v100, v13
    v_pk_fma_f32 v[184:185], v[184:185], v[12:13], v[100:101] op_sel:[0,1,0] op_sel_hi:[1,1,0]
    v_pk_fma_f32 v[186:187], v[186:187], v[12:13], v[100:101] op_sel:[0,1,0] op_sel_hi:[1,1,0]
    v_pk_fma_f32 v[188:189], v[188:189], v[12:13], v[100:101] op_sel:[0,1,0] op_sel_hi:[1,1,0]
    v_pk_fma_f32 v[190:191], v[190:191], v[12:13], v[100:101] op_sel:[0,1,0] op_sel_hi:[1,1,0]
    v_pk_fma_f32 v[192:193], v[192:193], v[12:13], v[100:101] op_sel:[0,1,0] op_sel_hi:[1,1,0]
    v_pk_fma_f32 v[194:195], v[194:195], v[12:13], v[100:101] op_sel:[0,1,0] op_sel_hi:[1,1,0]
    v_pk_fma_f32 v[196:197], v[196:197], v[12:13], v[100:101] op_sel:[0,1,0] op_sel_hi:[1,1,0]
    v_pk_fma_f32 v[198:199], v[198:199], v[12:13], v[100:101] op_sel:[0,1,0] op_sel_hi:[1,1,0]
    v_pk_fma_f32 v[200:201], v[200:201], v[12:13], v[100:101] op_sel:[0,1,0] op_sel_hi:[1,1,0]
    v_pk_fma_f32 v[202:203], v[202:203], v[12:13], v[100:101] op_sel:[0,1,0] op_sel_hi:[1,1,0]
    v_pk_fma_f32 v[204:205], v[204:205], v[12:13], v[100:101] op_sel:[0,1,0] op_sel_hi:[1,1,0]
    v_pk_fma_f32 v[206:207], v[206:207], v[12:13], v[100:101] op_sel:[0,1,0] op_sel_hi:[1,1,0]
    v_pk_fma_f32 v[184:185], v[184:185], v[112:113], v[136:137]
    v_pk_fma_f32 v[186:187], v[186:187], v[114:115], v[138:139]
    v_pk_fma_f32 v[188:189], v[188:189], v[116:117], v[140:141]
    v_pk_fma_f32 v[190:191], v[190:191], v[118:119], v[142:143]
    v_pk_fma_f32 v[192:193], v[192:193], v[120:121], v[144:145]
    v_pk_fma_f32 v[194:195], v[194:195], v[122:123], v[146:147]
    v_pk_fma_f32 v[196:197], v[196:197], v[124:125], v[148:149]
    v_pk_fma_f32 v[198:199], v[198:199], v[126:127], v[150:151]
    v_pk_fma_f32 v[200:201], v[200:201], v[128:129], v[152:153]
    v_pk_fma_f32 v[202:203], v[202:203], v[130:131], v[154:155]
    v_pk_fma_f32 v[204:205], v[204:205], v[132:133], v[156:157]
    v_pk_fma_f32 v[206:207], v[206:207], v[134:135], v[158:159]
    v_cvt_pk_bf16_f32 v124, v184, v185
    v_cvt_pk_bf16_f32 v125, v186, v187
    v_cvt_pk_bf16_f32 v126, v188, v189
    v_cvt_pk_bf16_f32 v127, v190, v191
    v_min_u32 v124, -2, v124
    v_min_u32 v125, -2, v125
    v_min_u32 v126, -2, v126
    v_min_u32 v127, -2, v127
    ds_write_b128 v1, v[124:127] offset:9344
    v_cvt_pk_bf16_f32 v128, v192, v193
    v_cvt_pk_bf16_f32 v129, v194, v195
    v_cvt_pk_bf16_f32 v130, v196, v197
    v_cvt_pk_bf16_f32 v131, v198, v199
    v_min_u32 v128, -2, v128
    v_min_u32 v129, -2, v129
    v_min_u32 v130, -2, v130
    v_min_u32 v131, -2, v131
    ds_write_b128 v1, v[128:131] offset:9856
    v_cvt_pk_bf16_f32 v132, v200, v201
    v_cvt_pk_bf16_f32 v133, v202, v203
    v_cvt_pk_bf16_f32 v134, v204, v205
    v_cvt_pk_bf16_f32 v135, v206, v207
    v_min_u32 v132, -2, v132
    v_min_u32 v133, -2, v133
    v_min_u32 v134, -2, v134
    v_min_u32 v135, -2, v135
    ds_write_b128 v2, v[132:135] offset:9344
    v_pk_fma_f32 v[16:17], v[184:185], v[160:161], v[16:17]
    v_pk_fma_f32 v[18:19], v[186:187], v[162:163], v[18:19]
    v_pk_fma_f32 v[20:21], v[188:189], v[164:165], v[20:21]
    v_pk_fma_f32 v[22:23], v[190:191], v[166:167], v[22:23]
    v_pk_fma_f32 v[24:25], v[192:193], v[168:169], v[24:25]
    v_pk_fma_f32 v[26:27], v[194:195], v[170:171], v[26:27]
    v_pk_fma_f32 v[28:29], v[196:197], v[172:173], v[28:29]
    v_pk_fma_f32 v[30:31], v[198:199], v[174:175], v[30:31]
    v_pk_fma_f32 v[32:33], v[200:201], v[176:177], v[32:33]
    v_pk_fma_f32 v[34:35], v[202:203], v[178:179], v[34:35]
    v_pk_fma_f32 v[36:37], v[204:205], v[180:181], v[36:37]
    v_pk_fma_f32 v[38:39], v[206:207], v[182:183], v[38:39]
    v_cvt_pk_bf16_f32 v112, v16, v17
    v_cvt_pk_bf16_f32 v113, v18, v19
    v_cvt_pk_bf16_f32 v114, v20, v21
    v_cvt_pk_bf16_f32 v115, v22, v23
    ds_write_b128 v1, v[112:115] offset:0
    v_cvt_pk_bf16_f32 v116, v24, v25
    v_cvt_pk_bf16_f32 v117, v26, v27
    v_cvt_pk_bf16_f32 v118, v28, v29
    v_cvt_pk_bf16_f32 v119, v30, v31
    ds_write_b128 v1, v[116:119] offset:512
    v_cvt_pk_bf16_f32 v120, v32, v33
    v_cvt_pk_bf16_f32 v121, v34, v35
    v_cvt_pk_bf16_f32 v122, v36, v37
    v_cvt_pk_bf16_f32 v123, v38, v39
    ds_write_b128 v2, v[120:123] offset:0
    v_lshrrev_b32 v7, 4, v0
    v_and_b32 v6, 1, v0
    v_bfe_u32 v5, v0, 2, 2
    v_lshlrev_b32 v5, 6, v5
    v_lshl_add_u32 v5, v7, 4, v5
L2_pad15:
    s_cbranch_execz L2_walkret
    v_mov_b32 v14, 15616
    s_movk_i32 s57, 1168
    s_waitcnt lgkmcnt(0)
    s_barrier
    s_cmp_lt_u32 s51, 2
    s_cbranch_scc1 L2_keys
    s_cmp_eq_u32 s51, 2
    s_cbranch_scc1 L2_rows
    v_not_b32 v12, v44
    v_not_b32 v13, v45
    v_and_b32 v12, 7, v12
    v_and_b32 v13, 7, v13
    v_cmp_gt_u32 vcc, 8, v0
    v_mul_u32_u24 v148, 1168, v12
    v_mul_u32_u24 v149, 1168, v13
    v_cndmask_b32 v15, v13, v12, vcc
    v_add_u32 v148, v148, v107
    v_add_u32 v149, v149, v107
    ds_read_b128 v[136:139], v148
    ds_read_b128 v[140:143], v149
    v_lshrrev_b32 v150, 3, v0
    v_sub_u32 v15, v15, v150
    v_mad_i32_i24 v150, v15, s57, v108
    ds_read_b128 v[144:147], v150 offset:1024
    s_movk_i32 s3, 1152
    v_mad_u32_u24 v12, v12, s3, v8
    v_mad_u32_u24 v13, v13, s3, v8
    v_mad_i32_i24 v15, v15, s3, v109
    s_waitcnt lgkmcnt(2)
    buffer_store_dwordx4 v[136:139], v12, s[24:27], 0 offen sc1
    s_waitcnt lgkmcnt(1)
    buffer_store_dwordx4 v[140:143], v13, s[24:27], 0 offen sc1
    s_mov_b64 exec, 0xffff
    s_waitcnt lgkmcnt(0)
    buffer_store_dwordx4 v[144:147], v15, s[24:27], 0 offen offset:1024 sc1
    s_mov_b64 exec, -1
    s_branch L2_rowsdone
L2_rows:
    ds_read_b128 v[136:139], v107 offset:0
    ds_read_b128 v[140:143], v107 offset:1168
    ds_read_b128 v[144:147], v107 offset:2336
    ds_read_b128 v[148:151], v107 offset:3504
    ds_read_b128 v[152:155], v107 offset:4672
    ds_read_b128 v[156:159], v107 offset:5840
    ds_read_b128 v[160:163], v107 offset:7008
    ds_read_b128 v[164:167], v107 offset:8176
    ds_read_b128 v[168:171], v108 offset:1024
    s_movk_i32 s3, 0
    s_waitcnt lgkmcnt(8)
    buffer_store_dwordx4 v[136:139], v8, s[24:27], s3 offen offset:0 sc1
    s_waitcnt lgkmcnt(7)
    buffer_store_dwordx4 v[140:143], v8, s[24:27], s3 offen offset:1152 sc1
    s_waitcnt lgkmcnt(6)
    buffer_store_dwordx4 v[144:147], v8, s[24:27], s3 offen offset:2304 sc1
    s_waitcnt lgkmcnt(5)
    buffer_store_dwordx4 v[148:151], v8, s[24:27], s3 offen offset:3456 sc1
    s_movk_i32 s3, 4608
    s_waitcnt lgkmcnt(4)
    buffer_store_dwordx4 v[152:155], v8, s[24:27], s3 offen offset:0 sc1
    s_waitcnt lgkmcnt(3)
    buffer_store_dwordx4 v[156:159], v8, s[24:27], s3 offen offset:1152 sc1
    s_waitcnt lgkmcnt(2)
    buffer_store_dwordx4 v[160:163], v8, s[24:27], s3 offen offset:2304 sc1
    s_waitcnt lgkmcnt(1)
    buffer_store_dwordx4 v[164:167], v8, s[24:27], s3 offen offset:3456 sc1
    s_waitcnt lgkmcnt(0)
    buffer_store_dwordx4 v[168:171], v109, s[24:27], 0 offen offset:1024 sc1
L2_rowsdone:
    ds_read_b64_tr_b16 a[64:65], v110 offset:0
    ds_read_b64_tr_b16 a[66:67], v110 offset:256
    ds_read_b64_tr_b16 a[68:69], v110 offset:2048
    ds_read_b64_tr_b16 a[70:71], v110 offset:2304
    ds_read_b64_tr_b16 a[72:73], v110 offset:4096
    ds_read_b64_tr_b16 a[74:75], v110 offset:4352
    ds_read_b64_tr_b16 a[76:77], v110 offset:6144
    ds_read_b64_tr_b16 a[78:79], v110 offset:6400
    ds_read_b64_tr_b16 a[80:81], v110 offset:8192
    ds_read_b64_tr_b16 a[82:83], v110 offset:8448
    ds_read_b64_tr_b16 a[84:85], v110 offset:10240
    ds_read_b64_tr_b16 a[86:87], v110 offset:10496
    ds_read_b64_tr_b16 a[88:89], v110 offset:12288
    ds_read_b64_tr_b16 a[90:91], v110 offset:12544
    ds_read_b64_tr_b16 a[92:93], v110 offset:14336
    ds_read_b64_tr_b16 a[94:95], v110 offset:14592
    ds_read_b64_tr_b16 a[96:97], v110 offset:16384
    ds_read_b64_tr_b16 a[98:99], v110 offset:16640
    ds_read_b64_tr_b16 a[100:101], v110 offset:18432
    ds_read_b64_tr_b16 a[102:103], v110 offset:18688
    ds_read_b64_tr_b16 a[104:105], v110 offset:20480
    ds_read_b64_tr_b16 a[106:107], v110 offset:20736
    ds_read_b64_tr_b16 a[108:109], v110 offset:22528
    ds_read_b64_tr_b16 a[110:111], v110 offset:22784
    ds_read_b64_tr_b16 a[112:113], v110 offset:24576
    ds_read_b64_tr_b16 a[114:115], v110 offset:24832
    ds_read_b64_tr_b16 a[116:117], v110 offset:26624
    ds_read_b64_tr_b16 a[118:119], v110 offset:26880
    ds_read_b64_tr_b16 a[120:121], v110 offset:28672
    ds_read_b64_tr_b16 a[122:123], v110 offset:28928
    ds_read_b64_tr_b16 a[124:125], v110 offset:30720
    ds_read_b64_tr_b16 a[126:127], v110 offset:30976
    ds_read_b64_tr_b16 a[128:129], v110 offset:32768
    ds_read_b64_tr_b16 a[130:131], v110 offset:33024
    ds_read_b64_tr_b16 a[132:133], v110 offset:34816
    ds_read_b64_tr_b16 a[134:135], v110 offset:35072
    ds_read_b64_tr_b16 a[136:137], v111 offset:0
    ds_read_b64_tr_b16 a[138:139], v111 offset:4608
    ds_read_b64_tr_b16 a[140:141], v111 offset:32
    ds_read_b64_tr_b16 a[142:143], v111 offset:4640
    ds_read_b64_tr_b16 a[144:145], v111 offset:64
    ds_read_b64_tr_b16 a[146:147], v111 offset:4672
    ds_read_b64_tr_b16 a[148:149], v111 offset:96
    ds_read_b64_tr_b16 a[150:151], v111 offset:4704
    ds_read_b64_tr_b16 a[152:153], v111 offset:128
    ds_read_b64_tr_b16 a[154:155], v111 offset:4736
    ds_read_b64_tr_b16 a[156:157], v111 offset:160
    ds_read_b64_tr_b16 a[158:159], v111 offset:4768
    ds_read_b64_tr_b16 a[160:161], v111 offset:192
    ds_read_b64_tr_b16 a[162:163], v111 offset:4800
    ds_read_b64_tr_b16 a[164:165], v111 offset:224
    ds_read_b64_tr_b16 a[166:167], v111 offset:4832
    ds_read_b64_tr_b16 a[168:169], v111 offset:256
    ds_read_b64_tr_b16 a[170:171], v111 offset:4864
    s_cmp_lt_u32 s2, 144
    s_cbranch_scc1 L2_join
    s_waitcnt vmcnt(0)
    buffer_store_dword v14, v9, s[84:87], s56 offen offset:128 sc1
    s_cmp_lt_u32 s2, 180
    s_cbranch_scc1 L2_join
    s_branch L2_fin
L2_keys:
    s_cmp_ge_u32 s2, 180
    s_cbranch_scc1 L2_fin
    buffer_load_dwordx2 v[64:65], v68, s[84:87], s15 offen offset:8 sc1
    buffer_load_dwordx2 v[66:67], v68, s[84:87], s59 offen offset:8 sc1
    ds_read_b64_tr_b16 a[64:65], v110 offset:0
    ds_read_b64_tr_b16 a[66:67], v110 offset:256
    ds_read_b64_tr_b16 a[68:69], v110 offset:2048
    ds_read_b64_tr_b16 a[70:71], v110 offset:2304
    ds_read_b64_tr_b16 a[72:73], v110 offset:4096
    ds_read_b64_tr_b16 a[74:75], v110 offset:4352
    ds_read_b64_tr_b16 a[76:77], v110 offset:6144
    ds_read_b64_tr_b16 a[78:79], v110 offset:6400
    ds_read_b64_tr_b16 a[80:81], v110 offset:8192
    ds_read_b64_tr_b16 a[82:83], v110 offset:8448
    ds_read_b64_tr_b16 a[84:85], v110 offset:10240
    ds_read_b64_tr_b16 a[86:87], v110 offset:10496
    ds_read_b64_tr_b16 a[88:89], v110 offset:12288
    ds_read_b64_tr_b16 a[90:91], v110 offset:12544
    ds_read_b64_tr_b16 a[92:93], v110 offset:14336
    ds_read_b64_tr_b16 a[94:95], v110 offset:14592
    ds_read_b64_tr_b16 a[96:97], v110 offset:16384
    ds_read_b64_tr_b16 a[98:99], v110 offset:16640
    ds_read_b64_tr_b16 a[100:101], v110 offset:18432
    ds_read_b64_tr_b16 a[102:103], v110 offset:18688
    ds_read_b64_tr_b16 a[104:105], v110 offset:20480
    ds_read_b64_tr_b16 a[106:107], v110 offset:20736
    ds_read_b64_tr_b16 a[108:109], v110 offset:22528
    ds_read_b64_tr_b16 a[110:111], v110 offset:22784
    ds_read_b64_tr_b16 a[112:113], v110 offset:24576
    ds_read_b64_tr_b16 a[114:115], v110 offset:24832
    ds_read_b64_tr_b16 a[116:117], v110 offset:26624
    ds_read_b64_tr_b16 a[118:119], v110 offset:26880
    ds_read_b64_tr_b16 a[120:121], v110 offset:28672
    ds_read_b64_tr_b16 a[122:123], v110 offset:28928
    ds_read_b64_tr_b16 a[124:125], v110 offset:30720
    ds_read_b64_tr_b16 a[126:127], v110 offset:30976
    ds_read_b64_tr_b16 a[128:129], v110 offset:32768
    ds_read_b64_tr_b16 a[130:131], v110 offset:33024
    ds_read_b64_tr_b16 a[132:133], v110 offset:34816
    ds_read_b64_tr_b16 a[134:135], v110 offset:35072
    ds_read_b64_tr_b16 a[136:137], v111 offset:0
    ds_read_b64_tr_b16 a[138:139], v111 offset:4608
    ds_read_b64_tr_b16 a[140:141], v111 offset:32
    ds_read_b64_tr_b16 a[142:143], v111 offset:4640
    ds_read_b64_tr_b16 a[144:145], v111 offset:64
    ds_read_b64_tr_b16 a[146:147], v111 offset:4672
    ds_read_b64_tr_b16 a[148:149], v111 offset:96
    ds_read_b64_tr_b16 a[150:151], v111 offset:4704
    ds_read_b64_tr_b16 a[152:153], v111 offset:128
    ds_read_b64_tr_b16 a[154:155], v111 offset:4736
    ds_read_b64_tr_b16 a[156:157], v111 offset:160
    ds_read_b64_tr_b16 a[158:159], v111 offset:4768
    ds_read_b64_tr_b16 a[160:161], v111 offset:192
    ds_read_b64_tr_b16 a[162:163], v111 offset:4800
    ds_read_b64_tr_b16 a[164:165], v111 offset:224
    ds_read_b64_tr_b16 a[166:167], v111 offset:4832
    ds_read_b64_tr_b16 a[168:169], v111 offset:256
    ds_read_b64_tr_b16 a[170:171], v111 offset:4864
    s_waitcnt vmcnt(0)
    v_cndmask_b32 v64, v64, v44, s[60:61]
    v_cndmask_b32 v65, v65, v45, s[60:61]
    v_cndmask_b32 v66, v66, v44, s[62:63]
    v_cndmask_b32 v67, v67, v45, s[62:63]
    v_min_u32 v12, v64, v65
    v_min_u32 v13, v66, v67
    v_cmp_eq_u32 s[4:5], 0, v12
    v_cmp_eq_u32 s[6:7], 0, v13
    s_nop 0
    s_or_b64 vcc, s[4:5], s[6:7]
    s_cbranch_scc0 L2_p2_ok
    s_mov_b32 s97, 0x20000
L2_p2:
    s_or_b64 exec, s[4:5], 1
    buffer_load_dwordx2 v[64:65], v68, s[84:87], s15 offen offset:8 sc1
    s_or_b64 exec, s[6:7], 1
    buffer_load_dwordx2 v[66:67], v68, s[84:87], s59 offen offset:8 sc1
    s_mov_b64 exec, -1
    s_waitcnt vmcnt(0)
    v_cndmask_b32 v64, v64, v44, s[60:61]
    v_cndmask_b32 v65, v65, v45, s[60:61]
    v_cndmask_b32 v66, v66, v44, s[62:63]
    v_cndmask_b32 v67, v67, v45, s[62:63]
    v_min_u32 v12, v64, v65
    v_min_u32 v13, v66, v67
    v_cmp_eq_u32 s[4:5], 0, v12
    v_cmp_eq_u32 s[6:7], 0, v13
    s_nop 0
    s_or_b64 vcc, s[4:5], s[6:7]
    s_sub_u32 s97, s97, 1
    s_cselect_b64 vcc, 0, vcc
    s_cmp_eq_u64 vcc, 0
    s_cbranch_scc1 L2_p2_ok
    s_sleep 1
    s_branch L2_p2
L2_p2_ok:
    v_max_u32 v65, v65, v67
    v_med3_u32 v65, v64, v66, v65
    v_max_u32 v64, v64, v66
    s_nop 1
    v_mov_b32_dpp v12, v64 row_ror:1 row_mask:0xf bank_mask:0xf
    v_mov_b32_dpp v13, v65 row_ror:1 row_mask:0xf bank_mask:0xf
    v_max_u32 v65, v65, v13
    v_med3_u32 v65, v64, v12, v65
    v_max_u32 v64, v64, v12
    s_nop 1
    v_mov_b32_dpp v12, v64 row_ror:2 row_mask:0xf bank_mask:0xf
    v_mov_b32_dpp v13, v65 row_ror:2 row_mask:0xf bank_mask:0xf
    v_max_u32 v65, v65, v13
    v_med3_u32 v65, v64, v12, v65
    v_max_u32 v64, v64, v12
    s_nop 1
    v_mov_b32_dpp v12, v64 row_ror:4 row_mask:0xf bank_mask:0xf
    v_mov_b32_dpp v13, v65 row_ror:4 row_mask:0xf bank_mask:0xf
    v_max_u32 v65, v65, v13
    v_med3_u32 v65, v64, v12, v65
    v_max_u32 v64, v64, v12
    s_nop 1
    v_mov_b32_dpp v12, v64 row_ror:8 row_mask:0xf bank_mask:0xf
    v_mov_b32_dpp v13, v65 row_ror:8 row_mask:0xf bank_mask:0xf
    v_max_u32 v65, v65, v13
    v_med3_u32 v65, v64, v12, v65
    v_max_u32 v64, v64, v12
    v_mov_b32 v12, v64
    v_mov_b32 v13, v65
    s_nop 0
    v_permlane16_swap_b32 v12, v64
    v_permlane16_swap_b32 v13, v65
    v_max_u32 v65, v65, v13
    v_med3_u32 v65, v64, v12, v65
    v_max_u32 v64, v64, v12
    v_mov_b32 v12, v64
    v_mov_b32 v13, v65
    s_nop 0
    v_permlane32_swap_b32 v12, v64
    v_permlane32_swap_b32 v13, v65
    v_max_u32 v65, v65, v13
    v_med3_u32 v65, v64, v12, v65
    v_max_u32 v64, v64, v12
    s_lshl3_add_u32 s3, s51, 15616
    v_mov_b32 v12, s3
    ds_write_b64 v12, v[64:65]
    s_waitcnt lgkmcnt(0)
L2_join:
    s_barrier
    ds_read_b128 v[16:19], v14
    v_cmp_eq_u32 vcc, 0, v6
    s_waitcnt lgkmcnt(0)
    v_max_u32 v17, v17, v19
    v_med3_u32 v17, v16, v18, v17
    v_max_u32 v16, v16, v18
    v_cndmask_b32 v16, v17, v16, vcc
    v_and_b32 v3, 0x7ff, v16
    v_sub_u32 v3, 2047, v3
    v_mul_u32_u24 v4, 1152, v3
    s_cmp_ge_u32 s2, 144
    s_cbranch_scc1 L2_red
    v_add_u32 v5, v5, v4
    s_mov_b32 s59, 4194304
    v_and_b32 v12, 8, v0
    v_lshlrev_b32 v12, 4, v12
    v_sub_u32 v3, v5, v12
    buffer_load_dwordx4 v[128:131], v5, s[84:87], s59 offen offset:0 sc1
    buffer_load_dwordx4 v[132:135], v5, s[84:87], s59 offen offset:256 sc1
    buffer_load_dwordx4 v[136:139], v5, s[84:87], s59 offen offset:512 sc1
    buffer_load_dwordx4 v[140:143], v5, s[84:87], s59 offen offset:768 sc1
    buffer_load_dwordx4 v[144:147], v3, s[84:87], s59 offen offset:1024 sc1
    v_lshlrev_b32 v11, 7, v6
    v_lshl_add_u32 v13, v7, 5, v11
    v_add_u32 v13, 14848, v13
    v_lshl_add_u32 v11, v7, 4, v11
    s_lshr_b32 s3, s51, 1
    s_lshl_b32 s3, s3, 8
    s_and_b32 s14, s51, 1
    s_lshl_b32 s14, s14, 6
    s_add_u32 s3, s3, s14
    s_add_u32 s3, s3, 14848
    v_add_u32 v11, s3, v11
    s_mul_i32 s14, s51, 1152
    s_mul_i32 s15, s2, 4608
    s_add_u32 s15, s15, s14
    s_add_u32 s15, s15, 98304
    v_lshlrev_b32 v10, 3, v0
    s_waitcnt vmcnt(0)
    buffer_store_dword v14, v9, s[84:87], s56 offen offset:128 sc1
L2_hr:
    v_mfma_f32_16x16x32_bf16 v[88:91], a[64:67], v[128:131], 0
    v_max_u32 v12, v128, v129
    v_mfma_f32_16x16x32_bf16 v[92:95], a[68:71], v[128:131], 0
    v_max3_u32 v12, v12, v130, v131
    v_mfma_f32_16x16x32_bf16 v[96:99], a[72:75], v[128:131], 0
    v_max3_u32 v12, v12, v132, v133
    v_mfma_f32_16x16x32_bf16 v[100:103], a[76:79], v[128:131], 0
    v_max3_u32 v12, v12, v134, v135
    v_mfma_f32_16x16x32_bf16 v[88:91], a[80:83], v[132:135], v[88:91]
    v_max3_u32 v12, v12, v136, v137
    v_mfma_f32_16x16x32_bf16 v[92:95], a[84:87], v[132:135], v[92:95]
    v_max3_u32 v12, v12, v138, v139
    v_mfma_f32_16x16x32_bf16 v[96:99], a[88:91], v[132:135], v[96:99]
    v_max3_u32 v12, v12, v140, v141
    v_mfma_f32_16x16x32_bf16 v[100:103], a[92:95], v[132:135], v[100:103]
    v_max3_u32 v12, v12, v142, v143
    v_mfma_f32_16x16x32_bf16 v[88:91], a[96:99], v[136:139], v[88:91]
    v_max3_u32 v12, v12, v144, v145
    v_mfma_f32_16x16x32_bf16 v[92:95], a[100:103], v[136:139], v[92:95]
    v_max3_u32 v12, v12, v146, v147
    v_mfma_f32_16x16x32_bf16 v[96:99], a[104:107], v[136:139], v[96:99]
    v_cmp_eq_u32 vcc, -1, v12
    v_mfma_f32_16x16x32_bf16 v[100:103], a[108:111], v[136:139], v[100:103]
    v_mfma_f32_16x16x32_bf16 v[96:99], a[120:123], v[140:143], v[96:99]
    v_mfma_f32_16x16x32_bf16 v[100:103], a[124:127], v[140:143], v[100:103]
    v_mfma_f32_16x16x32_bf16 v[88:91], a[112:115], v[140:143], v[88:91]
    v_mfma_f32_16x16x32_bf16 v[92:95], a[116:119], v[140:143], v[92:95]
    v_mfma_f32_16x16x32_bf16 v[92:95], a[132:135], v[144:147], v[92:95]
    v_mfma_f32_16x16x32_bf16 v[88:91], a[128:131], v[144:147], v[88:91]
    s_cmp_lg_u64 vcc, 0
    s_cbranch_scc1 L2_hs
    s_nop 1
    v_add_f32_dpp v96, v100, v96 row_shl:4 row_mask:0xf bank_mask:0xf bound_ctrl:1
    v_add_f32_dpp v97, v101, v97 row_shl:4 row_mask:0xf bank_mask:0xf bound_ctrl:1
    v_add_f32_dpp v98, v102, v98 row_shl:4 row_mask:0xf bank_mask:0xf bound_ctrl:1
    v_add_f32_dpp v99, v103, v99 row_shl:4 row_mask:0xf bank_mask:0xf bound_ctrl:1
    v_add_f32_dpp v88, v92, v88 row_shl:4 row_mask:0xf bank_mask:0xf bound_ctrl:1
    v_add_f32_dpp v89, v93, v89 row_shl:4 row_mask:0xf bank_mask:0xf bound_ctrl:1
    v_add_f32_dpp v90, v94, v90 row_shl:4 row_mask:0xf bank_mask:0xf bound_ctrl:1
    v_add_f32_dpp v91, v95, v91 row_shl:4 row_mask:0xf bank_mask:0xf bound_ctrl:1
    v_add_f32_dpp v88, v96, v88 row_shl:8 row_mask:0xf bank_mask:0xf bound_ctrl:1
    v_add_f32_dpp v89, v97, v89 row_shl:8 row_mask:0xf bank_mask:0xf bound_ctrl:1
    v_add_f32_dpp v90, v98, v90 row_shl:8 row_mask:0xf bank_mask:0xf bound_ctrl:1
    v_add_f32_dpp v91, v99, v91 row_shl:8 row_mask:0xf bank_mask:0xf bound_ctrl:1
    s_mov_b32 exec_lo, 0x30003
    s_mov_b32 exec_hi, 0x30003
    ds_write_b128 v11, v[88:91]
    s_mov_b64 exec, -1
    s_waitcnt lgkmcnt(0)
    s_barrier
    ds_read_b128 v[16:19], v13 offset:0
    ds_read_b128 v[20:23], v13 offset:16
    ds_read_b128 v[24:27], v13 offset:256
    ds_read_b128 v[28:31], v13 offset:272
    v_mov_b32 v12, 0xbfb8aa3b
    s_waitcnt lgkmcnt(2)
    v_pk_mul_f32 v[32:33], v[16:17], v[12:13] op_sel_hi:[1,0]
    v_pk_mul_f32 v[34:35], v[18:19], v[12:13] op_sel_hi:[1,0]
    v_pk_mul_f32 v[36:37], v[20:21], v[12:13] op_sel_hi:[1,0]
    v_pk_mul_f32 v[38:39], v[22:23], v[12:13] op_sel_hi:[1,0]
    v_exp_f32 v32, v32
    v_exp_f32 v33, v33
    v_exp_f32 v34, v34
    v_exp_f32 v35, v35
    v_exp_f32 v36, v36
    v_exp_f32 v37, v37
    v_exp_f32 v38, v38
    v_exp_f32 v39, v39
    v_pk_add_f32 v[32:33], v[32:33], 1.0 op_sel_hi:[1,0]
    v_pk_add_f32 v[34:35], v[34:35], 1.0 op_sel_hi:[1,0]
    v_pk_add_f32 v[36:37], v[36:37], 1.0 op_sel_hi:[1,0]
    v_pk_add_f32 v[38:39], v[38:39], 1.0 op_sel_hi:[1,0]
    v_rcp_f32 v32, v32
    v_rcp_f32 v33, v33
    v_rcp_f32 v34, v34
    v_rcp_f32 v35, v35
    v_rcp_f32 v36, v36
    v_rcp_f32 v37, v37
    v_rcp_f32 v38, v38
    v_rcp_f32 v39, v39
    s_waitcnt lgkmcnt(0)
    v_pk_mul_f32 v[16:17], v[16:17], v[32:33]
    v_pk_mul_f32 v[18:19], v[18:19], v[34:35]
    v_pk_mul_f32 v[20:21], v[20:21], v[36:37]
    v_pk_mul_f32 v[22:23], v[22:23], v[38:39]
    v_pk_mul_f32 v[16:17], v[16:17], v[24:25]
    v_pk_mul_f32 v[18:19], v[18:19], v[26:27]
    v_pk_mul_f32 v[20:21], v[20:21], v[28:29]
    v_pk_mul_f32 v[22:23], v[22:23], v[30:31]
    v_cvt_pk_bf16_f32 v40, v16, v17
    v_cvt_pk_bf16_f32 v41, v18, v19
    v_cvt_pk_bf16_f32 v42, v20, v21
    v_cvt_pk_bf16_f32 v43, v22, v23
    s_nop 1
    v_mfma_f32_16x16x32_bf16 v[48:51], v[40:43], a[136:139], 0
    v_mfma_f32_16x16x32_bf16 v[52:55], v[40:43], a[140:143], 0
    v_mfma_f32_16x16x32_bf16 v[56:59], v[40:43], a[144:147], 0
    v_mfma_f32_16x16x32_bf16 v[60:63], v[40:43], a[148:151], 0
    v_mfma_f32_16x16x32_bf16 v[64:67], v[40:43], a[152:155], 0
    v_mfma_f32_16x16x32_bf16 v[68:71], v[40:43], a[156:159], 0
    v_mfma_f32_16x16x32_bf16 v[72:75], v[40:43], a[160:163], 0
    v_mfma_f32_16x16x32_bf16 v[76:79], v[40:43], a[164:167], 0
    v_mfma_f32_16x16x32_bf16 v[80:83], v[40:43], a[168:171], 0
    s_nop 0
    v_mov_b32_dpp v48, v52 quad_perm:[0,1,2,3] row_mask:0x2 bank_mask:0xf
    v_mov_b32_dpp v49, v53 quad_perm:[0,1,2,3] row_mask:0x2 bank_mask:0xf
    s_nop 0
    v_mov_b32_dpp v48, v56 quad_perm:[0,1,2,3] row_mask:0x4 bank_mask:0xf
    v_mov_b32_dpp v49, v57 quad_perm:[0,1,2,3] row_mask:0x4 bank_mask:0xf
    s_nop 0
    v_mov_b32_dpp v48, v60 quad_perm:[0,1,2,3] row_mask:0x8 bank_mask:0xf
    v_mov_b32_dpp v49, v61 quad_perm:[0,1,2,3] row_mask:0x8 bank_mask:0xf
    v_mov_b32_dpp v50, v64 quad_perm:[0,1,2,3] row_mask:0x1 bank_mask:0xf
    v_mov_b32_dpp v51, v65 quad_perm:[0,1,2,3] row_mask:0x1 bank_mask:0xf
    s_nop 0
    v_mov_b32_dpp v50, v68 quad_perm:[0,1,2,3] row_mask:0x2 bank_mask:0xf
    v_mov_b32_dpp v51, v69 quad_perm:[0,1,2,3] row_mask:0x2 bank_mask:0xf
    s_nop 0
    v_mov_b32_dpp v50, v72 quad_perm:[0,1,2,3] row_mask:0x4 bank_mask:0xf
    v_mov_b32_dpp v51, v73 quad_perm:[0,1,2,3] row_mask:0x4 bank_mask:0xf
    s_nop 0
    v_mov_b32_dpp v50, v76 quad_perm:[0,1,2,3] row_mask:0x8 bank_mask:0xf
    v_mov_b32_dpp v51, v77 quad_perm:[0,1,2,3] row_mask:0x8 bank_mask:0xf
    v_min_u32 v48, -2, v48
    v_min_u32 v49, -2, v49
    v_min_u32 v50, -2, v50
    v_min_u32 v51, -2, v51
    v_min_u32 v80, -2, v80
    v_min_u32 v81, -2, v81
    buffer_store_dwordx4 v[48:51], v8, s[84:87], s15 offen sc1
    s_mov_b64 exec, 0xffff
    buffer_store_dwordx2 v[80:81], v10, s[84:87], s15 offen offset:1024 sc1
    s_branch L2_fin
L2_red:
    s_mov_b32 s3, 98304
    s_add_u32 s32, s84, s3
    s_addc_u32 s33, s85, 0
    s_mov_b32 s34, 663552
    s_mov_b32 s35, 0x20000
    s_sub_u32 s3, s2, 144
    s_mul_i32 s14, s3, 7282
    s_lshr_b32 s14, s14, 16
    s_mul_i32 s15, s14, 9
    s_sub_u32 s15, s3, s15
    s_mul_i32 s14, s14, 144
    s_cmp_eq_u32 s15, 8
    s_cselect_b32 s56, 1, 64
    s_cselect_b32 s57, 2, 1
    s_cselect_b32 s15, 16, s15
    s_lshl3_add_u32 s14, s15, s14
    v_bfe_u32 v7, v0, 2, 3
    v_mul_u32_u24 v7, s57, v7
    v_bfe_u32 v9, v0, 1, 1
    v_mul_u32_u24 v9, s56, v9
    v_add3_u32 v7, v7, v9, s14
    v_lshl_add_u32 v9, v7, 1, v4
    v_lshlrev_b32 v7, 2, v7
    v_lshrrev_b32 v12, 7, v3
    v_bfe_u32 v13, v3, 3, 4
    v_lshl_add_u32 v13, v12, 6, v13
    v_lshlrev_b32 v13, 8, v13
    s_mov_b32 s59, 794624
    s_mov_b32 s97, 0x20000
L2_r:
    buffer_load_dword v12, v13, s[84:87], s59 offen offset:128 sc1
    s_waitcnt vmcnt(0)
    v_cmp_eq_u32 vcc, 0, v12
    s_sub_u32 s97, s97, 1
    s_cselect_b64 vcc, 0, vcc
    s_cmp_eq_u64 vcc, 0
    s_cbranch_scc1 L2_r_ok
    s_sleep 1
    s_branch L2_r
L2_r_ok:
    buffer_load_ushort v18, v9, s[80:83], 0 offen sc1
    ds_read_b32 v20, v7 offset:6912
    v_and_b32 v6, 7, v0
    v_lshrrev_b32 v10, 3, v0
    s_lshl_b32 s14, s51, 3
    v_add_u32 v10, s14, v10
    v_mul_u32_u24 v10, 4608, v10
    v_lshl_add_u32 v10, v6, 4, v10
    s_lshl_b32 s3, s3, 7
    v_add_u32 v24, s3, v10
    v_add_u32 v25, 147456, v24
    v_add_u32 v26, 294912, v24
    v_add_u32 v27, 442368, v24
    v_add_u32 v28, 589824, v24
    v_and_b32 v16, 0xfffff800, v16
    v_not_b32 v12, v16
    v_ashrrev_i32 v12, 31, v12
    v_or_b32 v12, 0x80000000, v12
    v_xor_b32 v16, v16, v12
    v_mul_f32 v16, 0xbfb8aa3b, v16
    v_exp_f32 v16, v16
    s_nop 0
    v_add_f32 v16, 1.0, v16
    v_rcp_f32 v16, v16
    s_waitcnt lgkmcnt(0)
    v_mul_f32 v20, v20, v16
    s_lshl_b32 s14, s51, 7
    s_add_u32 s14, s14, 15872
    v_lshl_add_u32 v10, v6, 4, s14
    v_and_b32 v11, 31, v0
    v_lshlrev_b32 v11, 2, v11
    s_mov_b32 s97, 0x20000
L2_p3:
    buffer_load_dwordx4 v[32:35], v24, s[32:35], 0 offen sc1
    buffer_load_dwordx4 v[36:39], v25, s[32:35], 0 offen sc1
    buffer_load_dwordx4 v[40:43], v26, s[32:35], 0 offen sc1
    buffer_load_dwordx4 v[44:47], v27, s[32:35], 0 offen sc1
    buffer_load_dwordx4 v[48:51], v28, s[32:35], 0 offen sc1
    s_waitcnt vmcnt(0)
    v_max3_u32 v12, v32, v33, v34
    v_max3_u32 v12, v12, v35, v36
    v_max3_u32 v12, v12, v37, v38
    v_max3_u32 v12, v12, v39, v40
    v_max3_u32 v12, v12, v41, v42
    v_max3_u32 v12, v12, v43, v44
    v_max3_u32 v12, v12, v45, v46
    v_max3_u32 v12, v12, v47, v48
    v_max3_u32 v12, v12, v49, v50
    v_max_u32 v12, v12, v51
    v_cmp_eq_u32 vcc, -1, v12
    s_sub_u32 s97, s97, 1
    s_cselect_b64 vcc, 0, vcc
    s_cmp_eq_u64 vcc, 0
    s_cbranch_scc1 L2_p3_ok
    s_branch L2_p3
L2_p3_ok:
    v_pk_add_f32 v[32:33], v[32:33], v[36:37]
    v_pk_add_f32 v[40:41], v[40:41], v[44:45]
    v_pk_add_f32 v[32:33], v[32:33], v[48:49]
    v_pk_add_f32 v[32:33], v[32:33], v[40:41]
    v_pk_add_f32 v[34:35], v[34:35], v[38:39]
    v_pk_add_f32 v[42:43], v[42:43], v[46:47]
    v_pk_add_f32 v[34:35], v[34:35], v[50:51]
    v_pk_add_f32 v[34:35], v[34:35], v[42:43]
    s_nop 1
    v_add_f32_dpp v32, v32, v32 row_ror:8 row_mask:0xf bank_mask:0xf
    v_add_f32_dpp v33, v33, v33 row_ror:8 row_mask:0xf bank_mask:0xf
    v_add_f32_dpp v34, v34, v34 row_ror:8 row_mask:0xf bank_mask:0xf
    v_add_f32_dpp v35, v35, v35 row_ror:8 row_mask:0xf bank_mask:0xf
    v_mov_b32 v12, v32
    v_mov_b32 v13, v33
    v_mov_b32 v14, v34
    v_mov_b32 v15, v35
    v_permlane16_swap_b32 v12, v32
    v_permlane16_swap_b32 v13, v33
    v_permlane16_swap_b32 v14, v34
    v_permlane16_swap_b32 v15, v35
    v_add_f32 v32, v32, v12
    v_add_f32 v33, v33, v13
    v_add_f32 v34, v34, v14
    v_add_f32 v35, v35, v15
    v_mov_b32 v12, v32
    v_mov_b32 v13, v33
    v_mov_b32 v14, v34
    v_mov_b32 v15, v35
    v_permlane32_swap_b32 v12, v32
    v_permlane32_swap_b32 v13, v33
    v_permlane32_swap_b32 v14, v34
    v_permlane32_swap_b32 v15, v35
    v_add_f32 v32, v32, v12
    v_add_f32 v33, v33, v13
    v_add_f32 v34, v34, v14
    v_add_f32 v35, v35, v15
    ds_write_b128 v10, v[32:35]
    s_waitcnt lgkmcnt(0)
    s_barrier
    s_cmp_lg_u32 s51, 0
    s_cbranch_scc1 L2_fin
    ds_read_b32 v32, v11 offset:15872
    ds_read_b32 v33, v11 offset:16000
    ds_read_b32 v34, v11 offset:16128
    ds_read_b32 v35, v11 offset:16256
    v_lshlrev_b32 v12, 16, v18
    s_mov_b32 exec_hi, 0
    s_waitcnt lgkmcnt(0)
    v_pk_add_f32 v[32:33], v[32:33], v[34:35]
    v_add_f32 v32, v32, v33
    v_fmac_f32 v12, v32, v20
    v_cvt_pk_bf16_f32 v12, v12, v12
    buffer_store_short v12, v9, s[80:83], 0 offen sc1
L2_fin:
L2_end:
    s_endpgm
L2_p0s:
    s_mov_b32 s97, 0x20000
L2_p0:
    buffer_load_dword v51, v156, s[60:63], 0 offen sc1
    s_waitcnt vmcnt(0)
    v_cmp_eq_u32 vcc, 0, v51
    s_sub_u32 s97, s97, 1
    s_cselect_b64 vcc, 0, vcc
    s_cmp_eq_u64 vcc, 0
    s_cbranch_scc1 L2_p0_ok
    s_sleep 1
    s_branch L2_p0
L2_p0_ok:
    s_branch L2_p0r
L2_pms:
    s_mov_b32 s97, 0x20000
L2_pm:
    buffer_load_dwordx4 v[168:171], v166, s[84:87], 0 offen sc1
    buffer_load_dwordx4 v[176:179], v166, s[84:87], s14 offen sc1
    s_mov_b64 exec, 0xff
    buffer_load_dwordx4 v[172:175], v166, s[84:87], 0 offen offset:1024 sc1
    buffer_load_dwordx4 v[180:183], v166, s[84:87], s14 offen offset:1024 sc1
    s_mov_b64 exec, -1
    s_waitcnt vmcnt(0)
    v_max_u32 v13, v168, v169
    v_max3_u32 v13, v13, v170, v171
    v_max3_u32 v13, v13, v172, v173
    v_max3_u32 v13, v13, v174, v175
    v_max3_u32 v13, v13, v176, v177
    v_max3_u32 v13, v13, v178, v179
    v_max3_u32 v13, v13, v180, v181
    v_max3_u32 v13, v13, v182, v183
    v_cmp_eq_u32 vcc, -1, v13
    s_sub_u32 s97, s97, 1
    s_cselect_b64 vcc, 0, vcc
    s_cmp_eq_u64 vcc, 0
    s_cbranch_scc1 L2_pm_ok
    s_sleep 1
    s_branch L2_pm
L2_pm_ok:
    s_branch L2_pmr
L2_g0s:
    s_mov_b32 s97, 0x20000
L2_g0:
    buffer_load_dword v9, v6, s[84:87], s47 offen sc1
    s_waitcnt vmcnt(0)
    v_cmp_ne_u32 vcc, 0, v9
    s_nop 0
    s_lshr_b32 s3, vcc_lo, 1
    s_and_b32 s3, s3, vcc_lo
    s_lshr_b32 s14, s3, 2
    s_and_b32 s3, s3, s14
    s_and_b32 s3, s3, s48
    s_cselect_b64 vcc, 0, -1
    s_sub_u32 s97, s97, 1
    s_cselect_b64 vcc, 0, vcc
    s_cmp_eq_u64 vcc, 0
    s_cbranch_scc1 L2_g0_ok
    s_sleep 1
    s_branch L2_g0
L2_g0_ok:
    s_cmp_eq_u32 s3, 0
    s_cselect_b32 s3, s48, s3
    s_branch L2_g0r
L2_g1s:
    s_mov_b32 s97, 0x20000
L2_g1:
    buffer_load_dword v9, v6, s[84:87], s47 offen sc1
    s_waitcnt vmcnt(0)
    v_cmp_ne_u32 vcc, 0, v9
    s_nop 0
    s_lshr_b32 s3, vcc_lo, 1
    s_and_b32 s3, s3, vcc_lo
    s_lshr_b32 s14, s3, 2
    s_and_b32 s3, s3, s14
    s_and_b32 s3, s3, s48
    s_cselect_b64 vcc, 0, -1
    s_sub_u32 s97, s97, 1
    s_cselect_b64 vcc, 0, vcc
    s_cmp_eq_u64 vcc, 0
    s_cbranch_scc1 L2_g1_ok
    s_sleep 1
    s_branch L2_g1
L2_g1_ok:
    s_cmp_eq_u32 s3, 0
    s_cselect_b32 s3, s48, s3
    s_branch L2_g1r
L2_pns:
    s_mov_b32 s97, 0x20000
L2_pn:
    s_movk_i32 s45, 4608
    buffer_load_dwordx4 v[76:79], v5, s[84:87], s45 offen sc1
    s_movk_i32 s45, 18432
    buffer_load_dwordx4 v[88:91], v5, s[84:87], s45 offen sc1
    s_movk_i32 s45, 8704
    buffer_load_dwordx4 v[80:83], v5, s[84:87], s45 offen sc1
    s_movk_i32 s45, 22528
    buffer_load_dwordx4 v[92:95], v5, s[84:87], s45 offen sc1
    s_movk_i32 s45, 12800
    buffer_load_dwordx4 v[84:87], v59, s[84:87], s45 offen sc1
    s_movk_i32 s45, 26624
    buffer_load_dwordx4 v[96:99], v59, s[84:87], s45 offen sc1
    s_waitcnt vmcnt(0)
    v_max_u32 v13, v76, v77
    v_max3_u32 v13, v13, v78, v79
    v_max3_u32 v13, v13, v88, v89
    v_max3_u32 v13, v13, v90, v91
    v_max3_u32 v13, v13, v80, v81
    v_max3_u32 v13, v13, v82, v83
    v_max3_u32 v13, v13, v92, v93
    v_max3_u32 v13, v13, v94, v95
    v_max3_u32 v13, v13, v84, v85
    v_max3_u32 v13, v13, v86, v87
    v_max3_u32 v13, v13, v96, v97
    v_max3_u32 v13, v13, v98, v99
    v_cmp_eq_u32 vcc, -1, v13
    s_sub_u32 s97, s97, 1
    s_cselect_b64 vcc, 0, vcc
    s_cmp_eq_u64 vcc, 0
    s_cbranch_scc1 L2_pn_ok
    s_sleep 1
    s_branch L2_pn
L2_pn_ok:
    s_branch L2_pnr
L2_g2s:
    s_mov_b32 s97, 0x20000
L2_g2:
    buffer_load_dword v9, v6, s[84:87], s47 offen sc1
    s_waitcnt vmcnt(0)
    v_cmp_ne_u32 vcc, 0, v9
    s_nop 0
    s_lshr_b32 s3, vcc_lo, 1
    s_and_b32 s3, s3, vcc_lo
    s_lshr_b32 s14, s3, 2
    s_and_b32 s3, s3, s14
    s_and_b32 s3, s3, s48
    s_cselect_b64 vcc, 0, -1
    s_sub_u32 s97, s97, 1
    s_cselect_b64 vcc, 0, vcc
    s_cmp_eq_u64 vcc, 0
    s_cbranch_scc1 L2_g2_ok
    s_sleep 1
    s_branch L2_g2
L2_g2_ok:
    s_cmp_eq_u32 s3, 0
    s_cselect_b32 s3, s48, s3
    s_branch L2_g2r
L2_g3s:
    s_mov_b32 s97, 0x20000
L2_g3:
    buffer_load_dword v9, v6, s[84:87], s47 offen sc1
    s_waitcnt vmcnt(0)
    v_cmp_ne_u32 vcc, 0, v9
    s_nop 0
    s_lshr_b32 s3, vcc_lo, 1
    s_and_b32 s3, s3, vcc_lo
    s_lshr_b32 s14, s3, 2
    s_and_b32 s3, s3, s14
    s_and_b32 s3, s3, s48
    s_cselect_b64 vcc, 0, -1
    s_sub_u32 s97, s97, 1
    s_cselect_b64 vcc, 0, vcc
    s_cmp_eq_u64 vcc, 0
    s_cbranch_scc1 L2_g3_ok
    s_sleep 1
    s_branch L2_g3
L2_g3_ok:
    s_cmp_eq_u32 s3, 0
    s_cselect_b32 s3, s48, s3
    s_branch L2_g3r
L2_hs:
    s_mov_b32 s97, 0x20000
L2_h:
    buffer_load_dwordx4 v[128:131], v5, s[84:87], s59 offen offset:0 sc1
    buffer_load_dwordx4 v[132:135], v5, s[84:87], s59 offen offset:256 sc1
    buffer_load_dwordx4 v[136:139], v5, s[84:87], s59 offen offset:512 sc1
    buffer_load_dwordx4 v[140:143], v5, s[84:87], s59 offen offset:768 sc1
    buffer_load_dwordx4 v[144:147], v3, s[84:87], s59 offen offset:1024 sc1
    s_waitcnt vmcnt(0)
    v_max_u32 v12, v128, v129
    v_max3_u32 v12, v12, v130, v131
    v_max3_u32 v12, v12, v132, v133
    v_max3_u32 v12, v12, v134, v135
    v_max3_u32 v12, v12, v136, v137
    v_max3_u32 v12, v12, v138, v139
    v_max3_u32 v12, v12, v140, v141
    v_max3_u32 v12, v12, v142, v143
    v_max3_u32 v12, v12, v144, v145
    v_max3_u32 v12, v12, v146, v147
    v_cmp_eq_u32 vcc, -1, v12
    s_sub_u32 s97, s97, 1
    s_cselect_b64 vcc, 0, vcc
    s_cmp_eq_u64 vcc, 0
    s_cbranch_scc1 L2_h_ok
    s_sleep 1
    s_branch L2_h
L2_h_ok:
    v_min_u32 v128, -2, v128
    v_min_u32 v129, -2, v129
    v_min_u32 v130, -2, v130
    v_min_u32 v131, -2, v131
    v_min_u32 v132, -2, v132
    v_min_u32 v133, -2, v133
    v_min_u32 v134, -2, v134
    v_min_u32 v135, -2, v135
    v_min_u32 v136, -2, v136
    v_min_u32 v137, -2, v137
    v_min_u32 v138, -2, v138
    v_min_u32 v139, -2, v139
    v_min_u32 v140, -2, v140
    v_min_u32 v141, -2, v141
    v_min_u32 v142, -2, v142
    v_min_u32 v143, -2, v143
    v_min_u32 v144, -2, v144
    v_min_u32 v145, -2, v145
    v_min_u32 v146, -2, v146
    v_min_u32 v147, -2, v147
    s_nop 1
    s_branch L2_hr
L2_fallback:
    s_waitcnt vmcnt(0) lgkmcnt(0)
    s_nop 7
    s_barrier
    s_lshl_b32 s3, s51, 12
    v_add_u32 v5, s3, v8
    v_lshrrev_b32 v14, 2, v0
    v_mul_u32_u24 v14, 1056, v14
    v_and_b32 v15, 3, v0
    v_lshl_add_u32 v14, v15, 3, v14
    v_add_u32 v2, 107008, v14
    v_and_b32 v14, 15, v0
    v_mul_u32_u24 v14, 1056, v14
    v_lshrrev_b32 v15, 4, v0
    v_lshl_add_u32 v14, v15, 4, v14
    v_add_u32 v1, 90112, v14
    v_mov_b32 v32, 0xff800000
    v_mov_b32 v33, 0xff800000
    v_mov_b32 v34, 0xff800000
    v_mov_b32 v35, 0xff800000
    s_mov_b32 s50, 1
    s_mov_b32 s46, 0
L2_fb_loop:
    s_add_u32 m0, s44, 73728
    s_nop 0
    buffer_load_dwordx4 off, s[16:19], s46 offset:0 lds
    s_add_u32 m0, s44, 73760
    s_nop 0
    buffer_load_dwordx4 off, s[16:19], s46 offset:1024 lds
    s_add_u32 m0, s44, 73792
    s_nop 0
    buffer_load_dwordx4 off, s[16:19], s46 offset:2048 lds
    s_add_u32 m0, s44, 73824
    s_nop 0
    buffer_load_dwordx4 off, s[16:19], s46 offset:3072 lds
    s_waitcnt vmcnt(0) lgkmcnt(0)
    s_barrier
    ds_read_b128 a[64:67], v1 offset:0
    ds_read_b128 a[68:71], v1 offset:64
    ds_read_b128 a[72:75], v1 offset:128
    ds_read_b128 a[76:79], v1 offset:192
    ds_read_b128 a[80:83], v1 offset:256
    ds_read_b128 a[84:87], v1 offset:320
    ds_read_b128 a[88:91], v1 offset:384
    ds_read_b128 a[92:95], v1 offset:448
    ds_read_b128 a[96:99], v1 offset:512
    ds_read_b128 a[100:103], v1 offset:576
    ds_read_b128 a[104:107], v1 offset:640
    ds_read_b128 a[108:111], v1 offset:704
    ds_read_b128 a[112:115], v1 offset:768
    ds_read_b128 a[116:119], v1 offset:832
    ds_read_b128 a[120:123], v1 offset:896
    ds_read_b128 a[124:127], v1 offset:960
    s_waitcnt vmcnt(0) lgkmcnt(0)
    s_barrier
    v_mfma_f32_16x16x32_bf16 v[16:19], a[64:67], v[64:67], 0
    v_mfma_f32_16x16x32_bf16 v[16:19], a[68:71], v[68:71], v[16:19]
    v_mfma_f32_16x16x32_bf16 v[16:19], a[72:75], v[72:75], v[16:19]
    v_mfma_f32_16x16x32_bf16 v[16:19], a[76:79], v[76:79], v[16:19]
    v_mfma_f32_16x16x32_bf16 v[20:23], a[80:83], v[64:67], 0
    v_mfma_f32_16x16x32_bf16 v[20:23], a[84:87], v[68:71], v[20:23]
    v_mfma_f32_16x16x32_bf16 v[20:23], a[88:91], v[72:75], v[20:23]
    v_mfma_f32_16x16x32_bf16 v[20:23], a[92:95], v[76:79], v[20:23]
    v_mfma_f32_16x16x32_bf16 v[24:27], a[96:99], v[64:67], 0
    v_mfma_f32_16x16x32_bf16 v[24:27], a[100:103], v[68:71], v[24:27]
    v_mfma_f32_16x16x32_bf16 v[24:27], a[104:107], v[72:75], v[24:27]
    v_mfma_f32_16x16x32_bf16 v[24:27], a[108:111], v[76:79], v[24:27]
    v_mfma_f32_16x16x32_bf16 v[28:31], a[112:115], v[64:67], 0
    v_mfma_f32_16x16x32_bf16 v[28:31], a[116:119], v[68:71], v[28:31]
    v_mfma_f32_16x16x32_bf16 v[28:31], a[120:123], v[72:75], v[28:31]
    v_mfma_f32_16x16x32_bf16 v[28:31], a[124:127], v[76:79], v[28:31]
    s_nop 7
    v_max3_f32 v32, v32, v16, v17
    v_max3_f32 v32, v32, v18, v19
    v_max3_f32 v32, v32, v20, v21
    v_max3_f32 v32, v32, v22, v23
    v_max3_f32 v32, v32, v24, v25
    v_max3_f32 v32, v32, v26, v27
    v_max3_f32 v32, v32, v28, v29
    v_max3_f32 v32, v32, v30, v31
    v_mfma_f32_16x16x32_bf16 v[16:19], a[64:67], v[80:83], 0
    v_mfma_f32_16x16x32_bf16 v[16:19], a[68:71], v[84:87], v[16:19]
    v_mfma_f32_16x16x32_bf16 v[16:19], a[72:75], v[88:91], v[16:19]
    v_mfma_f32_16x16x32_bf16 v[16:19], a[76:79], v[92:95], v[16:19]
    v_mfma_f32_16x16x32_bf16 v[20:23], a[80:83], v[80:83], 0
    v_mfma_f32_16x16x32_bf16 v[20:23], a[84:87], v[84:87], v[20:23]
    v_mfma_f32_16x16x32_bf16 v[20:23], a[88:91], v[88:91], v[20:23]
    v_mfma_f32_16x16x32_bf16 v[20:23], a[92:95], v[92:95], v[20:23]
    v_mfma_f32_16x16x32_bf16 v[24:27], a[96:99], v[80:83], 0
    v_mfma_f32_16x16x32_bf16 v[24:27], a[100:103], v[84:87], v[24:27]
    v_mfma_f32_16x16x32_bf16 v[24:27], a[104:107], v[88:91], v[24:27]
    v_mfma_f32_16x16x32_bf16 v[24:27], a[108:111], v[92:95], v[24:27]
    v_mfma_f32_16x16x32_bf16 v[28:31], a[112:115], v[80:83], 0
    v_mfma_f32_16x16x32_bf16 v[28:31], a[116:119], v[84:87], v[28:31]
    v_mfma_f32_16x16x32_bf16 v[28:31], a[120:123], v[88:91], v[28:31]
    v_mfma_f32_16x16x32_bf16 v[28:31], a[124:127], v[92:95], v[28:31]
    s_nop 7
    v_max3_f32 v33, v33, v16, v17
    v_max3_f32 v33, v33, v18, v19
    v_max3_f32 v33, v33, v20, v21
    v_max3_f32 v33, v33, v22, v23
    v_max3_f32 v33, v33, v24, v25
    v_max3_f32 v33, v33, v26, v27
    v_max3_f32 v33, v33, v28, v29
    v_max3_f32 v33, v33, v30, v31
    v_mfma_f32_16x16x32_bf16 v[16:19], a[64:67], v[96:99], 0
    v_mfma_f32_16x16x32_bf16 v[16:19], a[68:71], v[100:103], v[16:19]
    v_mfma_f32_16x16x32_bf16 v[16:19], a[72:75], v[104:107], v[16:19]
    v_mfma_f32_16x16x32_bf16 v[16:19], a[76:79], v[108:111], v[16:19]
    v_mfma_f32_16x16x32_bf16 v[20:23], a[80:83], v[96:99], 0
    v_mfma_f32_16x16x32_bf16 v[20:23], a[84:87], v[100:103], v[20:23]
    v_mfma_f32_16x16x32_bf16 v[20:23], a[88:91], v[104:107], v[20:23]
    v_mfma_f32_16x16x32_bf16 v[20:23], a[92:95], v[108:111], v[20:23]
    v_mfma_f32_16x16x32_bf16 v[24:27], a[96:99], v[96:99], 0
    v_mfma_f32_16x16x32_bf16 v[24:27], a[100:103], v[100:103], v[24:27]
    v_mfma_f32_16x16x32_bf16 v[24:27], a[104:107], v[104:107], v[24:27]
    v_mfma_f32_16x16x32_bf16 v[24:27], a[108:111], v[108:111], v[24:27]
    v_mfma_f32_16x16x32_bf16 v[28:31], a[112:115], v[96:99], 0
    v_mfma_f32_16x16x32_bf16 v[28:31], a[116:119], v[100:103], v[28:31]
    v_mfma_f32_16x16x32_bf16 v[28:31], a[120:123], v[104:107], v[28:31]
    v_mfma_f32_16x16x32_bf16 v[28:31], a[124:127], v[108:111], v[28:31]
    s_nop 7
    v_max3_f32 v34, v34, v16, v17
    v_max3_f32 v34, v34, v18, v19
    v_max3_f32 v34, v34, v20, v21
    v_max3_f32 v34, v34, v22, v23
    v_max3_f32 v34, v34, v24, v25
    v_max3_f32 v34, v34, v26, v27
    v_max3_f32 v34, v34, v28, v29
    v_max3_f32 v34, v34, v30, v31
    v_mfma_f32_16x16x32_bf16 v[16:19], a[64:67], v[112:115], 0
    v_mfma_f32_16x16x32_bf16 v[16:19], a[68:71], v[116:119], v[16:19]
    v_mfma_f32_16x16x32_bf16 v[16:19], a[72:75], v[120:123], v[16:19]
    v_mfma_f32_16x16x32_bf16 v[16:19], a[76:79], v[124:127], v[16:19]
    v_mfma_f32_16x16x32_bf16 v[20:23], a[80:83], v[112:115], 0
    v_mfma_f32_16x16x32_bf16 v[20:23], a[84:87], v[116:119], v[20:23]
    v_mfma_f32_16x16x32_bf16 v[20:23], a[88:91], v[120:123], v[20:23]
    v_mfma_f32_16x16x32_bf16 v[20:23], a[92:95], v[124:127], v[20:23]
    v_mfma_f32_16x16x32_bf16 v[24:27], a[96:99], v[112:115], 0
    v_mfma_f32_16x16x32_bf16 v[24:27], a[100:103], v[116:119], v[24:27]
    v_mfma_f32_16x16x32_bf16 v[24:27], a[104:107], v[120:123], v[24:27]
    v_mfma_f32_16x16x32_bf16 v[24:27], a[108:111], v[124:127], v[24:27]
    v_mfma_f32_16x16x32_bf16 v[28:31], a[112:115], v[112:115], 0
    v_mfma_f32_16x16x32_bf16 v[28:31], a[116:119], v[116:119], v[28:31]
    v_mfma_f32_16x16x32_bf16 v[28:31], a[120:123], v[120:123], v[28:31]
    v_mfma_f32_16x16x32_bf16 v[28:31], a[124:127], v[124:127], v[28:31]
    s_nop 7
    v_max3_f32 v35, v35, v16, v17
    v_max3_f32 v35, v35, v18, v19
    v_max3_f32 v35, v35, v20, v21
    v_max3_f32 v35, v35, v22, v23
    v_max3_f32 v35, v35, v24, v25
    v_max3_f32 v35, v35, v26, v27
    v_max3_f32 v35, v35, v28, v29
    v_max3_f32 v35, v35, v30, v31
    s_add_u32 s46, s46, 16384
    s_cmp_lt_u32 s46, 524288
    s_cbranch_scc1 L2_fb_loop
    v_mov_b32 v40, v32
    v_mov_b32 v41, v33
    v_mov_b32 v42, v34
    v_mov_b32 v43, v35
    v_permlane16_swap_b32 v40, v32
    v_permlane16_swap_b32 v41, v33
    v_permlane16_swap_b32 v42, v34
    v_permlane16_swap_b32 v43, v35
    v_max_f32 v32, v32, v40
    v_max_f32 v33, v33, v41
    v_max_f32 v34, v34, v42
    v_max_f32 v35, v35, v43
    v_mov_b32 v40, v32
    v_mov_b32 v41, v33
    v_mov_b32 v42, v34
    v_mov_b32 v43, v35
    v_permlane32_swap_b32 v40, v32
    v_permlane32_swap_b32 v41, v33
    v_permlane32_swap_b32 v42, v34
    v_permlane32_swap_b32 v43, v35
    v_max_f32 v32, v32, v40
    v_max_f32 v33, v33, v41
    v_max_f32 v34, v34, v42
    v_max_f32 v35, v35, v43
    v_sub_f32 v48, 0x80000000, v32
    v_sub_f32 v49, 0x80000000, v32
    v_sub_f32 v50, 0x80000000, v32
    v_sub_f32 v51, 0x80000000, v32
    v_sub_f32 v52, 0x80000000, v33
    v_sub_f32 v53, 0x80000000, v33
    v_sub_f32 v54, 0x80000000, v33
    v_sub_f32 v55, 0x80000000, v33
    v_sub_f32 v56, 0x80000000, v34
    v_sub_f32 v57, 0x80000000, v34
    v_sub_f32 v58, 0x80000000, v34
    v_sub_f32 v59, 0x80000000, v34
    v_sub_f32 v60, 0x80000000, v35
    v_sub_f32 v61, 0x80000000, v35
    v_sub_f32 v62, 0x80000000, v35
    v_sub_f32 v63, 0x80000000, v35
    s_add_u32 m0, s44, 73728
    s_mov_b32 s46, 0
    buffer_load_dwordx4 off, s[16:19], s46 offset:0 lds
    s_add_u32 m0, s44, 73760
    s_nop 0
    buffer_load_dwordx4 off, s[16:19], s46 offset:1024 lds
    s_add_u32 m0, s44, 73792
    s_nop 0
    buffer_load_dwordx4 off, s[16:19], s46 offset:2048 lds
    s_add_u32 m0, s44, 73824
    s_nop 0
    buffer_load_dwordx4 off, s[16:19], s46 offset:3072 lds
    s_add_u32 m0, s44, 90624
    s_nop 0
    buffer_load_dwordx4 off, s[20:23], s46 offset:0 lds
    s_add_u32 m0, s44, 90656
    s_nop 0
    buffer_load_dwordx4 off, s[20:23], s46 offset:1024 lds
    s_add_u32 m0, s44, 90688
    s_nop 0
    buffer_load_dwordx4 off, s[20:23], s46 offset:2048 lds
    s_add_u32 m0, s44, 90720
    s_nop 0
    buffer_load_dwordx4 off, s[20:23], s46 offset:3072 lds
    s_add_u32 m0, s44, 110592
    s_mov_b32 s46, 16384
    buffer_load_dwordx4 off, s[16:19], s46 offset:0 lds
    s_add_u32 m0, s44, 110624
    s_nop 0
    buffer_load_dwordx4 off, s[16:19], s46 offset:1024 lds
    s_add_u32 m0, s44, 110656
    s_nop 0
    buffer_load_dwordx4 off, s[16:19], s46 offset:2048 lds
    s_add_u32 m0, s44, 110688
    s_nop 0
    buffer_load_dwordx4 off, s[16:19], s46 offset:3072 lds
    s_add_u32 m0, s44, 127488
    s_nop 0
    buffer_load_dwordx4 off, s[20:23], s46 offset:0 lds
    s_add_u32 m0, s44, 127520
    s_nop 0
    buffer_load_dwordx4 off, s[20:23], s46 offset:1024 lds
    s_add_u32 m0, s44, 127552
    s_nop 0
    buffer_load_dwordx4 off, s[20:23], s46 offset:2048 lds
    s_add_u32 m0, s44, 127584
    s_nop 0
    buffer_load_dwordx4 off, s[20:23], s46 offset:3072 lds
    s_add_u32 m0, s44, 0
    s_mov_b32 s46, 32768
    buffer_load_dwordx4 off, s[16:19], s46 offset:0 lds
    s_add_u32 m0, s44, 32
    s_nop 0
    buffer_load_dwordx4 off, s[16:19], s46 offset:1024 lds
    s_add_u32 m0, s44, 64
    s_nop 0
    buffer_load_dwordx4 off, s[16:19], s46 offset:2048 lds
    s_add_u32 m0, s44, 96
    s_nop 0
    buffer_load_dwordx4 off, s[16:19], s46 offset:3072 lds
    s_add_u32 m0, s44, 16896
    s_nop 0
    buffer_load_dwordx4 off, s[20:23], s46 offset:0 lds
    s_add_u32 m0, s44, 16928
    s_nop 0
    buffer_load_dwordx4 off, s[20:23], s46 offset:1024 lds
    s_add_u32 m0, s44, 16960
    s_nop 0
    buffer_load_dwordx4 off, s[20:23], s46 offset:2048 lds
    s_add_u32 m0, s44, 16992
    s_nop 0
    buffer_load_dwordx4 off, s[20:23], s46 offset:3072 lds
    s_waitcnt vmcnt(0) lgkmcnt(0)
    s_barrier
    ds_read_b128 a[64:67], v1 offset:0
    ds_read_b128 a[68:71], v1 offset:64
    ds_read_b128 a[72:75], v1 offset:128
    ds_read_b128 a[76:79], v1 offset:192
    ds_read_b128 a[80:83], v1 offset:256
    ds_read_b128 a[84:87], v1 offset:320
    ds_read_b128 a[88:91], v1 offset:384
    ds_read_b128 a[92:95], v1 offset:448
    ds_read_b128 a[96:99], v1 offset:512
    ds_read_b128 a[100:103], v1 offset:576
    ds_read_b128 a[104:107], v1 offset:640
    ds_read_b128 a[108:111], v1 offset:704
    ds_read_b128 a[112:115], v1 offset:768
    ds_read_b128 a[116:119], v1 offset:832
    ds_read_b128 a[120:123], v1 offset:896
    ds_read_b128 a[124:127], v1 offset:960
    v_lshrrev_b32 v14, 2, v0
    s_mul_i32 s3, s51, 144
    v_add_u32 v14, s3, v14
    v_mul_u32_u24 v14, 9216, v14
    v_and_b32 v15, 3, v0
    v_lshl_add_u32 v6, v15, 4, v14
    s_lshr_b32 s3, s2, 3
    s_lshl2_add_u32 s3, s3, s51
    s_and_b32 s15, s2, 7
    v_lshlrev_b32 v9, 7, v0
    s_mul_i32 s14, s3, 9
    s_lshr_b32 s14, s14, 1
    v_min_u32 v15, 44, v0
    v_mul_u32_u24 v12, 7282, v15
    v_lshrrev_b32 v12, 16, v12
    v_mul_u32_u24 v13, 63, v12
    v_add_u32 v12, v15, v13
    s_mul_i32 s14, s14, 72
    s_mul_i32 s56, s15, 9
    s_add_u32 s14, s14, s56
    v_add_lshl_u32 v12, s14, v12, 7
    s_mul_i32 s14, s3, 81
    s_lshr_b32 s14, s14, 1
    s_mul_i32 s56, s15, 5184
    s_add_u32 s14, s14, s56
    v_min_u32 v13, 40, v0
    v_add_lshl_u32 v13, s14, v13, 7
    s_mul_i32 s14, s3, 72
    s_andn2_b32 s56, s52, 3
    s_mul_i32 s56, s56, 2304
    s_add_u32 s14, s14, s56
    v_min_u32 v14, 35, v0
    v_add_lshl_u32 v14, s14, v14, 7
    v_add_u32 v15, 4608, v14
    v_accvgpr_write_b32 a0, 0
    v_accvgpr_write_b32 a1, 0
    v_accvgpr_write_b32 a2, 0
    v_accvgpr_write_b32 a3, 0
    v_accvgpr_write_b32 a4, 0
    v_accvgpr_write_b32 a5, 0
    v_accvgpr_write_b32 a6, 0
    v_accvgpr_write_b32 a7, 0
    v_accvgpr_write_b32 a8, 0
    v_accvgpr_write_b32 a9, 0
    v_accvgpr_write_b32 a10, 0
    v_accvgpr_write_b32 a11, 0
    v_accvgpr_write_b32 a12, 0
    v_accvgpr_write_b32 a13, 0
    v_accvgpr_write_b32 a14, 0
    v_accvgpr_write_b32 a15, 0
    s_waitcnt vmcnt(0) lgkmcnt(0)
    s_branch L2_entry
L2_codeend:

.section .rodata,"a"
.p2align 6
.amdhsa_kernel adaLN_cond__gqa_block_cached__moe_arch_mod__prompt_kernel
  .amdhsa_next_free_vgpr 512
  .amdhsa_next_free_sgpr 102
  .amdhsa_accum_offset 256
  .amdhsa_group_segment_fixed_size 0
  .amdhsa_kernarg_size 120
  .amdhsa_user_sgpr_count 2
  .amdhsa_user_sgpr_kernarg_segment_ptr 1
  .amdhsa_system_sgpr_workgroup_id_x 1
  .amdhsa_float_denorm_mode_32 3
.end_amdhsa_kernel
```

```asm
; @launch grid=(256,1,1) block=(256,1,1) lds=163840
.amdgcn_target "amdgcn-amd-amdhsa--gfx950"
.text
.globl adaLN_cond__gqa_block_cached__moe_arch_mod__prompt_kernel
.p2align 8
.type adaLN_cond__gqa_block_cached__moe_arch_mod__prompt_kernel,@function
adaLN_cond__gqa_block_cached__moe_arch_mod__prompt_kernel:
L2_begin:
    s_getpc_b64 s[98:99]
    s_cmp_ge_u32 s2, 256
    s_cbranch_scc1 L2_end
    s_load_dwordx2 s[76:77], s[0:1], 0
    s_load_dwordx2 s[16:17], s[0:1], 80
    s_load_dwordx2 s[88:89], s[0:1], 88
    s_load_dwordx2 s[12:13], s[0:1], 112
    s_load_dwordx2 s[60:61], s[0:1], 104
    s_and_b32 s3, s2, 7
    s_lshr_b32 s14, s2, 3
    v_mov_b32 v155, v0
    v_lshrrev_b32 v10, 6, v0
    v_and_b32 v0, 63, v0
    s_lshl_b32 s15, s14, 9
    v_lshl_add_u32 v13, v10, 7, s15
    v_lshl_add_u32 v13, v0, 14, v13
    v_min_u32 v13, L2_codeend-L2_begin-8, v13
    s_mov_b64 exec, 31
    global_load_dword a63, v13, s[98:99]
    s_mov_b64 exec, -1
    v_readfirstlane_b32 s51, v10
    s_and_b32 s52, s3, 3
    s_and_b32 s15, s14, 3
    s_lshl2_add_u32 s52, s52, s15
    s_lshr_b32 s53, s3, 2
    s_lshr_b32 s15, s14, 2
    s_lshl3_add_u32 s53, s53, s15
    s_lshl4_add_u32 s96, s53, s52
    s_mul_i32 s49, s3, 27
    s_max_u32 s14, s14, 5
    s_add_u32 s49, s49, s14
    s_sub_u32 s49, s49, 5
    s_lshr_b32 s55, s3, 2
    s_mul_i32 s15, s55, 108
    s_sub_u32 s50, s49, s15
    s_mul_i32 s3, s51, 288
    v_lshrrev_b32 v14, 3, v0
    v_lshl_add_u32 v12, v14, 4, s3
    v_and_b32 v14, 1, v14
    v_lshl_add_u32 v13, v14, 4, s3
    v_and_b32 v14, 7, v0
    v_mul_u32_u24 v14, 1152, v14
    v_add_u32 v1, v14, v12
    v_add_u32 v2, v14, v13
    v_add_u32 v2, 256, v2
    v_and_b32 v4, 0xfc, v155
    v_and_b32 v7, 3, v0
    v_mul_u32_u24 v3, 6912, v4
    v_lshl_add_u32 v153, v7, 4, v3
    s_mul_i32 s3, s96, 9216
    s_movk_i32 s78, 9216
    s_mov_b32 s79, 0x20000
    s_mov_b32 s91, s79
    v_lshlrev_b32 v8, 4, v0
    s_mov_b32 s86, 8388608
    s_mov_b32 s87, s79
    s_movk_i32 s62, 256
    s_mov_b32 s63, s79
    s_lshl_b32 s14, s50, 6
    s_sub_u32 s90, 1990656, s14
    s_cmp_ge_u32 s2, 40
    s_cselect_b32 s90, s90, 0
    s_mul_i32 s15, s55, 1990656
    s_add_u32 s14, s14, s15
    s_waitcnt lgkmcnt(0)
    s_add_u32 s76, s76, s3
    s_addc_u32 s77, s77, 0
    buffer_load_dwordx4 v[64:67], v1, s[76:79], 0 offen offset:0
    buffer_load_dwordx4 v[68:71], v1, s[76:79], 0 offen offset:128
    buffer_load_dwordx4 v[72:75], v2, s[76:79], 0 offen offset:0
    s_add_u32 s88, s88, s14
    s_addc_u32 s89, s89, 0
    s_mov_b64 s[84:85], s[12:13]
    s_cmp_ge_u32 s2, 8
    s_cbranch_scc1 L2_noclr
    v_mov_b32 v52, -1
    v_mov_b32 v56, 0
    v_mov_b32 v53, -1
    v_mov_b32 v57, 0
    v_mov_b32 v54, -1
    v_mov_b32 v58, 0
    v_mov_b32 v55, -1
    v_mov_b32 v59, 0
    s_lshl2_add_u32 s15, s2, s51
    s_lshl_b32 s3, s15, 10
    buffer_store_dwordx4 v[52:55], v8, s[84:87], s3 offen sc1
    v_lshrrev_b32 v13, 3, v0
    v_mul_u32_u24 v13, 0, v13
    v_add_u32 v13, v13, v8
    s_mul_i32 s3, s15, 1024
    s_add_u32 s3, s3, 6815744
    buffer_store_dwordx4 v[56:59], v13, s[84:87], s3 offen sc1
L2_noclr:
    buffer_load_dwordx4 v[128:131], v153, s[88:91], 0 offen
    s_movk_i32 s3, 6912
    buffer_load_dwordx4 v[132:135], v153, s[88:91], s3 offen
    s_movk_i32 s3, 13824
    buffer_load_dwordx4 v[136:139], v153, s[88:91], s3 offen
    s_movk_i32 s3, 20736
    buffer_load_dwordx4 v[140:143], v153, s[88:91], s3 offen
    v_lshrrev_b32 v3, 2, v3
    v_lshl_add_u32 v3, v7, 4, v3
    v_add_u32 v154, 1769472, v3
    v_lshrrev_b32 v3, 1, v4
    v_lshlrev_b32 v4, 1, v4
    s_mul_i32 s3, s55, 576
    s_add_u32 s16, s16, s3
    s_addc_u32 s17, s17, 0
    s_mov_b32 s18, 576
    s_mov_b32 s19, 0x20000
    v_mov_b32 v144, 0
    v_mov_b32 v145, 0
    v_mov_b32 v146, 0
    v_mov_b32 v147, 0
    v_mov_b32 v150, 0
    s_cmp_ge_u32 s51, 2
    s_cbranch_scc1 L2_w23
    buffer_load_dwordx4 v[144:147], v154, s[88:91], 0 offen
    buffer_load_ushort v150, v3, s[16:19], 0 offen offset:512
L2_w23:
    buffer_load_dwordx2 v[148:149], v4, s[16:19], 0 offen
    s_load_dwordx8 s[4:11], s[0:1], 8
    s_load_dwordx2 s[64:65], s[0:1], 56
    s_load_dwordx2 s[68:69], s[0:1], 64
    s_load_dwordx2 s[72:73], s[0:1], 72
    s_load_dwordx2 s[80:81], s[0:1], 96
    s_load_dwordx2 s[36:37], s[0:1], 48
    s_cmp_eq_u32 s51, 0
    s_cselect_b32 s3, 0, 0x40000000
    v_mul_u32_u24 v156, 32, v0
    v_or_b32 v156, s3, v156
    s_mul_i32 s44, s51, 4224
    s_add_u32 s44, s44, 16384
    v_lshl_add_u32 v5, v10, 12, v8
    v_lshrrev_b32 v13, 5, v0
    v_lshl_add_u32 v13, v10, 1, v13
    v_lshlrev_b32 v13, 15, v13
    v_and_b32 v14, 31, v0
    v_lshl_add_u32 v6, v14, 4, v13
    v_mov_b32 v56, 0
    v_mov_b32 v60, -1
    v_mov_b32 v57, 0
    v_mov_b32 v61, -1
    v_mov_b32 v58, 0
    v_mov_b32 v62, -1
    v_mov_b32 v59, 0
    v_mov_b32 v63, -1
    s_and_b32 s14, s53, 7
    s_lshl2_add_u32 s14, s14, s51
    v_lshrrev_b32 v13, 2, v0
    v_lshl_add_u32 v13, v13, 5, s14
    v_lshlrev_b32 v13, 13, v13
    v_lshl_add_u32 v165, v7, 7, v13
    s_waitcnt lgkmcnt(0)
    s_lshl_b32 s3, s52, 9
    s_add_u32 s24, s8, s3
    s_addc_u32 s25, s9, 0
    s_mov_b32 s26, 0
    s_mov_b32 s27, 0x20000
    s_sub_u32 s26, 4718592, s3
    s_mov_b32 s38, 1152
    s_mov_b32 s39, 0x20000
    v_and_b32 v14, 7, v0
    v_lshlrev_b32 v157, 4, v14
    v_add_u32 v157, 14080, v157
    v_lshl_add_u32 v158, v10, 2, v157
    s_mul_i32 s3, s51, 4608
    v_lshl_add_u32 v14, v14, 4, s3
    v_lshrrev_b32 v15, 3, v0
    v_lshl_add_u32 v159, v15, 8, v14
    s_lshr_b32 s3, s96, 1
    s_mul_i32 s3, s3, 18432
    s_and_b32 s14, s96, 1
    s_lshl_b32 s14, s14, 7
    s_add_u32 s3, s3, s14
    s_add_u32 s58, s3, 1048576
    s_lshl_b32 s3, s53, 2
    s_add_u32 s3, s3, s51
    s_lshl_b32 s14, s3, 4
    s_add_u32 s14, s14, s52
    s_lshl_b32 s14, s14, 8
    s_add_u32 s56, s14, 786432
    s_mul_i32 s14, s3, 512
    s_add_u32 s59, s14, 6815744
    v_and_b32 v14, 3, v0
    v_mul_u32_u24 v163, 128, v14
    s_mul_i32 s14, s3, 36864
    s_add_u32 s14, s14, 1048576
    s_add_u32 s32, s12, s14
    s_addc_u32 s33, s13, 0
    s_mov_b32 s34, 36864
    s_mov_b32 s35, 0x20000
    s_or_b32 s33, s33, 0x100000
    s_mov_b32 s35, 0x800000
    s_mul_i32 s15, s2, 4608
    s_mul_i32 s14, s51, 1152
    s_add_u32 s15, s15, s14
    s_add_u32 s57, s15, 98304
    s_cmp_ge_u32 s2, 144
    s_cselect_b32 s14, 0x40000000, 0
    v_or_b32 v160, s14, v8
    v_lshrrev_b32 v12, 4, v155
    v_lshlrev_b32 v12, 7, v12
    v_lshl_add_u32 v161, v7, 5, v12
    v_lshlrev_b32 v162, 2, v0
    s_mul_i32 s3, s50, 3641
    s_lshr_b32 s3, s3, 16
    s_mov_b32 s47, 1.0
    s_mov_b32 s48, 0
    s_cmp_lt_u32 s3, 2
    s_cselect_b32 s47, 0x3e0293ee, s47
    s_cmp_eq_u32 s3, 1
    s_cselect_b32 s48, 0x3e0293ee, s48
    s_cmp_eq_u32 s3, 4
    s_cselect_b32 s48, 1.0, s48
    s_cmp_eq_u32 s55, 0
    s_cselect_b32 s48, s48, 0
    s_lshl_b32 s100, s49, 7
    s_mul_i32 s14, s96, 128
    s_add_u32 s101, s14, 6815744
    s_mul_i32 s3, s51, 1152
    v_add_u32 v166, s3, v8
    s_and_b32 s3, s51, 1
    s_mul_i32 s3, s3, 2304
    s_cmp_lt_u32 s51, 2
    s_cselect_b32 s14, 32, 0
    s_add_u32 s3, s3, s14
    s_add_u32 s3, s3, 9216
    v_lshrrev_b32 v14, 1, v0
    v_lshl_add_u32 v14, v14, 6, s3
    v_and_b32 v15, 1, v0
    v_lshl_add_u32 v167, v15, 4, v14
    s_cmp_eq_u32 s51, 1
    s_cselect_b32 s3, 40, 256
    s_cmp_ge_u32 s2, s3
    s_cselect_b32 s3, 0, 0x40000000
    v_or_b32 v164, s3, v162
    v_mov_b32 v172, 0
    v_mov_b32 v180, 0
    v_mov_b32 v173, 0
    v_mov_b32 v181, 0
    v_mov_b32 v174, 0
    v_mov_b32 v182, 0
    v_mov_b32 v175, 0
    v_mov_b32 v183, 0
    s_lshl_b32 s3, s53, 2
    s_add_u32 s3, s3, s51
    v_mov_b32 v12, v10
    s_mul_i32 s14, s3, 589824
    s_mul_i32 s15, s52, 9216
    s_add_u32 s14, s14, s15
    s_add_u32 s14, s14, 8388608
    s_add_u32 s40, s12, s14
    s_addc_u32 s41, s13, 0
    s_mov_b32 s42, 0
    s_mov_b32 s43, 0x20000
    s_sub_u32 s42, 589824, s15
    s_lshl_b32 s3, s52, 19
    s_add_u32 s16, s4, s3
    s_addc_u32 s17, s5, 0
    s_mov_b32 s18, 524288
    s_mov_b32 s19, 0x20000
    s_add_u32 s20, s6, s3
    s_addc_u32 s21, s7, 0
    s_mov_b32 s22, 524288
    s_mov_b32 s23, 0x20000
    s_lshl_b32 s3, s51, 12
    s_add_u32 s16, s16, s3
    s_addc_u32 s17, s17, 0x100000
    s_mov_b32 s18, 32768
    s_mov_b32 s19, 0x800000
    s_add_u32 s20, s20, s3
    s_addc_u32 s21, s21, 0x100000
    s_mov_b32 s22, 32768
    s_mov_b32 s23, 0x800000
    s_mul_i32 s3, s52, 294912
    s_add_u32 s28, s10, s3
    s_addc_u32 s29, s11, 0
    s_mov_b32 s30, 294912
    s_mov_b32 s31, 0x20000
    s_mov_b64 s[4:5], s[64:65]
    s_mov_b64 s[6:7], s[68:69]
    s_mov_b64 s[8:9], s[72:73]
    s_mov_b32 s50, 0
    s_mul_i32 s55, s51, 9216
    s_min_u32 s15, s2, 143
    s_and_b32 s3, s15, 7
    s_mul_i32 s3, s3, 18
    s_lshr_b32 s15, s15, 3
    s_add_u32 s15, s15, s3
    s_lshl_b32 s3, s15, 6
    s_add_u32 s64, s64, s3
    s_addc_u32 s65, s65, 0
    s_mov_b32 s66, 0
    s_mov_b32 s67, 0x20000
    s_add_u32 s68, s68, s3
    s_addc_u32 s69, s69, 0
    s_mov_b32 s70, 0
    s_mov_b32 s71, 0x20000
    s_sub_u32 s14, 5308416, s3
    s_mul_i32 s3, s15, 36864
    s_add_u32 s72, s72, s3
    s_addc_u32 s73, s73, 0
    s_mov_b32 s74, 0
    s_mov_b32 s75, 0x20000
    s_cmp_lt_u32 s2, 144
    s_cselect_b32 s66, s14, 0
    s_cselect_b32 s70, s14, 0
    s_cselect_b32 s74, 36864, 0
    s_mov_b32 s82, 2359296
    s_mov_b32 s83, 0x20000
    v_lshrrev_b32 v13, 4, v0
    v_lshlrev_b32 v9, 6, v13
    v_lshrrev_b32 v14, 2, v0
    v_mul_u32_u24 v14, 1056, v14
    v_add_u32 v14, 16384, v14
    v_and_b32 v15, 1, v0
    v_lshlrev_b32 v15, 4, v15
    v_add_u32 v3, v14, v15
    v_and_b32 v15, 2, v0
    v_lshl_add_u32 v3, v15, 2, v3
    v_add_u32 v4, 73728, v3
    v_lshrrev_b32 v14, 3, v0
    v_lshlrev_b32 v14, 2, v14
    v_add_u32 v14, v14, v12
    v_mul_u32_u24 v14, 4608, v14
    v_and_b32 v15, 7, v0
    v_lshl_add_u32 v7, v15, 4, v14
    v_lshlrev_b32 v10, 4, v15
    v_lshl_add_u32 v10, v13, 7, v10
    v_bfe_u32 v14, v0, 3, 1
    v_mul_u32_u24 v14, 147456, v14
    v_add_u32 v10, v10, v14
    v_lshrrev_b32 v14, 2, v0
    v_mul_u32_u24 v14, 1056, v14
    v_and_b32 v15, 3, v0
    v_lshl_add_u32 v14, v15, 3, v14
    v_add_u32 v2, 107008, v14
    v_and_b32 v14, 15, v0
    v_mul_u32_u24 v14, 1056, v14
    v_lshrrev_b32 v15, 4, v0
    v_lshl_add_u32 v14, v15, 4, v14
    v_add_u32 v1, 90112, v14
    v_and_b32 v14, 1, v0
    v_cmp_eq_u32 vcc, 0, v14
    v_mov_b32 v11, 0xeeeeeeee
    v_mov_b32 v15, 0x44444444
    v_cndmask_b32 v11, v11, v15, vcc
    v_and_b32 v14, 2, v0
    v_cmp_eq_u32 vcc, 0, v14
    v_mov_b32 v15, 0x3f803f80
    s_nop 0
    v_cndmask_b32 v15, 0, v15, vcc
    v_accvgpr_write_b32 a16, v15
    v_accvgpr_write_b32 a56, -1
    v_accvgpr_write_b32 a17, v15
    v_accvgpr_write_b32 a57, -1
    v_accvgpr_write_b32 a18, v15
    v_accvgpr_write_b32 a58, -1
    v_accvgpr_write_b32 a19, v15
    v_accvgpr_write_b32 a59, -1
    v_accvgpr_write_b32 a0, 0
    v_accvgpr_write_b32 a1, 0
    v_accvgpr_write_b32 a2, 0
    v_accvgpr_write_b32 a3, 0
    v_accvgpr_write_b32 a4, 0
    v_accvgpr_write_b32 a5, 0
    v_accvgpr_write_b32 a6, 0
    v_accvgpr_write_b32 a7, 0
    v_accvgpr_write_b32 a8, 0
    v_accvgpr_write_b32 a9, 0
    v_accvgpr_write_b32 a10, 0
    v_accvgpr_write_b32 a11, 0
    v_accvgpr_write_b32 a12, 0
    v_accvgpr_write_b32 a13, 0
    v_accvgpr_write_b32 a14, 0
    v_accvgpr_write_b32 a15, 0
    s_cmp_ge_u32 s2, 8
    s_cbranch_scc1 L2_noclr2
    s_mul_i32 s14, s2, 32
    s_mov_b64 exec, 1
    s_waitcnt vmcnt(5)
    s_barrier
    buffer_store_dword v60, v156, s[60:63], s14 offen sc1
    s_mov_b64 exec, -1
L2_noclr2:
    s_mov_b64 exec, 0xffff
    buffer_load_dword a63, v165, s[24:27], 0 offen
    s_mov_b64 exec, -1
    s_waitcnt vmcnt(6)
    v_lshlrev_b32 v24, 16, v64
    v_and_b32 v25, 0xffff0000, v64
    v_lshlrev_b32 v26, 16, v65
    v_and_b32 v27, 0xffff0000, v65
    v_lshlrev_b32 v28, 16, v66
    v_and_b32 v29, 0xffff0000, v66
    v_lshlrev_b32 v30, 16, v67
    v_and_b32 v31, 0xffff0000, v67
    v_lshlrev_b32 v32, 16, v68
    v_and_b32 v33, 0xffff0000, v68
    v_lshlrev_b32 v34, 16, v69
    v_and_b32 v35, 0xffff0000, v69
    v_lshlrev_b32 v36, 16, v70
    v_and_b32 v37, 0xffff0000, v70
    v_lshlrev_b32 v38, 16, v71
    v_and_b32 v39, 0xffff0000, v71
    v_lshlrev_b32 v40, 16, v72
    v_and_b32 v41, 0xffff0000, v72
    v_lshlrev_b32 v42, 16, v73
    v_and_b32 v43, 0xffff0000, v73
    v_lshlrev_b32 v44, 16, v74
    v_and_b32 v45, 0xffff0000, v74
    v_lshlrev_b32 v46, 16, v75
    v_and_b32 v47, 0xffff0000, v75
    v_pk_add_f32 v[12:13], v[24:25], v[26:27]
    v_pk_add_f32 v[12:13], v[12:13], v[28:29]
    v_pk_add_f32 v[12:13], v[12:13], v[30:31]
    v_pk_add_f32 v[12:13], v[12:13], v[32:33]
    v_pk_add_f32 v[12:13], v[12:13], v[34:35]
    v_pk_add_f32 v[12:13], v[12:13], v[36:37]
    v_pk_add_f32 v[12:13], v[12:13], v[38:39]
    v_pk_add_f32 v[14:15], v[40:41], v[42:43]
    v_pk_add_f32 v[14:15], v[14:15], v[44:45]
    v_pk_add_f32 v[14:15], v[14:15], v[46:47]
    v_add_f32 v48, v12, v13
    v_add_f32 v14, v14, v15
    v_fmac_f32 v48, 0x3e800000, v14
    s_nop 1
    v_add_f32_dpp v48, v48, v48 row_ror:8 row_mask:0xf bank_mask:0xf
    v_mov_b32 v50, v48
    s_nop 1
    v_permlane16_swap_b32 v50, v48
    v_add_f32 v48, v48, v50
    v_mov_b32 v50, v48
    s_nop 1
    v_permlane32_swap_b32 v50, v48
    v_add_f32 v48, v48, v50
    v_mul_f32 v48, 0x3be38e39, v48
    v_pk_add_f32 v[24:25], v[24:25], v[48:49] op_sel_hi:[1,0] neg_lo:[0,1] neg_hi:[0,1]
    v_pk_add_f32 v[26:27], v[26:27], v[48:49] op_sel_hi:[1,0] neg_lo:[0,1] neg_hi:[0,1]
    v_pk_add_f32 v[28:29], v[28:29], v[48:49] op_sel_hi:[1,0] neg_lo:[0,1] neg_hi:[0,1]
    v_pk_add_f32 v[30:31], v[30:31], v[48:49] op_sel_hi:[1,0] neg_lo:[0,1] neg_hi:[0,1]
    v_pk_add_f32 v[32:33], v[32:33], v[48:49] op_sel_hi:[1,0] neg_lo:[0,1] neg_hi:[0,1]
    v_pk_add_f32 v[34:35], v[34:35], v[48:49] op_sel_hi:[1,0] neg_lo:[0,1] neg_hi:[0,1]
    v_pk_add_f32 v[36:37], v[36:37], v[48:49] op_sel_hi:[1,0] neg_lo:[0,1] neg_hi:[0,1]
    v_pk_add_f32 v[38:39], v[38:39], v[48:49] op_sel_hi:[1,0] neg_lo:[0,1] neg_hi:[0,1]
    v_pk_add_f32 v[40:41], v[40:41], v[48:49] op_sel_hi:[1,0] neg_lo:[0,1] neg_hi:[0,1]
    v_pk_add_f32 v[42:43], v[42:43], v[48:49] op_sel_hi:[1,0] neg_lo:[0,1] neg_hi:[0,1]
    v_pk_add_f32 v[44:45], v[44:45], v[48:49] op_sel_hi:[1,0] neg_lo:[0,1] neg_hi:[0,1]
    v_pk_add_f32 v[46:47], v[46:47], v[48:49] op_sel_hi:[1,0] neg_lo:[0,1] neg_hi:[0,1]
    v_pk_mul_f32 v[12:13], v[24:25], v[24:25]
    v_pk_fma_f32 v[12:13], v[26:27], v[26:27], v[12:13]
    v_pk_fma_f32 v[12:13], v[28:29], v[28:29], v[12:13]
    v_pk_fma_f32 v[12:13], v[30:31], v[30:31], v[12:13]
    v_pk_fma_f32 v[12:13], v[32:33], v[32:33], v[12:13]
    v_pk_fma_f32 v[12:13], v[34:35], v[34:35], v[12:13]
    v_pk_fma_f32 v[12:13], v[36:37], v[36:37], v[12:13]
    v_pk_fma_f32 v[12:13], v[38:39], v[38:39], v[12:13]
    v_pk_mul_f32 v[14:15], v[40:41], v[40:41]
    v_pk_fma_f32 v[14:15], v[42:43], v[42:43], v[14:15]
    v_pk_fma_f32 v[14:15], v[44:45], v[44:45], v[14:15]
    v_pk_fma_f32 v[14:15], v[46:47], v[46:47], v[14:15]
    v_add_f32 v49, v12, v13
    v_add_f32 v14, v14, v15
    v_fmac_f32 v49, 0x3e800000, v14
    s_nop 1
    v_add_f32_dpp v49, v49, v49 row_ror:8 row_mask:0xf bank_mask:0xf
    v_mov_b32 v50, v49
    s_nop 1
    v_permlane16_swap_b32 v50, v49
    v_add_f32 v49, v49, v50
    v_mov_b32 v50, v49
    s_nop 1
    v_permlane32_swap_b32 v50, v49
    v_add_f32 v49, v49, v50
    ds_write_b32 v158, v48
    ds_write_b32 v158, v49 offset:128
    s_waitcnt lgkmcnt(0)
    s_barrier
    ds_read_b128 v[16:19], v157
    ds_read_b128 v[20:23], v157 offset:128
    s_add_u32 s14, s58, 4096
    s_waitcnt lgkmcnt(1)
    v_add_f32 v12, v16, v17
    v_add_f32 v13, v18, v19
    v_add_f32 v12, v12, v13
    v_mul_f32 v12, 0x3e800000, v12
    v_sub_f32 v16, v16, v12
    v_sub_f32 v17, v17, v12
    v_sub_f32 v18, v18, v12
    v_sub_f32 v19, v19, v12
    v_sub_f32 v48, v48, v12
    v_mul_f32 v13, v16, v16
    v_fmac_f32 v13, v17, v17
    v_fmac_f32 v13, v18, v18
    v_fmac_f32 v13, v19, v19
    s_waitcnt lgkmcnt(0)
    v_add_f32 v14, v20, v21
    v_add_f32 v15, v22, v23
    v_add_f32 v14, v14, v15
    v_fmac_f32 v14, 0x43100000, v13
    v_mov_b32 v12, 0x3727c5ac
    v_fmac_f32 v12, 0x3ae38e39, v14
    v_rsq_f32 v12, v12
    s_nop 0
    v_mul_f32 v48, v48, v12
    v_pk_fma_f32 v[24:25], v[24:25], v[12:13], v[48:49] op_sel_hi:[1,0,0]
    v_pk_fma_f32 v[26:27], v[26:27], v[12:13], v[48:49] op_sel_hi:[1,0,0]
    v_pk_fma_f32 v[28:29], v[28:29], v[12:13], v[48:49] op_sel_hi:[1,0,0]
    v_pk_fma_f32 v[30:31], v[30:31], v[12:13], v[48:49] op_sel_hi:[1,0,0]
    v_cvt_pk_f16_f32 v64, v24, v25
    v_cvt_pk_f16_f32 v65, v26, v27
    v_cvt_pk_f16_f32 v66, v28, v29
    v_cvt_pk_f16_f32 v67, v30, v31
    buffer_store_dwordx4 v[64:67], v159, s[84:87], s58 offen offset:0 sc1
    v_pk_fma_f32 v[32:33], v[32:33], v[12:13], v[48:49] op_sel_hi:[1,0,0]
    v_pk_fma_f32 v[34:35], v[34:35], v[12:13], v[48:49] op_sel_hi:[1,0,0]
    v_pk_fma_f32 v[36:37], v[36:37], v[12:13], v[48:49] op_sel_hi:[1,0,0]
    v_pk_fma_f32 v[38:39], v[38:39], v[12:13], v[48:49] op_sel_hi:[1,0,0]
    v_cvt_pk_f16_f32 v68, v32, v33
    v_cvt_pk_f16_f32 v69, v34, v35
    v_cvt_pk_f16_f32 v70, v36, v37
    v_cvt_pk_f16_f32 v71, v38, v39
    buffer_store_dwordx4 v[68:71], v159, s[84:87], s58 offen offset:2048 sc1
    v_pk_fma_f32 v[40:41], v[40:41], v[12:13], v[48:49] op_sel_hi:[1,0,0]
    v_pk_fma_f32 v[42:43], v[42:43], v[12:13], v[48:49] op_sel_hi:[1,0,0]
    v_pk_fma_f32 v[44:45], v[44:45], v[12:13], v[48:49] op_sel_hi:[1,0,0]
    v_pk_fma_f32 v[46:47], v[46:47], v[12:13], v[48:49] op_sel_hi:[1,0,0]
    v_cvt_pk_f16_f32 v72, v40, v41
    v_cvt_pk_f16_f32 v73, v42, v43
    v_cvt_pk_f16_f32 v74, v44, v45
    v_cvt_pk_f16_f32 v75, v46, v47
    s_mov_b64 exec, 0xffff
    buffer_store_dwordx4 v[72:75], v159, s[84:87], s14 offen offset:0 sc1
    buffer_store_dwordx4 v[56:59], v8, s[84:87], s56 offen sc1
    s_mov_b64 exec, 0xff
    buffer_store_dwordx4 v[60:63], v160, s[84:87], s57 offen offset:1024 sc1
    s_mov_b64 exec, -1
    buffer_store_dwordx4 v[60:63], v160, s[84:87], s57 offen sc1
    s_mov_b64 exec, 255
    buffer_load_dword v51, v156, s[60:63], 0 offen sc1
    s_mov_b64 exec, -1
    s_mul_i32 s3, s96, 147456
    s_add_u32 s3, s3, 8392704
    s_add_u32 s88, s12, s3
    s_addc_u32 s89, s13, 0
    s_mov_b32 s90, 143360
    s_mov_b32 s91, 0x20000
    s_waitcnt vmcnt(8)
    v_lshlrev_b32 v40, 16, v148
    v_and_b32 v41, 0xffff0000, v148
    v_lshlrev_b32 v42, 16, v149
    v_and_b32 v43, 0xffff0000, v149
    v_lshlrev_b32 v44, 16, v150
    v_mul_f32 v16, 0xbfb8aa3b, v40
    v_mul_f32 v17, 0xbfb8aa3b, v41
    v_mul_f32 v18, 0xbfb8aa3b, v42
    v_mul_f32 v19, 0xbfb8aa3b, v43
    v_mul_f32 v20, 0xbfb8aa3b, v44
    v_exp_f32 v16, v16
    v_exp_f32 v17, v17
    v_exp_f32 v18, v18
    v_exp_f32 v19, v19
    v_exp_f32 v20, v20
    v_add_f32 v16, 1.0, v16
    v_add_f32 v17, 1.0, v17
    v_add_f32 v18, 1.0, v18
    v_add_f32 v19, 1.0, v19
    v_add_f32 v20, 1.0, v20
    v_rcp_f32 v16, v16
    v_rcp_f32 v17, v17
    v_rcp_f32 v18, v18
    v_rcp_f32 v19, v19
    v_rcp_f32 v20, v20
    v_mul_f32 v24, v40, v16
    v_mul_f32 v26, v41, v17
    v_mul_f32 v28, v42, v18
    v_mul_f32 v30, v43, v19
    v_mul_f32 v32, v44, v20
    v_lshlrev_b32 v12, 16, v128
    v_and_b32 v13, 0xffff0000, v128
    v_pk_mul_f32 v[16:17], v[12:13], v[24:25] op_sel_hi:[1,0]
    v_lshlrev_b32 v14, 16, v129
    v_and_b32 v15, 0xffff0000, v129
    v_pk_mul_f32 v[18:19], v[14:15], v[24:25] op_sel_hi:[1,0]
    v_lshlrev_b32 v12, 16, v130
    v_and_b32 v13, 0xffff0000, v130
    v_pk_mul_f32 v[20:21], v[12:13], v[24:25] op_sel_hi:[1,0]
    v_lshlrev_b32 v14, 16, v131
    v_and_b32 v15, 0xffff0000, v131
    v_pk_mul_f32 v[22:23], v[14:15], v[24:25] op_sel_hi:[1,0]
    v_lshlrev_b32 v12, 16, v132
    v_and_b32 v13, 0xffff0000, v132
    v_pk_fma_f32 v[16:17], v[12:13], v[26:27], v[16:17] op_sel_hi:[1,0,1]
    v_lshlrev_b32 v14, 16, v133
    v_and_b32 v15, 0xffff0000, v133
    v_pk_fma_f32 v[18:19], v[14:15], v[26:27], v[18:19] op_sel_hi:[1,0,1]
    v_lshlrev_b32 v12, 16, v134
    v_and_b32 v13, 0xffff0000, v134
    v_pk_fma_f32 v[20:21], v[12:13], v[26:27], v[20:21] op_sel_hi:[1,0,1]
    v_lshlrev_b32 v14, 16, v135
    v_and_b32 v15, 0xffff0000, v135
    v_pk_fma_f32 v[22:23], v[14:15], v[26:27], v[22:23] op_sel_hi:[1,0,1]
    v_lshlrev_b32 v12, 16, v136
    v_and_b32 v13, 0xffff0000, v136
    v_pk_fma_f32 v[16:17], v[12:13], v[28:29], v[16:17] op_sel_hi:[1,0,1]
    v_lshlrev_b32 v14, 16, v137
    v_and_b32 v15, 0xffff0000, v137
    v_pk_fma_f32 v[18:19], v[14:15], v[28:29], v[18:19] op_sel_hi:[1,0,1]
    v_lshlrev_b32 v12, 16, v138
    v_and_b32 v13, 0xffff0000, v138
    v_pk_fma_f32 v[20:21], v[12:13], v[28:29], v[20:21] op_sel_hi:[1,0,1]
    v_lshlrev_b32 v14, 16, v139
    v_and_b32 v15, 0xffff0000, v139
    v_pk_fma_f32 v[22:23], v[14:15], v[28:29], v[22:23] op_sel_hi:[1,0,1]
    v_lshlrev_b32 v12, 16, v140
    v_and_b32 v13, 0xffff0000, v140
    v_pk_fma_f32 v[16:17], v[12:13], v[30:31], v[16:17] op_sel_hi:[1,0,1]
    v_lshlrev_b32 v14, 16, v141
    v_and_b32 v15, 0xffff0000, v141
    v_pk_fma_f32 v[18:19], v[14:15], v[30:31], v[18:19] op_sel_hi:[1,0,1]
    v_lshlrev_b32 v12, 16, v142
    v_and_b32 v13, 0xffff0000, v142
    v_pk_fma_f32 v[20:21], v[12:13], v[30:31], v[20:21] op_sel_hi:[1,0,1]
    v_lshlrev_b32 v14, 16, v143
    v_and_b32 v15, 0xffff0000, v143
    v_pk_fma_f32 v[22:23], v[14:15], v[30:31], v[22:23] op_sel_hi:[1,0,1]
    v_lshlrev_b32 v12, 16, v144
    v_and_b32 v13, 0xffff0000, v144
    v_pk_fma_f32 v[16:17], v[12:13], v[32:33], v[16:17] op_sel_hi:[1,0,1]
    v_lshlrev_b32 v14, 16, v145
    v_and_b32 v15, 0xffff0000, v145
    v_pk_fma_f32 v[18:19], v[14:15], v[32:33], v[18:19] op_sel_hi:[1,0,1]
    v_lshlrev_b32 v12, 16, v146
    v_and_b32 v13, 0xffff0000, v146
    v_pk_fma_f32 v[20:21], v[12:13], v[32:33], v[20:21] op_sel_hi:[1,0,1]
    v_lshlrev_b32 v14, 16, v147
    v_and_b32 v15, 0xffff0000, v147
    v_pk_fma_f32 v[22:23], v[14:15], v[32:33], v[22:23] op_sel_hi:[1,0,1]
    v_add_f32_dpp v16, v16, v16 row_ror:4 row_mask:0xf bank_mask:0xf
    v_add_f32_dpp v17, v17, v17 row_ror:4 row_mask:0xf bank_mask:0xf
    v_add_f32_dpp v18, v18, v18 row_ror:4 row_mask:0xf bank_mask:0xf
    v_add_f32_dpp v19, v19, v19 row_ror:4 row_mask:0xf bank_mask:0xf
    v_add_f32_dpp v20, v20, v20 row_ror:4 row_mask:0xf bank_mask:0xf
    v_add_f32_dpp v21, v21, v21 row_ror:4 row_mask:0xf bank_mask:0xf
    v_add_f32_dpp v22, v22, v22 row_ror:4 row_mask:0xf bank_mask:0xf
    v_add_f32_dpp v23, v23, v23 row_ror:4 row_mask:0xf bank_mask:0xf
    v_add_f32_dpp v16, v16, v16 row_ror:8 row_mask:0xf bank_mask:0xf
    v_add_f32_dpp v17, v17, v17 row_ror:8 row_mask:0xf bank_mask:0xf
    v_add_f32_dpp v18, v18, v18 row_ror:8 row_mask:0xf bank_mask:0xf
    v_add_f32_dpp v19, v19, v19 row_ror:8 row_mask:0xf bank_mask:0xf
    v_add_f32_dpp v20, v20, v20 row_ror:8 row_mask:0xf bank_mask:0xf
    v_add_f32_dpp v21, v21, v21 row_ror:8 row_mask:0xf bank_mask:0xf
    v_add_f32_dpp v22, v22, v22 row_ror:8 row_mask:0xf bank_mask:0xf
    v_add_f32_dpp v23, v23, v23 row_ror:8 row_mask:0xf bank_mask:0xf
    s_mov_b32 exec_lo, 0xf000f
    s_mov_b32 exec_hi, 0xf000f
    ds_write_b128 v161, v[16:19] offset:16384
    ds_write_b128 v161, v[20:23] offset:16400
    s_mov_b64 exec, 255
    s_waitcnt vmcnt(0)
    v_cmp_eq_u32 vcc, s51, v51
    s_nop 0
    s_cmp_lg_u64 vcc, 0
    s_cbranch_scc1 L2_p0s
L2_p0r:
    s_mov_b64 exec, 1
    s_waitcnt lgkmcnt(0)
    s_barrier
    buffer_store_dword v60, v156, s[84:87], s101 offen sc1
    s_mov_b64 exec, -1
    ds_read_b32 v24, v162 offset:16384
    ds_read_b32 v25, v162 offset:16640
    ds_read_b32 v26, v162 offset:16896
    ds_read_b32 v27, v162 offset:17152
    ds_read_b32 v28, v162 offset:17408
    ds_read_b32 v29, v162 offset:17664
    ds_read_b32 v30, v162 offset:17920
    ds_read_b32 v31, v162 offset:18176
    s_waitcnt lgkmcnt(0)
    v_pk_add_f32 v[24:25], v[24:25], v[26:27]
    v_pk_add_f32 v[28:29], v[28:29], v[30:31]
    v_pk_add_f32 v[24:25], v[24:25], v[28:29]
    v_add_f32 v52, v24, v25
    v_mov_b32 v53, v52
    v_mov_b32 v54, s48
    s_nop 0
    v_permlane32_swap_b32 v53, v52
    v_add_f32 v52, v52, v53
    v_fma_f32 v52, v52, s47, v54
    v_min_u32 v52, -2, v52
    s_mov_b32 exec_hi, 0
    buffer_store_dword v52, v164, s[84:87], s100 offen sc1
    s_mov_b64 exec, -1
    s_add_u32 m0, s44, 36864
    s_mov_b32 s45, 0
    buffer_load_dwordx4 v6, s[24:27], s45 offen lds
    s_add_u32 m0, s44, 37920
    s_mov_b32 s45, 8192
    buffer_load_dwordx4 v6, s[24:27], s45 offen lds
    s_add_u32 m0, s44, 38976
    s_mov_b32 s45, 16384
    buffer_load_dwordx4 v6, s[24:27], s45 offen lds
    s_add_u32 m0, s44, 40032
    s_mov_b32 s45, 24576
    buffer_load_dwordx4 v6, s[24:27], s45 offen lds
    s_add_u32 m0, s44, 53760
    s_mov_b32 s45, 262144
    buffer_load_dwordx4 v6, s[24:27], s45 offen lds
    s_add_u32 m0, s44, 54816
    s_mov_b32 s45, 270336
    buffer_load_dwordx4 v6, s[24:27], s45 offen lds
    s_add_u32 m0, s44, 55872
    s_mov_b32 s45, 278528
    buffer_load_dwordx4 v6, s[24:27], s45 offen lds
    s_add_u32 m0, s44, 56928
    s_mov_b32 s45, 286720
    buffer_load_dwordx4 v6, s[24:27], s45 offen lds
    s_add_u32 m0, s44, 73728
    s_mov_b32 s45, 524288
    buffer_load_dwordx4 v6, s[24:27], s45 offen lds
    s_add_u32 m0, s44, 74784
    s_mov_b32 s45, 532480
    buffer_load_dwordx4 v6, s[24:27], s45 offen lds
    s_add_u32 m0, s44, 75840
    s_mov_b32 s45, 540672
    buffer_load_dwordx4 v6, s[24:27], s45 offen lds
    s_add_u32 m0, s44, 76896
    s_mov_b32 s45, 548864
    buffer_load_dwordx4 v6, s[24:27], s45 offen lds
    s_add_u32 m0, s44, 90624
    s_mov_b32 s45, 786432
    buffer_load_dwordx4 v6, s[24:27], s45 offen lds
    s_add_u32 m0, s44, 91680
    s_mov_b32 s45, 794624
    buffer_load_dwordx4 v6, s[24:27], s45 offen lds
    s_add_u32 m0, s44, 92736
    s_mov_b32 s45, 802816
    buffer_load_dwordx4 v6, s[24:27], s45 offen lds
    s_add_u32 m0, s44, 93792
    s_mov_b32 s45, 811008
    buffer_load_dwordx4 v6, s[24:27], s45 offen lds
    s_mov_b64 exec, 0
    s_cmp_eq_u32 s51, 0
    s_cbranch_scc1 L2_pad0
    s_cmp_eq_u32 s51, 1
    s_cbranch_scc1 L2_pad1
    s_cmp_eq_u32 s51, 2
    s_cbranch_scc1 L2_pad2
    s_branch L2_pad3
.p2align 12
L2_walkret:
    s_mov_b64 exec, 15
    buffer_load_dword v12, v163, s[84:87], s59 offen sc1
    s_mov_b64 exec, -1
    s_movk_i32 s14, 13824
    buffer_load_dwordx4 v[168:171], v166, s[84:87], 0 offen sc1
    buffer_load_dwordx4 v[176:179], v166, s[84:87], s14 offen sc1
    s_mov_b64 exec, 0xff
    buffer_load_dwordx4 v[172:175], v166, s[84:87], 0 offen offset:1024 sc1
    buffer_load_dwordx4 v[180:183], v166, s[84:87], s14 offen offset:1024 sc1
    s_mov_b64 exec, -1
    s_mov_b64 exec, 15
    s_waitcnt vmcnt(4)
    v_cmp_eq_u32 vcc, 0, v12
    s_nop 0
    s_cmp_eq_u64 vcc, 0
    s_cbranch_scc1 L2_px_ok
    s_mov_b32 s97, 0x20000
L2_px:
    buffer_load_dword v12, v163, s[84:87], s59 offen sc1
    s_waitcnt vmcnt(0)
    v_cmp_eq_u32 vcc, 0, v12
    s_sub_u32 s97, s97, 1
    s_cselect_b64 vcc, 0, vcc
    s_cmp_eq_u64 vcc, 0
    s_cbranch_scc1 L2_px_ok
    s_branch L2_px
L2_px_ok:
    s_mov_b64 exec, -1
    s_mov_b32 s54, 0
    buffer_load_dwordx4 v[80:83], off, s[32:35], s54 sc1
    s_mov_b32 s54, 1024
    buffer_load_dwordx4 v[84:87], off, s[32:35], s54 sc1
    s_mov_b32 s54, 18432
    buffer_load_dwordx4 v[88:91], off, s[32:35], s54 sc1
    s_mov_b32 s54, 19456
    buffer_load_dwordx4 v[92:95], off, s[32:35], s54 sc1
    s_mov_b32 s54, 2048
    buffer_load_dwordx4 v[96:99], off, s[32:35], s54 sc1
    s_mov_b32 s54, 3072
    buffer_load_dwordx4 v[100:103], off, s[32:35], s54 sc1
    s_mov_b32 s54, 20480
    buffer_load_dwordx4 v[104:107], off, s[32:35], s54 sc1
    s_mov_b32 s54, 21504
    buffer_load_dwordx4 v[108:111], off, s[32:35], s54 sc1
    s_waitcnt vmcnt(8)
    v_max_u32 v13, v168, v169
    v_max3_u32 v13, v13, v170, v171
    v_max3_u32 v13, v13, v172, v173
    v_max3_u32 v13, v13, v174, v175
    v_max3_u32 v13, v13, v176, v177
    v_max3_u32 v13, v13, v178, v179
    v_max3_u32 v13, v13, v180, v181
    v_max3_u32 v13, v13, v182, v183
    v_cmp_eq_u32 vcc, -1, v13
    s_nop 0
    s_cmp_lg_u64 vcc, 0
    s_cbranch_scc1 L2_pms
L2_pmr:
    v_pk_add_f32 v[168:169], v[168:169], v[176:177]
    v_pk_add_f32 v[170:171], v[170:171], v[178:179]
    v_pk_add_f32 v[172:173], v[172:173], v[180:181]
    v_pk_add_f32 v[174:175], v[174:175], v[182:183]
    ds_write_b128 v167, v[168:171]
    s_mov_b64 exec, 0xff
    ds_write_b128 v167, v[172:175] offset:2048
    s_mov_b64 exec, -1
    s_waitcnt lgkmcnt(0)
    s_barrier
    ds_read_b128 v[16:19], v9 offset:9216
    ds_read_b128 v[20:23], v9 offset:9248
    ds_read_b128 v[24:27], v9 offset:9232
    ds_read_b128 v[28:31], v9 offset:9264
    s_mov_b32 s54, 4096
    buffer_load_dwordx4 v[112:115], off, s[32:35], s54 sc1
    s_mov_b32 s54, 5120
    buffer_load_dwordx4 v[116:119], off, s[32:35], s54 sc1
    s_mov_b32 s54, 22528
    buffer_load_dwordx4 v[120:123], off, s[32:35], s54 sc1
    s_mov_b32 s54, 23552
    buffer_load_dwordx4 v[124:127], off, s[32:35], s54 sc1
    s_waitcnt vmcnt(8)
    s_waitcnt lgkmcnt(2)
    v_fma_mix_f32 v32, v80, v16, v20 op_sel:[0,0,0] op_sel_hi:[1,0,0]
    v_fma_mix_f32 v33, v80, v17, v21 op_sel:[1,0,0] op_sel_hi:[1,0,0]
    v_fma_mix_f32 v34, v81, v18, v22 op_sel:[0,0,0] op_sel_hi:[1,0,0]
    v_fma_mix_f32 v35, v81, v19, v23 op_sel:[1,0,0] op_sel_hi:[1,0,0]
    v_cvt_pk_bf16_f32 v80, v32, v33
    v_cvt_pk_bf16_f32 v81, v34, v35
    v_fma_mix_f32 v36, v88, v16, v20 op_sel:[0,0,0] op_sel_hi:[1,0,0]
    v_fma_mix_f32 v37, v88, v17, v21 op_sel:[1,0,0] op_sel_hi:[1,0,0]
    v_fma_mix_f32 v38, v89, v18, v22 op_sel:[0,0,0] op_sel_hi:[1,0,0]
    v_fma_mix_f32 v39, v89, v19, v23 op_sel:[1,0,0] op_sel_hi:[1,0,0]
    v_cvt_pk_bf16_f32 v88, v36, v37
    v_cvt_pk_bf16_f32 v89, v38, v39
    ds_read_b128 v[16:19], v9 offset:9472
    ds_read_b128 v[20:23], v9 offset:9504
    s_waitcnt lgkmcnt(2)
    v_fma_mix_f32 v32, v82, v24, v28 op_sel:[0,0,0] op_sel_hi:[1,0,0]
    v_fma_mix_f32 v33, v82, v25, v29 op_sel:[1,0,0] op_sel_hi:[1,0,0]
    v_fma_mix_f32 v34, v83, v26, v30 op_sel:[0,0,0] op_sel_hi:[1,0,0]
    v_fma_mix_f32 v35, v83, v27, v31 op_sel:[1,0,0] op_sel_hi:[1,0,0]
    v_cvt_pk_bf16_f32 v82, v32, v33
    v_cvt_pk_bf16_f32 v83, v34, v35
    v_fma_mix_f32 v36, v90, v24, v28 op_sel:[0,0,0] op_sel_hi:[1,0,0]
    v_fma_mix_f32 v37, v90, v25, v29 op_sel:[1,0,0] op_sel_hi:[1,0,0]
    v_fma_mix_f32 v38, v91, v26, v30 op_sel:[0,0,0] op_sel_hi:[1,0,0]
    v_fma_mix_f32 v39, v91, v27, v31 op_sel:[1,0,0] op_sel_hi:[1,0,0]
    v_cvt_pk_bf16_f32 v90, v36, v37
    v_cvt_pk_bf16_f32 v91, v38, v39
    ds_read_b128 v[24:27], v9 offset:9488
    ds_read_b128 v[28:31], v9 offset:9520
    s_waitcnt lgkmcnt(2)
    v_fma_mix_f32 v32, v84, v16, v20 op_sel:[0,0,0] op_sel_hi:[1,0,0]
    v_fma_mix_f32 v33, v84, v17, v21 op_sel:[1,0,0] op_sel_hi:[1,0,0]
    v_fma_mix_f32 v34, v85, v18, v22 op_sel:[0,0,0] op_sel_hi:[1,0,0]
    v_fma_mix_f32 v35, v85, v19, v23 op_sel:[1,0,0] op_sel_hi:[1,0,0]
    v_cvt_pk_bf16_f32 v84, v32, v33
    v_cvt_pk_bf16_f32 v85, v34, v35
    v_fma_mix_f32 v36, v92, v16, v20 op_sel:[0,0,0] op_sel_hi:[1,0,0]
    v_fma_mix_f32 v37, v92, v17, v21 op_sel:[1,0,0] op_sel_hi:[1,0,0]
    v_fma_mix_f32 v38, v93, v18, v22 op_sel:[0,0,0] op_sel_hi:[1,0,0]
    v_fma_mix_f32 v39, v93, v19, v23 op_sel:[1,0,0] op_sel_hi:[1,0,0]
    v_cvt_pk_bf16_f32 v92, v36, v37
    v_cvt_pk_bf16_f32 v93, v38, v39
    ds_read_b128 v[16:19], v9 offset:9728
    ds_read_b128 v[20:23], v9 offset:9760
    ds_read_b64_tr_b16 a[192:193], v3 offset:36864
    ds_read_b64_tr_b16 a[194:195], v3 offset:37376
    ds_read_b64_tr_b16 a[196:197], v3 offset:53760
    ds_read_b64_tr_b16 a[198:199], v3 offset:54272
    ds_read_b64_tr_b16 a[200:201], v3 offset:36896
    ds_read_b64_tr_b16 a[202:203], v3 offset:37408
    ds_read_b64_tr_b16 a[204:205], v3 offset:53792
    ds_read_b64_tr_b16 a[206:207], v3 offset:54304
    ds_read_b64_tr_b16 a[208:209], v3 offset:36928
    ds_read_b64_tr_b16 a[210:211], v3 offset:37440
    ds_read_b64_tr_b16 a[212:213], v3 offset:53824
    ds_read_b64_tr_b16 a[214:215], v3 offset:54336
    s_waitcnt lgkmcnt(14)
    v_fma_mix_f32 v32, v86, v24, v28 op_sel:[0,0,0] op_sel_hi:[1,0,0]
    v_fma_mix_f32 v33, v86, v25, v29 op_sel:[1,0,0] op_sel_hi:[1,0,0]
    v_fma_mix_f32 v34, v87, v26, v30 op_sel:[0,0,0] op_sel_hi:[1,0,0]
    v_fma_mix_f32 v35, v87, v27, v31 op_sel:[1,0,0] op_sel_hi:[1,0,0]
    v_cvt_pk_bf16_f32 v86, v32, v33
    v_cvt_pk_bf16_f32 v87, v34, v35
    v_fma_mix_f32 v36, v94, v24, v28 op_sel:[0,0,0] op_sel_hi:[1,0,0]
    v_fma_mix_f32 v37, v94, v25, v29 op_sel:[1,0,0] op_sel_hi:[1,0,0]
    v_fma_mix_f32 v38, v95, v26, v30 op_sel:[0,0,0] op_sel_hi:[1,0,0]
    v_fma_mix_f32 v39, v95, v27, v31 op_sel:[1,0,0] op_sel_hi:[1,0,0]
    v_cvt_pk_bf16_f32 v94, v36, v37
    v_cvt_pk_bf16_f32 v95, v38, v39
    s_waitcnt lgkmcnt(8)
    v_mfma_f32_16x16x32_bf16 v[128:131], a[192:195], v[80:83], 0
    s_waitcnt vmcnt(4)
    ds_read_b64_tr_b16 a[216:217], v3 offset:36960
    ds_read_b128 v[24:27], v9 offset:9744
    v_mfma_f32_16x16x32_bf16 v[128:131], a[196:199], v[84:87], v[128:131]
    ds_read_b64_tr_b16 a[218:219], v3 offset:37472
    ds_read_b64_tr_b16 a[220:221], v3 offset:53856
    v_fma_mix_f32 v32, v96, v16, v20 op_sel:[0,0,0] op_sel_hi:[1,0,0]
    v_mfma_f32_16x16x32_bf16 v[160:163], a[192:195], v[88:91], 0
    s_add_u32 m0, s44, 110592
    ds_read_b64_tr_b16 a[222:223], v3 offset:54368
    ds_read_b128 v[28:31], v9 offset:9776
    v_mfma_f32_16x16x32_bf16 v[160:163], a[196:199], v[92:95], v[160:163]
    s_mov_b32 s45, 1048576
    s_waitcnt lgkmcnt(10)
    buffer_load_dwordx4 v6, s[24:27], s45 offen lds
    v_mfma_f32_16x16x32_bf16 v[132:135], a[200:203], v[80:83], 0
    ds_read_b64_tr_b16 a[224:225], v3 offset:36992
    v_fma_mix_f32 v33, v96, v17, v21 op_sel:[1,0,0] op_sel_hi:[1,0,0]
    v_mfma_f32_16x16x32_bf16 v[132:135], a[204:207], v[84:87], v[132:135]
    ds_read_b64_tr_b16 a[226:227], v3 offset:37504
    ds_read_b64_tr_b16 a[228:229], v3 offset:53888
    v_fma_mix_f32 v34, v97, v18, v22 op_sel:[0,0,0] op_sel_hi:[1,0,0]
    v_mfma_f32_16x16x32_bf16 v[164:167], a[200:203], v[88:91], 0
    s_add_u32 m0, s44, 111648
    ds_read_b64_tr_b16 a[230:231], v3 offset:54400
    v_fma_mix_f32 v35, v97, v19, v23 op_sel:[1,0,0] op_sel_hi:[1,0,0]
    v_mfma_f32_16x16x32_bf16 v[164:167], a[204:207], v[92:95], v[164:167]
    s_mov_b32 s45, 1056768
    s_waitcnt lgkmcnt(10)
    buffer_load_dwordx4 v6, s[24:27], s45 offen lds
    v_mfma_f32_16x16x32_bf16 v[136:139], a[208:211], v[80:83], 0
    ds_read_b64_tr_b16 a[232:233], v3 offset:37024
    v_cvt_pk_bf16_f32 v96, v32, v33
    v_mfma_f32_16x16x32_bf16 v[136:139], a[212:215], v[84:87], v[136:139]
    ds_read_b64_tr_b16 a[234:235], v3 offset:37536
    ds_read_b64_tr_b16 a[236:237], v3 offset:53920
    v_cvt_pk_bf16_f32 v97, v34, v35
    v_mfma_f32_16x16x32_bf16 v[168:171], a[208:211], v[88:91], 0
    s_add_u32 m0, s44, 112704
    ds_read_b64_tr_b16 a[238:239], v3 offset:54432
    v_fma_mix_f32 v36, v104, v16, v20 op_sel:[0,0,0] op_sel_hi:[1,0,0]
    v_mfma_f32_16x16x32_bf16 v[168:171], a[212:215], v[92:95], v[168:171]
    s_mov_b32 s45, 1064960
    s_waitcnt lgkmcnt(9)
    buffer_load_dwordx4 v6, s[24:27], s45 offen lds
    v_fma_mix_f32 v37, v104, v17, v21 op_sel:[1,0,0] op_sel_hi:[1,0,0]
    v_mfma_f32_16x16x32_bf16 v[140:143], a[216:219], v[80:83], 0
    ds_read_b64_tr_b16 a[240:241], v3 offset:37056
    v_fma_mix_f32 v38, v105, v18, v22 op_sel:[0,0,0] op_sel_hi:[1,0,0]
    v_mfma_f32_16x16x32_bf16 v[140:143], a[220:223], v[84:87], v[140:143]
    ds_read_b64_tr_b16 a[242:243], v3 offset:37568
    ds_read_b64_tr_b16 a[244:245], v3 offset:53952
    v_fma_mix_f32 v39, v105, v19, v23 op_sel:[1,0,0] op_sel_hi:[1,0,0]
    v_mfma_f32_16x16x32_bf16 v[172:175], a[216:219], v[88:91], 0
    s_add_u32 m0, s44, 113760
    ds_read_b64_tr_b16 a[246:247], v3 offset:54464
    v_cvt_pk_bf16_f32 v104, v36, v37
    v_mfma_f32_16x16x32_bf16 v[172:175], a[220:223], v[92:95], v[172:175]
    s_mov_b32 s45, 1073152
    s_waitcnt lgkmcnt(8)
    buffer_load_dwordx4 v6, s[24:27], s45 offen lds
    v_cvt_pk_bf16_f32 v105, v38, v39
    v_mfma_f32_16x16x32_bf16 v[144:147], a[224:227], v[80:83], 0
    ds_read_b64_tr_b16 a[248:249], v3 offset:37088
    ds_read_b128 v[16:19], v9 offset:9984
    v_mfma_f32_16x16x32_bf16 v[144:147], a[228:231], v[84:87], v[144:147]
    ds_read_b64_tr_b16 a[250:251], v3 offset:37600
    ds_read_b64_tr_b16 a[252:253], v3 offset:53984
    v_fma_mix_f32 v32, v98, v24, v28 op_sel:[0,0,0] op_sel_hi:[1,0,0]
    v_mfma_f32_16x16x32_bf16 v[176:179], a[224:227], v[88:91], 0
    s_add_u32 m0, s44, 127488
    ds_read_b64_tr_b16 a[254:255], v3 offset:54496
    ds_read_b128 v[20:23], v9 offset:10016
    v_mfma_f32_16x16x32_bf16 v[176:179], a[228:231], v[92:95], v[176:179]
    s_mov_b32 s45, 1310720
    s_waitcnt lgkmcnt(10)
    buffer_load_dwordx4 v6, s[24:27], s45 offen lds
    v_mfma_f32_16x16x32_bf16 v[148:151], a[232:235], v[80:83], 0
    ds_read_b64_tr_b16 a[192:193], v3 offset:37120
    v_fma_mix_f32 v33, v98, v25, v29 op_sel:[1,0,0] op_sel_hi:[1,0,0]
    v_mfma_f32_16x16x32_bf16 v[148:151], a[236:239], v[84:87], v[148:151]
    ds_read_b64_tr_b16 a[194:195], v3 offset:37632
    ds_read_b64_tr_b16 a[196:197], v3 offset:54016
    v_fma_mix_f32 v34, v99, v26, v30 op_sel:[0,0,0] op_sel_hi:[1,0,0]
    v_mfma_f32_16x16x32_bf16 v[180:183], a[232:235], v[88:91], 0
    s_add_u32 m0, s44, 128544
    ds_read_b64_tr_b16 a[198:199], v3 offset:54528
    v_fma_mix_f32 v35, v99, v27, v31 op_sel:[1,0,0] op_sel_hi:[1,0,0]
    v_mfma_f32_16x16x32_bf16 v[180:183], a[236:239], v[92:95], v[180:183]
    s_mov_b32 s45, 1318912
    s_waitcnt lgkmcnt(10)
    buffer_load_dwordx4 v6, s[24:27], s45 offen lds
    v_mfma_f32_16x16x32_bf16 v[152:155], a[240:243], v[80:83], 0
    ds_read_b64_tr_b16 a[200:201], v3 offset:37152
    v_cvt_pk_bf16_f32 v98, v32, v33
    v_mfma_f32_16x16x32_bf16 v[152:155], a[244:247], v[84:87], v[152:155]
    ds_read_b64_tr_b16 a[202:203], v3 offset:37664
    ds_read_b64_tr_b16 a[204:205], v3 offset:54048
    v_cvt_pk_bf16_f32 v99, v34, v35
    v_mfma_f32_16x16x32_bf16 v[184:187], a[240:243], v[88:91], 0
    s_add_u32 m0, s44, 129600
    ds_read_b64_tr_b16 a[206:207], v3 offset:54560
    v_fma_mix_f32 v36, v106, v24, v28 op_sel:[0,0,0] op_sel_hi:[1,0,0]
    v_mfma_f32_16x16x32_bf16 v[184:187], a[244:247], v[92:95], v[184:187]
    s_mov_b32 s45, 1327104
    s_waitcnt lgkmcnt(9)
    buffer_load_dwordx4 v6, s[24:27], s45 offen lds
    v_fma_mix_f32 v37, v106, v25, v29 op_sel:[1,0,0] op_sel_hi:[1,0,0]
    v_mfma_f32_16x16x32_bf16 v[156:159], a[248:251], v[80:83], 0
    ds_read_b64_tr_b16 a[208:209], v3 offset:37184
    v_fma_mix_f32 v38, v107, v26, v30 op_sel:[0,0,0] op_sel_hi:[1,0,0]
    v_mfma_f32_16x16x32_bf16 v[156:159], a[252:255], v[84:87], v[156:159]
    ds_read_b64_tr_b16 a[210:211], v3 offset:37696
    ds_read_b64_tr_b16 a[212:213], v3 offset:54080
    v_fma_mix_f32 v39, v107, v27, v31 op_sel:[1,0,0] op_sel_hi:[1,0,0]
    v_mfma_f32_16x16x32_bf16 v[188:191], a[248:251], v[88:91], 0
    s_add_u32 m0, s44, 130656
    ds_read_b64_tr_b16 a[214:215], v3 offset:54592
    v_cvt_pk_bf16_f32 v106, v36, v37
    v_mfma_f32_16x16x32_bf16 v[188:191], a[252:255], v[92:95], v[188:191]
    s_mov_b32 s45, 1335296
    s_waitcnt lgkmcnt(8)
    buffer_load_dwordx4 v6, s[24:27], s45 offen lds
    v_cvt_pk_bf16_f32 v107, v38, v39
    v_mfma_f32_16x16x32_bf16 v[192:195], a[192:195], v[80:83], 0
    ds_read_b64_tr_b16 a[216:217], v3 offset:37216
    ds_read_b128 v[24:27], v9 offset:10000
    v_mfma_f32_16x16x32_bf16 v[192:195], a[196:199], v[84:87], v[192:195]
    ds_read_b64_tr_b16 a[218:219], v3 offset:37728
    ds_read_b64_tr_b16 a[220:221], v3 offset:54112
    v_fma_mix_f32 v32, v100, v16, v20 op_sel:[0,0,0] op_sel_hi:[1,0,0]
    v_mfma_f32_16x16x32_bf16 v[224:227], a[192:195], v[88:91], 0
    s_mov_b32 s54, 6144
    ds_read_b64_tr_b16 a[222:223], v3 offset:54624
    ds_read_b128 v[28:31], v9 offset:10032
    v_mfma_f32_16x16x32_bf16 v[224:227], a[196:199], v[92:95], v[224:227]
    s_waitcnt lgkmcnt(10)
    buffer_load_dwordx4 v[48:51], off, s[32:35], s54 sc1
    v_mfma_f32_16x16x32_bf16 v[196:199], a[200:203], v[80:83], 0
    ds_read_b64_tr_b16 a[224:225], v3 offset:37248
    v_fma_mix_f32 v33, v100, v17, v21 op_sel:[1,0,0] op_sel_hi:[1,0,0]
    v_mfma_f32_16x16x32_bf16 v[196:199], a[204:207], v[84:87], v[196:199]
    ds_read_b64_tr_b16 a[226:227], v3 offset:37760
    ds_read_b64_tr_b16 a[228:229], v3 offset:54144
    v_fma_mix_f32 v34, v101, v18, v22 op_sel:[0,0,0] op_sel_hi:[1,0,0]
    v_mfma_f32_16x16x32_bf16 v[228:231], a[200:203], v[88:91], 0
    s_mov_b32 s54, 7168
    ds_read_b64_tr_b16 a[230:231], v3 offset:54656
    v_fma_mix_f32 v35, v101, v19, v23 op_sel:[1,0,0] op_sel_hi:[1,0,0]
    v_mfma_f32_16x16x32_bf16 v[228:231], a[204:207], v[92:95], v[228:231]
    s_waitcnt lgkmcnt(10)
    buffer_load_dwordx4 v[52:55], off, s[32:35], s54 sc1
    v_mfma_f32_16x16x32_bf16 v[200:203], a[208:211], v[80:83], 0
    ds_read_b64_tr_b16 a[232:233], v3 offset:37280
    v_cvt_pk_bf16_f32 v100, v32, v33
    v_mfma_f32_16x16x32_bf16 v[200:203], a[212:215], v[84:87], v[200:203]
    ds_read_b64_tr_b16 a[234:235], v3 offset:37792
    ds_read_b64_tr_b16 a[236:237], v3 offset:54176
    v_cvt_pk_bf16_f32 v101, v34, v35
    v_mfma_f32_16x16x32_bf16 v[232:235], a[208:211], v[88:91], 0
    s_mov_b32 s54, 24576
    ds_read_b64_tr_b16 a[238:239], v3 offset:54688
    v_fma_mix_f32 v36, v108, v16, v20 op_sel:[0,0,0] op_sel_hi:[1,0,0]
    v_mfma_f32_16x16x32_bf16 v[232:235], a[212:215], v[92:95], v[232:235]
    s_waitcnt lgkmcnt(9)
    buffer_load_dwordx4 v[56:59], off, s[32:35], s54 sc1
    v_fma_mix_f32 v37, v108, v17, v21 op_sel:[1,0,0] op_sel_hi:[1,0,0]
    v_mfma_f32_16x16x32_bf16 v[204:207], a[216:219], v[80:83], 0
    ds_read_b64_tr_b16 a[240:241], v3 offset:37312
    v_fma_mix_f32 v38, v109, v18, v22 op_sel:[0,0,0] op_sel_hi:[1,0,0]
    v_mfma_f32_16x16x32_bf16 v[204:207], a[220:223], v[84:87], v[204:207]
    ds_read_b64_tr_b16 a[242:243], v3 offset:37824
    ds_read_b64_tr_b16 a[244:245], v3 offset:54208
    v_fma_mix_f32 v39, v109, v19, v23 op_sel:[1,0,0] op_sel_hi:[1,0,0]
    v_mfma_f32_16x16x32_bf16 v[236:239], a[216:219], v[88:91], 0
    s_mov_b32 s54, 25600
    ds_read_b64_tr_b16 a[246:247], v3 offset:54720
    v_cvt_pk_bf16_f32 v108, v36, v37
    v_mfma_f32_16x16x32_bf16 v[236:239], a[220:223], v[92:95], v[236:239]
    s_waitcnt lgkmcnt(8)
    buffer_load_dwordx4 v[60:63], off, s[32:35], s54 sc1
    v_cvt_pk_bf16_f32 v109, v38, v39
    v_mfma_f32_16x16x32_bf16 v[208:211], a[224:227], v[80:83], 0
    ds_read_b64_tr_b16 a[248:249], v3 offset:37344
    ds_read_b128 v[16:19], v9 offset:10240
    v_mfma_f32_16x16x32_bf16 v[208:211], a[228:231], v[84:87], v[208:211]
    ds_read_b64_tr_b16 a[250:251], v3 offset:37856
    ds_read_b128 v[20:23], v9 offset:10272
    v_mfma_f32_16x16x32_bf16 v[240:243], a[224:227], v[88:91], 0
    ds_read_b64_tr_b16 a[252:253], v3 offset:54240
    v_fma_mix_f32 v32, v102, v24, v28 op_sel:[0,0,0] op_sel_hi:[1,0,0]
    v_mfma_f32_16x16x32_bf16 v[240:243], a[228:231], v[92:95], v[240:243]
    s_barrier
    s_waitcnt lgkmcnt(9)
    ds_read_b64_tr_b16 a[254:255], v3 offset:54752
    v_fma_mix_f32 v33, v102, v25, v29 op_sel:[1,0,0] op_sel_hi:[1,0,0]
    v_fma_mix_f32 v34, v103, v26, v30 op_sel:[0,0,0] op_sel_hi:[1,0,0]
    v_mfma_f32_16x16x32_bf16 v[212:215], a[232:235], v[80:83], 0
    ds_read_b64_tr_b16 a[192:193], v4 offset:0
    v_fma_mix_f32 v35, v103, v27, v31 op_sel:[1,0,0] op_sel_hi:[1,0,0]
    v_mfma_f32_16x16x32_bf16 v[212:215], a[236:239], v[84:87], v[212:215]
    ds_read_b64_tr_b16 a[194:195], v4 offset:512
    ds_read_b64_tr_b16 a[196:197], v4 offset:16896
    v_cvt_pk_bf16_f32 v102, v32, v33
    v_mfma_f32_16x16x32_bf16 v[244:247], a[232:235], v[88:91], 0
    s_add_u32 m0, s44, 0
    ds_read_b64_tr_b16 a[198:199], v4 offset:17408
    v_cvt_pk_bf16_f32 v103, v34, v35
    v_mfma_f32_16x16x32_bf16 v[244:247], a[236:239], v[92:95], v[244:247]
    s_mov_b32 s45, 1572864
    s_waitcnt lgkmcnt(10)
    buffer_load_dwordx4 v6, s[24:27], s45 offen lds
    v_mfma_f32_16x16x32_bf16 v[216:219], a[240:243], v[80:83], 0
    ds_read_b64_tr_b16 a[200:201], v4 offset:32
    v_fma_mix_f32 v36, v110, v24, v28 op_sel:[0,0,0] op_sel_hi:[1,0,0]
    v_mfma_f32_16x16x32_bf16 v[216:219], a[244:247], v[84:87], v[216:219]
    ds_read_b64_tr_b16 a[202:203], v4 offset:544
    ds_read_b64_tr_b16 a[204:205], v4 offset:16928
    v_fma_mix_f32 v37, v110, v25, v29 op_sel:[1,0,0] op_sel_hi:[1,0,0]
    v_mfma_f32_16x16x32_bf16 v[248:251], a[240:243], v[88:91], 0
    s_add_u32 m0, s44, 1056
    ds_read_b64_tr_b16 a[206:207], v4 offset:17440
    v_fma_mix_f32 v38, v111, v26, v30 op_sel:[0,0,0] op_sel_hi:[1,0,0]
    v_mfma_f32_16x16x32_bf16 v[248:251], a[244:247], v[92:95], v[248:251]
    s_mov_b32 s45, 1581056
    s_waitcnt lgkmcnt(8)
    buffer_load_dwordx4 v6, s[24:27], s45 offen lds
    v_mfma_f32_16x16x32_bf16 v[220:223], a[248:251], v[80:83], 0
    ds_read_b64_tr_b16 a[208:209], v4 offset:64
    v_fma_mix_f32 v39, v111, v27, v31 op_sel:[1,0,0] op_sel_hi:[1,0,0]
    v_mfma_f32_16x16x32_bf16 v[220:223], a[252:255], v[84:87], v[220:223]
    ds_read_b64_tr_b16 a[210:211], v4 offset:576
    ds_read_b64_tr_b16 a[212:213], v4 offset:16960
    v_cvt_pk_bf16_f32 v110, v36, v37
    v_mfma_f32_16x16x32_bf16 v[252:255], a[248:251], v[88:91], 0
    s_add_u32 m0, s44, 2112
    ds_read_b64_tr_b16 a[214:215], v4 offset:17472
    v_cvt_pk_bf16_f32 v111, v38, v39
    v_mfma_f32_16x16x32_bf16 v[252:255], a[252:255], v[92:95], v[252:255]
    s_mov_b32 s45, 1589248
    s_waitcnt lgkmcnt(8)
    buffer_load_dwordx4 v6, s[24:27], s45 offen lds
    v_mfma_f32_16x16x32_bf16 v[128:131], a[192:195], v[96:99], v[128:131]
    s_waitcnt vmcnt(15)
    ds_read_b64_tr_b16 a[216:217], v4 offset:96
    ds_read_b128 v[24:27], v9 offset:10256
    v_mfma_f32_16x16x32_bf16 v[128:131], a[196:199], v[100:103], v[128:131]
    ds_read_b64_tr_b16 a[218:219], v4 offset:608
    ds_read_b64_tr_b16 a[220:221], v4 offset:16992
    v_fma_mix_f32 v32, v112, v16, v20 op_sel:[0,0,0] op_sel_hi:[1,0,0]
    v_mfma_f32_16x16x32_bf16 v[160:163], a[192:195], v[104:107], v[160:163]
    s_add_u32 m0, s44, 3168
    ds_read_b64_tr_b16 a[222:223], v4 offset:17504
    ds_read_b128 v[28:31], v9 offset:10288
    v_mfma_f32_16x16x32_bf16 v[160:163], a[196:199], v[108:111], v[160:163]
    s_mov_b32 s45, 1597440
    s_waitcnt lgkmcnt(10)
    buffer_load_dwordx4 v6, s[24:27], s45 offen lds
    v_mfma_f32_16x16x32_bf16 v[132:135], a[200:203], v[96:99], v[132:135]
    ds_read_b64_tr_b16 a[224:225], v4 offset:128
    v_fma_mix_f32 v33, v112, v17, v21 op_sel:[1,0,0] op_sel_hi:[1,0,0]
    v_mfma_f32_16x16x32_bf16 v[132:135], a[204:207], v[100:103], v[132:135]
    ds_read_b64_tr_b16 a[226:227], v4 offset:640
    ds_read_b64_tr_b16 a[228:229], v4 offset:17024
    v_fma_mix_f32 v34, v113, v18, v22 op_sel:[0,0,0] op_sel_hi:[1,0,0]
    v_mfma_f32_16x16x32_bf16 v[164:167], a[200:203], v[104:107], v[164:167]
    s_add_u32 m0, s44, 16896
    ds_read_b64_tr_b16 a[230:231], v4 offset:17536
    v_fma_mix_f32 v35, v113, v19, v23 op_sel:[1,0,0] op_sel_hi:[1,0,0]
    v_mfma_f32_16x16x32_bf16 v[164:167], a[204:207], v[108:111], v[164:167]
    s_mov_b32 s45, 1835008
    s_waitcnt lgkmcnt(10)
    buffer_load_dwordx4 v6, s[24:27], s45 offen lds
    v_mfma_f32_16x16x32_bf16 v[136:139], a[208:211], v[96:99], v[136:139]
    ds_read_b64_tr_b16 a[232:233], v4 offset:160
    v_cvt_pk_bf16_f32 v112, v32, v33
    v_mfma_f32_16x16x32_bf16 v[136:139], a[212:215], v[100:103], v[136:139]
    ds_read_b64_tr_b16 a[234:235], v4 offset:672
    ds_read_b64_tr_b16 a[236:237], v4 offset:17056
    v_cvt_pk_bf16_f32 v113, v34, v35
    v_mfma_f32_16x16x32_bf16 v[168:171], a[208:211], v[104:107], v[168:171]
    s_add_u32 m0, s44, 17952
    ds_read_b64_tr_b16 a[238:239], v4 offset:17568
    v_fma_mix_f32 v36, v120, v16, v20 op_sel:[0,0,0] op_sel_hi:[1,0,0]
    v_mfma_f32_16x16x32_bf16 v[168:171], a[212:215], v[108:111], v[168:171]
    s_mov_b32 s45, 1843200
    s_waitcnt lgkmcnt(9)
    buffer_load_dwordx4 v6, s[24:27], s45 offen lds
    v_fma_mix_f32 v37, v120, v17, v21 op_sel:[1,0,0] op_sel_hi:[1,0,0]
    v_mfma_f32_16x16x32_bf16 v[140:143], a[216:219], v[96:99], v[140:143]
    ds_read_b64_tr_b16 a[240:241], v4 offset:192
    v_fma_mix_f32 v38, v121, v18, v22 op_sel:[0,0,0] op_sel_hi:[1,0,0]
    v_mfma_f32_16x16x32_bf16 v[140:143], a[220:223], v[100:103], v[140:143]
    ds_read_b64_tr_b16 a[242:243], v4 offset:704
    ds_read_b64_tr_b16 a[244:245], v4 offset:17088
    v_fma_mix_f32 v39, v121, v19, v23 op_sel:[1,0,0] op_sel_hi:[1,0,0]
    v_mfma_f32_16x16x32_bf16 v[172:175], a[216:219], v[104:107], v[172:175]
    s_add_u32 m0, s44, 19008
    ds_read_b64_tr_b16 a[246:247], v4 offset:17600
    v_cvt_pk_bf16_f32 v120, v36, v37
    v_mfma_f32_16x16x32_bf16 v[172:175], a[220:223], v[108:111], v[172:175]
    s_mov_b32 s45, 1851392
    s_waitcnt lgkmcnt(8)
    buffer_load_dwordx4 v6, s[24:27], s45 offen lds
    v_cvt_pk_bf16_f32 v121, v38, v39
    v_mfma_f32_16x16x32_bf16 v[144:147], a[224:227], v[96:99], v[144:147]
    ds_read_b64_tr_b16 a[248:249], v4 offset:224
    ds_read_b128 v[16:19], v9 offset:10496
    v_mfma_f32_16x16x32_bf16 v[144:147], a[228:231], v[100:103], v[144:147]
    ds_read_b64_tr_b16 a[250:251], v4 offset:736
    ds_read_b64_tr_b16 a[252:253], v4 offset:17120
    v_mfma_f32_16x16x32_bf16 v[176:179], a[224:227], v[104:107], v[176:179]
    s_add_u32 m0, s44, 20064
    ds_read_b64_tr_b16 a[254:255], v4 offset:17632
    ds_read_b128 v[20:23], v9 offset:10528
    v_mfma_f32_16x16x32_bf16 v[176:179], a[228:231], v[108:111], v[176:179]
    s_mov_b32 s45, 1859584
    s_waitcnt lgkmcnt(10)
    buffer_load_dwordx4 v6, s[24:27], s45 offen lds
    v_mfma_f32_16x16x32_bf16 v[148:151], a[232:235], v[96:99], v[148:151]
    ds_read_b64_tr_b16 a[192:193], v4 offset:256
    v_fma_mix_f32 v32, v114, v24, v28 op_sel:[0,0,0] op_sel_hi:[1,0,0]
    v_mfma_f32_16x16x32_bf16 v[148:151], a[236:239], v[100:103], v[148:151]
    ds_read_b64_tr_b16 a[194:195], v4 offset:768
    v_fma_mix_f32 v33, v114, v25, v29 op_sel:[1,0,0] op_sel_hi:[1,0,0]
    v_mfma_f32_16x16x32_bf16 v[180:183], a[232:235], v[104:107], v[180:183]
    ds_read_b64_tr_b16 a[196:197], v4 offset:17152
    v_fma_mix_f32 v34, v115, v26, v30 op_sel:[0,0,0] op_sel_hi:[1,0,0]
    v_mfma_f32_16x16x32_bf16 v[180:183], a[236:239], v[108:111], v[180:183]
    s_waitcnt lgkmcnt(9)
    ds_read_b64_tr_b16 a[198:199], v4 offset:17664
    v_fma_mix_f32 v35, v115, v27, v31 op_sel:[1,0,0] op_sel_hi:[1,0,0]
    v_mfma_f32_16x16x32_bf16 v[152:155], a[240:243], v[96:99], v[152:155]
    ds_read_b64_tr_b16 a[200:201], v4 offset:288
    v_cvt_pk_bf16_f32 v114, v32, v33
    v_mfma_f32_16x16x32_bf16 v[152:155], a[244:247], v[100:103], v[152:155]
    ds_read_b64_tr_b16 a[202:203], v4 offset:800
    v_cvt_pk_bf16_f32 v115, v34, v35
    v_mfma_f32_16x16x32_bf16 v[184:187], a[240:243], v[104:107], v[184:187]
    ds_read_b64_tr_b16 a[204:205], v4 offset:17184
    v_fma_mix_f32 v36, v122, v24, v28 op_sel:[0,0,0] op_sel_hi:[1,0,0]
    v_mfma_f32_16x16x32_bf16 v[184:187], a[244:247], v[108:111], v[184:187]
    s_waitcnt lgkmcnt(8)
    ds_read_b64_tr_b16 a[206:207], v4 offset:17696
    v_fma_mix_f32 v37, v122, v25, v29 op_sel:[1,0,0] op_sel_hi:[1,0,0]
    v_mfma_f32_16x16x32_bf16 v[156:159], a[248:251], v[96:99], v[156:159]
    ds_read_b64_tr_b16 a[208:209], v4 offset:320
    v_fma_mix_f32 v38, v123, v26, v30 op_sel:[0,0,0] op_sel_hi:[1,0,0]
    v_mfma_f32_16x16x32_bf16 v[156:159], a[252:255], v[100:103], v[156:159]
    ds_read_b64_tr_b16 a[210:211], v4 offset:832
    v_fma_mix_f32 v39, v123, v27, v31 op_sel:[1,0,0] op_sel_hi:[1,0,0]
    v_mfma_f32_16x16x32_bf16 v[188:191], a[248:251], v[104:107], v[188:191]
    ds_read_b64_tr_b16 a[212:213], v4 offset:17216
    v_cvt_pk_bf16_f32 v122, v36, v37
    v_mfma_f32_16x16x32_bf16 v[188:191], a[252:255], v[108:111], v[188:191]
    s_waitcnt lgkmcnt(7)
    ds_read_b64_tr_b16 a[214:215], v4 offset:17728
    v_cvt_pk_bf16_f32 v123, v38, v39
    v_mfma_f32_16x16x32_bf16 v[192:195], a[192:195], v[96:99], v[192:195]
    ds_read_b64_tr_b16 a[216:217], v4 offset:352
    ds_read_b128 v[24:27], v9 offset:10512
    v_mfma_f32_16x16x32_bf16 v[192:195], a[196:199], v[100:103], v[192:195]
    ds_read_b64_tr_b16 a[218:219], v4 offset:864
    ds_read_b64_tr_b16 a[220:221], v4 offset:17248
    v_fma_mix_f32 v32, v116, v16, v20 op_sel:[0,0,0] op_sel_hi:[1,0,0]
    v_mfma_f32_16x16x32_bf16 v[224:227], a[192:195], v[104:107], v[224:227]
    s_mov_b32 s54, 8192
    ds_read_b64_tr_b16 a[222:223], v4 offset:17760
    ds_read_b128 v[28:31], v9 offset:10544
    v_mfma_f32_16x16x32_bf16 v[224:227], a[196:199], v[108:111], v[224:227]
    s_waitcnt lgkmcnt(10)
    buffer_load_dwordx4 v[64:67], off, s[32:35], s54 sc1
    v_mfma_f32_16x16x32_bf16 v[196:199], a[200:203], v[96:99], v[196:199]
    ds_read_b64_tr_b16 a[224:225], v4 offset:384
    v_fma_mix_f32 v33, v116, v17, v21 op_sel:[1,0,0] op_sel_hi:[1,0,0]
    v_mfma_f32_16x16x32_bf16 v[196:199], a[204:207], v[100:103], v[196:199]
    ds_read_b64_tr_b16 a[226:227], v4 offset:896
    ds_read_b64_tr_b16 a[228:229], v4 offset:17280
    v_fma_mix_f32 v34, v117, v18, v22 op_sel:[0,0,0] op_sel_hi:[1,0,0]
    v_mfma_f32_16x16x32_bf16 v[228:231], a[200:203], v[104:107], v[228:231]
    s_mov_b32 s54, 9216
    ds_read_b64_tr_b16 a[230:231], v4 offset:17792
    v_fma_mix_f32 v35, v117, v19, v23 op_sel:[1,0,0] op_sel_hi:[1,0,0]
    v_mfma_f32_16x16x32_bf16 v[228:231], a[204:207], v[108:111], v[228:231]
    s_waitcnt lgkmcnt(10)
    buffer_load_dwordx4 v[68:71], off, s[32:35], s54 sc1
    v_mfma_f32_16x16x32_bf16 v[200:203], a[208:211], v[96:99], v[200:203]
    ds_read_b64_tr_b16 a[232:233], v4 offset:416
    v_cvt_pk_bf16_f32 v116, v32, v33
    v_mfma_f32_16x16x32_bf16 v[200:203], a[212:215], v[100:103], v[200:203]
    ds_read_b64_tr_b16 a[234:235], v4 offset:928
    ds_read_b64_tr_b16 a[236:237], v4 offset:17312
    v_cvt_pk_bf16_f32 v117, v34, v35
    v_mfma_f32_16x16x32_bf16 v[232:235], a[208:211], v[104:107], v[232:235]
    s_mov_b32 s54, 26624
    ds_read_b64_tr_b16 a[238:239], v4 offset:17824
    v_fma_mix_f32 v36, v124, v16, v20 op_sel:[0,0,0] op_sel_hi:[1,0,0]
    v_mfma_f32_16x16x32_bf16 v[232:235], a[212:215], v[108:111], v[232:235]
    s_waitcnt lgkmcnt(9)
    buffer_load_dwordx4 v[72:75], off, s[32:35], s54 sc1
    v_fma_mix_f32 v37, v124, v17, v21 op_sel:[1,0,0] op_sel_hi:[1,0,0]
L2_pad0:
    s_cbranch_execz L2_pad4
    v_mfma_f32_16x16x32_bf16 v[204:207], a[216:219], v[96:99], v[204:207]
    ds_read_b64_tr_b16 a[240:241], v4 offset:448
    v_fma_mix_f32 v38, v125, v18, v22 op_sel:[0,0,0] op_sel_hi:[1,0,0]
    v_mfma_f32_16x16x32_bf16 v[204:207], a[220:223], v[100:103], v[204:207]
    ds_read_b64_tr_b16 a[242:243], v4 offset:960
    ds_read_b64_tr_b16 a[244:245], v4 offset:17344
    v_fma_mix_f32 v39, v125, v19, v23 op_sel:[1,0,0] op_sel_hi:[1,0,0]
    v_mfma_f32_16x16x32_bf16 v[236:239], a[216:219], v[104:107], v[236:239]
    s_mov_b32 s54, 27648
    ds_read_b64_tr_b16 a[246:247], v4 offset:17856
    v_cvt_pk_bf16_f32 v124, v36, v37
    v_mfma_f32_16x16x32_bf16 v[236:239], a[220:223], v[108:111], v[236:239]
    s_waitcnt lgkmcnt(8)
    buffer_load_dwordx4 v[76:79], off, s[32:35], s54 sc1
    v_cvt_pk_bf16_f32 v125, v38, v39
    v_mfma_f32_16x16x32_bf16 v[208:211], a[224:227], v[96:99], v[208:211]
    ds_read_b64_tr_b16 a[248:249], v4 offset:480
    ds_read_b128 v[16:19], v9 offset:10752
    v_mfma_f32_16x16x32_bf16 v[208:211], a[228:231], v[100:103], v[208:211]
    ds_read_b64_tr_b16 a[250:251], v4 offset:992
    ds_read_b128 v[20:23], v9 offset:10784
    v_mfma_f32_16x16x32_bf16 v[240:243], a[224:227], v[104:107], v[240:243]
    ds_read_b64_tr_b16 a[252:253], v4 offset:17376
    v_fma_mix_f32 v32, v118, v24, v28 op_sel:[0,0,0] op_sel_hi:[1,0,0]
    v_mfma_f32_16x16x32_bf16 v[240:243], a[228:231], v[108:111], v[240:243]
    s_waitcnt vmcnt(16)
    s_barrier
    s_waitcnt lgkmcnt(9)
    ds_read_b64_tr_b16 a[254:255], v4 offset:17888
    v_fma_mix_f32 v33, v118, v25, v29 op_sel:[1,0,0] op_sel_hi:[1,0,0]
    v_fma_mix_f32 v34, v119, v26, v30 op_sel:[0,0,0] op_sel_hi:[1,0,0]
    v_mfma_f32_16x16x32_bf16 v[212:215], a[232:235], v[96:99], v[212:215]
    ds_read_b64_tr_b16 a[192:193], v4 offset:36864
    v_fma_mix_f32 v35, v119, v27, v31 op_sel:[1,0,0] op_sel_hi:[1,0,0]
    v_mfma_f32_16x16x32_bf16 v[212:215], a[236:239], v[100:103], v[212:215]
    ds_read_b64_tr_b16 a[194:195], v4 offset:37376
    ds_read_b64_tr_b16 a[196:197], v4 offset:53760
    v_cvt_pk_bf16_f32 v118, v32, v33
    v_mfma_f32_16x16x32_bf16 v[244:247], a[232:235], v[104:107], v[244:247]
    s_add_u32 m0, s44, 36864
    ds_read_b64_tr_b16 a[198:199], v4 offset:54272
    v_cvt_pk_bf16_f32 v119, v34, v35
    v_mfma_f32_16x16x32_bf16 v[244:247], a[236:239], v[108:111], v[244:247]
    s_mov_b32 s45, 2097152
    s_waitcnt lgkmcnt(10)
    buffer_load_dwordx4 v6, s[24:27], s45 offen lds
    v_mfma_f32_16x16x32_bf16 v[216:219], a[240:243], v[96:99], v[216:219]
    ds_read_b64_tr_b16 a[200:201], v4 offset:36896
    v_fma_mix_f32 v36, v126, v24, v28 op_sel:[0,0,0] op_sel_hi:[1,0,0]
    v_mfma_f32_16x16x32_bf16 v[216:219], a[244:247], v[100:103], v[216:219]
    ds_read_b64_tr_b16 a[202:203], v4 offset:37408
    ds_read_b64_tr_b16 a[204:205], v4 offset:53792
    v_fma_mix_f32 v37, v126, v25, v29 op_sel:[1,0,0] op_sel_hi:[1,0,0]
    v_mfma_f32_16x16x32_bf16 v[248:251], a[240:243], v[104:107], v[248:251]
    s_add_u32 m0, s44, 37920
    ds_read_b64_tr_b16 a[206:207], v4 offset:54304
    v_fma_mix_f32 v38, v127, v26, v30 op_sel:[0,0,0] op_sel_hi:[1,0,0]
    v_mfma_f32_16x16x32_bf16 v[248:251], a[244:247], v[108:111], v[248:251]
    s_mov_b32 s45, 2105344
    s_waitcnt lgkmcnt(8)
    buffer_load_dwordx4 v6, s[24:27], s45 offen lds
    v_mfma_f32_16x16x32_bf16 v[220:223], a[248:251], v[96:99], v[220:223]
    ds_read_b64_tr_b16 a[208:209], v4 offset:36928
    v_fma_mix_f32 v39, v127, v27, v31 op_sel:[1,0,0] op_sel_hi:[1,0,0]
    v_mfma_f32_16x16x32_bf16 v[220:223], a[252:255], v[100:103], v[220:223]
    ds_read_b64_tr_b16 a[210:211], v4 offset:37440
    ds_read_b64_tr_b16 a[212:213], v4 offset:53824
    v_cvt_pk_bf16_f32 v126, v36, v37
    v_mfma_f32_16x16x32_bf16 v[252:255], a[248:251], v[104:107], v[252:255]
    s_add_u32 m0, s44, 38976
    ds_read_b64_tr_b16 a[214:215], v4 offset:54336
    v_cvt_pk_bf16_f32 v127, v38, v39
    v_mfma_f32_16x16x32_bf16 v[252:255], a[252:255], v[108:111], v[252:255]
    s_mov_b32 s45, 2113536
    s_waitcnt lgkmcnt(8)
    buffer_load_dwordx4 v6, s[24:27], s45 offen lds
    v_mfma_f32_16x16x32_bf16 v[128:131], a[192:195], v[112:115], v[128:131]
    s_waitcnt vmcnt(15)
    ds_read_b64_tr_b16 a[216:217], v4 offset:36960
    ds_read_b128 v[24:27], v9 offset:10768
    v_mfma_f32_16x16x32_bf16 v[128:131], a[196:199], v[116:119], v[128:131]
    ds_read_b64_tr_b16 a[218:219], v4 offset:37472
    ds_read_b64_tr_b16 a[220:221], v4 offset:53856
    v_fma_mix_f32 v32, v48, v16, v20 op_sel:[0,0,0] op_sel_hi:[1,0,0]
    v_mfma_f32_16x16x32_bf16 v[160:163], a[192:195], v[120:123], v[160:163]
    s_add_u32 m0, s44, 40032
    ds_read_b64_tr_b16 a[222:223], v4 offset:54368
    ds_read_b128 v[28:31], v9 offset:10800
    v_mfma_f32_16x16x32_bf16 v[160:163], a[196:199], v[124:127], v[160:163]
    s_mov_b32 s45, 2121728
    s_waitcnt lgkmcnt(10)
    buffer_load_dwordx4 v6, s[24:27], s45 offen lds
    v_mfma_f32_16x16x32_bf16 v[132:135], a[200:203], v[112:115], v[132:135]
    ds_read_b64_tr_b16 a[224:225], v4 offset:36992
    v_fma_mix_f32 v33, v48, v17, v21 op_sel:[1,0,0] op_sel_hi:[1,0,0]
    v_mfma_f32_16x16x32_bf16 v[132:135], a[204:207], v[116:119], v[132:135]
    ds_read_b64_tr_b16 a[226:227], v4 offset:37504
    ds_read_b64_tr_b16 a[228:229], v4 offset:53888
    v_fma_mix_f32 v34, v49, v18, v22 op_sel:[0,0,0] op_sel_hi:[1,0,0]
    v_mfma_f32_16x16x32_bf16 v[164:167], a[200:203], v[120:123], v[164:167]
    s_add_u32 m0, s44, 53760
    ds_read_b64_tr_b16 a[230:231], v4 offset:54400
    v_fma_mix_f32 v35, v49, v19, v23 op_sel:[1,0,0] op_sel_hi:[1,0,0]
    v_mfma_f32_16x16x32_bf16 v[164:167], a[204:207], v[124:127], v[164:167]
    s_mov_b32 s45, 2359296
    s_waitcnt lgkmcnt(10)
    buffer_load_dwordx4 v6, s[24:27], s45 offen lds
    v_mfma_f32_16x16x32_bf16 v[136:139], a[208:211], v[112:115], v[136:139]
    ds_read_b64_tr_b16 a[232:233], v4 offset:37024
    v_cvt_pk_bf16_f32 v48, v32, v33
    v_mfma_f32_16x16x32_bf16 v[136:139], a[212:215], v[116:119], v[136:139]
    ds_read_b64_tr_b16 a[234:235], v4 offset:37536
    ds_read_b64_tr_b16 a[236:237], v4 offset:53920
    v_cvt_pk_bf16_f32 v49, v34, v35
    v_mfma_f32_16x16x32_bf16 v[168:171], a[208:211], v[120:123], v[168:171]
    s_add_u32 m0, s44, 54816
    ds_read_b64_tr_b16 a[238:239], v4 offset:54432
    v_fma_mix_f32 v36, v56, v16, v20 op_sel:[0,0,0] op_sel_hi:[1,0,0]
    v_mfma_f32_16x16x32_bf16 v[168:171], a[212:215], v[124:127], v[168:171]
    s_mov_b32 s45, 2367488
    s_waitcnt lgkmcnt(9)
    buffer_load_dwordx4 v6, s[24:27], s45 offen lds
    v_fma_mix_f32 v37, v56, v17, v21 op_sel:[1,0,0] op_sel_hi:[1,0,0]
    v_mfma_f32_16x16x32_bf16 v[140:143], a[216:219], v[112:115], v[140:143]
    ds_read_b64_tr_b16 a[240:241], v4 offset:37056
    v_fma_mix_f32 v38, v57, v18, v22 op_sel:[0,0,0] op_sel_hi:[1,0,0]
    v_mfma_f32_16x16x32_bf16 v[140:143], a[220:223], v[116:119], v[140:143]
    ds_read_b64_tr_b16 a[242:243], v4 offset:37568
    ds_read_b64_tr_b16 a[244:245], v4 offset:53952
    v_fma_mix_f32 v39, v57, v19, v23 op_sel:[1,0,0] op_sel_hi:[1,0,0]
    v_mfma_f32_16x16x32_bf16 v[172:175], a[216:219], v[120:123], v[172:175]
    s_add_u32 m0, s44, 55872
    ds_read_b64_tr_b16 a[246:247], v4 offset:54464
    v_cvt_pk_bf16_f32 v56, v36, v37
    v_mfma_f32_16x16x32_bf16 v[172:175], a[220:223], v[124:127], v[172:175]
    s_mov_b32 s45, 2375680
    s_waitcnt lgkmcnt(8)
    buffer_load_dwordx4 v6, s[24:27], s45 offen lds
    v_cvt_pk_bf16_f32 v57, v38, v39
    v_mfma_f32_16x16x32_bf16 v[144:147], a[224:227], v[112:115], v[144:147]
    ds_read_b64_tr_b16 a[248:249], v4 offset:37088
    ds_read_b128 v[16:19], v9 offset:11008
    v_mfma_f32_16x16x32_bf16 v[144:147], a[228:231], v[116:119], v[144:147]
    ds_read_b64_tr_b16 a[250:251], v4 offset:37600
    ds_read_b64_tr_b16 a[252:253], v4 offset:53984
    v_mfma_f32_16x16x32_bf16 v[176:179], a[224:227], v[120:123], v[176:179]
    s_add_u32 m0, s44, 56928
    ds_read_b64_tr_b16 a[254:255], v4 offset:54496
    ds_read_b128 v[20:23], v9 offset:11040
    v_mfma_f32_16x16x32_bf16 v[176:179], a[228:231], v[124:127], v[176:179]
    s_mov_b32 s45, 2383872
    s_waitcnt lgkmcnt(10)
    buffer_load_dwordx4 v6, s[24:27], s45 offen lds
    v_mfma_f32_16x16x32_bf16 v[148:151], a[232:235], v[112:115], v[148:151]
    ds_read_b64_tr_b16 a[192:193], v4 offset:37120
    v_fma_mix_f32 v32, v50, v24, v28 op_sel:[0,0,0] op_sel_hi:[1,0,0]
    v_mfma_f32_16x16x32_bf16 v[148:151], a[236:239], v[116:119], v[148:151]
    ds_read_b64_tr_b16 a[194:195], v4 offset:37632
    v_fma_mix_f32 v33, v50, v25, v29 op_sel:[1,0,0] op_sel_hi:[1,0,0]
    v_mfma_f32_16x16x32_bf16 v[180:183], a[232:235], v[120:123], v[180:183]
    ds_read_b64_tr_b16 a[196:197], v4 offset:54016
    v_fma_mix_f32 v34, v51, v26, v30 op_sel:[0,0,0] op_sel_hi:[1,0,0]
    v_mfma_f32_16x16x32_bf16 v[180:183], a[236:239], v[124:127], v[180:183]
    s_waitcnt lgkmcnt(9)
    ds_read_b64_tr_b16 a[198:199], v4 offset:54528
    v_fma_mix_f32 v35, v51, v27, v31 op_sel:[1,0,0] op_sel_hi:[1,0,0]
    v_mfma_f32_16x16x32_bf16 v[152:155], a[240:243], v[112:115], v[152:155]
    ds_read_b64_tr_b16 a[200:201], v4 offset:37152
    v_cvt_pk_bf16_f32 v50, v32, v33
    v_mfma_f32_16x16x32_bf16 v[152:155], a[244:247], v[116:119], v[152:155]
    ds_read_b64_tr_b16 a[202:203], v4 offset:37664
    v_cvt_pk_bf16_f32 v51, v34, v35
    v_mfma_f32_16x16x32_bf16 v[184:187], a[240:243], v[120:123], v[184:187]
    ds_read_b64_tr_b16 a[204:205], v4 offset:54048
    v_fma_mix_f32 v36, v58, v24, v28 op_sel:[0,0,0] op_sel_hi:[1,0,0]
    v_mfma_f32_16x16x32_bf16 v[184:187], a[244:247], v[124:127], v[184:187]
    s_waitcnt lgkmcnt(8)
    ds_read_b64_tr_b16 a[206:207], v4 offset:54560
    v_fma_mix_f32 v37, v58, v25, v29 op_sel:[1,0,0] op_sel_hi:[1,0,0]
    v_mfma_f32_16x16x32_bf16 v[156:159], a[248:251], v[112:115], v[156:159]
    ds_read_b64_tr_b16 a[208:209], v4 offset:37184
    v_fma_mix_f32 v38, v59, v26, v30 op_sel:[0,0,0] op_sel_hi:[1,0,0]
    v_mfma_f32_16x16x32_bf16 v[156:159], a[252:255], v[116:119], v[156:159]
    ds_read_b64_tr_b16 a[210:211], v4 offset:37696
    v_fma_mix_f32 v39, v59, v27, v31 op_sel:[1,0,0] op_sel_hi:[1,0,0]
    v_mfma_f32_16x16x32_bf16 v[188:191], a[248:251], v[120:123], v[188:191]
    ds_read_b64_tr_b16 a[212:213], v4 offset:54080
    v_cvt_pk_bf16_f32 v58, v36, v37
    v_mfma_f32_16x16x32_bf16 v[188:191], a[252:255], v[124:127], v[188:191]
    s_waitcnt lgkmcnt(7)
    ds_read_b64_tr_b16 a[214:215], v4 offset:54592
    v_cvt_pk_bf16_f32 v59, v38, v39
    v_mfma_f32_16x16x32_bf16 v[192:195], a[192:195], v[112:115], v[192:195]
    ds_read_b64_tr_b16 a[216:217], v4 offset:37216
    ds_read_b128 v[24:27], v9 offset:11024
    v_mfma_f32_16x16x32_bf16 v[192:195], a[196:199], v[116:119], v[192:195]
    ds_read_b64_tr_b16 a[218:219], v4 offset:37728
    ds_read_b64_tr_b16 a[220:221], v4 offset:54112
    v_fma_mix_f32 v32, v52, v16, v20 op_sel:[0,0,0] op_sel_hi:[1,0,0]
    v_mfma_f32_16x16x32_bf16 v[224:227], a[192:195], v[120:123], v[224:227]
    s_mov_b32 s54, 10240
    ds_read_b64_tr_b16 a[222:223], v4 offset:54624
    ds_read_b128 v[28:31], v9 offset:11056
    v_mfma_f32_16x16x32_bf16 v[224:227], a[196:199], v[124:127], v[224:227]
    s_waitcnt lgkmcnt(10)
    buffer_load_dwordx4 v[80:83], off, s[32:35], s54 sc1
    v_mfma_f32_16x16x32_bf16 v[196:199], a[200:203], v[112:115], v[196:199]
    ds_read_b64_tr_b16 a[224:225], v4 offset:37248
    v_fma_mix_f32 v33, v52, v17, v21 op_sel:[1,0,0] op_sel_hi:[1,0,0]
    v_mfma_f32_16x16x32_bf16 v[196:199], a[204:207], v[116:119], v[196:199]
    ds_read_b64_tr_b16 a[226:227], v4 offset:37760
    ds_read_b64_tr_b16 a[228:229], v4 offset:54144
    v_fma_mix_f32 v34, v53, v18, v22 op_sel:[0,0,0] op_sel_hi:[1,0,0]
    v_mfma_f32_16x16x32_bf16 v[228:231], a[200:203], v[120:123], v[228:231]
    s_mov_b32 s54, 11264
    ds_read_b64_tr_b16 a[230:231], v4 offset:54656
    v_fma_mix_f32 v35, v53, v19, v23 op_sel:[1,0,0] op_sel_hi:[1,0,0]
    v_mfma_f32_16x16x32_bf16 v[228:231], a[204:207], v[124:127], v[228:231]
    s_waitcnt lgkmcnt(10)
    buffer_load_dwordx4 v[84:87], off, s[32:35], s54 sc1
    v_mfma_f32_16x16x32_bf16 v[200:203], a[208:211], v[112:115], v[200:203]
    ds_read_b64_tr_b16 a[232:233], v4 offset:37280
    v_cvt_pk_bf16_f32 v52, v32, v33
    v_mfma_f32_16x16x32_bf16 v[200:203], a[212:215], v[116:119], v[200:203]
    ds_read_b64_tr_b16 a[234:235], v4 offset:37792
    ds_read_b64_tr_b16 a[236:237], v4 offset:54176
    v_cvt_pk_bf16_f32 v53, v34, v35
    v_mfma_f32_16x16x32_bf16 v[232:235], a[208:211], v[120:123], v[232:235]
    s_mov_b32 s54, 28672
    ds_read_b64_tr_b16 a[238:239], v4 offset:54688
    v_fma_mix_f32 v36, v60, v16, v20 op_sel:[0,0,0] op_sel_hi:[1,0,0]
    v_mfma_f32_16x16x32_bf16 v[232:235], a[212:215], v[124:127], v[232:235]
    s_waitcnt lgkmcnt(9)
    buffer_load_dwordx4 v[88:91], off, s[32:35], s54 sc1
    v_fma_mix_f32 v37, v60, v17, v21 op_sel:[1,0,0] op_sel_hi:[1,0,0]
    v_mfma_f32_16x16x32_bf16 v[204:207], a[216:219], v[112:115], v[204:207]
    ds_read_b64_tr_b16 a[240:241], v4 offset:37312
    v_fma_mix_f32 v38, v61, v18, v22 op_sel:[0,0,0] op_sel_hi:[1,0,0]
    v_mfma_f32_16x16x32_bf16 v[204:207], a[220:223], v[116:119], v[204:207]
    ds_read_b64_tr_b16 a[242:243], v4 offset:37824
    ds_read_b64_tr_b16 a[244:245], v4 offset:54208
    v_fma_mix_f32 v39, v61, v19, v23 op_sel:[1,0,0] op_sel_hi:[1,0,0]
    v_mfma_f32_16x16x32_bf16 v[236:239], a[216:219], v[120:123], v[236:239]
    s_mov_b32 s54, 29696
    ds_read_b64_tr_b16 a[246:247], v4 offset:54720
    v_cvt_pk_bf16_f32 v60, v36, v37
    v_mfma_f32_16x16x32_bf16 v[236:239], a[220:223], v[124:127], v[236:239]
    s_waitcnt lgkmcnt(8)
    buffer_load_dwordx4 v[92:95], off, s[32:35], s54 sc1
    v_cvt_pk_bf16_f32 v61, v38, v39
    v_mfma_f32_16x16x32_bf16 v[208:211], a[224:227], v[112:115], v[208:211]
    ds_read_b64_tr_b16 a[248:249], v4 offset:37344
    ds_read_b128 v[16:19], v9 offset:11264
    v_mfma_f32_16x16x32_bf16 v[208:211], a[228:231], v[116:119], v[208:211]
    ds_read_b64_tr_b16 a[250:251], v4 offset:37856
    ds_read_b128 v[20:23], v9 offset:11296
    v_mfma_f32_16x16x32_bf16 v[240:243], a[224:227], v[120:123], v[240:243]
    ds_read_b64_tr_b16 a[252:253], v4 offset:54240
    v_fma_mix_f32 v32, v54, v24, v28 op_sel:[0,0,0] op_sel_hi:[1,0,0]
    v_mfma_f32_16x16x32_bf16 v[240:243], a[228:231], v[124:127], v[240:243]
    s_waitcnt vmcnt(16)
    s_barrier
    s_waitcnt lgkmcnt(9)
    ds_read_b64_tr_b16 a[254:255], v4 offset:54752
    v_fma_mix_f32 v33, v54, v25, v29 op_sel:[1,0,0] op_sel_hi:[1,0,0]
    v_fma_mix_f32 v34, v55, v26, v30 op_sel:[0,0,0] op_sel_hi:[1,0,0]
    v_mfma_f32_16x16x32_bf16 v[212:215], a[232:235], v[112:115], v[212:215]
    ds_read_b64_tr_b16 a[192:193], v3 offset:0
    v_fma_mix_f32 v35, v55, v27, v31 op_sel:[1,0,0] op_sel_hi:[1,0,0]
    v_mfma_f32_16x16x32_bf16 v[212:215], a[236:239], v[116:119], v[212:215]
    ds_read_b64_tr_b16 a[194:195], v3 offset:512
    ds_read_b64_tr_b16 a[196:197], v3 offset:16896
    v_cvt_pk_bf16_f32 v54, v32, v33
    v_mfma_f32_16x16x32_bf16 v[244:247], a[232:235], v[120:123], v[244:247]
    s_add_u32 m0, s44, 73728
    ds_read_b64_tr_b16 a[198:199], v3 offset:17408
    v_cvt_pk_bf16_f32 v55, v34, v35
    v_mfma_f32_16x16x32_bf16 v[244:247], a[236:239], v[124:127], v[244:247]
    s_mov_b32 s45, 2621440
    s_waitcnt lgkmcnt(10)
    buffer_load_dwordx4 v6, s[24:27], s45 offen lds
    v_mfma_f32_16x16x32_bf16 v[216:219], a[240:243], v[112:115], v[216:219]
    ds_read_b64_tr_b16 a[200:201], v3 offset:32
    v_fma_mix_f32 v36, v62, v24, v28 op_sel:[0,0,0] op_sel_hi:[1,0,0]
    v_mfma_f32_16x16x32_bf16 v[216:219], a[244:247], v[116:119], v[216:219]
    ds_read_b64_tr_b16 a[202:203], v3 offset:544
    ds_read_b64_tr_b16 a[204:205], v3 offset:16928
    v_fma_mix_f32 v37, v62, v25, v29 op_sel:[1,0,0] op_sel_hi:[1,0,0]
    v_mfma_f32_16x16x32_bf16 v[248:251], a[240:243], v[120:123], v[248:251]
    s_add_u32 m0, s44, 74784
    ds_read_b64_tr_b16 a[206:207], v3 offset:17440
    v_fma_mix_f32 v38, v63, v26, v30 op_sel:[0,0,0] op_sel_hi:[1,0,0]
    v_mfma_f32_16x16x32_bf16 v[248:251], a[244:247], v[124:127], v[248:251]
    s_mov_b32 s45, 2629632
    s_waitcnt lgkmcnt(8)
    buffer_load_dwordx4 v6, s[24:27], s45 offen lds
    v_mfma_f32_16x16x32_bf16 v[220:223], a[248:251], v[112:115], v[220:223]
    ds_read_b64_tr_b16 a[208:209], v3 offset:64
    v_fma_mix_f32 v39, v63, v27, v31 op_sel:[1,0,0] op_sel_hi:[1,0,0]
    v_mfma_f32_16x16x32_bf16 v[220:223], a[252:255], v[116:119], v[220:223]
    ds_read_b64_tr_b16 a[210:211], v3 offset:576
    ds_read_b64_tr_b16 a[212:213], v3 offset:16960
    v_cvt_pk_bf16_f32 v62, v36, v37
    v_mfma_f32_16x16x32_bf16 v[252:255], a[248:251], v[120:123], v[252:255]
    s_add_u32 m0, s44, 75840
    ds_read_b64_tr_b16 a[214:215], v3 offset:17472
    v_cvt_pk_bf16_f32 v63, v38, v39
    v_mfma_f32_16x16x32_bf16 v[252:255], a[252:255], v[124:127], v[252:255]
    s_mov_b32 s45, 2637824
    s_waitcnt lgkmcnt(8)
    buffer_load_dwordx4 v6, s[24:27], s45 offen lds
    v_mfma_f32_16x16x32_bf16 v[128:131], a[192:195], v[48:51], v[128:131]
    s_waitcnt vmcnt(15)
    ds_read_b64_tr_b16 a[216:217], v3 offset:96
    ds_read_b128 v[24:27], v9 offset:11280
    v_mfma_f32_16x16x32_bf16 v[128:131], a[196:199], v[52:55], v[128:131]
    ds_read_b64_tr_b16 a[218:219], v3 offset:608
    ds_read_b64_tr_b16 a[220:221], v3 offset:16992
    v_fma_mix_f32 v32, v64, v16, v20 op_sel:[0,0,0] op_sel_hi:[1,0,0]
    v_mfma_f32_16x16x32_bf16 v[160:163], a[192:195], v[56:59], v[160:163]
    s_add_u32 m0, s44, 76896
    ds_read_b64_tr_b16 a[222:223], v3 offset:17504
    ds_read_b128 v[28:31], v9 offset:11312
    v_mfma_f32_16x16x32_bf16 v[160:163], a[196:199], v[60:63], v[160:163]
    s_mov_b32 s45, 2646016
    s_waitcnt lgkmcnt(10)
    buffer_load_dwordx4 v6, s[24:27], s45 offen lds
    v_mfma_f32_16x16x32_bf16 v[132:135], a[200:203], v[48:51], v[132:135]
    ds_read_b64_tr_b16 a[224:225], v3 offset:128
    v_fma_mix_f32 v33, v64, v17, v21 op_sel:[1,0,0] op_sel_hi:[1,0,0]
    v_mfma_f32_16x16x32_bf16 v[132:135], a[204:207], v[52:55], v[132:135]
    ds_read_b64_tr_b16 a[226:227], v3 offset:640
    ds_read_b64_tr_b16 a[228:229], v3 offset:17024
    v_fma_mix_f32 v34, v65, v18, v22 op_sel:[0,0,0] op_sel_hi:[1,0,0]
    v_mfma_f32_16x16x32_bf16 v[164:167], a[200:203], v[56:59], v[164:167]
    s_add_u32 m0, s44, 90624
    ds_read_b64_tr_b16 a[230:231], v3 offset:17536
    v_fma_mix_f32 v35, v65, v19, v23 op_sel:[1,0,0] op_sel_hi:[1,0,0]
    v_mfma_f32_16x16x32_bf16 v[164:167], a[204:207], v[60:63], v[164:167]
    s_mov_b32 s45, 2883584
    s_waitcnt lgkmcnt(10)
    buffer_load_dwordx4 v6, s[24:27], s45 offen lds
    v_mfma_f32_16x16x32_bf16 v[136:139], a[208:211], v[48:51], v[136:139]
    ds_read_b64_tr_b16 a[232:233], v3 offset:160
    v_cvt_pk_bf16_f32 v64, v32, v33
    v_mfma_f32_16x16x32_bf16 v[136:139], a[212:215], v[52:55], v[136:139]
    ds_read_b64_tr_b16 a[234:235], v3 offset:672
    ds_read_b64_tr_b16 a[236:237], v3 offset:17056
    v_cvt_pk_bf16_f32 v65, v34, v35
    v_mfma_f32_16x16x32_bf16 v[168:171], a[208:211], v[56:59], v[168:171]
    s_add_u32 m0, s44, 91680
    ds_read_b64_tr_b16 a[238:239], v3 offset:17568
    v_fma_mix_f32 v36, v72, v16, v20 op_sel:[0,0,0] op_sel_hi:[1,0,0]
    v_mfma_f32_16x16x32_bf16 v[168:171], a[212:215], v[60:63], v[168:171]
    s_mov_b32 s45, 2891776
    s_waitcnt lgkmcnt(9)
    buffer_load_dwordx4 v6, s[24:27], s45 offen lds
    v_fma_mix_f32 v37, v72, v17, v21 op_sel:[1,0,0] op_sel_hi:[1,0,0]
    v_mfma_f32_16x16x32_bf16 v[140:143], a[216:219], v[48:51], v[140:143]
    ds_read_b64_tr_b16 a[240:241], v3 offset:192
    v_fma_mix_f32 v38, v73, v18, v22 op_sel:[0,0,0] op_sel_hi:[1,0,0]
    v_mfma_f32_16x16x32_bf16 v[140:143], a[220:223], v[52:55], v[140:143]
    ds_read_b64_tr_b16 a[242:243], v3 offset:704
    ds_read_b64_tr_b16 a[244:245], v3 offset:17088
    v_fma_mix_f32 v39, v73, v19, v23 op_sel:[1,0,0] op_sel_hi:[1,0,0]
    v_mfma_f32_16x16x32_bf16 v[172:175], a[216:219], v[56:59], v[172:175]
    s_add_u32 m0, s44, 92736
    ds_read_b64_tr_b16 a[246:247], v3 offset:17600
    v_cvt_pk_bf16_f32 v72, v36, v37
    v_mfma_f32_16x16x32_bf16 v[172:175], a[220:223], v[60:63], v[172:175]
    s_mov_b32 s45, 2899968
    s_waitcnt lgkmcnt(8)
    buffer_load_dwordx4 v6, s[24:27], s45 offen lds
    v_cvt_pk_bf16_f32 v73, v38, v39
    v_mfma_f32_16x16x32_bf16 v[144:147], a[224:227], v[48:51], v[144:147]
    ds_read_b64_tr_b16 a[248:249], v3 offset:224
    ds_read_b128 v[16:19], v9 offset:11520
    v_mfma_f32_16x16x32_bf16 v[144:147], a[228:231], v[52:55], v[144:147]
    ds_read_b64_tr_b16 a[250:251], v3 offset:736
    ds_read_b64_tr_b16 a[252:253], v3 offset:17120
    v_mfma_f32_16x16x32_bf16 v[176:179], a[224:227], v[56:59], v[176:179]
    s_add_u32 m0, s44, 93792
    ds_read_b64_tr_b16 a[254:255], v3 offset:17632
    ds_read_b128 v[20:23], v9 offset:11552
    v_mfma_f32_16x16x32_bf16 v[176:179], a[228:231], v[60:63], v[176:179]
    s_mov_b32 s45, 2908160
    s_waitcnt lgkmcnt(10)
    buffer_load_dwordx4 v6, s[24:27], s45 offen lds
    v_mfma_f32_16x16x32_bf16 v[148:151], a[232:235], v[48:51], v[148:151]
    ds_read_b64_tr_b16 a[192:193], v3 offset:256
    v_fma_mix_f32 v32, v66, v24, v28 op_sel:[0,0,0] op_sel_hi:[1,0,0]
    v_mfma_f32_16x16x32_bf16 v[148:151], a[236:239], v[52:55], v[148:151]
    ds_read_b64_tr_b16 a[194:195], v3 offset:768
    v_fma_mix_f32 v33, v66, v25, v29 op_sel:[1,0,0] op_sel_hi:[1,0,0]
    v_mfma_f32_16x16x32_bf16 v[180:183], a[232:235], v[56:59], v[180:183]
    ds_read_b64_tr_b16 a[196:197], v3 offset:17152
    v_fma_mix_f32 v34, v67, v26, v30 op_sel:[0,0,0] op_sel_hi:[1,0,0]
    v_mfma_f32_16x16x32_bf16 v[180:183], a[236:239], v[60:63], v[180:183]
    s_waitcnt lgkmcnt(9)
    ds_read_b64_tr_b16 a[198:199], v3 offset:17664
    v_fma_mix_f32 v35, v67, v27, v31 op_sel:[1,0,0] op_sel_hi:[1,0,0]
    v_mfma_f32_16x16x32_bf16 v[152:155], a[240:243], v[48:51], v[152:155]
    ds_read_b64_tr_b16 a[200:201], v3 offset:288
    v_cvt_pk_bf16_f32 v66, v32, v33
    v_mfma_f32_16x16x32_bf16 v[152:155], a[244:247], v[52:55], v[152:155]
    ds_read_b64_tr_b16 a[202:203], v3 offset:800
    v_cvt_pk_bf16_f32 v67, v34, v35
    v_mfma_f32_16x16x32_bf16 v[184:187], a[240:243], v[56:59], v[184:187]
    ds_read_b64_tr_b16 a[204:205], v3 offset:17184
    v_fma_mix_f32 v36, v74, v24, v28 op_sel:[0,0,0] op_sel_hi:[1,0,0]
    v_mfma_f32_16x16x32_bf16 v[184:187], a[244:247], v[60:63], v[184:187]
    s_waitcnt lgkmcnt(8)
    ds_read_b64_tr_b16 a[206:207], v3 offset:17696
    v_fma_mix_f32 v37, v74, v25, v29 op_sel:[1,0,0] op_sel_hi:[1,0,0]
    v_mfma_f32_16x16x32_bf16 v[156:159], a[248:251], v[48:51], v[156:159]
    ds_read_b64_tr_b16 a[208:209], v3 offset:320
    v_fma_mix_f32 v38, v75, v26, v30 op_sel:[0,0,0] op_sel_hi:[1,0,0]
    v_mfma_f32_16x16x32_bf16 v[156:159], a[252:255], v[52:55], v[156:159]
    ds_read_b64_tr_b16 a[210:211], v3 offset:832
    v_fma_mix_f32 v39, v75, v27, v31 op_sel:[1,0,0] op_sel_hi:[1,0,0]
    v_mfma_f32_16x16x32_bf16 v[188:191], a[248:251], v[56:59], v[188:191]
    ds_read_b64_tr_b16 a[212:213], v3 offset:17216
    v_cvt_pk_bf16_f32 v74, v36, v37
    v_mfma_f32_16x16x32_bf16 v[188:191], a[252:255], v[60:63], v[188:191]
    s_waitcnt lgkmcnt(7)
    ds_read_b64_tr_b16 a[214:215], v3 offset:17728
    v_cvt_pk_bf16_f32 v75, v38, v39
    v_mfma_f32_16x16x32_bf16 v[192:195], a[192:195], v[48:51], v[192:195]
    ds_read_b64_tr_b16 a[216:217], v3 offset:352
    ds_read_b128 v[24:27], v9 offset:11536
    v_mfma_f32_16x16x32_bf16 v[192:195], a[196:199], v[52:55], v[192:195]
    ds_read_b64_tr_b16 a[218:219], v3 offset:864
    ds_read_b64_tr_b16 a[220:221], v3 offset:17248
    v_fma_mix_f32 v32, v68, v16, v20 op_sel:[0,0,0] op_sel_hi:[1,0,0]
    v_mfma_f32_16x16x32_bf16 v[224:227], a[192:195], v[56:59], v[224:227]
    s_mov_b32 s54, 12288
    ds_read_b64_tr_b16 a[222:223], v3 offset:17760
    ds_read_b128 v[28:31], v9 offset:11568
    v_mfma_f32_16x16x32_bf16 v[224:227], a[196:199], v[60:63], v[224:227]
    s_waitcnt lgkmcnt(10)
    buffer_load_dwordx4 v[96:99], off, s[32:35], s54 sc1
    v_mfma_f32_16x16x32_bf16 v[196:199], a[200:203], v[48:51], v[196:199]
    ds_read_b64_tr_b16 a[224:225], v3 offset:384
    v_fma_mix_f32 v33, v68, v17, v21 op_sel:[1,0,0] op_sel_hi:[1,0,0]
    v_mfma_f32_16x16x32_bf16 v[196:199], a[204:207], v[52:55], v[196:199]
    ds_read_b64_tr_b16 a[226:227], v3 offset:896
    ds_read_b64_tr_b16 a[228:229], v3 offset:17280
    v_fma_mix_f32 v34, v69, v18, v22 op_sel:[0,0,0] op_sel_hi:[1,0,0]
    v_mfma_f32_16x16x32_bf16 v[228:231], a[200:203], v[56:59], v[228:231]
    s_mov_b32 s54, 13312
    ds_read_b64_tr_b16 a[230:231], v3 offset:17792
    v_fma_mix_f32 v35, v69, v19, v23 op_sel:[1,0,0] op_sel_hi:[1,0,0]
    v_mfma_f32_16x16x32_bf16 v[228:231], a[204:207], v[60:63], v[228:231]
    s_waitcnt lgkmcnt(10)
    buffer_load_dwordx4 v[100:103], off, s[32:35], s54 sc1
    v_mfma_f32_16x16x32_bf16 v[200:203], a[208:211], v[48:51], v[200:203]
    ds_read_b64_tr_b16 a[232:233], v3 offset:416
    v_cvt_pk_bf16_f32 v68, v32, v33
    v_mfma_f32_16x16x32_bf16 v[200:203], a[212:215], v[52:55], v[200:203]
    ds_read_b64_tr_b16 a[234:235], v3 offset:928
    ds_read_b64_tr_b16 a[236:237], v3 offset:17312
    v_cvt_pk_bf16_f32 v69, v34, v35
    v_mfma_f32_16x16x32_bf16 v[232:235], a[208:211], v[56:59], v[232:235]
    s_mov_b32 s54, 30720
    ds_read_b64_tr_b16 a[238:239], v3 offset:17824
    v_fma_mix_f32 v36, v76, v16, v20 op_sel:[0,0,0] op_sel_hi:[1,0,0]
    v_mfma_f32_16x16x32_bf16 v[232:235], a[212:215], v[60:63], v[232:235]
    s_waitcnt lgkmcnt(9)
    buffer_load_dwordx4 v[104:107], off, s[32:35], s54 sc1
    v_fma_mix_f32 v37, v76, v17, v21 op_sel:[1,0,0] op_sel_hi:[1,0,0]
    v_mfma_f32_16x16x32_bf16 v[204:207], a[216:219], v[48:51], v[204:207]
    ds_read_b64_tr_b16 a[240:241], v3 offset:448
    v_fma_mix_f32 v38, v77, v18, v22 op_sel:[0,0,0] op_sel_hi:[1,0,0]
    v_mfma_f32_16x16x32_bf16 v[204:207], a[220:223], v[52:55], v[204:207]
    ds_read_b64_tr_b16 a[242:243], v3 offset:960
    ds_read_b64_tr_b16 a[244:245], v3 offset:17344
    v_fma_mix_f32 v39, v77, v19, v23 op_sel:[1,0,0] op_sel_hi:[1,0,0]
    v_mfma_f32_16x16x32_bf16 v[236:239], a[216:219], v[56:59], v[236:239]
    s_mov_b32 s54, 31744
    ds_read_b64_tr_b16 a[246:247], v3 offset:17856
    v_cvt_pk_bf16_f32 v76, v36, v37
    v_mfma_f32_16x16x32_bf16 v[236:239], a[220:223], v[60:63], v[236:239]
    s_waitcnt lgkmcnt(8)
    buffer_load_dwordx4 v[108:111], off, s[32:35], s54 sc1
    v_cvt_pk_bf16_f32 v77, v38, v39
    v_mfma_f32_16x16x32_bf16 v[208:211], a[224:227], v[48:51], v[208:211]
    ds_read_b64_tr_b16 a[248:249], v3 offset:480
    ds_read_b128 v[16:19], v9 offset:11776
    v_mfma_f32_16x16x32_bf16 v[208:211], a[228:231], v[52:55], v[208:211]
    ds_read_b64_tr_b16 a[250:251], v3 offset:992
    ds_read_b128 v[20:23], v9 offset:11808
    v_mfma_f32_16x16x32_bf16 v[240:243], a[224:227], v[56:59], v[240:243]
    ds_read_b64_tr_b16 a[252:253], v3 offset:17376
    v_fma_mix_f32 v32, v70, v24, v28 op_sel:[0,0,0] op_sel_hi:[1,0,0]
    v_mfma_f32_16x16x32_bf16 v[240:243], a[228:231], v[60:63], v[240:243]
    s_waitcnt vmcnt(16)
    s_barrier
    s_waitcnt lgkmcnt(9)
    ds_read_b64_tr_b16 a[254:255], v3 offset:17888
    v_fma_mix_f32 v33, v70, v25, v29 op_sel:[1,0,0] op_sel_hi:[1,0,0]
    v_fma_mix_f32 v34, v71, v26, v30 op_sel:[0,0,0] op_sel_hi:[1,0,0]
    v_mfma_f32_16x16x32_bf16 v[212:215], a[232:235], v[48:51], v[212:215]
    ds_read_b64_tr_b16 a[192:193], v3 offset:36864
    v_fma_mix_f32 v35, v71, v27, v31 op_sel:[1,0,0] op_sel_hi:[1,0,0]
    v_mfma_f32_16x16x32_bf16 v[212:215], a[236:239], v[52:55], v[212:215]
    ds_read_b64_tr_b16 a[194:195], v3 offset:37376
    ds_read_b64_tr_b16 a[196:197], v3 offset:53760
    v_cvt_pk_bf16_f32 v70, v32, v33
    v_mfma_f32_16x16x32_bf16 v[244:247], a[232:235], v[56:59], v[244:247]
    s_add_u32 m0, s44, 110592
    ds_read_b64_tr_b16 a[198:199], v3 offset:54272
    v_cvt_pk_bf16_f32 v71, v34, v35
    v_mfma_f32_16x16x32_bf16 v[244:247], a[236:239], v[60:63], v[244:247]
    s_mov_b32 s45, 3145728
    s_waitcnt lgkmcnt(10)
    buffer_load_dwordx4 v6, s[24:27], s45 offen lds
    v_mfma_f32_16x16x32_bf16 v[216:219], a[240:243], v[48:51], v[216:219]
    ds_read_b64_tr_b16 a[200:201], v3 offset:36896
    v_fma_mix_f32 v36, v78, v24, v28 op_sel:[0,0,0] op_sel_hi:[1,0,0]
    v_mfma_f32_16x16x32_bf16 v[216:219], a[244:247], v[52:55], v[216:219]
    ds_read_b64_tr_b16 a[202:203], v3 offset:37408
    ds_read_b64_tr_b16 a[204:205], v3 offset:53792
    v_fma_mix_f32 v37, v78, v25, v29 op_sel:[1,0,0] op_sel_hi:[1,0,0]
    v_mfma_f32_16x16x32_bf16 v[248:251], a[240:243], v[56:59], v[248:251]
    s_add_u32 m0, s44, 111648
    ds_read_b64_tr_b16 a[206:207], v3 offset:54304
    v_fma_mix_f32 v38, v79, v26, v30 op_sel:[0,0,0] op_sel_hi:[1,0,0]
    v_mfma_f32_16x16x32_bf16 v[248:251], a[244:247], v[60:63], v[248:251]
    s_mov_b32 s45, 3153920
    s_waitcnt lgkmcnt(8)
    buffer_load_dwordx4 v6, s[24:27], s45 offen lds
    v_mfma_f32_16x16x32_bf16 v[220:223], a[248:251], v[48:51], v[220:223]
L2_pad1:
    s_cbranch_execz L2_pad5
    ds_read_b64_tr_b16 a[208:209], v3 offset:36928
    v_fma_mix_f32 v39, v79, v27, v31 op_sel:[1,0,0] op_sel_hi:[1,0,0]
    v_mfma_f32_16x16x32_bf16 v[220:223], a[252:255], v[52:55], v[220:223]
    ds_read_b64_tr_b16 a[210:211], v3 offset:37440
    ds_read_b64_tr_b16 a[212:213], v3 offset:53824
    v_cvt_pk_bf16_f32 v78, v36, v37
    v_mfma_f32_16x16x32_bf16 v[252:255], a[248:251], v[56:59], v[252:255]
    s_add_u32 m0, s44, 112704
    ds_read_b64_tr_b16 a[214:215], v3 offset:54336
    v_cvt_pk_bf16_f32 v79, v38, v39
    v_mfma_f32_16x16x32_bf16 v[252:255], a[252:255], v[60:63], v[252:255]
    s_mov_b32 s45, 3162112
    s_waitcnt lgkmcnt(8)
    buffer_load_dwordx4 v6, s[24:27], s45 offen lds
    v_mfma_f32_16x16x32_bf16 v[128:131], a[192:195], v[64:67], v[128:131]
    s_waitcnt vmcnt(15)
    ds_read_b64_tr_b16 a[216:217], v3 offset:36960
    ds_read_b128 v[24:27], v9 offset:11792
    v_mfma_f32_16x16x32_bf16 v[128:131], a[196:199], v[68:71], v[128:131]
    ds_read_b64_tr_b16 a[218:219], v3 offset:37472
    ds_read_b64_tr_b16 a[220:221], v3 offset:53856
    v_fma_mix_f32 v32, v80, v16, v20 op_sel:[0,0,0] op_sel_hi:[1,0,0]
    v_mfma_f32_16x16x32_bf16 v[160:163], a[192:195], v[72:75], v[160:163]
    s_add_u32 m0, s44, 113760
    ds_read_b64_tr_b16 a[222:223], v3 offset:54368
    ds_read_b128 v[28:31], v9 offset:11824
    v_mfma_f32_16x16x32_bf16 v[160:163], a[196:199], v[76:79], v[160:163]
    s_mov_b32 s45, 3170304
    s_waitcnt lgkmcnt(10)
    buffer_load_dwordx4 v6, s[24:27], s45 offen lds
    v_mfma_f32_16x16x32_bf16 v[132:135], a[200:203], v[64:67], v[132:135]
    ds_read_b64_tr_b16 a[224:225], v3 offset:36992
    v_fma_mix_f32 v33, v80, v17, v21 op_sel:[1,0,0] op_sel_hi:[1,0,0]
    v_mfma_f32_16x16x32_bf16 v[132:135], a[204:207], v[68:71], v[132:135]
    ds_read_b64_tr_b16 a[226:227], v3 offset:37504
    ds_read_b64_tr_b16 a[228:229], v3 offset:53888
    v_fma_mix_f32 v34, v81, v18, v22 op_sel:[0,0,0] op_sel_hi:[1,0,0]
    v_mfma_f32_16x16x32_bf16 v[164:167], a[200:203], v[72:75], v[164:167]
    s_add_u32 m0, s44, 127488
    ds_read_b64_tr_b16 a[230:231], v3 offset:54400
    v_fma_mix_f32 v35, v81, v19, v23 op_sel:[1,0,0] op_sel_hi:[1,0,0]
    v_mfma_f32_16x16x32_bf16 v[164:167], a[204:207], v[76:79], v[164:167]
    s_mov_b32 s45, 3407872
    s_waitcnt lgkmcnt(10)
    buffer_load_dwordx4 v6, s[24:27], s45 offen lds
    v_mfma_f32_16x16x32_bf16 v[136:139], a[208:211], v[64:67], v[136:139]
    ds_read_b64_tr_b16 a[232:233], v3 offset:37024
    v_cvt_pk_bf16_f32 v80, v32, v33
    v_mfma_f32_16x16x32_bf16 v[136:139], a[212:215], v[68:71], v[136:139]
    ds_read_b64_tr_b16 a[234:235], v3 offset:37536
    ds_read_b64_tr_b16 a[236:237], v3 offset:53920
    v_cvt_pk_bf16_f32 v81, v34, v35
    v_mfma_f32_16x16x32_bf16 v[168:171], a[208:211], v[72:75], v[168:171]
    s_add_u32 m0, s44, 128544
    ds_read_b64_tr_b16 a[238:239], v3 offset:54432
    v_fma_mix_f32 v36, v88, v16, v20 op_sel:[0,0,0] op_sel_hi:[1,0,0]
    v_mfma_f32_16x16x32_bf16 v[168:171], a[212:215], v[76:79], v[168:171]
    s_mov_b32 s45, 3416064
    s_waitcnt lgkmcnt(9)
    buffer_load_dwordx4 v6, s[24:27], s45 offen lds
    v_fma_mix_f32 v37, v88, v17, v21 op_sel:[1,0,0] op_sel_hi:[1,0,0]
    v_mfma_f32_16x16x32_bf16 v[140:143], a[216:219], v[64:67], v[140:143]
    ds_read_b64_tr_b16 a[240:241], v3 offset:37056
    v_fma_mix_f32 v38, v89, v18, v22 op_sel:[0,0,0] op_sel_hi:[1,0,0]
    v_mfma_f32_16x16x32_bf16 v[140:143], a[220:223], v[68:71], v[140:143]
    ds_read_b64_tr_b16 a[242:243], v3 offset:37568
    ds_read_b64_tr_b16 a[244:245], v3 offset:53952
    v_fma_mix_f32 v39, v89, v19, v23 op_sel:[1,0,0] op_sel_hi:[1,0,0]
    v_mfma_f32_16x16x32_bf16 v[172:175], a[216:219], v[72:75], v[172:175]
    s_add_u32 m0, s44, 129600
    ds_read_b64_tr_b16 a[246:247], v3 offset:54464
    v_cvt_pk_bf16_f32 v88, v36, v37
    v_mfma_f32_16x16x32_bf16 v[172:175], a[220:223], v[76:79], v[172:175]
    s_mov_b32 s45, 3424256
    s_waitcnt lgkmcnt(8)
    buffer_load_dwordx4 v6, s[24:27], s45 offen lds
    v_cvt_pk_bf16_f32 v89, v38, v39
    v_mfma_f32_16x16x32_bf16 v[144:147], a[224:227], v[64:67], v[144:147]
    ds_read_b64_tr_b16 a[248:249], v3 offset:37088
    ds_read_b128 v[16:19], v9 offset:12032
    v_mfma_f32_16x16x32_bf16 v[144:147], a[228:231], v[68:71], v[144:147]
    ds_read_b64_tr_b16 a[250:251], v3 offset:37600
    ds_read_b64_tr_b16 a[252:253], v3 offset:53984
    v_mfma_f32_16x16x32_bf16 v[176:179], a[224:227], v[72:75], v[176:179]
    s_add_u32 m0, s44, 130656
    ds_read_b64_tr_b16 a[254:255], v3 offset:54496
    ds_read_b128 v[20:23], v9 offset:12064
    v_mfma_f32_16x16x32_bf16 v[176:179], a[228:231], v[76:79], v[176:179]
    s_mov_b32 s45, 3432448
    s_waitcnt lgkmcnt(10)
    buffer_load_dwordx4 v6, s[24:27], s45 offen lds
    v_mfma_f32_16x16x32_bf16 v[148:151], a[232:235], v[64:67], v[148:151]
    ds_read_b64_tr_b16 a[192:193], v3 offset:37120
    v_fma_mix_f32 v32, v82, v24, v28 op_sel:[0,0,0] op_sel_hi:[1,0,0]
    v_mfma_f32_16x16x32_bf16 v[148:151], a[236:239], v[68:71], v[148:151]
    ds_read_b64_tr_b16 a[194:195], v3 offset:37632
    v_fma_mix_f32 v33, v82, v25, v29 op_sel:[1,0,0] op_sel_hi:[1,0,0]
    v_mfma_f32_16x16x32_bf16 v[180:183], a[232:235], v[72:75], v[180:183]
    ds_read_b64_tr_b16 a[196:197], v3 offset:54016
    v_fma_mix_f32 v34, v83, v26, v30 op_sel:[0,0,0] op_sel_hi:[1,0,0]
    v_mfma_f32_16x16x32_bf16 v[180:183], a[236:239], v[76:79], v[180:183]
    s_waitcnt lgkmcnt(9)
    ds_read_b64_tr_b16 a[198:199], v3 offset:54528
    v_fma_mix_f32 v35, v83, v27, v31 op_sel:[1,0,0] op_sel_hi:[1,0,0]
    v_mfma_f32_16x16x32_bf16 v[152:155], a[240:243], v[64:67], v[152:155]
    ds_read_b64_tr_b16 a[200:201], v3 offset:37152
    v_cvt_pk_bf16_f32 v82, v32, v33
    v_mfma_f32_16x16x32_bf16 v[152:155], a[244:247], v[68:71], v[152:155]
    ds_read_b64_tr_b16 a[202:203], v3 offset:37664
    v_cvt_pk_bf16_f32 v83, v34, v35
    v_mfma_f32_16x16x32_bf16 v[184:187], a[240:243], v[72:75], v[184:187]
    ds_read_b64_tr_b16 a[204:205], v3 offset:54048
    v_fma_mix_f32 v36, v90, v24, v28 op_sel:[0,0,0] op_sel_hi:[1,0,0]
    v_mfma_f32_16x16x32_bf16 v[184:187], a[244:247], v[76:79], v[184:187]
    s_waitcnt lgkmcnt(8)
    ds_read_b64_tr_b16 a[206:207], v3 offset:54560
    v_fma_mix_f32 v37, v90, v25, v29 op_sel:[1,0,0] op_sel_hi:[1,0,0]
    v_mfma_f32_16x16x32_bf16 v[156:159], a[248:251], v[64:67], v[156:159]
    ds_read_b64_tr_b16 a[208:209], v3 offset:37184
    v_fma_mix_f32 v38, v91, v26, v30 op_sel:[0,0,0] op_sel_hi:[1,0,0]
    v_mfma_f32_16x16x32_bf16 v[156:159], a[252:255], v[68:71], v[156:159]
    ds_read_b64_tr_b16 a[210:211], v3 offset:37696
    v_fma_mix_f32 v39, v91, v27, v31 op_sel:[1,0,0] op_sel_hi:[1,0,0]
    v_mfma_f32_16x16x32_bf16 v[188:191], a[248:251], v[72:75], v[188:191]
    ds_read_b64_tr_b16 a[212:213], v3 offset:54080
    v_cvt_pk_bf16_f32 v90, v36, v37
    v_mfma_f32_16x16x32_bf16 v[188:191], a[252:255], v[76:79], v[188:191]
    s_waitcnt lgkmcnt(7)
    ds_read_b64_tr_b16 a[214:215], v3 offset:54592
    v_cvt_pk_bf16_f32 v91, v38, v39
    v_mfma_f32_16x16x32_bf16 v[192:195], a[192:195], v[64:67], v[192:195]
    ds_read_b64_tr_b16 a[216:217], v3 offset:37216
    ds_read_b128 v[24:27], v9 offset:12048
    v_mfma_f32_16x16x32_bf16 v[192:195], a[196:199], v[68:71], v[192:195]
    ds_read_b64_tr_b16 a[218:219], v3 offset:37728
    ds_read_b64_tr_b16 a[220:221], v3 offset:54112
    v_fma_mix_f32 v32, v84, v16, v20 op_sel:[0,0,0] op_sel_hi:[1,0,0]
    v_mfma_f32_16x16x32_bf16 v[224:227], a[192:195], v[72:75], v[224:227]
    s_mov_b32 s54, 14336
    ds_read_b64_tr_b16 a[222:223], v3 offset:54624
    ds_read_b128 v[28:31], v9 offset:12080
    v_mfma_f32_16x16x32_bf16 v[224:227], a[196:199], v[76:79], v[224:227]
    s_waitcnt lgkmcnt(10)
    buffer_load_dwordx4 v[112:115], off, s[32:35], s54 sc1
    v_mfma_f32_16x16x32_bf16 v[196:199], a[200:203], v[64:67], v[196:199]
    ds_read_b64_tr_b16 a[224:225], v3 offset:37248
    v_fma_mix_f32 v33, v84, v17, v21 op_sel:[1,0,0] op_sel_hi:[1,0,0]
    v_mfma_f32_16x16x32_bf16 v[196:199], a[204:207], v[68:71], v[196:199]
    ds_read_b64_tr_b16 a[226:227], v3 offset:37760
    ds_read_b64_tr_b16 a[228:229], v3 offset:54144
    v_fma_mix_f32 v34, v85, v18, v22 op_sel:[0,0,0] op_sel_hi:[1,0,0]
    v_mfma_f32_16x16x32_bf16 v[228:231], a[200:203], v[72:75], v[228:231]
    s_mov_b32 s54, 15360
    ds_read_b64_tr_b16 a[230:231], v3 offset:54656
    v_fma_mix_f32 v35, v85, v19, v23 op_sel:[1,0,0] op_sel_hi:[1,0,0]
    v_mfma_f32_16x16x32_bf16 v[228:231], a[204:207], v[76:79], v[228:231]
    s_waitcnt lgkmcnt(10)
    buffer_load_dwordx4 v[116:119], off, s[32:35], s54 sc1
    v_mfma_f32_16x16x32_bf16 v[200:203], a[208:211], v[64:67], v[200:203]
    ds_read_b64_tr_b16 a[232:233], v3 offset:37280
    v_cvt_pk_bf16_f32 v84, v32, v33
    v_mfma_f32_16x16x32_bf16 v[200:203], a[212:215], v[68:71], v[200:203]
    ds_read_b64_tr_b16 a[234:235], v3 offset:37792
    ds_read_b64_tr_b16 a[236:237], v3 offset:54176
    v_cvt_pk_bf16_f32 v85, v34, v35
    v_mfma_f32_16x16x32_bf16 v[232:235], a[208:211], v[72:75], v[232:235]
    s_mov_b32 s54, 32768
    ds_read_b64_tr_b16 a[238:239], v3 offset:54688
    v_fma_mix_f32 v36, v92, v16, v20 op_sel:[0,0,0] op_sel_hi:[1,0,0]
    v_mfma_f32_16x16x32_bf16 v[232:235], a[212:215], v[76:79], v[232:235]
    s_waitcnt lgkmcnt(9)
    buffer_load_dwordx4 v[120:123], off, s[32:35], s54 sc1
    v_fma_mix_f32 v37, v92, v17, v21 op_sel:[1,0,0] op_sel_hi:[1,0,0]
    v_mfma_f32_16x16x32_bf16 v[204:207], a[216:219], v[64:67], v[204:207]
    ds_read_b64_tr_b16 a[240:241], v3 offset:37312
    v_fma_mix_f32 v38, v93, v18, v22 op_sel:[0,0,0] op_sel_hi:[1,0,0]
    v_mfma_f32_16x16x32_bf16 v[204:207], a[220:223], v[68:71], v[204:207]
    ds_read_b64_tr_b16 a[242:243], v3 offset:37824
    ds_read_b64_tr_b16 a[244:245], v3 offset:54208
    v_fma_mix_f32 v39, v93, v19, v23 op_sel:[1,0,0] op_sel_hi:[1,0,0]
    v_mfma_f32_16x16x32_bf16 v[236:239], a[216:219], v[72:75], v[236:239]
    s_mov_b32 s54, 33792
    ds_read_b64_tr_b16 a[246:247], v3 offset:54720
    v_cvt_pk_bf16_f32 v92, v36, v37
    v_mfma_f32_16x16x32_bf16 v[236:239], a[220:223], v[76:79], v[236:239]
    s_waitcnt lgkmcnt(8)
    buffer_load_dwordx4 v[124:127], off, s[32:35], s54 sc1
    v_cvt_pk_bf16_f32 v93, v38, v39
    v_mfma_f32_16x16x32_bf16 v[208:211], a[224:227], v[64:67], v[208:211]
    ds_read_b64_tr_b16 a[248:249], v3 offset:37344
    ds_read_b128 v[16:19], v9 offset:12288
    v_mfma_f32_16x16x32_bf16 v[208:211], a[228:231], v[68:71], v[208:211]
    ds_read_b64_tr_b16 a[250:251], v3 offset:37856
    ds_read_b128 v[20:23], v9 offset:12320
    v_mfma_f32_16x16x32_bf16 v[240:243], a[224:227], v[72:75], v[240:243]
    ds_read_b64_tr_b16 a[252:253], v3 offset:54240
    v_fma_mix_f32 v32, v86, v24, v28 op_sel:[0,0,0] op_sel_hi:[1,0,0]
    v_mfma_f32_16x16x32_bf16 v[240:243], a[228:231], v[76:79], v[240:243]
    s_waitcnt vmcnt(16)
    s_barrier
    s_waitcnt lgkmcnt(9)
    ds_read_b64_tr_b16 a[254:255], v3 offset:54752
    v_fma_mix_f32 v33, v86, v25, v29 op_sel:[1,0,0] op_sel_hi:[1,0,0]
    v_fma_mix_f32 v34, v87, v26, v30 op_sel:[0,0,0] op_sel_hi:[1,0,0]
    v_mfma_f32_16x16x32_bf16 v[212:215], a[232:235], v[64:67], v[212:215]
    ds_read_b64_tr_b16 a[192:193], v4 offset:0
    v_fma_mix_f32 v35, v87, v27, v31 op_sel:[1,0,0] op_sel_hi:[1,0,0]
    v_mfma_f32_16x16x32_bf16 v[212:215], a[236:239], v[68:71], v[212:215]
    ds_read_b64_tr_b16 a[194:195], v4 offset:512
    ds_read_b64_tr_b16 a[196:197], v4 offset:16896
    v_cvt_pk_bf16_f32 v86, v32, v33
    v_mfma_f32_16x16x32_bf16 v[244:247], a[232:235], v[72:75], v[244:247]
    s_add_u32 m0, s44, 0
    ds_read_b64_tr_b16 a[198:199], v4 offset:17408
    v_cvt_pk_bf16_f32 v87, v34, v35
    v_mfma_f32_16x16x32_bf16 v[244:247], a[236:239], v[76:79], v[244:247]
    s_mov_b32 s45, 3670016
    s_waitcnt lgkmcnt(10)
    buffer_load_dwordx4 v6, s[24:27], s45 offen lds
    v_mfma_f32_16x16x32_bf16 v[216:219], a[240:243], v[64:67], v[216:219]
    ds_read_b64_tr_b16 a[200:201], v4 offset:32
    v_fma_mix_f32 v36, v94, v24, v28 op_sel:[0,0,0] op_sel_hi:[1,0,0]
    v_mfma_f32_16x16x32_bf16 v[216:219], a[244:247], v[68:71], v[216:219]
    ds_read_b64_tr_b16 a[202:203], v4 offset:544
    ds_read_b64_tr_b16 a[204:205], v4 offset:16928
    v_fma_mix_f32 v37, v94, v25, v29 op_sel:[1,0,0] op_sel_hi:[1,0,0]
    v_mfma_f32_16x16x32_bf16 v[248:251], a[240:243], v[72:75], v[248:251]
    s_add_u32 m0, s44, 1056
    ds_read_b64_tr_b16 a[206:207], v4 offset:17440
    v_fma_mix_f32 v38, v95, v26, v30 op_sel:[0,0,0] op_sel_hi:[1,0,0]
    v_mfma_f32_16x16x32_bf16 v[248:251], a[244:247], v[76:79], v[248:251]
    s_mov_b32 s45, 3678208
    s_waitcnt lgkmcnt(8)
    buffer_load_dwordx4 v6, s[24:27], s45 offen lds
    v_mfma_f32_16x16x32_bf16 v[220:223], a[248:251], v[64:67], v[220:223]
    ds_read_b64_tr_b16 a[208:209], v4 offset:64
    v_fma_mix_f32 v39, v95, v27, v31 op_sel:[1,0,0] op_sel_hi:[1,0,0]
    v_mfma_f32_16x16x32_bf16 v[220:223], a[252:255], v[68:71], v[220:223]
    ds_read_b64_tr_b16 a[210:211], v4 offset:576
    ds_read_b64_tr_b16 a[212:213], v4 offset:16960
    v_cvt_pk_bf16_f32 v94, v36, v37
    v_mfma_f32_16x16x32_bf16 v[252:255], a[248:251], v[72:75], v[252:255]
    s_add_u32 m0, s44, 2112
    ds_read_b64_tr_b16 a[214:215], v4 offset:17472
    v_cvt_pk_bf16_f32 v95, v38, v39
    v_mfma_f32_16x16x32_bf16 v[252:255], a[252:255], v[76:79], v[252:255]
    s_mov_b32 s45, 3686400
    s_waitcnt lgkmcnt(8)
    buffer_load_dwordx4 v6, s[24:27], s45 offen lds
    v_mfma_f32_16x16x32_bf16 v[128:131], a[192:195], v[80:83], v[128:131]
    s_waitcnt vmcnt(15)
    ds_read_b64_tr_b16 a[216:217], v4 offset:96
    ds_read_b128 v[24:27], v9 offset:12304
    v_mfma_f32_16x16x32_bf16 v[128:131], a[196:199], v[84:87], v[128:131]
    ds_read_b64_tr_b16 a[218:219], v4 offset:608
    ds_read_b64_tr_b16 a[220:221], v4 offset:16992
    v_fma_mix_f32 v32, v96, v16, v20 op_sel:[0,0,0] op_sel_hi:[1,0,0]
    v_mfma_f32_16x16x32_bf16 v[160:163], a[192:195], v[88:91], v[160:163]
    s_add_u32 m0, s44, 3168
    ds_read_b64_tr_b16 a[222:223], v4 offset:17504
    ds_read_b128 v[28:31], v9 offset:12336
    v_mfma_f32_16x16x32_bf16 v[160:163], a[196:199], v[92:95], v[160:163]
    s_mov_b32 s45, 3694592
    s_waitcnt lgkmcnt(10)
    buffer_load_dwordx4 v6, s[24:27], s45 offen lds
    v_mfma_f32_16x16x32_bf16 v[132:135], a[200:203], v[80:83], v[132:135]
    ds_read_b64_tr_b16 a[224:225], v4 offset:128
    v_fma_mix_f32 v33, v96, v17, v21 op_sel:[1,0,0] op_sel_hi:[1,0,0]
    v_mfma_f32_16x16x32_bf16 v[132:135], a[204:207], v[84:87], v[132:135]
    ds_read_b64_tr_b16 a[226:227], v4 offset:640
    ds_read_b64_tr_b16 a[228:229], v4 offset:17024
    v_fma_mix_f32 v34, v97, v18, v22 op_sel:[0,0,0] op_sel_hi:[1,0,0]
    v_mfma_f32_16x16x32_bf16 v[164:167], a[200:203], v[88:91], v[164:167]
    s_add_u32 m0, s44, 16896
    ds_read_b64_tr_b16 a[230:231], v4 offset:17536
    v_fma_mix_f32 v35, v97, v19, v23 op_sel:[1,0,0] op_sel_hi:[1,0,0]
    v_mfma_f32_16x16x32_bf16 v[164:167], a[204:207], v[92:95], v[164:167]
    s_mov_b32 s45, 3932160
    s_waitcnt lgkmcnt(10)
    buffer_load_dwordx4 v6, s[24:27], s45 offen lds
    v_mfma_f32_16x16x32_bf16 v[136:139], a[208:211], v[80:83], v[136:139]
    ds_read_b64_tr_b16 a[232:233], v4 offset:160
    v_cvt_pk_bf16_f32 v96, v32, v33
    v_mfma_f32_16x16x32_bf16 v[136:139], a[212:215], v[84:87], v[136:139]
    ds_read_b64_tr_b16 a[234:235], v4 offset:672
    ds_read_b64_tr_b16 a[236:237], v4 offset:17056
    v_cvt_pk_bf16_f32 v97, v34, v35
    v_mfma_f32_16x16x32_bf16 v[168:171], a[208:211], v[88:91], v[168:171]
    s_add_u32 m0, s44, 17952
    ds_read_b64_tr_b16 a[238:239], v4 offset:17568
    v_fma_mix_f32 v36, v104, v16, v20 op_sel:[0,0,0] op_sel_hi:[1,0,0]
    v_mfma_f32_16x16x32_bf16 v[168:171], a[212:215], v[92:95], v[168:171]
    s_mov_b32 s45, 3940352
    s_waitcnt lgkmcnt(9)
    buffer_load_dwordx4 v6, s[24:27], s45 offen lds
    v_fma_mix_f32 v37, v104, v17, v21 op_sel:[1,0,0] op_sel_hi:[1,0,0]
    v_mfma_f32_16x16x32_bf16 v[140:143], a[216:219], v[80:83], v[140:143]
    ds_read_b64_tr_b16 a[240:241], v4 offset:192
    v_fma_mix_f32 v38, v105, v18, v22 op_sel:[0,0,0] op_sel_hi:[1,0,0]
    v_mfma_f32_16x16x32_bf16 v[140:143], a[220:223], v[84:87], v[140:143]
    ds_read_b64_tr_b16 a[242:243], v4 offset:704
    ds_read_b64_tr_b16 a[244:245], v4 offset:17088
    v_fma_mix_f32 v39, v105, v19, v23 op_sel:[1,0,0] op_sel_hi:[1,0,0]
    v_mfma_f32_16x16x32_bf16 v[172:175], a[216:219], v[88:91], v[172:175]
    s_add_u32 m0, s44, 19008
    ds_read_b64_tr_b16 a[246:247], v4 offset:17600
    v_cvt_pk_bf16_f32 v104, v36, v37
    v_mfma_f32_16x16x32_bf16 v[172:175], a[220:223], v[92:95], v[172:175]
    s_mov_b32 s45, 3948544
    s_waitcnt lgkmcnt(8)
    buffer_load_dwordx4 v6, s[24:27], s45 offen lds
    v_cvt_pk_bf16_f32 v105, v38, v39
    v_mfma_f32_16x16x32_bf16 v[144:147], a[224:227], v[80:83], v[144:147]
    ds_read_b64_tr_b16 a[248:249], v4 offset:224
    ds_read_b128 v[16:19], v9 offset:12544
    v_mfma_f32_16x16x32_bf16 v[144:147], a[228:231], v[84:87], v[144:147]
    ds_read_b64_tr_b16 a[250:251], v4 offset:736
    ds_read_b64_tr_b16 a[252:253], v4 offset:17120
    v_mfma_f32_16x16x32_bf16 v[176:179], a[224:227], v[88:91], v[176:179]
    s_add_u32 m0, s44, 20064
    ds_read_b64_tr_b16 a[254:255], v4 offset:17632
    ds_read_b128 v[20:23], v9 offset:12576
    v_mfma_f32_16x16x32_bf16 v[176:179], a[228:231], v[92:95], v[176:179]
    s_mov_b32 s45, 3956736
    s_waitcnt lgkmcnt(10)
    buffer_load_dwordx4 v6, s[24:27], s45 offen lds
    v_mfma_f32_16x16x32_bf16 v[148:151], a[232:235], v[80:83], v[148:151]
    ds_read_b64_tr_b16 a[192:193], v4 offset:256
    v_fma_mix_f32 v32, v98, v24, v28 op_sel:[0,0,0] op_sel_hi:[1,0,0]
    v_mfma_f32_16x16x32_bf16 v[148:151], a[236:239], v[84:87], v[148:151]
    ds_read_b64_tr_b16 a[194:195], v4 offset:768
    v_fma_mix_f32 v33, v98, v25, v29 op_sel:[1,0,0] op_sel_hi:[1,0,0]
    v_mfma_f32_16x16x32_bf16 v[180:183], a[232:235], v[88:91], v[180:183]
    ds_read_b64_tr_b16 a[196:197], v4 offset:17152
    v_fma_mix_f32 v34, v99, v26, v30 op_sel:[0,0,0] op_sel_hi:[1,0,0]
    v_mfma_f32_16x16x32_bf16 v[180:183], a[236:239], v[92:95], v[180:183]
    s_waitcnt lgkmcnt(9)
    ds_read_b64_tr_b16 a[198:199], v4 offset:17664
    v_fma_mix_f32 v35, v99, v27, v31 op_sel:[1,0,0] op_sel_hi:[1,0,0]
    v_mfma_f32_16x16x32_bf16 v[152:155], a[240:243], v[80:83], v[152:155]
    ds_read_b64_tr_b16 a[200:201], v4 offset:288
    v_cvt_pk_bf16_f32 v98, v32, v33
    v_mfma_f32_16x16x32_bf16 v[152:155], a[244:247], v[84:87], v[152:155]
    ds_read_b64_tr_b16 a[202:203], v4 offset:800
    v_cvt_pk_bf16_f32 v99, v34, v35
    v_mfma_f32_16x16x32_bf16 v[184:187], a[240:243], v[88:91], v[184:187]
    ds_read_b64_tr_b16 a[204:205], v4 offset:17184
    v_fma_mix_f32 v36, v106, v24, v28 op_sel:[0,0,0] op_sel_hi:[1,0,0]
    v_mfma_f32_16x16x32_bf16 v[184:187], a[244:247], v[92:95], v[184:187]
    s_waitcnt lgkmcnt(8)
    ds_read_b64_tr_b16 a[206:207], v4 offset:17696
    v_fma_mix_f32 v37, v106, v25, v29 op_sel:[1,0,0] op_sel_hi:[1,0,0]
    v_mfma_f32_16x16x32_bf16 v[156:159], a[248:251], v[80:83], v[156:159]
    ds_read_b64_tr_b16 a[208:209], v4 offset:320
    v_fma_mix_f32 v38, v107, v26, v30 op_sel:[0,0,0] op_sel_hi:[1,0,0]
    v_mfma_f32_16x16x32_bf16 v[156:159], a[252:255], v[84:87], v[156:159]
    ds_read_b64_tr_b16 a[210:211], v4 offset:832
    v_fma_mix_f32 v39, v107, v27, v31 op_sel:[1,0,0] op_sel_hi:[1,0,0]
    v_mfma_f32_16x16x32_bf16 v[188:191], a[248:251], v[88:91], v[188:191]
    ds_read_b64_tr_b16 a[212:213], v4 offset:17216
    v_cvt_pk_bf16_f32 v106, v36, v37
    v_mfma_f32_16x16x32_bf16 v[188:191], a[252:255], v[92:95], v[188:191]
    s_waitcnt lgkmcnt(7)
    ds_read_b64_tr_b16 a[214:215], v4 offset:17728
    v_cvt_pk_bf16_f32 v107, v38, v39
    v_mfma_f32_16x16x32_bf16 v[192:195], a[192:195], v[80:83], v[192:195]
    ds_read_b64_tr_b16 a[216:217], v4 offset:352
    ds_read_b128 v[24:27], v9 offset:12560
    v_mfma_f32_16x16x32_bf16 v[192:195], a[196:199], v[84:87], v[192:195]
    ds_read_b64_tr_b16 a[218:219], v4 offset:864
    ds_read_b64_tr_b16 a[220:221], v4 offset:17248
    v_fma_mix_f32 v32, v100, v16, v20 op_sel:[0,0,0] op_sel_hi:[1,0,0]
    v_mfma_f32_16x16x32_bf16 v[224:227], a[192:195], v[88:91], v[224:227]
    s_mov_b32 s54, 16384
    ds_read_b64_tr_b16 a[222:223], v4 offset:17760
    ds_read_b128 v[28:31], v9 offset:12592
    v_mfma_f32_16x16x32_bf16 v[224:227], a[196:199], v[92:95], v[224:227]
    s_waitcnt lgkmcnt(10)
    buffer_load_dwordx4 v[48:51], off, s[32:35], s54 sc1
    v_mfma_f32_16x16x32_bf16 v[196:199], a[200:203], v[80:83], v[196:199]
    ds_read_b64_tr_b16 a[224:225], v4 offset:384
    v_fma_mix_f32 v33, v100, v17, v21 op_sel:[1,0,0] op_sel_hi:[1,0,0]
    v_mfma_f32_16x16x32_bf16 v[196:199], a[204:207], v[84:87], v[196:199]
    ds_read_b64_tr_b16 a[226:227], v4 offset:896
    ds_read_b64_tr_b16 a[228:229], v4 offset:17280
    v_fma_mix_f32 v34, v101, v18, v22 op_sel:[0,0,0] op_sel_hi:[1,0,0]
    v_mfma_f32_16x16x32_bf16 v[228:231], a[200:203], v[88:91], v[228:231]
    s_mov_b32 s54, 17408
    ds_read_b64_tr_b16 a[230:231], v4 offset:17792
    v_fma_mix_f32 v35, v101, v19, v23 op_sel:[1,0,0] op_sel_hi:[1,0,0]
    v_mfma_f32_16x16x32_bf16 v[228:231], a[204:207], v[92:95], v[228:231]
    s_waitcnt lgkmcnt(10)
    buffer_load_dwordx4 v[52:55], off, s[32:35], s54 sc1
    v_mfma_f32_16x16x32_bf16 v[200:203], a[208:211], v[80:83], v[200:203]
    ds_read_b64_tr_b16 a[232:233], v4 offset:416
    v_cvt_pk_bf16_f32 v100, v32, v33
    v_mfma_f32_16x16x32_bf16 v[200:203], a[212:215], v[84:87], v[200:203]
    ds_read_b64_tr_b16 a[234:235], v4 offset:928
    ds_read_b64_tr_b16 a[236:237], v4 offset:17312
    v_cvt_pk_bf16_f32 v101, v34, v35
    v_mfma_f32_16x16x32_bf16 v[232:235], a[208:211], v[88:91], v[232:235]
    s_mov_b32 s54, 34816
    ds_read_b64_tr_b16 a[238:239], v4 offset:17824
    v_fma_mix_f32 v36, v108, v16, v20 op_sel:[0,0,0] op_sel_hi:[1,0,0]
    v_mfma_f32_16x16x32_bf16 v[232:235], a[212:215], v[92:95], v[232:235]
    s_waitcnt lgkmcnt(9)
    buffer_load_dwordx4 v[56:59], off, s[32:35], s54 sc1
    v_fma_mix_f32 v37, v108, v17, v21 op_sel:[1,0,0] op_sel_hi:[1,0,0]
    v_mfma_f32_16x16x32_bf16 v[204:207], a[216:219], v[80:83], v[204:207]
    ds_read_b64_tr_b16 a[240:241], v4 offset:448
    v_fma_mix_f32 v38, v109, v18, v22 op_sel:[0,0,0] op_sel_hi:[1,0,0]
    v_mfma_f32_16x16x32_bf16 v[204:207], a[220:223], v[84:87], v[204:207]
    ds_read_b64_tr_b16 a[242:243], v4 offset:960
    ds_read_b64_tr_b16 a[244:245], v4 offset:17344
    v_fma_mix_f32 v39, v109, v19, v23 op_sel:[1,0,0] op_sel_hi:[1,0,0]
    v_mfma_f32_16x16x32_bf16 v[236:239], a[216:219], v[88:91], v[236:239]
    s_mov_b32 s54, 35840
    ds_read_b64_tr_b16 a[246:247], v4 offset:17856
    v_cvt_pk_bf16_f32 v108, v36, v37
    v_mfma_f32_16x16x32_bf16 v[236:239], a[220:223], v[92:95], v[236:239]
    s_waitcnt lgkmcnt(8)
    buffer_load_dwordx4 v[60:63], off, s[32:35], s54 sc1
    v_cvt_pk_bf16_f32 v109, v38, v39
    v_mfma_f32_16x16x32_bf16 v[208:211], a[224:227], v[80:83], v[208:211]
    ds_read_b64_tr_b16 a[248:249], v4 offset:480
    ds_read_b128 v[16:19], v9 offset:12800
    v_mfma_f32_16x16x32_bf16 v[208:211], a[228:231], v[84:87], v[208:211]
    ds_read_b64_tr_b16 a[250:251], v4 offset:992
    ds_read_b128 v[20:23], v9 offset:12832
    v_mfma_f32_16x16x32_bf16 v[240:243], a[224:227], v[88:91], v[240:243]
    ds_read_b64_tr_b16 a[252:253], v4 offset:17376
    v_fma_mix_f32 v32, v102, v24, v28 op_sel:[0,0,0] op_sel_hi:[1,0,0]
    v_mfma_f32_16x16x32_bf16 v[240:243], a[228:231], v[92:95], v[240:243]
    s_waitcnt vmcnt(16)
    s_barrier
    s_waitcnt lgkmcnt(9)
    ds_read_b64_tr_b16 a[254:255], v4 offset:17888
    v_fma_mix_f32 v33, v102, v25, v29 op_sel:[1,0,0] op_sel_hi:[1,0,0]
    v_fma_mix_f32 v34, v103, v26, v30 op_sel:[0,0,0] op_sel_hi:[1,0,0]
    v_mfma_f32_16x16x32_bf16 v[212:215], a[232:235], v[80:83], v[212:215]
    ds_read_b64_tr_b16 a[192:193], v4 offset:36864
    v_fma_mix_f32 v35, v103, v27, v31 op_sel:[1,0,0] op_sel_hi:[1,0,0]
    v_mfma_f32_16x16x32_bf16 v[212:215], a[236:239], v[84:87], v[212:215]
    ds_read_b64_tr_b16 a[194:195], v4 offset:37376
    ds_read_b64_tr_b16 a[196:197], v4 offset:53760
    v_cvt_pk_bf16_f32 v102, v32, v33
    v_mfma_f32_16x16x32_bf16 v[244:247], a[232:235], v[88:91], v[244:247]
    s_add_u32 m0, s44, 36864
    ds_read_b64_tr_b16 a[198:199], v4 offset:54272
    v_cvt_pk_bf16_f32 v103, v34, v35
    v_mfma_f32_16x16x32_bf16 v[244:247], a[236:239], v[92:95], v[244:247]
    s_mov_b32 s45, 4194304
    s_waitcnt lgkmcnt(10)
    buffer_load_dwordx4 v6, s[24:27], s45 offen lds
    v_mfma_f32_16x16x32_bf16 v[216:219], a[240:243], v[80:83], v[216:219]
    ds_read_b64_tr_b16 a[200:201], v4 offset:36896
    v_fma_mix_f32 v36, v110, v24, v28 op_sel:[0,0,0] op_sel_hi:[1,0,0]
    v_mfma_f32_16x16x32_bf16 v[216:219], a[244:247], v[84:87], v[216:219]
    ds_read_b64_tr_b16 a[202:203], v4 offset:37408
    ds_read_b64_tr_b16 a[204:205], v4 offset:53792
    v_fma_mix_f32 v37, v110, v25, v29 op_sel:[1,0,0] op_sel_hi:[1,0,0]
    v_mfma_f32_16x16x32_bf16 v[248:251], a[240:243], v[88:91], v[248:251]
    s_add_u32 m0, s44, 37920
    ds_read_b64_tr_b16 a[206:207], v4 offset:54304
    v_fma_mix_f32 v38, v111, v26, v30 op_sel:[0,0,0] op_sel_hi:[1,0,0]
    v_mfma_f32_16x16x32_bf16 v[248:251], a[244:247], v[92:95], v[248:251]
    s_mov_b32 s45, 4202496
    s_waitcnt lgkmcnt(8)
    buffer_load_dwordx4 v6, s[24:27], s45 offen lds
    v_mfma_f32_16x16x32_bf16 v[220:223], a[248:251], v[80:83], v[220:223]
    ds_read_b64_tr_b16 a[208:209], v4 offset:36928
    v_fma_mix_f32 v39, v111, v27, v31 op_sel:[1,0,0] op_sel_hi:[1,0,0]
    v_mfma_f32_16x16x32_bf16 v[220:223], a[252:255], v[84:87], v[220:223]
    ds_read_b64_tr_b16 a[210:211], v4 offset:37440
    ds_read_b64_tr_b16 a[212:213], v4 offset:53824
    v_cvt_pk_bf16_f32 v110, v36, v37
    v_mfma_f32_16x16x32_bf16 v[252:255], a[248:251], v[88:91], v[252:255]
    s_add_u32 m0, s44, 38976
    ds_read_b64_tr_b16 a[214:215], v4 offset:54336
    v_cvt_pk_bf16_f32 v111, v38, v39
    v_mfma_f32_16x16x32_bf16 v[252:255], a[252:255], v[92:95], v[252:255]
    s_mov_b32 s45, 4210688
    s_waitcnt lgkmcnt(8)
    buffer_load_dwordx4 v6, s[24:27], s45 offen lds
    v_mfma_f32_16x16x32_bf16 v[128:131], a[192:195], v[96:99], v[128:131]
    s_waitcnt vmcnt(15)
    ds_read_b64_tr_b16 a[216:217], v4 offset:36960
    ds_read_b128 v[24:27], v9 offset:12816
    v_mfma_f32_16x16x32_bf16 v[128:131], a[196:199], v[100:103], v[128:131]
    ds_read_b64_tr_b16 a[218:219], v4 offset:37472
    ds_read_b64_tr_b16 a[220:221], v4 offset:53856
    v_fma_mix_f32 v32, v112, v16, v20 op_sel:[0,0,0] op_sel_hi:[1,0,0]
    v_mfma_f32_16x16x32_bf16 v[160:163], a[192:195], v[104:107], v[160:163]
    s_add_u32 m0, s44, 40032
    ds_read_b64_tr_b16 a[222:223], v4 offset:54368
    ds_read_b128 v[28:31], v9 offset:12848
    v_mfma_f32_16x16x32_bf16 v[160:163], a[196:199], v[108:111], v[160:163]
    s_mov_b32 s45, 4218880
    s_waitcnt lgkmcnt(10)
    buffer_load_dwordx4 v6, s[24:27], s45 offen lds
    v_mfma_f32_16x16x32_bf16 v[132:135], a[200:203], v[96:99], v[132:135]
    ds_read_b64_tr_b16 a[224:225], v4 offset:36992
    v_fma_mix_f32 v33, v112, v17, v21 op_sel:[1,0,0] op_sel_hi:[1,0,0]
    v_mfma_f32_16x16x32_bf16 v[132:135], a[204:207], v[100:103], v[132:135]
    ds_read_b64_tr_b16 a[226:227], v4 offset:37504
    ds_read_b64_tr_b16 a[228:229], v4 offset:53888
    v_fma_mix_f32 v34, v113, v18, v22 op_sel:[0,0,0] op_sel_hi:[1,0,0]
    v_mfma_f32_16x16x32_bf16 v[164:167], a[200:203], v[104:107], v[164:167]
    s_add_u32 m0, s44, 53760
    ds_read_b64_tr_b16 a[230:231], v4 offset:54400
    v_fma_mix_f32 v35, v113, v19, v23 op_sel:[1,0,0] op_sel_hi:[1,0,0]
    v_mfma_f32_16x16x32_bf16 v[164:167], a[204:207], v[108:111], v[164:167]
    s_mov_b32 s45, 4456448
    s_waitcnt lgkmcnt(10)
    buffer_load_dwordx4 v6, s[24:27], s45 offen lds
    v_mfma_f32_16x16x32_bf16 v[136:139], a[208:211], v[96:99], v[136:139]
    ds_read_b64_tr_b16 a[232:233], v4 offset:37024
    v_cvt_pk_bf16_f32 v112, v32, v33
    v_mfma_f32_16x16x32_bf16 v[136:139], a[212:215], v[100:103], v[136:139]
    ds_read_b64_tr_b16 a[234:235], v4 offset:37536
    ds_read_b64_tr_b16 a[236:237], v4 offset:53920
    v_cvt_pk_bf16_f32 v113, v34, v35
    v_mfma_f32_16x16x32_bf16 v[168:171], a[208:211], v[104:107], v[168:171]
    s_add_u32 m0, s44, 54816
    ds_read_b64_tr_b16 a[238:239], v4 offset:54432
    v_fma_mix_f32 v36, v120, v16, v20 op_sel:[0,0,0] op_sel_hi:[1,0,0]
    v_mfma_f32_16x16x32_bf16 v[168:171], a[212:215], v[108:111], v[168:171]
    s_mov_b32 s45, 4464640
    s_waitcnt lgkmcnt(9)
    buffer_load_dwordx4 v6, s[24:27], s45 offen lds
    v_fma_mix_f32 v37, v120, v17, v21 op_sel:[1,0,0] op_sel_hi:[1,0,0]
    v_mfma_f32_16x16x32_bf16 v[140:143], a[216:219], v[96:99], v[140:143]
L2_pad2:
    s_cbranch_execz L2_pad6
    ds_read_b64_tr_b16 a[240:241], v4 offset:37056
    v_fma_mix_f32 v38, v121, v18, v22 op_sel:[0,0,0] op_sel_hi:[1,0,0]
    v_mfma_f32_16x16x32_bf16 v[140:143], a[220:223], v[100:103], v[140:143]
    ds_read_b64_tr_b16 a[242:243], v4 offset:37568
    ds_read_b64_tr_b16 a[244:245], v4 offset:53952
    v_fma_mix_f32 v39, v121, v19, v23 op_sel:[1,0,0] op_sel_hi:[1,0,0]
    v_mfma_f32_16x16x32_bf16 v[172:175], a[216:219], v[104:107], v[172:175]
    s_add_u32 m0, s44, 55872
    ds_read_b64_tr_b16 a[246:247], v4 offset:54464
    v_cvt_pk_bf16_f32 v120, v36, v37
    v_mfma_f32_16x16x32_bf16 v[172:175], a[220:223], v[108:111], v[172:175]
    s_mov_b32 s45, 4472832
    s_waitcnt lgkmcnt(8)
    buffer_load_dwordx4 v6, s[24:27], s45 offen lds
    v_cvt_pk_bf16_f32 v121, v38, v39
    v_mfma_f32_16x16x32_bf16 v[144:147], a[224:227], v[96:99], v[144:147]
    ds_read_b64_tr_b16 a[248:249], v4 offset:37088
    ds_read_b128 v[16:19], v9 offset:13056
    v_mfma_f32_16x16x32_bf16 v[144:147], a[228:231], v[100:103], v[144:147]
    ds_read_b64_tr_b16 a[250:251], v4 offset:37600
    ds_read_b64_tr_b16 a[252:253], v4 offset:53984
    v_mfma_f32_16x16x32_bf16 v[176:179], a[224:227], v[104:107], v[176:179]
    s_add_u32 m0, s44, 56928
    ds_read_b64_tr_b16 a[254:255], v4 offset:54496
    ds_read_b128 v[20:23], v9 offset:13088
    v_mfma_f32_16x16x32_bf16 v[176:179], a[228:231], v[108:111], v[176:179]
    s_mov_b32 s45, 4481024
    s_waitcnt lgkmcnt(10)
    buffer_load_dwordx4 v6, s[24:27], s45 offen lds
    v_mfma_f32_16x16x32_bf16 v[148:151], a[232:235], v[96:99], v[148:151]
    ds_read_b64_tr_b16 a[192:193], v4 offset:37120
    v_fma_mix_f32 v32, v114, v24, v28 op_sel:[0,0,0] op_sel_hi:[1,0,0]
    v_mfma_f32_16x16x32_bf16 v[148:151], a[236:239], v[100:103], v[148:151]
    ds_read_b64_tr_b16 a[194:195], v4 offset:37632
    v_fma_mix_f32 v33, v114, v25, v29 op_sel:[1,0,0] op_sel_hi:[1,0,0]
    v_mfma_f32_16x16x32_bf16 v[180:183], a[232:235], v[104:107], v[180:183]
    ds_read_b64_tr_b16 a[196:197], v4 offset:54016
    v_fma_mix_f32 v34, v115, v26, v30 op_sel:[0,0,0] op_sel_hi:[1,0,0]
    v_mfma_f32_16x16x32_bf16 v[180:183], a[236:239], v[108:111], v[180:183]
    s_waitcnt lgkmcnt(9)
    ds_read_b64_tr_b16 a[198:199], v4 offset:54528
    v_fma_mix_f32 v35, v115, v27, v31 op_sel:[1,0,0] op_sel_hi:[1,0,0]
    v_mfma_f32_16x16x32_bf16 v[152:155], a[240:243], v[96:99], v[152:155]
    ds_read_b64_tr_b16 a[200:201], v4 offset:37152
    v_cvt_pk_bf16_f32 v114, v32, v33
    v_mfma_f32_16x16x32_bf16 v[152:155], a[244:247], v[100:103], v[152:155]
    ds_read_b64_tr_b16 a[202:203], v4 offset:37664
    v_cvt_pk_bf16_f32 v115, v34, v35
    v_mfma_f32_16x16x32_bf16 v[184:187], a[240:243], v[104:107], v[184:187]
    ds_read_b64_tr_b16 a[204:205], v4 offset:54048
    v_fma_mix_f32 v36, v122, v24, v28 op_sel:[0,0,0] op_sel_hi:[1,0,0]
    v_mfma_f32_16x16x32_bf16 v[184:187], a[244:247], v[108:111], v[184:187]
    s_waitcnt lgkmcnt(8)
    ds_read_b64_tr_b16 a[206:207], v4 offset:54560
    v_fma_mix_f32 v37, v122, v25, v29 op_sel:[1,0,0] op_sel_hi:[1,0,0]
    v_mfma_f32_16x16x32_bf16 v[156:159], a[248:251], v[96:99], v[156:159]
    ds_read_b64_tr_b16 a[208:209], v4 offset:37184
    v_fma_mix_f32 v38, v123, v26, v30 op_sel:[0,0,0] op_sel_hi:[1,0,0]
    v_mfma_f32_16x16x32_bf16 v[156:159], a[252:255], v[100:103], v[156:159]
    ds_read_b64_tr_b16 a[210:211], v4 offset:37696
    v_fma_mix_f32 v39, v123, v27, v31 op_sel:[1,0,0] op_sel_hi:[1,0,0]
    v_mfma_f32_16x16x32_bf16 v[188:191], a[248:251], v[104:107], v[188:191]
    ds_read_b64_tr_b16 a[212:213], v4 offset:54080
    v_cvt_pk_bf16_f32 v122, v36, v37
    v_mfma_f32_16x16x32_bf16 v[188:191], a[252:255], v[108:111], v[188:191]
    s_waitcnt lgkmcnt(7)
    ds_read_b64_tr_b16 a[214:215], v4 offset:54592
    v_cvt_pk_bf16_f32 v123, v38, v39
    v_mfma_f32_16x16x32_bf16 v[192:195], a[192:195], v[96:99], v[192:195]
    ds_read_b64_tr_b16 a[216:217], v4 offset:37216
    ds_read_b128 v[24:27], v9 offset:13072
    v_mfma_f32_16x16x32_bf16 v[192:195], a[196:199], v[100:103], v[192:195]
    ds_read_b64_tr_b16 a[218:219], v4 offset:37728
    ds_read_b128 v[28:31], v9 offset:13104
    v_mfma_f32_16x16x32_bf16 v[224:227], a[192:195], v[104:107], v[224:227]
    ds_read_b64_tr_b16 a[220:221], v4 offset:54112
    v_fma_mix_f32 v32, v116, v16, v20 op_sel:[0,0,0] op_sel_hi:[1,0,0]
    v_mfma_f32_16x16x32_bf16 v[224:227], a[196:199], v[108:111], v[224:227]
    s_waitcnt lgkmcnt(9)
    ds_read_b64_tr_b16 a[222:223], v4 offset:54624
    v_fma_mix_f32 v33, v116, v17, v21 op_sel:[1,0,0] op_sel_hi:[1,0,0]
    v_mfma_f32_16x16x32_bf16 v[196:199], a[200:203], v[96:99], v[196:199]
    ds_read_b64_tr_b16 a[224:225], v4 offset:37248
    v_fma_mix_f32 v34, v117, v18, v22 op_sel:[0,0,0] op_sel_hi:[1,0,0]
    v_mfma_f32_16x16x32_bf16 v[196:199], a[204:207], v[100:103], v[196:199]
    ds_read_b64_tr_b16 a[226:227], v4 offset:37760
    v_fma_mix_f32 v35, v117, v19, v23 op_sel:[1,0,0] op_sel_hi:[1,0,0]
    v_mfma_f32_16x16x32_bf16 v[228:231], a[200:203], v[104:107], v[228:231]
    ds_read_b64_tr_b16 a[228:229], v4 offset:54144
    v_cvt_pk_bf16_f32 v116, v32, v33
    v_mfma_f32_16x16x32_bf16 v[228:231], a[204:207], v[108:111], v[228:231]
    s_waitcnt lgkmcnt(9)
    ds_read_b64_tr_b16 a[230:231], v4 offset:54656
    v_cvt_pk_bf16_f32 v117, v34, v35
    v_mfma_f32_16x16x32_bf16 v[200:203], a[208:211], v[96:99], v[200:203]
    ds_read_b64_tr_b16 a[232:233], v4 offset:37280
    v_fma_mix_f32 v36, v124, v16, v20 op_sel:[0,0,0] op_sel_hi:[1,0,0]
    v_mfma_f32_16x16x32_bf16 v[200:203], a[212:215], v[100:103], v[200:203]
    ds_read_b64_tr_b16 a[234:235], v4 offset:37792
    v_fma_mix_f32 v37, v124, v17, v21 op_sel:[1,0,0] op_sel_hi:[1,0,0]
    v_mfma_f32_16x16x32_bf16 v[232:235], a[208:211], v[104:107], v[232:235]
    ds_read_b64_tr_b16 a[236:237], v4 offset:54176
    v_fma_mix_f32 v38, v125, v18, v22 op_sel:[0,0,0] op_sel_hi:[1,0,0]
    v_mfma_f32_16x16x32_bf16 v[232:235], a[212:215], v[108:111], v[232:235]
    s_waitcnt lgkmcnt(7)
    ds_read_b64_tr_b16 a[238:239], v4 offset:54688
    v_fma_mix_f32 v39, v125, v19, v23 op_sel:[1,0,0] op_sel_hi:[1,0,0]
    v_mfma_f32_16x16x32_bf16 v[204:207], a[216:219], v[96:99], v[204:207]
    ds_read_b64_tr_b16 a[240:241], v4 offset:37312
    v_cvt_pk_bf16_f32 v124, v36, v37
    v_mfma_f32_16x16x32_bf16 v[204:207], a[220:223], v[100:103], v[204:207]
    ds_read_b64_tr_b16 a[242:243], v4 offset:37824
    v_cvt_pk_bf16_f32 v125, v38, v39
    v_mfma_f32_16x16x32_bf16 v[236:239], a[216:219], v[104:107], v[236:239]
    ds_read_b64_tr_b16 a[244:245], v4 offset:54208
    v_mfma_f32_16x16x32_bf16 v[236:239], a[220:223], v[108:111], v[236:239]
    s_waitcnt lgkmcnt(7)
    ds_read_b64_tr_b16 a[246:247], v4 offset:54720
    v_mfma_f32_16x16x32_bf16 v[208:211], a[224:227], v[96:99], v[208:211]
    ds_read_b64_tr_b16 a[248:249], v4 offset:37344
    ds_read_b128 v[16:19], v9 offset:13312
    v_mfma_f32_16x16x32_bf16 v[208:211], a[228:231], v[100:103], v[208:211]
    ds_read_b64_tr_b16 a[250:251], v4 offset:37856
    ds_read_b128 v[20:23], v9 offset:13344
    v_mfma_f32_16x16x32_bf16 v[240:243], a[224:227], v[104:107], v[240:243]
    ds_read_b64_tr_b16 a[252:253], v4 offset:54240
    v_fma_mix_f32 v32, v118, v24, v28 op_sel:[0,0,0] op_sel_hi:[1,0,0]
    v_mfma_f32_16x16x32_bf16 v[240:243], a[228:231], v[108:111], v[240:243]
    s_waitcnt vmcnt(12)
    s_barrier
    s_waitcnt lgkmcnt(9)
    ds_read_b64_tr_b16 a[254:255], v4 offset:54752
    v_fma_mix_f32 v33, v118, v25, v29 op_sel:[1,0,0] op_sel_hi:[1,0,0]
    v_fma_mix_f32 v34, v119, v26, v30 op_sel:[0,0,0] op_sel_hi:[1,0,0]
    v_mfma_f32_16x16x32_bf16 v[212:215], a[232:235], v[96:99], v[212:215]
    ds_read_b64_tr_b16 a[192:193], v3 offset:0
    v_fma_mix_f32 v35, v119, v27, v31 op_sel:[1,0,0] op_sel_hi:[1,0,0]
    v_mfma_f32_16x16x32_bf16 v[212:215], a[236:239], v[100:103], v[212:215]
    ds_read_b64_tr_b16 a[194:195], v3 offset:512
    ds_read_b64_tr_b16 a[196:197], v3 offset:16896
    v_cvt_pk_bf16_f32 v118, v32, v33
    v_mfma_f32_16x16x32_bf16 v[244:247], a[232:235], v[104:107], v[244:247]
    s_add_u32 m0, s44, 73728
    ds_read_b64_tr_b16 a[198:199], v3 offset:17408
    v_cvt_pk_bf16_f32 v119, v34, v35
    v_mfma_f32_16x16x32_bf16 v[244:247], a[236:239], v[108:111], v[244:247]
    s_mov_b32 s46, 0
    s_waitcnt lgkmcnt(10)
    buffer_load_dwordx4 off, s[16:19], s46 offset:0 lds
    v_mfma_f32_16x16x32_bf16 v[216:219], a[240:243], v[96:99], v[216:219]
    ds_read_b64_tr_b16 a[200:201], v3 offset:32
    v_fma_mix_f32 v36, v126, v24, v28 op_sel:[0,0,0] op_sel_hi:[1,0,0]
    v_mfma_f32_16x16x32_bf16 v[216:219], a[244:247], v[100:103], v[216:219]
    ds_read_b64_tr_b16 a[202:203], v3 offset:544
    ds_read_b64_tr_b16 a[204:205], v3 offset:16928
    v_fma_mix_f32 v37, v126, v25, v29 op_sel:[1,0,0] op_sel_hi:[1,0,0]
    v_mfma_f32_16x16x32_bf16 v[248:251], a[240:243], v[104:107], v[248:251]
    s_add_u32 m0, s44, 73760
    ds_read_b64_tr_b16 a[206:207], v3 offset:17440
    v_fma_mix_f32 v38, v127, v26, v30 op_sel:[0,0,0] op_sel_hi:[1,0,0]
    v_mfma_f32_16x16x32_bf16 v[248:251], a[244:247], v[108:111], v[248:251]
    s_waitcnt lgkmcnt(8)
    buffer_load_dwordx4 off, s[16:19], s46 offset:1024 lds
    v_mfma_f32_16x16x32_bf16 v[220:223], a[248:251], v[96:99], v[220:223]
    ds_read_b64_tr_b16 a[208:209], v3 offset:64
    v_fma_mix_f32 v39, v127, v27, v31 op_sel:[1,0,0] op_sel_hi:[1,0,0]
    v_mfma_f32_16x16x32_bf16 v[220:223], a[252:255], v[100:103], v[220:223]
    ds_read_b64_tr_b16 a[210:211], v3 offset:576
    ds_read_b64_tr_b16 a[212:213], v3 offset:16960
    v_cvt_pk_bf16_f32 v126, v36, v37
    v_mfma_f32_16x16x32_bf16 v[252:255], a[248:251], v[104:107], v[252:255]
    s_add_u32 m0, s44, 73792
    ds_read_b64_tr_b16 a[214:215], v3 offset:17472
    v_cvt_pk_bf16_f32 v127, v38, v39
    v_mfma_f32_16x16x32_bf16 v[252:255], a[252:255], v[108:111], v[252:255]
    s_waitcnt lgkmcnt(8)
    buffer_load_dwordx4 off, s[16:19], s46 offset:2048 lds
    v_mfma_f32_16x16x32_bf16 v[128:131], a[192:195], v[112:115], v[128:131]
    s_waitcnt vmcnt(11)
    ds_read_b64_tr_b16 a[216:217], v3 offset:96
    ds_read_b128 v[24:27], v9 offset:13328
    v_mfma_f32_16x16x32_bf16 v[128:131], a[196:199], v[116:119], v[128:131]
    ds_read_b64_tr_b16 a[218:219], v3 offset:608
    ds_read_b64_tr_b16 a[220:221], v3 offset:16992
    v_fma_mix_f32 v32, v48, v16, v20 op_sel:[0,0,0] op_sel_hi:[1,0,0]
    v_mfma_f32_16x16x32_bf16 v[160:163], a[192:195], v[120:123], v[160:163]
    s_add_u32 m0, s44, 73824
    ds_read_b64_tr_b16 a[222:223], v3 offset:17504
    ds_read_b128 v[28:31], v9 offset:13360
    v_mfma_f32_16x16x32_bf16 v[160:163], a[196:199], v[124:127], v[160:163]
    s_waitcnt lgkmcnt(10)
    buffer_load_dwordx4 off, s[16:19], s46 offset:3072 lds
    v_mfma_f32_16x16x32_bf16 v[132:135], a[200:203], v[112:115], v[132:135]
    ds_read_b64_tr_b16 a[224:225], v3 offset:128
    v_fma_mix_f32 v33, v48, v17, v21 op_sel:[1,0,0] op_sel_hi:[1,0,0]
    v_mfma_f32_16x16x32_bf16 v[132:135], a[204:207], v[116:119], v[132:135]
    ds_read_b64_tr_b16 a[226:227], v3 offset:640
    ds_read_b64_tr_b16 a[228:229], v3 offset:17024
    v_fma_mix_f32 v34, v49, v18, v22 op_sel:[0,0,0] op_sel_hi:[1,0,0]
    v_mfma_f32_16x16x32_bf16 v[164:167], a[200:203], v[120:123], v[164:167]
    s_add_u32 m0, s44, 90624
    ds_read_b64_tr_b16 a[230:231], v3 offset:17536
    v_fma_mix_f32 v35, v49, v19, v23 op_sel:[1,0,0] op_sel_hi:[1,0,0]
    v_mfma_f32_16x16x32_bf16 v[164:167], a[204:207], v[124:127], v[164:167]
    s_waitcnt lgkmcnt(10)
    buffer_load_dwordx4 off, s[20:23], s46 offset:0 lds
    v_mfma_f32_16x16x32_bf16 v[136:139], a[208:211], v[112:115], v[136:139]
    ds_read_b64_tr_b16 a[232:233], v3 offset:160
    v_cvt_pk_bf16_f32 v48, v32, v33
    v_mfma_f32_16x16x32_bf16 v[136:139], a[212:215], v[116:119], v[136:139]
    ds_read_b64_tr_b16 a[234:235], v3 offset:672
    ds_read_b64_tr_b16 a[236:237], v3 offset:17056
    v_cvt_pk_bf16_f32 v49, v34, v35
    v_mfma_f32_16x16x32_bf16 v[168:171], a[208:211], v[120:123], v[168:171]
    s_add_u32 m0, s44, 90656
    ds_read_b64_tr_b16 a[238:239], v3 offset:17568
    v_fma_mix_f32 v36, v56, v16, v20 op_sel:[0,0,0] op_sel_hi:[1,0,0]
    v_mfma_f32_16x16x32_bf16 v[168:171], a[212:215], v[124:127], v[168:171]
    s_waitcnt lgkmcnt(9)
    buffer_load_dwordx4 off, s[20:23], s46 offset:1024 lds
    v_fma_mix_f32 v37, v56, v17, v21 op_sel:[1,0,0] op_sel_hi:[1,0,0]
    v_mfma_f32_16x16x32_bf16 v[140:143], a[216:219], v[112:115], v[140:143]
    ds_read_b64_tr_b16 a[240:241], v3 offset:192
    v_fma_mix_f32 v38, v57, v18, v22 op_sel:[0,0,0] op_sel_hi:[1,0,0]
    v_mfma_f32_16x16x32_bf16 v[140:143], a[220:223], v[116:119], v[140:143]
    ds_read_b64_tr_b16 a[242:243], v3 offset:704
    ds_read_b64_tr_b16 a[244:245], v3 offset:17088
    v_fma_mix_f32 v39, v57, v19, v23 op_sel:[1,0,0] op_sel_hi:[1,0,0]
    v_mfma_f32_16x16x32_bf16 v[172:175], a[216:219], v[120:123], v[172:175]
    s_add_u32 m0, s44, 90688
    ds_read_b64_tr_b16 a[246:247], v3 offset:17600
    v_cvt_pk_bf16_f32 v56, v36, v37
    v_mfma_f32_16x16x32_bf16 v[172:175], a[220:223], v[124:127], v[172:175]
    s_waitcnt lgkmcnt(8)
    buffer_load_dwordx4 off, s[20:23], s46 offset:2048 lds
    v_cvt_pk_bf16_f32 v57, v38, v39
    v_mfma_f32_16x16x32_bf16 v[144:147], a[224:227], v[112:115], v[144:147]
    ds_read_b64_tr_b16 a[248:249], v3 offset:224
    ds_read_b128 v[16:19], v9 offset:13568
    v_mfma_f32_16x16x32_bf16 v[144:147], a[228:231], v[116:119], v[144:147]
    ds_read_b64_tr_b16 a[250:251], v3 offset:736
    ds_read_b64_tr_b16 a[252:253], v3 offset:17120
    v_mfma_f32_16x16x32_bf16 v[176:179], a[224:227], v[120:123], v[176:179]
    s_add_u32 m0, s44, 90720
    ds_read_b64_tr_b16 a[254:255], v3 offset:17632
    ds_read_b128 v[20:23], v9 offset:13600
    v_mfma_f32_16x16x32_bf16 v[176:179], a[228:231], v[124:127], v[176:179]
    s_waitcnt lgkmcnt(10)
    buffer_load_dwordx4 off, s[20:23], s46 offset:3072 lds
    v_mfma_f32_16x16x32_bf16 v[148:151], a[232:235], v[112:115], v[148:151]
    ds_read_b64_tr_b16 a[192:193], v3 offset:256
    v_fma_mix_f32 v32, v50, v24, v28 op_sel:[0,0,0] op_sel_hi:[1,0,0]
    v_mfma_f32_16x16x32_bf16 v[148:151], a[236:239], v[116:119], v[148:151]
    ds_read_b64_tr_b16 a[194:195], v3 offset:768
    v_fma_mix_f32 v33, v50, v25, v29 op_sel:[1,0,0] op_sel_hi:[1,0,0]
    v_mfma_f32_16x16x32_bf16 v[180:183], a[232:235], v[120:123], v[180:183]
    ds_read_b64_tr_b16 a[196:197], v3 offset:17152
    v_fma_mix_f32 v34, v51, v26, v30 op_sel:[0,0,0] op_sel_hi:[1,0,0]
    v_mfma_f32_16x16x32_bf16 v[180:183], a[236:239], v[124:127], v[180:183]
    s_waitcnt lgkmcnt(9)
    ds_read_b64_tr_b16 a[198:199], v3 offset:17664
    v_fma_mix_f32 v35, v51, v27, v31 op_sel:[1,0,0] op_sel_hi:[1,0,0]
    v_mfma_f32_16x16x32_bf16 v[152:155], a[240:243], v[112:115], v[152:155]
    ds_read_b64_tr_b16 a[200:201], v3 offset:288
    v_cvt_pk_bf16_f32 v50, v32, v33
    v_mfma_f32_16x16x32_bf16 v[152:155], a[244:247], v[116:119], v[152:155]
    ds_read_b64_tr_b16 a[202:203], v3 offset:800
    v_cvt_pk_bf16_f32 v51, v34, v35
    v_mfma_f32_16x16x32_bf16 v[184:187], a[240:243], v[120:123], v[184:187]
    ds_read_b64_tr_b16 a[204:205], v3 offset:17184
    v_fma_mix_f32 v36, v58, v24, v28 op_sel:[0,0,0] op_sel_hi:[1,0,0]
    v_mfma_f32_16x16x32_bf16 v[184:187], a[244:247], v[124:127], v[184:187]
    s_waitcnt lgkmcnt(8)
    ds_read_b64_tr_b16 a[206:207], v3 offset:17696
    v_fma_mix_f32 v37, v58, v25, v29 op_sel:[1,0,0] op_sel_hi:[1,0,0]
    v_mfma_f32_16x16x32_bf16 v[156:159], a[248:251], v[112:115], v[156:159]
    ds_read_b64_tr_b16 a[208:209], v3 offset:320
    v_fma_mix_f32 v38, v59, v26, v30 op_sel:[0,0,0] op_sel_hi:[1,0,0]
    v_mfma_f32_16x16x32_bf16 v[156:159], a[252:255], v[116:119], v[156:159]
    ds_read_b64_tr_b16 a[210:211], v3 offset:832
    v_fma_mix_f32 v39, v59, v27, v31 op_sel:[1,0,0] op_sel_hi:[1,0,0]
    v_mfma_f32_16x16x32_bf16 v[188:191], a[248:251], v[120:123], v[188:191]
    ds_read_b64_tr_b16 a[212:213], v3 offset:17216
    v_cvt_pk_bf16_f32 v58, v36, v37
    v_mfma_f32_16x16x32_bf16 v[188:191], a[252:255], v[124:127], v[188:191]
    s_waitcnt lgkmcnt(7)
    ds_read_b64_tr_b16 a[214:215], v3 offset:17728
    v_cvt_pk_bf16_f32 v59, v38, v39
    v_mfma_f32_16x16x32_bf16 v[192:195], a[192:195], v[112:115], v[192:195]
    ds_read_b64_tr_b16 a[216:217], v3 offset:352
    ds_read_b128 v[24:27], v9 offset:13584
    v_mfma_f32_16x16x32_bf16 v[192:195], a[196:199], v[116:119], v[192:195]
    ds_read_b64_tr_b16 a[218:219], v3 offset:864
    ds_read_b128 v[28:31], v9 offset:13616
    v_mfma_f32_16x16x32_bf16 v[224:227], a[192:195], v[120:123], v[224:227]
    ds_read_b64_tr_b16 a[220:221], v3 offset:17248
    v_fma_mix_f32 v32, v52, v16, v20 op_sel:[0,0,0] op_sel_hi:[1,0,0]
    v_mfma_f32_16x16x32_bf16 v[224:227], a[196:199], v[124:127], v[224:227]
    s_waitcnt lgkmcnt(9)
    ds_read_b64_tr_b16 a[222:223], v3 offset:17760
    v_fma_mix_f32 v33, v52, v17, v21 op_sel:[1,0,0] op_sel_hi:[1,0,0]
    v_mfma_f32_16x16x32_bf16 v[196:199], a[200:203], v[112:115], v[196:199]
    ds_read_b64_tr_b16 a[224:225], v3 offset:384
    v_fma_mix_f32 v34, v53, v18, v22 op_sel:[0,0,0] op_sel_hi:[1,0,0]
    v_mfma_f32_16x16x32_bf16 v[196:199], a[204:207], v[116:119], v[196:199]
    ds_read_b64_tr_b16 a[226:227], v3 offset:896
    v_fma_mix_f32 v35, v53, v19, v23 op_sel:[1,0,0] op_sel_hi:[1,0,0]
    v_mfma_f32_16x16x32_bf16 v[228:231], a[200:203], v[120:123], v[228:231]
    ds_read_b64_tr_b16 a[228:229], v3 offset:17280
    v_cvt_pk_bf16_f32 v52, v32, v33
    v_mfma_f32_16x16x32_bf16 v[228:231], a[204:207], v[124:127], v[228:231]
    s_waitcnt lgkmcnt(9)
    ds_read_b64_tr_b16 a[230:231], v3 offset:17792
    v_cvt_pk_bf16_f32 v53, v34, v35
    v_mfma_f32_16x16x32_bf16 v[200:203], a[208:211], v[112:115], v[200:203]
    ds_read_b64_tr_b16 a[232:233], v3 offset:416
    v_fma_mix_f32 v36, v60, v16, v20 op_sel:[0,0,0] op_sel_hi:[1,0,0]
    v_mfma_f32_16x16x32_bf16 v[200:203], a[212:215], v[116:119], v[200:203]
    ds_read_b64_tr_b16 a[234:235], v3 offset:928
    v_fma_mix_f32 v37, v60, v17, v21 op_sel:[1,0,0] op_sel_hi:[1,0,0]
    v_mfma_f32_16x16x32_bf16 v[232:235], a[208:211], v[120:123], v[232:235]
    ds_read_b64_tr_b16 a[236:237], v3 offset:17312
    v_fma_mix_f32 v38, v61, v18, v22 op_sel:[0,0,0] op_sel_hi:[1,0,0]
    v_mfma_f32_16x16x32_bf16 v[232:235], a[212:215], v[124:127], v[232:235]
    s_waitcnt lgkmcnt(7)
    ds_read_b64_tr_b16 a[238:239], v3 offset:17824
    v_fma_mix_f32 v39, v61, v19, v23 op_sel:[1,0,0] op_sel_hi:[1,0,0]
    v_mfma_f32_16x16x32_bf16 v[204:207], a[216:219], v[112:115], v[204:207]
    ds_read_b64_tr_b16 a[240:241], v3 offset:448
    v_cvt_pk_bf16_f32 v60, v36, v37
    v_mfma_f32_16x16x32_bf16 v[204:207], a[220:223], v[116:119], v[204:207]
    ds_read_b64_tr_b16 a[242:243], v3 offset:960
    v_cvt_pk_bf16_f32 v61, v38, v39
    v_mfma_f32_16x16x32_bf16 v[236:239], a[216:219], v[120:123], v[236:239]
    ds_read_b64_tr_b16 a[244:245], v3 offset:17344
    v_mfma_f32_16x16x32_bf16 v[236:239], a[220:223], v[124:127], v[236:239]
    s_waitcnt lgkmcnt(7)
    ds_read_b64_tr_b16 a[246:247], v3 offset:17856
    v_mfma_f32_16x16x32_bf16 v[208:211], a[224:227], v[112:115], v[208:211]
    ds_read_b64_tr_b16 a[248:249], v3 offset:480
    v_fma_mix_f32 v32, v54, v24, v28 op_sel:[0,0,0] op_sel_hi:[1,0,0]
    v_mfma_f32_16x16x32_bf16 v[208:211], a[228:231], v[116:119], v[208:211]
    ds_read_b64_tr_b16 a[250:251], v3 offset:992
    v_fma_mix_f32 v33, v54, v25, v29 op_sel:[1,0,0] op_sel_hi:[1,0,0]
    v_mfma_f32_16x16x32_bf16 v[240:243], a[224:227], v[120:123], v[240:243]
    ds_read_b64_tr_b16 a[252:253], v3 offset:17376
    v_fma_mix_f32 v34, v55, v26, v30 op_sel:[0,0,0] op_sel_hi:[1,0,0]
    v_mfma_f32_16x16x32_bf16 v[240:243], a[228:231], v[124:127], v[240:243]
    s_waitcnt vmcnt(8)
    s_barrier
    s_waitcnt lgkmcnt(7)
    ds_read_b64_tr_b16 a[254:255], v3 offset:17888
    v_fma_mix_f32 v35, v55, v27, v31 op_sel:[1,0,0] op_sel_hi:[1,0,0]
    v_mfma_f32_16x16x32_bf16 v[212:215], a[232:235], v[112:115], v[212:215]
    ds_read_b64_tr_b16 a[192:193], v3 offset:36864
    v_cvt_pk_bf16_f32 v54, v32, v33
    v_mfma_f32_16x16x32_bf16 v[212:215], a[236:239], v[116:119], v[212:215]
    ds_read_b64_tr_b16 a[194:195], v3 offset:37376
    ds_read_b64_tr_b16 a[196:197], v3 offset:53760
    v_mfma_f32_16x16x32_bf16 v[244:247], a[232:235], v[120:123], v[244:247]
    s_add_u32 m0, s44, 110592
    ds_read_b64_tr_b16 a[198:199], v3 offset:54272
    v_cvt_pk_bf16_f32 v55, v34, v35
    v_mfma_f32_16x16x32_bf16 v[244:247], a[236:239], v[124:127], v[244:247]
    s_mov_b32 s46, 16384
    s_waitcnt lgkmcnt(8)
    buffer_load_dwordx4 off, s[16:19], s46 offset:0 lds
    v_mfma_f32_16x16x32_bf16 v[216:219], a[240:243], v[112:115], v[216:219]
    ds_read_b64_tr_b16 a[200:201], v3 offset:36896
    v_fma_mix_f32 v36, v62, v24, v28 op_sel:[0,0,0] op_sel_hi:[1,0,0]
    v_mfma_f32_16x16x32_bf16 v[216:219], a[244:247], v[116:119], v[216:219]
    ds_read_b64_tr_b16 a[202:203], v3 offset:37408
    ds_read_b64_tr_b16 a[204:205], v3 offset:53792
    v_fma_mix_f32 v37, v62, v25, v29 op_sel:[1,0,0] op_sel_hi:[1,0,0]
    v_mfma_f32_16x16x32_bf16 v[248:251], a[240:243], v[120:123], v[248:251]
    s_add_u32 m0, s44, 110624
    ds_read_b64_tr_b16 a[206:207], v3 offset:54304
    v_fma_mix_f32 v38, v63, v26, v30 op_sel:[0,0,0] op_sel_hi:[1,0,0]
    v_mfma_f32_16x16x32_bf16 v[248:251], a[244:247], v[124:127], v[248:251]
    s_waitcnt lgkmcnt(8)
    buffer_load_dwordx4 off, s[16:19], s46 offset:1024 lds
    v_mfma_f32_16x16x32_bf16 v[220:223], a[248:251], v[112:115], v[220:223]
    ds_read_b64_tr_b16 a[208:209], v3 offset:36928
    v_fma_mix_f32 v39, v63, v27, v31 op_sel:[1,0,0] op_sel_hi:[1,0,0]
    v_mfma_f32_16x16x32_bf16 v[220:223], a[252:255], v[116:119], v[220:223]
    ds_read_b64_tr_b16 a[210:211], v3 offset:37440
    ds_read_b64_tr_b16 a[212:213], v3 offset:53824
    v_cvt_pk_bf16_f32 v62, v36, v37
    v_mfma_f32_16x16x32_bf16 v[252:255], a[248:251], v[120:123], v[252:255]
    s_add_u32 m0, s44, 110656
    ds_read_b64_tr_b16 a[214:215], v3 offset:54336
    v_cvt_pk_bf16_f32 v63, v38, v39
    v_mfma_f32_16x16x32_bf16 v[252:255], a[252:255], v[124:127], v[252:255]
    s_waitcnt lgkmcnt(8)
    buffer_load_dwordx4 off, s[16:19], s46 offset:2048 lds
    v_mfma_f32_16x16x32_bf16 v[128:131], a[192:195], v[48:51], v[128:131]
    ds_read_b64_tr_b16 a[216:217], v3 offset:36960
    v_lshrrev_b32 v14, 2, v0
    v_mfma_f32_16x16x32_bf16 v[128:131], a[196:199], v[52:55], v[128:131]
    s_mul_i32 s3, s51, 144
    ds_read_b64_tr_b16 a[218:219], v3 offset:37472
    ds_read_b64_tr_b16 a[220:221], v3 offset:53856
    v_mfma_f32_16x16x32_bf16 v[160:163], a[192:195], v[56:59], v[160:163]
    s_add_u32 m0, s44, 110688
    ds_read_b64_tr_b16 a[222:223], v3 offset:54368
    v_add_u32 v14, s3, v14
    v_mfma_f32_16x16x32_bf16 v[160:163], a[196:199], v[60:63], v[160:163]
    s_waitcnt lgkmcnt(8)
    buffer_load_dwordx4 off, s[16:19], s46 offset:3072 lds
    v_mfma_f32_16x16x32_bf16 v[132:135], a[200:203], v[48:51], v[132:135]
    ds_read_b64_tr_b16 a[224:225], v3 offset:36992
    v_mul_u32_u24 v14, 9216, v14
    v_mfma_f32_16x16x32_bf16 v[132:135], a[204:207], v[52:55], v[132:135]
    ds_read_b64_tr_b16 a[226:227], v3 offset:37504
    ds_read_b64_tr_b16 a[228:229], v3 offset:53888
    v_mfma_f32_16x16x32_bf16 v[164:167], a[200:203], v[56:59], v[164:167]
    s_add_u32 m0, s44, 127488
    ds_read_b64_tr_b16 a[230:231], v3 offset:54400
    v_and_b32 v15, 3, v0
    v_mfma_f32_16x16x32_bf16 v[164:167], a[204:207], v[60:63], v[164:167]
    s_waitcnt lgkmcnt(8)
    buffer_load_dwordx4 off, s[20:23], s46 offset:0 lds
    v_mfma_f32_16x16x32_bf16 v[136:139], a[208:211], v[48:51], v[136:139]
    ds_read_b64_tr_b16 a[232:233], v3 offset:37024
    v_lshl_add_u32 v6, v15, 4, v14
    v_mfma_f32_16x16x32_bf16 v[136:139], a[212:215], v[52:55], v[136:139]
    s_lshr_b32 s3, s2, 3
    s_lshl2_add_u32 s3, s3, s51
    s_and_b32 s15, s2, 7
    ds_read_b64_tr_b16 a[234:235], v3 offset:37536
    ds_read_b64_tr_b16 a[236:237], v3 offset:53920
    v_mfma_f32_16x16x32_bf16 v[168:171], a[208:211], v[56:59], v[168:171]
    s_add_u32 m0, s44, 127520
    ds_read_b64_tr_b16 a[238:239], v3 offset:54432
    v_lshlrev_b32 v9, 7, v0
    v_mfma_f32_16x16x32_bf16 v[168:171], a[212:215], v[60:63], v[168:171]
    s_waitcnt lgkmcnt(8)
    s_mul_i32 s14, s3, 9
    s_lshr_b32 s14, s14, 1
    buffer_load_dwordx4 off, s[20:23], s46 offset:1024 lds
    v_mfma_f32_16x16x32_bf16 v[140:143], a[216:219], v[48:51], v[140:143]
    ds_read_b64_tr_b16 a[240:241], v3 offset:37056
    v_min_u32 v15, 44, v0
    v_mfma_f32_16x16x32_bf16 v[140:143], a[220:223], v[52:55], v[140:143]
    ds_read_b64_tr_b16 a[242:243], v3 offset:37568
    ds_read_b64_tr_b16 a[244:245], v3 offset:53952
    v_mfma_f32_16x16x32_bf16 v[172:175], a[216:219], v[56:59], v[172:175]
    s_add_u32 m0, s44, 127552
    ds_read_b64_tr_b16 a[246:247], v3 offset:54464
    v_mul_u32_u24 v12, 7282, v15
    v_mfma_f32_16x16x32_bf16 v[172:175], a[220:223], v[60:63], v[172:175]
    s_waitcnt lgkmcnt(8)
    buffer_load_dwordx4 off, s[20:23], s46 offset:2048 lds
    v_mfma_f32_16x16x32_bf16 v[144:147], a[224:227], v[48:51], v[144:147]
    ds_read_b64_tr_b16 a[248:249], v3 offset:37088
    v_lshrrev_b32 v12, 16, v12
    v_mfma_f32_16x16x32_bf16 v[144:147], a[228:231], v[52:55], v[144:147]
    ds_read_b64_tr_b16 a[250:251], v3 offset:37600
    ds_read_b64_tr_b16 a[252:253], v3 offset:53984
    v_mfma_f32_16x16x32_bf16 v[176:179], a[224:227], v[56:59], v[176:179]
    s_add_u32 m0, s44, 127584
    ds_read_b64_tr_b16 a[254:255], v3 offset:54496
    v_mul_u32_u24 v13, 63, v12
    v_mfma_f32_16x16x32_bf16 v[176:179], a[228:231], v[60:63], v[176:179]
    s_waitcnt lgkmcnt(8)
    buffer_load_dwordx4 off, s[20:23], s46 offset:3072 lds
    v_mfma_f32_16x16x32_bf16 v[148:151], a[232:235], v[48:51], v[148:151]
    ds_read_b64_tr_b16 a[192:193], v3 offset:37120
    v_add_u32 v12, v15, v13
    v_mfma_f32_16x16x32_bf16 v[148:151], a[236:239], v[52:55], v[148:151]
    s_mul_i32 s14, s14, 72
    s_mul_i32 s56, s15, 9
    s_add_u32 s14, s14, s56
    ds_read_b64_tr_b16 a[194:195], v3 offset:37632
    v_add_lshl_u32 v12, s14, v12, 7
    v_mfma_f32_16x16x32_bf16 v[180:183], a[232:235], v[56:59], v[180:183]
    s_mul_i32 s14, s3, 81
    s_lshr_b32 s14, s14, 1
    s_mul_i32 s56, s15, 5184
    s_add_u32 s14, s14, s56
    ds_read_b64_tr_b16 a[196:197], v3 offset:54016
    v_min_u32 v13, 40, v0
    v_mfma_f32_16x16x32_bf16 v[180:183], a[236:239], v[60:63], v[180:183]
    s_waitcnt lgkmcnt(7)
    ds_read_b64_tr_b16 a[198:199], v3 offset:54528
    v_add_lshl_u32 v13, s14, v13, 7
    v_mfma_f32_16x16x32_bf16 v[152:155], a[240:243], v[48:51], v[152:155]
    s_mul_i32 s14, s3, 72
    s_andn2_b32 s56, s52, 3
    s_mul_i32 s56, s56, 2304
    s_add_u32 s14, s14, s56
    ds_read_b64_tr_b16 a[200:201], v3 offset:37152
    v_min_u32 v14, 35, v0
    v_mfma_f32_16x16x32_bf16 v[152:155], a[244:247], v[52:55], v[152:155]
    ds_read_b64_tr_b16 a[202:203], v3 offset:37664
    v_add_lshl_u32 v14, s14, v14, 7
    v_mfma_f32_16x16x32_bf16 v[184:187], a[240:243], v[56:59], v[184:187]
    ds_read_b64_tr_b16 a[204:205], v3 offset:54048
    v_add_u32 v15, 4608, v14
    v_mfma_f32_16x16x32_bf16 v[184:187], a[244:247], v[60:63], v[184:187]
    s_waitcnt lgkmcnt(7)
    ds_read_b64_tr_b16 a[206:207], v3 offset:54560
    v_cvt_pk_bf16_f32 v64, v128, v129
    v_mfma_f32_16x16x32_bf16 v[156:159], a[248:251], v[48:51], v[156:159]
    ds_read_b64_tr_b16 a[208:209], v3 offset:37184
    v_cvt_pk_bf16_f32 v65, v130, v131
    v_mfma_f32_16x16x32_bf16 v[156:159], a[252:255], v[52:55], v[156:159]
    ds_read_b64_tr_b16 a[210:211], v3 offset:37696
    v_cvt_pk_bf16_f32 v66, v132, v133
    v_mfma_f32_16x16x32_bf16 v[188:191], a[248:251], v[56:59], v[188:191]
    ds_read_b64_tr_b16 a[212:213], v3 offset:54080
    v_cvt_pk_bf16_f32 v67, v134, v135
    v_mfma_f32_16x16x32_bf16 v[188:191], a[252:255], v[60:63], v[188:191]
    s_waitcnt lgkmcnt(7)
    ds_read_b64_tr_b16 a[214:215], v3 offset:54592
    v_cvt_pk_bf16_f32 v80, v160, v161
    v_mfma_f32_16x16x32_bf16 v[192:195], a[192:195], v[48:51], v[192:195]
    ds_read_b64_tr_b16 a[216:217], v3 offset:37216
    v_cvt_pk_bf16_f32 v81, v162, v163
    v_mfma_f32_16x16x32_bf16 v[192:195], a[196:199], v[52:55], v[192:195]
    ds_read_b64_tr_b16 a[218:219], v3 offset:37728
    v_cvt_pk_bf16_f32 v82, v164, v165
    v_mfma_f32_16x16x32_bf16 v[224:227], a[192:195], v[56:59], v[224:227]
    ds_read_b64_tr_b16 a[220:221], v3 offset:54112
    v_cvt_pk_bf16_f32 v83, v166, v167
    v_mfma_f32_16x16x32_bf16 v[224:227], a[196:199], v[60:63], v[224:227]
    s_waitcnt lgkmcnt(7)
    ds_read_b64_tr_b16 a[222:223], v3 offset:54624
    v_cvt_pk_bf16_f32 v68, v136, v137
    v_mfma_f32_16x16x32_bf16 v[196:199], a[200:203], v[48:51], v[196:199]
    ds_read_b64_tr_b16 a[224:225], v3 offset:37248
    v_cvt_pk_bf16_f32 v69, v138, v139
    v_mfma_f32_16x16x32_bf16 v[196:199], a[204:207], v[52:55], v[196:199]
    ds_read_b64_tr_b16 a[226:227], v3 offset:37760
    v_cvt_pk_bf16_f32 v70, v140, v141
    v_mfma_f32_16x16x32_bf16 v[228:231], a[200:203], v[56:59], v[228:231]
    ds_read_b64_tr_b16 a[228:229], v3 offset:54144
    v_cvt_pk_bf16_f32 v71, v142, v143
    v_mfma_f32_16x16x32_bf16 v[228:231], a[204:207], v[60:63], v[228:231]
    s_waitcnt vmcnt(8)
    s_barrier
    s_waitcnt lgkmcnt(7)
    ds_read_b64_tr_b16 a[230:231], v3 offset:54656
    v_cvt_pk_bf16_f32 v84, v168, v169
    v_mfma_f32_16x16x32_bf16 v[200:203], a[208:211], v[48:51], v[200:203]
L2_pad3:
    s_cbranch_execz L2_pad7
    ds_read_b64_tr_b16 a[232:233], v3 offset:37280
    v_cvt_pk_bf16_f32 v85, v170, v171
    v_mfma_f32_16x16x32_bf16 v[200:203], a[212:215], v[52:55], v[200:203]
    ds_read_b64_tr_b16 a[234:235], v3 offset:37792
    ds_read_b64_tr_b16 a[236:237], v3 offset:54176
    v_mfma_f32_16x16x32_bf16 v[232:235], a[208:211], v[56:59], v[232:235]
    s_add_u32 m0, s44, 0
    ds_read_b64_tr_b16 a[238:239], v3 offset:54688
    v_cvt_pk_bf16_f32 v86, v172, v173
    v_mfma_f32_16x16x32_bf16 v[232:235], a[212:215], v[60:63], v[232:235]
    s_mov_b32 s46, 32768
    s_waitcnt lgkmcnt(8)
    buffer_load_dwordx4 off, s[16:19], s46 offset:0 lds
    v_mfma_f32_16x16x32_bf16 v[204:207], a[216:219], v[48:51], v[204:207]
    ds_read_b64_tr_b16 a[240:241], v3 offset:37312
    v_cvt_pk_bf16_f32 v87, v174, v175
    v_mfma_f32_16x16x32_bf16 v[204:207], a[220:223], v[52:55], v[204:207]
    ds_read_b64_tr_b16 a[242:243], v3 offset:37824
    ds_read_b64_tr_b16 a[244:245], v3 offset:54208
    v_mfma_f32_16x16x32_bf16 v[236:239], a[216:219], v[56:59], v[236:239]
    s_add_u32 m0, s44, 32
    ds_read_b64_tr_b16 a[246:247], v3 offset:54720
    v_cvt_pk_bf16_f32 v72, v144, v145
    v_mfma_f32_16x16x32_bf16 v[236:239], a[220:223], v[60:63], v[236:239]
    s_waitcnt lgkmcnt(8)
    buffer_load_dwordx4 off, s[16:19], s46 offset:1024 lds
    v_mfma_f32_16x16x32_bf16 v[208:211], a[224:227], v[48:51], v[208:211]
    ds_read_b64_tr_b16 a[248:249], v3 offset:37344
    v_cvt_pk_bf16_f32 v73, v146, v147
    v_mfma_f32_16x16x32_bf16 v[208:211], a[228:231], v[52:55], v[208:211]
    ds_read_b64_tr_b16 a[250:251], v3 offset:37856
    ds_read_b64_tr_b16 a[252:253], v3 offset:54240
    v_mfma_f32_16x16x32_bf16 v[240:243], a[224:227], v[56:59], v[240:243]
    s_add_u32 m0, s44, 64
    ds_read_b64_tr_b16 a[254:255], v3 offset:54752
    v_cvt_pk_bf16_f32 v74, v148, v149
    v_mfma_f32_16x16x32_bf16 v[240:243], a[228:231], v[60:63], v[240:243]
    s_waitcnt lgkmcnt(8)
    buffer_load_dwordx4 off, s[16:19], s46 offset:2048 lds
    v_mfma_f32_16x16x32_bf16 v[212:215], a[232:235], v[48:51], v[212:215]
    ds_read_b128 a[64:67], v1 offset:0
    ds_read_b128 a[68:71], v1 offset:64
    v_mfma_f32_16x16x32_bf16 v[212:215], a[236:239], v[52:55], v[212:215]
    ds_read_b128 a[72:75], v1 offset:128
    ds_read_b128 a[76:79], v1 offset:192
    v_mfma_f32_16x16x32_bf16 v[244:247], a[232:235], v[56:59], v[244:247]
    s_add_u32 m0, s44, 96
    ds_read_b128 a[80:83], v1 offset:256
    ds_read_b128 a[84:87], v1 offset:320
    v_mfma_f32_16x16x32_bf16 v[244:247], a[236:239], v[60:63], v[244:247]
    s_waitcnt lgkmcnt(10)
    buffer_load_dwordx4 off, s[16:19], s46 offset:3072 lds
    v_mfma_f32_16x16x32_bf16 v[216:219], a[240:243], v[48:51], v[216:219]
    ds_read_b128 a[88:91], v1 offset:384
    ds_read_b128 a[92:95], v1 offset:448
    v_mfma_f32_16x16x32_bf16 v[216:219], a[244:247], v[52:55], v[216:219]
    ds_read_b128 a[96:99], v1 offset:512
    ds_read_b128 a[100:103], v1 offset:576
    v_mfma_f32_16x16x32_bf16 v[248:251], a[240:243], v[56:59], v[248:251]
    s_add_u32 m0, s44, 16896
    ds_read_b128 a[104:107], v1 offset:640
    ds_read_b128 a[108:111], v1 offset:704
    v_mfma_f32_16x16x32_bf16 v[248:251], a[244:247], v[60:63], v[248:251]
    s_waitcnt lgkmcnt(12)
    buffer_load_dwordx4 off, s[20:23], s46 offset:0 lds
    v_mfma_f32_16x16x32_bf16 v[220:223], a[248:251], v[48:51], v[220:223]
    ds_read_b128 a[112:115], v1 offset:768
    ds_read_b128 a[116:119], v1 offset:832
    v_mfma_f32_16x16x32_bf16 v[220:223], a[252:255], v[52:55], v[220:223]
    ds_read_b128 a[120:123], v1 offset:896
    ds_read_b128 a[124:127], v1 offset:960
    v_mfma_f32_16x16x32_bf16 v[252:255], a[248:251], v[56:59], v[252:255]
    s_add_u32 m0, s44, 16928
    v_cvt_pk_bf16_f32 v75, v150, v151
    v_cvt_pk_bf16_f32 v88, v176, v177
    v_mfma_f32_16x16x32_bf16 v[252:255], a[252:255], v[60:63], v[252:255]
    buffer_load_dwordx4 off, s[20:23], s46 offset:1024 lds
    s_mul_i32 s3, s96, 9216
    s_add_u32 s3, s3, 4194304
    s_add_u32 s32, s84, s3
    s_addc_u32 s33, s85, 0
    s_mov_b32 s34, 9216
    s_mov_b32 s35, 0x20000
    s_add_u32 m0, s44, 16960
    s_nop 0
    buffer_load_dwordx4 off, s[20:23], s46 offset:2048 lds
    s_add_u32 m0, s44, 16992
    s_nop 0
    buffer_load_dwordx4 off, s[20:23], s46 offset:3072 lds
    v_cvt_pk_bf16_f32 v89, v178, v179
    v_cvt_pk_bf16_f32 v90, v180, v181
    v_cvt_pk_bf16_f32 v91, v182, v183
    v_cvt_pk_bf16_f32 v76, v152, v153
    v_cvt_pk_bf16_f32 v77, v154, v155
    v_cvt_pk_bf16_f32 v78, v156, v157
    v_cvt_pk_bf16_f32 v79, v158, v159
    v_cvt_pk_bf16_f32 v92, v184, v185
    v_cvt_pk_bf16_f32 v93, v186, v187
    v_cvt_pk_bf16_f32 v94, v188, v189
    v_cvt_pk_bf16_f32 v95, v190, v191
    v_permlane32_swap_b32 v64, v66
    v_permlane32_swap_b32 v65, v67
    v_permlane32_swap_b32 v80, v82
    v_permlane32_swap_b32 v81, v83
    v_permlane32_swap_b32 v68, v70
    v_permlane32_swap_b32 v69, v71
    v_permlane32_swap_b32 v84, v86
    v_permlane32_swap_b32 v85, v87
    v_permlane32_swap_b32 v72, v74
    v_permlane32_swap_b32 v73, v75
    v_permlane32_swap_b32 v88, v90
    v_permlane32_swap_b32 v89, v91
    v_permlane32_swap_b32 v76, v78
    v_permlane32_swap_b32 v77, v79
    v_permlane32_swap_b32 v92, v94
    v_permlane32_swap_b32 v93, v95
    v_cvt_pk_bf16_f32 v96, v192, v193
    v_cvt_pk_bf16_f32 v97, v194, v195
    v_cvt_pk_bf16_f32 v98, v196, v197
    v_cvt_pk_bf16_f32 v99, v198, v199
    v_cvt_pk_bf16_f32 v112, v224, v225
    v_cvt_pk_bf16_f32 v113, v226, v227
    v_cvt_pk_bf16_f32 v114, v228, v229
    v_cvt_pk_bf16_f32 v115, v230, v231
    v_cvt_pk_bf16_f32 v100, v200, v201
    v_cvt_pk_bf16_f32 v101, v202, v203
    v_cvt_pk_bf16_f32 v102, v204, v205
    v_cvt_pk_bf16_f32 v103, v206, v207
    v_cvt_pk_bf16_f32 v116, v232, v233
    v_cvt_pk_bf16_f32 v117, v234, v235
    v_cvt_pk_bf16_f32 v118, v236, v237
    v_cvt_pk_bf16_f32 v119, v238, v239
    v_cvt_pk_bf16_f32 v104, v208, v209
    v_cvt_pk_bf16_f32 v105, v210, v211
    v_cvt_pk_bf16_f32 v106, v212, v213
    v_cvt_pk_bf16_f32 v107, v214, v215
    v_cvt_pk_bf16_f32 v120, v240, v241
    v_cvt_pk_bf16_f32 v121, v242, v243
    v_cvt_pk_bf16_f32 v122, v244, v245
    v_cvt_pk_bf16_f32 v123, v246, v247
    v_cvt_pk_bf16_f32 v108, v216, v217
    v_cvt_pk_bf16_f32 v109, v218, v219
    v_cvt_pk_bf16_f32 v110, v220, v221
    v_cvt_pk_bf16_f32 v111, v222, v223
    v_cvt_pk_bf16_f32 v124, v248, v249
    v_cvt_pk_bf16_f32 v125, v250, v251
    v_cvt_pk_bf16_f32 v126, v252, v253
    v_cvt_pk_bf16_f32 v127, v254, v255
    s_nop 0
    v_permlane32_swap_b32 v96, v98
    v_permlane32_swap_b32 v97, v99
    v_permlane32_swap_b32 v112, v114
    v_permlane32_swap_b32 v113, v115
    v_permlane32_swap_b32 v100, v102
    v_permlane32_swap_b32 v101, v103
    v_permlane32_swap_b32 v116, v118
    v_permlane32_swap_b32 v117, v119
    v_permlane32_swap_b32 v104, v106
    v_permlane32_swap_b32 v105, v107
    v_permlane32_swap_b32 v120, v122
    v_permlane32_swap_b32 v121, v123
    v_permlane32_swap_b32 v108, v110
    v_permlane32_swap_b32 v109, v111
    v_permlane32_swap_b32 v124, v126
    v_permlane32_swap_b32 v125, v127
    s_waitcnt lgkmcnt(12)
    v_mfma_f32_16x16x32_bf16 v[16:19], a[64:67], v[64:67], 0
    v_mfma_f32_16x16x32_bf16 v[16:19], a[68:71], v[68:71], v[16:19]
    v_mfma_f32_16x16x32_bf16 v[16:19], a[72:75], v[72:75], v[16:19]
    v_mfma_f32_16x16x32_bf16 v[16:19], a[76:79], v[76:79], v[16:19]
    v_mfma_f32_16x16x32_bf16 v[20:23], a[64:67], v[80:83], 0
    v_mfma_f32_16x16x32_bf16 v[20:23], a[68:71], v[84:87], v[20:23]
    v_mfma_f32_16x16x32_bf16 v[20:23], a[72:75], v[88:91], v[20:23]
    v_mfma_f32_16x16x32_bf16 v[20:23], a[76:79], v[92:95], v[20:23]
    v_mfma_f32_16x16x32_bf16 v[24:27], a[64:67], v[96:99], 0
    v_mfma_f32_16x16x32_bf16 v[24:27], a[68:71], v[100:103], v[24:27]
    v_mfma_f32_16x16x32_bf16 v[24:27], a[72:75], v[104:107], v[24:27]
    v_mfma_f32_16x16x32_bf16 v[24:27], a[76:79], v[108:111], v[24:27]
    v_mfma_f32_16x16x32_bf16 v[28:31], a[64:67], v[112:115], 0
    v_mfma_f32_16x16x32_bf16 v[28:31], a[68:71], v[116:119], v[28:31]
    v_mfma_f32_16x16x32_bf16 v[28:31], a[72:75], v[120:123], v[28:31]
    v_mfma_f32_16x16x32_bf16 v[28:31], a[76:79], v[124:127], v[28:31]
    s_nop 1
    v_max3_f32 v16, v16, v17, v18
    v_max_f32 v16, v16, v19
    v_max3_f32 v20, v20, v21, v22
    v_max_f32 v20, v20, v23
    v_max3_f32 v24, v24, v25, v26
    v_max_f32 v24, v24, v27
    v_max3_f32 v28, v28, v29, v30
    v_max_f32 v28, v28, v31
    v_mov_b32 v40, v16
    v_mov_b32 v41, v20
    v_mov_b32 v42, v24
    v_mov_b32 v43, v28
    v_permlane16_swap_b32 v40, v16
    v_permlane16_swap_b32 v41, v20
    v_permlane16_swap_b32 v42, v24
    v_permlane16_swap_b32 v43, v28
    v_max_f32 v16, v16, v40
    v_max_f32 v20, v20, v41
    v_max_f32 v24, v24, v42
    v_max_f32 v28, v28, v43
    v_mov_b32 v40, v16
    v_mov_b32 v41, v20
    v_mov_b32 v42, v24
    v_mov_b32 v43, v28
    v_permlane32_swap_b32 v40, v16
    v_permlane32_swap_b32 v41, v20
    v_permlane32_swap_b32 v42, v24
    v_permlane32_swap_b32 v43, v28
    v_max_f32 v16, v16, v40
    v_max_f32 v20, v20, v41
    v_max_f32 v24, v24, v42
    v_max_f32 v28, v28, v43
    v_sub_f32 v48, 0xc2800000, v16
    v_sub_f32 v49, 0xc2800000, v16
    v_sub_f32 v50, 0xc2800000, v16
    v_sub_f32 v51, 0xc2800000, v16
    v_sub_f32 v52, 0xc2800000, v20
    v_sub_f32 v53, 0xc2800000, v20
    v_sub_f32 v54, 0xc2800000, v20
    v_sub_f32 v55, 0xc2800000, v20
    v_sub_f32 v56, 0xc2800000, v24
    v_sub_f32 v57, 0xc2800000, v24
    v_sub_f32 v58, 0xc2800000, v24
    v_sub_f32 v59, 0xc2800000, v24
    v_sub_f32 v60, 0xc2800000, v28
    v_sub_f32 v61, 0xc2800000, v28
    v_sub_f32 v62, 0xc2800000, v28
    v_sub_f32 v63, 0xc2800000, v28
L2_entry:
    s_mov_b32 s47, s44
    s_mov_b32 s48, -73728
    s_mov_b32 s49, 11
    s_mov_b32 s46, 32768
    s_mov_b32 s100, 0x07060302
    s_waitcnt vmcnt(8)
    s_barrier
    v_mfma_f32_16x16x32_bf16 v[16:19], a[64:67], v[64:67], v[48:51]
    ds_read_b64_tr_b16 a[128:129], v2 offset:0
    ds_read_b64_tr_b16 a[130:131], v2 offset:256
    v_mfma_f32_16x16x32_bf16 v[16:19], a[68:71], v[68:71], v[16:19]
    ds_read_b64_tr_b16 a[132:133], v2 offset:512
    ds_read_b64_tr_b16 a[134:135], v2 offset:768
    v_mfma_f32_16x16x32_bf16 v[16:19], a[72:75], v[72:75], v[16:19]
    s_add_u32 m0, s47, 36864
    ds_read_b64_tr_b16 a[136:137], v2 offset:32
    ds_read_b64_tr_b16 a[138:139], v2 offset:288
    v_mfma_f32_16x16x32_bf16 v[16:19], a[76:79], v[76:79], v[16:19]
    s_waitcnt lgkmcnt(14)
    s_add_u32 s46, s46, 16384
    buffer_load_dwordx4 off, s[16:19], s46 offset:0 lds
    v_mfma_f32_16x16x32_bf16 v[20:23], a[80:83], v[64:67], v[48:51]
    ds_read_b64_tr_b16 a[140:141], v2 offset:544
    ds_read_b64_tr_b16 a[142:143], v2 offset:800
    v_mfma_f32_16x16x32_bf16 v[20:23], a[84:87], v[68:71], v[20:23]
    ds_read_b64_tr_b16 a[144:145], v2 offset:64
    ds_read_b64_tr_b16 a[146:147], v2 offset:320
    v_mfma_f32_16x16x32_bf16 v[20:23], a[88:91], v[72:75], v[20:23]
    s_add_u32 m0, s47, 36896
    ds_read_b64_tr_b16 a[148:149], v2 offset:576
    ds_read_b64_tr_b16 a[150:151], v2 offset:832
    v_mfma_f32_16x16x32_bf16 v[20:23], a[92:95], v[76:79], v[20:23]
    s_waitcnt lgkmcnt(15)
    buffer_load_dwordx4 off, s[16:19], s46 offset:1024 lds
    v_mfma_f32_16x16x32_bf16 v[24:27], a[96:99], v[64:67], v[48:51]
    s_nop 1
    v_exp_f32 v16, v16
    v_mfma_f32_16x16x32_bf16 v[24:27], a[100:103], v[68:71], v[24:27]
    ds_read_b64_tr_b16 a[152:153], v2 offset:96
    ds_read_b64_tr_b16 a[154:155], v2 offset:352
    v_mfma_f32_16x16x32_bf16 v[24:27], a[104:107], v[72:75], v[24:27]
    s_add_u32 m0, s47, 36928
    v_exp_f32 v17, v17
    v_mfma_f32_16x16x32_bf16 v[24:27], a[108:111], v[76:79], v[24:27]
    s_waitcnt lgkmcnt(14)
    buffer_load_dwordx4 off, s[16:19], s46 offset:2048 lds
    v_mfma_f32_16x16x32_bf16 v[28:31], a[112:115], v[64:67], v[48:51]
    v_exp_f32 v18, v18
    v_mfma_f32_16x16x32_bf16 v[28:31], a[116:119], v[68:71], v[28:31]
    ds_read_b64_tr_b16 a[156:157], v2 offset:608
    v_perm_b32 v32, v17, v16, s100
    v_mfma_f32_16x16x32_bf16 v[28:31], a[120:123], v[72:75], v[28:31]
    s_add_u32 m0, s47, 36960
    v_exp_f32 v19, v19
    v_mfma_f32_16x16x32_bf16 v[28:31], a[124:127], v[76:79], v[28:31]
    buffer_load_dwordx4 off, s[16:19], s46 offset:3072 lds
    s_nop 3
    ds_read_b64_tr_b16 a[158:159], v2 offset:864
    ds_read_b64_tr_b16 a[160:161], v2 offset:128
    ds_read_b64_tr_b16 a[162:163], v2 offset:384
    ds_read_b64_tr_b16 a[164:165], v2 offset:640
    ds_read_b64_tr_b16 a[166:167], v2 offset:896
    ds_read_b64_tr_b16 a[168:169], v2 offset:160
    ds_read_b64_tr_b16 a[170:171], v2 offset:416
    ds_read_b64_tr_b16 a[172:173], v2 offset:672
    ds_read_b64_tr_b16 a[174:175], v2 offset:928
    ds_read_b64_tr_b16 a[176:177], v2 offset:192
    ds_read_b64_tr_b16 a[178:179], v2 offset:448
    ds_read_b64_tr_b16 a[180:181], v2 offset:704
    ds_read_b64_tr_b16 a[182:183], v2 offset:960
    ds_read_b64_tr_b16 a[184:185], v2 offset:224
    ds_read_b64_tr_b16 a[186:187], v2 offset:480
    ds_read_b64_tr_b16 a[188:189], v2 offset:736
    ds_read_b64_tr_b16 a[190:191], v2 offset:992
    v_exp_f32 v20, v20
    s_nop 0
    ds_read_b64_tr_b16 a[192:193], v2 offset:36864
    v_perm_b32 v33, v19, v18, s100
    s_add_u32 m0, s47, 53760
    v_exp_f32 v21, v21
    s_nop 0
    buffer_load_dwordx4 off, s[20:23], s46 offset:0 lds
    v_exp_f32 v22, v22
    s_nop 0
    ds_read_b64_tr_b16 a[194:195], v2 offset:37120
    v_perm_b32 v34, v21, v20, s100
    s_add_u32 m0, s47, 53792
    v_exp_f32 v23, v23
    s_nop 0
    buffer_load_dwordx4 off, s[20:23], s46 offset:1024 lds
    v_exp_f32 v24, v24
    s_nop 0
    ds_read_b64_tr_b16 a[196:197], v2 offset:37376
    v_perm_b32 v35, v23, v22, s100
    s_add_u32 m0, s47, 53824
    v_exp_f32 v25, v25
    s_nop 0
    buffer_load_dwordx4 off, s[20:23], s46 offset:2048 lds
    v_exp_f32 v26, v26
    s_nop 0
    ds_read_b64_tr_b16 a[198:199], v2 offset:37632
    v_perm_b32 v36, v25, v24, s100
    s_add_u32 m0, s47, 53856
    v_exp_f32 v27, v27
    s_nop 0
    buffer_load_dwordx4 off, s[20:23], s46 offset:3072 lds
    ds_read_b64_tr_b16 a[200:201], v2 offset:36896
    s_nop 0
    v_mfma_f32_16x16x32_bf16 v[16:19], a[64:67], v[80:83], v[52:55]
    v_exp_f32 v28, v28
    v_mfma_f32_16x16x32_bf16 v[16:19], a[68:71], v[84:87], v[16:19]
    ds_read_b64_tr_b16 a[202:203], v2 offset:37152
    v_perm_b32 v37, v27, v26, s100
    v_mfma_f32_16x16x32_bf16 v[16:19], a[72:75], v[88:91], v[16:19]
    v_exp_f32 v29, v29
    v_mfma_f32_16x16x32_bf16 v[16:19], a[76:79], v[92:95], v[16:19]
    ds_read_b64_tr_b16 a[204:205], v2 offset:37408
    v_mov_b32 v224, 0
    v_mfma_f32_16x16x32_bf16 v[20:23], a[80:83], v[80:83], v[52:55]
    v_exp_f32 v30, v30
    v_mfma_f32_16x16x32_bf16 v[20:23], a[84:87], v[84:87], v[20:23]
    ds_read_b64_tr_b16 a[206:207], v2 offset:37664
    v_perm_b32 v38, v29, v28, s100
    v_mfma_f32_16x16x32_bf16 v[20:23], a[88:91], v[88:91], v[20:23]
    v_exp_f32 v31, v31
    v_mfma_f32_16x16x32_bf16 v[20:23], a[92:95], v[92:95], v[20:23]
    ds_read_b64_tr_b16 a[208:209], v2 offset:36928
    v_mov_b32 v225, 0
    v_mfma_f32_16x16x32_bf16 v[24:27], a[96:99], v[80:83], v[52:55]
    v_exp_f32 v16, v16
    v_mfma_f32_16x16x32_bf16 v[24:27], a[100:103], v[84:87], v[24:27]
    ds_read_b64_tr_b16 a[210:211], v2 offset:37184
    v_perm_b32 v39, v31, v30, s100
    v_mfma_f32_16x16x32_bf16 v[24:27], a[104:107], v[88:91], v[24:27]
    v_exp_f32 v17, v17
    v_mfma_f32_16x16x32_bf16 v[24:27], a[108:111], v[92:95], v[24:27]
    ds_read_b64_tr_b16 a[212:213], v2 offset:37440
    v_mov_b32 v226, 0
    v_mfma_f32_16x16x32_bf16 v[28:31], a[112:115], v[80:83], v[52:55]
    v_exp_f32 v18, v18
    v_mfma_f32_16x16x32_bf16 v[28:31], a[116:119], v[84:87], v[28:31]
    ds_read_b64_tr_b16 a[214:215], v2 offset:37696
    v_perm_b32 v40, v17, v16, s100
    v_mfma_f32_16x16x32_bf16 v[28:31], a[120:123], v[88:91], v[28:31]
    s_waitcnt lgkmcnt(12)
    v_exp_f32 v19, v19
    v_mfma_f32_16x16x32_bf16 v[28:31], a[124:127], v[92:95], v[28:31]
    ds_read_b64_tr_b16 a[216:217], v2 offset:36960
    v_mov_b32 v227, 0
    v_mfma_f32_16x16x32_bf16 v[128:131], a[128:131], v[32:35], 0
    v_exp_f32 v20, v20
    v_mfma_f32_16x16x32_bf16 v[128:131], a[132:135], v[36:39], v[128:131]
    ds_read_b64_tr_b16 a[218:219], v2 offset:37216
    v_perm_b32 v41, v19, v18, s100
    v_mfma_f32_16x16x32_bf16 v[132:135], a[136:139], v[32:35], 0
    v_exp_f32 v21, v21
    v_mfma_f32_16x16x32_bf16 v[132:135], a[140:143], v[36:39], v[132:135]
    ds_read_b64_tr_b16 a[220:221], v2 offset:37472
    v_mov_b32 v228, 0
    v_mfma_f32_16x16x32_bf16 v[136:139], a[144:147], v[32:35], 0
    v_exp_f32 v22, v22
    v_mfma_f32_16x16x32_bf16 v[136:139], a[148:151], v[36:39], v[136:139]
    ds_read_b64_tr_b16 a[222:223], v2 offset:37728
    v_perm_b32 v42, v21, v20, s100
    v_mfma_f32_16x16x32_bf16 v[140:143], a[152:155], v[32:35], 0
    v_exp_f32 v23, v23
    v_mfma_f32_16x16x32_bf16 v[140:143], a[156:159], v[36:39], v[140:143]
    ds_read_b64_tr_b16 a[224:225], v2 offset:36992
    v_mov_b32 v229, 0
    v_mfma_f32_16x16x32_bf16 v[144:147], a[160:163], v[32:35], 0
    v_exp_f32 v24, v24
    v_mfma_f32_16x16x32_bf16 v[144:147], a[164:167], v[36:39], v[144:147]
    ds_read_b64_tr_b16 a[226:227], v2 offset:37248
    v_perm_b32 v43, v23, v22, s100
    v_mfma_f32_16x16x32_bf16 v[148:151], a[168:171], v[32:35], 0
    v_exp_f32 v25, v25
    v_mfma_f32_16x16x32_bf16 v[148:151], a[172:175], v[36:39], v[148:151]
    ds_read_b64_tr_b16 a[228:229], v2 offset:37504
    v_mov_b32 v230, 0
    v_mfma_f32_16x16x32_bf16 v[152:155], a[176:179], v[32:35], 0
    v_exp_f32 v26, v26
    v_mfma_f32_16x16x32_bf16 v[152:155], a[180:183], v[36:39], v[152:155]
    ds_read_b64_tr_b16 a[230:231], v2 offset:37760
    v_perm_b32 v44, v25, v24, s100
    v_mfma_f32_16x16x32_bf16 v[156:159], a[184:187], v[32:35], 0
    v_exp_f32 v27, v27
    v_mfma_f32_16x16x32_bf16 v[156:159], a[188:191], v[36:39], v[156:159]
    ds_read_b64_tr_b16 a[232:233], v2 offset:37024
    v_mov_b32 v231, 0
    v_smfmac_f32_16x16x64_bf16 a[0:3], a[16:19], v[32:39], v11
    ds_read_b64_tr_b16 a[234:235], v2 offset:37280
    v_mov_b32 v232, 0
    v_mfma_f32_16x16x32_bf16 v[16:19], a[64:67], v[96:99], v[56:59]
    v_exp_f32 v28, v28
    v_mfma_f32_16x16x32_bf16 v[16:19], a[68:71], v[100:103], v[16:19]
    ds_read_b64_tr_b16 a[236:237], v2 offset:37536
    v_perm_b32 v45, v27, v26, s100
    v_mfma_f32_16x16x32_bf16 v[16:19], a[72:75], v[104:107], v[16:19]
    v_exp_f32 v29, v29
    v_mfma_f32_16x16x32_bf16 v[16:19], a[76:79], v[108:111], v[16:19]
    ds_read_b64_tr_b16 a[238:239], v2 offset:37792
    v_mov_b32 v233, 0
    v_mfma_f32_16x16x32_bf16 v[20:23], a[80:83], v[96:99], v[56:59]
    v_exp_f32 v30, v30
    v_mfma_f32_16x16x32_bf16 v[20:23], a[84:87], v[100:103], v[20:23]
    ds_read_b64_tr_b16 a[240:241], v2 offset:37056
    v_perm_b32 v46, v29, v28, s100
    v_mfma_f32_16x16x32_bf16 v[20:23], a[88:91], v[104:107], v[20:23]
    v_exp_f32 v31, v31
    v_mfma_f32_16x16x32_bf16 v[20:23], a[92:95], v[108:111], v[20:23]
    ds_read_b64_tr_b16 a[242:243], v2 offset:37312
    v_mov_b32 v234, 0
    v_mfma_f32_16x16x32_bf16 v[24:27], a[96:99], v[96:99], v[56:59]
    v_exp_f32 v16, v16
    v_mfma_f32_16x16x32_bf16 v[24:27], a[100:103], v[100:103], v[24:27]
    ds_read_b64_tr_b16 a[244:245], v2 offset:37568
    v_perm_b32 v47, v31, v30, s100
    v_mfma_f32_16x16x32_bf16 v[24:27], a[104:107], v[104:107], v[24:27]
    v_exp_f32 v17, v17
    v_mfma_f32_16x16x32_bf16 v[24:27], a[108:111], v[108:111], v[24:27]
    ds_read_b64_tr_b16 a[246:247], v2 offset:37824
    v_mov_b32 v235, 0
    v_mfma_f32_16x16x32_bf16 v[28:31], a[112:115], v[96:99], v[56:59]
    v_exp_f32 v18, v18
    v_mfma_f32_16x16x32_bf16 v[28:31], a[116:119], v[100:103], v[28:31]
    ds_read_b64_tr_b16 a[248:249], v2 offset:37088
    v_perm_b32 v32, v17, v16, s100
    v_mfma_f32_16x16x32_bf16 v[28:31], a[120:123], v[104:107], v[28:31]
    v_exp_f32 v19, v19
    v_mfma_f32_16x16x32_bf16 v[28:31], a[124:127], v[108:111], v[28:31]
    ds_read_b64_tr_b16 a[250:251], v2 offset:37344
    v_mov_b32 v236, 0
    v_mfma_f32_16x16x32_bf16 v[160:163], a[128:131], v[40:43], 0
    v_exp_f32 v20, v20
    v_mfma_f32_16x16x32_bf16 v[160:163], a[132:135], v[44:47], v[160:163]
    ds_read_b64_tr_b16 a[252:253], v2 offset:37600
    v_perm_b32 v33, v19, v18, s100
    v_mfma_f32_16x16x32_bf16 v[164:167], a[136:139], v[40:43], 0
    v_exp_f32 v21, v21
    v_mfma_f32_16x16x32_bf16 v[164:167], a[140:143], v[44:47], v[164:167]
    ds_read_b64_tr_b16 a[254:255], v2 offset:37856
    v_mov_b32 v237, 0
    v_mfma_f32_16x16x32_bf16 v[168:171], a[144:147], v[40:43], 0
    v_exp_f32 v22, v22
    v_mfma_f32_16x16x32_bf16 v[168:171], a[148:151], v[44:47], v[168:171]
    v_perm_b32 v34, v21, v20, s100
    v_mov_b32 v238, 0
    v_mfma_f32_16x16x32_bf16 v[172:175], a[152:155], v[40:43], 0
    v_exp_f32 v23, v23
    v_mfma_f32_16x16x32_bf16 v[172:175], a[156:159], v[44:47], v[172:175]
    v_mov_b32 v239, 0
    v_mov_b32 v240, 0
    v_mfma_f32_16x16x32_bf16 v[176:179], a[160:163], v[40:43], 0
    v_exp_f32 v24, v24
    v_mfma_f32_16x16x32_bf16 v[176:179], a[164:167], v[44:47], v[176:179]
    v_perm_b32 v35, v23, v22, s100
    v_mov_b32 v241, 0
    v_mfma_f32_16x16x32_bf16 v[180:183], a[168:171], v[40:43], 0
    v_exp_f32 v25, v25
    v_mfma_f32_16x16x32_bf16 v[180:183], a[172:175], v[44:47], v[180:183]
    v_mov_b32 v242, 0
    v_mov_b32 v243, 0
    v_mfma_f32_16x16x32_bf16 v[184:187], a[176:179], v[40:43], 0
    v_exp_f32 v26, v26
    v_mfma_f32_16x16x32_bf16 v[184:187], a[180:183], v[44:47], v[184:187]
    v_perm_b32 v36, v25, v24, s100
    v_mov_b32 v244, 0
    v_mfma_f32_16x16x32_bf16 v[188:191], a[184:187], v[40:43], 0
    v_exp_f32 v27, v27
    v_mfma_f32_16x16x32_bf16 v[188:191], a[188:191], v[44:47], v[188:191]
    v_mov_b32 v245, 0
    v_mov_b32 v246, 0
    v_smfmac_f32_16x16x64_bf16 a[4:7], a[16:19], v[40:47], v11
    v_mov_b32 v247, 0
    v_mov_b32 v248, 0
    v_mfma_f32_16x16x32_bf16 v[16:19], a[64:67], v[112:115], v[60:63]
    v_exp_f32 v28, v28
    v_mfma_f32_16x16x32_bf16 v[16:19], a[68:71], v[116:119], v[16:19]
    ds_read_b128 a[64:67], v1 offset:36864
    v_perm_b32 v37, v27, v26, s100
    v_mfma_f32_16x16x32_bf16 v[16:19], a[72:75], v[120:123], v[16:19]
    v_exp_f32 v29, v29
    v_mfma_f32_16x16x32_bf16 v[16:19], a[76:79], v[124:127], v[16:19]
    ds_read_b128 a[68:71], v1 offset:36928
    v_mov_b32 v249, 0
    v_mfma_f32_16x16x32_bf16 v[20:23], a[80:83], v[112:115], v[60:63]
    v_exp_f32 v30, v30
    v_mfma_f32_16x16x32_bf16 v[20:23], a[84:87], v[116:119], v[20:23]
    ds_read_b128 a[72:75], v1 offset:36992
    v_perm_b32 v38, v29, v28, s100
    v_mfma_f32_16x16x32_bf16 v[20:23], a[88:91], v[120:123], v[20:23]
    v_exp_f32 v31, v31
    v_mfma_f32_16x16x32_bf16 v[20:23], a[92:95], v[124:127], v[20:23]
    ds_read_b128 a[76:79], v1 offset:37056
    v_mov_b32 v250, 0
    v_mfma_f32_16x16x32_bf16 v[24:27], a[96:99], v[112:115], v[60:63]
    v_exp_f32 v16, v16
    v_mfma_f32_16x16x32_bf16 v[24:27], a[100:103], v[116:119], v[24:27]
    ds_read_b128 a[80:83], v1 offset:37120
    v_perm_b32 v39, v31, v30, s100
    v_mfma_f32_16x16x32_bf16 v[24:27], a[104:107], v[120:123], v[24:27]
    v_exp_f32 v17, v17
    v_mfma_f32_16x16x32_bf16 v[24:27], a[108:111], v[124:127], v[24:27]
    ds_read_b128 a[84:87], v1 offset:37184
    v_mov_b32 v251, 0
    v_mfma_f32_16x16x32_bf16 v[28:31], a[112:115], v[112:115], v[60:63]
    v_exp_f32 v18, v18
    v_mfma_f32_16x16x32_bf16 v[28:31], a[116:119], v[116:119], v[28:31]
    ds_read_b128 a[88:91], v1 offset:37248
    v_perm_b32 v40, v17, v16, s100
    v_mfma_f32_16x16x32_bf16 v[28:31], a[120:123], v[120:123], v[28:31]
    v_exp_f32 v19, v19
    v_mfma_f32_16x16x32_bf16 v[28:31], a[124:127], v[124:127], v[28:31]
    ds_read_b128 a[92:95], v1 offset:37312
    v_mov_b32 v252, 0
    v_mfma_f32_16x16x32_bf16 v[192:195], a[128:131], v[32:35], 0
    v_exp_f32 v20, v20
    v_mfma_f32_16x16x32_bf16 v[192:195], a[132:135], v[36:39], v[192:195]
    ds_read_b128 a[96:99], v1 offset:37376
    v_perm_b32 v41, v19, v18, s100
    v_mfma_f32_16x16x32_bf16 v[196:199], a[136:139], v[32:35], 0
    v_exp_f32 v21, v21
    v_mfma_f32_16x16x32_bf16 v[196:199], a[140:143], v[36:39], v[196:199]
    ds_read_b128 a[100:103], v1 offset:37440
    v_mov_b32 v253, 0
    v_mfma_f32_16x16x32_bf16 v[200:203], a[144:147], v[32:35], 0
    v_exp_f32 v22, v22
    v_mfma_f32_16x16x32_bf16 v[200:203], a[148:151], v[36:39], v[200:203]
    ds_read_b128 a[104:107], v1 offset:37504
    v_perm_b32 v42, v21, v20, s100
    v_mfma_f32_16x16x32_bf16 v[204:207], a[152:155], v[32:35], 0
    v_exp_f32 v23, v23
    v_mfma_f32_16x16x32_bf16 v[204:207], a[156:159], v[36:39], v[204:207]
    ds_read_b128 a[108:111], v1 offset:37568
    v_mov_b32 v254, 0
    v_mfma_f32_16x16x32_bf16 v[208:211], a[160:163], v[32:35], 0
    v_exp_f32 v24, v24
    v_mfma_f32_16x16x32_bf16 v[208:211], a[164:167], v[36:39], v[208:211]
    ds_read_b128 a[112:115], v1 offset:37632
    v_perm_b32 v43, v23, v22, s100
    v_mfma_f32_16x16x32_bf16 v[212:215], a[168:171], v[32:35], 0
    v_exp_f32 v25, v25
    v_mfma_f32_16x16x32_bf16 v[212:215], a[172:175], v[36:39], v[212:215]
    ds_read_b128 a[116:119], v1 offset:37696
    v_mov_b32 v255, 0
    v_mfma_f32_16x16x32_bf16 v[216:219], a[176:179], v[32:35], 0
    v_exp_f32 v26, v26
    v_mfma_f32_16x16x32_bf16 v[216:219], a[180:183], v[36:39], v[216:219]
    ds_read_b128 a[120:123], v1 offset:37760
    v_perm_b32 v44, v25, v24, s100
    v_mfma_f32_16x16x32_bf16 v[220:223], a[184:187], v[32:35], 0
    v_exp_f32 v27, v27
    v_mfma_f32_16x16x32_bf16 v[220:223], a[188:191], v[36:39], v[220:223]
    ds_read_b128 a[124:127], v1 offset:37824
    v_smfmac_f32_16x16x64_bf16 a[8:11], a[16:19], v[32:39], v11
    s_waitcnt lgkmcnt(12)
.p2align 5
L2_loop:
    v_mfma_f32_16x16x32_bf16 v[16:19], a[64:67], v[64:67], v[48:51]
    s_sub_u32 s47, s47, s48
    v_exp_f32 v28, v28
    v_mfma_f32_16x16x32_bf16 v[16:19], a[68:71], v[68:71], v[16:19]
    v_perm_b32 v45, v27, v26, s100
    v_add_u32 v1, s48, v1
    v_mfma_f32_16x16x32_bf16 v[16:19], a[72:75], v[72:75], v[16:19]
    v_exp_f32 v29, v29
    v_mfma_f32_16x16x32_bf16 v[16:19], a[76:79], v[76:79], v[16:19]
    s_waitcnt lgkmcnt(8)
    v_mfma_f32_16x16x32_bf16 v[20:23], a[80:83], v[64:67], v[48:51]
    v_exp_f32 v30, v30
    v_mfma_f32_16x16x32_bf16 v[20:23], a[84:87], v[68:71], v[20:23]
    v_perm_b32 v46, v29, v28, s100
    v_add_u32 v2, s48, v2
    v_mfma_f32_16x16x32_bf16 v[20:23], a[88:91], v[72:75], v[20:23]
L2_pad4:
    s_cbranch_execz L2_pad8
    v_exp_f32 v31, v31
    v_mfma_f32_16x16x32_bf16 v[20:23], a[92:95], v[76:79], v[20:23]
    s_waitcnt lgkmcnt(4)
    v_mfma_f32_16x16x32_bf16 v[24:27], a[96:99], v[64:67], v[48:51]
    s_sub_u32 s48, 0, s48
    v_exp_f32 v16, v16
    v_mfma_f32_16x16x32_bf16 v[24:27], a[100:103], v[68:71], v[24:27]
    v_perm_b32 v47, v31, v30, s100
    v_mfma_f32_16x16x32_bf16 v[24:27], a[104:107], v[72:75], v[24:27]
    v_exp_f32 v17, v17
    v_mfma_f32_16x16x32_bf16 v[24:27], a[108:111], v[76:79], v[24:27]
    s_waitcnt lgkmcnt(0)
    v_mfma_f32_16x16x32_bf16 v[28:31], a[112:115], v[64:67], v[48:51]
    v_exp_f32 v18, v18
    v_mfma_f32_16x16x32_bf16 v[28:31], a[116:119], v[68:71], v[28:31]
    v_perm_b32 v32, v17, v16, s100
    v_mfma_f32_16x16x32_bf16 v[28:31], a[120:123], v[72:75], v[28:31]
    v_exp_f32 v19, v19
    v_mfma_f32_16x16x32_bf16 v[28:31], a[124:127], v[76:79], v[28:31]
    s_waitcnt vmcnt(0)
    s_barrier
    v_mfma_f32_16x16x32_bf16 v[224:227], a[128:131], v[40:43], v[224:227]
    v_exp_f32 v20, v20
    v_mfma_f32_16x16x32_bf16 v[224:227], a[132:135], v[44:47], v[224:227]
    ds_read_b64_tr_b16 a[128:129], v2 offset:0
    v_perm_b32 v33, v19, v18, s100
    v_mfma_f32_16x16x32_bf16 v[228:231], a[136:139], v[40:43], v[228:231]
    s_add_u32 m0, s47, 0
    v_exp_f32 v21, v21
    v_mfma_f32_16x16x32_bf16 v[228:231], a[140:143], v[44:47], v[228:231]
    s_add_u32 s46, s46, 16384
    buffer_load_dwordx4 off, s[16:19], s46 offset:0 lds
    v_mfma_f32_16x16x32_bf16 v[232:235], a[144:147], v[40:43], v[232:235]
    v_exp_f32 v22, v22
    v_mfma_f32_16x16x32_bf16 v[232:235], a[148:151], v[44:47], v[232:235]
    ds_read_b64_tr_b16 a[130:131], v2 offset:256
    v_perm_b32 v34, v21, v20, s100
    v_mfma_f32_16x16x32_bf16 v[236:239], a[152:155], v[40:43], v[236:239]
    s_add_u32 m0, s47, 32
    v_exp_f32 v23, v23
    v_mfma_f32_16x16x32_bf16 v[236:239], a[156:159], v[44:47], v[236:239]
    buffer_load_dwordx4 off, s[16:19], s46 offset:1024 lds
    v_mfma_f32_16x16x32_bf16 v[240:243], a[160:163], v[40:43], v[240:243]
    v_exp_f32 v24, v24
    v_mfma_f32_16x16x32_bf16 v[240:243], a[164:167], v[44:47], v[240:243]
    ds_read_b64_tr_b16 a[132:133], v2 offset:512
    v_perm_b32 v35, v23, v22, s100
    v_mfma_f32_16x16x32_bf16 v[244:247], a[168:171], v[40:43], v[244:247]
    s_add_u32 m0, s47, 64
    v_exp_f32 v25, v25
    v_mfma_f32_16x16x32_bf16 v[244:247], a[172:175], v[44:47], v[244:247]
    buffer_load_dwordx4 off, s[16:19], s46 offset:2048 lds
    v_mfma_f32_16x16x32_bf16 v[248:251], a[176:179], v[40:43], v[248:251]
    v_exp_f32 v26, v26
    v_mfma_f32_16x16x32_bf16 v[248:251], a[180:183], v[44:47], v[248:251]
    ds_read_b64_tr_b16 a[134:135], v2 offset:768
    v_perm_b32 v36, v25, v24, s100
    v_mfma_f32_16x16x32_bf16 v[252:255], a[184:187], v[40:43], v[252:255]
    s_add_u32 m0, s47, 96
    v_exp_f32 v27, v27
    v_mfma_f32_16x16x32_bf16 v[252:255], a[188:191], v[44:47], v[252:255]
    buffer_load_dwordx4 off, s[16:19], s46 offset:3072 lds
    v_smfmac_f32_16x16x64_bf16 a[12:15], a[16:19], v[40:47], v11
    ds_read_b64_tr_b16 a[136:137], v2 offset:32
    v_mfma_f32_16x16x32_bf16 v[16:19], a[64:67], v[80:83], v[52:55]
    v_exp_f32 v28, v28
    v_mfma_f32_16x16x32_bf16 v[16:19], a[68:71], v[84:87], v[16:19]
    ds_read_b64_tr_b16 a[138:139], v2 offset:288
    v_perm_b32 v37, v27, v26, s100
    v_mfma_f32_16x16x32_bf16 v[16:19], a[72:75], v[88:91], v[16:19]
    s_add_u32 m0, s47, 16896
    v_exp_f32 v29, v29
    v_mfma_f32_16x16x32_bf16 v[16:19], a[76:79], v[92:95], v[16:19]
    buffer_load_dwordx4 off, s[20:23], s46 offset:0 lds
    v_mfma_f32_16x16x32_bf16 v[20:23], a[80:83], v[80:83], v[52:55]
    v_exp_f32 v30, v30
    v_mfma_f32_16x16x32_bf16 v[20:23], a[84:87], v[84:87], v[20:23]
    ds_read_b64_tr_b16 a[140:141], v2 offset:544
    v_perm_b32 v38, v29, v28, s100
    v_mfma_f32_16x16x32_bf16 v[20:23], a[88:91], v[88:91], v[20:23]
    s_add_u32 m0, s47, 16928
    v_exp_f32 v31, v31
    v_mfma_f32_16x16x32_bf16 v[20:23], a[92:95], v[92:95], v[20:23]
    buffer_load_dwordx4 off, s[20:23], s46 offset:1024 lds
    v_mfma_f32_16x16x32_bf16 v[24:27], a[96:99], v[80:83], v[52:55]
    v_exp_f32 v16, v16
    v_mfma_f32_16x16x32_bf16 v[24:27], a[100:103], v[84:87], v[24:27]
    ds_read_b64_tr_b16 a[142:143], v2 offset:800
    v_perm_b32 v39, v31, v30, s100
    v_mfma_f32_16x16x32_bf16 v[24:27], a[104:107], v[88:91], v[24:27]
    s_add_u32 m0, s47, 16960
    v_exp_f32 v17, v17
    v_mfma_f32_16x16x32_bf16 v[24:27], a[108:111], v[92:95], v[24:27]
    buffer_load_dwordx4 off, s[20:23], s46 offset:2048 lds
    v_mfma_f32_16x16x32_bf16 v[28:31], a[112:115], v[80:83], v[52:55]
    v_exp_f32 v18, v18
    v_mfma_f32_16x16x32_bf16 v[28:31], a[116:119], v[84:87], v[28:31]
    ds_read_b64_tr_b16 a[144:145], v2 offset:64
    v_perm_b32 v40, v17, v16, s100
    v_mfma_f32_16x16x32_bf16 v[28:31], a[120:123], v[88:91], v[28:31]
    s_add_u32 m0, s47, 16992
    v_exp_f32 v19, v19
    v_mfma_f32_16x16x32_bf16 v[28:31], a[124:127], v[92:95], v[28:31]
    buffer_load_dwordx4 off, s[20:23], s46 offset:3072 lds
    v_mfma_f32_16x16x32_bf16 v[128:131], a[192:195], v[32:35], v[128:131]
    v_exp_f32 v20, v20
    v_mfma_f32_16x16x32_bf16 v[128:131], a[196:199], v[36:39], v[128:131]
    ds_read_b64_tr_b16 a[146:147], v2 offset:320
    v_perm_b32 v41, v19, v18, s100
    v_mfma_f32_16x16x32_bf16 v[132:135], a[200:203], v[32:35], v[132:135]
    v_exp_f32 v21, v21
    v_mfma_f32_16x16x32_bf16 v[132:135], a[204:207], v[36:39], v[132:135]
    ds_read_b64_tr_b16 a[148:149], v2 offset:576
    v_mfma_f32_16x16x32_bf16 v[136:139], a[208:211], v[32:35], v[136:139]
    v_exp_f32 v22, v22
    v_mfma_f32_16x16x32_bf16 v[136:139], a[212:215], v[36:39], v[136:139]
    ds_read_b64_tr_b16 a[150:151], v2 offset:832
    v_perm_b32 v42, v21, v20, s100
    v_mfma_f32_16x16x32_bf16 v[140:143], a[216:219], v[32:35], v[140:143]
    v_exp_f32 v23, v23
    v_mfma_f32_16x16x32_bf16 v[140:143], a[220:223], v[36:39], v[140:143]
    ds_read_b64_tr_b16 a[152:153], v2 offset:96
    ds_read_b64_tr_b16 a[154:155], v2 offset:352
    v_mfma_f32_16x16x32_bf16 v[144:147], a[224:227], v[32:35], v[144:147]
    v_exp_f32 v24, v24
    v_mfma_f32_16x16x32_bf16 v[144:147], a[228:231], v[36:39], v[144:147]
    ds_read_b64_tr_b16 a[156:157], v2 offset:608
    v_perm_b32 v43, v23, v22, s100
    v_mfma_f32_16x16x32_bf16 v[148:151], a[232:235], v[32:35], v[148:151]
    v_exp_f32 v25, v25
    v_mfma_f32_16x16x32_bf16 v[148:151], a[236:239], v[36:39], v[148:151]
    ds_read_b64_tr_b16 a[158:159], v2 offset:864
    ds_read_b64_tr_b16 a[160:161], v2 offset:128
    v_mfma_f32_16x16x32_bf16 v[152:155], a[240:243], v[32:35], v[152:155]
    v_exp_f32 v26, v26
    v_mfma_f32_16x16x32_bf16 v[152:155], a[244:247], v[36:39], v[152:155]
    ds_read_b64_tr_b16 a[162:163], v2 offset:384
    v_perm_b32 v44, v25, v24, s100
    v_mfma_f32_16x16x32_bf16 v[156:159], a[248:251], v[32:35], v[156:159]
    v_exp_f32 v27, v27
    v_mfma_f32_16x16x32_bf16 v[156:159], a[252:255], v[36:39], v[156:159]
    ds_read_b64_tr_b16 a[164:165], v2 offset:640
    ds_read_b64_tr_b16 a[166:167], v2 offset:896
    v_smfmac_f32_16x16x64_bf16 a[0:3], a[16:19], v[32:39], v11
    ds_read_b64_tr_b16 a[168:169], v2 offset:160
    ds_read_b64_tr_b16 a[170:171], v2 offset:416
    v_mfma_f32_16x16x32_bf16 v[16:19], a[64:67], v[96:99], v[56:59]
    v_exp_f32 v28, v28
    v_mfma_f32_16x16x32_bf16 v[16:19], a[68:71], v[100:103], v[16:19]
    ds_read_b64_tr_b16 a[172:173], v2 offset:672
    v_perm_b32 v45, v27, v26, s100
    v_mfma_f32_16x16x32_bf16 v[16:19], a[72:75], v[104:107], v[16:19]
    s_add_u32 m0, s47, 36864
    v_exp_f32 v29, v29
    v_mfma_f32_16x16x32_bf16 v[16:19], a[76:79], v[108:111], v[16:19]
    s_add_u32 s46, s46, 16384
    buffer_load_dwordx4 off, s[16:19], s46 offset:0 lds
    v_mfma_f32_16x16x32_bf16 v[20:23], a[80:83], v[96:99], v[56:59]
    v_exp_f32 v30, v30
    v_mfma_f32_16x16x32_bf16 v[20:23], a[84:87], v[100:103], v[20:23]
    ds_read_b64_tr_b16 a[174:175], v2 offset:928
    v_perm_b32 v46, v29, v28, s100
    v_mfma_f32_16x16x32_bf16 v[20:23], a[88:91], v[104:107], v[20:23]
    s_add_u32 m0, s47, 36896
    v_exp_f32 v31, v31
    v_mfma_f32_16x16x32_bf16 v[20:23], a[92:95], v[108:111], v[20:23]
    buffer_load_dwordx4 off, s[16:19], s46 offset:1024 lds
    v_mfma_f32_16x16x32_bf16 v[24:27], a[96:99], v[96:99], v[56:59]
    v_exp_f32 v16, v16
    v_mfma_f32_16x16x32_bf16 v[24:27], a[100:103], v[100:103], v[24:27]
    ds_read_b64_tr_b16 a[176:177], v2 offset:192
    v_perm_b32 v47, v31, v30, s100
    v_mfma_f32_16x16x32_bf16 v[24:27], a[104:107], v[104:107], v[24:27]
    s_add_u32 m0, s47, 36928
    v_exp_f32 v17, v17
    v_mfma_f32_16x16x32_bf16 v[24:27], a[108:111], v[108:111], v[24:27]
    buffer_load_dwordx4 off, s[16:19], s46 offset:2048 lds
    v_mfma_f32_16x16x32_bf16 v[28:31], a[112:115], v[96:99], v[56:59]
    v_exp_f32 v18, v18
    v_mfma_f32_16x16x32_bf16 v[28:31], a[116:119], v[100:103], v[28:31]
    ds_read_b64_tr_b16 a[178:179], v2 offset:448
    v_perm_b32 v32, v17, v16, s100
    v_mfma_f32_16x16x32_bf16 v[28:31], a[120:123], v[104:107], v[28:31]
    s_add_u32 m0, s47, 36960
    v_exp_f32 v19, v19
    v_mfma_f32_16x16x32_bf16 v[28:31], a[124:127], v[108:111], v[28:31]
    buffer_load_dwordx4 off, s[16:19], s46 offset:3072 lds
    v_mfma_f32_16x16x32_bf16 v[160:163], a[192:195], v[40:43], v[160:163]
    v_exp_f32 v20, v20
    v_mfma_f32_16x16x32_bf16 v[160:163], a[196:199], v[44:47], v[160:163]
    ds_read_b64_tr_b16 a[180:181], v2 offset:704
    v_perm_b32 v33, v19, v18, s100
    v_mfma_f32_16x16x32_bf16 v[164:167], a[200:203], v[40:43], v[164:167]
    s_add_u32 m0, s47, 53760
    v_exp_f32 v21, v21
    v_mfma_f32_16x16x32_bf16 v[164:167], a[204:207], v[44:47], v[164:167]
    buffer_load_dwordx4 off, s[20:23], s46 offset:0 lds
    v_mfma_f32_16x16x32_bf16 v[168:171], a[208:211], v[40:43], v[168:171]
    v_exp_f32 v22, v22
    v_mfma_f32_16x16x32_bf16 v[168:171], a[212:215], v[44:47], v[168:171]
    ds_read_b64_tr_b16 a[182:183], v2 offset:960
    v_perm_b32 v34, v21, v20, s100
    v_mfma_f32_16x16x32_bf16 v[172:175], a[216:219], v[40:43], v[172:175]
    s_add_u32 m0, s47, 53792
    v_exp_f32 v23, v23
    v_mfma_f32_16x16x32_bf16 v[172:175], a[220:223], v[44:47], v[172:175]
    buffer_load_dwordx4 off, s[20:23], s46 offset:1024 lds
    v_mfma_f32_16x16x32_bf16 v[176:179], a[224:227], v[40:43], v[176:179]
    v_exp_f32 v24, v24
    v_mfma_f32_16x16x32_bf16 v[176:179], a[228:231], v[44:47], v[176:179]
    ds_read_b64_tr_b16 a[184:185], v2 offset:224
    v_perm_b32 v35, v23, v22, s100
    v_mfma_f32_16x16x32_bf16 v[180:183], a[232:235], v[40:43], v[180:183]
    s_add_u32 m0, s47, 53824
    v_exp_f32 v25, v25
    v_mfma_f32_16x16x32_bf16 v[180:183], a[236:239], v[44:47], v[180:183]
    buffer_load_dwordx4 off, s[20:23], s46 offset:2048 lds
    v_mfma_f32_16x16x32_bf16 v[184:187], a[240:243], v[40:43], v[184:187]
    v_exp_f32 v26, v26
    v_mfma_f32_16x16x32_bf16 v[184:187], a[244:247], v[44:47], v[184:187]
    ds_read_b64_tr_b16 a[186:187], v2 offset:480
    v_perm_b32 v36, v25, v24, s100
    v_mfma_f32_16x16x32_bf16 v[188:191], a[248:251], v[40:43], v[188:191]
    s_add_u32 m0, s47, 53856
    v_exp_f32 v27, v27
    v_mfma_f32_16x16x32_bf16 v[188:191], a[252:255], v[44:47], v[188:191]
    buffer_load_dwordx4 off, s[20:23], s46 offset:3072 lds
    v_smfmac_f32_16x16x64_bf16 a[4:7], a[16:19], v[40:47], v11
    ds_read_b64_tr_b16 a[188:189], v2 offset:736
    ds_read_b64_tr_b16 a[190:191], v2 offset:992
    v_mfma_f32_16x16x32_bf16 v[16:19], a[64:67], v[112:115], v[60:63]
    v_exp_f32 v28, v28
    v_mfma_f32_16x16x32_bf16 v[16:19], a[68:71], v[116:119], v[16:19]
    ds_read_b128 a[64:67], v1 offset:0
    v_perm_b32 v37, v27, v26, s100
    v_mfma_f32_16x16x32_bf16 v[16:19], a[72:75], v[120:123], v[16:19]
    v_exp_f32 v29, v29
    v_mfma_f32_16x16x32_bf16 v[16:19], a[76:79], v[124:127], v[16:19]
    ds_read_b128 a[68:71], v1 offset:64
    v_mfma_f32_16x16x32_bf16 v[20:23], a[80:83], v[112:115], v[60:63]
    v_exp_f32 v30, v30
    v_mfma_f32_16x16x32_bf16 v[20:23], a[84:87], v[116:119], v[20:23]
    ds_read_b128 a[72:75], v1 offset:128
    v_perm_b32 v38, v29, v28, s100
    v_mfma_f32_16x16x32_bf16 v[20:23], a[88:91], v[120:123], v[20:23]
    v_exp_f32 v31, v31
    v_mfma_f32_16x16x32_bf16 v[20:23], a[92:95], v[124:127], v[20:23]
    ds_read_b128 a[76:79], v1 offset:192
    v_mfma_f32_16x16x32_bf16 v[24:27], a[96:99], v[112:115], v[60:63]
    v_exp_f32 v16, v16
    v_mfma_f32_16x16x32_bf16 v[24:27], a[100:103], v[116:119], v[24:27]
    ds_read_b128 a[80:83], v1 offset:256
    v_perm_b32 v39, v31, v30, s100
    v_mfma_f32_16x16x32_bf16 v[24:27], a[104:107], v[120:123], v[24:27]
    v_exp_f32 v17, v17
    v_mfma_f32_16x16x32_bf16 v[24:27], a[108:111], v[124:127], v[24:27]
    ds_read_b128 a[84:87], v1 offset:320
    v_mfma_f32_16x16x32_bf16 v[28:31], a[112:115], v[112:115], v[60:63]
    v_exp_f32 v18, v18
    v_mfma_f32_16x16x32_bf16 v[28:31], a[116:119], v[116:119], v[28:31]
    ds_read_b128 a[88:91], v1 offset:384
    v_perm_b32 v40, v17, v16, s100
    v_mfma_f32_16x16x32_bf16 v[28:31], a[120:123], v[120:123], v[28:31]
    v_exp_f32 v19, v19
    v_mfma_f32_16x16x32_bf16 v[28:31], a[124:127], v[124:127], v[28:31]
    ds_read_b128 a[92:95], v1 offset:448
    v_mfma_f32_16x16x32_bf16 v[192:195], a[192:195], v[32:35], v[192:195]
    v_exp_f32 v20, v20
    v_mfma_f32_16x16x32_bf16 v[192:195], a[196:199], v[36:39], v[192:195]
    ds_read_b128 a[96:99], v1 offset:512
    v_perm_b32 v41, v19, v18, s100
    v_mfma_f32_16x16x32_bf16 v[196:199], a[200:203], v[32:35], v[196:199]
    v_exp_f32 v21, v21
    v_mfma_f32_16x16x32_bf16 v[196:199], a[204:207], v[36:39], v[196:199]
    ds_read_b128 a[100:103], v1 offset:576
    v_mfma_f32_16x16x32_bf16 v[200:203], a[208:211], v[32:35], v[200:203]
    v_exp_f32 v22, v22
    v_mfma_f32_16x16x32_bf16 v[200:203], a[212:215], v[36:39], v[200:203]
    ds_read_b128 a[104:107], v1 offset:640
    v_perm_b32 v42, v21, v20, s100
    v_mfma_f32_16x16x32_bf16 v[204:207], a[216:219], v[32:35], v[204:207]
    v_exp_f32 v23, v23
    v_mfma_f32_16x16x32_bf16 v[204:207], a[220:223], v[36:39], v[204:207]
    ds_read_b128 a[108:111], v1 offset:704
    v_mfma_f32_16x16x32_bf16 v[208:211], a[224:227], v[32:35], v[208:211]
    v_exp_f32 v24, v24
    v_mfma_f32_16x16x32_bf16 v[208:211], a[228:231], v[36:39], v[208:211]
    ds_read_b128 a[112:115], v1 offset:768
    v_perm_b32 v43, v23, v22, s100
    v_mfma_f32_16x16x32_bf16 v[212:215], a[232:235], v[32:35], v[212:215]
    v_exp_f32 v25, v25
    v_mfma_f32_16x16x32_bf16 v[212:215], a[236:239], v[36:39], v[212:215]
    ds_read_b128 a[116:119], v1 offset:832
    v_mfma_f32_16x16x32_bf16 v[216:219], a[240:243], v[32:35], v[216:219]
    v_exp_f32 v26, v26
    v_mfma_f32_16x16x32_bf16 v[216:219], a[244:247], v[36:39], v[216:219]
    ds_read_b128 a[120:123], v1 offset:896
    v_perm_b32 v44, v25, v24, s100
    v_mfma_f32_16x16x32_bf16 v[220:223], a[248:251], v[32:35], v[220:223]
    v_exp_f32 v27, v27
    v_mfma_f32_16x16x32_bf16 v[220:223], a[252:255], v[36:39], v[220:223]
    ds_read_b128 a[124:127], v1 offset:960
    v_smfmac_f32_16x16x64_bf16 a[8:11], a[16:19], v[32:39], v11
    s_waitcnt lgkmcnt(12)
    v_mfma_f32_16x16x32_bf16 v[16:19], a[64:67], v[64:67], v[48:51]
    v_exp_f32 v28, v28
    v_mfma_f32_16x16x32_bf16 v[16:19], a[68:71], v[68:71], v[16:19]
    v_perm_b32 v45, v27, v26, s100
    v_mfma_f32_16x16x32_bf16 v[16:19], a[72:75], v[72:75], v[16:19]
    v_exp_f32 v29, v29
    v_mfma_f32_16x16x32_bf16 v[16:19], a[76:79], v[76:79], v[16:19]
    s_waitcnt lgkmcnt(8)
    v_mfma_f32_16x16x32_bf16 v[20:23], a[80:83], v[64:67], v[48:51]
    v_exp_f32 v30, v30
    v_mfma_f32_16x16x32_bf16 v[20:23], a[84:87], v[68:71], v[20:23]
    v_perm_b32 v46, v29, v28, s100
    v_mfma_f32_16x16x32_bf16 v[20:23], a[88:91], v[72:75], v[20:23]
    v_exp_f32 v31, v31
    v_mfma_f32_16x16x32_bf16 v[20:23], a[92:95], v[76:79], v[20:23]
    s_waitcnt lgkmcnt(4)
    v_mfma_f32_16x16x32_bf16 v[24:27], a[96:99], v[64:67], v[48:51]
    v_exp_f32 v16, v16
    v_mfma_f32_16x16x32_bf16 v[24:27], a[100:103], v[68:71], v[24:27]
    v_perm_b32 v47, v31, v30, s100
    v_mfma_f32_16x16x32_bf16 v[24:27], a[104:107], v[72:75], v[24:27]
    v_exp_f32 v17, v17
    v_mfma_f32_16x16x32_bf16 v[24:27], a[108:111], v[76:79], v[24:27]
    s_waitcnt lgkmcnt(0)
    v_mfma_f32_16x16x32_bf16 v[28:31], a[112:115], v[64:67], v[48:51]
    v_exp_f32 v18, v18
    v_mfma_f32_16x16x32_bf16 v[28:31], a[116:119], v[68:71], v[28:31]
    v_perm_b32 v32, v17, v16, s100
    v_mfma_f32_16x16x32_bf16 v[28:31], a[120:123], v[72:75], v[28:31]
    v_exp_f32 v19, v19
    v_mfma_f32_16x16x32_bf16 v[28:31], a[124:127], v[76:79], v[28:31]
    v_mfma_f32_16x16x32_bf16 v[224:227], a[192:195], v[40:43], v[224:227]
    v_exp_f32 v20, v20
    v_mfma_f32_16x16x32_bf16 v[224:227], a[196:199], v[44:47], v[224:227]
    ds_read_b64_tr_b16 a[192:193], v2 offset:36864
    v_perm_b32 v33, v19, v18, s100
    v_mfma_f32_16x16x32_bf16 v[228:231], a[200:203], v[40:43], v[228:231]
    v_exp_f32 v21, v21
    v_mfma_f32_16x16x32_bf16 v[228:231], a[204:207], v[44:47], v[228:231]
    ds_read_b64_tr_b16 a[194:195], v2 offset:37120
    v_mfma_f32_16x16x32_bf16 v[232:235], a[208:211], v[40:43], v[232:235]
    v_exp_f32 v22, v22
    v_mfma_f32_16x16x32_bf16 v[232:235], a[212:215], v[44:47], v[232:235]
    ds_read_b64_tr_b16 a[196:197], v2 offset:37376
    v_perm_b32 v34, v21, v20, s100
    v_mfma_f32_16x16x32_bf16 v[236:239], a[216:219], v[40:43], v[236:239]
    v_exp_f32 v23, v23
    v_mfma_f32_16x16x32_bf16 v[236:239], a[220:223], v[44:47], v[236:239]
    ds_read_b64_tr_b16 a[198:199], v2 offset:37632
    v_mfma_f32_16x16x32_bf16 v[240:243], a[224:227], v[40:43], v[240:243]
    v_exp_f32 v24, v24
    v_mfma_f32_16x16x32_bf16 v[240:243], a[228:231], v[44:47], v[240:243]
    ds_read_b64_tr_b16 a[200:201], v2 offset:36896
    v_perm_b32 v35, v23, v22, s100
    v_mfma_f32_16x16x32_bf16 v[244:247], a[232:235], v[40:43], v[244:247]
    v_exp_f32 v25, v25
    v_mfma_f32_16x16x32_bf16 v[244:247], a[236:239], v[44:47], v[244:247]
    ds_read_b64_tr_b16 a[202:203], v2 offset:37152
    v_mfma_f32_16x16x32_bf16 v[248:251], a[240:243], v[40:43], v[248:251]
    v_exp_f32 v26, v26
    v_mfma_f32_16x16x32_bf16 v[248:251], a[244:247], v[44:47], v[248:251]
    ds_read_b64_tr_b16 a[204:205], v2 offset:37408
    v_perm_b32 v36, v25, v24, s100
    v_mfma_f32_16x16x32_bf16 v[252:255], a[248:251], v[40:43], v[252:255]
    v_exp_f32 v27, v27
    v_mfma_f32_16x16x32_bf16 v[252:255], a[252:255], v[44:47], v[252:255]
    ds_read_b64_tr_b16 a[206:207], v2 offset:37664
    v_smfmac_f32_16x16x64_bf16 a[12:15], a[16:19], v[40:47], v11
    ds_read_b64_tr_b16 a[208:209], v2 offset:36928
    v_mfma_f32_16x16x32_bf16 v[16:19], a[64:67], v[80:83], v[52:55]
    v_exp_f32 v28, v28
    v_mfma_f32_16x16x32_bf16 v[16:19], a[68:71], v[84:87], v[16:19]
    ds_read_b64_tr_b16 a[210:211], v2 offset:37184
    v_perm_b32 v37, v27, v26, s100
    v_mfma_f32_16x16x32_bf16 v[16:19], a[72:75], v[88:91], v[16:19]
    v_exp_f32 v29, v29
    v_mfma_f32_16x16x32_bf16 v[16:19], a[76:79], v[92:95], v[16:19]
    ds_read_b64_tr_b16 a[212:213], v2 offset:37440
    v_mfma_f32_16x16x32_bf16 v[20:23], a[80:83], v[80:83], v[52:55]
    v_exp_f32 v30, v30
    v_mfma_f32_16x16x32_bf16 v[20:23], a[84:87], v[84:87], v[20:23]
    ds_read_b64_tr_b16 a[214:215], v2 offset:37696
    v_perm_b32 v38, v29, v28, s100
    v_mfma_f32_16x16x32_bf16 v[20:23], a[88:91], v[88:91], v[20:23]
    v_exp_f32 v31, v31
    v_mfma_f32_16x16x32_bf16 v[20:23], a[92:95], v[92:95], v[20:23]
    ds_read_b64_tr_b16 a[216:217], v2 offset:36960
    v_mfma_f32_16x16x32_bf16 v[24:27], a[96:99], v[80:83], v[52:55]
    v_exp_f32 v16, v16
    v_mfma_f32_16x16x32_bf16 v[24:27], a[100:103], v[84:87], v[24:27]
    ds_read_b64_tr_b16 a[218:219], v2 offset:37216
    v_perm_b32 v39, v31, v30, s100
    v_mfma_f32_16x16x32_bf16 v[24:27], a[104:107], v[88:91], v[24:27]
    v_exp_f32 v17, v17
    v_mfma_f32_16x16x32_bf16 v[24:27], a[108:111], v[92:95], v[24:27]
    ds_read_b64_tr_b16 a[220:221], v2 offset:37472
    v_mfma_f32_16x16x32_bf16 v[28:31], a[112:115], v[80:83], v[52:55]
    v_exp_f32 v18, v18
    v_mfma_f32_16x16x32_bf16 v[28:31], a[116:119], v[84:87], v[28:31]
    ds_read_b64_tr_b16 a[222:223], v2 offset:37728
    v_perm_b32 v40, v17, v16, s100
    v_mfma_f32_16x16x32_bf16 v[28:31], a[120:123], v[88:91], v[28:31]
    v_exp_f32 v19, v19
    v_mfma_f32_16x16x32_bf16 v[28:31], a[124:127], v[92:95], v[28:31]
    ds_read_b64_tr_b16 a[224:225], v2 offset:36992
    v_mfma_f32_16x16x32_bf16 v[128:131], a[128:131], v[32:35], v[128:131]
    v_exp_f32 v20, v20
    v_mfma_f32_16x16x32_bf16 v[128:131], a[132:135], v[36:39], v[128:131]
    ds_read_b64_tr_b16 a[226:227], v2 offset:37248
    v_perm_b32 v41, v19, v18, s100
    v_mfma_f32_16x16x32_bf16 v[132:135], a[136:139], v[32:35], v[132:135]
    v_exp_f32 v21, v21
    v_mfma_f32_16x16x32_bf16 v[132:135], a[140:143], v[36:39], v[132:135]
    ds_read_b64_tr_b16 a[228:229], v2 offset:37504
    v_mfma_f32_16x16x32_bf16 v[136:139], a[144:147], v[32:35], v[136:139]
    v_exp_f32 v22, v22
    v_mfma_f32_16x16x32_bf16 v[136:139], a[148:151], v[36:39], v[136:139]
    ds_read_b64_tr_b16 a[230:231], v2 offset:37760
    v_perm_b32 v42, v21, v20, s100
    v_mfma_f32_16x16x32_bf16 v[140:143], a[152:155], v[32:35], v[140:143]
    v_exp_f32 v23, v23
    v_mfma_f32_16x16x32_bf16 v[140:143], a[156:159], v[36:39], v[140:143]
    ds_read_b64_tr_b16 a[232:233], v2 offset:37024
    v_mfma_f32_16x16x32_bf16 v[144:147], a[160:163], v[32:35], v[144:147]
    v_exp_f32 v24, v24
    v_mfma_f32_16x16x32_bf16 v[144:147], a[164:167], v[36:39], v[144:147]
    ds_read_b64_tr_b16 a[234:235], v2 offset:37280
    v_perm_b32 v43, v23, v22, s100
    v_mfma_f32_16x16x32_bf16 v[148:151], a[168:171], v[32:35], v[148:151]
    v_exp_f32 v25, v25
    v_mfma_f32_16x16x32_bf16 v[148:151], a[172:175], v[36:39], v[148:151]
    ds_read_b64_tr_b16 a[236:237], v2 offset:37536
    v_mfma_f32_16x16x32_bf16 v[152:155], a[176:179], v[32:35], v[152:155]
    v_exp_f32 v26, v26
    v_mfma_f32_16x16x32_bf16 v[152:155], a[180:183], v[36:39], v[152:155]
    ds_read_b64_tr_b16 a[238:239], v2 offset:37792
    v_perm_b32 v44, v25, v24, s100
    v_mfma_f32_16x16x32_bf16 v[156:159], a[184:187], v[32:35], v[156:159]
    v_exp_f32 v27, v27
    v_mfma_f32_16x16x32_bf16 v[156:159], a[188:191], v[36:39], v[156:159]
    ds_read_b64_tr_b16 a[240:241], v2 offset:37056
    v_smfmac_f32_16x16x64_bf16 a[0:3], a[16:19], v[32:39], v11
    ds_read_b64_tr_b16 a[242:243], v2 offset:37312
    v_mfma_f32_16x16x32_bf16 v[16:19], a[64:67], v[96:99], v[56:59]
    v_exp_f32 v28, v28
    v_mfma_f32_16x16x32_bf16 v[16:19], a[68:71], v[100:103], v[16:19]
    ds_read_b64_tr_b16 a[244:245], v2 offset:37568
    v_perm_b32 v45, v27, v26, s100
    v_mfma_f32_16x16x32_bf16 v[16:19], a[72:75], v[104:107], v[16:19]
    v_exp_f32 v29, v29
    v_mfma_f32_16x16x32_bf16 v[16:19], a[76:79], v[108:111], v[16:19]
    ds_read_b64_tr_b16 a[246:247], v2 offset:37824
    v_mfma_f32_16x16x32_bf16 v[20:23], a[80:83], v[96:99], v[56:59]
    v_exp_f32 v30, v30
    v_mfma_f32_16x16x32_bf16 v[20:23], a[84:87], v[100:103], v[20:23]
    ds_read_b64_tr_b16 a[248:249], v2 offset:37088
    v_perm_b32 v46, v29, v28, s100
    v_mfma_f32_16x16x32_bf16 v[20:23], a[88:91], v[104:107], v[20:23]
    v_exp_f32 v31, v31
    v_mfma_f32_16x16x32_bf16 v[20:23], a[92:95], v[108:111], v[20:23]
    ds_read_b64_tr_b16 a[250:251], v2 offset:37344
    v_mfma_f32_16x16x32_bf16 v[24:27], a[96:99], v[96:99], v[56:59]
    v_exp_f32 v16, v16
    v_mfma_f32_16x16x32_bf16 v[24:27], a[100:103], v[100:103], v[24:27]
    ds_read_b64_tr_b16 a[252:253], v2 offset:37600
    v_perm_b32 v47, v31, v30, s100
    v_mfma_f32_16x16x32_bf16 v[24:27], a[104:107], v[104:107], v[24:27]
    v_exp_f32 v17, v17
    v_mfma_f32_16x16x32_bf16 v[24:27], a[108:111], v[108:111], v[24:27]
    ds_read_b64_tr_b16 a[254:255], v2 offset:37856
    v_mfma_f32_16x16x32_bf16 v[28:31], a[112:115], v[96:99], v[56:59]
    v_exp_f32 v18, v18
    v_mfma_f32_16x16x32_bf16 v[28:31], a[116:119], v[100:103], v[28:31]
    v_perm_b32 v32, v17, v16, s100
    v_mfma_f32_16x16x32_bf16 v[28:31], a[120:123], v[104:107], v[28:31]
    v_exp_f32 v19, v19
    v_mfma_f32_16x16x32_bf16 v[28:31], a[124:127], v[108:111], v[28:31]
    v_mfma_f32_16x16x32_bf16 v[160:163], a[128:131], v[40:43], v[160:163]
    v_exp_f32 v20, v20
    v_mfma_f32_16x16x32_bf16 v[160:163], a[132:135], v[44:47], v[160:163]
    v_perm_b32 v33, v19, v18, s100
    v_mfma_f32_16x16x32_bf16 v[164:167], a[136:139], v[40:43], v[164:167]
    v_exp_f32 v21, v21
    v_mfma_f32_16x16x32_bf16 v[164:167], a[140:143], v[44:47], v[164:167]
    v_mfma_f32_16x16x32_bf16 v[168:171], a[144:147], v[40:43], v[168:171]
    v_exp_f32 v22, v22
    v_mfma_f32_16x16x32_bf16 v[168:171], a[148:151], v[44:47], v[168:171]
    v_perm_b32 v34, v21, v20, s100
    v_mfma_f32_16x16x32_bf16 v[172:175], a[152:155], v[40:43], v[172:175]
    v_exp_f32 v23, v23
    v_mfma_f32_16x16x32_bf16 v[172:175], a[156:159], v[44:47], v[172:175]
    v_mfma_f32_16x16x32_bf16 v[176:179], a[160:163], v[40:43], v[176:179]
    v_exp_f32 v24, v24
    v_mfma_f32_16x16x32_bf16 v[176:179], a[164:167], v[44:47], v[176:179]
    v_perm_b32 v35, v23, v22, s100
    v_mfma_f32_16x16x32_bf16 v[180:183], a[168:171], v[40:43], v[180:183]
    v_exp_f32 v25, v25
    v_mfma_f32_16x16x32_bf16 v[180:183], a[172:175], v[44:47], v[180:183]
    v_mfma_f32_16x16x32_bf16 v[184:187], a[176:179], v[40:43], v[184:187]
    v_exp_f32 v26, v26
    v_mfma_f32_16x16x32_bf16 v[184:187], a[180:183], v[44:47], v[184:187]
    v_perm_b32 v36, v25, v24, s100
    v_mfma_f32_16x16x32_bf16 v[188:191], a[184:187], v[40:43], v[188:191]
    v_exp_f32 v27, v27
    v_mfma_f32_16x16x32_bf16 v[188:191], a[188:191], v[44:47], v[188:191]
    v_smfmac_f32_16x16x64_bf16 a[4:7], a[16:19], v[40:47], v11
    v_mfma_f32_16x16x32_bf16 v[16:19], a[64:67], v[112:115], v[60:63]
    v_exp_f32 v28, v28
    v_mfma_f32_16x16x32_bf16 v[16:19], a[68:71], v[116:119], v[16:19]
    ds_read_b128 a[64:67], v1 offset:36864
    v_perm_b32 v37, v27, v26, s100
    v_mfma_f32_16x16x32_bf16 v[16:19], a[72:75], v[120:123], v[16:19]
    v_exp_f32 v29, v29
    v_mfma_f32_16x16x32_bf16 v[16:19], a[76:79], v[124:127], v[16:19]
    ds_read_b128 a[68:71], v1 offset:36928
    v_mfma_f32_16x16x32_bf16 v[20:23], a[80:83], v[112:115], v[60:63]
    v_exp_f32 v30, v30
    v_mfma_f32_16x16x32_bf16 v[20:23], a[84:87], v[116:119], v[20:23]
    ds_read_b128 a[72:75], v1 offset:36992
    v_perm_b32 v38, v29, v28, s100
    v_mfma_f32_16x16x32_bf16 v[20:23], a[88:91], v[120:123], v[20:23]
    v_exp_f32 v31, v31
    v_mfma_f32_16x16x32_bf16 v[20:23], a[92:95], v[124:127], v[20:23]
    ds_read_b128 a[76:79], v1 offset:37056
    v_mfma_f32_16x16x32_bf16 v[24:27], a[96:99], v[112:115], v[60:63]
    v_exp_f32 v16, v16
    v_mfma_f32_16x16x32_bf16 v[24:27], a[100:103], v[116:119], v[24:27]
    ds_read_b128 a[80:83], v1 offset:37120
    v_perm_b32 v39, v31, v30, s100
    v_mfma_f32_16x16x32_bf16 v[24:27], a[104:107], v[120:123], v[24:27]
    v_exp_f32 v17, v17
    v_mfma_f32_16x16x32_bf16 v[24:27], a[108:111], v[124:127], v[24:27]
    ds_read_b128 a[84:87], v1 offset:37184
    v_mfma_f32_16x16x32_bf16 v[28:31], a[112:115], v[112:115], v[60:63]
    v_exp_f32 v18, v18
    v_mfma_f32_16x16x32_bf16 v[28:31], a[116:119], v[116:119], v[28:31]
    ds_read_b128 a[88:91], v1 offset:37248
    v_perm_b32 v40, v17, v16, s100
    v_mfma_f32_16x16x32_bf16 v[28:31], a[120:123], v[120:123], v[28:31]
    v_exp_f32 v19, v19
    v_mfma_f32_16x16x32_bf16 v[28:31], a[124:127], v[124:127], v[28:31]
    ds_read_b128 a[92:95], v1 offset:37312
    v_mfma_f32_16x16x32_bf16 v[192:195], a[128:131], v[32:35], v[192:195]
    v_exp_f32 v20, v20
    v_mfma_f32_16x16x32_bf16 v[192:195], a[132:135], v[36:39], v[192:195]
    ds_read_b128 a[96:99], v1 offset:37376
    v_perm_b32 v41, v19, v18, s100
    v_mfma_f32_16x16x32_bf16 v[196:199], a[136:139], v[32:35], v[196:199]
    v_exp_f32 v21, v21
    v_mfma_f32_16x16x32_bf16 v[196:199], a[140:143], v[36:39], v[196:199]
    ds_read_b128 a[100:103], v1 offset:37440
    v_mfma_f32_16x16x32_bf16 v[200:203], a[144:147], v[32:35], v[200:203]
    v_exp_f32 v22, v22
    v_mfma_f32_16x16x32_bf16 v[200:203], a[148:151], v[36:39], v[200:203]
    ds_read_b128 a[104:107], v1 offset:37504
    v_perm_b32 v42, v21, v20, s100
    v_mfma_f32_16x16x32_bf16 v[204:207], a[152:155], v[32:35], v[204:207]
    v_exp_f32 v23, v23
    v_mfma_f32_16x16x32_bf16 v[204:207], a[156:159], v[36:39], v[204:207]
    ds_read_b128 a[108:111], v1 offset:37568
    v_mfma_f32_16x16x32_bf16 v[208:211], a[160:163], v[32:35], v[208:211]
    v_exp_f32 v24, v24
    v_mfma_f32_16x16x32_bf16 v[208:211], a[164:167], v[36:39], v[208:211]
    ds_read_b128 a[112:115], v1 offset:37632
    v_perm_b32 v43, v23, v22, s100
    v_mfma_f32_16x16x32_bf16 v[212:215], a[168:171], v[32:35], v[212:215]
    v_exp_f32 v25, v25
    v_mfma_f32_16x16x32_bf16 v[212:215], a[172:175], v[36:39], v[212:215]
    ds_read_b128 a[116:119], v1 offset:37696
    v_mfma_f32_16x16x32_bf16 v[216:219], a[176:179], v[32:35], v[216:219]
    v_exp_f32 v26, v26
    v_mfma_f32_16x16x32_bf16 v[216:219], a[180:183], v[36:39], v[216:219]
    s_sub_u32 s49, s49, 1
    ds_read_b128 a[120:123], v1 offset:37760
    v_perm_b32 v44, v25, v24, s100
    v_mfma_f32_16x16x32_bf16 v[220:223], a[184:187], v[32:35], v[220:223]
    s_cmp_lg_u32 s49, 0
    v_exp_f32 v27, v27
    v_mfma_f32_16x16x32_bf16 v[220:223], a[188:191], v[36:39], v[220:223]
L2_pad5:
    s_cbranch_execz L2_pad9
    ds_read_b128 a[124:127], v1 offset:37824
    v_smfmac_f32_16x16x64_bf16 a[8:11], a[16:19], v[32:39], v11
    s_waitcnt lgkmcnt(12)
    s_cbranch_scc1 L2_loop
    v_mfma_f32_16x16x32_bf16 v[16:19], a[64:67], v[64:67], v[48:51]
    s_sub_u32 s47, s47, s48
    v_exp_f32 v28, v28
    v_mfma_f32_16x16x32_bf16 v[16:19], a[68:71], v[68:71], v[16:19]
    v_perm_b32 v45, v27, v26, s100
    v_add_u32 v1, s48, v1
    v_mfma_f32_16x16x32_bf16 v[16:19], a[72:75], v[72:75], v[16:19]
    v_exp_f32 v29, v29
    v_mfma_f32_16x16x32_bf16 v[16:19], a[76:79], v[76:79], v[16:19]
    s_waitcnt lgkmcnt(8)
    v_mfma_f32_16x16x32_bf16 v[20:23], a[80:83], v[64:67], v[48:51]
    v_exp_f32 v30, v30
    v_mfma_f32_16x16x32_bf16 v[20:23], a[84:87], v[68:71], v[20:23]
    v_perm_b32 v46, v29, v28, s100
    v_add_u32 v2, s48, v2
    v_mfma_f32_16x16x32_bf16 v[20:23], a[88:91], v[72:75], v[20:23]
    v_exp_f32 v31, v31
    v_mfma_f32_16x16x32_bf16 v[20:23], a[92:95], v[76:79], v[20:23]
    s_waitcnt lgkmcnt(4)
    v_mfma_f32_16x16x32_bf16 v[24:27], a[96:99], v[64:67], v[48:51]
    s_sub_u32 s48, 0, s48
    v_exp_f32 v16, v16
    v_mfma_f32_16x16x32_bf16 v[24:27], a[100:103], v[68:71], v[24:27]
    v_perm_b32 v47, v31, v30, s100
    v_mfma_f32_16x16x32_bf16 v[24:27], a[104:107], v[72:75], v[24:27]
    v_exp_f32 v17, v17
    v_mfma_f32_16x16x32_bf16 v[24:27], a[108:111], v[76:79], v[24:27]
    s_waitcnt lgkmcnt(0)
    v_mfma_f32_16x16x32_bf16 v[28:31], a[112:115], v[64:67], v[48:51]
    v_exp_f32 v18, v18
    v_mfma_f32_16x16x32_bf16 v[28:31], a[116:119], v[68:71], v[28:31]
    v_perm_b32 v32, v17, v16, s100
    v_mfma_f32_16x16x32_bf16 v[28:31], a[120:123], v[72:75], v[28:31]
    v_exp_f32 v19, v19
    v_mfma_f32_16x16x32_bf16 v[28:31], a[124:127], v[76:79], v[28:31]
    s_waitcnt vmcnt(0)
    s_barrier
    v_mfma_f32_16x16x32_bf16 v[224:227], a[128:131], v[40:43], v[224:227]
    v_exp_f32 v20, v20
    v_mfma_f32_16x16x32_bf16 v[224:227], a[132:135], v[44:47], v[224:227]
    ds_read_b64_tr_b16 a[128:129], v2 offset:0
    v_perm_b32 v33, v19, v18, s100
    v_mfma_f32_16x16x32_bf16 v[228:231], a[136:139], v[40:43], v[228:231]
    s_add_u32 m0, s47, 0
    v_exp_f32 v21, v21
    v_mfma_f32_16x16x32_bf16 v[228:231], a[140:143], v[44:47], v[228:231]
    s_add_u32 s46, s46, 16384
    buffer_load_dwordx4 off, s[16:19], s46 offset:0 lds
    v_mfma_f32_16x16x32_bf16 v[232:235], a[144:147], v[40:43], v[232:235]
    v_exp_f32 v22, v22
    v_mfma_f32_16x16x32_bf16 v[232:235], a[148:151], v[44:47], v[232:235]
    ds_read_b64_tr_b16 a[130:131], v2 offset:256
    v_perm_b32 v34, v21, v20, s100
    v_mfma_f32_16x16x32_bf16 v[236:239], a[152:155], v[40:43], v[236:239]
    s_add_u32 m0, s47, 32
    v_exp_f32 v23, v23
    v_mfma_f32_16x16x32_bf16 v[236:239], a[156:159], v[44:47], v[236:239]
    buffer_load_dwordx4 off, s[16:19], s46 offset:1024 lds
    v_mfma_f32_16x16x32_bf16 v[240:243], a[160:163], v[40:43], v[240:243]
    v_exp_f32 v24, v24
    v_mfma_f32_16x16x32_bf16 v[240:243], a[164:167], v[44:47], v[240:243]
    ds_read_b64_tr_b16 a[132:133], v2 offset:512
    v_perm_b32 v35, v23, v22, s100
    v_mfma_f32_16x16x32_bf16 v[244:247], a[168:171], v[40:43], v[244:247]
    s_add_u32 m0, s47, 64
    v_exp_f32 v25, v25
    v_mfma_f32_16x16x32_bf16 v[244:247], a[172:175], v[44:47], v[244:247]
    buffer_load_dwordx4 off, s[16:19], s46 offset:2048 lds
    v_mfma_f32_16x16x32_bf16 v[248:251], a[176:179], v[40:43], v[248:251]
    v_exp_f32 v26, v26
    v_mfma_f32_16x16x32_bf16 v[248:251], a[180:183], v[44:47], v[248:251]
    ds_read_b64_tr_b16 a[134:135], v2 offset:768
    v_perm_b32 v36, v25, v24, s100
    v_mfma_f32_16x16x32_bf16 v[252:255], a[184:187], v[40:43], v[252:255]
    s_add_u32 m0, s47, 96
    v_exp_f32 v27, v27
    v_mfma_f32_16x16x32_bf16 v[252:255], a[188:191], v[44:47], v[252:255]
    buffer_load_dwordx4 off, s[16:19], s46 offset:3072 lds
    v_smfmac_f32_16x16x64_bf16 a[12:15], a[16:19], v[40:47], v11
    ds_read_b64_tr_b16 a[136:137], v2 offset:32
    v_mfma_f32_16x16x32_bf16 v[16:19], a[64:67], v[80:83], v[52:55]
    v_exp_f32 v28, v28
    v_mfma_f32_16x16x32_bf16 v[16:19], a[68:71], v[84:87], v[16:19]
    ds_read_b64_tr_b16 a[138:139], v2 offset:288
    v_perm_b32 v37, v27, v26, s100
    v_mfma_f32_16x16x32_bf16 v[16:19], a[72:75], v[88:91], v[16:19]
    s_add_u32 m0, s47, 16896
    v_exp_f32 v29, v29
    v_mfma_f32_16x16x32_bf16 v[16:19], a[76:79], v[92:95], v[16:19]
    buffer_load_dwordx4 off, s[20:23], s46 offset:0 lds
    v_mfma_f32_16x16x32_bf16 v[20:23], a[80:83], v[80:83], v[52:55]
    v_exp_f32 v30, v30
    v_mfma_f32_16x16x32_bf16 v[20:23], a[84:87], v[84:87], v[20:23]
    ds_read_b64_tr_b16 a[140:141], v2 offset:544
    v_perm_b32 v38, v29, v28, s100
    v_mfma_f32_16x16x32_bf16 v[20:23], a[88:91], v[88:91], v[20:23]
    s_add_u32 m0, s47, 16928
    v_exp_f32 v31, v31
    v_mfma_f32_16x16x32_bf16 v[20:23], a[92:95], v[92:95], v[20:23]
    buffer_load_dwordx4 off, s[20:23], s46 offset:1024 lds
    v_mfma_f32_16x16x32_bf16 v[24:27], a[96:99], v[80:83], v[52:55]
    v_exp_f32 v16, v16
    v_mfma_f32_16x16x32_bf16 v[24:27], a[100:103], v[84:87], v[24:27]
    ds_read_b64_tr_b16 a[142:143], v2 offset:800
    v_perm_b32 v39, v31, v30, s100
    v_mfma_f32_16x16x32_bf16 v[24:27], a[104:107], v[88:91], v[24:27]
    s_add_u32 m0, s47, 16960
    v_exp_f32 v17, v17
    v_mfma_f32_16x16x32_bf16 v[24:27], a[108:111], v[92:95], v[24:27]
    buffer_load_dwordx4 off, s[20:23], s46 offset:2048 lds
    v_mfma_f32_16x16x32_bf16 v[28:31], a[112:115], v[80:83], v[52:55]
    v_exp_f32 v18, v18
    v_mfma_f32_16x16x32_bf16 v[28:31], a[116:119], v[84:87], v[28:31]
    ds_read_b64_tr_b16 a[144:145], v2 offset:64
    v_perm_b32 v40, v17, v16, s100
    v_mfma_f32_16x16x32_bf16 v[28:31], a[120:123], v[88:91], v[28:31]
    s_add_u32 m0, s47, 16992
    v_exp_f32 v19, v19
    v_mfma_f32_16x16x32_bf16 v[28:31], a[124:127], v[92:95], v[28:31]
    buffer_load_dwordx4 off, s[20:23], s46 offset:3072 lds
    v_mfma_f32_16x16x32_bf16 v[128:131], a[192:195], v[32:35], v[128:131]
    v_exp_f32 v20, v20
    v_mfma_f32_16x16x32_bf16 v[128:131], a[196:199], v[36:39], v[128:131]
    ds_read_b64_tr_b16 a[146:147], v2 offset:320
    v_perm_b32 v41, v19, v18, s100
    v_mfma_f32_16x16x32_bf16 v[132:135], a[200:203], v[32:35], v[132:135]
    v_exp_f32 v21, v21
    v_mfma_f32_16x16x32_bf16 v[132:135], a[204:207], v[36:39], v[132:135]
    ds_read_b64_tr_b16 a[148:149], v2 offset:576
    v_mfma_f32_16x16x32_bf16 v[136:139], a[208:211], v[32:35], v[136:139]
    v_exp_f32 v22, v22
    v_mfma_f32_16x16x32_bf16 v[136:139], a[212:215], v[36:39], v[136:139]
    ds_read_b64_tr_b16 a[150:151], v2 offset:832
    v_perm_b32 v42, v21, v20, s100
    v_mfma_f32_16x16x32_bf16 v[140:143], a[216:219], v[32:35], v[140:143]
    v_exp_f32 v23, v23
    v_mfma_f32_16x16x32_bf16 v[140:143], a[220:223], v[36:39], v[140:143]
    ds_read_b64_tr_b16 a[152:153], v2 offset:96
    ds_read_b64_tr_b16 a[154:155], v2 offset:352
    v_mfma_f32_16x16x32_bf16 v[144:147], a[224:227], v[32:35], v[144:147]
    v_exp_f32 v24, v24
    v_mfma_f32_16x16x32_bf16 v[144:147], a[228:231], v[36:39], v[144:147]
    ds_read_b64_tr_b16 a[156:157], v2 offset:608
    v_perm_b32 v43, v23, v22, s100
    v_mfma_f32_16x16x32_bf16 v[148:151], a[232:235], v[32:35], v[148:151]
    v_exp_f32 v25, v25
    v_mfma_f32_16x16x32_bf16 v[148:151], a[236:239], v[36:39], v[148:151]
    ds_read_b64_tr_b16 a[158:159], v2 offset:864
    ds_read_b64_tr_b16 a[160:161], v2 offset:128
    v_mfma_f32_16x16x32_bf16 v[152:155], a[240:243], v[32:35], v[152:155]
    v_exp_f32 v26, v26
    v_mfma_f32_16x16x32_bf16 v[152:155], a[244:247], v[36:39], v[152:155]
    ds_read_b64_tr_b16 a[162:163], v2 offset:384
    v_perm_b32 v44, v25, v24, s100
    v_mfma_f32_16x16x32_bf16 v[156:159], a[248:251], v[32:35], v[156:159]
    v_exp_f32 v27, v27
    v_mfma_f32_16x16x32_bf16 v[156:159], a[252:255], v[36:39], v[156:159]
    ds_read_b64_tr_b16 a[164:165], v2 offset:640
    ds_read_b64_tr_b16 a[166:167], v2 offset:896
    v_smfmac_f32_16x16x64_bf16 a[0:3], a[16:19], v[32:39], v11
    ds_read_b64_tr_b16 a[168:169], v2 offset:160
    ds_read_b64_tr_b16 a[170:171], v2 offset:416
    v_mfma_f32_16x16x32_bf16 v[16:19], a[64:67], v[96:99], v[56:59]
    v_exp_f32 v28, v28
    v_mfma_f32_16x16x32_bf16 v[16:19], a[68:71], v[100:103], v[16:19]
    ds_read_b64_tr_b16 a[172:173], v2 offset:672
    v_perm_b32 v45, v27, v26, s100
    v_mfma_f32_16x16x32_bf16 v[16:19], a[72:75], v[104:107], v[16:19]
    s_add_u32 m0, s47, 36864
    v_exp_f32 v29, v29
    v_mfma_f32_16x16x32_bf16 v[16:19], a[76:79], v[108:111], v[16:19]
    s_add_u32 s46, s46, 16384
    buffer_load_dwordx4 off, s[16:19], s46 offset:0 lds
    v_mfma_f32_16x16x32_bf16 v[20:23], a[80:83], v[96:99], v[56:59]
    v_exp_f32 v30, v30
    v_mfma_f32_16x16x32_bf16 v[20:23], a[84:87], v[100:103], v[20:23]
    ds_read_b64_tr_b16 a[174:175], v2 offset:928
    v_perm_b32 v46, v29, v28, s100
    v_mfma_f32_16x16x32_bf16 v[20:23], a[88:91], v[104:107], v[20:23]
    s_add_u32 m0, s47, 36896
    v_exp_f32 v31, v31
    v_mfma_f32_16x16x32_bf16 v[20:23], a[92:95], v[108:111], v[20:23]
    buffer_load_dwordx4 off, s[16:19], s46 offset:1024 lds
    v_mfma_f32_16x16x32_bf16 v[24:27], a[96:99], v[96:99], v[56:59]
    v_exp_f32 v16, v16
    v_mfma_f32_16x16x32_bf16 v[24:27], a[100:103], v[100:103], v[24:27]
    ds_read_b64_tr_b16 a[176:177], v2 offset:192
    v_perm_b32 v47, v31, v30, s100
    v_mfma_f32_16x16x32_bf16 v[24:27], a[104:107], v[104:107], v[24:27]
    s_add_u32 m0, s47, 36928
    v_exp_f32 v17, v17
    v_mfma_f32_16x16x32_bf16 v[24:27], a[108:111], v[108:111], v[24:27]
    buffer_load_dwordx4 off, s[16:19], s46 offset:2048 lds
    v_mfma_f32_16x16x32_bf16 v[28:31], a[112:115], v[96:99], v[56:59]
    v_exp_f32 v18, v18
    v_mfma_f32_16x16x32_bf16 v[28:31], a[116:119], v[100:103], v[28:31]
    ds_read_b64_tr_b16 a[178:179], v2 offset:448
    v_perm_b32 v32, v17, v16, s100
    v_mfma_f32_16x16x32_bf16 v[28:31], a[120:123], v[104:107], v[28:31]
    s_add_u32 m0, s47, 36960
    v_exp_f32 v19, v19
    v_mfma_f32_16x16x32_bf16 v[28:31], a[124:127], v[108:111], v[28:31]
    buffer_load_dwordx4 off, s[16:19], s46 offset:3072 lds
    v_mfma_f32_16x16x32_bf16 v[160:163], a[192:195], v[40:43], v[160:163]
    v_exp_f32 v20, v20
    v_mfma_f32_16x16x32_bf16 v[160:163], a[196:199], v[44:47], v[160:163]
    ds_read_b64_tr_b16 a[180:181], v2 offset:704
    v_perm_b32 v33, v19, v18, s100
    v_mfma_f32_16x16x32_bf16 v[164:167], a[200:203], v[40:43], v[164:167]
    s_add_u32 m0, s47, 53760
    v_exp_f32 v21, v21
    v_mfma_f32_16x16x32_bf16 v[164:167], a[204:207], v[44:47], v[164:167]
    buffer_load_dwordx4 off, s[20:23], s46 offset:0 lds
    v_mfma_f32_16x16x32_bf16 v[168:171], a[208:211], v[40:43], v[168:171]
    v_exp_f32 v22, v22
    v_mfma_f32_16x16x32_bf16 v[168:171], a[212:215], v[44:47], v[168:171]
    ds_read_b64_tr_b16 a[182:183], v2 offset:960
    v_perm_b32 v34, v21, v20, s100
    v_mfma_f32_16x16x32_bf16 v[172:175], a[216:219], v[40:43], v[172:175]
    s_add_u32 m0, s47, 53792
    v_exp_f32 v23, v23
    v_mfma_f32_16x16x32_bf16 v[172:175], a[220:223], v[44:47], v[172:175]
    buffer_load_dwordx4 off, s[20:23], s46 offset:1024 lds
    v_mfma_f32_16x16x32_bf16 v[176:179], a[224:227], v[40:43], v[176:179]
    v_exp_f32 v24, v24
    v_mfma_f32_16x16x32_bf16 v[176:179], a[228:231], v[44:47], v[176:179]
    ds_read_b64_tr_b16 a[184:185], v2 offset:224
    v_perm_b32 v35, v23, v22, s100
    v_mfma_f32_16x16x32_bf16 v[180:183], a[232:235], v[40:43], v[180:183]
    s_add_u32 m0, s47, 53824
    v_exp_f32 v25, v25
    v_mfma_f32_16x16x32_bf16 v[180:183], a[236:239], v[44:47], v[180:183]
    buffer_load_dwordx4 off, s[20:23], s46 offset:2048 lds
    v_mfma_f32_16x16x32_bf16 v[184:187], a[240:243], v[40:43], v[184:187]
    v_exp_f32 v26, v26
    v_mfma_f32_16x16x32_bf16 v[184:187], a[244:247], v[44:47], v[184:187]
    ds_read_b64_tr_b16 a[186:187], v2 offset:480
    v_perm_b32 v36, v25, v24, s100
    v_mfma_f32_16x16x32_bf16 v[188:191], a[248:251], v[40:43], v[188:191]
    s_add_u32 m0, s47, 53856
    v_exp_f32 v27, v27
    v_mfma_f32_16x16x32_bf16 v[188:191], a[252:255], v[44:47], v[188:191]
    buffer_load_dwordx4 off, s[20:23], s46 offset:3072 lds
    v_smfmac_f32_16x16x64_bf16 a[4:7], a[16:19], v[40:47], v11
    ds_read_b64_tr_b16 a[188:189], v2 offset:736
    ds_read_b64_tr_b16 a[190:191], v2 offset:992
    v_mfma_f32_16x16x32_bf16 v[16:19], a[64:67], v[112:115], v[60:63]
    v_exp_f32 v28, v28
    v_mfma_f32_16x16x32_bf16 v[16:19], a[68:71], v[116:119], v[16:19]
    ds_read_b128 a[64:67], v1 offset:0
    v_perm_b32 v37, v27, v26, s100
    v_mfma_f32_16x16x32_bf16 v[16:19], a[72:75], v[120:123], v[16:19]
    v_exp_f32 v29, v29
    v_mfma_f32_16x16x32_bf16 v[16:19], a[76:79], v[124:127], v[16:19]
    ds_read_b128 a[68:71], v1 offset:64
    v_mfma_f32_16x16x32_bf16 v[20:23], a[80:83], v[112:115], v[60:63]
    v_exp_f32 v30, v30
    v_mfma_f32_16x16x32_bf16 v[20:23], a[84:87], v[116:119], v[20:23]
    ds_read_b128 a[72:75], v1 offset:128
    v_perm_b32 v38, v29, v28, s100
    v_mfma_f32_16x16x32_bf16 v[20:23], a[88:91], v[120:123], v[20:23]
    v_exp_f32 v31, v31
    v_mfma_f32_16x16x32_bf16 v[20:23], a[92:95], v[124:127], v[20:23]
    ds_read_b128 a[76:79], v1 offset:192
    v_mfma_f32_16x16x32_bf16 v[24:27], a[96:99], v[112:115], v[60:63]
    v_exp_f32 v16, v16
    v_mfma_f32_16x16x32_bf16 v[24:27], a[100:103], v[116:119], v[24:27]
    ds_read_b128 a[80:83], v1 offset:256
    v_perm_b32 v39, v31, v30, s100
    v_mfma_f32_16x16x32_bf16 v[24:27], a[104:107], v[120:123], v[24:27]
    v_exp_f32 v17, v17
    v_mfma_f32_16x16x32_bf16 v[24:27], a[108:111], v[124:127], v[24:27]
    ds_read_b128 a[84:87], v1 offset:320
    v_mfma_f32_16x16x32_bf16 v[28:31], a[112:115], v[112:115], v[60:63]
    v_exp_f32 v18, v18
    v_mfma_f32_16x16x32_bf16 v[28:31], a[116:119], v[116:119], v[28:31]
    ds_read_b128 a[88:91], v1 offset:384
    v_perm_b32 v40, v17, v16, s100
    v_mfma_f32_16x16x32_bf16 v[28:31], a[120:123], v[120:123], v[28:31]
    v_exp_f32 v19, v19
    v_mfma_f32_16x16x32_bf16 v[28:31], a[124:127], v[124:127], v[28:31]
    ds_read_b128 a[92:95], v1 offset:448
    v_mfma_f32_16x16x32_bf16 v[192:195], a[192:195], v[32:35], v[192:195]
    v_exp_f32 v20, v20
    v_mfma_f32_16x16x32_bf16 v[192:195], a[196:199], v[36:39], v[192:195]
    ds_read_b128 a[96:99], v1 offset:512
    v_perm_b32 v41, v19, v18, s100
    v_mfma_f32_16x16x32_bf16 v[196:199], a[200:203], v[32:35], v[196:199]
    v_exp_f32 v21, v21
    v_mfma_f32_16x16x32_bf16 v[196:199], a[204:207], v[36:39], v[196:199]
    ds_read_b128 a[100:103], v1 offset:576
    v_mfma_f32_16x16x32_bf16 v[200:203], a[208:211], v[32:35], v[200:203]
    v_exp_f32 v22, v22
    v_mfma_f32_16x16x32_bf16 v[200:203], a[212:215], v[36:39], v[200:203]
    ds_read_b128 a[104:107], v1 offset:640
    v_perm_b32 v42, v21, v20, s100
    v_mfma_f32_16x16x32_bf16 v[204:207], a[216:219], v[32:35], v[204:207]
    v_exp_f32 v23, v23
    v_mfma_f32_16x16x32_bf16 v[204:207], a[220:223], v[36:39], v[204:207]
    ds_read_b128 a[108:111], v1 offset:704
    v_mfma_f32_16x16x32_bf16 v[208:211], a[224:227], v[32:35], v[208:211]
    v_exp_f32 v24, v24
    v_mfma_f32_16x16x32_bf16 v[208:211], a[228:231], v[36:39], v[208:211]
    ds_read_b128 a[112:115], v1 offset:768
    v_perm_b32 v43, v23, v22, s100
    v_mfma_f32_16x16x32_bf16 v[212:215], a[232:235], v[32:35], v[212:215]
    v_exp_f32 v25, v25
    v_mfma_f32_16x16x32_bf16 v[212:215], a[236:239], v[36:39], v[212:215]
    ds_read_b128 a[116:119], v1 offset:832
    v_mfma_f32_16x16x32_bf16 v[216:219], a[240:243], v[32:35], v[216:219]
    v_exp_f32 v26, v26
    v_mfma_f32_16x16x32_bf16 v[216:219], a[244:247], v[36:39], v[216:219]
    ds_read_b128 a[120:123], v1 offset:896
    v_perm_b32 v44, v25, v24, s100
    v_mfma_f32_16x16x32_bf16 v[220:223], a[248:251], v[32:35], v[220:223]
    v_exp_f32 v27, v27
    v_mfma_f32_16x16x32_bf16 v[220:223], a[252:255], v[36:39], v[220:223]
    ds_read_b128 a[124:127], v1 offset:960
    v_smfmac_f32_16x16x64_bf16 a[8:11], a[16:19], v[32:39], v11
    s_waitcnt lgkmcnt(12)
    v_mfma_f32_16x16x32_bf16 v[16:19], a[64:67], v[64:67], v[48:51]
    v_exp_f32 v28, v28
    v_mfma_f32_16x16x32_bf16 v[16:19], a[68:71], v[68:71], v[16:19]
    v_perm_b32 v45, v27, v26, s100
    v_mfma_f32_16x16x32_bf16 v[16:19], a[72:75], v[72:75], v[16:19]
    v_exp_f32 v29, v29
    v_mfma_f32_16x16x32_bf16 v[16:19], a[76:79], v[76:79], v[16:19]
    s_waitcnt lgkmcnt(8)
    global_load_dword a63, v12, s[4:5]
    v_mfma_f32_16x16x32_bf16 v[20:23], a[80:83], v[64:67], v[48:51]
    v_exp_f32 v30, v30
    v_mfma_f32_16x16x32_bf16 v[20:23], a[84:87], v[68:71], v[20:23]
    v_perm_b32 v46, v29, v28, s100
    v_mfma_f32_16x16x32_bf16 v[20:23], a[88:91], v[72:75], v[20:23]
    v_exp_f32 v31, v31
    v_mfma_f32_16x16x32_bf16 v[20:23], a[92:95], v[76:79], v[20:23]
    s_waitcnt lgkmcnt(4)
    v_mfma_f32_16x16x32_bf16 v[24:27], a[96:99], v[64:67], v[48:51]
    v_exp_f32 v16, v16
    v_mfma_f32_16x16x32_bf16 v[24:27], a[100:103], v[68:71], v[24:27]
    v_perm_b32 v47, v31, v30, s100
    v_mfma_f32_16x16x32_bf16 v[24:27], a[104:107], v[72:75], v[24:27]
    v_exp_f32 v17, v17
    v_mfma_f32_16x16x32_bf16 v[24:27], a[108:111], v[76:79], v[24:27]
    s_waitcnt lgkmcnt(0)
    v_mfma_f32_16x16x32_bf16 v[28:31], a[112:115], v[64:67], v[48:51]
    v_exp_f32 v18, v18
    v_mfma_f32_16x16x32_bf16 v[28:31], a[116:119], v[68:71], v[28:31]
    v_perm_b32 v32, v17, v16, s100
    v_mfma_f32_16x16x32_bf16 v[28:31], a[120:123], v[72:75], v[28:31]
    v_exp_f32 v19, v19
    v_mfma_f32_16x16x32_bf16 v[28:31], a[124:127], v[76:79], v[28:31]
    v_mfma_f32_16x16x32_bf16 v[224:227], a[192:195], v[40:43], v[224:227]
    v_exp_f32 v20, v20
    v_mfma_f32_16x16x32_bf16 v[224:227], a[196:199], v[44:47], v[224:227]
    ds_read_b64_tr_b16 a[192:193], v2 offset:36864
    v_perm_b32 v33, v19, v18, s100
    v_mfma_f32_16x16x32_bf16 v[228:231], a[200:203], v[40:43], v[228:231]
    v_exp_f32 v21, v21
    v_mfma_f32_16x16x32_bf16 v[228:231], a[204:207], v[44:47], v[228:231]
    ds_read_b64_tr_b16 a[194:195], v2 offset:37120
    v_mfma_f32_16x16x32_bf16 v[232:235], a[208:211], v[40:43], v[232:235]
    v_exp_f32 v22, v22
    v_mfma_f32_16x16x32_bf16 v[232:235], a[212:215], v[44:47], v[232:235]
    ds_read_b64_tr_b16 a[196:197], v2 offset:37376
    v_perm_b32 v34, v21, v20, s100
    v_mfma_f32_16x16x32_bf16 v[236:239], a[216:219], v[40:43], v[236:239]
    v_exp_f32 v23, v23
    v_mfma_f32_16x16x32_bf16 v[236:239], a[220:223], v[44:47], v[236:239]
    ds_read_b64_tr_b16 a[198:199], v2 offset:37632
    v_mfma_f32_16x16x32_bf16 v[240:243], a[224:227], v[40:43], v[240:243]
    v_exp_f32 v24, v24
    v_mfma_f32_16x16x32_bf16 v[240:243], a[228:231], v[44:47], v[240:243]
    ds_read_b64_tr_b16 a[200:201], v2 offset:36896
    v_perm_b32 v35, v23, v22, s100
    v_mfma_f32_16x16x32_bf16 v[244:247], a[232:235], v[40:43], v[244:247]
    v_exp_f32 v25, v25
    v_mfma_f32_16x16x32_bf16 v[244:247], a[236:239], v[44:47], v[244:247]
    ds_read_b64_tr_b16 a[202:203], v2 offset:37152
    v_mfma_f32_16x16x32_bf16 v[248:251], a[240:243], v[40:43], v[248:251]
    v_exp_f32 v26, v26
    v_mfma_f32_16x16x32_bf16 v[248:251], a[244:247], v[44:47], v[248:251]
    ds_read_b64_tr_b16 a[204:205], v2 offset:37408
    v_perm_b32 v36, v25, v24, s100
    v_mfma_f32_16x16x32_bf16 v[252:255], a[248:251], v[40:43], v[252:255]
    v_exp_f32 v27, v27
    v_mfma_f32_16x16x32_bf16 v[252:255], a[252:255], v[44:47], v[252:255]
    ds_read_b64_tr_b16 a[206:207], v2 offset:37664
    v_smfmac_f32_16x16x64_bf16 a[12:15], a[16:19], v[40:47], v11
    ds_read_b64_tr_b16 a[208:209], v2 offset:36928
    v_mfma_f32_16x16x32_bf16 v[16:19], a[64:67], v[80:83], v[52:55]
    v_exp_f32 v28, v28
    v_mfma_f32_16x16x32_bf16 v[16:19], a[68:71], v[84:87], v[16:19]
    ds_read_b64_tr_b16 a[210:211], v2 offset:37184
    v_perm_b32 v37, v27, v26, s100
    v_mfma_f32_16x16x32_bf16 v[16:19], a[72:75], v[88:91], v[16:19]
    v_exp_f32 v29, v29
    v_mfma_f32_16x16x32_bf16 v[16:19], a[76:79], v[92:95], v[16:19]
    ds_read_b64_tr_b16 a[212:213], v2 offset:37440
    v_mfma_f32_16x16x32_bf16 v[20:23], a[80:83], v[80:83], v[52:55]
    v_exp_f32 v30, v30
    v_mfma_f32_16x16x32_bf16 v[20:23], a[84:87], v[84:87], v[20:23]
    ds_read_b64_tr_b16 a[214:215], v2 offset:37696
    v_perm_b32 v38, v29, v28, s100
    v_mfma_f32_16x16x32_bf16 v[20:23], a[88:91], v[88:91], v[20:23]
    v_exp_f32 v31, v31
    v_mfma_f32_16x16x32_bf16 v[20:23], a[92:95], v[92:95], v[20:23]
    ds_read_b64_tr_b16 a[216:217], v2 offset:36960
    v_mfma_f32_16x16x32_bf16 v[24:27], a[96:99], v[80:83], v[52:55]
    v_exp_f32 v16, v16
    v_mfma_f32_16x16x32_bf16 v[24:27], a[100:103], v[84:87], v[24:27]
    ds_read_b64_tr_b16 a[218:219], v2 offset:37216
    v_perm_b32 v39, v31, v30, s100
    v_mfma_f32_16x16x32_bf16 v[24:27], a[104:107], v[88:91], v[24:27]
    v_exp_f32 v17, v17
    v_mfma_f32_16x16x32_bf16 v[24:27], a[108:111], v[92:95], v[24:27]
    ds_read_b64_tr_b16 a[220:221], v2 offset:37472
    v_mfma_f32_16x16x32_bf16 v[28:31], a[112:115], v[80:83], v[52:55]
    v_exp_f32 v18, v18
    v_mfma_f32_16x16x32_bf16 v[28:31], a[116:119], v[84:87], v[28:31]
    ds_read_b64_tr_b16 a[222:223], v2 offset:37728
    v_perm_b32 v40, v17, v16, s100
    v_mfma_f32_16x16x32_bf16 v[28:31], a[120:123], v[88:91], v[28:31]
    v_exp_f32 v19, v19
    v_mfma_f32_16x16x32_bf16 v[28:31], a[124:127], v[92:95], v[28:31]
    ds_read_b64_tr_b16 a[224:225], v2 offset:36992
    v_mfma_f32_16x16x32_bf16 v[128:131], a[128:131], v[32:35], v[128:131]
    v_exp_f32 v20, v20
    v_mfma_f32_16x16x32_bf16 v[128:131], a[132:135], v[36:39], v[128:131]
    ds_read_b64_tr_b16 a[226:227], v2 offset:37248
    v_perm_b32 v41, v19, v18, s100
    v_mfma_f32_16x16x32_bf16 v[132:135], a[136:139], v[32:35], v[132:135]
    v_exp_f32 v21, v21
    v_mfma_f32_16x16x32_bf16 v[132:135], a[140:143], v[36:39], v[132:135]
    global_load_dword a63, v14, s[10:11]
    v_mfma_f32_16x16x32_bf16 v[136:139], a[144:147], v[32:35], v[136:139]
    v_exp_f32 v22, v22
    v_mfma_f32_16x16x32_bf16 v[136:139], a[148:151], v[36:39], v[136:139]
    ds_read_b64_tr_b16 a[228:229], v2 offset:37504
    v_perm_b32 v42, v21, v20, s100
    v_mfma_f32_16x16x32_bf16 v[140:143], a[152:155], v[32:35], v[140:143]
    v_exp_f32 v23, v23
    v_mfma_f32_16x16x32_bf16 v[140:143], a[156:159], v[36:39], v[140:143]
    ds_read_b64_tr_b16 a[230:231], v2 offset:37760
    v_mfma_f32_16x16x32_bf16 v[144:147], a[160:163], v[32:35], v[144:147]
    v_exp_f32 v24, v24
    v_mfma_f32_16x16x32_bf16 v[144:147], a[164:167], v[36:39], v[144:147]
    ds_read_b64_tr_b16 a[232:233], v2 offset:37024
    v_perm_b32 v43, v23, v22, s100
    v_mfma_f32_16x16x32_bf16 v[148:151], a[168:171], v[32:35], v[148:151]
    v_exp_f32 v25, v25
    v_mfma_f32_16x16x32_bf16 v[148:151], a[172:175], v[36:39], v[148:151]
    ds_read_b64_tr_b16 a[234:235], v2 offset:37280
    v_mfma_f32_16x16x32_bf16 v[152:155], a[176:179], v[32:35], v[152:155]
    v_exp_f32 v26, v26
    v_mfma_f32_16x16x32_bf16 v[152:155], a[180:183], v[36:39], v[152:155]
    ds_read_b64_tr_b16 a[236:237], v2 offset:37536
    v_perm_b32 v44, v25, v24, s100
    v_mfma_f32_16x16x32_bf16 v[156:159], a[184:187], v[32:35], v[156:159]
    v_exp_f32 v27, v27
    v_mfma_f32_16x16x32_bf16 v[156:159], a[188:191], v[36:39], v[156:159]
    ds_read_b64_tr_b16 a[238:239], v2 offset:37792
    v_smfmac_f32_16x16x64_bf16 a[0:3], a[16:19], v[32:39], v11
    ds_read_b64_tr_b16 a[240:241], v2 offset:37056
    v_mfma_f32_16x16x32_bf16 v[16:19], a[64:67], v[96:99], v[56:59]
    v_exp_f32 v28, v28
    v_mfma_f32_16x16x32_bf16 v[16:19], a[68:71], v[100:103], v[16:19]
    ds_read_b64_tr_b16 a[242:243], v2 offset:37312
    v_perm_b32 v45, v27, v26, s100
    v_mfma_f32_16x16x32_bf16 v[16:19], a[72:75], v[104:107], v[16:19]
    v_exp_f32 v29, v29
    v_mfma_f32_16x16x32_bf16 v[16:19], a[76:79], v[108:111], v[16:19]
    ds_read_b64_tr_b16 a[244:245], v2 offset:37568
    v_mfma_f32_16x16x32_bf16 v[20:23], a[80:83], v[96:99], v[56:59]
    v_exp_f32 v30, v30
    v_mfma_f32_16x16x32_bf16 v[20:23], a[84:87], v[100:103], v[20:23]
    ds_read_b64_tr_b16 a[246:247], v2 offset:37824
    v_perm_b32 v46, v29, v28, s100
    v_mfma_f32_16x16x32_bf16 v[20:23], a[88:91], v[104:107], v[20:23]
    v_exp_f32 v31, v31
    v_mfma_f32_16x16x32_bf16 v[20:23], a[92:95], v[108:111], v[20:23]
    ds_read_b64_tr_b16 a[248:249], v2 offset:37088
    v_mfma_f32_16x16x32_bf16 v[24:27], a[96:99], v[96:99], v[56:59]
    v_exp_f32 v16, v16
    v_mfma_f32_16x16x32_bf16 v[24:27], a[100:103], v[100:103], v[24:27]
    ds_read_b64_tr_b16 a[250:251], v2 offset:37344
    v_perm_b32 v47, v31, v30, s100
    v_mfma_f32_16x16x32_bf16 v[24:27], a[104:107], v[104:107], v[24:27]
    v_exp_f32 v17, v17
    v_mfma_f32_16x16x32_bf16 v[24:27], a[108:111], v[108:111], v[24:27]
    ds_read_b64_tr_b16 a[252:253], v2 offset:37600
    v_mfma_f32_16x16x32_bf16 v[28:31], a[112:115], v[96:99], v[56:59]
    v_exp_f32 v18, v18
    v_mfma_f32_16x16x32_bf16 v[28:31], a[116:119], v[100:103], v[28:31]
    ds_read_b64_tr_b16 a[254:255], v2 offset:37856
    v_perm_b32 v32, v17, v16, s100
    v_mfma_f32_16x16x32_bf16 v[28:31], a[120:123], v[104:107], v[28:31]
    v_exp_f32 v19, v19
    v_mfma_f32_16x16x32_bf16 v[28:31], a[124:127], v[108:111], v[28:31]
    v_mfma_f32_16x16x32_bf16 v[160:163], a[128:131], v[40:43], v[160:163]
    v_exp_f32 v20, v20
    v_mfma_f32_16x16x32_bf16 v[160:163], a[132:135], v[44:47], v[160:163]
    v_perm_b32 v33, v19, v18, s100
    v_mfma_f32_16x16x32_bf16 v[164:167], a[136:139], v[40:43], v[164:167]
    v_exp_f32 v21, v21
    v_mfma_f32_16x16x32_bf16 v[164:167], a[140:143], v[44:47], v[164:167]
    v_mfma_f32_16x16x32_bf16 v[168:171], a[144:147], v[40:43], v[168:171]
    v_exp_f32 v22, v22
    v_mfma_f32_16x16x32_bf16 v[168:171], a[148:151], v[44:47], v[168:171]
    v_perm_b32 v34, v21, v20, s100
    v_mfma_f32_16x16x32_bf16 v[172:175], a[152:155], v[40:43], v[172:175]
    v_exp_f32 v23, v23
    v_mfma_f32_16x16x32_bf16 v[172:175], a[156:159], v[44:47], v[172:175]
    v_mfma_f32_16x16x32_bf16 v[176:179], a[160:163], v[40:43], v[176:179]
    v_exp_f32 v24, v24
    v_mfma_f32_16x16x32_bf16 v[176:179], a[164:167], v[44:47], v[176:179]
    v_perm_b32 v35, v23, v22, s100
    v_mfma_f32_16x16x32_bf16 v[180:183], a[168:171], v[40:43], v[180:183]
    v_exp_f32 v25, v25
    v_mfma_f32_16x16x32_bf16 v[180:183], a[172:175], v[44:47], v[180:183]
    v_mfma_f32_16x16x32_bf16 v[184:187], a[176:179], v[40:43], v[184:187]
    v_exp_f32 v26, v26
    v_mfma_f32_16x16x32_bf16 v[184:187], a[180:183], v[44:47], v[184:187]
    v_perm_b32 v36, v25, v24, s100
    v_mfma_f32_16x16x32_bf16 v[188:191], a[184:187], v[40:43], v[188:191]
    v_exp_f32 v27, v27
    v_mfma_f32_16x16x32_bf16 v[188:191], a[188:191], v[44:47], v[188:191]
    v_smfmac_f32_16x16x64_bf16 a[4:7], a[16:19], v[40:47], v11
    v_mfma_f32_16x16x32_bf16 v[16:19], a[64:67], v[112:115], v[60:63]
    v_exp_f32 v28, v28
    v_mfma_f32_16x16x32_bf16 v[16:19], a[68:71], v[116:119], v[16:19]
    ds_read_b128 a[64:67], v1 offset:36864
    v_perm_b32 v37, v27, v26, s100
    v_mfma_f32_16x16x32_bf16 v[16:19], a[72:75], v[120:123], v[16:19]
    v_exp_f32 v29, v29
    v_mfma_f32_16x16x32_bf16 v[16:19], a[76:79], v[124:127], v[16:19]
    ds_read_b128 a[68:71], v1 offset:36928
    v_mfma_f32_16x16x32_bf16 v[20:23], a[80:83], v[112:115], v[60:63]
    v_exp_f32 v30, v30
    v_mfma_f32_16x16x32_bf16 v[20:23], a[84:87], v[116:119], v[20:23]
    ds_read_b128 a[72:75], v1 offset:36992
    v_perm_b32 v38, v29, v28, s100
    v_mfma_f32_16x16x32_bf16 v[20:23], a[88:91], v[120:123], v[20:23]
    v_exp_f32 v31, v31
    v_mfma_f32_16x16x32_bf16 v[20:23], a[92:95], v[124:127], v[20:23]
    ds_read_b128 a[76:79], v1 offset:37056
    v_mfma_f32_16x16x32_bf16 v[24:27], a[96:99], v[112:115], v[60:63]
    v_exp_f32 v16, v16
    v_mfma_f32_16x16x32_bf16 v[24:27], a[100:103], v[116:119], v[24:27]
    ds_read_b128 a[80:83], v1 offset:37120
    v_perm_b32 v39, v31, v30, s100
    v_mfma_f32_16x16x32_bf16 v[24:27], a[104:107], v[120:123], v[24:27]
    v_exp_f32 v17, v17
    v_mfma_f32_16x16x32_bf16 v[24:27], a[108:111], v[124:127], v[24:27]
    ds_read_b128 a[84:87], v1 offset:37184
    v_mfma_f32_16x16x32_bf16 v[28:31], a[112:115], v[112:115], v[60:63]
    v_exp_f32 v18, v18
    v_mfma_f32_16x16x32_bf16 v[28:31], a[116:119], v[116:119], v[28:31]
    ds_read_b128 a[88:91], v1 offset:37248
    v_perm_b32 v40, v17, v16, s100
    v_mfma_f32_16x16x32_bf16 v[28:31], a[120:123], v[120:123], v[28:31]
    v_exp_f32 v19, v19
    v_mfma_f32_16x16x32_bf16 v[28:31], a[124:127], v[124:127], v[28:31]
    ds_read_b128 a[92:95], v1 offset:37312
    v_mfma_f32_16x16x32_bf16 v[192:195], a[128:131], v[32:35], v[192:195]
    v_exp_f32 v20, v20
    v_mfma_f32_16x16x32_bf16 v[192:195], a[132:135], v[36:39], v[192:195]
    ds_read_b128 a[96:99], v1 offset:37376
    v_perm_b32 v41, v19, v18, s100
    v_mfma_f32_16x16x32_bf16 v[196:199], a[136:139], v[32:35], v[196:199]
    v_exp_f32 v21, v21
    v_mfma_f32_16x16x32_bf16 v[196:199], a[140:143], v[36:39], v[196:199]
    ds_read_b128 a[100:103], v1 offset:37440
    v_mfma_f32_16x16x32_bf16 v[200:203], a[144:147], v[32:35], v[200:203]
    v_exp_f32 v22, v22
    v_mfma_f32_16x16x32_bf16 v[200:203], a[148:151], v[36:39], v[200:203]
L2_pad6:
    s_cbranch_execz L2_pad10
    ds_read_b128 a[104:107], v1 offset:37504
    v_perm_b32 v42, v21, v20, s100
    v_mfma_f32_16x16x32_bf16 v[204:207], a[152:155], v[32:35], v[204:207]
    v_exp_f32 v23, v23
    v_mfma_f32_16x16x32_bf16 v[204:207], a[156:159], v[36:39], v[204:207]
    ds_read_b128 a[108:111], v1 offset:37568
    v_mfma_f32_16x16x32_bf16 v[208:211], a[160:163], v[32:35], v[208:211]
    v_exp_f32 v24, v24
    v_mfma_f32_16x16x32_bf16 v[208:211], a[164:167], v[36:39], v[208:211]
    ds_read_b128 a[112:115], v1 offset:37632
    v_perm_b32 v43, v23, v22, s100
    v_mfma_f32_16x16x32_bf16 v[212:215], a[168:171], v[32:35], v[212:215]
    v_exp_f32 v25, v25
    v_mfma_f32_16x16x32_bf16 v[212:215], a[172:175], v[36:39], v[212:215]
    ds_read_b128 a[116:119], v1 offset:37696
    v_mfma_f32_16x16x32_bf16 v[216:219], a[176:179], v[32:35], v[216:219]
    v_exp_f32 v26, v26
    v_mfma_f32_16x16x32_bf16 v[216:219], a[180:183], v[36:39], v[216:219]
    ds_read_b128 a[120:123], v1 offset:37760
    v_perm_b32 v44, v25, v24, s100
    v_mfma_f32_16x16x32_bf16 v[220:223], a[184:187], v[32:35], v[220:223]
    v_exp_f32 v27, v27
    v_mfma_f32_16x16x32_bf16 v[220:223], a[188:191], v[36:39], v[220:223]
    ds_read_b128 a[124:127], v1 offset:37824
    v_smfmac_f32_16x16x64_bf16 a[8:11], a[16:19], v[32:39], v11
    s_waitcnt lgkmcnt(12)
    v_mfma_f32_16x16x32_bf16 v[16:19], a[64:67], v[64:67], v[48:51]
    s_sub_u32 s47, s47, s48
    v_exp_f32 v28, v28
    v_mfma_f32_16x16x32_bf16 v[16:19], a[68:71], v[68:71], v[16:19]
    v_perm_b32 v45, v27, v26, s100
    v_add_u32 v1, s48, v1
    v_mfma_f32_16x16x32_bf16 v[16:19], a[72:75], v[72:75], v[16:19]
    v_exp_f32 v29, v29
    v_mfma_f32_16x16x32_bf16 v[16:19], a[76:79], v[76:79], v[16:19]
    s_waitcnt lgkmcnt(8)
    v_mfma_f32_16x16x32_bf16 v[20:23], a[80:83], v[64:67], v[48:51]
    v_exp_f32 v30, v30
    v_mfma_f32_16x16x32_bf16 v[20:23], a[84:87], v[68:71], v[20:23]
    v_perm_b32 v46, v29, v28, s100
    v_add_u32 v2, s48, v2
    v_mfma_f32_16x16x32_bf16 v[20:23], a[88:91], v[72:75], v[20:23]
    v_exp_f32 v31, v31
    v_mfma_f32_16x16x32_bf16 v[20:23], a[92:95], v[76:79], v[20:23]
    s_waitcnt lgkmcnt(4)
    v_mfma_f32_16x16x32_bf16 v[24:27], a[96:99], v[64:67], v[48:51]
    s_sub_u32 s48, 0, s48
    v_exp_f32 v16, v16
    v_mfma_f32_16x16x32_bf16 v[24:27], a[100:103], v[68:71], v[24:27]
    v_perm_b32 v47, v31, v30, s100
    v_mfma_f32_16x16x32_bf16 v[24:27], a[104:107], v[72:75], v[24:27]
    v_exp_f32 v17, v17
    v_mfma_f32_16x16x32_bf16 v[24:27], a[108:111], v[76:79], v[24:27]
    s_waitcnt lgkmcnt(0)
    v_mfma_f32_16x16x32_bf16 v[28:31], a[112:115], v[64:67], v[48:51]
    v_exp_f32 v18, v18
    v_mfma_f32_16x16x32_bf16 v[28:31], a[116:119], v[68:71], v[28:31]
    v_perm_b32 v32, v17, v16, s100
    v_mfma_f32_16x16x32_bf16 v[28:31], a[120:123], v[72:75], v[28:31]
    v_exp_f32 v19, v19
    v_mfma_f32_16x16x32_bf16 v[28:31], a[124:127], v[76:79], v[28:31]
    s_waitcnt vmcnt(2)
    s_barrier
    v_mfma_f32_16x16x32_bf16 v[224:227], a[128:131], v[40:43], v[224:227]
    v_exp_f32 v20, v20
    v_mfma_f32_16x16x32_bf16 v[224:227], a[132:135], v[44:47], v[224:227]
    ds_read_b64_tr_b16 a[128:129], v2 offset:0
    v_perm_b32 v33, v19, v18, s100
    v_mfma_f32_16x16x32_bf16 v[228:231], a[136:139], v[40:43], v[228:231]
    s_add_u32 m0, s47, 0
    v_exp_f32 v21, v21
    v_mfma_f32_16x16x32_bf16 v[228:231], a[140:143], v[44:47], v[228:231]
    s_add_u32 s46, s46, 16384
    buffer_load_dwordx4 off, s[16:19], s46 offset:0 lds
    v_mfma_f32_16x16x32_bf16 v[232:235], a[144:147], v[40:43], v[232:235]
    v_exp_f32 v22, v22
    v_mfma_f32_16x16x32_bf16 v[232:235], a[148:151], v[44:47], v[232:235]
    ds_read_b64_tr_b16 a[130:131], v2 offset:256
    v_perm_b32 v34, v21, v20, s100
    v_mfma_f32_16x16x32_bf16 v[236:239], a[152:155], v[40:43], v[236:239]
    s_add_u32 m0, s47, 32
    v_exp_f32 v23, v23
    v_mfma_f32_16x16x32_bf16 v[236:239], a[156:159], v[44:47], v[236:239]
    buffer_load_dwordx4 off, s[16:19], s46 offset:1024 lds
    v_mfma_f32_16x16x32_bf16 v[240:243], a[160:163], v[40:43], v[240:243]
    v_exp_f32 v24, v24
    v_mfma_f32_16x16x32_bf16 v[240:243], a[164:167], v[44:47], v[240:243]
    ds_read_b64_tr_b16 a[132:133], v2 offset:512
    v_perm_b32 v35, v23, v22, s100
    v_mfma_f32_16x16x32_bf16 v[244:247], a[168:171], v[40:43], v[244:247]
    s_add_u32 m0, s47, 64
    v_exp_f32 v25, v25
    v_mfma_f32_16x16x32_bf16 v[244:247], a[172:175], v[44:47], v[244:247]
    buffer_load_dwordx4 off, s[16:19], s46 offset:2048 lds
    v_mfma_f32_16x16x32_bf16 v[248:251], a[176:179], v[40:43], v[248:251]
    v_exp_f32 v26, v26
    v_mfma_f32_16x16x32_bf16 v[248:251], a[180:183], v[44:47], v[248:251]
    ds_read_b64_tr_b16 a[134:135], v2 offset:768
    v_perm_b32 v36, v25, v24, s100
    v_mfma_f32_16x16x32_bf16 v[252:255], a[184:187], v[40:43], v[252:255]
    s_add_u32 m0, s47, 96
    v_exp_f32 v27, v27
    v_mfma_f32_16x16x32_bf16 v[252:255], a[188:191], v[44:47], v[252:255]
    buffer_load_dwordx4 off, s[16:19], s46 offset:3072 lds
    v_smfmac_f32_16x16x64_bf16 a[12:15], a[16:19], v[40:47], v11
    ds_read_b64_tr_b16 a[136:137], v2 offset:32
    v_mfma_f32_16x16x32_bf16 v[16:19], a[64:67], v[80:83], v[52:55]
    v_exp_f32 v28, v28
    v_mfma_f32_16x16x32_bf16 v[16:19], a[68:71], v[84:87], v[16:19]
    ds_read_b64_tr_b16 a[138:139], v2 offset:288
    v_perm_b32 v37, v27, v26, s100
    v_mfma_f32_16x16x32_bf16 v[16:19], a[72:75], v[88:91], v[16:19]
    s_add_u32 m0, s47, 16896
    v_exp_f32 v29, v29
    v_mfma_f32_16x16x32_bf16 v[16:19], a[76:79], v[92:95], v[16:19]
    buffer_load_dwordx4 off, s[20:23], s46 offset:0 lds
    v_mfma_f32_16x16x32_bf16 v[20:23], a[80:83], v[80:83], v[52:55]
    v_exp_f32 v30, v30
    v_mfma_f32_16x16x32_bf16 v[20:23], a[84:87], v[84:87], v[20:23]
    ds_read_b64_tr_b16 a[140:141], v2 offset:544
    v_perm_b32 v38, v29, v28, s100
    v_mfma_f32_16x16x32_bf16 v[20:23], a[88:91], v[88:91], v[20:23]
    s_add_u32 m0, s47, 16928
    v_exp_f32 v31, v31
    v_mfma_f32_16x16x32_bf16 v[20:23], a[92:95], v[92:95], v[20:23]
    buffer_load_dwordx4 off, s[20:23], s46 offset:1024 lds
    v_mfma_f32_16x16x32_bf16 v[24:27], a[96:99], v[80:83], v[52:55]
    v_exp_f32 v16, v16
    v_mfma_f32_16x16x32_bf16 v[24:27], a[100:103], v[84:87], v[24:27]
    ds_read_b64_tr_b16 a[142:143], v2 offset:800
    v_perm_b32 v39, v31, v30, s100
    v_mfma_f32_16x16x32_bf16 v[24:27], a[104:107], v[88:91], v[24:27]
    s_add_u32 m0, s47, 16960
    v_exp_f32 v17, v17
    v_mfma_f32_16x16x32_bf16 v[24:27], a[108:111], v[92:95], v[24:27]
    buffer_load_dwordx4 off, s[20:23], s46 offset:2048 lds
    v_mfma_f32_16x16x32_bf16 v[28:31], a[112:115], v[80:83], v[52:55]
    v_exp_f32 v18, v18
    v_mfma_f32_16x16x32_bf16 v[28:31], a[116:119], v[84:87], v[28:31]
    ds_read_b64_tr_b16 a[144:145], v2 offset:64
    v_perm_b32 v40, v17, v16, s100
    v_mfma_f32_16x16x32_bf16 v[28:31], a[120:123], v[88:91], v[28:31]
    s_add_u32 m0, s47, 16992
    v_exp_f32 v19, v19
    v_mfma_f32_16x16x32_bf16 v[28:31], a[124:127], v[92:95], v[28:31]
    buffer_load_dwordx4 off, s[20:23], s46 offset:3072 lds
    v_mfma_f32_16x16x32_bf16 v[128:131], a[192:195], v[32:35], v[128:131]
    v_exp_f32 v20, v20
    v_mfma_f32_16x16x32_bf16 v[128:131], a[196:199], v[36:39], v[128:131]
    ds_read_b64_tr_b16 a[146:147], v2 offset:320
    v_perm_b32 v41, v19, v18, s100
    v_mfma_f32_16x16x32_bf16 v[132:135], a[200:203], v[32:35], v[132:135]
    v_exp_f32 v21, v21
    v_mfma_f32_16x16x32_bf16 v[132:135], a[204:207], v[36:39], v[132:135]
    ds_read_b64_tr_b16 a[148:149], v2 offset:576
    v_mfma_f32_16x16x32_bf16 v[136:139], a[208:211], v[32:35], v[136:139]
    v_exp_f32 v22, v22
    v_mfma_f32_16x16x32_bf16 v[136:139], a[212:215], v[36:39], v[136:139]
    ds_read_b64_tr_b16 a[150:151], v2 offset:832
    v_perm_b32 v42, v21, v20, s100
    v_mfma_f32_16x16x32_bf16 v[140:143], a[216:219], v[32:35], v[140:143]
    v_exp_f32 v23, v23
    v_mfma_f32_16x16x32_bf16 v[140:143], a[220:223], v[36:39], v[140:143]
    ds_read_b64_tr_b16 a[152:153], v2 offset:96
    ds_read_b64_tr_b16 a[154:155], v2 offset:352
    v_mfma_f32_16x16x32_bf16 v[144:147], a[224:227], v[32:35], v[144:147]
    v_exp_f32 v24, v24
    v_mfma_f32_16x16x32_bf16 v[144:147], a[228:231], v[36:39], v[144:147]
    ds_read_b64_tr_b16 a[156:157], v2 offset:608
    v_perm_b32 v43, v23, v22, s100
    v_mfma_f32_16x16x32_bf16 v[148:151], a[232:235], v[32:35], v[148:151]
    v_exp_f32 v25, v25
    v_mfma_f32_16x16x32_bf16 v[148:151], a[236:239], v[36:39], v[148:151]
    ds_read_b64_tr_b16 a[158:159], v2 offset:864
    ds_read_b64_tr_b16 a[160:161], v2 offset:128
    v_mfma_f32_16x16x32_bf16 v[152:155], a[240:243], v[32:35], v[152:155]
    v_exp_f32 v26, v26
    v_mfma_f32_16x16x32_bf16 v[152:155], a[244:247], v[36:39], v[152:155]
    ds_read_b64_tr_b16 a[162:163], v2 offset:384
    v_perm_b32 v44, v25, v24, s100
    v_mfma_f32_16x16x32_bf16 v[156:159], a[248:251], v[32:35], v[156:159]
    v_exp_f32 v27, v27
    v_mfma_f32_16x16x32_bf16 v[156:159], a[252:255], v[36:39], v[156:159]
    ds_read_b64_tr_b16 a[164:165], v2 offset:640
    ds_read_b64_tr_b16 a[166:167], v2 offset:896
    v_smfmac_f32_16x16x64_bf16 a[0:3], a[16:19], v[32:39], v11
    ds_read_b64_tr_b16 a[168:169], v2 offset:160
    ds_read_b64_tr_b16 a[170:171], v2 offset:416
    v_mfma_f32_16x16x32_bf16 v[16:19], a[64:67], v[96:99], v[56:59]
    v_exp_f32 v28, v28
    v_mfma_f32_16x16x32_bf16 v[16:19], a[68:71], v[100:103], v[16:19]
    ds_read_b64_tr_b16 a[172:173], v2 offset:672
    v_perm_b32 v45, v27, v26, s100
    v_mfma_f32_16x16x32_bf16 v[16:19], a[72:75], v[104:107], v[16:19]
    s_add_u32 m0, s47, 36864
    v_exp_f32 v29, v29
    v_mfma_f32_16x16x32_bf16 v[16:19], a[76:79], v[108:111], v[16:19]
    s_add_u32 s46, s46, 16384
    buffer_load_dwordx4 off, s[16:19], s46 offset:0 lds
    v_mfma_f32_16x16x32_bf16 v[20:23], a[80:83], v[96:99], v[56:59]
    v_exp_f32 v30, v30
    v_mfma_f32_16x16x32_bf16 v[20:23], a[84:87], v[100:103], v[20:23]
    ds_read_b64_tr_b16 a[174:175], v2 offset:928
    v_perm_b32 v46, v29, v28, s100
    v_mfma_f32_16x16x32_bf16 v[20:23], a[88:91], v[104:107], v[20:23]
    s_add_u32 m0, s47, 36896
    v_exp_f32 v31, v31
    v_mfma_f32_16x16x32_bf16 v[20:23], a[92:95], v[108:111], v[20:23]
    buffer_load_dwordx4 off, s[16:19], s46 offset:1024 lds
    v_mfma_f32_16x16x32_bf16 v[24:27], a[96:99], v[96:99], v[56:59]
    v_exp_f32 v16, v16
    v_mfma_f32_16x16x32_bf16 v[24:27], a[100:103], v[100:103], v[24:27]
    ds_read_b64_tr_b16 a[176:177], v2 offset:192
    v_perm_b32 v47, v31, v30, s100
    v_mfma_f32_16x16x32_bf16 v[24:27], a[104:107], v[104:107], v[24:27]
    s_add_u32 m0, s47, 36928
    v_exp_f32 v17, v17
    v_mfma_f32_16x16x32_bf16 v[24:27], a[108:111], v[108:111], v[24:27]
    buffer_load_dwordx4 off, s[16:19], s46 offset:2048 lds
    v_mfma_f32_16x16x32_bf16 v[28:31], a[112:115], v[96:99], v[56:59]
    v_exp_f32 v18, v18
    v_mfma_f32_16x16x32_bf16 v[28:31], a[116:119], v[100:103], v[28:31]
    ds_read_b64_tr_b16 a[178:179], v2 offset:448
    v_perm_b32 v32, v17, v16, s100
    v_mfma_f32_16x16x32_bf16 v[28:31], a[120:123], v[104:107], v[28:31]
    s_add_u32 m0, s47, 36960
    v_exp_f32 v19, v19
    v_mfma_f32_16x16x32_bf16 v[28:31], a[124:127], v[108:111], v[28:31]
    buffer_load_dwordx4 off, s[16:19], s46 offset:3072 lds
    v_mfma_f32_16x16x32_bf16 v[160:163], a[192:195], v[40:43], v[160:163]
    v_exp_f32 v20, v20
    v_mfma_f32_16x16x32_bf16 v[160:163], a[196:199], v[44:47], v[160:163]
    ds_read_b64_tr_b16 a[180:181], v2 offset:704
    v_perm_b32 v33, v19, v18, s100
    v_mfma_f32_16x16x32_bf16 v[164:167], a[200:203], v[40:43], v[164:167]
    s_add_u32 m0, s47, 53760
    v_exp_f32 v21, v21
    v_mfma_f32_16x16x32_bf16 v[164:167], a[204:207], v[44:47], v[164:167]
    buffer_load_dwordx4 off, s[20:23], s46 offset:0 lds
    v_mfma_f32_16x16x32_bf16 v[168:171], a[208:211], v[40:43], v[168:171]
    v_exp_f32 v22, v22
    v_mfma_f32_16x16x32_bf16 v[168:171], a[212:215], v[44:47], v[168:171]
    ds_read_b64_tr_b16 a[182:183], v2 offset:960
    v_perm_b32 v34, v21, v20, s100
    v_mfma_f32_16x16x32_bf16 v[172:175], a[216:219], v[40:43], v[172:175]
    s_add_u32 m0, s47, 53792
    v_exp_f32 v23, v23
    v_mfma_f32_16x16x32_bf16 v[172:175], a[220:223], v[44:47], v[172:175]
    buffer_load_dwordx4 off, s[20:23], s46 offset:1024 lds
    v_mfma_f32_16x16x32_bf16 v[176:179], a[224:227], v[40:43], v[176:179]
    v_exp_f32 v24, v24
    v_mfma_f32_16x16x32_bf16 v[176:179], a[228:231], v[44:47], v[176:179]
    ds_read_b64_tr_b16 a[184:185], v2 offset:224
    v_perm_b32 v35, v23, v22, s100
    v_mfma_f32_16x16x32_bf16 v[180:183], a[232:235], v[40:43], v[180:183]
    s_add_u32 m0, s47, 53824
    v_exp_f32 v25, v25
    v_mfma_f32_16x16x32_bf16 v[180:183], a[236:239], v[44:47], v[180:183]
    buffer_load_dwordx4 off, s[20:23], s46 offset:2048 lds
    v_mfma_f32_16x16x32_bf16 v[184:187], a[240:243], v[40:43], v[184:187]
    v_exp_f32 v26, v26
    v_mfma_f32_16x16x32_bf16 v[184:187], a[244:247], v[44:47], v[184:187]
    ds_read_b64_tr_b16 a[186:187], v2 offset:480
    v_perm_b32 v36, v25, v24, s100
    v_mfma_f32_16x16x32_bf16 v[188:191], a[248:251], v[40:43], v[188:191]
    s_add_u32 m0, s47, 53856
    v_exp_f32 v27, v27
    v_mfma_f32_16x16x32_bf16 v[188:191], a[252:255], v[44:47], v[188:191]
    buffer_load_dwordx4 off, s[20:23], s46 offset:3072 lds
    v_smfmac_f32_16x16x64_bf16 a[4:7], a[16:19], v[40:47], v11
    ds_read_b64_tr_b16 a[188:189], v2 offset:736
    ds_read_b64_tr_b16 a[190:191], v2 offset:992
    v_mfma_f32_16x16x32_bf16 v[16:19], a[64:67], v[112:115], v[60:63]
    v_exp_f32 v28, v28
    v_mfma_f32_16x16x32_bf16 v[16:19], a[68:71], v[116:119], v[16:19]
    ds_read_b128 a[64:67], v1 offset:0
    v_perm_b32 v37, v27, v26, s100
    v_mfma_f32_16x16x32_bf16 v[16:19], a[72:75], v[120:123], v[16:19]
    v_exp_f32 v29, v29
    v_mfma_f32_16x16x32_bf16 v[16:19], a[76:79], v[124:127], v[16:19]
    ds_read_b128 a[68:71], v1 offset:64
    v_mfma_f32_16x16x32_bf16 v[20:23], a[80:83], v[112:115], v[60:63]
    v_exp_f32 v30, v30
    v_mfma_f32_16x16x32_bf16 v[20:23], a[84:87], v[116:119], v[20:23]
    ds_read_b128 a[72:75], v1 offset:128
    v_perm_b32 v38, v29, v28, s100
    v_mfma_f32_16x16x32_bf16 v[20:23], a[88:91], v[120:123], v[20:23]
    v_exp_f32 v31, v31
    v_mfma_f32_16x16x32_bf16 v[20:23], a[92:95], v[124:127], v[20:23]
    ds_read_b128 a[76:79], v1 offset:192
    v_mfma_f32_16x16x32_bf16 v[24:27], a[96:99], v[112:115], v[60:63]
    v_exp_f32 v16, v16
    v_mfma_f32_16x16x32_bf16 v[24:27], a[100:103], v[116:119], v[24:27]
    ds_read_b128 a[80:83], v1 offset:256
    v_perm_b32 v39, v31, v30, s100
    v_mfma_f32_16x16x32_bf16 v[24:27], a[104:107], v[120:123], v[24:27]
    v_exp_f32 v17, v17
    v_mfma_f32_16x16x32_bf16 v[24:27], a[108:111], v[124:127], v[24:27]
    ds_read_b128 a[84:87], v1 offset:320
    v_mfma_f32_16x16x32_bf16 v[28:31], a[112:115], v[112:115], v[60:63]
    v_exp_f32 v18, v18
    v_mfma_f32_16x16x32_bf16 v[28:31], a[116:119], v[116:119], v[28:31]
    ds_read_b128 a[88:91], v1 offset:384
    v_perm_b32 v40, v17, v16, s100
    v_mfma_f32_16x16x32_bf16 v[28:31], a[120:123], v[120:123], v[28:31]
    v_exp_f32 v19, v19
    v_mfma_f32_16x16x32_bf16 v[28:31], a[124:127], v[124:127], v[28:31]
    ds_read_b128 a[92:95], v1 offset:448
    v_mfma_f32_16x16x32_bf16 v[192:195], a[192:195], v[32:35], v[192:195]
    v_exp_f32 v20, v20
    v_mfma_f32_16x16x32_bf16 v[192:195], a[196:199], v[36:39], v[192:195]
    ds_read_b128 a[96:99], v1 offset:512
    v_perm_b32 v41, v19, v18, s100
    v_mfma_f32_16x16x32_bf16 v[196:199], a[200:203], v[32:35], v[196:199]
    v_exp_f32 v21, v21
    v_mfma_f32_16x16x32_bf16 v[196:199], a[204:207], v[36:39], v[196:199]
    ds_read_b128 a[100:103], v1 offset:576
    v_mfma_f32_16x16x32_bf16 v[200:203], a[208:211], v[32:35], v[200:203]
    v_exp_f32 v22, v22
    v_mfma_f32_16x16x32_bf16 v[200:203], a[212:215], v[36:39], v[200:203]
    ds_read_b128 a[104:107], v1 offset:640
    v_perm_b32 v42, v21, v20, s100
    v_mfma_f32_16x16x32_bf16 v[204:207], a[216:219], v[32:35], v[204:207]
    v_exp_f32 v23, v23
    v_mfma_f32_16x16x32_bf16 v[204:207], a[220:223], v[36:39], v[204:207]
    ds_read_b128 a[108:111], v1 offset:704
    v_mfma_f32_16x16x32_bf16 v[208:211], a[224:227], v[32:35], v[208:211]
    v_exp_f32 v24, v24
    v_mfma_f32_16x16x32_bf16 v[208:211], a[228:231], v[36:39], v[208:211]
    ds_read_b128 a[112:115], v1 offset:768
    v_perm_b32 v43, v23, v22, s100
    v_mfma_f32_16x16x32_bf16 v[212:215], a[232:235], v[32:35], v[212:215]
    v_exp_f32 v25, v25
    v_mfma_f32_16x16x32_bf16 v[212:215], a[236:239], v[36:39], v[212:215]
    ds_read_b128 a[116:119], v1 offset:832
    v_mfma_f32_16x16x32_bf16 v[216:219], a[240:243], v[32:35], v[216:219]
    v_exp_f32 v26, v26
    v_mfma_f32_16x16x32_bf16 v[216:219], a[244:247], v[36:39], v[216:219]
    ds_read_b128 a[120:123], v1 offset:896
    v_perm_b32 v44, v25, v24, s100
    v_mfma_f32_16x16x32_bf16 v[220:223], a[248:251], v[32:35], v[220:223]
    v_exp_f32 v27, v27
    v_mfma_f32_16x16x32_bf16 v[220:223], a[252:255], v[36:39], v[220:223]
    ds_read_b128 a[124:127], v1 offset:960
    v_smfmac_f32_16x16x64_bf16 a[8:11], a[16:19], v[32:39], v11
    s_waitcnt lgkmcnt(12)
    v_mfma_f32_16x16x32_bf16 v[16:19], a[64:67], v[64:67], v[48:51]
    v_exp_f32 v28, v28
    v_mfma_f32_16x16x32_bf16 v[16:19], a[68:71], v[68:71], v[16:19]
    v_perm_b32 v45, v27, v26, s100
    v_mfma_f32_16x16x32_bf16 v[16:19], a[72:75], v[72:75], v[16:19]
    v_exp_f32 v29, v29
    v_mfma_f32_16x16x32_bf16 v[16:19], a[76:79], v[76:79], v[16:19]
    s_waitcnt lgkmcnt(8)
    global_load_dword a63, v15, s[10:11]
    v_mfma_f32_16x16x32_bf16 v[20:23], a[80:83], v[64:67], v[48:51]
    v_exp_f32 v30, v30
    v_mfma_f32_16x16x32_bf16 v[20:23], a[84:87], v[68:71], v[20:23]
    v_perm_b32 v46, v29, v28, s100
    v_mfma_f32_16x16x32_bf16 v[20:23], a[88:91], v[72:75], v[20:23]
    v_exp_f32 v31, v31
    v_mfma_f32_16x16x32_bf16 v[20:23], a[92:95], v[76:79], v[20:23]
    s_waitcnt lgkmcnt(4)
    v_mfma_f32_16x16x32_bf16 v[24:27], a[96:99], v[64:67], v[48:51]
    v_exp_f32 v16, v16
    v_mfma_f32_16x16x32_bf16 v[24:27], a[100:103], v[68:71], v[24:27]
    v_perm_b32 v47, v31, v30, s100
    v_mfma_f32_16x16x32_bf16 v[24:27], a[104:107], v[72:75], v[24:27]
    v_exp_f32 v17, v17
    v_mfma_f32_16x16x32_bf16 v[24:27], a[108:111], v[76:79], v[24:27]
    s_waitcnt lgkmcnt(0)
    v_mfma_f32_16x16x32_bf16 v[28:31], a[112:115], v[64:67], v[48:51]
    v_exp_f32 v18, v18
    v_mfma_f32_16x16x32_bf16 v[28:31], a[116:119], v[68:71], v[28:31]
    v_perm_b32 v32, v17, v16, s100
    v_mfma_f32_16x16x32_bf16 v[28:31], a[120:123], v[72:75], v[28:31]
    v_exp_f32 v19, v19
    v_mfma_f32_16x16x32_bf16 v[28:31], a[124:127], v[76:79], v[28:31]
    v_mfma_f32_16x16x32_bf16 v[224:227], a[192:195], v[40:43], v[224:227]
    v_exp_f32 v20, v20
    v_mfma_f32_16x16x32_bf16 v[224:227], a[196:199], v[44:47], v[224:227]
    ds_read_b64_tr_b16 a[192:193], v2 offset:36864
    v_perm_b32 v33, v19, v18, s100
    v_mfma_f32_16x16x32_bf16 v[228:231], a[200:203], v[40:43], v[228:231]
    v_exp_f32 v21, v21
    v_mfma_f32_16x16x32_bf16 v[228:231], a[204:207], v[44:47], v[228:231]
    ds_read_b64_tr_b16 a[194:195], v2 offset:37120
    v_mfma_f32_16x16x32_bf16 v[232:235], a[208:211], v[40:43], v[232:235]
    v_exp_f32 v22, v22
    v_mfma_f32_16x16x32_bf16 v[232:235], a[212:215], v[44:47], v[232:235]
    ds_read_b64_tr_b16 a[196:197], v2 offset:37376
    v_perm_b32 v34, v21, v20, s100
    v_mfma_f32_16x16x32_bf16 v[236:239], a[216:219], v[40:43], v[236:239]
    v_exp_f32 v23, v23
    v_mfma_f32_16x16x32_bf16 v[236:239], a[220:223], v[44:47], v[236:239]
    ds_read_b64_tr_b16 a[198:199], v2 offset:37632
    v_mfma_f32_16x16x32_bf16 v[240:243], a[224:227], v[40:43], v[240:243]
    v_exp_f32 v24, v24
    v_mfma_f32_16x16x32_bf16 v[240:243], a[228:231], v[44:47], v[240:243]
    ds_read_b64_tr_b16 a[200:201], v2 offset:36896
    v_perm_b32 v35, v23, v22, s100
    v_mfma_f32_16x16x32_bf16 v[244:247], a[232:235], v[40:43], v[244:247]
    v_exp_f32 v25, v25
    v_mfma_f32_16x16x32_bf16 v[244:247], a[236:239], v[44:47], v[244:247]
    ds_read_b64_tr_b16 a[202:203], v2 offset:37152
    v_mfma_f32_16x16x32_bf16 v[248:251], a[240:243], v[40:43], v[248:251]
    v_exp_f32 v26, v26
    v_mfma_f32_16x16x32_bf16 v[248:251], a[244:247], v[44:47], v[248:251]
    ds_read_b64_tr_b16 a[204:205], v2 offset:37408
    v_perm_b32 v36, v25, v24, s100
    v_mfma_f32_16x16x32_bf16 v[252:255], a[248:251], v[40:43], v[252:255]
    v_exp_f32 v27, v27
    v_mfma_f32_16x16x32_bf16 v[252:255], a[252:255], v[44:47], v[252:255]
    ds_read_b64_tr_b16 a[206:207], v2 offset:37664
    v_smfmac_f32_16x16x64_bf16 a[12:15], a[16:19], v[40:47], v11
    ds_read_b64_tr_b16 a[208:209], v2 offset:36928
    v_mfma_f32_16x16x32_bf16 v[16:19], a[64:67], v[80:83], v[52:55]
    v_exp_f32 v28, v28
    v_mfma_f32_16x16x32_bf16 v[16:19], a[68:71], v[84:87], v[16:19]
    ds_read_b64_tr_b16 a[210:211], v2 offset:37184
    v_perm_b32 v37, v27, v26, s100
    v_mfma_f32_16x16x32_bf16 v[16:19], a[72:75], v[88:91], v[16:19]
    v_exp_f32 v29, v29
    v_mfma_f32_16x16x32_bf16 v[16:19], a[76:79], v[92:95], v[16:19]
    ds_read_b64_tr_b16 a[212:213], v2 offset:37440
    v_mfma_f32_16x16x32_bf16 v[20:23], a[80:83], v[80:83], v[52:55]
    v_exp_f32 v30, v30
    v_mfma_f32_16x16x32_bf16 v[20:23], a[84:87], v[84:87], v[20:23]
    ds_read_b64_tr_b16 a[214:215], v2 offset:37696
    v_perm_b32 v38, v29, v28, s100
    v_mfma_f32_16x16x32_bf16 v[20:23], a[88:91], v[88:91], v[20:23]
    v_exp_f32 v31, v31
    v_mfma_f32_16x16x32_bf16 v[20:23], a[92:95], v[92:95], v[20:23]
    ds_read_b64_tr_b16 a[216:217], v2 offset:36960
    v_mfma_f32_16x16x32_bf16 v[24:27], a[96:99], v[80:83], v[52:55]
    v_exp_f32 v16, v16
    v_mfma_f32_16x16x32_bf16 v[24:27], a[100:103], v[84:87], v[24:27]
    ds_read_b64_tr_b16 a[218:219], v2 offset:37216
    v_perm_b32 v39, v31, v30, s100
    v_mfma_f32_16x16x32_bf16 v[24:27], a[104:107], v[88:91], v[24:27]
    v_exp_f32 v17, v17
    v_mfma_f32_16x16x32_bf16 v[24:27], a[108:111], v[92:95], v[24:27]
    ds_read_b64_tr_b16 a[220:221], v2 offset:37472
    v_mfma_f32_16x16x32_bf16 v[28:31], a[112:115], v[80:83], v[52:55]
    v_exp_f32 v18, v18
    v_mfma_f32_16x16x32_bf16 v[28:31], a[116:119], v[84:87], v[28:31]
    ds_read_b64_tr_b16 a[222:223], v2 offset:37728
    v_perm_b32 v40, v17, v16, s100
    v_mfma_f32_16x16x32_bf16 v[28:31], a[120:123], v[88:91], v[28:31]
    v_exp_f32 v19, v19
    v_mfma_f32_16x16x32_bf16 v[28:31], a[124:127], v[92:95], v[28:31]
    ds_read_b64_tr_b16 a[224:225], v2 offset:36992
    v_mfma_f32_16x16x32_bf16 v[128:131], a[128:131], v[32:35], v[128:131]
    v_exp_f32 v20, v20
    v_mfma_f32_16x16x32_bf16 v[128:131], a[132:135], v[36:39], v[128:131]
    ds_read_b64_tr_b16 a[226:227], v2 offset:37248
    v_perm_b32 v41, v19, v18, s100
    v_mfma_f32_16x16x32_bf16 v[132:135], a[136:139], v[32:35], v[132:135]
    v_exp_f32 v21, v21
    v_mfma_f32_16x16x32_bf16 v[132:135], a[140:143], v[36:39], v[132:135]
    global_load_dword a63, v12, s[6:7]
    v_mfma_f32_16x16x32_bf16 v[136:139], a[144:147], v[32:35], v[136:139]
    v_exp_f32 v22, v22
    v_mfma_f32_16x16x32_bf16 v[136:139], a[148:151], v[36:39], v[136:139]
    ds_read_b64_tr_b16 a[228:229], v2 offset:37504
    v_perm_b32 v42, v21, v20, s100
    v_mfma_f32_16x16x32_bf16 v[140:143], a[152:155], v[32:35], v[140:143]
    v_exp_f32 v23, v23
    v_mfma_f32_16x16x32_bf16 v[140:143], a[156:159], v[36:39], v[140:143]
    ds_read_b64_tr_b16 a[230:231], v2 offset:37760
    v_mfma_f32_16x16x32_bf16 v[144:147], a[160:163], v[32:35], v[144:147]
    v_exp_f32 v24, v24
    v_mfma_f32_16x16x32_bf16 v[144:147], a[164:167], v[36:39], v[144:147]
    ds_read_b64_tr_b16 a[232:233], v2 offset:37024
    v_perm_b32 v43, v23, v22, s100
    v_mfma_f32_16x16x32_bf16 v[148:151], a[168:171], v[32:35], v[148:151]
    v_exp_f32 v25, v25
    v_mfma_f32_16x16x32_bf16 v[148:151], a[172:175], v[36:39], v[148:151]
    ds_read_b64_tr_b16 a[234:235], v2 offset:37280
    v_mfma_f32_16x16x32_bf16 v[152:155], a[176:179], v[32:35], v[152:155]
    v_exp_f32 v26, v26
    v_mfma_f32_16x16x32_bf16 v[152:155], a[180:183], v[36:39], v[152:155]
    ds_read_b64_tr_b16 a[236:237], v2 offset:37536
    v_perm_b32 v44, v25, v24, s100
    v_mfma_f32_16x16x32_bf16 v[156:159], a[184:187], v[32:35], v[156:159]
    v_exp_f32 v27, v27
    v_mfma_f32_16x16x32_bf16 v[156:159], a[188:191], v[36:39], v[156:159]
    ds_read_b64_tr_b16 a[238:239], v2 offset:37792
    v_smfmac_f32_16x16x64_bf16 a[0:3], a[16:19], v[32:39], v11
    ds_read_b64_tr_b16 a[240:241], v2 offset:37056
    v_mfma_f32_16x16x32_bf16 v[16:19], a[64:67], v[96:99], v[56:59]
    v_exp_f32 v28, v28
    v_mfma_f32_16x16x32_bf16 v[16:19], a[68:71], v[100:103], v[16:19]
    ds_read_b64_tr_b16 a[242:243], v2 offset:37312
    v_perm_b32 v45, v27, v26, s100
    v_mfma_f32_16x16x32_bf16 v[16:19], a[72:75], v[104:107], v[16:19]
    v_exp_f32 v29, v29
    v_mfma_f32_16x16x32_bf16 v[16:19], a[76:79], v[108:111], v[16:19]
    ds_read_b64_tr_b16 a[244:245], v2 offset:37568
    v_mfma_f32_16x16x32_bf16 v[20:23], a[80:83], v[96:99], v[56:59]
    v_exp_f32 v30, v30
    v_mfma_f32_16x16x32_bf16 v[20:23], a[84:87], v[100:103], v[20:23]
    ds_read_b64_tr_b16 a[246:247], v2 offset:37824
    v_perm_b32 v46, v29, v28, s100
    v_mfma_f32_16x16x32_bf16 v[20:23], a[88:91], v[104:107], v[20:23]
    v_exp_f32 v31, v31
    v_mfma_f32_16x16x32_bf16 v[20:23], a[92:95], v[108:111], v[20:23]
    ds_read_b64_tr_b16 a[248:249], v2 offset:37088
    v_mfma_f32_16x16x32_bf16 v[24:27], a[96:99], v[96:99], v[56:59]
    v_exp_f32 v16, v16
    v_mfma_f32_16x16x32_bf16 v[24:27], a[100:103], v[100:103], v[24:27]
    ds_read_b64_tr_b16 a[250:251], v2 offset:37344
    v_perm_b32 v47, v31, v30, s100
    v_mfma_f32_16x16x32_bf16 v[24:27], a[104:107], v[104:107], v[24:27]
    v_exp_f32 v17, v17
    v_mfma_f32_16x16x32_bf16 v[24:27], a[108:111], v[108:111], v[24:27]
    ds_read_b64_tr_b16 a[252:253], v2 offset:37600
    v_mfma_f32_16x16x32_bf16 v[28:31], a[112:115], v[96:99], v[56:59]
    v_exp_f32 v18, v18
    v_mfma_f32_16x16x32_bf16 v[28:31], a[116:119], v[100:103], v[28:31]
    ds_read_b64_tr_b16 a[254:255], v2 offset:37856
    v_perm_b32 v32, v17, v16, s100
    v_mfma_f32_16x16x32_bf16 v[28:31], a[120:123], v[104:107], v[28:31]
    v_exp_f32 v19, v19
    v_mfma_f32_16x16x32_bf16 v[28:31], a[124:127], v[108:111], v[28:31]
    v_mfma_f32_16x16x32_bf16 v[160:163], a[128:131], v[40:43], v[160:163]
    v_exp_f32 v20, v20
    v_mfma_f32_16x16x32_bf16 v[160:163], a[132:135], v[44:47], v[160:163]
    v_perm_b32 v33, v19, v18, s100
    v_mfma_f32_16x16x32_bf16 v[164:167], a[136:139], v[40:43], v[164:167]
    v_exp_f32 v21, v21
    v_mfma_f32_16x16x32_bf16 v[164:167], a[140:143], v[44:47], v[164:167]
    v_mfma_f32_16x16x32_bf16 v[168:171], a[144:147], v[40:43], v[168:171]
    v_exp_f32 v22, v22
    v_mfma_f32_16x16x32_bf16 v[168:171], a[148:151], v[44:47], v[168:171]
    v_perm_b32 v34, v21, v20, s100
    v_mfma_f32_16x16x32_bf16 v[172:175], a[152:155], v[40:43], v[172:175]
    v_exp_f32 v23, v23
    v_mfma_f32_16x16x32_bf16 v[172:175], a[156:159], v[44:47], v[172:175]
    v_mfma_f32_16x16x32_bf16 v[176:179], a[160:163], v[40:43], v[176:179]
    v_exp_f32 v24, v24
    v_mfma_f32_16x16x32_bf16 v[176:179], a[164:167], v[44:47], v[176:179]
    v_perm_b32 v35, v23, v22, s100
    v_mfma_f32_16x16x32_bf16 v[180:183], a[168:171], v[40:43], v[180:183]
    v_exp_f32 v25, v25
    v_mfma_f32_16x16x32_bf16 v[180:183], a[172:175], v[44:47], v[180:183]
    v_mfma_f32_16x16x32_bf16 v[184:187], a[176:179], v[40:43], v[184:187]
    v_exp_f32 v26, v26
    v_mfma_f32_16x16x32_bf16 v[184:187], a[180:183], v[44:47], v[184:187]
    v_perm_b32 v36, v25, v24, s100
    v_mfma_f32_16x16x32_bf16 v[188:191], a[184:187], v[40:43], v[188:191]
    v_exp_f32 v27, v27
    v_mfma_f32_16x16x32_bf16 v[188:191], a[188:191], v[44:47], v[188:191]
    v_smfmac_f32_16x16x64_bf16 a[4:7], a[16:19], v[40:47], v11
    v_mfma_f32_16x16x32_bf16 v[16:19], a[64:67], v[112:115], v[60:63]
    v_exp_f32 v28, v28
    v_mfma_f32_16x16x32_bf16 v[16:19], a[68:71], v[116:119], v[16:19]
    ds_read_b128 a[64:67], v1 offset:36864
    v_perm_b32 v37, v27, v26, s100
    v_mfma_f32_16x16x32_bf16 v[16:19], a[72:75], v[120:123], v[16:19]
    v_exp_f32 v29, v29
    v_mfma_f32_16x16x32_bf16 v[16:19], a[76:79], v[124:127], v[16:19]
    ds_read_b128 a[68:71], v1 offset:36928
    v_mfma_f32_16x16x32_bf16 v[20:23], a[80:83], v[112:115], v[60:63]
    v_exp_f32 v30, v30
    v_mfma_f32_16x16x32_bf16 v[20:23], a[84:87], v[116:119], v[20:23]
    ds_read_b128 a[72:75], v1 offset:36992
    v_perm_b32 v38, v29, v28, s100
    v_mfma_f32_16x16x32_bf16 v[20:23], a[88:91], v[120:123], v[20:23]
    v_exp_f32 v31, v31
    v_mfma_f32_16x16x32_bf16 v[20:23], a[92:95], v[124:127], v[20:23]
    ds_read_b128 a[76:79], v1 offset:37056
    v_mfma_f32_16x16x32_bf16 v[24:27], a[96:99], v[112:115], v[60:63]
    v_exp_f32 v16, v16
    v_mfma_f32_16x16x32_bf16 v[24:27], a[100:103], v[116:119], v[24:27]
    ds_read_b128 a[80:83], v1 offset:37120
    v_perm_b32 v39, v31, v30, s100
    v_mfma_f32_16x16x32_bf16 v[24:27], a[104:107], v[120:123], v[24:27]
    v_exp_f32 v17, v17
    v_mfma_f32_16x16x32_bf16 v[24:27], a[108:111], v[124:127], v[24:27]
    ds_read_b128 a[84:87], v1 offset:37184
    v_mfma_f32_16x16x32_bf16 v[28:31], a[112:115], v[112:115], v[60:63]
L2_pad7:
    s_cbranch_execz L2_pad11
    v_exp_f32 v18, v18
    v_mfma_f32_16x16x32_bf16 v[28:31], a[116:119], v[116:119], v[28:31]
    ds_read_b128 a[88:91], v1 offset:37248
    v_perm_b32 v40, v17, v16, s100
    v_mfma_f32_16x16x32_bf16 v[28:31], a[120:123], v[120:123], v[28:31]
    v_exp_f32 v19, v19
    v_mfma_f32_16x16x32_bf16 v[28:31], a[124:127], v[124:127], v[28:31]
    ds_read_b128 a[92:95], v1 offset:37312
    v_mfma_f32_16x16x32_bf16 v[192:195], a[128:131], v[32:35], v[192:195]
    v_exp_f32 v20, v20
    v_mfma_f32_16x16x32_bf16 v[192:195], a[132:135], v[36:39], v[192:195]
    ds_read_b128 a[96:99], v1 offset:37376
    v_perm_b32 v41, v19, v18, s100
    v_mfma_f32_16x16x32_bf16 v[196:199], a[136:139], v[32:35], v[196:199]
    v_exp_f32 v21, v21
    v_mfma_f32_16x16x32_bf16 v[196:199], a[140:143], v[36:39], v[196:199]
    ds_read_b128 a[100:103], v1 offset:37440
    v_mfma_f32_16x16x32_bf16 v[200:203], a[144:147], v[32:35], v[200:203]
    v_exp_f32 v22, v22
    v_mfma_f32_16x16x32_bf16 v[200:203], a[148:151], v[36:39], v[200:203]
    ds_read_b128 a[104:107], v1 offset:37504
    v_perm_b32 v42, v21, v20, s100
    v_mfma_f32_16x16x32_bf16 v[204:207], a[152:155], v[32:35], v[204:207]
    v_exp_f32 v23, v23
    v_mfma_f32_16x16x32_bf16 v[204:207], a[156:159], v[36:39], v[204:207]
    ds_read_b128 a[108:111], v1 offset:37568
    v_mfma_f32_16x16x32_bf16 v[208:211], a[160:163], v[32:35], v[208:211]
    v_exp_f32 v24, v24
    v_mfma_f32_16x16x32_bf16 v[208:211], a[164:167], v[36:39], v[208:211]
    ds_read_b128 a[112:115], v1 offset:37632
    v_perm_b32 v43, v23, v22, s100
    v_mfma_f32_16x16x32_bf16 v[212:215], a[168:171], v[32:35], v[212:215]
    v_exp_f32 v25, v25
    v_mfma_f32_16x16x32_bf16 v[212:215], a[172:175], v[36:39], v[212:215]
    ds_read_b128 a[116:119], v1 offset:37696
    v_mfma_f32_16x16x32_bf16 v[216:219], a[176:179], v[32:35], v[216:219]
    v_exp_f32 v26, v26
    v_mfma_f32_16x16x32_bf16 v[216:219], a[180:183], v[36:39], v[216:219]
    ds_read_b128 a[120:123], v1 offset:37760
    v_perm_b32 v44, v25, v24, s100
    v_mfma_f32_16x16x32_bf16 v[220:223], a[184:187], v[32:35], v[220:223]
    v_exp_f32 v27, v27
    v_mfma_f32_16x16x32_bf16 v[220:223], a[188:191], v[36:39], v[220:223]
    ds_read_b128 a[124:127], v1 offset:37824
    v_smfmac_f32_16x16x64_bf16 a[8:11], a[16:19], v[32:39], v11
    s_waitcnt lgkmcnt(12)
    v_mfma_f32_16x16x32_bf16 v[16:19], a[64:67], v[64:67], v[48:51]
    s_sub_u32 s47, s47, s48
    v_exp_f32 v28, v28
    v_mfma_f32_16x16x32_bf16 v[16:19], a[68:71], v[68:71], v[16:19]
    v_perm_b32 v45, v27, v26, s100
    v_add_u32 v1, s48, v1
    v_mfma_f32_16x16x32_bf16 v[16:19], a[72:75], v[72:75], v[16:19]
    v_exp_f32 v29, v29
    v_mfma_f32_16x16x32_bf16 v[16:19], a[76:79], v[76:79], v[16:19]
    s_waitcnt lgkmcnt(8)
    v_mfma_f32_16x16x32_bf16 v[20:23], a[80:83], v[64:67], v[48:51]
    v_exp_f32 v30, v30
    v_mfma_f32_16x16x32_bf16 v[20:23], a[84:87], v[68:71], v[20:23]
    v_perm_b32 v46, v29, v28, s100
    v_add_u32 v2, s48, v2
    v_mfma_f32_16x16x32_bf16 v[20:23], a[88:91], v[72:75], v[20:23]
    v_exp_f32 v31, v31
    v_mfma_f32_16x16x32_bf16 v[20:23], a[92:95], v[76:79], v[20:23]
    s_waitcnt lgkmcnt(4)
    v_mfma_f32_16x16x32_bf16 v[24:27], a[96:99], v[64:67], v[48:51]
    s_sub_u32 s48, 0, s48
    v_exp_f32 v16, v16
    v_mfma_f32_16x16x32_bf16 v[24:27], a[100:103], v[68:71], v[24:27]
    v_perm_b32 v47, v31, v30, s100
    v_mfma_f32_16x16x32_bf16 v[24:27], a[104:107], v[72:75], v[24:27]
    v_exp_f32 v17, v17
    v_mfma_f32_16x16x32_bf16 v[24:27], a[108:111], v[76:79], v[24:27]
    s_waitcnt lgkmcnt(0)
    v_mfma_f32_16x16x32_bf16 v[28:31], a[112:115], v[64:67], v[48:51]
    v_exp_f32 v18, v18
    v_mfma_f32_16x16x32_bf16 v[28:31], a[116:119], v[68:71], v[28:31]
    v_perm_b32 v32, v17, v16, s100
    v_mfma_f32_16x16x32_bf16 v[28:31], a[120:123], v[72:75], v[28:31]
    v_exp_f32 v19, v19
    v_mfma_f32_16x16x32_bf16 v[28:31], a[124:127], v[76:79], v[28:31]
    s_waitcnt vmcnt(2)
    s_barrier
    v_mfma_f32_16x16x32_bf16 v[224:227], a[128:131], v[40:43], v[224:227]
    v_exp_f32 v20, v20
    v_mfma_f32_16x16x32_bf16 v[224:227], a[132:135], v[44:47], v[224:227]
    ds_read_b64_tr_b16 a[128:129], v2 offset:0
    v_perm_b32 v33, v19, v18, s100
    v_mfma_f32_16x16x32_bf16 v[228:231], a[136:139], v[40:43], v[228:231]
    s_add_u32 m0, s47, 0
    v_exp_f32 v21, v21
    v_mfma_f32_16x16x32_bf16 v[228:231], a[140:143], v[44:47], v[228:231]
    s_add_u32 s46, s46, 16384
    buffer_load_dwordx4 off, s[16:19], s46 offset:0 lds
    v_mfma_f32_16x16x32_bf16 v[232:235], a[144:147], v[40:43], v[232:235]
    v_exp_f32 v22, v22
    v_mfma_f32_16x16x32_bf16 v[232:235], a[148:151], v[44:47], v[232:235]
    ds_read_b64_tr_b16 a[130:131], v2 offset:256
    v_perm_b32 v34, v21, v20, s100
    v_mfma_f32_16x16x32_bf16 v[236:239], a[152:155], v[40:43], v[236:239]
    s_add_u32 m0, s47, 32
    v_exp_f32 v23, v23
    v_mfma_f32_16x16x32_bf16 v[236:239], a[156:159], v[44:47], v[236:239]
    buffer_load_dwordx4 off, s[16:19], s46 offset:1024 lds
    v_mfma_f32_16x16x32_bf16 v[240:243], a[160:163], v[40:43], v[240:243]
    v_exp_f32 v24, v24
    v_mfma_f32_16x16x32_bf16 v[240:243], a[164:167], v[44:47], v[240:243]
    ds_read_b64_tr_b16 a[132:133], v2 offset:512
    v_perm_b32 v35, v23, v22, s100
    v_mfma_f32_16x16x32_bf16 v[244:247], a[168:171], v[40:43], v[244:247]
    s_add_u32 m0, s47, 64
    v_exp_f32 v25, v25
    v_mfma_f32_16x16x32_bf16 v[244:247], a[172:175], v[44:47], v[244:247]
    buffer_load_dwordx4 off, s[16:19], s46 offset:2048 lds
    v_mfma_f32_16x16x32_bf16 v[248:251], a[176:179], v[40:43], v[248:251]
    v_exp_f32 v26, v26
    v_mfma_f32_16x16x32_bf16 v[248:251], a[180:183], v[44:47], v[248:251]
    ds_read_b64_tr_b16 a[134:135], v2 offset:768
    v_perm_b32 v36, v25, v24, s100
    v_mfma_f32_16x16x32_bf16 v[252:255], a[184:187], v[40:43], v[252:255]
    s_add_u32 m0, s47, 96
    v_exp_f32 v27, v27
    v_mfma_f32_16x16x32_bf16 v[252:255], a[188:191], v[44:47], v[252:255]
    buffer_load_dwordx4 off, s[16:19], s46 offset:3072 lds
    v_smfmac_f32_16x16x64_bf16 a[12:15], a[16:19], v[40:47], v11
    ds_read_b64_tr_b16 a[136:137], v2 offset:32
    v_mfma_f32_16x16x32_bf16 v[16:19], a[64:67], v[80:83], v[52:55]
    v_exp_f32 v28, v28
    v_mfma_f32_16x16x32_bf16 v[16:19], a[68:71], v[84:87], v[16:19]
    ds_read_b64_tr_b16 a[138:139], v2 offset:288
    v_perm_b32 v37, v27, v26, s100
    v_mfma_f32_16x16x32_bf16 v[16:19], a[72:75], v[88:91], v[16:19]
    s_add_u32 m0, s47, 16896
    v_exp_f32 v29, v29
    v_mfma_f32_16x16x32_bf16 v[16:19], a[76:79], v[92:95], v[16:19]
    buffer_load_dwordx4 off, s[20:23], s46 offset:0 lds
    v_mfma_f32_16x16x32_bf16 v[20:23], a[80:83], v[80:83], v[52:55]
    v_exp_f32 v30, v30
    v_mfma_f32_16x16x32_bf16 v[20:23], a[84:87], v[84:87], v[20:23]
    ds_read_b64_tr_b16 a[140:141], v2 offset:544
    v_perm_b32 v38, v29, v28, s100
    v_mfma_f32_16x16x32_bf16 v[20:23], a[88:91], v[88:91], v[20:23]
    s_add_u32 m0, s47, 16928
    v_exp_f32 v31, v31
    v_mfma_f32_16x16x32_bf16 v[20:23], a[92:95], v[92:95], v[20:23]
    buffer_load_dwordx4 off, s[20:23], s46 offset:1024 lds
    v_mfma_f32_16x16x32_bf16 v[24:27], a[96:99], v[80:83], v[52:55]
    v_exp_f32 v16, v16
    v_mfma_f32_16x16x32_bf16 v[24:27], a[100:103], v[84:87], v[24:27]
    ds_read_b64_tr_b16 a[142:143], v2 offset:800
    v_perm_b32 v39, v31, v30, s100
    v_mfma_f32_16x16x32_bf16 v[24:27], a[104:107], v[88:91], v[24:27]
    s_add_u32 m0, s47, 16960
    v_exp_f32 v17, v17
    v_mfma_f32_16x16x32_bf16 v[24:27], a[108:111], v[92:95], v[24:27]
    buffer_load_dwordx4 off, s[20:23], s46 offset:2048 lds
    v_mfma_f32_16x16x32_bf16 v[28:31], a[112:115], v[80:83], v[52:55]
    v_exp_f32 v18, v18
    v_mfma_f32_16x16x32_bf16 v[28:31], a[116:119], v[84:87], v[28:31]
    ds_read_b64_tr_b16 a[144:145], v2 offset:64
    v_perm_b32 v40, v17, v16, s100
    v_mfma_f32_16x16x32_bf16 v[28:31], a[120:123], v[88:91], v[28:31]
    s_add_u32 m0, s47, 16992
    v_exp_f32 v19, v19
    v_mfma_f32_16x16x32_bf16 v[28:31], a[124:127], v[92:95], v[28:31]
    buffer_load_dwordx4 off, s[20:23], s46 offset:3072 lds
    v_mfma_f32_16x16x32_bf16 v[128:131], a[192:195], v[32:35], v[128:131]
    v_exp_f32 v20, v20
    v_mfma_f32_16x16x32_bf16 v[128:131], a[196:199], v[36:39], v[128:131]
    ds_read_b64_tr_b16 a[146:147], v2 offset:320
    v_perm_b32 v41, v19, v18, s100
    v_mfma_f32_16x16x32_bf16 v[132:135], a[200:203], v[32:35], v[132:135]
    v_exp_f32 v21, v21
    v_mfma_f32_16x16x32_bf16 v[132:135], a[204:207], v[36:39], v[132:135]
    ds_read_b64_tr_b16 a[148:149], v2 offset:576
    v_mfma_f32_16x16x32_bf16 v[136:139], a[208:211], v[32:35], v[136:139]
    v_exp_f32 v22, v22
    v_mfma_f32_16x16x32_bf16 v[136:139], a[212:215], v[36:39], v[136:139]
    ds_read_b64_tr_b16 a[150:151], v2 offset:832
    v_perm_b32 v42, v21, v20, s100
    v_mfma_f32_16x16x32_bf16 v[140:143], a[216:219], v[32:35], v[140:143]
    v_exp_f32 v23, v23
    v_mfma_f32_16x16x32_bf16 v[140:143], a[220:223], v[36:39], v[140:143]
    ds_read_b64_tr_b16 a[152:153], v2 offset:96
    ds_read_b64_tr_b16 a[154:155], v2 offset:352
    v_mfma_f32_16x16x32_bf16 v[144:147], a[224:227], v[32:35], v[144:147]
    v_exp_f32 v24, v24
    v_mfma_f32_16x16x32_bf16 v[144:147], a[228:231], v[36:39], v[144:147]
    ds_read_b64_tr_b16 a[156:157], v2 offset:608
    v_perm_b32 v43, v23, v22, s100
    v_mfma_f32_16x16x32_bf16 v[148:151], a[232:235], v[32:35], v[148:151]
    v_exp_f32 v25, v25
    v_mfma_f32_16x16x32_bf16 v[148:151], a[236:239], v[36:39], v[148:151]
    ds_read_b64_tr_b16 a[158:159], v2 offset:864
    ds_read_b64_tr_b16 a[160:161], v2 offset:128
    v_mfma_f32_16x16x32_bf16 v[152:155], a[240:243], v[32:35], v[152:155]
    v_exp_f32 v26, v26
    v_mfma_f32_16x16x32_bf16 v[152:155], a[244:247], v[36:39], v[152:155]
    ds_read_b64_tr_b16 a[162:163], v2 offset:384
    v_perm_b32 v44, v25, v24, s100
    v_mfma_f32_16x16x32_bf16 v[156:159], a[248:251], v[32:35], v[156:159]
    v_exp_f32 v27, v27
    v_mfma_f32_16x16x32_bf16 v[156:159], a[252:255], v[36:39], v[156:159]
    ds_read_b64_tr_b16 a[164:165], v2 offset:640
    ds_read_b64_tr_b16 a[166:167], v2 offset:896
    v_smfmac_f32_16x16x64_bf16 a[0:3], a[16:19], v[32:39], v11
    ds_read_b64_tr_b16 a[168:169], v2 offset:160
    ds_read_b64_tr_b16 a[170:171], v2 offset:416
    v_mfma_f32_16x16x32_bf16 v[16:19], a[64:67], v[96:99], v[56:59]
    v_exp_f32 v28, v28
    v_mfma_f32_16x16x32_bf16 v[16:19], a[68:71], v[100:103], v[16:19]
    ds_read_b64_tr_b16 a[172:173], v2 offset:672
    v_perm_b32 v45, v27, v26, s100
    v_mfma_f32_16x16x32_bf16 v[16:19], a[72:75], v[104:107], v[16:19]
    s_add_u32 m0, s47, 36864
    v_exp_f32 v29, v29
    v_mfma_f32_16x16x32_bf16 v[16:19], a[76:79], v[108:111], v[16:19]
    s_add_u32 s46, s46, 16384
    buffer_load_dwordx4 off, s[16:19], s46 offset:0 lds
    v_mfma_f32_16x16x32_bf16 v[20:23], a[80:83], v[96:99], v[56:59]
    v_exp_f32 v30, v30
    v_mfma_f32_16x16x32_bf16 v[20:23], a[84:87], v[100:103], v[20:23]
    ds_read_b64_tr_b16 a[174:175], v2 offset:928
    v_perm_b32 v46, v29, v28, s100
    v_mfma_f32_16x16x32_bf16 v[20:23], a[88:91], v[104:107], v[20:23]
    s_add_u32 m0, s47, 36896
    v_exp_f32 v31, v31
    v_mfma_f32_16x16x32_bf16 v[20:23], a[92:95], v[108:111], v[20:23]
    buffer_load_dwordx4 off, s[16:19], s46 offset:1024 lds
    v_mfma_f32_16x16x32_bf16 v[24:27], a[96:99], v[96:99], v[56:59]
    v_exp_f32 v16, v16
    v_mfma_f32_16x16x32_bf16 v[24:27], a[100:103], v[100:103], v[24:27]
    ds_read_b64_tr_b16 a[176:177], v2 offset:192
    v_perm_b32 v47, v31, v30, s100
    v_mfma_f32_16x16x32_bf16 v[24:27], a[104:107], v[104:107], v[24:27]
    s_add_u32 m0, s47, 36928
    v_exp_f32 v17, v17
    v_mfma_f32_16x16x32_bf16 v[24:27], a[108:111], v[108:111], v[24:27]
    buffer_load_dwordx4 off, s[16:19], s46 offset:2048 lds
    v_mfma_f32_16x16x32_bf16 v[28:31], a[112:115], v[96:99], v[56:59]
    v_exp_f32 v18, v18
    v_mfma_f32_16x16x32_bf16 v[28:31], a[116:119], v[100:103], v[28:31]
    ds_read_b64_tr_b16 a[178:179], v2 offset:448
    v_perm_b32 v32, v17, v16, s100
    v_mfma_f32_16x16x32_bf16 v[28:31], a[120:123], v[104:107], v[28:31]
    s_add_u32 m0, s47, 36960
    v_exp_f32 v19, v19
    v_mfma_f32_16x16x32_bf16 v[28:31], a[124:127], v[108:111], v[28:31]
    buffer_load_dwordx4 off, s[16:19], s46 offset:3072 lds
    v_mfma_f32_16x16x32_bf16 v[160:163], a[192:195], v[40:43], v[160:163]
    v_exp_f32 v20, v20
    v_mfma_f32_16x16x32_bf16 v[160:163], a[196:199], v[44:47], v[160:163]
    ds_read_b64_tr_b16 a[180:181], v2 offset:704
    v_perm_b32 v33, v19, v18, s100
    v_mfma_f32_16x16x32_bf16 v[164:167], a[200:203], v[40:43], v[164:167]
    s_add_u32 m0, s47, 53760
    v_exp_f32 v21, v21
    v_mfma_f32_16x16x32_bf16 v[164:167], a[204:207], v[44:47], v[164:167]
    buffer_load_dwordx4 off, s[20:23], s46 offset:0 lds
    v_mfma_f32_16x16x32_bf16 v[168:171], a[208:211], v[40:43], v[168:171]
    v_exp_f32 v22, v22
    v_mfma_f32_16x16x32_bf16 v[168:171], a[212:215], v[44:47], v[168:171]
    ds_read_b64_tr_b16 a[182:183], v2 offset:960
    v_perm_b32 v34, v21, v20, s100
    v_mfma_f32_16x16x32_bf16 v[172:175], a[216:219], v[40:43], v[172:175]
    s_add_u32 m0, s47, 53792
    v_exp_f32 v23, v23
    v_mfma_f32_16x16x32_bf16 v[172:175], a[220:223], v[44:47], v[172:175]
    buffer_load_dwordx4 off, s[20:23], s46 offset:1024 lds
    v_mfma_f32_16x16x32_bf16 v[176:179], a[224:227], v[40:43], v[176:179]
    v_exp_f32 v24, v24
    v_mfma_f32_16x16x32_bf16 v[176:179], a[228:231], v[44:47], v[176:179]
    ds_read_b64_tr_b16 a[184:185], v2 offset:224
    v_perm_b32 v35, v23, v22, s100
    v_mfma_f32_16x16x32_bf16 v[180:183], a[232:235], v[40:43], v[180:183]
    s_add_u32 m0, s47, 53824
    v_exp_f32 v25, v25
    v_mfma_f32_16x16x32_bf16 v[180:183], a[236:239], v[44:47], v[180:183]
    buffer_load_dwordx4 off, s[20:23], s46 offset:2048 lds
    v_mfma_f32_16x16x32_bf16 v[184:187], a[240:243], v[40:43], v[184:187]
    v_exp_f32 v26, v26
    v_mfma_f32_16x16x32_bf16 v[184:187], a[244:247], v[44:47], v[184:187]
    ds_read_b64_tr_b16 a[186:187], v2 offset:480
    v_perm_b32 v36, v25, v24, s100
    v_mfma_f32_16x16x32_bf16 v[188:191], a[248:251], v[40:43], v[188:191]
    s_add_u32 m0, s47, 53856
    v_exp_f32 v27, v27
    v_mfma_f32_16x16x32_bf16 v[188:191], a[252:255], v[44:47], v[188:191]
    buffer_load_dwordx4 off, s[20:23], s46 offset:3072 lds
    v_smfmac_f32_16x16x64_bf16 a[4:7], a[16:19], v[40:47], v11
    ds_read_b64_tr_b16 a[188:189], v2 offset:736
    ds_read_b64_tr_b16 a[190:191], v2 offset:992
    v_mfma_f32_16x16x32_bf16 v[16:19], a[64:67], v[112:115], v[60:63]
    v_exp_f32 v28, v28
    v_mfma_f32_16x16x32_bf16 v[16:19], a[68:71], v[116:119], v[16:19]
    ds_read_b128 a[64:67], v1 offset:0
    v_perm_b32 v37, v27, v26, s100
    v_mfma_f32_16x16x32_bf16 v[16:19], a[72:75], v[120:123], v[16:19]
    v_exp_f32 v29, v29
    v_mfma_f32_16x16x32_bf16 v[16:19], a[76:79], v[124:127], v[16:19]
    ds_read_b128 a[68:71], v1 offset:64
    v_mfma_f32_16x16x32_bf16 v[20:23], a[80:83], v[112:115], v[60:63]
    v_exp_f32 v30, v30
    v_mfma_f32_16x16x32_bf16 v[20:23], a[84:87], v[116:119], v[20:23]
    ds_read_b128 a[72:75], v1 offset:128
    v_perm_b32 v38, v29, v28, s100
    v_mfma_f32_16x16x32_bf16 v[20:23], a[88:91], v[120:123], v[20:23]
    v_exp_f32 v31, v31
    v_mfma_f32_16x16x32_bf16 v[20:23], a[92:95], v[124:127], v[20:23]
    ds_read_b128 a[76:79], v1 offset:192
    v_mfma_f32_16x16x32_bf16 v[24:27], a[96:99], v[112:115], v[60:63]
    v_exp_f32 v16, v16
    v_mfma_f32_16x16x32_bf16 v[24:27], a[100:103], v[116:119], v[24:27]
    ds_read_b128 a[80:83], v1 offset:256
    v_perm_b32 v39, v31, v30, s100
    v_mfma_f32_16x16x32_bf16 v[24:27], a[104:107], v[120:123], v[24:27]
    v_exp_f32 v17, v17
    v_mfma_f32_16x16x32_bf16 v[24:27], a[108:111], v[124:127], v[24:27]
    ds_read_b128 a[84:87], v1 offset:320
    v_mfma_f32_16x16x32_bf16 v[28:31], a[112:115], v[112:115], v[60:63]
    v_exp_f32 v18, v18
    v_mfma_f32_16x16x32_bf16 v[28:31], a[116:119], v[116:119], v[28:31]
    ds_read_b128 a[88:91], v1 offset:384
    v_perm_b32 v40, v17, v16, s100
    v_mfma_f32_16x16x32_bf16 v[28:31], a[120:123], v[120:123], v[28:31]
    v_exp_f32 v19, v19
    v_mfma_f32_16x16x32_bf16 v[28:31], a[124:127], v[124:127], v[28:31]
    ds_read_b128 a[92:95], v1 offset:448
    v_mfma_f32_16x16x32_bf16 v[192:195], a[192:195], v[32:35], v[192:195]
    v_exp_f32 v20, v20
    v_mfma_f32_16x16x32_bf16 v[192:195], a[196:199], v[36:39], v[192:195]
    ds_read_b128 a[96:99], v1 offset:512
    v_perm_b32 v41, v19, v18, s100
    v_mfma_f32_16x16x32_bf16 v[196:199], a[200:203], v[32:35], v[196:199]
    v_exp_f32 v21, v21
    v_mfma_f32_16x16x32_bf16 v[196:199], a[204:207], v[36:39], v[196:199]
    ds_read_b128 a[100:103], v1 offset:576
    v_mfma_f32_16x16x32_bf16 v[200:203], a[208:211], v[32:35], v[200:203]
    v_exp_f32 v22, v22
    v_mfma_f32_16x16x32_bf16 v[200:203], a[212:215], v[36:39], v[200:203]
    ds_read_b128 a[104:107], v1 offset:640
    v_perm_b32 v42, v21, v20, s100
    v_mfma_f32_16x16x32_bf16 v[204:207], a[216:219], v[32:35], v[204:207]
    v_exp_f32 v23, v23
    v_mfma_f32_16x16x32_bf16 v[204:207], a[220:223], v[36:39], v[204:207]
    ds_read_b128 a[108:111], v1 offset:704
    v_mfma_f32_16x16x32_bf16 v[208:211], a[224:227], v[32:35], v[208:211]
    v_exp_f32 v24, v24
    v_mfma_f32_16x16x32_bf16 v[208:211], a[228:231], v[36:39], v[208:211]
    ds_read_b128 a[112:115], v1 offset:768
    v_perm_b32 v43, v23, v22, s100
    v_mfma_f32_16x16x32_bf16 v[212:215], a[232:235], v[32:35], v[212:215]
    v_exp_f32 v25, v25
    v_mfma_f32_16x16x32_bf16 v[212:215], a[236:239], v[36:39], v[212:215]
    ds_read_b128 a[116:119], v1 offset:832
    v_mfma_f32_16x16x32_bf16 v[216:219], a[240:243], v[32:35], v[216:219]
    v_exp_f32 v26, v26
    v_mfma_f32_16x16x32_bf16 v[216:219], a[244:247], v[36:39], v[216:219]
    ds_read_b128 a[120:123], v1 offset:896
    v_perm_b32 v44, v25, v24, s100
    v_mfma_f32_16x16x32_bf16 v[220:223], a[248:251], v[32:35], v[220:223]
    v_exp_f32 v27, v27
    v_mfma_f32_16x16x32_bf16 v[220:223], a[252:255], v[36:39], v[220:223]
    ds_read_b128 a[124:127], v1 offset:960
    v_smfmac_f32_16x16x64_bf16 a[8:11], a[16:19], v[32:39], v11
    s_waitcnt lgkmcnt(12)
    v_mfma_f32_16x16x32_bf16 v[16:19], a[64:67], v[64:67], v[48:51]
    v_exp_f32 v28, v28
    v_mfma_f32_16x16x32_bf16 v[16:19], a[68:71], v[68:71], v[16:19]
    v_perm_b32 v45, v27, v26, s100
    v_mfma_f32_16x16x32_bf16 v[16:19], a[72:75], v[72:75], v[16:19]
    v_exp_f32 v29, v29
    v_mfma_f32_16x16x32_bf16 v[16:19], a[76:79], v[76:79], v[16:19]
    s_waitcnt lgkmcnt(8)
    global_load_dword a63, v13, s[8:9]
    v_mfma_f32_16x16x32_bf16 v[20:23], a[80:83], v[64:67], v[48:51]
    v_exp_f32 v30, v30
    v_mfma_f32_16x16x32_bf16 v[20:23], a[84:87], v[68:71], v[20:23]
    v_perm_b32 v46, v29, v28, s100
    v_mfma_f32_16x16x32_bf16 v[20:23], a[88:91], v[72:75], v[20:23]
    v_exp_f32 v31, v31
    v_mfma_f32_16x16x32_bf16 v[20:23], a[92:95], v[76:79], v[20:23]
    s_waitcnt lgkmcnt(4)
    v_mfma_f32_16x16x32_bf16 v[24:27], a[96:99], v[64:67], v[48:51]
    v_exp_f32 v16, v16
    v_mfma_f32_16x16x32_bf16 v[24:27], a[100:103], v[68:71], v[24:27]
    v_perm_b32 v47, v31, v30, s100
    v_mfma_f32_16x16x32_bf16 v[24:27], a[104:107], v[72:75], v[24:27]
    v_exp_f32 v17, v17
    v_mfma_f32_16x16x32_bf16 v[24:27], a[108:111], v[76:79], v[24:27]
    s_waitcnt lgkmcnt(0)
    v_mfma_f32_16x16x32_bf16 v[28:31], a[112:115], v[64:67], v[48:51]
    v_exp_f32 v18, v18
    v_mfma_f32_16x16x32_bf16 v[28:31], a[116:119], v[68:71], v[28:31]
    v_perm_b32 v32, v17, v16, s100
    v_mfma_f32_16x16x32_bf16 v[28:31], a[120:123], v[72:75], v[28:31]
    v_exp_f32 v19, v19
    v_mfma_f32_16x16x32_bf16 v[28:31], a[124:127], v[76:79], v[28:31]
    buffer_load_dword a63, v9, s[36:39], 0 offen
    v_mfma_f32_16x16x32_bf16 v[224:227], a[192:195], v[40:43], v[224:227]
    v_exp_f32 v20, v20
    v_mfma_f32_16x16x32_bf16 v[224:227], a[196:199], v[44:47], v[224:227]
    ds_read_b64_tr_b16 a[192:193], v2 offset:36864
    v_perm_b32 v33, v19, v18, s100
    v_mfma_f32_16x16x32_bf16 v[228:231], a[200:203], v[40:43], v[228:231]
    v_exp_f32 v21, v21
    v_mfma_f32_16x16x32_bf16 v[228:231], a[204:207], v[44:47], v[228:231]
    ds_read_b64_tr_b16 a[194:195], v2 offset:37120
    v_mfma_f32_16x16x32_bf16 v[232:235], a[208:211], v[40:43], v[232:235]
    v_exp_f32 v22, v22
    v_mfma_f32_16x16x32_bf16 v[232:235], a[212:215], v[44:47], v[232:235]
    ds_read_b64_tr_b16 a[196:197], v2 offset:37376
    v_perm_b32 v34, v21, v20, s100
    v_mfma_f32_16x16x32_bf16 v[236:239], a[216:219], v[40:43], v[236:239]
    v_exp_f32 v23, v23
    v_mfma_f32_16x16x32_bf16 v[236:239], a[220:223], v[44:47], v[236:239]
    ds_read_b64_tr_b16 a[198:199], v2 offset:37632
    v_mfma_f32_16x16x32_bf16 v[240:243], a[224:227], v[40:43], v[240:243]
    v_exp_f32 v24, v24
    v_mfma_f32_16x16x32_bf16 v[240:243], a[228:231], v[44:47], v[240:243]
    ds_read_b64_tr_b16 a[200:201], v2 offset:36896
    v_perm_b32 v35, v23, v22, s100
    v_mfma_f32_16x16x32_bf16 v[244:247], a[232:235], v[40:43], v[244:247]
    s_mov_b32 s54, 0
    v_exp_f32 v25, v25
    v_mfma_f32_16x16x32_bf16 v[244:247], a[236:239], v[44:47], v[244:247]
    buffer_load_dwordx4 a[20:23], v6, s[64:67], s54 offen
    v_mfma_f32_16x16x32_bf16 v[248:251], a[240:243], v[40:43], v[248:251]
    v_exp_f32 v26, v26
    v_mfma_f32_16x16x32_bf16 v[248:251], a[244:247], v[44:47], v[248:251]
    ds_read_b64_tr_b16 a[202:203], v2 offset:37152
    v_perm_b32 v36, v25, v24, s100
    v_mfma_f32_16x16x32_bf16 v[252:255], a[248:251], v[40:43], v[252:255]
    v_exp_f32 v27, v27
    v_mfma_f32_16x16x32_bf16 v[252:255], a[252:255], v[44:47], v[252:255]
    ds_read_b64_tr_b16 a[204:205], v2 offset:37408
    v_smfmac_f32_16x16x64_bf16 a[12:15], a[16:19], v[40:47], v11
    ds_read_b64_tr_b16 a[206:207], v2 offset:37664
    v_mfma_f32_16x16x32_bf16 v[16:19], a[64:67], v[80:83], v[52:55]
    v_exp_f32 v28, v28
    v_mfma_f32_16x16x32_bf16 v[16:19], a[68:71], v[84:87], v[16:19]
    ds_read_b64_tr_b16 a[208:209], v2 offset:36928
    v_perm_b32 v37, v27, v26, s100
    v_mfma_f32_16x16x32_bf16 v[16:19], a[72:75], v[88:91], v[16:19]
    v_exp_f32 v29, v29
    v_mfma_f32_16x16x32_bf16 v[16:19], a[76:79], v[92:95], v[16:19]
    ds_read_b64_tr_b16 a[210:211], v2 offset:37184
    v_mfma_f32_16x16x32_bf16 v[20:23], a[80:83], v[80:83], v[52:55]
    v_exp_f32 v30, v30
    v_mfma_f32_16x16x32_bf16 v[20:23], a[84:87], v[84:87], v[20:23]
    ds_read_b64_tr_b16 a[212:213], v2 offset:37440
    v_perm_b32 v38, v29, v28, s100
    v_mfma_f32_16x16x32_bf16 v[20:23], a[88:91], v[88:91], v[20:23]
    s_mov_b32 s54, 147456
    v_exp_f32 v31, v31
    v_mfma_f32_16x16x32_bf16 v[20:23], a[92:95], v[92:95], v[20:23]
    buffer_load_dwordx4 a[24:27], v6, s[64:67], s54 offen
    v_mfma_f32_16x16x32_bf16 v[24:27], a[96:99], v[80:83], v[52:55]
    v_exp_f32 v16, v16
    v_mfma_f32_16x16x32_bf16 v[24:27], a[100:103], v[84:87], v[24:27]
    ds_read_b64_tr_b16 a[214:215], v2 offset:37696
    v_perm_b32 v39, v31, v30, s100
    v_mfma_f32_16x16x32_bf16 v[24:27], a[104:107], v[88:91], v[24:27]
    v_exp_f32 v17, v17
    v_mfma_f32_16x16x32_bf16 v[24:27], a[108:111], v[92:95], v[24:27]
    ds_read_b64_tr_b16 a[216:217], v2 offset:36960
    v_mfma_f32_16x16x32_bf16 v[28:31], a[112:115], v[80:83], v[52:55]
    v_exp_f32 v18, v18
    v_mfma_f32_16x16x32_bf16 v[28:31], a[116:119], v[84:87], v[28:31]
    ds_read_b64_tr_b16 a[218:219], v2 offset:37216
    v_perm_b32 v40, v17, v16, s100
    v_mfma_f32_16x16x32_bf16 v[28:31], a[120:123], v[88:91], v[28:31]
    v_exp_f32 v19, v19
    v_mfma_f32_16x16x32_bf16 v[28:31], a[124:127], v[92:95], v[28:31]
    ds_read_b64_tr_b16 a[220:221], v2 offset:37472
    v_mfma_f32_16x16x32_bf16 v[128:131], a[128:131], v[32:35], v[128:131]
    v_exp_f32 v20, v20
    v_mfma_f32_16x16x32_bf16 v[128:131], a[132:135], v[36:39], v[128:131]
    ds_read_b64_tr_b16 a[222:223], v2 offset:37728
    v_perm_b32 v41, v19, v18, s100
    v_mfma_f32_16x16x32_bf16 v[132:135], a[136:139], v[32:35], v[132:135]
    s_mov_b32 s54, 294912
    v_exp_f32 v21, v21
    v_mfma_f32_16x16x32_bf16 v[132:135], a[140:143], v[36:39], v[132:135]
    buffer_load_dwordx4 a[28:31], v6, s[64:67], s54 offen
    v_mfma_f32_16x16x32_bf16 v[136:139], a[144:147], v[32:35], v[136:139]
    v_exp_f32 v22, v22
    v_mfma_f32_16x16x32_bf16 v[136:139], a[148:151], v[36:39], v[136:139]
    ds_read_b64_tr_b16 a[224:225], v2 offset:36992
    v_perm_b32 v42, v21, v20, s100
    v_mfma_f32_16x16x32_bf16 v[140:143], a[152:155], v[32:35], v[140:143]
    v_exp_f32 v23, v23
    v_mfma_f32_16x16x32_bf16 v[140:143], a[156:159], v[36:39], v[140:143]
    ds_read_b64_tr_b16 a[226:227], v2 offset:37248
    v_mfma_f32_16x16x32_bf16 v[144:147], a[160:163], v[32:35], v[144:147]
    v_exp_f32 v24, v24
    v_mfma_f32_16x16x32_bf16 v[144:147], a[164:167], v[36:39], v[144:147]
    ds_read_b64_tr_b16 a[228:229], v2 offset:37504
    v_perm_b32 v43, v23, v22, s100
    v_mfma_f32_16x16x32_bf16 v[148:151], a[168:171], v[32:35], v[148:151]
    v_exp_f32 v25, v25
    v_mfma_f32_16x16x32_bf16 v[148:151], a[172:175], v[36:39], v[148:151]
    ds_read_b64_tr_b16 a[230:231], v2 offset:37760
    v_mfma_f32_16x16x32_bf16 v[152:155], a[176:179], v[32:35], v[152:155]
    v_exp_f32 v26, v26
    v_mfma_f32_16x16x32_bf16 v[152:155], a[180:183], v[36:39], v[152:155]
    ds_read_b64_tr_b16 a[232:233], v2 offset:37024
    v_perm_b32 v44, v25, v24, s100
    v_mfma_f32_16x16x32_bf16 v[156:159], a[184:187], v[32:35], v[156:159]
    s_mov_b32 s54, 442368
    v_exp_f32 v27, v27
    v_mfma_f32_16x16x32_bf16 v[156:159], a[188:191], v[36:39], v[156:159]
    buffer_load_dwordx4 a[32:35], v6, s[64:67], s54 offen
    v_smfmac_f32_16x16x64_bf16 a[0:3], a[16:19], v[32:39], v11
    ds_read_b64_tr_b16 a[234:235], v2 offset:37280
    v_mfma_f32_16x16x32_bf16 v[16:19], a[64:67], v[96:99], v[56:59]
    v_exp_f32 v28, v28
    v_mfma_f32_16x16x32_bf16 v[16:19], a[68:71], v[100:103], v[16:19]
    ds_read_b64_tr_b16 a[236:237], v2 offset:37536
    v_perm_b32 v45, v27, v26, s100
    v_mfma_f32_16x16x32_bf16 v[16:19], a[72:75], v[104:107], v[16:19]
    v_exp_f32 v29, v29
    v_mfma_f32_16x16x32_bf16 v[16:19], a[76:79], v[108:111], v[16:19]
    ds_read_b64_tr_b16 a[238:239], v2 offset:37792
    v_mfma_f32_16x16x32_bf16 v[20:23], a[80:83], v[96:99], v[56:59]
    v_exp_f32 v30, v30
    v_mfma_f32_16x16x32_bf16 v[20:23], a[84:87], v[100:103], v[20:23]
    ds_read_b64_tr_b16 a[240:241], v2 offset:37056
    v_perm_b32 v46, v29, v28, s100
    v_mfma_f32_16x16x32_bf16 v[20:23], a[88:91], v[104:107], v[20:23]
    v_exp_f32 v31, v31
    v_mfma_f32_16x16x32_bf16 v[20:23], a[92:95], v[108:111], v[20:23]
    ds_read_b64_tr_b16 a[242:243], v2 offset:37312
    v_mfma_f32_16x16x32_bf16 v[24:27], a[96:99], v[96:99], v[56:59]
    v_exp_f32 v16, v16
    v_mfma_f32_16x16x32_bf16 v[24:27], a[100:103], v[100:103], v[24:27]
    ds_read_b64_tr_b16 a[244:245], v2 offset:37568
    v_perm_b32 v47, v31, v30, s100
    v_mfma_f32_16x16x32_bf16 v[24:27], a[104:107], v[104:107], v[24:27]
    s_mov_b32 s54, 589824
    v_exp_f32 v17, v17
    v_mfma_f32_16x16x32_bf16 v[24:27], a[108:111], v[108:111], v[24:27]
    buffer_load_dwordx4 a[36:39], v6, s[64:67], s54 offen
    v_mfma_f32_16x16x32_bf16 v[28:31], a[112:115], v[96:99], v[56:59]
    v_exp_f32 v18, v18
    v_mfma_f32_16x16x32_bf16 v[28:31], a[116:119], v[100:103], v[28:31]
    ds_read_b64_tr_b16 a[246:247], v2 offset:37824
    v_perm_b32 v32, v17, v16, s100
    v_mfma_f32_16x16x32_bf16 v[28:31], a[120:123], v[104:107], v[28:31]
    v_exp_f32 v19, v19
    v_mfma_f32_16x16x32_bf16 v[28:31], a[124:127], v[108:111], v[28:31]
    ds_read_b64_tr_b16 a[248:249], v2 offset:37088
    v_mfma_f32_16x16x32_bf16 v[160:163], a[128:131], v[40:43], v[160:163]
    v_exp_f32 v20, v20
    v_mfma_f32_16x16x32_bf16 v[160:163], a[132:135], v[44:47], v[160:163]
    ds_read_b64_tr_b16 a[250:251], v2 offset:37344
    v_perm_b32 v33, v19, v18, s100
    v_mfma_f32_16x16x32_bf16 v[164:167], a[136:139], v[40:43], v[164:167]
    v_exp_f32 v21, v21
    v_mfma_f32_16x16x32_bf16 v[164:167], a[140:143], v[44:47], v[164:167]
    ds_read_b64_tr_b16 a[252:253], v2 offset:37600
    v_mfma_f32_16x16x32_bf16 v[168:171], a[144:147], v[40:43], v[168:171]
    v_exp_f32 v22, v22
    v_mfma_f32_16x16x32_bf16 v[168:171], a[148:151], v[44:47], v[168:171]
    ds_read_b64_tr_b16 a[254:255], v2 offset:37856
    v_perm_b32 v34, v21, v20, s100
    v_mfma_f32_16x16x32_bf16 v[172:175], a[152:155], v[40:43], v[172:175]
    v_exp_f32 v23, v23
    v_mfma_f32_16x16x32_bf16 v[172:175], a[156:159], v[44:47], v[172:175]
    v_mfma_f32_16x16x32_bf16 v[176:179], a[160:163], v[40:43], v[176:179]
    v_exp_f32 v24, v24
    v_mfma_f32_16x16x32_bf16 v[176:179], a[164:167], v[44:47], v[176:179]
    v_perm_b32 v35, v23, v22, s100
    v_mfma_f32_16x16x32_bf16 v[180:183], a[168:171], v[40:43], v[180:183]
    v_exp_f32 v25, v25
    v_mfma_f32_16x16x32_bf16 v[180:183], a[172:175], v[44:47], v[180:183]
    v_mfma_f32_16x16x32_bf16 v[184:187], a[176:179], v[40:43], v[184:187]
    v_exp_f32 v26, v26
    v_mfma_f32_16x16x32_bf16 v[184:187], a[180:183], v[44:47], v[184:187]
    v_perm_b32 v36, v25, v24, s100
    v_mfma_f32_16x16x32_bf16 v[188:191], a[184:187], v[40:43], v[188:191]
L2_pad8:
    s_cbranch_execz L2_pad12
    v_exp_f32 v27, v27
    v_mfma_f32_16x16x32_bf16 v[188:191], a[188:191], v[44:47], v[188:191]
    v_smfmac_f32_16x16x64_bf16 a[4:7], a[16:19], v[40:47], v11
    v_mfma_f32_16x16x32_bf16 v[16:19], a[64:67], v[112:115], v[60:63]
    v_exp_f32 v28, v28
    v_mfma_f32_16x16x32_bf16 v[16:19], a[68:71], v[116:119], v[16:19]
    ds_read_b128 a[64:67], v1 offset:36864
    v_perm_b32 v37, v27, v26, s100
    v_mfma_f32_16x16x32_bf16 v[16:19], a[72:75], v[120:123], v[16:19]
    v_exp_f32 v29, v29
    v_mfma_f32_16x16x32_bf16 v[16:19], a[76:79], v[124:127], v[16:19]
    ds_read_b128 a[68:71], v1 offset:36928
    v_mfma_f32_16x16x32_bf16 v[20:23], a[80:83], v[112:115], v[60:63]
    v_exp_f32 v30, v30
    v_mfma_f32_16x16x32_bf16 v[20:23], a[84:87], v[116:119], v[20:23]
    ds_read_b128 a[72:75], v1 offset:36992
    v_perm_b32 v38, v29, v28, s100
    v_mfma_f32_16x16x32_bf16 v[20:23], a[88:91], v[120:123], v[20:23]
    v_exp_f32 v31, v31
    v_mfma_f32_16x16x32_bf16 v[20:23], a[92:95], v[124:127], v[20:23]
    ds_read_b128 a[76:79], v1 offset:37056
    v_mfma_f32_16x16x32_bf16 v[24:27], a[96:99], v[112:115], v[60:63]
    v_exp_f32 v16, v16
    v_mfma_f32_16x16x32_bf16 v[24:27], a[100:103], v[116:119], v[24:27]
    ds_read_b128 a[80:83], v1 offset:37120
    v_perm_b32 v39, v31, v30, s100
    v_mfma_f32_16x16x32_bf16 v[24:27], a[104:107], v[120:123], v[24:27]
    v_exp_f32 v17, v17
    v_mfma_f32_16x16x32_bf16 v[24:27], a[108:111], v[124:127], v[24:27]
    ds_read_b128 a[84:87], v1 offset:37184
    v_mfma_f32_16x16x32_bf16 v[28:31], a[112:115], v[112:115], v[60:63]
    v_exp_f32 v18, v18
    v_mfma_f32_16x16x32_bf16 v[28:31], a[116:119], v[116:119], v[28:31]
    ds_read_b128 a[88:91], v1 offset:37248
    v_perm_b32 v40, v17, v16, s100
    v_mfma_f32_16x16x32_bf16 v[28:31], a[120:123], v[120:123], v[28:31]
    v_exp_f32 v19, v19
    v_mfma_f32_16x16x32_bf16 v[28:31], a[124:127], v[124:127], v[28:31]
    ds_read_b128 a[92:95], v1 offset:37312
    v_mfma_f32_16x16x32_bf16 v[192:195], a[128:131], v[32:35], v[192:195]
    v_exp_f32 v20, v20
    v_mfma_f32_16x16x32_bf16 v[192:195], a[132:135], v[36:39], v[192:195]
    ds_read_b128 a[96:99], v1 offset:37376
    v_perm_b32 v41, v19, v18, s100
    v_mfma_f32_16x16x32_bf16 v[196:199], a[136:139], v[32:35], v[196:199]
    v_exp_f32 v21, v21
    v_mfma_f32_16x16x32_bf16 v[196:199], a[140:143], v[36:39], v[196:199]
    ds_read_b128 a[100:103], v1 offset:37440
    v_mfma_f32_16x16x32_bf16 v[200:203], a[144:147], v[32:35], v[200:203]
    v_exp_f32 v22, v22
    v_mfma_f32_16x16x32_bf16 v[200:203], a[148:151], v[36:39], v[200:203]
    ds_read_b128 a[104:107], v1 offset:37504
    v_perm_b32 v42, v21, v20, s100
    v_mfma_f32_16x16x32_bf16 v[204:207], a[152:155], v[32:35], v[204:207]
    v_exp_f32 v23, v23
    v_mfma_f32_16x16x32_bf16 v[204:207], a[156:159], v[36:39], v[204:207]
    ds_read_b128 a[108:111], v1 offset:37568
    v_mfma_f32_16x16x32_bf16 v[208:211], a[160:163], v[32:35], v[208:211]
    v_exp_f32 v24, v24
    v_mfma_f32_16x16x32_bf16 v[208:211], a[164:167], v[36:39], v[208:211]
    ds_read_b128 a[112:115], v1 offset:37632
    v_perm_b32 v43, v23, v22, s100
    v_mfma_f32_16x16x32_bf16 v[212:215], a[168:171], v[32:35], v[212:215]
    v_exp_f32 v25, v25
    v_mfma_f32_16x16x32_bf16 v[212:215], a[172:175], v[36:39], v[212:215]
    ds_read_b128 a[116:119], v1 offset:37696
    v_mfma_f32_16x16x32_bf16 v[216:219], a[176:179], v[32:35], v[216:219]
    v_exp_f32 v26, v26
    v_mfma_f32_16x16x32_bf16 v[216:219], a[180:183], v[36:39], v[216:219]
    ds_read_b128 a[120:123], v1 offset:37760
    v_perm_b32 v44, v25, v24, s100
    v_mfma_f32_16x16x32_bf16 v[220:223], a[184:187], v[32:35], v[220:223]
    v_exp_f32 v27, v27
    v_mfma_f32_16x16x32_bf16 v[220:223], a[188:191], v[36:39], v[220:223]
    ds_read_b128 a[124:127], v1 offset:37824
    v_smfmac_f32_16x16x64_bf16 a[8:11], a[16:19], v[32:39], v11
    s_waitcnt lgkmcnt(12)
    v_mfma_f32_16x16x32_bf16 v[16:19], a[64:67], v[64:67], v[48:51]
    s_sub_u32 s47, s47, s48
    v_exp_f32 v28, v28
    v_mfma_f32_16x16x32_bf16 v[16:19], a[68:71], v[68:71], v[16:19]
    v_perm_b32 v45, v27, v26, s100
    v_add_u32 v1, s48, v1
    v_mfma_f32_16x16x32_bf16 v[16:19], a[72:75], v[72:75], v[16:19]
    v_exp_f32 v29, v29
    v_mfma_f32_16x16x32_bf16 v[16:19], a[76:79], v[76:79], v[16:19]
    s_waitcnt lgkmcnt(8)
    v_mfma_f32_16x16x32_bf16 v[20:23], a[80:83], v[64:67], v[48:51]
    v_exp_f32 v30, v30
    v_mfma_f32_16x16x32_bf16 v[20:23], a[84:87], v[68:71], v[20:23]
    v_perm_b32 v46, v29, v28, s100
    v_add_u32 v2, s48, v2
    v_mfma_f32_16x16x32_bf16 v[20:23], a[88:91], v[72:75], v[20:23]
    v_exp_f32 v31, v31
    v_mfma_f32_16x16x32_bf16 v[20:23], a[92:95], v[76:79], v[20:23]
    s_waitcnt lgkmcnt(4)
    v_mfma_f32_16x16x32_bf16 v[24:27], a[96:99], v[64:67], v[48:51]
    s_sub_u32 s48, 0, s48
    v_exp_f32 v16, v16
    v_mfma_f32_16x16x32_bf16 v[24:27], a[100:103], v[68:71], v[24:27]
    v_perm_b32 v47, v31, v30, s100
    v_mfma_f32_16x16x32_bf16 v[24:27], a[104:107], v[72:75], v[24:27]
    v_exp_f32 v17, v17
    v_mfma_f32_16x16x32_bf16 v[24:27], a[108:111], v[76:79], v[24:27]
    s_waitcnt lgkmcnt(0)
    v_mfma_f32_16x16x32_bf16 v[28:31], a[112:115], v[64:67], v[48:51]
    v_exp_f32 v18, v18
    v_mfma_f32_16x16x32_bf16 v[28:31], a[116:119], v[68:71], v[28:31]
    v_perm_b32 v32, v17, v16, s100
    v_mfma_f32_16x16x32_bf16 v[28:31], a[120:123], v[72:75], v[28:31]
    v_exp_f32 v19, v19
    v_mfma_f32_16x16x32_bf16 v[28:31], a[124:127], v[76:79], v[28:31]
    s_waitcnt vmcnt(7)
    s_barrier
    v_mfma_f32_16x16x32_bf16 v[224:227], a[128:131], v[40:43], v[224:227]
    v_exp_f32 v20, v20
    v_mfma_f32_16x16x32_bf16 v[224:227], a[132:135], v[44:47], v[224:227]
    ds_read_b64_tr_b16 a[128:129], v2 offset:0
    v_perm_b32 v33, v19, v18, s100
    v_mfma_f32_16x16x32_bf16 v[228:231], a[136:139], v[40:43], v[228:231]
    s_add_u32 m0, s44, 73728
    v_exp_f32 v21, v21
    v_mfma_f32_16x16x32_bf16 v[228:231], a[140:143], v[44:47], v[228:231]
    s_mov_b32 s45, 0
    buffer_load_dwordx4 v7, s[28:31], s45 offen offset:0 lds
    v_mfma_f32_16x16x32_bf16 v[232:235], a[144:147], v[40:43], v[232:235]
    v_exp_f32 v22, v22
    v_mfma_f32_16x16x32_bf16 v[232:235], a[148:151], v[44:47], v[232:235]
    ds_read_b64_tr_b16 a[130:131], v2 offset:256
    v_perm_b32 v34, v21, v20, s100
    v_mfma_f32_16x16x32_bf16 v[236:239], a[152:155], v[40:43], v[236:239]
    s_add_u32 m0, s44, 73632
    v_exp_f32 v23, v23
    v_mfma_f32_16x16x32_bf16 v[236:239], a[156:159], v[44:47], v[236:239]
    buffer_load_dwordx4 v7, s[28:31], s45 offen offset:1152 lds
    v_mfma_f32_16x16x32_bf16 v[240:243], a[160:163], v[40:43], v[240:243]
    v_exp_f32 v24, v24
    v_mfma_f32_16x16x32_bf16 v[240:243], a[164:167], v[44:47], v[240:243]
    ds_read_b64_tr_b16 a[132:133], v2 offset:512
    v_perm_b32 v35, v23, v22, s100
    v_mfma_f32_16x16x32_bf16 v[244:247], a[168:171], v[40:43], v[244:247]
    s_add_u32 m0, s44, 73536
    v_exp_f32 v25, v25
    v_mfma_f32_16x16x32_bf16 v[244:247], a[172:175], v[44:47], v[244:247]
    buffer_load_dwordx4 v7, s[28:31], s45 offen offset:2304 lds
    v_mfma_f32_16x16x32_bf16 v[248:251], a[176:179], v[40:43], v[248:251]
    v_exp_f32 v26, v26
    v_mfma_f32_16x16x32_bf16 v[248:251], a[180:183], v[44:47], v[248:251]
    ds_read_b64_tr_b16 a[134:135], v2 offset:768
    v_perm_b32 v36, v25, v24, s100
    v_mfma_f32_16x16x32_bf16 v[252:255], a[184:187], v[40:43], v[252:255]
    s_add_u32 m0, s44, 73440
    v_exp_f32 v27, v27
    v_mfma_f32_16x16x32_bf16 v[252:255], a[188:191], v[44:47], v[252:255]
    buffer_load_dwordx4 v7, s[28:31], s45 offen offset:3456 lds
    v_smfmac_f32_16x16x64_bf16 a[12:15], a[16:19], v[40:47], v11
    ds_read_b64_tr_b16 a[136:137], v2 offset:32
    v_mfma_f32_16x16x32_bf16 v[16:19], a[64:67], v[80:83], v[52:55]
    v_exp_f32 v28, v28
    v_mfma_f32_16x16x32_bf16 v[16:19], a[68:71], v[84:87], v[16:19]
    ds_read_b64_tr_b16 a[138:139], v2 offset:288
    v_perm_b32 v37, v27, v26, s100
    v_mfma_f32_16x16x32_bf16 v[16:19], a[72:75], v[88:91], v[16:19]
    s_add_u32 m0, s44, 90624
    v_exp_f32 v29, v29
    v_mfma_f32_16x16x32_bf16 v[16:19], a[76:79], v[92:95], v[16:19]
    s_mov_b32 s45, 147456
    buffer_load_dwordx4 v7, s[28:31], s45 offen offset:0 lds
    v_mfma_f32_16x16x32_bf16 v[20:23], a[80:83], v[80:83], v[52:55]
    v_exp_f32 v30, v30
    v_mfma_f32_16x16x32_bf16 v[20:23], a[84:87], v[84:87], v[20:23]
    ds_read_b64_tr_b16 a[140:141], v2 offset:544
    v_perm_b32 v38, v29, v28, s100
    v_mfma_f32_16x16x32_bf16 v[20:23], a[88:91], v[88:91], v[20:23]
    s_add_u32 m0, s44, 90528
    v_exp_f32 v31, v31
    v_mfma_f32_16x16x32_bf16 v[20:23], a[92:95], v[92:95], v[20:23]
    buffer_load_dwordx4 v7, s[28:31], s45 offen offset:1152 lds
    v_mfma_f32_16x16x32_bf16 v[24:27], a[96:99], v[80:83], v[52:55]
    v_exp_f32 v16, v16
    v_mfma_f32_16x16x32_bf16 v[24:27], a[100:103], v[84:87], v[24:27]
    ds_read_b64_tr_b16 a[142:143], v2 offset:800
    v_perm_b32 v39, v31, v30, s100
    v_mfma_f32_16x16x32_bf16 v[24:27], a[104:107], v[88:91], v[24:27]
    s_add_u32 m0, s44, 90432
    v_exp_f32 v17, v17
    v_mfma_f32_16x16x32_bf16 v[24:27], a[108:111], v[92:95], v[24:27]
    buffer_load_dwordx4 v7, s[28:31], s45 offen offset:2304 lds
    v_mfma_f32_16x16x32_bf16 v[28:31], a[112:115], v[80:83], v[52:55]
    v_exp_f32 v18, v18
    v_mfma_f32_16x16x32_bf16 v[28:31], a[116:119], v[84:87], v[28:31]
    ds_read_b64_tr_b16 a[144:145], v2 offset:64
    v_perm_b32 v40, v17, v16, s100
    v_mfma_f32_16x16x32_bf16 v[28:31], a[120:123], v[88:91], v[28:31]
    s_add_u32 m0, s44, 90336
    v_exp_f32 v19, v19
    v_mfma_f32_16x16x32_bf16 v[28:31], a[124:127], v[92:95], v[28:31]
    buffer_load_dwordx4 v7, s[28:31], s45 offen offset:3456 lds
    v_mfma_f32_16x16x32_bf16 v[128:131], a[192:195], v[32:35], v[128:131]
    v_exp_f32 v20, v20
    v_mfma_f32_16x16x32_bf16 v[128:131], a[196:199], v[36:39], v[128:131]
    ds_read_b64_tr_b16 a[146:147], v2 offset:320
    v_perm_b32 v41, v19, v18, s100
    v_mfma_f32_16x16x32_bf16 v[132:135], a[200:203], v[32:35], v[132:135]
    v_exp_f32 v21, v21
    v_mfma_f32_16x16x32_bf16 v[132:135], a[204:207], v[36:39], v[132:135]
    ds_read_b64_tr_b16 a[148:149], v2 offset:576
    v_mfma_f32_16x16x32_bf16 v[136:139], a[208:211], v[32:35], v[136:139]
    v_exp_f32 v22, v22
    v_mfma_f32_16x16x32_bf16 v[136:139], a[212:215], v[36:39], v[136:139]
    ds_read_b64_tr_b16 a[150:151], v2 offset:832
    v_perm_b32 v42, v21, v20, s100
    v_mfma_f32_16x16x32_bf16 v[140:143], a[216:219], v[32:35], v[140:143]
    v_exp_f32 v23, v23
    v_mfma_f32_16x16x32_bf16 v[140:143], a[220:223], v[36:39], v[140:143]
    ds_read_b64_tr_b16 a[152:153], v2 offset:96
    ds_read_b64_tr_b16 a[154:155], v2 offset:352
    v_mfma_f32_16x16x32_bf16 v[144:147], a[224:227], v[32:35], v[144:147]
    v_exp_f32 v24, v24
    v_mfma_f32_16x16x32_bf16 v[144:147], a[228:231], v[36:39], v[144:147]
    ds_read_b64_tr_b16 a[156:157], v2 offset:608
    v_perm_b32 v43, v23, v22, s100
    v_mfma_f32_16x16x32_bf16 v[148:151], a[232:235], v[32:35], v[148:151]
    v_exp_f32 v25, v25
    v_mfma_f32_16x16x32_bf16 v[148:151], a[236:239], v[36:39], v[148:151]
    ds_read_b64_tr_b16 a[158:159], v2 offset:864
    ds_read_b64_tr_b16 a[160:161], v2 offset:128
    v_mfma_f32_16x16x32_bf16 v[152:155], a[240:243], v[32:35], v[152:155]
    v_exp_f32 v26, v26
    v_mfma_f32_16x16x32_bf16 v[152:155], a[244:247], v[36:39], v[152:155]
    ds_read_b64_tr_b16 a[162:163], v2 offset:384
    v_perm_b32 v44, v25, v24, s100
    v_mfma_f32_16x16x32_bf16 v[156:159], a[248:251], v[32:35], v[156:159]
    v_exp_f32 v27, v27
    v_mfma_f32_16x16x32_bf16 v[156:159], a[252:255], v[36:39], v[156:159]
    ds_read_b64_tr_b16 a[164:165], v2 offset:640
    ds_read_b64_tr_b16 a[166:167], v2 offset:896
    v_smfmac_f32_16x16x64_bf16 a[0:3], a[16:19], v[32:39], v11
    ds_read_b64_tr_b16 a[168:169], v2 offset:160
    ds_read_b64_tr_b16 a[170:171], v2 offset:416
    v_mfma_f32_16x16x32_bf16 v[16:19], a[64:67], v[96:99], v[56:59]
    v_exp_f32 v28, v28
    v_mfma_f32_16x16x32_bf16 v[16:19], a[68:71], v[100:103], v[16:19]
    ds_read_b64_tr_b16 a[172:173], v2 offset:672
    v_perm_b32 v45, v27, v26, s100
    v_mfma_f32_16x16x32_bf16 v[16:19], a[72:75], v[104:107], v[16:19]
    s_add_u32 m0, s44, 110592
    v_exp_f32 v29, v29
    v_mfma_f32_16x16x32_bf16 v[16:19], a[76:79], v[108:111], v[16:19]
    s_mov_b32 s45, 128
    buffer_load_dwordx4 v7, s[28:31], s45 offen offset:0 lds
    v_mfma_f32_16x16x32_bf16 v[20:23], a[80:83], v[96:99], v[56:59]
    v_exp_f32 v30, v30
    v_mfma_f32_16x16x32_bf16 v[20:23], a[84:87], v[100:103], v[20:23]
    ds_read_b64_tr_b16 a[174:175], v2 offset:928
    v_perm_b32 v46, v29, v28, s100
    v_mfma_f32_16x16x32_bf16 v[20:23], a[88:91], v[104:107], v[20:23]
    s_add_u32 m0, s44, 110496
    v_exp_f32 v31, v31
    v_mfma_f32_16x16x32_bf16 v[20:23], a[92:95], v[108:111], v[20:23]
    buffer_load_dwordx4 v7, s[28:31], s45 offen offset:1152 lds
    v_mfma_f32_16x16x32_bf16 v[24:27], a[96:99], v[96:99], v[56:59]
    v_exp_f32 v16, v16
    v_mfma_f32_16x16x32_bf16 v[24:27], a[100:103], v[100:103], v[24:27]
    ds_read_b64_tr_b16 a[176:177], v2 offset:192
    v_perm_b32 v47, v31, v30, s100
    v_mfma_f32_16x16x32_bf16 v[24:27], a[104:107], v[104:107], v[24:27]
    s_add_u32 m0, s44, 110400
    v_exp_f32 v17, v17
    v_mfma_f32_16x16x32_bf16 v[24:27], a[108:111], v[108:111], v[24:27]
    buffer_load_dwordx4 v7, s[28:31], s45 offen offset:2304 lds
    v_mfma_f32_16x16x32_bf16 v[28:31], a[112:115], v[96:99], v[56:59]
    v_exp_f32 v18, v18
    v_mfma_f32_16x16x32_bf16 v[28:31], a[116:119], v[100:103], v[28:31]
    ds_read_b64_tr_b16 a[178:179], v2 offset:448
    v_perm_b32 v32, v17, v16, s100
    v_mfma_f32_16x16x32_bf16 v[28:31], a[120:123], v[104:107], v[28:31]
    s_add_u32 m0, s44, 110304
    v_exp_f32 v19, v19
    v_mfma_f32_16x16x32_bf16 v[28:31], a[124:127], v[108:111], v[28:31]
    buffer_load_dwordx4 v7, s[28:31], s45 offen offset:3456 lds
    v_mfma_f32_16x16x32_bf16 v[160:163], a[192:195], v[40:43], v[160:163]
    v_exp_f32 v20, v20
    v_mfma_f32_16x16x32_bf16 v[160:163], a[196:199], v[44:47], v[160:163]
    ds_read_b64_tr_b16 a[180:181], v2 offset:704
    v_perm_b32 v33, v19, v18, s100
    v_mfma_f32_16x16x32_bf16 v[164:167], a[200:203], v[40:43], v[164:167]
    s_add_u32 m0, s44, 127488
    v_exp_f32 v21, v21
    v_mfma_f32_16x16x32_bf16 v[164:167], a[204:207], v[44:47], v[164:167]
    s_mov_b32 s45, 147584
    buffer_load_dwordx4 v7, s[28:31], s45 offen offset:0 lds
    v_mfma_f32_16x16x32_bf16 v[168:171], a[208:211], v[40:43], v[168:171]
    v_exp_f32 v22, v22
    v_mfma_f32_16x16x32_bf16 v[168:171], a[212:215], v[44:47], v[168:171]
    ds_read_b64_tr_b16 a[182:183], v2 offset:960
    v_perm_b32 v34, v21, v20, s100
    v_mfma_f32_16x16x32_bf16 v[172:175], a[216:219], v[40:43], v[172:175]
    s_add_u32 m0, s44, 127392
    v_exp_f32 v23, v23
    v_mfma_f32_16x16x32_bf16 v[172:175], a[220:223], v[44:47], v[172:175]
    buffer_load_dwordx4 v7, s[28:31], s45 offen offset:1152 lds
    v_mfma_f32_16x16x32_bf16 v[176:179], a[224:227], v[40:43], v[176:179]
    v_exp_f32 v24, v24
    v_mfma_f32_16x16x32_bf16 v[176:179], a[228:231], v[44:47], v[176:179]
    ds_read_b64_tr_b16 a[184:185], v2 offset:224
    v_perm_b32 v35, v23, v22, s100
    v_mfma_f32_16x16x32_bf16 v[180:183], a[232:235], v[40:43], v[180:183]
    s_add_u32 m0, s44, 127296
    v_exp_f32 v25, v25
    v_mfma_f32_16x16x32_bf16 v[180:183], a[236:239], v[44:47], v[180:183]
    buffer_load_dwordx4 v7, s[28:31], s45 offen offset:2304 lds
    v_mfma_f32_16x16x32_bf16 v[184:187], a[240:243], v[40:43], v[184:187]
    v_exp_f32 v26, v26
    v_mfma_f32_16x16x32_bf16 v[184:187], a[244:247], v[44:47], v[184:187]
    ds_read_b64_tr_b16 a[186:187], v2 offset:480
    v_perm_b32 v36, v25, v24, s100
    v_mfma_f32_16x16x32_bf16 v[188:191], a[248:251], v[40:43], v[188:191]
    s_add_u32 m0, s44, 127200
    v_exp_f32 v27, v27
    v_mfma_f32_16x16x32_bf16 v[188:191], a[252:255], v[44:47], v[188:191]
    buffer_load_dwordx4 v7, s[28:31], s45 offen offset:3456 lds
    v_smfmac_f32_16x16x64_bf16 a[4:7], a[16:19], v[40:47], v11
    ds_read_b64_tr_b16 a[188:189], v2 offset:736
    ds_read_b64_tr_b16 a[190:191], v2 offset:992
    v_mfma_f32_16x16x32_bf16 v[16:19], a[64:67], v[112:115], v[60:63]
    v_exp_f32 v28, v28
    v_mfma_f32_16x16x32_bf16 v[16:19], a[68:71], v[116:119], v[16:19]
    ds_read_b128 a[64:67], v1 offset:0
    v_perm_b32 v37, v27, v26, s100
    v_mfma_f32_16x16x32_bf16 v[16:19], a[72:75], v[120:123], v[16:19]
    v_exp_f32 v29, v29
    v_mfma_f32_16x16x32_bf16 v[16:19], a[76:79], v[124:127], v[16:19]
    ds_read_b128 a[68:71], v1 offset:64
    v_mfma_f32_16x16x32_bf16 v[20:23], a[80:83], v[112:115], v[60:63]
    v_exp_f32 v30, v30
    v_mfma_f32_16x16x32_bf16 v[20:23], a[84:87], v[116:119], v[20:23]
    ds_read_b128 a[72:75], v1 offset:128
    v_perm_b32 v38, v29, v28, s100
    v_mfma_f32_16x16x32_bf16 v[20:23], a[88:91], v[120:123], v[20:23]
    v_exp_f32 v31, v31
    v_mfma_f32_16x16x32_bf16 v[20:23], a[92:95], v[124:127], v[20:23]
    ds_read_b128 a[76:79], v1 offset:192
    v_mfma_f32_16x16x32_bf16 v[24:27], a[96:99], v[112:115], v[60:63]
    v_exp_f32 v16, v16
    v_mfma_f32_16x16x32_bf16 v[24:27], a[100:103], v[116:119], v[24:27]
    ds_read_b128 a[80:83], v1 offset:256
    v_perm_b32 v39, v31, v30, s100
    v_mfma_f32_16x16x32_bf16 v[24:27], a[104:107], v[120:123], v[24:27]
    v_exp_f32 v17, v17
    v_mfma_f32_16x16x32_bf16 v[24:27], a[108:111], v[124:127], v[24:27]
    ds_read_b128 a[84:87], v1 offset:320
    v_mfma_f32_16x16x32_bf16 v[28:31], a[112:115], v[112:115], v[60:63]
    v_exp_f32 v18, v18
    v_mfma_f32_16x16x32_bf16 v[28:31], a[116:119], v[116:119], v[28:31]
    ds_read_b128 a[88:91], v1 offset:384
    v_perm_b32 v40, v17, v16, s100
    v_mfma_f32_16x16x32_bf16 v[28:31], a[120:123], v[120:123], v[28:31]
    v_exp_f32 v19, v19
    v_mfma_f32_16x16x32_bf16 v[28:31], a[124:127], v[124:127], v[28:31]
    ds_read_b128 a[92:95], v1 offset:448
    v_mfma_f32_16x16x32_bf16 v[192:195], a[192:195], v[32:35], v[192:195]
    v_exp_f32 v20, v20
    v_mfma_f32_16x16x32_bf16 v[192:195], a[196:199], v[36:39], v[192:195]
    ds_read_b128 a[96:99], v1 offset:512
    v_perm_b32 v41, v19, v18, s100
    v_mfma_f32_16x16x32_bf16 v[196:199], a[200:203], v[32:35], v[196:199]
    v_exp_f32 v21, v21
    v_mfma_f32_16x16x32_bf16 v[196:199], a[204:207], v[36:39], v[196:199]
    ds_read_b128 a[100:103], v1 offset:576
    v_mfma_f32_16x16x32_bf16 v[200:203], a[208:211], v[32:35], v[200:203]
    v_exp_f32 v22, v22
    v_mfma_f32_16x16x32_bf16 v[200:203], a[212:215], v[36:39], v[200:203]
    ds_read_b128 a[104:107], v1 offset:640
    v_perm_b32 v42, v21, v20, s100
    v_mfma_f32_16x16x32_bf16 v[204:207], a[216:219], v[32:35], v[204:207]
    v_exp_f32 v23, v23
    v_mfma_f32_16x16x32_bf16 v[204:207], a[220:223], v[36:39], v[204:207]
    ds_read_b128 a[108:111], v1 offset:704
    v_mfma_f32_16x16x32_bf16 v[208:211], a[224:227], v[32:35], v[208:211]
    v_exp_f32 v24, v24
    v_mfma_f32_16x16x32_bf16 v[208:211], a[228:231], v[36:39], v[208:211]
    ds_read_b128 a[112:115], v1 offset:768
    v_perm_b32 v43, v23, v22, s100
    v_mfma_f32_16x16x32_bf16 v[212:215], a[232:235], v[32:35], v[212:215]
    v_exp_f32 v25, v25
    v_mfma_f32_16x16x32_bf16 v[212:215], a[236:239], v[36:39], v[212:215]
    ds_read_b128 a[116:119], v1 offset:832
    v_mfma_f32_16x16x32_bf16 v[216:219], a[240:243], v[32:35], v[216:219]
    v_exp_f32 v26, v26
    v_mfma_f32_16x16x32_bf16 v[216:219], a[244:247], v[36:39], v[216:219]
    ds_read_b128 a[120:123], v1 offset:896
    v_perm_b32 v44, v25, v24, s100
    v_mfma_f32_16x16x32_bf16 v[220:223], a[248:251], v[32:35], v[220:223]
    v_exp_f32 v27, v27
    v_mfma_f32_16x16x32_bf16 v[220:223], a[252:255], v[36:39], v[220:223]
    ds_read_b128 a[124:127], v1 offset:960
    v_smfmac_f32_16x16x64_bf16 a[8:11], a[16:19], v[32:39], v11
    s_waitcnt lgkmcnt(12)
    v_mfma_f32_16x16x32_bf16 v[16:19], a[64:67], v[64:67], v[48:51]
    v_exp_f32 v28, v28
    v_mfma_f32_16x16x32_bf16 v[16:19], a[68:71], v[68:71], v[16:19]
    v_perm_b32 v45, v27, v26, s100
    v_mfma_f32_16x16x32_bf16 v[16:19], a[72:75], v[72:75], v[16:19]
    s_mov_b32 s54, 737280
    v_exp_f32 v29, v29
    v_mfma_f32_16x16x32_bf16 v[16:19], a[76:79], v[76:79], v[16:19]
    s_waitcnt lgkmcnt(8)
    buffer_load_dwordx4 a[40:43], v6, s[64:67], s54 offen
    v_mfma_f32_16x16x32_bf16 v[20:23], a[80:83], v[64:67], v[48:51]
    v_exp_f32 v30, v30
    v_mfma_f32_16x16x32_bf16 v[20:23], a[84:87], v[68:71], v[20:23]
    v_perm_b32 v46, v29, v28, s100
    v_mfma_f32_16x16x32_bf16 v[20:23], a[88:91], v[72:75], v[20:23]
    v_exp_f32 v31, v31
    v_mfma_f32_16x16x32_bf16 v[20:23], a[92:95], v[76:79], v[20:23]
    s_waitcnt lgkmcnt(4)
    v_mfma_f32_16x16x32_bf16 v[24:27], a[96:99], v[64:67], v[48:51]
    v_exp_f32 v16, v16
    v_mfma_f32_16x16x32_bf16 v[24:27], a[100:103], v[68:71], v[24:27]
    v_perm_b32 v47, v31, v30, s100
    v_mfma_f32_16x16x32_bf16 v[24:27], a[104:107], v[72:75], v[24:27]
    v_exp_f32 v17, v17
    v_mfma_f32_16x16x32_bf16 v[24:27], a[108:111], v[76:79], v[24:27]
    s_waitcnt lgkmcnt(0)
    v_mfma_f32_16x16x32_bf16 v[28:31], a[112:115], v[64:67], v[48:51]
    v_exp_f32 v18, v18
    v_mfma_f32_16x16x32_bf16 v[28:31], a[116:119], v[68:71], v[28:31]
    v_perm_b32 v32, v17, v16, s100
    v_mfma_f32_16x16x32_bf16 v[28:31], a[120:123], v[72:75], v[28:31]
    s_mov_b32 s54, 884736
    v_exp_f32 v19, v19
    v_mfma_f32_16x16x32_bf16 v[28:31], a[124:127], v[76:79], v[28:31]
    buffer_load_dwordx4 a[44:47], v6, s[64:67], s54 offen
    v_mfma_f32_16x16x32_bf16 v[224:227], a[192:195], v[40:43], v[224:227]
    v_exp_f32 v20, v20
    v_mfma_f32_16x16x32_bf16 v[224:227], a[196:199], v[44:47], v[224:227]
    ds_read_b64_tr_b16 a[192:193], v2 offset:36864
    v_perm_b32 v33, v19, v18, s100
    v_mfma_f32_16x16x32_bf16 v[228:231], a[200:203], v[40:43], v[228:231]
    v_exp_f32 v21, v21
    v_mfma_f32_16x16x32_bf16 v[228:231], a[204:207], v[44:47], v[228:231]
    ds_read_b64_tr_b16 a[194:195], v2 offset:37120
    v_mfma_f32_16x16x32_bf16 v[232:235], a[208:211], v[40:43], v[232:235]
    v_exp_f32 v22, v22
    v_mfma_f32_16x16x32_bf16 v[232:235], a[212:215], v[44:47], v[232:235]
    ds_read_b64_tr_b16 a[196:197], v2 offset:37376
    v_perm_b32 v34, v21, v20, s100
    v_mfma_f32_16x16x32_bf16 v[236:239], a[216:219], v[40:43], v[236:239]
    v_exp_f32 v23, v23
    v_mfma_f32_16x16x32_bf16 v[236:239], a[220:223], v[44:47], v[236:239]
    ds_read_b64_tr_b16 a[198:199], v2 offset:37632
    v_mfma_f32_16x16x32_bf16 v[240:243], a[224:227], v[40:43], v[240:243]
    v_exp_f32 v24, v24
    v_mfma_f32_16x16x32_bf16 v[240:243], a[228:231], v[44:47], v[240:243]
    ds_read_b64_tr_b16 a[200:201], v2 offset:36896
    v_perm_b32 v35, v23, v22, s100
    v_mfma_f32_16x16x32_bf16 v[244:247], a[232:235], v[40:43], v[244:247]
    s_mov_b32 s54, 1032192
    v_exp_f32 v25, v25
    v_mfma_f32_16x16x32_bf16 v[244:247], a[236:239], v[44:47], v[244:247]
    buffer_load_dwordx4 a[48:51], v6, s[64:67], s54 offen
    v_mfma_f32_16x16x32_bf16 v[248:251], a[240:243], v[40:43], v[248:251]
    v_exp_f32 v26, v26
    v_mfma_f32_16x16x32_bf16 v[248:251], a[244:247], v[44:47], v[248:251]
    ds_read_b64_tr_b16 a[202:203], v2 offset:37152
    v_perm_b32 v36, v25, v24, s100
    v_mfma_f32_16x16x32_bf16 v[252:255], a[248:251], v[40:43], v[252:255]
    v_exp_f32 v27, v27
    v_mfma_f32_16x16x32_bf16 v[252:255], a[252:255], v[44:47], v[252:255]
    ds_read_b64_tr_b16 a[204:205], v2 offset:37408
    v_smfmac_f32_16x16x64_bf16 a[12:15], a[16:19], v[40:47], v11
    ds_read_b64_tr_b16 a[206:207], v2 offset:37664
    v_mfma_f32_16x16x32_bf16 v[16:19], a[64:67], v[80:83], v[52:55]
    v_exp_f32 v28, v28
    v_mfma_f32_16x16x32_bf16 v[16:19], a[68:71], v[84:87], v[16:19]
    ds_read_b64_tr_b16 a[208:209], v2 offset:36928
    v_perm_b32 v37, v27, v26, s100
    v_mfma_f32_16x16x32_bf16 v[16:19], a[72:75], v[88:91], v[16:19]
    v_exp_f32 v29, v29
    v_mfma_f32_16x16x32_bf16 v[16:19], a[76:79], v[92:95], v[16:19]
    ds_read_b64_tr_b16 a[210:211], v2 offset:37184
    v_mfma_f32_16x16x32_bf16 v[20:23], a[80:83], v[80:83], v[52:55]
    v_exp_f32 v30, v30
    v_mfma_f32_16x16x32_bf16 v[20:23], a[84:87], v[84:87], v[20:23]
    ds_read_b64_tr_b16 a[212:213], v2 offset:37440
    v_perm_b32 v38, v29, v28, s100
    v_mfma_f32_16x16x32_bf16 v[20:23], a[88:91], v[88:91], v[20:23]
    s_mov_b32 s54, 1179648
    v_exp_f32 v31, v31
    v_mfma_f32_16x16x32_bf16 v[20:23], a[92:95], v[92:95], v[20:23]
    buffer_load_dwordx4 a[52:55], v6, s[64:67], s54 offen
    v_mfma_f32_16x16x32_bf16 v[24:27], a[96:99], v[80:83], v[52:55]
    v_exp_f32 v16, v16
    v_mfma_f32_16x16x32_bf16 v[24:27], a[100:103], v[84:87], v[24:27]
    ds_read_b64_tr_b16 a[214:215], v2 offset:37696
    v_perm_b32 v39, v31, v30, s100
    v_mfma_f32_16x16x32_bf16 v[24:27], a[104:107], v[88:91], v[24:27]
    v_exp_f32 v17, v17
    v_mfma_f32_16x16x32_bf16 v[24:27], a[108:111], v[92:95], v[24:27]
    ds_read_b64_tr_b16 a[216:217], v2 offset:36960
    v_mfma_f32_16x16x32_bf16 v[28:31], a[112:115], v[80:83], v[52:55]
    v_exp_f32 v18, v18
    v_mfma_f32_16x16x32_bf16 v[28:31], a[116:119], v[84:87], v[28:31]
    ds_read_b64_tr_b16 a[218:219], v2 offset:37216
    v_perm_b32 v40, v17, v16, s100
    v_mfma_f32_16x16x32_bf16 v[28:31], a[120:123], v[88:91], v[28:31]
    v_exp_f32 v19, v19
    v_mfma_f32_16x16x32_bf16 v[28:31], a[124:127], v[92:95], v[28:31]
    ds_read_b64_tr_b16 a[220:221], v2 offset:37472
    v_mfma_f32_16x16x32_bf16 v[128:131], a[128:131], v[32:35], v[128:131]
    v_exp_f32 v20, v20
    v_mfma_f32_16x16x32_bf16 v[128:131], a[132:135], v[36:39], v[128:131]
    ds_read_b64_tr_b16 a[222:223], v2 offset:37728
    v_perm_b32 v41, v19, v18, s100
    v_mfma_f32_16x16x32_bf16 v[132:135], a[136:139], v[32:35], v[132:135]
    v_exp_f32 v21, v21
    v_mfma_f32_16x16x32_bf16 v[132:135], a[140:143], v[36:39], v[132:135]
    buffer_store_dwordx4 a[56:59], v5, s[32:35], 0 offen offset:0 sc1
    v_mfma_f32_16x16x32_bf16 v[136:139], a[144:147], v[32:35], v[136:139]
    v_exp_f32 v22, v22
    v_mfma_f32_16x16x32_bf16 v[136:139], a[148:151], v[36:39], v[136:139]
    ds_read_b64_tr_b16 a[224:225], v2 offset:36992
    v_perm_b32 v42, v21, v20, s100
    v_mfma_f32_16x16x32_bf16 v[140:143], a[152:155], v[32:35], v[140:143]
    v_exp_f32 v23, v23
    v_mfma_f32_16x16x32_bf16 v[140:143], a[156:159], v[36:39], v[140:143]
    ds_read_b64_tr_b16 a[226:227], v2 offset:37248
    v_mfma_f32_16x16x32_bf16 v[144:147], a[160:163], v[32:35], v[144:147]
    v_exp_f32 v24, v24
    v_mfma_f32_16x16x32_bf16 v[144:147], a[164:167], v[36:39], v[144:147]
    ds_read_b64_tr_b16 a[228:229], v2 offset:37504
    v_perm_b32 v43, v23, v22, s100
    v_mfma_f32_16x16x32_bf16 v[148:151], a[168:171], v[32:35], v[148:151]
    v_exp_f32 v25, v25
    v_mfma_f32_16x16x32_bf16 v[148:151], a[172:175], v[36:39], v[148:151]
    ds_read_b64_tr_b16 a[230:231], v2 offset:37760
    v_mfma_f32_16x16x32_bf16 v[152:155], a[176:179], v[32:35], v[152:155]
    v_exp_f32 v26, v26
    v_mfma_f32_16x16x32_bf16 v[152:155], a[180:183], v[36:39], v[152:155]
    ds_read_b64_tr_b16 a[232:233], v2 offset:37024
    v_perm_b32 v44, v25, v24, s100
    v_mfma_f32_16x16x32_bf16 v[156:159], a[184:187], v[32:35], v[156:159]
    v_exp_f32 v27, v27
    v_mfma_f32_16x16x32_bf16 v[156:159], a[188:191], v[36:39], v[156:159]
    buffer_store_dwordx4 a[56:59], v5, s[32:35], 0 offen offset:1024 sc1
    v_smfmac_f32_16x16x64_bf16 a[0:3], a[16:19], v[32:39], v11
    ds_read_b64_tr_b16 a[234:235], v2 offset:37280
    v_mfma_f32_16x16x32_bf16 v[16:19], a[64:67], v[96:99], v[56:59]
    v_exp_f32 v28, v28
    v_mfma_f32_16x16x32_bf16 v[16:19], a[68:71], v[100:103], v[16:19]
    ds_read_b64_tr_b16 a[236:237], v2 offset:37536
    v_perm_b32 v45, v27, v26, s100
    v_mfma_f32_16x16x32_bf16 v[16:19], a[72:75], v[104:107], v[16:19]
    v_exp_f32 v29, v29
    v_mfma_f32_16x16x32_bf16 v[16:19], a[76:79], v[108:111], v[16:19]
    ds_read_b64_tr_b16 a[238:239], v2 offset:37792
    v_mfma_f32_16x16x32_bf16 v[20:23], a[80:83], v[96:99], v[56:59]
    v_exp_f32 v30, v30
    v_mfma_f32_16x16x32_bf16 v[20:23], a[84:87], v[100:103], v[20:23]
    ds_read_b64_tr_b16 a[240:241], v2 offset:37056
    v_perm_b32 v46, v29, v28, s100
    v_mfma_f32_16x16x32_bf16 v[20:23], a[88:91], v[104:107], v[20:23]
    v_exp_f32 v31, v31
    v_mfma_f32_16x16x32_bf16 v[20:23], a[92:95], v[108:111], v[20:23]
    ds_read_b64_tr_b16 a[242:243], v2 offset:37312
    v_mfma_f32_16x16x32_bf16 v[24:27], a[96:99], v[96:99], v[56:59]
    v_exp_f32 v16, v16
    v_mfma_f32_16x16x32_bf16 v[24:27], a[100:103], v[100:103], v[24:27]
    ds_read_b64_tr_b16 a[244:245], v2 offset:37568
    v_perm_b32 v47, v31, v30, s100
    v_mfma_f32_16x16x32_bf16 v[24:27], a[104:107], v[104:107], v[24:27]
    v_exp_f32 v17, v17
    v_mfma_f32_16x16x32_bf16 v[24:27], a[108:111], v[108:111], v[24:27]
    buffer_store_dwordx4 a[56:59], v5, s[32:35], 0 offen offset:2048 sc1
    v_mfma_f32_16x16x32_bf16 v[28:31], a[112:115], v[96:99], v[56:59]
    v_exp_f32 v18, v18
    v_mfma_f32_16x16x32_bf16 v[28:31], a[116:119], v[100:103], v[28:31]
L2_pad9:
    s_cbranch_execz L2_pad13
    ds_read_b64_tr_b16 a[246:247], v2 offset:37824
    v_perm_b32 v32, v17, v16, s100
    v_mfma_f32_16x16x32_bf16 v[28:31], a[120:123], v[104:107], v[28:31]
    v_exp_f32 v19, v19
    v_mfma_f32_16x16x32_bf16 v[28:31], a[124:127], v[108:111], v[28:31]
    ds_read_b64_tr_b16 a[248:249], v2 offset:37088
    v_mfma_f32_16x16x32_bf16 v[160:163], a[128:131], v[40:43], v[160:163]
    v_exp_f32 v20, v20
    v_mfma_f32_16x16x32_bf16 v[160:163], a[132:135], v[44:47], v[160:163]
    ds_read_b64_tr_b16 a[250:251], v2 offset:37344
    v_perm_b32 v33, v19, v18, s100
    v_mfma_f32_16x16x32_bf16 v[164:167], a[136:139], v[40:43], v[164:167]
    v_exp_f32 v21, v21
    v_mfma_f32_16x16x32_bf16 v[164:167], a[140:143], v[44:47], v[164:167]
    ds_read_b64_tr_b16 a[252:253], v2 offset:37600
    v_mfma_f32_16x16x32_bf16 v[168:171], a[144:147], v[40:43], v[168:171]
    v_exp_f32 v22, v22
    v_mfma_f32_16x16x32_bf16 v[168:171], a[148:151], v[44:47], v[168:171]
    ds_read_b64_tr_b16 a[254:255], v2 offset:37856
    v_perm_b32 v34, v21, v20, s100
    v_mfma_f32_16x16x32_bf16 v[172:175], a[152:155], v[40:43], v[172:175]
    v_exp_f32 v23, v23
    v_mfma_f32_16x16x32_bf16 v[172:175], a[156:159], v[44:47], v[172:175]
    buffer_store_dwordx4 a[56:59], v5, s[32:35], 0 offen offset:3072 sc1
    v_mfma_f32_16x16x32_bf16 v[176:179], a[160:163], v[40:43], v[176:179]
    v_exp_f32 v24, v24
    v_mfma_f32_16x16x32_bf16 v[176:179], a[164:167], v[44:47], v[176:179]
    v_perm_b32 v35, v23, v22, s100
    v_mfma_f32_16x16x32_bf16 v[180:183], a[168:171], v[40:43], v[180:183]
    v_exp_f32 v25, v25
    v_mfma_f32_16x16x32_bf16 v[180:183], a[172:175], v[44:47], v[180:183]
    v_mfma_f32_16x16x32_bf16 v[184:187], a[176:179], v[40:43], v[184:187]
    v_exp_f32 v26, v26
    v_mfma_f32_16x16x32_bf16 v[184:187], a[180:183], v[44:47], v[184:187]
    v_perm_b32 v36, v25, v24, s100
    v_mfma_f32_16x16x32_bf16 v[188:191], a[184:187], v[40:43], v[188:191]
    v_exp_f32 v27, v27
    v_mfma_f32_16x16x32_bf16 v[188:191], a[188:191], v[44:47], v[188:191]
    v_smfmac_f32_16x16x64_bf16 a[4:7], a[16:19], v[40:47], v11
    v_mfma_f32_16x16x32_bf16 v[16:19], a[64:67], v[112:115], v[60:63]
    v_exp_f32 v28, v28
    v_mfma_f32_16x16x32_bf16 v[16:19], a[68:71], v[116:119], v[16:19]
    ds_read_b128 a[64:67], v1 offset:36864
    v_perm_b32 v37, v27, v26, s100
    v_mfma_f32_16x16x32_bf16 v[16:19], a[72:75], v[120:123], v[16:19]
    v_exp_f32 v29, v29
    v_mfma_f32_16x16x32_bf16 v[16:19], a[76:79], v[124:127], v[16:19]
    ds_read_b128 a[68:71], v1 offset:36928
    v_mfma_f32_16x16x32_bf16 v[20:23], a[80:83], v[112:115], v[60:63]
    v_exp_f32 v30, v30
    v_mfma_f32_16x16x32_bf16 v[20:23], a[84:87], v[116:119], v[20:23]
    ds_read_b128 a[72:75], v1 offset:36992
    v_perm_b32 v38, v29, v28, s100
    v_mfma_f32_16x16x32_bf16 v[20:23], a[88:91], v[120:123], v[20:23]
    v_exp_f32 v31, v31
    v_mfma_f32_16x16x32_bf16 v[20:23], a[92:95], v[124:127], v[20:23]
    ds_read_b128 a[76:79], v1 offset:37056
    v_mfma_f32_16x16x32_bf16 v[24:27], a[96:99], v[112:115], v[60:63]
    v_exp_f32 v16, v16
    v_mfma_f32_16x16x32_bf16 v[24:27], a[100:103], v[116:119], v[24:27]
    ds_read_b128 a[80:83], v1 offset:37120
    v_perm_b32 v39, v31, v30, s100
    v_mfma_f32_16x16x32_bf16 v[24:27], a[104:107], v[120:123], v[24:27]
    v_exp_f32 v17, v17
    v_mfma_f32_16x16x32_bf16 v[24:27], a[108:111], v[124:127], v[24:27]
    ds_read_b128 a[84:87], v1 offset:37184
    v_mfma_f32_16x16x32_bf16 v[28:31], a[112:115], v[112:115], v[60:63]
    v_exp_f32 v18, v18
    v_mfma_f32_16x16x32_bf16 v[28:31], a[116:119], v[116:119], v[28:31]
    ds_read_b128 a[88:91], v1 offset:37248
    v_perm_b32 v40, v17, v16, s100
    v_mfma_f32_16x16x32_bf16 v[28:31], a[120:123], v[120:123], v[28:31]
    v_exp_f32 v19, v19
    v_mfma_f32_16x16x32_bf16 v[28:31], a[124:127], v[124:127], v[28:31]
    ds_read_b128 a[92:95], v1 offset:37312
    v_mfma_f32_16x16x32_bf16 v[192:195], a[128:131], v[32:35], v[192:195]
    v_exp_f32 v20, v20
    v_mfma_f32_16x16x32_bf16 v[192:195], a[132:135], v[36:39], v[192:195]
    ds_read_b128 a[96:99], v1 offset:37376
    v_perm_b32 v41, v19, v18, s100
    v_mfma_f32_16x16x32_bf16 v[196:199], a[136:139], v[32:35], v[196:199]
    v_exp_f32 v21, v21
    v_mfma_f32_16x16x32_bf16 v[196:199], a[140:143], v[36:39], v[196:199]
    ds_read_b128 a[100:103], v1 offset:37440
    v_mfma_f32_16x16x32_bf16 v[200:203], a[144:147], v[32:35], v[200:203]
    v_exp_f32 v22, v22
    v_mfma_f32_16x16x32_bf16 v[200:203], a[148:151], v[36:39], v[200:203]
    ds_read_b128 a[104:107], v1 offset:37504
    v_perm_b32 v42, v21, v20, s100
    v_mfma_f32_16x16x32_bf16 v[204:207], a[152:155], v[32:35], v[204:207]
    v_exp_f32 v23, v23
    v_mfma_f32_16x16x32_bf16 v[204:207], a[156:159], v[36:39], v[204:207]
    ds_read_b128 a[108:111], v1 offset:37568
    v_mfma_f32_16x16x32_bf16 v[208:211], a[160:163], v[32:35], v[208:211]
    v_exp_f32 v24, v24
    v_mfma_f32_16x16x32_bf16 v[208:211], a[164:167], v[36:39], v[208:211]
    ds_read_b128 a[112:115], v1 offset:37632
    v_perm_b32 v43, v23, v22, s100
    v_mfma_f32_16x16x32_bf16 v[212:215], a[168:171], v[32:35], v[212:215]
    v_exp_f32 v25, v25
    v_mfma_f32_16x16x32_bf16 v[212:215], a[172:175], v[36:39], v[212:215]
    ds_read_b128 a[116:119], v1 offset:37696
    v_mfma_f32_16x16x32_bf16 v[216:219], a[176:179], v[32:35], v[216:219]
    v_exp_f32 v26, v26
    v_mfma_f32_16x16x32_bf16 v[216:219], a[180:183], v[36:39], v[216:219]
    ds_read_b128 a[120:123], v1 offset:37760
    v_perm_b32 v44, v25, v24, s100
    v_mfma_f32_16x16x32_bf16 v[220:223], a[184:187], v[32:35], v[220:223]
    v_exp_f32 v27, v27
    v_mfma_f32_16x16x32_bf16 v[220:223], a[188:191], v[36:39], v[220:223]
    ds_read_b128 a[124:127], v1 offset:37824
    v_smfmac_f32_16x16x64_bf16 a[8:11], a[16:19], v[32:39], v11
    s_waitcnt lgkmcnt(12)
    v_mfma_f32_16x16x32_bf16 v[16:19], a[64:67], v[64:67], v[48:51]
    v_exp_f32 v28, v28
    v_mfma_f32_16x16x32_bf16 v[16:19], a[68:71], v[68:71], v[16:19]
    v_perm_b32 v45, v27, v26, s100
    v_mfma_f32_16x16x32_bf16 v[16:19], a[72:75], v[72:75], v[16:19]
    v_exp_f32 v29, v29
    v_mfma_f32_16x16x32_bf16 v[16:19], a[76:79], v[76:79], v[16:19]
    s_waitcnt lgkmcnt(8)
    v_mfma_f32_16x16x32_bf16 v[20:23], a[80:83], v[64:67], v[48:51]
    v_exp_f32 v30, v30
    v_mfma_f32_16x16x32_bf16 v[20:23], a[84:87], v[68:71], v[20:23]
    v_perm_b32 v46, v29, v28, s100
    v_mfma_f32_16x16x32_bf16 v[20:23], a[88:91], v[72:75], v[20:23]
    v_exp_f32 v31, v31
    v_mfma_f32_16x16x32_bf16 v[20:23], a[92:95], v[76:79], v[20:23]
    s_waitcnt lgkmcnt(4)
    v_mfma_f32_16x16x32_bf16 v[24:27], a[96:99], v[64:67], v[48:51]
    v_exp_f32 v16, v16
    v_mfma_f32_16x16x32_bf16 v[24:27], a[100:103], v[68:71], v[24:27]
    v_perm_b32 v47, v31, v30, s100
    v_mfma_f32_16x16x32_bf16 v[24:27], a[104:107], v[72:75], v[24:27]
    v_exp_f32 v17, v17
    v_mfma_f32_16x16x32_bf16 v[24:27], a[108:111], v[76:79], v[24:27]
    s_waitcnt lgkmcnt(0)
    v_mfma_f32_16x16x32_bf16 v[28:31], a[112:115], v[64:67], v[48:51]
    v_exp_f32 v18, v18
    v_mfma_f32_16x16x32_bf16 v[28:31], a[116:119], v[68:71], v[28:31]
    v_perm_b32 v32, v17, v16, s100
    v_mfma_f32_16x16x32_bf16 v[28:31], a[120:123], v[72:75], v[28:31]
    v_exp_f32 v19, v19
    v_mfma_f32_16x16x32_bf16 v[28:31], a[124:127], v[76:79], v[28:31]
    s_waitcnt vmcnt(8)
    s_barrier
    v_mfma_f32_16x16x32_bf16 v[224:227], a[128:131], v[40:43], v[224:227]
    v_exp_f32 v20, v20
    v_mfma_f32_16x16x32_bf16 v[224:227], a[132:135], v[44:47], v[224:227]
    v_perm_b32 v33, v19, v18, s100
    v_mfma_f32_16x16x32_bf16 v[228:231], a[136:139], v[40:43], v[228:231]
    s_add_u32 m0, s44, 0
    v_exp_f32 v21, v21
    v_mfma_f32_16x16x32_bf16 v[228:231], a[140:143], v[44:47], v[228:231]
    s_mov_b32 s45, 256
    buffer_load_dwordx4 v7, s[28:31], s45 offen offset:0 lds
    v_mfma_f32_16x16x32_bf16 v[232:235], a[144:147], v[40:43], v[232:235]
    v_exp_f32 v22, v22
    v_mfma_f32_16x16x32_bf16 v[232:235], a[148:151], v[44:47], v[232:235]
    v_perm_b32 v34, v21, v20, s100
    v_mfma_f32_16x16x32_bf16 v[236:239], a[152:155], v[40:43], v[236:239]
    s_add_u32 m0, s44, -96
    v_exp_f32 v23, v23
    v_mfma_f32_16x16x32_bf16 v[236:239], a[156:159], v[44:47], v[236:239]
    buffer_load_dwordx4 v7, s[28:31], s45 offen offset:1152 lds
    v_mfma_f32_16x16x32_bf16 v[240:243], a[160:163], v[40:43], v[240:243]
    v_exp_f32 v24, v24
    v_mfma_f32_16x16x32_bf16 v[240:243], a[164:167], v[44:47], v[240:243]
    v_perm_b32 v35, v23, v22, s100
    v_mfma_f32_16x16x32_bf16 v[244:247], a[168:171], v[40:43], v[244:247]
    s_add_u32 m0, s44, -192
    v_exp_f32 v25, v25
    v_mfma_f32_16x16x32_bf16 v[244:247], a[172:175], v[44:47], v[244:247]
    buffer_load_dwordx4 v7, s[28:31], s45 offen offset:2304 lds
    v_mfma_f32_16x16x32_bf16 v[248:251], a[176:179], v[40:43], v[248:251]
    v_exp_f32 v26, v26
    v_mfma_f32_16x16x32_bf16 v[248:251], a[180:183], v[44:47], v[248:251]
    v_perm_b32 v36, v25, v24, s100
    v_mfma_f32_16x16x32_bf16 v[252:255], a[184:187], v[40:43], v[252:255]
    s_add_u32 m0, s44, -288
    v_exp_f32 v27, v27
    v_mfma_f32_16x16x32_bf16 v[252:255], a[188:191], v[44:47], v[252:255]
    buffer_load_dwordx4 v7, s[28:31], s45 offen offset:3456 lds
    v_smfmac_f32_16x16x64_bf16 a[12:15], a[16:19], v[40:47], v11
    v_mfma_f32_16x16x32_bf16 v[16:19], a[64:67], v[80:83], v[52:55]
    v_exp_f32 v28, v28
    v_mfma_f32_16x16x32_bf16 v[16:19], a[68:71], v[84:87], v[16:19]
    v_perm_b32 v37, v27, v26, s100
    v_mfma_f32_16x16x32_bf16 v[16:19], a[72:75], v[88:91], v[16:19]
    s_add_u32 m0, s44, 16896
    v_exp_f32 v29, v29
    v_mfma_f32_16x16x32_bf16 v[16:19], a[76:79], v[92:95], v[16:19]
    s_mov_b32 s45, 147712
    buffer_load_dwordx4 v7, s[28:31], s45 offen offset:0 lds
    v_mfma_f32_16x16x32_bf16 v[20:23], a[80:83], v[80:83], v[52:55]
    v_exp_f32 v30, v30
    v_mfma_f32_16x16x32_bf16 v[20:23], a[84:87], v[84:87], v[20:23]
    v_perm_b32 v38, v29, v28, s100
    v_mfma_f32_16x16x32_bf16 v[20:23], a[88:91], v[88:91], v[20:23]
    s_add_u32 m0, s44, 16800
    v_exp_f32 v31, v31
    v_mfma_f32_16x16x32_bf16 v[20:23], a[92:95], v[92:95], v[20:23]
    s_mov_b32 s15, 0x3f800000
    buffer_load_dwordx4 v7, s[28:31], s45 offen offset:1152 lds
    v_mfma_f32_16x16x32_bf16 v[24:27], a[96:99], v[80:83], v[52:55]
    v_exp_f32 v16, v16
    v_mfma_f32_16x16x32_bf16 v[24:27], a[100:103], v[84:87], v[24:27]
    v_perm_b32 v39, v31, v30, s100
    v_mfma_f32_16x16x32_bf16 v[24:27], a[104:107], v[88:91], v[24:27]
    s_add_u32 m0, s44, 16704
    v_exp_f32 v17, v17
    v_mfma_f32_16x16x32_bf16 v[24:27], a[108:111], v[92:95], v[24:27]
    buffer_load_dwordx4 v7, s[28:31], s45 offen offset:2304 lds
    v_mfma_f32_16x16x32_bf16 v[28:31], a[112:115], v[80:83], v[52:55]
    v_exp_f32 v18, v18
    v_mfma_f32_16x16x32_bf16 v[28:31], a[116:119], v[84:87], v[28:31]
    v_perm_b32 v40, v17, v16, s100
    v_mfma_f32_16x16x32_bf16 v[28:31], a[120:123], v[88:91], v[28:31]
    s_add_u32 m0, s44, 16608
    v_exp_f32 v19, v19
    v_mfma_f32_16x16x32_bf16 v[28:31], a[124:127], v[92:95], v[28:31]
    buffer_load_dwordx4 v7, s[28:31], s45 offen offset:3456 lds
    v_mfma_f32_16x16x32_bf16 v[128:131], a[192:195], v[32:35], v[128:131]
    v_exp_f32 v20, v20
    v_mfma_f32_16x16x32_bf16 v[128:131], a[196:199], v[36:39], v[128:131]
    v_perm_b32 v41, v19, v18, s100
    v_mfma_f32_16x16x32_bf16 v[132:135], a[200:203], v[32:35], v[132:135]
    s_mov_b32 s54, 0
    v_exp_f32 v21, v21
    v_mfma_f32_16x16x32_bf16 v[132:135], a[204:207], v[36:39], v[132:135]
    buffer_load_dwordx4 a[128:131], v6, s[68:71], s54 offen
    v_mfma_f32_16x16x32_bf16 v[136:139], a[208:211], v[32:35], v[136:139]
    v_exp_f32 v22, v22
    v_mfma_f32_16x16x32_bf16 v[136:139], a[212:215], v[36:39], v[136:139]
    v_perm_b32 v42, v21, v20, s100
    v_mfma_f32_16x16x32_bf16 v[140:143], a[216:219], v[32:35], v[140:143]
    s_add_u32 s54, s55, 0
    v_exp_f32 v23, v23
    v_mfma_f32_16x16x32_bf16 v[140:143], a[220:223], v[36:39], v[140:143]
    buffer_load_dwordx4 a[164:167], v8, s[72:75], s54 offen
    v_mfma_f32_16x16x32_bf16 v[144:147], a[224:227], v[32:35], v[144:147]
    v_exp_f32 v24, v24
    v_mfma_f32_16x16x32_bf16 v[144:147], a[228:231], v[36:39], v[144:147]
    v_perm_b32 v43, v23, v22, s100
    v_mfma_f32_16x16x32_bf16 v[148:151], a[232:235], v[32:35], v[148:151]
    s_mov_b32 s54, 147456
    v_exp_f32 v25, v25
    v_mfma_f32_16x16x32_bf16 v[148:151], a[236:239], v[36:39], v[148:151]
    buffer_load_dwordx4 a[132:135], v6, s[68:71], s54 offen
    v_mfma_f32_16x16x32_bf16 v[152:155], a[240:243], v[32:35], v[152:155]
    v_exp_f32 v26, v26
    v_mfma_f32_16x16x32_bf16 v[152:155], a[244:247], v[36:39], v[152:155]
    v_perm_b32 v44, v25, v24, s100
    v_mfma_f32_16x16x32_bf16 v[156:159], a[248:251], v[32:35], v[156:159]
    s_add_u32 s54, s55, 1024
    v_exp_f32 v27, v27
    v_mfma_f32_16x16x32_bf16 v[156:159], a[252:255], v[36:39], v[156:159]
    buffer_load_dwordx4 a[168:171], v8, s[72:75], s54 offen
    v_smfmac_f32_16x16x64_bf16 a[0:3], a[16:19], v[32:39], v11
    v_mfma_f32_16x16x32_bf16 v[16:19], a[64:67], v[96:99], v[56:59]
    v_exp_f32 v28, v28
    v_mfma_f32_16x16x32_bf16 v[16:19], a[68:71], v[100:103], v[16:19]
    v_perm_b32 v45, v27, v26, s100
    v_mfma_f32_16x16x32_bf16 v[16:19], a[72:75], v[104:107], v[16:19]
    s_mov_b32 s54, 294912
    v_exp_f32 v29, v29
    v_mfma_f32_16x16x32_bf16 v[16:19], a[76:79], v[108:111], v[16:19]
    buffer_load_dwordx4 a[136:139], v6, s[68:71], s54 offen
    v_mfma_f32_16x16x32_bf16 v[20:23], a[80:83], v[96:99], v[56:59]
    v_exp_f32 v30, v30
    v_mfma_f32_16x16x32_bf16 v[20:23], a[84:87], v[100:103], v[20:23]
    v_perm_b32 v46, v29, v28, s100
    v_accvgpr_read_b32 v12, a0
    v_mfma_f32_16x16x32_bf16 v[20:23], a[88:91], v[104:107], v[20:23]
    s_add_u32 s54, s55, 2048
    v_exp_f32 v31, v31
    v_mfma_f32_16x16x32_bf16 v[20:23], a[92:95], v[108:111], v[20:23]
    buffer_load_dwordx4 a[172:175], v8, s[72:75], s54 offen
    v_mfma_f32_16x16x32_bf16 v[24:27], a[96:99], v[96:99], v[56:59]
    v_exp_f32 v16, v16
    v_mfma_f32_16x16x32_bf16 v[24:27], a[100:103], v[100:103], v[24:27]
    v_perm_b32 v47, v31, v30, s100
    v_accvgpr_read_b32 v13, a1
    v_mfma_f32_16x16x32_bf16 v[24:27], a[104:107], v[104:107], v[24:27]
    s_mov_b32 s54, 442368
    v_exp_f32 v17, v17
    v_mfma_f32_16x16x32_bf16 v[24:27], a[108:111], v[108:111], v[24:27]
    buffer_load_dwordx4 a[140:143], v6, s[68:71], s54 offen
    v_mfma_f32_16x16x32_bf16 v[28:31], a[112:115], v[96:99], v[56:59]
    v_exp_f32 v18, v18
    v_mfma_f32_16x16x32_bf16 v[28:31], a[116:119], v[100:103], v[28:31]
    v_perm_b32 v32, v17, v16, s100
    v_add_f32 v12, v12, v13
    v_mfma_f32_16x16x32_bf16 v[28:31], a[120:123], v[104:107], v[28:31]
    s_add_u32 s54, s55, 3072
    v_exp_f32 v19, v19
    v_mfma_f32_16x16x32_bf16 v[28:31], a[124:127], v[108:111], v[28:31]
    buffer_load_dwordx4 a[176:179], v8, s[72:75], s54 offen
    v_mfma_f32_16x16x32_bf16 v[160:163], a[192:195], v[40:43], v[160:163]
    v_exp_f32 v20, v20
    v_mfma_f32_16x16x32_bf16 v[160:163], a[196:199], v[44:47], v[160:163]
    v_perm_b32 v33, v19, v18, s100
    v_subrev_u32 v13, 0x1e000000, v12
    v_mfma_f32_16x16x32_bf16 v[164:167], a[200:203], v[40:43], v[164:167]
    s_mov_b32 s54, 589824
    v_exp_f32 v21, v21
    v_mfma_f32_16x16x32_bf16 v[164:167], a[204:207], v[44:47], v[164:167]
    buffer_load_dwordx4 a[144:147], v6, s[68:71], s54 offen
    v_mfma_f32_16x16x32_bf16 v[168:171], a[208:211], v[40:43], v[168:171]
    v_exp_f32 v22, v22
    v_mfma_f32_16x16x32_bf16 v[168:171], a[212:215], v[44:47], v[168:171]
    v_perm_b32 v34, v21, v20, s100
    v_cmp_gt_u32 s[56:57], v13, s15
    v_mfma_f32_16x16x32_bf16 v[172:175], a[216:219], v[40:43], v[172:175]
    s_add_u32 s54, s55, 4096
    v_exp_f32 v23, v23
    v_mfma_f32_16x16x32_bf16 v[172:175], a[220:223], v[44:47], v[172:175]
    buffer_load_dwordx4 a[180:183], v8, s[72:75], s54 offen
    v_mfma_f32_16x16x32_bf16 v[176:179], a[224:227], v[40:43], v[176:179]
    v_exp_f32 v24, v24
    v_mfma_f32_16x16x32_bf16 v[176:179], a[228:231], v[44:47], v[176:179]
    v_perm_b32 v35, v23, v22, s100
    v_mfma_f32_16x16x32_bf16 v[180:183], a[232:235], v[40:43], v[180:183]
    s_mov_b32 s54, 737280
    v_exp_f32 v25, v25
    v_mfma_f32_16x16x32_bf16 v[180:183], a[236:239], v[44:47], v[180:183]
    buffer_load_dwordx4 a[148:151], v6, s[68:71], s54 offen
    v_mfma_f32_16x16x32_bf16 v[184:187], a[240:243], v[40:43], v[184:187]
    v_exp_f32 v26, v26
    v_mfma_f32_16x16x32_bf16 v[184:187], a[244:247], v[44:47], v[184:187]
    v_perm_b32 v36, v25, v24, s100
    v_mfma_f32_16x16x32_bf16 v[188:191], a[248:251], v[40:43], v[188:191]
    s_add_u32 s54, s55, 5120
    v_exp_f32 v27, v27
    v_mfma_f32_16x16x32_bf16 v[188:191], a[252:255], v[44:47], v[188:191]
    buffer_load_dwordx4 a[184:187], v8, s[72:75], s54 offen
    v_smfmac_f32_16x16x64_bf16 a[4:7], a[16:19], v[40:47], v11
    v_rcp_f32 v12, v12
    v_mfma_f32_16x16x32_bf16 v[16:19], a[64:67], v[112:115], v[60:63]
    v_exp_f32 v28, v28
    v_mfma_f32_16x16x32_bf16 v[16:19], a[68:71], v[116:119], v[16:19]
    v_perm_b32 v37, v27, v26, s100
    v_mul_f32 v128, v128, v12
    v_mfma_f32_16x16x32_bf16 v[16:19], a[72:75], v[120:123], v[16:19]
    s_mov_b32 s54, 884736
    v_exp_f32 v29, v29
    v_mfma_f32_16x16x32_bf16 v[16:19], a[76:79], v[124:127], v[16:19]
    buffer_load_dwordx4 a[152:155], v6, s[68:71], s54 offen
    v_mfma_f32_16x16x32_bf16 v[20:23], a[80:83], v[112:115], v[60:63]
    v_exp_f32 v30, v30
    v_mfma_f32_16x16x32_bf16 v[20:23], a[84:87], v[116:119], v[20:23]
    v_perm_b32 v38, v29, v28, s100
    v_mul_f32 v129, v129, v12
    v_mfma_f32_16x16x32_bf16 v[20:23], a[88:91], v[120:123], v[20:23]
    s_add_u32 s54, s55, 6144
    v_exp_f32 v31, v31
    v_mfma_f32_16x16x32_bf16 v[20:23], a[92:95], v[124:127], v[20:23]
    buffer_load_dwordx4 a[188:191], v8, s[72:75], s54 offen
    v_mfma_f32_16x16x32_bf16 v[24:27], a[96:99], v[112:115], v[60:63]
    v_exp_f32 v16, v16
    v_mfma_f32_16x16x32_bf16 v[24:27], a[100:103], v[116:119], v[24:27]
    v_perm_b32 v39, v31, v30, s100
    v_mul_f32 v130, v130, v12
    v_mfma_f32_16x16x32_bf16 v[24:27], a[104:107], v[120:123], v[24:27]
    s_mov_b32 s54, 1032192
    v_exp_f32 v17, v17
    v_mfma_f32_16x16x32_bf16 v[24:27], a[108:111], v[124:127], v[24:27]
    buffer_load_dwordx4 a[156:159], v6, s[68:71], s54 offen
    v_mfma_f32_16x16x32_bf16 v[28:31], a[112:115], v[112:115], v[60:63]
    v_exp_f32 v18, v18
    v_mfma_f32_16x16x32_bf16 v[28:31], a[116:119], v[116:119], v[28:31]
    v_perm_b32 v40, v17, v16, s100
    v_mul_f32 v131, v131, v12
    v_mfma_f32_16x16x32_bf16 v[28:31], a[120:123], v[120:123], v[28:31]
    s_mov_b32 s54, 1179648
    v_exp_f32 v19, v19
    v_mfma_f32_16x16x32_bf16 v[28:31], a[124:127], v[124:127], v[28:31]
    buffer_load_dwordx4 a[160:163], v6, s[68:71], s54 offen
    v_mfma_f32_16x16x32_bf16 v[192:195], a[192:195], v[32:35], v[192:195]
    v_exp_f32 v20, v20
    v_mfma_f32_16x16x32_bf16 v[192:195], a[196:199], v[36:39], v[192:195]
    v_perm_b32 v41, v19, v18, s100
    v_mul_f32 v132, v132, v12
    v_mfma_f32_16x16x32_bf16 v[196:199], a[200:203], v[32:35], v[196:199]
    v_exp_f32 v21, v21
    v_mfma_f32_16x16x32_bf16 v[196:199], a[204:207], v[36:39], v[196:199]
    v_mul_f32 v133, v133, v12
    v_mul_f32 v134, v134, v12
    v_mfma_f32_16x16x32_bf16 v[200:203], a[208:211], v[32:35], v[200:203]
    v_exp_f32 v22, v22
    v_mfma_f32_16x16x32_bf16 v[200:203], a[212:215], v[36:39], v[200:203]
    v_perm_b32 v42, v21, v20, s100
    v_mul_f32 v135, v135, v12
    v_mfma_f32_16x16x32_bf16 v[204:207], a[216:219], v[32:35], v[204:207]
    v_exp_f32 v23, v23
    v_mfma_f32_16x16x32_bf16 v[204:207], a[220:223], v[36:39], v[204:207]
    v_cvt_pk_bf16_f32 v128, v128, v129
    v_cvt_pk_bf16_f32 v129, v130, v131
    v_mfma_f32_16x16x32_bf16 v[208:211], a[224:227], v[32:35], v[208:211]
    v_exp_f32 v24, v24
    v_mfma_f32_16x16x32_bf16 v[208:211], a[228:231], v[36:39], v[208:211]
    v_perm_b32 v43, v23, v22, s100
    v_cvt_pk_bf16_f32 v130, v132, v133
    v_mfma_f32_16x16x32_bf16 v[212:215], a[232:235], v[32:35], v[212:215]
    v_exp_f32 v25, v25
    v_mfma_f32_16x16x32_bf16 v[212:215], a[236:239], v[36:39], v[212:215]
    v_cvt_pk_bf16_f32 v131, v134, v135
    v_mul_f32 v136, v136, v12
    v_mfma_f32_16x16x32_bf16 v[216:219], a[240:243], v[32:35], v[216:219]
    v_exp_f32 v26, v26
    v_mfma_f32_16x16x32_bf16 v[216:219], a[244:247], v[36:39], v[216:219]
    v_perm_b32 v44, v25, v24, s100
    v_mul_f32 v137, v137, v12
    v_mfma_f32_16x16x32_bf16 v[220:223], a[248:251], v[32:35], v[220:223]
    v_exp_f32 v27, v27
    v_mfma_f32_16x16x32_bf16 v[220:223], a[252:255], v[36:39], v[220:223]
    v_mul_f32 v138, v138, v12
    v_mul_f32 v139, v139, v12
    v_smfmac_f32_16x16x64_bf16 a[8:11], a[16:19], v[32:39], v11
    v_mul_f32 v140, v140, v12
    v_mul_f32 v141, v141, v12
    v_exp_f32 v28, v28
    s_nop 0
    v_perm_b32 v45, v27, v26, s100
    v_exp_f32 v29, v29
    s_nop 0
    v_exp_f32 v30, v30
    s_nop 0
    v_perm_b32 v46, v29, v28, s100
    v_exp_f32 v31, v31
    s_nop 0
    v_perm_b32 v47, v31, v30, s100
    s_nop 1
    v_mfma_f32_16x16x32_bf16 v[224:227], a[192:195], v[40:43], v[224:227]
    v_mul_f32 v142, v142, v12
    v_mul_f32 v143, v143, v12
    v_mfma_f32_16x16x32_bf16 v[224:227], a[196:199], v[44:47], v[224:227]
    ds_read_b64_tr_b16 a[64:65], v4 offset:0
    ds_read_b64_tr_b16 a[66:67], v4 offset:128
    v_mfma_f32_16x16x32_bf16 v[228:231], a[200:203], v[40:43], v[228:231]
    ds_read_b64_tr_b16 a[68:69], v4 offset:256
    ds_read_b64_tr_b16 a[70:71], v4 offset:384
    v_mfma_f32_16x16x32_bf16 v[228:231], a[204:207], v[44:47], v[228:231]
    ds_read_b64_tr_b16 a[72:73], v4 offset:512
    ds_read_b64_tr_b16 a[74:75], v4 offset:640
    v_mfma_f32_16x16x32_bf16 v[232:235], a[208:211], v[40:43], v[232:235]
    ds_read_b64_tr_b16 a[76:77], v4 offset:768
    ds_read_b64_tr_b16 a[78:79], v4 offset:896
    v_mfma_f32_16x16x32_bf16 v[232:235], a[212:215], v[44:47], v[232:235]
    ds_read_b64_tr_b16 a[80:81], v4 offset:16896
    ds_read_b64_tr_b16 a[82:83], v4 offset:17024
    v_mfma_f32_16x16x32_bf16 v[236:239], a[216:219], v[40:43], v[236:239]
    ds_read_b64_tr_b16 a[84:85], v4 offset:17152
    ds_read_b64_tr_b16 a[86:87], v4 offset:17280
    v_mfma_f32_16x16x32_bf16 v[236:239], a[220:223], v[44:47], v[236:239]
    ds_read_b64_tr_b16 a[88:89], v4 offset:17408
    ds_read_b64_tr_b16 a[90:91], v4 offset:17536
    v_mfma_f32_16x16x32_bf16 v[240:243], a[224:227], v[40:43], v[240:243]
    ds_read_b64_tr_b16 a[92:93], v4 offset:17664
    ds_read_b64_tr_b16 a[94:95], v4 offset:17792
    v_mfma_f32_16x16x32_bf16 v[240:243], a[228:231], v[44:47], v[240:243]
    v_cvt_pk_bf16_f32 v136, v136, v137
    v_cvt_pk_bf16_f32 v137, v138, v139
    v_mfma_f32_16x16x32_bf16 v[244:247], a[232:235], v[40:43], v[244:247]
    v_cvt_pk_bf16_f32 v138, v140, v141
    v_cvt_pk_bf16_f32 v139, v142, v143
    v_mfma_f32_16x16x32_bf16 v[244:247], a[236:239], v[44:47], v[244:247]
    v_mul_f32 v144, v144, v12
    v_mul_f32 v145, v145, v12
    v_mfma_f32_16x16x32_bf16 v[248:251], a[240:243], v[40:43], v[248:251]
    v_mul_f32 v146, v146, v12
    v_mul_f32 v147, v147, v12
    v_mfma_f32_16x16x32_bf16 v[248:251], a[244:247], v[44:47], v[248:251]
    v_mul_f32 v148, v148, v12
    v_mul_f32 v149, v149, v12
    v_mfma_f32_16x16x32_bf16 v[252:255], a[248:251], v[40:43], v[252:255]
    v_mul_f32 v150, v150, v12
    v_mul_f32 v151, v151, v12
    v_mfma_f32_16x16x32_bf16 v[252:255], a[252:255], v[44:47], v[252:255]
    v_cvt_pk_bf16_f32 v144, v144, v145
    v_cvt_pk_bf16_f32 v145, v146, v147
    v_smfmac_f32_16x16x64_bf16 a[12:15], a[16:19], v[40:47], v11
    v_cvt_pk_bf16_f32 v146, v148, v149
    v_cvt_pk_bf16_f32 v147, v150, v151
    v_mul_f32 v152, v152, v12
    v_mul_f32 v153, v153, v12
    v_mul_f32 v154, v154, v12
    v_mul_f32 v155, v155, v12
    v_mul_f32 v156, v156, v12
    v_mul_f32 v157, v157, v12
    v_mul_f32 v158, v158, v12
    v_mul_f32 v159, v159, v12
    v_cvt_pk_bf16_f32 v152, v152, v153
    v_cvt_pk_bf16_f32 v153, v154, v155
    v_cvt_pk_bf16_f32 v154, v156, v157
    v_cvt_pk_bf16_f32 v155, v158, v159
    v_accvgpr_read_b32 v14, a4
    v_accvgpr_read_b32 v15, a5
    v_add_f32 v14, v14, v15
    v_subrev_u32 v15, 0x1e000000, v14
    v_cmp_gt_u32 s[58:59], v15, s15
    v_rcp_f32 v14, v14
    v_accvgpr_read_b32 v12, a8
    v_accvgpr_read_b32 v13, a9
    v_add_f32 v12, v12, v13
    v_subrev_u32 v13, 0x1e000000, v12
    v_cmp_gt_u32 s[60:61], v13, s15
    v_rcp_f32 v12, v12
    v_pk_mul_f32 v[160:161], v[160:161], v[14:15] op_sel_hi:[1,0]
    v_pk_mul_f32 v[162:163], v[162:163], v[14:15] op_sel_hi:[1,0]
    v_pk_mul_f32 v[164:165], v[164:165], v[14:15] op_sel_hi:[1,0]
    v_pk_mul_f32 v[166:167], v[166:167], v[14:15] op_sel_hi:[1,0]
    v_cvt_pk_bf16_f32 v160, v160, v161
    v_cvt_pk_bf16_f32 v161, v162, v163
    v_cvt_pk_bf16_f32 v162, v164, v165
    v_cvt_pk_bf16_f32 v163, v166, v167
    v_pk_mul_f32 v[168:169], v[168:169], v[14:15] op_sel_hi:[1,0]
    v_pk_mul_f32 v[170:171], v[170:171], v[14:15] op_sel_hi:[1,0]
    v_pk_mul_f32 v[172:173], v[172:173], v[14:15] op_sel_hi:[1,0]
    v_pk_mul_f32 v[174:175], v[174:175], v[14:15] op_sel_hi:[1,0]
    v_cvt_pk_bf16_f32 v168, v168, v169
    v_cvt_pk_bf16_f32 v169, v170, v171
    v_cvt_pk_bf16_f32 v170, v172, v173
    v_cvt_pk_bf16_f32 v171, v174, v175
    v_pk_mul_f32 v[176:177], v[176:177], v[14:15] op_sel_hi:[1,0]
    v_pk_mul_f32 v[178:179], v[178:179], v[14:15] op_sel_hi:[1,0]
    v_pk_mul_f32 v[180:181], v[180:181], v[14:15] op_sel_hi:[1,0]
    v_pk_mul_f32 v[182:183], v[182:183], v[14:15] op_sel_hi:[1,0]
    v_cvt_pk_bf16_f32 v176, v176, v177
    v_cvt_pk_bf16_f32 v177, v178, v179
    v_cvt_pk_bf16_f32 v178, v180, v181
    v_cvt_pk_bf16_f32 v179, v182, v183
    v_pk_mul_f32 v[184:185], v[184:185], v[14:15] op_sel_hi:[1,0]
    v_pk_mul_f32 v[186:187], v[186:187], v[14:15] op_sel_hi:[1,0]
    v_pk_mul_f32 v[188:189], v[188:189], v[14:15] op_sel_hi:[1,0]
    v_pk_mul_f32 v[190:191], v[190:191], v[14:15] op_sel_hi:[1,0]
    v_cvt_pk_bf16_f32 v184, v184, v185
    v_cvt_pk_bf16_f32 v185, v186, v187
    v_cvt_pk_bf16_f32 v186, v188, v189
    v_cvt_pk_bf16_f32 v187, v190, v191
    v_accvgpr_read_b32 v14, a12
    v_accvgpr_read_b32 v15, a13
    v_add_f32 v14, v14, v15
    v_subrev_u32 v15, 0x1e000000, v14
    v_cmp_gt_u32 s[62:63], v15, s15
    s_or_b64 s[56:57], s[56:57], s[58:59]
    v_rcp_f32 v14, v14
    s_or_b64 s[60:61], s[60:61], s[62:63]
    s_or_b64 s[56:57], s[56:57], s[60:61]
    s_lshl2_add_u32 s14, s51, 13824
    v_mov_b32 v57, s14
    v_mov_b32 v58, 13824
    v_pk_mul_f32 v[192:193], v[192:193], v[12:13] op_sel_hi:[1,0]
    v_pk_mul_f32 v[194:195], v[194:195], v[12:13] op_sel_hi:[1,0]
    v_pk_mul_f32 v[196:197], v[196:197], v[12:13] op_sel_hi:[1,0]
    v_pk_mul_f32 v[198:199], v[198:199], v[12:13] op_sel_hi:[1,0]
    v_cvt_pk_bf16_f32 v192, v192, v193
    v_cvt_pk_bf16_f32 v193, v194, v195
    v_cvt_pk_bf16_f32 v194, v196, v197
    v_cvt_pk_bf16_f32 v195, v198, v199
    v_pk_mul_f32 v[200:201], v[200:201], v[12:13] op_sel_hi:[1,0]
    v_pk_mul_f32 v[202:203], v[202:203], v[12:13] op_sel_hi:[1,0]
    v_pk_mul_f32 v[204:205], v[204:205], v[12:13] op_sel_hi:[1,0]
    v_pk_mul_f32 v[206:207], v[206:207], v[12:13] op_sel_hi:[1,0]
    v_cvt_pk_bf16_f32 v200, v200, v201
    v_cvt_pk_bf16_f32 v201, v202, v203
    v_cvt_pk_bf16_f32 v202, v204, v205
    v_cvt_pk_bf16_f32 v203, v206, v207
    v_pk_mul_f32 v[208:209], v[208:209], v[12:13] op_sel_hi:[1,0]
    v_pk_mul_f32 v[210:211], v[210:211], v[12:13] op_sel_hi:[1,0]
    v_pk_mul_f32 v[212:213], v[212:213], v[12:13] op_sel_hi:[1,0]
    v_pk_mul_f32 v[214:215], v[214:215], v[12:13] op_sel_hi:[1,0]
    v_cvt_pk_bf16_f32 v208, v208, v209
    v_cvt_pk_bf16_f32 v209, v210, v211
    v_cvt_pk_bf16_f32 v210, v212, v213
    v_cvt_pk_bf16_f32 v211, v214, v215
    v_pk_mul_f32 v[216:217], v[216:217], v[12:13] op_sel_hi:[1,0]
    v_pk_mul_f32 v[218:219], v[218:219], v[12:13] op_sel_hi:[1,0]
    v_pk_mul_f32 v[220:221], v[220:221], v[12:13] op_sel_hi:[1,0]
    v_pk_mul_f32 v[222:223], v[222:223], v[12:13] op_sel_hi:[1,0]
    v_cvt_pk_bf16_f32 v216, v216, v217
    v_cvt_pk_bf16_f32 v217, v218, v219
    v_cvt_pk_bf16_f32 v218, v220, v221
    v_cvt_pk_bf16_f32 v219, v222, v223
    v_pk_mul_f32 v[224:225], v[224:225], v[14:15] op_sel_hi:[1,0]
    v_pk_mul_f32 v[226:227], v[226:227], v[14:15] op_sel_hi:[1,0]
    v_pk_mul_f32 v[228:229], v[228:229], v[14:15] op_sel_hi:[1,0]
    v_pk_mul_f32 v[230:231], v[230:231], v[14:15] op_sel_hi:[1,0]
    v_cvt_pk_bf16_f32 v224, v224, v225
    v_cvt_pk_bf16_f32 v225, v226, v227
    v_cvt_pk_bf16_f32 v226, v228, v229
    v_cvt_pk_bf16_f32 v227, v230, v231
    v_pk_mul_f32 v[232:233], v[232:233], v[14:15] op_sel_hi:[1,0]
    v_pk_mul_f32 v[234:235], v[234:235], v[14:15] op_sel_hi:[1,0]
L2_pad10:
    s_cbranch_execz L2_pad14
    v_pk_mul_f32 v[236:237], v[236:237], v[14:15] op_sel_hi:[1,0]
    v_pk_mul_f32 v[238:239], v[238:239], v[14:15] op_sel_hi:[1,0]
    v_cvt_pk_bf16_f32 v232, v232, v233
    v_cvt_pk_bf16_f32 v233, v234, v235
    v_cvt_pk_bf16_f32 v234, v236, v237
    v_cvt_pk_bf16_f32 v235, v238, v239
    v_pk_mul_f32 v[240:241], v[240:241], v[14:15] op_sel_hi:[1,0]
    v_pk_mul_f32 v[242:243], v[242:243], v[14:15] op_sel_hi:[1,0]
    v_pk_mul_f32 v[244:245], v[244:245], v[14:15] op_sel_hi:[1,0]
    v_pk_mul_f32 v[246:247], v[246:247], v[14:15] op_sel_hi:[1,0]
    v_cvt_pk_bf16_f32 v240, v240, v241
    v_cvt_pk_bf16_f32 v241, v242, v243
    v_cvt_pk_bf16_f32 v242, v244, v245
    v_cvt_pk_bf16_f32 v243, v246, v247
    v_pk_mul_f32 v[248:249], v[248:249], v[14:15] op_sel_hi:[1,0]
    v_pk_mul_f32 v[250:251], v[250:251], v[14:15] op_sel_hi:[1,0]
    v_pk_mul_f32 v[252:253], v[252:253], v[14:15] op_sel_hi:[1,0]
    v_pk_mul_f32 v[254:255], v[254:255], v[14:15] op_sel_hi:[1,0]
    v_cvt_pk_bf16_f32 v248, v248, v249
    v_cvt_pk_bf16_f32 v249, v250, v251
    v_cvt_pk_bf16_f32 v250, v252, v253
    v_cvt_pk_bf16_f32 v251, v254, v255
    s_waitcnt lgkmcnt(12)
    v_mfma_f32_16x16x32_bf16 v[16:19], a[64:67], v[128:131], 0
    ds_read_b64_tr_b16 a[96:97], v4 offset:32
    ds_read_b64_tr_b16 a[98:99], v4 offset:160
    v_mfma_f32_16x16x32_bf16 v[16:19], a[68:71], v[136:139], v[16:19]
    s_waitcnt lgkmcnt(10)
    ds_read_b64_tr_b16 a[100:101], v4 offset:288
    ds_read_b64_tr_b16 a[102:103], v4 offset:416
    v_mfma_f32_16x16x32_bf16 v[16:19], a[72:75], v[144:147], v[16:19]
    s_add_u32 s54, s55, 7168
    s_cmp_lg_u64 s[56:57], 0
    s_cselect_b32 s3, 1, 0
    ds_read_b64_tr_b16 a[104:105], v4 offset:544
    v_mfma_f32_16x16x32_bf16 v[16:19], a[76:79], v[152:155], v[16:19]
    s_waitcnt lgkmcnt(9)
    buffer_load_dwordx4 a[192:195], v8, s[72:75], s54 offen
    v_mfma_f32_16x16x32_bf16 v[16:19], a[80:83], v[192:195], v[16:19]
    s_andn2_b32 s3, s3, s50
    ds_read_b64_tr_b16 a[106:107], v4 offset:672
    v_mfma_f32_16x16x32_bf16 v[16:19], a[84:87], v[200:203], v[16:19]
    s_waitcnt lgkmcnt(6)
    ds_read_b64_tr_b16 a[108:109], v4 offset:800
    v_mfma_f32_16x16x32_bf16 v[16:19], a[88:91], v[208:211], v[16:19]
    s_add_u32 s54, s55, 8192
    ds_read_b64_tr_b16 a[110:111], v4 offset:928
    v_mfma_f32_16x16x32_bf16 v[16:19], a[92:95], v[216:219], v[16:19]
    buffer_load_dwordx4 a[196:199], v8, s[72:75], s54 offen
    v_mfma_f32_16x16x32_bf16 v[20:23], a[64:67], v[160:163], 0
    ds_read_b64_tr_b16 a[112:113], v4 offset:16928
    v_mfma_f32_16x16x32_bf16 v[20:23], a[68:71], v[168:171], v[20:23]
    ds_read_b64_tr_b16 a[114:115], v4 offset:17056
    v_mov_b32 v56, s3
    v_mfma_f32_16x16x32_bf16 v[20:23], a[72:75], v[176:179], v[20:23]
    ds_read_b64_tr_b16 a[116:117], v4 offset:17184
    v_mfma_f32_16x16x32_bf16 v[20:23], a[76:79], v[184:187], v[20:23]
    ds_read_b64_tr_b16 a[118:119], v4 offset:17312
    v_mfma_f32_16x16x32_bf16 v[20:23], a[80:83], v[224:227], v[20:23]
    ds_read_b64_tr_b16 a[120:121], v4 offset:17440
    v_mfma_f32_16x16x32_bf16 v[20:23], a[84:87], v[232:235], v[20:23]
    ds_read_b64_tr_b16 a[122:123], v4 offset:17568
    v_mfma_f32_16x16x32_bf16 v[20:23], a[88:91], v[240:243], v[20:23]
    ds_read_b64_tr_b16 a[124:125], v4 offset:17696
    v_mfma_f32_16x16x32_bf16 v[20:23], a[92:95], v[248:251], v[20:23]
    s_waitcnt lgkmcnt(11)
    ds_read_b64_tr_b16 a[126:127], v4 offset:17824
    ds_write_b32 v57, v56
    v_mfma_f32_16x16x32_bf16 v[24:27], a[96:99], v[128:131], 0
    ds_read_b64_tr_b16 a[64:65], v4 offset:64
    v_mfma_f32_16x16x32_bf16 v[24:27], a[100:103], v[136:139], v[24:27]
    s_waitcnt lgkmcnt(10)
    ds_read_b64_tr_b16 a[66:67], v4 offset:192
    v_mfma_f32_16x16x32_bf16 v[24:27], a[104:107], v[144:147], v[24:27]
    ds_read_b64_tr_b16 a[68:69], v4 offset:320
    v_mfma_f32_16x16x32_bf16 v[24:27], a[108:111], v[152:155], v[24:27]
    s_waitcnt lgkmcnt(8)
    ds_read_b64_tr_b16 a[70:71], v4 offset:448
    v_mfma_f32_16x16x32_bf16 v[24:27], a[112:115], v[192:195], v[24:27]
    ds_read_b64_tr_b16 a[72:73], v4 offset:576
    v_mfma_f32_16x16x32_bf16 v[24:27], a[116:119], v[200:203], v[24:27]
    s_waitcnt lgkmcnt(6)
    ds_read_b64_tr_b16 a[74:75], v4 offset:704
    v_mfma_f32_16x16x32_bf16 v[24:27], a[120:123], v[208:211], v[24:27]
    ds_read_b64_tr_b16 a[76:77], v4 offset:832
    v_mfma_f32_16x16x32_bf16 v[24:27], a[124:127], v[216:219], v[24:27]
    ds_read_b64_tr_b16 a[78:79], v4 offset:960
    v_mfma_f32_16x16x32_bf16 v[28:31], a[96:99], v[160:163], 0
    ds_read_b64_tr_b16 a[80:81], v4 offset:16960
    v_mfma_f32_16x16x32_bf16 v[28:31], a[100:103], v[168:171], v[28:31]
    ds_read_b64_tr_b16 a[82:83], v4 offset:17088
    v_mfma_f32_16x16x32_bf16 v[28:31], a[104:107], v[176:179], v[28:31]
    ds_read_b64_tr_b16 a[84:85], v4 offset:17216
    v_mfma_f32_16x16x32_bf16 v[28:31], a[108:111], v[184:187], v[28:31]
    ds_read_b64_tr_b16 a[86:87], v4 offset:17344
    v_mfma_f32_16x16x32_bf16 v[28:31], a[112:115], v[224:227], v[28:31]
    ds_read_b64_tr_b16 a[88:89], v4 offset:17472
    v_mfma_f32_16x16x32_bf16 v[28:31], a[116:119], v[232:235], v[28:31]
    ds_read_b64_tr_b16 a[90:91], v4 offset:17600
    v_mfma_f32_16x16x32_bf16 v[28:31], a[120:123], v[240:243], v[28:31]
    ds_read_b64_tr_b16 a[92:93], v4 offset:17728
    v_mfma_f32_16x16x32_bf16 v[28:31], a[124:127], v[248:251], v[28:31]
    s_waitcnt lgkmcnt(11)
    ds_read_b64_tr_b16 a[94:95], v4 offset:17856
    v_mfma_f32_16x16x32_bf16 v[32:35], a[64:67], v[128:131], 0
    ds_read_b64_tr_b16 a[96:97], v4 offset:96
    v_cvt_pk_bf16_f32 v48, v16, v17
    v_mfma_f32_16x16x32_bf16 v[32:35], a[68:71], v[136:139], v[32:35]
    s_waitcnt lgkmcnt(9)
    ds_read_b64_tr_b16 a[98:99], v4 offset:224
    v_cvt_pk_bf16_f32 v49, v18, v19
    v_mfma_f32_16x16x32_bf16 v[32:35], a[72:75], v[144:147], v[32:35]
    ds_read_b64_tr_b16 a[100:101], v4 offset:352
    v_cvt_pk_bf16_f32 v50, v24, v25
    v_mfma_f32_16x16x32_bf16 v[32:35], a[76:79], v[152:155], v[32:35]
    s_waitcnt lgkmcnt(7)
    ds_read_b64_tr_b16 a[102:103], v4 offset:480
    v_cvt_pk_bf16_f32 v51, v26, v27
    v_mfma_f32_16x16x32_bf16 v[32:35], a[80:83], v[192:195], v[32:35]
    s_mov_b32 s54, 0
    ds_read_b64_tr_b16 a[104:105], v4 offset:608
    ds_read_b64_tr_b16 a[106:107], v4 offset:736
    v_mfma_f32_16x16x32_bf16 v[32:35], a[84:87], v[200:203], v[32:35]
    s_waitcnt lgkmcnt(6)
    v_permlane32_swap_b32 v48, v50
    v_mfma_f32_16x16x32_bf16 v[32:35], a[88:91], v[208:211], v[32:35]
    v_permlane32_swap_b32 v49, v51
    v_mfma_f32_16x16x32_bf16 v[32:35], a[92:95], v[216:219], v[32:35]
    ds_read_b64_tr_b16 a[108:109], v4 offset:864
    ds_read_b64_tr_b16 a[110:111], v4 offset:992
    buffer_store_dwordx4 v[48:51], v10, s[40:43], s54 offen offset:0 sc1
    v_mfma_f32_16x16x32_bf16 v[36:39], a[64:67], v[160:163], 0
    ds_read_b64_tr_b16 a[112:113], v4 offset:16992
    v_cvt_pk_bf16_f32 v52, v20, v21
    v_mfma_f32_16x16x32_bf16 v[36:39], a[68:71], v[168:171], v[36:39]
    ds_read_b64_tr_b16 a[114:115], v4 offset:17120
    v_cvt_pk_bf16_f32 v53, v22, v23
    v_mfma_f32_16x16x32_bf16 v[36:39], a[72:75], v[176:179], v[36:39]
    ds_read_b64_tr_b16 a[116:117], v4 offset:17248
    v_cvt_pk_bf16_f32 v54, v28, v29
    v_mfma_f32_16x16x32_bf16 v[36:39], a[76:79], v[184:187], v[36:39]
    ds_read_b64_tr_b16 a[118:119], v4 offset:17376
    v_cvt_pk_bf16_f32 v55, v30, v31
    v_mfma_f32_16x16x32_bf16 v[36:39], a[80:83], v[224:227], v[36:39]
    s_mov_b32 s54, 294912
    ds_read_b64_tr_b16 a[120:121], v4 offset:17504
    ds_read_b64_tr_b16 a[122:123], v4 offset:17632
    v_mfma_f32_16x16x32_bf16 v[36:39], a[84:87], v[232:235], v[36:39]
    v_permlane32_swap_b32 v52, v54
    v_mfma_f32_16x16x32_bf16 v[36:39], a[88:91], v[240:243], v[36:39]
    v_permlane32_swap_b32 v53, v55
    v_mfma_f32_16x16x32_bf16 v[36:39], a[92:95], v[248:251], v[36:39]
    s_barrier
    s_waitcnt lgkmcnt(10)
    ds_read_b64_tr_b16 a[124:125], v4 offset:17760
    ds_read_b64_tr_b16 a[126:127], v4 offset:17888
    ds_read_b128 v[60:63], v58
    buffer_store_dwordx4 v[52:55], v10, s[40:43], s54 offen offset:0 sc1
    v_mfma_f32_16x16x32_bf16 v[40:43], a[96:99], v[128:131], 0
    s_add_u32 m0, s44, 36864
    ds_read_b64_tr_b16 a[64:65], v4 offset:36864
    ds_read_b64_tr_b16 a[66:67], v4 offset:36992
    v_mfma_f32_16x16x32_bf16 v[40:43], a[100:103], v[136:139], v[40:43]
    s_mov_b32 s45, 384
    s_waitcnt lgkmcnt(11)
    buffer_load_dwordx4 v7, s[28:31], s45 offen offset:0 lds
    v_mfma_f32_16x16x32_bf16 v[40:43], a[104:107], v[144:147], v[40:43]
    s_add_u32 m0, s44, 36768
    ds_read_b64_tr_b16 a[68:69], v4 offset:37120
    ds_read_b64_tr_b16 a[70:71], v4 offset:37248
    v_mfma_f32_16x16x32_bf16 v[40:43], a[108:111], v[152:155], v[40:43]
    s_waitcnt lgkmcnt(9)
    buffer_load_dwordx4 v7, s[28:31], s45 offen offset:1152 lds
    v_mfma_f32_16x16x32_bf16 v[40:43], a[112:115], v[192:195], v[40:43]
    s_add_u32 m0, s44, 36672
    ds_read_b64_tr_b16 a[72:73], v4 offset:37376
    ds_read_b64_tr_b16 a[74:75], v4 offset:37504
    v_mfma_f32_16x16x32_bf16 v[40:43], a[116:119], v[200:203], v[40:43]
    s_waitcnt lgkmcnt(7)
    buffer_load_dwordx4 v7, s[28:31], s45 offen offset:2304 lds
    v_mfma_f32_16x16x32_bf16 v[40:43], a[120:123], v[208:211], v[40:43]
    s_add_u32 m0, s44, 36576
    ds_read_b64_tr_b16 a[76:77], v4 offset:37632
    ds_read_b64_tr_b16 a[78:79], v4 offset:37760
    v_mfma_f32_16x16x32_bf16 v[40:43], a[124:127], v[216:219], v[40:43]
    s_waitcnt lgkmcnt(8)
    buffer_load_dwordx4 v7, s[28:31], s45 offen offset:3456 lds
    v_or3_b32 v60, v60, v61, v62
    v_or_b32 v60, v60, v63
    v_mfma_f32_16x16x32_bf16 v[44:47], a[96:99], v[160:163], 0
    s_add_u32 m0, s44, 53760
    ds_read_b64_tr_b16 a[80:81], v4 offset:53760
    ds_read_b64_tr_b16 a[82:83], v4 offset:53888
    v_mfma_f32_16x16x32_bf16 v[44:47], a[100:103], v[168:171], v[44:47]
    s_mov_b32 s45, 147840
    buffer_load_dwordx4 v7, s[28:31], s45 offen offset:0 lds
    v_mfma_f32_16x16x32_bf16 v[44:47], a[104:107], v[176:179], v[44:47]
    s_add_u32 m0, s44, 53664
    ds_read_b64_tr_b16 a[84:85], v4 offset:54016
    ds_read_b64_tr_b16 a[86:87], v4 offset:54144
    v_mfma_f32_16x16x32_bf16 v[44:47], a[108:111], v[184:187], v[44:47]
    buffer_load_dwordx4 v7, s[28:31], s45 offen offset:1152 lds
    v_mfma_f32_16x16x32_bf16 v[44:47], a[112:115], v[224:227], v[44:47]
    s_add_u32 m0, s44, 53568
    ds_read_b64_tr_b16 a[88:89], v4 offset:54272
    ds_read_b64_tr_b16 a[90:91], v4 offset:54400
    v_mfma_f32_16x16x32_bf16 v[44:47], a[116:119], v[232:235], v[44:47]
    buffer_load_dwordx4 v7, s[28:31], s45 offen offset:2304 lds
    v_mfma_f32_16x16x32_bf16 v[44:47], a[120:123], v[240:243], v[44:47]
    s_add_u32 m0, s44, 53472
    ds_read_b64_tr_b16 a[92:93], v4 offset:54528
    ds_read_b64_tr_b16 a[94:95], v4 offset:54656
    v_mfma_f32_16x16x32_bf16 v[44:47], a[124:127], v[248:251], v[44:47]
    s_waitcnt lgkmcnt(12)
    buffer_load_dwordx4 v7, s[28:31], s45 offen offset:3456 lds
    v_readfirstlane_b32 s3, v60
    v_mfma_f32_16x16x32_bf16 v[16:19], a[64:67], v[128:131], 0
    ds_read_b64_tr_b16 a[96:97], v4 offset:36896
    v_cvt_pk_bf16_f32 v48, v32, v33
    v_mfma_f32_16x16x32_bf16 v[16:19], a[68:71], v[136:139], v[16:19]
    s_waitcnt lgkmcnt(9)
    s_cmp_lg_u32 s3, 0
    ds_read_b64_tr_b16 a[98:99], v4 offset:37024
    v_cvt_pk_bf16_f32 v49, v34, v35
    v_mfma_f32_16x16x32_bf16 v[16:19], a[72:75], v[144:147], v[16:19]
    s_cbranch_scc1 L2_fallback
    ds_read_b64_tr_b16 a[100:101], v4 offset:37152
    v_cvt_pk_bf16_f32 v50, v40, v41
    v_mfma_f32_16x16x32_bf16 v[16:19], a[76:79], v[152:155], v[16:19]
    s_waitcnt lgkmcnt(7)
    ds_read_b64_tr_b16 a[102:103], v4 offset:37280
    v_cvt_pk_bf16_f32 v51, v42, v43
    v_mfma_f32_16x16x32_bf16 v[16:19], a[80:83], v[192:195], v[16:19]
    s_mov_b32 s54, 0
    ds_read_b64_tr_b16 a[104:105], v4 offset:37408
    ds_read_b64_tr_b16 a[106:107], v4 offset:37536
    v_mfma_f32_16x16x32_bf16 v[16:19], a[84:87], v[200:203], v[16:19]
    s_waitcnt lgkmcnt(6)
    v_permlane32_swap_b32 v48, v50
    v_mfma_f32_16x16x32_bf16 v[16:19], a[88:91], v[208:211], v[16:19]
    v_permlane32_swap_b32 v49, v51
    v_mfma_f32_16x16x32_bf16 v[16:19], a[92:95], v[216:219], v[16:19]
    ds_read_b64_tr_b16 a[108:109], v4 offset:37664
    ds_read_b64_tr_b16 a[110:111], v4 offset:37792
    buffer_store_dwordx4 v[48:51], v10, s[40:43], s54 offen offset:512 sc1
    v_mfma_f32_16x16x32_bf16 v[20:23], a[64:67], v[160:163], 0
    ds_read_b64_tr_b16 a[112:113], v4 offset:53792
    v_cvt_pk_bf16_f32 v52, v36, v37
    v_mfma_f32_16x16x32_bf16 v[20:23], a[68:71], v[168:171], v[20:23]
    ds_read_b64_tr_b16 a[114:115], v4 offset:53920
    v_cvt_pk_bf16_f32 v53, v38, v39
    v_mfma_f32_16x16x32_bf16 v[20:23], a[72:75], v[176:179], v[20:23]
    ds_read_b64_tr_b16 a[116:117], v4 offset:54048
    v_cvt_pk_bf16_f32 v54, v44, v45
    v_mfma_f32_16x16x32_bf16 v[20:23], a[76:79], v[184:187], v[20:23]
    ds_read_b64_tr_b16 a[118:119], v4 offset:54176
    v_cvt_pk_bf16_f32 v55, v46, v47
    v_mfma_f32_16x16x32_bf16 v[20:23], a[80:83], v[224:227], v[20:23]
    s_mov_b32 s54, 294912
    ds_read_b64_tr_b16 a[120:121], v4 offset:54304
    ds_read_b64_tr_b16 a[122:123], v4 offset:54432
    v_mfma_f32_16x16x32_bf16 v[20:23], a[84:87], v[232:235], v[20:23]
    v_permlane32_swap_b32 v52, v54
    v_mfma_f32_16x16x32_bf16 v[20:23], a[88:91], v[240:243], v[20:23]
    v_permlane32_swap_b32 v53, v55
    v_mfma_f32_16x16x32_bf16 v[20:23], a[92:95], v[248:251], v[20:23]
    s_waitcnt lgkmcnt(10)
    ds_read_b64_tr_b16 a[124:125], v4 offset:54560
    ds_read_b64_tr_b16 a[126:127], v4 offset:54688
    buffer_store_dwordx4 v[52:55], v10, s[40:43], s54 offen offset:512 sc1
    v_mfma_f32_16x16x32_bf16 v[24:27], a[96:99], v[128:131], 0
    s_mul_i32 s3, s51, 128
    ds_read_b64_tr_b16 a[64:65], v4 offset:36928
    v_lshrrev_b32 v14, 3, v0
    v_mfma_f32_16x16x32_bf16 v[24:27], a[100:103], v[136:139], v[24:27]
    s_waitcnt lgkmcnt(9)
    ds_read_b64_tr_b16 a[66:67], v4 offset:37056
    v_lshl_add_u32 v12, v14, 4, s3
    v_mfma_f32_16x16x32_bf16 v[24:27], a[104:107], v[144:147], v[24:27]
    ds_read_b64_tr_b16 a[68:69], v4 offset:37184
    v_and_b32 v14, 1, v14
    v_mfma_f32_16x16x32_bf16 v[24:27], a[108:111], v[152:155], v[24:27]
    s_waitcnt lgkmcnt(7)
    s_mul_i32 s3, s51, 32
    ds_read_b64_tr_b16 a[70:71], v4 offset:37312
    v_lshl_add_u32 v13, v14, 4, s3
    v_mfma_f32_16x16x32_bf16 v[24:27], a[112:115], v[192:195], v[24:27]
    ds_read_b64_tr_b16 a[72:73], v4 offset:37440
    v_and_b32 v14, 7, v0
    v_mfma_f32_16x16x32_bf16 v[24:27], a[116:119], v[200:203], v[24:27]
    s_waitcnt lgkmcnt(5)
    ds_read_b64_tr_b16 a[74:75], v4 offset:37568
    v_mul_u32_u24 v14, 1152, v14
    v_mfma_f32_16x16x32_bf16 v[24:27], a[120:123], v[208:211], v[24:27]
    ds_read_b64_tr_b16 a[76:77], v4 offset:37696
    v_add_u32 v1, v14, v12
    v_mfma_f32_16x16x32_bf16 v[24:27], a[124:127], v[216:219], v[24:27]
    ds_read_b64_tr_b16 a[78:79], v4 offset:37824
    v_add_u32 v2, v14, v13
    v_mfma_f32_16x16x32_bf16 v[28:31], a[96:99], v[160:163], 0
    ds_read_b64_tr_b16 a[80:81], v4 offset:53824
    v_add_u32 v2, 1024, v2
    v_mfma_f32_16x16x32_bf16 v[28:31], a[100:103], v[168:171], v[28:31]
    s_lshl_b32 s14, s51, 10
    ds_read_b64_tr_b16 a[82:83], v4 offset:53952
    v_add_u32 v5, s14, v8
    v_mfma_f32_16x16x32_bf16 v[28:31], a[104:107], v[176:179], v[28:31]
    ds_read_b64_tr_b16 a[84:85], v4 offset:54080
    v_and_b32 v59, 0xf0, v8
    v_mfma_f32_16x16x32_bf16 v[28:31], a[108:111], v[184:187], v[28:31]
    s_lshl_b32 s14, s51, 8
    ds_read_b64_tr_b16 a[86:87], v4 offset:54208
    v_add_u32 v59, s14, v59
    v_mfma_f32_16x16x32_bf16 v[28:31], a[112:115], v[224:227], v[28:31]
    ds_read_b64_tr_b16 a[88:89], v4 offset:54336
    v_and_b32 v6, 15, v0
    v_mfma_f32_16x16x32_bf16 v[28:31], a[116:119], v[232:235], v[28:31]
    ds_read_b64_tr_b16 a[90:91], v4 offset:54464
    v_lshlrev_b32 v6, 8, v6
    v_mfma_f32_16x16x32_bf16 v[28:31], a[120:123], v[240:243], v[28:31]
    ds_read_b64_tr_b16 a[92:93], v4 offset:54592
    v_min_u32 v15, 1, v0
    v_mfma_f32_16x16x32_bf16 v[28:31], a[124:127], v[248:251], v[28:31]
    s_waitcnt lgkmcnt(11)
    ds_read_b64_tr_b16 a[94:95], v4 offset:54720
    v_lshlrev_b32 v15, 30, v15
    v_mfma_f32_16x16x32_bf16 v[32:35], a[64:67], v[128:131], 0
    s_lshl_b32 s15, s53, 14
    s_add_u32 s15, s15, 786432
    s_and_b32 s14, s52, 12
    s_lshl_b32 s14, s14, 10
    s_add_u32 s47, s15, s14
    s_lshl4_add_u32 s3, s51, s52
    s_lshl_b32 s3, s3, 8
    s_add_u32 s56, s3, s15
    s_add_u32 s14, s55, 16384
    ds_read_b64_tr_b16 a[96:97], v4 offset:36960
    v_cvt_pk_bf16_f32 v48, v16, v17
    v_mfma_f32_16x16x32_bf16 v[32:35], a[68:71], v[136:139], v[32:35]
    s_waitcnt lgkmcnt(9)
    ds_read_b64_tr_b16 a[98:99], v4 offset:37088
    v_cvt_pk_bf16_f32 v49, v18, v19
    v_mfma_f32_16x16x32_bf16 v[32:35], a[72:75], v[144:147], v[32:35]
    ds_read_b64_tr_b16 a[100:101], v4 offset:37216
    v_cvt_pk_bf16_f32 v50, v24, v25
    v_mfma_f32_16x16x32_bf16 v[32:35], a[76:79], v[152:155], v[32:35]
    s_waitcnt lgkmcnt(7)
    ds_read_b64_tr_b16 a[102:103], v4 offset:37344
    v_cvt_pk_bf16_f32 v51, v26, v27
    v_mfma_f32_16x16x32_bf16 v[32:35], a[80:83], v[192:195], v[32:35]
    s_mov_b32 s54, 1024
    ds_read_b64_tr_b16 a[104:105], v4 offset:37472
    ds_read_b64_tr_b16 a[106:107], v4 offset:37600
    v_mfma_f32_16x16x32_bf16 v[32:35], a[84:87], v[200:203], v[32:35]
    s_waitcnt lgkmcnt(6)
    v_permlane32_swap_b32 v48, v50
    v_mfma_f32_16x16x32_bf16 v[32:35], a[88:91], v[208:211], v[32:35]
    v_permlane32_swap_b32 v49, v51
    v_mfma_f32_16x16x32_bf16 v[32:35], a[92:95], v[216:219], v[32:35]
    ds_read_b64_tr_b16 a[108:109], v4 offset:37728
    ds_read_b64_tr_b16 a[110:111], v4 offset:37856
    buffer_store_dwordx4 v[48:51], v10, s[40:43], s54 offen offset:0 sc1
    v_mfma_f32_16x16x32_bf16 v[36:39], a[64:67], v[160:163], 0
    ds_read_b64_tr_b16 a[112:113], v4 offset:53856
    v_cvt_pk_bf16_f32 v52, v20, v21
    v_mfma_f32_16x16x32_bf16 v[36:39], a[68:71], v[168:171], v[36:39]
    ds_read_b64_tr_b16 a[114:115], v4 offset:53984
    v_cvt_pk_bf16_f32 v53, v22, v23
    v_mfma_f32_16x16x32_bf16 v[36:39], a[72:75], v[176:179], v[36:39]
    ds_read_b64_tr_b16 a[116:117], v4 offset:54112
    v_cvt_pk_bf16_f32 v54, v28, v29
    v_mfma_f32_16x16x32_bf16 v[36:39], a[76:79], v[184:187], v[36:39]
    ds_read_b64_tr_b16 a[118:119], v4 offset:54240
    v_cvt_pk_bf16_f32 v55, v30, v31
    v_mfma_f32_16x16x32_bf16 v[36:39], a[80:83], v[224:227], v[36:39]
    s_mov_b32 s54, 295936
    ds_read_b64_tr_b16 a[120:121], v4 offset:54368
    ds_read_b64_tr_b16 a[122:123], v4 offset:54496
    v_mfma_f32_16x16x32_bf16 v[36:39], a[84:87], v[232:235], v[36:39]
    v_permlane32_swap_b32 v52, v54
    v_mfma_f32_16x16x32_bf16 v[36:39], a[88:91], v[240:243], v[36:39]
    v_permlane32_swap_b32 v53, v55
    v_mfma_f32_16x16x32_bf16 v[36:39], a[92:95], v[248:251], v[36:39]
    s_waitcnt vmcnt(31)
    s_barrier
    s_waitcnt lgkmcnt(10)
    ds_read_b64_tr_b16 a[124:125], v4 offset:54624
    ds_read_b64_tr_b16 a[126:127], v4 offset:54752
    buffer_store_dwordx4 v[52:55], v10, s[40:43], s54 offen offset:0 sc1
    v_mfma_f32_16x16x32_bf16 v[40:43], a[96:99], v[128:131], 0
    s_add_u32 m0, s44, 73728
    ds_read_b64_tr_b16 a[64:65], v3 offset:0
    ds_read_b64_tr_b16 a[66:67], v3 offset:128
    v_mfma_f32_16x16x32_bf16 v[40:43], a[100:103], v[136:139], v[40:43]
    s_mov_b32 s45, 512
    s_waitcnt lgkmcnt(10)
    buffer_load_dwordx4 v7, s[28:31], s45 offen offset:0 lds
    v_mfma_f32_16x16x32_bf16 v[40:43], a[104:107], v[144:147], v[40:43]
    s_add_u32 m0, s44, 73632
    ds_read_b64_tr_b16 a[68:69], v3 offset:256
    ds_read_b64_tr_b16 a[70:71], v3 offset:384
    v_mfma_f32_16x16x32_bf16 v[40:43], a[108:111], v[152:155], v[40:43]
    s_waitcnt lgkmcnt(8)
    buffer_load_dwordx4 v7, s[28:31], s45 offen offset:1152 lds
    v_mfma_f32_16x16x32_bf16 v[40:43], a[112:115], v[192:195], v[40:43]
    s_add_u32 m0, s44, 73536
    ds_read_b64_tr_b16 a[72:73], v3 offset:512
    ds_read_b64_tr_b16 a[74:75], v3 offset:640
    v_mfma_f32_16x16x32_bf16 v[40:43], a[116:119], v[200:203], v[40:43]
    s_waitcnt lgkmcnt(6)
    buffer_load_dwordx4 v7, s[28:31], s45 offen offset:2304 lds
    v_mfma_f32_16x16x32_bf16 v[40:43], a[120:123], v[208:211], v[40:43]
    s_add_u32 m0, s44, 73440
    ds_read_b64_tr_b16 a[76:77], v3 offset:768
    ds_read_b64_tr_b16 a[78:79], v3 offset:896
    v_mfma_f32_16x16x32_bf16 v[40:43], a[124:127], v[216:219], v[40:43]
    buffer_load_dwordx4 v7, s[28:31], s45 offen offset:3456 lds
    v_mfma_f32_16x16x32_bf16 v[44:47], a[96:99], v[160:163], 0
    s_add_u32 m0, s44, 90624
    ds_read_b64_tr_b16 a[80:81], v3 offset:16896
    ds_read_b64_tr_b16 a[82:83], v3 offset:17024
    v_mfma_f32_16x16x32_bf16 v[44:47], a[100:103], v[168:171], v[44:47]
    s_mov_b32 s45, 147968
    buffer_load_dwordx4 v7, s[28:31], s45 offen offset:0 lds
    v_mfma_f32_16x16x32_bf16 v[44:47], a[104:107], v[176:179], v[44:47]
    s_add_u32 m0, s44, 90528
    ds_read_b64_tr_b16 a[84:85], v3 offset:17152
    ds_read_b64_tr_b16 a[86:87], v3 offset:17280
    v_mfma_f32_16x16x32_bf16 v[44:47], a[108:111], v[184:187], v[44:47]
    buffer_load_dwordx4 v7, s[28:31], s45 offen offset:1152 lds
    v_mfma_f32_16x16x32_bf16 v[44:47], a[112:115], v[224:227], v[44:47]
    s_add_u32 m0, s44, 90432
    ds_read_b64_tr_b16 a[88:89], v3 offset:17408
    ds_read_b64_tr_b16 a[90:91], v3 offset:17536
    v_mfma_f32_16x16x32_bf16 v[44:47], a[116:119], v[232:235], v[44:47]
    buffer_load_dwordx4 v7, s[28:31], s45 offen offset:2304 lds
    v_mfma_f32_16x16x32_bf16 v[44:47], a[120:123], v[240:243], v[44:47]
    s_add_u32 m0, s44, 90336
    ds_read_b64_tr_b16 a[92:93], v3 offset:17664
    ds_read_b64_tr_b16 a[94:95], v3 offset:17792
    v_mfma_f32_16x16x32_bf16 v[44:47], a[124:127], v[248:251], v[44:47]
    s_waitcnt lgkmcnt(12)
    buffer_load_dwordx4 v7, s[28:31], s45 offen offset:3456 lds
    v_mfma_f32_16x16x32_bf16 v[16:19], a[64:67], v[128:131], 0
    ds_read_b64_tr_b16 a[96:97], v3 offset:32
    v_cvt_pk_bf16_f32 v48, v32, v33
    v_mfma_f32_16x16x32_bf16 v[16:19], a[68:71], v[136:139], v[16:19]
    s_waitcnt lgkmcnt(9)
    ds_read_b64_tr_b16 a[98:99], v3 offset:160
    v_cvt_pk_bf16_f32 v49, v34, v35
    v_mfma_f32_16x16x32_bf16 v[16:19], a[72:75], v[144:147], v[16:19]
    ds_read_b64_tr_b16 a[100:101], v3 offset:288
    v_cvt_pk_bf16_f32 v50, v40, v41
    v_mfma_f32_16x16x32_bf16 v[16:19], a[76:79], v[152:155], v[16:19]
    s_waitcnt lgkmcnt(7)
    ds_read_b64_tr_b16 a[102:103], v3 offset:416
    v_cvt_pk_bf16_f32 v51, v42, v43
    v_mfma_f32_16x16x32_bf16 v[16:19], a[80:83], v[192:195], v[16:19]
    s_mov_b32 s54, 1024
    ds_read_b64_tr_b16 a[104:105], v3 offset:544
    ds_read_b64_tr_b16 a[106:107], v3 offset:672
    v_mfma_f32_16x16x32_bf16 v[16:19], a[84:87], v[200:203], v[16:19]
    s_waitcnt lgkmcnt(6)
    v_permlane32_swap_b32 v48, v50
    v_mfma_f32_16x16x32_bf16 v[16:19], a[88:91], v[208:211], v[16:19]
    v_permlane32_swap_b32 v49, v51
    v_mfma_f32_16x16x32_bf16 v[16:19], a[92:95], v[216:219], v[16:19]
    ds_read_b64_tr_b16 a[108:109], v3 offset:800
    ds_read_b64_tr_b16 a[110:111], v3 offset:928
    buffer_store_dwordx4 v[48:51], v10, s[40:43], s54 offen offset:512 sc1
    v_mfma_f32_16x16x32_bf16 v[20:23], a[64:67], v[160:163], 0
    ds_read_b64_tr_b16 a[112:113], v3 offset:16928
    v_cvt_pk_bf16_f32 v52, v36, v37
    v_mfma_f32_16x16x32_bf16 v[20:23], a[68:71], v[168:171], v[20:23]
    ds_read_b64_tr_b16 a[114:115], v3 offset:17056
    v_cvt_pk_bf16_f32 v53, v38, v39
    v_mfma_f32_16x16x32_bf16 v[20:23], a[72:75], v[176:179], v[20:23]
    ds_read_b64_tr_b16 a[116:117], v3 offset:17184
    v_cvt_pk_bf16_f32 v54, v44, v45
    v_mfma_f32_16x16x32_bf16 v[20:23], a[76:79], v[184:187], v[20:23]
    ds_read_b64_tr_b16 a[118:119], v3 offset:17312
    v_cvt_pk_bf16_f32 v55, v46, v47
    v_mfma_f32_16x16x32_bf16 v[20:23], a[80:83], v[224:227], v[20:23]
    s_mov_b32 s54, 295936
    ds_read_b64_tr_b16 a[120:121], v3 offset:17440
    ds_read_b64_tr_b16 a[122:123], v3 offset:17568
    v_mfma_f32_16x16x32_bf16 v[20:23], a[84:87], v[232:235], v[20:23]
    v_permlane32_swap_b32 v52, v54
    v_mfma_f32_16x16x32_bf16 v[20:23], a[88:91], v[240:243], v[20:23]
    v_permlane32_swap_b32 v53, v55
    v_mfma_f32_16x16x32_bf16 v[20:23], a[92:95], v[248:251], v[20:23]
    s_waitcnt lgkmcnt(10)
    ds_read_b64_tr_b16 a[124:125], v3 offset:17696
    ds_read_b64_tr_b16 a[126:127], v3 offset:17824
    buffer_store_dwordx4 v[52:55], v10, s[40:43], s54 offen offset:512 sc1
    v_mfma_f32_16x16x32_bf16 v[24:27], a[96:99], v[128:131], 0
    ds_read_b64_tr_b16 a[64:65], v3 offset:64
    v_add_u32 v104, s14, v8
    v_mfma_f32_16x16x32_bf16 v[24:27], a[100:103], v[136:139], v[24:27]
    s_waitcnt lgkmcnt(9)
    ds_read_b64_tr_b16 a[66:67], v3 offset:192
    v_and_b32 v14, 32, v0
    v_mfma_f32_16x16x32_bf16 v[24:27], a[104:107], v[144:147], v[24:27]
    ds_read_b64_tr_b16 a[68:69], v3 offset:320
    v_xor_b32 v105, v14, v104
    v_mfma_f32_16x16x32_bf16 v[24:27], a[108:111], v[152:155], v[24:27]
    s_waitcnt lgkmcnt(7)
    ds_read_b64_tr_b16 a[70:71], v3 offset:448
    v_add_u32 v106, 73728, v105
    v_mfma_f32_16x16x32_bf16 v[24:27], a[112:115], v[192:195], v[24:27]
    ds_read_b64_tr_b16 a[72:73], v3 offset:576
    v_lshrrev_b32 v110, 4, v0
    v_mfma_f32_16x16x32_bf16 v[24:27], a[116:119], v[200:203], v[24:27]
    s_waitcnt lgkmcnt(5)
    ds_read_b64_tr_b16 a[74:75], v3 offset:704
    v_bfe_u32 v14, v0, 2, 2
    v_mfma_f32_16x16x32_bf16 v[24:27], a[120:123], v[208:211], v[24:27]
    ds_read_b64_tr_b16 a[76:77], v3 offset:832
    v_lshl_add_u32 v110, v110, 3, v14
    v_mfma_f32_16x16x32_bf16 v[24:27], a[124:127], v[216:219], v[24:27]
    ds_read_b64_tr_b16 a[78:79], v3 offset:960
    v_and_b32 v14, 3, v0
    v_mfma_f32_16x16x32_bf16 v[28:31], a[96:99], v[160:163], 0
    ds_read_b64_tr_b16 a[80:81], v3 offset:16960
    v_mul_u32_u24 v111, 1152, v110
    v_mfma_f32_16x16x32_bf16 v[28:31], a[100:103], v[168:171], v[28:31]
    ds_read_b64_tr_b16 a[82:83], v3 offset:17088
    v_lshlrev_b32 v110, 6, v110
    v_mfma_f32_16x16x32_bf16 v[28:31], a[104:107], v[176:179], v[28:31]
    ds_read_b64_tr_b16 a[84:85], v3 offset:17216
    v_lshl_add_u32 v110, v14, 3, v110
    v_mfma_f32_16x16x32_bf16 v[28:31], a[108:111], v[184:187], v[28:31]
    ds_read_b64_tr_b16 a[86:87], v3 offset:17344
    v_lshl_add_u32 v111, v14, 3, v111
    v_mfma_f32_16x16x32_bf16 v[28:31], a[112:115], v[224:227], v[28:31]
    s_lshr_b32 s3, s51, 1
    s_xor_b32 s3, s3, 1
    s_mul_i32 s3, s3, 110592
    s_and_b32 s14, s51, 1
    s_lshl_b32 s14, s14, 5
    s_add_u32 s3, s3, s14
    s_add_u32 s3, s3, 16384
    ds_read_b64_tr_b16 a[88:89], v3 offset:17472
    v_add_u32 v110, s3, v110
    v_mfma_f32_16x16x32_bf16 v[28:31], a[116:119], v[232:235], v[28:31]
    ds_read_b64_tr_b16 a[90:91], v3 offset:17600
    v_and_b32 v14, 16, v0
    v_mfma_f32_16x16x32_bf16 v[28:31], a[120:123], v[240:243], v[28:31]
    ds_read_b64_tr_b16 a[92:93], v3 offset:17728
    v_lshlrev_b32 v14, 1, v14
    v_mfma_f32_16x16x32_bf16 v[28:31], a[124:127], v[248:251], v[28:31]
    s_waitcnt lgkmcnt(11)
    ds_read_b64_tr_b16 a[94:95], v3 offset:17856
    v_xor_b32 v110, v14, v110
    v_mfma_f32_16x16x32_bf16 v[32:35], a[64:67], v[128:131], 0
    s_mul_i32 s3, s51, 288
    s_add_u32 s3, s3, 53248
    ds_read_b64_tr_b16 a[96:97], v3 offset:96
    v_cvt_pk_bf16_f32 v48, v16, v17
    v_mfma_f32_16x16x32_bf16 v[32:35], a[68:71], v[136:139], v[32:35]
    s_waitcnt lgkmcnt(9)
    ds_read_b64_tr_b16 a[98:99], v3 offset:224
    v_cvt_pk_bf16_f32 v49, v18, v19
    v_mfma_f32_16x16x32_bf16 v[32:35], a[72:75], v[144:147], v[32:35]
L2_pad11:
    s_cbranch_execz L2_pad15
    ds_read_b64_tr_b16 a[100:101], v3 offset:352
    v_cvt_pk_bf16_f32 v50, v24, v25
    v_mfma_f32_16x16x32_bf16 v[32:35], a[76:79], v[152:155], v[32:35]
    s_waitcnt lgkmcnt(7)
    ds_read_b64_tr_b16 a[102:103], v3 offset:480
    v_cvt_pk_bf16_f32 v51, v26, v27
    v_mfma_f32_16x16x32_bf16 v[32:35], a[80:83], v[192:195], v[32:35]
    s_mov_b32 s54, 2048
    ds_read_b64_tr_b16 a[104:105], v3 offset:608
    ds_read_b64_tr_b16 a[106:107], v3 offset:736
    v_mfma_f32_16x16x32_bf16 v[32:35], a[84:87], v[200:203], v[32:35]
    s_waitcnt lgkmcnt(6)
    v_permlane32_swap_b32 v48, v50
    v_mfma_f32_16x16x32_bf16 v[32:35], a[88:91], v[208:211], v[32:35]
    v_permlane32_swap_b32 v49, v51
    v_mfma_f32_16x16x32_bf16 v[32:35], a[92:95], v[216:219], v[32:35]
    ds_read_b64_tr_b16 a[108:109], v3 offset:864
    ds_read_b64_tr_b16 a[110:111], v3 offset:992
    buffer_store_dwordx4 v[48:51], v10, s[40:43], s54 offen offset:0 sc1
    v_mfma_f32_16x16x32_bf16 v[36:39], a[64:67], v[160:163], 0
    ds_read_b64_tr_b16 a[112:113], v3 offset:16992
    v_cvt_pk_bf16_f32 v52, v20, v21
    v_mfma_f32_16x16x32_bf16 v[36:39], a[68:71], v[168:171], v[36:39]
    ds_read_b64_tr_b16 a[114:115], v3 offset:17120
    v_cvt_pk_bf16_f32 v53, v22, v23
    v_mfma_f32_16x16x32_bf16 v[36:39], a[72:75], v[176:179], v[36:39]
    ds_read_b64_tr_b16 a[116:117], v3 offset:17248
    v_cvt_pk_bf16_f32 v54, v28, v29
    v_mfma_f32_16x16x32_bf16 v[36:39], a[76:79], v[184:187], v[36:39]
    ds_read_b64_tr_b16 a[118:119], v3 offset:17376
    v_cvt_pk_bf16_f32 v55, v30, v31
    v_mfma_f32_16x16x32_bf16 v[36:39], a[80:83], v[224:227], v[36:39]
    s_mov_b32 s54, 296960
    ds_read_b64_tr_b16 a[120:121], v3 offset:17504
    ds_read_b64_tr_b16 a[122:123], v3 offset:17632
    v_mfma_f32_16x16x32_bf16 v[36:39], a[84:87], v[232:235], v[36:39]
    v_permlane32_swap_b32 v52, v54
    v_mfma_f32_16x16x32_bf16 v[36:39], a[88:91], v[240:243], v[36:39]
    v_permlane32_swap_b32 v53, v55
    v_mfma_f32_16x16x32_bf16 v[36:39], a[92:95], v[248:251], v[36:39]
    s_waitcnt vmcnt(15)
    s_barrier
    s_waitcnt lgkmcnt(10)
    ds_read_b64_tr_b16 a[124:125], v3 offset:17760
    ds_read_b64_tr_b16 a[126:127], v3 offset:17888
    buffer_store_dwordx4 v[52:55], v10, s[40:43], s54 offen offset:0 sc1
    v_mfma_f32_16x16x32_bf16 v[40:43], a[96:99], v[128:131], 0
    s_add_u32 m0, s44, 110592
    ds_read_b64_tr_b16 a[64:65], v3 offset:36864
    ds_read_b64_tr_b16 a[66:67], v3 offset:36992
    v_mfma_f32_16x16x32_bf16 v[40:43], a[100:103], v[136:139], v[40:43]
    s_mov_b32 s45, 640
    s_waitcnt lgkmcnt(10)
    buffer_load_dwordx4 v7, s[28:31], s45 offen offset:0 lds
    v_mfma_f32_16x16x32_bf16 v[40:43], a[104:107], v[144:147], v[40:43]
    s_add_u32 m0, s44, 110496
    ds_read_b64_tr_b16 a[68:69], v3 offset:37120
    ds_read_b64_tr_b16 a[70:71], v3 offset:37248
    v_mfma_f32_16x16x32_bf16 v[40:43], a[108:111], v[152:155], v[40:43]
    s_waitcnt lgkmcnt(8)
    buffer_load_dwordx4 v7, s[28:31], s45 offen offset:1152 lds
    v_mfma_f32_16x16x32_bf16 v[40:43], a[112:115], v[192:195], v[40:43]
    s_add_u32 m0, s44, 110400
    ds_read_b64_tr_b16 a[72:73], v3 offset:37376
    ds_read_b64_tr_b16 a[74:75], v3 offset:37504
    v_mfma_f32_16x16x32_bf16 v[40:43], a[116:119], v[200:203], v[40:43]
    s_waitcnt lgkmcnt(6)
    buffer_load_dwordx4 v7, s[28:31], s45 offen offset:2304 lds
    v_mfma_f32_16x16x32_bf16 v[40:43], a[120:123], v[208:211], v[40:43]
    s_add_u32 m0, s44, 110304
    ds_read_b64_tr_b16 a[76:77], v3 offset:37632
    ds_read_b64_tr_b16 a[78:79], v3 offset:37760
    v_mfma_f32_16x16x32_bf16 v[40:43], a[124:127], v[216:219], v[40:43]
    buffer_load_dwordx4 v7, s[28:31], s45 offen offset:3456 lds
    v_mfma_f32_16x16x32_bf16 v[44:47], a[96:99], v[160:163], 0
    s_add_u32 m0, s44, 127488
    ds_read_b64_tr_b16 a[80:81], v3 offset:53760
    ds_read_b64_tr_b16 a[82:83], v3 offset:53888
    v_mfma_f32_16x16x32_bf16 v[44:47], a[100:103], v[168:171], v[44:47]
    s_mov_b32 s45, 148096
    buffer_load_dwordx4 v7, s[28:31], s45 offen offset:0 lds
    v_mfma_f32_16x16x32_bf16 v[44:47], a[104:107], v[176:179], v[44:47]
    s_add_u32 m0, s44, 127392
    ds_read_b64_tr_b16 a[84:85], v3 offset:54016
    ds_read_b64_tr_b16 a[86:87], v3 offset:54144
    v_mfma_f32_16x16x32_bf16 v[44:47], a[108:111], v[184:187], v[44:47]
    buffer_load_dwordx4 v7, s[28:31], s45 offen offset:1152 lds
    v_mfma_f32_16x16x32_bf16 v[44:47], a[112:115], v[224:227], v[44:47]
    s_add_u32 m0, s44, 127296
    ds_read_b64_tr_b16 a[88:89], v3 offset:54272
    ds_read_b64_tr_b16 a[90:91], v3 offset:54400
    v_mfma_f32_16x16x32_bf16 v[44:47], a[116:119], v[232:235], v[44:47]
    buffer_load_dwordx4 v7, s[28:31], s45 offen offset:2304 lds
    v_mfma_f32_16x16x32_bf16 v[44:47], a[120:123], v[240:243], v[44:47]
    s_add_u32 m0, s44, 127200
    ds_read_b64_tr_b16 a[92:93], v3 offset:54528
    ds_read_b64_tr_b16 a[94:95], v3 offset:54656
    v_mfma_f32_16x16x32_bf16 v[44:47], a[124:127], v[248:251], v[44:47]
    s_waitcnt lgkmcnt(12)
    buffer_load_dwordx4 v7, s[28:31], s45 offen offset:3456 lds
    v_mfma_f32_16x16x32_bf16 v[16:19], a[64:67], v[128:131], 0
    ds_read_b64_tr_b16 a[96:97], v3 offset:36896
    v_cvt_pk_bf16_f32 v48, v32, v33
    v_mfma_f32_16x16x32_bf16 v[16:19], a[68:71], v[136:139], v[16:19]
    s_waitcnt lgkmcnt(9)
    ds_read_b64_tr_b16 a[98:99], v3 offset:37024
    v_cvt_pk_bf16_f32 v49, v34, v35
    v_mfma_f32_16x16x32_bf16 v[16:19], a[72:75], v[144:147], v[16:19]
    ds_read_b64_tr_b16 a[100:101], v3 offset:37152
    v_cvt_pk_bf16_f32 v50, v40, v41
    v_mfma_f32_16x16x32_bf16 v[16:19], a[76:79], v[152:155], v[16:19]
    s_waitcnt lgkmcnt(7)
    ds_read_b64_tr_b16 a[102:103], v3 offset:37280
    v_cvt_pk_bf16_f32 v51, v42, v43
    v_mfma_f32_16x16x32_bf16 v[16:19], a[80:83], v[192:195], v[16:19]
    s_mov_b32 s54, 2048
    ds_read_b64_tr_b16 a[104:105], v3 offset:37408
    ds_read_b64_tr_b16 a[106:107], v3 offset:37536
    v_mfma_f32_16x16x32_bf16 v[16:19], a[84:87], v[200:203], v[16:19]
    s_waitcnt lgkmcnt(6)
    v_permlane32_swap_b32 v48, v50
    v_mfma_f32_16x16x32_bf16 v[16:19], a[88:91], v[208:211], v[16:19]
    v_permlane32_swap_b32 v49, v51
    v_mfma_f32_16x16x32_bf16 v[16:19], a[92:95], v[216:219], v[16:19]
    ds_read_b64_tr_b16 a[108:109], v3 offset:37664
    ds_read_b64_tr_b16 a[110:111], v3 offset:37792
    buffer_store_dwordx4 v[48:51], v10, s[40:43], s54 offen offset:512 sc1
    v_mfma_f32_16x16x32_bf16 v[20:23], a[64:67], v[160:163], 0
    ds_read_b64_tr_b16 a[112:113], v3 offset:53792
    v_cvt_pk_bf16_f32 v52, v36, v37
    v_mfma_f32_16x16x32_bf16 v[20:23], a[68:71], v[168:171], v[20:23]
    ds_read_b64_tr_b16 a[114:115], v3 offset:53920
    v_cvt_pk_bf16_f32 v53, v38, v39
    v_mfma_f32_16x16x32_bf16 v[20:23], a[72:75], v[176:179], v[20:23]
    ds_read_b64_tr_b16 a[116:117], v3 offset:54048
    v_cvt_pk_bf16_f32 v54, v44, v45
    v_mfma_f32_16x16x32_bf16 v[20:23], a[76:79], v[184:187], v[20:23]
    ds_read_b64_tr_b16 a[118:119], v3 offset:54176
    v_cvt_pk_bf16_f32 v55, v46, v47
    v_mfma_f32_16x16x32_bf16 v[20:23], a[80:83], v[224:227], v[20:23]
    s_mov_b32 s54, 296960
    ds_read_b64_tr_b16 a[120:121], v3 offset:54304
    ds_read_b64_tr_b16 a[122:123], v3 offset:54432
    v_mfma_f32_16x16x32_bf16 v[20:23], a[84:87], v[232:235], v[20:23]
    v_permlane32_swap_b32 v52, v54
    v_mfma_f32_16x16x32_bf16 v[20:23], a[88:91], v[240:243], v[20:23]
    v_permlane32_swap_b32 v53, v55
    v_mfma_f32_16x16x32_bf16 v[20:23], a[92:95], v[248:251], v[20:23]
    s_waitcnt lgkmcnt(10)
    ds_read_b64_tr_b16 a[124:125], v3 offset:54560
    ds_read_b64_tr_b16 a[126:127], v3 offset:54688
    buffer_store_dwordx4 v[52:55], v10, s[40:43], s54 offen offset:512 sc1
    v_mfma_f32_16x16x32_bf16 v[24:27], a[96:99], v[128:131], 0
    ds_read_b64_tr_b16 a[64:65], v3 offset:36928
    v_add_u32 v111, s3, v111
    v_mfma_f32_16x16x32_bf16 v[24:27], a[100:103], v[136:139], v[24:27]
    s_waitcnt lgkmcnt(9)
    ds_read_b64_tr_b16 a[66:67], v3 offset:37056
    v_mfma_f32_16x16x32_bf16 v[24:27], a[104:107], v[144:147], v[24:27]
    ds_read_b64_tr_b16 a[68:69], v3 offset:37184
    v_mfma_f32_16x16x32_bf16 v[24:27], a[108:111], v[152:155], v[24:27]
    s_waitcnt lgkmcnt(7)
    ds_read_b64_tr_b16 a[70:71], v3 offset:37312
    v_mfma_f32_16x16x32_bf16 v[24:27], a[112:115], v[192:195], v[24:27]
    ds_read_b64_tr_b16 a[72:73], v3 offset:37440
    v_mfma_f32_16x16x32_bf16 v[24:27], a[116:119], v[200:203], v[24:27]
    s_waitcnt lgkmcnt(5)
    ds_read_b64_tr_b16 a[74:75], v3 offset:37568
    v_mfma_f32_16x16x32_bf16 v[24:27], a[120:123], v[208:211], v[24:27]
    ds_read_b64_tr_b16 a[76:77], v3 offset:37696
    v_mfma_f32_16x16x32_bf16 v[24:27], a[124:127], v[216:219], v[24:27]
    ds_read_b64_tr_b16 a[78:79], v3 offset:37824
    v_mfma_f32_16x16x32_bf16 v[28:31], a[96:99], v[160:163], 0
    ds_read_b64_tr_b16 a[80:81], v3 offset:53824
    v_mfma_f32_16x16x32_bf16 v[28:31], a[100:103], v[168:171], v[28:31]
    ds_read_b64_tr_b16 a[82:83], v3 offset:53952
    v_mfma_f32_16x16x32_bf16 v[28:31], a[104:107], v[176:179], v[28:31]
    ds_read_b64_tr_b16 a[84:85], v3 offset:54080
    v_mfma_f32_16x16x32_bf16 v[28:31], a[108:111], v[184:187], v[28:31]
    ds_read_b64_tr_b16 a[86:87], v3 offset:54208
    v_mfma_f32_16x16x32_bf16 v[28:31], a[112:115], v[224:227], v[28:31]
    ds_read_b64_tr_b16 a[88:89], v3 offset:54336
    v_mfma_f32_16x16x32_bf16 v[28:31], a[116:119], v[232:235], v[28:31]
    ds_read_b64_tr_b16 a[90:91], v3 offset:54464
    v_mfma_f32_16x16x32_bf16 v[28:31], a[120:123], v[240:243], v[28:31]
    ds_read_b64_tr_b16 a[92:93], v3 offset:54592
    v_mfma_f32_16x16x32_bf16 v[28:31], a[124:127], v[248:251], v[28:31]
    s_waitcnt lgkmcnt(11)
    ds_read_b64_tr_b16 a[94:95], v3 offset:54720
    v_mfma_f32_16x16x32_bf16 v[32:35], a[64:67], v[128:131], 0
    ds_read_b64_tr_b16 a[96:97], v3 offset:36960
    v_cvt_pk_bf16_f32 v48, v16, v17
    v_mfma_f32_16x16x32_bf16 v[32:35], a[68:71], v[136:139], v[32:35]
    s_waitcnt lgkmcnt(9)
    ds_read_b64_tr_b16 a[98:99], v3 offset:37088
    v_cvt_pk_bf16_f32 v49, v18, v19
    v_mfma_f32_16x16x32_bf16 v[32:35], a[72:75], v[144:147], v[32:35]
    ds_read_b64_tr_b16 a[100:101], v3 offset:37216
    v_cvt_pk_bf16_f32 v50, v24, v25
    v_mfma_f32_16x16x32_bf16 v[32:35], a[76:79], v[152:155], v[32:35]
    s_waitcnt lgkmcnt(7)
    ds_read_b64_tr_b16 a[102:103], v3 offset:37344
    v_cvt_pk_bf16_f32 v51, v26, v27
    v_mfma_f32_16x16x32_bf16 v[32:35], a[80:83], v[192:195], v[32:35]
    s_mov_b32 s54, 3072
    ds_read_b64_tr_b16 a[104:105], v3 offset:37472
    ds_read_b64_tr_b16 a[106:107], v3 offset:37600
    v_mfma_f32_16x16x32_bf16 v[32:35], a[84:87], v[200:203], v[32:35]
    s_waitcnt lgkmcnt(6)
    v_permlane32_swap_b32 v48, v50
    v_mfma_f32_16x16x32_bf16 v[32:35], a[88:91], v[208:211], v[32:35]
    v_permlane32_swap_b32 v49, v51
    v_mfma_f32_16x16x32_bf16 v[32:35], a[92:95], v[216:219], v[32:35]
    ds_read_b64_tr_b16 a[108:109], v3 offset:37728
    ds_read_b64_tr_b16 a[110:111], v3 offset:37856
    buffer_store_dwordx4 v[48:51], v10, s[40:43], s54 offen offset:0 sc1
    v_mfma_f32_16x16x32_bf16 v[36:39], a[64:67], v[160:163], 0
    ds_read_b64_tr_b16 a[112:113], v3 offset:53856
    v_cvt_pk_bf16_f32 v52, v20, v21
    v_mfma_f32_16x16x32_bf16 v[36:39], a[68:71], v[168:171], v[36:39]
    ds_read_b64_tr_b16 a[114:115], v3 offset:53984
    v_cvt_pk_bf16_f32 v53, v22, v23
    v_mfma_f32_16x16x32_bf16 v[36:39], a[72:75], v[176:179], v[36:39]
    ds_read_b64_tr_b16 a[116:117], v3 offset:54112
    v_cvt_pk_bf16_f32 v54, v28, v29
    v_mfma_f32_16x16x32_bf16 v[36:39], a[76:79], v[184:187], v[36:39]
    ds_read_b64_tr_b16 a[118:119], v3 offset:54240
    v_cvt_pk_bf16_f32 v55, v30, v31
    v_mfma_f32_16x16x32_bf16 v[36:39], a[80:83], v[224:227], v[36:39]
    s_mov_b32 s54, 297984
    ds_read_b64_tr_b16 a[120:121], v3 offset:54368
    ds_read_b64_tr_b16 a[122:123], v3 offset:54496
    v_mfma_f32_16x16x32_bf16 v[36:39], a[84:87], v[232:235], v[36:39]
    v_permlane32_swap_b32 v52, v54
    v_mfma_f32_16x16x32_bf16 v[36:39], a[88:91], v[240:243], v[36:39]
    v_permlane32_swap_b32 v53, v55
    v_mfma_f32_16x16x32_bf16 v[36:39], a[92:95], v[248:251], v[36:39]
    s_waitcnt vmcnt(15)
    s_barrier
    s_waitcnt lgkmcnt(10)
    ds_read_b64_tr_b16 a[124:125], v3 offset:54624
    ds_read_b64_tr_b16 a[126:127], v3 offset:54752
    buffer_store_dwordx4 v[52:55], v10, s[40:43], s54 offen offset:0 sc1
    v_mfma_f32_16x16x32_bf16 v[40:43], a[96:99], v[128:131], 0
    s_add_u32 m0, s44, 0
    ds_read_b64_tr_b16 a[64:65], v4 offset:0
    ds_read_b64_tr_b16 a[66:67], v4 offset:128
    v_mfma_f32_16x16x32_bf16 v[40:43], a[100:103], v[136:139], v[40:43]
    s_mov_b32 s45, 768
    s_waitcnt lgkmcnt(10)
    buffer_load_dwordx4 v7, s[28:31], s45 offen offset:0 lds
    v_mfma_f32_16x16x32_bf16 v[40:43], a[104:107], v[144:147], v[40:43]
    s_add_u32 m0, s44, -96
    ds_read_b64_tr_b16 a[68:69], v4 offset:256
    ds_read_b64_tr_b16 a[70:71], v4 offset:384
    v_mfma_f32_16x16x32_bf16 v[40:43], a[108:111], v[152:155], v[40:43]
    s_waitcnt lgkmcnt(8)
    buffer_load_dwordx4 v7, s[28:31], s45 offen offset:1152 lds
    v_mfma_f32_16x16x32_bf16 v[40:43], a[112:115], v[192:195], v[40:43]
    s_add_u32 m0, s44, -192
    ds_read_b64_tr_b16 a[72:73], v4 offset:512
    ds_read_b64_tr_b16 a[74:75], v4 offset:640
    v_mfma_f32_16x16x32_bf16 v[40:43], a[116:119], v[200:203], v[40:43]
    s_waitcnt lgkmcnt(6)
    buffer_load_dwordx4 v7, s[28:31], s45 offen offset:2304 lds
    v_mfma_f32_16x16x32_bf16 v[40:43], a[120:123], v[208:211], v[40:43]
    s_add_u32 m0, s44, -288
    ds_read_b64_tr_b16 a[76:77], v4 offset:768
    ds_read_b64_tr_b16 a[78:79], v4 offset:896
    v_mfma_f32_16x16x32_bf16 v[40:43], a[124:127], v[216:219], v[40:43]
    buffer_load_dwordx4 v7, s[28:31], s45 offen offset:3456 lds
    v_mfma_f32_16x16x32_bf16 v[44:47], a[96:99], v[160:163], 0
    s_add_u32 m0, s44, 16896
    ds_read_b64_tr_b16 a[80:81], v4 offset:16896
    ds_read_b64_tr_b16 a[82:83], v4 offset:17024
    v_mfma_f32_16x16x32_bf16 v[44:47], a[100:103], v[168:171], v[44:47]
    s_mov_b32 s45, 148224
    buffer_load_dwordx4 v7, s[28:31], s45 offen offset:0 lds
    v_mfma_f32_16x16x32_bf16 v[44:47], a[104:107], v[176:179], v[44:47]
    s_add_u32 m0, s44, 16800
    ds_read_b64_tr_b16 a[84:85], v4 offset:17152
    ds_read_b64_tr_b16 a[86:87], v4 offset:17280
    v_mfma_f32_16x16x32_bf16 v[44:47], a[108:111], v[184:187], v[44:47]
    buffer_load_dwordx4 v7, s[28:31], s45 offen offset:1152 lds
    v_mfma_f32_16x16x32_bf16 v[44:47], a[112:115], v[224:227], v[44:47]
    s_add_u32 m0, s44, 16704
    ds_read_b64_tr_b16 a[88:89], v4 offset:17408
    ds_read_b64_tr_b16 a[90:91], v4 offset:17536
    v_mfma_f32_16x16x32_bf16 v[44:47], a[116:119], v[232:235], v[44:47]
    buffer_load_dwordx4 v7, s[28:31], s45 offen offset:2304 lds
    v_mfma_f32_16x16x32_bf16 v[44:47], a[120:123], v[240:243], v[44:47]
    s_add_u32 m0, s44, 16608
    ds_read_b64_tr_b16 a[92:93], v4 offset:17664
    ds_read_b64_tr_b16 a[94:95], v4 offset:17792
    v_mfma_f32_16x16x32_bf16 v[44:47], a[124:127], v[248:251], v[44:47]
    s_waitcnt lgkmcnt(12)
    buffer_load_dwordx4 v7, s[28:31], s45 offen offset:3456 lds
    v_mfma_f32_16x16x32_bf16 v[16:19], a[64:67], v[128:131], 0
    ds_read_b64_tr_b16 a[96:97], v4 offset:32
    v_cvt_pk_bf16_f32 v48, v32, v33
    v_mfma_f32_16x16x32_bf16 v[16:19], a[68:71], v[136:139], v[16:19]
    s_waitcnt lgkmcnt(9)
    ds_read_b64_tr_b16 a[98:99], v4 offset:160
    v_cvt_pk_bf16_f32 v49, v34, v35
    v_mfma_f32_16x16x32_bf16 v[16:19], a[72:75], v[144:147], v[16:19]
    ds_read_b64_tr_b16 a[100:101], v4 offset:288
    v_cvt_pk_bf16_f32 v50, v40, v41
    v_mfma_f32_16x16x32_bf16 v[16:19], a[76:79], v[152:155], v[16:19]
    s_waitcnt lgkmcnt(7)
    ds_read_b64_tr_b16 a[102:103], v4 offset:416
    v_cvt_pk_bf16_f32 v51, v42, v43
    v_mfma_f32_16x16x32_bf16 v[16:19], a[80:83], v[192:195], v[16:19]
    s_mov_b32 s54, 3072
    ds_read_b64_tr_b16 a[104:105], v4 offset:544
    ds_read_b64_tr_b16 a[106:107], v4 offset:672
    v_mfma_f32_16x16x32_bf16 v[16:19], a[84:87], v[200:203], v[16:19]
    s_waitcnt lgkmcnt(6)
    v_permlane32_swap_b32 v48, v50
    v_mfma_f32_16x16x32_bf16 v[16:19], a[88:91], v[208:211], v[16:19]
    v_permlane32_swap_b32 v49, v51
    v_mfma_f32_16x16x32_bf16 v[16:19], a[92:95], v[216:219], v[16:19]
    ds_read_b64_tr_b16 a[108:109], v4 offset:800
    ds_read_b64_tr_b16 a[110:111], v4 offset:928
    buffer_store_dwordx4 v[48:51], v10, s[40:43], s54 offen offset:512 sc1
    v_mfma_f32_16x16x32_bf16 v[20:23], a[64:67], v[160:163], 0
    ds_read_b64_tr_b16 a[112:113], v4 offset:16928
    v_cvt_pk_bf16_f32 v52, v36, v37
    v_mfma_f32_16x16x32_bf16 v[20:23], a[68:71], v[168:171], v[20:23]
    ds_read_b64_tr_b16 a[114:115], v4 offset:17056
    v_cvt_pk_bf16_f32 v53, v38, v39
    v_mfma_f32_16x16x32_bf16 v[20:23], a[72:75], v[176:179], v[20:23]
    ds_read_b64_tr_b16 a[116:117], v4 offset:17184
    v_cvt_pk_bf16_f32 v54, v44, v45
    v_mfma_f32_16x16x32_bf16 v[20:23], a[76:79], v[184:187], v[20:23]
    ds_read_b64_tr_b16 a[118:119], v4 offset:17312
    v_cvt_pk_bf16_f32 v55, v46, v47
    v_mfma_f32_16x16x32_bf16 v[20:23], a[80:83], v[224:227], v[20:23]
    s_mov_b32 s54, 297984
    ds_read_b64_tr_b16 a[120:121], v4 offset:17440
    ds_read_b64_tr_b16 a[122:123], v4 offset:17568
    v_mfma_f32_16x16x32_bf16 v[20:23], a[84:87], v[232:235], v[20:23]
    v_permlane32_swap_b32 v52, v54
    v_mfma_f32_16x16x32_bf16 v[20:23], a[88:91], v[240:243], v[20:23]
    v_permlane32_swap_b32 v53, v55
    v_mfma_f32_16x16x32_bf16 v[20:23], a[92:95], v[248:251], v[20:23]
    s_waitcnt lgkmcnt(10)
    ds_read_b64_tr_b16 a[124:125], v4 offset:17696
    ds_read_b64_tr_b16 a[126:127], v4 offset:17824
    buffer_store_dwordx4 v[52:55], v10, s[40:43], s54 offen offset:512 sc1
    v_mfma_f32_16x16x32_bf16 v[24:27], a[96:99], v[128:131], 0
    ds_read_b64_tr_b16 a[64:65], v4 offset:64
    v_mfma_f32_16x16x32_bf16 v[24:27], a[100:103], v[136:139], v[24:27]
    s_waitcnt lgkmcnt(9)
    ds_read_b64_tr_b16 a[66:67], v4 offset:192
    v_mfma_f32_16x16x32_bf16 v[24:27], a[104:107], v[144:147], v[24:27]
    ds_read_b64_tr_b16 a[68:69], v4 offset:320
    v_mfma_f32_16x16x32_bf16 v[24:27], a[108:111], v[152:155], v[24:27]
    s_waitcnt lgkmcnt(7)
    ds_read_b64_tr_b16 a[70:71], v4 offset:448
    v_mfma_f32_16x16x32_bf16 v[24:27], a[112:115], v[192:195], v[24:27]
    ds_read_b64_tr_b16 a[72:73], v4 offset:576
    v_mfma_f32_16x16x32_bf16 v[24:27], a[116:119], v[200:203], v[24:27]
    s_waitcnt lgkmcnt(5)
    ds_read_b64_tr_b16 a[74:75], v4 offset:704
    v_mfma_f32_16x16x32_bf16 v[24:27], a[120:123], v[208:211], v[24:27]
    ds_read_b64_tr_b16 a[76:77], v4 offset:832
    v_mfma_f32_16x16x32_bf16 v[24:27], a[124:127], v[216:219], v[24:27]
    ds_read_b64_tr_b16 a[78:79], v4 offset:960
    v_mfma_f32_16x16x32_bf16 v[28:31], a[96:99], v[160:163], 0
    ds_read_b64_tr_b16 a[80:81], v4 offset:16960
    v_mfma_f32_16x16x32_bf16 v[28:31], a[100:103], v[168:171], v[28:31]
    ds_read_b64_tr_b16 a[82:83], v4 offset:17088
    v_mfma_f32_16x16x32_bf16 v[28:31], a[104:107], v[176:179], v[28:31]
    ds_read_b64_tr_b16 a[84:85], v4 offset:17216
    v_mfma_f32_16x16x32_bf16 v[28:31], a[108:111], v[184:187], v[28:31]
    ds_read_b64_tr_b16 a[86:87], v4 offset:17344
    v_mfma_f32_16x16x32_bf16 v[28:31], a[112:115], v[224:227], v[28:31]
    ds_read_b64_tr_b16 a[88:89], v4 offset:17472
    v_mfma_f32_16x16x32_bf16 v[28:31], a[116:119], v[232:235], v[28:31]
    ds_read_b64_tr_b16 a[90:91], v4 offset:17600
    v_mfma_f32_16x16x32_bf16 v[28:31], a[120:123], v[240:243], v[28:31]
    ds_read_b64_tr_b16 a[92:93], v4 offset:17728
    v_mfma_f32_16x16x32_bf16 v[28:31], a[124:127], v[248:251], v[28:31]
    s_waitcnt lgkmcnt(11)
    ds_read_b64_tr_b16 a[94:95], v4 offset:17856
    v_mfma_f32_16x16x32_bf16 v[32:35], a[64:67], v[128:131], 0
    ds_read_b64_tr_b16 a[96:97], v4 offset:96
    v_cvt_pk_bf16_f32 v48, v16, v17
    v_mfma_f32_16x16x32_bf16 v[32:35], a[68:71], v[136:139], v[32:35]
    s_waitcnt lgkmcnt(9)
    ds_read_b64_tr_b16 a[98:99], v4 offset:224
    v_cvt_pk_bf16_f32 v49, v18, v19
    v_mfma_f32_16x16x32_bf16 v[32:35], a[72:75], v[144:147], v[32:35]
    ds_read_b64_tr_b16 a[100:101], v4 offset:352
    v_cvt_pk_bf16_f32 v50, v24, v25
    v_mfma_f32_16x16x32_bf16 v[32:35], a[76:79], v[152:155], v[32:35]
    s_waitcnt lgkmcnt(7)
    ds_read_b64_tr_b16 a[102:103], v4 offset:480
    v_cvt_pk_bf16_f32 v51, v26, v27
    v_mfma_f32_16x16x32_bf16 v[32:35], a[80:83], v[192:195], v[32:35]
    s_mov_b32 s54, 4096
    ds_read_b64_tr_b16 a[104:105], v4 offset:608
    ds_read_b64_tr_b16 a[106:107], v4 offset:736
    v_mfma_f32_16x16x32_bf16 v[32:35], a[84:87], v[200:203], v[32:35]
    s_waitcnt lgkmcnt(6)
    v_permlane32_swap_b32 v48, v50
    v_mfma_f32_16x16x32_bf16 v[32:35], a[88:91], v[208:211], v[32:35]
    v_permlane32_swap_b32 v49, v51
    v_mfma_f32_16x16x32_bf16 v[32:35], a[92:95], v[216:219], v[32:35]
    ds_read_b64_tr_b16 a[108:109], v4 offset:864
    ds_read_b64_tr_b16 a[110:111], v4 offset:992
    buffer_store_dwordx4 v[48:51], v10, s[40:43], s54 offen offset:0 sc1
    v_mfma_f32_16x16x32_bf16 v[36:39], a[64:67], v[160:163], 0
    ds_read_b64_tr_b16 a[112:113], v4 offset:16992
    v_cvt_pk_bf16_f32 v52, v20, v21
    v_mfma_f32_16x16x32_bf16 v[36:39], a[68:71], v[168:171], v[36:39]
    ds_read_b64_tr_b16 a[114:115], v4 offset:17120
    v_cvt_pk_bf16_f32 v53, v22, v23
    v_mfma_f32_16x16x32_bf16 v[36:39], a[72:75], v[176:179], v[36:39]
    ds_read_b64_tr_b16 a[116:117], v4 offset:17248
    v_cvt_pk_bf16_f32 v54, v28, v29
    v_mfma_f32_16x16x32_bf16 v[36:39], a[76:79], v[184:187], v[36:39]
    ds_read_b64_tr_b16 a[118:119], v4 offset:17376
    v_cvt_pk_bf16_f32 v55, v30, v31
    v_mfma_f32_16x16x32_bf16 v[36:39], a[80:83], v[224:227], v[36:39]
    s_mov_b32 s54, 299008
    ds_read_b64_tr_b16 a[120:121], v4 offset:17504
    ds_read_b64_tr_b16 a[122:123], v4 offset:17632
    v_mfma_f32_16x16x32_bf16 v[36:39], a[84:87], v[232:235], v[36:39]
    v_permlane32_swap_b32 v52, v54
    v_mfma_f32_16x16x32_bf16 v[36:39], a[88:91], v[240:243], v[36:39]
    v_permlane32_swap_b32 v53, v55
    v_mfma_f32_16x16x32_bf16 v[36:39], a[92:95], v[248:251], v[36:39]
    s_waitcnt vmcnt(15)
    s_barrier
    s_waitcnt lgkmcnt(10)
    ds_read_b64_tr_b16 a[124:125], v4 offset:17760
    ds_read_b64_tr_b16 a[126:127], v4 offset:17888
    buffer_store_dwordx4 v[52:55], v10, s[40:43], s54 offen offset:0 sc1
    v_mfma_f32_16x16x32_bf16 v[40:43], a[96:99], v[128:131], 0
    s_add_u32 m0, s44, 36864
    ds_read_b64_tr_b16 a[64:65], v4 offset:36864
    ds_read_b64_tr_b16 a[66:67], v4 offset:36992
    v_mfma_f32_16x16x32_bf16 v[40:43], a[100:103], v[136:139], v[40:43]
    s_mov_b32 s45, 896
    s_waitcnt lgkmcnt(10)
    buffer_load_dwordx4 v7, s[28:31], s45 offen offset:0 lds
    v_mfma_f32_16x16x32_bf16 v[40:43], a[104:107], v[144:147], v[40:43]
    s_add_u32 m0, s44, 36768
    ds_read_b64_tr_b16 a[68:69], v4 offset:37120
    ds_read_b64_tr_b16 a[70:71], v4 offset:37248
    v_mfma_f32_16x16x32_bf16 v[40:43], a[108:111], v[152:155], v[40:43]
    s_waitcnt lgkmcnt(8)
    buffer_load_dwordx4 v7, s[28:31], s45 offen offset:1152 lds
    v_mfma_f32_16x16x32_bf16 v[40:43], a[112:115], v[192:195], v[40:43]
    s_add_u32 m0, s44, 36672
    ds_read_b64_tr_b16 a[72:73], v4 offset:37376
    ds_read_b64_tr_b16 a[74:75], v4 offset:37504
    v_mfma_f32_16x16x32_bf16 v[40:43], a[116:119], v[200:203], v[40:43]
    s_waitcnt lgkmcnt(6)
    buffer_load_dwordx4 v7, s[28:31], s45 offen offset:2304 lds
    v_mfma_f32_16x16x32_bf16 v[40:43], a[120:123], v[208:211], v[40:43]
    s_add_u32 m0, s44, 36576
    ds_read_b64_tr_b16 a[76:77], v4 offset:37632
    ds_read_b64_tr_b16 a[78:79], v4 offset:37760
    v_mfma_f32_16x16x32_bf16 v[40:43], a[124:127], v[216:219], v[40:43]
    buffer_load_dwordx4 v7, s[28:31], s45 offen offset:3456 lds
    v_mfma_f32_16x16x32_bf16 v[44:47], a[96:99], v[160:163], 0
    s_add_u32 m0, s44, 53760
    ds_read_b64_tr_b16 a[80:81], v4 offset:53760
    ds_read_b64_tr_b16 a[82:83], v4 offset:53888
    v_mfma_f32_16x16x32_bf16 v[44:47], a[100:103], v[168:171], v[44:47]
    s_mov_b32 s45, 148352
    buffer_load_dwordx4 v7, s[28:31], s45 offen offset:0 lds
    v_mfma_f32_16x16x32_bf16 v[44:47], a[104:107], v[176:179], v[44:47]
    s_add_u32 m0, s44, 53664
    ds_read_b64_tr_b16 a[84:85], v4 offset:54016
    ds_read_b64_tr_b16 a[86:87], v4 offset:54144
    v_mfma_f32_16x16x32_bf16 v[44:47], a[108:111], v[184:187], v[44:47]
    buffer_load_dwordx4 v7, s[28:31], s45 offen offset:1152 lds
    v_mfma_f32_16x16x32_bf16 v[44:47], a[112:115], v[224:227], v[44:47]
    s_add_u32 m0, s44, 53568
    ds_read_b64_tr_b16 a[88:89], v4 offset:54272
    ds_read_b64_tr_b16 a[90:91], v4 offset:54400
    v_mfma_f32_16x16x32_bf16 v[44:47], a[116:119], v[232:235], v[44:47]
    buffer_load_dwordx4 v7, s[28:31], s45 offen offset:2304 lds
    v_mfma_f32_16x16x32_bf16 v[44:47], a[120:123], v[240:243], v[44:47]
    s_add_u32 m0, s44, 53472
    ds_read_b64_tr_b16 a[92:93], v4 offset:54528
    ds_read_b64_tr_b16 a[94:95], v4 offset:54656
    v_mfma_f32_16x16x32_bf16 v[44:47], a[124:127], v[248:251], v[44:47]
    s_waitcnt lgkmcnt(12)
    buffer_load_dwordx4 v7, s[28:31], s45 offen offset:3456 lds
    v_mfma_f32_16x16x32_bf16 v[16:19], a[64:67], v[128:131], 0
    ds_read_b64_tr_b16 a[96:97], v4 offset:36896
    v_cvt_pk_bf16_f32 v48, v32, v33
    v_mfma_f32_16x16x32_bf16 v[16:19], a[68:71], v[136:139], v[16:19]
    s_waitcnt lgkmcnt(9)
    ds_read_b64_tr_b16 a[98:99], v4 offset:37024
    v_cvt_pk_bf16_f32 v49, v34, v35
    v_mfma_f32_16x16x32_bf16 v[16:19], a[72:75], v[144:147], v[16:19]
    ds_read_b64_tr_b16 a[100:101], v4 offset:37152
    v_cvt_pk_bf16_f32 v50, v40, v41
    v_mfma_f32_16x16x32_bf16 v[16:19], a[76:79], v[152:155], v[16:19]
    s_waitcnt lgkmcnt(7)
    ds_read_b64_tr_b16 a[102:103], v4 offset:37280
    v_cvt_pk_bf16_f32 v51, v42, v43
    v_mfma_f32_16x16x32_bf16 v[16:19], a[80:83], v[192:195], v[16:19]
    s_mov_b32 s54, 4096
    ds_read_b64_tr_b16 a[104:105], v4 offset:37408
    ds_read_b64_tr_b16 a[106:107], v4 offset:37536
    v_mfma_f32_16x16x32_bf16 v[16:19], a[84:87], v[200:203], v[16:19]
    s_waitcnt lgkmcnt(6)
    v_permlane32_swap_b32 v48, v50
    v_mfma_f32_16x16x32_bf16 v[16:19], a[88:91], v[208:211], v[16:19]
    v_permlane32_swap_b32 v49, v51
    v_mfma_f32_16x16x32_bf16 v[16:19], a[92:95], v[216:219], v[16:19]
    ds_read_b64_tr_b16 a[108:109], v4 offset:37664
    ds_read_b64_tr_b16 a[110:111], v4 offset:37792
    buffer_store_dwordx4 v[48:51], v10, s[40:43], s54 offen offset:512 sc1
    v_mfma_f32_16x16x32_bf16 v[20:23], a[64:67], v[160:163], 0
    ds_read_b64_tr_b16 a[112:113], v4 offset:53792
    v_cvt_pk_bf16_f32 v52, v36, v37
    v_mfma_f32_16x16x32_bf16 v[20:23], a[68:71], v[168:171], v[20:23]
    ds_read_b64_tr_b16 a[114:115], v4 offset:53920
    v_cvt_pk_bf16_f32 v53, v38, v39
    v_mfma_f32_16x16x32_bf16 v[20:23], a[72:75], v[176:179], v[20:23]
    ds_read_b64_tr_b16 a[116:117], v4 offset:54048
    v_cvt_pk_bf16_f32 v54, v44, v45
    v_mfma_f32_16x16x32_bf16 v[20:23], a[76:79], v[184:187], v[20:23]
    ds_read_b64_tr_b16 a[118:119], v4 offset:54176
    v_cvt_pk_bf16_f32 v55, v46, v47
    v_mfma_f32_16x16x32_bf16 v[20:23], a[80:83], v[224:227], v[20:23]
    s_mov_b32 s54, 299008
    ds_read_b64_tr_b16 a[120:121], v4 offset:54304
    ds_read_b64_tr_b16 a[122:123], v4 offset:54432
    v_mfma_f32_16x16x32_bf16 v[20:23], a[84:87], v[232:235], v[20:23]
    v_permlane32_swap_b32 v52, v54
    v_mfma_f32_16x16x32_bf16 v[20:23], a[88:91], v[240:243], v[20:23]
    v_permlane32_swap_b32 v53, v55
    v_mfma_f32_16x16x32_bf16 v[20:23], a[92:95], v[248:251], v[20:23]
    s_waitcnt lgkmcnt(10)
    ds_read_b64_tr_b16 a[124:125], v4 offset:54560
    ds_read_b64_tr_b16 a[126:127], v4 offset:54688
    buffer_store_dwordx4 v[52:55], v10, s[40:43], s54 offen offset:512 sc1
    v_mfma_f32_16x16x32_bf16 v[24:27], a[96:99], v[128:131], 0
L2_pad12:
    s_cbranch_execz L2_walkret
    ds_read_b64_tr_b16 a[64:65], v4 offset:36928
    v_mfma_f32_16x16x32_bf16 v[24:27], a[100:103], v[136:139], v[24:27]
    s_waitcnt lgkmcnt(9)
    ds_read_b64_tr_b16 a[66:67], v4 offset:37056
    v_mfma_f32_16x16x32_bf16 v[24:27], a[104:107], v[144:147], v[24:27]
    ds_read_b64_tr_b16 a[68:69], v4 offset:37184
    v_mfma_f32_16x16x32_bf16 v[24:27], a[108:111], v[152:155], v[24:27]
    s_waitcnt lgkmcnt(7)
    ds_read_b64_tr_b16 a[70:71], v4 offset:37312
    v_mfma_f32_16x16x32_bf16 v[24:27], a[112:115], v[192:195], v[24:27]
    ds_read_b64_tr_b16 a[72:73], v4 offset:37440
    v_mfma_f32_16x16x32_bf16 v[24:27], a[116:119], v[200:203], v[24:27]
    s_waitcnt lgkmcnt(5)
    ds_read_b64_tr_b16 a[74:75], v4 offset:37568
    v_mfma_f32_16x16x32_bf16 v[24:27], a[120:123], v[208:211], v[24:27]
    ds_read_b64_tr_b16 a[76:77], v4 offset:37696
    v_mfma_f32_16x16x32_bf16 v[24:27], a[124:127], v[216:219], v[24:27]
    ds_read_b64_tr_b16 a[78:79], v4 offset:37824
    v_mfma_f32_16x16x32_bf16 v[28:31], a[96:99], v[160:163], 0
    ds_read_b64_tr_b16 a[80:81], v4 offset:53824
    v_mfma_f32_16x16x32_bf16 v[28:31], a[100:103], v[168:171], v[28:31]
    ds_read_b64_tr_b16 a[82:83], v4 offset:53952
    v_mfma_f32_16x16x32_bf16 v[28:31], a[104:107], v[176:179], v[28:31]
    ds_read_b64_tr_b16 a[84:85], v4 offset:54080
    v_mfma_f32_16x16x32_bf16 v[28:31], a[108:111], v[184:187], v[28:31]
    ds_read_b64_tr_b16 a[86:87], v4 offset:54208
    v_mfma_f32_16x16x32_bf16 v[28:31], a[112:115], v[224:227], v[28:31]
    ds_read_b64_tr_b16 a[88:89], v4 offset:54336
    v_mfma_f32_16x16x32_bf16 v[28:31], a[116:119], v[232:235], v[28:31]
    ds_read_b64_tr_b16 a[90:91], v4 offset:54464
    v_mfma_f32_16x16x32_bf16 v[28:31], a[120:123], v[240:243], v[28:31]
    ds_read_b64_tr_b16 a[92:93], v4 offset:54592
    v_mfma_f32_16x16x32_bf16 v[28:31], a[124:127], v[248:251], v[28:31]
    s_waitcnt lgkmcnt(11)
    ds_read_b64_tr_b16 a[94:95], v4 offset:54720
    v_mfma_f32_16x16x32_bf16 v[32:35], a[64:67], v[128:131], 0
    ds_read_b64_tr_b16 a[96:97], v4 offset:36960
    v_cvt_pk_bf16_f32 v48, v16, v17
    v_mfma_f32_16x16x32_bf16 v[32:35], a[68:71], v[136:139], v[32:35]
    s_waitcnt lgkmcnt(9)
    ds_read_b64_tr_b16 a[98:99], v4 offset:37088
    v_cvt_pk_bf16_f32 v49, v18, v19
    v_mfma_f32_16x16x32_bf16 v[32:35], a[72:75], v[144:147], v[32:35]
    ds_read_b64_tr_b16 a[100:101], v4 offset:37216
    v_cvt_pk_bf16_f32 v50, v24, v25
    v_mfma_f32_16x16x32_bf16 v[32:35], a[76:79], v[152:155], v[32:35]
    s_waitcnt lgkmcnt(7)
    ds_read_b64_tr_b16 a[102:103], v4 offset:37344
    v_cvt_pk_bf16_f32 v51, v26, v27
    v_mfma_f32_16x16x32_bf16 v[32:35], a[80:83], v[192:195], v[32:35]
    s_mov_b32 s54, 5120
    ds_read_b64_tr_b16 a[104:105], v4 offset:37472
    ds_read_b64_tr_b16 a[106:107], v4 offset:37600
    v_mfma_f32_16x16x32_bf16 v[32:35], a[84:87], v[200:203], v[32:35]
    s_waitcnt lgkmcnt(6)
    v_permlane32_swap_b32 v48, v50
    v_mfma_f32_16x16x32_bf16 v[32:35], a[88:91], v[208:211], v[32:35]
    v_permlane32_swap_b32 v49, v51
    v_mfma_f32_16x16x32_bf16 v[32:35], a[92:95], v[216:219], v[32:35]
    ds_read_b64_tr_b16 a[108:109], v4 offset:37728
    ds_read_b64_tr_b16 a[110:111], v4 offset:37856
    buffer_store_dwordx4 v[48:51], v10, s[40:43], s54 offen offset:0 sc1
    v_mfma_f32_16x16x32_bf16 v[36:39], a[64:67], v[160:163], 0
    ds_read_b64_tr_b16 a[112:113], v4 offset:53856
    v_cvt_pk_bf16_f32 v52, v20, v21
    v_mfma_f32_16x16x32_bf16 v[36:39], a[68:71], v[168:171], v[36:39]
    ds_read_b64_tr_b16 a[114:115], v4 offset:53984
    v_cvt_pk_bf16_f32 v53, v22, v23
    v_mfma_f32_16x16x32_bf16 v[36:39], a[72:75], v[176:179], v[36:39]
    ds_read_b64_tr_b16 a[116:117], v4 offset:54112
    v_cvt_pk_bf16_f32 v54, v28, v29
    v_mfma_f32_16x16x32_bf16 v[36:39], a[76:79], v[184:187], v[36:39]
    ds_read_b64_tr_b16 a[118:119], v4 offset:54240
    v_cvt_pk_bf16_f32 v55, v30, v31
    v_mfma_f32_16x16x32_bf16 v[36:39], a[80:83], v[224:227], v[36:39]
    s_mov_b32 s54, 300032
    ds_read_b64_tr_b16 a[120:121], v4 offset:54368
    ds_read_b64_tr_b16 a[122:123], v4 offset:54496
    v_mfma_f32_16x16x32_bf16 v[36:39], a[84:87], v[232:235], v[36:39]
    v_permlane32_swap_b32 v52, v54
    v_mfma_f32_16x16x32_bf16 v[36:39], a[88:91], v[240:243], v[36:39]
    v_permlane32_swap_b32 v53, v55
    v_mfma_f32_16x16x32_bf16 v[36:39], a[92:95], v[248:251], v[36:39]
    s_waitcnt vmcnt(15)
    s_barrier
    s_waitcnt lgkmcnt(10)
    ds_read_b64_tr_b16 a[124:125], v4 offset:54624
    ds_read_b64_tr_b16 a[126:127], v4 offset:54752
    buffer_store_dwordx4 v[52:55], v10, s[40:43], s54 offen offset:0 sc1
    v_mfma_f32_16x16x32_bf16 v[40:43], a[96:99], v[128:131], 0
    s_add_u32 m0, s44, 73728
    ds_read_b64_tr_b16 a[64:65], v3 offset:0
    ds_read_b64_tr_b16 a[66:67], v3 offset:128
    v_mfma_f32_16x16x32_bf16 v[40:43], a[100:103], v[136:139], v[40:43]
    s_mov_b32 s45, 1024
    s_waitcnt lgkmcnt(10)
    buffer_load_dwordx4 v7, s[28:31], s45 offen offset:0 lds
    v_mfma_f32_16x16x32_bf16 v[40:43], a[104:107], v[144:147], v[40:43]
    s_add_u32 m0, s44, 73632
    ds_read_b64_tr_b16 a[68:69], v3 offset:256
    ds_read_b64_tr_b16 a[70:71], v3 offset:384
    v_mfma_f32_16x16x32_bf16 v[40:43], a[108:111], v[152:155], v[40:43]
    s_waitcnt lgkmcnt(8)
    buffer_load_dwordx4 v7, s[28:31], s45 offen offset:1152 lds
    v_mfma_f32_16x16x32_bf16 v[40:43], a[112:115], v[192:195], v[40:43]
    s_add_u32 m0, s44, 73536
    ds_read_b64_tr_b16 a[72:73], v3 offset:512
    ds_read_b64_tr_b16 a[74:75], v3 offset:640
    v_mfma_f32_16x16x32_bf16 v[40:43], a[116:119], v[200:203], v[40:43]
    s_waitcnt lgkmcnt(6)
    buffer_load_dwordx4 v7, s[28:31], s45 offen offset:2304 lds
    v_mfma_f32_16x16x32_bf16 v[40:43], a[120:123], v[208:211], v[40:43]
    s_add_u32 m0, s44, 73440
    ds_read_b64_tr_b16 a[76:77], v3 offset:768
    ds_read_b64_tr_b16 a[78:79], v3 offset:896
    v_mfma_f32_16x16x32_bf16 v[40:43], a[124:127], v[216:219], v[40:43]
    buffer_load_dwordx4 v7, s[28:31], s45 offen offset:3456 lds
    v_mfma_f32_16x16x32_bf16 v[44:47], a[96:99], v[160:163], 0
    s_add_u32 m0, s44, 90624
    ds_read_b64_tr_b16 a[80:81], v3 offset:16896
    ds_read_b64_tr_b16 a[82:83], v3 offset:17024
    v_mfma_f32_16x16x32_bf16 v[44:47], a[100:103], v[168:171], v[44:47]
    s_mov_b32 s45, 148480
    buffer_load_dwordx4 v7, s[28:31], s45 offen offset:0 lds
    v_mfma_f32_16x16x32_bf16 v[44:47], a[104:107], v[176:179], v[44:47]
    s_add_u32 m0, s44, 90528
    ds_read_b64_tr_b16 a[84:85], v3 offset:17152
    ds_read_b64_tr_b16 a[86:87], v3 offset:17280
    v_mfma_f32_16x16x32_bf16 v[44:47], a[108:111], v[184:187], v[44:47]
    buffer_load_dwordx4 v7, s[28:31], s45 offen offset:1152 lds
    v_mfma_f32_16x16x32_bf16 v[44:47], a[112:115], v[224:227], v[44:47]
    s_add_u32 m0, s44, 90432
    ds_read_b64_tr_b16 a[88:89], v3 offset:17408
    ds_read_b64_tr_b16 a[90:91], v3 offset:17536
    v_mfma_f32_16x16x32_bf16 v[44:47], a[116:119], v[232:235], v[44:47]
    buffer_load_dwordx4 v7, s[28:31], s45 offen offset:2304 lds
    v_mfma_f32_16x16x32_bf16 v[44:47], a[120:123], v[240:243], v[44:47]
    s_add_u32 m0, s44, 90336
    ds_read_b64_tr_b16 a[92:93], v3 offset:17664
    ds_read_b64_tr_b16 a[94:95], v3 offset:17792
    v_mfma_f32_16x16x32_bf16 v[44:47], a[124:127], v[248:251], v[44:47]
    s_waitcnt lgkmcnt(12)
    buffer_load_dwordx4 v7, s[28:31], s45 offen offset:3456 lds
    v_mfma_f32_16x16x32_bf16 v[16:19], a[64:67], v[128:131], 0
    ds_read_b64_tr_b16 a[96:97], v3 offset:32
    v_cvt_pk_bf16_f32 v48, v32, v33
    v_mfma_f32_16x16x32_bf16 v[16:19], a[68:71], v[136:139], v[16:19]
    s_waitcnt lgkmcnt(9)
    ds_read_b64_tr_b16 a[98:99], v3 offset:160
    v_cvt_pk_bf16_f32 v49, v34, v35
    v_mfma_f32_16x16x32_bf16 v[16:19], a[72:75], v[144:147], v[16:19]
    ds_read_b64_tr_b16 a[100:101], v3 offset:288
    v_cvt_pk_bf16_f32 v50, v40, v41
    v_mfma_f32_16x16x32_bf16 v[16:19], a[76:79], v[152:155], v[16:19]
    s_waitcnt lgkmcnt(7)
    ds_read_b64_tr_b16 a[102:103], v3 offset:416
    v_cvt_pk_bf16_f32 v51, v42, v43
    v_mfma_f32_16x16x32_bf16 v[16:19], a[80:83], v[192:195], v[16:19]
    s_mov_b32 s54, 5120
    ds_read_b64_tr_b16 a[104:105], v3 offset:544
    ds_read_b64_tr_b16 a[106:107], v3 offset:672
    v_mfma_f32_16x16x32_bf16 v[16:19], a[84:87], v[200:203], v[16:19]
    s_waitcnt lgkmcnt(6)
    v_permlane32_swap_b32 v48, v50
    v_mfma_f32_16x16x32_bf16 v[16:19], a[88:91], v[208:211], v[16:19]
    v_permlane32_swap_b32 v49, v51
    v_mfma_f32_16x16x32_bf16 v[16:19], a[92:95], v[216:219], v[16:19]
    ds_read_b64_tr_b16 a[108:109], v3 offset:800
    ds_read_b64_tr_b16 a[110:111], v3 offset:928
    buffer_store_dwordx4 v[48:51], v10, s[40:43], s54 offen offset:512 sc1
    v_mfma_f32_16x16x32_bf16 v[20:23], a[64:67], v[160:163], 0
    ds_read_b64_tr_b16 a[112:113], v3 offset:16928
    v_cvt_pk_bf16_f32 v52, v36, v37
    v_mfma_f32_16x16x32_bf16 v[20:23], a[68:71], v[168:171], v[20:23]
    ds_read_b64_tr_b16 a[114:115], v3 offset:17056
    v_cvt_pk_bf16_f32 v53, v38, v39
    v_mfma_f32_16x16x32_bf16 v[20:23], a[72:75], v[176:179], v[20:23]
    ds_read_b64_tr_b16 a[116:117], v3 offset:17184
    v_cvt_pk_bf16_f32 v54, v44, v45
    v_mfma_f32_16x16x32_bf16 v[20:23], a[76:79], v[184:187], v[20:23]
    ds_read_b64_tr_b16 a[118:119], v3 offset:17312
    v_cvt_pk_bf16_f32 v55, v46, v47
    v_mfma_f32_16x16x32_bf16 v[20:23], a[80:83], v[224:227], v[20:23]
    s_mov_b32 s54, 300032
    ds_read_b64_tr_b16 a[120:121], v3 offset:17440
    ds_read_b64_tr_b16 a[122:123], v3 offset:17568
    v_mfma_f32_16x16x32_bf16 v[20:23], a[84:87], v[232:235], v[20:23]
    v_permlane32_swap_b32 v52, v54
    v_mfma_f32_16x16x32_bf16 v[20:23], a[88:91], v[240:243], v[20:23]
    v_permlane32_swap_b32 v53, v55
    v_mfma_f32_16x16x32_bf16 v[20:23], a[92:95], v[248:251], v[20:23]
    s_waitcnt lgkmcnt(10)
    ds_read_b64_tr_b16 a[124:125], v3 offset:17696
    ds_read_b64_tr_b16 a[126:127], v3 offset:17824
    buffer_store_dwordx4 v[52:55], v10, s[40:43], s54 offen offset:512 sc1
    v_mfma_f32_16x16x32_bf16 v[24:27], a[96:99], v[128:131], 0
    ds_read_b64_tr_b16 a[64:65], v3 offset:64
    v_mfma_f32_16x16x32_bf16 v[24:27], a[100:103], v[136:139], v[24:27]
    s_waitcnt lgkmcnt(9)
    ds_read_b64_tr_b16 a[66:67], v3 offset:192
    v_mfma_f32_16x16x32_bf16 v[24:27], a[104:107], v[144:147], v[24:27]
    ds_read_b64_tr_b16 a[68:69], v3 offset:320
    v_mfma_f32_16x16x32_bf16 v[24:27], a[108:111], v[152:155], v[24:27]
    s_waitcnt lgkmcnt(7)
    ds_read_b64_tr_b16 a[70:71], v3 offset:448
    v_mfma_f32_16x16x32_bf16 v[24:27], a[112:115], v[192:195], v[24:27]
    ds_read_b64_tr_b16 a[72:73], v3 offset:576
    v_mfma_f32_16x16x32_bf16 v[24:27], a[116:119], v[200:203], v[24:27]
    s_waitcnt lgkmcnt(5)
    ds_read_b64_tr_b16 a[74:75], v3 offset:704
    v_mfma_f32_16x16x32_bf16 v[24:27], a[120:123], v[208:211], v[24:27]
    ds_read_b64_tr_b16 a[76:77], v3 offset:832
    v_mfma_f32_16x16x32_bf16 v[24:27], a[124:127], v[216:219], v[24:27]
    ds_read_b64_tr_b16 a[78:79], v3 offset:960
    v_mfma_f32_16x16x32_bf16 v[28:31], a[96:99], v[160:163], 0
    ds_read_b64_tr_b16 a[80:81], v3 offset:16960
    v_mfma_f32_16x16x32_bf16 v[28:31], a[100:103], v[168:171], v[28:31]
    ds_read_b64_tr_b16 a[82:83], v3 offset:17088
    v_mfma_f32_16x16x32_bf16 v[28:31], a[104:107], v[176:179], v[28:31]
    ds_read_b64_tr_b16 a[84:85], v3 offset:17216
    v_mfma_f32_16x16x32_bf16 v[28:31], a[108:111], v[184:187], v[28:31]
    ds_read_b64_tr_b16 a[86:87], v3 offset:17344
    v_mfma_f32_16x16x32_bf16 v[28:31], a[112:115], v[224:227], v[28:31]
    ds_read_b64_tr_b16 a[88:89], v3 offset:17472
    v_mfma_f32_16x16x32_bf16 v[28:31], a[116:119], v[232:235], v[28:31]
    ds_read_b64_tr_b16 a[90:91], v3 offset:17600
    v_mfma_f32_16x16x32_bf16 v[28:31], a[120:123], v[240:243], v[28:31]
    ds_read_b64_tr_b16 a[92:93], v3 offset:17728
    v_mfma_f32_16x16x32_bf16 v[28:31], a[124:127], v[248:251], v[28:31]
    s_waitcnt lgkmcnt(11)
    ds_read_b64_tr_b16 a[94:95], v3 offset:17856
    v_mfma_f32_16x16x32_bf16 v[32:35], a[64:67], v[128:131], 0
    ds_read_b64_tr_b16 a[96:97], v3 offset:96
    v_cvt_pk_bf16_f32 v48, v16, v17
    v_mfma_f32_16x16x32_bf16 v[32:35], a[68:71], v[136:139], v[32:35]
    s_waitcnt lgkmcnt(9)
    ds_read_b64_tr_b16 a[98:99], v3 offset:224
    v_cvt_pk_bf16_f32 v49, v18, v19
    v_mfma_f32_16x16x32_bf16 v[32:35], a[72:75], v[144:147], v[32:35]
    ds_read_b64_tr_b16 a[100:101], v3 offset:352
    v_cvt_pk_bf16_f32 v50, v24, v25
    v_mfma_f32_16x16x32_bf16 v[32:35], a[76:79], v[152:155], v[32:35]
    s_waitcnt lgkmcnt(7)
    ds_read_b64_tr_b16 a[102:103], v3 offset:480
    v_cvt_pk_bf16_f32 v51, v26, v27
    v_mfma_f32_16x16x32_bf16 v[32:35], a[80:83], v[192:195], v[32:35]
    s_mov_b32 s54, 6144
    ds_read_b64_tr_b16 a[104:105], v3 offset:608
    ds_read_b64_tr_b16 a[106:107], v3 offset:736
    v_mfma_f32_16x16x32_bf16 v[32:35], a[84:87], v[200:203], v[32:35]
    s_waitcnt lgkmcnt(6)
    v_permlane32_swap_b32 v48, v50
    v_mfma_f32_16x16x32_bf16 v[32:35], a[88:91], v[208:211], v[32:35]
    v_permlane32_swap_b32 v49, v51
    v_mfma_f32_16x16x32_bf16 v[32:35], a[92:95], v[216:219], v[32:35]
    ds_read_b64_tr_b16 a[108:109], v3 offset:864
    ds_read_b64_tr_b16 a[110:111], v3 offset:992
    buffer_store_dwordx4 v[48:51], v10, s[40:43], s54 offen offset:0 sc1
    v_mfma_f32_16x16x32_bf16 v[36:39], a[64:67], v[160:163], 0
    ds_read_b64_tr_b16 a[112:113], v3 offset:16992
    v_cvt_pk_bf16_f32 v52, v20, v21
    v_mfma_f32_16x16x32_bf16 v[36:39], a[68:71], v[168:171], v[36:39]
    ds_read_b64_tr_b16 a[114:115], v3 offset:17120
    v_cvt_pk_bf16_f32 v53, v22, v23
    v_mfma_f32_16x16x32_bf16 v[36:39], a[72:75], v[176:179], v[36:39]
    ds_read_b64_tr_b16 a[116:117], v3 offset:17248
    v_cvt_pk_bf16_f32 v54, v28, v29
    v_mfma_f32_16x16x32_bf16 v[36:39], a[76:79], v[184:187], v[36:39]
    ds_read_b64_tr_b16 a[118:119], v3 offset:17376
    v_cvt_pk_bf16_f32 v55, v30, v31
    v_mfma_f32_16x16x32_bf16 v[36:39], a[80:83], v[224:227], v[36:39]
    s_mov_b32 s54, 301056
    ds_read_b64_tr_b16 a[120:121], v3 offset:17504
    ds_read_b64_tr_b16 a[122:123], v3 offset:17632
    v_mfma_f32_16x16x32_bf16 v[36:39], a[84:87], v[232:235], v[36:39]
    v_permlane32_swap_b32 v52, v54
    v_mfma_f32_16x16x32_bf16 v[36:39], a[88:91], v[240:243], v[36:39]
    v_permlane32_swap_b32 v53, v55
    v_mfma_f32_16x16x32_bf16 v[36:39], a[92:95], v[248:251], v[36:39]
    s_waitcnt vmcnt(15)
    s_barrier
    s_waitcnt lgkmcnt(10)
    ds_read_b64_tr_b16 a[124:125], v3 offset:17760
    ds_read_b64_tr_b16 a[126:127], v3 offset:17888
    buffer_store_dwordx4 v[52:55], v10, s[40:43], s54 offen offset:0 sc1
    v_mfma_f32_16x16x32_bf16 v[40:43], a[96:99], v[128:131], 0
    ds_read_b64_tr_b16 a[64:65], v3 offset:36864
    v_mfma_f32_16x16x32_bf16 v[40:43], a[100:103], v[136:139], v[40:43]
    s_waitcnt lgkmcnt(9)
    ds_read_b64_tr_b16 a[66:67], v3 offset:36992
    v_mfma_f32_16x16x32_bf16 v[40:43], a[104:107], v[144:147], v[40:43]
    ds_read_b64_tr_b16 a[68:69], v3 offset:37120
    v_mfma_f32_16x16x32_bf16 v[40:43], a[108:111], v[152:155], v[40:43]
    s_waitcnt lgkmcnt(7)
    ds_read_b64_tr_b16 a[70:71], v3 offset:37248
    v_mfma_f32_16x16x32_bf16 v[40:43], a[112:115], v[192:195], v[40:43]
    ds_read_b64_tr_b16 a[72:73], v3 offset:37376
    v_mfma_f32_16x16x32_bf16 v[40:43], a[116:119], v[200:203], v[40:43]
    s_waitcnt lgkmcnt(5)
    ds_read_b64_tr_b16 a[74:75], v3 offset:37504
    v_mfma_f32_16x16x32_bf16 v[40:43], a[120:123], v[208:211], v[40:43]
    ds_read_b64_tr_b16 a[76:77], v3 offset:37632
    v_mfma_f32_16x16x32_bf16 v[40:43], a[124:127], v[216:219], v[40:43]
    ds_read_b64_tr_b16 a[78:79], v3 offset:37760
    v_mfma_f32_16x16x32_bf16 v[44:47], a[96:99], v[160:163], 0
    s_sub_u32 s28, s88, 4096
    s_subb_u32 s29, s89, 0
    ds_read_b64_tr_b16 a[80:81], v3 offset:53760
    v_mfma_f32_16x16x32_bf16 v[44:47], a[100:103], v[168:171], v[44:47]
    s_mov_b32 s30, 147456
    ds_read_b64_tr_b16 a[82:83], v3 offset:53888
    v_mfma_f32_16x16x32_bf16 v[44:47], a[104:107], v[176:179], v[44:47]
    ds_read_b64_tr_b16 a[84:85], v3 offset:54016
    v_mfma_f32_16x16x32_bf16 v[44:47], a[108:111], v[184:187], v[44:47]
    ds_read_b64_tr_b16 a[86:87], v3 offset:54144
    v_mfma_f32_16x16x32_bf16 v[44:47], a[112:115], v[224:227], v[44:47]
    ds_read_b64_tr_b16 a[88:89], v3 offset:54272
    v_mfma_f32_16x16x32_bf16 v[44:47], a[116:119], v[232:235], v[44:47]
    ds_read_b64_tr_b16 a[90:91], v3 offset:54400
    v_mfma_f32_16x16x32_bf16 v[44:47], a[120:123], v[240:243], v[44:47]
    ds_read_b64_tr_b16 a[92:93], v3 offset:54528
    v_mfma_f32_16x16x32_bf16 v[44:47], a[124:127], v[248:251], v[44:47]
    s_waitcnt lgkmcnt(11)
    ds_read_b64_tr_b16 a[94:95], v3 offset:54656
    v_mfma_f32_16x16x32_bf16 v[16:19], a[64:67], v[128:131], 0
    ds_read_b64_tr_b16 a[96:97], v3 offset:36896
    v_cvt_pk_bf16_f32 v48, v32, v33
    v_mfma_f32_16x16x32_bf16 v[16:19], a[68:71], v[136:139], v[16:19]
    s_waitcnt lgkmcnt(9)
    ds_read_b64_tr_b16 a[98:99], v3 offset:37024
    v_cvt_pk_bf16_f32 v49, v34, v35
    v_mfma_f32_16x16x32_bf16 v[16:19], a[72:75], v[144:147], v[16:19]
    ds_read_b64_tr_b16 a[100:101], v3 offset:37152
    v_cvt_pk_bf16_f32 v50, v40, v41
    v_mfma_f32_16x16x32_bf16 v[16:19], a[76:79], v[152:155], v[16:19]
    s_waitcnt lgkmcnt(7)
    ds_read_b64_tr_b16 a[102:103], v3 offset:37280
    v_cvt_pk_bf16_f32 v51, v42, v43
    v_mfma_f32_16x16x32_bf16 v[16:19], a[80:83], v[192:195], v[16:19]
    s_mov_b32 s54, 6144
    ds_read_b64_tr_b16 a[104:105], v3 offset:37408
    ds_read_b64_tr_b16 a[106:107], v3 offset:37536
    v_mfma_f32_16x16x32_bf16 v[16:19], a[84:87], v[200:203], v[16:19]
    s_waitcnt lgkmcnt(6)
    v_permlane32_swap_b32 v48, v50
    v_mfma_f32_16x16x32_bf16 v[16:19], a[88:91], v[208:211], v[16:19]
    v_permlane32_swap_b32 v49, v51
    v_mfma_f32_16x16x32_bf16 v[16:19], a[92:95], v[216:219], v[16:19]
    ds_read_b64_tr_b16 a[108:109], v3 offset:37664
    ds_read_b64_tr_b16 a[110:111], v3 offset:37792
    buffer_store_dwordx4 v[48:51], v10, s[40:43], s54 offen offset:512 sc1
    v_mfma_f32_16x16x32_bf16 v[20:23], a[64:67], v[160:163], 0
    ds_read_b64_tr_b16 a[112:113], v3 offset:53792
    v_cvt_pk_bf16_f32 v52, v36, v37
    v_mfma_f32_16x16x32_bf16 v[20:23], a[68:71], v[168:171], v[20:23]
    ds_read_b64_tr_b16 a[114:115], v3 offset:53920
    v_cvt_pk_bf16_f32 v53, v38, v39
    v_mfma_f32_16x16x32_bf16 v[20:23], a[72:75], v[176:179], v[20:23]
    ds_read_b64_tr_b16 a[116:117], v3 offset:54048
    v_cvt_pk_bf16_f32 v54, v44, v45
    v_mfma_f32_16x16x32_bf16 v[20:23], a[76:79], v[184:187], v[20:23]
    ds_read_b64_tr_b16 a[118:119], v3 offset:54176
    v_cvt_pk_bf16_f32 v55, v46, v47
    v_mfma_f32_16x16x32_bf16 v[20:23], a[80:83], v[224:227], v[20:23]
    s_mov_b32 s54, 301056
    ds_read_b64_tr_b16 a[120:121], v3 offset:54304
    ds_read_b64_tr_b16 a[122:123], v3 offset:54432
    v_mfma_f32_16x16x32_bf16 v[20:23], a[84:87], v[232:235], v[20:23]
    v_permlane32_swap_b32 v52, v54
    v_mfma_f32_16x16x32_bf16 v[20:23], a[88:91], v[240:243], v[20:23]
    v_permlane32_swap_b32 v53, v55
    v_mfma_f32_16x16x32_bf16 v[20:23], a[92:95], v[248:251], v[20:23]
    s_waitcnt lgkmcnt(10)
    ds_read_b64_tr_b16 a[124:125], v3 offset:54560
    ds_read_b64_tr_b16 a[126:127], v3 offset:54688
    buffer_store_dwordx4 v[52:55], v10, s[40:43], s54 offen offset:512 sc1
    v_mfma_f32_16x16x32_bf16 v[24:27], a[96:99], v[128:131], 0
    ds_read_b64_tr_b16 a[64:65], v3 offset:36928
    v_mfma_f32_16x16x32_bf16 v[24:27], a[100:103], v[136:139], v[24:27]
    s_waitcnt lgkmcnt(9)
    ds_read_b64_tr_b16 a[66:67], v3 offset:37056
    v_mfma_f32_16x16x32_bf16 v[24:27], a[104:107], v[144:147], v[24:27]
    ds_read_b64_tr_b16 a[68:69], v3 offset:37184
    v_mfma_f32_16x16x32_bf16 v[24:27], a[108:111], v[152:155], v[24:27]
    s_waitcnt lgkmcnt(7)
    ds_read_b64_tr_b16 a[70:71], v3 offset:37312
    v_mfma_f32_16x16x32_bf16 v[24:27], a[112:115], v[192:195], v[24:27]
    ds_read_b64_tr_b16 a[72:73], v3 offset:37440
    v_mfma_f32_16x16x32_bf16 v[24:27], a[116:119], v[200:203], v[24:27]
    s_waitcnt lgkmcnt(5)
    ds_read_b64_tr_b16 a[74:75], v3 offset:37568
    v_mfma_f32_16x16x32_bf16 v[24:27], a[120:123], v[208:211], v[24:27]
    ds_read_b64_tr_b16 a[76:77], v3 offset:37696
    v_mfma_f32_16x16x32_bf16 v[24:27], a[124:127], v[216:219], v[24:27]
    ds_read_b64_tr_b16 a[78:79], v3 offset:37824
    v_mfma_f32_16x16x32_bf16 v[28:31], a[96:99], v[160:163], 0
    ds_read_b64_tr_b16 a[80:81], v3 offset:53824
    v_mfma_f32_16x16x32_bf16 v[28:31], a[100:103], v[168:171], v[28:31]
    ds_read_b64_tr_b16 a[82:83], v3 offset:53952
    v_mfma_f32_16x16x32_bf16 v[28:31], a[104:107], v[176:179], v[28:31]
    ds_read_b64_tr_b16 a[84:85], v3 offset:54080
    v_mfma_f32_16x16x32_bf16 v[28:31], a[108:111], v[184:187], v[28:31]
    ds_read_b64_tr_b16 a[86:87], v3 offset:54208
    v_mfma_f32_16x16x32_bf16 v[28:31], a[112:115], v[224:227], v[28:31]
    ds_read_b64_tr_b16 a[88:89], v3 offset:54336
    v_mfma_f32_16x16x32_bf16 v[28:31], a[116:119], v[232:235], v[28:31]
    ds_read_b64_tr_b16 a[90:91], v3 offset:54464
    v_mfma_f32_16x16x32_bf16 v[28:31], a[120:123], v[240:243], v[28:31]
    ds_read_b64_tr_b16 a[92:93], v3 offset:54592
    v_mfma_f32_16x16x32_bf16 v[28:31], a[124:127], v[248:251], v[28:31]
    s_waitcnt lgkmcnt(11)
    ds_read_b64_tr_b16 a[94:95], v3 offset:54720
    v_mfma_f32_16x16x32_bf16 v[32:35], a[64:67], v[128:131], 0
    ds_read_b64_tr_b16 a[96:97], v3 offset:36960
    v_cvt_pk_bf16_f32 v48, v16, v17
    v_mfma_f32_16x16x32_bf16 v[32:35], a[68:71], v[136:139], v[32:35]
    s_waitcnt lgkmcnt(9)
    ds_read_b64_tr_b16 a[98:99], v3 offset:37088
    v_cvt_pk_bf16_f32 v49, v18, v19
    v_mfma_f32_16x16x32_bf16 v[32:35], a[72:75], v[144:147], v[32:35]
    ds_read_b64_tr_b16 a[100:101], v3 offset:37216
    v_cvt_pk_bf16_f32 v50, v24, v25
    v_mfma_f32_16x16x32_bf16 v[32:35], a[76:79], v[152:155], v[32:35]
    s_waitcnt lgkmcnt(7)
    ds_read_b64_tr_b16 a[102:103], v3 offset:37344
    v_cvt_pk_bf16_f32 v51, v26, v27
    v_mfma_f32_16x16x32_bf16 v[32:35], a[80:83], v[192:195], v[32:35]
    s_mov_b32 s54, 7168
    ds_read_b64_tr_b16 a[104:105], v3 offset:37472
    ds_read_b64_tr_b16 a[106:107], v3 offset:37600
    v_mfma_f32_16x16x32_bf16 v[32:35], a[84:87], v[200:203], v[32:35]
    s_waitcnt lgkmcnt(6)
    v_permlane32_swap_b32 v48, v50
    v_mfma_f32_16x16x32_bf16 v[32:35], a[88:91], v[208:211], v[32:35]
    v_permlane32_swap_b32 v49, v51
    v_mfma_f32_16x16x32_bf16 v[32:35], a[92:95], v[216:219], v[32:35]
    ds_read_b64_tr_b16 a[108:109], v3 offset:37728
    ds_read_b64_tr_b16 a[110:111], v3 offset:37856
    buffer_store_dwordx4 v[48:51], v10, s[40:43], s54 offen offset:0 sc1
    v_mfma_f32_16x16x32_bf16 v[36:39], a[64:67], v[160:163], 0
    ds_read_b64_tr_b16 a[112:113], v3 offset:53856
    v_cvt_pk_bf16_f32 v52, v20, v21
    v_mfma_f32_16x16x32_bf16 v[36:39], a[68:71], v[168:171], v[36:39]
    ds_read_b64_tr_b16 a[114:115], v3 offset:53984
    v_cvt_pk_bf16_f32 v53, v22, v23
    v_mfma_f32_16x16x32_bf16 v[36:39], a[72:75], v[176:179], v[36:39]
    ds_read_b64_tr_b16 a[116:117], v3 offset:54112
    v_cvt_pk_bf16_f32 v54, v28, v29
    v_mfma_f32_16x16x32_bf16 v[36:39], a[76:79], v[184:187], v[36:39]
    ds_read_b64_tr_b16 a[118:119], v3 offset:54240
    v_cvt_pk_bf16_f32 v55, v30, v31
    v_mfma_f32_16x16x32_bf16 v[36:39], a[80:83], v[224:227], v[36:39]
    s_mov_b32 s54, 302080
    ds_read_b64_tr_b16 a[120:121], v3 offset:54368
    ds_read_b64_tr_b16 a[122:123], v3 offset:54496
    v_mfma_f32_16x16x32_bf16 v[36:39], a[84:87], v[232:235], v[36:39]
    v_permlane32_swap_b32 v52, v54
    v_mfma_f32_16x16x32_bf16 v[36:39], a[88:91], v[240:243], v[36:39]
    v_permlane32_swap_b32 v53, v55
    v_mfma_f32_16x16x32_bf16 v[36:39], a[92:95], v[248:251], v[36:39]
    s_waitcnt vmcnt(7)
    s_barrier
    s_waitcnt lgkmcnt(10)
    ds_read_b64_tr_b16 a[124:125], v3 offset:54624
    ds_read_b64_tr_b16 a[126:127], v3 offset:54752
    buffer_store_dwordx4 v[52:55], v10, s[40:43], s54 offen offset:0 sc1
    v_mfma_f32_16x16x32_bf16 v[40:43], a[96:99], v[128:131], 0
    ds_read_b64_tr_b16 a[64:65], v4 offset:0
    v_mfma_f32_16x16x32_bf16 v[40:43], a[100:103], v[136:139], v[40:43]
    s_waitcnt lgkmcnt(9)
    ds_read_b64_tr_b16 a[66:67], v4 offset:128
    v_mfma_f32_16x16x32_bf16 v[40:43], a[104:107], v[144:147], v[40:43]
    ds_read_b64_tr_b16 a[68:69], v4 offset:256
    v_mfma_f32_16x16x32_bf16 v[40:43], a[108:111], v[152:155], v[40:43]
    s_waitcnt lgkmcnt(7)
    ds_read_b64_tr_b16 a[70:71], v4 offset:384
    v_mfma_f32_16x16x32_bf16 v[40:43], a[112:115], v[192:195], v[40:43]
    ds_read_b64_tr_b16 a[72:73], v4 offset:512
    v_mfma_f32_16x16x32_bf16 v[40:43], a[116:119], v[200:203], v[40:43]
    s_waitcnt lgkmcnt(5)
    ds_read_b64_tr_b16 a[74:75], v4 offset:640
    v_mfma_f32_16x16x32_bf16 v[40:43], a[120:123], v[208:211], v[40:43]
    ds_read_b64_tr_b16 a[76:77], v4 offset:768
    v_mfma_f32_16x16x32_bf16 v[40:43], a[124:127], v[216:219], v[40:43]
    ds_read_b64_tr_b16 a[78:79], v4 offset:896
    v_mfma_f32_16x16x32_bf16 v[44:47], a[96:99], v[160:163], 0
    ds_read_b64_tr_b16 a[80:81], v4 offset:16896
    v_mfma_f32_16x16x32_bf16 v[44:47], a[100:103], v[168:171], v[44:47]
    ds_read_b64_tr_b16 a[82:83], v4 offset:17024
    v_mfma_f32_16x16x32_bf16 v[44:47], a[104:107], v[176:179], v[44:47]
    ds_read_b64_tr_b16 a[84:85], v4 offset:17152
    v_mfma_f32_16x16x32_bf16 v[44:47], a[108:111], v[184:187], v[44:47]
    ds_read_b64_tr_b16 a[86:87], v4 offset:17280
    v_mfma_f32_16x16x32_bf16 v[44:47], a[112:115], v[224:227], v[44:47]
    ds_read_b64_tr_b16 a[88:89], v4 offset:17408
    v_mfma_f32_16x16x32_bf16 v[44:47], a[116:119], v[232:235], v[44:47]
    ds_read_b64_tr_b16 a[90:91], v4 offset:17536
    v_mfma_f32_16x16x32_bf16 v[44:47], a[120:123], v[240:243], v[44:47]
    ds_read_b64_tr_b16 a[92:93], v4 offset:17664
    v_mfma_f32_16x16x32_bf16 v[44:47], a[124:127], v[248:251], v[44:47]
    s_waitcnt lgkmcnt(11)
    ds_read_b64_tr_b16 a[94:95], v4 offset:17792
    v_mfma_f32_16x16x32_bf16 v[16:19], a[64:67], v[128:131], 0
    ds_read_b64_tr_b16 a[96:97], v4 offset:32
    v_cvt_pk_bf16_f32 v48, v32, v33
    v_mfma_f32_16x16x32_bf16 v[16:19], a[68:71], v[136:139], v[16:19]
    s_waitcnt lgkmcnt(9)
    ds_read_b64_tr_b16 a[98:99], v4 offset:160
    v_cvt_pk_bf16_f32 v49, v34, v35
    v_mfma_f32_16x16x32_bf16 v[16:19], a[72:75], v[144:147], v[16:19]
    ds_read_b64_tr_b16 a[100:101], v4 offset:288
    v_cvt_pk_bf16_f32 v50, v40, v41
    v_mfma_f32_16x16x32_bf16 v[16:19], a[76:79], v[152:155], v[16:19]
    s_waitcnt lgkmcnt(7)
    ds_read_b64_tr_b16 a[102:103], v4 offset:416
    v_cvt_pk_bf16_f32 v51, v42, v43
    v_mfma_f32_16x16x32_bf16 v[16:19], a[80:83], v[192:195], v[16:19]
    s_mov_b32 s54, 7168
    ds_read_b64_tr_b16 a[104:105], v4 offset:544
    ds_read_b64_tr_b16 a[106:107], v4 offset:672
    v_mfma_f32_16x16x32_bf16 v[16:19], a[84:87], v[200:203], v[16:19]
    s_waitcnt lgkmcnt(6)
    v_permlane32_swap_b32 v48, v50
    v_mfma_f32_16x16x32_bf16 v[16:19], a[88:91], v[208:211], v[16:19]
    v_permlane32_swap_b32 v49, v51
    v_mfma_f32_16x16x32_bf16 v[16:19], a[92:95], v[216:219], v[16:19]
    ds_read_b64_tr_b16 a[108:109], v4 offset:800
    ds_read_b64_tr_b16 a[110:111], v4 offset:928
    buffer_store_dwordx4 v[48:51], v10, s[40:43], s54 offen offset:512 sc1
    v_mfma_f32_16x16x32_bf16 v[20:23], a[64:67], v[160:163], 0
    ds_read_b64_tr_b16 a[112:113], v4 offset:16928
    v_cvt_pk_bf16_f32 v52, v36, v37
    v_mfma_f32_16x16x32_bf16 v[20:23], a[68:71], v[168:171], v[20:23]
    ds_read_b64_tr_b16 a[114:115], v4 offset:17056
    v_cvt_pk_bf16_f32 v53, v38, v39
    v_mfma_f32_16x16x32_bf16 v[20:23], a[72:75], v[176:179], v[20:23]
    ds_read_b64_tr_b16 a[116:117], v4 offset:17184
    v_cvt_pk_bf16_f32 v54, v44, v45
    v_mfma_f32_16x16x32_bf16 v[20:23], a[76:79], v[184:187], v[20:23]
    ds_read_b64_tr_b16 a[118:119], v4 offset:17312
    v_cvt_pk_bf16_f32 v55, v46, v47
    v_mfma_f32_16x16x32_bf16 v[20:23], a[80:83], v[224:227], v[20:23]
    s_mov_b32 s54, 302080
    ds_read_b64_tr_b16 a[120:121], v4 offset:17440
    ds_read_b64_tr_b16 a[122:123], v4 offset:17568
    v_mfma_f32_16x16x32_bf16 v[20:23], a[84:87], v[232:235], v[20:23]
    v_permlane32_swap_b32 v52, v54
    v_mfma_f32_16x16x32_bf16 v[20:23], a[88:91], v[240:243], v[20:23]
L2_pad13:
    s_cbranch_execz L2_walkret
    v_permlane32_swap_b32 v53, v55
    v_mfma_f32_16x16x32_bf16 v[20:23], a[92:95], v[248:251], v[20:23]
    s_waitcnt lgkmcnt(10)
    ds_read_b64_tr_b16 a[124:125], v4 offset:17696
    ds_read_b64_tr_b16 a[126:127], v4 offset:17824
    buffer_store_dwordx4 v[52:55], v10, s[40:43], s54 offen offset:512 sc1
    v_mfma_f32_16x16x32_bf16 v[24:27], a[96:99], v[128:131], 0
    ds_read_b64_tr_b16 a[64:65], v4 offset:64
    v_mfma_f32_16x16x32_bf16 v[24:27], a[100:103], v[136:139], v[24:27]
    s_waitcnt lgkmcnt(9)
    ds_read_b64_tr_b16 a[66:67], v4 offset:192
    v_mfma_f32_16x16x32_bf16 v[24:27], a[104:107], v[144:147], v[24:27]
    ds_read_b64_tr_b16 a[68:69], v4 offset:320
    v_mfma_f32_16x16x32_bf16 v[24:27], a[108:111], v[152:155], v[24:27]
    s_waitcnt lgkmcnt(7)
    ds_read_b64_tr_b16 a[70:71], v4 offset:448
    v_mfma_f32_16x16x32_bf16 v[24:27], a[112:115], v[192:195], v[24:27]
    ds_read_b64_tr_b16 a[72:73], v4 offset:576
    v_mfma_f32_16x16x32_bf16 v[24:27], a[116:119], v[200:203], v[24:27]
    s_waitcnt lgkmcnt(5)
    ds_read_b64_tr_b16 a[74:75], v4 offset:704
    v_mfma_f32_16x16x32_bf16 v[24:27], a[120:123], v[208:211], v[24:27]
    ds_read_b64_tr_b16 a[76:77], v4 offset:832
    v_mfma_f32_16x16x32_bf16 v[24:27], a[124:127], v[216:219], v[24:27]
    ds_read_b64_tr_b16 a[78:79], v4 offset:960
    v_mfma_f32_16x16x32_bf16 v[28:31], a[96:99], v[160:163], 0
    ds_read_b64_tr_b16 a[80:81], v4 offset:16960
    v_mfma_f32_16x16x32_bf16 v[28:31], a[100:103], v[168:171], v[28:31]
    ds_read_b64_tr_b16 a[82:83], v4 offset:17088
    v_mfma_f32_16x16x32_bf16 v[28:31], a[104:107], v[176:179], v[28:31]
    ds_read_b64_tr_b16 a[84:85], v4 offset:17216
    v_mfma_f32_16x16x32_bf16 v[28:31], a[108:111], v[184:187], v[28:31]
    ds_read_b64_tr_b16 a[86:87], v4 offset:17344
    v_mfma_f32_16x16x32_bf16 v[28:31], a[112:115], v[224:227], v[28:31]
    ds_read_b64_tr_b16 a[88:89], v4 offset:17472
    v_mfma_f32_16x16x32_bf16 v[28:31], a[116:119], v[232:235], v[28:31]
    ds_read_b64_tr_b16 a[90:91], v4 offset:17600
    v_mfma_f32_16x16x32_bf16 v[28:31], a[120:123], v[240:243], v[28:31]
    ds_read_b64_tr_b16 a[92:93], v4 offset:17728
    v_mfma_f32_16x16x32_bf16 v[28:31], a[124:127], v[248:251], v[28:31]
    s_waitcnt lgkmcnt(11)
    ds_read_b64_tr_b16 a[94:95], v4 offset:17856
    v_mfma_f32_16x16x32_bf16 v[32:35], a[64:67], v[128:131], 0
    ds_read_b64_tr_b16 a[96:97], v4 offset:96
    v_cvt_pk_bf16_f32 v48, v16, v17
    v_mfma_f32_16x16x32_bf16 v[32:35], a[68:71], v[136:139], v[32:35]
    s_waitcnt lgkmcnt(9)
    ds_read_b64_tr_b16 a[98:99], v4 offset:224
    v_cvt_pk_bf16_f32 v49, v18, v19
    v_mfma_f32_16x16x32_bf16 v[32:35], a[72:75], v[144:147], v[32:35]
    ds_read_b64_tr_b16 a[100:101], v4 offset:352
    v_cvt_pk_bf16_f32 v50, v24, v25
    v_mfma_f32_16x16x32_bf16 v[32:35], a[76:79], v[152:155], v[32:35]
    s_waitcnt lgkmcnt(7)
    ds_read_b64_tr_b16 a[102:103], v4 offset:480
    v_cvt_pk_bf16_f32 v51, v26, v27
    v_mfma_f32_16x16x32_bf16 v[32:35], a[80:83], v[192:195], v[32:35]
    s_mov_b32 s54, 8192
    ds_read_b64_tr_b16 a[104:105], v4 offset:608
    ds_read_b64_tr_b16 a[106:107], v4 offset:736
    v_mfma_f32_16x16x32_bf16 v[32:35], a[84:87], v[200:203], v[32:35]
    s_waitcnt lgkmcnt(6)
    v_permlane32_swap_b32 v48, v50
    v_mfma_f32_16x16x32_bf16 v[32:35], a[88:91], v[208:211], v[32:35]
    v_permlane32_swap_b32 v49, v51
    v_mfma_f32_16x16x32_bf16 v[32:35], a[92:95], v[216:219], v[32:35]
    ds_read_b64_tr_b16 a[108:109], v4 offset:864
    ds_read_b64_tr_b16 a[110:111], v4 offset:992
    buffer_store_dwordx4 v[48:51], v10, s[40:43], s54 offen offset:0 sc1
    v_mfma_f32_16x16x32_bf16 v[36:39], a[64:67], v[160:163], 0
    ds_read_b64_tr_b16 a[112:113], v4 offset:16992
    v_cvt_pk_bf16_f32 v52, v20, v21
    v_mfma_f32_16x16x32_bf16 v[36:39], a[68:71], v[168:171], v[36:39]
    ds_read_b64_tr_b16 a[114:115], v4 offset:17120
    v_cvt_pk_bf16_f32 v53, v22, v23
    v_mfma_f32_16x16x32_bf16 v[36:39], a[72:75], v[176:179], v[36:39]
    ds_read_b64_tr_b16 a[116:117], v4 offset:17248
    v_cvt_pk_bf16_f32 v54, v28, v29
    v_mfma_f32_16x16x32_bf16 v[36:39], a[76:79], v[184:187], v[36:39]
    ds_read_b64_tr_b16 a[118:119], v4 offset:17376
    v_cvt_pk_bf16_f32 v55, v30, v31
    v_mfma_f32_16x16x32_bf16 v[36:39], a[80:83], v[224:227], v[36:39]
    s_mov_b32 s54, 303104
    ds_read_b64_tr_b16 a[120:121], v4 offset:17504
    ds_read_b64_tr_b16 a[122:123], v4 offset:17632
    v_mfma_f32_16x16x32_bf16 v[36:39], a[84:87], v[232:235], v[36:39]
    v_permlane32_swap_b32 v52, v54
    v_mfma_f32_16x16x32_bf16 v[36:39], a[88:91], v[240:243], v[36:39]
    v_permlane32_swap_b32 v53, v55
    v_mfma_f32_16x16x32_bf16 v[36:39], a[92:95], v[248:251], v[36:39]
    s_waitcnt lgkmcnt(10)
    ds_read_b64_tr_b16 a[124:125], v4 offset:17760
    ds_read_b64_tr_b16 a[126:127], v4 offset:17888
    buffer_store_dwordx4 v[52:55], v10, s[40:43], s54 offen offset:0 sc1
    v_mfma_f32_16x16x32_bf16 v[40:43], a[96:99], v[128:131], 0
    v_mfma_f32_16x16x32_bf16 v[40:43], a[100:103], v[136:139], v[40:43]
    s_waitcnt lgkmcnt(8)
    v_mfma_f32_16x16x32_bf16 v[40:43], a[104:107], v[144:147], v[40:43]
    v_mfma_f32_16x16x32_bf16 v[40:43], a[108:111], v[152:155], v[40:43]
    s_waitcnt lgkmcnt(4)
    v_mfma_f32_16x16x32_bf16 v[40:43], a[112:115], v[192:195], v[40:43]
    v_mfma_f32_16x16x32_bf16 v[40:43], a[116:119], v[200:203], v[40:43]
    s_waitcnt lgkmcnt(0)
    v_mfma_f32_16x16x32_bf16 v[40:43], a[120:123], v[208:211], v[40:43]
    v_mfma_f32_16x16x32_bf16 v[40:43], a[124:127], v[216:219], v[40:43]
    v_mfma_f32_16x16x32_bf16 v[44:47], a[96:99], v[160:163], 0
    v_mfma_f32_16x16x32_bf16 v[44:47], a[100:103], v[168:171], v[44:47]
    v_mfma_f32_16x16x32_bf16 v[44:47], a[104:107], v[176:179], v[44:47]
    v_mfma_f32_16x16x32_bf16 v[44:47], a[108:111], v[184:187], v[44:47]
    v_mfma_f32_16x16x32_bf16 v[44:47], a[112:115], v[224:227], v[44:47]
    v_mfma_f32_16x16x32_bf16 v[44:47], a[116:119], v[232:235], v[44:47]
    v_mfma_f32_16x16x32_bf16 v[44:47], a[120:123], v[240:243], v[44:47]
    v_mfma_f32_16x16x32_bf16 v[44:47], a[124:127], v[248:251], v[44:47]
    s_nop 7
    v_cvt_pk_bf16_f32 v48, v32, v33
    v_cvt_pk_bf16_f32 v49, v34, v35
    v_cvt_pk_bf16_f32 v50, v40, v41
    v_cvt_pk_bf16_f32 v51, v42, v43
    s_nop 1
    v_permlane32_swap_b32 v48, v50
    v_permlane32_swap_b32 v49, v51
    s_mov_b32 s54, 8192
    buffer_store_dwordx4 v[48:51], v10, s[40:43], s54 offen offset:512 sc1
    v_cvt_pk_bf16_f32 v52, v36, v37
    v_cvt_pk_bf16_f32 v53, v38, v39
    v_cvt_pk_bf16_f32 v54, v44, v45
    v_cvt_pk_bf16_f32 v55, v46, v47
    s_nop 1
    v_permlane32_swap_b32 v52, v54
    v_permlane32_swap_b32 v53, v55
    s_mov_b32 s54, 303104
    buffer_store_dwordx4 v[52:55], v10, s[40:43], s54 offen offset:512 sc1
    buffer_load_dword v9, v6, s[84:87], s47 offen sc1
    s_movk_i32 s45, 4608
    buffer_load_dwordx4 v[76:79], v5, s[84:87], s45 offen sc1
    s_movk_i32 s45, 18432
    buffer_load_dwordx4 v[88:91], v5, s[84:87], s45 offen sc1
    s_movk_i32 s45, 8704
    buffer_load_dwordx4 v[80:83], v5, s[84:87], s45 offen sc1
    s_movk_i32 s45, 22528
    buffer_load_dwordx4 v[92:95], v5, s[84:87], s45 offen sc1
    s_movk_i32 s45, 12800
    buffer_load_dwordx4 v[84:87], v59, s[84:87], s45 offen sc1
    s_movk_i32 s45, 26624
    buffer_load_dwordx4 v[96:99], v59, s[84:87], s45 offen sc1
    buffer_load_dwordx4 v[224:227], v12, s[36:39], 0 offen offset:0
    buffer_load_dwordx4 v[232:235], v12, s[36:39], 0 offen offset:512
    buffer_load_dwordx4 v[240:243], v13, s[36:39], 0 offen offset:1024
    buffer_load_dwordx4 v[64:67], v1, s[76:79], 0 offen offset:0
    buffer_load_dwordx4 v[68:71], v1, s[76:79], 0 offen offset:512
    buffer_load_dwordx4 v[72:75], v2, s[76:79], 0 offen offset:0
    s_waitcnt vmcnt(13)
    buffer_store_dword v3, v15, s[84:87], s56 offen sc1
    s_movk_i32 s48, 0x1111
    v_lshrrev_b32 v15, 4, v0
    v_mul_u32_u24 v15, 9216, v15
    v_add_u32 v15, 4096, v15
    v_add_u32 v7, v59, v15
    s_waitcnt vmcnt(13)
    v_cmp_ne_u32 vcc, 0, v9
    s_nop 0
    s_lshr_b32 s3, vcc_lo, 1
    s_and_b32 s3, s3, vcc_lo
    s_lshr_b32 s14, s3, 2
    s_and_b32 s3, s3, s14
    s_and_b32 s3, s3, s48
    s_cbranch_scc0 L2_g0s
L2_g0r:
    s_ff1_i32_b32 s3, s3
    s_bitset0_b32 s48, s3
    s_mul_i32 s46, s3, 9216
    buffer_load_dwordx4 v[112:115], v7, s[88:91], s46 offen sc1
    buffer_load_dwordx4 v[116:119], v5, s[88:91], s46 offen sc1
    buffer_load_dwordx4 v[120:123], v5, s[28:31], s46 offen sc1
    s_add_u32 s46, s46, 9216
    buffer_load_dwordx4 v[124:127], v5, s[88:91], s46 offen sc1
    buffer_load_dwordx4 v[128:131], v5, s[28:31], s46 offen sc1
    s_add_u32 s46, s46, 9216
    buffer_load_dwordx4 v[132:135], v5, s[88:91], s46 offen sc1
    buffer_load_dwordx4 v[136:139], v5, s[28:31], s46 offen sc1
    s_add_u32 s46, s46, 9216
    buffer_load_dwordx4 v[140:143], v5, s[88:91], s46 offen sc1
    buffer_load_dwordx4 v[144:147], v5, s[28:31], s46 offen sc1
    v_cmp_ne_u32 vcc, 0, v9
    s_nop 0
    s_lshr_b32 s3, vcc_lo, 1
    s_and_b32 s3, s3, vcc_lo
    s_lshr_b32 s14, s3, 2
    s_and_b32 s3, s3, s14
    s_and_b32 s3, s3, s48
    s_cbranch_scc0 L2_g1s
L2_g1r:
    s_ff1_i32_b32 s3, s3
    s_bitset0_b32 s48, s3
    s_mul_i32 s46, s3, 9216
    buffer_load_dword v9, v6, s[84:87], s47 offen sc1
    buffer_load_dwordx4 v[148:151], v7, s[88:91], s46 offen sc1
    buffer_load_dwordx4 v[152:155], v5, s[88:91], s46 offen sc1
    buffer_load_dwordx4 v[156:159], v5, s[28:31], s46 offen sc1
    s_add_u32 s46, s46, 9216
    buffer_load_dwordx4 v[160:163], v5, s[88:91], s46 offen sc1
    buffer_load_dwordx4 v[164:167], v5, s[28:31], s46 offen sc1
    s_add_u32 s46, s46, 9216
    buffer_load_dwordx4 v[168:171], v5, s[88:91], s46 offen sc1
    buffer_load_dwordx4 v[172:175], v5, s[28:31], s46 offen sc1
    s_add_u32 s46, s46, 9216
    buffer_load_dwordx4 v[176:179], v5, s[88:91], s46 offen sc1
    buffer_load_dwordx4 v[180:183], v5, s[28:31], s46 offen sc1
    s_waitcnt vmcnt(20)
    v_mov_b32 v14, v13
    v_max_u32 v13, v76, v77
    v_max3_u32 v13, v13, v78, v79
    v_max3_u32 v13, v13, v88, v89
    v_max3_u32 v13, v13, v90, v91
    v_max3_u32 v13, v13, v80, v81
    v_max3_u32 v13, v13, v82, v83
    v_max3_u32 v13, v13, v92, v93
    v_max3_u32 v13, v13, v94, v95
    v_max3_u32 v13, v13, v84, v85
    v_max3_u32 v13, v13, v86, v87
    v_max3_u32 v13, v13, v96, v97
    v_max3_u32 v13, v13, v98, v99
    v_cmp_eq_u32 vcc, -1, v13
    s_nop 0
    s_cmp_lg_u64 vcc, 0
    s_cbranch_scc1 L2_pns
L2_pnr:
    v_pk_add_f32 v[76:77], v[76:77], v[88:89]
    v_pk_add_f32 v[78:79], v[78:79], v[90:91]
    ds_write_b128 v5, v[76:79] offset:0
    v_pk_add_f32 v[80:81], v[80:81], v[92:93]
    v_pk_add_f32 v[82:83], v[82:83], v[94:95]
    ds_write_b128 v5, v[80:83] offset:4096
    v_pk_add_f32 v[84:85], v[84:85], v[96:97]
    v_pk_add_f32 v[86:87], v[86:87], v[98:99]
    ds_write_b128 v59, v[84:87] offset:8192
    s_waitcnt lgkmcnt(0)
    s_barrier
    v_lshlrev_b32 v3, 1, v12
    v_lshlrev_b32 v4, 1, v14
    ds_read_b128 v[76:79], v3 offset:4608
    ds_read_b128 v[80:83], v3 offset:4624
    ds_read_b128 v[84:87], v3 offset:5632
    ds_read_b128 v[88:91], v3 offset:5648
    ds_read_b128 v[92:95], v4 offset:6656
    ds_read_b128 v[96:99], v4 offset:6672
    ds_read_b128 v[40:43], v3 offset:2304
    ds_read_b128 v[44:47], v3 offset:2320
    ds_read_b128 v[48:51], v3 offset:3328
    ds_read_b128 v[52:55], v3 offset:3344
    ds_read_b128 v[56:59], v4 offset:4352
    ds_read_b128 v[60:63], v4 offset:4368
    ds_write_b128 v106, a[20:23] offset:36864
    ds_write_b128 v106, a[24:27] offset:37888
    s_waitcnt lgkmcnt(2)
    v_lshlrev_b32 v12, 16, v224
    v_and_b32 v13, 0xffff0000, v224
    v_pk_mul_f32 v[76:77], v[76:77], v[12:13]
    v_pk_mul_f32 v[40:41], v[40:41], v[12:13]
    v_lshlrev_b32 v14, 16, v225
    v_and_b32 v15, 0xffff0000, v225
    v_pk_mul_f32 v[78:79], v[78:79], v[14:15]
    v_pk_mul_f32 v[42:43], v[42:43], v[14:15]
    v_lshlrev_b32 v12, 16, v226
    v_and_b32 v13, 0xffff0000, v226
    v_pk_mul_f32 v[80:81], v[80:81], v[12:13]
    v_pk_mul_f32 v[44:45], v[44:45], v[12:13]
    v_lshlrev_b32 v14, 16, v227
    v_and_b32 v15, 0xffff0000, v227
    v_pk_mul_f32 v[82:83], v[82:83], v[14:15]
    v_pk_mul_f32 v[46:47], v[46:47], v[14:15]
    v_lshlrev_b32 v12, 16, v232
    v_and_b32 v13, 0xffff0000, v232
    v_pk_mul_f32 v[84:85], v[84:85], v[12:13]
    v_pk_mul_f32 v[48:49], v[48:49], v[12:13]
    v_lshlrev_b32 v14, 16, v233
    v_and_b32 v15, 0xffff0000, v233
    v_pk_mul_f32 v[86:87], v[86:87], v[14:15]
    v_pk_mul_f32 v[50:51], v[50:51], v[14:15]
    ds_write_b128 v106, a[28:31] offset:38912
    ds_write_b128 v106, a[32:35] offset:39936
    v_lshlrev_b32 v12, 16, v234
    v_and_b32 v13, 0xffff0000, v234
    v_pk_mul_f32 v[88:89], v[88:89], v[12:13]
    v_pk_mul_f32 v[52:53], v[52:53], v[12:13]
    v_lshlrev_b32 v14, 16, v235
    v_and_b32 v15, 0xffff0000, v235
    v_pk_mul_f32 v[90:91], v[90:91], v[14:15]
    v_pk_mul_f32 v[54:55], v[54:55], v[14:15]
    v_lshlrev_b32 v12, 16, v240
    v_and_b32 v13, 0xffff0000, v240
    v_pk_mul_f32 v[92:93], v[92:93], v[12:13]
    v_pk_mul_f32 v[56:57], v[56:57], v[12:13]
    v_lshlrev_b32 v14, 16, v241
    v_and_b32 v15, 0xffff0000, v241
    v_pk_mul_f32 v[94:95], v[94:95], v[14:15]
    v_pk_mul_f32 v[58:59], v[58:59], v[14:15]
    v_lshlrev_b32 v12, 16, v242
    v_and_b32 v13, 0xffff0000, v242
    v_pk_mul_f32 v[96:97], v[96:97], v[12:13]
    v_pk_mul_f32 v[60:61], v[60:61], v[12:13]
    v_lshlrev_b32 v14, 16, v243
    v_and_b32 v15, 0xffff0000, v243
    v_pk_mul_f32 v[98:99], v[98:99], v[14:15]
    v_pk_mul_f32 v[62:63], v[62:63], v[14:15]
    ds_write_b128 v106, a[36:39] offset:40960
    ds_write_b128 v106, a[40:43] offset:41984
    v_pk_add_f32 v[12:13], v[76:77], v[78:79]
    v_pk_add_f32 v[12:13], v[12:13], v[80:81]
    v_pk_add_f32 v[12:13], v[12:13], v[82:83]
    v_pk_add_f32 v[12:13], v[12:13], v[84:85]
    v_pk_add_f32 v[12:13], v[12:13], v[86:87]
    v_pk_add_f32 v[12:13], v[12:13], v[88:89]
    v_pk_add_f32 v[12:13], v[12:13], v[90:91]
    v_pk_add_f32 v[14:15], v[92:93], v[94:95]
    v_pk_add_f32 v[14:15], v[14:15], v[96:97]
    v_pk_add_f32 v[14:15], v[14:15], v[98:99]
    v_add_f32 v100, v12, v13
    v_add_f32 v14, v14, v15
    v_fmac_f32 v100, 0x3e800000, v14
    v_pk_add_f32 v[12:13], v[40:41], v[42:43]
    v_pk_add_f32 v[12:13], v[12:13], v[44:45]
    v_pk_add_f32 v[12:13], v[12:13], v[46:47]
    v_pk_add_f32 v[12:13], v[12:13], v[48:49]
    v_pk_add_f32 v[12:13], v[12:13], v[50:51]
    v_pk_add_f32 v[12:13], v[12:13], v[52:53]
    v_pk_add_f32 v[12:13], v[12:13], v[54:55]
    v_pk_add_f32 v[14:15], v[56:57], v[58:59]
    v_pk_add_f32 v[14:15], v[14:15], v[60:61]
    v_pk_add_f32 v[14:15], v[14:15], v[62:63]
    v_add_f32 v101, v12, v13
    v_add_f32 v14, v14, v15
    v_fmac_f32 v101, 0x3e800000, v14
    ds_read_b128 v[40:43], v3 offset:0
    ds_read_b128 v[44:47], v3 offset:16
    ds_read_b128 v[48:51], v3 offset:1024
    ds_read_b128 v[52:55], v3 offset:1040
    ds_read_b128 v[56:59], v4 offset:2048
    ds_read_b128 v[60:63], v4 offset:2064
    ds_write_b128 v106, a[44:47] offset:43008
    ds_write_b128 v106, a[48:51] offset:44032
    s_nop 1
    v_add_f32_dpp v100, v100, v100 row_ror:8 row_mask:0xf bank_mask:0xf
    v_add_f32_dpp v101, v101, v101 row_ror:8 row_mask:0xf bank_mask:0xf
    v_mov_b32 v102, v100
    v_mov_b32 v103, v101
    s_nop 0
    v_permlane16_swap_b32 v102, v100
    v_permlane16_swap_b32 v103, v101
    v_add_f32 v100, v100, v102
    v_add_f32 v101, v101, v103
    v_mov_b32 v102, v100
    v_mov_b32 v103, v101
    s_nop 0
    v_permlane32_swap_b32 v102, v100
    v_permlane32_swap_b32 v103, v101
    v_add_f32 v100, v100, v102
    v_add_f32 v101, v101, v103
    v_and_b32 v14, 7, v0
    v_lshlrev_b32 v11, 4, v14
    v_add_u32 v11, 14080, v11
    s_lshl_b32 s3, s51, 2
    v_add_u32 v10, s3, v11
    ds_write_b32 v10, v100 offset:384
    ds_write_b32 v10, v101 offset:512
    v_lshl_add_u32 v1, v14, 4, v1
    v_lshl_add_u32 v2, v14, 4, v2
    v_add_u32 v1, 90112, v1
    v_add_u32 v2, 90112, v2
    s_and_b32 s14, s51, 1
    s_mul_i32 s14, s14, 9344
    s_add_u32 s14, s14, 90112
    v_add_u32 v107, s14, v8
    v_lshrrev_b32 v15, 3, v0
    v_mul_u32_u24 v12, 1024, v15
    v_add_u32 v109, v12, v8
    v_lshl_add_u32 v12, v15, 4, v12
    v_add_u32 v108, v12, v107
    s_mul_i32 s3, s96, 9216
    s_cmp_eq_u32 s51, 3
    s_cselect_b32 s3, 0, s3
    s_cselect_b64 s[24:25], s[32:33], s[80:81]
    s_add_u32 s24, s24, s3
    s_addc_u32 s25, s25, 0
    s_mov_b32 s26, 9216
    s_mov_b32 s27, 0x20000
    ds_write_b128 v106, a[52:55] offset:45056
    ds_write_b128 v105, a[128:131] offset:0
    s_waitcnt lgkmcnt(2)
    s_waitcnt vmcnt(18)
    ds_write_b128 v105, a[132:135] offset:1024
    ds_write_b128 v105, a[136:139] offset:2048
    v_lshlrev_b32 v32, 16, v112
    v_and_b32 v33, 0xffff0000, v112
    v_lshlrev_b32 v34, 16, v113
    v_and_b32 v35, 0xffff0000, v113
    v_lshlrev_b32 v36, 16, v114
    v_and_b32 v37, 0xffff0000, v114
    v_lshlrev_b32 v38, 16, v115
    v_and_b32 v39, 0xffff0000, v115
    s_waitcnt vmcnt(17)
    ds_write_b128 v105, a[140:143] offset:3072
    ds_write_b128 v105, a[144:147] offset:4096
    v_lshlrev_b32 v24, 16, v116
    v_and_b32 v25, 0xffff0000, v116
    v_lshlrev_b32 v26, 16, v117
    v_and_b32 v27, 0xffff0000, v117
    v_lshlrev_b32 v28, 16, v118
    v_and_b32 v29, 0xffff0000, v118
    v_lshlrev_b32 v30, 16, v119
    v_and_b32 v31, 0xffff0000, v119
    s_waitcnt vmcnt(16)
    v_lshlrev_b32 v16, 16, v120
    v_and_b32 v17, 0xffff0000, v120
    v_lshlrev_b32 v18, 16, v121
    v_and_b32 v19, 0xffff0000, v121
    v_lshlrev_b32 v20, 16, v122
    v_and_b32 v21, 0xffff0000, v122
    v_lshlrev_b32 v22, 16, v123
    v_and_b32 v23, 0xffff0000, v123
    s_waitcnt vmcnt(15)
    ds_write_b128 v105, a[148:151] offset:5120
    ds_write_b128 v105, a[152:155] offset:6144
    v_lshlrev_b32 v100, 16, v124
    v_and_b32 v101, 0xffff0000, v124
    v_pk_add_f32 v[24:25], v[24:25], v[100:101]
    v_lshlrev_b32 v102, 16, v125
    v_and_b32 v103, 0xffff0000, v125
    v_pk_add_f32 v[26:27], v[26:27], v[102:103]
    v_lshlrev_b32 v100, 16, v126
    v_and_b32 v101, 0xffff0000, v126
    v_pk_add_f32 v[28:29], v[28:29], v[100:101]
    v_lshlrev_b32 v102, 16, v127
    v_and_b32 v103, 0xffff0000, v127
    v_pk_add_f32 v[30:31], v[30:31], v[102:103]
    s_waitcnt vmcnt(14)
    v_lshlrev_b32 v100, 16, v128
    v_and_b32 v101, 0xffff0000, v128
    v_pk_add_f32 v[16:17], v[16:17], v[100:101]
    v_lshlrev_b32 v102, 16, v129
    v_and_b32 v103, 0xffff0000, v129
    v_pk_add_f32 v[18:19], v[18:19], v[102:103]
    v_lshlrev_b32 v100, 16, v130
    v_and_b32 v101, 0xffff0000, v130
    v_pk_add_f32 v[20:21], v[20:21], v[100:101]
    v_lshlrev_b32 v102, 16, v131
    v_and_b32 v103, 0xffff0000, v131
    v_pk_add_f32 v[22:23], v[22:23], v[102:103]
    s_waitcnt vmcnt(13)
    ds_write_b128 v105, a[156:159] offset:7168
    ds_write_b128 v105, a[160:163] offset:8192
    v_lshlrev_b32 v100, 16, v132
    v_and_b32 v101, 0xffff0000, v132
    v_pk_add_f32 v[24:25], v[24:25], v[100:101]
    v_lshlrev_b32 v102, 16, v133
    v_and_b32 v103, 0xffff0000, v133
    v_pk_add_f32 v[26:27], v[26:27], v[102:103]
    v_lshlrev_b32 v100, 16, v134
    v_and_b32 v101, 0xffff0000, v134
    v_pk_add_f32 v[28:29], v[28:29], v[100:101]
    v_lshlrev_b32 v102, 16, v135
    v_and_b32 v103, 0xffff0000, v135
    v_pk_add_f32 v[30:31], v[30:31], v[102:103]
    s_waitcnt vmcnt(12)
    v_lshlrev_b32 v100, 16, v136
    v_and_b32 v101, 0xffff0000, v136
    v_pk_add_f32 v[16:17], v[16:17], v[100:101]
    v_lshlrev_b32 v102, 16, v137
    v_and_b32 v103, 0xffff0000, v137
    v_pk_add_f32 v[18:19], v[18:19], v[102:103]
    v_lshlrev_b32 v100, 16, v138
    v_and_b32 v101, 0xffff0000, v138
    v_pk_add_f32 v[20:21], v[20:21], v[100:101]
    v_lshlrev_b32 v102, 16, v139
    v_and_b32 v103, 0xffff0000, v139
    v_pk_add_f32 v[22:23], v[22:23], v[102:103]
    s_waitcnt vmcnt(11)
    ds_write_b128 v104, a[164:167] offset:36864
    ds_write_b128 v104, a[168:171] offset:37888
    v_lshlrev_b32 v100, 16, v140
    v_and_b32 v101, 0xffff0000, v140
    v_pk_add_f32 v[24:25], v[24:25], v[100:101]
    v_lshlrev_b32 v102, 16, v141
    v_and_b32 v103, 0xffff0000, v141
    v_pk_add_f32 v[26:27], v[26:27], v[102:103]
    v_lshlrev_b32 v100, 16, v142
    v_and_b32 v101, 0xffff0000, v142
    v_pk_add_f32 v[28:29], v[28:29], v[100:101]
    v_lshlrev_b32 v102, 16, v143
    v_and_b32 v103, 0xffff0000, v143
    v_pk_add_f32 v[30:31], v[30:31], v[102:103]
    s_waitcnt vmcnt(10)
    v_lshlrev_b32 v100, 16, v144
    v_and_b32 v101, 0xffff0000, v144
    v_pk_add_f32 v[16:17], v[16:17], v[100:101]
    v_lshlrev_b32 v102, 16, v145
    v_and_b32 v103, 0xffff0000, v145
    v_pk_add_f32 v[18:19], v[18:19], v[102:103]
    v_lshlrev_b32 v100, 16, v146
    v_and_b32 v101, 0xffff0000, v146
    v_pk_add_f32 v[20:21], v[20:21], v[100:101]
    v_lshlrev_b32 v102, 16, v147
    v_and_b32 v103, 0xffff0000, v147
    v_pk_add_f32 v[22:23], v[22:23], v[102:103]
    s_waitcnt vmcnt(8)
    ds_write_b128 v104, a[172:175] offset:38912
    ds_write_b128 v104, a[176:179] offset:39936
    v_lshlrev_b32 v100, 16, v148
    v_and_b32 v101, 0xffff0000, v148
    v_pk_add_f32 v[32:33], v[32:33], v[100:101]
    v_lshlrev_b32 v102, 16, v149
    v_and_b32 v103, 0xffff0000, v149
    v_pk_add_f32 v[34:35], v[34:35], v[102:103]
    v_lshlrev_b32 v100, 16, v150
    v_and_b32 v101, 0xffff0000, v150
    v_pk_add_f32 v[36:37], v[36:37], v[100:101]
    v_lshlrev_b32 v102, 16, v151
    v_and_b32 v103, 0xffff0000, v151
    v_pk_add_f32 v[38:39], v[38:39], v[102:103]
    s_waitcnt vmcnt(7)
    ds_write_b128 v104, a[180:183] offset:40960
    ds_write_b128 v104, a[184:187] offset:41984
    v_lshlrev_b32 v100, 16, v152
    v_and_b32 v101, 0xffff0000, v152
    v_pk_add_f32 v[24:25], v[24:25], v[100:101]
    v_lshlrev_b32 v102, 16, v153
    v_and_b32 v103, 0xffff0000, v153
    v_pk_add_f32 v[26:27], v[26:27], v[102:103]
    v_lshlrev_b32 v100, 16, v154
    v_and_b32 v101, 0xffff0000, v154
    v_pk_add_f32 v[28:29], v[28:29], v[100:101]
    v_lshlrev_b32 v102, 16, v155
    v_and_b32 v103, 0xffff0000, v155
    v_pk_add_f32 v[30:31], v[30:31], v[102:103]
    s_waitcnt vmcnt(6)
    v_lshlrev_b32 v100, 16, v156
    v_and_b32 v101, 0xffff0000, v156
    v_pk_add_f32 v[16:17], v[16:17], v[100:101]
    v_lshlrev_b32 v102, 16, v157
    v_and_b32 v103, 0xffff0000, v157
    v_pk_add_f32 v[18:19], v[18:19], v[102:103]
    v_lshlrev_b32 v100, 16, v158
    v_and_b32 v101, 0xffff0000, v158
    v_pk_add_f32 v[20:21], v[20:21], v[100:101]
    v_lshlrev_b32 v102, 16, v159
    v_and_b32 v103, 0xffff0000, v159
    v_pk_add_f32 v[22:23], v[22:23], v[102:103]
    s_waitcnt vmcnt(5)
    v_cmp_ne_u32 vcc, 0, v9
    s_nop 0
    s_lshr_b32 s3, vcc_lo, 1
    s_and_b32 s3, s3, vcc_lo
    s_lshr_b32 s14, s3, 2
    s_and_b32 s3, s3, s14
    s_and_b32 s3, s3, s48
    s_cbranch_scc0 L2_g2s
L2_g2r:
    s_ff1_i32_b32 s3, s3
    s_bitset0_b32 s48, s3
    s_mul_i32 s46, s3, 9216
    buffer_load_dword v9, v6, s[84:87], s47 offen sc1
    buffer_load_dwordx4 v[184:187], v7, s[88:91], s46 offen sc1
    ds_write_b128 v104, a[188:191] offset:43008
    ds_write_b128 v104, a[192:195] offset:44032
    v_lshlrev_b32 v100, 16, v160
    v_and_b32 v101, 0xffff0000, v160
    v_pk_add_f32 v[24:25], v[24:25], v[100:101]
    v_lshlrev_b32 v102, 16, v161
    v_and_b32 v103, 0xffff0000, v161
    v_pk_add_f32 v[26:27], v[26:27], v[102:103]
    v_lshlrev_b32 v100, 16, v162
    v_and_b32 v101, 0xffff0000, v162
    v_pk_add_f32 v[28:29], v[28:29], v[100:101]
    v_lshlrev_b32 v102, 16, v163
    v_and_b32 v103, 0xffff0000, v163
    v_pk_add_f32 v[30:31], v[30:31], v[102:103]
    s_waitcnt vmcnt(6)
    v_lshlrev_b32 v100, 16, v164
    v_and_b32 v101, 0xffff0000, v164
    v_pk_add_f32 v[16:17], v[16:17], v[100:101]
    v_lshlrev_b32 v102, 16, v165
    v_and_b32 v103, 0xffff0000, v165
    v_pk_add_f32 v[18:19], v[18:19], v[102:103]
    v_lshlrev_b32 v100, 16, v166
    v_and_b32 v101, 0xffff0000, v166
    v_pk_add_f32 v[20:21], v[20:21], v[100:101]
    v_lshlrev_b32 v102, 16, v167
    v_and_b32 v103, 0xffff0000, v167
    v_pk_add_f32 v[22:23], v[22:23], v[102:103]
    s_waitcnt vmcnt(5)
    buffer_load_dwordx4 v[188:191], v5, s[88:91], s46 offen sc1
    buffer_load_dwordx4 v[192:195], v5, s[28:31], s46 offen sc1
    ds_write_b128 v104, a[196:199] offset:45056
    v_lshlrev_b32 v100, 16, v168
    v_and_b32 v101, 0xffff0000, v168
    v_pk_add_f32 v[24:25], v[24:25], v[100:101]
    v_lshlrev_b32 v102, 16, v169
    v_and_b32 v103, 0xffff0000, v169
    v_pk_add_f32 v[26:27], v[26:27], v[102:103]
    v_lshlrev_b32 v100, 16, v170
    v_and_b32 v101, 0xffff0000, v170
    v_pk_add_f32 v[28:29], v[28:29], v[100:101]
    v_lshlrev_b32 v102, 16, v171
    v_and_b32 v103, 0xffff0000, v171
    v_pk_add_f32 v[30:31], v[30:31], v[102:103]
    s_waitcnt vmcnt(6)
    v_lshlrev_b32 v100, 16, v172
    v_and_b32 v101, 0xffff0000, v172
    v_pk_add_f32 v[16:17], v[16:17], v[100:101]
    v_lshlrev_b32 v102, 16, v173
    v_and_b32 v103, 0xffff0000, v173
    v_pk_add_f32 v[18:19], v[18:19], v[102:103]
    v_lshlrev_b32 v100, 16, v174
    v_and_b32 v101, 0xffff0000, v174
    v_pk_add_f32 v[20:21], v[20:21], v[100:101]
    v_lshlrev_b32 v102, 16, v175
    v_and_b32 v103, 0xffff0000, v175
    v_pk_add_f32 v[22:23], v[22:23], v[102:103]
    s_waitcnt vmcnt(5)
    s_add_u32 s46, s46, 9216
    buffer_load_dwordx4 v[196:199], v5, s[88:91], s46 offen sc1
    buffer_load_dwordx4 v[200:203], v5, s[28:31], s46 offen sc1
    v_lshlrev_b32 v100, 16, v176
    v_and_b32 v101, 0xffff0000, v176
    v_pk_add_f32 v[24:25], v[24:25], v[100:101]
L2_pad14:
    s_cbranch_execz L2_walkret
    v_lshlrev_b32 v102, 16, v177
    v_and_b32 v103, 0xffff0000, v177
    v_pk_add_f32 v[26:27], v[26:27], v[102:103]
    v_lshlrev_b32 v100, 16, v178
    v_and_b32 v101, 0xffff0000, v178
    v_pk_add_f32 v[28:29], v[28:29], v[100:101]
    v_lshlrev_b32 v102, 16, v179
    v_and_b32 v103, 0xffff0000, v179
    v_pk_add_f32 v[30:31], v[30:31], v[102:103]
    s_waitcnt vmcnt(6)
    v_lshlrev_b32 v100, 16, v180
    v_and_b32 v101, 0xffff0000, v180
    v_pk_add_f32 v[16:17], v[16:17], v[100:101]
    v_lshlrev_b32 v102, 16, v181
    v_and_b32 v103, 0xffff0000, v181
    v_pk_add_f32 v[18:19], v[18:19], v[102:103]
    v_lshlrev_b32 v100, 16, v182
    v_and_b32 v101, 0xffff0000, v182
    v_pk_add_f32 v[20:21], v[20:21], v[100:101]
    v_lshlrev_b32 v102, 16, v183
    v_and_b32 v103, 0xffff0000, v183
    v_pk_add_f32 v[22:23], v[22:23], v[102:103]
    s_waitcnt vmcnt(4)
    s_add_u32 s46, s46, 9216
    buffer_load_dwordx4 v[204:207], v5, s[88:91], s46 offen sc1
    buffer_load_dwordx4 v[208:211], v5, s[28:31], s46 offen sc1
    v_lshlrev_b32 v100, 16, v184
    v_and_b32 v101, 0xffff0000, v184
    v_pk_add_f32 v[32:33], v[32:33], v[100:101]
    v_lshlrev_b32 v102, 16, v185
    v_and_b32 v103, 0xffff0000, v185
    v_pk_add_f32 v[34:35], v[34:35], v[102:103]
    v_lshlrev_b32 v100, 16, v186
    v_and_b32 v101, 0xffff0000, v186
    v_pk_add_f32 v[36:37], v[36:37], v[100:101]
    v_lshlrev_b32 v102, 16, v187
    v_and_b32 v103, 0xffff0000, v187
    v_pk_add_f32 v[38:39], v[38:39], v[102:103]
    ds_read_b128 v[112:115], v3 offset:4608
    ds_read_b128 v[116:119], v3 offset:4624
    ds_read_b128 v[120:123], v3 offset:5632
    ds_read_b128 v[124:127], v3 offset:5648
    ds_read_b128 v[128:131], v4 offset:6656
    ds_read_b128 v[132:135], v4 offset:6672
    ds_read_b128 v[136:139], v3 offset:2304
    ds_read_b128 v[140:143], v3 offset:2320
    ds_read_b128 v[144:147], v3 offset:3328
    ds_read_b128 v[148:151], v3 offset:3344
    ds_read_b128 v[152:155], v4 offset:4352
    ds_read_b128 v[156:159], v4 offset:4368
    ds_read_b128 v[160:163], v3 offset:6912
    ds_read_b128 v[164:167], v3 offset:6928
    ds_read_b128 v[168:171], v3 offset:7936
    ds_read_b128 v[172:175], v3 offset:7952
    ds_read_b128 v[176:179], v4 offset:8960
    ds_read_b128 v[180:183], v4 offset:8976
    s_waitcnt vmcnt(5)
    s_add_u32 s46, s46, 9216
    buffer_load_dwordx4 v[212:215], v5, s[88:91], s46 offen sc1
    buffer_load_dwordx4 v[216:219], v5, s[28:31], s46 offen sc1
    v_lshlrev_b32 v100, 16, v188
    v_and_b32 v101, 0xffff0000, v188
    v_pk_add_f32 v[24:25], v[24:25], v[100:101]
    v_lshlrev_b32 v102, 16, v189
    v_and_b32 v103, 0xffff0000, v189
    v_pk_add_f32 v[26:27], v[26:27], v[102:103]
    v_lshlrev_b32 v100, 16, v190
    v_and_b32 v101, 0xffff0000, v190
    v_pk_add_f32 v[28:29], v[28:29], v[100:101]
    v_lshlrev_b32 v102, 16, v191
    v_and_b32 v103, 0xffff0000, v191
    v_pk_add_f32 v[30:31], v[30:31], v[102:103]
    s_waitcnt vmcnt(6)
    v_lshlrev_b32 v100, 16, v192
    v_and_b32 v101, 0xffff0000, v192
    v_pk_add_f32 v[16:17], v[16:17], v[100:101]
    v_lshlrev_b32 v102, 16, v193
    v_and_b32 v103, 0xffff0000, v193
    v_pk_add_f32 v[18:19], v[18:19], v[102:103]
    v_lshlrev_b32 v100, 16, v194
    v_and_b32 v101, 0xffff0000, v194
    v_pk_add_f32 v[20:21], v[20:21], v[100:101]
    v_lshlrev_b32 v102, 16, v195
    v_and_b32 v103, 0xffff0000, v195
    v_pk_add_f32 v[22:23], v[22:23], v[102:103]
    s_waitcnt vmcnt(5)
    v_cmp_ne_u32 vcc, 0, v9
    s_nop 0
    s_lshr_b32 s3, vcc_lo, 1
    s_and_b32 s3, s3, vcc_lo
    s_lshr_b32 s14, s3, 2
    s_and_b32 s3, s3, s14
    s_and_b32 s3, s3, s48
    s_cbranch_scc0 L2_g3s
L2_g3r:
    s_ff1_i32_b32 s3, s3
    s_bitset0_b32 s48, s3
    s_mul_i32 s46, s3, 9216
    buffer_load_dwordx4 v[220:223], v7, s[88:91], s46 offen sc1
    v_lshlrev_b32 v100, 16, v196
    v_and_b32 v101, 0xffff0000, v196
    v_pk_add_f32 v[24:25], v[24:25], v[100:101]
    v_lshlrev_b32 v102, 16, v197
    v_and_b32 v103, 0xffff0000, v197
    v_pk_add_f32 v[26:27], v[26:27], v[102:103]
    v_lshlrev_b32 v100, 16, v198
    v_and_b32 v101, 0xffff0000, v198
    v_pk_add_f32 v[28:29], v[28:29], v[100:101]
    v_lshlrev_b32 v102, 16, v199
    v_and_b32 v103, 0xffff0000, v199
    v_pk_add_f32 v[30:31], v[30:31], v[102:103]
    s_waitcnt vmcnt(5)
    v_lshlrev_b32 v100, 16, v200
    v_and_b32 v101, 0xffff0000, v200
    v_pk_add_f32 v[16:17], v[16:17], v[100:101]
    v_lshlrev_b32 v102, 16, v201
    v_and_b32 v103, 0xffff0000, v201
    v_pk_add_f32 v[18:19], v[18:19], v[102:103]
    v_lshlrev_b32 v100, 16, v202
    v_and_b32 v101, 0xffff0000, v202
    v_pk_add_f32 v[20:21], v[20:21], v[100:101]
    v_lshlrev_b32 v102, 16, v203
    v_and_b32 v103, 0xffff0000, v203
    v_pk_add_f32 v[22:23], v[22:23], v[102:103]
    s_waitcnt vmcnt(4)
    buffer_load_dwordx4 v[224:227], v5, s[88:91], s46 offen sc1
    buffer_load_dwordx4 v[228:231], v5, s[28:31], s46 offen sc1
    v_lshlrev_b32 v100, 16, v204
    v_and_b32 v101, 0xffff0000, v204
    v_pk_add_f32 v[24:25], v[24:25], v[100:101]
    v_lshlrev_b32 v102, 16, v205
    v_and_b32 v103, 0xffff0000, v205
    v_pk_add_f32 v[26:27], v[26:27], v[102:103]
    v_lshlrev_b32 v100, 16, v206
    v_and_b32 v101, 0xffff0000, v206
    v_pk_add_f32 v[28:29], v[28:29], v[100:101]
    v_lshlrev_b32 v102, 16, v207
    v_and_b32 v103, 0xffff0000, v207
    v_pk_add_f32 v[30:31], v[30:31], v[102:103]
    s_waitcnt vmcnt(5)
    v_lshlrev_b32 v100, 16, v208
    v_and_b32 v101, 0xffff0000, v208
    v_pk_add_f32 v[16:17], v[16:17], v[100:101]
    v_lshlrev_b32 v102, 16, v209
    v_and_b32 v103, 0xffff0000, v209
    v_pk_add_f32 v[18:19], v[18:19], v[102:103]
    v_lshlrev_b32 v100, 16, v210
    v_and_b32 v101, 0xffff0000, v210
    v_pk_add_f32 v[20:21], v[20:21], v[100:101]
    v_lshlrev_b32 v102, 16, v211
    v_and_b32 v103, 0xffff0000, v211
    v_pk_add_f32 v[22:23], v[22:23], v[102:103]
    s_waitcnt vmcnt(4)
    s_add_u32 s46, s46, 9216
    buffer_load_dwordx4 v[232:235], v5, s[88:91], s46 offen sc1
    buffer_load_dwordx4 v[236:239], v5, s[28:31], s46 offen sc1
    v_lshlrev_b32 v100, 16, v212
    v_and_b32 v101, 0xffff0000, v212
    v_pk_add_f32 v[24:25], v[24:25], v[100:101]
    v_lshlrev_b32 v102, 16, v213
    v_and_b32 v103, 0xffff0000, v213
    v_pk_add_f32 v[26:27], v[26:27], v[102:103]
    v_lshlrev_b32 v100, 16, v214
    v_and_b32 v101, 0xffff0000, v214
    v_pk_add_f32 v[28:29], v[28:29], v[100:101]
    v_lshlrev_b32 v102, 16, v215
    v_and_b32 v103, 0xffff0000, v215
    v_pk_add_f32 v[30:31], v[30:31], v[102:103]
    s_waitcnt vmcnt(5)
    v_lshlrev_b32 v100, 16, v216
    v_and_b32 v101, 0xffff0000, v216
    v_pk_add_f32 v[16:17], v[16:17], v[100:101]
    v_lshlrev_b32 v102, 16, v217
    v_and_b32 v103, 0xffff0000, v217
    v_pk_add_f32 v[18:19], v[18:19], v[102:103]
    v_lshlrev_b32 v100, 16, v218
    v_and_b32 v101, 0xffff0000, v218
    v_pk_add_f32 v[20:21], v[20:21], v[100:101]
    v_lshlrev_b32 v102, 16, v219
    v_and_b32 v103, 0xffff0000, v219
    v_pk_add_f32 v[22:23], v[22:23], v[102:103]
    s_waitcnt vmcnt(4)
    s_add_u32 s46, s46, 9216
    buffer_load_dwordx4 v[240:243], v5, s[88:91], s46 offen sc1
    buffer_load_dwordx4 v[244:247], v5, s[28:31], s46 offen sc1
    v_lshlrev_b32 v100, 16, v220
    v_and_b32 v101, 0xffff0000, v220
    v_pk_add_f32 v[32:33], v[32:33], v[100:101]
    v_lshlrev_b32 v102, 16, v221
    v_and_b32 v103, 0xffff0000, v221
    v_pk_add_f32 v[34:35], v[34:35], v[102:103]
    v_lshlrev_b32 v100, 16, v222
    v_and_b32 v101, 0xffff0000, v222
    v_pk_add_f32 v[36:37], v[36:37], v[100:101]
    v_lshlrev_b32 v102, 16, v223
    v_and_b32 v103, 0xffff0000, v223
    v_pk_add_f32 v[38:39], v[38:39], v[102:103]
    s_lshl_b32 s3, s96, 3
    s_sub_u32 s3, 0xfff, s3
    v_and_b32 v6, 7, v0
    v_sub_u32 v6, s3, v6
    s_mov_b32 s57, 0xfffff000
    s_mul_i32 s58, s96, 128
    s_add_u32 s58, s58, 6815744
    s_xor_b32 s3, s51, 2
    v_or_b32 v9, s3, v0
    v_min_u32 v9, 1, v9
    v_lshlrev_b32 v9, 30, v9
    v_mov_b32 v208, v32
    v_mov_b32 v209, v33
    v_mov_b32 v210, v34
    v_mov_b32 v211, v35
    v_mov_b32 v212, v36
    v_mov_b32 v213, v37
    v_mov_b32 v214, v38
    v_mov_b32 v215, v39
    v_permlane16_swap_b32 v208, v32
    v_permlane16_swap_b32 v209, v33
    v_permlane16_swap_b32 v210, v34
    v_permlane16_swap_b32 v211, v35
    v_permlane16_swap_b32 v212, v36
    v_permlane16_swap_b32 v213, v37
    v_permlane16_swap_b32 v214, v38
    v_permlane16_swap_b32 v215, v39
    v_add_f32 v32, v32, v208
    v_add_f32 v33, v33, v209
    v_add_f32 v34, v34, v210
    v_add_f32 v35, v35, v211
    v_add_f32 v36, v36, v212
    v_add_f32 v37, v37, v213
    v_add_f32 v38, v38, v214
    v_add_f32 v39, v39, v215
    v_mov_b32 v208, v32
    v_mov_b32 v209, v33
    v_mov_b32 v210, v34
    v_mov_b32 v211, v35
    v_mov_b32 v212, v36
    v_mov_b32 v213, v37
    v_mov_b32 v214, v38
    v_mov_b32 v215, v39
    v_permlane32_swap_b32 v208, v32
    v_permlane32_swap_b32 v209, v33
    v_permlane32_swap_b32 v210, v34
    v_permlane32_swap_b32 v211, v35
    v_permlane32_swap_b32 v212, v36
    v_permlane32_swap_b32 v213, v37
    v_permlane32_swap_b32 v214, v38
    v_permlane32_swap_b32 v215, v39
    v_add_f32 v32, v32, v208
    v_add_f32 v33, v33, v209
    v_add_f32 v34, v34, v210
    v_add_f32 v35, v35, v211
    v_add_f32 v36, v36, v212
    v_add_f32 v37, v37, v213
    v_add_f32 v38, v38, v214
    v_add_f32 v39, v39, v215
    v_lshlrev_b32 v184, 16, v64
    v_and_b32 v185, 0xffff0000, v64
    v_lshlrev_b32 v186, 16, v65
    v_and_b32 v187, 0xffff0000, v65
    v_lshlrev_b32 v188, 16, v66
    v_and_b32 v189, 0xffff0000, v66
    v_lshlrev_b32 v190, 16, v67
    v_and_b32 v191, 0xffff0000, v67
    v_lshlrev_b32 v192, 16, v68
    v_and_b32 v193, 0xffff0000, v68
    v_lshlrev_b32 v194, 16, v69
    v_and_b32 v195, 0xffff0000, v69
    v_lshlrev_b32 v196, 16, v70
    v_and_b32 v197, 0xffff0000, v70
    v_lshlrev_b32 v198, 16, v71
    v_and_b32 v199, 0xffff0000, v71
    v_lshlrev_b32 v200, 16, v72
    v_and_b32 v201, 0xffff0000, v72
    v_lshlrev_b32 v202, 16, v73
    v_and_b32 v203, 0xffff0000, v73
    v_lshlrev_b32 v204, 16, v74
    v_and_b32 v205, 0xffff0000, v74
    v_lshlrev_b32 v206, 16, v75
    v_and_b32 v207, 0xffff0000, v75
    s_cmp_lt_u32 s2, 180
    s_cselect_b32 s3, 2, 0
    s_cmp_lt_u32 s51, s3
    s_cselect_b32 s3, 0, 0x40000000
    v_mul_u32_u24 v68, 128, v0
    v_or_b32 v68, s3, v68
    s_mul_i32 s15, s51, 16384
    s_add_u32 s15, s15, 6815744
    s_add_u32 s59, s15, 8192
    s_lshl_b32 s3, s51, 7
    s_sub_u32 s3, s96, s3
    v_cmp_eq_u32 s[60:61], s3, v0
    s_sub_u32 s3, s3, 64
    v_cmp_eq_u32 s[62:63], s3, v0
    s_waitcnt vmcnt(5)
    s_add_u32 s46, s46, 9216
    buffer_load_dwordx4 v[248:251], v5, s[88:91], s46 offen sc1
    buffer_load_dwordx4 v[252:255], v5, s[28:31], s46 offen sc1
    v_lshlrev_b32 v100, 16, v224
    v_and_b32 v101, 0xffff0000, v224
    v_pk_add_f32 v[24:25], v[24:25], v[100:101]
    v_lshlrev_b32 v102, 16, v225
    v_and_b32 v103, 0xffff0000, v225
    v_pk_add_f32 v[26:27], v[26:27], v[102:103]
    v_lshlrev_b32 v100, 16, v226
    v_and_b32 v101, 0xffff0000, v226
    v_pk_add_f32 v[28:29], v[28:29], v[100:101]
    v_lshlrev_b32 v102, 16, v227
    v_and_b32 v103, 0xffff0000, v227
    v_pk_add_f32 v[30:31], v[30:31], v[102:103]
    s_waitcnt vmcnt(6)
    v_lshlrev_b32 v100, 16, v228
    v_and_b32 v101, 0xffff0000, v228
    v_pk_add_f32 v[16:17], v[16:17], v[100:101]
    v_lshlrev_b32 v102, 16, v229
    v_and_b32 v103, 0xffff0000, v229
    v_pk_add_f32 v[18:19], v[18:19], v[102:103]
    v_lshlrev_b32 v100, 16, v230
    v_and_b32 v101, 0xffff0000, v230
    v_pk_add_f32 v[20:21], v[20:21], v[100:101]
    v_lshlrev_b32 v102, 16, v231
    v_and_b32 v103, 0xffff0000, v231
    v_pk_add_f32 v[22:23], v[22:23], v[102:103]
    s_waitcnt vmcnt(5)
    v_lshlrev_b32 v100, 16, v232
    v_and_b32 v101, 0xffff0000, v232
    v_pk_add_f32 v[24:25], v[24:25], v[100:101]
    v_lshlrev_b32 v102, 16, v233
    v_and_b32 v103, 0xffff0000, v233
    v_pk_add_f32 v[26:27], v[26:27], v[102:103]
    v_lshlrev_b32 v100, 16, v234
    v_and_b32 v101, 0xffff0000, v234
    v_pk_add_f32 v[28:29], v[28:29], v[100:101]
    v_lshlrev_b32 v102, 16, v235
    v_and_b32 v103, 0xffff0000, v235
    v_pk_add_f32 v[30:31], v[30:31], v[102:103]
    s_waitcnt vmcnt(4)
    v_lshlrev_b32 v100, 16, v236
    v_and_b32 v101, 0xffff0000, v236
    v_pk_add_f32 v[16:17], v[16:17], v[100:101]
    v_lshlrev_b32 v102, 16, v237
    v_and_b32 v103, 0xffff0000, v237
    v_pk_add_f32 v[18:19], v[18:19], v[102:103]
    v_lshlrev_b32 v100, 16, v238
    v_and_b32 v101, 0xffff0000, v238
    v_pk_add_f32 v[20:21], v[20:21], v[100:101]
    v_lshlrev_b32 v102, 16, v239
    v_and_b32 v103, 0xffff0000, v239
    v_pk_add_f32 v[22:23], v[22:23], v[102:103]
    s_waitcnt vmcnt(3)
    v_lshlrev_b32 v100, 16, v240
    v_and_b32 v101, 0xffff0000, v240
    v_pk_add_f32 v[24:25], v[24:25], v[100:101]
    v_lshlrev_b32 v102, 16, v241
    v_and_b32 v103, 0xffff0000, v241
    v_pk_add_f32 v[26:27], v[26:27], v[102:103]
    v_lshlrev_b32 v100, 16, v242
    v_and_b32 v101, 0xffff0000, v242
    v_pk_add_f32 v[28:29], v[28:29], v[100:101]
    v_lshlrev_b32 v102, 16, v243
    v_and_b32 v103, 0xffff0000, v243
    v_pk_add_f32 v[30:31], v[30:31], v[102:103]
    s_waitcnt vmcnt(2)
    v_lshlrev_b32 v100, 16, v244
    v_and_b32 v101, 0xffff0000, v244
    v_pk_add_f32 v[16:17], v[16:17], v[100:101]
    v_lshlrev_b32 v102, 16, v245
    v_and_b32 v103, 0xffff0000, v245
    v_pk_add_f32 v[18:19], v[18:19], v[102:103]
    v_lshlrev_b32 v100, 16, v246
    v_and_b32 v101, 0xffff0000, v246
    v_pk_add_f32 v[20:21], v[20:21], v[100:101]
    v_lshlrev_b32 v102, 16, v247
    v_and_b32 v103, 0xffff0000, v247
    v_pk_add_f32 v[22:23], v[22:23], v[102:103]
    s_waitcnt vmcnt(1)
    v_lshlrev_b32 v100, 16, v248
    v_and_b32 v101, 0xffff0000, v248
    v_pk_add_f32 v[24:25], v[24:25], v[100:101]
    v_lshlrev_b32 v102, 16, v249
    v_and_b32 v103, 0xffff0000, v249
    v_pk_add_f32 v[26:27], v[26:27], v[102:103]
    v_lshlrev_b32 v100, 16, v250
    v_and_b32 v101, 0xffff0000, v250
    v_pk_add_f32 v[28:29], v[28:29], v[100:101]
    v_lshlrev_b32 v102, 16, v251
    v_and_b32 v103, 0xffff0000, v251
    v_pk_add_f32 v[30:31], v[30:31], v[102:103]
    s_waitcnt vmcnt(0)
    v_lshlrev_b32 v100, 16, v252
    v_and_b32 v101, 0xffff0000, v252
    v_pk_add_f32 v[16:17], v[16:17], v[100:101]
    v_lshlrev_b32 v102, 16, v253
    v_and_b32 v103, 0xffff0000, v253
    v_pk_add_f32 v[18:19], v[18:19], v[102:103]
    v_lshlrev_b32 v100, 16, v254
    v_and_b32 v101, 0xffff0000, v254
    v_pk_add_f32 v[20:21], v[20:21], v[100:101]
    v_lshlrev_b32 v102, 16, v255
    v_and_b32 v103, 0xffff0000, v255
    v_pk_add_f32 v[22:23], v[22:23], v[102:103]
    v_pk_fma_f32 v[16:17], v[16:17], v[40:41], v[184:185]
    v_pk_fma_f32 v[18:19], v[18:19], v[42:43], v[186:187]
    v_pk_fma_f32 v[20:21], v[20:21], v[44:45], v[188:189]
    v_pk_fma_f32 v[22:23], v[22:23], v[46:47], v[190:191]
    v_pk_fma_f32 v[24:25], v[24:25], v[48:49], v[192:193]
    v_pk_fma_f32 v[26:27], v[26:27], v[50:51], v[194:195]
    v_pk_fma_f32 v[28:29], v[28:29], v[52:53], v[196:197]
    v_pk_fma_f32 v[30:31], v[30:31], v[54:55], v[198:199]
    v_pk_fma_f32 v[32:33], v[32:33], v[56:57], v[200:201]
    v_pk_fma_f32 v[34:35], v[34:35], v[58:59], v[202:203]
    v_pk_fma_f32 v[36:37], v[36:37], v[60:61], v[204:205]
    v_pk_fma_f32 v[38:39], v[38:39], v[62:63], v[206:207]
    v_pk_add_f32 v[12:13], v[16:17], v[18:19]
    v_pk_add_f32 v[12:13], v[12:13], v[20:21]
    v_pk_add_f32 v[12:13], v[12:13], v[22:23]
    v_pk_add_f32 v[12:13], v[12:13], v[24:25]
    v_pk_add_f32 v[12:13], v[12:13], v[26:27]
    v_pk_add_f32 v[12:13], v[12:13], v[28:29]
    v_pk_add_f32 v[12:13], v[12:13], v[30:31]
    v_pk_add_f32 v[14:15], v[32:33], v[34:35]
    v_pk_add_f32 v[14:15], v[14:15], v[36:37]
    v_pk_add_f32 v[14:15], v[14:15], v[38:39]
    v_add_f32 v100, v12, v13
    v_add_f32 v14, v14, v15
    v_fmac_f32 v100, 0x3e800000, v14
    s_nop 1
    v_add_f32_dpp v100, v100, v100 row_ror:8 row_mask:0xf bank_mask:0xf
    v_mov_b32 v103, v100
    s_nop 1
    v_permlane16_swap_b32 v103, v100
    v_add_f32 v100, v100, v103
    v_mov_b32 v103, v100
    s_nop 1
    v_permlane32_swap_b32 v103, v100
    v_add_f32 v100, v100, v103
    v_mul_f32 v100, 0x3be38e39, v100
    v_pk_add_f32 v[184:185], v[16:17], v[100:101] op_sel_hi:[1,0] neg_lo:[0,1] neg_hi:[0,1]
    v_pk_add_f32 v[186:187], v[18:19], v[100:101] op_sel_hi:[1,0] neg_lo:[0,1] neg_hi:[0,1]
    v_pk_add_f32 v[188:189], v[20:21], v[100:101] op_sel_hi:[1,0] neg_lo:[0,1] neg_hi:[0,1]
    v_pk_add_f32 v[190:191], v[22:23], v[100:101] op_sel_hi:[1,0] neg_lo:[0,1] neg_hi:[0,1]
    v_pk_add_f32 v[192:193], v[24:25], v[100:101] op_sel_hi:[1,0] neg_lo:[0,1] neg_hi:[0,1]
    v_pk_add_f32 v[194:195], v[26:27], v[100:101] op_sel_hi:[1,0] neg_lo:[0,1] neg_hi:[0,1]
    v_pk_add_f32 v[196:197], v[28:29], v[100:101] op_sel_hi:[1,0] neg_lo:[0,1] neg_hi:[0,1]
    v_pk_add_f32 v[198:199], v[30:31], v[100:101] op_sel_hi:[1,0] neg_lo:[0,1] neg_hi:[0,1]
    v_pk_add_f32 v[200:201], v[32:33], v[100:101] op_sel_hi:[1,0] neg_lo:[0,1] neg_hi:[0,1]
    v_pk_add_f32 v[202:203], v[34:35], v[100:101] op_sel_hi:[1,0] neg_lo:[0,1] neg_hi:[0,1]
    v_pk_add_f32 v[204:205], v[36:37], v[100:101] op_sel_hi:[1,0] neg_lo:[0,1] neg_hi:[0,1]
    v_pk_add_f32 v[206:207], v[38:39], v[100:101] op_sel_hi:[1,0] neg_lo:[0,1] neg_hi:[0,1]
    v_pk_mul_f32 v[12:13], v[184:185], v[184:185]
    v_pk_fma_f32 v[12:13], v[186:187], v[186:187], v[12:13]
    v_pk_fma_f32 v[12:13], v[188:189], v[188:189], v[12:13]
    v_pk_fma_f32 v[12:13], v[190:191], v[190:191], v[12:13]
    v_pk_fma_f32 v[12:13], v[192:193], v[192:193], v[12:13]
    v_pk_fma_f32 v[12:13], v[194:195], v[194:195], v[12:13]
    v_pk_fma_f32 v[12:13], v[196:197], v[196:197], v[12:13]
    v_pk_fma_f32 v[12:13], v[198:199], v[198:199], v[12:13]
    v_pk_mul_f32 v[14:15], v[200:201], v[200:201]
    v_pk_fma_f32 v[14:15], v[202:203], v[202:203], v[14:15]
    v_pk_fma_f32 v[14:15], v[204:205], v[204:205], v[14:15]
    v_pk_fma_f32 v[14:15], v[206:207], v[206:207], v[14:15]
    v_add_f32 v101, v12, v13
    v_add_f32 v14, v14, v15
    v_fmac_f32 v101, 0x3e800000, v14
    v_pk_mul_f32 v[12:13], v[184:185], v[76:77]
    v_pk_fma_f32 v[12:13], v[186:187], v[78:79], v[12:13]
    v_pk_fma_f32 v[12:13], v[188:189], v[80:81], v[12:13]
    v_pk_fma_f32 v[12:13], v[190:191], v[82:83], v[12:13]
    v_pk_fma_f32 v[12:13], v[192:193], v[84:85], v[12:13]
    v_pk_fma_f32 v[12:13], v[194:195], v[86:87], v[12:13]
    v_pk_fma_f32 v[12:13], v[196:197], v[88:89], v[12:13]
    v_pk_fma_f32 v[12:13], v[198:199], v[90:91], v[12:13]
    v_pk_mul_f32 v[14:15], v[200:201], v[92:93]
    v_pk_fma_f32 v[14:15], v[202:203], v[94:95], v[14:15]
    v_pk_fma_f32 v[14:15], v[204:205], v[96:97], v[14:15]
    v_pk_fma_f32 v[14:15], v[206:207], v[98:99], v[14:15]
    v_add_f32 v102, v12, v13
    v_add_f32 v14, v14, v15
    v_fmac_f32 v102, 0x3e800000, v14
    s_nop 1
    v_add_f32_dpp v101, v101, v101 row_ror:8 row_mask:0xf bank_mask:0xf
    v_add_f32_dpp v102, v102, v102 row_ror:8 row_mask:0xf bank_mask:0xf
    v_mov_b32 v103, v101
    v_mov_b32 v104, v102
    s_nop 0
    v_permlane16_swap_b32 v103, v101
    v_permlane16_swap_b32 v104, v102
    v_add_f32 v101, v101, v103
    v_add_f32 v102, v102, v104
    v_mov_b32 v103, v101
    v_mov_b32 v104, v102
    s_nop 0
    v_permlane32_swap_b32 v103, v101
    v_permlane32_swap_b32 v104, v102
    v_add_f32 v101, v101, v103
    v_add_f32 v102, v102, v104
    ds_write_b32 v10, v100 offset:0
    ds_write_b32 v10, v101 offset:128
    ds_write_b32 v10, v102 offset:256
    s_waitcnt lgkmcnt(0)
    s_barrier
    ds_read_b128 v[40:43], v11 offset:0
    ds_read_b128 v[44:47], v11 offset:128
    ds_read_b128 v[48:51], v11 offset:256
    ds_read_b128 v[52:55], v11 offset:384
    ds_read_b128 v[56:59], v11 offset:512
    s_waitcnt lgkmcnt(4)
    v_add_f32 v12, v40, v41
    v_add_f32 v13, v42, v43
    v_add_f32 v12, v12, v13
    v_mul_f32 v12, 0x3e800000, v12
    v_sub_f32 v40, v40, v12
    v_sub_f32 v41, v41, v12
    v_sub_f32 v42, v42, v12
    v_sub_f32 v43, v43, v12
    v_sub_f32 v100, v100, v12
    v_mul_f32 v13, v40, v40
    v_fmac_f32 v13, v41, v41
    v_fmac_f32 v13, v42, v42
    v_fmac_f32 v13, v43, v43
    s_waitcnt lgkmcnt(3)
    v_add_f32 v14, v44, v45
    v_add_f32 v15, v46, v47
    v_add_f32 v14, v14, v15
    v_fmac_f32 v14, 0x43100000, v13
    v_mov_b32 v13, 0x3727c5ac
    v_fmac_f32 v13, 0x3ae38e39, v14
    v_rsq_f32 v13, v13
    s_waitcnt lgkmcnt(0)
    v_pk_fma_f32 v[48:49], v[40:41], v[52:53], v[48:49]
    v_pk_fma_f32 v[50:51], v[42:43], v[54:55], v[50:51]
    v_pk_add_f32 v[48:49], v[48:49], v[50:51]
    v_pk_add_f32 v[56:57], v[56:57], v[58:59]
    v_add_f32 v14, v48, v49
    v_add_f32 v15, v56, v57
    v_fmac_f32 v15, v14, v13
    v_ashrrev_i32 v12, 31, v15
    v_or_b32 v12, 0x80000000, v12
    v_xor_b32 v12, v12, v15
    v_and_or_b32 v44, v12, s57, v6
    v_mov_b32 v45, 0
    s_nop 1
    v_mov_b32_dpp v14, v44 row_ror:1 row_mask:0xf bank_mask:0xf
    v_mov_b32_dpp v15, v45 row_ror:1 row_mask:0xf bank_mask:0xf
    v_max_u32 v45, v45, v15
    v_med3_u32 v45, v44, v14, v45
    v_max_u32 v44, v44, v14
    s_nop 1
    v_mov_b32_dpp v14, v44 row_ror:2 row_mask:0xf bank_mask:0xf
    v_mov_b32_dpp v15, v45 row_ror:2 row_mask:0xf bank_mask:0xf
    v_max_u32 v45, v45, v15
    v_med3_u32 v45, v44, v14, v45
    v_max_u32 v44, v44, v14
    s_nop 1
    v_mov_b32_dpp v14, v44 row_ror:4 row_mask:0xf bank_mask:0xf
    v_mov_b32_dpp v15, v45 row_ror:4 row_mask:0xf bank_mask:0xf
    v_max_u32 v45, v45, v15
    v_med3_u32 v45, v44, v14, v45
    v_max_u32 v44, v44, v14
    buffer_store_dwordx2 v[44:45], v9, s[84:87], s58 offen offset:8 sc1
    v_mul_f32 v100, v100, v13
    v_pk_fma_f32 v[184:185], v[184:185], v[12:13], v[100:101] op_sel:[0,1,0] op_sel_hi:[1,1,0]
    v_pk_fma_f32 v[186:187], v[186:187], v[12:13], v[100:101] op_sel:[0,1,0] op_sel_hi:[1,1,0]
    v_pk_fma_f32 v[188:189], v[188:189], v[12:13], v[100:101] op_sel:[0,1,0] op_sel_hi:[1,1,0]
    v_pk_fma_f32 v[190:191], v[190:191], v[12:13], v[100:101] op_sel:[0,1,0] op_sel_hi:[1,1,0]
    v_pk_fma_f32 v[192:193], v[192:193], v[12:13], v[100:101] op_sel:[0,1,0] op_sel_hi:[1,1,0]
    v_pk_fma_f32 v[194:195], v[194:195], v[12:13], v[100:101] op_sel:[0,1,0] op_sel_hi:[1,1,0]
    v_pk_fma_f32 v[196:197], v[196:197], v[12:13], v[100:101] op_sel:[0,1,0] op_sel_hi:[1,1,0]
    v_pk_fma_f32 v[198:199], v[198:199], v[12:13], v[100:101] op_sel:[0,1,0] op_sel_hi:[1,1,0]
    v_pk_fma_f32 v[200:201], v[200:201], v[12:13], v[100:101] op_sel:[0,1,0] op_sel_hi:[1,1,0]
    v_pk_fma_f32 v[202:203], v[202:203], v[12:13], v[100:101] op_sel:[0,1,0] op_sel_hi:[1,1,0]
    v_pk_fma_f32 v[204:205], v[204:205], v[12:13], v[100:101] op_sel:[0,1,0] op_sel_hi:[1,1,0]
    v_pk_fma_f32 v[206:207], v[206:207], v[12:13], v[100:101] op_sel:[0,1,0] op_sel_hi:[1,1,0]
    v_pk_fma_f32 v[184:185], v[184:185], v[112:113], v[136:137]
    v_pk_fma_f32 v[186:187], v[186:187], v[114:115], v[138:139]
    v_pk_fma_f32 v[188:189], v[188:189], v[116:117], v[140:141]
    v_pk_fma_f32 v[190:191], v[190:191], v[118:119], v[142:143]
    v_pk_fma_f32 v[192:193], v[192:193], v[120:121], v[144:145]
    v_pk_fma_f32 v[194:195], v[194:195], v[122:123], v[146:147]
    v_pk_fma_f32 v[196:197], v[196:197], v[124:125], v[148:149]
    v_pk_fma_f32 v[198:199], v[198:199], v[126:127], v[150:151]
    v_pk_fma_f32 v[200:201], v[200:201], v[128:129], v[152:153]
    v_pk_fma_f32 v[202:203], v[202:203], v[130:131], v[154:155]
    v_pk_fma_f32 v[204:205], v[204:205], v[132:133], v[156:157]
    v_pk_fma_f32 v[206:207], v[206:207], v[134:135], v[158:159]
    v_cvt_pk_bf16_f32 v124, v184, v185
    v_cvt_pk_bf16_f32 v125, v186, v187
    v_cvt_pk_bf16_f32 v126, v188, v189
    v_cvt_pk_bf16_f32 v127, v190, v191
    v_min_u32 v124, -2, v124
    v_min_u32 v125, -2, v125
    v_min_u32 v126, -2, v126
    v_min_u32 v127, -2, v127
    ds_write_b128 v1, v[124:127] offset:9344
    v_cvt_pk_bf16_f32 v128, v192, v193
    v_cvt_pk_bf16_f32 v129, v194, v195
    v_cvt_pk_bf16_f32 v130, v196, v197
    v_cvt_pk_bf16_f32 v131, v198, v199
    v_min_u32 v128, -2, v128
    v_min_u32 v129, -2, v129
    v_min_u32 v130, -2, v130
    v_min_u32 v131, -2, v131
    ds_write_b128 v1, v[128:131] offset:9856
    v_cvt_pk_bf16_f32 v132, v200, v201
    v_cvt_pk_bf16_f32 v133, v202, v203
    v_cvt_pk_bf16_f32 v134, v204, v205
    v_cvt_pk_bf16_f32 v135, v206, v207
    v_min_u32 v132, -2, v132
    v_min_u32 v133, -2, v133
    v_min_u32 v134, -2, v134
    v_min_u32 v135, -2, v135
    ds_write_b128 v2, v[132:135] offset:9344
    v_pk_fma_f32 v[16:17], v[184:185], v[160:161], v[16:17]
    v_pk_fma_f32 v[18:19], v[186:187], v[162:163], v[18:19]
    v_pk_fma_f32 v[20:21], v[188:189], v[164:165], v[20:21]
    v_pk_fma_f32 v[22:23], v[190:191], v[166:167], v[22:23]
    v_pk_fma_f32 v[24:25], v[192:193], v[168:169], v[24:25]
    v_pk_fma_f32 v[26:27], v[194:195], v[170:171], v[26:27]
    v_pk_fma_f32 v[28:29], v[196:197], v[172:173], v[28:29]
    v_pk_fma_f32 v[30:31], v[198:199], v[174:175], v[30:31]
    v_pk_fma_f32 v[32:33], v[200:201], v[176:177], v[32:33]
    v_pk_fma_f32 v[34:35], v[202:203], v[178:179], v[34:35]
    v_pk_fma_f32 v[36:37], v[204:205], v[180:181], v[36:37]
    v_pk_fma_f32 v[38:39], v[206:207], v[182:183], v[38:39]
    v_cvt_pk_bf16_f32 v112, v16, v17
    v_cvt_pk_bf16_f32 v113, v18, v19
    v_cvt_pk_bf16_f32 v114, v20, v21
    v_cvt_pk_bf16_f32 v115, v22, v23
    ds_write_b128 v1, v[112:115] offset:0
    v_cvt_pk_bf16_f32 v116, v24, v25
    v_cvt_pk_bf16_f32 v117, v26, v27
    v_cvt_pk_bf16_f32 v118, v28, v29
    v_cvt_pk_bf16_f32 v119, v30, v31
    ds_write_b128 v1, v[116:119] offset:512
    v_cvt_pk_bf16_f32 v120, v32, v33
    v_cvt_pk_bf16_f32 v121, v34, v35
    v_cvt_pk_bf16_f32 v122, v36, v37
    v_cvt_pk_bf16_f32 v123, v38, v39
    ds_write_b128 v2, v[120:123] offset:0
    v_lshrrev_b32 v7, 4, v0
    v_and_b32 v6, 1, v0
    v_bfe_u32 v5, v0, 2, 2
    v_lshlrev_b32 v5, 6, v5
    v_lshl_add_u32 v5, v7, 4, v5
L2_pad15:
    s_cbranch_execz L2_walkret
    v_mov_b32 v14, 15616
    s_movk_i32 s57, 1168
    s_waitcnt lgkmcnt(0)
    s_barrier
    s_cmp_lt_u32 s51, 2
    s_cbranch_scc1 L2_keys
    s_cmp_eq_u32 s51, 2
    s_cbranch_scc1 L2_rows
    v_not_b32 v12, v44
    v_not_b32 v13, v45
    v_and_b32 v12, 7, v12
    v_and_b32 v13, 7, v13
    v_cmp_gt_u32 vcc, 8, v0
    v_mul_u32_u24 v148, 1168, v12
    v_mul_u32_u24 v149, 1168, v13
    v_cndmask_b32 v15, v13, v12, vcc
    v_add_u32 v148, v148, v107
    v_add_u32 v149, v149, v107
    ds_read_b128 v[136:139], v148
    ds_read_b128 v[140:143], v149
    v_lshrrev_b32 v150, 3, v0
    v_sub_u32 v15, v15, v150
    v_mad_i32_i24 v150, v15, s57, v108
    ds_read_b128 v[144:147], v150 offset:1024
    s_movk_i32 s3, 1152
    v_mad_u32_u24 v12, v12, s3, v8
    v_mad_u32_u24 v13, v13, s3, v8
    v_mad_i32_i24 v15, v15, s3, v109
    s_waitcnt lgkmcnt(2)
    buffer_store_dwordx4 v[136:139], v12, s[24:27], 0 offen sc1
    s_waitcnt lgkmcnt(1)
    buffer_store_dwordx4 v[140:143], v13, s[24:27], 0 offen sc1
    s_mov_b64 exec, 0xffff
    s_waitcnt lgkmcnt(0)
    buffer_store_dwordx4 v[144:147], v15, s[24:27], 0 offen offset:1024 sc1
    s_mov_b64 exec, -1
    s_branch L2_rowsdone
L2_rows:
    ds_read_b128 v[136:139], v107 offset:0
    ds_read_b128 v[140:143], v107 offset:1168
    ds_read_b128 v[144:147], v107 offset:2336
    ds_read_b128 v[148:151], v107 offset:3504
    ds_read_b128 v[152:155], v107 offset:4672
    ds_read_b128 v[156:159], v107 offset:5840
    ds_read_b128 v[160:163], v107 offset:7008
    ds_read_b128 v[164:167], v107 offset:8176
    ds_read_b128 v[168:171], v108 offset:1024
    s_movk_i32 s3, 0
    s_waitcnt lgkmcnt(8)
    buffer_store_dwordx4 v[136:139], v8, s[24:27], s3 offen offset:0 sc1
    s_waitcnt lgkmcnt(7)
    buffer_store_dwordx4 v[140:143], v8, s[24:27], s3 offen offset:1152 sc1
    s_waitcnt lgkmcnt(6)
    buffer_store_dwordx4 v[144:147], v8, s[24:27], s3 offen offset:2304 sc1
    s_waitcnt lgkmcnt(5)
    buffer_store_dwordx4 v[148:151], v8, s[24:27], s3 offen offset:3456 sc1
    s_movk_i32 s3, 4608
    s_waitcnt lgkmcnt(4)
    buffer_store_dwordx4 v[152:155], v8, s[24:27], s3 offen offset:0 sc1
    s_waitcnt lgkmcnt(3)
    buffer_store_dwordx4 v[156:159], v8, s[24:27], s3 offen offset:1152 sc1
    s_waitcnt lgkmcnt(2)
    buffer_store_dwordx4 v[160:163], v8, s[24:27], s3 offen offset:2304 sc1
    s_waitcnt lgkmcnt(1)
    buffer_store_dwordx4 v[164:167], v8, s[24:27], s3 offen offset:3456 sc1
    s_waitcnt lgkmcnt(0)
    buffer_store_dwordx4 v[168:171], v109, s[24:27], 0 offen offset:1024 sc1
L2_rowsdone:
    ds_read_b64_tr_b16 a[64:65], v110 offset:0
    ds_read_b64_tr_b16 a[66:67], v110 offset:256
    ds_read_b64_tr_b16 a[68:69], v110 offset:2048
    ds_read_b64_tr_b16 a[70:71], v110 offset:2304
    ds_read_b64_tr_b16 a[72:73], v110 offset:4096
    ds_read_b64_tr_b16 a[74:75], v110 offset:4352
    ds_read_b64_tr_b16 a[76:77], v110 offset:6144
    ds_read_b64_tr_b16 a[78:79], v110 offset:6400
    ds_read_b64_tr_b16 a[80:81], v110 offset:8192
    ds_read_b64_tr_b16 a[82:83], v110 offset:8448
    ds_read_b64_tr_b16 a[84:85], v110 offset:10240
    ds_read_b64_tr_b16 a[86:87], v110 offset:10496
    ds_read_b64_tr_b16 a[88:89], v110 offset:12288
    ds_read_b64_tr_b16 a[90:91], v110 offset:12544
    ds_read_b64_tr_b16 a[92:93], v110 offset:14336
    ds_read_b64_tr_b16 a[94:95], v110 offset:14592
    ds_read_b64_tr_b16 a[96:97], v110 offset:16384
    ds_read_b64_tr_b16 a[98:99], v110 offset:16640
    ds_read_b64_tr_b16 a[100:101], v110 offset:18432
    ds_read_b64_tr_b16 a[102:103], v110 offset:18688
    ds_read_b64_tr_b16 a[104:105], v110 offset:20480
    ds_read_b64_tr_b16 a[106:107], v110 offset:20736
    ds_read_b64_tr_b16 a[108:109], v110 offset:22528
    ds_read_b64_tr_b16 a[110:111], v110 offset:22784
    ds_read_b64_tr_b16 a[112:113], v110 offset:24576
    ds_read_b64_tr_b16 a[114:115], v110 offset:24832
    ds_read_b64_tr_b16 a[116:117], v110 offset:26624
    ds_read_b64_tr_b16 a[118:119], v110 offset:26880
    ds_read_b64_tr_b16 a[120:121], v110 offset:28672
    ds_read_b64_tr_b16 a[122:123], v110 offset:28928
    ds_read_b64_tr_b16 a[124:125], v110 offset:30720
    ds_read_b64_tr_b16 a[126:127], v110 offset:30976
    ds_read_b64_tr_b16 a[128:129], v110 offset:32768
    ds_read_b64_tr_b16 a[130:131], v110 offset:33024
    ds_read_b64_tr_b16 a[132:133], v110 offset:34816
    ds_read_b64_tr_b16 a[134:135], v110 offset:35072
    ds_read_b64_tr_b16 a[136:137], v111 offset:0
    ds_read_b64_tr_b16 a[138:139], v111 offset:4608
    ds_read_b64_tr_b16 a[140:141], v111 offset:32
    ds_read_b64_tr_b16 a[142:143], v111 offset:4640
    ds_read_b64_tr_b16 a[144:145], v111 offset:64
    ds_read_b64_tr_b16 a[146:147], v111 offset:4672
    ds_read_b64_tr_b16 a[148:149], v111 offset:96
    ds_read_b64_tr_b16 a[150:151], v111 offset:4704
    ds_read_b64_tr_b16 a[152:153], v111 offset:128
    ds_read_b64_tr_b16 a[154:155], v111 offset:4736
    ds_read_b64_tr_b16 a[156:157], v111 offset:160
    ds_read_b64_tr_b16 a[158:159], v111 offset:4768
    ds_read_b64_tr_b16 a[160:161], v111 offset:192
    ds_read_b64_tr_b16 a[162:163], v111 offset:4800
    ds_read_b64_tr_b16 a[164:165], v111 offset:224
    ds_read_b64_tr_b16 a[166:167], v111 offset:4832
    ds_read_b64_tr_b16 a[168:169], v111 offset:256
    ds_read_b64_tr_b16 a[170:171], v111 offset:4864
    s_cmp_lt_u32 s2, 144
    s_cbranch_scc1 L2_join
    s_waitcnt vmcnt(0)
    buffer_store_dword v14, v9, s[84:87], s56 offen offset:128 sc1
    s_cmp_lt_u32 s2, 180
    s_cbranch_scc1 L2_join
    s_branch L2_fin
L2_keys:
    s_cmp_ge_u32 s2, 180
    s_cbranch_scc1 L2_fin
    buffer_load_dwordx2 v[64:65], v68, s[84:87], s15 offen offset:8 sc1
    buffer_load_dwordx2 v[66:67], v68, s[84:87], s59 offen offset:8 sc1
    ds_read_b64_tr_b16 a[64:65], v110 offset:0
    ds_read_b64_tr_b16 a[66:67], v110 offset:256
    ds_read_b64_tr_b16 a[68:69], v110 offset:2048
    ds_read_b64_tr_b16 a[70:71], v110 offset:2304
    ds_read_b64_tr_b16 a[72:73], v110 offset:4096
    ds_read_b64_tr_b16 a[74:75], v110 offset:4352
    ds_read_b64_tr_b16 a[76:77], v110 offset:6144
    ds_read_b64_tr_b16 a[78:79], v110 offset:6400
    ds_read_b64_tr_b16 a[80:81], v110 offset:8192
    ds_read_b64_tr_b16 a[82:83], v110 offset:8448
    ds_read_b64_tr_b16 a[84:85], v110 offset:10240
    ds_read_b64_tr_b16 a[86:87], v110 offset:10496
    ds_read_b64_tr_b16 a[88:89], v110 offset:12288
    ds_read_b64_tr_b16 a[90:91], v110 offset:12544
    ds_read_b64_tr_b16 a[92:93], v110 offset:14336
    ds_read_b64_tr_b16 a[94:95], v110 offset:14592
    ds_read_b64_tr_b16 a[96:97], v110 offset:16384
    ds_read_b64_tr_b16 a[98:99], v110 offset:16640
    ds_read_b64_tr_b16 a[100:101], v110 offset:18432
    ds_read_b64_tr_b16 a[102:103], v110 offset:18688
    ds_read_b64_tr_b16 a[104:105], v110 offset:20480
    ds_read_b64_tr_b16 a[106:107], v110 offset:20736
    ds_read_b64_tr_b16 a[108:109], v110 offset:22528
    ds_read_b64_tr_b16 a[110:111], v110 offset:22784
    ds_read_b64_tr_b16 a[112:113], v110 offset:24576
    ds_read_b64_tr_b16 a[114:115], v110 offset:24832
    ds_read_b64_tr_b16 a[116:117], v110 offset:26624
    ds_read_b64_tr_b16 a[118:119], v110 offset:26880
    ds_read_b64_tr_b16 a[120:121], v110 offset:28672
    ds_read_b64_tr_b16 a[122:123], v110 offset:28928
    ds_read_b64_tr_b16 a[124:125], v110 offset:30720
    ds_read_b64_tr_b16 a[126:127], v110 offset:30976
    ds_read_b64_tr_b16 a[128:129], v110 offset:32768
    ds_read_b64_tr_b16 a[130:131], v110 offset:33024
    ds_read_b64_tr_b16 a[132:133], v110 offset:34816
    ds_read_b64_tr_b16 a[134:135], v110 offset:35072
    ds_read_b64_tr_b16 a[136:137], v111 offset:0
    ds_read_b64_tr_b16 a[138:139], v111 offset:4608
    ds_read_b64_tr_b16 a[140:141], v111 offset:32
    ds_read_b64_tr_b16 a[142:143], v111 offset:4640
    ds_read_b64_tr_b16 a[144:145], v111 offset:64
    ds_read_b64_tr_b16 a[146:147], v111 offset:4672
    ds_read_b64_tr_b16 a[148:149], v111 offset:96
    ds_read_b64_tr_b16 a[150:151], v111 offset:4704
    ds_read_b64_tr_b16 a[152:153], v111 offset:128
    ds_read_b64_tr_b16 a[154:155], v111 offset:4736
    ds_read_b64_tr_b16 a[156:157], v111 offset:160
    ds_read_b64_tr_b16 a[158:159], v111 offset:4768
    ds_read_b64_tr_b16 a[160:161], v111 offset:192
    ds_read_b64_tr_b16 a[162:163], v111 offset:4800
    ds_read_b64_tr_b16 a[164:165], v111 offset:224
    ds_read_b64_tr_b16 a[166:167], v111 offset:4832
    ds_read_b64_tr_b16 a[168:169], v111 offset:256
    ds_read_b64_tr_b16 a[170:171], v111 offset:4864
    s_waitcnt vmcnt(0)
    v_cndmask_b32 v64, v64, v44, s[60:61]
    v_cndmask_b32 v65, v65, v45, s[60:61]
    v_cndmask_b32 v66, v66, v44, s[62:63]
    v_cndmask_b32 v67, v67, v45, s[62:63]
    v_min_u32 v12, v64, v65
    v_min_u32 v13, v66, v67
    v_cmp_eq_u32 s[4:5], 0, v12
    v_cmp_eq_u32 s[6:7], 0, v13
    s_nop 0
    s_or_b64 vcc, s[4:5], s[6:7]
    s_cbranch_scc0 L2_p2_ok
    s_mov_b32 s97, 0x20000
L2_p2:
    s_or_b64 exec, s[4:5], 1
    buffer_load_dwordx2 v[64:65], v68, s[84:87], s15 offen offset:8 sc1
    s_or_b64 exec, s[6:7], 1
    buffer_load_dwordx2 v[66:67], v68, s[84:87], s59 offen offset:8 sc1
    s_mov_b64 exec, -1
    s_waitcnt vmcnt(0)
    v_cndmask_b32 v64, v64, v44, s[60:61]
    v_cndmask_b32 v65, v65, v45, s[60:61]
    v_cndmask_b32 v66, v66, v44, s[62:63]
    v_cndmask_b32 v67, v67, v45, s[62:63]
    v_min_u32 v12, v64, v65
    v_min_u32 v13, v66, v67
    v_cmp_eq_u32 s[4:5], 0, v12
    v_cmp_eq_u32 s[6:7], 0, v13
    s_nop 0
    s_or_b64 vcc, s[4:5], s[6:7]
    s_sub_u32 s97, s97, 1
    s_cselect_b64 vcc, 0, vcc
    s_cmp_eq_u64 vcc, 0
    s_cbranch_scc1 L2_p2_ok
    s_sleep 1
    s_branch L2_p2
L2_p2_ok:
    v_max_u32 v65, v65, v67
    v_med3_u32 v65, v64, v66, v65
    v_max_u32 v64, v64, v66
    s_nop 1
    v_mov_b32_dpp v12, v64 row_ror:1 row_mask:0xf bank_mask:0xf
    v_mov_b32_dpp v13, v65 row_ror:1 row_mask:0xf bank_mask:0xf
    v_max_u32 v65, v65, v13
    v_med3_u32 v65, v64, v12, v65
    v_max_u32 v64, v64, v12
    s_nop 1
    v_mov_b32_dpp v12, v64 row_ror:2 row_mask:0xf bank_mask:0xf
    v_mov_b32_dpp v13, v65 row_ror:2 row_mask:0xf bank_mask:0xf
    v_max_u32 v65, v65, v13
    v_med3_u32 v65, v64, v12, v65
    v_max_u32 v64, v64, v12
    s_nop 1
    v_mov_b32_dpp v12, v64 row_ror:4 row_mask:0xf bank_mask:0xf
    v_mov_b32_dpp v13, v65 row_ror:4 row_mask:0xf bank_mask:0xf
    v_max_u32 v65, v65, v13
    v_med3_u32 v65, v64, v12, v65
    v_max_u32 v64, v64, v12
    s_nop 1
    v_mov_b32_dpp v12, v64 row_ror:8 row_mask:0xf bank_mask:0xf
    v_mov_b32_dpp v13, v65 row_ror:8 row_mask:0xf bank_mask:0xf
    v_max_u32 v65, v65, v13
    v_med3_u32 v65, v64, v12, v65
    v_max_u32 v64, v64, v12
    v_mov_b32 v12, v64
    v_mov_b32 v13, v65
    s_nop 0
    v_permlane16_swap_b32 v12, v64
    v_permlane16_swap_b32 v13, v65
    v_max_u32 v65, v65, v13
    v_med3_u32 v65, v64, v12, v65
    v_max_u32 v64, v64, v12
    v_mov_b32 v12, v64
    v_mov_b32 v13, v65
    s_nop 0
    v_permlane32_swap_b32 v12, v64
    v_permlane32_swap_b32 v13, v65
    v_max_u32 v65, v65, v13
    v_med3_u32 v65, v64, v12, v65
    v_max_u32 v64, v64, v12
    s_lshl3_add_u32 s3, s51, 15616
    v_mov_b32 v12, s3
    ds_write_b64 v12, v[64:65]
    s_waitcnt lgkmcnt(0)
L2_join:
    s_barrier
    ds_read_b128 v[16:19], v14
    v_cmp_eq_u32 vcc, 0, v6
    s_waitcnt lgkmcnt(0)
    v_max_u32 v17, v17, v19
    v_med3_u32 v17, v16, v18, v17
    v_max_u32 v16, v16, v18
    v_cndmask_b32 v16, v17, v16, vcc
    v_and_b32 v3, 0x7ff, v16
    v_sub_u32 v3, 2047, v3
    v_mul_u32_u24 v4, 1152, v3
    s_cmp_ge_u32 s2, 144
    s_cbranch_scc1 L2_red
    v_add_u32 v5, v5, v4
    s_mov_b32 s59, 4194304
    v_and_b32 v12, 8, v0
    v_lshlrev_b32 v12, 4, v12
    v_sub_u32 v3, v5, v12
    buffer_load_dwordx4 v[128:131], v5, s[84:87], s59 offen offset:0 sc1
    buffer_load_dwordx4 v[132:135], v5, s[84:87], s59 offen offset:256 sc1
    buffer_load_dwordx4 v[136:139], v5, s[84:87], s59 offen offset:512 sc1
    buffer_load_dwordx4 v[140:143], v5, s[84:87], s59 offen offset:768 sc1
    buffer_load_dwordx4 v[144:147], v3, s[84:87], s59 offen offset:1024 sc1
    v_lshlrev_b32 v11, 7, v6
    v_lshl_add_u32 v13, v7, 5, v11
    v_add_u32 v13, 14848, v13
    v_lshl_add_u32 v11, v7, 4, v11
    s_lshr_b32 s3, s51, 1
    s_lshl_b32 s3, s3, 8
    s_and_b32 s14, s51, 1
    s_lshl_b32 s14, s14, 6
    s_add_u32 s3, s3, s14
    s_add_u32 s3, s3, 14848
    v_add_u32 v11, s3, v11
    s_mul_i32 s14, s51, 1152
    s_mul_i32 s15, s2, 4608
    s_add_u32 s15, s15, s14
    s_add_u32 s15, s15, 98304
    v_lshlrev_b32 v10, 3, v0
    s_waitcnt vmcnt(0)
    buffer_store_dword v14, v9, s[84:87], s56 offen offset:128 sc1
L2_hr:
    v_mfma_f32_16x16x32_bf16 v[88:91], a[64:67], v[128:131], 0
    v_max_u32 v12, v128, v129
    v_mfma_f32_16x16x32_bf16 v[92:95], a[68:71], v[128:131], 0
    v_max3_u32 v12, v12, v130, v131
    v_mfma_f32_16x16x32_bf16 v[96:99], a[72:75], v[128:131], 0
    v_max3_u32 v12, v12, v132, v133
    v_mfma_f32_16x16x32_bf16 v[100:103], a[76:79], v[128:131], 0
    v_max3_u32 v12, v12, v134, v135
    v_mfma_f32_16x16x32_bf16 v[88:91], a[80:83], v[132:135], v[88:91]
    v_max3_u32 v12, v12, v136, v137
    v_mfma_f32_16x16x32_bf16 v[92:95], a[84:87], v[132:135], v[92:95]
    v_max3_u32 v12, v12, v138, v139
    v_mfma_f32_16x16x32_bf16 v[96:99], a[88:91], v[132:135], v[96:99]
    v_max3_u32 v12, v12, v140, v141
    v_mfma_f32_16x16x32_bf16 v[100:103], a[92:95], v[132:135], v[100:103]
    v_max3_u32 v12, v12, v142, v143
    v_mfma_f32_16x16x32_bf16 v[88:91], a[96:99], v[136:139], v[88:91]
    v_max3_u32 v12, v12, v144, v145
    v_mfma_f32_16x16x32_bf16 v[92:95], a[100:103], v[136:139], v[92:95]
    v_max3_u32 v12, v12, v146, v147
    v_mfma_f32_16x16x32_bf16 v[96:99], a[104:107], v[136:139], v[96:99]
    v_cmp_eq_u32 vcc, -1, v12
    v_mfma_f32_16x16x32_bf16 v[100:103], a[108:111], v[136:139], v[100:103]
    v_mfma_f32_16x16x32_bf16 v[96:99], a[120:123], v[140:143], v[96:99]
    v_mfma_f32_16x16x32_bf16 v[100:103], a[124:127], v[140:143], v[100:103]
    v_mfma_f32_16x16x32_bf16 v[88:91], a[112:115], v[140:143], v[88:91]
    v_mfma_f32_16x16x32_bf16 v[92:95], a[116:119], v[140:143], v[92:95]
    v_mfma_f32_16x16x32_bf16 v[92:95], a[132:135], v[144:147], v[92:95]
    v_mfma_f32_16x16x32_bf16 v[88:91], a[128:131], v[144:147], v[88:91]
    s_cmp_lg_u64 vcc, 0
    s_cbranch_scc1 L2_hs
    s_nop 1
    v_add_f32_dpp v96, v100, v96 row_shl:4 row_mask:0xf bank_mask:0xf bound_ctrl:1
    v_add_f32_dpp v97, v101, v97 row_shl:4 row_mask:0xf bank_mask:0xf bound_ctrl:1
    v_add_f32_dpp v98, v102, v98 row_shl:4 row_mask:0xf bank_mask:0xf bound_ctrl:1
    v_add_f32_dpp v99, v103, v99 row_shl:4 row_mask:0xf bank_mask:0xf bound_ctrl:1
    v_add_f32_dpp v88, v92, v88 row_shl:4 row_mask:0xf bank_mask:0xf bound_ctrl:1
    v_add_f32_dpp v89, v93, v89 row_shl:4 row_mask:0xf bank_mask:0xf bound_ctrl:1
    v_add_f32_dpp v90, v94, v90 row_shl:4 row_mask:0xf bank_mask:0xf bound_ctrl:1
    v_add_f32_dpp v91, v95, v91 row_shl:4 row_mask:0xf bank_mask:0xf bound_ctrl:1
    v_add_f32_dpp v88, v96, v88 row_shl:8 row_mask:0xf bank_mask:0xf bound_ctrl:1
    v_add_f32_dpp v89, v97, v89 row_shl:8 row_mask:0xf bank_mask:0xf bound_ctrl:1
    v_add_f32_dpp v90, v98, v90 row_shl:8 row_mask:0xf bank_mask:0xf bound_ctrl:1
    v_add_f32_dpp v91, v99, v91 row_shl:8 row_mask:0xf bank_mask:0xf bound_ctrl:1
    s_mov_b32 exec_lo, 0x30003
    s_mov_b32 exec_hi, 0x30003
    ds_write_b128 v11, v[88:91]
    s_mov_b64 exec, -1
    s_waitcnt lgkmcnt(0)
    s_barrier
    ds_read_b128 v[16:19], v13 offset:0
    ds_read_b128 v[20:23], v13 offset:16
    ds_read_b128 v[24:27], v13 offset:256
    ds_read_b128 v[28:31], v13 offset:272
    v_mov_b32 v12, 0xbfb8aa3b
    s_waitcnt lgkmcnt(2)
    v_pk_mul_f32 v[32:33], v[16:17], v[12:13] op_sel_hi:[1,0]
    v_pk_mul_f32 v[34:35], v[18:19], v[12:13] op_sel_hi:[1,0]
    v_pk_mul_f32 v[36:37], v[20:21], v[12:13] op_sel_hi:[1,0]
    v_pk_mul_f32 v[38:39], v[22:23], v[12:13] op_sel_hi:[1,0]
    v_exp_f32 v32, v32
    v_exp_f32 v33, v33
    v_exp_f32 v34, v34
    v_exp_f32 v35, v35
    v_exp_f32 v36, v36
    v_exp_f32 v37, v37
    v_exp_f32 v38, v38
    v_exp_f32 v39, v39
    v_pk_add_f32 v[32:33], v[32:33], 1.0 op_sel_hi:[1,0]
    v_pk_add_f32 v[34:35], v[34:35], 1.0 op_sel_hi:[1,0]
    v_pk_add_f32 v[36:37], v[36:37], 1.0 op_sel_hi:[1,0]
    v_pk_add_f32 v[38:39], v[38:39], 1.0 op_sel_hi:[1,0]
    v_rcp_f32 v32, v32
    v_rcp_f32 v33, v33
    v_rcp_f32 v34, v34
    v_rcp_f32 v35, v35
    v_rcp_f32 v36, v36
    v_rcp_f32 v37, v37
    v_rcp_f32 v38, v38
    v_rcp_f32 v39, v39
    s_waitcnt lgkmcnt(0)
    v_pk_mul_f32 v[16:17], v[16:17], v[32:33]
    v_pk_mul_f32 v[18:19], v[18:19], v[34:35]
    v_pk_mul_f32 v[20:21], v[20:21], v[36:37]
    v_pk_mul_f32 v[22:23], v[22:23], v[38:39]
    v_pk_mul_f32 v[16:17], v[16:17], v[24:25]
    v_pk_mul_f32 v[18:19], v[18:19], v[26:27]
    v_pk_mul_f32 v[20:21], v[20:21], v[28:29]
    v_pk_mul_f32 v[22:23], v[22:23], v[30:31]
    v_cvt_pk_bf16_f32 v40, v16, v17
    v_cvt_pk_bf16_f32 v41, v18, v19
    v_cvt_pk_bf16_f32 v42, v20, v21
    v_cvt_pk_bf16_f32 v43, v22, v23
    s_nop 1
    v_mfma_f32_16x16x32_bf16 v[48:51], v[40:43], a[136:139], 0
    v_mfma_f32_16x16x32_bf16 v[52:55], v[40:43], a[140:143], 0
    v_mfma_f32_16x16x32_bf16 v[56:59], v[40:43], a[144:147], 0
    v_mfma_f32_16x16x32_bf16 v[60:63], v[40:43], a[148:151], 0
    v_mfma_f32_16x16x32_bf16 v[64:67], v[40:43], a[152:155], 0
    v_mfma_f32_16x16x32_bf16 v[68:71], v[40:43], a[156:159], 0
    v_mfma_f32_16x16x32_bf16 v[72:75], v[40:43], a[160:163], 0
    v_mfma_f32_16x16x32_bf16 v[76:79], v[40:43], a[164:167], 0
    v_mfma_f32_16x16x32_bf16 v[80:83], v[40:43], a[168:171], 0
    s_nop 0
    v_mov_b32_dpp v48, v52 quad_perm:[0,1,2,3] row_mask:0x2 bank_mask:0xf
    v_mov_b32_dpp v49, v53 quad_perm:[0,1,2,3] row_mask:0x2 bank_mask:0xf
    s_nop 0
    v_mov_b32_dpp v48, v56 quad_perm:[0,1,2,3] row_mask:0x4 bank_mask:0xf
    v_mov_b32_dpp v49, v57 quad_perm:[0,1,2,3] row_mask:0x4 bank_mask:0xf
    s_nop 0
    v_mov_b32_dpp v48, v60 quad_perm:[0,1,2,3] row_mask:0x8 bank_mask:0xf
    v_mov_b32_dpp v49, v61 quad_perm:[0,1,2,3] row_mask:0x8 bank_mask:0xf
    v_mov_b32_dpp v50, v64 quad_perm:[0,1,2,3] row_mask:0x1 bank_mask:0xf
    v_mov_b32_dpp v51, v65 quad_perm:[0,1,2,3] row_mask:0x1 bank_mask:0xf
    s_nop 0
    v_mov_b32_dpp v50, v68 quad_perm:[0,1,2,3] row_mask:0x2 bank_mask:0xf
    v_mov_b32_dpp v51, v69 quad_perm:[0,1,2,3] row_mask:0x2 bank_mask:0xf
    s_nop 0
    v_mov_b32_dpp v50, v72 quad_perm:[0,1,2,3] row_mask:0x4 bank_mask:0xf
    v_mov_b32_dpp v51, v73 quad_perm:[0,1,2,3] row_mask:0x4 bank_mask:0xf
    s_nop 0
    v_mov_b32_dpp v50, v76 quad_perm:[0,1,2,3] row_mask:0x8 bank_mask:0xf
    v_mov_b32_dpp v51, v77 quad_perm:[0,1,2,3] row_mask:0x8 bank_mask:0xf
    v_min_u32 v48, -2, v48
    v_min_u32 v49, -2, v49
    v_min_u32 v50, -2, v50
    v_min_u32 v51, -2, v51
    v_min_u32 v80, -2, v80
    v_min_u32 v81, -2, v81
    buffer_store_dwordx4 v[48:51], v8, s[84:87], s15 offen sc1
    s_mov_b64 exec, 0xffff
    buffer_store_dwordx2 v[80:81], v10, s[84:87], s15 offen offset:1024 sc1
    s_branch L2_fin
L2_red:
    s_mov_b32 s3, 98304
    s_add_u32 s32, s84, s3
    s_addc_u32 s33, s85, 0
    s_mov_b32 s34, 663552
    s_mov_b32 s35, 0x20000
    s_sub_u32 s3, s2, 144
    s_mul_i32 s14, s3, 7282
    s_lshr_b32 s14, s14, 16
    s_mul_i32 s15, s14, 9
    s_sub_u32 s15, s3, s15
    s_mul_i32 s14, s14, 144
    s_cmp_eq_u32 s15, 8
    s_cselect_b32 s56, 1, 64
    s_cselect_b32 s57, 2, 1
    s_cselect_b32 s15, 16, s15
    s_lshl3_add_u32 s14, s15, s14
    v_bfe_u32 v7, v0, 2, 3
    v_mul_u32_u24 v7, s57, v7
    v_bfe_u32 v9, v0, 1, 1
    v_mul_u32_u24 v9, s56, v9
    v_add3_u32 v7, v7, v9, s14
    v_lshl_add_u32 v9, v7, 1, v4
    v_lshlrev_b32 v7, 2, v7
    v_lshrrev_b32 v12, 7, v3
    v_bfe_u32 v13, v3, 3, 4
    v_lshl_add_u32 v13, v12, 6, v13
    v_lshlrev_b32 v13, 8, v13
    s_mov_b32 s59, 794624
    s_mov_b32 s97, 0x20000
L2_r:
    buffer_load_dword v12, v13, s[84:87], s59 offen offset:128 sc1
    s_waitcnt vmcnt(0)
    v_cmp_eq_u32 vcc, 0, v12
    s_sub_u32 s97, s97, 1
    s_cselect_b64 vcc, 0, vcc
    s_cmp_eq_u64 vcc, 0
    s_cbranch_scc1 L2_r_ok
    s_sleep 1
    s_branch L2_r
L2_r_ok:
    buffer_load_ushort v18, v9, s[80:83], 0 offen sc1
    ds_read_b32 v20, v7 offset:6912
    v_and_b32 v6, 7, v0
    v_lshrrev_b32 v10, 3, v0
    s_lshl_b32 s14, s51, 3
    v_add_u32 v10, s14, v10
    v_mul_u32_u24 v10, 4608, v10
    v_lshl_add_u32 v10, v6, 4, v10
    s_lshl_b32 s3, s3, 7
    v_add_u32 v24, s3, v10
    v_add_u32 v25, 147456, v24
    v_add_u32 v26, 294912, v24
    v_add_u32 v27, 442368, v24
    v_add_u32 v28, 589824, v24
    v_and_b32 v16, 0xfffff800, v16
    v_not_b32 v12, v16
    v_ashrrev_i32 v12, 31, v12
    v_or_b32 v12, 0x80000000, v12
    v_xor_b32 v16, v16, v12
    v_mul_f32 v16, 0xbfb8aa3b, v16
    v_exp_f32 v16, v16
    s_nop 0
    v_add_f32 v16, 1.0, v16
    v_rcp_f32 v16, v16
    s_waitcnt lgkmcnt(0)
    v_mul_f32 v20, v20, v16
    s_lshl_b32 s14, s51, 7
    s_add_u32 s14, s14, 15872
    v_lshl_add_u32 v10, v6, 4, s14
    v_and_b32 v11, 31, v0
    v_lshlrev_b32 v11, 2, v11
    s_mov_b32 s97, 0x20000
L2_p3:
    buffer_load_dwordx4 v[32:35], v24, s[32:35], 0 offen sc1
    buffer_load_dwordx4 v[36:39], v25, s[32:35], 0 offen sc1
    buffer_load_dwordx4 v[40:43], v26, s[32:35], 0 offen sc1
    buffer_load_dwordx4 v[44:47], v27, s[32:35], 0 offen sc1
    buffer_load_dwordx4 v[48:51], v28, s[32:35], 0 offen sc1
    s_waitcnt vmcnt(0)
    v_max3_u32 v12, v32, v33, v34
    v_max3_u32 v12, v12, v35, v36
    v_max3_u32 v12, v12, v37, v38
    v_max3_u32 v12, v12, v39, v40
    v_max3_u32 v12, v12, v41, v42
    v_max3_u32 v12, v12, v43, v44
    v_max3_u32 v12, v12, v45, v46
    v_max3_u32 v12, v12, v47, v48
    v_max3_u32 v12, v12, v49, v50
    v_max_u32 v12, v12, v51
    v_cmp_eq_u32 vcc, -1, v12
    s_sub_u32 s97, s97, 1
    s_cselect_b64 vcc, 0, vcc
    s_cmp_eq_u64 vcc, 0
    s_cbranch_scc1 L2_p3_ok
    s_branch L2_p3
L2_p3_ok:
    v_pk_add_f32 v[32:33], v[32:33], v[36:37]
    v_pk_add_f32 v[40:41], v[40:41], v[44:45]
    v_pk_add_f32 v[32:33], v[32:33], v[48:49]
    v_pk_add_f32 v[32:33], v[32:33], v[40:41]
    v_pk_add_f32 v[34:35], v[34:35], v[38:39]
    v_pk_add_f32 v[42:43], v[42:43], v[46:47]
    v_pk_add_f32 v[34:35], v[34:35], v[50:51]
    v_pk_add_f32 v[34:35], v[34:35], v[42:43]
    s_nop 1
    v_add_f32_dpp v32, v32, v32 row_ror:8 row_mask:0xf bank_mask:0xf
    v_add_f32_dpp v33, v33, v33 row_ror:8 row_mask:0xf bank_mask:0xf
    v_add_f32_dpp v34, v34, v34 row_ror:8 row_mask:0xf bank_mask:0xf
    v_add_f32_dpp v35, v35, v35 row_ror:8 row_mask:0xf bank_mask:0xf
    v_mov_b32 v12, v32
    v_mov_b32 v13, v33
    v_mov_b32 v14, v34
    v_mov_b32 v15, v35
    v_permlane16_swap_b32 v12, v32
    v_permlane16_swap_b32 v13, v33
    v_permlane16_swap_b32 v14, v34
    v_permlane16_swap_b32 v15, v35
    v_add_f32 v32, v32, v12
    v_add_f32 v33, v33, v13
    v_add_f32 v34, v34, v14
    v_add_f32 v35, v35, v15
    v_mov_b32 v12, v32
    v_mov_b32 v13, v33
    v_mov_b32 v14, v34
    v_mov_b32 v15, v35
    v_permlane32_swap_b32 v12, v32
    v_permlane32_swap_b32 v13, v33
    v_permlane32_swap_b32 v14, v34
    v_permlane32_swap_b32 v15, v35
    v_add_f32 v32, v32, v12
    v_add_f32 v33, v33, v13
    v_add_f32 v34, v34, v14
    v_add_f32 v35, v35, v15
    ds_write_b128 v10, v[32:35]
    s_waitcnt lgkmcnt(0)
    s_barrier
    s_cmp_lg_u32 s51, 0
    s_cbranch_scc1 L2_fin
    ds_read_b32 v32, v11 offset:15872
    ds_read_b32 v33, v11 offset:16000
    ds_read_b32 v34, v11 offset:16128
    ds_read_b32 v35, v11 offset:16256
    v_lshlrev_b32 v12, 16, v18
    s_mov_b32 exec_hi, 0
    s_waitcnt lgkmcnt(0)
    v_pk_add_f32 v[32:33], v[32:33], v[34:35]
    v_add_f32 v32, v32, v33
    v_fmac_f32 v12, v32, v20
    v_cvt_pk_bf16_f32 v12, v12, v12
    buffer_store_short v12, v9, s[80:83], 0 offen sc1
L2_fin:
L2_end:
    s_endpgm
L2_p0s:
    s_mov_b32 s97, 0x20000
L2_p0:
    buffer_load_dword v51, v156, s[60:63], 0 offen sc1
    s_waitcnt vmcnt(0)
    v_cmp_eq_u32 vcc, 0, v51
    s_sub_u32 s97, s97, 1
    s_cselect_b64 vcc, 0, vcc
    s_cmp_eq_u64 vcc, 0
    s_cbranch_scc1 L2_p0_ok
    s_sleep 1
    s_branch L2_p0
L2_p0_ok:
    s_branch L2_p0r
L2_pms:
    s_mov_b32 s97, 0x20000
L2_pm:
    buffer_load_dwordx4 v[168:171], v166, s[84:87], 0 offen sc1
    buffer_load_dwordx4 v[176:179], v166, s[84:87], s14 offen sc1
    s_mov_b64 exec, 0xff
    buffer_load_dwordx4 v[172:175], v166, s[84:87], 0 offen offset:1024 sc1
    buffer_load_dwordx4 v[180:183], v166, s[84:87], s14 offen offset:1024 sc1
    s_mov_b64 exec, -1
    s_waitcnt vmcnt(0)
    v_max_u32 v13, v168, v169
    v_max3_u32 v13, v13, v170, v171
    v_max3_u32 v13, v13, v172, v173
    v_max3_u32 v13, v13, v174, v175
    v_max3_u32 v13, v13, v176, v177
    v_max3_u32 v13, v13, v178, v179
    v_max3_u32 v13, v13, v180, v181
    v_max3_u32 v13, v13, v182, v183
    v_cmp_eq_u32 vcc, -1, v13
    s_sub_u32 s97, s97, 1
    s_cselect_b64 vcc, 0, vcc
    s_cmp_eq_u64 vcc, 0
    s_cbranch_scc1 L2_pm_ok
    s_sleep 1
    s_branch L2_pm
L2_pm_ok:
    s_branch L2_pmr
L2_g0s:
    s_mov_b32 s97, 0x20000
L2_g0:
    buffer_load_dword v9, v6, s[84:87], s47 offen sc1
    s_waitcnt vmcnt(0)
    v_cmp_ne_u32 vcc, 0, v9
    s_nop 0
    s_lshr_b32 s3, vcc_lo, 1
    s_and_b32 s3, s3, vcc_lo
    s_lshr_b32 s14, s3, 2
    s_and_b32 s3, s3, s14
    s_and_b32 s3, s3, s48
    s_cselect_b64 vcc, 0, -1
    s_sub_u32 s97, s97, 1
    s_cselect_b64 vcc, 0, vcc
    s_cmp_eq_u64 vcc, 0
    s_cbranch_scc1 L2_g0_ok
    s_sleep 1
    s_branch L2_g0
L2_g0_ok:
    s_cmp_eq_u32 s3, 0
    s_cselect_b32 s3, s48, s3
    s_branch L2_g0r
L2_g1s:
    s_mov_b32 s97, 0x20000
L2_g1:
    buffer_load_dword v9, v6, s[84:87], s47 offen sc1
    s_waitcnt vmcnt(0)
    v_cmp_ne_u32 vcc, 0, v9
    s_nop 0
    s_lshr_b32 s3, vcc_lo, 1
    s_and_b32 s3, s3, vcc_lo
    s_lshr_b32 s14, s3, 2
    s_and_b32 s3, s3, s14
    s_and_b32 s3, s3, s48
    s_cselect_b64 vcc, 0, -1
    s_sub_u32 s97, s97, 1
    s_cselect_b64 vcc, 0, vcc
    s_cmp_eq_u64 vcc, 0
    s_cbranch_scc1 L2_g1_ok
    s_sleep 1
    s_branch L2_g1
L2_g1_ok:
    s_cmp_eq_u32 s3, 0
    s_cselect_b32 s3, s48, s3
    s_branch L2_g1r
L2_pns:
    s_mov_b32 s97, 0x20000
L2_pn:
    s_movk_i32 s45, 4608
    buffer_load_dwordx4 v[76:79], v5, s[84:87], s45 offen sc1
    s_movk_i32 s45, 18432
    buffer_load_dwordx4 v[88:91], v5, s[84:87], s45 offen sc1
    s_movk_i32 s45, 8704
    buffer_load_dwordx4 v[80:83], v5, s[84:87], s45 offen sc1
    s_movk_i32 s45, 22528
    buffer_load_dwordx4 v[92:95], v5, s[84:87], s45 offen sc1
    s_movk_i32 s45, 12800
    buffer_load_dwordx4 v[84:87], v59, s[84:87], s45 offen sc1
    s_movk_i32 s45, 26624
    buffer_load_dwordx4 v[96:99], v59, s[84:87], s45 offen sc1
    s_waitcnt vmcnt(0)
    v_max_u32 v13, v76, v77
    v_max3_u32 v13, v13, v78, v79
    v_max3_u32 v13, v13, v88, v89
    v_max3_u32 v13, v13, v90, v91
    v_max3_u32 v13, v13, v80, v81
    v_max3_u32 v13, v13, v82, v83
    v_max3_u32 v13, v13, v92, v93
    v_max3_u32 v13, v13, v94, v95
    v_max3_u32 v13, v13, v84, v85
    v_max3_u32 v13, v13, v86, v87
    v_max3_u32 v13, v13, v96, v97
    v_max3_u32 v13, v13, v98, v99
    v_cmp_eq_u32 vcc, -1, v13
    s_sub_u32 s97, s97, 1
    s_cselect_b64 vcc, 0, vcc
    s_cmp_eq_u64 vcc, 0
    s_cbranch_scc1 L2_pn_ok
    s_sleep 1
    s_branch L2_pn
L2_pn_ok:
    s_branch L2_pnr
L2_g2s:
    s_mov_b32 s97, 0x20000
L2_g2:
    buffer_load_dword v9, v6, s[84:87], s47 offen sc1
    s_waitcnt vmcnt(0)
    v_cmp_ne_u32 vcc, 0, v9
    s_nop 0
    s_lshr_b32 s3, vcc_lo, 1
    s_and_b32 s3, s3, vcc_lo
    s_lshr_b32 s14, s3, 2
    s_and_b32 s3, s3, s14
    s_and_b32 s3, s3, s48
    s_cselect_b64 vcc, 0, -1
    s_sub_u32 s97, s97, 1
    s_cselect_b64 vcc, 0, vcc
    s_cmp_eq_u64 vcc, 0
    s_cbranch_scc1 L2_g2_ok
    s_sleep 1
    s_branch L2_g2
L2_g2_ok:
    s_cmp_eq_u32 s3, 0
    s_cselect_b32 s3, s48, s3
    s_branch L2_g2r
L2_g3s:
    s_mov_b32 s97, 0x20000
L2_g3:
    buffer_load_dword v9, v6, s[84:87], s47 offen sc1
    s_waitcnt vmcnt(0)
    v_cmp_ne_u32 vcc, 0, v9
    s_nop 0
    s_lshr_b32 s3, vcc_lo, 1
    s_and_b32 s3, s3, vcc_lo
    s_lshr_b32 s14, s3, 2
    s_and_b32 s3, s3, s14
    s_and_b32 s3, s3, s48
    s_cselect_b64 vcc, 0, -1
    s_sub_u32 s97, s97, 1
    s_cselect_b64 vcc, 0, vcc
    s_cmp_eq_u64 vcc, 0
    s_cbranch_scc1 L2_g3_ok
    s_sleep 1
    s_branch L2_g3
L2_g3_ok:
    s_cmp_eq_u32 s3, 0
    s_cselect_b32 s3, s48, s3
    s_branch L2_g3r
L2_hs:
    s_mov_b32 s97, 0x20000
L2_h:
    buffer_load_dwordx4 v[128:131], v5, s[84:87], s59 offen offset:0 sc1
    buffer_load_dwordx4 v[132:135], v5, s[84:87], s59 offen offset:256 sc1
    buffer_load_dwordx4 v[136:139], v5, s[84:87], s59 offen offset:512 sc1
    buffer_load_dwordx4 v[140:143], v5, s[84:87], s59 offen offset:768 sc1
    buffer_load_dwordx4 v[144:147], v3, s[84:87], s59 offen offset:1024 sc1
    s_waitcnt vmcnt(0)
    v_max_u32 v12, v128, v129
    v_max3_u32 v12, v12, v130, v131
    v_max3_u32 v12, v12, v132, v133
    v_max3_u32 v12, v12, v134, v135
    v_max3_u32 v12, v12, v136, v137
    v_max3_u32 v12, v12, v138, v139
    v_max3_u32 v12, v12, v140, v141
    v_max3_u32 v12, v12, v142, v143
    v_max3_u32 v12, v12, v144, v145
    v_max3_u32 v12, v12, v146, v147
    v_cmp_eq_u32 vcc, -1, v12
    s_sub_u32 s97, s97, 1
    s_cselect_b64 vcc, 0, vcc
    s_cmp_eq_u64 vcc, 0
    s_cbranch_scc1 L2_h_ok
    s_sleep 1
    s_branch L2_h
L2_h_ok:
    v_min_u32 v128, -2, v128
    v_min_u32 v129, -2, v129
    v_min_u32 v130, -2, v130
    v_min_u32 v131, -2, v131
    v_min_u32 v132, -2, v132
    v_min_u32 v133, -2, v133
    v_min_u32 v134, -2, v134
    v_min_u32 v135, -2, v135
    v_min_u32 v136, -2, v136
    v_min_u32 v137, -2, v137
    v_min_u32 v138, -2, v138
    v_min_u32 v139, -2, v139
    v_min_u32 v140, -2, v140
    v_min_u32 v141, -2, v141
    v_min_u32 v142, -2, v142
    v_min_u32 v143, -2, v143
    v_min_u32 v144, -2, v144
    v_min_u32 v145, -2, v145
    v_min_u32 v146, -2, v146
    v_min_u32 v147, -2, v147
    s_nop 1
    s_branch L2_hr
L2_fallback:
    s_waitcnt vmcnt(0) lgkmcnt(0)
    s_nop 7
    s_barrier
    s_lshl_b32 s3, s51, 12
    v_add_u32 v5, s3, v8
    v_lshrrev_b32 v14, 2, v0
    v_mul_u32_u24 v14, 1056, v14
    v_and_b32 v15, 3, v0
    v_lshl_add_u32 v14, v15, 3, v14
    v_add_u32 v2, 107008, v14
    v_and_b32 v14, 15, v0
    v_mul_u32_u24 v14, 1056, v14
    v_lshrrev_b32 v15, 4, v0
    v_lshl_add_u32 v14, v15, 4, v14
    v_add_u32 v1, 90112, v14
    v_mov_b32 v32, 0xff800000
    v_mov_b32 v33, 0xff800000
    v_mov_b32 v34, 0xff800000
    v_mov_b32 v35, 0xff800000
    s_mov_b32 s50, 1
    s_mov_b32 s46, 0
L2_fb_loop:
    s_add_u32 m0, s44, 73728
    s_nop 0
    buffer_load_dwordx4 off, s[16:19], s46 offset:0 lds
    s_add_u32 m0, s44, 73760
    s_nop 0
    buffer_load_dwordx4 off, s[16:19], s46 offset:1024 lds
    s_add_u32 m0, s44, 73792
    s_nop 0
    buffer_load_dwordx4 off, s[16:19], s46 offset:2048 lds
    s_add_u32 m0, s44, 73824
    s_nop 0
    buffer_load_dwordx4 off, s[16:19], s46 offset:3072 lds
    s_waitcnt vmcnt(0) lgkmcnt(0)
    s_barrier
    ds_read_b128 a[64:67], v1 offset:0
    ds_read_b128 a[68:71], v1 offset:64
    ds_read_b128 a[72:75], v1 offset:128
    ds_read_b128 a[76:79], v1 offset:192
    ds_read_b128 a[80:83], v1 offset:256
    ds_read_b128 a[84:87], v1 offset:320
    ds_read_b128 a[88:91], v1 offset:384
    ds_read_b128 a[92:95], v1 offset:448
    ds_read_b128 a[96:99], v1 offset:512
    ds_read_b128 a[100:103], v1 offset:576
    ds_read_b128 a[104:107], v1 offset:640
    ds_read_b128 a[108:111], v1 offset:704
    ds_read_b128 a[112:115], v1 offset:768
    ds_read_b128 a[116:119], v1 offset:832
    ds_read_b128 a[120:123], v1 offset:896
    ds_read_b128 a[124:127], v1 offset:960
    s_waitcnt vmcnt(0) lgkmcnt(0)
    s_barrier
    v_mfma_f32_16x16x32_bf16 v[16:19], a[64:67], v[64:67], 0
    v_mfma_f32_16x16x32_bf16 v[16:19], a[68:71], v[68:71], v[16:19]
    v_mfma_f32_16x16x32_bf16 v[16:19], a[72:75], v[72:75], v[16:19]
    v_mfma_f32_16x16x32_bf16 v[16:19], a[76:79], v[76:79], v[16:19]
    v_mfma_f32_16x16x32_bf16 v[20:23], a[80:83], v[64:67], 0
    v_mfma_f32_16x16x32_bf16 v[20:23], a[84:87], v[68:71], v[20:23]
    v_mfma_f32_16x16x32_bf16 v[20:23], a[88:91], v[72:75], v[20:23]
    v_mfma_f32_16x16x32_bf16 v[20:23], a[92:95], v[76:79], v[20:23]
    v_mfma_f32_16x16x32_bf16 v[24:27], a[96:99], v[64:67], 0
    v_mfma_f32_16x16x32_bf16 v[24:27], a[100:103], v[68:71], v[24:27]
    v_mfma_f32_16x16x32_bf16 v[24:27], a[104:107], v[72:75], v[24:27]
    v_mfma_f32_16x16x32_bf16 v[24:27], a[108:111], v[76:79], v[24:27]
    v_mfma_f32_16x16x32_bf16 v[28:31], a[112:115], v[64:67], 0
    v_mfma_f32_16x16x32_bf16 v[28:31], a[116:119], v[68:71], v[28:31]
    v_mfma_f32_16x16x32_bf16 v[28:31], a[120:123], v[72:75], v[28:31]
    v_mfma_f32_16x16x32_bf16 v[28:31], a[124:127], v[76:79], v[28:31]
    s_nop 7
    v_max3_f32 v32, v32, v16, v17
    v_max3_f32 v32, v32, v18, v19
    v_max3_f32 v32, v32, v20, v21
    v_max3_f32 v32, v32, v22, v23
    v_max3_f32 v32, v32, v24, v25
    v_max3_f32 v32, v32, v26, v27
    v_max3_f32 v32, v32, v28, v29
    v_max3_f32 v32, v32, v30, v31
    v_mfma_f32_16x16x32_bf16 v[16:19], a[64:67], v[80:83], 0
    v_mfma_f32_16x16x32_bf16 v[16:19], a[68:71], v[84:87], v[16:19]
    v_mfma_f32_16x16x32_bf16 v[16:19], a[72:75], v[88:91], v[16:19]
    v_mfma_f32_16x16x32_bf16 v[16:19], a[76:79], v[92:95], v[16:19]
    v_mfma_f32_16x16x32_bf16 v[20:23], a[80:83], v[80:83], 0
    v_mfma_f32_16x16x32_bf16 v[20:23], a[84:87], v[84:87], v[20:23]
    v_mfma_f32_16x16x32_bf16 v[20:23], a[88:91], v[88:91], v[20:23]
    v_mfma_f32_16x16x32_bf16 v[20:23], a[92:95], v[92:95], v[20:23]
    v_mfma_f32_16x16x32_bf16 v[24:27], a[96:99], v[80:83], 0
    v_mfma_f32_16x16x32_bf16 v[24:27], a[100:103], v[84:87], v[24:27]
    v_mfma_f32_16x16x32_bf16 v[24:27], a[104:107], v[88:91], v[24:27]
    v_mfma_f32_16x16x32_bf16 v[24:27], a[108:111], v[92:95], v[24:27]
    v_mfma_f32_16x16x32_bf16 v[28:31], a[112:115], v[80:83], 0
    v_mfma_f32_16x16x32_bf16 v[28:31], a[116:119], v[84:87], v[28:31]
    v_mfma_f32_16x16x32_bf16 v[28:31], a[120:123], v[88:91], v[28:31]
    v_mfma_f32_16x16x32_bf16 v[28:31], a[124:127], v[92:95], v[28:31]
    s_nop 7
    v_max3_f32 v33, v33, v16, v17
    v_max3_f32 v33, v33, v18, v19
    v_max3_f32 v33, v33, v20, v21
    v_max3_f32 v33, v33, v22, v23
    v_max3_f32 v33, v33, v24, v25
    v_max3_f32 v33, v33, v26, v27
    v_max3_f32 v33, v33, v28, v29
    v_max3_f32 v33, v33, v30, v31
    v_mfma_f32_16x16x32_bf16 v[16:19], a[64:67], v[96:99], 0
    v_mfma_f32_16x16x32_bf16 v[16:19], a[68:71], v[100:103], v[16:19]
    v_mfma_f32_16x16x32_bf16 v[16:19], a[72:75], v[104:107], v[16:19]
    v_mfma_f32_16x16x32_bf16 v[16:19], a[76:79], v[108:111], v[16:19]
    v_mfma_f32_16x16x32_bf16 v[20:23], a[80:83], v[96:99], 0
    v_mfma_f32_16x16x32_bf16 v[20:23], a[84:87], v[100:103], v[20:23]
    v_mfma_f32_16x16x32_bf16 v[20:23], a[88:91], v[104:107], v[20:23]
    v_mfma_f32_16x16x32_bf16 v[20:23], a[92:95], v[108:111], v[20:23]
    v_mfma_f32_16x16x32_bf16 v[24:27], a[96:99], v[96:99], 0
    v_mfma_f32_16x16x32_bf16 v[24:27], a[100:103], v[100:103], v[24:27]
    v_mfma_f32_16x16x32_bf16 v[24:27], a[104:107], v[104:107], v[24:27]
    v_mfma_f32_16x16x32_bf16 v[24:27], a[108:111], v[108:111], v[24:27]
    v_mfma_f32_16x16x32_bf16 v[28:31], a[112:115], v[96:99], 0
    v_mfma_f32_16x16x32_bf16 v[28:31], a[116:119], v[100:103], v[28:31]
    v_mfma_f32_16x16x32_bf16 v[28:31], a[120:123], v[104:107], v[28:31]
    v_mfma_f32_16x16x32_bf16 v[28:31], a[124:127], v[108:111], v[28:31]
    s_nop 7
    v_max3_f32 v34, v34, v16, v17
    v_max3_f32 v34, v34, v18, v19
    v_max3_f32 v34, v34, v20, v21
    v_max3_f32 v34, v34, v22, v23
    v_max3_f32 v34, v34, v24, v25
    v_max3_f32 v34, v34, v26, v27
    v_max3_f32 v34, v34, v28, v29
    v_max3_f32 v34, v34, v30, v31
    v_mfma_f32_16x16x32_bf16 v[16:19], a[64:67], v[112:115], 0
    v_mfma_f32_16x16x32_bf16 v[16:19], a[68:71], v[116:119], v[16:19]
    v_mfma_f32_16x16x32_bf16 v[16:19], a[72:75], v[120:123], v[16:19]
    v_mfma_f32_16x16x32_bf16 v[16:19], a[76:79], v[124:127], v[16:19]
    v_mfma_f32_16x16x32_bf16 v[20:23], a[80:83], v[112:115], 0
    v_mfma_f32_16x16x32_bf16 v[20:23], a[84:87], v[116:119], v[20:23]
    v_mfma_f32_16x16x32_bf16 v[20:23], a[88:91], v[120:123], v[20:23]
    v_mfma_f32_16x16x32_bf16 v[20:23], a[92:95], v[124:127], v[20:23]
    v_mfma_f32_16x16x32_bf16 v[24:27], a[96:99], v[112:115], 0
    v_mfma_f32_16x16x32_bf16 v[24:27], a[100:103], v[116:119], v[24:27]
    v_mfma_f32_16x16x32_bf16 v[24:27], a[104:107], v[120:123], v[24:27]
    v_mfma_f32_16x16x32_bf16 v[24:27], a[108:111], v[124:127], v[24:27]
    v_mfma_f32_16x16x32_bf16 v[28:31], a[112:115], v[112:115], 0
    v_mfma_f32_16x16x32_bf16 v[28:31], a[116:119], v[116:119], v[28:31]
    v_mfma_f32_16x16x32_bf16 v[28:31], a[120:123], v[120:123], v[28:31]
    v_mfma_f32_16x16x32_bf16 v[28:31], a[124:127], v[124:127], v[28:31]
    s_nop 7
    v_max3_f32 v35, v35, v16, v17
    v_max3_f32 v35, v35, v18, v19
    v_max3_f32 v35, v35, v20, v21
    v_max3_f32 v35, v35, v22, v23
    v_max3_f32 v35, v35, v24, v25
    v_max3_f32 v35, v35, v26, v27
    v_max3_f32 v35, v35, v28, v29
    v_max3_f32 v35, v35, v30, v31
    s_add_u32 s46, s46, 16384
    s_cmp_lt_u32 s46, 524288
    s_cbranch_scc1 L2_fb_loop
    v_mov_b32 v40, v32
    v_mov_b32 v41, v33
    v_mov_b32 v42, v34
    v_mov_b32 v43, v35
    v_permlane16_swap_b32 v40, v32
    v_permlane16_swap_b32 v41, v33
    v_permlane16_swap_b32 v42, v34
    v_permlane16_swap_b32 v43, v35
    v_max_f32 v32, v32, v40
    v_max_f32 v33, v33, v41
    v_max_f32 v34, v34, v42
    v_max_f32 v35, v35, v43
    v_mov_b32 v40, v32
    v_mov_b32 v41, v33
    v_mov_b32 v42, v34
    v_mov_b32 v43, v35
    v_permlane32_swap_b32 v40, v32
    v_permlane32_swap_b32 v41, v33
    v_permlane32_swap_b32 v42, v34
    v_permlane32_swap_b32 v43, v35
    v_max_f32 v32, v32, v40
    v_max_f32 v33, v33, v41
    v_max_f32 v34, v34, v42
    v_max_f32 v35, v35, v43
    v_sub_f32 v48, 0x80000000, v32
    v_sub_f32 v49, 0x80000000, v32
    v_sub_f32 v50, 0x80000000, v32
    v_sub_f32 v51, 0x80000000, v32
    v_sub_f32 v52, 0x80000000, v33
    v_sub_f32 v53, 0x80000000, v33
    v_sub_f32 v54, 0x80000000, v33
    v_sub_f32 v55, 0x80000000, v33
    v_sub_f32 v56, 0x80000000, v34
    v_sub_f32 v57, 0x80000000, v34
    v_sub_f32 v58, 0x80000000, v34
    v_sub_f32 v59, 0x80000000, v34
    v_sub_f32 v60, 0x80000000, v35
    v_sub_f32 v61, 0x80000000, v35
    v_sub_f32 v62, 0x80000000, v35
    v_sub_f32 v63, 0x80000000, v35
    s_add_u32 m0, s44, 73728
    s_mov_b32 s46, 0
    buffer_load_dwordx4 off, s[16:19], s46 offset:0 lds
    s_add_u32 m0, s44, 73760
    s_nop 0
    buffer_load_dwordx4 off, s[16:19], s46 offset:1024 lds
    s_add_u32 m0, s44, 73792
    s_nop 0
    buffer_load_dwordx4 off, s[16:19], s46 offset:2048 lds
    s_add_u32 m0, s44, 73824
    s_nop 0
    buffer_load_dwordx4 off, s[16:19], s46 offset:3072 lds
    s_add_u32 m0, s44, 90624
    s_nop 0
    buffer_load_dwordx4 off, s[20:23], s46 offset:0 lds
    s_add_u32 m0, s44, 90656
    s_nop 0
    buffer_load_dwordx4 off, s[20:23], s46 offset:1024 lds
    s_add_u32 m0, s44, 90688
    s_nop 0
    buffer_load_dwordx4 off, s[20:23], s46 offset:2048 lds
    s_add_u32 m0, s44, 90720
    s_nop 0
    buffer_load_dwordx4 off, s[20:23], s46 offset:3072 lds
    s_add_u32 m0, s44, 110592
    s_mov_b32 s46, 16384
    buffer_load_dwordx4 off, s[16:19], s46 offset:0 lds
    s_add_u32 m0, s44, 110624
    s_nop 0
    buffer_load_dwordx4 off, s[16:19], s46 offset:1024 lds
    s_add_u32 m0, s44, 110656
    s_nop 0
    buffer_load_dwordx4 off, s[16:19], s46 offset:2048 lds
    s_add_u32 m0, s44, 110688
    s_nop 0
    buffer_load_dwordx4 off, s[16:19], s46 offset:3072 lds
    s_add_u32 m0, s44, 127488
    s_nop 0
    buffer_load_dwordx4 off, s[20:23], s46 offset:0 lds
    s_add_u32 m0, s44, 127520
    s_nop 0
    buffer_load_dwordx4 off, s[20:23], s46 offset:1024 lds
    s_add_u32 m0, s44, 127552
    s_nop 0
    buffer_load_dwordx4 off, s[20:23], s46 offset:2048 lds
    s_add_u32 m0, s44, 127584
    s_nop 0
    buffer_load_dwordx4 off, s[20:23], s46 offset:3072 lds
    s_add_u32 m0, s44, 0
    s_mov_b32 s46, 32768
    buffer_load_dwordx4 off, s[16:19], s46 offset:0 lds
    s_add_u32 m0, s44, 32
    s_nop 0
    buffer_load_dwordx4 off, s[16:19], s46 offset:1024 lds
    s_add_u32 m0, s44, 64
    s_nop 0
    buffer_load_dwordx4 off, s[16:19], s46 offset:2048 lds
    s_add_u32 m0, s44, 96
    s_nop 0
    buffer_load_dwordx4 off, s[16:19], s46 offset:3072 lds
    s_add_u32 m0, s44, 16896
    s_nop 0
    buffer_load_dwordx4 off, s[20:23], s46 offset:0 lds
    s_add_u32 m0, s44, 16928
    s_nop 0
    buffer_load_dwordx4 off, s[20:23], s46 offset:1024 lds
    s_add_u32 m0, s44, 16960
    s_nop 0
    buffer_load_dwordx4 off, s[20:23], s46 offset:2048 lds
    s_add_u32 m0, s44, 16992
    s_nop 0
    buffer_load_dwordx4 off, s[20:23], s46 offset:3072 lds
    s_waitcnt vmcnt(0) lgkmcnt(0)
    s_barrier
    ds_read_b128 a[64:67], v1 offset:0
    ds_read_b128 a[68:71], v1 offset:64
    ds_read_b128 a[72:75], v1 offset:128
    ds_read_b128 a[76:79], v1 offset:192
    ds_read_b128 a[80:83], v1 offset:256
    ds_read_b128 a[84:87], v1 offset:320
    ds_read_b128 a[88:91], v1 offset:384
    ds_read_b128 a[92:95], v1 offset:448
    ds_read_b128 a[96:99], v1 offset:512
    ds_read_b128 a[100:103], v1 offset:576
    ds_read_b128 a[104:107], v1 offset:640
    ds_read_b128 a[108:111], v1 offset:704
    ds_read_b128 a[112:115], v1 offset:768
    ds_read_b128 a[116:119], v1 offset:832
    ds_read_b128 a[120:123], v1 offset:896
    ds_read_b128 a[124:127], v1 offset:960
    v_lshrrev_b32 v14, 2, v0
    s_mul_i32 s3, s51, 144
    v_add_u32 v14, s3, v14
    v_mul_u32_u24 v14, 9216, v14
    v_and_b32 v15, 3, v0
    v_lshl_add_u32 v6, v15, 4, v14
    s_lshr_b32 s3, s2, 3
    s_lshl2_add_u32 s3, s3, s51
    s_and_b32 s15, s2, 7
    v_lshlrev_b32 v9, 7, v0
    s_mul_i32 s14, s3, 9
    s_lshr_b32 s14, s14, 1
    v_min_u32 v15, 44, v0
    v_mul_u32_u24 v12, 7282, v15
    v_lshrrev_b32 v12, 16, v12
    v_mul_u32_u24 v13, 63, v12
    v_add_u32 v12, v15, v13
    s_mul_i32 s14, s14, 72
    s_mul_i32 s56, s15, 9
    s_add_u32 s14, s14, s56
    v_add_lshl_u32 v12, s14, v12, 7
    s_mul_i32 s14, s3, 81
    s_lshr_b32 s14, s14, 1
    s_mul_i32 s56, s15, 5184
    s_add_u32 s14, s14, s56
    v_min_u32 v13, 40, v0
    v_add_lshl_u32 v13, s14, v13, 7
    s_mul_i32 s14, s3, 72
    s_andn2_b32 s56, s52, 3
    s_mul_i32 s56, s56, 2304
    s_add_u32 s14, s14, s56
    v_min_u32 v14, 35, v0
    v_add_lshl_u32 v14, s14, v14, 7
    v_add_u32 v15, 4608, v14
    v_accvgpr_write_b32 a0, 0
    v_accvgpr_write_b32 a1, 0
    v_accvgpr_write_b32 a2, 0
    v_accvgpr_write_b32 a3, 0
    v_accvgpr_write_b32 a4, 0
    v_accvgpr_write_b32 a5, 0
    v_accvgpr_write_b32 a6, 0
    v_accvgpr_write_b32 a7, 0
    v_accvgpr_write_b32 a8, 0
    v_accvgpr_write_b32 a9, 0
    v_accvgpr_write_b32 a10, 0
    v_accvgpr_write_b32 a11, 0
    v_accvgpr_write_b32 a12, 0
    v_accvgpr_write_b32 a13, 0
    v_accvgpr_write_b32 a14, 0
    v_accvgpr_write_b32 a15, 0
    s_waitcnt vmcnt(0) lgkmcnt(0)
    s_branch L2_entry
L2_codeend:

.section .rodata,"a"
.p2align 6
.amdhsa_kernel adaLN_cond__gqa_block_cached__moe_arch_mod__prompt_kernel
  .amdhsa_next_free_vgpr 512
  .amdhsa_next_free_sgpr 102
  .amdhsa_accum_offset 256
  .amdhsa_group_segment_fixed_size 0
  .amdhsa_kernarg_size 120
  .amdhsa_user_sgpr_count 2
  .amdhsa_user_sgpr_kernarg_segment_ptr 1
  .amdhsa_system_sgpr_workgroup_id_x 1
  .amdhsa_float_denorm_mode_32 3
.end_amdhsa_kernel
```
